```python
import torch

def _softmax(x, axis=-1):
    return torch.softmax(x, dim=axis)

def _gelu(x):
    return torch.nn.functional.gelu(x, approximate='tanh')

def _silu(x):
    return torch.nn.functional.silu(x)

def _sigmoid(x):
    return torch.sigmoid(x)

def _layernorm(x, axis=-1, eps=1e-05):
    m = x.mean(dim=axis, keepdim=True)
    v = x.var(dim=axis, keepdim=True, unbiased=False)
    return (x - m) / torch.sqrt(v + eps)

def _scatter_add(tgt, idx, src, axis=0):
    return tgt.clone().index_add_(axis, idx, src)

def _segment_sum(src, seg, n):
    out = torch.zeros((n,) + src.shape[1:], dtype=src.dtype)
    return out.index_add_(0, seg, src)

def _pad(x, pw):
    flat = tuple((v for pair in reversed(pw) for v in pair))
    return torch.nn.functional.pad(x, flat)
kernel_name = 'concat_heads__compressed_kv_cla__memory_aug_recurrent_mem_tr__prompt'

def setup_inputs():

    _w = lambda a: (lambda t: t.to(torch.bfloat16) if t.is_floating_point() else t)(torch.as_tensor(a))

    def _A_setup():
        B, H, Sq, Sk, D, M = (1, 32, 2048, 2048, 128, 576)
        Dc = 4 * D
        return {'x': _w((lambda *s: torch.randn(*s, dtype=torch.bfloat16) * 1.6)(B, Sq, M)), 'c_kv': _w((lambda *s: torch.randn(*s, dtype=torch.bfloat16) * 0.2)(B, Sk, Dc)), 'w_q': _w((lambda *s: torch.randn(*s, dtype=torch.bfloat16) * 3.2)(M, H, D) * M ** (-0.5)), 'w_uk': _w((lambda *s: torch.randn(*s, dtype=torch.bfloat16) * 3.2)(Dc, H, D) * Dc ** (-0.5)), 'w_uv': _w((lambda *s: torch.randn(*s, dtype=torch.bfloat16) * 0.2)(Dc, H, D) * Dc ** (-0.5)), 'w_o': _w((lambda *s: torch.randn(*s, dtype=torch.bfloat16) * 0.2)(H, D, M) * (H * D) ** (-0.5))}
    _A_in = _A_setup()

    def _B_setup():
        B, S, Dm = (1, 2048, 576)
        H, Dh = (32, 128)
        M, seg = (8, 32)
        seg = min(seg, S)
        S = S // seg * seg
        return {'x': _w((lambda *s: torch.randn(*s, dtype=torch.bfloat16) * 0.05)(B, S, Dm)), 'mem0': _w((lambda *s: torch.randn(*s, dtype=torch.bfloat16) * 0.4)(B, M, Dm)), 'Wq': _w((lambda *s: torch.randn(*s, dtype=torch.bfloat16) * 6.4)(Dm, H, Dh) * Dm ** (-0.5)), 'Wk': _w((lambda *s: torch.randn(*s, dtype=torch.bfloat16) * 6.4)(Dm, H, Dh) * Dm ** (-0.5)), 'Wv': _w((lambda *s: torch.randn(*s, dtype=torch.bfloat16) * 0.4)(Dm, H, Dh) * Dm ** (-0.5)), 'Wo': _w((lambda *s: torch.randn(*s, dtype=torch.bfloat16) * 0.4)(H, Dh, Dm) * (H * Dh) ** (-0.5)), 'seg_len': seg}
    _B_in = _B_setup()
    return {'A_x': _A_in['x'], 'A_c_kv': _A_in['c_kv'], 'A_w_q': _A_in['w_q'], 'A_w_uk': _A_in['w_uk'], 'A_w_uv': _A_in['w_uv'], 'A_w_o': _A_in['w_o'], 'B_x': _B_in['x'], 'B_mem0': _B_in['mem0'], 'B_Wq': _B_in['Wq'], 'B_Wk': _B_in['Wk'], 'B_Wv': _B_in['Wv'], 'B_Wo': _B_in['Wo'], 'B_seg_len': _B_in['seg_len']}

def reference(A_x, A_c_kv, A_w_q, A_w_uk, A_w_uv, A_w_o, B_x, B_mem0, B_Wq, B_Wk, B_Wv, B_Wo, B_seg_len):

    def _A_ref(x, c_kv, w_q, w_uk, w_uv, w_o):
        B, Sq, M = (x.shape[0], x.shape[1], x.shape[2])
        Sk = c_kv.shape[1]
        H, D = (w_q.shape[1], w_q.shape[2])
        q = torch.einsum('bqm,mhd->bhqd', x, w_q)
        k = torch.einsum('bkc,chd->bhkd', c_kv, w_uk)
        v = torch.einsum('bkc,chd->bhkd', c_kv, w_uv)
        scores = torch.einsum('bhqd,bhkd->bhqk', q, k) * D ** (-0.5)
        off = Sk - Sq
        qi = torch.arange(Sq)[:, None]
        kj = torch.arange(Sk)[None, :]
        cmask = kj <= qi + off
        scores = torch.where(cmask[None, None], scores, -1000000000.0)
        p = _softmax(scores, axis=-1)
        ctx = torch.einsum('bhqk,bhkd->bhqd', p, v)
        return torch.einsum('bhqd,hdm->bqm', ctx, w_o)

    def _B_ref(x, mem0, Wq, Wk, Wv, Wo, seg_len):
        B, S, Dm = x.shape
        H, Dh = (Wq.shape[1], Wq.shape[2])
        M = mem0.shape[1]
        scale = Dh ** (-0.5)
        n_seg = S // seg_len
        L = M + seg_len
        idx = torch.arange(L)
        mask = (idx[:, None] < M) | (idx[:, None] >= idx[None, :])
        mem = mem0
        outs = []
        for s in range(n_seg):
            xs = x[:, s * seg_len:(s + 1) * seg_len, :].clone()
            h = torch.concatenate([mem, xs], axis=1)
            q = torch.einsum('btd,dhe->bhte', h, Wq)
            k = torch.einsum('btd,dhe->bhte', h, Wk)
            v = torch.einsum('btd,dhe->bhte', h, Wv)
            scores = torch.einsum('bhqe,bhke->bhqk', q, k) * scale
            scores = torch.where(mask[None, None], scores, -1000000000.0)
            p = _softmax(scores, axis=-1)
            o = torch.einsum('bhqk,bhke->bhqe', p, v)
            o = torch.einsum('bhte,hed->btd', o, Wo)
            mem = o[:, :M, :].clone()
            outs.append(o[:, M:, :])
        return torch.concatenate(outs, axis=1)
    a = _A_ref(A_x, A_c_kv, A_w_q, A_w_uk, A_w_uv, A_w_o)
    b = _B_ref(B_x, B_mem0, B_Wq, B_Wk, B_Wv, B_Wo, B_seg_len)
    return torch.concatenate([a, b], axis=-1)
```

```asm
; @launch grid=(256,1,1) block=(256,1,1) lds=163840
.amdgcn_target "amdgcn-amd-amdhsa--gfx950"
.text
.globl concat_heads__compressed_kv_cla__memory_aug_recurrent_mem_tr__prompt_kernel
.p2align 8
.type concat_heads__compressed_kv_cla__memory_aug_recurrent_mem_tr__prompt_kernel,@function
concat_heads__compressed_kv_cla__memory_aug_recurrent_mem_tr__prompt_kernel:
s_cmp_ge_u32 s2, 256
s_cbranch_scc1 L_end
s_getreg_b32 s3, hwreg(HW_REG_XCC_ID)
s_and_b32 s3, s3, 7
s_load_dwordx2 s[4:5], s[0:1], 120
s_load_dwordx2 s[6:7], s[0:1], 112
v_lshrrev_b32 v1, 6, v0
s_nop 0
v_readfirstlane_b32 s17, v1
s_waitcnt lgkmcnt(0)
s_mov_b32 s8, s4
s_and_b32 s9, s5, 0xffff
s_mov_b32 s10, 268435456
s_mov_b32 s11, 0x20000
s_mov_b32 s56, s6
s_and_b32 s57, s7, 0xffff
s_mov_b32 s58, 256
s_mov_b32 s59, 0x20000
s_cmp_eq_u32 s17, 0
s_cbranch_scc0 L_tk
s_mov_b64 exec, 1
v_mov_b32 v1, 1
s_lshl_b32 s24, s3, 2
v_mov_b32 v2, 0
buffer_atomic_add v1, v2, s[56:59], s24 offen sc0
s_waitcnt vmcnt(0)
ds_write_b32 v2, v1
s_waitcnt lgkmcnt(0)
s_mov_b64 exec, -1
L_tk:
s_barrier
v_mov_b32 v2, 0
ds_read_b32 v1, v2
s_waitcnt lgkmcnt(0)
v_readfirstlane_b32 s16, v1
s_barrier
s_cmp_ge_u32 s16, 32
s_cbranch_scc1 L_end
s_cmp_eq_u32 s3, 0
s_cbranch_scc1 L_team
s_cmp_eq_u32 s3, 1
s_cbranch_scc1 L_bkv
s_cmp_eq_u32 s3, 2
s_cbranch_scc1 L_batt
s_cmp_eq_u32 s3, 3
s_cbranch_scc1 L_bout
s_sub_u32 s24, s3, 4
s_lshl_b32 s24, s24, 3
s_lshr_b32 s42, s16, 2
s_add_u32 s42, s42, s24
s_and_b32 s62, s16, 3
s_load_dwordx2 s[4:5], s[0:1], 8
s_waitcnt lgkmcnt(0)
s_mov_b32 s12, s4
s_and_b32 s13, s5, 0xffff
s_mov_b32 s14, 2097152
s_mov_b32 s15, 0x20000
s_load_dwordx2 s[4:5], s[0:1], 24
s_load_dwordx2 s[6:7], s[0:1], 32
s_waitcnt lgkmcnt(0)
s_cmp_ge_u32 s17, 2
s_cselect_b64 s[4:5], s[6:7], s[4:5]
s_mov_b32 s20, s4
s_and_b32 s21, s5, 0xffff
s_mov_b32 s22, 4194304
s_mov_b32 s23, 0x20000
s_lshl_b32 s26, s42, 8
v_lshrrev_b32 v15, 6, v0
v_lshlrev_b32 v15, 6, v15
v_bfe_u32 v16, v0, 2, 4
v_add_u32 v15, v15, v16
v_mul_u32_u24 v15, 1024, v15
v_bfe_u32 v16, v0, 4, 2
v_and_b32 v17, 3, v0
v_xor_b32 v17, v17, v16
v_lshl_add_u32 v1, v17, 4, v15
v_add_u32 v2, 15360, v1
v_add_u32 v3, 30720, v1
v_add_u32 v4, 46080, v1
v_bfe_u32 v15, v0, 2, 2
v_xor_b32 v15, v15, v16
v_lshlrev_b32 v15, 6, v15
v_and_b32 v17, 3, v0
v_lshl_add_u32 v15, v17, 4, v15
v_lshl_add_u32 v15, v16, 13, v15
s_and_b32 s24, s17, 1
s_lshl_b32 s24, s24, 17
s_add_u32 s24, s24, s26
v_add_u32 v5, s24, v15
v_add_u32 v6, 31744, v5
v_add_u32 v7, 63488, v5
v_add_u32 v8, 95232, v5
s_lshl_b32 s37, s17, 12
s_lshl_b32 s38, s17, 12
s_add_u32 s38, s38, 16384
s_mov_b32 s60, s62
L_akv:
s_lshl_b32 s36, s60, 18
s_mov_b32 s32, s36
s_mov_b32 s33, 0
s_mov_b32 s34, s37
s_mov_b32 s35, s38
s_mov_b32 m0, s34
s_nop 0
buffer_load_dwordx4 v1, s[12:15], s32 offen offset:0 lds
buffer_load_dwordx4 v2, s[12:15], s32 offen offset:1024 lds
buffer_load_dwordx4 v3, s[12:15], s32 offen offset:2048 lds
buffer_load_dwordx4 v4, s[12:15], s32 offen offset:3072 lds
s_mov_b32 m0, s35
s_nop 0
buffer_load_dwordx4 v5, s[20:23], s33 offen offset:0 lds
buffer_load_dwordx4 v6, s[20:23], s33 offen offset:1024 lds
buffer_load_dwordx4 v7, s[20:23], s33 offen offset:2048 lds
buffer_load_dwordx4 v8, s[20:23], s33 offen offset:3072 lds
s_add_u32 s32, s32, 64
s_add_u32 s33, s33, 262144
s_add_u32 s34, s34, 32768
s_and_b32 s34, s34, 131071
s_add_u32 s35, s35, 32768
s_and_b32 s35, s35, 131071
s_mov_b32 m0, s34
s_nop 0
buffer_load_dwordx4 v1, s[12:15], s32 offen offset:0 lds
buffer_load_dwordx4 v2, s[12:15], s32 offen offset:1024 lds
buffer_load_dwordx4 v3, s[12:15], s32 offen offset:2048 lds
buffer_load_dwordx4 v4, s[12:15], s32 offen offset:3072 lds
s_mov_b32 m0, s35
s_nop 0
buffer_load_dwordx4 v5, s[20:23], s33 offen offset:0 lds
buffer_load_dwordx4 v6, s[20:23], s33 offen offset:1024 lds
buffer_load_dwordx4 v7, s[20:23], s33 offen offset:2048 lds
buffer_load_dwordx4 v8, s[20:23], s33 offen offset:3072 lds
s_add_u32 s32, s32, 64
s_add_u32 s33, s33, 262144
s_add_u32 s34, s34, 32768
s_and_b32 s34, s34, 131071
s_add_u32 s35, s35, 32768
s_and_b32 s35, s35, 131071
s_mov_b32 m0, s34
s_nop 0
buffer_load_dwordx4 v1, s[12:15], s32 offen offset:0 lds
buffer_load_dwordx4 v2, s[12:15], s32 offen offset:1024 lds
buffer_load_dwordx4 v3, s[12:15], s32 offen offset:2048 lds
buffer_load_dwordx4 v4, s[12:15], s32 offen offset:3072 lds
s_mov_b32 m0, s35
s_nop 0
buffer_load_dwordx4 v5, s[20:23], s33 offen offset:0 lds
buffer_load_dwordx4 v6, s[20:23], s33 offen offset:1024 lds
buffer_load_dwordx4 v7, s[20:23], s33 offen offset:2048 lds
buffer_load_dwordx4 v8, s[20:23], s33 offen offset:3072 lds
s_add_u32 s32, s32, 64
s_add_u32 s33, s33, 262144
s_add_u32 s34, s34, 32768
s_and_b32 s34, s34, 131071
s_add_u32 s35, s35, 32768
s_and_b32 s35, s35, 131071
s_mov_b32 m0, s34
s_nop 0
buffer_load_dwordx4 v1, s[12:15], s32 offen offset:0 lds
buffer_load_dwordx4 v2, s[12:15], s32 offen offset:1024 lds
buffer_load_dwordx4 v3, s[12:15], s32 offen offset:2048 lds
buffer_load_dwordx4 v4, s[12:15], s32 offen offset:3072 lds
s_mov_b32 m0, s35
s_nop 0
buffer_load_dwordx4 v5, s[20:23], s33 offen offset:0 lds
buffer_load_dwordx4 v6, s[20:23], s33 offen offset:1024 lds
buffer_load_dwordx4 v7, s[20:23], s33 offen offset:2048 lds
buffer_load_dwordx4 v8, s[20:23], s33 offen offset:3072 lds
s_add_u32 s32, s32, 64
s_add_u32 s33, s33, 262144
s_add_u32 s34, s34, 32768
s_and_b32 s34, s34, 131071
s_add_u32 s35, s35, 32768
s_and_b32 s35, s35, 131071
v_and_b32 v15, 31, v0
v_lshlrev_b32 v15, 6, v15
v_bfe_u32 v16, v0, 2, 2
v_bfe_u32 v17, v0, 5, 1
v_xor_b32 v16, v16, v17
v_lshl_add_u32 v15, v16, 4, v15
s_and_b32 s24, s17, 1
s_lshl_b32 s24, s24, 13
v_add_u32 v9, s24, v15
v_xor_b32 v10, 32, v9
v_bfe_u32 v16, v0, 2, 2
v_mul_u32_u24 v15, 320, v16
v_lshl_add_u32 v15, v17, 11, v15
v_bfe_u32 v16, v0, 4, 1
v_lshl_add_u32 v15, v16, 5, v15
v_and_b32 v16, 3, v0
v_lshl_add_u32 v15, v16, 3, v15
s_lshr_b32 s24, s17, 1
s_lshl_b32 s24, s24, 13
s_add_u32 s24, s24, 16384
v_add_u32 v11, s24, v15
v_xor_b32 v12, 64, v11
v_xor_b32 v13, 128, v11
v_xor_b32 v14, 192, v11
v_accvgpr_write_b32 a0, 0
v_accvgpr_write_b32 a1, 0
v_accvgpr_write_b32 a2, 0
v_accvgpr_write_b32 a3, 0
v_accvgpr_write_b32 a4, 0
v_accvgpr_write_b32 a5, 0
v_accvgpr_write_b32 a6, 0
v_accvgpr_write_b32 a7, 0
v_accvgpr_write_b32 a8, 0
v_accvgpr_write_b32 a9, 0
v_accvgpr_write_b32 a10, 0
v_accvgpr_write_b32 a11, 0
v_accvgpr_write_b32 a12, 0
v_accvgpr_write_b32 a13, 0
v_accvgpr_write_b32 a14, 0
v_accvgpr_write_b32 a15, 0
v_accvgpr_write_b32 a16, 0
v_accvgpr_write_b32 a17, 0
v_accvgpr_write_b32 a18, 0
v_accvgpr_write_b32 a19, 0
v_accvgpr_write_b32 a20, 0
v_accvgpr_write_b32 a21, 0
v_accvgpr_write_b32 a22, 0
v_accvgpr_write_b32 a23, 0
v_accvgpr_write_b32 a24, 0
v_accvgpr_write_b32 a25, 0
v_accvgpr_write_b32 a26, 0
v_accvgpr_write_b32 a27, 0
v_accvgpr_write_b32 a28, 0
v_accvgpr_write_b32 a29, 0
v_accvgpr_write_b32 a30, 0
v_accvgpr_write_b32 a31, 0
v_accvgpr_write_b32 a32, 0
v_accvgpr_write_b32 a33, 0
v_accvgpr_write_b32 a34, 0
v_accvgpr_write_b32 a35, 0
v_accvgpr_write_b32 a36, 0
v_accvgpr_write_b32 a37, 0
v_accvgpr_write_b32 a38, 0
v_accvgpr_write_b32 a39, 0
v_accvgpr_write_b32 a40, 0
v_accvgpr_write_b32 a41, 0
v_accvgpr_write_b32 a42, 0
v_accvgpr_write_b32 a43, 0
v_accvgpr_write_b32 a44, 0
v_accvgpr_write_b32 a45, 0
v_accvgpr_write_b32 a46, 0
v_accvgpr_write_b32 a47, 0
v_accvgpr_write_b32 a48, 0
v_accvgpr_write_b32 a49, 0
v_accvgpr_write_b32 a50, 0
v_accvgpr_write_b32 a51, 0
v_accvgpr_write_b32 a52, 0
v_accvgpr_write_b32 a53, 0
v_accvgpr_write_b32 a54, 0
v_accvgpr_write_b32 a55, 0
v_accvgpr_write_b32 a56, 0
v_accvgpr_write_b32 a57, 0
v_accvgpr_write_b32 a58, 0
v_accvgpr_write_b32 a59, 0
v_accvgpr_write_b32 a60, 0
v_accvgpr_write_b32 a61, 0
v_accvgpr_write_b32 a62, 0
v_accvgpr_write_b32 a63, 0
v_accvgpr_write_b32 a64, 0
v_accvgpr_write_b32 a65, 0
v_accvgpr_write_b32 a66, 0
v_accvgpr_write_b32 a67, 0
v_accvgpr_write_b32 a68, 0
v_accvgpr_write_b32 a69, 0
v_accvgpr_write_b32 a70, 0
v_accvgpr_write_b32 a71, 0
v_accvgpr_write_b32 a72, 0
v_accvgpr_write_b32 a73, 0
v_accvgpr_write_b32 a74, 0
v_accvgpr_write_b32 a75, 0
v_accvgpr_write_b32 a76, 0
v_accvgpr_write_b32 a77, 0
v_accvgpr_write_b32 a78, 0
v_accvgpr_write_b32 a79, 0
v_accvgpr_write_b32 a80, 0
v_accvgpr_write_b32 a81, 0
v_accvgpr_write_b32 a82, 0
v_accvgpr_write_b32 a83, 0
v_accvgpr_write_b32 a84, 0
v_accvgpr_write_b32 a85, 0
v_accvgpr_write_b32 a86, 0
v_accvgpr_write_b32 a87, 0
v_accvgpr_write_b32 a88, 0
v_accvgpr_write_b32 a89, 0
v_accvgpr_write_b32 a90, 0
v_accvgpr_write_b32 a91, 0
v_accvgpr_write_b32 a92, 0
v_accvgpr_write_b32 a93, 0
v_accvgpr_write_b32 a94, 0
v_accvgpr_write_b32 a95, 0
v_accvgpr_write_b32 a96, 0
v_accvgpr_write_b32 a97, 0
v_accvgpr_write_b32 a98, 0
v_accvgpr_write_b32 a99, 0
v_accvgpr_write_b32 a100, 0
v_accvgpr_write_b32 a101, 0
v_accvgpr_write_b32 a102, 0
v_accvgpr_write_b32 a103, 0
v_accvgpr_write_b32 a104, 0
v_accvgpr_write_b32 a105, 0
v_accvgpr_write_b32 a106, 0
v_accvgpr_write_b32 a107, 0
v_accvgpr_write_b32 a108, 0
v_accvgpr_write_b32 a109, 0
v_accvgpr_write_b32 a110, 0
v_accvgpr_write_b32 a111, 0
v_accvgpr_write_b32 a112, 0
v_accvgpr_write_b32 a113, 0
v_accvgpr_write_b32 a114, 0
v_accvgpr_write_b32 a115, 0
v_accvgpr_write_b32 a116, 0
v_accvgpr_write_b32 a117, 0
v_accvgpr_write_b32 a118, 0
v_accvgpr_write_b32 a119, 0
v_accvgpr_write_b32 a120, 0
v_accvgpr_write_b32 a121, 0
v_accvgpr_write_b32 a122, 0
v_accvgpr_write_b32 a123, 0
v_accvgpr_write_b32 a124, 0
v_accvgpr_write_b32 a125, 0
v_accvgpr_write_b32 a126, 0
v_accvgpr_write_b32 a127, 0
v_accvgpr_write_b32 a128, 0
v_accvgpr_write_b32 a129, 0
v_accvgpr_write_b32 a130, 0
v_accvgpr_write_b32 a131, 0
v_accvgpr_write_b32 a132, 0
v_accvgpr_write_b32 a133, 0
v_accvgpr_write_b32 a134, 0
v_accvgpr_write_b32 a135, 0
v_accvgpr_write_b32 a136, 0
v_accvgpr_write_b32 a137, 0
v_accvgpr_write_b32 a138, 0
v_accvgpr_write_b32 a139, 0
v_accvgpr_write_b32 a140, 0
v_accvgpr_write_b32 a141, 0
v_accvgpr_write_b32 a142, 0
v_accvgpr_write_b32 a143, 0
v_accvgpr_write_b32 a144, 0
v_accvgpr_write_b32 a145, 0
v_accvgpr_write_b32 a146, 0
v_accvgpr_write_b32 a147, 0
v_accvgpr_write_b32 a148, 0
v_accvgpr_write_b32 a149, 0
v_accvgpr_write_b32 a150, 0
v_accvgpr_write_b32 a151, 0
v_accvgpr_write_b32 a152, 0
v_accvgpr_write_b32 a153, 0
v_accvgpr_write_b32 a154, 0
v_accvgpr_write_b32 a155, 0
v_accvgpr_write_b32 a156, 0
v_accvgpr_write_b32 a157, 0
v_accvgpr_write_b32 a158, 0
v_accvgpr_write_b32 a159, 0
v_accvgpr_write_b32 a160, 0
v_accvgpr_write_b32 a161, 0
v_accvgpr_write_b32 a162, 0
v_accvgpr_write_b32 a163, 0
v_accvgpr_write_b32 a164, 0
v_accvgpr_write_b32 a165, 0
v_accvgpr_write_b32 a166, 0
v_accvgpr_write_b32 a167, 0
v_accvgpr_write_b32 a168, 0
v_accvgpr_write_b32 a169, 0
v_accvgpr_write_b32 a170, 0
v_accvgpr_write_b32 a171, 0
v_accvgpr_write_b32 a172, 0
v_accvgpr_write_b32 a173, 0
v_accvgpr_write_b32 a174, 0
v_accvgpr_write_b32 a175, 0
v_accvgpr_write_b32 a176, 0
v_accvgpr_write_b32 a177, 0
v_accvgpr_write_b32 a178, 0
v_accvgpr_write_b32 a179, 0
v_accvgpr_write_b32 a180, 0
v_accvgpr_write_b32 a181, 0
v_accvgpr_write_b32 a182, 0
v_accvgpr_write_b32 a183, 0
v_accvgpr_write_b32 a184, 0
v_accvgpr_write_b32 a185, 0
v_accvgpr_write_b32 a186, 0
v_accvgpr_write_b32 a187, 0
v_accvgpr_write_b32 a188, 0
v_accvgpr_write_b32 a189, 0
v_accvgpr_write_b32 a190, 0
v_accvgpr_write_b32 a191, 0
v_accvgpr_write_b32 a192, 0
v_accvgpr_write_b32 a193, 0
v_accvgpr_write_b32 a194, 0
v_accvgpr_write_b32 a195, 0
v_accvgpr_write_b32 a196, 0
v_accvgpr_write_b32 a197, 0
v_accvgpr_write_b32 a198, 0
v_accvgpr_write_b32 a199, 0
v_accvgpr_write_b32 a200, 0
v_accvgpr_write_b32 a201, 0
v_accvgpr_write_b32 a202, 0
v_accvgpr_write_b32 a203, 0
v_accvgpr_write_b32 a204, 0
v_accvgpr_write_b32 a205, 0
v_accvgpr_write_b32 a206, 0
v_accvgpr_write_b32 a207, 0
v_accvgpr_write_b32 a208, 0
v_accvgpr_write_b32 a209, 0
v_accvgpr_write_b32 a210, 0
v_accvgpr_write_b32 a211, 0
v_accvgpr_write_b32 a212, 0
v_accvgpr_write_b32 a213, 0
v_accvgpr_write_b32 a214, 0
v_accvgpr_write_b32 a215, 0
v_accvgpr_write_b32 a216, 0
v_accvgpr_write_b32 a217, 0
v_accvgpr_write_b32 a218, 0
v_accvgpr_write_b32 a219, 0
v_accvgpr_write_b32 a220, 0
v_accvgpr_write_b32 a221, 0
v_accvgpr_write_b32 a222, 0
v_accvgpr_write_b32 a223, 0
v_accvgpr_write_b32 a224, 0
v_accvgpr_write_b32 a225, 0
v_accvgpr_write_b32 a226, 0
v_accvgpr_write_b32 a227, 0
v_accvgpr_write_b32 a228, 0
v_accvgpr_write_b32 a229, 0
v_accvgpr_write_b32 a230, 0
v_accvgpr_write_b32 a231, 0
v_accvgpr_write_b32 a232, 0
v_accvgpr_write_b32 a233, 0
v_accvgpr_write_b32 a234, 0
v_accvgpr_write_b32 a235, 0
v_accvgpr_write_b32 a236, 0
v_accvgpr_write_b32 a237, 0
v_accvgpr_write_b32 a238, 0
v_accvgpr_write_b32 a239, 0
v_accvgpr_write_b32 a240, 0
v_accvgpr_write_b32 a241, 0
v_accvgpr_write_b32 a242, 0
v_accvgpr_write_b32 a243, 0
v_accvgpr_write_b32 a244, 0
v_accvgpr_write_b32 a245, 0
v_accvgpr_write_b32 a246, 0
v_accvgpr_write_b32 a247, 0
v_accvgpr_write_b32 a248, 0
v_accvgpr_write_b32 a249, 0
v_accvgpr_write_b32 a250, 0
v_accvgpr_write_b32 a251, 0
v_accvgpr_write_b32 a252, 0
v_accvgpr_write_b32 a253, 0
v_accvgpr_write_b32 a254, 0
v_accvgpr_write_b32 a255, 0
s_waitcnt vmcnt(24)
s_barrier
ds_read_b64_tr_b16 v[48:49], v11 offset:0
ds_read_b64_tr_b16 v[50:51], v11 offset:1024
ds_read_b128 v[32:35], v9 offset:0
ds_read_b128 v[36:39], v9 offset:2048
ds_read_b128 v[40:43], v9 offset:4096
ds_read_b128 v[44:47], v9 offset:6144
ds_read_b64_tr_b16 v[52:53], v12 offset:0
ds_read_b64_tr_b16 v[54:55], v12 offset:1024
ds_read_b64_tr_b16 v[56:57], v13 offset:0
ds_read_b64_tr_b16 v[58:59], v13 offset:1024
ds_read_b64_tr_b16 v[60:61], v14 offset:0
ds_read_b64_tr_b16 v[62:63], v14 offset:1024
s_mov_b32 s30, 0
s_cmp_ge_u32 s17, 2
s_cbranch_scc1 L_ga_v
.p2align 3
L_ga_k:
s_waitcnt lgkmcnt(0)
v_mfma_f32_32x32x16_bf16 a[0:15], v[48:51], v[32:35], a[0:15]
ds_read_b64_tr_b16 v[80:81], v11 offset:4096
v_mfma_f32_32x32x16_bf16 a[16:31], v[48:51], v[36:39], a[16:31]
ds_read_b64_tr_b16 v[82:83], v11 offset:5120
v_mfma_f32_32x32x16_bf16 a[32:47], v[48:51], v[40:43], a[32:47]
ds_read_b128 v[64:67], v10 offset:0
v_mfma_f32_32x32x16_bf16 a[48:63], v[48:51], v[44:47], a[48:63]
ds_read_b128 v[68:71], v10 offset:2048
v_mfma_f32_32x32x16_bf16 a[64:79], v[52:55], v[32:35], a[64:79]
ds_read_b128 v[72:75], v10 offset:4096
v_mfma_f32_32x32x16_bf16 a[80:95], v[52:55], v[36:39], a[80:95]
ds_read_b128 v[76:79], v10 offset:6144
v_mfma_f32_32x32x16_bf16 a[96:111], v[52:55], v[40:43], a[96:111]
ds_read_b64_tr_b16 v[84:85], v12 offset:4096
v_mfma_f32_32x32x16_bf16 a[112:127], v[52:55], v[44:47], a[112:127]
ds_read_b64_tr_b16 v[86:87], v12 offset:5120
v_mfma_f32_32x32x16_bf16 a[128:143], v[56:59], v[32:35], a[128:143]
ds_read_b64_tr_b16 v[88:89], v13 offset:4096
v_mfma_f32_32x32x16_bf16 a[144:159], v[56:59], v[36:39], a[144:159]
ds_read_b64_tr_b16 v[90:91], v13 offset:5120
v_mfma_f32_32x32x16_bf16 a[160:175], v[56:59], v[40:43], a[160:175]
ds_read_b64_tr_b16 v[92:93], v14 offset:4096
v_mfma_f32_32x32x16_bf16 a[176:191], v[56:59], v[44:47], a[176:191]
ds_read_b64_tr_b16 v[94:95], v14 offset:5120
v_mfma_f32_32x32x16_bf16 a[192:207], v[60:63], v[32:35], a[192:207]
v_add_u32 v9, 32768, v9
v_and_b32 v9, 131071, v9
v_add_u32 v10, 32768, v10
v_mfma_f32_32x32x16_bf16 a[208:223], v[60:63], v[36:39], a[208:223]
v_and_b32 v10, 131071, v10
v_add_u32 v11, 32768, v11
v_and_b32 v11, 131071, v11
v_mfma_f32_32x32x16_bf16 a[224:239], v[60:63], v[40:43], a[224:239]
v_add_u32 v12, 32768, v12
v_and_b32 v12, 131071, v12
v_add_u32 v13, 32768, v13
v_mfma_f32_32x32x16_bf16 a[240:255], v[60:63], v[44:47], a[240:255]
s_add_u32 s25, s30, 4
s_cmp_lt_u32 s25, 16
s_cselect_b32 s32, s32, 536870912
v_and_b32 v13, 131071, v13
v_add_u32 v14, 32768, v14
v_and_b32 v14, 131071, v14
s_waitcnt vmcnt(16) lgkmcnt(0)
s_barrier
v_mfma_f32_32x32x16_bf16 a[0:15], v[80:83], v[64:67], a[0:15]
ds_read_b64_tr_b16 v[48:49], v11 offset:0
s_mov_b32 m0, s34
v_mfma_f32_32x32x16_bf16 a[16:31], v[80:83], v[68:71], a[16:31]
ds_read_b64_tr_b16 v[50:51], v11 offset:1024
v_mfma_f32_32x32x16_bf16 a[32:47], v[80:83], v[72:75], a[32:47]
ds_read_b128 v[32:35], v9 offset:0
buffer_load_dwordx4 v1, s[12:15], s32 offen offset:0 lds
v_mfma_f32_32x32x16_bf16 a[48:63], v[80:83], v[76:79], a[48:63]
ds_read_b128 v[36:39], v9 offset:2048
v_mfma_f32_32x32x16_bf16 a[64:79], v[84:87], v[64:67], a[64:79]
ds_read_b128 v[40:43], v9 offset:4096
buffer_load_dwordx4 v2, s[12:15], s32 offen offset:1024 lds
v_mfma_f32_32x32x16_bf16 a[80:95], v[84:87], v[68:71], a[80:95]
ds_read_b128 v[44:47], v9 offset:6144
v_mfma_f32_32x32x16_bf16 a[96:111], v[84:87], v[72:75], a[96:111]
ds_read_b64_tr_b16 v[52:53], v12 offset:0
buffer_load_dwordx4 v3, s[12:15], s32 offen offset:2048 lds
v_mfma_f32_32x32x16_bf16 a[112:127], v[84:87], v[76:79], a[112:127]
ds_read_b64_tr_b16 v[54:55], v12 offset:1024
v_mfma_f32_32x32x16_bf16 a[128:143], v[88:91], v[64:67], a[128:143]
ds_read_b64_tr_b16 v[56:57], v13 offset:0
buffer_load_dwordx4 v4, s[12:15], s32 offen offset:3072 lds
s_mov_b32 m0, s35
v_mfma_f32_32x32x16_bf16 a[144:159], v[88:91], v[68:71], a[144:159]
ds_read_b64_tr_b16 v[58:59], v13 offset:1024
v_mfma_f32_32x32x16_bf16 a[160:175], v[88:91], v[72:75], a[160:175]
ds_read_b64_tr_b16 v[60:61], v14 offset:0
buffer_load_dwordx4 v5, s[20:23], s33 offen offset:0 lds
v_mfma_f32_32x32x16_bf16 a[176:191], v[88:91], v[76:79], a[176:191]
ds_read_b64_tr_b16 v[62:63], v14 offset:1024
v_mfma_f32_32x32x16_bf16 a[192:207], v[92:95], v[64:67], a[192:207]
buffer_load_dwordx4 v6, s[20:23], s33 offen offset:1024 lds
v_mfma_f32_32x32x16_bf16 a[208:223], v[92:95], v[68:71], a[208:223]
v_mfma_f32_32x32x16_bf16 a[224:239], v[92:95], v[72:75], a[224:239]
buffer_load_dwordx4 v7, s[20:23], s33 offen offset:2048 lds
v_mfma_f32_32x32x16_bf16 a[240:255], v[92:95], v[76:79], a[240:255]
buffer_load_dwordx4 v8, s[20:23], s33 offen offset:3072 lds
s_add_u32 s32, s32, 64
s_add_u32 s33, s33, 262144
s_add_u32 s34, s34, 32768
s_and_b32 s34, s34, 131071
s_add_u32 s35, s35, 32768
s_and_b32 s35, s35, 131071
s_add_u32 s30, s30, 1
s_cmp_lt_u32 s30, 16
s_cbranch_scc1 L_ga_k
s_branch L_ga_end
.p2align 3
L_ga_v:
s_waitcnt lgkmcnt(0)
v_mfma_f32_32x32x16_bf16 a[0:15], v[32:35], v[48:51], a[0:15]
ds_read_b64_tr_b16 v[80:81], v11 offset:4096
v_mfma_f32_32x32x16_bf16 a[16:31], v[36:39], v[48:51], a[16:31]
ds_read_b64_tr_b16 v[82:83], v11 offset:5120
v_mfma_f32_32x32x16_bf16 a[32:47], v[40:43], v[48:51], a[32:47]
ds_read_b128 v[64:67], v10 offset:0
v_mfma_f32_32x32x16_bf16 a[48:63], v[44:47], v[48:51], a[48:63]
ds_read_b128 v[68:71], v10 offset:2048
v_mfma_f32_32x32x16_bf16 a[64:79], v[32:35], v[52:55], a[64:79]
ds_read_b128 v[72:75], v10 offset:4096
v_mfma_f32_32x32x16_bf16 a[80:95], v[36:39], v[52:55], a[80:95]
ds_read_b128 v[76:79], v10 offset:6144
v_mfma_f32_32x32x16_bf16 a[96:111], v[40:43], v[52:55], a[96:111]
ds_read_b64_tr_b16 v[84:85], v12 offset:4096
v_mfma_f32_32x32x16_bf16 a[112:127], v[44:47], v[52:55], a[112:127]
ds_read_b64_tr_b16 v[86:87], v12 offset:5120
v_mfma_f32_32x32x16_bf16 a[128:143], v[32:35], v[56:59], a[128:143]
ds_read_b64_tr_b16 v[88:89], v13 offset:4096
v_mfma_f32_32x32x16_bf16 a[144:159], v[36:39], v[56:59], a[144:159]
ds_read_b64_tr_b16 v[90:91], v13 offset:5120
v_mfma_f32_32x32x16_bf16 a[160:175], v[40:43], v[56:59], a[160:175]
ds_read_b64_tr_b16 v[92:93], v14 offset:4096
v_mfma_f32_32x32x16_bf16 a[176:191], v[44:47], v[56:59], a[176:191]
ds_read_b64_tr_b16 v[94:95], v14 offset:5120
v_mfma_f32_32x32x16_bf16 a[192:207], v[32:35], v[60:63], a[192:207]
v_add_u32 v9, 32768, v9
v_and_b32 v9, 131071, v9
v_add_u32 v10, 32768, v10
v_mfma_f32_32x32x16_bf16 a[208:223], v[36:39], v[60:63], a[208:223]
v_and_b32 v10, 131071, v10
v_add_u32 v11, 32768, v11
v_and_b32 v11, 131071, v11
v_mfma_f32_32x32x16_bf16 a[224:239], v[40:43], v[60:63], a[224:239]
v_add_u32 v12, 32768, v12
v_and_b32 v12, 131071, v12
v_add_u32 v13, 32768, v13
v_mfma_f32_32x32x16_bf16 a[240:255], v[44:47], v[60:63], a[240:255]
s_add_u32 s25, s30, 4
s_cmp_lt_u32 s25, 16
s_cselect_b32 s32, s32, 536870912
v_and_b32 v13, 131071, v13
v_add_u32 v14, 32768, v14
v_and_b32 v14, 131071, v14
s_waitcnt vmcnt(16) lgkmcnt(0)
s_barrier
v_mfma_f32_32x32x16_bf16 a[0:15], v[64:67], v[80:83], a[0:15]
ds_read_b64_tr_b16 v[48:49], v11 offset:0
s_mov_b32 m0, s34
v_mfma_f32_32x32x16_bf16 a[16:31], v[68:71], v[80:83], a[16:31]
ds_read_b64_tr_b16 v[50:51], v11 offset:1024
v_mfma_f32_32x32x16_bf16 a[32:47], v[72:75], v[80:83], a[32:47]
ds_read_b128 v[32:35], v9 offset:0
buffer_load_dwordx4 v1, s[12:15], s32 offen offset:0 lds
v_mfma_f32_32x32x16_bf16 a[48:63], v[76:79], v[80:83], a[48:63]
ds_read_b128 v[36:39], v9 offset:2048
v_mfma_f32_32x32x16_bf16 a[64:79], v[64:67], v[84:87], a[64:79]
ds_read_b128 v[40:43], v9 offset:4096
buffer_load_dwordx4 v2, s[12:15], s32 offen offset:1024 lds
v_mfma_f32_32x32x16_bf16 a[80:95], v[68:71], v[84:87], a[80:95]
ds_read_b128 v[44:47], v9 offset:6144
v_mfma_f32_32x32x16_bf16 a[96:111], v[72:75], v[84:87], a[96:111]
ds_read_b64_tr_b16 v[52:53], v12 offset:0
buffer_load_dwordx4 v3, s[12:15], s32 offen offset:2048 lds
v_mfma_f32_32x32x16_bf16 a[112:127], v[76:79], v[84:87], a[112:127]
ds_read_b64_tr_b16 v[54:55], v12 offset:1024
v_mfma_f32_32x32x16_bf16 a[128:143], v[64:67], v[88:91], a[128:143]
ds_read_b64_tr_b16 v[56:57], v13 offset:0
buffer_load_dwordx4 v4, s[12:15], s32 offen offset:3072 lds
s_mov_b32 m0, s35
v_mfma_f32_32x32x16_bf16 a[144:159], v[68:71], v[88:91], a[144:159]
ds_read_b64_tr_b16 v[58:59], v13 offset:1024
v_mfma_f32_32x32x16_bf16 a[160:175], v[72:75], v[88:91], a[160:175]
ds_read_b64_tr_b16 v[60:61], v14 offset:0
buffer_load_dwordx4 v5, s[20:23], s33 offen offset:0 lds
v_mfma_f32_32x32x16_bf16 a[176:191], v[76:79], v[88:91], a[176:191]
ds_read_b64_tr_b16 v[62:63], v14 offset:1024
v_mfma_f32_32x32x16_bf16 a[192:207], v[64:67], v[92:95], a[192:207]
buffer_load_dwordx4 v6, s[20:23], s33 offen offset:1024 lds
v_mfma_f32_32x32x16_bf16 a[208:223], v[68:71], v[92:95], a[208:223]
v_mfma_f32_32x32x16_bf16 a[224:239], v[72:75], v[92:95], a[224:239]
buffer_load_dwordx4 v7, s[20:23], s33 offen offset:2048 lds
v_mfma_f32_32x32x16_bf16 a[240:255], v[76:79], v[92:95], a[240:255]
buffer_load_dwordx4 v8, s[20:23], s33 offen offset:3072 lds
s_add_u32 s32, s32, 64
s_add_u32 s33, s33, 262144
s_add_u32 s34, s34, 32768
s_and_b32 s34, s34, 131071
s_add_u32 s35, s35, 32768
s_and_b32 s35, s35, 131071
s_add_u32 s30, s30, 1
s_cmp_lt_u32 s30, 16
s_cbranch_scc1 L_ga_v
L_ga_end:
s_waitcnt vmcnt(0) lgkmcnt(0)
s_lshl_b32 s61, s42, 3
s_add_u32 s61, s61, s60
s_lshl_b32 s61, s61, 17
s_add_u32 s61, s61, 0
v_and_b32 v15, 63, v0
v_lshlrev_b32 v15, 4, v15
s_and_b32 s24, s17, 1
s_lshl_b32 s24, s24, 16
s_lshr_b32 s25, s17, 1
s_lshl_b32 s25, s25, 13
s_add_u32 s24, s24, s25
s_add_u32 s24, s24, s61
s_add_u32 s25, s24, 0
v_accvgpr_read_b32 v32, a0
v_accvgpr_read_b32 v33, a1
v_accvgpr_read_b32 v34, a2
v_accvgpr_read_b32 v35, a3
v_accvgpr_read_b32 v36, a4
v_accvgpr_read_b32 v37, a5
v_accvgpr_read_b32 v38, a6
v_accvgpr_read_b32 v39, a7
v_cvt_pk_bf16_f32 v32, v32, v33
v_cvt_pk_bf16_f32 v33, v34, v35
v_cvt_pk_bf16_f32 v34, v36, v37
v_cvt_pk_bf16_f32 v35, v38, v39
buffer_store_dwordx4 v[32:35], v15, s[8:11], s25 offen offset:0 sc1
v_accvgpr_read_b32 v40, a8
v_accvgpr_read_b32 v41, a9
v_accvgpr_read_b32 v42, a10
v_accvgpr_read_b32 v43, a11
v_accvgpr_read_b32 v44, a12
v_accvgpr_read_b32 v45, a13
v_accvgpr_read_b32 v46, a14
v_accvgpr_read_b32 v47, a15
v_cvt_pk_bf16_f32 v40, v40, v41
v_cvt_pk_bf16_f32 v41, v42, v43
v_cvt_pk_bf16_f32 v42, v44, v45
v_cvt_pk_bf16_f32 v43, v46, v47
buffer_store_dwordx4 v[40:43], v15, s[8:11], s25 offen offset:1024 sc1
v_accvgpr_read_b32 v48, a64
v_accvgpr_read_b32 v49, a65
v_accvgpr_read_b32 v50, a66
v_accvgpr_read_b32 v51, a67
v_accvgpr_read_b32 v52, a68
v_accvgpr_read_b32 v53, a69
v_accvgpr_read_b32 v54, a70
v_accvgpr_read_b32 v55, a71
v_cvt_pk_bf16_f32 v48, v48, v49
v_cvt_pk_bf16_f32 v49, v50, v51
v_cvt_pk_bf16_f32 v50, v52, v53
v_cvt_pk_bf16_f32 v51, v54, v55
buffer_store_dwordx4 v[48:51], v15, s[8:11], s25 offen offset:2048 sc1
v_accvgpr_read_b32 v56, a72
v_accvgpr_read_b32 v57, a73
v_accvgpr_read_b32 v58, a74
v_accvgpr_read_b32 v59, a75
v_accvgpr_read_b32 v60, a76
v_accvgpr_read_b32 v61, a77
v_accvgpr_read_b32 v62, a78
v_accvgpr_read_b32 v63, a79
v_cvt_pk_bf16_f32 v56, v56, v57
v_cvt_pk_bf16_f32 v57, v58, v59
v_cvt_pk_bf16_f32 v58, v60, v61
v_cvt_pk_bf16_f32 v59, v62, v63
buffer_store_dwordx4 v[56:59], v15, s[8:11], s25 offen offset:3072 sc1
s_add_u32 s25, s24, 4096
v_accvgpr_read_b32 v64, a128
v_accvgpr_read_b32 v65, a129
v_accvgpr_read_b32 v66, a130
v_accvgpr_read_b32 v67, a131
v_accvgpr_read_b32 v68, a132
v_accvgpr_read_b32 v69, a133
v_accvgpr_read_b32 v70, a134
v_accvgpr_read_b32 v71, a135
v_cvt_pk_bf16_f32 v64, v64, v65
v_cvt_pk_bf16_f32 v65, v66, v67
v_cvt_pk_bf16_f32 v66, v68, v69
v_cvt_pk_bf16_f32 v67, v70, v71
buffer_store_dwordx4 v[64:67], v15, s[8:11], s25 offen offset:0 sc1
v_accvgpr_read_b32 v72, a136
v_accvgpr_read_b32 v73, a137
v_accvgpr_read_b32 v74, a138
v_accvgpr_read_b32 v75, a139
v_accvgpr_read_b32 v76, a140
v_accvgpr_read_b32 v77, a141
v_accvgpr_read_b32 v78, a142
v_accvgpr_read_b32 v79, a143
v_cvt_pk_bf16_f32 v72, v72, v73
v_cvt_pk_bf16_f32 v73, v74, v75
v_cvt_pk_bf16_f32 v74, v76, v77
v_cvt_pk_bf16_f32 v75, v78, v79
buffer_store_dwordx4 v[72:75], v15, s[8:11], s25 offen offset:1024 sc1
v_accvgpr_read_b32 v80, a192
v_accvgpr_read_b32 v81, a193
v_accvgpr_read_b32 v82, a194
v_accvgpr_read_b32 v83, a195
v_accvgpr_read_b32 v84, a196
v_accvgpr_read_b32 v85, a197
v_accvgpr_read_b32 v86, a198
v_accvgpr_read_b32 v87, a199
v_cvt_pk_bf16_f32 v80, v80, v81
v_cvt_pk_bf16_f32 v81, v82, v83
v_cvt_pk_bf16_f32 v82, v84, v85
v_cvt_pk_bf16_f32 v83, v86, v87
buffer_store_dwordx4 v[80:83], v15, s[8:11], s25 offen offset:2048 sc1
v_accvgpr_read_b32 v88, a200
v_accvgpr_read_b32 v89, a201
v_accvgpr_read_b32 v90, a202
v_accvgpr_read_b32 v91, a203
v_accvgpr_read_b32 v92, a204
v_accvgpr_read_b32 v93, a205
v_accvgpr_read_b32 v94, a206
v_accvgpr_read_b32 v95, a207
v_cvt_pk_bf16_f32 v88, v88, v89
v_cvt_pk_bf16_f32 v89, v90, v91
v_cvt_pk_bf16_f32 v90, v92, v93
v_cvt_pk_bf16_f32 v91, v94, v95
buffer_store_dwordx4 v[88:91], v15, s[8:11], s25 offen offset:3072 sc1
s_add_u32 s25, s24, 16384
v_accvgpr_read_b32 v32, a16
v_accvgpr_read_b32 v33, a17
v_accvgpr_read_b32 v34, a18
v_accvgpr_read_b32 v35, a19
v_accvgpr_read_b32 v36, a20
v_accvgpr_read_b32 v37, a21
v_accvgpr_read_b32 v38, a22
v_accvgpr_read_b32 v39, a23
v_cvt_pk_bf16_f32 v32, v32, v33
v_cvt_pk_bf16_f32 v33, v34, v35
v_cvt_pk_bf16_f32 v34, v36, v37
v_cvt_pk_bf16_f32 v35, v38, v39
buffer_store_dwordx4 v[32:35], v15, s[8:11], s25 offen offset:0 sc1
v_accvgpr_read_b32 v40, a24
v_accvgpr_read_b32 v41, a25
v_accvgpr_read_b32 v42, a26
v_accvgpr_read_b32 v43, a27
v_accvgpr_read_b32 v44, a28
v_accvgpr_read_b32 v45, a29
v_accvgpr_read_b32 v46, a30
v_accvgpr_read_b32 v47, a31
v_cvt_pk_bf16_f32 v40, v40, v41
v_cvt_pk_bf16_f32 v41, v42, v43
v_cvt_pk_bf16_f32 v42, v44, v45
v_cvt_pk_bf16_f32 v43, v46, v47
buffer_store_dwordx4 v[40:43], v15, s[8:11], s25 offen offset:1024 sc1
v_accvgpr_read_b32 v48, a80
v_accvgpr_read_b32 v49, a81
v_accvgpr_read_b32 v50, a82
v_accvgpr_read_b32 v51, a83
v_accvgpr_read_b32 v52, a84
v_accvgpr_read_b32 v53, a85
v_accvgpr_read_b32 v54, a86
v_accvgpr_read_b32 v55, a87
v_cvt_pk_bf16_f32 v48, v48, v49
v_cvt_pk_bf16_f32 v49, v50, v51
v_cvt_pk_bf16_f32 v50, v52, v53
v_cvt_pk_bf16_f32 v51, v54, v55
buffer_store_dwordx4 v[48:51], v15, s[8:11], s25 offen offset:2048 sc1
v_accvgpr_read_b32 v56, a88
v_accvgpr_read_b32 v57, a89
v_accvgpr_read_b32 v58, a90
v_accvgpr_read_b32 v59, a91
v_accvgpr_read_b32 v60, a92
v_accvgpr_read_b32 v61, a93
v_accvgpr_read_b32 v62, a94
v_accvgpr_read_b32 v63, a95
v_cvt_pk_bf16_f32 v56, v56, v57
v_cvt_pk_bf16_f32 v57, v58, v59
v_cvt_pk_bf16_f32 v58, v60, v61
v_cvt_pk_bf16_f32 v59, v62, v63
buffer_store_dwordx4 v[56:59], v15, s[8:11], s25 offen offset:3072 sc1
s_add_u32 s25, s24, 20480
v_accvgpr_read_b32 v64, a144
v_accvgpr_read_b32 v65, a145
v_accvgpr_read_b32 v66, a146
v_accvgpr_read_b32 v67, a147
v_accvgpr_read_b32 v68, a148
v_accvgpr_read_b32 v69, a149
v_accvgpr_read_b32 v70, a150
v_accvgpr_read_b32 v71, a151
v_cvt_pk_bf16_f32 v64, v64, v65
v_cvt_pk_bf16_f32 v65, v66, v67
v_cvt_pk_bf16_f32 v66, v68, v69
v_cvt_pk_bf16_f32 v67, v70, v71
buffer_store_dwordx4 v[64:67], v15, s[8:11], s25 offen offset:0 sc1
v_accvgpr_read_b32 v72, a152
v_accvgpr_read_b32 v73, a153
v_accvgpr_read_b32 v74, a154
v_accvgpr_read_b32 v75, a155
v_accvgpr_read_b32 v76, a156
v_accvgpr_read_b32 v77, a157
v_accvgpr_read_b32 v78, a158
v_accvgpr_read_b32 v79, a159
v_cvt_pk_bf16_f32 v72, v72, v73
v_cvt_pk_bf16_f32 v73, v74, v75
v_cvt_pk_bf16_f32 v74, v76, v77
v_cvt_pk_bf16_f32 v75, v78, v79
buffer_store_dwordx4 v[72:75], v15, s[8:11], s25 offen offset:1024 sc1
v_accvgpr_read_b32 v80, a208
v_accvgpr_read_b32 v81, a209
v_accvgpr_read_b32 v82, a210
v_accvgpr_read_b32 v83, a211
v_accvgpr_read_b32 v84, a212
v_accvgpr_read_b32 v85, a213
v_accvgpr_read_b32 v86, a214
v_accvgpr_read_b32 v87, a215
v_cvt_pk_bf16_f32 v80, v80, v81
v_cvt_pk_bf16_f32 v81, v82, v83
v_cvt_pk_bf16_f32 v82, v84, v85
v_cvt_pk_bf16_f32 v83, v86, v87
buffer_store_dwordx4 v[80:83], v15, s[8:11], s25 offen offset:2048 sc1
v_accvgpr_read_b32 v88, a216
v_accvgpr_read_b32 v89, a217
v_accvgpr_read_b32 v90, a218
v_accvgpr_read_b32 v91, a219
v_accvgpr_read_b32 v92, a220
v_accvgpr_read_b32 v93, a221
v_accvgpr_read_b32 v94, a222
v_accvgpr_read_b32 v95, a223
v_cvt_pk_bf16_f32 v88, v88, v89
v_cvt_pk_bf16_f32 v89, v90, v91
v_cvt_pk_bf16_f32 v90, v92, v93
v_cvt_pk_bf16_f32 v91, v94, v95
buffer_store_dwordx4 v[88:91], v15, s[8:11], s25 offen offset:3072 sc1
s_add_u32 s25, s24, 32768
v_accvgpr_read_b32 v32, a32
v_accvgpr_read_b32 v33, a33
v_accvgpr_read_b32 v34, a34
v_accvgpr_read_b32 v35, a35
v_accvgpr_read_b32 v36, a36
v_accvgpr_read_b32 v37, a37
v_accvgpr_read_b32 v38, a38
v_accvgpr_read_b32 v39, a39
v_cvt_pk_bf16_f32 v32, v32, v33
v_cvt_pk_bf16_f32 v33, v34, v35
v_cvt_pk_bf16_f32 v34, v36, v37
v_cvt_pk_bf16_f32 v35, v38, v39
buffer_store_dwordx4 v[32:35], v15, s[8:11], s25 offen offset:0 sc1
v_accvgpr_read_b32 v40, a40
v_accvgpr_read_b32 v41, a41
v_accvgpr_read_b32 v42, a42
v_accvgpr_read_b32 v43, a43
v_accvgpr_read_b32 v44, a44
v_accvgpr_read_b32 v45, a45
v_accvgpr_read_b32 v46, a46
v_accvgpr_read_b32 v47, a47
v_cvt_pk_bf16_f32 v40, v40, v41
v_cvt_pk_bf16_f32 v41, v42, v43
v_cvt_pk_bf16_f32 v42, v44, v45
v_cvt_pk_bf16_f32 v43, v46, v47
buffer_store_dwordx4 v[40:43], v15, s[8:11], s25 offen offset:1024 sc1
v_accvgpr_read_b32 v48, a96
v_accvgpr_read_b32 v49, a97
v_accvgpr_read_b32 v50, a98
v_accvgpr_read_b32 v51, a99
v_accvgpr_read_b32 v52, a100
v_accvgpr_read_b32 v53, a101
v_accvgpr_read_b32 v54, a102
v_accvgpr_read_b32 v55, a103
v_cvt_pk_bf16_f32 v48, v48, v49
v_cvt_pk_bf16_f32 v49, v50, v51
v_cvt_pk_bf16_f32 v50, v52, v53
v_cvt_pk_bf16_f32 v51, v54, v55
buffer_store_dwordx4 v[48:51], v15, s[8:11], s25 offen offset:2048 sc1
v_accvgpr_read_b32 v56, a104
v_accvgpr_read_b32 v57, a105
v_accvgpr_read_b32 v58, a106
v_accvgpr_read_b32 v59, a107
v_accvgpr_read_b32 v60, a108
v_accvgpr_read_b32 v61, a109
v_accvgpr_read_b32 v62, a110
v_accvgpr_read_b32 v63, a111
v_cvt_pk_bf16_f32 v56, v56, v57
v_cvt_pk_bf16_f32 v57, v58, v59
v_cvt_pk_bf16_f32 v58, v60, v61
v_cvt_pk_bf16_f32 v59, v62, v63
buffer_store_dwordx4 v[56:59], v15, s[8:11], s25 offen offset:3072 sc1
s_add_u32 s25, s24, 36864
v_accvgpr_read_b32 v64, a160
v_accvgpr_read_b32 v65, a161
v_accvgpr_read_b32 v66, a162
v_accvgpr_read_b32 v67, a163
v_accvgpr_read_b32 v68, a164
v_accvgpr_read_b32 v69, a165
v_accvgpr_read_b32 v70, a166
v_accvgpr_read_b32 v71, a167
v_cvt_pk_bf16_f32 v64, v64, v65
v_cvt_pk_bf16_f32 v65, v66, v67
v_cvt_pk_bf16_f32 v66, v68, v69
v_cvt_pk_bf16_f32 v67, v70, v71
buffer_store_dwordx4 v[64:67], v15, s[8:11], s25 offen offset:0 sc1
v_accvgpr_read_b32 v72, a168
v_accvgpr_read_b32 v73, a169
v_accvgpr_read_b32 v74, a170
v_accvgpr_read_b32 v75, a171
v_accvgpr_read_b32 v76, a172
v_accvgpr_read_b32 v77, a173
v_accvgpr_read_b32 v78, a174
v_accvgpr_read_b32 v79, a175
v_cvt_pk_bf16_f32 v72, v72, v73
v_cvt_pk_bf16_f32 v73, v74, v75
v_cvt_pk_bf16_f32 v74, v76, v77
v_cvt_pk_bf16_f32 v75, v78, v79
buffer_store_dwordx4 v[72:75], v15, s[8:11], s25 offen offset:1024 sc1
v_accvgpr_read_b32 v80, a224
v_accvgpr_read_b32 v81, a225
v_accvgpr_read_b32 v82, a226
v_accvgpr_read_b32 v83, a227
v_accvgpr_read_b32 v84, a228
v_accvgpr_read_b32 v85, a229
v_accvgpr_read_b32 v86, a230
v_accvgpr_read_b32 v87, a231
v_cvt_pk_bf16_f32 v80, v80, v81
v_cvt_pk_bf16_f32 v81, v82, v83
v_cvt_pk_bf16_f32 v82, v84, v85
v_cvt_pk_bf16_f32 v83, v86, v87
buffer_store_dwordx4 v[80:83], v15, s[8:11], s25 offen offset:2048 sc1
v_accvgpr_read_b32 v88, a232
v_accvgpr_read_b32 v89, a233
v_accvgpr_read_b32 v90, a234
v_accvgpr_read_b32 v91, a235
v_accvgpr_read_b32 v92, a236
v_accvgpr_read_b32 v93, a237
v_accvgpr_read_b32 v94, a238
v_accvgpr_read_b32 v95, a239
v_cvt_pk_bf16_f32 v88, v88, v89
v_cvt_pk_bf16_f32 v89, v90, v91
v_cvt_pk_bf16_f32 v90, v92, v93
v_cvt_pk_bf16_f32 v91, v94, v95
buffer_store_dwordx4 v[88:91], v15, s[8:11], s25 offen offset:3072 sc1
s_add_u32 s25, s24, 49152
v_accvgpr_read_b32 v32, a48
v_accvgpr_read_b32 v33, a49
v_accvgpr_read_b32 v34, a50
v_accvgpr_read_b32 v35, a51
v_accvgpr_read_b32 v36, a52
v_accvgpr_read_b32 v37, a53
v_accvgpr_read_b32 v38, a54
v_accvgpr_read_b32 v39, a55
v_cvt_pk_bf16_f32 v32, v32, v33
v_cvt_pk_bf16_f32 v33, v34, v35
v_cvt_pk_bf16_f32 v34, v36, v37
v_cvt_pk_bf16_f32 v35, v38, v39
buffer_store_dwordx4 v[32:35], v15, s[8:11], s25 offen offset:0 sc1
v_accvgpr_read_b32 v40, a56
v_accvgpr_read_b32 v41, a57
v_accvgpr_read_b32 v42, a58
v_accvgpr_read_b32 v43, a59
v_accvgpr_read_b32 v44, a60
v_accvgpr_read_b32 v45, a61
v_accvgpr_read_b32 v46, a62
v_accvgpr_read_b32 v47, a63
v_cvt_pk_bf16_f32 v40, v40, v41
v_cvt_pk_bf16_f32 v41, v42, v43
v_cvt_pk_bf16_f32 v42, v44, v45
v_cvt_pk_bf16_f32 v43, v46, v47
buffer_store_dwordx4 v[40:43], v15, s[8:11], s25 offen offset:1024 sc1
v_accvgpr_read_b32 v48, a112
v_accvgpr_read_b32 v49, a113
v_accvgpr_read_b32 v50, a114
v_accvgpr_read_b32 v51, a115
v_accvgpr_read_b32 v52, a116
v_accvgpr_read_b32 v53, a117
v_accvgpr_read_b32 v54, a118
v_accvgpr_read_b32 v55, a119
v_cvt_pk_bf16_f32 v48, v48, v49
v_cvt_pk_bf16_f32 v49, v50, v51
v_cvt_pk_bf16_f32 v50, v52, v53
v_cvt_pk_bf16_f32 v51, v54, v55
buffer_store_dwordx4 v[48:51], v15, s[8:11], s25 offen offset:2048 sc1
v_accvgpr_read_b32 v56, a120
v_accvgpr_read_b32 v57, a121
v_accvgpr_read_b32 v58, a122
v_accvgpr_read_b32 v59, a123
v_accvgpr_read_b32 v60, a124
v_accvgpr_read_b32 v61, a125
v_accvgpr_read_b32 v62, a126
v_accvgpr_read_b32 v63, a127
v_cvt_pk_bf16_f32 v56, v56, v57
v_cvt_pk_bf16_f32 v57, v58, v59
v_cvt_pk_bf16_f32 v58, v60, v61
v_cvt_pk_bf16_f32 v59, v62, v63
buffer_store_dwordx4 v[56:59], v15, s[8:11], s25 offen offset:3072 sc1
s_add_u32 s25, s24, 53248
v_accvgpr_read_b32 v64, a176
v_accvgpr_read_b32 v65, a177
v_accvgpr_read_b32 v66, a178
v_accvgpr_read_b32 v67, a179
v_accvgpr_read_b32 v68, a180
v_accvgpr_read_b32 v69, a181
v_accvgpr_read_b32 v70, a182
v_accvgpr_read_b32 v71, a183
v_cvt_pk_bf16_f32 v64, v64, v65
v_cvt_pk_bf16_f32 v65, v66, v67
v_cvt_pk_bf16_f32 v66, v68, v69
v_cvt_pk_bf16_f32 v67, v70, v71
buffer_store_dwordx4 v[64:67], v15, s[8:11], s25 offen offset:0 sc1
v_accvgpr_read_b32 v72, a184
v_accvgpr_read_b32 v73, a185
v_accvgpr_read_b32 v74, a186
v_accvgpr_read_b32 v75, a187
v_accvgpr_read_b32 v76, a188
v_accvgpr_read_b32 v77, a189
v_accvgpr_read_b32 v78, a190
v_accvgpr_read_b32 v79, a191
v_cvt_pk_bf16_f32 v72, v72, v73
v_cvt_pk_bf16_f32 v73, v74, v75
v_cvt_pk_bf16_f32 v74, v76, v77
v_cvt_pk_bf16_f32 v75, v78, v79
buffer_store_dwordx4 v[72:75], v15, s[8:11], s25 offen offset:1024 sc1
v_accvgpr_read_b32 v80, a240
v_accvgpr_read_b32 v81, a241
v_accvgpr_read_b32 v82, a242
v_accvgpr_read_b32 v83, a243
v_accvgpr_read_b32 v84, a244
v_accvgpr_read_b32 v85, a245
v_accvgpr_read_b32 v86, a246
v_accvgpr_read_b32 v87, a247
v_cvt_pk_bf16_f32 v80, v80, v81
v_cvt_pk_bf16_f32 v81, v82, v83
v_cvt_pk_bf16_f32 v82, v84, v85
v_cvt_pk_bf16_f32 v83, v86, v87
buffer_store_dwordx4 v[80:83], v15, s[8:11], s25 offen offset:2048 sc1
v_accvgpr_read_b32 v88, a248
v_accvgpr_read_b32 v89, a249
v_accvgpr_read_b32 v90, a250
v_accvgpr_read_b32 v91, a251
v_accvgpr_read_b32 v92, a252
v_accvgpr_read_b32 v93, a253
v_accvgpr_read_b32 v94, a254
v_accvgpr_read_b32 v95, a255
v_cvt_pk_bf16_f32 v88, v88, v89
v_cvt_pk_bf16_f32 v89, v90, v91
v_cvt_pk_bf16_f32 v90, v92, v93
v_cvt_pk_bf16_f32 v91, v94, v95
buffer_store_dwordx4 v[88:91], v15, s[8:11], s25 offen offset:3072 sc1
v_mov_b32 v20, 128
s_mov_b32 s28, 0
L_poll_1:
buffer_load_dword v21, v20, s[56:59], 0 offen sc1
s_add_u32 s28, s28, 1
s_cmp_gt_u32 s28, 40000
s_cbranch_scc1 L_end
s_waitcnt vmcnt(0)
v_cmp_ne_u32 vcc, 8, v21
s_cbranch_vccz L_pd_2
s_sleep 1
s_branch L_poll_1
L_pd_2:
s_lshl_b32 s61, s42, 5
s_add_u32 s61, s61, s60
s_lshl_b32 s61, s61, 2
s_add_u32 s61, s61, 111165440
s_waitcnt vmcnt(0)
s_barrier
s_cmp_lg_u32 s17, 0
s_cbranch_scc1 L_sf_3
v_mov_b32 v20, 0
v_mov_b32 v21, 1
s_mov_b64 exec, 1
buffer_store_dword v21, v20, s[8:11], s61 offen sc1
s_mov_b64 exec, -1
L_sf_3:
s_add_u32 s60, s60, 4
s_cmp_lt_u32 s60, 8
s_cbranch_scc1 L_akv
s_load_dwordx2 s[4:5], s[0:1], 0
s_waitcnt lgkmcnt(0)
s_mov_b32 s12, s4
s_and_b32 s13, s5, 0xffff
s_mov_b32 s14, 2359296
s_mov_b32 s15, 0x20000
s_load_dwordx2 s[4:5], s[0:1], 16
s_waitcnt lgkmcnt(0)
s_mov_b32 s20, s4
s_and_b32 s21, s5, 0xffff
s_mov_b32 s22, 4718592
s_mov_b32 s23, 0x20000
s_mov_b32 s40, 0x3e0293ee
s_mov_b32 s50, 0xf149f2ca
s_mov_b32 s51, 0x41000000
s_sub_u32 s41, 7, s62
s_mov_b32 s60, 0
L_aat:
s_mul_i32 s36, s41, 294912
s_lshl_b32 s26, s42, 8
v_lshrrev_b32 v15, 6, v0
v_lshlrev_b32 v15, 6, v15
v_bfe_u32 v16, v0, 2, 4
v_add_u32 v15, v15, v16
v_mul_u32_u24 v15, 1152, v15
v_bfe_u32 v16, v0, 4, 2
v_and_b32 v17, 3, v0
v_xor_b32 v17, v17, v16
v_lshl_add_u32 v1, v17, 4, v15
v_add_u32 v2, 17408, v1
v_add_u32 v3, 34816, v1
v_add_u32 v4, 52224, v1
v_bfe_u32 v15, v0, 2, 2
v_xor_b32 v15, v15, v16
v_lshlrev_b32 v15, 6, v15
v_and_b32 v17, 3, v0
v_lshl_add_u32 v15, v17, 4, v15
v_lshl_add_u32 v15, v16, 13, v15
s_lshl_b32 s24, s17, 16
s_add_u32 s24, s24, s26
v_add_u32 v5, s24, v15
v_add_u32 v6, 31744, v5
s_lshl_b32 s37, s17, 12
s_lshl_b32 s38, s17, 11
s_add_u32 s38, s38, 16384
s_mov_b32 s32, s36
s_mov_b32 s33, 0
s_mov_b32 s34, s37
s_mov_b32 s35, s38
s_mov_b32 m0, s34
s_nop 0
buffer_load_dwordx4 v1, s[12:15], s32 offen offset:0 lds
buffer_load_dwordx4 v2, s[12:15], s32 offen offset:1024 lds
buffer_load_dwordx4 v3, s[12:15], s32 offen offset:2048 lds
buffer_load_dwordx4 v4, s[12:15], s32 offen offset:3072 lds
s_mov_b32 m0, s35
s_nop 0
buffer_load_dwordx4 v5, s[20:23], s33 offen offset:0 lds
buffer_load_dwordx4 v6, s[20:23], s33 offen offset:1024 lds
s_add_u32 s32, s32, 64
s_add_u32 s33, s33, 262144
s_add_u32 s34, s34, 32768
s_and_b32 s34, s34, 131071
s_add_u32 s35, s35, 32768
s_and_b32 s35, s35, 131071
s_mov_b32 m0, s34
s_nop 0
buffer_load_dwordx4 v1, s[12:15], s32 offen offset:0 lds
buffer_load_dwordx4 v2, s[12:15], s32 offen offset:1024 lds
buffer_load_dwordx4 v3, s[12:15], s32 offen offset:2048 lds
buffer_load_dwordx4 v4, s[12:15], s32 offen offset:3072 lds
s_mov_b32 m0, s35
s_nop 0
buffer_load_dwordx4 v5, s[20:23], s33 offen offset:0 lds
buffer_load_dwordx4 v6, s[20:23], s33 offen offset:1024 lds
s_add_u32 s32, s32, 64
s_add_u32 s33, s33, 262144
s_add_u32 s34, s34, 32768
s_and_b32 s34, s34, 131071
s_add_u32 s35, s35, 32768
s_and_b32 s35, s35, 131071
s_mov_b32 m0, s34
s_nop 0
buffer_load_dwordx4 v1, s[12:15], s32 offen offset:0 lds
buffer_load_dwordx4 v2, s[12:15], s32 offen offset:1024 lds
buffer_load_dwordx4 v3, s[12:15], s32 offen offset:2048 lds
buffer_load_dwordx4 v4, s[12:15], s32 offen offset:3072 lds
s_mov_b32 m0, s35
s_nop 0
buffer_load_dwordx4 v5, s[20:23], s33 offen offset:0 lds
buffer_load_dwordx4 v6, s[20:23], s33 offen offset:1024 lds
s_add_u32 s32, s32, 64
s_add_u32 s33, s33, 262144
s_add_u32 s34, s34, 32768
s_and_b32 s34, s34, 131071
s_add_u32 s35, s35, 32768
s_and_b32 s35, s35, 131071
s_mov_b32 m0, s34
s_nop 0
buffer_load_dwordx4 v1, s[12:15], s32 offen offset:0 lds
buffer_load_dwordx4 v2, s[12:15], s32 offen offset:1024 lds
buffer_load_dwordx4 v3, s[12:15], s32 offen offset:2048 lds
buffer_load_dwordx4 v4, s[12:15], s32 offen offset:3072 lds
s_mov_b32 m0, s35
s_nop 0
buffer_load_dwordx4 v5, s[20:23], s33 offen offset:0 lds
buffer_load_dwordx4 v6, s[20:23], s33 offen offset:1024 lds
s_add_u32 s32, s32, 64
s_add_u32 s33, s33, 262144
s_add_u32 s34, s34, 32768
s_and_b32 s34, s34, 131071
s_add_u32 s35, s35, 32768
s_and_b32 s35, s35, 131071
v_and_b32 v15, 31, v0
v_lshlrev_b32 v15, 6, v15
v_bfe_u32 v16, v0, 2, 2
v_bfe_u32 v17, v0, 5, 1
v_xor_b32 v16, v16, v17
v_lshl_add_u32 v15, v16, 4, v15
s_lshl_b32 s24, s17, 12
v_add_u32 v9, s24, v15
v_xor_b32 v10, 32, v9
v_bfe_u32 v16, v0, 2, 2
v_mul_u32_u24 v15, 320, v16
v_lshl_add_u32 v15, v17, 11, v15
v_bfe_u32 v16, v0, 4, 1
v_lshl_add_u32 v15, v16, 5, v15
v_and_b32 v16, 3, v0
v_lshl_add_u32 v15, v16, 3, v15
s_mov_b32 s24, 16384
v_add_u32 v11, s24, v15
v_xor_b32 v12, 64, v11
v_xor_b32 v13, 128, v11
v_xor_b32 v14, 192, v11
v_mov_b32 v128, 0
v_mov_b32 v129, 0
v_mov_b32 v130, 0
v_mov_b32 v131, 0
v_mov_b32 v132, 0
v_mov_b32 v133, 0
v_mov_b32 v134, 0
v_mov_b32 v135, 0
v_mov_b32 v136, 0
v_mov_b32 v137, 0
v_mov_b32 v138, 0
v_mov_b32 v139, 0
v_mov_b32 v140, 0
v_mov_b32 v141, 0
v_mov_b32 v142, 0
v_mov_b32 v143, 0
v_mov_b32 v144, 0
v_mov_b32 v145, 0
v_mov_b32 v146, 0
v_mov_b32 v147, 0
v_mov_b32 v148, 0
v_mov_b32 v149, 0
v_mov_b32 v150, 0
v_mov_b32 v151, 0
v_mov_b32 v152, 0
v_mov_b32 v153, 0
v_mov_b32 v154, 0
v_mov_b32 v155, 0
v_mov_b32 v156, 0
v_mov_b32 v157, 0
v_mov_b32 v158, 0
v_mov_b32 v159, 0
v_mov_b32 v160, 0
v_mov_b32 v161, 0
v_mov_b32 v162, 0
v_mov_b32 v163, 0
v_mov_b32 v164, 0
v_mov_b32 v165, 0
v_mov_b32 v166, 0
v_mov_b32 v167, 0
v_mov_b32 v168, 0
v_mov_b32 v169, 0
v_mov_b32 v170, 0
v_mov_b32 v171, 0
v_mov_b32 v172, 0
v_mov_b32 v173, 0
v_mov_b32 v174, 0
v_mov_b32 v175, 0
v_mov_b32 v176, 0
v_mov_b32 v177, 0
v_mov_b32 v178, 0
v_mov_b32 v179, 0
v_mov_b32 v180, 0
v_mov_b32 v181, 0
v_mov_b32 v182, 0
v_mov_b32 v183, 0
v_mov_b32 v184, 0
v_mov_b32 v185, 0
v_mov_b32 v186, 0
v_mov_b32 v187, 0
v_mov_b32 v188, 0
v_mov_b32 v189, 0
v_mov_b32 v190, 0
v_mov_b32 v191, 0
v_mov_b32 v192, 0
v_mov_b32 v193, 0
v_mov_b32 v194, 0
v_mov_b32 v195, 0
v_mov_b32 v196, 0
v_mov_b32 v197, 0
v_mov_b32 v198, 0
v_mov_b32 v199, 0
v_mov_b32 v200, 0
v_mov_b32 v201, 0
v_mov_b32 v202, 0
v_mov_b32 v203, 0
v_mov_b32 v204, 0
v_mov_b32 v205, 0
v_mov_b32 v206, 0
v_mov_b32 v207, 0
v_mov_b32 v208, 0
v_mov_b32 v209, 0
v_mov_b32 v210, 0
v_mov_b32 v211, 0
v_mov_b32 v212, 0
v_mov_b32 v213, 0
v_mov_b32 v214, 0
v_mov_b32 v215, 0
v_mov_b32 v216, 0
v_mov_b32 v217, 0
v_mov_b32 v218, 0
v_mov_b32 v219, 0
v_mov_b32 v220, 0
v_mov_b32 v221, 0
v_mov_b32 v222, 0
v_mov_b32 v223, 0
v_mov_b32 v224, 0
v_mov_b32 v225, 0
v_mov_b32 v226, 0
v_mov_b32 v227, 0
v_mov_b32 v228, 0
v_mov_b32 v229, 0
v_mov_b32 v230, 0
v_mov_b32 v231, 0
v_mov_b32 v232, 0
v_mov_b32 v233, 0
v_mov_b32 v234, 0
v_mov_b32 v235, 0
v_mov_b32 v236, 0
v_mov_b32 v237, 0
v_mov_b32 v238, 0
v_mov_b32 v239, 0
v_mov_b32 v240, 0
v_mov_b32 v241, 0
v_mov_b32 v242, 0
v_mov_b32 v243, 0
v_mov_b32 v244, 0
v_mov_b32 v245, 0
v_mov_b32 v246, 0
v_mov_b32 v247, 0
v_mov_b32 v248, 0
v_mov_b32 v249, 0
v_mov_b32 v250, 0
v_mov_b32 v251, 0
v_mov_b32 v252, 0
v_mov_b32 v253, 0
v_mov_b32 v254, 0
v_mov_b32 v255, 0
s_waitcnt vmcnt(18)
s_barrier
ds_read_b64_tr_b16 a[72:73], v11 offset:0
ds_read_b64_tr_b16 a[74:75], v11 offset:1024
ds_read_b128 a[64:67], v9 offset:0
ds_read_b128 a[68:71], v9 offset:2048
ds_read_b64_tr_b16 a[76:77], v12 offset:0
ds_read_b64_tr_b16 a[78:79], v12 offset:1024
ds_read_b64_tr_b16 a[80:81], v13 offset:0
ds_read_b64_tr_b16 a[82:83], v13 offset:1024
ds_read_b64_tr_b16 a[84:85], v14 offset:0
ds_read_b64_tr_b16 a[86:87], v14 offset:1024
s_mov_b32 s30, 0
.p2align 3
L_gqa_q:
s_waitcnt lgkmcnt(0)
v_mfma_f32_32x32x16_bf16 v[128:143], a[72:75], a[64:67], v[128:143]
ds_read_b64_tr_b16 a[96:97], v11 offset:4096
ds_read_b64_tr_b16 a[98:99], v11 offset:5120
v_mfma_f32_32x32x16_bf16 v[144:159], a[72:75], a[68:71], v[144:159]
ds_read_b128 a[88:91], v10 offset:0
ds_read_b128 a[92:95], v10 offset:2048
v_mfma_f32_32x32x16_bf16 v[160:175], a[76:79], a[64:67], v[160:175]
ds_read_b64_tr_b16 a[100:101], v12 offset:4096
ds_read_b64_tr_b16 a[102:103], v12 offset:5120
v_mfma_f32_32x32x16_bf16 v[176:191], a[76:79], a[68:71], v[176:191]
ds_read_b64_tr_b16 a[104:105], v13 offset:4096
ds_read_b64_tr_b16 a[106:107], v13 offset:5120
v_mfma_f32_32x32x16_bf16 v[192:207], a[80:83], a[64:67], v[192:207]
ds_read_b64_tr_b16 a[108:109], v14 offset:4096
ds_read_b64_tr_b16 a[110:111], v14 offset:5120
v_mfma_f32_32x32x16_bf16 v[208:223], a[80:83], a[68:71], v[208:223]
v_add_u32 v9, 32768, v9
v_and_b32 v9, 131071, v9
v_add_u32 v10, 32768, v10
v_and_b32 v10, 131071, v10
v_mfma_f32_32x32x16_bf16 v[224:239], a[84:87], a[64:67], v[224:239]
v_add_u32 v11, 32768, v11
v_and_b32 v11, 131071, v11
v_add_u32 v12, 32768, v12
v_and_b32 v12, 131071, v12
v_mfma_f32_32x32x16_bf16 v[240:255], a[84:87], a[68:71], v[240:255]
s_add_u32 s25, s30, 4
s_cmp_lt_u32 s25, 18
s_cselect_b32 s32, s32, 536870912
v_add_u32 v13, 32768, v13
v_and_b32 v13, 131071, v13
v_add_u32 v14, 32768, v14
v_and_b32 v14, 131071, v14
s_waitcnt vmcnt(12) lgkmcnt(0)
s_barrier
v_mfma_f32_32x32x16_bf16 v[128:143], a[96:99], a[88:91], v[128:143]
ds_read_b64_tr_b16 a[72:73], v11 offset:0
ds_read_b64_tr_b16 a[74:75], v11 offset:1024
s_mov_b32 m0, s34
v_mfma_f32_32x32x16_bf16 v[144:159], a[96:99], a[92:95], v[144:159]
ds_read_b128 a[64:67], v9 offset:0
ds_read_b128 a[68:71], v9 offset:2048
buffer_load_dwordx4 v1, s[12:15], s32 offen offset:0 lds
v_mfma_f32_32x32x16_bf16 v[160:175], a[100:103], a[88:91], v[160:175]
ds_read_b64_tr_b16 a[76:77], v12 offset:0
ds_read_b64_tr_b16 a[78:79], v12 offset:1024
buffer_load_dwordx4 v2, s[12:15], s32 offen offset:1024 lds
v_mfma_f32_32x32x16_bf16 v[176:191], a[100:103], a[92:95], v[176:191]
ds_read_b64_tr_b16 a[80:81], v13 offset:0
ds_read_b64_tr_b16 a[82:83], v13 offset:1024
buffer_load_dwordx4 v3, s[12:15], s32 offen offset:2048 lds
v_mfma_f32_32x32x16_bf16 v[192:207], a[104:107], a[88:91], v[192:207]
ds_read_b64_tr_b16 a[84:85], v14 offset:0
ds_read_b64_tr_b16 a[86:87], v14 offset:1024
buffer_load_dwordx4 v4, s[12:15], s32 offen offset:3072 lds
s_mov_b32 m0, s35
v_mfma_f32_32x32x16_bf16 v[208:223], a[104:107], a[92:95], v[208:223]
buffer_load_dwordx4 v5, s[20:23], s33 offen offset:0 lds
v_mfma_f32_32x32x16_bf16 v[224:239], a[108:111], a[88:91], v[224:239]
buffer_load_dwordx4 v6, s[20:23], s33 offen offset:1024 lds
v_mfma_f32_32x32x16_bf16 v[240:255], a[108:111], a[92:95], v[240:255]
s_add_u32 s32, s32, 64
s_add_u32 s33, s33, 262144
s_add_u32 s34, s34, 32768
s_and_b32 s34, s34, 131071
s_add_u32 s35, s35, 32768
s_and_b32 s35, s35, 131071
s_add_u32 s30, s30, 1
s_cmp_lt_u32 s30, 18
s_cbranch_scc1 L_gqa_q
L_gqa_end:
s_waitcnt vmcnt(0) lgkmcnt(0)
v_cvt_pk_bf16_f32 v128, v128, v129
v_cvt_pk_bf16_f32 v130, v130, v131
v_cvt_pk_bf16_f32 v132, v132, v133
v_cvt_pk_bf16_f32 v134, v134, v135
v_cvt_pk_bf16_f32 v136, v136, v137
v_cvt_pk_bf16_f32 v138, v138, v139
v_cvt_pk_bf16_f32 v140, v140, v141
v_cvt_pk_bf16_f32 v142, v142, v143
v_accvgpr_write_b32 a0, v128
v_accvgpr_write_b32 a1, v130
v_accvgpr_write_b32 a2, v132
v_accvgpr_write_b32 a3, v134
v_accvgpr_write_b32 a4, v136
v_accvgpr_write_b32 a5, v138
v_accvgpr_write_b32 a6, v140
v_accvgpr_write_b32 a7, v142
v_cvt_pk_bf16_f32 v160, v160, v161
v_cvt_pk_bf16_f32 v162, v162, v163
v_cvt_pk_bf16_f32 v164, v164, v165
v_cvt_pk_bf16_f32 v166, v166, v167
v_cvt_pk_bf16_f32 v168, v168, v169
v_cvt_pk_bf16_f32 v170, v170, v171
v_cvt_pk_bf16_f32 v172, v172, v173
v_cvt_pk_bf16_f32 v174, v174, v175
v_accvgpr_write_b32 a8, v160
v_accvgpr_write_b32 a9, v162
v_accvgpr_write_b32 a10, v164
v_accvgpr_write_b32 a11, v166
v_accvgpr_write_b32 a12, v168
v_accvgpr_write_b32 a13, v170
v_accvgpr_write_b32 a14, v172
v_accvgpr_write_b32 a15, v174
v_cvt_pk_bf16_f32 v192, v192, v193
v_cvt_pk_bf16_f32 v194, v194, v195
v_cvt_pk_bf16_f32 v196, v196, v197
v_cvt_pk_bf16_f32 v198, v198, v199
v_cvt_pk_bf16_f32 v200, v200, v201
v_cvt_pk_bf16_f32 v202, v202, v203
v_cvt_pk_bf16_f32 v204, v204, v205
v_cvt_pk_bf16_f32 v206, v206, v207
v_accvgpr_write_b32 a16, v192
v_accvgpr_write_b32 a17, v194
v_accvgpr_write_b32 a18, v196
v_accvgpr_write_b32 a19, v198
v_accvgpr_write_b32 a20, v200
v_accvgpr_write_b32 a21, v202
v_accvgpr_write_b32 a22, v204
v_accvgpr_write_b32 a23, v206
v_cvt_pk_bf16_f32 v224, v224, v225
v_cvt_pk_bf16_f32 v226, v226, v227
v_cvt_pk_bf16_f32 v228, v228, v229
v_cvt_pk_bf16_f32 v230, v230, v231
v_cvt_pk_bf16_f32 v232, v232, v233
v_cvt_pk_bf16_f32 v234, v234, v235
v_cvt_pk_bf16_f32 v236, v236, v237
v_cvt_pk_bf16_f32 v238, v238, v239
v_accvgpr_write_b32 a24, v224
v_accvgpr_write_b32 a25, v226
v_accvgpr_write_b32 a26, v228
v_accvgpr_write_b32 a27, v230
v_accvgpr_write_b32 a28, v232
v_accvgpr_write_b32 a29, v234
v_accvgpr_write_b32 a30, v236
v_accvgpr_write_b32 a31, v238
v_cvt_pk_bf16_f32 v144, v144, v145
v_cvt_pk_bf16_f32 v146, v146, v147
v_cvt_pk_bf16_f32 v148, v148, v149
v_cvt_pk_bf16_f32 v150, v150, v151
v_cvt_pk_bf16_f32 v152, v152, v153
v_cvt_pk_bf16_f32 v154, v154, v155
v_cvt_pk_bf16_f32 v156, v156, v157
v_cvt_pk_bf16_f32 v158, v158, v159
v_accvgpr_write_b32 a32, v144
v_accvgpr_write_b32 a33, v146
v_accvgpr_write_b32 a34, v148
v_accvgpr_write_b32 a35, v150
v_accvgpr_write_b32 a36, v152
v_accvgpr_write_b32 a37, v154
v_accvgpr_write_b32 a38, v156
v_accvgpr_write_b32 a39, v158
v_cvt_pk_bf16_f32 v176, v176, v177
v_cvt_pk_bf16_f32 v178, v178, v179
v_cvt_pk_bf16_f32 v180, v180, v181
v_cvt_pk_bf16_f32 v182, v182, v183
v_cvt_pk_bf16_f32 v184, v184, v185
v_cvt_pk_bf16_f32 v186, v186, v187
v_cvt_pk_bf16_f32 v188, v188, v189
v_cvt_pk_bf16_f32 v190, v190, v191
v_accvgpr_write_b32 a40, v176
v_accvgpr_write_b32 a41, v178
v_accvgpr_write_b32 a42, v180
v_accvgpr_write_b32 a43, v182
v_accvgpr_write_b32 a44, v184
v_accvgpr_write_b32 a45, v186
v_accvgpr_write_b32 a46, v188
v_accvgpr_write_b32 a47, v190
v_cvt_pk_bf16_f32 v208, v208, v209
v_cvt_pk_bf16_f32 v210, v210, v211
v_cvt_pk_bf16_f32 v212, v212, v213
v_cvt_pk_bf16_f32 v214, v214, v215
v_cvt_pk_bf16_f32 v216, v216, v217
v_cvt_pk_bf16_f32 v218, v218, v219
v_cvt_pk_bf16_f32 v220, v220, v221
v_cvt_pk_bf16_f32 v222, v222, v223
v_accvgpr_write_b32 a48, v208
v_accvgpr_write_b32 a49, v210
v_accvgpr_write_b32 a50, v212
v_accvgpr_write_b32 a51, v214
v_accvgpr_write_b32 a52, v216
v_accvgpr_write_b32 a53, v218
v_accvgpr_write_b32 a54, v220
v_accvgpr_write_b32 a55, v222
v_cvt_pk_bf16_f32 v240, v240, v241
v_cvt_pk_bf16_f32 v242, v242, v243
v_cvt_pk_bf16_f32 v244, v244, v245
v_cvt_pk_bf16_f32 v246, v246, v247
v_cvt_pk_bf16_f32 v248, v248, v249
v_cvt_pk_bf16_f32 v250, v250, v251
v_cvt_pk_bf16_f32 v252, v252, v253
v_cvt_pk_bf16_f32 v254, v254, v255
v_accvgpr_write_b32 a56, v240
v_accvgpr_write_b32 a57, v242
v_accvgpr_write_b32 a58, v244
v_accvgpr_write_b32 a59, v246
v_accvgpr_write_b32 a60, v248
v_accvgpr_write_b32 a61, v250
v_accvgpr_write_b32 a62, v252
v_accvgpr_write_b32 a63, v254
v_and_b32 v20, 7, v0
v_lshlrev_b32 v20, 2, v20
s_lshl_b32 s25, s42, 7
s_add_u32 s25, s25, 111165440
s_mov_b32 s28, 0
L_poll_4:
buffer_load_dword v21, v20, s[8:11], s25 offen sc1
s_add_u32 s28, s28, 1
s_cmp_gt_u32 s28, 40000
s_cbranch_scc1 L_end
s_waitcnt vmcnt(0)
v_cmp_ne_u32 vcc, 1, v21
s_cbranch_vccz L_pd_5
s_sleep 1
s_branch L_poll_4
L_pd_5:
v_and_b32 v5, 31, v0
v_bfe_u32 v26, v0, 5, 1
v_lshlrev_b32 v27, 2, v26
v_sub_u32 v5, v5, v27
v_bfe_u32 v27, v0, 4, 1
v_lshlrev_b32 v6, 17, v27
v_lshl_add_u32 v6, v26, 8, v6
v_and_b32 v27, 15, v0
v_lshl_add_u32 v6, v27, 4, v6
v_and_b32 v2, 63, v0
v_lshlrev_b32 v2, 4, v2
s_lshl_b32 s24, s17, 13
v_add_u32 v1, s24, v2
v_add_u32 v3, 32768, v2
v_mov_b32 v4, v2
s_lshl_b32 s46, s42, 20
s_add_u32 s46, s46, 0
s_mov_b32 s47, s24
s_lshl_b32 s44, s41, 2
s_add_u32 s45, s44, 4
s_add_u32 s44, s44, s17
s_mov_b32 s43, 0
s_mov_b32 s48, 0
s_barrier
s_mov_b32 m0, s47
s_add_u32 s24, s46, 4096
buffer_load_dwordx4 v1, s[8:11], s46 offen offset:0 sc1 lds
buffer_load_dwordx4 v1, s[8:11], s46 offen offset:1024 sc1 lds
buffer_load_dwordx4 v1, s[8:11], s46 offen offset:2048 sc1 lds
buffer_load_dwordx4 v1, s[8:11], s46 offen offset:3072 sc1 lds
s_add_u32 m0, s47, 4096
s_nop 0
buffer_load_dwordx4 v1, s[8:11], s24 offen offset:0 sc1 lds
buffer_load_dwordx4 v1, s[8:11], s24 offen offset:1024 sc1 lds
buffer_load_dwordx4 v1, s[8:11], s24 offen offset:2048 sc1 lds
buffer_load_dwordx4 v1, s[8:11], s24 offen offset:3072 sc1 lds
s_add_u32 s46, s46, 32768
s_add_u32 s47, s47, 32768
s_and_b32 s47, s47, 131071
s_mov_b32 m0, s47
s_add_u32 s24, s46, 4096
buffer_load_dwordx4 v1, s[8:11], s46 offen offset:0 sc1 lds
buffer_load_dwordx4 v1, s[8:11], s46 offen offset:1024 sc1 lds
buffer_load_dwordx4 v1, s[8:11], s46 offen offset:2048 sc1 lds
buffer_load_dwordx4 v1, s[8:11], s46 offen offset:3072 sc1 lds
s_add_u32 m0, s47, 4096
s_nop 0
buffer_load_dwordx4 v1, s[8:11], s24 offen offset:0 sc1 lds
buffer_load_dwordx4 v1, s[8:11], s24 offen offset:1024 sc1 lds
buffer_load_dwordx4 v1, s[8:11], s24 offen offset:2048 sc1 lds
buffer_load_dwordx4 v1, s[8:11], s24 offen offset:3072 sc1 lds
s_add_u32 s46, s46, 32768
s_add_u32 s47, s47, 32768
s_and_b32 s47, s47, 131071
s_mov_b32 m0, s47
s_add_u32 s24, s46, 4096
buffer_load_dwordx4 v1, s[8:11], s46 offen offset:0 sc1 lds
buffer_load_dwordx4 v1, s[8:11], s46 offen offset:1024 sc1 lds
buffer_load_dwordx4 v1, s[8:11], s46 offen offset:2048 sc1 lds
buffer_load_dwordx4 v1, s[8:11], s46 offen offset:3072 sc1 lds
s_add_u32 m0, s47, 4096
s_nop 0
buffer_load_dwordx4 v1, s[8:11], s24 offen offset:0 sc1 lds
buffer_load_dwordx4 v1, s[8:11], s24 offen offset:1024 sc1 lds
buffer_load_dwordx4 v1, s[8:11], s24 offen offset:2048 sc1 lds
buffer_load_dwordx4 v1, s[8:11], s24 offen offset:3072 sc1 lds
s_add_u32 s46, s46, 32768
s_add_u32 s47, s47, 32768
s_and_b32 s47, s47, 131071
v_mov_b64 v[128:129], 0
v_mov_b64 v[130:131], 0
v_mov_b64 v[132:133], 0
v_mov_b64 v[134:135], 0
v_mov_b64 v[136:137], 0
v_mov_b64 v[138:139], 0
v_mov_b64 v[140:141], 0
v_mov_b64 v[142:143], 0
v_mov_b64 v[144:145], 0
v_mov_b64 v[146:147], 0
v_mov_b64 v[148:149], 0
v_mov_b64 v[150:151], 0
v_mov_b64 v[152:153], 0
v_mov_b64 v[154:155], 0
v_mov_b64 v[156:157], 0
v_mov_b64 v[158:159], 0
v_mov_b64 v[160:161], 0
v_mov_b64 v[162:163], 0
v_mov_b64 v[164:165], 0
v_mov_b64 v[166:167], 0
v_mov_b64 v[168:169], 0
v_mov_b64 v[170:171], 0
v_mov_b64 v[172:173], 0
v_mov_b64 v[174:175], 0
v_mov_b64 v[176:177], 0
v_mov_b64 v[178:179], 0
v_mov_b64 v[180:181], 0
v_mov_b64 v[182:183], 0
v_mov_b64 v[184:185], 0
v_mov_b64 v[186:187], 0
v_mov_b64 v[188:189], 0
v_mov_b64 v[190:191], 0
v_mov_b64 v[192:193], 0
v_mov_b64 v[194:195], 0
v_mov_b64 v[196:197], 0
v_mov_b64 v[198:199], 0
v_mov_b64 v[200:201], 0
v_mov_b64 v[202:203], 0
v_mov_b64 v[204:205], 0
v_mov_b64 v[206:207], 0
v_mov_b64 v[208:209], 0
v_mov_b64 v[210:211], 0
v_mov_b64 v[212:213], 0
v_mov_b64 v[214:215], 0
v_mov_b64 v[216:217], 0
v_mov_b64 v[218:219], 0
v_mov_b64 v[220:221], 0
v_mov_b64 v[222:223], 0
v_mov_b64 v[224:225], 0
v_mov_b64 v[226:227], 0
v_mov_b64 v[228:229], 0
v_mov_b64 v[230:231], 0
v_mov_b64 v[232:233], 0
v_mov_b64 v[234:235], 0
v_mov_b64 v[236:237], 0
v_mov_b64 v[238:239], 0
v_mov_b64 v[240:241], 0
v_mov_b64 v[242:243], 0
v_mov_b64 v[244:245], 0
v_mov_b64 v[246:247], 0
v_mov_b64 v[248:249], 0
v_mov_b64 v[250:251], 0
v_mov_b64 v[252:253], 0
v_mov_b64 v[254:255], 0
v_mov_b64 v[112:113], 0
v_mov_b64 v[114:115], 0
v_mov_b64 v[116:117], 0
v_mov_b64 v[118:119], 0
v_mov_b64 v[120:121], 0
v_mov_b64 v[122:123], 0
v_mov_b64 v[124:125], 0
v_mov_b64 v[126:127], 0
v_mov_b32 v20, s50
v_mov_b32 v21, s50
v_mov_b64 v[22:23], 0
s_waitcnt vmcnt(16)
s_barrier
ds_read_b128 a[64:67], v2 offset:0
ds_read_b128 a[68:71], v2 offset:1024
ds_read_b128 a[72:75], v2 offset:2048
ds_read_b128 a[76:79], v2 offset:3072
s_waitcnt lgkmcnt(3)
v_mfma_f32_32x32x16_bf16 v[32:47], a[64:67], a[0:3], 0
ds_read_b128 a[80:83], v2 offset:4096
v_mfma_f32_32x32x16_bf16 v[48:63], a[64:67], a[32:35], 0
s_waitcnt lgkmcnt(3)
v_mfma_f32_32x32x16_bf16 v[32:47], a[68:71], a[4:7], v[32:47]
ds_read_b128 a[84:87], v2 offset:5120
v_mfma_f32_32x32x16_bf16 v[48:63], a[68:71], a[36:39], v[48:63]
s_waitcnt lgkmcnt(3)
v_mfma_f32_32x32x16_bf16 v[32:47], a[72:75], a[8:11], v[32:47]
ds_read_b128 a[88:91], v2 offset:6144
v_mfma_f32_32x32x16_bf16 v[48:63], a[72:75], a[40:43], v[48:63]
s_waitcnt lgkmcnt(3)
v_mfma_f32_32x32x16_bf16 v[32:47], a[76:79], a[12:15], v[32:47]
ds_read_b128 a[92:95], v2 offset:7168
v_mfma_f32_32x32x16_bf16 v[48:63], a[76:79], a[44:47], v[48:63]
s_waitcnt lgkmcnt(3)
v_mfma_f32_32x32x16_bf16 v[32:47], a[80:83], a[16:19], v[32:47]
ds_read_b128 a[64:67], v4 offset:24576
v_mfma_f32_32x32x16_bf16 v[48:63], a[80:83], a[48:51], v[48:63]
s_waitcnt lgkmcnt(3)
v_mfma_f32_32x32x16_bf16 v[32:47], a[84:87], a[20:23], v[32:47]
ds_read_b128 a[68:71], v4 offset:25600
v_mfma_f32_32x32x16_bf16 v[48:63], a[84:87], a[52:55], v[48:63]
s_waitcnt lgkmcnt(3)
v_mfma_f32_32x32x16_bf16 v[32:47], a[88:91], a[24:27], v[32:47]
ds_read_b128 a[72:75], v4 offset:26624
v_mfma_f32_32x32x16_bf16 v[48:63], a[88:91], a[56:59], v[48:63]
s_waitcnt lgkmcnt(3)
v_mfma_f32_32x32x16_bf16 v[32:47], a[92:95], a[28:31], v[32:47]
ds_read_b128 a[76:79], v4 offset:27648
v_mfma_f32_32x32x16_bf16 v[48:63], a[92:95], a[60:63], v[48:63]
s_cmp_eq_u32 s44, 0
s_cbranch_scc1 L_at_last
.p2align 3
L_at_loop:
s_waitcnt lgkmcnt(3)
v_mfma_f32_32x32x16_bf16 v[128:143], a[64:67], v[112:115], v[128:143]
ds_read_b128 a[80:83], v4 offset:28672
v_mfma_f32_32x32x16_bf16 v[144:159], a[64:67], v[120:123], v[144:159]
s_add_u32 s24, s43, 3
s_cmp_lt_u32 s24, s45
s_cselect_b32 s46, s46, 536870912
s_waitcnt lgkmcnt(3)
v_mfma_f32_32x32x16_bf16 v[128:143], a[68:71], v[116:119], v[128:143]
ds_read_b128 a[84:87], v4 offset:29696
v_max3_f32 v26, v32, v33, v34
v_max3_f32 v26, v26, v35, v36
v_max3_f32 v26, v26, v37, v38
v_max3_f32 v26, v26, v39, v40
v_max3_f32 v26, v26, v41, v42
v_max3_f32 v26, v26, v43, v44
v_mfma_f32_32x32x16_bf16 v[144:159], a[68:71], v[124:127], v[144:159]
v_max3_f32 v26, v26, v45, v46
v_max_f32 v26, v26, v47
v_max3_f32 v27, v48, v49, v50
v_max3_f32 v27, v27, v51, v52
v_max3_f32 v27, v27, v53, v54
s_waitcnt lgkmcnt(3)
v_mfma_f32_32x32x16_bf16 v[160:175], a[72:75], v[112:115], v[160:175]
ds_read_b128 a[88:91], v4 offset:30720
v_max3_f32 v27, v27, v55, v56
v_max3_f32 v27, v27, v57, v58
v_max3_f32 v27, v27, v59, v60
v_max3_f32 v27, v27, v61, v62
v_max_f32 v27, v27, v63
v_fma_f32 v28, v26, s40, -v20
v_mfma_f32_32x32x16_bf16 v[176:191], a[72:75], v[120:123], v[176:191]
v_fma_f32 v29, v27, s40, -v21
v_max_f32 v28, v28, v29
v_cmp_lt_f32 vcc, s51, v28
s_cbranch_vccnz L_at_upa
L_at_upra:
v_fma_f32 v32, v32, s40, -v20
s_waitcnt lgkmcnt(3)
v_mfma_f32_32x32x16_bf16 v[160:175], a[76:79], v[116:119], v[160:175]
ds_read_b128 a[92:95], v4 offset:31744
v_fma_f32 v33, v33, s40, -v20
v_fma_f32 v34, v34, s40, -v20
v_fma_f32 v35, v35, s40, -v20
v_exp_f32 v32, v32
v_mfma_f32_32x32x16_bf16 v[176:191], a[76:79], v[124:127], v[176:191]
v_exp_f32 v33, v33
v_fma_f32 v36, v36, s40, -v20
v_fma_f32 v37, v37, s40, -v20
v_exp_f32 v34, v34
s_waitcnt lgkmcnt(3)
v_mfma_f32_32x32x16_bf16 v[192:207], a[80:83], v[112:115], v[192:207]
ds_read_b128 a[64:67], v2 offset:16384
v_exp_f32 v35, v35
v_add_f32 v22, v22, v32
v_cvt_pk_bf16_f32 v96, v32, v33
v_add_f32 v22, v22, v33
v_fma_f32 v38, v38, s40, -v20
v_mfma_f32_32x32x16_bf16 v[208:223], a[80:83], v[120:123], v[208:223]
v_fma_f32 v39, v39, s40, -v20
v_exp_f32 v36, v36
v_exp_f32 v37, v37
s_waitcnt lgkmcnt(3)
v_mfma_f32_32x32x16_bf16 v[192:207], a[84:87], v[116:119], v[192:207]
ds_read_b128 a[68:71], v2 offset:17408
v_add_f32 v22, v22, v34
v_cvt_pk_bf16_f32 v97, v34, v35
v_add_f32 v22, v22, v35
v_fma_f32 v40, v40, s40, -v20
v_fma_f32 v41, v41, s40, -v20
v_mfma_f32_32x32x16_bf16 v[208:223], a[84:87], v[124:127], v[208:223]
v_exp_f32 v38, v38
v_exp_f32 v39, v39
v_add_f32 v22, v22, v36
v_cvt_pk_bf16_f32 v98, v36, v37
s_waitcnt lgkmcnt(3)
v_mfma_f32_32x32x16_bf16 v[224:239], a[88:91], v[112:115], v[224:239]
ds_read_b128 a[72:75], v2 offset:18432
v_add_f32 v22, v22, v37
v_fma_f32 v42, v42, s40, -v20
v_fma_f32 v43, v43, s40, -v20
v_exp_f32 v40, v40
v_mfma_f32_32x32x16_bf16 v[240:255], a[88:91], v[120:123], v[240:255]
v_exp_f32 v41, v41
v_add_f32 v22, v22, v38
v_cvt_pk_bf16_f32 v99, v38, v39
v_add_f32 v22, v22, v39
v_fma_f32 v44, v44, s40, -v20
s_waitcnt lgkmcnt(3)
v_mfma_f32_32x32x16_bf16 v[224:239], a[92:95], v[116:119], v[224:239]
ds_read_b128 a[76:79], v2 offset:19456
v_fma_f32 v45, v45, s40, -v20
v_exp_f32 v42, v42
v_exp_f32 v43, v43
v_add_f32 v22, v22, v40
v_mfma_f32_32x32x16_bf16 v[240:255], a[92:95], v[124:127], v[240:255]
s_cmp_eq_u32 s48, 0
s_cbranch_scc0 L_at_rsa
L_at_rsra:
v_cvt_pk_bf16_f32 v100, v40, v41
v_add_f32 v22, v22, v41
v_fma_f32 v46, v46, s40, -v20
v_fma_f32 v47, v47, s40, -v20
v_exp_f32 v44, v44
s_waitcnt lgkmcnt(3)
v_mfma_f32_32x32x16_bf16 v[64:79], a[64:67], a[0:3], 0
ds_read_b128 a[80:83], v2 offset:20480
v_exp_f32 v45, v45
v_add_f32 v22, v22, v42
v_cvt_pk_bf16_f32 v101, v42, v43
v_add_f32 v22, v22, v43
v_mfma_f32_32x32x16_bf16 v[80:95], a[64:67], a[32:35], 0
v_fma_f32 v48, v48, s40, -v21
v_fma_f32 v49, v49, s40, -v21
v_exp_f32 v46, v46
v_exp_f32 v47, v47
s_waitcnt lgkmcnt(3)
v_mfma_f32_32x32x16_bf16 v[64:79], a[68:71], a[4:7], v[64:79]
ds_read_b128 a[84:87], v2 offset:21504
v_add_f32 v22, v22, v44
v_cvt_pk_bf16_f32 v102, v44, v45
v_add_f32 v22, v22, v45
v_fma_f32 v50, v50, s40, -v21
v_fma_f32 v51, v51, s40, -v21
v_mfma_f32_32x32x16_bf16 v[80:95], a[68:71], a[36:39], v[80:95]
v_exp_f32 v48, v48
v_exp_f32 v49, v49
v_add_f32 v22, v22, v46
s_waitcnt lgkmcnt(3)
v_mfma_f32_32x32x16_bf16 v[64:79], a[72:75], a[8:11], v[64:79]
ds_read_b128 a[88:91], v2 offset:22528
v_cvt_pk_bf16_f32 v103, v46, v47
v_add_f32 v22, v22, v47
v_fma_f32 v52, v52, s40, -v21
v_fma_f32 v53, v53, s40, -v21
v_exp_f32 v50, v50
v_mfma_f32_32x32x16_bf16 v[80:95], a[72:75], a[40:43], v[80:95]
v_exp_f32 v51, v51
v_add_f32 v23, v23, v48
v_cvt_pk_bf16_f32 v104, v48, v49
v_add_f32 v23, v23, v49
s_waitcnt lgkmcnt(3)
v_mfma_f32_32x32x16_bf16 v[64:79], a[76:79], a[12:15], v[64:79]
ds_read_b128 a[92:95], v2 offset:23552
v_fma_f32 v54, v54, s40, -v21
v_fma_f32 v55, v55, s40, -v21
v_exp_f32 v52, v52
v_exp_f32 v53, v53
v_mfma_f32_32x32x16_bf16 v[80:95], a[76:79], a[44:47], v[80:95]
v_add_f32 v23, v23, v50
v_cvt_pk_bf16_f32 v105, v50, v51
v_add_f32 v23, v23, v51
v_fma_f32 v56, v56, s40, -v21
v_fma_f32 v57, v57, s40, -v21
s_waitcnt lgkmcnt(3)
v_mfma_f32_32x32x16_bf16 v[64:79], a[80:83], a[16:19], v[64:79]
ds_read_b128 a[64:67], v2 offset:8192
v_exp_f32 v54, v54
v_exp_f32 v55, v55
v_add_f32 v23, v23, v52
v_cvt_pk_bf16_f32 v106, v52, v53
v_mfma_f32_32x32x16_bf16 v[80:95], a[80:83], a[48:51], v[80:95]
v_add_f32 v23, v23, v53
v_fma_f32 v58, v58, s40, -v21
v_fma_f32 v59, v59, s40, -v21
v_exp_f32 v56, v56
s_waitcnt lgkmcnt(3)
v_mfma_f32_32x32x16_bf16 v[64:79], a[84:87], a[20:23], v[64:79]
ds_read_b128 a[68:71], v2 offset:9216
v_exp_f32 v57, v57
v_add_f32 v23, v23, v54
v_cvt_pk_bf16_f32 v107, v54, v55
v_add_f32 v23, v23, v55
v_fma_f32 v60, v60, s40, -v21
v_mfma_f32_32x32x16_bf16 v[80:95], a[84:87], a[52:55], v[80:95]
v_fma_f32 v61, v61, s40, -v21
v_exp_f32 v58, v58
v_exp_f32 v59, v59
s_waitcnt lgkmcnt(3)
v_mfma_f32_32x32x16_bf16 v[64:79], a[88:91], a[24:27], v[64:79]
ds_read_b128 a[72:75], v2 offset:10240
v_add_f32 v23, v23, v56
v_cvt_pk_bf16_f32 v108, v56, v57
v_add_f32 v23, v23, v57
v_fma_f32 v62, v62, s40, -v21
v_fma_f32 v63, v63, s40, -v21
v_mfma_f32_32x32x16_bf16 v[80:95], a[88:91], a[56:59], v[80:95]
v_exp_f32 v60, v60
v_exp_f32 v61, v61
v_add_f32 v23, v23, v58
v_cvt_pk_bf16_f32 v109, v58, v59
s_waitcnt lgkmcnt(3)
v_mfma_f32_32x32x16_bf16 v[64:79], a[92:95], a[28:31], v[64:79]
ds_read_b128 a[76:79], v2 offset:11264
v_add_f32 v23, v23, v59
v_exp_f32 v62, v62
v_exp_f32 v63, v63
v_add_f32 v23, v23, v60
v_mfma_f32_32x32x16_bf16 v[80:95], a[92:95], a[60:63], v[80:95]
v_cvt_pk_bf16_f32 v110, v60, v61
v_add_f32 v23, v23, v61
v_add_f32 v23, v23, v62
v_cvt_pk_bf16_f32 v111, v62, v63
v_add_f32 v23, v23, v63
s_waitcnt vmcnt(8)
s_barrier
s_waitcnt lgkmcnt(3)
v_mfma_f32_32x32x16_bf16 v[128:143], a[64:67], v[96:99], v[128:143]
ds_read_b128 a[80:83], v2 offset:12288
v_mfma_f32_32x32x16_bf16 v[144:159], a[64:67], v[104:107], v[144:159]
s_mov_b32 m0, s47
s_add_u32 s24, s46, 4096
s_waitcnt lgkmcnt(3)
v_mfma_f32_32x32x16_bf16 v[128:143], a[68:71], v[100:103], v[128:143]
ds_read_b128 a[84:87], v2 offset:13312
v_max3_f32 v26, v64, v65, v66
v_max3_f32 v26, v26, v67, v68
v_max3_f32 v26, v26, v69, v70
v_max3_f32 v26, v26, v71, v72
v_max3_f32 v26, v26, v73, v74
v_max3_f32 v26, v26, v75, v76
v_mfma_f32_32x32x16_bf16 v[144:159], a[68:71], v[108:111], v[144:159]
buffer_load_dwordx4 v1, s[8:11], s46 offen offset:0 sc1 lds
v_max3_f32 v26, v26, v77, v78
v_max_f32 v26, v26, v79
v_max3_f32 v27, v80, v81, v82
v_max3_f32 v27, v27, v83, v84
v_max3_f32 v27, v27, v85, v86
s_waitcnt lgkmcnt(3)
v_mfma_f32_32x32x16_bf16 v[160:175], a[72:75], v[96:99], v[160:175]
ds_read_b128 a[88:91], v2 offset:14336
v_max3_f32 v27, v27, v87, v88
v_max3_f32 v27, v27, v89, v90
v_max3_f32 v27, v27, v91, v92
v_max3_f32 v27, v27, v93, v94
v_max_f32 v27, v27, v95
v_fma_f32 v28, v26, s40, -v20
v_mfma_f32_32x32x16_bf16 v[176:191], a[72:75], v[104:107], v[176:191]
buffer_load_dwordx4 v1, s[8:11], s46 offen offset:1024 sc1 lds
v_fma_f32 v29, v27, s40, -v21
v_max_f32 v28, v28, v29
v_cmp_lt_f32 vcc, s51, v28
s_cbranch_vccnz L_at_upb
L_at_uprb:
v_fma_f32 v64, v64, s40, -v20
s_waitcnt lgkmcnt(3)
v_mfma_f32_32x32x16_bf16 v[160:175], a[76:79], v[100:103], v[160:175]
ds_read_b128 a[92:95], v2 offset:15360
v_fma_f32 v65, v65, s40, -v20
v_fma_f32 v66, v66, s40, -v20
v_fma_f32 v67, v67, s40, -v20
v_exp_f32 v64, v64
v_mfma_f32_32x32x16_bf16 v[176:191], a[76:79], v[108:111], v[176:191]
buffer_load_dwordx4 v1, s[8:11], s46 offen offset:2048 sc1 lds
v_exp_f32 v65, v65
v_fma_f32 v68, v68, s40, -v20
v_fma_f32 v69, v69, s40, -v20
v_exp_f32 v66, v66
s_waitcnt lgkmcnt(3)
v_mfma_f32_32x32x16_bf16 v[192:207], a[80:83], v[96:99], v[192:207]
ds_read_b128 a[64:67], v3 offset:0
v_exp_f32 v67, v67
v_add_f32 v22, v22, v64
v_cvt_pk_bf16_f32 v112, v64, v65
v_add_f32 v22, v22, v65
v_fma_f32 v70, v70, s40, -v20
v_mfma_f32_32x32x16_bf16 v[208:223], a[80:83], v[104:107], v[208:223]
buffer_load_dwordx4 v1, s[8:11], s46 offen offset:3072 sc1 lds
s_add_u32 m0, s47, 4096
v_fma_f32 v71, v71, s40, -v20
v_exp_f32 v68, v68
v_exp_f32 v69, v69
s_waitcnt lgkmcnt(3)
v_mfma_f32_32x32x16_bf16 v[192:207], a[84:87], v[100:103], v[192:207]
ds_read_b128 a[68:71], v3 offset:1024
v_add_f32 v22, v22, v66
v_cvt_pk_bf16_f32 v113, v66, v67
v_add_f32 v22, v22, v67
v_fma_f32 v72, v72, s40, -v20
v_fma_f32 v73, v73, s40, -v20
v_mfma_f32_32x32x16_bf16 v[208:223], a[84:87], v[108:111], v[208:223]
buffer_load_dwordx4 v1, s[8:11], s24 offen offset:0 sc1 lds
v_exp_f32 v70, v70
v_exp_f32 v71, v71
v_add_f32 v22, v22, v68
v_cvt_pk_bf16_f32 v114, v68, v69
s_waitcnt lgkmcnt(3)
v_mfma_f32_32x32x16_bf16 v[224:239], a[88:91], v[96:99], v[224:239]
ds_read_b128 a[72:75], v3 offset:2048
v_add_f32 v22, v22, v69
v_fma_f32 v74, v74, s40, -v20
v_fma_f32 v75, v75, s40, -v20
v_exp_f32 v72, v72
v_mfma_f32_32x32x16_bf16 v[240:255], a[88:91], v[104:107], v[240:255]
buffer_load_dwordx4 v1, s[8:11], s24 offen offset:1024 sc1 lds
v_exp_f32 v73, v73
v_add_f32 v22, v22, v70
v_cvt_pk_bf16_f32 v115, v70, v71
v_add_f32 v22, v22, v71
v_fma_f32 v76, v76, s40, -v20
s_waitcnt lgkmcnt(3)
v_mfma_f32_32x32x16_bf16 v[224:239], a[92:95], v[100:103], v[224:239]
ds_read_b128 a[76:79], v3 offset:3072
v_fma_f32 v77, v77, s40, -v20
v_exp_f32 v74, v74
v_exp_f32 v75, v75
v_add_f32 v22, v22, v72
v_mfma_f32_32x32x16_bf16 v[240:255], a[92:95], v[108:111], v[240:255]
s_cmp_eq_u32 s48, 0
s_cbranch_scc0 L_at_rsb
L_at_rsrb:
buffer_load_dwordx4 v1, s[8:11], s24 offen offset:2048 sc1 lds
v_cvt_pk_bf16_f32 v116, v72, v73
v_add_f32 v22, v22, v73
v_fma_f32 v78, v78, s40, -v20
v_fma_f32 v79, v79, s40, -v20
v_exp_f32 v76, v76
s_waitcnt lgkmcnt(3)
v_mfma_f32_32x32x16_bf16 v[32:47], a[64:67], a[0:3], 0
ds_read_b128 a[80:83], v3 offset:4096
v_exp_f32 v77, v77
v_add_f32 v22, v22, v74
v_cvt_pk_bf16_f32 v117, v74, v75
v_add_f32 v22, v22, v75
v_mfma_f32_32x32x16_bf16 v[48:63], a[64:67], a[32:35], 0
buffer_load_dwordx4 v1, s[8:11], s24 offen offset:3072 sc1 lds
s_add_u32 s46, s46, 32768
s_add_u32 s47, s47, 32768
s_and_b32 s47, s47, 131071
v_fma_f32 v80, v80, s40, -v21
v_fma_f32 v81, v81, s40, -v21
v_exp_f32 v78, v78
v_exp_f32 v79, v79
s_waitcnt lgkmcnt(3)
v_mfma_f32_32x32x16_bf16 v[32:47], a[68:71], a[4:7], v[32:47]
ds_read_b128 a[84:87], v3 offset:5120
v_add_f32 v22, v22, v76
v_cvt_pk_bf16_f32 v118, v76, v77
v_add_f32 v22, v22, v77
v_fma_f32 v82, v82, s40, -v21
v_fma_f32 v83, v83, s40, -v21
v_mfma_f32_32x32x16_bf16 v[48:63], a[68:71], a[36:39], v[48:63]
v_exp_f32 v80, v80
v_exp_f32 v81, v81
v_add_f32 v22, v22, v78
s_waitcnt lgkmcnt(3)
v_mfma_f32_32x32x16_bf16 v[32:47], a[72:75], a[8:11], v[32:47]
ds_read_b128 a[88:91], v3 offset:6144
v_cvt_pk_bf16_f32 v119, v78, v79
v_add_f32 v22, v22, v79
v_fma_f32 v84, v84, s40, -v21
v_fma_f32 v85, v85, s40, -v21
v_exp_f32 v82, v82
v_mfma_f32_32x32x16_bf16 v[48:63], a[72:75], a[40:43], v[48:63]
v_exp_f32 v83, v83
v_add_f32 v23, v23, v80
v_cvt_pk_bf16_f32 v120, v80, v81
v_add_f32 v23, v23, v81
s_waitcnt lgkmcnt(3)
v_mfma_f32_32x32x16_bf16 v[32:47], a[76:79], a[12:15], v[32:47]
ds_read_b128 a[92:95], v3 offset:7168
v_fma_f32 v86, v86, s40, -v21
v_fma_f32 v87, v87, s40, -v21
v_exp_f32 v84, v84
v_exp_f32 v85, v85
v_mfma_f32_32x32x16_bf16 v[48:63], a[76:79], a[44:47], v[48:63]
v_add_f32 v23, v23, v82
v_cvt_pk_bf16_f32 v121, v82, v83
v_add_f32 v23, v23, v83
v_fma_f32 v88, v88, s40, -v21
v_fma_f32 v89, v89, s40, -v21
s_waitcnt lgkmcnt(3)
v_mfma_f32_32x32x16_bf16 v[32:47], a[80:83], a[16:19], v[32:47]
ds_read_b128 a[64:67], v2 offset:24576
v_exp_f32 v86, v86
v_exp_f32 v87, v87
v_add_f32 v23, v23, v84
v_cvt_pk_bf16_f32 v122, v84, v85
v_mfma_f32_32x32x16_bf16 v[48:63], a[80:83], a[48:51], v[48:63]
v_add_f32 v23, v23, v85
v_fma_f32 v90, v90, s40, -v21
v_fma_f32 v91, v91, s40, -v21
v_exp_f32 v88, v88
s_waitcnt lgkmcnt(3)
v_mfma_f32_32x32x16_bf16 v[32:47], a[84:87], a[20:23], v[32:47]
ds_read_b128 a[68:71], v2 offset:25600
v_exp_f32 v89, v89
v_add_f32 v23, v23, v86
v_cvt_pk_bf16_f32 v123, v86, v87
v_add_f32 v23, v23, v87
v_fma_f32 v92, v92, s40, -v21
v_mfma_f32_32x32x16_bf16 v[48:63], a[84:87], a[52:55], v[48:63]
v_fma_f32 v93, v93, s40, -v21
v_exp_f32 v90, v90
v_exp_f32 v91, v91
s_waitcnt lgkmcnt(3)
v_mfma_f32_32x32x16_bf16 v[32:47], a[88:91], a[24:27], v[32:47]
ds_read_b128 a[72:75], v2 offset:26624
v_add_f32 v23, v23, v88
v_cvt_pk_bf16_f32 v124, v88, v89
v_add_f32 v23, v23, v89
v_fma_f32 v94, v94, s40, -v21
v_fma_f32 v95, v95, s40, -v21
v_mfma_f32_32x32x16_bf16 v[48:63], a[88:91], a[56:59], v[48:63]
v_exp_f32 v92, v92
v_exp_f32 v93, v93
v_add_f32 v23, v23, v90
v_cvt_pk_bf16_f32 v125, v90, v91
s_waitcnt lgkmcnt(3)
v_mfma_f32_32x32x16_bf16 v[32:47], a[92:95], a[28:31], v[32:47]
ds_read_b128 a[76:79], v2 offset:27648
v_add_f32 v23, v23, v91
v_exp_f32 v94, v94
v_exp_f32 v95, v95
v_add_f32 v23, v23, v92
v_mfma_f32_32x32x16_bf16 v[48:63], a[92:95], a[60:63], v[48:63]
v_cvt_pk_bf16_f32 v126, v92, v93
v_add_f32 v23, v23, v93
v_add_f32 v23, v23, v94
v_cvt_pk_bf16_f32 v127, v94, v95
v_add_f32 v23, v23, v95
v_mov_b32 v4, v2
v_mov_b32 v2, v3
v_add_u32 v3, 32768, v3
v_and_b32 v3, 131071, v3
s_add_u32 s43, s43, 1
s_cmp_lt_u32 s43, s44
s_cbranch_scc1 L_at_loop
L_at_last:
s_waitcnt lgkmcnt(3)
v_mfma_f32_32x32x16_bf16 v[128:143], a[64:67], v[112:115], v[128:143]
ds_read_b128 a[80:83], v4 offset:28672
v_mfma_f32_32x32x16_bf16 v[144:159], a[64:67], v[120:123], v[144:159]
s_add_u32 s24, s43, 3
s_cmp_lt_u32 s24, s45
s_cselect_b32 s46, s46, 536870912
s_waitcnt lgkmcnt(3)
v_mfma_f32_32x32x16_bf16 v[128:143], a[68:71], v[116:119], v[128:143]
ds_read_b128 a[84:87], v4 offset:29696
v_mov_b32 v31, s50
v_cmp_le_i32 vcc, 0, v5
s_nop 1
v_cndmask_b32 v32, v31, v32, vcc
v_cmp_le_i32 vcc, 1, v5
s_nop 1
v_cndmask_b32 v33, v31, v33, vcc
v_mfma_f32_32x32x16_bf16 v[144:159], a[68:71], v[124:127], v[144:159]
v_cmp_le_i32 vcc, 2, v5
s_nop 1
v_cndmask_b32 v34, v31, v34, vcc
v_cmp_le_i32 vcc, 3, v5
s_nop 1
v_cndmask_b32 v35, v31, v35, vcc
s_waitcnt lgkmcnt(3)
v_mfma_f32_32x32x16_bf16 v[160:175], a[72:75], v[112:115], v[160:175]
ds_read_b128 a[88:91], v4 offset:30720
v_cmp_le_i32 vcc, 8, v5
s_nop 1
v_cndmask_b32 v36, v31, v36, vcc
v_cmp_le_i32 vcc, 9, v5
s_nop 1
v_cndmask_b32 v37, v31, v37, vcc
v_cmp_le_i32 vcc, 10, v5
v_mfma_f32_32x32x16_bf16 v[176:191], a[72:75], v[120:123], v[176:191]
s_nop 0
v_cndmask_b32 v38, v31, v38, vcc
v_cmp_le_i32 vcc, 11, v5
s_nop 1
v_cndmask_b32 v39, v31, v39, vcc
v_cmp_le_i32 vcc, 16, v5
s_waitcnt lgkmcnt(3)
v_mfma_f32_32x32x16_bf16 v[160:175], a[76:79], v[116:119], v[160:175]
ds_read_b128 a[92:95], v4 offset:31744
v_cndmask_b32 v40, v31, v40, vcc
v_cmp_le_i32 vcc, 17, v5
s_nop 1
v_cndmask_b32 v41, v31, v41, vcc
v_cmp_le_i32 vcc, 18, v5
s_nop 1
v_cndmask_b32 v42, v31, v42, vcc
v_mfma_f32_32x32x16_bf16 v[176:191], a[76:79], v[124:127], v[176:191]
v_cmp_le_i32 vcc, 19, v5
s_nop 1
v_cndmask_b32 v43, v31, v43, vcc
v_cmp_le_i32 vcc, 24, v5
s_nop 1
v_cndmask_b32 v44, v31, v44, vcc
s_waitcnt lgkmcnt(3)
v_mfma_f32_32x32x16_bf16 v[192:207], a[80:83], v[112:115], v[192:207]
ds_read_b128 a[64:67], v2 offset:16384
v_cmp_le_i32 vcc, 25, v5
s_nop 1
v_cndmask_b32 v45, v31, v45, vcc
v_cmp_le_i32 vcc, 26, v5
s_nop 1
v_cndmask_b32 v46, v31, v46, vcc
v_cmp_le_i32 vcc, 27, v5
v_mfma_f32_32x32x16_bf16 v[208:223], a[80:83], v[120:123], v[208:223]
s_nop 0
v_cndmask_b32 v47, v31, v47, vcc
v_max3_f32 v26, v32, v33, v34
v_max3_f32 v26, v26, v35, v36
v_max3_f32 v26, v26, v37, v38
s_waitcnt lgkmcnt(3)
v_mfma_f32_32x32x16_bf16 v[192:207], a[84:87], v[116:119], v[192:207]
ds_read_b128 a[68:71], v2 offset:17408
v_max3_f32 v26, v26, v39, v40
v_max3_f32 v26, v26, v41, v42
v_max3_f32 v26, v26, v43, v44
v_max3_f32 v26, v26, v45, v46
v_max_f32 v26, v26, v47
v_mfma_f32_32x32x16_bf16 v[208:223], a[84:87], v[124:127], v[208:223]
v_max3_f32 v27, v48, v49, v50
v_max3_f32 v27, v27, v51, v52
v_max3_f32 v27, v27, v53, v54
v_max3_f32 v27, v27, v55, v56
s_waitcnt lgkmcnt(3)
v_mfma_f32_32x32x16_bf16 v[224:239], a[88:91], v[112:115], v[224:239]
ds_read_b128 a[72:75], v2 offset:18432
v_max3_f32 v27, v27, v57, v58
v_max3_f32 v27, v27, v59, v60
v_max3_f32 v27, v27, v61, v62
v_max_f32 v27, v27, v63
v_fma_f32 v28, v26, s40, -v20
v_mfma_f32_32x32x16_bf16 v[240:255], a[88:91], v[120:123], v[240:255]
v_fma_f32 v29, v27, s40, -v21
v_max_f32 v28, v28, v29
v_cmp_lt_f32 vcc, s51, v28
s_cbranch_vccnz L_at_upc
L_at_uprc:
s_waitcnt lgkmcnt(3)
v_mfma_f32_32x32x16_bf16 v[224:239], a[92:95], v[116:119], v[224:239]
ds_read_b128 a[76:79], v2 offset:19456
v_fma_f32 v32, v32, s40, -v20
v_fma_f32 v33, v33, s40, -v20
v_fma_f32 v34, v34, s40, -v20
v_fma_f32 v35, v35, s40, -v20
v_exp_f32 v32, v32
v_exp_f32 v33, v33
v_mfma_f32_32x32x16_bf16 v[240:255], a[92:95], v[124:127], v[240:255]
s_cmp_eq_u32 s48, 0
s_cbranch_scc0 L_at_rsc
L_at_rsrc:
v_fma_f32 v36, v36, s40, -v20
v_fma_f32 v37, v37, s40, -v20
v_exp_f32 v34, v34
v_exp_f32 v35, v35
v_add_f32 v22, v22, v32
v_cvt_pk_bf16_f32 v96, v32, v33
s_waitcnt lgkmcnt(3)
v_mfma_f32_32x32x16_bf16 v[64:79], a[64:67], a[0:3], 0
ds_read_b128 a[80:83], v2 offset:20480
v_add_f32 v22, v22, v33
v_fma_f32 v38, v38, s40, -v20
v_fma_f32 v39, v39, s40, -v20
v_exp_f32 v36, v36
v_exp_f32 v37, v37
v_add_f32 v22, v22, v34
v_mfma_f32_32x32x16_bf16 v[80:95], a[64:67], a[32:35], 0
v_cvt_pk_bf16_f32 v97, v34, v35
v_add_f32 v22, v22, v35
v_fma_f32 v40, v40, s40, -v20
v_fma_f32 v41, v41, s40, -v20
v_exp_f32 v38, v38
v_exp_f32 v39, v39
s_waitcnt lgkmcnt(3)
v_mfma_f32_32x32x16_bf16 v[64:79], a[68:71], a[4:7], v[64:79]
ds_read_b128 a[84:87], v2 offset:21504
v_add_f32 v22, v22, v36
v_cvt_pk_bf16_f32 v98, v36, v37
v_add_f32 v22, v22, v37
v_fma_f32 v42, v42, s40, -v20
v_fma_f32 v43, v43, s40, -v20
v_exp_f32 v40, v40
v_exp_f32 v41, v41
v_mfma_f32_32x32x16_bf16 v[80:95], a[68:71], a[36:39], v[80:95]
v_add_f32 v22, v22, v38
v_cvt_pk_bf16_f32 v99, v38, v39
v_add_f32 v22, v22, v39
v_fma_f32 v44, v44, s40, -v20
v_fma_f32 v45, v45, s40, -v20
v_exp_f32 v42, v42
s_waitcnt lgkmcnt(3)
v_mfma_f32_32x32x16_bf16 v[64:79], a[72:75], a[8:11], v[64:79]
ds_read_b128 a[88:91], v2 offset:22528
v_exp_f32 v43, v43
v_add_f32 v22, v22, v40
v_cvt_pk_bf16_f32 v100, v40, v41
v_add_f32 v22, v22, v41
v_fma_f32 v46, v46, s40, -v20
v_fma_f32 v47, v47, s40, -v20
v_exp_f32 v44, v44
v_mfma_f32_32x32x16_bf16 v[80:95], a[72:75], a[40:43], v[80:95]
v_exp_f32 v45, v45
v_add_f32 v22, v22, v42
v_cvt_pk_bf16_f32 v101, v42, v43
v_add_f32 v22, v22, v43
v_fma_f32 v48, v48, s40, -v21
v_fma_f32 v49, v49, s40, -v21
s_waitcnt lgkmcnt(3)
v_mfma_f32_32x32x16_bf16 v[64:79], a[76:79], a[12:15], v[64:79]
ds_read_b128 a[92:95], v2 offset:23552
v_exp_f32 v46, v46
v_exp_f32 v47, v47
v_add_f32 v22, v22, v44
v_cvt_pk_bf16_f32 v102, v44, v45
v_add_f32 v22, v22, v45
v_fma_f32 v50, v50, s40, -v21
v_mfma_f32_32x32x16_bf16 v[80:95], a[76:79], a[44:47], v[80:95]
v_fma_f32 v51, v51, s40, -v21
v_exp_f32 v48, v48
v_exp_f32 v49, v49
v_add_f32 v22, v22, v46
v_cvt_pk_bf16_f32 v103, v46, v47
v_add_f32 v22, v22, v47
s_waitcnt lgkmcnt(3)
v_mfma_f32_32x32x16_bf16 v[64:79], a[80:83], a[16:19], v[64:79]
ds_read_b128 a[64:67], v2 offset:8192
v_fma_f32 v52, v52, s40, -v21
v_fma_f32 v53, v53, s40, -v21
v_exp_f32 v50, v50
v_exp_f32 v51, v51
v_add_f32 v23, v23, v48
v_cvt_pk_bf16_f32 v104, v48, v49
v_mfma_f32_32x32x16_bf16 v[80:95], a[80:83], a[48:51], v[80:95]
v_add_f32 v23, v23, v49
v_fma_f32 v54, v54, s40, -v21
v_fma_f32 v55, v55, s40, -v21
v_exp_f32 v52, v52
v_exp_f32 v53, v53
v_add_f32 v23, v23, v50
s_waitcnt lgkmcnt(3)
v_mfma_f32_32x32x16_bf16 v[64:79], a[84:87], a[20:23], v[64:79]
ds_read_b128 a[68:71], v2 offset:9216
v_cvt_pk_bf16_f32 v105, v50, v51
v_add_f32 v23, v23, v51
v_fma_f32 v56, v56, s40, -v21
v_fma_f32 v57, v57, s40, -v21
v_exp_f32 v54, v54
v_exp_f32 v55, v55
v_mfma_f32_32x32x16_bf16 v[80:95], a[84:87], a[52:55], v[80:95]
v_add_f32 v23, v23, v52
v_cvt_pk_bf16_f32 v106, v52, v53
v_add_f32 v23, v23, v53
v_fma_f32 v58, v58, s40, -v21
v_fma_f32 v59, v59, s40, -v21
v_exp_f32 v56, v56
v_exp_f32 v57, v57
s_waitcnt lgkmcnt(3)
v_mfma_f32_32x32x16_bf16 v[64:79], a[88:91], a[24:27], v[64:79]
ds_read_b128 a[72:75], v2 offset:10240
v_add_f32 v23, v23, v54
v_cvt_pk_bf16_f32 v107, v54, v55
v_add_f32 v23, v23, v55
v_fma_f32 v60, v60, s40, -v21
v_fma_f32 v61, v61, s40, -v21
v_exp_f32 v58, v58
v_mfma_f32_32x32x16_bf16 v[80:95], a[88:91], a[56:59], v[80:95]
v_exp_f32 v59, v59
v_add_f32 v23, v23, v56
v_cvt_pk_bf16_f32 v108, v56, v57
v_add_f32 v23, v23, v57
v_fma_f32 v62, v62, s40, -v21
v_fma_f32 v63, v63, s40, -v21
v_exp_f32 v60, v60
s_waitcnt lgkmcnt(3)
v_mfma_f32_32x32x16_bf16 v[64:79], a[92:95], a[28:31], v[64:79]
ds_read_b128 a[76:79], v2 offset:11264
v_exp_f32 v61, v61
v_add_f32 v23, v23, v58
v_cvt_pk_bf16_f32 v109, v58, v59
v_add_f32 v23, v23, v59
v_exp_f32 v62, v62
v_mfma_f32_32x32x16_bf16 v[80:95], a[92:95], a[60:63], v[80:95]
v_exp_f32 v63, v63
v_add_f32 v23, v23, v60
v_cvt_pk_bf16_f32 v110, v60, v61
v_add_f32 v23, v23, v61
v_add_f32 v23, v23, v62
v_cvt_pk_bf16_f32 v111, v62, v63
v_add_f32 v23, v23, v63
s_waitcnt vmcnt(8)
s_barrier
s_waitcnt lgkmcnt(3)
v_mfma_f32_32x32x16_bf16 v[128:143], a[64:67], v[96:99], v[128:143]
ds_read_b128 a[80:83], v2 offset:12288
v_mfma_f32_32x32x16_bf16 v[144:159], a[64:67], v[104:107], v[144:159]
s_mov_b32 m0, s47
s_add_u32 s24, s46, 4096
s_nop 0
buffer_load_dwordx4 v1, s[8:11], s46 offen offset:0 sc1 lds
s_waitcnt lgkmcnt(3)
v_mfma_f32_32x32x16_bf16 v[128:143], a[68:71], v[100:103], v[128:143]
ds_read_b128 a[84:87], v2 offset:13312
v_mov_b32 v31, s50
v_cmp_le_i32 vcc, 0, v5
s_nop 1
v_cndmask_b32 v80, v31, v80, vcc
v_cmp_le_i32 vcc, 1, v5
s_nop 1
v_cndmask_b32 v81, v31, v81, vcc
v_cmp_le_i32 vcc, 2, v5
v_mfma_f32_32x32x16_bf16 v[144:159], a[68:71], v[108:111], v[144:159]
buffer_load_dwordx4 v1, s[8:11], s46 offen offset:1024 sc1 lds
v_cndmask_b32 v82, v31, v82, vcc
v_cmp_le_i32 vcc, 3, v5
s_nop 1
v_cndmask_b32 v83, v31, v83, vcc
v_cmp_le_i32 vcc, 8, v5
s_nop 1
v_cndmask_b32 v84, v31, v84, vcc
v_cmp_le_i32 vcc, 9, v5
s_waitcnt lgkmcnt(3)
v_mfma_f32_32x32x16_bf16 v[160:175], a[72:75], v[96:99], v[160:175]
ds_read_b128 a[88:91], v2 offset:14336
v_cndmask_b32 v85, v31, v85, vcc
v_cmp_le_i32 vcc, 10, v5
s_nop 1
v_cndmask_b32 v86, v31, v86, vcc
v_cmp_le_i32 vcc, 11, v5
s_nop 1
v_cndmask_b32 v87, v31, v87, vcc
v_cmp_le_i32 vcc, 16, v5
v_mfma_f32_32x32x16_bf16 v[176:191], a[72:75], v[104:107], v[176:191]
buffer_load_dwordx4 v1, s[8:11], s46 offen offset:2048 sc1 lds
v_cndmask_b32 v88, v31, v88, vcc
v_cmp_le_i32 vcc, 17, v5
s_nop 1
v_cndmask_b32 v89, v31, v89, vcc
v_cmp_le_i32 vcc, 18, v5
s_nop 1
v_cndmask_b32 v90, v31, v90, vcc
s_waitcnt lgkmcnt(3)
v_mfma_f32_32x32x16_bf16 v[160:175], a[76:79], v[100:103], v[160:175]
ds_read_b128 a[92:95], v2 offset:15360
v_cmp_le_i32 vcc, 19, v5
s_nop 1
v_cndmask_b32 v91, v31, v91, vcc
v_cmp_le_i32 vcc, 24, v5
s_nop 1
v_cndmask_b32 v92, v31, v92, vcc
v_cmp_le_i32 vcc, 25, v5
s_nop 1
v_cndmask_b32 v93, v31, v93, vcc
v_mfma_f32_32x32x16_bf16 v[176:191], a[76:79], v[108:111], v[176:191]
buffer_load_dwordx4 v1, s[8:11], s46 offen offset:3072 sc1 lds
s_add_u32 m0, s47, 4096
v_cmp_le_i32 vcc, 26, v5
s_nop 1
v_cndmask_b32 v94, v31, v94, vcc
v_cmp_le_i32 vcc, 27, v5
s_nop 1
v_cndmask_b32 v95, v31, v95, vcc
v_mov_b32 v64, v31
v_mov_b32 v65, v31
s_waitcnt lgkmcnt(3)
v_mfma_f32_32x32x16_bf16 v[192:207], a[80:83], v[96:99], v[192:207]
ds_read_b128 a[64:67], v2 offset:24576
v_mov_b32 v66, v31
v_mov_b32 v67, v31
v_mov_b32 v68, v31
v_mov_b32 v69, v31
v_mov_b32 v70, v31
v_mov_b32 v71, v31
v_mfma_f32_32x32x16_bf16 v[208:223], a[80:83], v[104:107], v[208:223]
buffer_load_dwordx4 v1, s[8:11], s24 offen offset:0 sc1 lds
v_mov_b32 v72, v31
v_mov_b32 v73, v31
v_mov_b32 v74, v31
v_mov_b32 v75, v31
v_mov_b32 v76, v31
v_mov_b32 v77, v31
s_waitcnt lgkmcnt(3)
v_mfma_f32_32x32x16_bf16 v[192:207], a[84:87], v[100:103], v[192:207]
ds_read_b128 a[68:71], v2 offset:25600
v_mov_b32 v78, v31
v_mov_b32 v79, v31
v_max3_f32 v26, v64, v65, v66
v_max3_f32 v26, v26, v67, v68
v_max3_f32 v26, v26, v69, v70
v_max3_f32 v26, v26, v71, v72
v_mfma_f32_32x32x16_bf16 v[208:223], a[84:87], v[108:111], v[208:223]
buffer_load_dwordx4 v1, s[8:11], s24 offen offset:1024 sc1 lds
v_max3_f32 v26, v26, v73, v74
v_max3_f32 v26, v26, v75, v76
v_max3_f32 v26, v26, v77, v78
v_max_f32 v26, v26, v79
v_max3_f32 v27, v80, v81, v82
s_waitcnt lgkmcnt(3)
v_mfma_f32_32x32x16_bf16 v[224:239], a[88:91], v[96:99], v[224:239]
ds_read_b128 a[72:75], v2 offset:26624
v_max3_f32 v27, v27, v83, v84
v_max3_f32 v27, v27, v85, v86
v_max3_f32 v27, v27, v87, v88
v_max3_f32 v27, v27, v89, v90
v_max3_f32 v27, v27, v91, v92
v_max3_f32 v27, v27, v93, v94
v_mfma_f32_32x32x16_bf16 v[240:255], a[88:91], v[104:107], v[240:255]
buffer_load_dwordx4 v1, s[8:11], s24 offen offset:2048 sc1 lds
v_max_f32 v27, v27, v95
v_fma_f32 v28, v26, s40, -v20
v_fma_f32 v29, v27, s40, -v21
v_max_f32 v28, v28, v29
v_cmp_lt_f32 vcc, s51, v28
s_cbranch_vccnz L_at_upd
L_at_uprd:
s_waitcnt lgkmcnt(3)
v_mfma_f32_32x32x16_bf16 v[224:239], a[92:95], v[100:103], v[224:239]
ds_read_b128 a[76:79], v2 offset:27648
v_fma_f32 v64, v64, s40, -v20
v_fma_f32 v65, v65, s40, -v20
v_fma_f32 v66, v66, s40, -v20
v_fma_f32 v67, v67, s40, -v20
v_exp_f32 v64, v64
v_exp_f32 v65, v65
v_fma_f32 v68, v68, s40, -v20
v_fma_f32 v69, v69, s40, -v20
v_exp_f32 v66, v66
v_exp_f32 v67, v67
v_add_f32 v22, v22, v64
v_cvt_pk_bf16_f32 v112, v64, v65
v_add_f32 v22, v22, v65
v_fma_f32 v70, v70, s40, -v20
v_fma_f32 v71, v71, s40, -v20
v_exp_f32 v68, v68
v_exp_f32 v69, v69
v_add_f32 v22, v22, v66
v_cvt_pk_bf16_f32 v113, v66, v67
v_add_f32 v22, v22, v67
v_fma_f32 v72, v72, s40, -v20
v_fma_f32 v73, v73, s40, -v20
v_exp_f32 v70, v70
v_exp_f32 v71, v71
v_add_f32 v22, v22, v68
v_cvt_pk_bf16_f32 v114, v68, v69
v_add_f32 v22, v22, v69
v_fma_f32 v74, v74, s40, -v20
v_fma_f32 v75, v75, s40, -v20
v_exp_f32 v72, v72
v_exp_f32 v73, v73
v_add_f32 v22, v22, v70
v_cvt_pk_bf16_f32 v115, v70, v71
v_add_f32 v22, v22, v71
v_fma_f32 v76, v76, s40, -v20
v_fma_f32 v77, v77, s40, -v20
v_exp_f32 v74, v74
v_exp_f32 v75, v75
v_add_f32 v22, v22, v72
v_cvt_pk_bf16_f32 v116, v72, v73
v_add_f32 v22, v22, v73
v_fma_f32 v78, v78, s40, -v20
v_fma_f32 v79, v79, s40, -v20
v_exp_f32 v76, v76
v_exp_f32 v77, v77
v_add_f32 v22, v22, v74
v_cvt_pk_bf16_f32 v117, v74, v75
v_add_f32 v22, v22, v75
v_fma_f32 v80, v80, s40, -v21
v_fma_f32 v81, v81, s40, -v21
v_exp_f32 v78, v78
v_exp_f32 v79, v79
v_add_f32 v22, v22, v76
v_cvt_pk_bf16_f32 v118, v76, v77
v_add_f32 v22, v22, v77
v_fma_f32 v82, v82, s40, -v21
v_mfma_f32_32x32x16_bf16 v[240:255], a[92:95], v[108:111], v[240:255]
s_cmp_eq_u32 s48, 0
s_cbranch_scc0 L_at_rsd
L_at_rsrd:
buffer_load_dwordx4 v1, s[8:11], s24 offen offset:3072 sc1 lds
s_add_u32 s46, s46, 32768
s_add_u32 s47, s47, 32768
s_and_b32 s47, s47, 131071
v_fma_f32 v83, v83, s40, -v21
v_exp_f32 v80, v80
v_exp_f32 v81, v81
v_add_f32 v22, v22, v78
v_cvt_pk_bf16_f32 v119, v78, v79
v_add_f32 v22, v22, v79
v_fma_f32 v84, v84, s40, -v21
v_fma_f32 v85, v85, s40, -v21
v_exp_f32 v82, v82
v_exp_f32 v83, v83
v_add_f32 v23, v23, v80
v_cvt_pk_bf16_f32 v120, v80, v81
v_add_f32 v23, v23, v81
v_fma_f32 v86, v86, s40, -v21
v_fma_f32 v87, v87, s40, -v21
v_exp_f32 v84, v84
v_exp_f32 v85, v85
v_add_f32 v23, v23, v82
v_cvt_pk_bf16_f32 v121, v82, v83
v_add_f32 v23, v23, v83
v_fma_f32 v88, v88, s40, -v21
v_fma_f32 v89, v89, s40, -v21
v_exp_f32 v86, v86
v_exp_f32 v87, v87
v_add_f32 v23, v23, v84
v_cvt_pk_bf16_f32 v122, v84, v85
v_add_f32 v23, v23, v85
v_fma_f32 v90, v90, s40, -v21
v_fma_f32 v91, v91, s40, -v21
v_exp_f32 v88, v88
v_exp_f32 v89, v89
v_add_f32 v23, v23, v86
v_cvt_pk_bf16_f32 v123, v86, v87
v_add_f32 v23, v23, v87
v_fma_f32 v92, v92, s40, -v21
v_fma_f32 v93, v93, s40, -v21
v_exp_f32 v90, v90
v_exp_f32 v91, v91
v_add_f32 v23, v23, v88
v_cvt_pk_bf16_f32 v124, v88, v89
v_add_f32 v23, v23, v89
v_fma_f32 v94, v94, s40, -v21
v_fma_f32 v95, v95, s40, -v21
v_exp_f32 v92, v92
v_exp_f32 v93, v93
v_add_f32 v23, v23, v90
v_cvt_pk_bf16_f32 v125, v90, v91
v_add_f32 v23, v23, v91
v_exp_f32 v94, v94
v_exp_f32 v95, v95
v_add_f32 v23, v23, v92
v_cvt_pk_bf16_f32 v126, v92, v93
v_add_f32 v23, v23, v93
v_add_f32 v23, v23, v94
v_cvt_pk_bf16_f32 v127, v94, v95
v_add_f32 v23, v23, v95
s_waitcnt lgkmcnt(3)
v_mfma_f32_32x32x16_bf16 v[128:143], a[64:67], v[112:115], v[128:143]
ds_read_b128 a[80:83], v2 offset:28672
v_mfma_f32_32x32x16_bf16 v[144:159], a[64:67], v[120:123], v[144:159]
s_waitcnt lgkmcnt(3)
v_mfma_f32_32x32x16_bf16 v[128:143], a[68:71], v[116:119], v[128:143]
ds_read_b128 a[84:87], v2 offset:29696
v_mfma_f32_32x32x16_bf16 v[144:159], a[68:71], v[124:127], v[144:159]
s_waitcnt lgkmcnt(3)
v_mfma_f32_32x32x16_bf16 v[160:175], a[72:75], v[112:115], v[160:175]
ds_read_b128 a[88:91], v2 offset:30720
v_mfma_f32_32x32x16_bf16 v[176:191], a[72:75], v[120:123], v[176:191]
s_waitcnt lgkmcnt(3)
v_mfma_f32_32x32x16_bf16 v[160:175], a[76:79], v[116:119], v[160:175]
ds_read_b128 a[92:95], v2 offset:31744
v_mfma_f32_32x32x16_bf16 v[176:191], a[76:79], v[124:127], v[176:191]
s_waitcnt lgkmcnt(3)
v_mfma_f32_32x32x16_bf16 v[192:207], a[80:83], v[112:115], v[192:207]
v_mfma_f32_32x32x16_bf16 v[208:223], a[80:83], v[120:123], v[208:223]
s_waitcnt lgkmcnt(2)
v_mfma_f32_32x32x16_bf16 v[192:207], a[84:87], v[116:119], v[192:207]
v_mfma_f32_32x32x16_bf16 v[208:223], a[84:87], v[124:127], v[208:223]
s_waitcnt lgkmcnt(1)
v_mfma_f32_32x32x16_bf16 v[224:239], a[88:91], v[112:115], v[224:239]
v_mfma_f32_32x32x16_bf16 v[240:255], a[88:91], v[120:123], v[240:255]
s_waitcnt lgkmcnt(0)
v_mfma_f32_32x32x16_bf16 v[224:239], a[92:95], v[116:119], v[224:239]
v_mfma_f32_32x32x16_bf16 v[240:255], a[92:95], v[124:127], v[240:255]
L_at_idle:
s_add_u32 s43, s43, 1
s_cmp_ge_u32 s43, s45
s_cbranch_scc1 L_at_fin
s_waitcnt vmcnt(0)
s_barrier
s_branch L_at_idle
L_at_upa:
v_mov_b32 v28, v26
s_nop 1
v_permlane32_swap_b32 v28, v26
v_max_f32 v26, v26, v28
v_mul_f32 v26, s40, v26
v_max_f32 v26, v26, v20
v_sub_f32 v28, v20, v26
v_exp_f32 v24, v28
v_mov_b32 v20, v26
v_mul_f32 v22, v22, v24
v_mov_b32 v29, v27
s_nop 1
v_permlane32_swap_b32 v29, v27
v_max_f32 v27, v27, v29
v_mul_f32 v27, s40, v27
v_max_f32 v27, v27, v21
v_sub_f32 v29, v21, v27
v_exp_f32 v25, v29
v_mov_b32 v21, v27
v_mul_f32 v23, v23, v25
s_mov_b32 s48, 1
s_branch L_at_upra
L_at_rsa:
s_nop 7
s_nop 3
v_pk_mul_f32 v[128:129], v[128:129], v[24:25] op_sel:[0,0] op_sel_hi:[1,0]
v_pk_mul_f32 v[130:131], v[130:131], v[24:25] op_sel:[0,0] op_sel_hi:[1,0]
v_pk_mul_f32 v[132:133], v[132:133], v[24:25] op_sel:[0,0] op_sel_hi:[1,0]
v_pk_mul_f32 v[134:135], v[134:135], v[24:25] op_sel:[0,0] op_sel_hi:[1,0]
v_pk_mul_f32 v[136:137], v[136:137], v[24:25] op_sel:[0,0] op_sel_hi:[1,0]
v_pk_mul_f32 v[138:139], v[138:139], v[24:25] op_sel:[0,0] op_sel_hi:[1,0]
v_pk_mul_f32 v[140:141], v[140:141], v[24:25] op_sel:[0,0] op_sel_hi:[1,0]
v_pk_mul_f32 v[142:143], v[142:143], v[24:25] op_sel:[0,0] op_sel_hi:[1,0]
v_pk_mul_f32 v[144:145], v[144:145], v[24:25] op_sel:[0,1] op_sel_hi:[1,1]
v_pk_mul_f32 v[146:147], v[146:147], v[24:25] op_sel:[0,1] op_sel_hi:[1,1]
v_pk_mul_f32 v[148:149], v[148:149], v[24:25] op_sel:[0,1] op_sel_hi:[1,1]
v_pk_mul_f32 v[150:151], v[150:151], v[24:25] op_sel:[0,1] op_sel_hi:[1,1]
v_pk_mul_f32 v[152:153], v[152:153], v[24:25] op_sel:[0,1] op_sel_hi:[1,1]
v_pk_mul_f32 v[154:155], v[154:155], v[24:25] op_sel:[0,1] op_sel_hi:[1,1]
v_pk_mul_f32 v[156:157], v[156:157], v[24:25] op_sel:[0,1] op_sel_hi:[1,1]
v_pk_mul_f32 v[158:159], v[158:159], v[24:25] op_sel:[0,1] op_sel_hi:[1,1]
v_pk_mul_f32 v[160:161], v[160:161], v[24:25] op_sel:[0,0] op_sel_hi:[1,0]
v_pk_mul_f32 v[162:163], v[162:163], v[24:25] op_sel:[0,0] op_sel_hi:[1,0]
v_pk_mul_f32 v[164:165], v[164:165], v[24:25] op_sel:[0,0] op_sel_hi:[1,0]
v_pk_mul_f32 v[166:167], v[166:167], v[24:25] op_sel:[0,0] op_sel_hi:[1,0]
v_pk_mul_f32 v[168:169], v[168:169], v[24:25] op_sel:[0,0] op_sel_hi:[1,0]
v_pk_mul_f32 v[170:171], v[170:171], v[24:25] op_sel:[0,0] op_sel_hi:[1,0]
v_pk_mul_f32 v[172:173], v[172:173], v[24:25] op_sel:[0,0] op_sel_hi:[1,0]
v_pk_mul_f32 v[174:175], v[174:175], v[24:25] op_sel:[0,0] op_sel_hi:[1,0]
v_pk_mul_f32 v[176:177], v[176:177], v[24:25] op_sel:[0,1] op_sel_hi:[1,1]
v_pk_mul_f32 v[178:179], v[178:179], v[24:25] op_sel:[0,1] op_sel_hi:[1,1]
v_pk_mul_f32 v[180:181], v[180:181], v[24:25] op_sel:[0,1] op_sel_hi:[1,1]
v_pk_mul_f32 v[182:183], v[182:183], v[24:25] op_sel:[0,1] op_sel_hi:[1,1]
v_pk_mul_f32 v[184:185], v[184:185], v[24:25] op_sel:[0,1] op_sel_hi:[1,1]
v_pk_mul_f32 v[186:187], v[186:187], v[24:25] op_sel:[0,1] op_sel_hi:[1,1]
v_pk_mul_f32 v[188:189], v[188:189], v[24:25] op_sel:[0,1] op_sel_hi:[1,1]
v_pk_mul_f32 v[190:191], v[190:191], v[24:25] op_sel:[0,1] op_sel_hi:[1,1]
v_pk_mul_f32 v[192:193], v[192:193], v[24:25] op_sel:[0,0] op_sel_hi:[1,0]
v_pk_mul_f32 v[194:195], v[194:195], v[24:25] op_sel:[0,0] op_sel_hi:[1,0]
v_pk_mul_f32 v[196:197], v[196:197], v[24:25] op_sel:[0,0] op_sel_hi:[1,0]
v_pk_mul_f32 v[198:199], v[198:199], v[24:25] op_sel:[0,0] op_sel_hi:[1,0]
v_pk_mul_f32 v[200:201], v[200:201], v[24:25] op_sel:[0,0] op_sel_hi:[1,0]
v_pk_mul_f32 v[202:203], v[202:203], v[24:25] op_sel:[0,0] op_sel_hi:[1,0]
v_pk_mul_f32 v[204:205], v[204:205], v[24:25] op_sel:[0,0] op_sel_hi:[1,0]
v_pk_mul_f32 v[206:207], v[206:207], v[24:25] op_sel:[0,0] op_sel_hi:[1,0]
v_pk_mul_f32 v[208:209], v[208:209], v[24:25] op_sel:[0,1] op_sel_hi:[1,1]
v_pk_mul_f32 v[210:211], v[210:211], v[24:25] op_sel:[0,1] op_sel_hi:[1,1]
v_pk_mul_f32 v[212:213], v[212:213], v[24:25] op_sel:[0,1] op_sel_hi:[1,1]
v_pk_mul_f32 v[214:215], v[214:215], v[24:25] op_sel:[0,1] op_sel_hi:[1,1]
v_pk_mul_f32 v[216:217], v[216:217], v[24:25] op_sel:[0,1] op_sel_hi:[1,1]
v_pk_mul_f32 v[218:219], v[218:219], v[24:25] op_sel:[0,1] op_sel_hi:[1,1]
v_pk_mul_f32 v[220:221], v[220:221], v[24:25] op_sel:[0,1] op_sel_hi:[1,1]
v_pk_mul_f32 v[222:223], v[222:223], v[24:25] op_sel:[0,1] op_sel_hi:[1,1]
v_pk_mul_f32 v[224:225], v[224:225], v[24:25] op_sel:[0,0] op_sel_hi:[1,0]
v_pk_mul_f32 v[226:227], v[226:227], v[24:25] op_sel:[0,0] op_sel_hi:[1,0]
v_pk_mul_f32 v[228:229], v[228:229], v[24:25] op_sel:[0,0] op_sel_hi:[1,0]
v_pk_mul_f32 v[230:231], v[230:231], v[24:25] op_sel:[0,0] op_sel_hi:[1,0]
v_pk_mul_f32 v[232:233], v[232:233], v[24:25] op_sel:[0,0] op_sel_hi:[1,0]
v_pk_mul_f32 v[234:235], v[234:235], v[24:25] op_sel:[0,0] op_sel_hi:[1,0]
v_pk_mul_f32 v[236:237], v[236:237], v[24:25] op_sel:[0,0] op_sel_hi:[1,0]
v_pk_mul_f32 v[238:239], v[238:239], v[24:25] op_sel:[0,0] op_sel_hi:[1,0]
v_pk_mul_f32 v[240:241], v[240:241], v[24:25] op_sel:[0,1] op_sel_hi:[1,1]
v_pk_mul_f32 v[242:243], v[242:243], v[24:25] op_sel:[0,1] op_sel_hi:[1,1]
v_pk_mul_f32 v[244:245], v[244:245], v[24:25] op_sel:[0,1] op_sel_hi:[1,1]
v_pk_mul_f32 v[246:247], v[246:247], v[24:25] op_sel:[0,1] op_sel_hi:[1,1]
v_pk_mul_f32 v[248:249], v[248:249], v[24:25] op_sel:[0,1] op_sel_hi:[1,1]
v_pk_mul_f32 v[250:251], v[250:251], v[24:25] op_sel:[0,1] op_sel_hi:[1,1]
v_pk_mul_f32 v[252:253], v[252:253], v[24:25] op_sel:[0,1] op_sel_hi:[1,1]
v_pk_mul_f32 v[254:255], v[254:255], v[24:25] op_sel:[0,1] op_sel_hi:[1,1]
s_mov_b32 s48, 0
s_nop 1
s_branch L_at_rsra
L_at_upb:
v_mov_b32 v28, v26
s_nop 1
v_permlane32_swap_b32 v28, v26
v_max_f32 v26, v26, v28
v_mul_f32 v26, s40, v26
v_max_f32 v26, v26, v20
v_sub_f32 v28, v20, v26
v_exp_f32 v24, v28
v_mov_b32 v20, v26
v_mul_f32 v22, v22, v24
v_mov_b32 v29, v27
s_nop 1
v_permlane32_swap_b32 v29, v27
v_max_f32 v27, v27, v29
v_mul_f32 v27, s40, v27
v_max_f32 v27, v27, v21
v_sub_f32 v29, v21, v27
v_exp_f32 v25, v29
v_mov_b32 v21, v27
v_mul_f32 v23, v23, v25
s_mov_b32 s48, 1
s_branch L_at_uprb
L_at_rsb:
s_nop 7
s_nop 3
v_pk_mul_f32 v[128:129], v[128:129], v[24:25] op_sel:[0,0] op_sel_hi:[1,0]
v_pk_mul_f32 v[130:131], v[130:131], v[24:25] op_sel:[0,0] op_sel_hi:[1,0]
v_pk_mul_f32 v[132:133], v[132:133], v[24:25] op_sel:[0,0] op_sel_hi:[1,0]
v_pk_mul_f32 v[134:135], v[134:135], v[24:25] op_sel:[0,0] op_sel_hi:[1,0]
v_pk_mul_f32 v[136:137], v[136:137], v[24:25] op_sel:[0,0] op_sel_hi:[1,0]
v_pk_mul_f32 v[138:139], v[138:139], v[24:25] op_sel:[0,0] op_sel_hi:[1,0]
v_pk_mul_f32 v[140:141], v[140:141], v[24:25] op_sel:[0,0] op_sel_hi:[1,0]
v_pk_mul_f32 v[142:143], v[142:143], v[24:25] op_sel:[0,0] op_sel_hi:[1,0]
v_pk_mul_f32 v[144:145], v[144:145], v[24:25] op_sel:[0,1] op_sel_hi:[1,1]
v_pk_mul_f32 v[146:147], v[146:147], v[24:25] op_sel:[0,1] op_sel_hi:[1,1]
v_pk_mul_f32 v[148:149], v[148:149], v[24:25] op_sel:[0,1] op_sel_hi:[1,1]
v_pk_mul_f32 v[150:151], v[150:151], v[24:25] op_sel:[0,1] op_sel_hi:[1,1]
v_pk_mul_f32 v[152:153], v[152:153], v[24:25] op_sel:[0,1] op_sel_hi:[1,1]
v_pk_mul_f32 v[154:155], v[154:155], v[24:25] op_sel:[0,1] op_sel_hi:[1,1]
v_pk_mul_f32 v[156:157], v[156:157], v[24:25] op_sel:[0,1] op_sel_hi:[1,1]
v_pk_mul_f32 v[158:159], v[158:159], v[24:25] op_sel:[0,1] op_sel_hi:[1,1]
v_pk_mul_f32 v[160:161], v[160:161], v[24:25] op_sel:[0,0] op_sel_hi:[1,0]
v_pk_mul_f32 v[162:163], v[162:163], v[24:25] op_sel:[0,0] op_sel_hi:[1,0]
v_pk_mul_f32 v[164:165], v[164:165], v[24:25] op_sel:[0,0] op_sel_hi:[1,0]
v_pk_mul_f32 v[166:167], v[166:167], v[24:25] op_sel:[0,0] op_sel_hi:[1,0]
v_pk_mul_f32 v[168:169], v[168:169], v[24:25] op_sel:[0,0] op_sel_hi:[1,0]
v_pk_mul_f32 v[170:171], v[170:171], v[24:25] op_sel:[0,0] op_sel_hi:[1,0]
v_pk_mul_f32 v[172:173], v[172:173], v[24:25] op_sel:[0,0] op_sel_hi:[1,0]
v_pk_mul_f32 v[174:175], v[174:175], v[24:25] op_sel:[0,0] op_sel_hi:[1,0]
v_pk_mul_f32 v[176:177], v[176:177], v[24:25] op_sel:[0,1] op_sel_hi:[1,1]
v_pk_mul_f32 v[178:179], v[178:179], v[24:25] op_sel:[0,1] op_sel_hi:[1,1]
v_pk_mul_f32 v[180:181], v[180:181], v[24:25] op_sel:[0,1] op_sel_hi:[1,1]
v_pk_mul_f32 v[182:183], v[182:183], v[24:25] op_sel:[0,1] op_sel_hi:[1,1]
v_pk_mul_f32 v[184:185], v[184:185], v[24:25] op_sel:[0,1] op_sel_hi:[1,1]
v_pk_mul_f32 v[186:187], v[186:187], v[24:25] op_sel:[0,1] op_sel_hi:[1,1]
v_pk_mul_f32 v[188:189], v[188:189], v[24:25] op_sel:[0,1] op_sel_hi:[1,1]
v_pk_mul_f32 v[190:191], v[190:191], v[24:25] op_sel:[0,1] op_sel_hi:[1,1]
v_pk_mul_f32 v[192:193], v[192:193], v[24:25] op_sel:[0,0] op_sel_hi:[1,0]
v_pk_mul_f32 v[194:195], v[194:195], v[24:25] op_sel:[0,0] op_sel_hi:[1,0]
v_pk_mul_f32 v[196:197], v[196:197], v[24:25] op_sel:[0,0] op_sel_hi:[1,0]
v_pk_mul_f32 v[198:199], v[198:199], v[24:25] op_sel:[0,0] op_sel_hi:[1,0]
v_pk_mul_f32 v[200:201], v[200:201], v[24:25] op_sel:[0,0] op_sel_hi:[1,0]
v_pk_mul_f32 v[202:203], v[202:203], v[24:25] op_sel:[0,0] op_sel_hi:[1,0]
v_pk_mul_f32 v[204:205], v[204:205], v[24:25] op_sel:[0,0] op_sel_hi:[1,0]
v_pk_mul_f32 v[206:207], v[206:207], v[24:25] op_sel:[0,0] op_sel_hi:[1,0]
v_pk_mul_f32 v[208:209], v[208:209], v[24:25] op_sel:[0,1] op_sel_hi:[1,1]
v_pk_mul_f32 v[210:211], v[210:211], v[24:25] op_sel:[0,1] op_sel_hi:[1,1]
v_pk_mul_f32 v[212:213], v[212:213], v[24:25] op_sel:[0,1] op_sel_hi:[1,1]
v_pk_mul_f32 v[214:215], v[214:215], v[24:25] op_sel:[0,1] op_sel_hi:[1,1]
v_pk_mul_f32 v[216:217], v[216:217], v[24:25] op_sel:[0,1] op_sel_hi:[1,1]
v_pk_mul_f32 v[218:219], v[218:219], v[24:25] op_sel:[0,1] op_sel_hi:[1,1]
v_pk_mul_f32 v[220:221], v[220:221], v[24:25] op_sel:[0,1] op_sel_hi:[1,1]
v_pk_mul_f32 v[222:223], v[222:223], v[24:25] op_sel:[0,1] op_sel_hi:[1,1]
v_pk_mul_f32 v[224:225], v[224:225], v[24:25] op_sel:[0,0] op_sel_hi:[1,0]
v_pk_mul_f32 v[226:227], v[226:227], v[24:25] op_sel:[0,0] op_sel_hi:[1,0]
v_pk_mul_f32 v[228:229], v[228:229], v[24:25] op_sel:[0,0] op_sel_hi:[1,0]
v_pk_mul_f32 v[230:231], v[230:231], v[24:25] op_sel:[0,0] op_sel_hi:[1,0]
v_pk_mul_f32 v[232:233], v[232:233], v[24:25] op_sel:[0,0] op_sel_hi:[1,0]
v_pk_mul_f32 v[234:235], v[234:235], v[24:25] op_sel:[0,0] op_sel_hi:[1,0]
v_pk_mul_f32 v[236:237], v[236:237], v[24:25] op_sel:[0,0] op_sel_hi:[1,0]
v_pk_mul_f32 v[238:239], v[238:239], v[24:25] op_sel:[0,0] op_sel_hi:[1,0]
v_pk_mul_f32 v[240:241], v[240:241], v[24:25] op_sel:[0,1] op_sel_hi:[1,1]
v_pk_mul_f32 v[242:243], v[242:243], v[24:25] op_sel:[0,1] op_sel_hi:[1,1]
v_pk_mul_f32 v[244:245], v[244:245], v[24:25] op_sel:[0,1] op_sel_hi:[1,1]
v_pk_mul_f32 v[246:247], v[246:247], v[24:25] op_sel:[0,1] op_sel_hi:[1,1]
v_pk_mul_f32 v[248:249], v[248:249], v[24:25] op_sel:[0,1] op_sel_hi:[1,1]
v_pk_mul_f32 v[250:251], v[250:251], v[24:25] op_sel:[0,1] op_sel_hi:[1,1]
v_pk_mul_f32 v[252:253], v[252:253], v[24:25] op_sel:[0,1] op_sel_hi:[1,1]
v_pk_mul_f32 v[254:255], v[254:255], v[24:25] op_sel:[0,1] op_sel_hi:[1,1]
s_mov_b32 s48, 0
s_nop 1
s_branch L_at_rsrb
L_at_upc:
v_mov_b32 v28, v26
s_nop 1
v_permlane32_swap_b32 v28, v26
v_max_f32 v26, v26, v28
v_mul_f32 v26, s40, v26
v_max_f32 v26, v26, v20
v_sub_f32 v28, v20, v26
v_exp_f32 v24, v28
v_mov_b32 v20, v26
v_mul_f32 v22, v22, v24
v_mov_b32 v29, v27
s_nop 1
v_permlane32_swap_b32 v29, v27
v_max_f32 v27, v27, v29
v_mul_f32 v27, s40, v27
v_max_f32 v27, v27, v21
v_sub_f32 v29, v21, v27
v_exp_f32 v25, v29
v_mov_b32 v21, v27
v_mul_f32 v23, v23, v25
s_mov_b32 s48, 1
s_branch L_at_uprc
L_at_rsc:
s_nop 7
s_nop 3
v_pk_mul_f32 v[128:129], v[128:129], v[24:25] op_sel:[0,0] op_sel_hi:[1,0]
v_pk_mul_f32 v[130:131], v[130:131], v[24:25] op_sel:[0,0] op_sel_hi:[1,0]
v_pk_mul_f32 v[132:133], v[132:133], v[24:25] op_sel:[0,0] op_sel_hi:[1,0]
v_pk_mul_f32 v[134:135], v[134:135], v[24:25] op_sel:[0,0] op_sel_hi:[1,0]
v_pk_mul_f32 v[136:137], v[136:137], v[24:25] op_sel:[0,0] op_sel_hi:[1,0]
v_pk_mul_f32 v[138:139], v[138:139], v[24:25] op_sel:[0,0] op_sel_hi:[1,0]
v_pk_mul_f32 v[140:141], v[140:141], v[24:25] op_sel:[0,0] op_sel_hi:[1,0]
v_pk_mul_f32 v[142:143], v[142:143], v[24:25] op_sel:[0,0] op_sel_hi:[1,0]
v_pk_mul_f32 v[144:145], v[144:145], v[24:25] op_sel:[0,1] op_sel_hi:[1,1]
v_pk_mul_f32 v[146:147], v[146:147], v[24:25] op_sel:[0,1] op_sel_hi:[1,1]
v_pk_mul_f32 v[148:149], v[148:149], v[24:25] op_sel:[0,1] op_sel_hi:[1,1]
v_pk_mul_f32 v[150:151], v[150:151], v[24:25] op_sel:[0,1] op_sel_hi:[1,1]
v_pk_mul_f32 v[152:153], v[152:153], v[24:25] op_sel:[0,1] op_sel_hi:[1,1]
v_pk_mul_f32 v[154:155], v[154:155], v[24:25] op_sel:[0,1] op_sel_hi:[1,1]
v_pk_mul_f32 v[156:157], v[156:157], v[24:25] op_sel:[0,1] op_sel_hi:[1,1]
v_pk_mul_f32 v[158:159], v[158:159], v[24:25] op_sel:[0,1] op_sel_hi:[1,1]
v_pk_mul_f32 v[160:161], v[160:161], v[24:25] op_sel:[0,0] op_sel_hi:[1,0]
v_pk_mul_f32 v[162:163], v[162:163], v[24:25] op_sel:[0,0] op_sel_hi:[1,0]
v_pk_mul_f32 v[164:165], v[164:165], v[24:25] op_sel:[0,0] op_sel_hi:[1,0]
v_pk_mul_f32 v[166:167], v[166:167], v[24:25] op_sel:[0,0] op_sel_hi:[1,0]
v_pk_mul_f32 v[168:169], v[168:169], v[24:25] op_sel:[0,0] op_sel_hi:[1,0]
v_pk_mul_f32 v[170:171], v[170:171], v[24:25] op_sel:[0,0] op_sel_hi:[1,0]
v_pk_mul_f32 v[172:173], v[172:173], v[24:25] op_sel:[0,0] op_sel_hi:[1,0]
v_pk_mul_f32 v[174:175], v[174:175], v[24:25] op_sel:[0,0] op_sel_hi:[1,0]
v_pk_mul_f32 v[176:177], v[176:177], v[24:25] op_sel:[0,1] op_sel_hi:[1,1]
v_pk_mul_f32 v[178:179], v[178:179], v[24:25] op_sel:[0,1] op_sel_hi:[1,1]
v_pk_mul_f32 v[180:181], v[180:181], v[24:25] op_sel:[0,1] op_sel_hi:[1,1]
v_pk_mul_f32 v[182:183], v[182:183], v[24:25] op_sel:[0,1] op_sel_hi:[1,1]
v_pk_mul_f32 v[184:185], v[184:185], v[24:25] op_sel:[0,1] op_sel_hi:[1,1]
v_pk_mul_f32 v[186:187], v[186:187], v[24:25] op_sel:[0,1] op_sel_hi:[1,1]
v_pk_mul_f32 v[188:189], v[188:189], v[24:25] op_sel:[0,1] op_sel_hi:[1,1]
v_pk_mul_f32 v[190:191], v[190:191], v[24:25] op_sel:[0,1] op_sel_hi:[1,1]
v_pk_mul_f32 v[192:193], v[192:193], v[24:25] op_sel:[0,0] op_sel_hi:[1,0]
v_pk_mul_f32 v[194:195], v[194:195], v[24:25] op_sel:[0,0] op_sel_hi:[1,0]
v_pk_mul_f32 v[196:197], v[196:197], v[24:25] op_sel:[0,0] op_sel_hi:[1,0]
v_pk_mul_f32 v[198:199], v[198:199], v[24:25] op_sel:[0,0] op_sel_hi:[1,0]
v_pk_mul_f32 v[200:201], v[200:201], v[24:25] op_sel:[0,0] op_sel_hi:[1,0]
v_pk_mul_f32 v[202:203], v[202:203], v[24:25] op_sel:[0,0] op_sel_hi:[1,0]
v_pk_mul_f32 v[204:205], v[204:205], v[24:25] op_sel:[0,0] op_sel_hi:[1,0]
v_pk_mul_f32 v[206:207], v[206:207], v[24:25] op_sel:[0,0] op_sel_hi:[1,0]
v_pk_mul_f32 v[208:209], v[208:209], v[24:25] op_sel:[0,1] op_sel_hi:[1,1]
v_pk_mul_f32 v[210:211], v[210:211], v[24:25] op_sel:[0,1] op_sel_hi:[1,1]
v_pk_mul_f32 v[212:213], v[212:213], v[24:25] op_sel:[0,1] op_sel_hi:[1,1]
v_pk_mul_f32 v[214:215], v[214:215], v[24:25] op_sel:[0,1] op_sel_hi:[1,1]
v_pk_mul_f32 v[216:217], v[216:217], v[24:25] op_sel:[0,1] op_sel_hi:[1,1]
v_pk_mul_f32 v[218:219], v[218:219], v[24:25] op_sel:[0,1] op_sel_hi:[1,1]
v_pk_mul_f32 v[220:221], v[220:221], v[24:25] op_sel:[0,1] op_sel_hi:[1,1]
v_pk_mul_f32 v[222:223], v[222:223], v[24:25] op_sel:[0,1] op_sel_hi:[1,1]
v_pk_mul_f32 v[224:225], v[224:225], v[24:25] op_sel:[0,0] op_sel_hi:[1,0]
v_pk_mul_f32 v[226:227], v[226:227], v[24:25] op_sel:[0,0] op_sel_hi:[1,0]
v_pk_mul_f32 v[228:229], v[228:229], v[24:25] op_sel:[0,0] op_sel_hi:[1,0]
v_pk_mul_f32 v[230:231], v[230:231], v[24:25] op_sel:[0,0] op_sel_hi:[1,0]
v_pk_mul_f32 v[232:233], v[232:233], v[24:25] op_sel:[0,0] op_sel_hi:[1,0]
v_pk_mul_f32 v[234:235], v[234:235], v[24:25] op_sel:[0,0] op_sel_hi:[1,0]
v_pk_mul_f32 v[236:237], v[236:237], v[24:25] op_sel:[0,0] op_sel_hi:[1,0]
v_pk_mul_f32 v[238:239], v[238:239], v[24:25] op_sel:[0,0] op_sel_hi:[1,0]
v_pk_mul_f32 v[240:241], v[240:241], v[24:25] op_sel:[0,1] op_sel_hi:[1,1]
v_pk_mul_f32 v[242:243], v[242:243], v[24:25] op_sel:[0,1] op_sel_hi:[1,1]
v_pk_mul_f32 v[244:245], v[244:245], v[24:25] op_sel:[0,1] op_sel_hi:[1,1]
v_pk_mul_f32 v[246:247], v[246:247], v[24:25] op_sel:[0,1] op_sel_hi:[1,1]
v_pk_mul_f32 v[248:249], v[248:249], v[24:25] op_sel:[0,1] op_sel_hi:[1,1]
v_pk_mul_f32 v[250:251], v[250:251], v[24:25] op_sel:[0,1] op_sel_hi:[1,1]
v_pk_mul_f32 v[252:253], v[252:253], v[24:25] op_sel:[0,1] op_sel_hi:[1,1]
v_pk_mul_f32 v[254:255], v[254:255], v[24:25] op_sel:[0,1] op_sel_hi:[1,1]
s_mov_b32 s48, 0
s_nop 1
s_branch L_at_rsrc
L_at_upd:
v_mov_b32 v28, v26
s_nop 1
v_permlane32_swap_b32 v28, v26
v_max_f32 v26, v26, v28
v_mul_f32 v26, s40, v26
v_max_f32 v26, v26, v20
v_sub_f32 v28, v20, v26
v_exp_f32 v24, v28
v_mov_b32 v20, v26
v_mul_f32 v22, v22, v24
v_mov_b32 v29, v27
s_nop 1
v_permlane32_swap_b32 v29, v27
v_max_f32 v27, v27, v29
v_mul_f32 v27, s40, v27
v_max_f32 v27, v27, v21
v_sub_f32 v29, v21, v27
v_exp_f32 v25, v29
v_mov_b32 v21, v27
v_mul_f32 v23, v23, v25
s_mov_b32 s48, 1
s_branch L_at_uprd
L_at_rsd:
s_nop 7
s_nop 3
v_pk_mul_f32 v[128:129], v[128:129], v[24:25] op_sel:[0,0] op_sel_hi:[1,0]
v_pk_mul_f32 v[130:131], v[130:131], v[24:25] op_sel:[0,0] op_sel_hi:[1,0]
v_pk_mul_f32 v[132:133], v[132:133], v[24:25] op_sel:[0,0] op_sel_hi:[1,0]
v_pk_mul_f32 v[134:135], v[134:135], v[24:25] op_sel:[0,0] op_sel_hi:[1,0]
v_pk_mul_f32 v[136:137], v[136:137], v[24:25] op_sel:[0,0] op_sel_hi:[1,0]
v_pk_mul_f32 v[138:139], v[138:139], v[24:25] op_sel:[0,0] op_sel_hi:[1,0]
v_pk_mul_f32 v[140:141], v[140:141], v[24:25] op_sel:[0,0] op_sel_hi:[1,0]
v_pk_mul_f32 v[142:143], v[142:143], v[24:25] op_sel:[0,0] op_sel_hi:[1,0]
v_pk_mul_f32 v[144:145], v[144:145], v[24:25] op_sel:[0,1] op_sel_hi:[1,1]
v_pk_mul_f32 v[146:147], v[146:147], v[24:25] op_sel:[0,1] op_sel_hi:[1,1]
v_pk_mul_f32 v[148:149], v[148:149], v[24:25] op_sel:[0,1] op_sel_hi:[1,1]
v_pk_mul_f32 v[150:151], v[150:151], v[24:25] op_sel:[0,1] op_sel_hi:[1,1]
v_pk_mul_f32 v[152:153], v[152:153], v[24:25] op_sel:[0,1] op_sel_hi:[1,1]
v_pk_mul_f32 v[154:155], v[154:155], v[24:25] op_sel:[0,1] op_sel_hi:[1,1]
v_pk_mul_f32 v[156:157], v[156:157], v[24:25] op_sel:[0,1] op_sel_hi:[1,1]
v_pk_mul_f32 v[158:159], v[158:159], v[24:25] op_sel:[0,1] op_sel_hi:[1,1]
v_pk_mul_f32 v[160:161], v[160:161], v[24:25] op_sel:[0,0] op_sel_hi:[1,0]
v_pk_mul_f32 v[162:163], v[162:163], v[24:25] op_sel:[0,0] op_sel_hi:[1,0]
v_pk_mul_f32 v[164:165], v[164:165], v[24:25] op_sel:[0,0] op_sel_hi:[1,0]
v_pk_mul_f32 v[166:167], v[166:167], v[24:25] op_sel:[0,0] op_sel_hi:[1,0]
v_pk_mul_f32 v[168:169], v[168:169], v[24:25] op_sel:[0,0] op_sel_hi:[1,0]
v_pk_mul_f32 v[170:171], v[170:171], v[24:25] op_sel:[0,0] op_sel_hi:[1,0]
v_pk_mul_f32 v[172:173], v[172:173], v[24:25] op_sel:[0,0] op_sel_hi:[1,0]
v_pk_mul_f32 v[174:175], v[174:175], v[24:25] op_sel:[0,0] op_sel_hi:[1,0]
v_pk_mul_f32 v[176:177], v[176:177], v[24:25] op_sel:[0,1] op_sel_hi:[1,1]
v_pk_mul_f32 v[178:179], v[178:179], v[24:25] op_sel:[0,1] op_sel_hi:[1,1]
v_pk_mul_f32 v[180:181], v[180:181], v[24:25] op_sel:[0,1] op_sel_hi:[1,1]
v_pk_mul_f32 v[182:183], v[182:183], v[24:25] op_sel:[0,1] op_sel_hi:[1,1]
v_pk_mul_f32 v[184:185], v[184:185], v[24:25] op_sel:[0,1] op_sel_hi:[1,1]
v_pk_mul_f32 v[186:187], v[186:187], v[24:25] op_sel:[0,1] op_sel_hi:[1,1]
v_pk_mul_f32 v[188:189], v[188:189], v[24:25] op_sel:[0,1] op_sel_hi:[1,1]
v_pk_mul_f32 v[190:191], v[190:191], v[24:25] op_sel:[0,1] op_sel_hi:[1,1]
v_pk_mul_f32 v[192:193], v[192:193], v[24:25] op_sel:[0,0] op_sel_hi:[1,0]
v_pk_mul_f32 v[194:195], v[194:195], v[24:25] op_sel:[0,0] op_sel_hi:[1,0]
v_pk_mul_f32 v[196:197], v[196:197], v[24:25] op_sel:[0,0] op_sel_hi:[1,0]
v_pk_mul_f32 v[198:199], v[198:199], v[24:25] op_sel:[0,0] op_sel_hi:[1,0]
v_pk_mul_f32 v[200:201], v[200:201], v[24:25] op_sel:[0,0] op_sel_hi:[1,0]
v_pk_mul_f32 v[202:203], v[202:203], v[24:25] op_sel:[0,0] op_sel_hi:[1,0]
v_pk_mul_f32 v[204:205], v[204:205], v[24:25] op_sel:[0,0] op_sel_hi:[1,0]
v_pk_mul_f32 v[206:207], v[206:207], v[24:25] op_sel:[0,0] op_sel_hi:[1,0]
v_pk_mul_f32 v[208:209], v[208:209], v[24:25] op_sel:[0,1] op_sel_hi:[1,1]
v_pk_mul_f32 v[210:211], v[210:211], v[24:25] op_sel:[0,1] op_sel_hi:[1,1]
v_pk_mul_f32 v[212:213], v[212:213], v[24:25] op_sel:[0,1] op_sel_hi:[1,1]
v_pk_mul_f32 v[214:215], v[214:215], v[24:25] op_sel:[0,1] op_sel_hi:[1,1]
v_pk_mul_f32 v[216:217], v[216:217], v[24:25] op_sel:[0,1] op_sel_hi:[1,1]
v_pk_mul_f32 v[218:219], v[218:219], v[24:25] op_sel:[0,1] op_sel_hi:[1,1]
v_pk_mul_f32 v[220:221], v[220:221], v[24:25] op_sel:[0,1] op_sel_hi:[1,1]
v_pk_mul_f32 v[222:223], v[222:223], v[24:25] op_sel:[0,1] op_sel_hi:[1,1]
v_pk_mul_f32 v[224:225], v[224:225], v[24:25] op_sel:[0,0] op_sel_hi:[1,0]
v_pk_mul_f32 v[226:227], v[226:227], v[24:25] op_sel:[0,0] op_sel_hi:[1,0]
v_pk_mul_f32 v[228:229], v[228:229], v[24:25] op_sel:[0,0] op_sel_hi:[1,0]
v_pk_mul_f32 v[230:231], v[230:231], v[24:25] op_sel:[0,0] op_sel_hi:[1,0]
v_pk_mul_f32 v[232:233], v[232:233], v[24:25] op_sel:[0,0] op_sel_hi:[1,0]
v_pk_mul_f32 v[234:235], v[234:235], v[24:25] op_sel:[0,0] op_sel_hi:[1,0]
v_pk_mul_f32 v[236:237], v[236:237], v[24:25] op_sel:[0,0] op_sel_hi:[1,0]
v_pk_mul_f32 v[238:239], v[238:239], v[24:25] op_sel:[0,0] op_sel_hi:[1,0]
v_pk_mul_f32 v[240:241], v[240:241], v[24:25] op_sel:[0,1] op_sel_hi:[1,1]
v_pk_mul_f32 v[242:243], v[242:243], v[24:25] op_sel:[0,1] op_sel_hi:[1,1]
v_pk_mul_f32 v[244:245], v[244:245], v[24:25] op_sel:[0,1] op_sel_hi:[1,1]
v_pk_mul_f32 v[246:247], v[246:247], v[24:25] op_sel:[0,1] op_sel_hi:[1,1]
v_pk_mul_f32 v[248:249], v[248:249], v[24:25] op_sel:[0,1] op_sel_hi:[1,1]
v_pk_mul_f32 v[250:251], v[250:251], v[24:25] op_sel:[0,1] op_sel_hi:[1,1]
v_pk_mul_f32 v[252:253], v[252:253], v[24:25] op_sel:[0,1] op_sel_hi:[1,1]
v_pk_mul_f32 v[254:255], v[254:255], v[24:25] op_sel:[0,1] op_sel_hi:[1,1]
s_mov_b32 s48, 0
s_nop 1
s_branch L_at_rsrd
L_at_fin:
s_lshl_b32 s26, s41, 4
s_lshl_b32 s27, s17, 2
s_add_u32 s26, s26, s27
s_lshl_b32 s26, s26, 17
s_lshl_b32 s27, s42, 12
s_add_u32 s26, s26, s27
s_add_u32 s26, s26, 67108864
s_add_u32 s27, s26, 262144
v_mov_b32 v26, v22
s_nop 1
v_permlane32_swap_b32 v26, v22
v_add_f32 v26, v26, v22
v_rcp_f32 v26, v26
s_nop 0
v_pk_mul_f32 v[128:129], v[128:129], v[26:27] op_sel_hi:[1,0]
v_pk_mul_f32 v[130:131], v[130:131], v[26:27] op_sel_hi:[1,0]
v_pk_mul_f32 v[132:133], v[132:133], v[26:27] op_sel_hi:[1,0]
v_pk_mul_f32 v[134:135], v[134:135], v[26:27] op_sel_hi:[1,0]
v_pk_mul_f32 v[136:137], v[136:137], v[26:27] op_sel_hi:[1,0]
v_pk_mul_f32 v[138:139], v[138:139], v[26:27] op_sel_hi:[1,0]
v_pk_mul_f32 v[140:141], v[140:141], v[26:27] op_sel_hi:[1,0]
v_pk_mul_f32 v[142:143], v[142:143], v[26:27] op_sel_hi:[1,0]
v_cvt_pk_bf16_f32 v128, v128, v129
v_cvt_pk_bf16_f32 v129, v130, v131
v_cvt_pk_bf16_f32 v130, v132, v133
v_cvt_pk_bf16_f32 v131, v134, v135
buffer_store_dwordx4 v[128:131], v6, s[8:11], s26 offen offset:0 sc1
v_cvt_pk_bf16_f32 v136, v136, v137
v_cvt_pk_bf16_f32 v137, v138, v139
v_cvt_pk_bf16_f32 v138, v140, v141
v_cvt_pk_bf16_f32 v139, v142, v143
buffer_store_dwordx4 v[136:139], v6, s[8:11], s26 offen offset:512 sc1
v_pk_mul_f32 v[160:161], v[160:161], v[26:27] op_sel_hi:[1,0]
v_pk_mul_f32 v[162:163], v[162:163], v[26:27] op_sel_hi:[1,0]
v_pk_mul_f32 v[164:165], v[164:165], v[26:27] op_sel_hi:[1,0]
v_pk_mul_f32 v[166:167], v[166:167], v[26:27] op_sel_hi:[1,0]
v_pk_mul_f32 v[168:169], v[168:169], v[26:27] op_sel_hi:[1,0]
v_pk_mul_f32 v[170:171], v[170:171], v[26:27] op_sel_hi:[1,0]
v_pk_mul_f32 v[172:173], v[172:173], v[26:27] op_sel_hi:[1,0]
v_pk_mul_f32 v[174:175], v[174:175], v[26:27] op_sel_hi:[1,0]
v_cvt_pk_bf16_f32 v160, v160, v161
v_cvt_pk_bf16_f32 v161, v162, v163
v_cvt_pk_bf16_f32 v162, v164, v165
v_cvt_pk_bf16_f32 v163, v166, v167
buffer_store_dwordx4 v[160:163], v6, s[8:11], s26 offen offset:1024 sc1
v_cvt_pk_bf16_f32 v168, v168, v169
v_cvt_pk_bf16_f32 v169, v170, v171
v_cvt_pk_bf16_f32 v170, v172, v173
v_cvt_pk_bf16_f32 v171, v174, v175
buffer_store_dwordx4 v[168:171], v6, s[8:11], s26 offen offset:1536 sc1
v_pk_mul_f32 v[192:193], v[192:193], v[26:27] op_sel_hi:[1,0]
v_pk_mul_f32 v[194:195], v[194:195], v[26:27] op_sel_hi:[1,0]
v_pk_mul_f32 v[196:197], v[196:197], v[26:27] op_sel_hi:[1,0]
v_pk_mul_f32 v[198:199], v[198:199], v[26:27] op_sel_hi:[1,0]
v_pk_mul_f32 v[200:201], v[200:201], v[26:27] op_sel_hi:[1,0]
v_pk_mul_f32 v[202:203], v[202:203], v[26:27] op_sel_hi:[1,0]
v_pk_mul_f32 v[204:205], v[204:205], v[26:27] op_sel_hi:[1,0]
v_pk_mul_f32 v[206:207], v[206:207], v[26:27] op_sel_hi:[1,0]
v_cvt_pk_bf16_f32 v192, v192, v193
v_cvt_pk_bf16_f32 v193, v194, v195
v_cvt_pk_bf16_f32 v194, v196, v197
v_cvt_pk_bf16_f32 v195, v198, v199
buffer_store_dwordx4 v[192:195], v6, s[8:11], s26 offen offset:2048 sc1
v_cvt_pk_bf16_f32 v200, v200, v201
v_cvt_pk_bf16_f32 v201, v202, v203
v_cvt_pk_bf16_f32 v202, v204, v205
v_cvt_pk_bf16_f32 v203, v206, v207
buffer_store_dwordx4 v[200:203], v6, s[8:11], s26 offen offset:2560 sc1
v_pk_mul_f32 v[224:225], v[224:225], v[26:27] op_sel_hi:[1,0]
v_pk_mul_f32 v[226:227], v[226:227], v[26:27] op_sel_hi:[1,0]
v_pk_mul_f32 v[228:229], v[228:229], v[26:27] op_sel_hi:[1,0]
v_pk_mul_f32 v[230:231], v[230:231], v[26:27] op_sel_hi:[1,0]
v_pk_mul_f32 v[232:233], v[232:233], v[26:27] op_sel_hi:[1,0]
v_pk_mul_f32 v[234:235], v[234:235], v[26:27] op_sel_hi:[1,0]
v_pk_mul_f32 v[236:237], v[236:237], v[26:27] op_sel_hi:[1,0]
v_pk_mul_f32 v[238:239], v[238:239], v[26:27] op_sel_hi:[1,0]
v_cvt_pk_bf16_f32 v224, v224, v225
v_cvt_pk_bf16_f32 v225, v226, v227
v_cvt_pk_bf16_f32 v226, v228, v229
v_cvt_pk_bf16_f32 v227, v230, v231
buffer_store_dwordx4 v[224:227], v6, s[8:11], s26 offen offset:3072 sc1
v_cvt_pk_bf16_f32 v232, v232, v233
v_cvt_pk_bf16_f32 v233, v234, v235
v_cvt_pk_bf16_f32 v234, v236, v237
v_cvt_pk_bf16_f32 v235, v238, v239
buffer_store_dwordx4 v[232:235], v6, s[8:11], s26 offen offset:3584 sc1
v_mov_b32 v26, v23
s_nop 1
v_permlane32_swap_b32 v26, v23
v_add_f32 v26, v26, v23
v_rcp_f32 v26, v26
s_nop 0
v_pk_mul_f32 v[144:145], v[144:145], v[26:27] op_sel_hi:[1,0]
v_pk_mul_f32 v[146:147], v[146:147], v[26:27] op_sel_hi:[1,0]
v_pk_mul_f32 v[148:149], v[148:149], v[26:27] op_sel_hi:[1,0]
v_pk_mul_f32 v[150:151], v[150:151], v[26:27] op_sel_hi:[1,0]
v_pk_mul_f32 v[152:153], v[152:153], v[26:27] op_sel_hi:[1,0]
v_pk_mul_f32 v[154:155], v[154:155], v[26:27] op_sel_hi:[1,0]
v_pk_mul_f32 v[156:157], v[156:157], v[26:27] op_sel_hi:[1,0]
v_pk_mul_f32 v[158:159], v[158:159], v[26:27] op_sel_hi:[1,0]
v_cvt_pk_bf16_f32 v144, v144, v145
v_cvt_pk_bf16_f32 v145, v146, v147
v_cvt_pk_bf16_f32 v146, v148, v149
v_cvt_pk_bf16_f32 v147, v150, v151
buffer_store_dwordx4 v[144:147], v6, s[8:11], s27 offen offset:0 sc1
v_cvt_pk_bf16_f32 v152, v152, v153
v_cvt_pk_bf16_f32 v153, v154, v155
v_cvt_pk_bf16_f32 v154, v156, v157
v_cvt_pk_bf16_f32 v155, v158, v159
buffer_store_dwordx4 v[152:155], v6, s[8:11], s27 offen offset:512 sc1
v_pk_mul_f32 v[176:177], v[176:177], v[26:27] op_sel_hi:[1,0]
v_pk_mul_f32 v[178:179], v[178:179], v[26:27] op_sel_hi:[1,0]
v_pk_mul_f32 v[180:181], v[180:181], v[26:27] op_sel_hi:[1,0]
v_pk_mul_f32 v[182:183], v[182:183], v[26:27] op_sel_hi:[1,0]
v_pk_mul_f32 v[184:185], v[184:185], v[26:27] op_sel_hi:[1,0]
v_pk_mul_f32 v[186:187], v[186:187], v[26:27] op_sel_hi:[1,0]
v_pk_mul_f32 v[188:189], v[188:189], v[26:27] op_sel_hi:[1,0]
v_pk_mul_f32 v[190:191], v[190:191], v[26:27] op_sel_hi:[1,0]
v_cvt_pk_bf16_f32 v176, v176, v177
v_cvt_pk_bf16_f32 v177, v178, v179
v_cvt_pk_bf16_f32 v178, v180, v181
v_cvt_pk_bf16_f32 v179, v182, v183
buffer_store_dwordx4 v[176:179], v6, s[8:11], s27 offen offset:1024 sc1
v_cvt_pk_bf16_f32 v184, v184, v185
v_cvt_pk_bf16_f32 v185, v186, v187
v_cvt_pk_bf16_f32 v186, v188, v189
v_cvt_pk_bf16_f32 v187, v190, v191
buffer_store_dwordx4 v[184:187], v6, s[8:11], s27 offen offset:1536 sc1
v_pk_mul_f32 v[208:209], v[208:209], v[26:27] op_sel_hi:[1,0]
v_pk_mul_f32 v[210:211], v[210:211], v[26:27] op_sel_hi:[1,0]
v_pk_mul_f32 v[212:213], v[212:213], v[26:27] op_sel_hi:[1,0]
v_pk_mul_f32 v[214:215], v[214:215], v[26:27] op_sel_hi:[1,0]
v_pk_mul_f32 v[216:217], v[216:217], v[26:27] op_sel_hi:[1,0]
v_pk_mul_f32 v[218:219], v[218:219], v[26:27] op_sel_hi:[1,0]
v_pk_mul_f32 v[220:221], v[220:221], v[26:27] op_sel_hi:[1,0]
v_pk_mul_f32 v[222:223], v[222:223], v[26:27] op_sel_hi:[1,0]
v_cvt_pk_bf16_f32 v208, v208, v209
v_cvt_pk_bf16_f32 v209, v210, v211
v_cvt_pk_bf16_f32 v210, v212, v213
v_cvt_pk_bf16_f32 v211, v214, v215
buffer_store_dwordx4 v[208:211], v6, s[8:11], s27 offen offset:2048 sc1
v_cvt_pk_bf16_f32 v216, v216, v217
v_cvt_pk_bf16_f32 v217, v218, v219
v_cvt_pk_bf16_f32 v218, v220, v221
v_cvt_pk_bf16_f32 v219, v222, v223
buffer_store_dwordx4 v[216:219], v6, s[8:11], s27 offen offset:2560 sc1
v_pk_mul_f32 v[240:241], v[240:241], v[26:27] op_sel_hi:[1,0]
v_pk_mul_f32 v[242:243], v[242:243], v[26:27] op_sel_hi:[1,0]
v_pk_mul_f32 v[244:245], v[244:245], v[26:27] op_sel_hi:[1,0]
v_pk_mul_f32 v[246:247], v[246:247], v[26:27] op_sel_hi:[1,0]
v_pk_mul_f32 v[248:249], v[248:249], v[26:27] op_sel_hi:[1,0]
v_pk_mul_f32 v[250:251], v[250:251], v[26:27] op_sel_hi:[1,0]
v_pk_mul_f32 v[252:253], v[252:253], v[26:27] op_sel_hi:[1,0]
v_pk_mul_f32 v[254:255], v[254:255], v[26:27] op_sel_hi:[1,0]
v_cvt_pk_bf16_f32 v240, v240, v241
v_cvt_pk_bf16_f32 v241, v242, v243
v_cvt_pk_bf16_f32 v242, v244, v245
v_cvt_pk_bf16_f32 v243, v246, v247
buffer_store_dwordx4 v[240:243], v6, s[8:11], s27 offen offset:3072 sc1
v_cvt_pk_bf16_f32 v248, v248, v249
v_cvt_pk_bf16_f32 v249, v250, v251
v_cvt_pk_bf16_f32 v250, v252, v253
v_cvt_pk_bf16_f32 v251, v254, v255
buffer_store_dwordx4 v[248:251], v6, s[8:11], s27 offen offset:3584 sc1
s_lshl_b32 s61, s41, 5
s_add_u32 s61, s61, s42
s_lshl_b32 s61, s61, 2
s_add_u32 s61, s61, 111169536
s_waitcnt vmcnt(0)
s_barrier
s_cmp_lg_u32 s17, 0
s_cbranch_scc1 L_sf_6
v_mov_b32 v20, 0
v_mov_b32 v21, 1
s_mov_b64 exec, 1
buffer_store_dword v21, v20, s[8:11], s61 offen sc1
s_mov_b64 exec, -1
L_sf_6:
s_mov_b32 s41, s62
s_add_u32 s60, s60, 1
s_cmp_lt_u32 s60, 2
s_cbranch_scc1 L_aat
s_cmp_ge_u32 s16, 24
s_cbranch_scc1 L_done
s_load_dwordx2 s[4:5], s[0:1], 40
s_waitcnt lgkmcnt(0)
s_mov_b32 s20, s4
s_and_b32 s21, s5, 0xffff
s_mov_b32 s22, 4718592
s_mov_b32 s23, 0x20000
s_cmp_ge_u32 s16, 12
s_cselect_b32 s24, 1, 0
s_mul_i32 s25, s24, 12
s_sub_u32 s40, s16, s25
s_sub_u32 s25, s3, 4
s_lshl_b32 s25, s25, 1
s_add_u32 s41, s25, s24
s_mov_b32 s43, 8
s_mov_b32 s44, 67108864
s_mov_b32 s45, 111169536
s_mov_b32 s46, 4
s_mov_b32 s47, 0
s_branch L_op
L_bout:
s_cmp_lt_u32 s16, 24
s_cbranch_scc1 L_bo
v_lshlrev_b32 v1, 4, v0
v_mov_b64 v[4:5], 0
v_mov_b64 v[6:7], 0
s_sub_u32 s24, s16, 24
s_lshl_b32 s24, s24, 12
s_add_u32 s24, s24, 111149056
buffer_store_dwordx4 v[4:7], v1, s[8:11], s24 offen sc1
s_waitcnt vmcnt(0)
s_barrier
s_cmp_lg_u32 s17, 0
s_cbranch_scc1 L_end
v_mov_b32 v1, 1
v_mov_b32 v2, 128
s_mov_b64 exec, 1
buffer_atomic_add v1, v2, s[56:59], 0 offen
s_waitcnt vmcnt(0)
s_endpgm
L_bo:
s_load_dwordx2 s[4:5], s[0:1], 88
s_waitcnt lgkmcnt(0)
s_mov_b32 s20, s4
s_and_b32 s21, s5, 0xffff
s_mov_b32 s22, 4718592
s_mov_b32 s23, 0x20000
s_cmp_ge_u32 s16, 12
s_cselect_b32 s41, 1, 0
s_mul_i32 s25, s41, 12
s_sub_u32 s40, s16, s25
s_mov_b32 s43, 2
s_mov_b32 s44, 83886080
s_mov_b32 s45, 111157248
s_mov_b32 s46, 1
s_mov_b32 s47, 1152
L_op:
s_mov_b32 s42, 128
s_load_dwordx2 s[4:5], s[0:1], 104
s_waitcnt lgkmcnt(0)
s_mov_b32 s12, s4
s_and_b32 s13, s5, 0xffff
s_mov_b32 s14, 4718592
s_mov_b32 s15, 0x20000
v_and_b32 v1, 63, v0
v_lshlrev_b32 v3, 3, v1
v_lshlrev_b32 v1, 4, v1
v_bfe_u32 v8, v0, 1, 3
v_bfe_u32 v9, v0, 4, 1
v_lshl_add_u32 v8, v9, 4, v8
v_bfe_u32 v9, v0, 5, 1
v_lshl_add_u32 v8, v9, 3, v8
v_mul_u32_u24 v8, 1152, v8
v_and_b32 v9, 1, v0
v_lshl_add_u32 v8, v9, 4, v8
s_mul_i32 s24, s17, 1179648
s_mul_i32 s25, s40, 96
s_add_u32 s24, s24, s25
v_add_u32 v2, s24, v8
s_mul_i32 s26, s17, 36864
v_add_u32 v3, s26, v3
s_add_u32 m0, s26, 0
s_mov_b32 s24, 0
buffer_load_dwordx4 v2, s[20:23], s24 offen lds
s_add_u32 m0, s26, 1024
s_mov_b32 s24, 32
buffer_load_dwordx4 v2, s[20:23], s24 offen lds
s_add_u32 m0, s26, 2048
s_mov_b32 s24, 64
buffer_load_dwordx4 v2, s[20:23], s24 offen lds
s_add_u32 m0, s26, 3072
s_mov_b32 s24, 36864
buffer_load_dwordx4 v2, s[20:23], s24 offen lds
s_add_u32 m0, s26, 4096
s_mov_b32 s24, 36896
buffer_load_dwordx4 v2, s[20:23], s24 offen lds
s_add_u32 m0, s26, 5120
s_mov_b32 s24, 36928
buffer_load_dwordx4 v2, s[20:23], s24 offen lds
s_add_u32 m0, s26, 6144
s_mov_b32 s24, 73728
buffer_load_dwordx4 v2, s[20:23], s24 offen lds
s_add_u32 m0, s26, 7168
s_mov_b32 s24, 73760
buffer_load_dwordx4 v2, s[20:23], s24 offen lds
s_add_u32 m0, s26, 8192
s_mov_b32 s24, 73792
buffer_load_dwordx4 v2, s[20:23], s24 offen lds
s_add_u32 m0, s26, 9216
s_mov_b32 s24, 110592
buffer_load_dwordx4 v2, s[20:23], s24 offen lds
s_add_u32 m0, s26, 10240
s_mov_b32 s24, 110624
buffer_load_dwordx4 v2, s[20:23], s24 offen lds
s_add_u32 m0, s26, 11264
s_mov_b32 s24, 110656
buffer_load_dwordx4 v2, s[20:23], s24 offen lds
s_add_u32 m0, s26, 12288
s_mov_b32 s24, 147456
buffer_load_dwordx4 v2, s[20:23], s24 offen lds
s_add_u32 m0, s26, 13312
s_mov_b32 s24, 147488
buffer_load_dwordx4 v2, s[20:23], s24 offen lds
s_add_u32 m0, s26, 14336
s_mov_b32 s24, 147520
buffer_load_dwordx4 v2, s[20:23], s24 offen lds
s_add_u32 m0, s26, 15360
s_mov_b32 s24, 184320
buffer_load_dwordx4 v2, s[20:23], s24 offen lds
s_add_u32 m0, s26, 16384
s_mov_b32 s24, 184352
buffer_load_dwordx4 v2, s[20:23], s24 offen lds
s_add_u32 m0, s26, 17408
s_mov_b32 s24, 184384
buffer_load_dwordx4 v2, s[20:23], s24 offen lds
s_add_u32 m0, s26, 18432
s_mov_b32 s24, 221184
buffer_load_dwordx4 v2, s[20:23], s24 offen lds
s_add_u32 m0, s26, 19456
s_mov_b32 s24, 221216
buffer_load_dwordx4 v2, s[20:23], s24 offen lds
s_add_u32 m0, s26, 20480
s_mov_b32 s24, 221248
buffer_load_dwordx4 v2, s[20:23], s24 offen lds
s_add_u32 m0, s26, 21504
s_mov_b32 s24, 258048
buffer_load_dwordx4 v2, s[20:23], s24 offen lds
s_add_u32 m0, s26, 22528
s_mov_b32 s24, 258080
buffer_load_dwordx4 v2, s[20:23], s24 offen lds
s_add_u32 m0, s26, 23552
s_mov_b32 s24, 258112
buffer_load_dwordx4 v2, s[20:23], s24 offen lds
s_add_u32 m0, s26, 24576
s_mov_b32 s24, 294912
buffer_load_dwordx4 v2, s[20:23], s24 offen lds
s_add_u32 m0, s26, 25600
s_mov_b32 s24, 294944
buffer_load_dwordx4 v2, s[20:23], s24 offen lds
s_add_u32 m0, s26, 26624
s_mov_b32 s24, 294976
buffer_load_dwordx4 v2, s[20:23], s24 offen lds
s_add_u32 m0, s26, 27648
s_mov_b32 s24, 331776
buffer_load_dwordx4 v2, s[20:23], s24 offen lds
s_add_u32 m0, s26, 28672
s_mov_b32 s24, 331808
buffer_load_dwordx4 v2, s[20:23], s24 offen lds
s_add_u32 m0, s26, 29696
s_mov_b32 s24, 331840
buffer_load_dwordx4 v2, s[20:23], s24 offen lds
s_add_u32 m0, s26, 30720
s_mov_b32 s24, 368640
buffer_load_dwordx4 v2, s[20:23], s24 offen lds
s_add_u32 m0, s26, 31744
s_mov_b32 s24, 368672
buffer_load_dwordx4 v2, s[20:23], s24 offen lds
s_add_u32 m0, s26, 32768
s_mov_b32 s24, 368704
buffer_load_dwordx4 v2, s[20:23], s24 offen lds
s_add_u32 m0, s26, 33792
s_mov_b32 s24, 405504
buffer_load_dwordx4 v2, s[20:23], s24 offen lds
s_add_u32 m0, s26, 34816
s_mov_b32 s24, 405536
buffer_load_dwordx4 v2, s[20:23], s24 offen lds
s_add_u32 m0, s26, 35840
s_mov_b32 s24, 405568
buffer_load_dwordx4 v2, s[20:23], s24 offen lds
s_waitcnt vmcnt(33)
ds_read_b64_tr_b16 v[128:129], v3 offset:0
ds_read_b64_tr_b16 v[130:131], v3 offset:512
ds_read_b64_tr_b16 v[132:133], v3 offset:1024
ds_read_b64_tr_b16 v[134:135], v3 offset:1536
ds_read_b64_tr_b16 v[136:137], v3 offset:2048
ds_read_b64_tr_b16 v[138:139], v3 offset:2560
s_waitcnt lgkmcnt(0)
s_add_u32 m0, s26, 0
s_mov_b32 s24, 442368
buffer_load_dwordx4 v2, s[20:23], s24 offen lds
s_add_u32 m0, s26, 1024
s_mov_b32 s24, 442400
buffer_load_dwordx4 v2, s[20:23], s24 offen lds
s_add_u32 m0, s26, 2048
s_mov_b32 s24, 442432
buffer_load_dwordx4 v2, s[20:23], s24 offen lds
s_waitcnt vmcnt(33)
ds_read_b64_tr_b16 v[140:141], v3 offset:3072
ds_read_b64_tr_b16 v[142:143], v3 offset:3584
ds_read_b64_tr_b16 v[144:145], v3 offset:4096
ds_read_b64_tr_b16 v[146:147], v3 offset:4608
ds_read_b64_tr_b16 v[148:149], v3 offset:5120
ds_read_b64_tr_b16 v[150:151], v3 offset:5632
s_waitcnt lgkmcnt(0)
s_add_u32 m0, s26, 3072
s_mov_b32 s24, 479232
buffer_load_dwordx4 v2, s[20:23], s24 offen lds
s_add_u32 m0, s26, 4096
s_mov_b32 s24, 479264
buffer_load_dwordx4 v2, s[20:23], s24 offen lds
s_add_u32 m0, s26, 5120
s_mov_b32 s24, 479296
buffer_load_dwordx4 v2, s[20:23], s24 offen lds
s_waitcnt vmcnt(33)
ds_read_b64_tr_b16 v[152:153], v3 offset:6144
ds_read_b64_tr_b16 v[154:155], v3 offset:6656
ds_read_b64_tr_b16 v[156:157], v3 offset:7168
ds_read_b64_tr_b16 v[158:159], v3 offset:7680
ds_read_b64_tr_b16 v[160:161], v3 offset:8192
ds_read_b64_tr_b16 v[162:163], v3 offset:8704
s_waitcnt lgkmcnt(0)
s_add_u32 m0, s26, 6144
s_mov_b32 s24, 516096
buffer_load_dwordx4 v2, s[20:23], s24 offen lds
s_add_u32 m0, s26, 7168
s_mov_b32 s24, 516128
buffer_load_dwordx4 v2, s[20:23], s24 offen lds
s_add_u32 m0, s26, 8192
s_mov_b32 s24, 516160
buffer_load_dwordx4 v2, s[20:23], s24 offen lds
s_waitcnt vmcnt(33)
ds_read_b64_tr_b16 v[164:165], v3 offset:9216
ds_read_b64_tr_b16 v[166:167], v3 offset:9728
ds_read_b64_tr_b16 v[168:169], v3 offset:10240
ds_read_b64_tr_b16 v[170:171], v3 offset:10752
ds_read_b64_tr_b16 v[172:173], v3 offset:11264
ds_read_b64_tr_b16 v[174:175], v3 offset:11776
s_waitcnt lgkmcnt(0)
s_add_u32 m0, s26, 9216
s_mov_b32 s24, 552960
buffer_load_dwordx4 v2, s[20:23], s24 offen lds
s_add_u32 m0, s26, 10240
s_mov_b32 s24, 552992
buffer_load_dwordx4 v2, s[20:23], s24 offen lds
s_add_u32 m0, s26, 11264
s_mov_b32 s24, 553024
buffer_load_dwordx4 v2, s[20:23], s24 offen lds
s_waitcnt vmcnt(33)
ds_read_b64_tr_b16 v[176:177], v3 offset:12288
ds_read_b64_tr_b16 v[178:179], v3 offset:12800
ds_read_b64_tr_b16 v[180:181], v3 offset:13312
ds_read_b64_tr_b16 v[182:183], v3 offset:13824
ds_read_b64_tr_b16 v[184:185], v3 offset:14336
ds_read_b64_tr_b16 v[186:187], v3 offset:14848
s_waitcnt lgkmcnt(0)
s_add_u32 m0, s26, 12288
s_mov_b32 s24, 589824
buffer_load_dwordx4 v2, s[20:23], s24 offen lds
s_add_u32 m0, s26, 13312
s_mov_b32 s24, 589856
buffer_load_dwordx4 v2, s[20:23], s24 offen lds
s_add_u32 m0, s26, 14336
s_mov_b32 s24, 589888
buffer_load_dwordx4 v2, s[20:23], s24 offen lds
s_waitcnt vmcnt(33)
ds_read_b64_tr_b16 v[188:189], v3 offset:15360
ds_read_b64_tr_b16 v[190:191], v3 offset:15872
ds_read_b64_tr_b16 v[192:193], v3 offset:16384
ds_read_b64_tr_b16 v[194:195], v3 offset:16896
ds_read_b64_tr_b16 v[196:197], v3 offset:17408
ds_read_b64_tr_b16 v[198:199], v3 offset:17920
s_waitcnt lgkmcnt(0)
s_add_u32 m0, s26, 15360
s_mov_b32 s24, 626688
buffer_load_dwordx4 v2, s[20:23], s24 offen lds
s_add_u32 m0, s26, 16384
s_mov_b32 s24, 626720
buffer_load_dwordx4 v2, s[20:23], s24 offen lds
s_add_u32 m0, s26, 17408
s_mov_b32 s24, 626752
buffer_load_dwordx4 v2, s[20:23], s24 offen lds
s_waitcnt vmcnt(33)
ds_read_b64_tr_b16 v[200:201], v3 offset:18432
ds_read_b64_tr_b16 v[202:203], v3 offset:18944
ds_read_b64_tr_b16 v[204:205], v3 offset:19456
ds_read_b64_tr_b16 v[206:207], v3 offset:19968
ds_read_b64_tr_b16 v[208:209], v3 offset:20480
ds_read_b64_tr_b16 v[210:211], v3 offset:20992
s_waitcnt lgkmcnt(0)
s_add_u32 m0, s26, 18432
s_mov_b32 s24, 663552
buffer_load_dwordx4 v2, s[20:23], s24 offen lds
s_add_u32 m0, s26, 19456
s_mov_b32 s24, 663584
buffer_load_dwordx4 v2, s[20:23], s24 offen lds
s_add_u32 m0, s26, 20480
s_mov_b32 s24, 663616
buffer_load_dwordx4 v2, s[20:23], s24 offen lds
s_waitcnt vmcnt(33)
ds_read_b64_tr_b16 v[212:213], v3 offset:21504
ds_read_b64_tr_b16 v[214:215], v3 offset:22016
ds_read_b64_tr_b16 v[216:217], v3 offset:22528
ds_read_b64_tr_b16 v[218:219], v3 offset:23040
ds_read_b64_tr_b16 v[220:221], v3 offset:23552
ds_read_b64_tr_b16 v[222:223], v3 offset:24064
s_waitcnt lgkmcnt(0)
s_add_u32 m0, s26, 21504
s_mov_b32 s24, 700416
buffer_load_dwordx4 v2, s[20:23], s24 offen lds
s_add_u32 m0, s26, 22528
s_mov_b32 s24, 700448
buffer_load_dwordx4 v2, s[20:23], s24 offen lds
s_add_u32 m0, s26, 23552
s_mov_b32 s24, 700480
buffer_load_dwordx4 v2, s[20:23], s24 offen lds
s_waitcnt vmcnt(33)
ds_read_b64_tr_b16 v[224:225], v3 offset:24576
ds_read_b64_tr_b16 v[226:227], v3 offset:25088
ds_read_b64_tr_b16 v[228:229], v3 offset:25600
ds_read_b64_tr_b16 v[230:231], v3 offset:26112
ds_read_b64_tr_b16 v[232:233], v3 offset:26624
ds_read_b64_tr_b16 v[234:235], v3 offset:27136
s_waitcnt lgkmcnt(0)
s_add_u32 m0, s26, 24576
s_mov_b32 s24, 737280
buffer_load_dwordx4 v2, s[20:23], s24 offen lds
s_add_u32 m0, s26, 25600
s_mov_b32 s24, 737312
buffer_load_dwordx4 v2, s[20:23], s24 offen lds
s_add_u32 m0, s26, 26624
s_mov_b32 s24, 737344
buffer_load_dwordx4 v2, s[20:23], s24 offen lds
s_waitcnt vmcnt(33)
ds_read_b64_tr_b16 v[236:237], v3 offset:27648
ds_read_b64_tr_b16 v[238:239], v3 offset:28160
ds_read_b64_tr_b16 v[240:241], v3 offset:28672
ds_read_b64_tr_b16 v[242:243], v3 offset:29184
ds_read_b64_tr_b16 v[244:245], v3 offset:29696
ds_read_b64_tr_b16 v[246:247], v3 offset:30208
s_waitcnt lgkmcnt(0)
s_add_u32 m0, s26, 27648
s_mov_b32 s24, 774144
buffer_load_dwordx4 v2, s[20:23], s24 offen lds
s_add_u32 m0, s26, 28672
s_mov_b32 s24, 774176
buffer_load_dwordx4 v2, s[20:23], s24 offen lds
s_add_u32 m0, s26, 29696
s_mov_b32 s24, 774208
buffer_load_dwordx4 v2, s[20:23], s24 offen lds
s_waitcnt vmcnt(33)
ds_read_b64_tr_b16 v[248:249], v3 offset:30720
ds_read_b64_tr_b16 v[250:251], v3 offset:31232
ds_read_b64_tr_b16 v[252:253], v3 offset:31744
ds_read_b64_tr_b16 v[254:255], v3 offset:32256
ds_read_b64_tr_b16 a[0:1], v3 offset:32768
ds_read_b64_tr_b16 a[2:3], v3 offset:33280
s_waitcnt lgkmcnt(0)
s_add_u32 m0, s26, 30720
s_mov_b32 s24, 811008
buffer_load_dwordx4 v2, s[20:23], s24 offen lds
s_add_u32 m0, s26, 31744
s_mov_b32 s24, 811040
buffer_load_dwordx4 v2, s[20:23], s24 offen lds
s_add_u32 m0, s26, 32768
s_mov_b32 s24, 811072
buffer_load_dwordx4 v2, s[20:23], s24 offen lds
s_waitcnt vmcnt(33)
ds_read_b64_tr_b16 a[4:5], v3 offset:33792
ds_read_b64_tr_b16 a[6:7], v3 offset:34304
ds_read_b64_tr_b16 a[8:9], v3 offset:34816
ds_read_b64_tr_b16 a[10:11], v3 offset:35328
ds_read_b64_tr_b16 a[12:13], v3 offset:35840
ds_read_b64_tr_b16 a[14:15], v3 offset:36352
s_waitcnt lgkmcnt(0)
s_add_u32 m0, s26, 33792
s_mov_b32 s24, 847872
buffer_load_dwordx4 v2, s[20:23], s24 offen lds
s_add_u32 m0, s26, 34816
s_mov_b32 s24, 847904
buffer_load_dwordx4 v2, s[20:23], s24 offen lds
s_add_u32 m0, s26, 35840
s_mov_b32 s24, 847936
buffer_load_dwordx4 v2, s[20:23], s24 offen lds
s_waitcnt vmcnt(33)
ds_read_b64_tr_b16 a[16:17], v3 offset:0
ds_read_b64_tr_b16 a[18:19], v3 offset:512
ds_read_b64_tr_b16 a[20:21], v3 offset:1024
ds_read_b64_tr_b16 a[22:23], v3 offset:1536
ds_read_b64_tr_b16 a[24:25], v3 offset:2048
ds_read_b64_tr_b16 a[26:27], v3 offset:2560
s_waitcnt lgkmcnt(0)
s_add_u32 m0, s26, 0
s_mov_b32 s24, 884736
buffer_load_dwordx4 v2, s[20:23], s24 offen lds
s_add_u32 m0, s26, 1024
s_mov_b32 s24, 884768
buffer_load_dwordx4 v2, s[20:23], s24 offen lds
s_add_u32 m0, s26, 2048
s_mov_b32 s24, 884800
buffer_load_dwordx4 v2, s[20:23], s24 offen lds
s_waitcnt vmcnt(33)
ds_read_b64_tr_b16 a[28:29], v3 offset:3072
ds_read_b64_tr_b16 a[30:31], v3 offset:3584
ds_read_b64_tr_b16 a[32:33], v3 offset:4096
ds_read_b64_tr_b16 a[34:35], v3 offset:4608
ds_read_b64_tr_b16 a[36:37], v3 offset:5120
ds_read_b64_tr_b16 a[38:39], v3 offset:5632
s_waitcnt lgkmcnt(0)
s_add_u32 m0, s26, 3072
s_mov_b32 s24, 921600
buffer_load_dwordx4 v2, s[20:23], s24 offen lds
s_add_u32 m0, s26, 4096
s_mov_b32 s24, 921632
buffer_load_dwordx4 v2, s[20:23], s24 offen lds
s_add_u32 m0, s26, 5120
s_mov_b32 s24, 921664
buffer_load_dwordx4 v2, s[20:23], s24 offen lds
s_waitcnt vmcnt(33)
ds_read_b64_tr_b16 a[40:41], v3 offset:6144
ds_read_b64_tr_b16 a[42:43], v3 offset:6656
ds_read_b64_tr_b16 a[44:45], v3 offset:7168
ds_read_b64_tr_b16 a[46:47], v3 offset:7680
ds_read_b64_tr_b16 a[48:49], v3 offset:8192
ds_read_b64_tr_b16 a[50:51], v3 offset:8704
s_waitcnt lgkmcnt(0)
s_add_u32 m0, s26, 6144
s_mov_b32 s24, 958464
buffer_load_dwordx4 v2, s[20:23], s24 offen lds
s_add_u32 m0, s26, 7168
s_mov_b32 s24, 958496
buffer_load_dwordx4 v2, s[20:23], s24 offen lds
s_add_u32 m0, s26, 8192
s_mov_b32 s24, 958528
buffer_load_dwordx4 v2, s[20:23], s24 offen lds
s_waitcnt vmcnt(33)
ds_read_b64_tr_b16 a[52:53], v3 offset:9216
ds_read_b64_tr_b16 a[54:55], v3 offset:9728
ds_read_b64_tr_b16 a[56:57], v3 offset:10240
ds_read_b64_tr_b16 a[58:59], v3 offset:10752
ds_read_b64_tr_b16 a[60:61], v3 offset:11264
ds_read_b64_tr_b16 a[62:63], v3 offset:11776
s_waitcnt lgkmcnt(0)
s_add_u32 m0, s26, 9216
s_mov_b32 s24, 995328
buffer_load_dwordx4 v2, s[20:23], s24 offen lds
s_add_u32 m0, s26, 10240
s_mov_b32 s24, 995360
buffer_load_dwordx4 v2, s[20:23], s24 offen lds
s_add_u32 m0, s26, 11264
s_mov_b32 s24, 995392
buffer_load_dwordx4 v2, s[20:23], s24 offen lds
s_waitcnt vmcnt(33)
ds_read_b64_tr_b16 a[64:65], v3 offset:12288
ds_read_b64_tr_b16 a[66:67], v3 offset:12800
ds_read_b64_tr_b16 a[68:69], v3 offset:13312
ds_read_b64_tr_b16 a[70:71], v3 offset:13824
ds_read_b64_tr_b16 a[72:73], v3 offset:14336
ds_read_b64_tr_b16 a[74:75], v3 offset:14848
s_waitcnt lgkmcnt(0)
s_add_u32 m0, s26, 12288
s_mov_b32 s24, 1032192
buffer_load_dwordx4 v2, s[20:23], s24 offen lds
s_add_u32 m0, s26, 13312
s_mov_b32 s24, 1032224
buffer_load_dwordx4 v2, s[20:23], s24 offen lds
s_add_u32 m0, s26, 14336
s_mov_b32 s24, 1032256
buffer_load_dwordx4 v2, s[20:23], s24 offen lds
s_waitcnt vmcnt(33)
ds_read_b64_tr_b16 a[76:77], v3 offset:15360
ds_read_b64_tr_b16 a[78:79], v3 offset:15872
ds_read_b64_tr_b16 a[80:81], v3 offset:16384
ds_read_b64_tr_b16 a[82:83], v3 offset:16896
ds_read_b64_tr_b16 a[84:85], v3 offset:17408
ds_read_b64_tr_b16 a[86:87], v3 offset:17920
s_waitcnt lgkmcnt(0)
s_add_u32 m0, s26, 15360
s_mov_b32 s24, 1069056
buffer_load_dwordx4 v2, s[20:23], s24 offen lds
s_add_u32 m0, s26, 16384
s_mov_b32 s24, 1069088
buffer_load_dwordx4 v2, s[20:23], s24 offen lds
s_add_u32 m0, s26, 17408
s_mov_b32 s24, 1069120
buffer_load_dwordx4 v2, s[20:23], s24 offen lds
s_waitcnt vmcnt(33)
ds_read_b64_tr_b16 a[88:89], v3 offset:18432
ds_read_b64_tr_b16 a[90:91], v3 offset:18944
ds_read_b64_tr_b16 a[92:93], v3 offset:19456
ds_read_b64_tr_b16 a[94:95], v3 offset:19968
ds_read_b64_tr_b16 a[96:97], v3 offset:20480
ds_read_b64_tr_b16 a[98:99], v3 offset:20992
s_waitcnt lgkmcnt(0)
s_add_u32 m0, s26, 18432
s_mov_b32 s24, 1105920
buffer_load_dwordx4 v2, s[20:23], s24 offen lds
s_add_u32 m0, s26, 19456
s_mov_b32 s24, 1105952
buffer_load_dwordx4 v2, s[20:23], s24 offen lds
s_add_u32 m0, s26, 20480
s_mov_b32 s24, 1105984
buffer_load_dwordx4 v2, s[20:23], s24 offen lds
s_waitcnt vmcnt(33)
ds_read_b64_tr_b16 a[100:101], v3 offset:21504
ds_read_b64_tr_b16 a[102:103], v3 offset:22016
ds_read_b64_tr_b16 a[104:105], v3 offset:22528
ds_read_b64_tr_b16 a[106:107], v3 offset:23040
ds_read_b64_tr_b16 a[108:109], v3 offset:23552
ds_read_b64_tr_b16 a[110:111], v3 offset:24064
s_waitcnt lgkmcnt(0)
s_add_u32 m0, s26, 21504
s_mov_b32 s24, 1142784
buffer_load_dwordx4 v2, s[20:23], s24 offen lds
s_add_u32 m0, s26, 22528
s_mov_b32 s24, 1142816
buffer_load_dwordx4 v2, s[20:23], s24 offen lds
s_add_u32 m0, s26, 23552
s_mov_b32 s24, 1142848
buffer_load_dwordx4 v2, s[20:23], s24 offen lds
s_waitcnt vmcnt(33)
ds_read_b64_tr_b16 a[112:113], v3 offset:24576
ds_read_b64_tr_b16 a[114:115], v3 offset:25088
ds_read_b64_tr_b16 a[116:117], v3 offset:25600
ds_read_b64_tr_b16 a[118:119], v3 offset:26112
ds_read_b64_tr_b16 a[120:121], v3 offset:26624
ds_read_b64_tr_b16 a[122:123], v3 offset:27136
s_waitcnt vmcnt(30)
ds_read_b64_tr_b16 a[124:125], v3 offset:27648
ds_read_b64_tr_b16 a[126:127], v3 offset:28160
ds_read_b64_tr_b16 a[128:129], v3 offset:28672
ds_read_b64_tr_b16 a[130:131], v3 offset:29184
ds_read_b64_tr_b16 a[132:133], v3 offset:29696
ds_read_b64_tr_b16 a[134:135], v3 offset:30208
s_waitcnt vmcnt(27)
ds_read_b64_tr_b16 a[136:137], v3 offset:30720
ds_read_b64_tr_b16 a[138:139], v3 offset:31232
ds_read_b64_tr_b16 a[140:141], v3 offset:31744
ds_read_b64_tr_b16 a[142:143], v3 offset:32256
ds_read_b64_tr_b16 a[144:145], v3 offset:32768
ds_read_b64_tr_b16 a[146:147], v3 offset:33280
s_waitcnt vmcnt(24)
ds_read_b64_tr_b16 a[148:149], v3 offset:33792
ds_read_b64_tr_b16 a[150:151], v3 offset:34304
ds_read_b64_tr_b16 a[152:153], v3 offset:34816
ds_read_b64_tr_b16 a[154:155], v3 offset:35328
ds_read_b64_tr_b16 a[156:157], v3 offset:35840
ds_read_b64_tr_b16 a[158:159], v3 offset:36352
s_waitcnt vmcnt(21)
ds_read_b64_tr_b16 a[160:161], v3 offset:0
ds_read_b64_tr_b16 a[162:163], v3 offset:512
ds_read_b64_tr_b16 a[164:165], v3 offset:1024
ds_read_b64_tr_b16 a[166:167], v3 offset:1536
ds_read_b64_tr_b16 a[168:169], v3 offset:2048
ds_read_b64_tr_b16 a[170:171], v3 offset:2560
s_waitcnt vmcnt(18)
ds_read_b64_tr_b16 a[172:173], v3 offset:3072
ds_read_b64_tr_b16 a[174:175], v3 offset:3584
ds_read_b64_tr_b16 a[176:177], v3 offset:4096
ds_read_b64_tr_b16 a[178:179], v3 offset:4608
ds_read_b64_tr_b16 a[180:181], v3 offset:5120
ds_read_b64_tr_b16 a[182:183], v3 offset:5632
s_waitcnt vmcnt(15)
ds_read_b64_tr_b16 a[184:185], v3 offset:6144
ds_read_b64_tr_b16 a[186:187], v3 offset:6656
ds_read_b64_tr_b16 a[188:189], v3 offset:7168
ds_read_b64_tr_b16 a[190:191], v3 offset:7680
ds_read_b64_tr_b16 a[192:193], v3 offset:8192
ds_read_b64_tr_b16 a[194:195], v3 offset:8704
s_waitcnt vmcnt(12)
ds_read_b64_tr_b16 a[196:197], v3 offset:9216
ds_read_b64_tr_b16 a[198:199], v3 offset:9728
ds_read_b64_tr_b16 a[200:201], v3 offset:10240
ds_read_b64_tr_b16 a[202:203], v3 offset:10752
ds_read_b64_tr_b16 a[204:205], v3 offset:11264
ds_read_b64_tr_b16 a[206:207], v3 offset:11776
s_waitcnt vmcnt(9)
ds_read_b64_tr_b16 a[208:209], v3 offset:12288
ds_read_b64_tr_b16 a[210:211], v3 offset:12800
ds_read_b64_tr_b16 a[212:213], v3 offset:13312
ds_read_b64_tr_b16 a[214:215], v3 offset:13824
ds_read_b64_tr_b16 a[216:217], v3 offset:14336
ds_read_b64_tr_b16 a[218:219], v3 offset:14848
s_waitcnt vmcnt(6)
ds_read_b64_tr_b16 a[220:221], v3 offset:15360
ds_read_b64_tr_b16 a[222:223], v3 offset:15872
ds_read_b64_tr_b16 a[224:225], v3 offset:16384
ds_read_b64_tr_b16 a[226:227], v3 offset:16896
ds_read_b64_tr_b16 a[228:229], v3 offset:17408
ds_read_b64_tr_b16 a[230:231], v3 offset:17920
s_waitcnt vmcnt(3)
ds_read_b64_tr_b16 a[232:233], v3 offset:18432
ds_read_b64_tr_b16 a[234:235], v3 offset:18944
ds_read_b64_tr_b16 a[236:237], v3 offset:19456
ds_read_b64_tr_b16 a[238:239], v3 offset:19968
ds_read_b64_tr_b16 a[240:241], v3 offset:20480
ds_read_b64_tr_b16 a[242:243], v3 offset:20992
s_waitcnt vmcnt(0)
ds_read_b64_tr_b16 a[244:245], v3 offset:21504
ds_read_b64_tr_b16 a[246:247], v3 offset:22016
ds_read_b64_tr_b16 a[248:249], v3 offset:22528
ds_read_b64_tr_b16 a[250:251], v3 offset:23040
ds_read_b64_tr_b16 a[252:253], v3 offset:23552
ds_read_b64_tr_b16 a[254:255], v3 offset:24064
s_waitcnt lgkmcnt(0)
v_mov_b32 v20, 128
s_mov_b32 s28, 0
L_poll_7:
buffer_load_dword v21, v20, s[56:59], 0 offen sc1
s_add_u32 s28, s28, 1
s_cmp_gt_u32 s28, 40000
s_cbranch_scc1 L_end
s_waitcnt vmcnt(0)
v_cmp_ne_u32 vcc, 8, v21
s_cbranch_vccz L_pd_8
s_sleep 1
s_branch L_poll_7
L_pd_8:
v_and_b32 v8, 15, v0
v_mul_u32_u24 v8, 2304, v8
v_bfe_u32 v9, v0, 4, 2
v_lshl_add_u32 v8, v9, 3, v8
s_mul_i32 s24, s40, 96
s_lshl_b32 s25, s17, 5
s_add_u32 s24, s24, s25
s_add_u32 s24, s24, s47
v_add_u32 v4, s24, v8
v_and_b32 v5, 31, v0
v_lshlrev_b32 v5, 2, v5
v_lshlrev_b32 v3, 4, v0
s_lshl_b32 s24, s17, 12
v_add_u32 v7, s24, v1
s_lshl_b32 s24, s17, 15
s_add_u32 s44, s44, s24
s_barrier
L_opl:
s_lshr_b32 s25, s41, s46
s_lshl_b32 s25, s25, 7
s_add_u32 s25, s25, s45
s_mov_b32 s28, 0
L_poll_9:
buffer_load_dword v6, v5, s[8:11], s25 offen sc1
s_add_u32 s28, s28, 1
s_cmp_gt_u32 s28, 40000
s_cbranch_scc1 L_end
s_waitcnt vmcnt(0)
v_cmp_ne_u32 vcc, 1, v6
s_cbranch_vccz L_pd_10
s_sleep 1
s_branch L_poll_9
L_pd_10:
s_lshl_b32 s26, s41, 17
s_add_u32 s26, s26, s44
s_add_u32 s24, s26, 0
buffer_load_dwordx4 v[16:19], v1, s[8:11], s24 offen offset:0 sc1
buffer_load_dwordx4 v[20:23], v1, s[8:11], s24 offen offset:1024 sc1
buffer_load_dwordx4 v[24:27], v1, s[8:11], s24 offen offset:2048 sc1
buffer_load_dwordx4 v[28:31], v1, s[8:11], s24 offen offset:3072 sc1
s_add_u32 s24, s26, 4096
buffer_load_dwordx4 v[32:35], v1, s[8:11], s24 offen offset:0 sc1
buffer_load_dwordx4 v[36:39], v1, s[8:11], s24 offen offset:1024 sc1
buffer_load_dwordx4 v[40:43], v1, s[8:11], s24 offen offset:2048 sc1
buffer_load_dwordx4 v[44:47], v1, s[8:11], s24 offen offset:3072 sc1
s_add_u32 s24, s26, 8192
buffer_load_dwordx4 v[48:51], v1, s[8:11], s24 offen offset:0 sc1
buffer_load_dwordx4 v[52:55], v1, s[8:11], s24 offen offset:1024 sc1
buffer_load_dwordx4 v[56:59], v1, s[8:11], s24 offen offset:2048 sc1
buffer_load_dwordx4 v[60:63], v1, s[8:11], s24 offen offset:3072 sc1
s_add_u32 s24, s26, 12288
buffer_load_dwordx4 v[64:67], v1, s[8:11], s24 offen offset:0 sc1
buffer_load_dwordx4 v[68:71], v1, s[8:11], s24 offen offset:1024 sc1
buffer_load_dwordx4 v[72:75], v1, s[8:11], s24 offen offset:2048 sc1
buffer_load_dwordx4 v[76:79], v1, s[8:11], s24 offen offset:3072 sc1
s_add_u32 s24, s26, 16384
buffer_load_dwordx4 v[80:83], v1, s[8:11], s24 offen offset:0 sc1
buffer_load_dwordx4 v[84:87], v1, s[8:11], s24 offen offset:1024 sc1
buffer_load_dwordx4 v[88:91], v1, s[8:11], s24 offen offset:2048 sc1
buffer_load_dwordx4 v[92:95], v1, s[8:11], s24 offen offset:3072 sc1
s_add_u32 s24, s26, 20480
buffer_load_dwordx4 v[96:99], v1, s[8:11], s24 offen offset:0 sc1
buffer_load_dwordx4 v[100:103], v1, s[8:11], s24 offen offset:1024 sc1
buffer_load_dwordx4 v[104:107], v1, s[8:11], s24 offen offset:2048 sc1
buffer_load_dwordx4 v[108:111], v1, s[8:11], s24 offen offset:3072 sc1
s_waitcnt vmcnt(23)
v_mfma_f32_16x16x32_bf16 v[112:115], v[128:131], v[16:19], 0
v_mfma_f32_16x16x32_bf16 v[116:119], v[132:135], v[16:19], 0
v_mfma_f32_16x16x32_bf16 v[120:123], v[136:139], v[16:19], 0
s_add_u32 s24, s26, 24576
buffer_load_dwordx4 v[16:19], v1, s[8:11], s24 offen offset:0 sc1
s_waitcnt vmcnt(23)
v_mfma_f32_16x16x32_bf16 v[112:115], v[140:143], v[20:23], v[112:115]
v_mfma_f32_16x16x32_bf16 v[116:119], v[144:147], v[20:23], v[116:119]
v_mfma_f32_16x16x32_bf16 v[120:123], v[148:151], v[20:23], v[120:123]
buffer_load_dwordx4 v[20:23], v1, s[8:11], s24 offen offset:1024 sc1
s_waitcnt vmcnt(23)
v_mfma_f32_16x16x32_bf16 v[112:115], v[152:155], v[24:27], v[112:115]
v_mfma_f32_16x16x32_bf16 v[116:119], v[156:159], v[24:27], v[116:119]
v_mfma_f32_16x16x32_bf16 v[120:123], v[160:163], v[24:27], v[120:123]
buffer_load_dwordx4 v[24:27], v1, s[8:11], s24 offen offset:2048 sc1
s_waitcnt vmcnt(23)
v_mfma_f32_16x16x32_bf16 v[112:115], v[164:167], v[28:31], v[112:115]
v_mfma_f32_16x16x32_bf16 v[116:119], v[168:171], v[28:31], v[116:119]
v_mfma_f32_16x16x32_bf16 v[120:123], v[172:175], v[28:31], v[120:123]
buffer_load_dwordx4 v[28:31], v1, s[8:11], s24 offen offset:3072 sc1
s_waitcnt vmcnt(23)
v_mfma_f32_16x16x32_bf16 v[112:115], v[176:179], v[32:35], v[112:115]
v_mfma_f32_16x16x32_bf16 v[116:119], v[180:183], v[32:35], v[116:119]
v_mfma_f32_16x16x32_bf16 v[120:123], v[184:187], v[32:35], v[120:123]
s_add_u32 s24, s26, 28672
buffer_load_dwordx4 v[32:35], v1, s[8:11], s24 offen offset:0 sc1
s_waitcnt vmcnt(23)
v_mfma_f32_16x16x32_bf16 v[112:115], v[188:191], v[36:39], v[112:115]
v_mfma_f32_16x16x32_bf16 v[116:119], v[192:195], v[36:39], v[116:119]
v_mfma_f32_16x16x32_bf16 v[120:123], v[196:199], v[36:39], v[120:123]
buffer_load_dwordx4 v[36:39], v1, s[8:11], s24 offen offset:1024 sc1
s_waitcnt vmcnt(23)
v_mfma_f32_16x16x32_bf16 v[112:115], v[200:203], v[40:43], v[112:115]
v_mfma_f32_16x16x32_bf16 v[116:119], v[204:207], v[40:43], v[116:119]
v_mfma_f32_16x16x32_bf16 v[120:123], v[208:211], v[40:43], v[120:123]
buffer_load_dwordx4 v[40:43], v1, s[8:11], s24 offen offset:2048 sc1
s_waitcnt vmcnt(23)
v_mfma_f32_16x16x32_bf16 v[112:115], v[212:215], v[44:47], v[112:115]
v_mfma_f32_16x16x32_bf16 v[116:119], v[216:219], v[44:47], v[116:119]
v_mfma_f32_16x16x32_bf16 v[120:123], v[220:223], v[44:47], v[120:123]
buffer_load_dwordx4 v[44:47], v1, s[8:11], s24 offen offset:3072 sc1
s_waitcnt vmcnt(23)
v_mfma_f32_16x16x32_bf16 v[112:115], v[224:227], v[48:51], v[112:115]
v_mfma_f32_16x16x32_bf16 v[116:119], v[228:231], v[48:51], v[116:119]
v_mfma_f32_16x16x32_bf16 v[120:123], v[232:235], v[48:51], v[120:123]
s_waitcnt vmcnt(22)
v_mfma_f32_16x16x32_bf16 v[112:115], v[236:239], v[52:55], v[112:115]
v_mfma_f32_16x16x32_bf16 v[116:119], v[240:243], v[52:55], v[116:119]
v_mfma_f32_16x16x32_bf16 v[120:123], v[244:247], v[52:55], v[120:123]
s_waitcnt vmcnt(21)
v_mfma_f32_16x16x32_bf16 v[112:115], v[248:251], v[56:59], v[112:115]
v_mfma_f32_16x16x32_bf16 v[116:119], v[252:255], v[56:59], v[116:119]
v_mfma_f32_16x16x32_bf16 v[120:123], a[0:3], v[56:59], v[120:123]
s_waitcnt vmcnt(20)
v_mfma_f32_16x16x32_bf16 v[112:115], a[4:7], v[60:63], v[112:115]
v_mfma_f32_16x16x32_bf16 v[116:119], a[8:11], v[60:63], v[116:119]
v_mfma_f32_16x16x32_bf16 v[120:123], a[12:15], v[60:63], v[120:123]
s_waitcnt vmcnt(19)
v_mfma_f32_16x16x32_bf16 v[112:115], a[16:19], v[64:67], v[112:115]
v_mfma_f32_16x16x32_bf16 v[116:119], a[20:23], v[64:67], v[116:119]
v_mfma_f32_16x16x32_bf16 v[120:123], a[24:27], v[64:67], v[120:123]
s_waitcnt vmcnt(18)
v_mfma_f32_16x16x32_bf16 v[112:115], a[28:31], v[68:71], v[112:115]
v_mfma_f32_16x16x32_bf16 v[116:119], a[32:35], v[68:71], v[116:119]
v_mfma_f32_16x16x32_bf16 v[120:123], a[36:39], v[68:71], v[120:123]
s_waitcnt vmcnt(17)
v_mfma_f32_16x16x32_bf16 v[112:115], a[40:43], v[72:75], v[112:115]
v_mfma_f32_16x16x32_bf16 v[116:119], a[44:47], v[72:75], v[116:119]
v_mfma_f32_16x16x32_bf16 v[120:123], a[48:51], v[72:75], v[120:123]
s_waitcnt vmcnt(16)
v_mfma_f32_16x16x32_bf16 v[112:115], a[52:55], v[76:79], v[112:115]
v_mfma_f32_16x16x32_bf16 v[116:119], a[56:59], v[76:79], v[116:119]
v_mfma_f32_16x16x32_bf16 v[120:123], a[60:63], v[76:79], v[120:123]
s_waitcnt vmcnt(15)
v_mfma_f32_16x16x32_bf16 v[112:115], a[64:67], v[80:83], v[112:115]
v_mfma_f32_16x16x32_bf16 v[116:119], a[68:71], v[80:83], v[116:119]
v_mfma_f32_16x16x32_bf16 v[120:123], a[72:75], v[80:83], v[120:123]
s_waitcnt vmcnt(14)
v_mfma_f32_16x16x32_bf16 v[112:115], a[76:79], v[84:87], v[112:115]
v_mfma_f32_16x16x32_bf16 v[116:119], a[80:83], v[84:87], v[116:119]
v_mfma_f32_16x16x32_bf16 v[120:123], a[84:87], v[84:87], v[120:123]
s_waitcnt vmcnt(13)
v_mfma_f32_16x16x32_bf16 v[112:115], a[88:91], v[88:91], v[112:115]
v_mfma_f32_16x16x32_bf16 v[116:119], a[92:95], v[88:91], v[116:119]
v_mfma_f32_16x16x32_bf16 v[120:123], a[96:99], v[88:91], v[120:123]
s_waitcnt vmcnt(12)
v_mfma_f32_16x16x32_bf16 v[112:115], a[100:103], v[92:95], v[112:115]
v_mfma_f32_16x16x32_bf16 v[116:119], a[104:107], v[92:95], v[116:119]
v_mfma_f32_16x16x32_bf16 v[120:123], a[108:111], v[92:95], v[120:123]
s_waitcnt vmcnt(11)
v_mfma_f32_16x16x32_bf16 v[112:115], a[112:115], v[96:99], v[112:115]
v_mfma_f32_16x16x32_bf16 v[116:119], a[116:119], v[96:99], v[116:119]
v_mfma_f32_16x16x32_bf16 v[120:123], a[120:123], v[96:99], v[120:123]
s_waitcnt vmcnt(10)
v_mfma_f32_16x16x32_bf16 v[112:115], a[124:127], v[100:103], v[112:115]
v_mfma_f32_16x16x32_bf16 v[116:119], a[128:131], v[100:103], v[116:119]
v_mfma_f32_16x16x32_bf16 v[120:123], a[132:135], v[100:103], v[120:123]
s_waitcnt vmcnt(9)
v_mfma_f32_16x16x32_bf16 v[112:115], a[136:139], v[104:107], v[112:115]
v_mfma_f32_16x16x32_bf16 v[116:119], a[140:143], v[104:107], v[116:119]
v_mfma_f32_16x16x32_bf16 v[120:123], a[144:147], v[104:107], v[120:123]
s_waitcnt vmcnt(8)
v_mfma_f32_16x16x32_bf16 v[112:115], a[148:151], v[108:111], v[112:115]
v_mfma_f32_16x16x32_bf16 v[116:119], a[152:155], v[108:111], v[116:119]
v_mfma_f32_16x16x32_bf16 v[120:123], a[156:159], v[108:111], v[120:123]
s_waitcnt vmcnt(7)
v_mfma_f32_16x16x32_bf16 v[112:115], a[160:163], v[16:19], v[112:115]
v_mfma_f32_16x16x32_bf16 v[116:119], a[164:167], v[16:19], v[116:119]
v_mfma_f32_16x16x32_bf16 v[120:123], a[168:171], v[16:19], v[120:123]
s_waitcnt vmcnt(6)
v_mfma_f32_16x16x32_bf16 v[112:115], a[172:175], v[20:23], v[112:115]
v_mfma_f32_16x16x32_bf16 v[116:119], a[176:179], v[20:23], v[116:119]
v_mfma_f32_16x16x32_bf16 v[120:123], a[180:183], v[20:23], v[120:123]
s_waitcnt vmcnt(5)
v_mfma_f32_16x16x32_bf16 v[112:115], a[184:187], v[24:27], v[112:115]
v_mfma_f32_16x16x32_bf16 v[116:119], a[188:191], v[24:27], v[116:119]
v_mfma_f32_16x16x32_bf16 v[120:123], a[192:195], v[24:27], v[120:123]
s_waitcnt vmcnt(4)
v_mfma_f32_16x16x32_bf16 v[112:115], a[196:199], v[28:31], v[112:115]
v_mfma_f32_16x16x32_bf16 v[116:119], a[200:203], v[28:31], v[116:119]
v_mfma_f32_16x16x32_bf16 v[120:123], a[204:207], v[28:31], v[120:123]
s_waitcnt vmcnt(3)
v_mfma_f32_16x16x32_bf16 v[112:115], a[208:211], v[32:35], v[112:115]
v_mfma_f32_16x16x32_bf16 v[116:119], a[212:215], v[32:35], v[116:119]
v_mfma_f32_16x16x32_bf16 v[120:123], a[216:219], v[32:35], v[120:123]
s_waitcnt vmcnt(2)
v_mfma_f32_16x16x32_bf16 v[112:115], a[220:223], v[36:39], v[112:115]
v_mfma_f32_16x16x32_bf16 v[116:119], a[224:227], v[36:39], v[116:119]
v_mfma_f32_16x16x32_bf16 v[120:123], a[228:231], v[36:39], v[120:123]
s_waitcnt vmcnt(1)
v_mfma_f32_16x16x32_bf16 v[112:115], a[232:235], v[40:43], v[112:115]
v_mfma_f32_16x16x32_bf16 v[116:119], a[236:239], v[40:43], v[116:119]
v_mfma_f32_16x16x32_bf16 v[120:123], a[240:243], v[40:43], v[120:123]
s_waitcnt vmcnt(0)
v_mfma_f32_16x16x32_bf16 v[112:115], a[244:247], v[44:47], v[112:115]
v_mfma_f32_16x16x32_bf16 v[116:119], a[248:251], v[44:47], v[116:119]
v_mfma_f32_16x16x32_bf16 v[120:123], a[252:255], v[44:47], v[120:123]
s_nop 5
ds_write_b128 v3, v[112:115] offset:0
ds_write_b128 v3, v[116:119] offset:4096
ds_write_b128 v3, v[120:123] offset:8192
s_waitcnt lgkmcnt(0)
s_barrier
s_cmp_eq_u32 s17, 3
s_cbranch_scc1 L_opl_n
ds_read_b128 v[16:19], v7 offset:0
ds_read_b128 v[20:23], v7 offset:1024
ds_read_b128 v[24:27], v7 offset:2048
ds_read_b128 v[28:31], v7 offset:3072
s_mul_i32 s24, s41, 36864
s_waitcnt lgkmcnt(2)
v_pk_add_f32 v[16:17], v[16:17], v[20:21]
v_pk_add_f32 v[18:19], v[18:19], v[22:23]
s_waitcnt lgkmcnt(1)
v_pk_add_f32 v[16:17], v[16:17], v[24:25]
v_pk_add_f32 v[18:19], v[18:19], v[26:27]
s_waitcnt lgkmcnt(0)
v_pk_add_f32 v[16:17], v[16:17], v[28:29]
v_pk_add_f32 v[18:19], v[18:19], v[30:31]
v_cvt_pk_bf16_f32 v112, v16, v17
v_cvt_pk_bf16_f32 v113, v18, v19
buffer_store_dwordx2 v[112:113], v4, s[12:15], s24 offen
L_opl_n:
v_xor_b32 v3, 16384, v3
v_xor_b32 v7, 16384, v7
s_add_u32 s41, s41, s43
s_cmp_lt_u32 s41, s42
s_cbranch_scc1 L_opl
s_branch L_done
L_bkv:
s_load_dwordx2 s[4:5], s[0:1], 48
s_waitcnt lgkmcnt(0)
s_mov_b32 s12, s4
s_and_b32 s13, s5, 0xffff
s_mov_b32 s14, 2359296
s_mov_b32 s15, 0x20000
s_load_dwordx2 s[4:5], s[0:1], 72
s_load_dwordx2 s[6:7], s[0:1], 80
s_waitcnt lgkmcnt(0)
s_cmp_ge_u32 s17, 2
s_cselect_b64 s[4:5], s[6:7], s[4:5]
s_mov_b32 s20, s4
s_and_b32 s21, s5, 0xffff
s_mov_b32 s22, 4718592
s_mov_b32 s23, 0x20000
s_lshl_b32 s26, s16, 8
v_lshrrev_b32 v15, 6, v0
v_lshlrev_b32 v15, 6, v15
v_bfe_u32 v16, v0, 2, 4
v_add_u32 v15, v15, v16
v_mul_u32_u24 v15, 1152, v15
v_bfe_u32 v16, v0, 4, 2
v_and_b32 v17, 3, v0
v_xor_b32 v17, v17, v16
v_lshl_add_u32 v1, v17, 4, v15
v_add_u32 v2, 17408, v1
v_add_u32 v3, 34816, v1
v_add_u32 v4, 52224, v1
v_bfe_u32 v15, v0, 2, 2
v_xor_b32 v15, v15, v16
v_lshlrev_b32 v15, 6, v15
v_and_b32 v17, 3, v0
v_lshl_add_u32 v15, v17, 4, v15
v_lshl_add_u32 v15, v16, 13, v15
s_and_b32 s24, s17, 1
s_lshl_b32 s24, s24, 17
s_add_u32 s24, s24, s26
v_add_u32 v5, s24, v15
v_add_u32 v6, 31744, v5
v_add_u32 v7, 63488, v5
v_add_u32 v8, 95232, v5
s_lshl_b32 s37, s17, 12
s_lshl_b32 s38, s17, 12
s_add_u32 s38, s38, 16384
s_mov_b32 s60, 0
L_bkvl:
s_mul_i32 s36, s60, 294912
s_mov_b32 s32, s36
s_mov_b32 s33, 0
s_mov_b32 s34, s37
s_mov_b32 s35, s38
s_mov_b32 m0, s34
s_nop 0
buffer_load_dwordx4 v1, s[12:15], s32 offen offset:0 lds
buffer_load_dwordx4 v2, s[12:15], s32 offen offset:1024 lds
buffer_load_dwordx4 v3, s[12:15], s32 offen offset:2048 lds
buffer_load_dwordx4 v4, s[12:15], s32 offen offset:3072 lds
s_mov_b32 m0, s35
s_nop 0
buffer_load_dwordx4 v5, s[20:23], s33 offen offset:0 lds
buffer_load_dwordx4 v6, s[20:23], s33 offen offset:1024 lds
buffer_load_dwordx4 v7, s[20:23], s33 offen offset:2048 lds
buffer_load_dwordx4 v8, s[20:23], s33 offen offset:3072 lds
s_add_u32 s32, s32, 64
s_add_u32 s33, s33, 262144
s_add_u32 s34, s34, 32768
s_and_b32 s34, s34, 131071
s_add_u32 s35, s35, 32768
s_and_b32 s35, s35, 131071
s_mov_b32 m0, s34
s_nop 0
buffer_load_dwordx4 v1, s[12:15], s32 offen offset:0 lds
buffer_load_dwordx4 v2, s[12:15], s32 offen offset:1024 lds
buffer_load_dwordx4 v3, s[12:15], s32 offen offset:2048 lds
buffer_load_dwordx4 v4, s[12:15], s32 offen offset:3072 lds
s_mov_b32 m0, s35
s_nop 0
buffer_load_dwordx4 v5, s[20:23], s33 offen offset:0 lds
buffer_load_dwordx4 v6, s[20:23], s33 offen offset:1024 lds
buffer_load_dwordx4 v7, s[20:23], s33 offen offset:2048 lds
buffer_load_dwordx4 v8, s[20:23], s33 offen offset:3072 lds
s_add_u32 s32, s32, 64
s_add_u32 s33, s33, 262144
s_add_u32 s34, s34, 32768
s_and_b32 s34, s34, 131071
s_add_u32 s35, s35, 32768
s_and_b32 s35, s35, 131071
s_mov_b32 m0, s34
s_nop 0
buffer_load_dwordx4 v1, s[12:15], s32 offen offset:0 lds
buffer_load_dwordx4 v2, s[12:15], s32 offen offset:1024 lds
buffer_load_dwordx4 v3, s[12:15], s32 offen offset:2048 lds
buffer_load_dwordx4 v4, s[12:15], s32 offen offset:3072 lds
s_mov_b32 m0, s35
s_nop 0
buffer_load_dwordx4 v5, s[20:23], s33 offen offset:0 lds
buffer_load_dwordx4 v6, s[20:23], s33 offen offset:1024 lds
buffer_load_dwordx4 v7, s[20:23], s33 offen offset:2048 lds
buffer_load_dwordx4 v8, s[20:23], s33 offen offset:3072 lds
s_add_u32 s32, s32, 64
s_add_u32 s33, s33, 262144
s_add_u32 s34, s34, 32768
s_and_b32 s34, s34, 131071
s_add_u32 s35, s35, 32768
s_and_b32 s35, s35, 131071
s_mov_b32 m0, s34
s_nop 0
buffer_load_dwordx4 v1, s[12:15], s32 offen offset:0 lds
buffer_load_dwordx4 v2, s[12:15], s32 offen offset:1024 lds
buffer_load_dwordx4 v3, s[12:15], s32 offen offset:2048 lds
buffer_load_dwordx4 v4, s[12:15], s32 offen offset:3072 lds
s_mov_b32 m0, s35
s_nop 0
buffer_load_dwordx4 v5, s[20:23], s33 offen offset:0 lds
buffer_load_dwordx4 v6, s[20:23], s33 offen offset:1024 lds
buffer_load_dwordx4 v7, s[20:23], s33 offen offset:2048 lds
buffer_load_dwordx4 v8, s[20:23], s33 offen offset:3072 lds
s_add_u32 s32, s32, 64
s_add_u32 s33, s33, 262144
s_add_u32 s34, s34, 32768
s_and_b32 s34, s34, 131071
s_add_u32 s35, s35, 32768
s_and_b32 s35, s35, 131071
v_and_b32 v15, 31, v0
v_lshlrev_b32 v15, 6, v15
v_bfe_u32 v16, v0, 2, 2
v_bfe_u32 v17, v0, 5, 1
v_xor_b32 v16, v16, v17
v_lshl_add_u32 v15, v16, 4, v15
s_and_b32 s24, s17, 1
s_lshl_b32 s24, s24, 13
v_add_u32 v9, s24, v15
v_xor_b32 v10, 32, v9
v_bfe_u32 v16, v0, 2, 2
v_mul_u32_u24 v15, 320, v16
v_lshl_add_u32 v15, v17, 11, v15
v_bfe_u32 v16, v0, 4, 1
v_lshl_add_u32 v15, v16, 5, v15
v_and_b32 v16, 3, v0
v_lshl_add_u32 v15, v16, 3, v15
s_lshr_b32 s24, s17, 1
s_lshl_b32 s24, s24, 13
s_add_u32 s24, s24, 16384
v_add_u32 v11, s24, v15
v_xor_b32 v12, 64, v11
v_xor_b32 v13, 128, v11
v_xor_b32 v14, 192, v11
v_accvgpr_write_b32 a0, 0
v_accvgpr_write_b32 a1, 0
v_accvgpr_write_b32 a2, 0
v_accvgpr_write_b32 a3, 0
v_accvgpr_write_b32 a4, 0
v_accvgpr_write_b32 a5, 0
v_accvgpr_write_b32 a6, 0
v_accvgpr_write_b32 a7, 0
v_accvgpr_write_b32 a8, 0
v_accvgpr_write_b32 a9, 0
v_accvgpr_write_b32 a10, 0
v_accvgpr_write_b32 a11, 0
v_accvgpr_write_b32 a12, 0
v_accvgpr_write_b32 a13, 0
v_accvgpr_write_b32 a14, 0
v_accvgpr_write_b32 a15, 0
v_accvgpr_write_b32 a16, 0
v_accvgpr_write_b32 a17, 0
v_accvgpr_write_b32 a18, 0
v_accvgpr_write_b32 a19, 0
v_accvgpr_write_b32 a20, 0
v_accvgpr_write_b32 a21, 0
v_accvgpr_write_b32 a22, 0
v_accvgpr_write_b32 a23, 0
v_accvgpr_write_b32 a24, 0
v_accvgpr_write_b32 a25, 0
v_accvgpr_write_b32 a26, 0
v_accvgpr_write_b32 a27, 0
v_accvgpr_write_b32 a28, 0
v_accvgpr_write_b32 a29, 0
v_accvgpr_write_b32 a30, 0
v_accvgpr_write_b32 a31, 0
v_accvgpr_write_b32 a32, 0
v_accvgpr_write_b32 a33, 0
v_accvgpr_write_b32 a34, 0
v_accvgpr_write_b32 a35, 0
v_accvgpr_write_b32 a36, 0
v_accvgpr_write_b32 a37, 0
v_accvgpr_write_b32 a38, 0
v_accvgpr_write_b32 a39, 0
v_accvgpr_write_b32 a40, 0
v_accvgpr_write_b32 a41, 0
v_accvgpr_write_b32 a42, 0
v_accvgpr_write_b32 a43, 0
v_accvgpr_write_b32 a44, 0
v_accvgpr_write_b32 a45, 0
v_accvgpr_write_b32 a46, 0
v_accvgpr_write_b32 a47, 0
v_accvgpr_write_b32 a48, 0
v_accvgpr_write_b32 a49, 0
v_accvgpr_write_b32 a50, 0
v_accvgpr_write_b32 a51, 0
v_accvgpr_write_b32 a52, 0
v_accvgpr_write_b32 a53, 0
v_accvgpr_write_b32 a54, 0
v_accvgpr_write_b32 a55, 0
v_accvgpr_write_b32 a56, 0
v_accvgpr_write_b32 a57, 0
v_accvgpr_write_b32 a58, 0
v_accvgpr_write_b32 a59, 0
v_accvgpr_write_b32 a60, 0
v_accvgpr_write_b32 a61, 0
v_accvgpr_write_b32 a62, 0
v_accvgpr_write_b32 a63, 0
v_accvgpr_write_b32 a64, 0
v_accvgpr_write_b32 a65, 0
v_accvgpr_write_b32 a66, 0
v_accvgpr_write_b32 a67, 0
v_accvgpr_write_b32 a68, 0
v_accvgpr_write_b32 a69, 0
v_accvgpr_write_b32 a70, 0
v_accvgpr_write_b32 a71, 0
v_accvgpr_write_b32 a72, 0
v_accvgpr_write_b32 a73, 0
v_accvgpr_write_b32 a74, 0
v_accvgpr_write_b32 a75, 0
v_accvgpr_write_b32 a76, 0
v_accvgpr_write_b32 a77, 0
v_accvgpr_write_b32 a78, 0
v_accvgpr_write_b32 a79, 0
v_accvgpr_write_b32 a80, 0
v_accvgpr_write_b32 a81, 0
v_accvgpr_write_b32 a82, 0
v_accvgpr_write_b32 a83, 0
v_accvgpr_write_b32 a84, 0
v_accvgpr_write_b32 a85, 0
v_accvgpr_write_b32 a86, 0
v_accvgpr_write_b32 a87, 0
v_accvgpr_write_b32 a88, 0
v_accvgpr_write_b32 a89, 0
v_accvgpr_write_b32 a90, 0
v_accvgpr_write_b32 a91, 0
v_accvgpr_write_b32 a92, 0
v_accvgpr_write_b32 a93, 0
v_accvgpr_write_b32 a94, 0
v_accvgpr_write_b32 a95, 0
v_accvgpr_write_b32 a96, 0
v_accvgpr_write_b32 a97, 0
v_accvgpr_write_b32 a98, 0
v_accvgpr_write_b32 a99, 0
v_accvgpr_write_b32 a100, 0
v_accvgpr_write_b32 a101, 0
v_accvgpr_write_b32 a102, 0
v_accvgpr_write_b32 a103, 0
v_accvgpr_write_b32 a104, 0
v_accvgpr_write_b32 a105, 0
v_accvgpr_write_b32 a106, 0
v_accvgpr_write_b32 a107, 0
v_accvgpr_write_b32 a108, 0
v_accvgpr_write_b32 a109, 0
v_accvgpr_write_b32 a110, 0
v_accvgpr_write_b32 a111, 0
v_accvgpr_write_b32 a112, 0
v_accvgpr_write_b32 a113, 0
v_accvgpr_write_b32 a114, 0
v_accvgpr_write_b32 a115, 0
v_accvgpr_write_b32 a116, 0
v_accvgpr_write_b32 a117, 0
v_accvgpr_write_b32 a118, 0
v_accvgpr_write_b32 a119, 0
v_accvgpr_write_b32 a120, 0
v_accvgpr_write_b32 a121, 0
v_accvgpr_write_b32 a122, 0
v_accvgpr_write_b32 a123, 0
v_accvgpr_write_b32 a124, 0
v_accvgpr_write_b32 a125, 0
v_accvgpr_write_b32 a126, 0
v_accvgpr_write_b32 a127, 0
v_accvgpr_write_b32 a128, 0
v_accvgpr_write_b32 a129, 0
v_accvgpr_write_b32 a130, 0
v_accvgpr_write_b32 a131, 0
v_accvgpr_write_b32 a132, 0
v_accvgpr_write_b32 a133, 0
v_accvgpr_write_b32 a134, 0
v_accvgpr_write_b32 a135, 0
v_accvgpr_write_b32 a136, 0
v_accvgpr_write_b32 a137, 0
v_accvgpr_write_b32 a138, 0
v_accvgpr_write_b32 a139, 0
v_accvgpr_write_b32 a140, 0
v_accvgpr_write_b32 a141, 0
v_accvgpr_write_b32 a142, 0
v_accvgpr_write_b32 a143, 0
v_accvgpr_write_b32 a144, 0
v_accvgpr_write_b32 a145, 0
v_accvgpr_write_b32 a146, 0
v_accvgpr_write_b32 a147, 0
v_accvgpr_write_b32 a148, 0
v_accvgpr_write_b32 a149, 0
v_accvgpr_write_b32 a150, 0
v_accvgpr_write_b32 a151, 0
v_accvgpr_write_b32 a152, 0
v_accvgpr_write_b32 a153, 0
v_accvgpr_write_b32 a154, 0
v_accvgpr_write_b32 a155, 0
v_accvgpr_write_b32 a156, 0
v_accvgpr_write_b32 a157, 0
v_accvgpr_write_b32 a158, 0
v_accvgpr_write_b32 a159, 0
v_accvgpr_write_b32 a160, 0
v_accvgpr_write_b32 a161, 0
v_accvgpr_write_b32 a162, 0
v_accvgpr_write_b32 a163, 0
v_accvgpr_write_b32 a164, 0
v_accvgpr_write_b32 a165, 0
v_accvgpr_write_b32 a166, 0
v_accvgpr_write_b32 a167, 0
v_accvgpr_write_b32 a168, 0
v_accvgpr_write_b32 a169, 0
v_accvgpr_write_b32 a170, 0
v_accvgpr_write_b32 a171, 0
v_accvgpr_write_b32 a172, 0
v_accvgpr_write_b32 a173, 0
v_accvgpr_write_b32 a174, 0
v_accvgpr_write_b32 a175, 0
v_accvgpr_write_b32 a176, 0
v_accvgpr_write_b32 a177, 0
v_accvgpr_write_b32 a178, 0
v_accvgpr_write_b32 a179, 0
v_accvgpr_write_b32 a180, 0
v_accvgpr_write_b32 a181, 0
v_accvgpr_write_b32 a182, 0
v_accvgpr_write_b32 a183, 0
v_accvgpr_write_b32 a184, 0
v_accvgpr_write_b32 a185, 0
v_accvgpr_write_b32 a186, 0
v_accvgpr_write_b32 a187, 0
v_accvgpr_write_b32 a188, 0
v_accvgpr_write_b32 a189, 0
v_accvgpr_write_b32 a190, 0
v_accvgpr_write_b32 a191, 0
v_accvgpr_write_b32 a192, 0
v_accvgpr_write_b32 a193, 0
v_accvgpr_write_b32 a194, 0
v_accvgpr_write_b32 a195, 0
v_accvgpr_write_b32 a196, 0
v_accvgpr_write_b32 a197, 0
v_accvgpr_write_b32 a198, 0
v_accvgpr_write_b32 a199, 0
v_accvgpr_write_b32 a200, 0
v_accvgpr_write_b32 a201, 0
v_accvgpr_write_b32 a202, 0
v_accvgpr_write_b32 a203, 0
v_accvgpr_write_b32 a204, 0
v_accvgpr_write_b32 a205, 0
v_accvgpr_write_b32 a206, 0
v_accvgpr_write_b32 a207, 0
v_accvgpr_write_b32 a208, 0
v_accvgpr_write_b32 a209, 0
v_accvgpr_write_b32 a210, 0
v_accvgpr_write_b32 a211, 0
v_accvgpr_write_b32 a212, 0
v_accvgpr_write_b32 a213, 0
v_accvgpr_write_b32 a214, 0
v_accvgpr_write_b32 a215, 0
v_accvgpr_write_b32 a216, 0
v_accvgpr_write_b32 a217, 0
v_accvgpr_write_b32 a218, 0
v_accvgpr_write_b32 a219, 0
v_accvgpr_write_b32 a220, 0
v_accvgpr_write_b32 a221, 0
v_accvgpr_write_b32 a222, 0
v_accvgpr_write_b32 a223, 0
v_accvgpr_write_b32 a224, 0
v_accvgpr_write_b32 a225, 0
v_accvgpr_write_b32 a226, 0
v_accvgpr_write_b32 a227, 0
v_accvgpr_write_b32 a228, 0
v_accvgpr_write_b32 a229, 0
v_accvgpr_write_b32 a230, 0
v_accvgpr_write_b32 a231, 0
v_accvgpr_write_b32 a232, 0
v_accvgpr_write_b32 a233, 0
v_accvgpr_write_b32 a234, 0
v_accvgpr_write_b32 a235, 0
v_accvgpr_write_b32 a236, 0
v_accvgpr_write_b32 a237, 0
v_accvgpr_write_b32 a238, 0
v_accvgpr_write_b32 a239, 0
v_accvgpr_write_b32 a240, 0
v_accvgpr_write_b32 a241, 0
v_accvgpr_write_b32 a242, 0
v_accvgpr_write_b32 a243, 0
v_accvgpr_write_b32 a244, 0
v_accvgpr_write_b32 a245, 0
v_accvgpr_write_b32 a246, 0
v_accvgpr_write_b32 a247, 0
v_accvgpr_write_b32 a248, 0
v_accvgpr_write_b32 a249, 0
v_accvgpr_write_b32 a250, 0
v_accvgpr_write_b32 a251, 0
v_accvgpr_write_b32 a252, 0
v_accvgpr_write_b32 a253, 0
v_accvgpr_write_b32 a254, 0
v_accvgpr_write_b32 a255, 0
s_waitcnt vmcnt(24)
s_barrier
ds_read_b64_tr_b16 v[48:49], v11 offset:0
ds_read_b64_tr_b16 v[50:51], v11 offset:1024
ds_read_b128 v[32:35], v9 offset:0
ds_read_b128 v[36:39], v9 offset:2048
ds_read_b128 v[40:43], v9 offset:4096
ds_read_b128 v[44:47], v9 offset:6144
ds_read_b64_tr_b16 v[52:53], v12 offset:0
ds_read_b64_tr_b16 v[54:55], v12 offset:1024
ds_read_b64_tr_b16 v[56:57], v13 offset:0
ds_read_b64_tr_b16 v[58:59], v13 offset:1024
ds_read_b64_tr_b16 v[60:61], v14 offset:0
ds_read_b64_tr_b16 v[62:63], v14 offset:1024
s_mov_b32 s30, 0
s_cmp_ge_u32 s17, 2
s_cbranch_scc1 L_gb_v
.p2align 3
L_gb_k:
s_waitcnt lgkmcnt(0)
v_mfma_f32_32x32x16_bf16 a[0:15], v[48:51], v[32:35], a[0:15]
ds_read_b64_tr_b16 v[80:81], v11 offset:4096
v_mfma_f32_32x32x16_bf16 a[16:31], v[48:51], v[36:39], a[16:31]
ds_read_b64_tr_b16 v[82:83], v11 offset:5120
v_mfma_f32_32x32x16_bf16 a[32:47], v[48:51], v[40:43], a[32:47]
ds_read_b128 v[64:67], v10 offset:0
v_mfma_f32_32x32x16_bf16 a[48:63], v[48:51], v[44:47], a[48:63]
ds_read_b128 v[68:71], v10 offset:2048
v_mfma_f32_32x32x16_bf16 a[64:79], v[52:55], v[32:35], a[64:79]
ds_read_b128 v[72:75], v10 offset:4096
v_mfma_f32_32x32x16_bf16 a[80:95], v[52:55], v[36:39], a[80:95]
ds_read_b128 v[76:79], v10 offset:6144
v_mfma_f32_32x32x16_bf16 a[96:111], v[52:55], v[40:43], a[96:111]
ds_read_b64_tr_b16 v[84:85], v12 offset:4096
v_mfma_f32_32x32x16_bf16 a[112:127], v[52:55], v[44:47], a[112:127]
ds_read_b64_tr_b16 v[86:87], v12 offset:5120
v_mfma_f32_32x32x16_bf16 a[128:143], v[56:59], v[32:35], a[128:143]
ds_read_b64_tr_b16 v[88:89], v13 offset:4096
v_mfma_f32_32x32x16_bf16 a[144:159], v[56:59], v[36:39], a[144:159]
ds_read_b64_tr_b16 v[90:91], v13 offset:5120
v_mfma_f32_32x32x16_bf16 a[160:175], v[56:59], v[40:43], a[160:175]
ds_read_b64_tr_b16 v[92:93], v14 offset:4096
v_mfma_f32_32x32x16_bf16 a[176:191], v[56:59], v[44:47], a[176:191]
ds_read_b64_tr_b16 v[94:95], v14 offset:5120
v_mfma_f32_32x32x16_bf16 a[192:207], v[60:63], v[32:35], a[192:207]
v_add_u32 v9, 32768, v9
v_and_b32 v9, 131071, v9
v_add_u32 v10, 32768, v10
v_mfma_f32_32x32x16_bf16 a[208:223], v[60:63], v[36:39], a[208:223]
v_and_b32 v10, 131071, v10
v_add_u32 v11, 32768, v11
v_and_b32 v11, 131071, v11
v_mfma_f32_32x32x16_bf16 a[224:239], v[60:63], v[40:43], a[224:239]
v_add_u32 v12, 32768, v12
v_and_b32 v12, 131071, v12
v_add_u32 v13, 32768, v13
v_mfma_f32_32x32x16_bf16 a[240:255], v[60:63], v[44:47], a[240:255]
s_add_u32 s25, s30, 4
s_cmp_lt_u32 s25, 18
s_cselect_b32 s32, s32, 536870912
v_and_b32 v13, 131071, v13
v_add_u32 v14, 32768, v14
v_and_b32 v14, 131071, v14
s_waitcnt vmcnt(16) lgkmcnt(0)
s_barrier
v_mfma_f32_32x32x16_bf16 a[0:15], v[80:83], v[64:67], a[0:15]
ds_read_b64_tr_b16 v[48:49], v11 offset:0
s_mov_b32 m0, s34
v_mfma_f32_32x32x16_bf16 a[16:31], v[80:83], v[68:71], a[16:31]
ds_read_b64_tr_b16 v[50:51], v11 offset:1024
v_mfma_f32_32x32x16_bf16 a[32:47], v[80:83], v[72:75], a[32:47]
ds_read_b128 v[32:35], v9 offset:0
buffer_load_dwordx4 v1, s[12:15], s32 offen offset:0 lds
v_mfma_f32_32x32x16_bf16 a[48:63], v[80:83], v[76:79], a[48:63]
ds_read_b128 v[36:39], v9 offset:2048
v_mfma_f32_32x32x16_bf16 a[64:79], v[84:87], v[64:67], a[64:79]
ds_read_b128 v[40:43], v9 offset:4096
buffer_load_dwordx4 v2, s[12:15], s32 offen offset:1024 lds
v_mfma_f32_32x32x16_bf16 a[80:95], v[84:87], v[68:71], a[80:95]
ds_read_b128 v[44:47], v9 offset:6144
v_mfma_f32_32x32x16_bf16 a[96:111], v[84:87], v[72:75], a[96:111]
ds_read_b64_tr_b16 v[52:53], v12 offset:0
buffer_load_dwordx4 v3, s[12:15], s32 offen offset:2048 lds
v_mfma_f32_32x32x16_bf16 a[112:127], v[84:87], v[76:79], a[112:127]
ds_read_b64_tr_b16 v[54:55], v12 offset:1024
v_mfma_f32_32x32x16_bf16 a[128:143], v[88:91], v[64:67], a[128:143]
ds_read_b64_tr_b16 v[56:57], v13 offset:0
buffer_load_dwordx4 v4, s[12:15], s32 offen offset:3072 lds
s_mov_b32 m0, s35
v_mfma_f32_32x32x16_bf16 a[144:159], v[88:91], v[68:71], a[144:159]
ds_read_b64_tr_b16 v[58:59], v13 offset:1024
v_mfma_f32_32x32x16_bf16 a[160:175], v[88:91], v[72:75], a[160:175]
ds_read_b64_tr_b16 v[60:61], v14 offset:0
buffer_load_dwordx4 v5, s[20:23], s33 offen offset:0 lds
v_mfma_f32_32x32x16_bf16 a[176:191], v[88:91], v[76:79], a[176:191]
ds_read_b64_tr_b16 v[62:63], v14 offset:1024
v_mfma_f32_32x32x16_bf16 a[192:207], v[92:95], v[64:67], a[192:207]
buffer_load_dwordx4 v6, s[20:23], s33 offen offset:1024 lds
v_mfma_f32_32x32x16_bf16 a[208:223], v[92:95], v[68:71], a[208:223]
v_mfma_f32_32x32x16_bf16 a[224:239], v[92:95], v[72:75], a[224:239]
buffer_load_dwordx4 v7, s[20:23], s33 offen offset:2048 lds
v_mfma_f32_32x32x16_bf16 a[240:255], v[92:95], v[76:79], a[240:255]
buffer_load_dwordx4 v8, s[20:23], s33 offen offset:3072 lds
s_add_u32 s32, s32, 64
s_add_u32 s33, s33, 262144
s_add_u32 s34, s34, 32768
s_and_b32 s34, s34, 131071
s_add_u32 s35, s35, 32768
s_and_b32 s35, s35, 131071
s_add_u32 s30, s30, 1
s_cmp_lt_u32 s30, 18
s_cbranch_scc1 L_gb_k
s_branch L_gb_end
.p2align 3
L_gb_v:
s_waitcnt lgkmcnt(0)
v_mfma_f32_32x32x16_bf16 a[0:15], v[32:35], v[48:51], a[0:15]
ds_read_b64_tr_b16 v[80:81], v11 offset:4096
v_mfma_f32_32x32x16_bf16 a[16:31], v[36:39], v[48:51], a[16:31]
ds_read_b64_tr_b16 v[82:83], v11 offset:5120
v_mfma_f32_32x32x16_bf16 a[32:47], v[40:43], v[48:51], a[32:47]
ds_read_b128 v[64:67], v10 offset:0
v_mfma_f32_32x32x16_bf16 a[48:63], v[44:47], v[48:51], a[48:63]
ds_read_b128 v[68:71], v10 offset:2048
v_mfma_f32_32x32x16_bf16 a[64:79], v[32:35], v[52:55], a[64:79]
ds_read_b128 v[72:75], v10 offset:4096
v_mfma_f32_32x32x16_bf16 a[80:95], v[36:39], v[52:55], a[80:95]
ds_read_b128 v[76:79], v10 offset:6144
v_mfma_f32_32x32x16_bf16 a[96:111], v[40:43], v[52:55], a[96:111]
ds_read_b64_tr_b16 v[84:85], v12 offset:4096
v_mfma_f32_32x32x16_bf16 a[112:127], v[44:47], v[52:55], a[112:127]
ds_read_b64_tr_b16 v[86:87], v12 offset:5120
v_mfma_f32_32x32x16_bf16 a[128:143], v[32:35], v[56:59], a[128:143]
ds_read_b64_tr_b16 v[88:89], v13 offset:4096
v_mfma_f32_32x32x16_bf16 a[144:159], v[36:39], v[56:59], a[144:159]
ds_read_b64_tr_b16 v[90:91], v13 offset:5120
v_mfma_f32_32x32x16_bf16 a[160:175], v[40:43], v[56:59], a[160:175]
ds_read_b64_tr_b16 v[92:93], v14 offset:4096
v_mfma_f32_32x32x16_bf16 a[176:191], v[44:47], v[56:59], a[176:191]
ds_read_b64_tr_b16 v[94:95], v14 offset:5120
v_mfma_f32_32x32x16_bf16 a[192:207], v[32:35], v[60:63], a[192:207]
v_add_u32 v9, 32768, v9
v_and_b32 v9, 131071, v9
v_add_u32 v10, 32768, v10
v_mfma_f32_32x32x16_bf16 a[208:223], v[36:39], v[60:63], a[208:223]
v_and_b32 v10, 131071, v10
v_add_u32 v11, 32768, v11
v_and_b32 v11, 131071, v11
v_mfma_f32_32x32x16_bf16 a[224:239], v[40:43], v[60:63], a[224:239]
v_add_u32 v12, 32768, v12
v_and_b32 v12, 131071, v12
v_add_u32 v13, 32768, v13
v_mfma_f32_32x32x16_bf16 a[240:255], v[44:47], v[60:63], a[240:255]
s_add_u32 s25, s30, 4
s_cmp_lt_u32 s25, 18
s_cselect_b32 s32, s32, 536870912
v_and_b32 v13, 131071, v13
v_add_u32 v14, 32768, v14
v_and_b32 v14, 131071, v14
s_waitcnt vmcnt(16) lgkmcnt(0)
s_barrier
v_mfma_f32_32x32x16_bf16 a[0:15], v[64:67], v[80:83], a[0:15]
ds_read_b64_tr_b16 v[48:49], v11 offset:0
s_mov_b32 m0, s34
v_mfma_f32_32x32x16_bf16 a[16:31], v[68:71], v[80:83], a[16:31]
ds_read_b64_tr_b16 v[50:51], v11 offset:1024
v_mfma_f32_32x32x16_bf16 a[32:47], v[72:75], v[80:83], a[32:47]
ds_read_b128 v[32:35], v9 offset:0
buffer_load_dwordx4 v1, s[12:15], s32 offen offset:0 lds
v_mfma_f32_32x32x16_bf16 a[48:63], v[76:79], v[80:83], a[48:63]
ds_read_b128 v[36:39], v9 offset:2048
v_mfma_f32_32x32x16_bf16 a[64:79], v[64:67], v[84:87], a[64:79]
ds_read_b128 v[40:43], v9 offset:4096
buffer_load_dwordx4 v2, s[12:15], s32 offen offset:1024 lds
v_mfma_f32_32x32x16_bf16 a[80:95], v[68:71], v[84:87], a[80:95]
ds_read_b128 v[44:47], v9 offset:6144
v_mfma_f32_32x32x16_bf16 a[96:111], v[72:75], v[84:87], a[96:111]
ds_read_b64_tr_b16 v[52:53], v12 offset:0
buffer_load_dwordx4 v3, s[12:15], s32 offen offset:2048 lds
v_mfma_f32_32x32x16_bf16 a[112:127], v[76:79], v[84:87], a[112:127]
ds_read_b64_tr_b16 v[54:55], v12 offset:1024
v_mfma_f32_32x32x16_bf16 a[128:143], v[64:67], v[88:91], a[128:143]
ds_read_b64_tr_b16 v[56:57], v13 offset:0
buffer_load_dwordx4 v4, s[12:15], s32 offen offset:3072 lds
s_mov_b32 m0, s35
v_mfma_f32_32x32x16_bf16 a[144:159], v[68:71], v[88:91], a[144:159]
ds_read_b64_tr_b16 v[58:59], v13 offset:1024
v_mfma_f32_32x32x16_bf16 a[160:175], v[72:75], v[88:91], a[160:175]
ds_read_b64_tr_b16 v[60:61], v14 offset:0
buffer_load_dwordx4 v5, s[20:23], s33 offen offset:0 lds
v_mfma_f32_32x32x16_bf16 a[176:191], v[76:79], v[88:91], a[176:191]
ds_read_b64_tr_b16 v[62:63], v14 offset:1024
v_mfma_f32_32x32x16_bf16 a[192:207], v[64:67], v[92:95], a[192:207]
buffer_load_dwordx4 v6, s[20:23], s33 offen offset:1024 lds
v_mfma_f32_32x32x16_bf16 a[208:223], v[68:71], v[92:95], a[208:223]
v_mfma_f32_32x32x16_bf16 a[224:239], v[72:75], v[92:95], a[224:239]
buffer_load_dwordx4 v7, s[20:23], s33 offen offset:2048 lds
v_mfma_f32_32x32x16_bf16 a[240:255], v[76:79], v[92:95], a[240:255]
buffer_load_dwordx4 v8, s[20:23], s33 offen offset:3072 lds
s_add_u32 s32, s32, 64
s_add_u32 s33, s33, 262144
s_add_u32 s34, s34, 32768
s_and_b32 s34, s34, 131071
s_add_u32 s35, s35, 32768
s_and_b32 s35, s35, 131071
s_add_u32 s30, s30, 1
s_cmp_lt_u32 s30, 18
s_cbranch_scc1 L_gb_v
L_gb_end:
s_waitcnt vmcnt(0) lgkmcnt(0)
s_lshl_b32 s61, s16, 3
s_add_u32 s61, s61, s60
s_lshl_b32 s61, s61, 17
s_add_u32 s61, s61, 33554432
v_and_b32 v15, 63, v0
v_lshlrev_b32 v15, 4, v15
s_and_b32 s24, s17, 1
s_lshl_b32 s24, s24, 16
s_lshr_b32 s25, s17, 1
s_lshl_b32 s25, s25, 13
s_add_u32 s24, s24, s25
s_add_u32 s24, s24, s61
s_add_u32 s25, s24, 0
v_accvgpr_read_b32 v32, a0
v_accvgpr_read_b32 v33, a1
v_accvgpr_read_b32 v34, a2
v_accvgpr_read_b32 v35, a3
v_accvgpr_read_b32 v36, a4
v_accvgpr_read_b32 v37, a5
v_accvgpr_read_b32 v38, a6
v_accvgpr_read_b32 v39, a7
v_cvt_pk_bf16_f32 v32, v32, v33
v_cvt_pk_bf16_f32 v33, v34, v35
v_cvt_pk_bf16_f32 v34, v36, v37
v_cvt_pk_bf16_f32 v35, v38, v39
buffer_store_dwordx4 v[32:35], v15, s[8:11], s25 offen offset:0 sc1
v_accvgpr_read_b32 v40, a8
v_accvgpr_read_b32 v41, a9
v_accvgpr_read_b32 v42, a10
v_accvgpr_read_b32 v43, a11
v_accvgpr_read_b32 v44, a12
v_accvgpr_read_b32 v45, a13
v_accvgpr_read_b32 v46, a14
v_accvgpr_read_b32 v47, a15
v_cvt_pk_bf16_f32 v40, v40, v41
v_cvt_pk_bf16_f32 v41, v42, v43
v_cvt_pk_bf16_f32 v42, v44, v45
v_cvt_pk_bf16_f32 v43, v46, v47
buffer_store_dwordx4 v[40:43], v15, s[8:11], s25 offen offset:1024 sc1
v_accvgpr_read_b32 v48, a64
v_accvgpr_read_b32 v49, a65
v_accvgpr_read_b32 v50, a66
v_accvgpr_read_b32 v51, a67
v_accvgpr_read_b32 v52, a68
v_accvgpr_read_b32 v53, a69
v_accvgpr_read_b32 v54, a70
v_accvgpr_read_b32 v55, a71
v_cvt_pk_bf16_f32 v48, v48, v49
v_cvt_pk_bf16_f32 v49, v50, v51
v_cvt_pk_bf16_f32 v50, v52, v53
v_cvt_pk_bf16_f32 v51, v54, v55
buffer_store_dwordx4 v[48:51], v15, s[8:11], s25 offen offset:2048 sc1
v_accvgpr_read_b32 v56, a72
v_accvgpr_read_b32 v57, a73
v_accvgpr_read_b32 v58, a74
v_accvgpr_read_b32 v59, a75
v_accvgpr_read_b32 v60, a76
v_accvgpr_read_b32 v61, a77
v_accvgpr_read_b32 v62, a78
v_accvgpr_read_b32 v63, a79
v_cvt_pk_bf16_f32 v56, v56, v57
v_cvt_pk_bf16_f32 v57, v58, v59
v_cvt_pk_bf16_f32 v58, v60, v61
v_cvt_pk_bf16_f32 v59, v62, v63
buffer_store_dwordx4 v[56:59], v15, s[8:11], s25 offen offset:3072 sc1
s_add_u32 s25, s24, 4096
v_accvgpr_read_b32 v64, a128
v_accvgpr_read_b32 v65, a129
v_accvgpr_read_b32 v66, a130
v_accvgpr_read_b32 v67, a131
v_accvgpr_read_b32 v68, a132
v_accvgpr_read_b32 v69, a133
v_accvgpr_read_b32 v70, a134
v_accvgpr_read_b32 v71, a135
v_cvt_pk_bf16_f32 v64, v64, v65
v_cvt_pk_bf16_f32 v65, v66, v67
v_cvt_pk_bf16_f32 v66, v68, v69
v_cvt_pk_bf16_f32 v67, v70, v71
buffer_store_dwordx4 v[64:67], v15, s[8:11], s25 offen offset:0 sc1
v_accvgpr_read_b32 v72, a136
v_accvgpr_read_b32 v73, a137
v_accvgpr_read_b32 v74, a138
v_accvgpr_read_b32 v75, a139
v_accvgpr_read_b32 v76, a140
v_accvgpr_read_b32 v77, a141
v_accvgpr_read_b32 v78, a142
v_accvgpr_read_b32 v79, a143
v_cvt_pk_bf16_f32 v72, v72, v73
v_cvt_pk_bf16_f32 v73, v74, v75
v_cvt_pk_bf16_f32 v74, v76, v77
v_cvt_pk_bf16_f32 v75, v78, v79
buffer_store_dwordx4 v[72:75], v15, s[8:11], s25 offen offset:1024 sc1
v_accvgpr_read_b32 v80, a192
v_accvgpr_read_b32 v81, a193
v_accvgpr_read_b32 v82, a194
v_accvgpr_read_b32 v83, a195
v_accvgpr_read_b32 v84, a196
v_accvgpr_read_b32 v85, a197
v_accvgpr_read_b32 v86, a198
v_accvgpr_read_b32 v87, a199
v_cvt_pk_bf16_f32 v80, v80, v81
v_cvt_pk_bf16_f32 v81, v82, v83
v_cvt_pk_bf16_f32 v82, v84, v85
v_cvt_pk_bf16_f32 v83, v86, v87
buffer_store_dwordx4 v[80:83], v15, s[8:11], s25 offen offset:2048 sc1
v_accvgpr_read_b32 v88, a200
v_accvgpr_read_b32 v89, a201
v_accvgpr_read_b32 v90, a202
v_accvgpr_read_b32 v91, a203
v_accvgpr_read_b32 v92, a204
v_accvgpr_read_b32 v93, a205
v_accvgpr_read_b32 v94, a206
v_accvgpr_read_b32 v95, a207
v_cvt_pk_bf16_f32 v88, v88, v89
v_cvt_pk_bf16_f32 v89, v90, v91
v_cvt_pk_bf16_f32 v90, v92, v93
v_cvt_pk_bf16_f32 v91, v94, v95
buffer_store_dwordx4 v[88:91], v15, s[8:11], s25 offen offset:3072 sc1
s_add_u32 s25, s24, 16384
v_accvgpr_read_b32 v32, a16
v_accvgpr_read_b32 v33, a17
v_accvgpr_read_b32 v34, a18
v_accvgpr_read_b32 v35, a19
v_accvgpr_read_b32 v36, a20
v_accvgpr_read_b32 v37, a21
v_accvgpr_read_b32 v38, a22
v_accvgpr_read_b32 v39, a23
v_cvt_pk_bf16_f32 v32, v32, v33
v_cvt_pk_bf16_f32 v33, v34, v35
v_cvt_pk_bf16_f32 v34, v36, v37
v_cvt_pk_bf16_f32 v35, v38, v39
buffer_store_dwordx4 v[32:35], v15, s[8:11], s25 offen offset:0 sc1
v_accvgpr_read_b32 v40, a24
v_accvgpr_read_b32 v41, a25
v_accvgpr_read_b32 v42, a26
v_accvgpr_read_b32 v43, a27
v_accvgpr_read_b32 v44, a28
v_accvgpr_read_b32 v45, a29
v_accvgpr_read_b32 v46, a30
v_accvgpr_read_b32 v47, a31
v_cvt_pk_bf16_f32 v40, v40, v41
v_cvt_pk_bf16_f32 v41, v42, v43
v_cvt_pk_bf16_f32 v42, v44, v45
v_cvt_pk_bf16_f32 v43, v46, v47
buffer_store_dwordx4 v[40:43], v15, s[8:11], s25 offen offset:1024 sc1
v_accvgpr_read_b32 v48, a80
v_accvgpr_read_b32 v49, a81
v_accvgpr_read_b32 v50, a82
v_accvgpr_read_b32 v51, a83
v_accvgpr_read_b32 v52, a84
v_accvgpr_read_b32 v53, a85
v_accvgpr_read_b32 v54, a86
v_accvgpr_read_b32 v55, a87
v_cvt_pk_bf16_f32 v48, v48, v49
v_cvt_pk_bf16_f32 v49, v50, v51
v_cvt_pk_bf16_f32 v50, v52, v53
v_cvt_pk_bf16_f32 v51, v54, v55
buffer_store_dwordx4 v[48:51], v15, s[8:11], s25 offen offset:2048 sc1
v_accvgpr_read_b32 v56, a88
v_accvgpr_read_b32 v57, a89
v_accvgpr_read_b32 v58, a90
v_accvgpr_read_b32 v59, a91
v_accvgpr_read_b32 v60, a92
v_accvgpr_read_b32 v61, a93
v_accvgpr_read_b32 v62, a94
v_accvgpr_read_b32 v63, a95
v_cvt_pk_bf16_f32 v56, v56, v57
v_cvt_pk_bf16_f32 v57, v58, v59
v_cvt_pk_bf16_f32 v58, v60, v61
v_cvt_pk_bf16_f32 v59, v62, v63
buffer_store_dwordx4 v[56:59], v15, s[8:11], s25 offen offset:3072 sc1
s_add_u32 s25, s24, 20480
v_accvgpr_read_b32 v64, a144
v_accvgpr_read_b32 v65, a145
v_accvgpr_read_b32 v66, a146
v_accvgpr_read_b32 v67, a147
v_accvgpr_read_b32 v68, a148
v_accvgpr_read_b32 v69, a149
v_accvgpr_read_b32 v70, a150
v_accvgpr_read_b32 v71, a151
v_cvt_pk_bf16_f32 v64, v64, v65
v_cvt_pk_bf16_f32 v65, v66, v67
v_cvt_pk_bf16_f32 v66, v68, v69
v_cvt_pk_bf16_f32 v67, v70, v71
buffer_store_dwordx4 v[64:67], v15, s[8:11], s25 offen offset:0 sc1
v_accvgpr_read_b32 v72, a152
v_accvgpr_read_b32 v73, a153
v_accvgpr_read_b32 v74, a154
v_accvgpr_read_b32 v75, a155
v_accvgpr_read_b32 v76, a156
v_accvgpr_read_b32 v77, a157
v_accvgpr_read_b32 v78, a158
v_accvgpr_read_b32 v79, a159
v_cvt_pk_bf16_f32 v72, v72, v73
v_cvt_pk_bf16_f32 v73, v74, v75
v_cvt_pk_bf16_f32 v74, v76, v77
v_cvt_pk_bf16_f32 v75, v78, v79
buffer_store_dwordx4 v[72:75], v15, s[8:11], s25 offen offset:1024 sc1
v_accvgpr_read_b32 v80, a208
v_accvgpr_read_b32 v81, a209
v_accvgpr_read_b32 v82, a210
v_accvgpr_read_b32 v83, a211
v_accvgpr_read_b32 v84, a212
v_accvgpr_read_b32 v85, a213
v_accvgpr_read_b32 v86, a214
v_accvgpr_read_b32 v87, a215
v_cvt_pk_bf16_f32 v80, v80, v81
v_cvt_pk_bf16_f32 v81, v82, v83
v_cvt_pk_bf16_f32 v82, v84, v85
v_cvt_pk_bf16_f32 v83, v86, v87
buffer_store_dwordx4 v[80:83], v15, s[8:11], s25 offen offset:2048 sc1
v_accvgpr_read_b32 v88, a216
v_accvgpr_read_b32 v89, a217
v_accvgpr_read_b32 v90, a218
v_accvgpr_read_b32 v91, a219
v_accvgpr_read_b32 v92, a220
v_accvgpr_read_b32 v93, a221
v_accvgpr_read_b32 v94, a222
v_accvgpr_read_b32 v95, a223
v_cvt_pk_bf16_f32 v88, v88, v89
v_cvt_pk_bf16_f32 v89, v90, v91
v_cvt_pk_bf16_f32 v90, v92, v93
v_cvt_pk_bf16_f32 v91, v94, v95
buffer_store_dwordx4 v[88:91], v15, s[8:11], s25 offen offset:3072 sc1
s_add_u32 s25, s24, 32768
v_accvgpr_read_b32 v32, a32
v_accvgpr_read_b32 v33, a33
v_accvgpr_read_b32 v34, a34
v_accvgpr_read_b32 v35, a35
v_accvgpr_read_b32 v36, a36
v_accvgpr_read_b32 v37, a37
v_accvgpr_read_b32 v38, a38
v_accvgpr_read_b32 v39, a39
v_cvt_pk_bf16_f32 v32, v32, v33
v_cvt_pk_bf16_f32 v33, v34, v35
v_cvt_pk_bf16_f32 v34, v36, v37
v_cvt_pk_bf16_f32 v35, v38, v39
buffer_store_dwordx4 v[32:35], v15, s[8:11], s25 offen offset:0 sc1
v_accvgpr_read_b32 v40, a40
v_accvgpr_read_b32 v41, a41
v_accvgpr_read_b32 v42, a42
v_accvgpr_read_b32 v43, a43
v_accvgpr_read_b32 v44, a44
v_accvgpr_read_b32 v45, a45
v_accvgpr_read_b32 v46, a46
v_accvgpr_read_b32 v47, a47
v_cvt_pk_bf16_f32 v40, v40, v41
v_cvt_pk_bf16_f32 v41, v42, v43
v_cvt_pk_bf16_f32 v42, v44, v45
v_cvt_pk_bf16_f32 v43, v46, v47
buffer_store_dwordx4 v[40:43], v15, s[8:11], s25 offen offset:1024 sc1
v_accvgpr_read_b32 v48, a96
v_accvgpr_read_b32 v49, a97
v_accvgpr_read_b32 v50, a98
v_accvgpr_read_b32 v51, a99
v_accvgpr_read_b32 v52, a100
v_accvgpr_read_b32 v53, a101
v_accvgpr_read_b32 v54, a102
v_accvgpr_read_b32 v55, a103
v_cvt_pk_bf16_f32 v48, v48, v49
v_cvt_pk_bf16_f32 v49, v50, v51
v_cvt_pk_bf16_f32 v50, v52, v53
v_cvt_pk_bf16_f32 v51, v54, v55
buffer_store_dwordx4 v[48:51], v15, s[8:11], s25 offen offset:2048 sc1
v_accvgpr_read_b32 v56, a104
v_accvgpr_read_b32 v57, a105
v_accvgpr_read_b32 v58, a106
v_accvgpr_read_b32 v59, a107
v_accvgpr_read_b32 v60, a108
v_accvgpr_read_b32 v61, a109
v_accvgpr_read_b32 v62, a110
v_accvgpr_read_b32 v63, a111
v_cvt_pk_bf16_f32 v56, v56, v57
v_cvt_pk_bf16_f32 v57, v58, v59
v_cvt_pk_bf16_f32 v58, v60, v61
v_cvt_pk_bf16_f32 v59, v62, v63
buffer_store_dwordx4 v[56:59], v15, s[8:11], s25 offen offset:3072 sc1
s_add_u32 s25, s24, 36864
v_accvgpr_read_b32 v64, a160
v_accvgpr_read_b32 v65, a161
v_accvgpr_read_b32 v66, a162
v_accvgpr_read_b32 v67, a163
v_accvgpr_read_b32 v68, a164
v_accvgpr_read_b32 v69, a165
v_accvgpr_read_b32 v70, a166
v_accvgpr_read_b32 v71, a167
v_cvt_pk_bf16_f32 v64, v64, v65
v_cvt_pk_bf16_f32 v65, v66, v67
v_cvt_pk_bf16_f32 v66, v68, v69
v_cvt_pk_bf16_f32 v67, v70, v71
buffer_store_dwordx4 v[64:67], v15, s[8:11], s25 offen offset:0 sc1
v_accvgpr_read_b32 v72, a168
v_accvgpr_read_b32 v73, a169
v_accvgpr_read_b32 v74, a170
v_accvgpr_read_b32 v75, a171
v_accvgpr_read_b32 v76, a172
v_accvgpr_read_b32 v77, a173
v_accvgpr_read_b32 v78, a174
v_accvgpr_read_b32 v79, a175
v_cvt_pk_bf16_f32 v72, v72, v73
v_cvt_pk_bf16_f32 v73, v74, v75
v_cvt_pk_bf16_f32 v74, v76, v77
v_cvt_pk_bf16_f32 v75, v78, v79
buffer_store_dwordx4 v[72:75], v15, s[8:11], s25 offen offset:1024 sc1
v_accvgpr_read_b32 v80, a224
v_accvgpr_read_b32 v81, a225
v_accvgpr_read_b32 v82, a226
v_accvgpr_read_b32 v83, a227
v_accvgpr_read_b32 v84, a228
v_accvgpr_read_b32 v85, a229
v_accvgpr_read_b32 v86, a230
v_accvgpr_read_b32 v87, a231
v_cvt_pk_bf16_f32 v80, v80, v81
v_cvt_pk_bf16_f32 v81, v82, v83
v_cvt_pk_bf16_f32 v82, v84, v85
v_cvt_pk_bf16_f32 v83, v86, v87
buffer_store_dwordx4 v[80:83], v15, s[8:11], s25 offen offset:2048 sc1
v_accvgpr_read_b32 v88, a232
v_accvgpr_read_b32 v89, a233
v_accvgpr_read_b32 v90, a234
v_accvgpr_read_b32 v91, a235
v_accvgpr_read_b32 v92, a236
v_accvgpr_read_b32 v93, a237
v_accvgpr_read_b32 v94, a238
v_accvgpr_read_b32 v95, a239
v_cvt_pk_bf16_f32 v88, v88, v89
v_cvt_pk_bf16_f32 v89, v90, v91
v_cvt_pk_bf16_f32 v90, v92, v93
v_cvt_pk_bf16_f32 v91, v94, v95
buffer_store_dwordx4 v[88:91], v15, s[8:11], s25 offen offset:3072 sc1
s_add_u32 s25, s24, 49152
v_accvgpr_read_b32 v32, a48
v_accvgpr_read_b32 v33, a49
v_accvgpr_read_b32 v34, a50
v_accvgpr_read_b32 v35, a51
v_accvgpr_read_b32 v36, a52
v_accvgpr_read_b32 v37, a53
v_accvgpr_read_b32 v38, a54
v_accvgpr_read_b32 v39, a55
v_cvt_pk_bf16_f32 v32, v32, v33
v_cvt_pk_bf16_f32 v33, v34, v35
v_cvt_pk_bf16_f32 v34, v36, v37
v_cvt_pk_bf16_f32 v35, v38, v39
buffer_store_dwordx4 v[32:35], v15, s[8:11], s25 offen offset:0 sc1
v_accvgpr_read_b32 v40, a56
v_accvgpr_read_b32 v41, a57
v_accvgpr_read_b32 v42, a58
v_accvgpr_read_b32 v43, a59
v_accvgpr_read_b32 v44, a60
v_accvgpr_read_b32 v45, a61
v_accvgpr_read_b32 v46, a62
v_accvgpr_read_b32 v47, a63
v_cvt_pk_bf16_f32 v40, v40, v41
v_cvt_pk_bf16_f32 v41, v42, v43
v_cvt_pk_bf16_f32 v42, v44, v45
v_cvt_pk_bf16_f32 v43, v46, v47
buffer_store_dwordx4 v[40:43], v15, s[8:11], s25 offen offset:1024 sc1
v_accvgpr_read_b32 v48, a112
v_accvgpr_read_b32 v49, a113
v_accvgpr_read_b32 v50, a114
v_accvgpr_read_b32 v51, a115
v_accvgpr_read_b32 v52, a116
v_accvgpr_read_b32 v53, a117
v_accvgpr_read_b32 v54, a118
v_accvgpr_read_b32 v55, a119
v_cvt_pk_bf16_f32 v48, v48, v49
v_cvt_pk_bf16_f32 v49, v50, v51
v_cvt_pk_bf16_f32 v50, v52, v53
v_cvt_pk_bf16_f32 v51, v54, v55
buffer_store_dwordx4 v[48:51], v15, s[8:11], s25 offen offset:2048 sc1
v_accvgpr_read_b32 v56, a120
v_accvgpr_read_b32 v57, a121
v_accvgpr_read_b32 v58, a122
v_accvgpr_read_b32 v59, a123
v_accvgpr_read_b32 v60, a124
v_accvgpr_read_b32 v61, a125
v_accvgpr_read_b32 v62, a126
v_accvgpr_read_b32 v63, a127
v_cvt_pk_bf16_f32 v56, v56, v57
v_cvt_pk_bf16_f32 v57, v58, v59
v_cvt_pk_bf16_f32 v58, v60, v61
v_cvt_pk_bf16_f32 v59, v62, v63
buffer_store_dwordx4 v[56:59], v15, s[8:11], s25 offen offset:3072 sc1
s_add_u32 s25, s24, 53248
v_accvgpr_read_b32 v64, a176
v_accvgpr_read_b32 v65, a177
v_accvgpr_read_b32 v66, a178
v_accvgpr_read_b32 v67, a179
v_accvgpr_read_b32 v68, a180
v_accvgpr_read_b32 v69, a181
v_accvgpr_read_b32 v70, a182
v_accvgpr_read_b32 v71, a183
v_cvt_pk_bf16_f32 v64, v64, v65
v_cvt_pk_bf16_f32 v65, v66, v67
v_cvt_pk_bf16_f32 v66, v68, v69
v_cvt_pk_bf16_f32 v67, v70, v71
buffer_store_dwordx4 v[64:67], v15, s[8:11], s25 offen offset:0 sc1
v_accvgpr_read_b32 v72, a184
v_accvgpr_read_b32 v73, a185
v_accvgpr_read_b32 v74, a186
v_accvgpr_read_b32 v75, a187
v_accvgpr_read_b32 v76, a188
v_accvgpr_read_b32 v77, a189
v_accvgpr_read_b32 v78, a190
v_accvgpr_read_b32 v79, a191
v_cvt_pk_bf16_f32 v72, v72, v73
v_cvt_pk_bf16_f32 v73, v74, v75
v_cvt_pk_bf16_f32 v74, v76, v77
v_cvt_pk_bf16_f32 v75, v78, v79
buffer_store_dwordx4 v[72:75], v15, s[8:11], s25 offen offset:1024 sc1
v_accvgpr_read_b32 v80, a240
v_accvgpr_read_b32 v81, a241
v_accvgpr_read_b32 v82, a242
v_accvgpr_read_b32 v83, a243
v_accvgpr_read_b32 v84, a244
v_accvgpr_read_b32 v85, a245
v_accvgpr_read_b32 v86, a246
v_accvgpr_read_b32 v87, a247
v_cvt_pk_bf16_f32 v80, v80, v81
v_cvt_pk_bf16_f32 v81, v82, v83
v_cvt_pk_bf16_f32 v82, v84, v85
v_cvt_pk_bf16_f32 v83, v86, v87
buffer_store_dwordx4 v[80:83], v15, s[8:11], s25 offen offset:2048 sc1
v_accvgpr_read_b32 v88, a248
v_accvgpr_read_b32 v89, a249
v_accvgpr_read_b32 v90, a250
v_accvgpr_read_b32 v91, a251
v_accvgpr_read_b32 v92, a252
v_accvgpr_read_b32 v93, a253
v_accvgpr_read_b32 v94, a254
v_accvgpr_read_b32 v95, a255
v_cvt_pk_bf16_f32 v88, v88, v89
v_cvt_pk_bf16_f32 v89, v90, v91
v_cvt_pk_bf16_f32 v90, v92, v93
v_cvt_pk_bf16_f32 v91, v94, v95
buffer_store_dwordx4 v[88:91], v15, s[8:11], s25 offen offset:3072 sc1
v_mov_b32 v20, 128
s_mov_b32 s28, 0
L_poll_11:
buffer_load_dword v21, v20, s[56:59], 0 offen sc1
s_add_u32 s28, s28, 1
s_cmp_gt_u32 s28, 40000
s_cbranch_scc1 L_end
s_waitcnt vmcnt(0)
v_cmp_ne_u32 vcc, 8, v21
s_cbranch_vccz L_pd_12
s_sleep 1
s_branch L_poll_11
L_pd_12:
s_lshl_b32 s61, s16, 7
s_add_u32 s61, s61, 111149056
s_add_u32 s60, s60, 1
s_waitcnt vmcnt(0)
s_barrier
s_cmp_lg_u32 s17, 0
s_cbranch_scc1 L_sf_13
v_mov_b32 v20, 0
v_mov_b32 v21, s60
s_mov_b64 exec, 1
buffer_store_dword v21, v20, s[8:11], s61 offen sc1
s_mov_b64 exec, -1
L_sf_13:
s_cmp_lt_u32 s60, 8
s_cbranch_scc1 L_bkvl
s_branch L_done
L_batt:
s_load_dwordx2 s[4:5], s[0:1], 48
s_waitcnt lgkmcnt(0)
s_mov_b32 s12, s4
s_and_b32 s13, s5, 0xffff
s_mov_b32 s14, 2359296
s_mov_b32 s15, 0x20000
s_load_dwordx2 s[4:5], s[0:1], 64
s_waitcnt lgkmcnt(0)
s_mov_b32 s20, s4
s_and_b32 s21, s5, 0xffff
s_mov_b32 s22, 4718592
s_mov_b32 s23, 0x20000
s_mov_b32 s40, 0x3e0293ee
s_mov_b32 s50, 0xf149f2ca
s_mov_b32 s51, 0x41000000
s_mov_b32 s42, s16
s_mov_b32 s41, 0
L_battl:
s_mul_i32 s36, s41, 294912
s_barrier
s_lshl_b32 s26, s42, 8
v_lshrrev_b32 v15, 6, v0
v_lshlrev_b32 v15, 6, v15
v_bfe_u32 v16, v0, 2, 4
v_add_u32 v15, v15, v16
v_mul_u32_u24 v15, 1152, v15
v_bfe_u32 v16, v0, 4, 2
v_and_b32 v17, 3, v0
v_xor_b32 v17, v17, v16
v_lshl_add_u32 v1, v17, 4, v15
v_add_u32 v2, 17408, v1
v_add_u32 v3, 34816, v1
v_add_u32 v4, 52224, v1
v_bfe_u32 v15, v0, 2, 2
v_xor_b32 v15, v15, v16
v_lshlrev_b32 v15, 6, v15
v_and_b32 v17, 3, v0
v_lshl_add_u32 v15, v17, 4, v15
v_lshl_add_u32 v15, v16, 13, v15
s_lshl_b32 s24, s17, 16
s_add_u32 s24, s24, s26
v_add_u32 v5, s24, v15
v_add_u32 v6, 31744, v5
s_lshl_b32 s37, s17, 12
s_lshl_b32 s38, s17, 11
s_add_u32 s38, s38, 16384
s_mov_b32 s32, s36
s_mov_b32 s33, 0
s_mov_b32 s34, s37
s_mov_b32 s35, s38
s_mov_b32 m0, s34
s_nop 0
buffer_load_dwordx4 v1, s[12:15], s32 offen offset:0 lds
buffer_load_dwordx4 v2, s[12:15], s32 offen offset:1024 lds
buffer_load_dwordx4 v3, s[12:15], s32 offen offset:2048 lds
buffer_load_dwordx4 v4, s[12:15], s32 offen offset:3072 lds
s_mov_b32 m0, s35
s_nop 0
buffer_load_dwordx4 v5, s[20:23], s33 offen offset:0 lds
buffer_load_dwordx4 v6, s[20:23], s33 offen offset:1024 lds
s_add_u32 s32, s32, 64
s_add_u32 s33, s33, 262144
s_add_u32 s34, s34, 32768
s_and_b32 s34, s34, 131071
s_add_u32 s35, s35, 32768
s_and_b32 s35, s35, 131071
s_mov_b32 m0, s34
s_nop 0
buffer_load_dwordx4 v1, s[12:15], s32 offen offset:0 lds
buffer_load_dwordx4 v2, s[12:15], s32 offen offset:1024 lds
buffer_load_dwordx4 v3, s[12:15], s32 offen offset:2048 lds
buffer_load_dwordx4 v4, s[12:15], s32 offen offset:3072 lds
s_mov_b32 m0, s35
s_nop 0
buffer_load_dwordx4 v5, s[20:23], s33 offen offset:0 lds
buffer_load_dwordx4 v6, s[20:23], s33 offen offset:1024 lds
s_add_u32 s32, s32, 64
s_add_u32 s33, s33, 262144
s_add_u32 s34, s34, 32768
s_and_b32 s34, s34, 131071
s_add_u32 s35, s35, 32768
s_and_b32 s35, s35, 131071
s_mov_b32 m0, s34
s_nop 0
buffer_load_dwordx4 v1, s[12:15], s32 offen offset:0 lds
buffer_load_dwordx4 v2, s[12:15], s32 offen offset:1024 lds
buffer_load_dwordx4 v3, s[12:15], s32 offen offset:2048 lds
buffer_load_dwordx4 v4, s[12:15], s32 offen offset:3072 lds
s_mov_b32 m0, s35
s_nop 0
buffer_load_dwordx4 v5, s[20:23], s33 offen offset:0 lds
buffer_load_dwordx4 v6, s[20:23], s33 offen offset:1024 lds
s_add_u32 s32, s32, 64
s_add_u32 s33, s33, 262144
s_add_u32 s34, s34, 32768
s_and_b32 s34, s34, 131071
s_add_u32 s35, s35, 32768
s_and_b32 s35, s35, 131071
s_mov_b32 m0, s34
s_nop 0
buffer_load_dwordx4 v1, s[12:15], s32 offen offset:0 lds
buffer_load_dwordx4 v2, s[12:15], s32 offen offset:1024 lds
buffer_load_dwordx4 v3, s[12:15], s32 offen offset:2048 lds
buffer_load_dwordx4 v4, s[12:15], s32 offen offset:3072 lds
s_mov_b32 m0, s35
s_nop 0
buffer_load_dwordx4 v5, s[20:23], s33 offen offset:0 lds
buffer_load_dwordx4 v6, s[20:23], s33 offen offset:1024 lds
s_add_u32 s32, s32, 64
s_add_u32 s33, s33, 262144
s_add_u32 s34, s34, 32768
s_and_b32 s34, s34, 131071
s_add_u32 s35, s35, 32768
s_and_b32 s35, s35, 131071
v_and_b32 v15, 31, v0
v_lshlrev_b32 v15, 6, v15
v_bfe_u32 v16, v0, 2, 2
v_bfe_u32 v17, v0, 5, 1
v_xor_b32 v16, v16, v17
v_lshl_add_u32 v15, v16, 4, v15
s_lshl_b32 s24, s17, 12
v_add_u32 v9, s24, v15
v_xor_b32 v10, 32, v9
v_bfe_u32 v16, v0, 2, 2
v_mul_u32_u24 v15, 320, v16
v_lshl_add_u32 v15, v17, 11, v15
v_bfe_u32 v16, v0, 4, 1
v_lshl_add_u32 v15, v16, 5, v15
v_and_b32 v16, 3, v0
v_lshl_add_u32 v15, v16, 3, v15
s_mov_b32 s24, 16384
v_add_u32 v11, s24, v15
v_xor_b32 v12, 64, v11
v_xor_b32 v13, 128, v11
v_xor_b32 v14, 192, v11
v_mov_b32 v128, 0
v_mov_b32 v129, 0
v_mov_b32 v130, 0
v_mov_b32 v131, 0
v_mov_b32 v132, 0
v_mov_b32 v133, 0
v_mov_b32 v134, 0
v_mov_b32 v135, 0
v_mov_b32 v136, 0
v_mov_b32 v137, 0
v_mov_b32 v138, 0
v_mov_b32 v139, 0
v_mov_b32 v140, 0
v_mov_b32 v141, 0
v_mov_b32 v142, 0
v_mov_b32 v143, 0
v_mov_b32 v144, 0
v_mov_b32 v145, 0
v_mov_b32 v146, 0
v_mov_b32 v147, 0
v_mov_b32 v148, 0
v_mov_b32 v149, 0
v_mov_b32 v150, 0
v_mov_b32 v151, 0
v_mov_b32 v152, 0
v_mov_b32 v153, 0
v_mov_b32 v154, 0
v_mov_b32 v155, 0
v_mov_b32 v156, 0
v_mov_b32 v157, 0
v_mov_b32 v158, 0
v_mov_b32 v159, 0
v_mov_b32 v160, 0
v_mov_b32 v161, 0
v_mov_b32 v162, 0
v_mov_b32 v163, 0
v_mov_b32 v164, 0
v_mov_b32 v165, 0
v_mov_b32 v166, 0
v_mov_b32 v167, 0
v_mov_b32 v168, 0
v_mov_b32 v169, 0
v_mov_b32 v170, 0
v_mov_b32 v171, 0
v_mov_b32 v172, 0
v_mov_b32 v173, 0
v_mov_b32 v174, 0
v_mov_b32 v175, 0
v_mov_b32 v176, 0
v_mov_b32 v177, 0
v_mov_b32 v178, 0
v_mov_b32 v179, 0
v_mov_b32 v180, 0
v_mov_b32 v181, 0
v_mov_b32 v182, 0
v_mov_b32 v183, 0
v_mov_b32 v184, 0
v_mov_b32 v185, 0
v_mov_b32 v186, 0
v_mov_b32 v187, 0
v_mov_b32 v188, 0
v_mov_b32 v189, 0
v_mov_b32 v190, 0
v_mov_b32 v191, 0
v_mov_b32 v192, 0
v_mov_b32 v193, 0
v_mov_b32 v194, 0
v_mov_b32 v195, 0
v_mov_b32 v196, 0
v_mov_b32 v197, 0
v_mov_b32 v198, 0
v_mov_b32 v199, 0
v_mov_b32 v200, 0
v_mov_b32 v201, 0
v_mov_b32 v202, 0
v_mov_b32 v203, 0
v_mov_b32 v204, 0
v_mov_b32 v205, 0
v_mov_b32 v206, 0
v_mov_b32 v207, 0
v_mov_b32 v208, 0
v_mov_b32 v209, 0
v_mov_b32 v210, 0
v_mov_b32 v211, 0
v_mov_b32 v212, 0
v_mov_b32 v213, 0
v_mov_b32 v214, 0
v_mov_b32 v215, 0
v_mov_b32 v216, 0
v_mov_b32 v217, 0
v_mov_b32 v218, 0
v_mov_b32 v219, 0
v_mov_b32 v220, 0
v_mov_b32 v221, 0
v_mov_b32 v222, 0
v_mov_b32 v223, 0
v_mov_b32 v224, 0
v_mov_b32 v225, 0
v_mov_b32 v226, 0
v_mov_b32 v227, 0
v_mov_b32 v228, 0
v_mov_b32 v229, 0
v_mov_b32 v230, 0
v_mov_b32 v231, 0
v_mov_b32 v232, 0
v_mov_b32 v233, 0
v_mov_b32 v234, 0
v_mov_b32 v235, 0
v_mov_b32 v236, 0
v_mov_b32 v237, 0
v_mov_b32 v238, 0
v_mov_b32 v239, 0
v_mov_b32 v240, 0
v_mov_b32 v241, 0
v_mov_b32 v242, 0
v_mov_b32 v243, 0
v_mov_b32 v244, 0
v_mov_b32 v245, 0
v_mov_b32 v246, 0
v_mov_b32 v247, 0
v_mov_b32 v248, 0
v_mov_b32 v249, 0
v_mov_b32 v250, 0
v_mov_b32 v251, 0
v_mov_b32 v252, 0
v_mov_b32 v253, 0
v_mov_b32 v254, 0
v_mov_b32 v255, 0
s_waitcnt vmcnt(18)
s_barrier
ds_read_b64_tr_b16 a[72:73], v11 offset:0
ds_read_b64_tr_b16 a[74:75], v11 offset:1024
ds_read_b128 a[64:67], v9 offset:0
ds_read_b128 a[68:71], v9 offset:2048
ds_read_b64_tr_b16 a[76:77], v12 offset:0
ds_read_b64_tr_b16 a[78:79], v12 offset:1024
ds_read_b64_tr_b16 a[80:81], v13 offset:0
ds_read_b64_tr_b16 a[82:83], v13 offset:1024
ds_read_b64_tr_b16 a[84:85], v14 offset:0
ds_read_b64_tr_b16 a[86:87], v14 offset:1024
s_mov_b32 s30, 0
.p2align 3
L_gqb_q:
s_waitcnt lgkmcnt(0)
v_mfma_f32_32x32x16_bf16 v[128:143], a[72:75], a[64:67], v[128:143]
ds_read_b64_tr_b16 a[96:97], v11 offset:4096
ds_read_b64_tr_b16 a[98:99], v11 offset:5120
v_mfma_f32_32x32x16_bf16 v[144:159], a[72:75], a[68:71], v[144:159]
ds_read_b128 a[88:91], v10 offset:0
ds_read_b128 a[92:95], v10 offset:2048
v_mfma_f32_32x32x16_bf16 v[160:175], a[76:79], a[64:67], v[160:175]
ds_read_b64_tr_b16 a[100:101], v12 offset:4096
ds_read_b64_tr_b16 a[102:103], v12 offset:5120
v_mfma_f32_32x32x16_bf16 v[176:191], a[76:79], a[68:71], v[176:191]
ds_read_b64_tr_b16 a[104:105], v13 offset:4096
ds_read_b64_tr_b16 a[106:107], v13 offset:5120
v_mfma_f32_32x32x16_bf16 v[192:207], a[80:83], a[64:67], v[192:207]
ds_read_b64_tr_b16 a[108:109], v14 offset:4096
ds_read_b64_tr_b16 a[110:111], v14 offset:5120
v_mfma_f32_32x32x16_bf16 v[208:223], a[80:83], a[68:71], v[208:223]
v_add_u32 v9, 32768, v9
v_and_b32 v9, 131071, v9
v_add_u32 v10, 32768, v10
v_and_b32 v10, 131071, v10
v_mfma_f32_32x32x16_bf16 v[224:239], a[84:87], a[64:67], v[224:239]
v_add_u32 v11, 32768, v11
v_and_b32 v11, 131071, v11
v_add_u32 v12, 32768, v12
v_and_b32 v12, 131071, v12
v_mfma_f32_32x32x16_bf16 v[240:255], a[84:87], a[68:71], v[240:255]
s_add_u32 s25, s30, 4
s_cmp_lt_u32 s25, 18
s_cselect_b32 s32, s32, 536870912
v_add_u32 v13, 32768, v13
v_and_b32 v13, 131071, v13
v_add_u32 v14, 32768, v14
v_and_b32 v14, 131071, v14
s_waitcnt vmcnt(12) lgkmcnt(0)
s_barrier
v_mfma_f32_32x32x16_bf16 v[128:143], a[96:99], a[88:91], v[128:143]
ds_read_b64_tr_b16 a[72:73], v11 offset:0
ds_read_b64_tr_b16 a[74:75], v11 offset:1024
s_mov_b32 m0, s34
v_mfma_f32_32x32x16_bf16 v[144:159], a[96:99], a[92:95], v[144:159]
ds_read_b128 a[64:67], v9 offset:0
ds_read_b128 a[68:71], v9 offset:2048
buffer_load_dwordx4 v1, s[12:15], s32 offen offset:0 lds
v_mfma_f32_32x32x16_bf16 v[160:175], a[100:103], a[88:91], v[160:175]
ds_read_b64_tr_b16 a[76:77], v12 offset:0
ds_read_b64_tr_b16 a[78:79], v12 offset:1024
buffer_load_dwordx4 v2, s[12:15], s32 offen offset:1024 lds
v_mfma_f32_32x32x16_bf16 v[176:191], a[100:103], a[92:95], v[176:191]
ds_read_b64_tr_b16 a[80:81], v13 offset:0
ds_read_b64_tr_b16 a[82:83], v13 offset:1024
buffer_load_dwordx4 v3, s[12:15], s32 offen offset:2048 lds
v_mfma_f32_32x32x16_bf16 v[192:207], a[104:107], a[88:91], v[192:207]
ds_read_b64_tr_b16 a[84:85], v14 offset:0
ds_read_b64_tr_b16 a[86:87], v14 offset:1024
buffer_load_dwordx4 v4, s[12:15], s32 offen offset:3072 lds
s_mov_b32 m0, s35
v_mfma_f32_32x32x16_bf16 v[208:223], a[104:107], a[92:95], v[208:223]
buffer_load_dwordx4 v5, s[20:23], s33 offen offset:0 lds
v_mfma_f32_32x32x16_bf16 v[224:239], a[108:111], a[88:91], v[224:239]
buffer_load_dwordx4 v6, s[20:23], s33 offen offset:1024 lds
v_mfma_f32_32x32x16_bf16 v[240:255], a[108:111], a[92:95], v[240:255]
s_add_u32 s32, s32, 64
s_add_u32 s33, s33, 262144
s_add_u32 s34, s34, 32768
s_and_b32 s34, s34, 131071
s_add_u32 s35, s35, 32768
s_and_b32 s35, s35, 131071
s_add_u32 s30, s30, 1
s_cmp_lt_u32 s30, 18
s_cbranch_scc1 L_gqb_q
L_gqb_end:
s_waitcnt vmcnt(0) lgkmcnt(0)
v_cvt_pk_bf16_f32 v128, v128, v129
v_cvt_pk_bf16_f32 v130, v130, v131
v_cvt_pk_bf16_f32 v132, v132, v133
v_cvt_pk_bf16_f32 v134, v134, v135
v_cvt_pk_bf16_f32 v136, v136, v137
v_cvt_pk_bf16_f32 v138, v138, v139
v_cvt_pk_bf16_f32 v140, v140, v141
v_cvt_pk_bf16_f32 v142, v142, v143
v_accvgpr_write_b32 a0, v128
v_accvgpr_write_b32 a1, v130
v_accvgpr_write_b32 a2, v132
v_accvgpr_write_b32 a3, v134
v_accvgpr_write_b32 a4, v136
v_accvgpr_write_b32 a5, v138
v_accvgpr_write_b32 a6, v140
v_accvgpr_write_b32 a7, v142
v_cvt_pk_bf16_f32 v160, v160, v161
v_cvt_pk_bf16_f32 v162, v162, v163
v_cvt_pk_bf16_f32 v164, v164, v165
v_cvt_pk_bf16_f32 v166, v166, v167
v_cvt_pk_bf16_f32 v168, v168, v169
v_cvt_pk_bf16_f32 v170, v170, v171
v_cvt_pk_bf16_f32 v172, v172, v173
v_cvt_pk_bf16_f32 v174, v174, v175
v_accvgpr_write_b32 a8, v160
v_accvgpr_write_b32 a9, v162
v_accvgpr_write_b32 a10, v164
v_accvgpr_write_b32 a11, v166
v_accvgpr_write_b32 a12, v168
v_accvgpr_write_b32 a13, v170
v_accvgpr_write_b32 a14, v172
v_accvgpr_write_b32 a15, v174
v_cvt_pk_bf16_f32 v192, v192, v193
v_cvt_pk_bf16_f32 v194, v194, v195
v_cvt_pk_bf16_f32 v196, v196, v197
v_cvt_pk_bf16_f32 v198, v198, v199
v_cvt_pk_bf16_f32 v200, v200, v201
v_cvt_pk_bf16_f32 v202, v202, v203
v_cvt_pk_bf16_f32 v204, v204, v205
v_cvt_pk_bf16_f32 v206, v206, v207
v_accvgpr_write_b32 a16, v192
v_accvgpr_write_b32 a17, v194
v_accvgpr_write_b32 a18, v196
v_accvgpr_write_b32 a19, v198
v_accvgpr_write_b32 a20, v200
v_accvgpr_write_b32 a21, v202
v_accvgpr_write_b32 a22, v204
v_accvgpr_write_b32 a23, v206
v_cvt_pk_bf16_f32 v224, v224, v225
v_cvt_pk_bf16_f32 v226, v226, v227
v_cvt_pk_bf16_f32 v228, v228, v229
v_cvt_pk_bf16_f32 v230, v230, v231
v_cvt_pk_bf16_f32 v232, v232, v233
v_cvt_pk_bf16_f32 v234, v234, v235
v_cvt_pk_bf16_f32 v236, v236, v237
v_cvt_pk_bf16_f32 v238, v238, v239
v_accvgpr_write_b32 a24, v224
v_accvgpr_write_b32 a25, v226
v_accvgpr_write_b32 a26, v228
v_accvgpr_write_b32 a27, v230
v_accvgpr_write_b32 a28, v232
v_accvgpr_write_b32 a29, v234
v_accvgpr_write_b32 a30, v236
v_accvgpr_write_b32 a31, v238
v_cvt_pk_bf16_f32 v144, v144, v145
v_cvt_pk_bf16_f32 v146, v146, v147
v_cvt_pk_bf16_f32 v148, v148, v149
v_cvt_pk_bf16_f32 v150, v150, v151
v_cvt_pk_bf16_f32 v152, v152, v153
v_cvt_pk_bf16_f32 v154, v154, v155
v_cvt_pk_bf16_f32 v156, v156, v157
v_cvt_pk_bf16_f32 v158, v158, v159
v_accvgpr_write_b32 a32, v144
v_accvgpr_write_b32 a33, v146
v_accvgpr_write_b32 a34, v148
v_accvgpr_write_b32 a35, v150
v_accvgpr_write_b32 a36, v152
v_accvgpr_write_b32 a37, v154
v_accvgpr_write_b32 a38, v156
v_accvgpr_write_b32 a39, v158
v_cvt_pk_bf16_f32 v176, v176, v177
v_cvt_pk_bf16_f32 v178, v178, v179
v_cvt_pk_bf16_f32 v180, v180, v181
v_cvt_pk_bf16_f32 v182, v182, v183
v_cvt_pk_bf16_f32 v184, v184, v185
v_cvt_pk_bf16_f32 v186, v186, v187
v_cvt_pk_bf16_f32 v188, v188, v189
v_cvt_pk_bf16_f32 v190, v190, v191
v_accvgpr_write_b32 a40, v176
v_accvgpr_write_b32 a41, v178
v_accvgpr_write_b32 a42, v180
v_accvgpr_write_b32 a43, v182
v_accvgpr_write_b32 a44, v184
v_accvgpr_write_b32 a45, v186
v_accvgpr_write_b32 a46, v188
v_accvgpr_write_b32 a47, v190
v_cvt_pk_bf16_f32 v208, v208, v209
v_cvt_pk_bf16_f32 v210, v210, v211
v_cvt_pk_bf16_f32 v212, v212, v213
v_cvt_pk_bf16_f32 v214, v214, v215
v_cvt_pk_bf16_f32 v216, v216, v217
v_cvt_pk_bf16_f32 v218, v218, v219
v_cvt_pk_bf16_f32 v220, v220, v221
v_cvt_pk_bf16_f32 v222, v222, v223
v_accvgpr_write_b32 a48, v208
v_accvgpr_write_b32 a49, v210
v_accvgpr_write_b32 a50, v212
v_accvgpr_write_b32 a51, v214
v_accvgpr_write_b32 a52, v216
v_accvgpr_write_b32 a53, v218
v_accvgpr_write_b32 a54, v220
v_accvgpr_write_b32 a55, v222
v_cvt_pk_bf16_f32 v240, v240, v241
v_cvt_pk_bf16_f32 v242, v242, v243
v_cvt_pk_bf16_f32 v244, v244, v245
v_cvt_pk_bf16_f32 v246, v246, v247
v_cvt_pk_bf16_f32 v248, v248, v249
v_cvt_pk_bf16_f32 v250, v250, v251
v_cvt_pk_bf16_f32 v252, v252, v253
v_cvt_pk_bf16_f32 v254, v254, v255
v_accvgpr_write_b32 a56, v240
v_accvgpr_write_b32 a57, v242
v_accvgpr_write_b32 a58, v244
v_accvgpr_write_b32 a59, v246
v_accvgpr_write_b32 a60, v248
v_accvgpr_write_b32 a61, v250
v_accvgpr_write_b32 a62, v252
v_accvgpr_write_b32 a63, v254
v_mov_b32 v20, 128
s_mov_b32 s28, 0
L_poll_14:
buffer_load_dword v21, v20, s[56:59], 0 offen sc1
s_add_u32 s28, s28, 1
s_cmp_gt_u32 s28, 40000
s_cbranch_scc1 L_end
s_waitcnt vmcnt(0)
v_cmp_ne_u32 vcc, 8, v21
s_cbranch_vccz L_pd_15
s_sleep 1
s_branch L_poll_14
L_pd_15:
v_mov_b32 v20, 0
s_lshl_b32 s25, s42, 7
s_add_u32 s25, s25, 111149056
s_mov_b32 s28, 0
L_poll_16:
buffer_load_dword v21, v20, s[8:11], s25 offen sc1
s_add_u32 s28, s28, 1
s_cmp_gt_u32 s28, 40000
s_cbranch_scc1 L_end
s_waitcnt vmcnt(0)
v_cmp_ge_u32 vcc, s41, v21
s_cbranch_vccz L_pd_17
s_sleep 1
s_branch L_poll_16
L_pd_17:
v_and_b32 v5, 31, v0
v_bfe_u32 v26, v0, 5, 1
v_lshlrev_b32 v27, 2, v26
v_sub_u32 v5, v5, v27
v_bfe_u32 v27, v0, 4, 1
v_lshlrev_b32 v6, 17, v27
v_lshl_add_u32 v6, v26, 8, v6
v_and_b32 v27, 15, v0
v_lshl_add_u32 v6, v27, 4, v6
v_and_b32 v1, 63, v0
v_lshlrev_b32 v1, 4, v1
v_bfe_u32 v26, v0, 5, 1
v_and_b32 v27, 7, v0
v_xor_b32 v27, v27, v26
v_lshlrev_b32 v27, 4, v27
v_lshl_add_u32 v2, v26, 7, v27
v_xor_b32 v7, 64, v2
v_and_b32 v27, 31, v0
v_lshlrev_b32 v27, 2, v27
v_lshl_add_u32 v3, v26, 8, v27
v_mov_b32 v4, 0
s_lshl_b32 s43, s41, 3
s_lshl_b32 s24, s17, 1
s_add_u32 s43, s43, s24
s_lshl_b32 s46, s42, 6
s_add_u32 s46, s46, s43
s_lshl_b32 s46, s46, 14
s_add_u32 s46, s46, 33554432
s_add_u32 s24, s46, 0
buffer_load_dwordx4 a[64:67], v1, s[8:11], s24 offen offset:0 sc1
buffer_load_dwordx4 a[68:71], v1, s[8:11], s24 offen offset:1024 sc1
buffer_load_dwordx4 a[72:75], v1, s[8:11], s24 offen offset:2048 sc1
buffer_load_dwordx4 a[76:79], v1, s[8:11], s24 offen offset:3072 sc1
s_add_u32 s24, s46, 4096
buffer_load_dwordx4 a[80:83], v1, s[8:11], s24 offen offset:0 sc1
buffer_load_dwordx4 a[84:87], v1, s[8:11], s24 offen offset:1024 sc1
buffer_load_dwordx4 a[88:91], v1, s[8:11], s24 offen offset:2048 sc1
buffer_load_dwordx4 a[92:95], v1, s[8:11], s24 offen offset:3072 sc1
s_add_u32 s24, s46, 8192
buffer_load_dwordx4 a[128:131], v1, s[8:11], s24 offen offset:0 sc1
buffer_load_dwordx4 a[132:135], v1, s[8:11], s24 offen offset:1024 sc1
buffer_load_dwordx4 a[136:139], v1, s[8:11], s24 offen offset:2048 sc1
buffer_load_dwordx4 a[140:143], v1, s[8:11], s24 offen offset:3072 sc1
s_add_u32 s24, s46, 12288
buffer_load_dwordx4 a[144:147], v1, s[8:11], s24 offen offset:0 sc1
buffer_load_dwordx4 a[148:151], v1, s[8:11], s24 offen offset:1024 sc1
buffer_load_dwordx4 a[152:155], v1, s[8:11], s24 offen offset:2048 sc1
buffer_load_dwordx4 a[156:159], v1, s[8:11], s24 offen offset:3072 sc1
s_add_u32 s24, s46, 16384
buffer_load_dwordx4 a[96:99], v1, s[8:11], s24 offen offset:0 sc1
buffer_load_dwordx4 a[100:103], v1, s[8:11], s24 offen offset:1024 sc1
buffer_load_dwordx4 a[104:107], v1, s[8:11], s24 offen offset:2048 sc1
buffer_load_dwordx4 a[108:111], v1, s[8:11], s24 offen offset:3072 sc1
s_add_u32 s24, s46, 20480
buffer_load_dwordx4 a[112:115], v1, s[8:11], s24 offen offset:0 sc1
buffer_load_dwordx4 a[116:119], v1, s[8:11], s24 offen offset:1024 sc1
buffer_load_dwordx4 a[120:123], v1, s[8:11], s24 offen offset:2048 sc1
buffer_load_dwordx4 a[124:127], v1, s[8:11], s24 offen offset:3072 sc1
s_add_u32 s24, s46, 24576
buffer_load_dwordx4 a[160:163], v1, s[8:11], s24 offen offset:0 sc1
buffer_load_dwordx4 a[164:167], v1, s[8:11], s24 offen offset:1024 sc1
buffer_load_dwordx4 a[168:171], v1, s[8:11], s24 offen offset:2048 sc1
buffer_load_dwordx4 a[172:175], v1, s[8:11], s24 offen offset:3072 sc1
s_add_u32 s24, s46, 28672
buffer_load_dwordx4 a[176:179], v1, s[8:11], s24 offen offset:0 sc1
buffer_load_dwordx4 a[180:183], v1, s[8:11], s24 offen offset:1024 sc1
buffer_load_dwordx4 a[184:187], v1, s[8:11], s24 offen offset:2048 sc1
buffer_load_dwordx4 a[188:191], v1, s[8:11], s24 offen offset:3072 sc1
s_waitcnt vmcnt(0)
v_mfma_f32_32x32x16_bf16 v[32:47], a[64:67], a[0:3], 0
v_mfma_f32_32x32x16_bf16 v[32:47], a[68:71], a[4:7], v[32:47]
v_mfma_f32_32x32x16_bf16 v[32:47], a[72:75], a[8:11], v[32:47]
v_mfma_f32_32x32x16_bf16 v[32:47], a[76:79], a[12:15], v[32:47]
v_mfma_f32_32x32x16_bf16 v[32:47], a[80:83], a[16:19], v[32:47]
v_mfma_f32_32x32x16_bf16 v[32:47], a[84:87], a[20:23], v[32:47]
v_mfma_f32_32x32x16_bf16 v[32:47], a[88:91], a[24:27], v[32:47]
v_mfma_f32_32x32x16_bf16 v[32:47], a[92:95], a[28:31], v[32:47]
v_mfma_f32_32x32x16_bf16 v[48:63], a[96:99], a[32:35], 0
v_mfma_f32_32x32x16_bf16 v[48:63], a[100:103], a[36:39], v[48:63]
v_mfma_f32_32x32x16_bf16 v[48:63], a[104:107], a[40:43], v[48:63]
v_mfma_f32_32x32x16_bf16 v[48:63], a[108:111], a[44:47], v[48:63]
v_mfma_f32_32x32x16_bf16 v[48:63], a[112:115], a[48:51], v[48:63]
v_mfma_f32_32x32x16_bf16 v[48:63], a[116:119], a[52:55], v[48:63]
v_mfma_f32_32x32x16_bf16 v[48:63], a[120:123], a[56:59], v[48:63]
v_mfma_f32_32x32x16_bf16 v[48:63], a[124:127], a[60:63], v[48:63]
v_mov_b32 v31, s50
v_cmp_le_i32 vcc, 0, v5
s_nop 1
v_cndmask_b32 v32, v31, v32, vcc
v_cmp_le_i32 vcc, 1, v5
s_nop 1
v_cndmask_b32 v33, v31, v33, vcc
v_cmp_le_i32 vcc, 2, v5
s_nop 1
v_cndmask_b32 v34, v31, v34, vcc
v_cmp_le_i32 vcc, 3, v5
s_nop 1
v_cndmask_b32 v35, v31, v35, vcc
v_cmp_le_i32 vcc, 8, v5
s_nop 1
v_cndmask_b32 v36, v31, v36, vcc
v_cmp_le_i32 vcc, 9, v5
s_nop 1
v_cndmask_b32 v37, v31, v37, vcc
v_cmp_le_i32 vcc, 10, v5
s_nop 1
v_cndmask_b32 v38, v31, v38, vcc
v_cmp_le_i32 vcc, 11, v5
s_nop 1
v_cndmask_b32 v39, v31, v39, vcc
v_cmp_le_i32 vcc, 16, v5
s_nop 1
v_cndmask_b32 v40, v31, v40, vcc
v_cmp_le_i32 vcc, 17, v5
s_nop 1
v_cndmask_b32 v41, v31, v41, vcc
v_cmp_le_i32 vcc, 18, v5
s_nop 1
v_cndmask_b32 v42, v31, v42, vcc
v_cmp_le_i32 vcc, 19, v5
s_nop 1
v_cndmask_b32 v43, v31, v43, vcc
v_cmp_le_i32 vcc, 24, v5
s_nop 1
v_cndmask_b32 v44, v31, v44, vcc
v_cmp_le_i32 vcc, 25, v5
s_nop 1
v_cndmask_b32 v45, v31, v45, vcc
v_cmp_le_i32 vcc, 26, v5
s_nop 1
v_cndmask_b32 v46, v31, v46, vcc
v_cmp_le_i32 vcc, 27, v5
s_nop 1
v_cndmask_b32 v47, v31, v47, vcc
v_max3_f32 v20, v32, v33, v34
v_max3_f32 v20, v20, v35, v36
v_max3_f32 v20, v20, v37, v38
v_max3_f32 v20, v20, v39, v40
v_max3_f32 v20, v20, v41, v42
v_max3_f32 v20, v20, v43, v44
v_max3_f32 v20, v20, v45, v46
v_max_f32 v20, v20, v47
v_mov_b32 v31, s50
v_cmp_le_i32 vcc, 0, v5
s_nop 1
v_cndmask_b32 v48, v31, v48, vcc
v_cmp_le_i32 vcc, 1, v5
s_nop 1
v_cndmask_b32 v49, v31, v49, vcc
v_cmp_le_i32 vcc, 2, v5
s_nop 1
v_cndmask_b32 v50, v31, v50, vcc
v_cmp_le_i32 vcc, 3, v5
s_nop 1
v_cndmask_b32 v51, v31, v51, vcc
v_cmp_le_i32 vcc, 8, v5
s_nop 1
v_cndmask_b32 v52, v31, v52, vcc
v_cmp_le_i32 vcc, 9, v5
s_nop 1
v_cndmask_b32 v53, v31, v53, vcc
v_cmp_le_i32 vcc, 10, v5
s_nop 1
v_cndmask_b32 v54, v31, v54, vcc
v_cmp_le_i32 vcc, 11, v5
s_nop 1
v_cndmask_b32 v55, v31, v55, vcc
v_cmp_le_i32 vcc, 16, v5
s_nop 1
v_cndmask_b32 v56, v31, v56, vcc
v_cmp_le_i32 vcc, 17, v5
s_nop 1
v_cndmask_b32 v57, v31, v57, vcc
v_cmp_le_i32 vcc, 18, v5
s_nop 1
v_cndmask_b32 v58, v31, v58, vcc
v_cmp_le_i32 vcc, 19, v5
s_nop 1
v_cndmask_b32 v59, v31, v59, vcc
v_cmp_le_i32 vcc, 24, v5
s_nop 1
v_cndmask_b32 v60, v31, v60, vcc
v_cmp_le_i32 vcc, 25, v5
s_nop 1
v_cndmask_b32 v61, v31, v61, vcc
v_cmp_le_i32 vcc, 26, v5
s_nop 1
v_cndmask_b32 v62, v31, v62, vcc
v_cmp_le_i32 vcc, 27, v5
s_nop 1
v_cndmask_b32 v63, v31, v63, vcc
v_max3_f32 v21, v48, v49, v50
v_max3_f32 v21, v21, v51, v52
v_max3_f32 v21, v21, v53, v54
v_max3_f32 v21, v21, v55, v56
v_max3_f32 v21, v21, v57, v58
v_max3_f32 v21, v21, v59, v60
v_max3_f32 v21, v21, v61, v62
v_max_f32 v21, v21, v63
s_lshl_b32 s25, s42, 7
s_add_u32 s25, s25, 111153152
s_mov_b32 s28, 0
L_poll_18:
buffer_load_dword v26, v4, s[8:11], s25 offen sc1
s_add_u32 s28, s28, 1
s_cmp_gt_u32 s28, 40000
s_cbranch_scc1 L_end
s_waitcnt vmcnt(0)
v_cmp_ge_u32 vcc, s43, v26
s_cbranch_vccz L_pd_19
s_sleep 1
s_branch L_poll_18
L_pd_19:
s_lshl_b32 s24, s43, 5
s_add_u32 s24, s24, s42
s_lshl_b32 s24, s24, 12
s_add_u32 s24, s24, 100663296
buffer_load_dwordx4 v[96:99], v2, s[8:11], s24 offen offset:0 sc1
buffer_load_dwordx4 v[100:103], v7, s[8:11], s24 offen offset:256 sc1
buffer_load_dwordx4 v[104:107], v2, s[8:11], s24 offen offset:512 sc1
buffer_load_dwordx4 v[108:111], v7, s[8:11], s24 offen offset:768 sc1
buffer_load_dwordx4 v[112:115], v2, s[8:11], s24 offen offset:1024 sc1
buffer_load_dwordx4 v[116:119], v7, s[8:11], s24 offen offset:1280 sc1
buffer_load_dwordx4 v[120:123], v2, s[8:11], s24 offen offset:1536 sc1
buffer_load_dwordx4 v[124:127], v7, s[8:11], s24 offen offset:1792 sc1
buffer_load_dword v8, v3, s[8:11], s24 offen offset:2048 sc1
buffer_load_dword v9, v3, s[8:11], s24 offen offset:2176 sc1
buffer_load_dword v10, v3, s[8:11], s24 offen offset:2560 sc1
buffer_load_dword v11, v3, s[8:11], s24 offen offset:2688 sc1
buffer_load_dword v12, v3, s[8:11], s24 offen offset:3072 sc1
buffer_load_dword v13, v3, s[8:11], s24 offen offset:3200 sc1
buffer_load_dword v14, v3, s[8:11], s24 offen offset:3584 sc1
buffer_load_dword v15, v3, s[8:11], s24 offen offset:3712 sc1
s_waitcnt vmcnt(15)
v_mfma_f32_32x32x16_bf16 v[64:79], v[96:99], a[0:3], 0
s_waitcnt vmcnt(14)
v_mfma_f32_32x32x16_bf16 v[64:79], v[100:103], a[4:7], v[64:79]
s_waitcnt vmcnt(13)
v_mfma_f32_32x32x16_bf16 v[64:79], v[104:107], a[8:11], v[64:79]
s_waitcnt vmcnt(12)
v_mfma_f32_32x32x16_bf16 v[64:79], v[108:111], a[12:15], v[64:79]
s_waitcnt vmcnt(11)
v_mfma_f32_32x32x16_bf16 v[64:79], v[112:115], a[16:19], v[64:79]
s_waitcnt vmcnt(10)
v_mfma_f32_32x32x16_bf16 v[64:79], v[116:119], a[20:23], v[64:79]
s_waitcnt vmcnt(9)
v_mfma_f32_32x32x16_bf16 v[64:79], v[120:123], a[24:27], v[64:79]
s_waitcnt vmcnt(8)
v_mfma_f32_32x32x16_bf16 v[64:79], v[124:127], a[28:31], v[64:79]
s_nop 11
v_max3_f32 v20, v20, v64, v65
v_max3_f32 v20, v20, v66, v67
v_mov_b32 v26, v20
s_nop 1
v_permlane32_swap_b32 v26, v20
v_max_f32 v20, v20, v26
v_mul_f32 v20, s40, v20
v_fma_f32 v64, v64, s40, -v20
v_fma_f32 v65, v65, s40, -v20
v_fma_f32 v66, v66, s40, -v20
v_fma_f32 v67, v67, s40, -v20
v_fma_f32 v32, v32, s40, -v20
v_fma_f32 v33, v33, s40, -v20
v_fma_f32 v34, v34, s40, -v20
v_fma_f32 v35, v35, s40, -v20
v_fma_f32 v36, v36, s40, -v20
v_fma_f32 v37, v37, s40, -v20
v_fma_f32 v38, v38, s40, -v20
v_fma_f32 v39, v39, s40, -v20
v_fma_f32 v40, v40, s40, -v20
v_fma_f32 v41, v41, s40, -v20
v_fma_f32 v42, v42, s40, -v20
v_fma_f32 v43, v43, s40, -v20
v_fma_f32 v44, v44, s40, -v20
v_fma_f32 v45, v45, s40, -v20
v_fma_f32 v46, v46, s40, -v20
v_fma_f32 v47, v47, s40, -v20
v_exp_f32 v64, v64
v_exp_f32 v65, v65
v_exp_f32 v66, v66
v_exp_f32 v67, v67
v_exp_f32 v32, v32
v_exp_f32 v33, v33
v_exp_f32 v34, v34
v_exp_f32 v35, v35
v_exp_f32 v36, v36
v_exp_f32 v37, v37
v_exp_f32 v38, v38
v_exp_f32 v39, v39
v_exp_f32 v40, v40
v_exp_f32 v41, v41
v_exp_f32 v42, v42
v_exp_f32 v43, v43
v_exp_f32 v44, v44
v_exp_f32 v45, v45
v_exp_f32 v46, v46
v_exp_f32 v47, v47
v_cvt_pk_bf16_f32 v88, v64, v65
v_cvt_pk_bf16_f32 v89, v66, v67
v_cvt_pk_bf16_f32 v80, v32, v33
v_cvt_pk_bf16_f32 v81, v34, v35
v_cvt_pk_bf16_f32 v82, v36, v37
v_cvt_pk_bf16_f32 v83, v38, v39
v_cvt_pk_bf16_f32 v84, v40, v41
v_cvt_pk_bf16_f32 v85, v42, v43
v_cvt_pk_bf16_f32 v86, v44, v45
v_cvt_pk_bf16_f32 v87, v46, v47
s_waitcnt vmcnt(0)
v_mfma_f32_32x32x8_bf16 v[128:143], v[8:9], v[88:89], 0
v_add_f32 v22, v64, v65
v_add_f32 v22, v22, v66
v_mfma_f32_32x32x16_bf16 v[128:143], a[128:131], v[80:83], v[128:143]
v_add_f32 v22, v22, v67
v_mfma_f32_32x32x16_bf16 v[128:143], a[132:135], v[84:87], v[128:143]
v_add_f32 v22, v22, v32
v_add_f32 v22, v22, v33
v_mfma_f32_32x32x8_bf16 v[160:175], v[10:11], v[88:89], 0
v_add_f32 v22, v22, v34
v_mfma_f32_32x32x16_bf16 v[160:175], a[136:139], v[80:83], v[160:175]
v_add_f32 v22, v22, v35
v_add_f32 v22, v22, v36
v_mfma_f32_32x32x16_bf16 v[160:175], a[140:143], v[84:87], v[160:175]
v_add_f32 v22, v22, v37
v_add_f32 v22, v22, v38
v_mfma_f32_32x32x8_bf16 v[192:207], v[12:13], v[88:89], 0
v_add_f32 v22, v22, v39
v_mfma_f32_32x32x16_bf16 v[192:207], a[144:147], v[80:83], v[192:207]
v_add_f32 v22, v22, v40
v_add_f32 v22, v22, v41
v_mfma_f32_32x32x16_bf16 v[192:207], a[148:151], v[84:87], v[192:207]
v_add_f32 v22, v22, v42
v_mfma_f32_32x32x8_bf16 v[224:239], v[14:15], v[88:89], 0
v_add_f32 v22, v22, v43
v_add_f32 v22, v22, v44
v_mfma_f32_32x32x16_bf16 v[224:239], a[152:155], v[80:83], v[224:239]
v_add_f32 v22, v22, v45
v_mfma_f32_32x32x16_bf16 v[224:239], a[156:159], v[84:87], v[224:239]
v_add_f32 v22, v22, v46
v_add_f32 v22, v22, v47
s_lshl_b32 s26, s43, 18
s_lshl_b32 s27, s42, 12
s_add_u32 s26, s26, s27
s_add_u32 s26, s26, 83886080
v_mov_b32 v26, v22
s_nop 1
v_permlane32_swap_b32 v26, v22
v_add_f32 v26, v26, v22
v_rcp_f32 v26, v26
s_nop 0
v_pk_mul_f32 v[128:129], v[128:129], v[26:27] op_sel_hi:[1,0]
v_pk_mul_f32 v[130:131], v[130:131], v[26:27] op_sel_hi:[1,0]
v_pk_mul_f32 v[132:133], v[132:133], v[26:27] op_sel_hi:[1,0]
v_pk_mul_f32 v[134:135], v[134:135], v[26:27] op_sel_hi:[1,0]
v_pk_mul_f32 v[136:137], v[136:137], v[26:27] op_sel_hi:[1,0]
v_pk_mul_f32 v[138:139], v[138:139], v[26:27] op_sel_hi:[1,0]
v_pk_mul_f32 v[140:141], v[140:141], v[26:27] op_sel_hi:[1,0]
v_pk_mul_f32 v[142:143], v[142:143], v[26:27] op_sel_hi:[1,0]
v_cvt_pk_bf16_f32 v128, v128, v129
v_cvt_pk_bf16_f32 v129, v130, v131
v_cvt_pk_bf16_f32 v130, v132, v133
v_cvt_pk_bf16_f32 v131, v134, v135
buffer_store_dwordx4 v[128:131], v6, s[8:11], s26 offen offset:0 sc1
v_cvt_pk_bf16_f32 v136, v136, v137
v_cvt_pk_bf16_f32 v137, v138, v139
v_cvt_pk_bf16_f32 v138, v140, v141
v_cvt_pk_bf16_f32 v139, v142, v143
buffer_store_dwordx4 v[136:139], v6, s[8:11], s26 offen offset:512 sc1
v_pk_mul_f32 v[160:161], v[160:161], v[26:27] op_sel_hi:[1,0]
v_pk_mul_f32 v[162:163], v[162:163], v[26:27] op_sel_hi:[1,0]
v_pk_mul_f32 v[164:165], v[164:165], v[26:27] op_sel_hi:[1,0]
v_pk_mul_f32 v[166:167], v[166:167], v[26:27] op_sel_hi:[1,0]
v_pk_mul_f32 v[168:169], v[168:169], v[26:27] op_sel_hi:[1,0]
v_pk_mul_f32 v[170:171], v[170:171], v[26:27] op_sel_hi:[1,0]
v_pk_mul_f32 v[172:173], v[172:173], v[26:27] op_sel_hi:[1,0]
v_pk_mul_f32 v[174:175], v[174:175], v[26:27] op_sel_hi:[1,0]
v_cvt_pk_bf16_f32 v160, v160, v161
v_cvt_pk_bf16_f32 v161, v162, v163
v_cvt_pk_bf16_f32 v162, v164, v165
v_cvt_pk_bf16_f32 v163, v166, v167
buffer_store_dwordx4 v[160:163], v6, s[8:11], s26 offen offset:1024 sc1
v_cvt_pk_bf16_f32 v168, v168, v169
v_cvt_pk_bf16_f32 v169, v170, v171
v_cvt_pk_bf16_f32 v170, v172, v173
v_cvt_pk_bf16_f32 v171, v174, v175
buffer_store_dwordx4 v[168:171], v6, s[8:11], s26 offen offset:1536 sc1
v_pk_mul_f32 v[192:193], v[192:193], v[26:27] op_sel_hi:[1,0]
v_pk_mul_f32 v[194:195], v[194:195], v[26:27] op_sel_hi:[1,0]
v_pk_mul_f32 v[196:197], v[196:197], v[26:27] op_sel_hi:[1,0]
v_pk_mul_f32 v[198:199], v[198:199], v[26:27] op_sel_hi:[1,0]
v_pk_mul_f32 v[200:201], v[200:201], v[26:27] op_sel_hi:[1,0]
v_pk_mul_f32 v[202:203], v[202:203], v[26:27] op_sel_hi:[1,0]
v_pk_mul_f32 v[204:205], v[204:205], v[26:27] op_sel_hi:[1,0]
v_pk_mul_f32 v[206:207], v[206:207], v[26:27] op_sel_hi:[1,0]
v_cvt_pk_bf16_f32 v192, v192, v193
v_cvt_pk_bf16_f32 v193, v194, v195
v_cvt_pk_bf16_f32 v194, v196, v197
v_cvt_pk_bf16_f32 v195, v198, v199
buffer_store_dwordx4 v[192:195], v6, s[8:11], s26 offen offset:2048 sc1
v_cvt_pk_bf16_f32 v200, v200, v201
v_cvt_pk_bf16_f32 v201, v202, v203
v_cvt_pk_bf16_f32 v202, v204, v205
v_cvt_pk_bf16_f32 v203, v206, v207
buffer_store_dwordx4 v[200:203], v6, s[8:11], s26 offen offset:2560 sc1
v_pk_mul_f32 v[224:225], v[224:225], v[26:27] op_sel_hi:[1,0]
v_pk_mul_f32 v[226:227], v[226:227], v[26:27] op_sel_hi:[1,0]
v_pk_mul_f32 v[228:229], v[228:229], v[26:27] op_sel_hi:[1,0]
v_pk_mul_f32 v[230:231], v[230:231], v[26:27] op_sel_hi:[1,0]
v_pk_mul_f32 v[232:233], v[232:233], v[26:27] op_sel_hi:[1,0]
v_pk_mul_f32 v[234:235], v[234:235], v[26:27] op_sel_hi:[1,0]
v_pk_mul_f32 v[236:237], v[236:237], v[26:27] op_sel_hi:[1,0]
v_pk_mul_f32 v[238:239], v[238:239], v[26:27] op_sel_hi:[1,0]
v_cvt_pk_bf16_f32 v224, v224, v225
v_cvt_pk_bf16_f32 v225, v226, v227
v_cvt_pk_bf16_f32 v226, v228, v229
v_cvt_pk_bf16_f32 v227, v230, v231
buffer_store_dwordx4 v[224:227], v6, s[8:11], s26 offen offset:3072 sc1
v_cvt_pk_bf16_f32 v232, v232, v233
v_cvt_pk_bf16_f32 v233, v234, v235
v_cvt_pk_bf16_f32 v234, v236, v237
v_cvt_pk_bf16_f32 v235, v238, v239
buffer_store_dwordx4 v[232:235], v6, s[8:11], s26 offen offset:3584 sc1
s_lshl_b32 s26, s43, 7
s_lshl_b32 s27, s42, 2
s_add_u32 s26, s26, s27
s_add_u32 s26, s26, 111157248
v_mov_b32 v26, 1
s_waitcnt vmcnt(0)
s_mov_b64 exec, 1
buffer_store_dword v26, v4, s[8:11], s26 offen sc1
s_mov_b64 exec, -1
s_add_u32 s43, s43, 1
s_lshl_b32 s25, s42, 7
s_add_u32 s25, s25, 111153152
s_mov_b32 s28, 0
L_poll_20:
buffer_load_dword v26, v4, s[8:11], s25 offen sc1
s_add_u32 s28, s28, 1
s_cmp_gt_u32 s28, 40000
s_cbranch_scc1 L_end
s_waitcnt vmcnt(0)
v_cmp_ge_u32 vcc, s43, v26
s_cbranch_vccz L_pd_21
s_sleep 1
s_branch L_poll_20
L_pd_21:
s_lshl_b32 s24, s43, 5
s_add_u32 s24, s24, s42
s_lshl_b32 s24, s24, 12
s_add_u32 s24, s24, 100663296
buffer_load_dwordx4 v[96:99], v2, s[8:11], s24 offen offset:0 sc1
buffer_load_dwordx4 v[100:103], v7, s[8:11], s24 offen offset:256 sc1
buffer_load_dwordx4 v[104:107], v2, s[8:11], s24 offen offset:512 sc1
buffer_load_dwordx4 v[108:111], v7, s[8:11], s24 offen offset:768 sc1
buffer_load_dwordx4 v[112:115], v2, s[8:11], s24 offen offset:1024 sc1
buffer_load_dwordx4 v[116:119], v7, s[8:11], s24 offen offset:1280 sc1
buffer_load_dwordx4 v[120:123], v2, s[8:11], s24 offen offset:1536 sc1
buffer_load_dwordx4 v[124:127], v7, s[8:11], s24 offen offset:1792 sc1
buffer_load_dword v8, v3, s[8:11], s24 offen offset:2048 sc1
buffer_load_dword v9, v3, s[8:11], s24 offen offset:2176 sc1
buffer_load_dword v10, v3, s[8:11], s24 offen offset:2560 sc1
buffer_load_dword v11, v3, s[8:11], s24 offen offset:2688 sc1
buffer_load_dword v12, v3, s[8:11], s24 offen offset:3072 sc1
buffer_load_dword v13, v3, s[8:11], s24 offen offset:3200 sc1
buffer_load_dword v14, v3, s[8:11], s24 offen offset:3584 sc1
buffer_load_dword v15, v3, s[8:11], s24 offen offset:3712 sc1
s_waitcnt vmcnt(15)
v_mfma_f32_32x32x16_bf16 v[64:79], v[96:99], a[32:35], 0
s_waitcnt vmcnt(14)
v_mfma_f32_32x32x16_bf16 v[64:79], v[100:103], a[36:39], v[64:79]
s_waitcnt vmcnt(13)
v_mfma_f32_32x32x16_bf16 v[64:79], v[104:107], a[40:43], v[64:79]
s_waitcnt vmcnt(12)
v_mfma_f32_32x32x16_bf16 v[64:79], v[108:111], a[44:47], v[64:79]
s_waitcnt vmcnt(11)
v_mfma_f32_32x32x16_bf16 v[64:79], v[112:115], a[48:51], v[64:79]
s_waitcnt vmcnt(10)
v_mfma_f32_32x32x16_bf16 v[64:79], v[116:119], a[52:55], v[64:79]
s_waitcnt vmcnt(9)
v_mfma_f32_32x32x16_bf16 v[64:79], v[120:123], a[56:59], v[64:79]
s_waitcnt vmcnt(8)
v_mfma_f32_32x32x16_bf16 v[64:79], v[124:127], a[60:63], v[64:79]
s_nop 11
v_max3_f32 v21, v21, v64, v65
v_max3_f32 v21, v21, v66, v67
v_mov_b32 v26, v21
s_nop 1
v_permlane32_swap_b32 v26, v21
v_max_f32 v21, v21, v26
v_mul_f32 v21, s40, v21
v_fma_f32 v64, v64, s40, -v21
v_fma_f32 v65, v65, s40, -v21
v_fma_f32 v66, v66, s40, -v21
v_fma_f32 v67, v67, s40, -v21
v_fma_f32 v48, v48, s40, -v21
v_fma_f32 v49, v49, s40, -v21
v_fma_f32 v50, v50, s40, -v21
v_fma_f32 v51, v51, s40, -v21
v_fma_f32 v52, v52, s40, -v21
v_fma_f32 v53, v53, s40, -v21
v_fma_f32 v54, v54, s40, -v21
v_fma_f32 v55, v55, s40, -v21
v_fma_f32 v56, v56, s40, -v21
v_fma_f32 v57, v57, s40, -v21
v_fma_f32 v58, v58, s40, -v21
v_fma_f32 v59, v59, s40, -v21
v_fma_f32 v60, v60, s40, -v21
v_fma_f32 v61, v61, s40, -v21
v_fma_f32 v62, v62, s40, -v21
v_fma_f32 v63, v63, s40, -v21
v_exp_f32 v64, v64
v_exp_f32 v65, v65
v_exp_f32 v66, v66
v_exp_f32 v67, v67
v_exp_f32 v48, v48
v_exp_f32 v49, v49
v_exp_f32 v50, v50
v_exp_f32 v51, v51
v_exp_f32 v52, v52
v_exp_f32 v53, v53
v_exp_f32 v54, v54
v_exp_f32 v55, v55
v_exp_f32 v56, v56
v_exp_f32 v57, v57
v_exp_f32 v58, v58
v_exp_f32 v59, v59
v_exp_f32 v60, v60
v_exp_f32 v61, v61
v_exp_f32 v62, v62
v_exp_f32 v63, v63
v_cvt_pk_bf16_f32 v88, v64, v65
v_cvt_pk_bf16_f32 v89, v66, v67
v_cvt_pk_bf16_f32 v80, v48, v49
v_cvt_pk_bf16_f32 v81, v50, v51
v_cvt_pk_bf16_f32 v82, v52, v53
v_cvt_pk_bf16_f32 v83, v54, v55
v_cvt_pk_bf16_f32 v84, v56, v57
v_cvt_pk_bf16_f32 v85, v58, v59
v_cvt_pk_bf16_f32 v86, v60, v61
v_cvt_pk_bf16_f32 v87, v62, v63
s_waitcnt vmcnt(0)
v_mfma_f32_32x32x8_bf16 v[144:159], v[8:9], v[88:89], 0
v_add_f32 v22, v64, v65
v_add_f32 v22, v22, v66
v_mfma_f32_32x32x16_bf16 v[144:159], a[160:163], v[80:83], v[144:159]
v_add_f32 v22, v22, v67
v_mfma_f32_32x32x16_bf16 v[144:159], a[164:167], v[84:87], v[144:159]
v_add_f32 v22, v22, v48
v_add_f32 v22, v22, v49
v_mfma_f32_32x32x8_bf16 v[176:191], v[10:11], v[88:89], 0
v_add_f32 v22, v22, v50
v_mfma_f32_32x32x16_bf16 v[176:191], a[168:171], v[80:83], v[176:191]
v_add_f32 v22, v22, v51
v_add_f32 v22, v22, v52
v_mfma_f32_32x32x16_bf16 v[176:191], a[172:175], v[84:87], v[176:191]
v_add_f32 v22, v22, v53
v_add_f32 v22, v22, v54
v_mfma_f32_32x32x8_bf16 v[208:223], v[12:13], v[88:89], 0
v_add_f32 v22, v22, v55
v_mfma_f32_32x32x16_bf16 v[208:223], a[176:179], v[80:83], v[208:223]
v_add_f32 v22, v22, v56
v_add_f32 v22, v22, v57
v_mfma_f32_32x32x16_bf16 v[208:223], a[180:183], v[84:87], v[208:223]
v_add_f32 v22, v22, v58
v_mfma_f32_32x32x8_bf16 v[240:255], v[14:15], v[88:89], 0
v_add_f32 v22, v22, v59
v_add_f32 v22, v22, v60
v_mfma_f32_32x32x16_bf16 v[240:255], a[184:187], v[80:83], v[240:255]
v_add_f32 v22, v22, v61
v_mfma_f32_32x32x16_bf16 v[240:255], a[188:191], v[84:87], v[240:255]
v_add_f32 v22, v22, v62
v_add_f32 v22, v22, v63
s_lshl_b32 s26, s43, 18
s_lshl_b32 s27, s42, 12
s_add_u32 s26, s26, s27
s_add_u32 s26, s26, 83886080
v_mov_b32 v26, v22
s_nop 1
v_permlane32_swap_b32 v26, v22
v_add_f32 v26, v26, v22
v_rcp_f32 v26, v26
s_nop 0
v_pk_mul_f32 v[144:145], v[144:145], v[26:27] op_sel_hi:[1,0]
v_pk_mul_f32 v[146:147], v[146:147], v[26:27] op_sel_hi:[1,0]
v_pk_mul_f32 v[148:149], v[148:149], v[26:27] op_sel_hi:[1,0]
v_pk_mul_f32 v[150:151], v[150:151], v[26:27] op_sel_hi:[1,0]
v_pk_mul_f32 v[152:153], v[152:153], v[26:27] op_sel_hi:[1,0]
v_pk_mul_f32 v[154:155], v[154:155], v[26:27] op_sel_hi:[1,0]
v_pk_mul_f32 v[156:157], v[156:157], v[26:27] op_sel_hi:[1,0]
v_pk_mul_f32 v[158:159], v[158:159], v[26:27] op_sel_hi:[1,0]
v_cvt_pk_bf16_f32 v144, v144, v145
v_cvt_pk_bf16_f32 v145, v146, v147
v_cvt_pk_bf16_f32 v146, v148, v149
v_cvt_pk_bf16_f32 v147, v150, v151
buffer_store_dwordx4 v[144:147], v6, s[8:11], s26 offen offset:0 sc1
v_cvt_pk_bf16_f32 v152, v152, v153
v_cvt_pk_bf16_f32 v153, v154, v155
v_cvt_pk_bf16_f32 v154, v156, v157
v_cvt_pk_bf16_f32 v155, v158, v159
buffer_store_dwordx4 v[152:155], v6, s[8:11], s26 offen offset:512 sc1
v_pk_mul_f32 v[176:177], v[176:177], v[26:27] op_sel_hi:[1,0]
v_pk_mul_f32 v[178:179], v[178:179], v[26:27] op_sel_hi:[1,0]
v_pk_mul_f32 v[180:181], v[180:181], v[26:27] op_sel_hi:[1,0]
v_pk_mul_f32 v[182:183], v[182:183], v[26:27] op_sel_hi:[1,0]
v_pk_mul_f32 v[184:185], v[184:185], v[26:27] op_sel_hi:[1,0]
v_pk_mul_f32 v[186:187], v[186:187], v[26:27] op_sel_hi:[1,0]
v_pk_mul_f32 v[188:189], v[188:189], v[26:27] op_sel_hi:[1,0]
v_pk_mul_f32 v[190:191], v[190:191], v[26:27] op_sel_hi:[1,0]
v_cvt_pk_bf16_f32 v176, v176, v177
v_cvt_pk_bf16_f32 v177, v178, v179
v_cvt_pk_bf16_f32 v178, v180, v181
v_cvt_pk_bf16_f32 v179, v182, v183
buffer_store_dwordx4 v[176:179], v6, s[8:11], s26 offen offset:1024 sc1
v_cvt_pk_bf16_f32 v184, v184, v185
v_cvt_pk_bf16_f32 v185, v186, v187
v_cvt_pk_bf16_f32 v186, v188, v189
v_cvt_pk_bf16_f32 v187, v190, v191
buffer_store_dwordx4 v[184:187], v6, s[8:11], s26 offen offset:1536 sc1
v_pk_mul_f32 v[208:209], v[208:209], v[26:27] op_sel_hi:[1,0]
v_pk_mul_f32 v[210:211], v[210:211], v[26:27] op_sel_hi:[1,0]
v_pk_mul_f32 v[212:213], v[212:213], v[26:27] op_sel_hi:[1,0]
v_pk_mul_f32 v[214:215], v[214:215], v[26:27] op_sel_hi:[1,0]
v_pk_mul_f32 v[216:217], v[216:217], v[26:27] op_sel_hi:[1,0]
v_pk_mul_f32 v[218:219], v[218:219], v[26:27] op_sel_hi:[1,0]
v_pk_mul_f32 v[220:221], v[220:221], v[26:27] op_sel_hi:[1,0]
v_pk_mul_f32 v[222:223], v[222:223], v[26:27] op_sel_hi:[1,0]
v_cvt_pk_bf16_f32 v208, v208, v209
v_cvt_pk_bf16_f32 v209, v210, v211
v_cvt_pk_bf16_f32 v210, v212, v213
v_cvt_pk_bf16_f32 v211, v214, v215
buffer_store_dwordx4 v[208:211], v6, s[8:11], s26 offen offset:2048 sc1
v_cvt_pk_bf16_f32 v216, v216, v217
v_cvt_pk_bf16_f32 v217, v218, v219
v_cvt_pk_bf16_f32 v218, v220, v221
v_cvt_pk_bf16_f32 v219, v222, v223
buffer_store_dwordx4 v[216:219], v6, s[8:11], s26 offen offset:2560 sc1
v_pk_mul_f32 v[240:241], v[240:241], v[26:27] op_sel_hi:[1,0]
v_pk_mul_f32 v[242:243], v[242:243], v[26:27] op_sel_hi:[1,0]
v_pk_mul_f32 v[244:245], v[244:245], v[26:27] op_sel_hi:[1,0]
v_pk_mul_f32 v[246:247], v[246:247], v[26:27] op_sel_hi:[1,0]
v_pk_mul_f32 v[248:249], v[248:249], v[26:27] op_sel_hi:[1,0]
v_pk_mul_f32 v[250:251], v[250:251], v[26:27] op_sel_hi:[1,0]
v_pk_mul_f32 v[252:253], v[252:253], v[26:27] op_sel_hi:[1,0]
v_pk_mul_f32 v[254:255], v[254:255], v[26:27] op_sel_hi:[1,0]
v_cvt_pk_bf16_f32 v240, v240, v241
v_cvt_pk_bf16_f32 v241, v242, v243
v_cvt_pk_bf16_f32 v242, v244, v245
v_cvt_pk_bf16_f32 v243, v246, v247
buffer_store_dwordx4 v[240:243], v6, s[8:11], s26 offen offset:3072 sc1
v_cvt_pk_bf16_f32 v248, v248, v249
v_cvt_pk_bf16_f32 v249, v250, v251
v_cvt_pk_bf16_f32 v250, v252, v253
v_cvt_pk_bf16_f32 v251, v254, v255
buffer_store_dwordx4 v[248:251], v6, s[8:11], s26 offen offset:3584 sc1
s_lshl_b32 s26, s43, 7
s_lshl_b32 s27, s42, 2
s_add_u32 s26, s26, s27
s_add_u32 s26, s26, 111157248
v_mov_b32 v26, 1
s_waitcnt vmcnt(0)
s_mov_b64 exec, 1
buffer_store_dword v26, v4, s[8:11], s26 offen sc1
s_mov_b64 exec, -1
s_add_u32 s43, s43, 1
s_add_u32 s41, s41, 1
s_cmp_lt_u32 s41, 8
s_cbranch_scc1 L_battl
s_branch L_done
L_team:
v_mov_b32 v12, v0
v_and_b32 v13, 15, v0
v_bfe_u32 v14, v0, 4, 2
v_lshlrev_b32 v1, 4, v12
v_and_b32 v2, 0x3f0, v1
s_mul_i32 s20, s17, 34816
s_add_u32 s20, s20, 24576
v_add_u32 v2, s20, v2
v_and_b32 v15, 1, v12
v_mul_u32_u24 v0, 0xaaaa, v15
v_add_u32 v0, 0xffff4444, v0
v_lshrrev_b32 v18, 2, v13
v_lshl_add_u32 v18, v18, 1, v15
v_bfe_u32 v19, v13, 1, 1
v_lshrrev_b32 v16, 5, v12
v_lshlrev_b32 v16, 8, v16
v_lshl_add_u32 v16, v18, 5, v16
v_and_b32 v17, 1, v14
v_lshl_add_u32 v16, v17, 4, v16
v_and_b32 v17, 0x7f, v16
v_xor_b32 v17, 16, v17
v_add_u32 v16, 4224, v16
v_add_u32 v17, 6272, v17
v_cmp_eq_u32 vcc, 1, v19
s_nop 1
v_cndmask_b32 v7, v17, v16, vcc
v_and_b32 v16, 1, v14
v_xor_b32 v16, v18, v16
v_and_b32 v17, 2, v14
v_lshlrev_b32 v17, 1, v17
v_xor_b32 v16, v16, v17
v_lshlrev_b32 v16, 4, v16
v_lshl_add_u32 v16, v14, 7, v16
v_mul_u32_u24 v17, 2176, v19
v_add_u32 v16, v16, v17
v_add_u32 v5, 0, v16
v_bfe_u32 v20, v13, 3, 1
v_bfe_u32 v21, v13, 1, 1
v_lshlrev_b32 v16, 1, v14
v_xor_b32 v16, v16, v21
v_lshlrev_b32 v17, 2, v20
v_xor_b32 v16, v16, v17
v_lshlrev_b32 v16, 4, v16
v_lshl_add_u32 v16, v20, 8, v16
v_lshl_add_u32 v16, v21, 7, v16
v_bfe_u32 v17, v13, 2, 1
v_lshl_add_u32 v16, v17, 3, v16
v_lshl_add_u32 v16, v15, 2, v16
s_lshl_b32 s20, s17, 9
s_add_u32 s20, s20, 0
v_add_u32 v4, s20, v16
v_xor_b32 v3, 16, v4
v_lshrrev_b32 v16, 4, v12
v_xor_b32 v17, s16, v16
v_lshlrev_b32 v16, 12, v16
v_lshl_add_u32 v16, v17, 7, v16
v_lshl_add_u32 v9, v13, 3, v16
s_lshr_b32 s20, s17, 1
s_lshl_b32 s20, s20, 2
v_add_u32 v16, s20, v14
v_xor_b32 v17, s16, v16
v_lshlrev_b32 v16, 12, v16
v_lshl_add_u32 v16, v17, 7, v16
v_lshl_add_u32 v16, v13, 2, v16
s_and_b32 s20, s17, 1
s_lshl_b32 s20, s20, 6
s_add_u32 s20, s20, 262144
v_add_u32 v10, s20, v16
v_bfe_u32 v16, v13, 2, 1
v_lshlrev_b32 v16, 5, v16
v_and_b32 v17, 1, v14
v_lshl_add_u32 v16, v17, 8, v16
v_lshrrev_b32 v17, 1, v14
v_lshl_add_u32 v16, v17, 4, v16
v_and_b32 v17, 3, v13
v_lshl_add_u32 v11, v17, 2, v16
v_lshlrev_b32 v6, 6, v12
v_lshlrev_b32 v8, 2, v12
s_mov_b32 s36, 0x11111111
s_mov_b32 s37, 0x11111111
s_mov_b32 s38, 0x22222222
s_mov_b32 s39, 0x22222222
s_mov_b32 s40, 0x44444444
s_mov_b32 s41, 0x44444444
s_mov_b32 s42, 0x88888888
s_mov_b32 s43, 0x88888888
s_mov_b32 s44, 0xf0f0f0f0
s_mov_b32 s45, 0xf0f0f0f0
s_mov_b32 s18, 0x3e0293ee
s_lshl_b32 s20, s17, 5
s_add_u32 s20, s20, s16
s_cmp_lt_u32 s20, 72
s_cselect_b32 s48, 1, 0
s_lshl_b32 s23, s20, 12
s_lshl_b32 s21, s17, 10
s_sub_u32 s23, s23, s21
s_lshr_b32 s24, s20, 2
s_lshl_b32 s24, s24, 9
s_and_b32 s21, s20, 3
s_lshl_b32 s21, s21, 6
s_add_u32 s24, s24, s21
s_add_u32 s24, s24, 110100480
s_cmp_lt_u32 s20, 72
s_cselect_b32 s24, s24, 536870912
s_lshl_b32 s25, s16, 12
s_add_u32 s26, s25, 131072
s_add_u32 s27, s25, 262144
s_cmp_lt_u32 s16, 8
s_cselect_b32 s27, s27, 536870912
s_mov_b32 s28, 109051904
s_mov_b32 s29, 109346816
s_lshl_b32 s30, s16, 20
s_add_u32 s30, s30, 33554432
s_lshl_b32 s31, s16, 12
s_add_u32 s31, s31, 100663296
s_add_u32 s35, s24, 32768
s_mov_b32 s53, 0x3f803f80
s_mov_b32 s86, 0x33333333
s_mov_b32 s87, 0x33333333
s_lshl_b32 s82, s16, 7
s_add_u32 s83, s82, 111152384
s_add_u32 s82, s82, 111148288
s_mov_b32 s19, 0
v_mov_b32 v64, -1
v_mov_b32 v65, -1
v_mov_b32 v66, -1
v_mov_b32 v67, -1
s_add_u32 s20, s28, s25
buffer_store_dwordx4 v[64:67], v1, s[8:11], s20 offen
s_add_u32 s20, s28, s26
buffer_store_dwordx4 v[64:67], v1, s[8:11], s20 offen
s_add_u32 s20, s28, s27
buffer_store_dwordx4 v[64:67], v1, s[8:11], s20 offen
s_add_u32 s20, s29, s25
buffer_store_dwordx4 v[64:67], v1, s[8:11], s20 offen
s_add_u32 s20, s29, s26
buffer_store_dwordx4 v[64:67], v1, s[8:11], s20 offen
s_add_u32 s20, s29, s27
buffer_store_dwordx4 v[64:67], v1, s[8:11], s20 offen
s_add_u32 s20, s24, 16384
buffer_store_dword v64, v11, s[8:11], s20 offen
v_lshrrev_b32 v0, 4, v1
s_waitcnt vmcnt(0)
s_barrier
s_cmp_eq_u32 s17, 0
s_cbranch_scc0 L_tw
s_mov_b64 exec, 1
v_mov_b32 v1, 1
v_mov_b32 v2, 64
buffer_atomic_add v1, v2, s[56:59], 0 offen
s_mov_b64 exec, -1
L_tw:
s_mov_b32 s46, 0x05040100
s_mov_b32 s47, 0x07060302
v_and_b32 v3, 63, v0
v_lshlrev_b32 v3, 4, v3
s_mul_i32 s20, s17, 34816
s_add_u32 s20, s20, 24576
v_add_u32 v3, s20, v3
v_bfe_u32 v64, v0, 5, 1
v_bfe_u32 v65, v0, 4, 1
v_and_b32 v66, 15, v0
v_lshlrev_b32 v1, 17, v64
v_lshl_add_u32 v1, v65, 14, v1
v_lshl_add_u32 v1, v66, 2, v1
s_lshl_b32 s20, s16, 8
s_lshl_b32 s21, s17, 6
s_add_u32 s20, s20, s21
v_add_u32 v1, s20, v1
v_lshlrev_b32 v2, 4, v64
v_lshl_add_u32 v2, v65, 2, v2
v_mul_u32_u24 v2, 1152, v2
s_mul_i32 s20, s16, 147456
v_add_u32 v2, s20, v2
s_load_dwordx2 s[50:51], s[0:1], 64
s_waitcnt lgkmcnt(0)
s_mov_b32 s12, s50
s_and_b32 s13, s51, 0xffff
s_mov_b32 s14, 4718592
s_mov_b32 s15, 0x20000
s_mov_b32 s20, 0
buffer_load_dword v4, v1, s[12:15], s20 offen
s_mov_b32 s21, 32768
buffer_load_dword v5, v1, s[12:15], s21 offen
s_mov_b32 s20, 65536
buffer_load_dword v6, v1, s[12:15], s20 offen
s_mov_b32 s21, 98304
buffer_load_dword v7, v1, s[12:15], s21 offen
s_mov_b32 s20, 8192
buffer_load_dword v8, v1, s[12:15], s20 offen
s_mov_b32 s21, 40960
buffer_load_dword v9, v1, s[12:15], s21 offen
s_mov_b32 s20, 73728
buffer_load_dword v10, v1, s[12:15], s20 offen
s_mov_b32 s21, 106496
buffer_load_dword v11, v1, s[12:15], s21 offen
s_mov_b32 s20, 262144
buffer_load_dword v12, v1, s[12:15], s20 offen
s_mov_b32 s21, 294912
buffer_load_dword v13, v1, s[12:15], s21 offen
s_mov_b32 s20, 327680
buffer_load_dword v14, v1, s[12:15], s20 offen
s_mov_b32 s21, 360448
buffer_load_dword v15, v1, s[12:15], s21 offen
s_mov_b32 s20, 270336
buffer_load_dword v16, v1, s[12:15], s20 offen
s_mov_b32 s21, 303104
buffer_load_dword v17, v1, s[12:15], s21 offen
s_mov_b32 s20, 335872
buffer_load_dword v18, v1, s[12:15], s20 offen
s_mov_b32 s21, 368640
buffer_load_dword v19, v1, s[12:15], s21 offen
s_mov_b32 s20, 524288
buffer_load_dword v20, v1, s[12:15], s20 offen
s_mov_b32 s21, 557056
buffer_load_dword v21, v1, s[12:15], s21 offen
s_mov_b32 s20, 589824
buffer_load_dword v22, v1, s[12:15], s20 offen
s_mov_b32 s21, 622592
buffer_load_dword v23, v1, s[12:15], s21 offen
s_mov_b32 s20, 532480
buffer_load_dword v24, v1, s[12:15], s20 offen
s_mov_b32 s21, 565248
buffer_load_dword v25, v1, s[12:15], s21 offen
s_mov_b32 s20, 598016
buffer_load_dword v26, v1, s[12:15], s20 offen
s_mov_b32 s21, 630784
buffer_load_dword v27, v1, s[12:15], s21 offen
s_mov_b32 s20, 786432
buffer_load_dword v28, v1, s[12:15], s20 offen
s_mov_b32 s21, 819200
buffer_load_dword v29, v1, s[12:15], s21 offen
s_mov_b32 s20, 851968
buffer_load_dword v30, v1, s[12:15], s20 offen
s_mov_b32 s21, 884736
buffer_load_dword v31, v1, s[12:15], s21 offen
s_mov_b32 s20, 794624
buffer_load_dword v32, v1, s[12:15], s20 offen
s_mov_b32 s21, 827392
buffer_load_dword v33, v1, s[12:15], s21 offen
s_mov_b32 s20, 860160
buffer_load_dword v34, v1, s[12:15], s20 offen
s_mov_b32 s21, 892928
buffer_load_dword v35, v1, s[12:15], s21 offen
s_mov_b32 s20, 1048576
buffer_load_dword v36, v1, s[12:15], s20 offen
s_mov_b32 s21, 1081344
buffer_load_dword v37, v1, s[12:15], s21 offen
s_mov_b32 s20, 1114112
buffer_load_dword v38, v1, s[12:15], s20 offen
s_mov_b32 s21, 1146880
buffer_load_dword v39, v1, s[12:15], s21 offen
s_mov_b32 s20, 1056768
buffer_load_dword v40, v1, s[12:15], s20 offen
s_mov_b32 s21, 1089536
buffer_load_dword v41, v1, s[12:15], s21 offen
s_mov_b32 s20, 1122304
buffer_load_dword v42, v1, s[12:15], s20 offen
s_mov_b32 s21, 1155072
buffer_load_dword v43, v1, s[12:15], s21 offen
s_mov_b32 s20, 1310720
buffer_load_dword v44, v1, s[12:15], s20 offen
s_mov_b32 s21, 1343488
buffer_load_dword v45, v1, s[12:15], s21 offen
s_mov_b32 s20, 1376256
buffer_load_dword v46, v1, s[12:15], s20 offen
s_mov_b32 s21, 1409024
buffer_load_dword v47, v1, s[12:15], s21 offen
s_mov_b32 s20, 1318912
buffer_load_dword v48, v1, s[12:15], s20 offen
s_mov_b32 s21, 1351680
buffer_load_dword v49, v1, s[12:15], s21 offen
s_mov_b32 s20, 1384448
buffer_load_dword v50, v1, s[12:15], s20 offen
s_mov_b32 s21, 1417216
buffer_load_dword v51, v1, s[12:15], s21 offen
s_mov_b32 s20, 1572864
buffer_load_dword v52, v1, s[12:15], s20 offen
s_mov_b32 s21, 1605632
buffer_load_dword v53, v1, s[12:15], s21 offen
s_mov_b32 s20, 1638400
buffer_load_dword v54, v1, s[12:15], s20 offen
s_mov_b32 s21, 1671168
buffer_load_dword v55, v1, s[12:15], s21 offen
s_mov_b32 s20, 1581056
buffer_load_dword v56, v1, s[12:15], s20 offen
s_mov_b32 s21, 1613824
buffer_load_dword v57, v1, s[12:15], s21 offen
s_mov_b32 s20, 1646592
buffer_load_dword v58, v1, s[12:15], s20 offen
s_mov_b32 s21, 1679360
buffer_load_dword v59, v1, s[12:15], s21 offen
s_mov_b32 s20, 1835008
buffer_load_dword v60, v1, s[12:15], s20 offen
s_mov_b32 s21, 1867776
buffer_load_dword v61, v1, s[12:15], s21 offen
s_mov_b32 s20, 1900544
buffer_load_dword v62, v1, s[12:15], s20 offen
s_mov_b32 s21, 1933312
buffer_load_dword v63, v1, s[12:15], s21 offen
s_waitcnt vmcnt(58)
v_perm_b32 v72, v5, v4, s46
v_perm_b32 v80, v5, v4, s47
s_mov_b32 s20, 1843200
buffer_load_dword v4, v1, s[12:15], s20 offen
s_mov_b32 s21, 1875968
buffer_load_dword v5, v1, s[12:15], s21 offen
s_waitcnt vmcnt(58)
v_perm_b32 v73, v7, v6, s46
v_perm_b32 v81, v7, v6, s47
s_mov_b32 s20, 1908736
buffer_load_dword v6, v1, s[12:15], s20 offen
s_mov_b32 s21, 1941504
buffer_load_dword v7, v1, s[12:15], s21 offen
s_waitcnt vmcnt(58)
v_perm_b32 v74, v9, v8, s46
v_perm_b32 v82, v9, v8, s47
s_mov_b32 s20, 2097152
buffer_load_dword v8, v1, s[12:15], s20 offen
s_mov_b32 s21, 2129920
buffer_load_dword v9, v1, s[12:15], s21 offen
s_waitcnt vmcnt(58)
v_perm_b32 v75, v11, v10, s46
v_perm_b32 v83, v11, v10, s47
s_mov_b32 s20, 2162688
buffer_load_dword v10, v1, s[12:15], s20 offen
s_mov_b32 s21, 2195456
buffer_load_dword v11, v1, s[12:15], s21 offen
s_waitcnt vmcnt(58)
v_perm_b32 v76, v13, v12, s46
v_perm_b32 v84, v13, v12, s47
s_mov_b32 s20, 2105344
buffer_load_dword v12, v1, s[12:15], s20 offen
s_mov_b32 s21, 2138112
buffer_load_dword v13, v1, s[12:15], s21 offen
s_waitcnt vmcnt(58)
v_perm_b32 v77, v15, v14, s46
v_perm_b32 v85, v15, v14, s47
s_mov_b32 s20, 2170880
buffer_load_dword v14, v1, s[12:15], s20 offen
s_mov_b32 s21, 2203648
buffer_load_dword v15, v1, s[12:15], s21 offen
s_waitcnt vmcnt(58)
v_perm_b32 v78, v17, v16, s46
v_perm_b32 v86, v17, v16, s47
s_mov_b32 s20, 2359296
buffer_load_dword v16, v1, s[12:15], s20 offen
s_mov_b32 s21, 2392064
buffer_load_dword v17, v1, s[12:15], s21 offen
s_waitcnt vmcnt(58)
v_perm_b32 v79, v19, v18, s46
v_perm_b32 v87, v19, v18, s47
s_mov_b32 s20, 2424832
buffer_load_dword v18, v1, s[12:15], s20 offen
s_mov_b32 s21, 2457600
buffer_load_dword v19, v1, s[12:15], s21 offen
s_waitcnt vmcnt(58)
v_perm_b32 v96, v21, v20, s46
v_perm_b32 v104, v21, v20, s47
s_mov_b32 s20, 2367488
buffer_load_dword v20, v1, s[12:15], s20 offen
s_mov_b32 s21, 2400256
buffer_load_dword v21, v1, s[12:15], s21 offen
s_waitcnt vmcnt(58)
v_perm_b32 v97, v23, v22, s46
v_perm_b32 v105, v23, v22, s47
s_mov_b32 s20, 2433024
buffer_load_dword v22, v1, s[12:15], s20 offen
s_mov_b32 s21, 2465792
buffer_load_dword v23, v1, s[12:15], s21 offen
s_waitcnt vmcnt(58)
v_perm_b32 v98, v25, v24, s46
v_perm_b32 v106, v25, v24, s47
s_mov_b32 s20, 2621440
buffer_load_dword v24, v1, s[12:15], s20 offen
s_mov_b32 s21, 2654208
buffer_load_dword v25, v1, s[12:15], s21 offen
s_waitcnt vmcnt(58)
v_perm_b32 v99, v27, v26, s46
v_perm_b32 v107, v27, v26, s47
s_mov_b32 s20, 2686976
buffer_load_dword v26, v1, s[12:15], s20 offen
s_mov_b32 s21, 2719744
buffer_load_dword v27, v1, s[12:15], s21 offen
s_waitcnt vmcnt(58)
v_perm_b32 v100, v29, v28, s46
v_perm_b32 v108, v29, v28, s47
s_mov_b32 s20, 2629632
buffer_load_dword v28, v1, s[12:15], s20 offen
s_mov_b32 s21, 2662400
buffer_load_dword v29, v1, s[12:15], s21 offen
s_waitcnt vmcnt(58)
v_perm_b32 v101, v31, v30, s46
v_perm_b32 v109, v31, v30, s47
s_mov_b32 s20, 2695168
buffer_load_dword v30, v1, s[12:15], s20 offen
s_mov_b32 s21, 2727936
buffer_load_dword v31, v1, s[12:15], s21 offen
s_waitcnt vmcnt(58)
v_perm_b32 v102, v33, v32, s46
v_perm_b32 v110, v33, v32, s47
s_mov_b32 s20, 2883584
buffer_load_dword v32, v1, s[12:15], s20 offen
s_mov_b32 s21, 2916352
buffer_load_dword v33, v1, s[12:15], s21 offen
s_waitcnt vmcnt(58)
v_perm_b32 v103, v35, v34, s46
v_perm_b32 v111, v35, v34, s47
s_mov_b32 s20, 2949120
buffer_load_dword v34, v1, s[12:15], s20 offen
s_mov_b32 s21, 2981888
buffer_load_dword v35, v1, s[12:15], s21 offen
s_waitcnt vmcnt(58)
v_perm_b32 v120, v37, v36, s46
v_perm_b32 v128, v37, v36, s47
s_mov_b32 s20, 2891776
buffer_load_dword v36, v1, s[12:15], s20 offen
s_mov_b32 s21, 2924544
buffer_load_dword v37, v1, s[12:15], s21 offen
s_waitcnt vmcnt(58)
v_perm_b32 v121, v39, v38, s46
v_perm_b32 v129, v39, v38, s47
s_mov_b32 s20, 2957312
buffer_load_dword v38, v1, s[12:15], s20 offen
s_mov_b32 s21, 2990080
buffer_load_dword v39, v1, s[12:15], s21 offen
s_waitcnt vmcnt(58)
v_perm_b32 v122, v41, v40, s46
v_perm_b32 v130, v41, v40, s47
s_mov_b32 s20, 3145728
buffer_load_dword v40, v1, s[12:15], s20 offen
s_mov_b32 s21, 3178496
buffer_load_dword v41, v1, s[12:15], s21 offen
s_waitcnt vmcnt(58)
v_perm_b32 v123, v43, v42, s46
v_perm_b32 v131, v43, v42, s47
s_mov_b32 s20, 3211264
buffer_load_dword v42, v1, s[12:15], s20 offen
s_mov_b32 s21, 3244032
buffer_load_dword v43, v1, s[12:15], s21 offen
s_waitcnt vmcnt(58)
v_perm_b32 v124, v45, v44, s46
v_perm_b32 v132, v45, v44, s47
s_mov_b32 s20, 3153920
buffer_load_dword v44, v1, s[12:15], s20 offen
s_mov_b32 s21, 3186688
buffer_load_dword v45, v1, s[12:15], s21 offen
s_waitcnt vmcnt(58)
v_perm_b32 v125, v47, v46, s46
v_perm_b32 v133, v47, v46, s47
s_mov_b32 s20, 3219456
buffer_load_dword v46, v1, s[12:15], s20 offen
s_mov_b32 s21, 3252224
buffer_load_dword v47, v1, s[12:15], s21 offen
s_waitcnt vmcnt(58)
v_perm_b32 v126, v49, v48, s46
v_perm_b32 v134, v49, v48, s47
s_mov_b32 s20, 3407872
buffer_load_dword v48, v1, s[12:15], s20 offen
s_mov_b32 s21, 3440640
buffer_load_dword v49, v1, s[12:15], s21 offen
s_waitcnt vmcnt(58)
v_perm_b32 v127, v51, v50, s46
v_perm_b32 v135, v51, v50, s47
s_mov_b32 s20, 3473408
buffer_load_dword v50, v1, s[12:15], s20 offen
s_mov_b32 s21, 3506176
buffer_load_dword v51, v1, s[12:15], s21 offen
s_waitcnt vmcnt(58)
v_perm_b32 v144, v53, v52, s46
v_perm_b32 v152, v53, v52, s47
s_mov_b32 s20, 3416064
buffer_load_dword v52, v1, s[12:15], s20 offen
s_mov_b32 s21, 3448832
buffer_load_dword v53, v1, s[12:15], s21 offen
s_waitcnt vmcnt(58)
v_perm_b32 v145, v55, v54, s46
v_perm_b32 v153, v55, v54, s47
s_mov_b32 s20, 3481600
buffer_load_dword v54, v1, s[12:15], s20 offen
s_mov_b32 s21, 3514368
buffer_load_dword v55, v1, s[12:15], s21 offen
s_waitcnt vmcnt(58)
v_perm_b32 v146, v57, v56, s46
v_perm_b32 v154, v57, v56, s47
s_mov_b32 s20, 3670016
buffer_load_dword v56, v1, s[12:15], s20 offen
s_mov_b32 s21, 3702784
buffer_load_dword v57, v1, s[12:15], s21 offen
s_waitcnt vmcnt(58)
v_perm_b32 v147, v59, v58, s46
v_perm_b32 v155, v59, v58, s47
s_mov_b32 s20, 3735552
buffer_load_dword v58, v1, s[12:15], s20 offen
s_mov_b32 s21, 3768320
buffer_load_dword v59, v1, s[12:15], s21 offen
s_waitcnt vmcnt(58)
v_perm_b32 v148, v61, v60, s46
v_perm_b32 v156, v61, v60, s47
s_mov_b32 s20, 3678208
buffer_load_dword v60, v1, s[12:15], s20 offen
s_mov_b32 s21, 3710976
buffer_load_dword v61, v1, s[12:15], s21 offen
s_waitcnt vmcnt(58)
v_perm_b32 v149, v63, v62, s46
v_perm_b32 v157, v63, v62, s47
s_mov_b32 s20, 3743744
buffer_load_dword v62, v1, s[12:15], s20 offen
s_mov_b32 s21, 3776512
buffer_load_dword v63, v1, s[12:15], s21 offen
s_waitcnt vmcnt(58)
v_perm_b32 v150, v5, v4, s46
v_perm_b32 v158, v5, v4, s47
s_mov_b32 s20, 3932160
buffer_load_dword v4, v1, s[12:15], s20 offen
s_mov_b32 s21, 3964928
buffer_load_dword v5, v1, s[12:15], s21 offen
s_waitcnt vmcnt(58)
v_perm_b32 v151, v7, v6, s46
v_perm_b32 v159, v7, v6, s47
s_mov_b32 s20, 3997696
buffer_load_dword v6, v1, s[12:15], s20 offen
s_mov_b32 s21, 4030464
buffer_load_dword v7, v1, s[12:15], s21 offen
s_waitcnt vmcnt(58)
v_perm_b32 v168, v9, v8, s46
v_perm_b32 v176, v9, v8, s47
s_mov_b32 s20, 3940352
buffer_load_dword v8, v1, s[12:15], s20 offen
s_mov_b32 s21, 3973120
buffer_load_dword v9, v1, s[12:15], s21 offen
s_waitcnt vmcnt(58)
v_perm_b32 v169, v11, v10, s46
v_perm_b32 v177, v11, v10, s47
s_mov_b32 s20, 4005888
buffer_load_dword v10, v1, s[12:15], s20 offen
s_mov_b32 s21, 4038656
buffer_load_dword v11, v1, s[12:15], s21 offen
s_waitcnt vmcnt(58)
v_perm_b32 v170, v13, v12, s46
v_perm_b32 v178, v13, v12, s47
s_mov_b32 s20, 4194304
buffer_load_dword v12, v1, s[12:15], s20 offen
s_mov_b32 s21, 4227072
buffer_load_dword v13, v1, s[12:15], s21 offen
s_waitcnt vmcnt(58)
v_perm_b32 v171, v15, v14, s46
v_perm_b32 v179, v15, v14, s47
s_mov_b32 s20, 4259840
buffer_load_dword v14, v1, s[12:15], s20 offen
s_mov_b32 s21, 4292608
buffer_load_dword v15, v1, s[12:15], s21 offen
s_waitcnt vmcnt(58)
v_perm_b32 v172, v17, v16, s46
v_perm_b32 v180, v17, v16, s47
s_mov_b32 s20, 4202496
buffer_load_dword v16, v1, s[12:15], s20 offen
s_mov_b32 s21, 4235264
buffer_load_dword v17, v1, s[12:15], s21 offen
s_waitcnt vmcnt(58)
v_perm_b32 v173, v19, v18, s46
v_perm_b32 v181, v19, v18, s47
s_mov_b32 s20, 4268032
buffer_load_dword v18, v1, s[12:15], s20 offen
s_mov_b32 s21, 4300800
buffer_load_dword v19, v1, s[12:15], s21 offen
s_waitcnt vmcnt(58)
v_perm_b32 v174, v21, v20, s46
v_perm_b32 v182, v21, v20, s47
s_mov_b32 s20, 4456448
buffer_load_dword v20, v1, s[12:15], s20 offen
s_mov_b32 s21, 4489216
buffer_load_dword v21, v1, s[12:15], s21 offen
s_waitcnt vmcnt(58)
v_perm_b32 v175, v23, v22, s46
v_perm_b32 v183, v23, v22, s47
s_mov_b32 s20, 4521984
buffer_load_dword v22, v1, s[12:15], s20 offen
s_mov_b32 s21, 4554752
buffer_load_dword v23, v1, s[12:15], s21 offen
s_waitcnt vmcnt(58)
v_perm_b32 v192, v25, v24, s46
v_perm_b32 v200, v25, v24, s47
s_mov_b32 s20, 4464640
buffer_load_dword v24, v1, s[12:15], s20 offen
s_mov_b32 s21, 4497408
buffer_load_dword v25, v1, s[12:15], s21 offen
s_waitcnt vmcnt(58)
v_perm_b32 v193, v27, v26, s46
v_perm_b32 v201, v27, v26, s47
s_mov_b32 s20, 4530176
buffer_load_dword v26, v1, s[12:15], s20 offen
s_mov_b32 s21, 4562944
buffer_load_dword v27, v1, s[12:15], s21 offen
s_waitcnt vmcnt(58)
v_perm_b32 v194, v29, v28, s46
v_perm_b32 v202, v29, v28, s47
s_load_dwordx2 s[50:51], s[0:1], 72
s_waitcnt lgkmcnt(0)
s_mov_b32 s12, s50
s_and_b32 s13, s51, 0xffff
s_mov_b32 s14, 4718592
s_mov_b32 s15, 0x20000
s_mov_b32 s20, 0
buffer_load_dword v28, v1, s[12:15], s20 offen
s_mov_b32 s21, 32768
buffer_load_dword v29, v1, s[12:15], s21 offen
s_waitcnt vmcnt(58)
v_perm_b32 v195, v31, v30, s46
v_perm_b32 v203, v31, v30, s47
s_mov_b32 s20, 65536
buffer_load_dword v30, v1, s[12:15], s20 offen
s_mov_b32 s21, 98304
buffer_load_dword v31, v1, s[12:15], s21 offen
s_waitcnt vmcnt(58)
v_perm_b32 v196, v33, v32, s46
v_perm_b32 v204, v33, v32, s47
s_mov_b32 s20, 8192
buffer_load_dword v32, v1, s[12:15], s20 offen
s_mov_b32 s21, 40960
buffer_load_dword v33, v1, s[12:15], s21 offen
s_waitcnt vmcnt(58)
v_perm_b32 v197, v35, v34, s46
v_perm_b32 v205, v35, v34, s47
s_mov_b32 s20, 73728
buffer_load_dword v34, v1, s[12:15], s20 offen
s_mov_b32 s21, 106496
buffer_load_dword v35, v1, s[12:15], s21 offen
s_waitcnt vmcnt(58)
v_perm_b32 v198, v37, v36, s46
v_perm_b32 v206, v37, v36, s47
s_mov_b32 s20, 262144
buffer_load_dword v36, v1, s[12:15], s20 offen
s_mov_b32 s21, 294912
buffer_load_dword v37, v1, s[12:15], s21 offen
s_waitcnt vmcnt(58)
v_perm_b32 v199, v39, v38, s46
v_perm_b32 v207, v39, v38, s47
s_mov_b32 s20, 327680
buffer_load_dword v38, v1, s[12:15], s20 offen
s_mov_b32 s21, 360448
buffer_load_dword v39, v1, s[12:15], s21 offen
s_waitcnt vmcnt(58)
v_perm_b32 v216, v41, v40, s46
v_perm_b32 v224, v41, v40, s47
s_mov_b32 s20, 270336
buffer_load_dword v40, v1, s[12:15], s20 offen
s_mov_b32 s21, 303104
buffer_load_dword v41, v1, s[12:15], s21 offen
s_waitcnt vmcnt(58)
v_perm_b32 v217, v43, v42, s46
v_perm_b32 v225, v43, v42, s47
s_mov_b32 s20, 335872
buffer_load_dword v42, v1, s[12:15], s20 offen
s_mov_b32 s21, 368640
buffer_load_dword v43, v1, s[12:15], s21 offen
s_waitcnt vmcnt(58)
v_perm_b32 v218, v45, v44, s46
v_perm_b32 v226, v45, v44, s47
s_mov_b32 s20, 524288
buffer_load_dword v44, v1, s[12:15], s20 offen
s_mov_b32 s21, 557056
buffer_load_dword v45, v1, s[12:15], s21 offen
s_waitcnt vmcnt(58)
v_perm_b32 v219, v47, v46, s46
v_perm_b32 v227, v47, v46, s47
s_mov_b32 s20, 589824
buffer_load_dword v46, v1, s[12:15], s20 offen
s_mov_b32 s21, 622592
buffer_load_dword v47, v1, s[12:15], s21 offen
s_waitcnt vmcnt(58)
v_perm_b32 v220, v49, v48, s46
v_perm_b32 v228, v49, v48, s47
s_mov_b32 s20, 532480
buffer_load_dword v48, v1, s[12:15], s20 offen
s_mov_b32 s21, 565248
buffer_load_dword v49, v1, s[12:15], s21 offen
s_waitcnt vmcnt(58)
v_perm_b32 v221, v51, v50, s46
v_perm_b32 v229, v51, v50, s47
s_mov_b32 s20, 598016
buffer_load_dword v50, v1, s[12:15], s20 offen
s_mov_b32 s21, 630784
buffer_load_dword v51, v1, s[12:15], s21 offen
s_waitcnt vmcnt(58)
v_perm_b32 v222, v53, v52, s46
v_perm_b32 v230, v53, v52, s47
s_mov_b32 s20, 786432
buffer_load_dword v52, v1, s[12:15], s20 offen
s_mov_b32 s21, 819200
buffer_load_dword v53, v1, s[12:15], s21 offen
s_waitcnt vmcnt(58)
v_perm_b32 v223, v55, v54, s46
v_perm_b32 v231, v55, v54, s47
s_mov_b32 s20, 851968
buffer_load_dword v54, v1, s[12:15], s20 offen
s_mov_b32 s21, 884736
buffer_load_dword v55, v1, s[12:15], s21 offen
s_waitcnt vmcnt(58)
v_perm_b32 v240, v57, v56, s46
v_perm_b32 v248, v57, v56, s47
s_mov_b32 s20, 794624
buffer_load_dword v56, v1, s[12:15], s20 offen
s_mov_b32 s21, 827392
buffer_load_dword v57, v1, s[12:15], s21 offen
s_waitcnt vmcnt(58)
v_perm_b32 v241, v59, v58, s46
v_perm_b32 v249, v59, v58, s47
s_mov_b32 s20, 860160
buffer_load_dword v58, v1, s[12:15], s20 offen
s_mov_b32 s21, 892928
buffer_load_dword v59, v1, s[12:15], s21 offen
s_waitcnt vmcnt(58)
v_perm_b32 v242, v61, v60, s46
v_perm_b32 v250, v61, v60, s47
s_mov_b32 s20, 1048576
buffer_load_dword v60, v1, s[12:15], s20 offen
s_mov_b32 s21, 1081344
buffer_load_dword v61, v1, s[12:15], s21 offen
s_waitcnt vmcnt(58)
v_perm_b32 v243, v63, v62, s46
v_perm_b32 v251, v63, v62, s47
s_mov_b32 s20, 1114112
buffer_load_dword v62, v1, s[12:15], s20 offen
s_mov_b32 s21, 1146880
buffer_load_dword v63, v1, s[12:15], s21 offen
s_waitcnt vmcnt(58)
v_perm_b32 v244, v5, v4, s46
v_perm_b32 v252, v5, v4, s47
s_mov_b32 s20, 1056768
buffer_load_dword v4, v1, s[12:15], s20 offen
s_mov_b32 s21, 1089536
buffer_load_dword v5, v1, s[12:15], s21 offen
s_waitcnt vmcnt(58)
v_perm_b32 v245, v7, v6, s46
v_perm_b32 v253, v7, v6, s47
s_mov_b32 s20, 1122304
buffer_load_dword v6, v1, s[12:15], s20 offen
s_mov_b32 s21, 1155072
buffer_load_dword v7, v1, s[12:15], s21 offen
s_waitcnt vmcnt(58)
v_perm_b32 v246, v9, v8, s46
v_perm_b32 v254, v9, v8, s47
s_mov_b32 s20, 1310720
buffer_load_dword v8, v1, s[12:15], s20 offen
s_mov_b32 s21, 1343488
buffer_load_dword v9, v1, s[12:15], s21 offen
s_waitcnt vmcnt(58)
v_perm_b32 v247, v11, v10, s46
v_perm_b32 v255, v11, v10, s47
s_mov_b32 s20, 1376256
buffer_load_dword v10, v1, s[12:15], s20 offen
s_mov_b32 s21, 1409024
buffer_load_dword v11, v1, s[12:15], s21 offen
s_waitcnt vmcnt(58)
v_perm_b32 v64, v13, v12, s46
v_accvgpr_write_b32 a8, v64
v_perm_b32 v68, v13, v12, s47
v_accvgpr_write_b32 a16, v68
s_mov_b32 s20, 1318912
buffer_load_dword v12, v1, s[12:15], s20 offen
s_mov_b32 s21, 1351680
buffer_load_dword v13, v1, s[12:15], s21 offen
s_waitcnt vmcnt(58)
v_perm_b32 v65, v15, v14, s46
v_accvgpr_write_b32 a9, v65
v_perm_b32 v69, v15, v14, s47
v_accvgpr_write_b32 a17, v69
s_mov_b32 s20, 1384448
buffer_load_dword v14, v1, s[12:15], s20 offen
s_mov_b32 s21, 1417216
buffer_load_dword v15, v1, s[12:15], s21 offen
s_waitcnt vmcnt(58)
v_perm_b32 v66, v17, v16, s46
v_accvgpr_write_b32 a10, v66
v_perm_b32 v70, v17, v16, s47
v_accvgpr_write_b32 a18, v70
s_mov_b32 s20, 1572864
buffer_load_dword v16, v1, s[12:15], s20 offen
s_mov_b32 s21, 1605632
buffer_load_dword v17, v1, s[12:15], s21 offen
s_waitcnt vmcnt(58)
v_perm_b32 v67, v19, v18, s46
v_accvgpr_write_b32 a11, v67
v_perm_b32 v71, v19, v18, s47
v_accvgpr_write_b32 a19, v71
s_mov_b32 s20, 1638400
buffer_load_dword v18, v1, s[12:15], s20 offen
s_mov_b32 s21, 1671168
buffer_load_dword v19, v1, s[12:15], s21 offen
s_waitcnt vmcnt(58)
v_perm_b32 v64, v21, v20, s46
v_accvgpr_write_b32 a12, v64
v_perm_b32 v68, v21, v20, s47
v_accvgpr_write_b32 a20, v68
s_mov_b32 s20, 1581056
buffer_load_dword v20, v1, s[12:15], s20 offen
s_mov_b32 s21, 1613824
buffer_load_dword v21, v1, s[12:15], s21 offen
s_waitcnt vmcnt(58)
v_perm_b32 v65, v23, v22, s46
v_accvgpr_write_b32 a13, v65
v_perm_b32 v69, v23, v22, s47
v_accvgpr_write_b32 a21, v69
s_mov_b32 s20, 1646592
buffer_load_dword v22, v1, s[12:15], s20 offen
s_mov_b32 s21, 1679360
buffer_load_dword v23, v1, s[12:15], s21 offen
s_waitcnt vmcnt(58)
v_perm_b32 v66, v25, v24, s46
v_accvgpr_write_b32 a14, v66
v_perm_b32 v70, v25, v24, s47
v_accvgpr_write_b32 a22, v70
s_mov_b32 s20, 1835008
buffer_load_dword v24, v1, s[12:15], s20 offen
s_mov_b32 s21, 1867776
buffer_load_dword v25, v1, s[12:15], s21 offen
s_waitcnt vmcnt(58)
v_perm_b32 v67, v27, v26, s46
v_accvgpr_write_b32 a15, v67
v_perm_b32 v71, v27, v26, s47
v_accvgpr_write_b32 a23, v71
s_mov_b32 s20, 1900544
buffer_load_dword v26, v1, s[12:15], s20 offen
s_mov_b32 s21, 1933312
buffer_load_dword v27, v1, s[12:15], s21 offen
s_waitcnt vmcnt(58)
v_perm_b32 v88, v29, v28, s46
v_perm_b32 v68, v29, v28, s47
s_mov_b32 s20, 1843200
buffer_load_dword v28, v1, s[12:15], s20 offen
s_mov_b32 s21, 1875968
buffer_load_dword v29, v1, s[12:15], s21 offen
s_waitcnt vmcnt(58)
v_perm_b32 v89, v31, v30, s46
v_perm_b32 v69, v31, v30, s47
s_mov_b32 s20, 1908736
buffer_load_dword v30, v1, s[12:15], s20 offen
s_mov_b32 s21, 1941504
buffer_load_dword v31, v1, s[12:15], s21 offen
s_waitcnt vmcnt(58)
v_perm_b32 v90, v33, v32, s46
v_perm_b32 v70, v33, v32, s47
s_mov_b32 s20, 2097152
buffer_load_dword v32, v1, s[12:15], s20 offen
s_mov_b32 s21, 2129920
buffer_load_dword v33, v1, s[12:15], s21 offen
s_waitcnt vmcnt(58)
v_perm_b32 v91, v35, v34, s46
v_perm_b32 v71, v35, v34, s47
ds_write_b128 v3, v[68:71] offset:0
s_waitcnt lgkmcnt(0)
s_mov_b32 s20, 2162688
buffer_load_dword v34, v1, s[12:15], s20 offen
s_mov_b32 s21, 2195456
buffer_load_dword v35, v1, s[12:15], s21 offen
s_waitcnt vmcnt(58)
v_perm_b32 v92, v37, v36, s46
v_perm_b32 v68, v37, v36, s47
s_mov_b32 s20, 2105344
buffer_load_dword v36, v1, s[12:15], s20 offen
s_mov_b32 s21, 2138112
buffer_load_dword v37, v1, s[12:15], s21 offen
s_waitcnt vmcnt(58)
v_perm_b32 v93, v39, v38, s46
v_perm_b32 v69, v39, v38, s47
s_mov_b32 s20, 2170880
buffer_load_dword v38, v1, s[12:15], s20 offen
s_mov_b32 s21, 2203648
buffer_load_dword v39, v1, s[12:15], s21 offen
s_waitcnt vmcnt(58)
v_perm_b32 v94, v41, v40, s46
v_perm_b32 v70, v41, v40, s47
s_mov_b32 s20, 2359296
buffer_load_dword v40, v1, s[12:15], s20 offen
s_mov_b32 s21, 2392064
buffer_load_dword v41, v1, s[12:15], s21 offen
s_waitcnt vmcnt(58)
v_perm_b32 v95, v43, v42, s46
v_perm_b32 v71, v43, v42, s47
ds_write_b128 v3, v[68:71] offset:1024
s_waitcnt lgkmcnt(0)
s_mov_b32 s20, 2424832
buffer_load_dword v42, v1, s[12:15], s20 offen
s_mov_b32 s21, 2457600
buffer_load_dword v43, v1, s[12:15], s21 offen
s_waitcnt vmcnt(58)
v_perm_b32 v112, v45, v44, s46
v_perm_b32 v68, v45, v44, s47
s_mov_b32 s20, 2367488
buffer_load_dword v44, v1, s[12:15], s20 offen
s_mov_b32 s21, 2400256
buffer_load_dword v45, v1, s[12:15], s21 offen
s_waitcnt vmcnt(58)
v_perm_b32 v113, v47, v46, s46
v_perm_b32 v69, v47, v46, s47
s_mov_b32 s20, 2433024
buffer_load_dword v46, v1, s[12:15], s20 offen
s_mov_b32 s21, 2465792
buffer_load_dword v47, v1, s[12:15], s21 offen
s_waitcnt vmcnt(58)
v_perm_b32 v114, v49, v48, s46
v_perm_b32 v70, v49, v48, s47
s_mov_b32 s20, 2621440
buffer_load_dword v48, v1, s[12:15], s20 offen
s_mov_b32 s21, 2654208
buffer_load_dword v49, v1, s[12:15], s21 offen
s_waitcnt vmcnt(58)
v_perm_b32 v115, v51, v50, s46
v_perm_b32 v71, v51, v50, s47
ds_write_b128 v3, v[68:71] offset:2048
s_waitcnt lgkmcnt(0)
s_mov_b32 s20, 2686976
buffer_load_dword v50, v1, s[12:15], s20 offen
s_mov_b32 s21, 2719744
buffer_load_dword v51, v1, s[12:15], s21 offen
s_waitcnt vmcnt(58)
v_perm_b32 v116, v53, v52, s46
v_perm_b32 v68, v53, v52, s47
s_mov_b32 s20, 2629632
buffer_load_dword v52, v1, s[12:15], s20 offen
s_mov_b32 s21, 2662400
buffer_load_dword v53, v1, s[12:15], s21 offen
s_waitcnt vmcnt(58)
v_perm_b32 v117, v55, v54, s46
v_perm_b32 v69, v55, v54, s47
s_mov_b32 s20, 2695168
buffer_load_dword v54, v1, s[12:15], s20 offen
s_mov_b32 s21, 2727936
buffer_load_dword v55, v1, s[12:15], s21 offen
s_waitcnt vmcnt(58)
v_perm_b32 v118, v57, v56, s46
v_perm_b32 v70, v57, v56, s47
s_mov_b32 s20, 2883584
buffer_load_dword v56, v1, s[12:15], s20 offen
s_mov_b32 s21, 2916352
buffer_load_dword v57, v1, s[12:15], s21 offen
s_waitcnt vmcnt(58)
v_perm_b32 v119, v59, v58, s46
v_perm_b32 v71, v59, v58, s47
ds_write_b128 v3, v[68:71] offset:3072
s_waitcnt lgkmcnt(0)
s_mov_b32 s20, 2949120
buffer_load_dword v58, v1, s[12:15], s20 offen
s_mov_b32 s21, 2981888
buffer_load_dword v59, v1, s[12:15], s21 offen
s_waitcnt vmcnt(58)
v_perm_b32 v136, v61, v60, s46
v_perm_b32 v68, v61, v60, s47
s_mov_b32 s20, 2891776
buffer_load_dword v60, v1, s[12:15], s20 offen
s_mov_b32 s21, 2924544
buffer_load_dword v61, v1, s[12:15], s21 offen
s_waitcnt vmcnt(58)
v_perm_b32 v137, v63, v62, s46
v_perm_b32 v69, v63, v62, s47
s_mov_b32 s20, 2957312
buffer_load_dword v62, v1, s[12:15], s20 offen
s_mov_b32 s21, 2990080
buffer_load_dword v63, v1, s[12:15], s21 offen
s_waitcnt vmcnt(58)
v_perm_b32 v138, v5, v4, s46
v_perm_b32 v70, v5, v4, s47
s_mov_b32 s20, 3145728
buffer_load_dword v4, v1, s[12:15], s20 offen
s_mov_b32 s21, 3178496
buffer_load_dword v5, v1, s[12:15], s21 offen
s_waitcnt vmcnt(58)
v_perm_b32 v139, v7, v6, s46
v_perm_b32 v71, v7, v6, s47
ds_write_b128 v3, v[68:71] offset:4096
s_waitcnt lgkmcnt(0)
s_mov_b32 s20, 3211264
buffer_load_dword v6, v1, s[12:15], s20 offen
s_mov_b32 s21, 3244032
buffer_load_dword v7, v1, s[12:15], s21 offen
s_waitcnt vmcnt(58)
v_perm_b32 v140, v9, v8, s46
v_perm_b32 v68, v9, v8, s47
s_mov_b32 s20, 3153920
buffer_load_dword v8, v1, s[12:15], s20 offen
s_mov_b32 s21, 3186688
buffer_load_dword v9, v1, s[12:15], s21 offen
s_waitcnt vmcnt(58)
v_perm_b32 v141, v11, v10, s46
v_perm_b32 v69, v11, v10, s47
s_mov_b32 s20, 3219456
buffer_load_dword v10, v1, s[12:15], s20 offen
s_mov_b32 s21, 3252224
buffer_load_dword v11, v1, s[12:15], s21 offen
s_waitcnt vmcnt(58)
v_perm_b32 v142, v13, v12, s46
v_perm_b32 v70, v13, v12, s47
s_mov_b32 s20, 3407872
buffer_load_dword v12, v1, s[12:15], s20 offen
s_mov_b32 s21, 3440640
buffer_load_dword v13, v1, s[12:15], s21 offen
s_waitcnt vmcnt(58)
v_perm_b32 v143, v15, v14, s46
v_perm_b32 v71, v15, v14, s47
ds_write_b128 v3, v[68:71] offset:5120
s_waitcnt lgkmcnt(0)
s_mov_b32 s20, 3473408
buffer_load_dword v14, v1, s[12:15], s20 offen
s_mov_b32 s21, 3506176
buffer_load_dword v15, v1, s[12:15], s21 offen
s_waitcnt vmcnt(58)
v_perm_b32 v160, v17, v16, s46
v_perm_b32 v68, v17, v16, s47
s_mov_b32 s20, 3416064
buffer_load_dword v16, v1, s[12:15], s20 offen
s_mov_b32 s21, 3448832
buffer_load_dword v17, v1, s[12:15], s21 offen
s_waitcnt vmcnt(58)
v_perm_b32 v161, v19, v18, s46
v_perm_b32 v69, v19, v18, s47
s_mov_b32 s20, 3481600
buffer_load_dword v18, v1, s[12:15], s20 offen
s_mov_b32 s21, 3514368
buffer_load_dword v19, v1, s[12:15], s21 offen
s_waitcnt vmcnt(58)
v_perm_b32 v162, v21, v20, s46
v_perm_b32 v70, v21, v20, s47
s_mov_b32 s20, 3670016
buffer_load_dword v20, v1, s[12:15], s20 offen
s_mov_b32 s21, 3702784
buffer_load_dword v21, v1, s[12:15], s21 offen
s_waitcnt vmcnt(58)
v_perm_b32 v163, v23, v22, s46
v_perm_b32 v71, v23, v22, s47
ds_write_b128 v3, v[68:71] offset:6144
s_waitcnt lgkmcnt(0)
s_mov_b32 s20, 3735552
buffer_load_dword v22, v1, s[12:15], s20 offen
s_mov_b32 s21, 3768320
buffer_load_dword v23, v1, s[12:15], s21 offen
s_waitcnt vmcnt(58)
v_perm_b32 v164, v25, v24, s46
v_perm_b32 v68, v25, v24, s47
s_mov_b32 s20, 3678208
buffer_load_dword v24, v1, s[12:15], s20 offen
s_mov_b32 s21, 3710976
buffer_load_dword v25, v1, s[12:15], s21 offen
s_waitcnt vmcnt(58)
v_perm_b32 v165, v27, v26, s46
v_perm_b32 v69, v27, v26, s47
s_mov_b32 s20, 3743744
buffer_load_dword v26, v1, s[12:15], s20 offen
s_mov_b32 s21, 3776512
buffer_load_dword v27, v1, s[12:15], s21 offen
s_waitcnt vmcnt(58)
v_perm_b32 v166, v29, v28, s46
v_perm_b32 v70, v29, v28, s47
s_mov_b32 s20, 3932160
buffer_load_dword v28, v1, s[12:15], s20 offen
s_mov_b32 s21, 3964928
buffer_load_dword v29, v1, s[12:15], s21 offen
s_waitcnt vmcnt(58)
v_perm_b32 v167, v31, v30, s46
v_perm_b32 v71, v31, v30, s47
ds_write_b128 v3, v[68:71] offset:7168
s_waitcnt lgkmcnt(0)
s_mov_b32 s20, 3997696
buffer_load_dword v30, v1, s[12:15], s20 offen
s_mov_b32 s21, 4030464
buffer_load_dword v31, v1, s[12:15], s21 offen
s_waitcnt vmcnt(58)
v_perm_b32 v184, v33, v32, s46
v_perm_b32 v68, v33, v32, s47
s_mov_b32 s20, 3940352
buffer_load_dword v32, v1, s[12:15], s20 offen
s_mov_b32 s21, 3973120
buffer_load_dword v33, v1, s[12:15], s21 offen
s_waitcnt vmcnt(58)
v_perm_b32 v185, v35, v34, s46
v_perm_b32 v69, v35, v34, s47
s_mov_b32 s20, 4005888
buffer_load_dword v34, v1, s[12:15], s20 offen
s_mov_b32 s21, 4038656
buffer_load_dword v35, v1, s[12:15], s21 offen
s_waitcnt vmcnt(58)
v_perm_b32 v186, v37, v36, s46
v_perm_b32 v70, v37, v36, s47
s_mov_b32 s20, 4194304
buffer_load_dword v36, v1, s[12:15], s20 offen
s_mov_b32 s21, 4227072
buffer_load_dword v37, v1, s[12:15], s21 offen
s_waitcnt vmcnt(58)
v_perm_b32 v187, v39, v38, s46
v_perm_b32 v71, v39, v38, s47
ds_write_b128 v3, v[68:71] offset:8192
s_waitcnt lgkmcnt(0)
s_mov_b32 s20, 4259840
buffer_load_dword v38, v1, s[12:15], s20 offen
s_mov_b32 s21, 4292608
buffer_load_dword v39, v1, s[12:15], s21 offen
s_waitcnt vmcnt(58)
v_perm_b32 v188, v41, v40, s46
v_perm_b32 v68, v41, v40, s47
s_mov_b32 s20, 4202496
buffer_load_dword v40, v1, s[12:15], s20 offen
s_mov_b32 s21, 4235264
buffer_load_dword v41, v1, s[12:15], s21 offen
s_waitcnt vmcnt(58)
v_perm_b32 v189, v43, v42, s46
v_perm_b32 v69, v43, v42, s47
s_mov_b32 s20, 4268032
buffer_load_dword v42, v1, s[12:15], s20 offen
s_mov_b32 s21, 4300800
buffer_load_dword v43, v1, s[12:15], s21 offen
s_waitcnt vmcnt(58)
v_perm_b32 v190, v45, v44, s46
v_perm_b32 v70, v45, v44, s47
s_mov_b32 s20, 4456448
buffer_load_dword v44, v1, s[12:15], s20 offen
s_mov_b32 s21, 4489216
buffer_load_dword v45, v1, s[12:15], s21 offen
s_waitcnt vmcnt(58)
v_perm_b32 v191, v47, v46, s46
v_perm_b32 v71, v47, v46, s47
ds_write_b128 v3, v[68:71] offset:9216
s_waitcnt lgkmcnt(0)
s_mov_b32 s20, 4521984
buffer_load_dword v46, v1, s[12:15], s20 offen
s_mov_b32 s21, 4554752
buffer_load_dword v47, v1, s[12:15], s21 offen
s_waitcnt vmcnt(58)
v_perm_b32 v208, v49, v48, s46
v_perm_b32 v68, v49, v48, s47
s_mov_b32 s20, 4464640
buffer_load_dword v48, v1, s[12:15], s20 offen
s_mov_b32 s21, 4497408
buffer_load_dword v49, v1, s[12:15], s21 offen
s_waitcnt vmcnt(58)
v_perm_b32 v209, v51, v50, s46
v_perm_b32 v69, v51, v50, s47
s_mov_b32 s20, 4530176
buffer_load_dword v50, v1, s[12:15], s20 offen
s_mov_b32 s21, 4562944
buffer_load_dword v51, v1, s[12:15], s21 offen
s_waitcnt vmcnt(58)
v_perm_b32 v210, v53, v52, s46
v_perm_b32 v70, v53, v52, s47
s_load_dwordx2 s[50:51], s[0:1], 80
s_waitcnt lgkmcnt(0)
s_mov_b32 s12, s50
s_and_b32 s13, s51, 0xffff
s_mov_b32 s14, 4718592
s_mov_b32 s15, 0x20000
s_mov_b32 s20, 0
buffer_load_dword v52, v1, s[12:15], s20 offen
s_mov_b32 s21, 32768
buffer_load_dword v53, v1, s[12:15], s21 offen
s_waitcnt vmcnt(58)
v_perm_b32 v211, v55, v54, s46
v_perm_b32 v71, v55, v54, s47
ds_write_b128 v3, v[68:71] offset:10240
s_waitcnt lgkmcnt(0)
s_mov_b32 s20, 65536
buffer_load_dword v54, v1, s[12:15], s20 offen
s_mov_b32 s21, 98304
buffer_load_dword v55, v1, s[12:15], s21 offen
s_waitcnt vmcnt(58)
v_perm_b32 v212, v57, v56, s46
v_perm_b32 v68, v57, v56, s47
s_mov_b32 s20, 8192
buffer_load_dword v56, v1, s[12:15], s20 offen
s_mov_b32 s21, 40960
buffer_load_dword v57, v1, s[12:15], s21 offen
s_waitcnt vmcnt(58)
v_perm_b32 v213, v59, v58, s46
v_perm_b32 v69, v59, v58, s47
s_mov_b32 s20, 73728
buffer_load_dword v58, v1, s[12:15], s20 offen
s_mov_b32 s21, 106496
buffer_load_dword v59, v1, s[12:15], s21 offen
s_waitcnt vmcnt(58)
v_perm_b32 v214, v61, v60, s46
v_perm_b32 v70, v61, v60, s47
s_mov_b32 s20, 262144
buffer_load_dword v60, v1, s[12:15], s20 offen
s_mov_b32 s21, 294912
buffer_load_dword v61, v1, s[12:15], s21 offen
s_waitcnt vmcnt(58)
v_perm_b32 v215, v63, v62, s46
v_perm_b32 v71, v63, v62, s47
ds_write_b128 v3, v[68:71] offset:11264
s_waitcnt lgkmcnt(0)
s_mov_b32 s20, 327680
buffer_load_dword v62, v1, s[12:15], s20 offen
s_mov_b32 s21, 360448
buffer_load_dword v63, v1, s[12:15], s21 offen
s_waitcnt vmcnt(58)
v_perm_b32 v232, v5, v4, s46
v_perm_b32 v68, v5, v4, s47
s_mov_b32 s20, 270336
buffer_load_dword v4, v1, s[12:15], s20 offen
s_mov_b32 s21, 303104
buffer_load_dword v5, v1, s[12:15], s21 offen
s_waitcnt vmcnt(58)
v_perm_b32 v233, v7, v6, s46
v_perm_b32 v69, v7, v6, s47
s_mov_b32 s20, 335872
buffer_load_dword v6, v1, s[12:15], s20 offen
s_mov_b32 s21, 368640
buffer_load_dword v7, v1, s[12:15], s21 offen
s_waitcnt vmcnt(58)
v_perm_b32 v234, v9, v8, s46
v_perm_b32 v70, v9, v8, s47
s_mov_b32 s20, 524288
buffer_load_dword v8, v1, s[12:15], s20 offen
s_mov_b32 s21, 557056
buffer_load_dword v9, v1, s[12:15], s21 offen
s_waitcnt vmcnt(58)
v_perm_b32 v235, v11, v10, s46
v_perm_b32 v71, v11, v10, s47
ds_write_b128 v3, v[68:71] offset:12288
s_waitcnt lgkmcnt(0)
s_mov_b32 s20, 589824
buffer_load_dword v10, v1, s[12:15], s20 offen
s_mov_b32 s21, 622592
buffer_load_dword v11, v1, s[12:15], s21 offen
s_waitcnt vmcnt(58)
v_perm_b32 v236, v13, v12, s46
v_perm_b32 v68, v13, v12, s47
s_mov_b32 s20, 532480
buffer_load_dword v12, v1, s[12:15], s20 offen
s_mov_b32 s21, 565248
buffer_load_dword v13, v1, s[12:15], s21 offen
s_waitcnt vmcnt(58)
v_perm_b32 v237, v15, v14, s46
v_perm_b32 v69, v15, v14, s47
s_mov_b32 s20, 598016
buffer_load_dword v14, v1, s[12:15], s20 offen
s_mov_b32 s21, 630784
buffer_load_dword v15, v1, s[12:15], s21 offen
s_waitcnt vmcnt(58)
v_perm_b32 v238, v17, v16, s46
v_perm_b32 v70, v17, v16, s47
s_mov_b32 s20, 786432
buffer_load_dword v16, v1, s[12:15], s20 offen
s_mov_b32 s21, 819200
buffer_load_dword v17, v1, s[12:15], s21 offen
s_waitcnt vmcnt(58)
v_perm_b32 v239, v19, v18, s46
v_perm_b32 v71, v19, v18, s47
ds_write_b128 v3, v[68:71] offset:13312
s_waitcnt lgkmcnt(0)
s_mov_b32 s20, 851968
buffer_load_dword v18, v1, s[12:15], s20 offen
s_mov_b32 s21, 884736
buffer_load_dword v19, v1, s[12:15], s21 offen
s_waitcnt vmcnt(58)
v_perm_b32 v64, v21, v20, s46
v_accvgpr_write_b32 a0, v64
v_perm_b32 v68, v21, v20, s47
s_mov_b32 s20, 794624
buffer_load_dword v20, v1, s[12:15], s20 offen
s_mov_b32 s21, 827392
buffer_load_dword v21, v1, s[12:15], s21 offen
s_waitcnt vmcnt(58)
v_perm_b32 v65, v23, v22, s46
v_accvgpr_write_b32 a1, v65
v_perm_b32 v69, v23, v22, s47
s_mov_b32 s20, 860160
buffer_load_dword v22, v1, s[12:15], s20 offen
s_mov_b32 s21, 892928
buffer_load_dword v23, v1, s[12:15], s21 offen
s_waitcnt vmcnt(58)
v_perm_b32 v66, v25, v24, s46
v_accvgpr_write_b32 a2, v66
v_perm_b32 v70, v25, v24, s47
s_mov_b32 s20, 1048576
buffer_load_dword v24, v1, s[12:15], s20 offen
s_mov_b32 s21, 1081344
buffer_load_dword v25, v1, s[12:15], s21 offen
s_waitcnt vmcnt(58)
v_perm_b32 v67, v27, v26, s46
v_accvgpr_write_b32 a3, v67
v_perm_b32 v71, v27, v26, s47
ds_write_b128 v3, v[68:71] offset:14336
s_waitcnt lgkmcnt(0)
s_mov_b32 s20, 1114112
buffer_load_dword v26, v1, s[12:15], s20 offen
s_mov_b32 s21, 1146880
buffer_load_dword v27, v1, s[12:15], s21 offen
s_waitcnt vmcnt(58)
v_perm_b32 v64, v29, v28, s46
v_accvgpr_write_b32 a4, v64
v_perm_b32 v68, v29, v28, s47
s_mov_b32 s20, 1056768
buffer_load_dword v28, v1, s[12:15], s20 offen
s_mov_b32 s21, 1089536
buffer_load_dword v29, v1, s[12:15], s21 offen
s_waitcnt vmcnt(58)
v_perm_b32 v65, v31, v30, s46
v_accvgpr_write_b32 a5, v65
v_perm_b32 v69, v31, v30, s47
s_mov_b32 s20, 1122304
buffer_load_dword v30, v1, s[12:15], s20 offen
s_mov_b32 s21, 1155072
buffer_load_dword v31, v1, s[12:15], s21 offen
s_waitcnt vmcnt(58)
v_perm_b32 v66, v33, v32, s46
v_accvgpr_write_b32 a6, v66
v_perm_b32 v70, v33, v32, s47
s_mov_b32 s20, 1310720
buffer_load_dword v32, v1, s[12:15], s20 offen
s_mov_b32 s21, 1343488
buffer_load_dword v33, v1, s[12:15], s21 offen
s_waitcnt vmcnt(58)
v_perm_b32 v67, v35, v34, s46
v_accvgpr_write_b32 a7, v67
v_perm_b32 v71, v35, v34, s47
ds_write_b128 v3, v[68:71] offset:15360
s_waitcnt lgkmcnt(0)
s_mov_b32 s20, 1376256
buffer_load_dword v34, v1, s[12:15], s20 offen
s_mov_b32 s21, 1409024
buffer_load_dword v35, v1, s[12:15], s21 offen
s_waitcnt vmcnt(58)
v_perm_b32 v64, v37, v36, s46
v_accvgpr_write_b32 a24, v64
v_perm_b32 v68, v37, v36, s47
s_mov_b32 s20, 1318912
buffer_load_dword v36, v1, s[12:15], s20 offen
s_mov_b32 s21, 1351680
buffer_load_dword v37, v1, s[12:15], s21 offen
s_waitcnt vmcnt(58)
v_perm_b32 v65, v39, v38, s46
v_accvgpr_write_b32 a25, v65
v_perm_b32 v69, v39, v38, s47
s_mov_b32 s20, 1384448
buffer_load_dword v38, v1, s[12:15], s20 offen
s_mov_b32 s21, 1417216
buffer_load_dword v39, v1, s[12:15], s21 offen
s_waitcnt vmcnt(58)
v_perm_b32 v66, v41, v40, s46
v_accvgpr_write_b32 a26, v66
v_perm_b32 v70, v41, v40, s47
s_mov_b32 s20, 1572864
buffer_load_dword v40, v1, s[12:15], s20 offen
s_mov_b32 s21, 1605632
buffer_load_dword v41, v1, s[12:15], s21 offen
s_waitcnt vmcnt(58)
v_perm_b32 v67, v43, v42, s46
v_accvgpr_write_b32 a27, v67
v_perm_b32 v71, v43, v42, s47
ds_write_b128 v3, v[68:71] offset:16384
s_waitcnt lgkmcnt(0)
s_mov_b32 s20, 1638400
buffer_load_dword v42, v1, s[12:15], s20 offen
s_mov_b32 s21, 1671168
buffer_load_dword v43, v1, s[12:15], s21 offen
s_waitcnt vmcnt(58)
v_perm_b32 v64, v45, v44, s46
v_accvgpr_write_b32 a28, v64
v_perm_b32 v68, v45, v44, s47
s_mov_b32 s20, 1581056
buffer_load_dword v44, v1, s[12:15], s20 offen
s_mov_b32 s21, 1613824
buffer_load_dword v45, v1, s[12:15], s21 offen
s_waitcnt vmcnt(58)
v_perm_b32 v65, v47, v46, s46
v_accvgpr_write_b32 a29, v65
v_perm_b32 v69, v47, v46, s47
s_mov_b32 s20, 1646592
buffer_load_dword v46, v1, s[12:15], s20 offen
s_mov_b32 s21, 1679360
buffer_load_dword v47, v1, s[12:15], s21 offen
s_waitcnt vmcnt(58)
v_perm_b32 v66, v49, v48, s46
v_accvgpr_write_b32 a30, v66
v_perm_b32 v70, v49, v48, s47
s_mov_b32 s20, 1835008
buffer_load_dword v48, v1, s[12:15], s20 offen
s_mov_b32 s21, 1867776
buffer_load_dword v49, v1, s[12:15], s21 offen
s_waitcnt vmcnt(58)
v_perm_b32 v67, v51, v50, s46
v_accvgpr_write_b32 a31, v67
v_perm_b32 v71, v51, v50, s47
ds_write_b128 v3, v[68:71] offset:17408
s_waitcnt lgkmcnt(0)
s_mov_b32 s20, 1900544
buffer_load_dword v50, v1, s[12:15], s20 offen
s_mov_b32 s21, 1933312
buffer_load_dword v51, v1, s[12:15], s21 offen
s_waitcnt vmcnt(58)
v_perm_b32 v64, v53, v52, s46
v_accvgpr_write_b32 a32, v64
v_perm_b32 v68, v53, v52, s47
v_accvgpr_write_b32 a40, v68
s_mov_b32 s20, 1843200
buffer_load_dword v52, v1, s[12:15], s20 offen
s_mov_b32 s21, 1875968
buffer_load_dword v53, v1, s[12:15], s21 offen
s_waitcnt vmcnt(58)
v_perm_b32 v65, v55, v54, s46
v_accvgpr_write_b32 a33, v65
v_perm_b32 v69, v55, v54, s47
v_accvgpr_write_b32 a41, v69
s_mov_b32 s20, 1908736
buffer_load_dword v54, v1, s[12:15], s20 offen
s_mov_b32 s21, 1941504
buffer_load_dword v55, v1, s[12:15], s21 offen
s_waitcnt vmcnt(58)
v_perm_b32 v66, v57, v56, s46
v_accvgpr_write_b32 a34, v66
v_perm_b32 v70, v57, v56, s47
v_accvgpr_write_b32 a42, v70
s_mov_b32 s20, 2097152
buffer_load_dword v56, v1, s[12:15], s20 offen
s_mov_b32 s21, 2129920
buffer_load_dword v57, v1, s[12:15], s21 offen
s_waitcnt vmcnt(58)
v_perm_b32 v67, v59, v58, s46
v_accvgpr_write_b32 a35, v67
v_perm_b32 v71, v59, v58, s47
v_accvgpr_write_b32 a43, v71
s_mov_b32 s20, 2162688
buffer_load_dword v58, v1, s[12:15], s20 offen
s_mov_b32 s21, 2195456
buffer_load_dword v59, v1, s[12:15], s21 offen
s_waitcnt vmcnt(58)
v_perm_b32 v64, v61, v60, s46
v_accvgpr_write_b32 a36, v64
v_perm_b32 v68, v61, v60, s47
v_accvgpr_write_b32 a44, v68
s_mov_b32 s20, 2105344
buffer_load_dword v60, v1, s[12:15], s20 offen
s_mov_b32 s21, 2138112
buffer_load_dword v61, v1, s[12:15], s21 offen
s_waitcnt vmcnt(58)
v_perm_b32 v65, v63, v62, s46
v_accvgpr_write_b32 a37, v65
v_perm_b32 v69, v63, v62, s47
v_accvgpr_write_b32 a45, v69
s_mov_b32 s20, 2170880
buffer_load_dword v62, v1, s[12:15], s20 offen
s_mov_b32 s21, 2203648
buffer_load_dword v63, v1, s[12:15], s21 offen
s_waitcnt vmcnt(58)
v_perm_b32 v66, v5, v4, s46
v_accvgpr_write_b32 a38, v66
v_perm_b32 v70, v5, v4, s47
v_accvgpr_write_b32 a46, v70
s_mov_b32 s20, 2359296
buffer_load_dword v4, v1, s[12:15], s20 offen
s_mov_b32 s21, 2392064
buffer_load_dword v5, v1, s[12:15], s21 offen
s_waitcnt vmcnt(58)
v_perm_b32 v67, v7, v6, s46
v_accvgpr_write_b32 a39, v67
v_perm_b32 v71, v7, v6, s47
v_accvgpr_write_b32 a47, v71
s_mov_b32 s20, 2424832
buffer_load_dword v6, v1, s[12:15], s20 offen
s_mov_b32 s21, 2457600
buffer_load_dword v7, v1, s[12:15], s21 offen
s_waitcnt vmcnt(58)
v_perm_b32 v64, v9, v8, s46
v_accvgpr_write_b32 a48, v64
v_perm_b32 v68, v9, v8, s47
v_accvgpr_write_b32 a56, v68
s_mov_b32 s20, 2367488
buffer_load_dword v8, v1, s[12:15], s20 offen
s_mov_b32 s21, 2400256
buffer_load_dword v9, v1, s[12:15], s21 offen
s_waitcnt vmcnt(58)
v_perm_b32 v65, v11, v10, s46
v_accvgpr_write_b32 a49, v65
v_perm_b32 v69, v11, v10, s47
v_accvgpr_write_b32 a57, v69
s_mov_b32 s20, 2433024
buffer_load_dword v10, v1, s[12:15], s20 offen
s_mov_b32 s21, 2465792
buffer_load_dword v11, v1, s[12:15], s21 offen
s_waitcnt vmcnt(58)
v_perm_b32 v66, v13, v12, s46
v_accvgpr_write_b32 a50, v66
v_perm_b32 v70, v13, v12, s47
v_accvgpr_write_b32 a58, v70
s_mov_b32 s20, 2621440
buffer_load_dword v12, v1, s[12:15], s20 offen
s_mov_b32 s21, 2654208
buffer_load_dword v13, v1, s[12:15], s21 offen
s_waitcnt vmcnt(58)
v_perm_b32 v67, v15, v14, s46
v_accvgpr_write_b32 a51, v67
v_perm_b32 v71, v15, v14, s47
v_accvgpr_write_b32 a59, v71
s_mov_b32 s20, 2686976
buffer_load_dword v14, v1, s[12:15], s20 offen
s_mov_b32 s21, 2719744
buffer_load_dword v15, v1, s[12:15], s21 offen
s_waitcnt vmcnt(58)
v_perm_b32 v64, v17, v16, s46
v_accvgpr_write_b32 a52, v64
v_perm_b32 v68, v17, v16, s47
v_accvgpr_write_b32 a60, v68
s_mov_b32 s20, 2629632
buffer_load_dword v16, v1, s[12:15], s20 offen
s_mov_b32 s21, 2662400
buffer_load_dword v17, v1, s[12:15], s21 offen
s_waitcnt vmcnt(58)
v_perm_b32 v65, v19, v18, s46
v_accvgpr_write_b32 a53, v65
v_perm_b32 v69, v19, v18, s47
v_accvgpr_write_b32 a61, v69
s_mov_b32 s20, 2695168
buffer_load_dword v18, v1, s[12:15], s20 offen
s_mov_b32 s21, 2727936
buffer_load_dword v19, v1, s[12:15], s21 offen
s_waitcnt vmcnt(58)
v_perm_b32 v66, v21, v20, s46
v_accvgpr_write_b32 a54, v66
v_perm_b32 v70, v21, v20, s47
v_accvgpr_write_b32 a62, v70
s_mov_b32 s20, 2883584
buffer_load_dword v20, v1, s[12:15], s20 offen
s_mov_b32 s21, 2916352
buffer_load_dword v21, v1, s[12:15], s21 offen
s_waitcnt vmcnt(58)
v_perm_b32 v67, v23, v22, s46
v_accvgpr_write_b32 a55, v67
v_perm_b32 v71, v23, v22, s47
v_accvgpr_write_b32 a63, v71
s_mov_b32 s20, 2949120
buffer_load_dword v22, v1, s[12:15], s20 offen
s_mov_b32 s21, 2981888
buffer_load_dword v23, v1, s[12:15], s21 offen
s_waitcnt vmcnt(58)
v_perm_b32 v64, v25, v24, s46
v_accvgpr_write_b32 a64, v64
v_perm_b32 v68, v25, v24, s47
v_accvgpr_write_b32 a72, v68
s_mov_b32 s20, 2891776
buffer_load_dword v24, v1, s[12:15], s20 offen
s_mov_b32 s21, 2924544
buffer_load_dword v25, v1, s[12:15], s21 offen
s_waitcnt vmcnt(58)
v_perm_b32 v65, v27, v26, s46
v_accvgpr_write_b32 a65, v65
v_perm_b32 v69, v27, v26, s47
v_accvgpr_write_b32 a73, v69
s_mov_b32 s20, 2957312
buffer_load_dword v26, v1, s[12:15], s20 offen
s_mov_b32 s21, 2990080
buffer_load_dword v27, v1, s[12:15], s21 offen
s_waitcnt vmcnt(58)
v_perm_b32 v66, v29, v28, s46
v_accvgpr_write_b32 a66, v66
v_perm_b32 v70, v29, v28, s47
v_accvgpr_write_b32 a74, v70
s_mov_b32 s20, 3145728
buffer_load_dword v28, v1, s[12:15], s20 offen
s_mov_b32 s21, 3178496
buffer_load_dword v29, v1, s[12:15], s21 offen
s_waitcnt vmcnt(58)
v_perm_b32 v67, v31, v30, s46
v_accvgpr_write_b32 a67, v67
v_perm_b32 v71, v31, v30, s47
v_accvgpr_write_b32 a75, v71
s_mov_b32 s20, 3211264
buffer_load_dword v30, v1, s[12:15], s20 offen
s_mov_b32 s21, 3244032
buffer_load_dword v31, v1, s[12:15], s21 offen
s_waitcnt vmcnt(58)
v_perm_b32 v64, v33, v32, s46
v_accvgpr_write_b32 a68, v64
v_perm_b32 v68, v33, v32, s47
v_accvgpr_write_b32 a76, v68
s_mov_b32 s20, 3153920
buffer_load_dword v32, v1, s[12:15], s20 offen
s_mov_b32 s21, 3186688
buffer_load_dword v33, v1, s[12:15], s21 offen
s_waitcnt vmcnt(58)
v_perm_b32 v65, v35, v34, s46
v_accvgpr_write_b32 a69, v65
v_perm_b32 v69, v35, v34, s47
v_accvgpr_write_b32 a77, v69
s_mov_b32 s20, 3219456
buffer_load_dword v34, v1, s[12:15], s20 offen
s_mov_b32 s21, 3252224
buffer_load_dword v35, v1, s[12:15], s21 offen
s_waitcnt vmcnt(58)
v_perm_b32 v66, v37, v36, s46
v_accvgpr_write_b32 a70, v66
v_perm_b32 v70, v37, v36, s47
v_accvgpr_write_b32 a78, v70
s_mov_b32 s20, 3407872
buffer_load_dword v36, v1, s[12:15], s20 offen
s_mov_b32 s21, 3440640
buffer_load_dword v37, v1, s[12:15], s21 offen
s_waitcnt vmcnt(58)
v_perm_b32 v67, v39, v38, s46
v_accvgpr_write_b32 a71, v67
v_perm_b32 v71, v39, v38, s47
v_accvgpr_write_b32 a79, v71
s_mov_b32 s20, 3473408
buffer_load_dword v38, v1, s[12:15], s20 offen
s_mov_b32 s21, 3506176
buffer_load_dword v39, v1, s[12:15], s21 offen
s_waitcnt vmcnt(58)
v_perm_b32 v64, v41, v40, s46
v_accvgpr_write_b32 a80, v64
v_perm_b32 v68, v41, v40, s47
v_accvgpr_write_b32 a88, v68
s_mov_b32 s20, 3416064
buffer_load_dword v40, v1, s[12:15], s20 offen
s_mov_b32 s21, 3448832
buffer_load_dword v41, v1, s[12:15], s21 offen
s_waitcnt vmcnt(58)
v_perm_b32 v65, v43, v42, s46
v_accvgpr_write_b32 a81, v65
v_perm_b32 v69, v43, v42, s47
v_accvgpr_write_b32 a89, v69
s_mov_b32 s20, 3481600
buffer_load_dword v42, v1, s[12:15], s20 offen
s_mov_b32 s21, 3514368
buffer_load_dword v43, v1, s[12:15], s21 offen
s_waitcnt vmcnt(58)
v_perm_b32 v66, v45, v44, s46
v_accvgpr_write_b32 a82, v66
v_perm_b32 v70, v45, v44, s47
v_accvgpr_write_b32 a90, v70
s_mov_b32 s20, 3670016
buffer_load_dword v44, v1, s[12:15], s20 offen
s_mov_b32 s21, 3702784
buffer_load_dword v45, v1, s[12:15], s21 offen
s_waitcnt vmcnt(58)
v_perm_b32 v67, v47, v46, s46
v_accvgpr_write_b32 a83, v67
v_perm_b32 v71, v47, v46, s47
v_accvgpr_write_b32 a91, v71
s_mov_b32 s20, 3735552
buffer_load_dword v46, v1, s[12:15], s20 offen
s_mov_b32 s21, 3768320
buffer_load_dword v47, v1, s[12:15], s21 offen
s_waitcnt vmcnt(58)
v_perm_b32 v64, v49, v48, s46
v_accvgpr_write_b32 a84, v64
v_perm_b32 v68, v49, v48, s47
v_accvgpr_write_b32 a92, v68
s_mov_b32 s20, 3678208
buffer_load_dword v48, v1, s[12:15], s20 offen
s_mov_b32 s21, 3710976
buffer_load_dword v49, v1, s[12:15], s21 offen
s_waitcnt vmcnt(58)
v_perm_b32 v65, v51, v50, s46
v_accvgpr_write_b32 a85, v65
v_perm_b32 v69, v51, v50, s47
v_accvgpr_write_b32 a93, v69
s_mov_b32 s20, 3743744
buffer_load_dword v50, v1, s[12:15], s20 offen
s_mov_b32 s21, 3776512
buffer_load_dword v51, v1, s[12:15], s21 offen
s_waitcnt vmcnt(58)
v_perm_b32 v66, v53, v52, s46
v_accvgpr_write_b32 a86, v66
v_perm_b32 v70, v53, v52, s47
v_accvgpr_write_b32 a94, v70
s_mov_b32 s20, 3932160
buffer_load_dword v52, v1, s[12:15], s20 offen
s_mov_b32 s21, 3964928
buffer_load_dword v53, v1, s[12:15], s21 offen
s_waitcnt vmcnt(58)
v_perm_b32 v67, v55, v54, s46
v_accvgpr_write_b32 a87, v67
v_perm_b32 v71, v55, v54, s47
v_accvgpr_write_b32 a95, v71
s_mov_b32 s20, 3997696
buffer_load_dword v54, v1, s[12:15], s20 offen
s_mov_b32 s21, 4030464
buffer_load_dword v55, v1, s[12:15], s21 offen
s_waitcnt vmcnt(58)
v_perm_b32 v64, v57, v56, s46
v_accvgpr_write_b32 a96, v64
v_perm_b32 v68, v57, v56, s47
v_accvgpr_write_b32 a104, v68
s_mov_b32 s20, 3940352
buffer_load_dword v56, v1, s[12:15], s20 offen
s_mov_b32 s21, 3973120
buffer_load_dword v57, v1, s[12:15], s21 offen
s_waitcnt vmcnt(58)
v_perm_b32 v65, v59, v58, s46
v_accvgpr_write_b32 a97, v65
v_perm_b32 v69, v59, v58, s47
v_accvgpr_write_b32 a105, v69
s_mov_b32 s20, 4005888
buffer_load_dword v58, v1, s[12:15], s20 offen
s_mov_b32 s21, 4038656
buffer_load_dword v59, v1, s[12:15], s21 offen
s_waitcnt vmcnt(58)
v_perm_b32 v66, v61, v60, s46
v_accvgpr_write_b32 a98, v66
v_perm_b32 v70, v61, v60, s47
v_accvgpr_write_b32 a106, v70
s_mov_b32 s20, 4194304
buffer_load_dword v60, v1, s[12:15], s20 offen
s_mov_b32 s21, 4227072
buffer_load_dword v61, v1, s[12:15], s21 offen
s_waitcnt vmcnt(58)
v_perm_b32 v67, v63, v62, s46
v_accvgpr_write_b32 a99, v67
v_perm_b32 v71, v63, v62, s47
v_accvgpr_write_b32 a107, v71
s_mov_b32 s20, 4259840
buffer_load_dword v62, v1, s[12:15], s20 offen
s_mov_b32 s21, 4292608
buffer_load_dword v63, v1, s[12:15], s21 offen
s_waitcnt vmcnt(58)
v_perm_b32 v64, v5, v4, s46
v_accvgpr_write_b32 a100, v64
v_perm_b32 v68, v5, v4, s47
v_accvgpr_write_b32 a108, v68
s_mov_b32 s20, 4202496
buffer_load_dword v4, v1, s[12:15], s20 offen
s_mov_b32 s21, 4235264
buffer_load_dword v5, v1, s[12:15], s21 offen
s_waitcnt vmcnt(58)
v_perm_b32 v65, v7, v6, s46
v_accvgpr_write_b32 a101, v65
v_perm_b32 v69, v7, v6, s47
v_accvgpr_write_b32 a109, v69
s_mov_b32 s20, 4268032
buffer_load_dword v6, v1, s[12:15], s20 offen
s_mov_b32 s21, 4300800
buffer_load_dword v7, v1, s[12:15], s21 offen
s_waitcnt vmcnt(58)
v_perm_b32 v66, v9, v8, s46
v_accvgpr_write_b32 a102, v66
v_perm_b32 v70, v9, v8, s47
v_accvgpr_write_b32 a110, v70
s_mov_b32 s20, 4456448
buffer_load_dword v8, v1, s[12:15], s20 offen
s_mov_b32 s21, 4489216
buffer_load_dword v9, v1, s[12:15], s21 offen
s_waitcnt vmcnt(58)
v_perm_b32 v67, v11, v10, s46
v_accvgpr_write_b32 a103, v67
v_perm_b32 v71, v11, v10, s47
v_accvgpr_write_b32 a111, v71
s_mov_b32 s20, 4521984
buffer_load_dword v10, v1, s[12:15], s20 offen
s_mov_b32 s21, 4554752
buffer_load_dword v11, v1, s[12:15], s21 offen
s_waitcnt vmcnt(58)
v_perm_b32 v64, v13, v12, s46
v_accvgpr_write_b32 a112, v64
v_perm_b32 v68, v13, v12, s47
v_accvgpr_write_b32 a120, v68
s_mov_b32 s20, 4464640
buffer_load_dword v12, v1, s[12:15], s20 offen
s_mov_b32 s21, 4497408
buffer_load_dword v13, v1, s[12:15], s21 offen
s_waitcnt vmcnt(58)
v_perm_b32 v65, v15, v14, s46
v_accvgpr_write_b32 a113, v65
v_perm_b32 v69, v15, v14, s47
v_accvgpr_write_b32 a121, v69
s_mov_b32 s20, 4530176
buffer_load_dword v14, v1, s[12:15], s20 offen
s_mov_b32 s21, 4562944
buffer_load_dword v15, v1, s[12:15], s21 offen
s_waitcnt vmcnt(58)
v_perm_b32 v66, v17, v16, s46
v_accvgpr_write_b32 a114, v66
v_perm_b32 v70, v17, v16, s47
v_accvgpr_write_b32 a122, v70
s_load_dwordx2 s[50:51], s[0:1], 88
s_waitcnt lgkmcnt(0)
s_mov_b32 s12, s50
s_and_b32 s13, s51, 0xffff
s_mov_b32 s14, 4718592
s_mov_b32 s15, 0x20000
v_and_b32 v1, 15, v0
s_lshl_b32 s20, s17, 4
v_add_u32 v1, s20, v1
v_lshlrev_b32 v1, 1, v1
v_add_u32 v2, v2, v1
v_add_u32 v1, v2, v1
s_mov_b32 s20, 0
buffer_load_dword v16, v1, s[12:15], s20 offen
s_mov_b32 s21, 1152
buffer_load_dword v17, v1, s[12:15], s21 offen
s_waitcnt vmcnt(58)
v_perm_b32 v67, v19, v18, s46
v_accvgpr_write_b32 a115, v67
v_perm_b32 v71, v19, v18, s47
v_accvgpr_write_b32 a123, v71
s_mov_b32 s20, 9216
buffer_load_dword v18, v1, s[12:15], s20 offen
s_mov_b32 s21, 10368
buffer_load_dword v19, v1, s[12:15], s21 offen
s_waitcnt vmcnt(58)
v_perm_b32 v64, v21, v20, s46
v_accvgpr_write_b32 a116, v64
v_perm_b32 v68, v21, v20, s47
v_accvgpr_write_b32 a124, v68
s_mov_b32 s20, 2304
buffer_load_dword v20, v1, s[12:15], s20 offen
s_mov_b32 s21, 3456
buffer_load_dword v21, v1, s[12:15], s21 offen
s_waitcnt vmcnt(58)
v_perm_b32 v65, v23, v22, s46
v_accvgpr_write_b32 a117, v65
v_perm_b32 v69, v23, v22, s47
v_accvgpr_write_b32 a125, v69
s_mov_b32 s20, 11520
buffer_load_dword v22, v1, s[12:15], s20 offen
s_mov_b32 s21, 12672
buffer_load_dword v23, v1, s[12:15], s21 offen
s_waitcnt vmcnt(58)
v_perm_b32 v66, v25, v24, s46
v_accvgpr_write_b32 a118, v66
v_perm_b32 v70, v25, v24, s47
v_accvgpr_write_b32 a126, v70
s_mov_b32 s20, 36864
buffer_load_dword v24, v1, s[12:15], s20 offen
s_mov_b32 s21, 38016
buffer_load_dword v25, v1, s[12:15], s21 offen
s_waitcnt vmcnt(58)
v_perm_b32 v67, v27, v26, s46
v_accvgpr_write_b32 a119, v67
v_perm_b32 v71, v27, v26, s47
v_accvgpr_write_b32 a127, v71
s_mov_b32 s20, 46080
buffer_load_dword v26, v1, s[12:15], s20 offen
s_mov_b32 s21, 47232
buffer_load_dword v27, v1, s[12:15], s21 offen
s_waitcnt vmcnt(58)
v_perm_b32 v64, v29, v28, s46
v_accvgpr_write_b32 a128, v64
v_perm_b32 v68, v29, v28, s47
v_accvgpr_write_b32 a136, v68
s_mov_b32 s20, 39168
buffer_load_dword v28, v1, s[12:15], s20 offen
s_mov_b32 s21, 40320
buffer_load_dword v29, v1, s[12:15], s21 offen
s_waitcnt vmcnt(58)
v_perm_b32 v65, v31, v30, s46
v_accvgpr_write_b32 a129, v65
v_perm_b32 v69, v31, v30, s47
v_accvgpr_write_b32 a137, v69
s_mov_b32 s20, 48384
buffer_load_dword v30, v1, s[12:15], s20 offen
s_mov_b32 s21, 49536
buffer_load_dword v31, v1, s[12:15], s21 offen
s_waitcnt vmcnt(58)
v_perm_b32 v66, v33, v32, s46
v_accvgpr_write_b32 a130, v66
v_perm_b32 v70, v33, v32, s47
v_accvgpr_write_b32 a138, v70
s_mov_b32 s20, 73728
buffer_load_dword v32, v1, s[12:15], s20 offen
s_mov_b32 s21, 74880
buffer_load_dword v33, v1, s[12:15], s21 offen
s_waitcnt vmcnt(58)
v_perm_b32 v67, v35, v34, s46
v_accvgpr_write_b32 a131, v67
v_perm_b32 v71, v35, v34, s47
v_accvgpr_write_b32 a139, v71
s_mov_b32 s20, 82944
buffer_load_dword v34, v1, s[12:15], s20 offen
s_mov_b32 s21, 84096
buffer_load_dword v35, v1, s[12:15], s21 offen
s_waitcnt vmcnt(58)
v_perm_b32 v64, v37, v36, s46
v_accvgpr_write_b32 a132, v64
v_perm_b32 v68, v37, v36, s47
v_accvgpr_write_b32 a140, v68
s_mov_b32 s20, 76032
buffer_load_dword v36, v1, s[12:15], s20 offen
s_mov_b32 s21, 77184
buffer_load_dword v37, v1, s[12:15], s21 offen
s_waitcnt vmcnt(58)
v_perm_b32 v65, v39, v38, s46
v_accvgpr_write_b32 a133, v65
v_perm_b32 v69, v39, v38, s47
v_accvgpr_write_b32 a141, v69
s_mov_b32 s20, 85248
buffer_load_dword v38, v1, s[12:15], s20 offen
s_mov_b32 s21, 86400
buffer_load_dword v39, v1, s[12:15], s21 offen
s_waitcnt vmcnt(58)
v_perm_b32 v66, v41, v40, s46
v_accvgpr_write_b32 a134, v66
v_perm_b32 v70, v41, v40, s47
v_accvgpr_write_b32 a142, v70
s_mov_b32 s20, 110592
buffer_load_dword v40, v1, s[12:15], s20 offen
s_mov_b32 s21, 111744
buffer_load_dword v41, v1, s[12:15], s21 offen
s_waitcnt vmcnt(58)
v_perm_b32 v67, v43, v42, s46
v_accvgpr_write_b32 a135, v67
v_perm_b32 v71, v43, v42, s47
v_accvgpr_write_b32 a143, v71
s_mov_b32 s20, 119808
buffer_load_dword v42, v1, s[12:15], s20 offen
s_mov_b32 s21, 120960
buffer_load_dword v43, v1, s[12:15], s21 offen
s_waitcnt vmcnt(58)
v_perm_b32 v64, v45, v44, s46
v_accvgpr_write_b32 a144, v64
v_perm_b32 v68, v45, v44, s47
v_accvgpr_write_b32 a152, v68
s_mov_b32 s20, 112896
buffer_load_dword v44, v1, s[12:15], s20 offen
s_mov_b32 s21, 114048
buffer_load_dword v45, v1, s[12:15], s21 offen
s_waitcnt vmcnt(58)
v_perm_b32 v65, v47, v46, s46
v_accvgpr_write_b32 a145, v65
v_perm_b32 v69, v47, v46, s47
v_accvgpr_write_b32 a153, v69
s_mov_b32 s20, 122112
buffer_load_dword v46, v1, s[12:15], s20 offen
s_mov_b32 s21, 123264
buffer_load_dword v47, v1, s[12:15], s21 offen
s_waitcnt vmcnt(58)
v_perm_b32 v66, v49, v48, s46
v_accvgpr_write_b32 a146, v66
v_perm_b32 v70, v49, v48, s47
v_accvgpr_write_b32 a154, v70
s_mov_b32 s20, 256
buffer_load_dword v48, v1, s[12:15], s20 offen
s_mov_b32 s21, 1408
buffer_load_dword v49, v1, s[12:15], s21 offen
s_waitcnt vmcnt(58)
v_perm_b32 v67, v51, v50, s46
v_accvgpr_write_b32 a147, v67
v_perm_b32 v71, v51, v50, s47
v_accvgpr_write_b32 a155, v71
s_mov_b32 s20, 9472
buffer_load_dword v50, v1, s[12:15], s20 offen
s_mov_b32 s21, 10624
buffer_load_dword v51, v1, s[12:15], s21 offen
s_waitcnt vmcnt(58)
v_perm_b32 v64, v53, v52, s46
v_accvgpr_write_b32 a148, v64
v_perm_b32 v68, v53, v52, s47
v_accvgpr_write_b32 a156, v68
s_mov_b32 s20, 2560
buffer_load_dword v52, v1, s[12:15], s20 offen
s_mov_b32 s21, 3712
buffer_load_dword v53, v1, s[12:15], s21 offen
s_waitcnt vmcnt(58)
v_perm_b32 v65, v55, v54, s46
v_accvgpr_write_b32 a149, v65
v_perm_b32 v69, v55, v54, s47
v_accvgpr_write_b32 a157, v69
s_mov_b32 s20, 11776
buffer_load_dword v54, v1, s[12:15], s20 offen
s_mov_b32 s21, 12928
buffer_load_dword v55, v1, s[12:15], s21 offen
s_waitcnt vmcnt(58)
v_perm_b32 v66, v57, v56, s46
v_accvgpr_write_b32 a150, v66
v_perm_b32 v70, v57, v56, s47
v_accvgpr_write_b32 a158, v70
s_mov_b32 s20, 37120
buffer_load_dword v56, v1, s[12:15], s20 offen
s_mov_b32 s21, 38272
buffer_load_dword v57, v1, s[12:15], s21 offen
s_waitcnt vmcnt(58)
v_perm_b32 v67, v59, v58, s46
v_accvgpr_write_b32 a151, v67
v_perm_b32 v71, v59, v58, s47
v_accvgpr_write_b32 a159, v71
s_mov_b32 s20, 46336
buffer_load_dword v58, v1, s[12:15], s20 offen
s_mov_b32 s21, 47488
buffer_load_dword v59, v1, s[12:15], s21 offen
s_waitcnt vmcnt(58)
v_perm_b32 v64, v61, v60, s46
v_accvgpr_write_b32 a160, v64
v_perm_b32 v68, v61, v60, s47
v_accvgpr_write_b32 a168, v68
s_mov_b32 s20, 39424
buffer_load_dword v60, v1, s[12:15], s20 offen
s_mov_b32 s21, 40576
buffer_load_dword v61, v1, s[12:15], s21 offen
s_waitcnt vmcnt(58)
v_perm_b32 v65, v63, v62, s46
v_accvgpr_write_b32 a161, v65
v_perm_b32 v69, v63, v62, s47
v_accvgpr_write_b32 a169, v69
s_mov_b32 s20, 48640
buffer_load_dword v62, v1, s[12:15], s20 offen
s_mov_b32 s21, 49792
buffer_load_dword v63, v1, s[12:15], s21 offen
s_waitcnt vmcnt(58)
v_perm_b32 v66, v5, v4, s46
v_accvgpr_write_b32 a162, v66
v_perm_b32 v70, v5, v4, s47
v_accvgpr_write_b32 a170, v70
s_mov_b32 s20, 73984
buffer_load_dword v4, v1, s[12:15], s20 offen
s_mov_b32 s21, 75136
buffer_load_dword v5, v1, s[12:15], s21 offen
s_waitcnt vmcnt(58)
v_perm_b32 v67, v7, v6, s46
v_accvgpr_write_b32 a163, v67
v_perm_b32 v71, v7, v6, s47
v_accvgpr_write_b32 a171, v71
s_mov_b32 s20, 83200
buffer_load_dword v6, v1, s[12:15], s20 offen
s_mov_b32 s21, 84352
buffer_load_dword v7, v1, s[12:15], s21 offen
s_waitcnt vmcnt(58)
v_perm_b32 v64, v9, v8, s46
v_accvgpr_write_b32 a164, v64
v_perm_b32 v68, v9, v8, s47
v_accvgpr_write_b32 a172, v68
s_mov_b32 s20, 76288
buffer_load_dword v8, v1, s[12:15], s20 offen
s_mov_b32 s21, 77440
buffer_load_dword v9, v1, s[12:15], s21 offen
s_waitcnt vmcnt(58)
v_perm_b32 v65, v11, v10, s46
v_accvgpr_write_b32 a165, v65
v_perm_b32 v69, v11, v10, s47
v_accvgpr_write_b32 a173, v69
s_mov_b32 s20, 85504
buffer_load_dword v10, v1, s[12:15], s20 offen
s_mov_b32 s21, 86656
buffer_load_dword v11, v1, s[12:15], s21 offen
s_waitcnt vmcnt(58)
v_perm_b32 v66, v13, v12, s46
v_accvgpr_write_b32 a166, v66
v_perm_b32 v70, v13, v12, s47
v_accvgpr_write_b32 a174, v70
s_mov_b32 s20, 110848
buffer_load_dword v12, v1, s[12:15], s20 offen
s_mov_b32 s21, 112000
buffer_load_dword v13, v1, s[12:15], s21 offen
s_waitcnt vmcnt(58)
v_perm_b32 v67, v15, v14, s46
v_accvgpr_write_b32 a167, v67
v_perm_b32 v71, v15, v14, s47
v_accvgpr_write_b32 a175, v71
s_mov_b32 s20, 120064
buffer_load_dword v14, v1, s[12:15], s20 offen
s_mov_b32 s21, 121216
buffer_load_dword v15, v1, s[12:15], s21 offen
s_waitcnt vmcnt(58)
v_perm_b32 v64, v17, v16, s46
v_accvgpr_write_b32 a176, v64
v_perm_b32 v68, v17, v16, s47
v_accvgpr_write_b32 a184, v68
s_mov_b32 s20, 113152
buffer_load_dword v16, v1, s[12:15], s20 offen
s_mov_b32 s21, 114304
buffer_load_dword v17, v1, s[12:15], s21 offen
s_waitcnt vmcnt(58)
v_perm_b32 v65, v19, v18, s46
v_accvgpr_write_b32 a177, v65
v_perm_b32 v69, v19, v18, s47
v_accvgpr_write_b32 a185, v69
s_mov_b32 s20, 122368
buffer_load_dword v18, v1, s[12:15], s20 offen
s_mov_b32 s21, 123520
buffer_load_dword v19, v1, s[12:15], s21 offen
s_waitcnt vmcnt(58)
v_perm_b32 v66, v21, v20, s46
v_accvgpr_write_b32 a178, v66
v_perm_b32 v70, v21, v20, s47
v_accvgpr_write_b32 a186, v70
s_mov_b32 s20, 512
buffer_load_dword v20, v1, s[12:15], s20 offen
s_mov_b32 s21, 1664
buffer_load_dword v21, v1, s[12:15], s21 offen
s_waitcnt vmcnt(58)
v_perm_b32 v67, v23, v22, s46
v_accvgpr_write_b32 a179, v67
v_perm_b32 v71, v23, v22, s47
v_accvgpr_write_b32 a187, v71
s_mov_b32 s20, 9728
buffer_load_dword v22, v1, s[12:15], s20 offen
s_mov_b32 s21, 10880
buffer_load_dword v23, v1, s[12:15], s21 offen
s_waitcnt vmcnt(58)
v_perm_b32 v64, v25, v24, s46
v_accvgpr_write_b32 a180, v64
v_perm_b32 v68, v25, v24, s47
v_accvgpr_write_b32 a188, v68
s_mov_b32 s20, 2816
buffer_load_dword v24, v1, s[12:15], s20 offen
s_mov_b32 s21, 3968
buffer_load_dword v25, v1, s[12:15], s21 offen
s_waitcnt vmcnt(58)
v_perm_b32 v65, v27, v26, s46
v_accvgpr_write_b32 a181, v65
v_perm_b32 v69, v27, v26, s47
v_accvgpr_write_b32 a189, v69
s_mov_b32 s20, 12032
buffer_load_dword v26, v1, s[12:15], s20 offen
s_mov_b32 s21, 13184
buffer_load_dword v27, v1, s[12:15], s21 offen
s_waitcnt vmcnt(58)
v_perm_b32 v66, v29, v28, s46
v_accvgpr_write_b32 a182, v66
v_perm_b32 v70, v29, v28, s47
v_accvgpr_write_b32 a190, v70
s_mov_b32 s20, 37376
buffer_load_dword v28, v1, s[12:15], s20 offen
s_mov_b32 s21, 38528
buffer_load_dword v29, v1, s[12:15], s21 offen
s_waitcnt vmcnt(58)
v_perm_b32 v67, v31, v30, s46
v_accvgpr_write_b32 a183, v67
v_perm_b32 v71, v31, v30, s47
v_accvgpr_write_b32 a191, v71
s_mov_b32 s20, 46592
buffer_load_dword v30, v1, s[12:15], s20 offen
s_mov_b32 s21, 47744
buffer_load_dword v31, v1, s[12:15], s21 offen
s_waitcnt vmcnt(58)
v_perm_b32 v64, v33, v32, s46
v_perm_b32 v68, v33, v32, s47
s_mov_b32 s20, 39680
buffer_load_dword v32, v1, s[12:15], s20 offen
s_mov_b32 s21, 40832
buffer_load_dword v33, v1, s[12:15], s21 offen
s_waitcnt vmcnt(58)
v_perm_b32 v65, v35, v34, s46
v_perm_b32 v69, v35, v34, s47
s_mov_b32 s20, 48896
buffer_load_dword v34, v1, s[12:15], s20 offen
s_mov_b32 s21, 50048
buffer_load_dword v35, v1, s[12:15], s21 offen
s_waitcnt vmcnt(58)
v_perm_b32 v66, v37, v36, s46
v_perm_b32 v70, v37, v36, s47
s_mov_b32 s20, 74240
buffer_load_dword v36, v1, s[12:15], s20 offen
s_mov_b32 s21, 75392
buffer_load_dword v37, v1, s[12:15], s21 offen
s_waitcnt vmcnt(58)
v_perm_b32 v67, v39, v38, s46
ds_write_b128 v3, v[64:67] offset:20480
s_waitcnt lgkmcnt(0)
v_perm_b32 v71, v39, v38, s47
ds_write_b128 v3, v[68:71] offset:22528
s_waitcnt lgkmcnt(0)
s_mov_b32 s20, 83456
buffer_load_dword v38, v1, s[12:15], s20 offen
s_mov_b32 s21, 84608
buffer_load_dword v39, v1, s[12:15], s21 offen
s_waitcnt vmcnt(58)
v_perm_b32 v64, v41, v40, s46
v_perm_b32 v68, v41, v40, s47
s_mov_b32 s20, 76544
buffer_load_dword v40, v1, s[12:15], s20 offen
s_mov_b32 s21, 77696
buffer_load_dword v41, v1, s[12:15], s21 offen
s_waitcnt vmcnt(58)
v_perm_b32 v65, v43, v42, s46
v_perm_b32 v69, v43, v42, s47
s_mov_b32 s20, 85760
buffer_load_dword v42, v1, s[12:15], s20 offen
s_mov_b32 s21, 86912
buffer_load_dword v43, v1, s[12:15], s21 offen
s_waitcnt vmcnt(58)
v_perm_b32 v66, v45, v44, s46
v_perm_b32 v70, v45, v44, s47
s_mov_b32 s20, 111104
buffer_load_dword v44, v1, s[12:15], s20 offen
s_mov_b32 s21, 112256
buffer_load_dword v45, v1, s[12:15], s21 offen
s_waitcnt vmcnt(58)
v_perm_b32 v67, v47, v46, s46
ds_write_b128 v3, v[64:67] offset:21504
s_waitcnt lgkmcnt(0)
v_perm_b32 v71, v47, v46, s47
ds_write_b128 v3, v[68:71] offset:23552
s_waitcnt lgkmcnt(0)
s_mov_b32 s20, 120320
buffer_load_dword v46, v1, s[12:15], s20 offen
s_mov_b32 s21, 121472
buffer_load_dword v47, v1, s[12:15], s21 offen
s_waitcnt vmcnt(58)
v_perm_b32 v64, v49, v48, s46
v_accvgpr_write_b32 a192, v64
v_perm_b32 v68, v49, v48, s47
v_accvgpr_write_b32 a200, v68
s_mov_b32 s20, 113408
buffer_load_dword v48, v1, s[12:15], s20 offen
s_mov_b32 s21, 114560
buffer_load_dword v49, v1, s[12:15], s21 offen
s_waitcnt vmcnt(58)
v_perm_b32 v65, v51, v50, s46
v_accvgpr_write_b32 a193, v65
v_perm_b32 v69, v51, v50, s47
v_accvgpr_write_b32 a201, v69
s_mov_b32 s20, 122624
buffer_load_dword v50, v1, s[12:15], s20 offen
s_mov_b32 s21, 123776
buffer_load_dword v51, v1, s[12:15], s21 offen
s_waitcnt vmcnt(58)
v_perm_b32 v66, v53, v52, s46
v_accvgpr_write_b32 a194, v66
v_perm_b32 v70, v53, v52, s47
v_accvgpr_write_b32 a202, v70
s_mov_b32 s20, 768
buffer_load_dword v52, v1, s[12:15], s20 offen
s_mov_b32 s21, 1920
buffer_load_dword v53, v1, s[12:15], s21 offen
s_waitcnt vmcnt(58)
v_perm_b32 v67, v55, v54, s46
v_accvgpr_write_b32 a195, v67
v_perm_b32 v71, v55, v54, s47
v_accvgpr_write_b32 a203, v71
s_mov_b32 s20, 9984
buffer_load_dword v54, v1, s[12:15], s20 offen
s_mov_b32 s21, 11136
buffer_load_dword v55, v1, s[12:15], s21 offen
s_waitcnt vmcnt(58)
v_perm_b32 v64, v57, v56, s46
v_accvgpr_write_b32 a196, v64
v_perm_b32 v68, v57, v56, s47
v_accvgpr_write_b32 a204, v68
s_mov_b32 s20, 3072
buffer_load_dword v56, v1, s[12:15], s20 offen
s_mov_b32 s21, 4224
buffer_load_dword v57, v1, s[12:15], s21 offen
s_waitcnt vmcnt(58)
v_perm_b32 v65, v59, v58, s46
v_accvgpr_write_b32 a197, v65
v_perm_b32 v69, v59, v58, s47
v_accvgpr_write_b32 a205, v69
s_mov_b32 s20, 12288
buffer_load_dword v58, v1, s[12:15], s20 offen
s_mov_b32 s21, 13440
buffer_load_dword v59, v1, s[12:15], s21 offen
s_waitcnt vmcnt(58)
v_perm_b32 v66, v61, v60, s46
v_accvgpr_write_b32 a198, v66
v_perm_b32 v70, v61, v60, s47
v_accvgpr_write_b32 a206, v70
s_mov_b32 s20, 37632
buffer_load_dword v60, v1, s[12:15], s20 offen
s_mov_b32 s21, 38784
buffer_load_dword v61, v1, s[12:15], s21 offen
s_waitcnt vmcnt(58)
v_perm_b32 v67, v63, v62, s46
v_accvgpr_write_b32 a199, v67
v_perm_b32 v71, v63, v62, s47
v_accvgpr_write_b32 a207, v71
s_mov_b32 s20, 46848
buffer_load_dword v62, v1, s[12:15], s20 offen
s_mov_b32 s21, 48000
buffer_load_dword v63, v1, s[12:15], s21 offen
s_waitcnt vmcnt(58)
v_perm_b32 v64, v5, v4, s46
v_perm_b32 v68, v5, v4, s47
s_mov_b32 s20, 39936
buffer_load_dword v4, v1, s[12:15], s20 offen
s_mov_b32 s21, 41088
buffer_load_dword v5, v1, s[12:15], s21 offen
s_waitcnt vmcnt(58)
v_perm_b32 v65, v7, v6, s46
v_perm_b32 v69, v7, v6, s47
s_mov_b32 s20, 49152
buffer_load_dword v6, v1, s[12:15], s20 offen
s_mov_b32 s21, 50304
buffer_load_dword v7, v1, s[12:15], s21 offen
s_waitcnt vmcnt(58)
v_perm_b32 v66, v9, v8, s46
v_perm_b32 v70, v9, v8, s47
s_mov_b32 s20, 74496
buffer_load_dword v8, v1, s[12:15], s20 offen
s_mov_b32 s21, 75648
buffer_load_dword v9, v1, s[12:15], s21 offen
s_waitcnt vmcnt(58)
v_perm_b32 v67, v11, v10, s46
ds_write_b128 v3, v[64:67] offset:24576
s_waitcnt lgkmcnt(0)
v_perm_b32 v71, v11, v10, s47
ds_write_b128 v3, v[68:71] offset:26624
s_waitcnt lgkmcnt(0)
s_mov_b32 s20, 83712
buffer_load_dword v10, v1, s[12:15], s20 offen
s_mov_b32 s21, 84864
buffer_load_dword v11, v1, s[12:15], s21 offen
s_waitcnt vmcnt(58)
v_perm_b32 v64, v13, v12, s46
v_perm_b32 v68, v13, v12, s47
s_mov_b32 s20, 76800
buffer_load_dword v12, v1, s[12:15], s20 offen
s_mov_b32 s21, 77952
buffer_load_dword v13, v1, s[12:15], s21 offen
s_waitcnt vmcnt(58)
v_perm_b32 v65, v15, v14, s46
v_perm_b32 v69, v15, v14, s47
s_mov_b32 s20, 86016
buffer_load_dword v14, v1, s[12:15], s20 offen
s_mov_b32 s21, 87168
buffer_load_dword v15, v1, s[12:15], s21 offen
s_waitcnt vmcnt(58)
v_perm_b32 v66, v17, v16, s46
v_perm_b32 v70, v17, v16, s47
s_mov_b32 s20, 111360
buffer_load_dword v16, v1, s[12:15], s20 offen
s_mov_b32 s21, 112512
buffer_load_dword v17, v1, s[12:15], s21 offen
s_waitcnt vmcnt(58)
v_perm_b32 v67, v19, v18, s46
ds_write_b128 v3, v[64:67] offset:25600
s_waitcnt lgkmcnt(0)
v_perm_b32 v71, v19, v18, s47
ds_write_b128 v3, v[68:71] offset:27648
s_waitcnt lgkmcnt(0)
s_mov_b32 s20, 120576
buffer_load_dword v18, v1, s[12:15], s20 offen
s_mov_b32 s21, 121728
buffer_load_dword v19, v1, s[12:15], s21 offen
s_waitcnt vmcnt(58)
v_perm_b32 v64, v21, v20, s46
v_accvgpr_write_b32 a208, v64
v_perm_b32 v68, v21, v20, s47
v_accvgpr_write_b32 a216, v68
s_mov_b32 s20, 113664
buffer_load_dword v20, v1, s[12:15], s20 offen
s_mov_b32 s21, 114816
buffer_load_dword v21, v1, s[12:15], s21 offen
s_waitcnt vmcnt(58)
v_perm_b32 v65, v23, v22, s46
v_accvgpr_write_b32 a209, v65
v_perm_b32 v69, v23, v22, s47
v_accvgpr_write_b32 a217, v69
s_mov_b32 s20, 122880
buffer_load_dword v22, v1, s[12:15], s20 offen
s_mov_b32 s21, 124032
buffer_load_dword v23, v1, s[12:15], s21 offen
s_waitcnt vmcnt(58)
v_perm_b32 v66, v25, v24, s46
v_accvgpr_write_b32 a210, v66
v_perm_b32 v70, v25, v24, s47
v_accvgpr_write_b32 a218, v70
s_mov_b32 s20, 1024
buffer_load_ushort v24, v2, s[12:15], s20 offen
s_mov_b32 s21, 2176
buffer_load_ushort v25, v2, s[12:15], s21 offen
s_waitcnt vmcnt(58)
v_perm_b32 v67, v27, v26, s46
v_accvgpr_write_b32 a211, v67
v_perm_b32 v71, v27, v26, s47
v_accvgpr_write_b32 a219, v71
s_mov_b32 s20, 10240
buffer_load_ushort v26, v2, s[12:15], s20 offen
s_mov_b32 s21, 11392
buffer_load_ushort v27, v2, s[12:15], s21 offen
s_waitcnt vmcnt(58)
v_perm_b32 v64, v29, v28, s46
v_accvgpr_write_b32 a212, v64
v_perm_b32 v68, v29, v28, s47
v_accvgpr_write_b32 a220, v68
s_mov_b32 s20, 3328
buffer_load_ushort v28, v2, s[12:15], s20 offen
s_mov_b32 s21, 4480
buffer_load_ushort v29, v2, s[12:15], s21 offen
s_waitcnt vmcnt(58)
v_perm_b32 v65, v31, v30, s46
v_accvgpr_write_b32 a213, v65
v_perm_b32 v69, v31, v30, s47
v_accvgpr_write_b32 a221, v69
s_mov_b32 s20, 12544
buffer_load_ushort v30, v2, s[12:15], s20 offen
s_mov_b32 s21, 13696
buffer_load_ushort v31, v2, s[12:15], s21 offen
s_waitcnt vmcnt(58)
v_perm_b32 v66, v33, v32, s46
v_accvgpr_write_b32 a214, v66
v_perm_b32 v70, v33, v32, s47
v_accvgpr_write_b32 a222, v70
s_mov_b32 s20, 37888
buffer_load_ushort v32, v2, s[12:15], s20 offen
s_mov_b32 s21, 39040
buffer_load_ushort v33, v2, s[12:15], s21 offen
s_waitcnt vmcnt(58)
v_perm_b32 v67, v35, v34, s46
v_accvgpr_write_b32 a215, v67
v_perm_b32 v71, v35, v34, s47
v_accvgpr_write_b32 a223, v71
s_mov_b32 s20, 47104
buffer_load_ushort v34, v2, s[12:15], s20 offen
s_mov_b32 s21, 48256
buffer_load_ushort v35, v2, s[12:15], s21 offen
s_waitcnt vmcnt(58)
v_perm_b32 v64, v37, v36, s46
v_perm_b32 v68, v37, v36, s47
s_mov_b32 s20, 40192
buffer_load_ushort v36, v2, s[12:15], s20 offen
s_mov_b32 s21, 41344
buffer_load_ushort v37, v2, s[12:15], s21 offen
s_waitcnt vmcnt(58)
v_perm_b32 v65, v39, v38, s46
v_perm_b32 v69, v39, v38, s47
s_mov_b32 s20, 49408
buffer_load_ushort v38, v2, s[12:15], s20 offen
s_mov_b32 s21, 50560
buffer_load_ushort v39, v2, s[12:15], s21 offen
s_waitcnt vmcnt(58)
v_perm_b32 v66, v41, v40, s46
v_perm_b32 v70, v41, v40, s47
s_mov_b32 s20, 74752
buffer_load_ushort v40, v2, s[12:15], s20 offen
s_mov_b32 s21, 75904
buffer_load_ushort v41, v2, s[12:15], s21 offen
s_waitcnt vmcnt(58)
v_perm_b32 v67, v43, v42, s46
ds_write_b128 v3, v[64:67] offset:28672
s_waitcnt lgkmcnt(0)
v_perm_b32 v71, v43, v42, s47
ds_write_b128 v3, v[68:71] offset:30720
s_waitcnt lgkmcnt(0)
s_mov_b32 s20, 83968
buffer_load_ushort v42, v2, s[12:15], s20 offen
s_mov_b32 s21, 85120
buffer_load_ushort v43, v2, s[12:15], s21 offen
s_waitcnt vmcnt(58)
v_perm_b32 v64, v45, v44, s46
v_perm_b32 v68, v45, v44, s47
s_mov_b32 s20, 77056
buffer_load_ushort v44, v2, s[12:15], s20 offen
s_mov_b32 s21, 78208
buffer_load_ushort v45, v2, s[12:15], s21 offen
s_waitcnt vmcnt(58)
v_perm_b32 v65, v47, v46, s46
v_perm_b32 v69, v47, v46, s47
s_mov_b32 s20, 86272
buffer_load_ushort v46, v2, s[12:15], s20 offen
s_mov_b32 s21, 87424
buffer_load_ushort v47, v2, s[12:15], s21 offen
s_waitcnt vmcnt(58)
v_perm_b32 v66, v49, v48, s46
v_perm_b32 v70, v49, v48, s47
s_mov_b32 s20, 111616
buffer_load_ushort v48, v2, s[12:15], s20 offen
s_mov_b32 s21, 112768
buffer_load_ushort v49, v2, s[12:15], s21 offen
s_waitcnt vmcnt(58)
v_perm_b32 v67, v51, v50, s46
ds_write_b128 v3, v[64:67] offset:29696
s_waitcnt lgkmcnt(0)
v_perm_b32 v71, v51, v50, s47
ds_write_b128 v3, v[68:71] offset:31744
s_waitcnt lgkmcnt(0)
s_mov_b32 s20, 120832
buffer_load_ushort v50, v2, s[12:15], s20 offen
s_mov_b32 s21, 121984
buffer_load_ushort v51, v2, s[12:15], s21 offen
s_waitcnt vmcnt(58)
v_perm_b32 v64, v53, v52, s46
v_accvgpr_write_b32 a224, v64
v_perm_b32 v68, v53, v52, s47
v_accvgpr_write_b32 a232, v68
s_mov_b32 s20, 113920
buffer_load_ushort v52, v2, s[12:15], s20 offen
s_mov_b32 s21, 115072
buffer_load_ushort v53, v2, s[12:15], s21 offen
s_waitcnt vmcnt(58)
v_perm_b32 v65, v55, v54, s46
v_accvgpr_write_b32 a225, v65
v_perm_b32 v69, v55, v54, s47
v_accvgpr_write_b32 a233, v69
s_mov_b32 s20, 123136
buffer_load_ushort v54, v2, s[12:15], s20 offen
s_mov_b32 s21, 124288
buffer_load_ushort v55, v2, s[12:15], s21 offen
s_waitcnt vmcnt(58)
v_perm_b32 v66, v57, v56, s46
v_accvgpr_write_b32 a226, v66
v_perm_b32 v70, v57, v56, s47
v_accvgpr_write_b32 a234, v70
s_waitcnt vmcnt(56)
v_perm_b32 v67, v59, v58, s46
v_accvgpr_write_b32 a227, v67
v_perm_b32 v71, v59, v58, s47
v_accvgpr_write_b32 a235, v71
s_waitcnt vmcnt(54)
v_perm_b32 v64, v61, v60, s46
v_accvgpr_write_b32 a228, v64
v_perm_b32 v68, v61, v60, s47
v_accvgpr_write_b32 a236, v68
s_waitcnt vmcnt(52)
v_perm_b32 v65, v63, v62, s46
v_accvgpr_write_b32 a229, v65
v_perm_b32 v69, v63, v62, s47
v_accvgpr_write_b32 a237, v69
s_waitcnt vmcnt(50)
v_perm_b32 v66, v5, v4, s46
v_accvgpr_write_b32 a230, v66
v_perm_b32 v70, v5, v4, s47
v_accvgpr_write_b32 a238, v70
s_waitcnt vmcnt(48)
v_perm_b32 v67, v7, v6, s46
v_accvgpr_write_b32 a231, v67
v_perm_b32 v71, v7, v6, s47
v_accvgpr_write_b32 a239, v71
s_waitcnt vmcnt(46)
v_perm_b32 v64, v9, v8, s46
v_perm_b32 v68, v9, v8, s47
v_accvgpr_write_b32 a240, v68
s_waitcnt vmcnt(44)
v_perm_b32 v65, v11, v10, s46
v_perm_b32 v69, v11, v10, s47
v_accvgpr_write_b32 a241, v69
s_waitcnt vmcnt(42)
v_perm_b32 v66, v13, v12, s46
v_perm_b32 v70, v13, v12, s47
v_accvgpr_write_b32 a242, v70
s_waitcnt vmcnt(40)
v_perm_b32 v67, v15, v14, s46
ds_write_b128 v3, v[64:67] offset:32768
s_waitcnt lgkmcnt(0)
v_perm_b32 v71, v15, v14, s47
v_accvgpr_write_b32 a243, v71
s_waitcnt vmcnt(38)
v_perm_b32 v64, v17, v16, s46
v_perm_b32 v68, v17, v16, s47
v_accvgpr_write_b32 a244, v68
s_waitcnt vmcnt(36)
v_perm_b32 v65, v19, v18, s46
v_perm_b32 v69, v19, v18, s47
v_accvgpr_write_b32 a245, v69
s_waitcnt vmcnt(34)
v_perm_b32 v66, v21, v20, s46
v_perm_b32 v70, v21, v20, s47
v_accvgpr_write_b32 a246, v70
s_waitcnt vmcnt(32)
v_perm_b32 v67, v23, v22, s46
ds_write_b128 v3, v[64:67] offset:33792
s_waitcnt lgkmcnt(0)
v_perm_b32 v71, v23, v22, s47
v_accvgpr_write_b32 a247, v71
s_waitcnt vmcnt(30)
v_perm_b32 v64, v25, v24, s46
v_accvgpr_write_b32 a248, v64
s_waitcnt vmcnt(28)
v_perm_b32 v65, v27, v26, s46
v_accvgpr_write_b32 a249, v65
s_waitcnt vmcnt(26)
v_perm_b32 v66, v29, v28, s46
v_accvgpr_write_b32 a250, v66
s_waitcnt vmcnt(24)
v_perm_b32 v67, v31, v30, s46
v_accvgpr_write_b32 a251, v67
s_waitcnt vmcnt(22)
v_perm_b32 v64, v33, v32, s46
v_accvgpr_write_b32 a252, v64
s_waitcnt vmcnt(20)
v_perm_b32 v65, v35, v34, s46
v_accvgpr_write_b32 a253, v65
s_waitcnt vmcnt(18)
v_perm_b32 v66, v37, v36, s46
v_accvgpr_write_b32 a254, v66
s_waitcnt vmcnt(16)
v_perm_b32 v67, v39, v38, s46
v_accvgpr_write_b32 a255, v67
s_waitcnt vmcnt(14)
v_perm_b32 v64, v41, v40, s46
s_waitcnt vmcnt(12)
v_perm_b32 v65, v43, v42, s46
s_waitcnt vmcnt(10)
v_perm_b32 v66, v45, v44, s46
s_waitcnt vmcnt(8)
v_perm_b32 v67, v47, v46, s46
ds_write_b128 v3, v[64:67] offset:18432
s_waitcnt lgkmcnt(0)
s_waitcnt vmcnt(6)
v_perm_b32 v64, v49, v48, s46
s_waitcnt vmcnt(4)
v_perm_b32 v65, v51, v50, s46
s_waitcnt vmcnt(2)
v_perm_b32 v66, v53, v52, s46
s_waitcnt vmcnt(0)
v_perm_b32 v67, v55, v54, s46
ds_write_b128 v3, v[64:67] offset:19456
s_waitcnt lgkmcnt(0)
v_mov_b32 v20, 64
s_mov_b32 s28, 0
L_poll_22:
buffer_load_dword v21, v20, s[56:59], 0 offen sc1
s_add_u32 s28, s28, 1
s_cmp_gt_u32 s28, 40000
s_cbranch_scc1 L_end
s_waitcnt vmcnt(0)
v_cmp_ne_u32 vcc, 32, v21
s_cbranch_vccz L_pd_23
s_sleep 1
s_branch L_poll_22
L_pd_23:
v_mov_b32 v20, 128
s_mov_b32 s28, 0
L_poll_24:
buffer_load_dword v21, v20, s[56:59], 0 offen sc1
s_add_u32 s28, s28, 1
s_cmp_gt_u32 s28, 40000
s_cbranch_scc1 L_end
s_waitcnt vmcnt(0)
v_cmp_ne_u32 vcc, 8, v21
s_cbranch_vccz L_pd_25
s_sleep 1
s_branch L_poll_24
L_pd_25:
v_mov_b32 v20, 0
s_lshl_b32 s25, s16, 7
s_add_u32 s25, s25, 111149056
s_mov_b32 s28, 0
L_poll_26:
buffer_load_dword v21, v20, s[8:11], s25 offen sc1
s_add_u32 s28, s28, 1
s_cmp_gt_u32 s28, 40000
s_cbranch_scc1 L_end
s_waitcnt vmcnt(0)
v_cmp_ge_u32 vcc, 0, v21
s_cbranch_vccz L_pd_27
s_sleep 1
s_branch L_poll_26
L_pd_27:
v_mov_b32 v12, v0
v_and_b32 v13, 15, v0
v_bfe_u32 v14, v0, 4, 2
v_lshlrev_b32 v1, 4, v12
v_and_b32 v2, 0x3f0, v1
s_mul_i32 s20, s17, 34816
s_add_u32 s20, s20, 24576
v_add_u32 v2, s20, v2
v_and_b32 v15, 1, v12
v_mul_u32_u24 v0, 0xaaaa, v15
v_add_u32 v0, 0xffff4444, v0
v_lshrrev_b32 v18, 2, v13
v_lshl_add_u32 v18, v18, 1, v15
v_bfe_u32 v19, v13, 1, 1
v_lshrrev_b32 v16, 5, v12
v_lshlrev_b32 v16, 8, v16
v_lshl_add_u32 v16, v18, 5, v16
v_and_b32 v17, 1, v14
v_lshl_add_u32 v16, v17, 4, v16
v_and_b32 v17, 0x7f, v16
v_xor_b32 v17, 16, v17
v_add_u32 v16, 4224, v16
v_add_u32 v17, 6272, v17
v_cmp_eq_u32 vcc, 1, v19
s_nop 1
v_cndmask_b32 v7, v17, v16, vcc
v_and_b32 v16, 1, v14
v_xor_b32 v16, v18, v16
v_and_b32 v17, 2, v14
v_lshlrev_b32 v17, 1, v17
v_xor_b32 v16, v16, v17
v_lshlrev_b32 v16, 4, v16
v_lshl_add_u32 v16, v14, 7, v16
v_mul_u32_u24 v17, 2176, v19
v_add_u32 v16, v16, v17
v_add_u32 v5, 0, v16
v_bfe_u32 v20, v13, 3, 1
v_bfe_u32 v21, v13, 1, 1
v_lshlrev_b32 v16, 1, v14
v_xor_b32 v16, v16, v21
v_lshlrev_b32 v17, 2, v20
v_xor_b32 v16, v16, v17
v_lshlrev_b32 v16, 4, v16
v_lshl_add_u32 v16, v20, 8, v16
v_lshl_add_u32 v16, v21, 7, v16
v_bfe_u32 v17, v13, 2, 1
v_lshl_add_u32 v16, v17, 3, v16
v_lshl_add_u32 v16, v15, 2, v16
s_lshl_b32 s20, s17, 9
s_add_u32 s20, s20, 0
v_add_u32 v4, s20, v16
v_xor_b32 v3, 16, v4
v_lshrrev_b32 v16, 4, v12
v_xor_b32 v17, s16, v16
v_lshlrev_b32 v16, 12, v16
v_lshl_add_u32 v16, v17, 7, v16
v_lshl_add_u32 v9, v13, 3, v16
s_lshr_b32 s20, s17, 1
s_lshl_b32 s20, s20, 2
v_add_u32 v16, s20, v14
v_xor_b32 v17, s16, v16
v_lshlrev_b32 v16, 12, v16
v_lshl_add_u32 v16, v17, 7, v16
v_lshl_add_u32 v16, v13, 2, v16
s_and_b32 s20, s17, 1
s_lshl_b32 s20, s20, 6
s_add_u32 s20, s20, 262144
v_add_u32 v10, s20, v16
v_bfe_u32 v16, v13, 2, 1
v_lshlrev_b32 v16, 5, v16
v_and_b32 v17, 1, v14
v_lshl_add_u32 v16, v17, 8, v16
v_lshrrev_b32 v17, 1, v14
v_lshl_add_u32 v16, v17, 4, v16
v_and_b32 v17, 3, v13
v_lshl_add_u32 v11, v17, 2, v16
v_lshlrev_b32 v6, 6, v12
v_lshlrev_b32 v8, 2, v12
s_mov_b32 s36, 0x11111111
s_mov_b32 s37, 0x11111111
s_mov_b32 s38, 0x22222222
s_mov_b32 s39, 0x22222222
s_mov_b32 s40, 0x44444444
s_mov_b32 s41, 0x44444444
s_mov_b32 s42, 0x88888888
s_mov_b32 s43, 0x88888888
s_mov_b32 s44, 0xf0f0f0f0
s_mov_b32 s45, 0xf0f0f0f0
s_mov_b32 s18, 0x3e0293ee
s_lshl_b32 s20, s17, 5
s_add_u32 s20, s20, s16
s_cmp_lt_u32 s20, 72
s_cselect_b32 s48, 1, 0
s_lshl_b32 s23, s20, 12
s_lshl_b32 s21, s17, 10
s_sub_u32 s23, s23, s21
s_lshr_b32 s24, s20, 2
s_lshl_b32 s24, s24, 9
s_and_b32 s21, s20, 3
s_lshl_b32 s21, s21, 6
s_add_u32 s24, s24, s21
s_add_u32 s24, s24, 110100480
s_cmp_lt_u32 s20, 72
s_cselect_b32 s24, s24, 536870912
s_lshl_b32 s25, s16, 12
s_add_u32 s26, s25, 131072
s_add_u32 s27, s25, 262144
s_cmp_lt_u32 s16, 8
s_cselect_b32 s27, s27, 536870912
s_mov_b32 s28, 109051904
s_mov_b32 s29, 109346816
s_lshl_b32 s30, s16, 20
s_add_u32 s30, s30, 33554432
s_lshl_b32 s31, s16, 12
s_add_u32 s31, s31, 100663296
s_add_u32 s35, s24, 32768
s_mov_b32 s53, 0x3f803f80
s_mov_b32 s86, 0x33333333
s_mov_b32 s87, 0x33333333
s_lshl_b32 s82, s16, 7
s_add_u32 s83, s82, 111152384
s_add_u32 s82, s82, 111148288
s_mov_b32 s19, 0
s_load_dwordx2 s[50:51], s[0:1], 56
s_waitcnt lgkmcnt(0)
s_mov_b32 s12, s50
s_and_b32 s13, s51, 0xffff
s_mov_b32 s14, 9216
s_mov_b32 s15, 0x20000
v_bfe_u32 v64, v1, 5, 3
v_mul_u32_u24 v64, 1152, v64
v_lshrrev_b32 v65, 8, v1
v_lshl_add_u32 v64, v65, 5, v64
v_and_b32 v65, 16, v1
v_add_u32 v64, v64, v65
buffer_load_dwordx4 v[24:27], v64, s[12:15], 0 offen offset:0
buffer_load_dwordx4 v[28:31], v64, s[12:15], 0 offen offset:512
buffer_load_dwordx4 v[32:35], v64, s[12:15], 0 offen offset:1024
s_waitcnt vmcnt(0)
v_perm_b32 v12, v26, v24, s46
v_perm_b32 v13, v26, v24, s47
v_perm_b32 v14, v27, v25, s46
v_perm_b32 v15, v27, v25, s47
v_min_u32 v12, 0xfffeffff, v12
v_min_u32 v13, 0xfffeffff, v13
v_min_u32 v14, 0xfffeffff, v14
v_min_u32 v15, 0xfffeffff, v15
v_perm_b32 v16, v30, v28, s46
v_perm_b32 v17, v30, v28, s47
v_perm_b32 v18, v31, v29, s46
v_perm_b32 v19, v31, v29, s47
v_min_u32 v16, 0xfffeffff, v16
v_min_u32 v17, 0xfffeffff, v17
v_min_u32 v18, 0xfffeffff, v18
v_min_u32 v19, 0xfffeffff, v19
v_perm_b32 v20, v34, v32, s46
v_perm_b32 v21, v34, v32, s47
v_perm_b32 v22, v35, v33, s46
v_perm_b32 v23, v35, v33, s47
v_min_u32 v20, 0xfffeffff, v20
v_min_u32 v21, 0xfffeffff, v21
v_min_u32 v22, 0xfffeffff, v22
v_min_u32 v23, 0xfffeffff, v23
s_cmp_lg_u32 s17, 0
s_cbranch_scc1 L_m0_28
ds_write_b128 v1, v[20:23] offset:14848
v_mov_b32 v64, 6528
v_mov_b32 v56, 0
v_mov_b32 v57, 0
v_mov_b32 v58, 0
v_mov_b32 v59, 0
ds_write_b128 v64, v[56:59]
L_m0_28:
s_waitcnt lgkmcnt(0)
s_barrier
ds_read_b32 v20, v8 offset:14848
s_waitcnt lgkmcnt(0)
s_mov_b32 s33, 110100480
s_mov_b32 s6, 110100480
s_mov_b32 s7, 110100480
s_mov_b32 s22, 0
s_cmp_eq_u32 s17, 0
s_cbranch_scc1 L_ent0
s_cmp_eq_u32 s17, 1
s_cbranch_scc1 L_ent1
s_cmp_eq_u32 s17, 2
s_cbranch_scc1 L_ent2
s_cmp_eq_u32 s17, 3
s_cbranch_scc1 L_ent3
s_branch L_end
L_ent0:
v_lshlrev_b32 v6, 3, v1
v_mov_b64 v[24:25], 0
v_mov_b64 v[26:27], 0
v_mov_b64 v[28:29], 0
v_mov_b64 v[30:31], 0
v_and_b32 v69, 0x380, v1
v_add_u32 v69, v69, v1
v_lshlrev_b32 v70, 1, v1
v_mov_b64 v[64:65], -1
v_mov_b64 v[66:67], -1
v_xor_b32 v3, 16, v4
ds_read_b128 v[48:51], v2 offset:8192
ds_read_b128 v[52:55], v2 offset:9216
ds_read_b128 v[40:43], v2 offset:0
ds_read_b128 v[44:47], v2 offset:1024
v_mov_b64 v[32:33], 0
v_mov_b64 v[34:35], 0
v_mov_b64 v[36:37], 0
v_mov_b64 v[38:39], 0
v_mov_b64 v[56:57], 0
v_mov_b64 v[58:59], 0
v_mov_b64 v[60:61], 0
v_mov_b64 v[62:63], 0
s_add_u32 s20, s30, 0
s_add_u32 s21, s30, 8192
s_add_u32 s49, s29, s25
s_add_u32 s50, s29, s26
s_add_u32 s51, s29, s27
s_add_u32 s52, s30, 16384
s_mov_b32 m0, 15872
s_waitcnt vmcnt(0) lgkmcnt(0)
s_branch L_step0
L_gr0:
buffer_load_dwordx4 v[12:15], v1, s[8:11], s33 offen sc1
buffer_load_dword v20, v8, s[8:11], s7 offen sc1
buffer_load_dwordx4 v[16:19], v1, s[8:11], s6 offen sc1
s_add_u32 s22, s22, 1
s_cmp_gt_u32 s22, 40000
s_cbranch_scc1 L_end
s_nop 0
v_mov_b64 v[24:25], 0
v_mov_b64 v[26:27], 0
v_mov_b64 v[28:29], 0
v_mov_b64 v[30:31], 0
v_mov_b64 v[32:33], 0
v_mov_b64 v[34:35], 0
v_mov_b64 v[36:37], 0
v_mov_b64 v[38:39], 0
v_mov_b64 v[56:57], 0
v_mov_b64 v[58:59], 0
v_mov_b64 v[60:61], 0
v_mov_b64 v[62:63], 0
s_waitcnt lgkmcnt(0)
s_branch L_step0
.p2align 3
L_gat0:
buffer_load_dwordx4 v[12:15], v1, s[8:11], s33 offen sc1
buffer_load_dword v20, v8, s[8:11], s7 offen sc1
buffer_load_dwordx4 v[16:19], v1, s[8:11], s6 offen sc1
s_add_u32 s20, s30, 0
s_add_u32 s21, s30, 8192
s_add_u32 s49, s29, s25
s_add_u32 s50, s29, s26
s_add_u32 s51, s29, s27
s_add_u32 s52, s30, 16384
s_mov_b32 m0, 15872
s_waitcnt lgkmcnt(0)
L_step0:
s_waitcnt vmcnt(2)
v_smfmac_f32_16x16x64_bf16 v[24:27], v[12:15], v[72:79], v0
ds_write_b128 v1, v[12:15] offset:6656
v_smfmac_f32_16x16x64_bf16 v[28:31], v[12:15], v[80:87], v0
s_waitcnt vmcnt(1)
ds_write_b32 v8, v20 offset:14848
v_smfmac_f32_16x16x64_bf16 v[32:35], v[12:15], v[88:95], v0
s_waitcnt vmcnt(0)
ds_write_b128 v1, v[16:19] offset:10752
v_smfmac_f32_16x16x64_bf16 v[56:59], v[12:15], a[32:39], v0
v_max3_u32 v21, v12, v13, v14
v_max3_u32 v21, v21, v15, v20
v_smfmac_f32_16x16x64_bf16 v[60:63], v[12:15], a[40:47], v0
v_max3_u32 v21, v21, v16, v17
v_max3_u32 v21, v21, v18, v19
v_smfmac_f32_16x16x64_bf16 v[36:39], v[12:15], v[40:47], v0
v_cmp_le_u32 vcc, 0xffff0000, v21
v_smfmac_f32_16x16x64_bf16 v[24:27], v[16:19], v[168:175], v0
s_cbranch_vccnz L_gr0
v_smfmac_f32_16x16x64_bf16 v[28:31], v[16:19], v[176:183], v0
s_waitcnt lgkmcnt(0)
s_barrier
ds_read_b128 v[20:23], v1 offset:7680
v_smfmac_f32_16x16x64_bf16 v[32:35], v[16:19], v[184:191], v0
ds_read_b128 v[12:15], v1 offset:8704
buffer_load_dwordx4 v69, s[8:11], s20 offen sc1 lds
v_smfmac_f32_16x16x64_bf16 v[56:59], v[16:19], a[96:103], v0
ds_read_b128 v[40:43], v2 offset:2048
s_mov_b32 m0, 16768
v_smfmac_f32_16x16x64_bf16 v[60:63], v[16:19], a[104:111], v0
ds_read_b128 v[44:47], v2 offset:3072
v_smfmac_f32_16x16x64_bf16 v[36:39], v[16:19], v[48:55], v0
ds_read_b128 v[16:19], v1 offset:9728
s_waitcnt lgkmcnt(4)
v_smfmac_f32_16x16x64_bf16 v[24:27], v[20:23], v[96:103], v0
ds_read_b128 v[48:51], v2 offset:4096
buffer_load_dwordx4 v69, s[8:11], s20 offen offset:128 sc1 lds
v_smfmac_f32_16x16x64_bf16 v[28:31], v[20:23], v[104:111], v0
ds_read_b128 v[52:55], v2 offset:5120
s_mov_b32 m0, 6272
v_smfmac_f32_16x16x64_bf16 v[32:35], v[20:23], v[112:119], v0
buffer_store_dword v0, v11, s[8:11], s35 offen
s_waitcnt lgkmcnt(3)
v_smfmac_f32_16x16x64_bf16 v[36:39], v[20:23], v[40:47], v0
ds_read_b128 v[20:23], v1 offset:11776
v_smfmac_f32_16x16x64_bf16 v[24:27], v[12:15], v[120:127], v0
ds_read_b128 v[40:43], v2 offset:6144
buffer_store_dwordx4 v[64:67], v1, s[8:11], s49 offen
v_smfmac_f32_16x16x64_bf16 v[28:31], v[12:15], v[128:135], v0
ds_read_b128 v[44:47], v2 offset:7168
v_smfmac_f32_16x16x64_bf16 v[32:35], v[12:15], v[136:143], v0
s_waitcnt lgkmcnt(3)
v_smfmac_f32_16x16x64_bf16 v[36:39], v[12:15], v[48:55], v0
ds_read_b128 v[12:15], v1 offset:12800
v_smfmac_f32_16x16x64_bf16 v[24:27], v[16:19], v[144:151], v0
ds_read_b128 v[48:51], v2 offset:10240
buffer_store_dwordx4 v[64:67], v1, s[8:11], s50 offen
v_smfmac_f32_16x16x64_bf16 v[28:31], v[16:19], v[152:159], v0
ds_read_b128 v[52:55], v2 offset:11264
v_smfmac_f32_16x16x64_bf16 v[32:35], v[16:19], v[160:167], v0
s_waitcnt lgkmcnt(3)
v_smfmac_f32_16x16x64_bf16 v[36:39], v[16:19], v[40:47], v0
ds_read_b128 v[16:19], v1 offset:13824
v_smfmac_f32_16x16x64_bf16 v[24:27], v[20:23], v[192:199], v0
ds_read_b128 v[40:43], v2 offset:12288
buffer_store_dwordx4 v[64:67], v1, s[8:11], s51 offen
v_smfmac_f32_16x16x64_bf16 v[28:31], v[20:23], v[200:207], v0
ds_read_b128 v[44:47], v2 offset:13312
v_smfmac_f32_16x16x64_bf16 v[32:35], v[20:23], v[208:215], v0
s_waitcnt lgkmcnt(3)
v_smfmac_f32_16x16x64_bf16 v[36:39], v[20:23], v[48:55], v0
ds_read_b128 v[20:23], v1 offset:14848
v_smfmac_f32_16x16x64_bf16 v[24:27], v[12:15], v[216:223], v0
ds_read_b128 v[48:51], v2 offset:14336
buffer_load_dwordx4 v[64:67], v70, s[8:11], s21 offen sc1
v_smfmac_f32_16x16x64_bf16 v[28:31], v[12:15], v[224:231], v0
ds_read_b128 v[52:55], v2 offset:15360
v_smfmac_f32_16x16x64_bf16 v[32:35], v[12:15], v[232:239], v0
s_waitcnt lgkmcnt(3)
v_smfmac_f32_16x16x64_bf16 v[36:39], v[12:15], v[40:47], v0
ds_read_b128 v[12:15], v1 offset:7680
v_smfmac_f32_16x16x64_bf16 v[24:27], v[16:19], v[240:247], v0
ds_read_b128 v[40:43], v2 offset:16384
buffer_load_dwordx4 v[68:71], v70, s[8:11], s21 offen offset:16 sc1
v_smfmac_f32_16x16x64_bf16 v[28:31], v[16:19], v[248:255], v0
ds_read_b128 v[44:47], v2 offset:17408
v_smfmac_f32_16x16x64_bf16 v[32:35], v[16:19], a[0:7], v0
s_waitcnt lgkmcnt(3)
v_smfmac_f32_16x16x64_bf16 v[36:39], v[16:19], v[48:55], v0
ds_read_b128 v[16:19], v1 offset:8704
v_smfmac_f32_16x16x64_bf16 v[24:27], v[20:23], a[8:15], v0
v_smfmac_f32_16x16x64_bf16 v[28:31], v[20:23], a[16:23], v0
buffer_load_dword v6, s[8:11], s52 offen sc1 lds
v_smfmac_f32_16x16x64_bf16 v[32:35], v[20:23], a[24:31], v0
s_waitcnt lgkmcnt(1)
v_smfmac_f32_16x16x64_bf16 v[36:39], v[20:23], v[40:47], v0
ds_read_b128 v[20:23], v1 offset:9728
v_smfmac_f32_16x16x64_bf16 v[56:59], v[12:15], a[48:55], v0
s_nop 0
v_add_f32 v24, v24, v25
v_add_f32 v26, v26, v27
v_add_f32 v28, v28, v29
v_add_f32 v30, v30, v31
v_cvt_pk_bf16_f32 v24, v24, v28
v_cvt_pk_bf16_f32 v26, v26, v30
ds_write_b32 v4, v24 offset:2176
v_add_f32 v32, v32, v33
v_add_f32 v34, v34, v35
v_add_f32 v36, v36, v37
v_add_f32 v38, v38, v39
ds_write_b32 v3, v26 offset:2176
v_cvt_pk_bf16_f32 v32, v32, v36
v_cvt_pk_bf16_f32 v34, v34, v38
ds_write_b32 v4, v32
v_smfmac_f32_16x16x64_bf16 v[60:63], v[12:15], a[56:63], v0
ds_write_b32 v3, v34
s_waitcnt lgkmcnt(5)
v_smfmac_f32_16x16x64_bf16 v[56:59], v[16:19], a[64:71], v0
ds_read_b128 v[12:15], v1 offset:11776
v_smfmac_f32_16x16x64_bf16 v[60:63], v[16:19], a[72:79], v0
ds_read_b128 v[16:19], v1 offset:12800
s_waitcnt lgkmcnt(6)
v_smfmac_f32_16x16x64_bf16 v[56:59], v[20:23], a[80:87], v0
s_waitcnt lgkmcnt(2) vmcnt(7)
s_barrier
ds_read_b128 v[24:27], v5 offset:0
v_smfmac_f32_16x16x64_bf16 v[60:63], v[20:23], a[88:95], v0
ds_read_b128 v[20:23], v1 offset:13824
s_waitcnt lgkmcnt(3)
v_smfmac_f32_16x16x64_bf16 v[56:59], v[12:15], a[112:119], v0
ds_read_b128 v[40:43], v1 offset:15872
v_smfmac_f32_16x16x64_bf16 v[60:63], v[12:15], a[120:127], v0
ds_read_b128 v[12:15], v1 offset:14848
s_waitcnt lgkmcnt(4)
v_smfmac_f32_16x16x64_bf16 v[56:59], v[16:19], a[128:135], v0
ds_read_b128 v[28:31], v5 offset:512
v_smfmac_f32_16x16x64_bf16 v[60:63], v[16:19], a[136:143], v0
ds_read_b128 v[44:47], v1 offset:17920
s_waitcnt lgkmcnt(4)
v_smfmac_f32_16x16x64_bf16 v[56:59], v[20:23], a[144:151], v0
ds_read_b128 v[32:35], v5 offset:1024
s_mov_b64 exec, s[86:87]
buffer_store_dwordx4 v[24:27], v5, s[8:11], s31 offen offset:0 sc1
s_mov_b64 exec, -1
v_smfmac_f32_16x16x64_bf16 v[60:63], v[20:23], a[152:159], v0
ds_read_b128 v[48:51], v1 offset:19968
s_waitcnt lgkmcnt(4)
v_smfmac_f32_16x16x64_bf16 v[56:59], v[12:15], a[160:167], v0
ds_read_b128 v[36:39], v5 offset:1536
v_smfmac_f32_16x16x64_bf16 v[60:63], v[12:15], a[168:175], v0
ds_read_b128 v[52:55], v1 offset:22016
v_mfma_f32_16x16x32_bf16 v[16:19], v[40:43], v[24:27], 0
ds_read_b128 v[40:43], v1 offset:16896
s_waitcnt lgkmcnt(5)
v_mfma_f32_16x16x32_bf16 v[16:19], v[44:47], v[28:31], v[16:19]
ds_read_b128 v[44:47], v1 offset:18944
s_waitcnt lgkmcnt(4)
v_mfma_f32_16x16x32_bf16 v[16:19], v[48:51], v[32:35], v[16:19]
ds_read_b128 v[48:51], v1 offset:20992
s_waitcnt lgkmcnt(3)
v_mfma_f32_16x16x32_bf16 v[16:19], v[52:55], v[36:39], v[16:19]
ds_read_b128 v[52:55], v1 offset:23040
v_mfma_f32_16x16x32_bf16 v[20:23], v[24:27], v[24:27], 0
v_add_f32 v56, v56, v57
v_add_f32 v58, v58, v59
v_mfma_f32_16x16x32_bf16 v[20:23], v[28:31], v[28:31], v[20:23]
v_add_f32 v60, v60, v61
v_add_f32 v62, v62, v63
v_mfma_f32_16x16x32_bf16 v[20:23], v[32:35], v[32:35], v[20:23]
v_cvt_pk_bf16_f32 v56, v56, v58
v_cvt_pk_bf16_f32 v57, v60, v62
v_mfma_f32_16x16x32_bf16 v[20:23], v[36:39], v[36:39], v[20:23]
v_lshrrev_b32 v58, 1, v1
v_max3_f32 v59, v16, v17, v18
s_waitcnt lgkmcnt(3)
v_mfma_f32_16x16x32_bf16 v[12:15], v[40:43], v[24:27], 0
ds_read_b128 v[40:43], v2 offset:18432
buffer_store_dwordx2 v[56:57], v58, s[8:11], s31 offen offset:2048 sc1
s_waitcnt lgkmcnt(3)
v_mfma_f32_16x16x32_bf16 v[12:15], v[44:47], v[28:31], v[12:15]
ds_read_b128 v[44:47], v2 offset:19456
s_waitcnt lgkmcnt(3)
v_mfma_f32_16x16x32_bf16 v[12:15], v[48:51], v[32:35], v[12:15]
ds_read_b128 v[48:51], v2 offset:20480
v_max3_f32 v59, v59, v19, v20
v_max_f32 v59, v59, v21
s_waitcnt lgkmcnt(3)
v_mfma_f32_16x16x32_bf16 v[12:15], v[52:55], v[36:39], v[12:15]
ds_read_b128 v[52:55], v2 offset:21504
v_mov_b32 v60, s53
s_add_u32 s49, s28, s23
v_mov_b32 v61, s53
s_add_u32 s50, s28, 65536
v_mov_b32 v62, s53
ds_read_b128 v[32:35], v2 offset:22528
v_mov_b32 v63, s53
v_max3_f32 v59, v59, v12, v13
v_max3_f32 v22, v59, v14, v15
v_max3_f32 v59, v59, v14, v15
s_add_u32 s51, s28, 131072
s_add_u32 s52, s28, 196608
v_permlane32_swap_b32 v22, v59
v_max_f32 v23, v59, v22
v_max_f32 v59, v59, v22
v_mov_b32 v22, 0
ds_read_b128 v[36:39], v2 offset:23552
v_permlane16_swap_b32 v23, v59
v_max_f32 v59, v59, v23
v_mul_f32 v58, s18, v59
v_pk_fma_f32 v[20:21], v[20:21], s[18:19], v[58:59] op_sel_hi:[1,0,0] neg_lo:[0,0,1] neg_hi:[0,0,1]
v_pk_fma_f32 v[16:17], v[16:17], s[18:19], v[58:59] op_sel_hi:[1,0,0] neg_lo:[0,0,1] neg_hi:[0,0,1]
v_pk_fma_f32 v[18:19], v[18:19], s[18:19], v[58:59] op_sel_hi:[1,0,0] neg_lo:[0,0,1] neg_hi:[0,0,1]
v_pk_fma_f32 v[12:13], v[12:13], s[18:19], v[58:59] op_sel_hi:[1,0,0] neg_lo:[0,0,1] neg_hi:[0,0,1]
v_pk_fma_f32 v[14:15], v[14:15], s[18:19], v[58:59] op_sel_hi:[1,0,0] neg_lo:[0,0,1] neg_hi:[0,0,1]
v_exp_f32 v20, v20
v_exp_f32 v21, v21
v_exp_f32 v16, v16
v_cvt_pk_bf16_f32 v23, v20, v21
v_cvt_pk_bf16_f32 v20, v20, v21
v_mov_b32 v21, 0
v_exp_f32 v17, v17
v_exp_f32 v18, v18
v_mfma_f32_16x16x16_bf16 v[24:27], v[56:57], v[20:21], 0
v_exp_f32 v19, v19
v_mfma_f32_16x16x16_bf16 v[28:31], v[56:57], v[22:23], 0
v_exp_f32 v12, v12
v_exp_f32 v13, v13
v_cvt_pk_bf16_f32 v16, v16, v17
v_cvt_pk_bf16_f32 v17, v18, v19
v_exp_f32 v14, v14
v_exp_f32 v15, v15
v_cvt_pk_bf16_f32 v18, v12, v13
v_cvt_pk_bf16_f32 v19, v14, v15
v_mfma_f32_16x16x16_bf16 v[12:15], v[60:61], v[20:21], 0
s_waitcnt vmcnt(3)
v_mfma_f32_16x16x32_bf16 v[12:15], v[60:63], v[16:19], v[12:15]
v_mov_b32 v20, 0
v_mov_b32 v23, 0
v_mfma_f32_16x16x32_bf16 v[24:27], v[64:67], v[16:19], v[24:27]
s_nop 1
v_mfma_f32_16x16x32_bf16 v[28:31], v[68:71], v[16:19], v[28:31]
v_mov_b32 v16, 0
v_mov_b32 v17, 0
v_rcp_f32 v12, v12
v_mov_b32 v18, 0
v_mov_b32 v19, 0
v_pk_mul_f32 v[24:25], v[24:25], v[12:13] op_sel_hi:[1,0]
v_pk_mul_f32 v[26:27], v[26:27], v[12:13] op_sel_hi:[1,0]
v_mov_b32 v15, 0
v_pk_mul_f32 v[28:29], v[28:29], v[12:13] op_sel_hi:[1,0]
v_pk_mul_f32 v[30:31], v[30:31], v[12:13] op_sel_hi:[1,0]
v_cvt_pk_bf16_f32 v24, v24, v28
v_cvt_pk_bf16_f32 v25, v25, v29
v_cvt_pk_bf16_f32 v26, v26, v30
v_cvt_pk_bf16_f32 v27, v27, v31
v_mfma_f32_16x16x32_bf16 v[56:59], v[20:23], v[20:23], 0
ds_write_b128 v7, v[24:27]
v_mfma_f32_16x16x32_bf16 v[60:63], v[20:23], v[20:23], 0
v_mov_b32 v12, 0
v_mov_b32 v13, 0
v_mov_b32 v14, 0
v_mov_b32 v3, 6528
s_nop 1
v_mfma_f32_16x16x32_bf16 v[64:67], v[20:23], v[20:23], 0
s_cmp_eq_u32 s19, 63
s_cbranch_scc1 L_texit
s_waitcnt lgkmcnt(0)
s_barrier
ds_read_b128 v[24:27], v1 offset:4224
v_mfma_f32_16x16x32_bf16 v[68:71], v[20:23], v[20:23], 0
ds_read_b128 v[28:31], v1 offset:5248
s_nop 2
v_mfma_f32_16x16x32_bf16 v[68:71], v[20:23], v[20:23], 0
s_waitcnt lgkmcnt(1)
v_smfmac_f32_16x16x64_bf16 v[12:15], v[24:27], a[248:255], v0
v_smfmac_f32_16x16x64_bf16 v[16:19], v[24:27], a[176:183], v0
s_waitcnt lgkmcnt(0)
v_smfmac_f32_16x16x64_bf16 v[12:15], v[28:31], v[40:47], v0
ds_read_b128 v[40:43], v2 offset:24576
v_smfmac_f32_16x16x64_bf16 v[16:19], v[28:31], v[48:55], v0
ds_read_b128 v[44:47], v2 offset:25600
v_smfmac_f32_16x16x64_bf16 v[20:23], v[24:27], a[184:191], v0
ds_read_b128 v[48:51], v2 offset:26624
v_smfmac_f32_16x16x64_bf16 v[20:23], v[28:31], v[32:39], v0
ds_read_b128 v[52:55], v2 offset:27648
s_nop 0
v_add_f32 v12, v12, v13
v_add_f32 v14, v14, v15
v_smfmac_f32_16x16x64_bf16 v[56:59], v[24:27], a[192:199], v0
ds_read_b128 v[32:35], v2 offset:28672
s_waitcnt lgkmcnt(3)
v_cvt_pk_bf16_f32 v12, v12, v14
buffer_store_dword v12, v10, s[8:11], s28 offen
v_smfmac_f32_16x16x64_bf16 v[56:59], v[28:31], v[40:47], v0
ds_read_b128 v[36:39], v2 offset:29696
v_add_f32 v16, v16, v17
v_add_f32 v18, v18, v19
v_smfmac_f32_16x16x64_bf16 v[60:63], v[24:27], a[200:207], v0
ds_read_b128 v[12:15], v3
s_waitcnt lgkmcnt(3)
v_cvt_pk_bf16_f32 v16, v16, v18
v_add_f32 v20, v20, v21
v_smfmac_f32_16x16x64_bf16 v[60:63], v[28:31], v[48:55], v0
ds_read_b128 v[40:43], v2 offset:30720
v_add_f32 v22, v22, v23
v_cvt_pk_bf16_f32 v17, v20, v22
v_smfmac_f32_16x16x64_bf16 v[64:67], v[24:27], a[208:215], v0
ds_read_b128 v[44:47], v2 offset:31744
s_waitcnt lgkmcnt(3)
buffer_store_dwordx2 v[16:17], v9, s[8:11], s28 offen
v_add_f32 v56, v56, v57
v_smfmac_f32_16x16x64_bf16 v[64:67], v[28:31], v[32:39], v0
ds_read_b128 v[48:51], v2 offset:32768
v_add_f32 v58, v58, v59
v_cvt_pk_bf16_f32 v56, v56, v58
v_smfmac_f32_16x16x64_bf16 v[68:71], v[24:27], a[216:223], v0
ds_read_b128 v[52:55], v2 offset:33792
s_waitcnt lgkmcnt(2)
v_add_f32 v60, v60, v61
v_add_f32 v62, v62, v63
v_smfmac_f32_16x16x64_bf16 v[68:71], v[28:31], v[40:47], v0
ds_read_b128 v[20:23], v3
v_cvt_pk_bf16_f32 v57, v60, v62
buffer_store_dwordx2 v[56:57], v9, s[8:11], s50 offen
v_smfmac_f32_16x16x64_bf16 v[12:15], v[24:27], a[224:231], v0
s_waitcnt lgkmcnt(1)
v_add_f32 v64, v64, v65
v_add_f32 v66, v66, v67
v_smfmac_f32_16x16x64_bf16 v[12:15], v[28:31], v[48:55], v0
s_waitcnt lgkmcnt(0)
v_cvt_pk_bf16_f32 v64, v64, v66
v_smfmac_f32_16x16x64_bf16 v[20:23], v[24:27], a[232:239], v0
v_add_f32 v68, v68, v69
v_add_f32 v70, v70, v71
v_smfmac_f32_16x16x64_bf16 v[20:23], v[28:31], a[240:247], v0
v_cvt_pk_bf16_f32 v65, v68, v70
buffer_store_dwordx2 v[64:65], v9, s[8:11], s51 offen
v_add_f32 v12, v12, v13
v_add_f32 v14, v14, v15
v_cvt_pk_bf16_f32 v12, v12, v14
s_nop 2
v_add_f32 v20, v20, v21
v_add_f32 v22, v22, v23
v_cvt_pk_bf16_f32 v13, v20, v22
buffer_store_dwordx2 v[12:13], v9, s[8:11], s52 offen
s_add_u32 s19, s19, 1
s_mov_b32 s20, s28
s_mov_b32 s28, s29
s_mov_b32 s29, s20
s_and_b32 s20, s19, 3
s_lshl_b32 s20, s20, 14
s_add_u32 s33, s20, 110100480
s_add_u32 s34, s20, s24
s_xor_b32 s20, s20, 32768
s_add_u32 s35, s20, s24
s_add_u32 s30, s30, 16384
s_add_u32 s31, s31, 131072
s_add_u32 s6, s33, 4096
s_add_u32 s7, s33, 8192
s_mov_b32 s22, 0
v_mov_b64 v[24:25], 0
v_mov_b64 v[26:27], 0
v_mov_b64 v[28:29], 0
v_mov_b64 v[30:31], 0
v_and_b32 v69, 0x380, v1
v_add_u32 v69, v69, v1
v_lshlrev_b32 v70, 1, v1
v_mov_b64 v[64:65], -1
v_mov_b64 v[66:67], -1
v_xor_b32 v3, 16, v4
ds_read_b128 v[48:51], v2 offset:8192
ds_read_b128 v[52:55], v2 offset:9216
v_mov_b32 v56, 0x3f80
v_cndmask_b32 v56, v56, 1.0, s[44:45]
v_cndmask_b32 v60, 0, v56, s[36:37]
v_cndmask_b32 v61, 0, v56, s[38:39]
v_cndmask_b32 v62, 0, v56, s[40:41]
v_cndmask_b32 v63, 0, v56, s[42:43]
s_nop 6
buffer_load_dwordx4 v[32:35], v1, s[8:11], s49 offen offset:0 sc1
buffer_load_dwordx4 v[36:39], v1, s[8:11], s49 offen offset:1024 sc1
buffer_load_dwordx4 v[40:43], v1, s[8:11], s49 offen offset:2048 sc1
buffer_load_dwordx4 v[44:47], v1, s[8:11], s49 offen offset:3072 sc1
s_waitcnt vmcnt(3)
v_mfma_f32_16x16x32_bf16 v[56:59], v[32:35], v[60:63], 0
v_max3_u32 v16, v32, v33, v34
v_max_u32 v16, v16, v35
s_waitcnt vmcnt(2)
v_mfma_f32_16x16x32_bf16 v[56:59], v[36:39], v[60:63], v[56:59]
v_max3_u32 v16, v16, v36, v37
v_max3_u32 v16, v16, v38, v39
s_waitcnt vmcnt(1)
v_mfma_f32_16x16x32_bf16 v[56:59], v[40:43], v[60:63], v[56:59]
v_max3_u32 v16, v16, v40, v41
v_max3_u32 v16, v16, v42, v43
s_waitcnt vmcnt(0)
v_mfma_f32_16x16x32_bf16 v[56:59], v[44:47], v[60:63], v[56:59]
v_max3_u32 v16, v16, v44, v45
v_max3_u32 v16, v16, v46, v47
v_cmp_le_u32 vcc, 0xffff0000, v16
s_cbranch_vccnz L_red0
L_redb0:
s_nop 3
v_permlane32_swap_b32 v56, v58
v_permlane32_swap_b32 v57, v59
v_pk_add_f32 v[56:57], v[56:57], v[58:59]
v_cvt_pk_bf16_f32 v56, v56, v57
buffer_store_dword v56, v11, s[8:11], s34 offen
s_barrier
ds_read_b128 v[40:43], v2 offset:0
ds_read_b128 v[44:47], v2 offset:1024
v_mov_b64 v[32:33], 0
v_mov_b64 v[34:35], 0
v_mov_b64 v[36:37], 0
v_mov_b64 v[38:39], 0
v_mov_b64 v[56:57], 0
v_mov_b64 v[58:59], 0
v_mov_b64 v[60:61], 0
v_mov_b64 v[62:63], 0
s_nop 15
s_nop 13
s_branch L_gat0
L_red0:
L_red0b:
buffer_load_dwordx4 v[32:35], v1, s[8:11], s49 offen offset:0 sc1
buffer_load_dwordx4 v[36:39], v1, s[8:11], s49 offen offset:1024 sc1
buffer_load_dwordx4 v[40:43], v1, s[8:11], s49 offen offset:2048 sc1
buffer_load_dwordx4 v[44:47], v1, s[8:11], s49 offen offset:3072 sc1
s_add_u32 s22, s22, 1
s_cmp_gt_u32 s22, 40000
s_cbranch_scc1 L_end
s_waitcnt vmcnt(3)
v_mfma_f32_16x16x32_bf16 v[56:59], v[32:35], v[60:63], 0
v_max3_u32 v16, v32, v33, v34
v_max_u32 v16, v16, v35
s_waitcnt vmcnt(2)
v_mfma_f32_16x16x32_bf16 v[56:59], v[36:39], v[60:63], v[56:59]
v_max3_u32 v16, v16, v36, v37
v_max3_u32 v16, v16, v38, v39
s_waitcnt vmcnt(1)
v_mfma_f32_16x16x32_bf16 v[56:59], v[40:43], v[60:63], v[56:59]
v_max3_u32 v16, v16, v40, v41
v_max3_u32 v16, v16, v42, v43
s_waitcnt vmcnt(0)
v_mfma_f32_16x16x32_bf16 v[56:59], v[44:47], v[60:63], v[56:59]
v_max3_u32 v16, v16, v44, v45
v_max3_u32 v16, v16, v46, v47
v_cmp_le_u32 vcc, 0xffff0000, v16
s_cbranch_vccz L_redb0
s_branch L_red0b
L_ent1:
v_lshlrev_b32 v6, 3, v1
v_mov_b64 v[24:25], 0
v_mov_b64 v[26:27], 0
v_mov_b64 v[28:29], 0
v_mov_b64 v[30:31], 0
v_and_b32 v69, 0x380, v1
v_add_u32 v69, v69, v1
v_lshlrev_b32 v70, 1, v1
v_mov_b64 v[64:65], -1
v_mov_b64 v[66:67], -1
v_xor_b32 v3, 16, v4
ds_read_b128 v[48:51], v2 offset:10240
ds_read_b128 v[52:55], v2 offset:11264
ds_read_b128 v[40:43], v2 offset:2048
ds_read_b128 v[44:47], v2 offset:3072
v_mov_b64 v[32:33], 0
v_mov_b64 v[34:35], 0
v_mov_b64 v[36:37], 0
v_mov_b64 v[38:39], 0
v_mov_b64 v[56:57], 0
v_mov_b64 v[58:59], 0
v_mov_b64 v[60:61], 0
v_mov_b64 v[62:63], 0
s_add_u32 s20, s30, 1024
s_add_u32 s21, s30, 8192
s_add_u32 s49, s29, s25
s_add_u32 s50, s29, s26
s_add_u32 s51, s29, s27
s_add_u32 s52, s30, 16384
s_mov_b32 m0, 17920
s_waitcnt vmcnt(0) lgkmcnt(0)
s_branch L_step1
L_gr1:
buffer_load_dwordx4 v[12:15], v1, s[8:11], s33 offen sc1
buffer_load_dword v20, v8, s[8:11], s7 offen sc1
buffer_load_dwordx4 v[16:19], v1, s[8:11], s6 offen sc1
s_add_u32 s22, s22, 1
s_cmp_gt_u32 s22, 40000
s_cbranch_scc1 L_end
s_nop 0
v_mov_b64 v[24:25], 0
v_mov_b64 v[26:27], 0
v_mov_b64 v[28:29], 0
v_mov_b64 v[30:31], 0
v_mov_b64 v[32:33], 0
v_mov_b64 v[34:35], 0
v_mov_b64 v[36:37], 0
v_mov_b64 v[38:39], 0
v_mov_b64 v[56:57], 0
v_mov_b64 v[58:59], 0
v_mov_b64 v[60:61], 0
v_mov_b64 v[62:63], 0
s_waitcnt lgkmcnt(0)
s_branch L_step1
.p2align 3
L_gat1:
buffer_load_dwordx4 v[12:15], v1, s[8:11], s33 offen sc1
buffer_load_dword v20, v8, s[8:11], s7 offen sc1
buffer_load_dwordx4 v[16:19], v1, s[8:11], s6 offen sc1
s_add_u32 s20, s30, 1024
s_add_u32 s21, s30, 8192
s_add_u32 s49, s29, s25
s_add_u32 s50, s29, s26
s_add_u32 s51, s29, s27
s_add_u32 s52, s30, 16384
s_mov_b32 m0, 17920
s_waitcnt lgkmcnt(0)
L_step1:
s_waitcnt vmcnt(2)
v_smfmac_f32_16x16x64_bf16 v[24:27], v[12:15], v[96:103], v0
ds_write_b128 v1, v[12:15] offset:6656
v_smfmac_f32_16x16x64_bf16 v[28:31], v[12:15], v[104:111], v0
s_waitcnt vmcnt(1)
ds_write_b32 v8, v20 offset:14848
v_smfmac_f32_16x16x64_bf16 v[32:35], v[12:15], v[112:119], v0
s_waitcnt vmcnt(0)
ds_write_b128 v1, v[16:19] offset:10752
v_smfmac_f32_16x16x64_bf16 v[56:59], v[12:15], a[48:55], v0
v_max3_u32 v21, v12, v13, v14
v_max3_u32 v21, v21, v15, v20
v_smfmac_f32_16x16x64_bf16 v[60:63], v[12:15], a[56:63], v0
v_max3_u32 v21, v21, v16, v17
v_max3_u32 v21, v21, v18, v19
v_smfmac_f32_16x16x64_bf16 v[36:39], v[12:15], v[40:47], v0
v_cmp_le_u32 vcc, 0xffff0000, v21
v_smfmac_f32_16x16x64_bf16 v[24:27], v[16:19], v[192:199], v0
s_cbranch_vccnz L_gr1
v_smfmac_f32_16x16x64_bf16 v[28:31], v[16:19], v[200:207], v0
s_waitcnt lgkmcnt(0)
s_barrier
ds_read_b128 v[20:23], v1 offset:5632
v_smfmac_f32_16x16x64_bf16 v[32:35], v[16:19], v[208:215], v0
ds_read_b128 v[12:15], v1 offset:7680
buffer_load_dwordx4 v69, s[8:11], s20 offen sc1 lds
v_smfmac_f32_16x16x64_bf16 v[56:59], v[16:19], a[112:119], v0
ds_read_b128 v[40:43], v2 offset:0
s_mov_b32 m0, 18816
v_smfmac_f32_16x16x64_bf16 v[60:63], v[16:19], a[120:127], v0
ds_read_b128 v[44:47], v2 offset:1024
v_smfmac_f32_16x16x64_bf16 v[36:39], v[16:19], v[48:55], v0
ds_read_b128 v[16:19], v1 offset:8704
s_waitcnt lgkmcnt(4)
v_smfmac_f32_16x16x64_bf16 v[24:27], v[20:23], v[72:79], v0
ds_read_b128 v[48:51], v2 offset:4096
buffer_load_dwordx4 v69, s[8:11], s20 offen offset:128 sc1 lds
v_smfmac_f32_16x16x64_bf16 v[28:31], v[20:23], v[80:87], v0
ds_read_b128 v[52:55], v2 offset:5120
s_mov_b32 m0, 6272
v_smfmac_f32_16x16x64_bf16 v[32:35], v[20:23], v[88:95], v0
buffer_store_dword v0, v11, s[8:11], s35 offen
s_waitcnt lgkmcnt(3)
v_smfmac_f32_16x16x64_bf16 v[36:39], v[20:23], v[40:47], v0
ds_read_b128 v[20:23], v1 offset:9728
v_smfmac_f32_16x16x64_bf16 v[24:27], v[12:15], v[120:127], v0
ds_read_b128 v[40:43], v2 offset:6144
v_smfmac_f32_16x16x64_bf16 v[28:31], v[12:15], v[128:135], v0
ds_read_b128 v[44:47], v2 offset:7168
buffer_store_dwordx4 v[64:67], v1, s[8:11], s49 offen
v_smfmac_f32_16x16x64_bf16 v[32:35], v[12:15], v[136:143], v0
s_waitcnt lgkmcnt(3)
v_smfmac_f32_16x16x64_bf16 v[36:39], v[12:15], v[48:55], v0
ds_read_b128 v[12:15], v1 offset:11776
v_smfmac_f32_16x16x64_bf16 v[24:27], v[16:19], v[144:151], v0
ds_read_b128 v[48:51], v2 offset:8192
v_smfmac_f32_16x16x64_bf16 v[28:31], v[16:19], v[152:159], v0
ds_read_b128 v[52:55], v2 offset:9216
buffer_store_dwordx4 v[64:67], v1, s[8:11], s50 offen
v_smfmac_f32_16x16x64_bf16 v[32:35], v[16:19], v[160:167], v0
s_waitcnt lgkmcnt(3)
v_smfmac_f32_16x16x64_bf16 v[36:39], v[16:19], v[40:47], v0
ds_read_b128 v[16:19], v1 offset:12800
v_smfmac_f32_16x16x64_bf16 v[24:27], v[20:23], v[168:175], v0
ds_read_b128 v[40:43], v2 offset:12288
v_smfmac_f32_16x16x64_bf16 v[28:31], v[20:23], v[176:183], v0
ds_read_b128 v[44:47], v2 offset:13312
buffer_store_dwordx4 v[64:67], v1, s[8:11], s51 offen
v_smfmac_f32_16x16x64_bf16 v[32:35], v[20:23], v[184:191], v0
s_waitcnt lgkmcnt(3)
v_smfmac_f32_16x16x64_bf16 v[36:39], v[20:23], v[48:55], v0
ds_read_b128 v[20:23], v1 offset:13824
v_smfmac_f32_16x16x64_bf16 v[24:27], v[12:15], v[216:223], v0
ds_read_b128 v[48:51], v2 offset:14336
buffer_load_dwordx4 v[64:67], v70, s[8:11], s21 offen sc1
v_smfmac_f32_16x16x64_bf16 v[28:31], v[12:15], v[224:231], v0
ds_read_b128 v[52:55], v2 offset:15360
v_smfmac_f32_16x16x64_bf16 v[32:35], v[12:15], v[232:239], v0
s_waitcnt lgkmcnt(3)
v_smfmac_f32_16x16x64_bf16 v[36:39], v[12:15], v[40:47], v0
ds_read_b128 v[12:15], v1 offset:5632
v_smfmac_f32_16x16x64_bf16 v[24:27], v[16:19], v[240:247], v0
ds_read_b128 v[40:43], v2 offset:16384
buffer_load_dwordx4 v[68:71], v70, s[8:11], s21 offen offset:16 sc1
v_smfmac_f32_16x16x64_bf16 v[28:31], v[16:19], v[248:255], v0
ds_read_b128 v[44:47], v2 offset:17408
v_smfmac_f32_16x16x64_bf16 v[32:35], v[16:19], a[0:7], v0
s_waitcnt lgkmcnt(3)
v_smfmac_f32_16x16x64_bf16 v[36:39], v[16:19], v[48:55], v0
ds_read_b128 v[16:19], v1 offset:7680
v_smfmac_f32_16x16x64_bf16 v[24:27], v[20:23], a[8:15], v0
v_smfmac_f32_16x16x64_bf16 v[28:31], v[20:23], a[16:23], v0
buffer_load_dword v6, s[8:11], s52 offen sc1 lds
v_smfmac_f32_16x16x64_bf16 v[32:35], v[20:23], a[24:31], v0
s_waitcnt lgkmcnt(1)
v_smfmac_f32_16x16x64_bf16 v[36:39], v[20:23], v[40:47], v0
ds_read_b128 v[20:23], v1 offset:8704
v_smfmac_f32_16x16x64_bf16 v[56:59], v[12:15], a[32:39], v0
s_nop 0
v_add_f32 v24, v24, v25
v_add_f32 v26, v26, v27
v_add_f32 v28, v28, v29
v_add_f32 v30, v30, v31
v_cvt_pk_bf16_f32 v24, v24, v28
v_cvt_pk_bf16_f32 v26, v26, v30
ds_write_b32 v4, v24 offset:2176
v_add_f32 v32, v32, v33
v_add_f32 v34, v34, v35
v_add_f32 v36, v36, v37
v_add_f32 v38, v38, v39
ds_write_b32 v3, v26 offset:2176
v_cvt_pk_bf16_f32 v32, v32, v36
v_cvt_pk_bf16_f32 v34, v34, v38
ds_write_b32 v4, v32
v_smfmac_f32_16x16x64_bf16 v[60:63], v[12:15], a[40:47], v0
ds_write_b32 v3, v34
s_waitcnt lgkmcnt(5)
v_smfmac_f32_16x16x64_bf16 v[56:59], v[16:19], a[64:71], v0
ds_read_b128 v[12:15], v1 offset:9728
v_smfmac_f32_16x16x64_bf16 v[60:63], v[16:19], a[72:79], v0
ds_read_b128 v[16:19], v1 offset:11776
s_waitcnt lgkmcnt(6)
v_smfmac_f32_16x16x64_bf16 v[56:59], v[20:23], a[80:87], v0
s_waitcnt lgkmcnt(2) vmcnt(7)
s_barrier
ds_read_b128 v[28:31], v5 offset:512
v_smfmac_f32_16x16x64_bf16 v[60:63], v[20:23], a[88:95], v0
ds_read_b128 v[20:23], v1 offset:12800
s_waitcnt lgkmcnt(3)
v_smfmac_f32_16x16x64_bf16 v[56:59], v[12:15], a[96:103], v0
ds_read_b128 v[44:47], v1 offset:16896
v_smfmac_f32_16x16x64_bf16 v[60:63], v[12:15], a[104:111], v0
ds_read_b128 v[12:15], v1 offset:13824
s_waitcnt lgkmcnt(4)
v_smfmac_f32_16x16x64_bf16 v[56:59], v[16:19], a[128:135], v0
ds_read_b128 v[32:35], v5 offset:1024
v_smfmac_f32_16x16x64_bf16 v[60:63], v[16:19], a[136:143], v0
ds_read_b128 v[48:51], v1 offset:18944
s_waitcnt lgkmcnt(4)
v_smfmac_f32_16x16x64_bf16 v[56:59], v[20:23], a[144:151], v0
ds_read_b128 v[36:39], v5 offset:1536
v_smfmac_f32_16x16x64_bf16 v[60:63], v[20:23], a[152:159], v0
ds_read_b128 v[52:55], v1 offset:20992
s_mov_b64 exec, s[86:87]
buffer_store_dwordx4 v[28:31], v5, s[8:11], s31 offen offset:512 sc1
s_mov_b64 exec, -1
s_waitcnt lgkmcnt(4)
v_smfmac_f32_16x16x64_bf16 v[56:59], v[12:15], a[160:167], v0
ds_read_b128 v[24:27], v5 offset:0
v_smfmac_f32_16x16x64_bf16 v[60:63], v[12:15], a[168:175], v0
ds_read_b128 v[40:43], v1 offset:14848
v_mfma_f32_16x16x32_bf16 v[16:19], v[44:47], v[28:31], 0
ds_read_b128 v[44:47], v1 offset:17920
s_waitcnt lgkmcnt(5)
v_mfma_f32_16x16x32_bf16 v[16:19], v[48:51], v[32:35], v[16:19]
ds_read_b128 v[48:51], v1 offset:19968
s_waitcnt lgkmcnt(4)
v_mfma_f32_16x16x32_bf16 v[16:19], v[52:55], v[36:39], v[16:19]
ds_read_b128 v[52:55], v1 offset:22016
s_waitcnt lgkmcnt(3)
v_mfma_f32_16x16x32_bf16 v[16:19], v[40:43], v[24:27], v[16:19]
ds_read_b128 v[40:43], v1 offset:15872
v_mfma_f32_16x16x32_bf16 v[20:23], v[28:31], v[28:31], 0
v_add_f32 v56, v56, v57
v_add_f32 v58, v58, v59
v_mfma_f32_16x16x32_bf16 v[20:23], v[32:35], v[32:35], v[20:23]
v_add_f32 v60, v60, v61
v_add_f32 v62, v62, v63
v_mfma_f32_16x16x32_bf16 v[20:23], v[36:39], v[36:39], v[20:23]
v_cvt_pk_bf16_f32 v56, v56, v58
v_cvt_pk_bf16_f32 v57, v60, v62
v_mfma_f32_16x16x32_bf16 v[20:23], v[24:27], v[24:27], v[20:23]
v_lshrrev_b32 v58, 1, v1
v_max3_f32 v59, v16, v17, v18
s_waitcnt lgkmcnt(3)
v_mfma_f32_16x16x32_bf16 v[12:15], v[44:47], v[28:31], 0
ds_read_b128 v[44:47], v2 offset:19456
s_waitcnt lgkmcnt(3)
v_mfma_f32_16x16x32_bf16 v[12:15], v[48:51], v[32:35], v[12:15]
ds_read_b128 v[48:51], v2 offset:20480
buffer_store_dwordx2 v[56:57], v58, s[8:11], s31 offen offset:2048 sc1
s_waitcnt lgkmcnt(3)
v_mfma_f32_16x16x32_bf16 v[12:15], v[52:55], v[36:39], v[12:15]
ds_read_b128 v[52:55], v2 offset:21504
v_max3_f32 v59, v59, v19, v20
v_max_f32 v59, v59, v21
s_waitcnt lgkmcnt(3)
v_mfma_f32_16x16x32_bf16 v[12:15], v[40:43], v[24:27], v[12:15]
ds_read_b128 v[40:43], v2 offset:18432
v_mov_b32 v60, s53
s_add_u32 s49, s28, s23
v_mov_b32 v61, s53
s_add_u32 s50, s28, 65536
v_mov_b32 v62, s53
ds_read_b128 v[32:35], v2 offset:22528
v_mov_b32 v63, s53
v_max3_f32 v59, v59, v12, v13
v_max3_f32 v22, v59, v14, v15
v_max3_f32 v59, v59, v14, v15
s_add_u32 s51, s28, 131072
s_add_u32 s52, s28, 196608
v_permlane32_swap_b32 v22, v59
v_max_f32 v23, v59, v22
v_max_f32 v59, v59, v22
v_mov_b32 v22, 0
ds_read_b128 v[36:39], v2 offset:23552
v_permlane16_swap_b32 v23, v59
v_max_f32 v59, v59, v23
v_mul_f32 v58, s18, v59
v_pk_fma_f32 v[20:21], v[20:21], s[18:19], v[58:59] op_sel_hi:[1,0,0] neg_lo:[0,0,1] neg_hi:[0,0,1]
v_pk_fma_f32 v[16:17], v[16:17], s[18:19], v[58:59] op_sel_hi:[1,0,0] neg_lo:[0,0,1] neg_hi:[0,0,1]
v_pk_fma_f32 v[18:19], v[18:19], s[18:19], v[58:59] op_sel_hi:[1,0,0] neg_lo:[0,0,1] neg_hi:[0,0,1]
v_pk_fma_f32 v[12:13], v[12:13], s[18:19], v[58:59] op_sel_hi:[1,0,0] neg_lo:[0,0,1] neg_hi:[0,0,1]
v_pk_fma_f32 v[14:15], v[14:15], s[18:19], v[58:59] op_sel_hi:[1,0,0] neg_lo:[0,0,1] neg_hi:[0,0,1]
v_exp_f32 v20, v20
v_exp_f32 v21, v21
v_exp_f32 v16, v16
v_cvt_pk_bf16_f32 v23, v20, v21
v_cvt_pk_bf16_f32 v20, v20, v21
v_mov_b32 v21, 0
v_exp_f32 v17, v17
v_exp_f32 v18, v18
v_mfma_f32_16x16x16_bf16 v[24:27], v[56:57], v[20:21], 0
v_exp_f32 v19, v19
v_mfma_f32_16x16x16_bf16 v[28:31], v[56:57], v[22:23], 0
v_exp_f32 v12, v12
v_exp_f32 v13, v13
v_cvt_pk_bf16_f32 v16, v16, v17
v_cvt_pk_bf16_f32 v17, v18, v19
v_exp_f32 v14, v14
v_exp_f32 v15, v15
v_cvt_pk_bf16_f32 v18, v12, v13
v_cvt_pk_bf16_f32 v19, v14, v15
v_mfma_f32_16x16x16_bf16 v[12:15], v[60:61], v[20:21], 0
s_waitcnt vmcnt(3)
v_mfma_f32_16x16x32_bf16 v[12:15], v[60:63], v[16:19], v[12:15]
v_mov_b32 v20, 0
v_mov_b32 v23, 0
v_mfma_f32_16x16x32_bf16 v[24:27], v[64:67], v[16:19], v[24:27]
s_nop 1
v_mfma_f32_16x16x32_bf16 v[28:31], v[68:71], v[16:19], v[28:31]
v_mov_b32 v16, 0
v_mov_b32 v17, 0
v_rcp_f32 v12, v12
v_mov_b32 v18, 0
v_mov_b32 v19, 0
v_pk_mul_f32 v[24:25], v[24:25], v[12:13] op_sel_hi:[1,0]
v_pk_mul_f32 v[26:27], v[26:27], v[12:13] op_sel_hi:[1,0]
v_mov_b32 v15, 0
v_pk_mul_f32 v[28:29], v[28:29], v[12:13] op_sel_hi:[1,0]
v_pk_mul_f32 v[30:31], v[30:31], v[12:13] op_sel_hi:[1,0]
v_cvt_pk_bf16_f32 v24, v24, v28
v_cvt_pk_bf16_f32 v25, v25, v29
v_cvt_pk_bf16_f32 v26, v26, v30
v_cvt_pk_bf16_f32 v27, v27, v31
v_mfma_f32_16x16x32_bf16 v[56:59], v[20:23], v[20:23], 0
ds_write_b128 v7, v[24:27]
v_mfma_f32_16x16x32_bf16 v[60:63], v[20:23], v[20:23], 0
v_mov_b32 v12, 0
v_mov_b32 v13, 0
v_mov_b32 v14, 0
v_mov_b32 v3, 6528
s_nop 1
v_mfma_f32_16x16x32_bf16 v[64:67], v[20:23], v[20:23], 0
s_cmp_eq_u32 s19, 63
s_cbranch_scc1 L_texit
s_waitcnt lgkmcnt(0)
s_barrier
ds_read_b128 v[24:27], v1 offset:3200
v_mfma_f32_16x16x32_bf16 v[68:71], v[20:23], v[20:23], 0
ds_read_b128 v[28:31], v1 offset:4224
s_nop 2
v_mfma_f32_16x16x32_bf16 v[68:71], v[20:23], v[20:23], 0
s_waitcnt lgkmcnt(1)
v_smfmac_f32_16x16x64_bf16 v[12:15], v[24:27], a[248:255], v0
v_smfmac_f32_16x16x64_bf16 v[16:19], v[24:27], a[176:183], v0
s_waitcnt lgkmcnt(0)
v_smfmac_f32_16x16x64_bf16 v[12:15], v[28:31], v[40:47], v0
ds_read_b128 v[40:43], v2 offset:24576
v_smfmac_f32_16x16x64_bf16 v[16:19], v[28:31], v[48:55], v0
ds_read_b128 v[44:47], v2 offset:25600
v_smfmac_f32_16x16x64_bf16 v[20:23], v[24:27], a[184:191], v0
ds_read_b128 v[48:51], v2 offset:26624
v_smfmac_f32_16x16x64_bf16 v[20:23], v[28:31], v[32:39], v0
ds_read_b128 v[52:55], v2 offset:27648
s_nop 0
v_add_f32 v12, v12, v13
v_add_f32 v14, v14, v15
v_smfmac_f32_16x16x64_bf16 v[56:59], v[24:27], a[192:199], v0
ds_read_b128 v[32:35], v2 offset:28672
s_waitcnt lgkmcnt(3)
v_cvt_pk_bf16_f32 v12, v12, v14
buffer_store_dword v12, v10, s[8:11], s28 offen
v_smfmac_f32_16x16x64_bf16 v[56:59], v[28:31], v[40:47], v0
ds_read_b128 v[36:39], v2 offset:29696
v_add_f32 v16, v16, v17
v_add_f32 v18, v18, v19
v_smfmac_f32_16x16x64_bf16 v[60:63], v[24:27], a[200:207], v0
ds_read_b128 v[12:15], v3
s_waitcnt lgkmcnt(3)
v_cvt_pk_bf16_f32 v16, v16, v18
v_add_f32 v20, v20, v21
v_smfmac_f32_16x16x64_bf16 v[60:63], v[28:31], v[48:55], v0
ds_read_b128 v[40:43], v2 offset:30720
v_add_f32 v22, v22, v23
v_cvt_pk_bf16_f32 v17, v20, v22
v_smfmac_f32_16x16x64_bf16 v[64:67], v[24:27], a[208:215], v0
ds_read_b128 v[44:47], v2 offset:31744
s_waitcnt lgkmcnt(3)
buffer_store_dwordx2 v[16:17], v9, s[8:11], s28 offen
v_add_f32 v56, v56, v57
v_smfmac_f32_16x16x64_bf16 v[64:67], v[28:31], v[32:39], v0
ds_read_b128 v[48:51], v2 offset:32768
v_add_f32 v58, v58, v59
v_cvt_pk_bf16_f32 v56, v56, v58
v_smfmac_f32_16x16x64_bf16 v[68:71], v[24:27], a[216:223], v0
ds_read_b128 v[52:55], v2 offset:33792
s_waitcnt lgkmcnt(2)
v_add_f32 v60, v60, v61
v_add_f32 v62, v62, v63
v_smfmac_f32_16x16x64_bf16 v[68:71], v[28:31], v[40:47], v0
ds_read_b128 v[20:23], v3
v_cvt_pk_bf16_f32 v57, v60, v62
buffer_store_dwordx2 v[56:57], v9, s[8:11], s50 offen
v_smfmac_f32_16x16x64_bf16 v[12:15], v[24:27], a[224:231], v0
s_waitcnt lgkmcnt(1)
v_add_f32 v64, v64, v65
v_add_f32 v66, v66, v67
v_smfmac_f32_16x16x64_bf16 v[12:15], v[28:31], v[48:55], v0
s_waitcnt lgkmcnt(0)
v_cvt_pk_bf16_f32 v64, v64, v66
v_smfmac_f32_16x16x64_bf16 v[20:23], v[24:27], a[232:239], v0
v_add_f32 v68, v68, v69
v_add_f32 v70, v70, v71
v_smfmac_f32_16x16x64_bf16 v[20:23], v[28:31], a[240:247], v0
v_cvt_pk_bf16_f32 v65, v68, v70
buffer_store_dwordx2 v[64:65], v9, s[8:11], s51 offen
v_add_f32 v12, v12, v13
v_add_f32 v14, v14, v15
v_cvt_pk_bf16_f32 v12, v12, v14
s_nop 2
v_add_f32 v20, v20, v21
v_add_f32 v22, v22, v23
v_cvt_pk_bf16_f32 v13, v20, v22
buffer_store_dwordx2 v[12:13], v9, s[8:11], s52 offen
s_add_u32 s19, s19, 1
s_mov_b32 s20, s28
s_mov_b32 s28, s29
s_mov_b32 s29, s20
s_and_b32 s20, s19, 3
s_lshl_b32 s20, s20, 14
s_add_u32 s33, s20, 110100480
s_add_u32 s34, s20, s24
s_xor_b32 s20, s20, 32768
s_add_u32 s35, s20, s24
s_add_u32 s30, s30, 16384
s_add_u32 s31, s31, 131072
s_add_u32 s6, s33, 4096
s_add_u32 s7, s33, 8192
s_mov_b32 s22, 0
v_mov_b64 v[24:25], 0
v_mov_b64 v[26:27], 0
v_mov_b64 v[28:29], 0
v_mov_b64 v[30:31], 0
v_and_b32 v69, 0x380, v1
v_add_u32 v69, v69, v1
v_lshlrev_b32 v70, 1, v1
v_mov_b64 v[64:65], -1
v_mov_b64 v[66:67], -1
v_xor_b32 v3, 16, v4
ds_read_b128 v[48:51], v2 offset:10240
ds_read_b128 v[52:55], v2 offset:11264
v_mov_b32 v56, 0x3f80
v_cndmask_b32 v56, v56, 1.0, s[44:45]
v_cndmask_b32 v60, 0, v56, s[36:37]
v_cndmask_b32 v61, 0, v56, s[38:39]
v_cndmask_b32 v62, 0, v56, s[40:41]
v_cndmask_b32 v63, 0, v56, s[42:43]
s_nop 6
buffer_load_dwordx4 v[32:35], v1, s[8:11], s49 offen offset:0 sc1
buffer_load_dwordx4 v[36:39], v1, s[8:11], s49 offen offset:1024 sc1
buffer_load_dwordx4 v[40:43], v1, s[8:11], s49 offen offset:2048 sc1
buffer_load_dwordx4 v[44:47], v1, s[8:11], s49 offen offset:3072 sc1
s_waitcnt vmcnt(3)
v_mfma_f32_16x16x32_bf16 v[56:59], v[32:35], v[60:63], 0
v_max3_u32 v16, v32, v33, v34
v_max_u32 v16, v16, v35
s_waitcnt vmcnt(2)
v_mfma_f32_16x16x32_bf16 v[56:59], v[36:39], v[60:63], v[56:59]
v_max3_u32 v16, v16, v36, v37
v_max3_u32 v16, v16, v38, v39
s_waitcnt vmcnt(1)
v_mfma_f32_16x16x32_bf16 v[56:59], v[40:43], v[60:63], v[56:59]
v_max3_u32 v16, v16, v40, v41
v_max3_u32 v16, v16, v42, v43
s_waitcnt vmcnt(0)
v_mfma_f32_16x16x32_bf16 v[56:59], v[44:47], v[60:63], v[56:59]
v_max3_u32 v16, v16, v44, v45
v_max3_u32 v16, v16, v46, v47
v_cmp_le_u32 vcc, 0xffff0000, v16
s_cbranch_vccnz L_red1
L_redb1:
s_nop 3
v_permlane32_swap_b32 v56, v58
v_permlane32_swap_b32 v57, v59
v_pk_add_f32 v[56:57], v[56:57], v[58:59]
v_cvt_pk_bf16_f32 v56, v56, v57
buffer_store_dword v56, v11, s[8:11], s34 offen
s_barrier
ds_read_b128 v[40:43], v2 offset:2048
ds_read_b128 v[44:47], v2 offset:3072
v_mov_b64 v[32:33], 0
v_mov_b64 v[34:35], 0
v_mov_b64 v[36:37], 0
v_mov_b64 v[38:39], 0
v_mov_b64 v[56:57], 0
v_mov_b64 v[58:59], 0
v_mov_b64 v[60:61], 0
v_mov_b64 v[62:63], 0
s_nop 15
s_nop 13
s_branch L_gat1
L_red1:
L_red1b:
buffer_load_dwordx4 v[32:35], v1, s[8:11], s49 offen offset:0 sc1
buffer_load_dwordx4 v[36:39], v1, s[8:11], s49 offen offset:1024 sc1
buffer_load_dwordx4 v[40:43], v1, s[8:11], s49 offen offset:2048 sc1
buffer_load_dwordx4 v[44:47], v1, s[8:11], s49 offen offset:3072 sc1
s_add_u32 s22, s22, 1
s_cmp_gt_u32 s22, 40000
s_cbranch_scc1 L_end
s_waitcnt vmcnt(3)
v_mfma_f32_16x16x32_bf16 v[56:59], v[32:35], v[60:63], 0
v_max3_u32 v16, v32, v33, v34
v_max_u32 v16, v16, v35
s_waitcnt vmcnt(2)
v_mfma_f32_16x16x32_bf16 v[56:59], v[36:39], v[60:63], v[56:59]
v_max3_u32 v16, v16, v36, v37
v_max3_u32 v16, v16, v38, v39
s_waitcnt vmcnt(1)
v_mfma_f32_16x16x32_bf16 v[56:59], v[40:43], v[60:63], v[56:59]
v_max3_u32 v16, v16, v40, v41
v_max3_u32 v16, v16, v42, v43
s_waitcnt vmcnt(0)
v_mfma_f32_16x16x32_bf16 v[56:59], v[44:47], v[60:63], v[56:59]
v_max3_u32 v16, v16, v44, v45
v_max3_u32 v16, v16, v46, v47
v_cmp_le_u32 vcc, 0xffff0000, v16
s_cbranch_vccz L_redb1
s_branch L_red1b
L_ent2:
v_lshlrev_b32 v6, 3, v1
v_mov_b64 v[24:25], 0
v_mov_b64 v[26:27], 0
v_mov_b64 v[28:29], 0
v_mov_b64 v[30:31], 0
v_and_b32 v69, 0x380, v1
v_add_u32 v69, v69, v1
v_lshlrev_b32 v70, 1, v1
v_mov_b64 v[64:65], -1
v_mov_b64 v[66:67], -1
v_xor_b32 v3, 16, v4
ds_read_b128 v[48:51], v2 offset:12288
ds_read_b128 v[52:55], v2 offset:13312
ds_read_b128 v[40:43], v2 offset:4096
ds_read_b128 v[44:47], v2 offset:5120
v_mov_b64 v[32:33], 0
v_mov_b64 v[34:35], 0
v_mov_b64 v[36:37], 0
v_mov_b64 v[38:39], 0
v_mov_b64 v[56:57], 0
v_mov_b64 v[58:59], 0
v_mov_b64 v[60:61], 0
v_mov_b64 v[62:63], 0
s_add_u32 s20, s30, 2048
s_add_u32 s21, s30, 8192
s_add_u32 s49, s29, s25
s_add_u32 s50, s29, s26
s_add_u32 s51, s29, s27
s_add_u32 s52, s30, 16384
s_mov_b32 m0, 19968
s_waitcnt vmcnt(0) lgkmcnt(0)
s_branch L_step2
L_gr2:
buffer_load_dwordx4 v[12:15], v1, s[8:11], s33 offen sc1
buffer_load_dword v20, v8, s[8:11], s7 offen sc1
buffer_load_dwordx4 v[16:19], v1, s[8:11], s6 offen sc1
s_add_u32 s22, s22, 1
s_cmp_gt_u32 s22, 40000
s_cbranch_scc1 L_end
s_nop 0
v_mov_b64 v[24:25], 0
v_mov_b64 v[26:27], 0
v_mov_b64 v[28:29], 0
v_mov_b64 v[30:31], 0
v_mov_b64 v[32:33], 0
v_mov_b64 v[34:35], 0
v_mov_b64 v[36:37], 0
v_mov_b64 v[38:39], 0
v_mov_b64 v[56:57], 0
v_mov_b64 v[58:59], 0
v_mov_b64 v[60:61], 0
v_mov_b64 v[62:63], 0
s_waitcnt lgkmcnt(0)
s_branch L_step2
.p2align 3
L_gat2:
buffer_load_dwordx4 v[12:15], v1, s[8:11], s33 offen sc1
buffer_load_dword v20, v8, s[8:11], s7 offen sc1
buffer_load_dwordx4 v[16:19], v1, s[8:11], s6 offen sc1
s_add_u32 s20, s30, 2048
s_add_u32 s21, s30, 8192
s_add_u32 s49, s29, s25
s_add_u32 s50, s29, s26
s_add_u32 s51, s29, s27
s_add_u32 s52, s30, 16384
s_mov_b32 m0, 19968
s_waitcnt lgkmcnt(0)
L_step2:
s_waitcnt vmcnt(2)
v_smfmac_f32_16x16x64_bf16 v[24:27], v[12:15], v[120:127], v0
ds_write_b128 v1, v[12:15] offset:6656
v_smfmac_f32_16x16x64_bf16 v[28:31], v[12:15], v[128:135], v0
s_waitcnt vmcnt(1)
ds_write_b32 v8, v20 offset:14848
v_smfmac_f32_16x16x64_bf16 v[32:35], v[12:15], v[136:143], v0
s_waitcnt vmcnt(0)
ds_write_b128 v1, v[16:19] offset:10752
v_smfmac_f32_16x16x64_bf16 v[56:59], v[12:15], a[64:71], v0
v_max3_u32 v21, v12, v13, v14
v_max3_u32 v21, v21, v15, v20
v_smfmac_f32_16x16x64_bf16 v[60:63], v[12:15], a[72:79], v0
v_max3_u32 v21, v21, v16, v17
v_max3_u32 v21, v21, v18, v19
v_smfmac_f32_16x16x64_bf16 v[36:39], v[12:15], v[40:47], v0
v_cmp_le_u32 vcc, 0xffff0000, v21
v_smfmac_f32_16x16x64_bf16 v[24:27], v[16:19], v[216:223], v0
s_cbranch_vccnz L_gr2
v_smfmac_f32_16x16x64_bf16 v[28:31], v[16:19], v[224:231], v0
s_waitcnt lgkmcnt(0)
s_barrier
ds_read_b128 v[20:23], v1 offset:4608
v_smfmac_f32_16x16x64_bf16 v[32:35], v[16:19], v[232:239], v0
ds_read_b128 v[12:15], v1 offset:5632
buffer_load_dwordx4 v69, s[8:11], s20 offen sc1 lds
v_smfmac_f32_16x16x64_bf16 v[56:59], v[16:19], a[128:135], v0
ds_read_b128 v[40:43], v2 offset:0
s_mov_b32 m0, 20864
v_smfmac_f32_16x16x64_bf16 v[60:63], v[16:19], a[136:143], v0
ds_read_b128 v[44:47], v2 offset:1024
v_smfmac_f32_16x16x64_bf16 v[36:39], v[16:19], v[48:55], v0
ds_read_b128 v[16:19], v1 offset:7680
s_waitcnt lgkmcnt(4)
v_smfmac_f32_16x16x64_bf16 v[24:27], v[20:23], v[72:79], v0
ds_read_b128 v[48:51], v2 offset:2048
buffer_load_dwordx4 v69, s[8:11], s20 offen offset:128 sc1 lds
v_smfmac_f32_16x16x64_bf16 v[28:31], v[20:23], v[80:87], v0
ds_read_b128 v[52:55], v2 offset:3072
s_mov_b32 m0, 6272
v_smfmac_f32_16x16x64_bf16 v[32:35], v[20:23], v[88:95], v0
buffer_store_dword v0, v11, s[8:11], s35 offen
s_waitcnt lgkmcnt(3)
v_smfmac_f32_16x16x64_bf16 v[36:39], v[20:23], v[40:47], v0
ds_read_b128 v[20:23], v1 offset:8704
v_smfmac_f32_16x16x64_bf16 v[24:27], v[12:15], v[96:103], v0
ds_read_b128 v[40:43], v2 offset:6144
v_smfmac_f32_16x16x64_bf16 v[28:31], v[12:15], v[104:111], v0
ds_read_b128 v[44:47], v2 offset:7168
v_smfmac_f32_16x16x64_bf16 v[32:35], v[12:15], v[112:119], v0
buffer_store_dwordx4 v[64:67], v1, s[8:11], s49 offen
s_waitcnt lgkmcnt(3)
v_smfmac_f32_16x16x64_bf16 v[36:39], v[12:15], v[48:55], v0
ds_read_b128 v[12:15], v1 offset:9728
v_smfmac_f32_16x16x64_bf16 v[24:27], v[16:19], v[144:151], v0
ds_read_b128 v[48:51], v2 offset:8192
v_smfmac_f32_16x16x64_bf16 v[28:31], v[16:19], v[152:159], v0
ds_read_b128 v[52:55], v2 offset:9216
v_smfmac_f32_16x16x64_bf16 v[32:35], v[16:19], v[160:167], v0
buffer_store_dwordx4 v[64:67], v1, s[8:11], s50 offen
s_waitcnt lgkmcnt(3)
v_smfmac_f32_16x16x64_bf16 v[36:39], v[16:19], v[40:47], v0
ds_read_b128 v[16:19], v1 offset:11776
v_smfmac_f32_16x16x64_bf16 v[24:27], v[20:23], v[168:175], v0
ds_read_b128 v[40:43], v2 offset:10240
v_smfmac_f32_16x16x64_bf16 v[28:31], v[20:23], v[176:183], v0
ds_read_b128 v[44:47], v2 offset:11264
v_smfmac_f32_16x16x64_bf16 v[32:35], v[20:23], v[184:191], v0
buffer_store_dwordx4 v[64:67], v1, s[8:11], s51 offen
s_waitcnt lgkmcnt(3)
v_smfmac_f32_16x16x64_bf16 v[36:39], v[20:23], v[48:55], v0
ds_read_b128 v[20:23], v1 offset:12800
v_smfmac_f32_16x16x64_bf16 v[24:27], v[12:15], v[192:199], v0
ds_read_b128 v[48:51], v2 offset:14336
buffer_load_dwordx4 v[64:67], v70, s[8:11], s21 offen sc1
v_smfmac_f32_16x16x64_bf16 v[28:31], v[12:15], v[200:207], v0
ds_read_b128 v[52:55], v2 offset:15360
v_smfmac_f32_16x16x64_bf16 v[32:35], v[12:15], v[208:215], v0
s_waitcnt lgkmcnt(3)
v_smfmac_f32_16x16x64_bf16 v[36:39], v[12:15], v[40:47], v0
ds_read_b128 v[12:15], v1 offset:4608
v_smfmac_f32_16x16x64_bf16 v[24:27], v[16:19], v[240:247], v0
ds_read_b128 v[40:43], v2 offset:16384
buffer_load_dwordx4 v[68:71], v70, s[8:11], s21 offen offset:16 sc1
v_smfmac_f32_16x16x64_bf16 v[28:31], v[16:19], v[248:255], v0
ds_read_b128 v[44:47], v2 offset:17408
v_smfmac_f32_16x16x64_bf16 v[32:35], v[16:19], a[0:7], v0
s_waitcnt lgkmcnt(3)
v_smfmac_f32_16x16x64_bf16 v[36:39], v[16:19], v[48:55], v0
ds_read_b128 v[16:19], v1 offset:5632
v_smfmac_f32_16x16x64_bf16 v[24:27], v[20:23], a[8:15], v0
v_smfmac_f32_16x16x64_bf16 v[28:31], v[20:23], a[16:23], v0
v_smfmac_f32_16x16x64_bf16 v[32:35], v[20:23], a[24:31], v0
s_waitcnt lgkmcnt(1)
v_smfmac_f32_16x16x64_bf16 v[36:39], v[20:23], v[40:47], v0
ds_read_b128 v[20:23], v1 offset:7680
v_smfmac_f32_16x16x64_bf16 v[56:59], v[12:15], a[32:39], v0
s_nop 1
v_add_f32 v24, v24, v25
v_add_f32 v26, v26, v27
v_add_f32 v28, v28, v29
v_add_f32 v30, v30, v31
v_cvt_pk_bf16_f32 v24, v24, v28
v_cvt_pk_bf16_f32 v26, v26, v30
ds_write_b32 v4, v24 offset:2176
v_add_f32 v32, v32, v33
v_add_f32 v34, v34, v35
v_add_f32 v36, v36, v37
v_add_f32 v38, v38, v39
ds_write_b32 v3, v26 offset:2176
v_cvt_pk_bf16_f32 v32, v32, v36
v_cvt_pk_bf16_f32 v34, v34, v38
ds_write_b32 v4, v32
v_smfmac_f32_16x16x64_bf16 v[60:63], v[12:15], a[40:47], v0
ds_write_b32 v3, v34
s_waitcnt lgkmcnt(5)
v_smfmac_f32_16x16x64_bf16 v[56:59], v[16:19], a[48:55], v0
ds_read_b128 v[12:15], v1 offset:8704
v_smfmac_f32_16x16x64_bf16 v[60:63], v[16:19], a[56:63], v0
ds_read_b128 v[16:19], v1 offset:9728
s_waitcnt lgkmcnt(6)
v_smfmac_f32_16x16x64_bf16 v[56:59], v[20:23], a[80:87], v0
s_waitcnt lgkmcnt(2) vmcnt(6)
s_barrier
ds_read_b128 v[32:35], v5 offset:1024
v_smfmac_f32_16x16x64_bf16 v[60:63], v[20:23], a[88:95], v0
ds_read_b128 v[20:23], v1 offset:11776
s_waitcnt lgkmcnt(3)
v_smfmac_f32_16x16x64_bf16 v[56:59], v[12:15], a[96:103], v0
ds_read_b128 v[48:51], v1 offset:17920
v_smfmac_f32_16x16x64_bf16 v[60:63], v[12:15], a[104:111], v0
ds_read_b128 v[12:15], v1 offset:12800
s_waitcnt lgkmcnt(4)
v_smfmac_f32_16x16x64_bf16 v[56:59], v[16:19], a[112:119], v0
ds_read_b128 v[36:39], v5 offset:1536
v_smfmac_f32_16x16x64_bf16 v[60:63], v[16:19], a[120:127], v0
ds_read_b128 v[52:55], v1 offset:19968
s_waitcnt lgkmcnt(4)
v_smfmac_f32_16x16x64_bf16 v[56:59], v[20:23], a[144:151], v0
ds_read_b128 v[24:27], v5 offset:0
v_smfmac_f32_16x16x64_bf16 v[60:63], v[20:23], a[152:159], v0
ds_read_b128 v[40:43], v1 offset:13824
s_waitcnt lgkmcnt(4)
v_smfmac_f32_16x16x64_bf16 v[56:59], v[12:15], a[160:167], v0
ds_read_b128 v[28:31], v5 offset:512
s_mov_b64 exec, s[86:87]
buffer_store_dwordx4 v[32:35], v5, s[8:11], s31 offen offset:1024 sc1
s_mov_b64 exec, -1
v_smfmac_f32_16x16x64_bf16 v[60:63], v[12:15], a[168:175], v0
ds_read_b128 v[44:47], v1 offset:15872
v_mfma_f32_16x16x32_bf16 v[16:19], v[48:51], v[32:35], 0
ds_read_b128 v[48:51], v1 offset:18944
s_waitcnt lgkmcnt(5)
v_mfma_f32_16x16x32_bf16 v[16:19], v[52:55], v[36:39], v[16:19]
ds_read_b128 v[52:55], v1 offset:20992
s_waitcnt lgkmcnt(4)
v_mfma_f32_16x16x32_bf16 v[16:19], v[40:43], v[24:27], v[16:19]
ds_read_b128 v[40:43], v1 offset:14848
s_waitcnt lgkmcnt(3)
v_mfma_f32_16x16x32_bf16 v[16:19], v[44:47], v[28:31], v[16:19]
ds_read_b128 v[44:47], v1 offset:16896
v_mfma_f32_16x16x32_bf16 v[20:23], v[32:35], v[32:35], 0
v_add_f32 v56, v56, v57
v_add_f32 v58, v58, v59
v_mfma_f32_16x16x32_bf16 v[20:23], v[36:39], v[36:39], v[20:23]
v_add_f32 v60, v60, v61
v_add_f32 v62, v62, v63
v_mfma_f32_16x16x32_bf16 v[20:23], v[24:27], v[24:27], v[20:23]
v_cvt_pk_bf16_f32 v56, v56, v58
v_cvt_pk_bf16_f32 v57, v60, v62
v_mfma_f32_16x16x32_bf16 v[20:23], v[28:31], v[28:31], v[20:23]
v_lshrrev_b32 v58, 1, v1
v_max3_f32 v59, v16, v17, v18
s_waitcnt lgkmcnt(3)
v_mfma_f32_16x16x32_bf16 v[12:15], v[48:51], v[32:35], 0
ds_read_b128 v[48:51], v2 offset:20480
s_waitcnt lgkmcnt(3)
v_mfma_f32_16x16x32_bf16 v[12:15], v[52:55], v[36:39], v[12:15]
ds_read_b128 v[52:55], v2 offset:21504
s_waitcnt lgkmcnt(3)
v_mfma_f32_16x16x32_bf16 v[12:15], v[40:43], v[24:27], v[12:15]
ds_read_b128 v[40:43], v2 offset:18432
buffer_store_dwordx2 v[56:57], v58, s[8:11], s31 offen offset:2048 sc1
s_waitcnt lgkmcnt(3)
v_mfma_f32_16x16x32_bf16 v[12:15], v[44:47], v[28:31], v[12:15]
ds_read_b128 v[44:47], v2 offset:19456
v_max3_f32 v59, v59, v19, v20
v_max_f32 v59, v59, v21
v_mov_b32 v60, s53
s_add_u32 s49, s28, s23
v_mov_b32 v61, s53
s_add_u32 s50, s28, 65536
v_mov_b32 v62, s53
ds_read_b128 v[32:35], v2 offset:22528
v_mov_b32 v63, s53
v_max3_f32 v59, v59, v12, v13
v_max3_f32 v22, v59, v14, v15
v_max3_f32 v59, v59, v14, v15
s_add_u32 s51, s28, 131072
s_add_u32 s52, s28, 196608
v_permlane32_swap_b32 v22, v59
v_max_f32 v23, v59, v22
v_max_f32 v59, v59, v22
v_mov_b32 v22, 0
ds_read_b128 v[36:39], v2 offset:23552
v_permlane16_swap_b32 v23, v59
v_max_f32 v59, v59, v23
v_mul_f32 v58, s18, v59
v_pk_fma_f32 v[20:21], v[20:21], s[18:19], v[58:59] op_sel_hi:[1,0,0] neg_lo:[0,0,1] neg_hi:[0,0,1]
v_pk_fma_f32 v[16:17], v[16:17], s[18:19], v[58:59] op_sel_hi:[1,0,0] neg_lo:[0,0,1] neg_hi:[0,0,1]
v_pk_fma_f32 v[18:19], v[18:19], s[18:19], v[58:59] op_sel_hi:[1,0,0] neg_lo:[0,0,1] neg_hi:[0,0,1]
v_pk_fma_f32 v[12:13], v[12:13], s[18:19], v[58:59] op_sel_hi:[1,0,0] neg_lo:[0,0,1] neg_hi:[0,0,1]
v_pk_fma_f32 v[14:15], v[14:15], s[18:19], v[58:59] op_sel_hi:[1,0,0] neg_lo:[0,0,1] neg_hi:[0,0,1]
v_exp_f32 v20, v20
v_exp_f32 v21, v21
v_exp_f32 v16, v16
v_cvt_pk_bf16_f32 v23, v20, v21
v_cvt_pk_bf16_f32 v20, v20, v21
v_mov_b32 v21, 0
v_exp_f32 v17, v17
v_exp_f32 v18, v18
v_mfma_f32_16x16x16_bf16 v[24:27], v[56:57], v[20:21], 0
v_exp_f32 v19, v19
v_mfma_f32_16x16x16_bf16 v[28:31], v[56:57], v[22:23], 0
v_exp_f32 v12, v12
v_exp_f32 v13, v13
v_cvt_pk_bf16_f32 v16, v16, v17
v_cvt_pk_bf16_f32 v17, v18, v19
v_exp_f32 v14, v14
v_exp_f32 v15, v15
v_cvt_pk_bf16_f32 v18, v12, v13
v_cvt_pk_bf16_f32 v19, v14, v15
v_mfma_f32_16x16x16_bf16 v[12:15], v[60:61], v[20:21], 0
s_waitcnt vmcnt(2)
v_mfma_f32_16x16x32_bf16 v[12:15], v[60:63], v[16:19], v[12:15]
v_mov_b32 v20, 0
v_mov_b32 v23, 0
v_mfma_f32_16x16x32_bf16 v[24:27], v[64:67], v[16:19], v[24:27]
s_nop 1
v_mfma_f32_16x16x32_bf16 v[28:31], v[68:71], v[16:19], v[28:31]
v_mov_b32 v16, 0
v_mov_b32 v17, 0
v_rcp_f32 v12, v12
v_mov_b32 v18, 0
v_mov_b32 v19, 0
v_pk_mul_f32 v[24:25], v[24:25], v[12:13] op_sel_hi:[1,0]
v_pk_mul_f32 v[26:27], v[26:27], v[12:13] op_sel_hi:[1,0]
v_mov_b32 v15, 0
v_pk_mul_f32 v[28:29], v[28:29], v[12:13] op_sel_hi:[1,0]
v_pk_mul_f32 v[30:31], v[30:31], v[12:13] op_sel_hi:[1,0]
v_cvt_pk_bf16_f32 v24, v24, v28
v_cvt_pk_bf16_f32 v25, v25, v29
v_cvt_pk_bf16_f32 v26, v26, v30
v_cvt_pk_bf16_f32 v27, v27, v31
v_mfma_f32_16x16x32_bf16 v[56:59], v[20:23], v[20:23], 0
ds_write_b128 v7, v[24:27]
v_mfma_f32_16x16x32_bf16 v[60:63], v[20:23], v[20:23], 0
v_mov_b32 v12, 0
v_mov_b32 v13, 0
v_mov_b32 v14, 0
v_mov_b32 v3, 6528
s_nop 1
v_mfma_f32_16x16x32_bf16 v[64:67], v[20:23], v[20:23], 0
s_cmp_eq_u32 s19, 63
s_cbranch_scc1 L_texit
s_waitcnt lgkmcnt(0)
s_barrier
ds_read_b128 v[24:27], v1 offset:2176
v_mfma_f32_16x16x32_bf16 v[68:71], v[20:23], v[20:23], 0
ds_read_b128 v[28:31], v1 offset:3200
s_nop 2
v_mfma_f32_16x16x32_bf16 v[68:71], v[20:23], v[20:23], 0
s_waitcnt lgkmcnt(1)
v_smfmac_f32_16x16x64_bf16 v[12:15], v[24:27], a[248:255], v0
v_smfmac_f32_16x16x64_bf16 v[16:19], v[24:27], a[176:183], v0
s_waitcnt lgkmcnt(0)
v_smfmac_f32_16x16x64_bf16 v[12:15], v[28:31], v[40:47], v0
ds_read_b128 v[40:43], v2 offset:24576
v_smfmac_f32_16x16x64_bf16 v[16:19], v[28:31], v[48:55], v0
ds_read_b128 v[44:47], v2 offset:25600
v_smfmac_f32_16x16x64_bf16 v[20:23], v[24:27], a[184:191], v0
ds_read_b128 v[48:51], v2 offset:26624
v_smfmac_f32_16x16x64_bf16 v[20:23], v[28:31], v[32:39], v0
ds_read_b128 v[52:55], v2 offset:27648
s_nop 0
v_add_f32 v12, v12, v13
v_add_f32 v14, v14, v15
v_smfmac_f32_16x16x64_bf16 v[56:59], v[24:27], a[192:199], v0
ds_read_b128 v[32:35], v2 offset:28672
s_waitcnt lgkmcnt(3)
v_cvt_pk_bf16_f32 v12, v12, v14
buffer_store_dword v12, v10, s[8:11], s28 offen
v_smfmac_f32_16x16x64_bf16 v[56:59], v[28:31], v[40:47], v0
ds_read_b128 v[36:39], v2 offset:29696
v_add_f32 v16, v16, v17
v_add_f32 v18, v18, v19
v_smfmac_f32_16x16x64_bf16 v[60:63], v[24:27], a[200:207], v0
ds_read_b128 v[12:15], v3
s_waitcnt lgkmcnt(3)
v_cvt_pk_bf16_f32 v16, v16, v18
v_add_f32 v20, v20, v21
v_smfmac_f32_16x16x64_bf16 v[60:63], v[28:31], v[48:55], v0
ds_read_b128 v[40:43], v2 offset:30720
v_add_f32 v22, v22, v23
v_cvt_pk_bf16_f32 v17, v20, v22
v_smfmac_f32_16x16x64_bf16 v[64:67], v[24:27], a[208:215], v0
ds_read_b128 v[44:47], v2 offset:31744
s_waitcnt lgkmcnt(3)
buffer_store_dwordx2 v[16:17], v9, s[8:11], s28 offen
v_add_f32 v56, v56, v57
v_smfmac_f32_16x16x64_bf16 v[64:67], v[28:31], v[32:39], v0
ds_read_b128 v[48:51], v2 offset:32768
v_add_f32 v58, v58, v59
v_cvt_pk_bf16_f32 v56, v56, v58
v_smfmac_f32_16x16x64_bf16 v[68:71], v[24:27], a[216:223], v0
ds_read_b128 v[52:55], v2 offset:33792
s_waitcnt lgkmcnt(2)
v_add_f32 v60, v60, v61
v_add_f32 v62, v62, v63
v_smfmac_f32_16x16x64_bf16 v[68:71], v[28:31], v[40:47], v0
ds_read_b128 v[20:23], v3
v_cvt_pk_bf16_f32 v57, v60, v62
buffer_store_dwordx2 v[56:57], v9, s[8:11], s50 offen
v_smfmac_f32_16x16x64_bf16 v[12:15], v[24:27], a[224:231], v0
s_waitcnt lgkmcnt(1)
v_add_f32 v64, v64, v65
v_add_f32 v66, v66, v67
v_smfmac_f32_16x16x64_bf16 v[12:15], v[28:31], v[48:55], v0
s_waitcnt lgkmcnt(0)
v_cvt_pk_bf16_f32 v64, v64, v66
v_smfmac_f32_16x16x64_bf16 v[20:23], v[24:27], a[232:239], v0
v_add_f32 v68, v68, v69
v_add_f32 v70, v70, v71
v_smfmac_f32_16x16x64_bf16 v[20:23], v[28:31], a[240:247], v0
v_cvt_pk_bf16_f32 v65, v68, v70
buffer_store_dwordx2 v[64:65], v9, s[8:11], s51 offen
v_add_f32 v12, v12, v13
v_add_f32 v14, v14, v15
v_cvt_pk_bf16_f32 v12, v12, v14
s_nop 2
v_add_f32 v20, v20, v21
v_add_f32 v22, v22, v23
v_cvt_pk_bf16_f32 v13, v20, v22
buffer_store_dwordx2 v[12:13], v9, s[8:11], s52 offen
s_cmp_eq_u32 s48, 0
s_cbranch_scc1 L_nojob2
s_add_u32 s19, s19, 1
s_mov_b32 s20, s28
s_mov_b32 s28, s29
s_mov_b32 s29, s20
s_and_b32 s20, s19, 3
s_lshl_b32 s20, s20, 14
s_add_u32 s33, s20, 110100480
s_add_u32 s34, s20, s24
s_xor_b32 s20, s20, 32768
s_add_u32 s35, s20, s24
s_add_u32 s30, s30, 16384
s_add_u32 s31, s31, 131072
s_add_u32 s6, s33, 4096
s_add_u32 s7, s33, 8192
s_mov_b32 s22, 0
v_mov_b64 v[24:25], 0
v_mov_b64 v[26:27], 0
v_mov_b64 v[28:29], 0
v_mov_b64 v[30:31], 0
v_and_b32 v69, 0x380, v1
v_add_u32 v69, v69, v1
v_lshlrev_b32 v70, 1, v1
v_mov_b64 v[64:65], -1
v_mov_b64 v[66:67], -1
v_xor_b32 v3, 16, v4
ds_read_b128 v[48:51], v2 offset:12288
ds_read_b128 v[52:55], v2 offset:13312
v_mov_b32 v56, 0x3f80
v_cndmask_b32 v56, v56, 1.0, s[44:45]
v_cndmask_b32 v60, 0, v56, s[36:37]
v_cndmask_b32 v61, 0, v56, s[38:39]
v_cndmask_b32 v62, 0, v56, s[40:41]
v_cndmask_b32 v63, 0, v56, s[42:43]
s_nop 6
buffer_load_dwordx4 v[32:35], v1, s[8:11], s49 offen offset:0 sc1
buffer_load_dwordx4 v[36:39], v1, s[8:11], s49 offen offset:1024 sc1
buffer_load_dwordx4 v[40:43], v1, s[8:11], s49 offen offset:2048 sc1
buffer_load_dwordx4 v[44:47], v1, s[8:11], s49 offen offset:3072 sc1
s_waitcnt vmcnt(3)
v_mfma_f32_16x16x32_bf16 v[56:59], v[32:35], v[60:63], 0
v_max3_u32 v16, v32, v33, v34
v_max_u32 v16, v16, v35
s_waitcnt vmcnt(2)
v_mfma_f32_16x16x32_bf16 v[56:59], v[36:39], v[60:63], v[56:59]
v_max3_u32 v16, v16, v36, v37
v_max3_u32 v16, v16, v38, v39
s_waitcnt vmcnt(1)
v_mfma_f32_16x16x32_bf16 v[56:59], v[40:43], v[60:63], v[56:59]
v_max3_u32 v16, v16, v40, v41
v_max3_u32 v16, v16, v42, v43
s_waitcnt vmcnt(0)
v_mfma_f32_16x16x32_bf16 v[56:59], v[44:47], v[60:63], v[56:59]
v_max3_u32 v16, v16, v44, v45
v_max3_u32 v16, v16, v46, v47
v_cmp_le_u32 vcc, 0xffff0000, v16
s_cbranch_vccnz L_red2
L_redb2:
s_nop 3
v_permlane32_swap_b32 v56, v58
v_permlane32_swap_b32 v57, v59
v_pk_add_f32 v[56:57], v[56:57], v[58:59]
v_cvt_pk_bf16_f32 v56, v56, v57
buffer_store_dword v56, v11, s[8:11], s34 offen
s_barrier
ds_read_b128 v[40:43], v2 offset:4096
ds_read_b128 v[44:47], v2 offset:5120
v_mov_b64 v[32:33], 0
v_mov_b64 v[34:35], 0
v_mov_b64 v[36:37], 0
v_mov_b64 v[38:39], 0
v_mov_b64 v[56:57], 0
v_mov_b64 v[58:59], 0
v_mov_b64 v[60:61], 0
v_mov_b64 v[62:63], 0
s_nop 15
s_nop 13
s_branch L_gat2
L_red2:
L_red2b:
buffer_load_dwordx4 v[32:35], v1, s[8:11], s49 offen offset:0 sc1
buffer_load_dwordx4 v[36:39], v1, s[8:11], s49 offen offset:1024 sc1
buffer_load_dwordx4 v[40:43], v1, s[8:11], s49 offen offset:2048 sc1
buffer_load_dwordx4 v[44:47], v1, s[8:11], s49 offen offset:3072 sc1
s_add_u32 s22, s22, 1
s_cmp_gt_u32 s22, 40000
s_cbranch_scc1 L_end
s_waitcnt vmcnt(3)
v_mfma_f32_16x16x32_bf16 v[56:59], v[32:35], v[60:63], 0
v_max3_u32 v16, v32, v33, v34
v_max_u32 v16, v16, v35
s_waitcnt vmcnt(2)
v_mfma_f32_16x16x32_bf16 v[56:59], v[36:39], v[60:63], v[56:59]
v_max3_u32 v16, v16, v36, v37
v_max3_u32 v16, v16, v38, v39
s_waitcnt vmcnt(1)
v_mfma_f32_16x16x32_bf16 v[56:59], v[40:43], v[60:63], v[56:59]
v_max3_u32 v16, v16, v40, v41
v_max3_u32 v16, v16, v42, v43
s_waitcnt vmcnt(0)
v_mfma_f32_16x16x32_bf16 v[56:59], v[44:47], v[60:63], v[56:59]
v_max3_u32 v16, v16, v44, v45
v_max3_u32 v16, v16, v46, v47
v_cmp_le_u32 vcc, 0xffff0000, v16
s_cbranch_vccz L_redb2
s_branch L_red2b
L_nojob2:
s_add_u32 s19, s19, 1
s_mov_b32 s20, s28
s_mov_b32 s28, s29
s_mov_b32 s29, s20
s_and_b32 s20, s19, 3
s_lshl_b32 s20, s20, 14
s_add_u32 s33, s20, 110100480
s_add_u32 s34, s20, s24
s_xor_b32 s20, s20, 32768
s_add_u32 s35, s20, s24
s_add_u32 s30, s30, 16384
s_add_u32 s31, s31, 131072
s_add_u32 s6, s33, 4096
s_add_u32 s7, s33, 8192
s_mov_b32 s22, 0
v_mov_b64 v[24:25], 0
v_mov_b64 v[26:27], 0
v_mov_b64 v[28:29], 0
v_mov_b64 v[30:31], 0
v_and_b32 v69, 0x380, v1
v_add_u32 v69, v69, v1
v_lshlrev_b32 v70, 1, v1
v_mov_b64 v[64:65], -1
v_mov_b64 v[66:67], -1
v_xor_b32 v3, 16, v4
ds_read_b128 v[48:51], v2 offset:12288
ds_read_b128 v[52:55], v2 offset:13312
ds_read_b128 v[40:43], v2 offset:4096
ds_read_b128 v[44:47], v2 offset:5120
v_mov_b64 v[32:33], 0
v_mov_b64 v[34:35], 0
v_mov_b64 v[36:37], 0
v_mov_b64 v[38:39], 0
v_mov_b64 v[56:57], 0
v_mov_b64 v[58:59], 0
v_mov_b64 v[60:61], 0
v_mov_b64 v[62:63], 0
s_barrier
s_nop 15
s_nop 15
s_nop 7
s_branch L_gat2
L_ent3:
v_lshlrev_b32 v6, 3, v1
v_mov_b64 v[24:25], 0
v_mov_b64 v[26:27], 0
v_mov_b64 v[28:29], 0
v_mov_b64 v[30:31], 0
v_and_b32 v69, 0x380, v1
v_add_u32 v69, v69, v1
v_lshlrev_b32 v70, 1, v1
v_mov_b64 v[64:65], -1
v_mov_b64 v[66:67], -1
v_xor_b32 v3, 16, v4
ds_read_b128 v[48:51], v2 offset:14336
ds_read_b128 v[52:55], v2 offset:15360
ds_read_b128 v[40:43], v2 offset:6144
ds_read_b128 v[44:47], v2 offset:7168
v_mov_b64 v[32:33], 0
v_mov_b64 v[34:35], 0
v_mov_b64 v[36:37], 0
v_mov_b64 v[38:39], 0
v_mov_b64 v[56:57], 0
v_mov_b64 v[58:59], 0
v_mov_b64 v[60:61], 0
v_mov_b64 v[62:63], 0
s_add_u32 s20, s30, 3072
s_add_u32 s21, s30, 8192
s_add_u32 s49, s29, s25
s_add_u32 s50, s29, s26
s_add_u32 s51, s29, s27
s_add_u32 s52, s30, 16384
s_mov_b32 m0, 22016
s_waitcnt vmcnt(0) lgkmcnt(0)
s_branch L_step3
L_gr3:
buffer_load_dwordx4 v[12:15], v1, s[8:11], s33 offen sc1
buffer_load_dword v20, v8, s[8:11], s7 offen sc1
buffer_load_dwordx4 v[16:19], v1, s[8:11], s6 offen sc1
s_add_u32 s22, s22, 1
s_cmp_gt_u32 s22, 40000
s_cbranch_scc1 L_end
s_nop 0
v_mov_b64 v[24:25], 0
v_mov_b64 v[26:27], 0
v_mov_b64 v[28:29], 0
v_mov_b64 v[30:31], 0
v_mov_b64 v[32:33], 0
v_mov_b64 v[34:35], 0
v_mov_b64 v[36:37], 0
v_mov_b64 v[38:39], 0
v_mov_b64 v[56:57], 0
v_mov_b64 v[58:59], 0
v_mov_b64 v[60:61], 0
v_mov_b64 v[62:63], 0
s_waitcnt lgkmcnt(0)
s_branch L_step3
.p2align 3
L_gat3:
buffer_load_dwordx4 v[12:15], v1, s[8:11], s33 offen sc1
buffer_load_dword v20, v8, s[8:11], s7 offen sc1
buffer_load_dwordx4 v[16:19], v1, s[8:11], s6 offen sc1
s_add_u32 s20, s30, 3072
s_add_u32 s21, s30, 8192
s_add_u32 s49, s29, s25
s_add_u32 s50, s29, s26
s_add_u32 s51, s29, s27
s_add_u32 s52, s30, 16384
s_mov_b32 m0, 22016
s_waitcnt lgkmcnt(0)
L_step3:
s_waitcnt vmcnt(2)
v_smfmac_f32_16x16x64_bf16 v[24:27], v[12:15], v[144:151], v0
ds_write_b128 v1, v[12:15] offset:6656
v_smfmac_f32_16x16x64_bf16 v[28:31], v[12:15], v[152:159], v0
s_waitcnt vmcnt(1)
ds_write_b32 v8, v20 offset:14848
v_smfmac_f32_16x16x64_bf16 v[32:35], v[12:15], v[160:167], v0
s_waitcnt vmcnt(0)
ds_write_b128 v1, v[16:19] offset:10752
v_smfmac_f32_16x16x64_bf16 v[56:59], v[12:15], a[80:87], v0
v_max3_u32 v21, v12, v13, v14
v_max3_u32 v21, v21, v15, v20
v_smfmac_f32_16x16x64_bf16 v[60:63], v[12:15], a[88:95], v0
v_max3_u32 v21, v21, v16, v17
v_max3_u32 v21, v21, v18, v19
v_smfmac_f32_16x16x64_bf16 v[36:39], v[12:15], v[40:47], v0
v_cmp_le_u32 vcc, 0xffff0000, v21
v_smfmac_f32_16x16x64_bf16 v[24:27], v[16:19], v[240:247], v0
s_cbranch_vccnz L_gr3
v_smfmac_f32_16x16x64_bf16 v[28:31], v[16:19], v[248:255], v0
s_waitcnt lgkmcnt(0)
s_barrier
ds_read_b128 v[20:23], v1 offset:3584
v_smfmac_f32_16x16x64_bf16 v[32:35], v[16:19], a[0:7], v0
ds_read_b128 v[12:15], v1 offset:4608
buffer_load_dwordx4 v69, s[8:11], s20 offen sc1 lds
v_smfmac_f32_16x16x64_bf16 v[56:59], v[16:19], a[144:151], v0
ds_read_b128 v[40:43], v2 offset:0
s_mov_b32 m0, 22912
v_smfmac_f32_16x16x64_bf16 v[60:63], v[16:19], a[152:159], v0
ds_read_b128 v[44:47], v2 offset:1024
v_smfmac_f32_16x16x64_bf16 v[36:39], v[16:19], v[48:55], v0
ds_read_b128 v[16:19], v1 offset:5632
s_waitcnt lgkmcnt(4)
v_smfmac_f32_16x16x64_bf16 v[24:27], v[20:23], v[72:79], v0
ds_read_b128 v[48:51], v2 offset:2048
buffer_load_dwordx4 v69, s[8:11], s20 offen offset:128 sc1 lds
v_smfmac_f32_16x16x64_bf16 v[28:31], v[20:23], v[80:87], v0
ds_read_b128 v[52:55], v2 offset:3072
s_mov_b32 m0, 6272
v_smfmac_f32_16x16x64_bf16 v[32:35], v[20:23], v[88:95], v0
s_waitcnt lgkmcnt(3)
v_smfmac_f32_16x16x64_bf16 v[36:39], v[20:23], v[40:47], v0
ds_read_b128 v[20:23], v1 offset:7680
v_smfmac_f32_16x16x64_bf16 v[24:27], v[12:15], v[96:103], v0
ds_read_b128 v[40:43], v2 offset:4096
v_smfmac_f32_16x16x64_bf16 v[28:31], v[12:15], v[104:111], v0
ds_read_b128 v[44:47], v2 offset:5120
v_smfmac_f32_16x16x64_bf16 v[32:35], v[12:15], v[112:119], v0
s_waitcnt lgkmcnt(3)
v_smfmac_f32_16x16x64_bf16 v[36:39], v[12:15], v[48:55], v0
ds_read_b128 v[12:15], v1 offset:8704
buffer_store_dwordx4 v[64:67], v1, s[8:11], s49 offen
v_smfmac_f32_16x16x64_bf16 v[24:27], v[16:19], v[120:127], v0
ds_read_b128 v[48:51], v2 offset:8192
v_smfmac_f32_16x16x64_bf16 v[28:31], v[16:19], v[128:135], v0
ds_read_b128 v[52:55], v2 offset:9216
v_smfmac_f32_16x16x64_bf16 v[32:35], v[16:19], v[136:143], v0
s_waitcnt lgkmcnt(3)
v_smfmac_f32_16x16x64_bf16 v[36:39], v[16:19], v[40:47], v0
ds_read_b128 v[16:19], v1 offset:9728
buffer_store_dwordx4 v[64:67], v1, s[8:11], s50 offen
v_smfmac_f32_16x16x64_bf16 v[24:27], v[20:23], v[168:175], v0
ds_read_b128 v[40:43], v2 offset:10240
v_smfmac_f32_16x16x64_bf16 v[28:31], v[20:23], v[176:183], v0
ds_read_b128 v[44:47], v2 offset:11264
v_smfmac_f32_16x16x64_bf16 v[32:35], v[20:23], v[184:191], v0
s_waitcnt lgkmcnt(3)
v_smfmac_f32_16x16x64_bf16 v[36:39], v[20:23], v[48:55], v0
ds_read_b128 v[20:23], v1 offset:11776
buffer_store_dwordx4 v[64:67], v1, s[8:11], s51 offen
v_smfmac_f32_16x16x64_bf16 v[24:27], v[12:15], v[192:199], v0
ds_read_b128 v[48:51], v2 offset:12288
buffer_load_dwordx4 v[64:67], v70, s[8:11], s21 offen sc1
v_smfmac_f32_16x16x64_bf16 v[28:31], v[12:15], v[200:207], v0
ds_read_b128 v[52:55], v2 offset:13312
v_smfmac_f32_16x16x64_bf16 v[32:35], v[12:15], v[208:215], v0
s_waitcnt lgkmcnt(3)
v_smfmac_f32_16x16x64_bf16 v[36:39], v[12:15], v[40:47], v0
ds_read_b128 v[12:15], v1 offset:3584
v_smfmac_f32_16x16x64_bf16 v[24:27], v[16:19], v[216:223], v0
ds_read_b128 v[40:43], v2 offset:16384
buffer_load_dwordx4 v[68:71], v70, s[8:11], s21 offen offset:16 sc1
v_smfmac_f32_16x16x64_bf16 v[28:31], v[16:19], v[224:231], v0
ds_read_b128 v[44:47], v2 offset:17408
v_smfmac_f32_16x16x64_bf16 v[32:35], v[16:19], v[232:239], v0
s_waitcnt lgkmcnt(3)
v_smfmac_f32_16x16x64_bf16 v[36:39], v[16:19], v[48:55], v0
ds_read_b128 v[16:19], v1 offset:4608
v_mov_b32 v11, s19
v_smfmac_f32_16x16x64_bf16 v[24:27], v[20:23], a[8:15], v0
v_smfmac_f32_16x16x64_bf16 v[28:31], v[20:23], a[16:23], v0
s_mov_b64 exec, 1
buffer_store_dword v11, v8, s[8:11], s83 offen sc1
buffer_load_dword v11, v8, s[8:11], s82 offen sc1
s_mov_b64 exec, -1
v_smfmac_f32_16x16x64_bf16 v[32:35], v[20:23], a[24:31], v0
s_waitcnt lgkmcnt(1)
v_smfmac_f32_16x16x64_bf16 v[36:39], v[20:23], v[40:47], v0
ds_read_b128 v[20:23], v1 offset:5632
v_smfmac_f32_16x16x64_bf16 v[56:59], v[12:15], a[32:39], v0
v_add_f32 v24, v24, v25
v_add_f32 v26, v26, v27
v_add_f32 v28, v28, v29
v_add_f32 v30, v30, v31
v_cvt_pk_bf16_f32 v24, v24, v28
v_cvt_pk_bf16_f32 v26, v26, v30
ds_write_b32 v4, v24 offset:2176
v_add_f32 v32, v32, v33
v_add_f32 v34, v34, v35
v_add_f32 v36, v36, v37
v_add_f32 v38, v38, v39
ds_write_b32 v3, v26 offset:2176
v_cvt_pk_bf16_f32 v32, v32, v36
v_cvt_pk_bf16_f32 v34, v34, v38
ds_write_b32 v4, v32
v_smfmac_f32_16x16x64_bf16 v[60:63], v[12:15], a[40:47], v0
ds_write_b32 v3, v34
s_waitcnt lgkmcnt(5)
v_smfmac_f32_16x16x64_bf16 v[56:59], v[16:19], a[48:55], v0
ds_read_b128 v[12:15], v1 offset:7680
v_smfmac_f32_16x16x64_bf16 v[60:63], v[16:19], a[56:63], v0
ds_read_b128 v[16:19], v1 offset:8704
s_waitcnt lgkmcnt(6)
v_smfmac_f32_16x16x64_bf16 v[56:59], v[20:23], a[64:71], v0
s_waitcnt lgkmcnt(2) vmcnt(7)
s_barrier
ds_read_b128 v[36:39], v5 offset:1536
v_smfmac_f32_16x16x64_bf16 v[60:63], v[20:23], a[72:79], v0
ds_read_b128 v[20:23], v1 offset:9728
s_waitcnt lgkmcnt(3)
v_smfmac_f32_16x16x64_bf16 v[56:59], v[12:15], a[96:103], v0
ds_read_b128 v[52:55], v1 offset:18944
v_smfmac_f32_16x16x64_bf16 v[60:63], v[12:15], a[104:111], v0
ds_read_b128 v[12:15], v1 offset:11776
s_waitcnt lgkmcnt(4)
v_smfmac_f32_16x16x64_bf16 v[56:59], v[16:19], a[112:119], v0
ds_read_b128 v[24:27], v5 offset:0
v_smfmac_f32_16x16x64_bf16 v[60:63], v[16:19], a[120:127], v0
ds_read_b128 v[40:43], v1 offset:12800
s_waitcnt lgkmcnt(4)
v_smfmac_f32_16x16x64_bf16 v[56:59], v[20:23], a[128:135], v0
ds_read_b128 v[28:31], v5 offset:512
v_smfmac_f32_16x16x64_bf16 v[60:63], v[20:23], a[136:143], v0
ds_read_b128 v[44:47], v1 offset:14848
s_waitcnt lgkmcnt(4)
v_smfmac_f32_16x16x64_bf16 v[56:59], v[12:15], a[160:167], v0
ds_read_b128 v[32:35], v5 offset:1024
v_smfmac_f32_16x16x64_bf16 v[60:63], v[12:15], a[168:175], v0
ds_read_b128 v[48:51], v1 offset:16896
s_mov_b64 exec, s[86:87]
buffer_store_dwordx4 v[36:39], v5, s[8:11], s31 offen offset:1536 sc1
s_mov_b64 exec, -1
v_mfma_f32_16x16x32_bf16 v[16:19], v[52:55], v[36:39], 0
ds_read_b128 v[52:55], v1 offset:19968
s_waitcnt lgkmcnt(5)
v_mfma_f32_16x16x32_bf16 v[16:19], v[40:43], v[24:27], v[16:19]
ds_read_b128 v[40:43], v1 offset:13824
s_waitcnt lgkmcnt(4)
v_mfma_f32_16x16x32_bf16 v[16:19], v[44:47], v[28:31], v[16:19]
ds_read_b128 v[44:47], v1 offset:15872
s_waitcnt lgkmcnt(3)
v_mfma_f32_16x16x32_bf16 v[16:19], v[48:51], v[32:35], v[16:19]
ds_read_b128 v[48:51], v1 offset:17920
v_mfma_f32_16x16x32_bf16 v[20:23], v[36:39], v[36:39], 0
v_add_f32 v56, v56, v57
v_add_f32 v58, v58, v59
v_mfma_f32_16x16x32_bf16 v[20:23], v[24:27], v[24:27], v[20:23]
v_add_f32 v60, v60, v61
v_add_f32 v62, v62, v63
v_mfma_f32_16x16x32_bf16 v[20:23], v[28:31], v[28:31], v[20:23]
v_cvt_pk_bf16_f32 v56, v56, v58
v_cvt_pk_bf16_f32 v57, v60, v62
v_mfma_f32_16x16x32_bf16 v[20:23], v[32:35], v[32:35], v[20:23]
v_lshrrev_b32 v58, 1, v1
v_max3_f32 v59, v16, v17, v18
s_waitcnt lgkmcnt(3)
v_mfma_f32_16x16x32_bf16 v[12:15], v[52:55], v[36:39], 0
ds_read_b128 v[52:55], v2 offset:21504
s_waitcnt lgkmcnt(3)
v_mfma_f32_16x16x32_bf16 v[12:15], v[40:43], v[24:27], v[12:15]
ds_read_b128 v[40:43], v2 offset:18432
s_waitcnt lgkmcnt(3)
v_mfma_f32_16x16x32_bf16 v[12:15], v[44:47], v[28:31], v[12:15]
ds_read_b128 v[44:47], v2 offset:19456
v_max3_f32 v59, v59, v19, v20
v_max_f32 v59, v59, v21
s_waitcnt lgkmcnt(3)
v_mfma_f32_16x16x32_bf16 v[12:15], v[48:51], v[32:35], v[12:15]
ds_read_b128 v[48:51], v2 offset:20480
buffer_store_dwordx2 v[56:57], v58, s[8:11], s31 offen offset:2048 sc1
v_mov_b32 v60, s53
s_add_u32 s49, s28, s23
v_mov_b32 v61, s53
s_add_u32 s50, s28, 65536
v_mov_b32 v62, s53
ds_read_b128 v[32:35], v2 offset:22528
v_mov_b32 v63, s53
v_max3_f32 v59, v59, v12, v13
v_max3_f32 v22, v59, v14, v15
v_max3_f32 v59, v59, v14, v15
s_add_u32 s51, s28, 131072
s_add_u32 s52, s28, 196608
v_permlane32_swap_b32 v22, v59
v_max_f32 v23, v59, v22
v_max_f32 v59, v59, v22
v_mov_b32 v22, 0
ds_read_b128 v[36:39], v2 offset:23552
v_permlane16_swap_b32 v23, v59
v_max_f32 v59, v59, v23
v_mul_f32 v58, s18, v59
v_pk_fma_f32 v[20:21], v[20:21], s[18:19], v[58:59] op_sel_hi:[1,0,0] neg_lo:[0,0,1] neg_hi:[0,0,1]
v_pk_fma_f32 v[16:17], v[16:17], s[18:19], v[58:59] op_sel_hi:[1,0,0] neg_lo:[0,0,1] neg_hi:[0,0,1]
v_pk_fma_f32 v[18:19], v[18:19], s[18:19], v[58:59] op_sel_hi:[1,0,0] neg_lo:[0,0,1] neg_hi:[0,0,1]
v_pk_fma_f32 v[12:13], v[12:13], s[18:19], v[58:59] op_sel_hi:[1,0,0] neg_lo:[0,0,1] neg_hi:[0,0,1]
v_pk_fma_f32 v[14:15], v[14:15], s[18:19], v[58:59] op_sel_hi:[1,0,0] neg_lo:[0,0,1] neg_hi:[0,0,1]
v_exp_f32 v20, v20
v_exp_f32 v21, v21
v_exp_f32 v16, v16
v_cvt_pk_bf16_f32 v23, v20, v21
v_cvt_pk_bf16_f32 v20, v20, v21
v_mov_b32 v21, 0
v_exp_f32 v17, v17
v_exp_f32 v18, v18
v_mfma_f32_16x16x16_bf16 v[24:27], v[56:57], v[20:21], 0
v_exp_f32 v19, v19
v_mfma_f32_16x16x16_bf16 v[28:31], v[56:57], v[22:23], 0
v_exp_f32 v12, v12
v_exp_f32 v13, v13
v_cvt_pk_bf16_f32 v16, v16, v17
v_cvt_pk_bf16_f32 v17, v18, v19
v_exp_f32 v14, v14
v_exp_f32 v15, v15
v_cvt_pk_bf16_f32 v18, v12, v13
v_cvt_pk_bf16_f32 v19, v14, v15
v_mfma_f32_16x16x16_bf16 v[12:15], v[60:61], v[20:21], 0
s_waitcnt vmcnt(4)
v_mfma_f32_16x16x32_bf16 v[12:15], v[60:63], v[16:19], v[12:15]
v_mov_b32 v20, 0
v_mov_b32 v23, 0
v_mfma_f32_16x16x32_bf16 v[24:27], v[64:67], v[16:19], v[24:27]
s_nop 1
v_mfma_f32_16x16x32_bf16 v[28:31], v[68:71], v[16:19], v[28:31]
v_mov_b32 v16, 0
v_mov_b32 v17, 0
v_rcp_f32 v12, v12
v_mov_b32 v18, 0
v_mov_b32 v19, 0
v_pk_mul_f32 v[24:25], v[24:25], v[12:13] op_sel_hi:[1,0]
v_pk_mul_f32 v[26:27], v[26:27], v[12:13] op_sel_hi:[1,0]
v_mov_b32 v15, 0
v_pk_mul_f32 v[28:29], v[28:29], v[12:13] op_sel_hi:[1,0]
v_pk_mul_f32 v[30:31], v[30:31], v[12:13] op_sel_hi:[1,0]
v_cvt_pk_bf16_f32 v24, v24, v28
v_cvt_pk_bf16_f32 v25, v25, v29
v_cvt_pk_bf16_f32 v26, v26, v30
v_cvt_pk_bf16_f32 v27, v27, v31
v_mfma_f32_16x16x32_bf16 v[56:59], v[20:23], v[20:23], 0
ds_write_b128 v7, v[24:27]
v_mfma_f32_16x16x32_bf16 v[60:63], v[20:23], v[20:23], 0
v_mov_b32 v12, 0
v_mov_b32 v13, 0
v_mov_b32 v14, 0
v_mov_b32 v3, 6528
s_nop 1
v_mfma_f32_16x16x32_bf16 v[64:67], v[20:23], v[20:23], 0
s_cmp_eq_u32 s19, 63
s_cbranch_scc1 L_texit
s_waitcnt lgkmcnt(0)
s_barrier
ds_read_b128 v[24:27], v1 offset:1152
v_mfma_f32_16x16x32_bf16 v[68:71], v[20:23], v[20:23], 0
ds_read_b128 v[28:31], v1 offset:2176
s_nop 2
v_mfma_f32_16x16x32_bf16 v[68:71], v[20:23], v[20:23], 0
s_waitcnt lgkmcnt(1)
v_smfmac_f32_16x16x64_bf16 v[12:15], v[24:27], a[248:255], v0
v_smfmac_f32_16x16x64_bf16 v[16:19], v[24:27], a[176:183], v0
s_waitcnt lgkmcnt(0)
v_smfmac_f32_16x16x64_bf16 v[12:15], v[28:31], v[40:47], v0
ds_read_b128 v[40:43], v2 offset:24576
v_smfmac_f32_16x16x64_bf16 v[16:19], v[28:31], v[48:55], v0
ds_read_b128 v[44:47], v2 offset:25600
v_smfmac_f32_16x16x64_bf16 v[20:23], v[24:27], a[184:191], v0
ds_read_b128 v[48:51], v2 offset:26624
v_smfmac_f32_16x16x64_bf16 v[20:23], v[28:31], v[32:39], v0
ds_read_b128 v[52:55], v2 offset:27648
s_nop 0
v_add_f32 v12, v12, v13
v_add_f32 v14, v14, v15
v_smfmac_f32_16x16x64_bf16 v[56:59], v[24:27], a[192:199], v0
ds_read_b128 v[32:35], v2 offset:28672
s_waitcnt lgkmcnt(3)
v_cvt_pk_bf16_f32 v12, v12, v14
buffer_store_dword v12, v10, s[8:11], s28 offen
v_smfmac_f32_16x16x64_bf16 v[56:59], v[28:31], v[40:47], v0
ds_read_b128 v[36:39], v2 offset:29696
v_add_f32 v16, v16, v17
v_add_f32 v18, v18, v19
v_smfmac_f32_16x16x64_bf16 v[60:63], v[24:27], a[200:207], v0
ds_read_b128 v[12:15], v3
s_waitcnt lgkmcnt(3)
v_cvt_pk_bf16_f32 v16, v16, v18
v_add_f32 v20, v20, v21
v_smfmac_f32_16x16x64_bf16 v[60:63], v[28:31], v[48:55], v0
ds_read_b128 v[40:43], v2 offset:30720
v_add_f32 v22, v22, v23
v_cvt_pk_bf16_f32 v17, v20, v22
v_smfmac_f32_16x16x64_bf16 v[64:67], v[24:27], a[208:215], v0
ds_read_b128 v[44:47], v2 offset:31744
s_waitcnt lgkmcnt(3)
buffer_store_dwordx2 v[16:17], v9, s[8:11], s28 offen
v_add_f32 v56, v56, v57
v_smfmac_f32_16x16x64_bf16 v[64:67], v[28:31], v[32:39], v0
ds_read_b128 v[48:51], v2 offset:32768
v_add_f32 v58, v58, v59
v_cvt_pk_bf16_f32 v56, v56, v58
v_smfmac_f32_16x16x64_bf16 v[68:71], v[24:27], a[216:223], v0
ds_read_b128 v[52:55], v2 offset:33792
s_waitcnt lgkmcnt(2)
v_add_f32 v60, v60, v61
v_add_f32 v62, v62, v63
v_smfmac_f32_16x16x64_bf16 v[68:71], v[28:31], v[40:47], v0
ds_read_b128 v[20:23], v3
v_cvt_pk_bf16_f32 v57, v60, v62
buffer_store_dwordx2 v[56:57], v9, s[8:11], s50 offen
v_smfmac_f32_16x16x64_bf16 v[12:15], v[24:27], a[224:231], v0
s_waitcnt lgkmcnt(1)
v_add_f32 v64, v64, v65
v_add_f32 v66, v66, v67
v_smfmac_f32_16x16x64_bf16 v[12:15], v[28:31], v[48:55], v0
s_waitcnt lgkmcnt(0)
v_cvt_pk_bf16_f32 v64, v64, v66
v_smfmac_f32_16x16x64_bf16 v[20:23], v[24:27], a[232:239], v0
v_add_f32 v68, v68, v69
v_add_f32 v70, v70, v71
v_smfmac_f32_16x16x64_bf16 v[20:23], v[28:31], a[240:247], v0
v_cvt_pk_bf16_f32 v65, v68, v70
buffer_store_dwordx2 v[64:65], v9, s[8:11], s51 offen
v_add_f32 v12, v12, v13
v_add_f32 v14, v14, v15
v_cvt_pk_bf16_f32 v12, v12, v14
s_nop 2
v_add_f32 v20, v20, v21
v_add_f32 v22, v22, v23
v_cvt_pk_bf16_f32 v13, v20, v22
buffer_store_dwordx2 v[12:13], v9, s[8:11], s52 offen
s_add_u32 s19, s19, 1
s_mov_b32 s20, s28
s_mov_b32 s28, s29
s_mov_b32 s29, s20
s_and_b32 s20, s19, 3
s_lshl_b32 s20, s20, 14
s_add_u32 s33, s20, 110100480
s_add_u32 s34, s20, s24
s_xor_b32 s20, s20, 32768
s_add_u32 s35, s20, s24
s_add_u32 s30, s30, 16384
s_add_u32 s31, s31, 131072
s_add_u32 s6, s33, 4096
s_add_u32 s7, s33, 8192
s_mov_b32 s22, 0
v_mov_b64 v[24:25], 0
v_mov_b64 v[26:27], 0
v_mov_b64 v[28:29], 0
v_mov_b64 v[30:31], 0
v_and_b32 v69, 0x380, v1
v_add_u32 v69, v69, v1
v_lshlrev_b32 v70, 1, v1
v_mov_b64 v[64:65], -1
v_mov_b64 v[66:67], -1
v_xor_b32 v3, 16, v4
ds_read_b128 v[48:51], v2 offset:14336
ds_read_b128 v[52:55], v2 offset:15360
ds_read_b128 v[40:43], v2 offset:6144
ds_read_b128 v[44:47], v2 offset:7168
v_mov_b64 v[32:33], 0
v_mov_b64 v[34:35], 0
v_mov_b64 v[36:37], 0
v_mov_b64 v[38:39], 0
v_mov_b64 v[56:57], 0
v_mov_b64 v[58:59], 0
v_mov_b64 v[60:61], 0
v_mov_b64 v[62:63], 0
s_add_u32 s20, s19, 1
s_lshr_b32 s20, s20, 3
s_min_u32 s20, s20, 7
s_waitcnt vmcnt(7)
L_kvw:
v_readfirstlane_b32 s21, v11
s_nop 0
s_cmp_gt_u32 s21, s20
s_cbranch_scc0 L_kvp
s_barrier
s_nop 15
s_nop 15
s_nop 7
s_branch L_gat3
L_kvp:
s_mov_b64 exec, 1
buffer_load_dword v11, v8, s[8:11], s82 offen sc1
s_mov_b64 exec, -1
s_add_u32 s22, s22, 1
s_cmp_gt_u32 s22, 40000
s_cbranch_scc1 L_end
s_waitcnt vmcnt(0)
s_branch L_kvw
L_texit:
s_lshl_b32 s61, s16, 7
s_add_u32 s61, s61, 111153152
s_waitcnt vmcnt(0)
s_barrier
s_cmp_lg_u32 s17, 0
s_cbranch_scc1 L_sf_29
v_mov_b32 v20, 0
v_mov_b32 v21, 64
s_mov_b64 exec, 1
buffer_store_dword v21, v20, s[8:11], s61 offen sc1
s_mov_b64 exec, -1
L_sf_29:
L_done:
L_end:
s_endpgm
.section .rodata,"a"
.p2align 6
.amdhsa_kernel concat_heads__compressed_kv_cla__memory_aug_recurrent_mem_tr__prompt_kernel
  .amdhsa_next_free_vgpr 512
  .amdhsa_next_free_sgpr 102
  .amdhsa_accum_offset 256
  .amdhsa_group_segment_fixed_size 0
  .amdhsa_kernarg_size 128
  .amdhsa_user_sgpr_count 2
  .amdhsa_user_sgpr_kernarg_segment_ptr 1
  .amdhsa_system_sgpr_workgroup_id_x 1
.end_amdhsa_kernel
```

```asm
; @launch grid=(256,1,1) block=(256,1,1) lds=163840
.amdgcn_target "amdgcn-amd-amdhsa--gfx950"
.text
.globl concat_heads__compressed_kv_cla__memory_aug_recurrent_mem_tr__prompt_kernel
.p2align 8
.type concat_heads__compressed_kv_cla__memory_aug_recurrent_mem_tr__prompt_kernel,@function
concat_heads__compressed_kv_cla__memory_aug_recurrent_mem_tr__prompt_kernel:
s_cmp_ge_u32 s2, 256
s_cbranch_scc1 L_end
s_getreg_b32 s3, hwreg(HW_REG_XCC_ID)
s_and_b32 s3, s3, 7
s_load_dwordx2 s[4:5], s[0:1], 120
s_load_dwordx2 s[6:7], s[0:1], 112
v_lshrrev_b32 v1, 6, v0
s_nop 0
v_readfirstlane_b32 s17, v1
s_waitcnt lgkmcnt(0)
s_mov_b32 s8, s4
s_and_b32 s9, s5, 0xffff
s_mov_b32 s10, 268435456
s_mov_b32 s11, 0x20000
s_mov_b32 s56, s6
s_and_b32 s57, s7, 0xffff
s_mov_b32 s58, 256
s_mov_b32 s59, 0x20000
s_lshl_b32 s24, s3, 2
s_cmp_eq_u32 s17, 0
s_cbranch_scc0 L_tk
s_mov_b64 exec, 1
v_mov_b32 v1, 1
v_mov_b32 v2, 0
buffer_atomic_add v1, v2, s[56:59], s24 offen sc0
s_waitcnt vmcnt(0)
ds_write_b32 v2, v1
s_waitcnt lgkmcnt(0)
s_mov_b64 exec, -1
L_tk:
s_barrier
v_mov_b32 v2, 0
ds_read_b32 v1, v2
s_lshr_b32 s3, 0x76530142, s24
s_and_b32 s3, s3, 7
s_waitcnt lgkmcnt(0)
v_readfirstlane_b32 s16, v1
s_barrier
s_cmp_ge_u32 s16, 32
s_cbranch_scc1 L_end
s_cmp_eq_u32 s3, 0
s_cbranch_scc1 L_team
s_cmp_eq_u32 s3, 1
s_cbranch_scc0 L_np
s_cmp_lt_u32 s16, 24
s_cbranch_scc1 L_np
v_lshlrev_b32 v1, 4, v0
v_mov_b64 v[4:5], 0
v_mov_b64 v[6:7], 0
s_sub_u32 s24, s16, 24
s_lshl_b32 s24, s24, 12
s_add_u32 s24, s24, 111149056
buffer_store_dwordx4 v[4:7], v1, s[8:11], s24 offen sc1
s_waitcnt vmcnt(0)
s_barrier
s_cmp_lg_u32 s17, 0
s_cbranch_scc1 L_np
v_mov_b32 v1, 1
v_mov_b32 v2, 128
s_mov_b64 exec, 1
buffer_atomic_add v1, v2, s[56:59], 0 offen
s_mov_b64 exec, -1
L_np:
s_cmp_lt_u32 s3, 4
s_cselect_b32 s61, 1, 0
s_cbranch_scc1 L_pb
s_load_dwordx2 s[52:53], s[0:1], 8
s_load_dwordx2 s[54:55], s[0:1], 0
s_load_dwordx2 s[6:7], s[0:1], 24
s_load_dwordx2 s[4:5], s[0:1], 32
s_load_dwordx2 s[18:19], s[0:1], 16
s_mov_b32 s45, 3
s_branch L_pg
L_pb:
s_load_dwordx2 s[52:53], s[0:1], 48
s_load_dwordx2 s[54:55], s[0:1], 48
s_load_dwordx2 s[6:7], s[0:1], 72
s_load_dwordx2 s[4:5], s[0:1], 80
s_load_dwordx2 s[18:19], s[0:1], 64
s_mov_b32 s45, 6
s_bitcmp1_b32 s16, 1
s_cselect_b32 s45, 5, 6
s_cmp_eq_u32 s3, 1
s_cselect_b32 s45, 1, s45
L_pg:
s_waitcnt lgkmcnt(0)
s_cmp_ge_u32 s17, 2
s_cselect_b64 s[6:7], s[4:5], s[6:7]
v_bfe_u32 v19, v0, 4, 2
v_bfe_u32 v18, v0, 2, 2
v_xor_b32 v18, v18, v19
v_lshlrev_b32 v18, 6, v18
v_and_b32 v20, 3, v0
v_lshl_add_u32 v18, v20, 4, v18
v_lshl_add_u32 v18, v19, 13, v18
s_and_b32 s24, s17, 1
s_lshl_b32 s25, s24, 17
v_add_u32 v5, s25, v18
v_add_u32 v6, 31744, v5
v_add_u32 v7, 63488, v5
v_add_u32 v8, 95232, v5
s_lshl_b32 s33, s17, 12
s_lshl_b32 s32, s17, 10
s_add_u32 s32, s32, 65536
v_and_b32 v18, 31, v0
v_lshlrev_b32 v18, 7, v18
v_bfe_u32 v19, v0, 1, 3
v_bfe_u32 v20, v0, 5, 1
v_xor_b32 v19, v19, v20
v_lshl_add_u32 v18, v19, 4, v18
s_lshl_b32 s24, s24, 14
s_add_u32 s24, s24, 65536
v_add_u32 v9, s24, v18
v_xor_b32 v10, 32, v9
v_xor_b32 v11, 64, v9
v_xor_b32 v12, 96, v9
v_bfe_u32 v19, v0, 2, 2
v_mul_u32_u24 v18, 320, v19
v_lshl_add_u32 v18, v20, 11, v18
v_bfe_u32 v19, v0, 4, 1
v_lshl_add_u32 v18, v19, 5, v18
v_and_b32 v19, 3, v0
v_lshl_add_u32 v18, v19, 3, v18
s_lshr_b32 s24, s17, 1
s_lshl_b32 s24, s24, 13
v_add_u32 v13, s24, v18
v_xor_b32 v14, 64, v13
v_xor_b32 v15, 128, v13
v_xor_b32 v16, 192, v13
s_mov_b32 s35, 0
s_cmp_eq_u32 s61, 0
s_cbranch_scc1 L_px_1
s_lshl_b32 s24, s35, 2
s_lshr_b32 s26, 0xe64a20, s24
s_bfe_u32 s2, s26, 0x10003
s_and_b32 s26, s26, 7
s_add_u32 s24, s2, 1
s_sub_u32 s27, s3, 2
s_cmp_eq_u32 s3, 1
s_cbranch_scc0 L_px_3
s_mov_b32 s2, 1
s_mov_b32 s27, 0
s_branch L_px_3
L_px_1:
s_cmp_eq_u32 s35, 2
s_cselect_b32 s2, 1, 0
s_and_b32 s26, s35, 1
s_lshl_b32 s26, s26, 2
s_add_u32 s24, s2, 2
s_sub_u32 s27, s3, 4
L_px_3:
s_lshl_b32 s27, s27, 5
s_add_u32 s27, s27, s16
s_bfm_b32 s25, s24, 0
s_and_b32 s25, s25, s16
s_add_u32 s26, s26, s25
s_lshr_b32 s27, s27, s24
s_or_b32 s40, s2, s61
s_lshr_b32 s24, s17, 1
s_cmp_eq_u32 s2, 0
s_cselect_b32 s41, s24, 0
s_cselect_b64 s[4:5], s[52:53], s[54:55]
s_cselect_b32 s25, 0, s24
s_and_b32 s51, s41, s61
s_lshl_b32 s46, s27, s2
s_add_u32 s46, s46, s25
s_lshl_b32 s46, s46, 8
s_lshl_b32 s47, s40, 7
s_add_u32 s47, s47, 1024
s_mov_b32 s12, s4
s_and_b32 s13, s5, 0xffff
s_lshl_b32 s14, s47, 11
s_mov_b32 s15, 0x20000
s_mul_i32 s30, s26, s47
s_lshl_b32 s30, s30, 8
s_lshl_b32 s42, s27, 3
s_add_u32 s42, s42, s26
s_lshl_b32 s42, s42, 1
s_and_b32 s25, s17, 1
s_add_u32 s42, s42, s25
s_lshl_b32 s42, s42, 3
s_add_u32 s42, s42, s24
s_lshl_b32 s42, s42, 13
s_lshl_b32 s43, s27, 5
s_add_u32 s43, s43, s26
s_lshl_b32 s43, s43, 2
s_lshl_b32 s24, s2, 1
s_add_u32 s24, s24, s61
s_lshl_b32 s24, s24, 2
s_lshr_b32 s25, 0x8720, s24
s_and_b32 s25, s25, 15
s_lshl_b32 s25, s25, 24
s_add_u32 s42, s42, s25
s_lshr_b32 s25, 0x7604, s24
s_and_b32 s25, s25, 15
s_lshl_b32 s25, s25, 12
s_add_u32 s43, s43, s25
s_add_u32 s43, s43, 111149056
s_mov_b32 s44, 1
s_cmp_lt_u32 s35, s45
s_cselect_b32 s30, s30, 536870912
s_cselect_b32 s46, s46, 536870912
v_lshrrev_b32 v18, 3, v0
v_mul_lo_u32 v18, v18, s47
v_bfe_u32 v19, v0, 4, 3
v_and_b32 v20, 7, v0
v_xor_b32 v20, v20, v19
v_lshl_add_u32 v1, v20, 4, v18
s_lshl_b32 s24, s47, 5
s_lshl_b32 s34, s47, 7
v_add_u32 v2, s24, v1
v_add_u32 v3, s24, v2
v_add_u32 v4, s24, v3
s_cmp_eq_u32 s2, 0
s_cselect_b64 s[4:5], s[6:7], s[18:19]
s_mov_b32 s20, s4
s_and_b32 s21, s5, 0xffff
s_lshl_b32 s22, s47, 12
s_mov_b32 s23, 0x20000
s_mov_b32 s31, s46
s_add_u32 m0, s32, 0
s_mov_b32 s48, s30
buffer_load_dwordx4 v1, s[12:15], s48 offen lds
s_add_u32 m0, s32, 4096
s_nop 0
buffer_load_dwordx4 v2, s[12:15], s48 offen lds
s_add_u32 m0, s32, 8192
s_nop 0
buffer_load_dwordx4 v3, s[12:15], s48 offen lds
s_add_u32 m0, s32, 12288
s_nop 0
buffer_load_dwordx4 v4, s[12:15], s48 offen lds
s_add_u32 m0, s32, 16384
s_add_u32 s48, s30, s34
buffer_load_dwordx4 v1, s[12:15], s48 offen lds
s_add_u32 m0, s32, 20480
s_nop 0
buffer_load_dwordx4 v2, s[12:15], s48 offen lds
s_add_u32 m0, s32, 24576
s_nop 0
buffer_load_dwordx4 v3, s[12:15], s48 offen lds
s_add_u32 m0, s32, 28672
s_nop 0
buffer_load_dwordx4 v4, s[12:15], s48 offen lds
s_add_u32 s30, s30, 128
s_add_u32 s32, s32, 32768
s_sub_u32 s24, s32, 98304
s_cmp_ge_u32 s32, 163840
s_cselect_b32 s32, s24, s32
s_mov_b32 m0, s33
s_nop 0
buffer_load_dwordx4 v5, s[20:23], s31 offen offset:0 lds
buffer_load_dwordx4 v6, s[20:23], s31 offen offset:1024 lds
buffer_load_dwordx4 v7, s[20:23], s31 offen offset:2048 lds
buffer_load_dwordx4 v8, s[20:23], s31 offen offset:3072 lds
s_add_u32 s31, s31, 262144
s_add_u32 s33, s33, 16384
s_and_b32 s33, s33, 65535
s_mov_b32 m0, s33
s_nop 0
buffer_load_dwordx4 v5, s[20:23], s31 offen offset:0 lds
buffer_load_dwordx4 v6, s[20:23], s31 offen offset:1024 lds
buffer_load_dwordx4 v7, s[20:23], s31 offen offset:2048 lds
buffer_load_dwordx4 v8, s[20:23], s31 offen offset:3072 lds
s_add_u32 s31, s31, 262144
s_add_u32 s33, s33, 16384
s_and_b32 s33, s33, 65535
s_add_u32 m0, s32, 0
s_mov_b32 s48, s30
buffer_load_dwordx4 v1, s[12:15], s48 offen lds
s_add_u32 m0, s32, 4096
s_nop 0
buffer_load_dwordx4 v2, s[12:15], s48 offen lds
s_add_u32 m0, s32, 8192
s_nop 0
buffer_load_dwordx4 v3, s[12:15], s48 offen lds
s_add_u32 m0, s32, 12288
s_nop 0
buffer_load_dwordx4 v4, s[12:15], s48 offen lds
s_mov_b32 m0, s33
s_nop 0
buffer_load_dwordx4 v5, s[20:23], s31 offen offset:0 lds
buffer_load_dwordx4 v6, s[20:23], s31 offen offset:1024 lds
buffer_load_dwordx4 v7, s[20:23], s31 offen offset:2048 lds
buffer_load_dwordx4 v8, s[20:23], s31 offen offset:3072 lds
s_add_u32 s31, s31, 262144
s_add_u32 s33, s33, 16384
s_and_b32 s33, s33, 65535
s_add_u32 m0, s32, 16384
s_add_u32 s48, s30, s34
buffer_load_dwordx4 v1, s[12:15], s48 offen lds
s_add_u32 m0, s32, 20480
s_nop 0
buffer_load_dwordx4 v2, s[12:15], s48 offen lds
s_add_u32 m0, s32, 24576
s_nop 0
buffer_load_dwordx4 v3, s[12:15], s48 offen lds
s_add_u32 m0, s32, 28672
s_nop 0
buffer_load_dwordx4 v4, s[12:15], s48 offen lds
s_add_u32 s30, s30, 128
s_add_u32 s32, s32, 32768
s_sub_u32 s24, s32, 98304
s_cmp_ge_u32 s32, 163840
s_cselect_b32 s32, s24, s32
s_mov_b32 m0, s33
s_nop 0
buffer_load_dwordx4 v5, s[20:23], s31 offen offset:0 lds
buffer_load_dwordx4 v6, s[20:23], s31 offen offset:1024 lds
buffer_load_dwordx4 v7, s[20:23], s31 offen offset:2048 lds
buffer_load_dwordx4 v8, s[20:23], s31 offen offset:3072 lds
s_add_u32 s31, s31, 262144
s_add_u32 s33, s33, 16384
s_and_b32 s33, s33, 65535
s_mov_b32 s62, 536870912
s_mov_b32 s63, 536870912
s_mov_b32 s60, 0
s_mov_b32 s50, 0
s_waitcnt vmcnt(20)
s_barrier
ds_read_b64_tr_b16 a[176:177], v13 offset:0
ds_read_b64_tr_b16 a[178:179], v13 offset:1024
ds_read_b128 a[160:163], v9 offset:0
ds_read_b128 a[164:167], v9 offset:4096
ds_read_b128 a[168:171], v9 offset:8192
ds_read_b128 a[172:175], v9 offset:12288
ds_read_b64_tr_b16 a[180:181], v14 offset:0
ds_read_b64_tr_b16 a[182:183], v14 offset:1024
ds_read_b64_tr_b16 a[184:185], v15 offset:0
ds_read_b64_tr_b16 a[186:187], v15 offset:1024
ds_read_b64_tr_b16 a[188:189], v16 offset:0
ds_read_b64_tr_b16 a[190:191], v16 offset:1024
L_g_tile:
s_mov_b32 s38, s62
s_mov_b32 s39, s63
s_mov_b32 s29, s60
s_mov_b32 s49, s50
s_mov_b32 s62, s42
s_mov_b32 s63, s43
s_mov_b32 s60, s44
s_mov_b32 s50, s51
s_mov_b32 s36, s40
s_add_u32 s35, s35, 1
s_cmp_eq_u32 s35, 2
s_cbranch_scc1 L_g_first
L_g_go:
s_cmp_eq_u32 s41, 0
s_cbranch_scc0 L_g_v
.p2align 3
L_g_k:
s_waitcnt lgkmcnt(0)
v_mfma_f32_32x32x16_bf16 v[160:175], a[176:179], a[160:163], 0
ds_read_b64_tr_b16 a[208:209], v13 offset:4096
s_add_u32 m0, s32, 0
s_mov_b32 s48, s30
v_accvgpr_read_b32 v24, a72
v_accvgpr_read_b32 v25, a73
v_cvt_pk_bf16_f32 v116, v24, v25
v_accvgpr_read_b32 v26, a74
v_accvgpr_read_b32 v27, a75
v_cvt_pk_bf16_f32 v117, v26, v27
v_accvgpr_read_b32 v28, a76
v_accvgpr_read_b32 v29, a77
v_cvt_pk_bf16_f32 v118, v28, v29
v_accvgpr_read_b32 v30, a78
v_mfma_f32_32x32x16_bf16 v[176:191], a[176:179], a[164:167], 0
ds_read_b64_tr_b16 a[210:211], v13 offset:5120
buffer_load_dwordx4 v1, s[12:15], s48 offen lds
v_accvgpr_read_b32 v31, a79
v_cvt_pk_bf16_f32 v119, v30, v31
v_accvgpr_read_b32 v24, a80
v_accvgpr_read_b32 v25, a81
v_cvt_pk_bf16_f32 v120, v24, v25
v_accvgpr_read_b32 v26, a82
v_accvgpr_read_b32 v27, a83
v_cvt_pk_bf16_f32 v121, v26, v27
v_accvgpr_read_b32 v28, a84
v_accvgpr_read_b32 v29, a85
v_mfma_f32_32x32x16_bf16 v[192:207], a[176:179], a[168:171], 0
ds_read_b128 a[192:195], v10 offset:0
v_cvt_pk_bf16_f32 v122, v28, v29
v_accvgpr_read_b32 v30, a86
v_accvgpr_read_b32 v31, a87
v_cvt_pk_bf16_f32 v123, v30, v31
v_accvgpr_read_b32 v24, a88
v_accvgpr_read_b32 v25, a89
v_cvt_pk_bf16_f32 v124, v24, v25
v_accvgpr_read_b32 v26, a90
v_accvgpr_read_b32 v27, a91
v_cvt_pk_bf16_f32 v125, v26, v27
v_mfma_f32_32x32x16_bf16 v[208:223], a[176:179], a[172:175], 0
ds_read_b128 a[196:199], v10 offset:4096
v_accvgpr_read_b32 v28, a92
v_accvgpr_read_b32 v29, a93
v_cvt_pk_bf16_f32 v126, v28, v29
v_accvgpr_read_b32 v30, a94
v_accvgpr_read_b32 v31, a95
v_cvt_pk_bf16_f32 v127, v30, v31
v_accvgpr_read_b32 v24, a96
v_accvgpr_read_b32 v25, a97
v_cvt_pk_bf16_f32 v128, v24, v25
v_accvgpr_read_b32 v26, a98
v_mfma_f32_32x32x16_bf16 v[224:239], a[180:183], a[160:163], 0
ds_read_b128 a[200:203], v10 offset:8192
s_add_u32 m0, s32, 4096
v_accvgpr_read_b32 v27, a99
v_cvt_pk_bf16_f32 v129, v26, v27
v_accvgpr_read_b32 v28, a100
v_accvgpr_read_b32 v29, a101
v_cvt_pk_bf16_f32 v130, v28, v29
v_accvgpr_read_b32 v30, a102
v_accvgpr_read_b32 v31, a103
v_cvt_pk_bf16_f32 v131, v30, v31
v_accvgpr_read_b32 v24, a104
v_accvgpr_read_b32 v25, a105
v_mfma_f32_32x32x16_bf16 v[240:255], a[180:183], a[164:167], 0
ds_read_b128 a[204:207], v10 offset:12288
buffer_load_dwordx4 v2, s[12:15], s48 offen lds
v_cvt_pk_bf16_f32 v132, v24, v25
v_accvgpr_read_b32 v26, a106
v_accvgpr_read_b32 v27, a107
v_cvt_pk_bf16_f32 v133, v26, v27
v_accvgpr_read_b32 v28, a108
v_accvgpr_read_b32 v29, a109
v_cvt_pk_bf16_f32 v134, v28, v29
v_accvgpr_read_b32 v30, a110
v_accvgpr_read_b32 v31, a111
v_cvt_pk_bf16_f32 v135, v30, v31
v_mfma_f32_32x32x16_bf16 a[0:15], a[180:183], a[168:171], 0
ds_read_b64_tr_b16 a[212:213], v14 offset:4096
v_accvgpr_read_b32 v24, a112
v_accvgpr_read_b32 v25, a113
v_cvt_pk_bf16_f32 v136, v24, v25
v_accvgpr_read_b32 v26, a114
v_accvgpr_read_b32 v27, a115
v_cvt_pk_bf16_f32 v137, v26, v27
v_accvgpr_read_b32 v28, a116
v_accvgpr_read_b32 v29, a117
v_cvt_pk_bf16_f32 v138, v28, v29
v_accvgpr_read_b32 v30, a118
v_mfma_f32_32x32x16_bf16 a[16:31], a[180:183], a[172:175], 0
ds_read_b64_tr_b16 a[214:215], v14 offset:5120
v_accvgpr_read_b32 v31, a119
v_cvt_pk_bf16_f32 v139, v30, v31
v_accvgpr_read_b32 v24, a120
v_accvgpr_read_b32 v25, a121
v_cvt_pk_bf16_f32 v140, v24, v25
v_accvgpr_read_b32 v26, a122
v_accvgpr_read_b32 v27, a123
v_cvt_pk_bf16_f32 v141, v26, v27
v_accvgpr_read_b32 v28, a124
v_accvgpr_read_b32 v29, a125
v_mfma_f32_32x32x16_bf16 a[32:47], a[184:187], a[160:163], 0
ds_read_b64_tr_b16 a[216:217], v15 offset:4096
s_add_u32 m0, s32, 8192
v_cvt_pk_bf16_f32 v142, v28, v29
v_accvgpr_read_b32 v30, a126
v_accvgpr_read_b32 v31, a127
v_cvt_pk_bf16_f32 v143, v30, v31
v_accvgpr_read_b32 v24, a128
v_accvgpr_read_b32 v25, a129
v_cvt_pk_bf16_f32 v144, v24, v25
v_accvgpr_read_b32 v26, a130
v_accvgpr_read_b32 v27, a131
v_cvt_pk_bf16_f32 v145, v26, v27
v_mfma_f32_32x32x16_bf16 a[48:63], a[184:187], a[164:167], 0
ds_read_b64_tr_b16 a[218:219], v15 offset:5120
buffer_load_dwordx4 v3, s[12:15], s48 offen lds
v_accvgpr_read_b32 v28, a132
v_accvgpr_read_b32 v29, a133
v_cvt_pk_bf16_f32 v146, v28, v29
v_accvgpr_read_b32 v30, a134
v_accvgpr_read_b32 v31, a135
v_cvt_pk_bf16_f32 v147, v30, v31
v_accvgpr_read_b32 v24, a136
v_accvgpr_read_b32 v25, a137
v_cvt_pk_bf16_f32 v148, v24, v25
v_accvgpr_read_b32 v26, a138
v_mfma_f32_32x32x16_bf16 a[64:79], a[184:187], a[168:171], 0
ds_read_b64_tr_b16 a[220:221], v16 offset:4096
v_accvgpr_read_b32 v27, a139
v_cvt_pk_bf16_f32 v149, v26, v27
v_accvgpr_read_b32 v28, a140
v_accvgpr_read_b32 v29, a141
v_cvt_pk_bf16_f32 v150, v28, v29
v_accvgpr_read_b32 v30, a142
v_accvgpr_read_b32 v31, a143
v_cvt_pk_bf16_f32 v151, v30, v31
v_accvgpr_read_b32 v24, a144
v_accvgpr_read_b32 v25, a145
v_mfma_f32_32x32x16_bf16 a[80:95], a[184:187], a[172:175], 0
ds_read_b64_tr_b16 a[222:223], v16 offset:5120
v_cvt_pk_bf16_f32 v152, v24, v25
v_accvgpr_read_b32 v26, a146
v_accvgpr_read_b32 v27, a147
v_cvt_pk_bf16_f32 v153, v26, v27
v_accvgpr_read_b32 v28, a148
v_accvgpr_read_b32 v29, a149
v_cvt_pk_bf16_f32 v154, v28, v29
v_accvgpr_read_b32 v30, a150
v_accvgpr_read_b32 v31, a151
v_cvt_pk_bf16_f32 v155, v30, v31
v_mfma_f32_32x32x16_bf16 a[96:111], a[188:191], a[160:163], 0
s_add_u32 m0, s32, 12288
v_accvgpr_read_b32 v24, a152
v_accvgpr_read_b32 v25, a153
v_cvt_pk_bf16_f32 v156, v24, v25
v_accvgpr_read_b32 v26, a154
v_accvgpr_read_b32 v27, a155
v_cvt_pk_bf16_f32 v157, v26, v27
v_accvgpr_read_b32 v28, a156
v_accvgpr_read_b32 v29, a157
v_cvt_pk_bf16_f32 v158, v28, v29
v_accvgpr_read_b32 v30, a158
v_mfma_f32_32x32x16_bf16 a[112:127], a[188:191], a[164:167], 0
buffer_load_dwordx4 v4, s[12:15], s48 offen lds
v_accvgpr_read_b32 v31, a159
v_cvt_pk_bf16_f32 v159, v30, v31
v_mfma_f32_32x32x16_bf16 a[128:143], a[188:191], a[168:171], 0
v_mfma_f32_32x32x16_bf16 a[144:159], a[188:191], a[172:175], 0
v_add_u32 v13, 16384, v13
v_and_b32 v13, 65535, v13
v_add_u32 v14, 16384, v14
v_and_b32 v14, 65535, v14
v_add_u32 v15, 16384, v15
v_and_b32 v15, 65535, v15
v_add_u32 v16, 16384, v16
v_and_b32 v16, 65535, v16
v_and_b32 v18, 63, v0
v_bfe_u32 v19, v0, 1, 4
v_and_b32 v20, 1, v0
v_lshl_add_u32 v19, v20, 4, v19
v_and_or_b32 v19, v0, 32, v19
v_cmp_eq_u32 vcc, 0, s49
s_nop 1
v_cndmask_b32 v18, v19, v18, vcc
v_lshlrev_b32 v17, 4, v18
s_waitcnt vmcnt(17) lgkmcnt(0)
s_barrier
v_mfma_f32_32x32x16_bf16 v[160:175], a[208:211], a[192:195], v[160:175]
ds_read_b64_tr_b16 a[176:177], v13 offset:0
s_mov_b32 m0, s33
v_mfma_f32_32x32x16_bf16 v[176:191], a[208:211], a[196:199], v[176:191]
ds_read_b64_tr_b16 a[178:179], v13 offset:1024
buffer_load_dwordx4 v5, s[20:23], s31 offen offset:0 lds
v_mfma_f32_32x32x16_bf16 v[192:207], a[208:211], a[200:203], v[192:207]
ds_read_b128 a[160:163], v11 offset:0
v_mfma_f32_32x32x16_bf16 v[208:223], a[208:211], a[204:207], v[208:223]
ds_read_b128 a[164:167], v11 offset:4096
v_mfma_f32_32x32x16_bf16 v[224:239], a[212:215], a[192:195], v[224:239]
ds_read_b128 a[168:171], v11 offset:8192
v_mfma_f32_32x32x16_bf16 v[240:255], a[212:215], a[196:199], v[240:255]
ds_read_b128 a[172:175], v11 offset:12288
buffer_load_dwordx4 v6, s[20:23], s31 offen offset:1024 lds
v_mfma_f32_32x32x16_bf16 a[0:15], a[212:215], a[200:203], a[0:15]
ds_read_b64_tr_b16 a[180:181], v14 offset:0
s_add_u32 s25, s38, 0
v_mfma_f32_32x32x16_bf16 a[16:31], a[212:215], a[204:207], a[16:31]
ds_read_b64_tr_b16 a[182:183], v14 offset:1024
buffer_store_dwordx4 v[32:35], v17, s[8:11], s25 offen offset:0 sc1
v_mfma_f32_32x32x16_bf16 a[32:47], a[216:219], a[192:195], a[32:47]
ds_read_b64_tr_b16 a[184:185], v15 offset:0
v_mfma_f32_32x32x16_bf16 a[48:63], a[216:219], a[196:199], a[48:63]
ds_read_b64_tr_b16 a[186:187], v15 offset:1024
buffer_load_dwordx4 v7, s[20:23], s31 offen offset:2048 lds
v_mfma_f32_32x32x16_bf16 a[64:79], a[216:219], a[200:203], a[64:79]
ds_read_b64_tr_b16 a[188:189], v16 offset:0
v_mfma_f32_32x32x16_bf16 a[80:95], a[216:219], a[204:207], a[80:95]
ds_read_b64_tr_b16 a[190:191], v16 offset:1024
v_mfma_f32_32x32x16_bf16 a[96:111], a[220:223], a[192:195], a[96:111]
v_mfma_f32_32x32x16_bf16 a[112:127], a[220:223], a[196:199], a[112:127]
buffer_load_dwordx4 v8, s[20:23], s31 offen offset:3072 lds
v_mfma_f32_32x32x16_bf16 a[128:143], a[220:223], a[200:203], a[128:143]
s_add_u32 s31, s31, 262144
s_add_u32 s33, s33, 16384
s_and_b32 s33, s33, 65535
s_add_u32 s25, s38, 0
v_mfma_f32_32x32x16_bf16 a[144:159], a[220:223], a[204:207], a[144:159]
buffer_store_dwordx4 v[36:39], v17, s[8:11], s25 offen offset:1024 sc1
s_waitcnt lgkmcnt(0)
v_mfma_f32_32x32x16_bf16 v[160:175], a[176:179], a[160:163], v[160:175]
ds_read_b64_tr_b16 a[208:209], v13 offset:4096
s_add_u32 m0, s32, 16384
s_add_u32 s48, s30, s34
v_mfma_f32_32x32x16_bf16 v[176:191], a[176:179], a[164:167], v[176:191]
ds_read_b64_tr_b16 a[210:211], v13 offset:5120
buffer_load_dwordx4 v1, s[12:15], s48 offen lds
v_mfma_f32_32x32x16_bf16 v[192:207], a[176:179], a[168:171], v[192:207]
ds_read_b128 a[192:195], v12 offset:0
v_mfma_f32_32x32x16_bf16 v[208:223], a[176:179], a[172:175], v[208:223]
ds_read_b128 a[196:199], v12 offset:4096
v_mfma_f32_32x32x16_bf16 v[224:239], a[180:183], a[160:163], v[224:239]
ds_read_b128 a[200:203], v12 offset:8192
s_add_u32 m0, s32, 20480
v_mfma_f32_32x32x16_bf16 v[240:255], a[180:183], a[164:167], v[240:255]
ds_read_b128 a[204:207], v12 offset:12288
buffer_load_dwordx4 v2, s[12:15], s48 offen lds
v_mfma_f32_32x32x16_bf16 a[0:15], a[180:183], a[168:171], a[0:15]
ds_read_b64_tr_b16 a[212:213], v14 offset:4096
s_add_u32 s25, s38, 16384
v_mfma_f32_32x32x16_bf16 a[16:31], a[180:183], a[172:175], a[16:31]
ds_read_b64_tr_b16 a[214:215], v14 offset:5120
buffer_store_dwordx4 v[40:43], v17, s[8:11], s25 offen offset:0 sc1
v_mfma_f32_32x32x16_bf16 a[32:47], a[184:187], a[160:163], a[32:47]
ds_read_b64_tr_b16 a[216:217], v15 offset:4096
s_add_u32 m0, s32, 24576
v_mfma_f32_32x32x16_bf16 a[48:63], a[184:187], a[164:167], a[48:63]
ds_read_b64_tr_b16 a[218:219], v15 offset:5120
buffer_load_dwordx4 v3, s[12:15], s48 offen lds
v_mfma_f32_32x32x16_bf16 a[64:79], a[184:187], a[168:171], a[64:79]
ds_read_b64_tr_b16 a[220:221], v16 offset:4096
v_mfma_f32_32x32x16_bf16 a[80:95], a[184:187], a[172:175], a[80:95]
ds_read_b64_tr_b16 a[222:223], v16 offset:5120
v_add_u32 v9, 32768, v9
v_subrev_u32 v20, 98304, v9
v_cmp_le_u32 vcc, 163840, v9
v_add_u32 v13, 16384, v13
v_mfma_f32_32x32x16_bf16 a[96:111], a[188:191], a[160:163], a[96:111]
s_add_u32 m0, s32, 28672
v_and_b32 v13, 65535, v13
v_add_u32 v14, 16384, v14
v_and_b32 v14, 65535, v14
v_add_u32 v15, 16384, v15
v_mfma_f32_32x32x16_bf16 a[112:127], a[188:191], a[164:167], a[112:127]
buffer_load_dwordx4 v4, s[12:15], s48 offen lds
v_and_b32 v15, 65535, v15
v_add_u32 v16, 16384, v16
v_and_b32 v16, 65535, v16
v_mfma_f32_32x32x16_bf16 a[128:143], a[188:191], a[168:171], a[128:143]
s_add_u32 s30, s30, 128
s_add_u32 s32, s32, 32768
s_sub_u32 s24, s32, 98304
s_cmp_ge_u32 s32, 163840
s_cselect_b32 s32, s24, s32
v_cndmask_b32 v9, v9, v20, vcc
v_xor_b32 v10, 32, v9
v_xor_b32 v11, 64, v9
v_xor_b32 v12, 96, v9
v_mfma_f32_32x32x16_bf16 a[144:159], a[188:191], a[172:175], a[144:159]
s_waitcnt vmcnt(19) lgkmcnt(0)
s_barrier
v_mfma_f32_32x32x16_bf16 v[160:175], a[208:211], a[192:195], v[160:175]
ds_read_b64_tr_b16 a[176:177], v13 offset:0
s_mov_b32 m0, s33
v_mfma_f32_32x32x16_bf16 v[176:191], a[208:211], a[196:199], v[176:191]
ds_read_b64_tr_b16 a[178:179], v13 offset:1024
buffer_load_dwordx4 v5, s[20:23], s31 offen offset:0 lds
v_mfma_f32_32x32x16_bf16 v[192:207], a[208:211], a[200:203], v[192:207]
ds_read_b128 a[160:163], v9 offset:0
v_mfma_f32_32x32x16_bf16 v[208:223], a[208:211], a[204:207], v[208:223]
ds_read_b128 a[164:167], v9 offset:4096
v_mfma_f32_32x32x16_bf16 v[224:239], a[212:215], a[192:195], v[224:239]
ds_read_b128 a[168:171], v9 offset:8192
v_mfma_f32_32x32x16_bf16 v[240:255], a[212:215], a[196:199], v[240:255]
ds_read_b128 a[172:175], v9 offset:12288
buffer_load_dwordx4 v6, s[20:23], s31 offen offset:1024 lds
v_mfma_f32_32x32x16_bf16 a[0:15], a[212:215], a[200:203], a[0:15]
ds_read_b64_tr_b16 a[180:181], v14 offset:0
s_add_u32 s25, s38, 16384
v_mfma_f32_32x32x16_bf16 a[16:31], a[212:215], a[204:207], a[16:31]
ds_read_b64_tr_b16 a[182:183], v14 offset:1024
buffer_store_dwordx4 v[44:47], v17, s[8:11], s25 offen offset:1024 sc1
v_mfma_f32_32x32x16_bf16 a[32:47], a[216:219], a[192:195], a[32:47]
ds_read_b64_tr_b16 a[184:185], v15 offset:0
v_mfma_f32_32x32x16_bf16 a[48:63], a[216:219], a[196:199], a[48:63]
ds_read_b64_tr_b16 a[186:187], v15 offset:1024
buffer_load_dwordx4 v7, s[20:23], s31 offen offset:2048 lds
v_mfma_f32_32x32x16_bf16 a[64:79], a[216:219], a[200:203], a[64:79]
ds_read_b64_tr_b16 a[188:189], v16 offset:0
v_mfma_f32_32x32x16_bf16 a[80:95], a[216:219], a[204:207], a[80:95]
ds_read_b64_tr_b16 a[190:191], v16 offset:1024
v_mfma_f32_32x32x16_bf16 a[96:111], a[220:223], a[192:195], a[96:111]
v_mfma_f32_32x32x16_bf16 a[112:127], a[220:223], a[196:199], a[112:127]
buffer_load_dwordx4 v8, s[20:23], s31 offen offset:3072 lds
v_mfma_f32_32x32x16_bf16 a[128:143], a[220:223], a[200:203], a[128:143]
s_add_u32 s31, s31, 262144
s_add_u32 s33, s33, 16384
s_and_b32 s33, s33, 65535
v_mfma_f32_32x32x16_bf16 a[144:159], a[220:223], a[204:207], a[144:159]
s_waitcnt lgkmcnt(0)
v_mfma_f32_32x32x16_bf16 v[160:175], a[176:179], a[160:163], v[160:175]
ds_read_b64_tr_b16 a[208:209], v13 offset:4096
s_add_u32 m0, s32, 0
s_mov_b32 s48, s30
v_mfma_f32_32x32x16_bf16 v[176:191], a[176:179], a[164:167], v[176:191]
ds_read_b64_tr_b16 a[210:211], v13 offset:5120
buffer_load_dwordx4 v1, s[12:15], s48 offen lds
v_mfma_f32_32x32x16_bf16 v[192:207], a[176:179], a[168:171], v[192:207]
ds_read_b128 a[192:195], v10 offset:0
v_mfma_f32_32x32x16_bf16 v[208:223], a[176:179], a[172:175], v[208:223]
ds_read_b128 a[196:199], v10 offset:4096
v_mfma_f32_32x32x16_bf16 v[224:239], a[180:183], a[160:163], v[224:239]
ds_read_b128 a[200:203], v10 offset:8192
s_add_u32 m0, s32, 4096
v_mfma_f32_32x32x16_bf16 v[240:255], a[180:183], a[164:167], v[240:255]
ds_read_b128 a[204:207], v10 offset:12288
buffer_load_dwordx4 v2, s[12:15], s48 offen lds
v_mfma_f32_32x32x16_bf16 a[0:15], a[180:183], a[168:171], a[0:15]
ds_read_b64_tr_b16 a[212:213], v14 offset:4096
s_add_u32 s25, s38, 32768
v_mfma_f32_32x32x16_bf16 a[16:31], a[180:183], a[172:175], a[16:31]
ds_read_b64_tr_b16 a[214:215], v14 offset:5120
buffer_store_dwordx4 v[48:51], v17, s[8:11], s25 offen offset:0 sc1
v_mfma_f32_32x32x16_bf16 a[32:47], a[184:187], a[160:163], a[32:47]
ds_read_b64_tr_b16 a[216:217], v15 offset:4096
s_add_u32 m0, s32, 8192
v_mfma_f32_32x32x16_bf16 a[48:63], a[184:187], a[164:167], a[48:63]
ds_read_b64_tr_b16 a[218:219], v15 offset:5120
buffer_load_dwordx4 v3, s[12:15], s48 offen lds
v_mfma_f32_32x32x16_bf16 a[64:79], a[184:187], a[168:171], a[64:79]
ds_read_b64_tr_b16 a[220:221], v16 offset:4096
v_mfma_f32_32x32x16_bf16 a[80:95], a[184:187], a[172:175], a[80:95]
ds_read_b64_tr_b16 a[222:223], v16 offset:5120
v_add_u32 v13, 16384, v13
v_and_b32 v13, 65535, v13
v_mfma_f32_32x32x16_bf16 a[96:111], a[188:191], a[160:163], a[96:111]
s_add_u32 m0, s32, 12288
v_add_u32 v14, 16384, v14
v_and_b32 v14, 65535, v14
v_mfma_f32_32x32x16_bf16 a[112:127], a[188:191], a[164:167], a[112:127]
buffer_load_dwordx4 v4, s[12:15], s48 offen lds
v_add_u32 v15, 16384, v15
v_and_b32 v15, 65535, v15
v_mfma_f32_32x32x16_bf16 a[128:143], a[188:191], a[168:171], a[128:143]
s_add_u32 s25, s38, 32768
v_add_u32 v16, 16384, v16
v_and_b32 v16, 65535, v16
v_mfma_f32_32x32x16_bf16 a[144:159], a[188:191], a[172:175], a[144:159]
buffer_store_dwordx4 v[52:55], v17, s[8:11], s25 offen offset:1024 sc1
s_waitcnt vmcnt(22) lgkmcnt(0)
s_barrier
v_mfma_f32_32x32x16_bf16 v[160:175], a[208:211], a[192:195], v[160:175]
ds_read_b64_tr_b16 a[176:177], v13 offset:0
s_mov_b32 m0, s33
v_mfma_f32_32x32x16_bf16 v[176:191], a[208:211], a[196:199], v[176:191]
ds_read_b64_tr_b16 a[178:179], v13 offset:1024
buffer_load_dwordx4 v5, s[20:23], s31 offen offset:0 lds
v_mfma_f32_32x32x16_bf16 v[192:207], a[208:211], a[200:203], v[192:207]
ds_read_b128 a[160:163], v11 offset:0
v_mfma_f32_32x32x16_bf16 v[208:223], a[208:211], a[204:207], v[208:223]
ds_read_b128 a[164:167], v11 offset:4096
v_mfma_f32_32x32x16_bf16 v[224:239], a[212:215], a[192:195], v[224:239]
ds_read_b128 a[168:171], v11 offset:8192
v_mfma_f32_32x32x16_bf16 v[240:255], a[212:215], a[196:199], v[240:255]
ds_read_b128 a[172:175], v11 offset:12288
buffer_load_dwordx4 v6, s[20:23], s31 offen offset:1024 lds
v_mfma_f32_32x32x16_bf16 a[0:15], a[212:215], a[200:203], a[0:15]
ds_read_b64_tr_b16 a[180:181], v14 offset:0
s_add_u32 s25, s38, 49152
v_mfma_f32_32x32x16_bf16 a[16:31], a[212:215], a[204:207], a[16:31]
ds_read_b64_tr_b16 a[182:183], v14 offset:1024
buffer_store_dwordx4 v[56:59], v17, s[8:11], s25 offen offset:0 sc1
v_mfma_f32_32x32x16_bf16 a[32:47], a[216:219], a[192:195], a[32:47]
ds_read_b64_tr_b16 a[184:185], v15 offset:0
v_mfma_f32_32x32x16_bf16 a[48:63], a[216:219], a[196:199], a[48:63]
ds_read_b64_tr_b16 a[186:187], v15 offset:1024
buffer_load_dwordx4 v7, s[20:23], s31 offen offset:2048 lds
v_mfma_f32_32x32x16_bf16 a[64:79], a[216:219], a[200:203], a[64:79]
ds_read_b64_tr_b16 a[188:189], v16 offset:0
v_mfma_f32_32x32x16_bf16 a[80:95], a[216:219], a[204:207], a[80:95]
ds_read_b64_tr_b16 a[190:191], v16 offset:1024
v_mfma_f32_32x32x16_bf16 a[96:111], a[220:223], a[192:195], a[96:111]
v_mfma_f32_32x32x16_bf16 a[112:127], a[220:223], a[196:199], a[112:127]
buffer_load_dwordx4 v8, s[20:23], s31 offen offset:3072 lds
v_mfma_f32_32x32x16_bf16 a[128:143], a[220:223], a[200:203], a[128:143]
s_add_u32 s31, s31, 262144
s_add_u32 s33, s33, 16384
s_and_b32 s33, s33, 65535
v_mfma_f32_32x32x16_bf16 a[144:159], a[220:223], a[204:207], a[144:159]
s_waitcnt lgkmcnt(0)
v_mfma_f32_32x32x16_bf16 v[160:175], a[176:179], a[160:163], v[160:175]
ds_read_b64_tr_b16 a[208:209], v13 offset:4096
s_add_u32 m0, s32, 16384
s_add_u32 s48, s30, s34
v_mfma_f32_32x32x16_bf16 v[176:191], a[176:179], a[164:167], v[176:191]
ds_read_b64_tr_b16 a[210:211], v13 offset:5120
buffer_load_dwordx4 v1, s[12:15], s48 offen lds
v_mfma_f32_32x32x16_bf16 v[192:207], a[176:179], a[168:171], v[192:207]
ds_read_b128 a[192:195], v12 offset:0
v_mfma_f32_32x32x16_bf16 v[208:223], a[176:179], a[172:175], v[208:223]
ds_read_b128 a[196:199], v12 offset:4096
v_mfma_f32_32x32x16_bf16 v[224:239], a[180:183], a[160:163], v[224:239]
ds_read_b128 a[200:203], v12 offset:8192
s_add_u32 m0, s32, 20480
v_mfma_f32_32x32x16_bf16 v[240:255], a[180:183], a[164:167], v[240:255]
ds_read_b128 a[204:207], v12 offset:12288
buffer_load_dwordx4 v2, s[12:15], s48 offen lds
v_mfma_f32_32x32x16_bf16 a[0:15], a[180:183], a[168:171], a[0:15]
ds_read_b64_tr_b16 a[212:213], v14 offset:4096
s_add_u32 s25, s38, 49152
v_mfma_f32_32x32x16_bf16 a[16:31], a[180:183], a[172:175], a[16:31]
ds_read_b64_tr_b16 a[214:215], v14 offset:5120
buffer_store_dwordx4 v[60:63], v17, s[8:11], s25 offen offset:1024 sc1
v_mfma_f32_32x32x16_bf16 a[32:47], a[184:187], a[160:163], a[32:47]
ds_read_b64_tr_b16 a[216:217], v15 offset:4096
s_add_u32 m0, s32, 24576
v_mfma_f32_32x32x16_bf16 a[48:63], a[184:187], a[164:167], a[48:63]
ds_read_b64_tr_b16 a[218:219], v15 offset:5120
buffer_load_dwordx4 v3, s[12:15], s48 offen lds
v_mfma_f32_32x32x16_bf16 a[64:79], a[184:187], a[168:171], a[64:79]
ds_read_b64_tr_b16 a[220:221], v16 offset:4096
v_mfma_f32_32x32x16_bf16 a[80:95], a[184:187], a[172:175], a[80:95]
ds_read_b64_tr_b16 a[222:223], v16 offset:5120
v_add_u32 v9, 32768, v9
v_subrev_u32 v20, 98304, v9
v_cmp_le_u32 vcc, 163840, v9
v_add_u32 v13, 16384, v13
v_mfma_f32_32x32x16_bf16 a[96:111], a[188:191], a[160:163], a[96:111]
s_add_u32 m0, s32, 28672
v_and_b32 v13, 65535, v13
v_add_u32 v14, 16384, v14
v_and_b32 v14, 65535, v14
v_add_u32 v15, 16384, v15
v_mfma_f32_32x32x16_bf16 a[112:127], a[188:191], a[164:167], a[112:127]
buffer_load_dwordx4 v4, s[12:15], s48 offen lds
v_and_b32 v15, 65535, v15
v_add_u32 v16, 16384, v16
v_and_b32 v16, 65535, v16
v_mfma_f32_32x32x16_bf16 a[128:143], a[188:191], a[168:171], a[128:143]
s_add_u32 s30, s30, 128
s_add_u32 s32, s32, 32768
s_sub_u32 s24, s32, 98304
s_cmp_ge_u32 s32, 163840
s_cselect_b32 s32, s24, s32
v_cndmask_b32 v9, v9, v20, vcc
v_xor_b32 v10, 32, v9
v_xor_b32 v11, 64, v9
v_xor_b32 v12, 96, v9
v_mfma_f32_32x32x16_bf16 a[144:159], a[188:191], a[172:175], a[144:159]
s_waitcnt vmcnt(21) lgkmcnt(0)
s_barrier
v_mfma_f32_32x32x16_bf16 v[160:175], a[208:211], a[192:195], v[160:175]
ds_read_b64_tr_b16 a[176:177], v13 offset:0
s_mov_b32 m0, s33
v_mfma_f32_32x32x16_bf16 v[176:191], a[208:211], a[196:199], v[176:191]
ds_read_b64_tr_b16 a[178:179], v13 offset:1024
buffer_load_dwordx4 v5, s[20:23], s31 offen offset:0 lds
v_mfma_f32_32x32x16_bf16 v[192:207], a[208:211], a[200:203], v[192:207]
ds_read_b128 a[160:163], v9 offset:0
v_mfma_f32_32x32x16_bf16 v[208:223], a[208:211], a[204:207], v[208:223]
ds_read_b128 a[164:167], v9 offset:4096
v_mfma_f32_32x32x16_bf16 v[224:239], a[212:215], a[192:195], v[224:239]
ds_read_b128 a[168:171], v9 offset:8192
v_mfma_f32_32x32x16_bf16 v[240:255], a[212:215], a[196:199], v[240:255]
ds_read_b128 a[172:175], v9 offset:12288
buffer_load_dwordx4 v6, s[20:23], s31 offen offset:1024 lds
v_mfma_f32_32x32x16_bf16 a[0:15], a[212:215], a[200:203], a[0:15]
ds_read_b64_tr_b16 a[180:181], v14 offset:0
s_add_u32 s25, s38, 2048
v_mfma_f32_32x32x16_bf16 a[16:31], a[212:215], a[204:207], a[16:31]
ds_read_b64_tr_b16 a[182:183], v14 offset:1024
buffer_store_dwordx4 v[64:67], v17, s[8:11], s25 offen offset:0 sc1
v_mfma_f32_32x32x16_bf16 a[32:47], a[216:219], a[192:195], a[32:47]
ds_read_b64_tr_b16 a[184:185], v15 offset:0
v_mfma_f32_32x32x16_bf16 a[48:63], a[216:219], a[196:199], a[48:63]
ds_read_b64_tr_b16 a[186:187], v15 offset:1024
buffer_load_dwordx4 v7, s[20:23], s31 offen offset:2048 lds
v_mfma_f32_32x32x16_bf16 a[64:79], a[216:219], a[200:203], a[64:79]
ds_read_b64_tr_b16 a[188:189], v16 offset:0
v_mfma_f32_32x32x16_bf16 a[80:95], a[216:219], a[204:207], a[80:95]
ds_read_b64_tr_b16 a[190:191], v16 offset:1024
v_mfma_f32_32x32x16_bf16 a[96:111], a[220:223], a[192:195], a[96:111]
v_mfma_f32_32x32x16_bf16 a[112:127], a[220:223], a[196:199], a[112:127]
buffer_load_dwordx4 v8, s[20:23], s31 offen offset:3072 lds
v_mfma_f32_32x32x16_bf16 a[128:143], a[220:223], a[200:203], a[128:143]
s_add_u32 s31, s31, 262144
s_add_u32 s33, s33, 16384
s_and_b32 s33, s33, 65535
s_add_u32 s25, s38, 2048
v_mfma_f32_32x32x16_bf16 a[144:159], a[220:223], a[204:207], a[144:159]
buffer_store_dwordx4 v[68:71], v17, s[8:11], s25 offen offset:1024 sc1
s_waitcnt lgkmcnt(0)
v_mfma_f32_32x32x16_bf16 v[160:175], a[176:179], a[160:163], v[160:175]
ds_read_b64_tr_b16 a[208:209], v13 offset:4096
s_add_u32 m0, s32, 0
s_mov_b32 s48, s30
v_mfma_f32_32x32x16_bf16 v[176:191], a[176:179], a[164:167], v[176:191]
ds_read_b64_tr_b16 a[210:211], v13 offset:5120
buffer_load_dwordx4 v1, s[12:15], s48 offen lds
v_mfma_f32_32x32x16_bf16 v[192:207], a[176:179], a[168:171], v[192:207]
ds_read_b128 a[192:195], v10 offset:0
v_mfma_f32_32x32x16_bf16 v[208:223], a[176:179], a[172:175], v[208:223]
ds_read_b128 a[196:199], v10 offset:4096
v_mfma_f32_32x32x16_bf16 v[224:239], a[180:183], a[160:163], v[224:239]
ds_read_b128 a[200:203], v10 offset:8192
s_add_u32 m0, s32, 4096
v_mfma_f32_32x32x16_bf16 v[240:255], a[180:183], a[164:167], v[240:255]
ds_read_b128 a[204:207], v10 offset:12288
buffer_load_dwordx4 v2, s[12:15], s48 offen lds
v_mfma_f32_32x32x16_bf16 a[0:15], a[180:183], a[168:171], a[0:15]
ds_read_b64_tr_b16 a[212:213], v14 offset:4096
s_add_u32 s25, s38, 18432
v_mfma_f32_32x32x16_bf16 a[16:31], a[180:183], a[172:175], a[16:31]
ds_read_b64_tr_b16 a[214:215], v14 offset:5120
buffer_store_dwordx4 v[72:75], v17, s[8:11], s25 offen offset:0 sc1
v_mfma_f32_32x32x16_bf16 a[32:47], a[184:187], a[160:163], a[32:47]
ds_read_b64_tr_b16 a[216:217], v15 offset:4096
s_add_u32 m0, s32, 8192
v_mfma_f32_32x32x16_bf16 a[48:63], a[184:187], a[164:167], a[48:63]
ds_read_b64_tr_b16 a[218:219], v15 offset:5120
buffer_load_dwordx4 v3, s[12:15], s48 offen lds
v_mfma_f32_32x32x16_bf16 a[64:79], a[184:187], a[168:171], a[64:79]
ds_read_b64_tr_b16 a[220:221], v16 offset:4096
v_mfma_f32_32x32x16_bf16 a[80:95], a[184:187], a[172:175], a[80:95]
ds_read_b64_tr_b16 a[222:223], v16 offset:5120
v_add_u32 v13, 16384, v13
v_and_b32 v13, 65535, v13
v_mfma_f32_32x32x16_bf16 a[96:111], a[188:191], a[160:163], a[96:111]
s_add_u32 m0, s32, 12288
v_add_u32 v14, 16384, v14
v_and_b32 v14, 65535, v14
v_mfma_f32_32x32x16_bf16 a[112:127], a[188:191], a[164:167], a[112:127]
buffer_load_dwordx4 v4, s[12:15], s48 offen lds
v_add_u32 v15, 16384, v15
v_and_b32 v15, 65535, v15
v_mfma_f32_32x32x16_bf16 a[128:143], a[188:191], a[168:171], a[128:143]
v_add_u32 v16, 16384, v16
v_and_b32 v16, 65535, v16
v_mfma_f32_32x32x16_bf16 a[144:159], a[188:191], a[172:175], a[144:159]
s_waitcnt vmcnt(21) lgkmcnt(0)
s_barrier
v_mfma_f32_32x32x16_bf16 v[160:175], a[208:211], a[192:195], v[160:175]
ds_read_b64_tr_b16 a[176:177], v13 offset:0
s_mov_b32 m0, s33
v_mfma_f32_32x32x16_bf16 v[176:191], a[208:211], a[196:199], v[176:191]
ds_read_b64_tr_b16 a[178:179], v13 offset:1024
buffer_load_dwordx4 v5, s[20:23], s31 offen offset:0 lds
v_mfma_f32_32x32x16_bf16 v[192:207], a[208:211], a[200:203], v[192:207]
ds_read_b128 a[160:163], v11 offset:0
v_mfma_f32_32x32x16_bf16 v[208:223], a[208:211], a[204:207], v[208:223]
ds_read_b128 a[164:167], v11 offset:4096
v_mfma_f32_32x32x16_bf16 v[224:239], a[212:215], a[192:195], v[224:239]
ds_read_b128 a[168:171], v11 offset:8192
v_mfma_f32_32x32x16_bf16 v[240:255], a[212:215], a[196:199], v[240:255]
ds_read_b128 a[172:175], v11 offset:12288
buffer_load_dwordx4 v6, s[20:23], s31 offen offset:1024 lds
v_mfma_f32_32x32x16_bf16 a[0:15], a[212:215], a[200:203], a[0:15]
ds_read_b64_tr_b16 a[180:181], v14 offset:0
s_add_u32 s25, s38, 18432
v_mfma_f32_32x32x16_bf16 a[16:31], a[212:215], a[204:207], a[16:31]
ds_read_b64_tr_b16 a[182:183], v14 offset:1024
buffer_store_dwordx4 v[76:79], v17, s[8:11], s25 offen offset:1024 sc1
v_mfma_f32_32x32x16_bf16 a[32:47], a[216:219], a[192:195], a[32:47]
ds_read_b64_tr_b16 a[184:185], v15 offset:0
v_mfma_f32_32x32x16_bf16 a[48:63], a[216:219], a[196:199], a[48:63]
ds_read_b64_tr_b16 a[186:187], v15 offset:1024
buffer_load_dwordx4 v7, s[20:23], s31 offen offset:2048 lds
v_mfma_f32_32x32x16_bf16 a[64:79], a[216:219], a[200:203], a[64:79]
ds_read_b64_tr_b16 a[188:189], v16 offset:0
v_mfma_f32_32x32x16_bf16 a[80:95], a[216:219], a[204:207], a[80:95]
ds_read_b64_tr_b16 a[190:191], v16 offset:1024
v_mfma_f32_32x32x16_bf16 a[96:111], a[220:223], a[192:195], a[96:111]
v_mfma_f32_32x32x16_bf16 a[112:127], a[220:223], a[196:199], a[112:127]
buffer_load_dwordx4 v8, s[20:23], s31 offen offset:3072 lds
v_mfma_f32_32x32x16_bf16 a[128:143], a[220:223], a[200:203], a[128:143]
s_add_u32 s31, s31, 262144
s_add_u32 s33, s33, 16384
s_and_b32 s33, s33, 65535
v_mfma_f32_32x32x16_bf16 a[144:159], a[220:223], a[204:207], a[144:159]
s_waitcnt lgkmcnt(0)
v_mfma_f32_32x32x16_bf16 v[160:175], a[176:179], a[160:163], v[160:175]
ds_read_b64_tr_b16 a[208:209], v13 offset:4096
s_add_u32 m0, s32, 16384
s_add_u32 s48, s30, s34
v_mfma_f32_32x32x16_bf16 v[176:191], a[176:179], a[164:167], v[176:191]
ds_read_b64_tr_b16 a[210:211], v13 offset:5120
buffer_load_dwordx4 v1, s[12:15], s48 offen lds
v_mfma_f32_32x32x16_bf16 v[192:207], a[176:179], a[168:171], v[192:207]
ds_read_b128 a[192:195], v12 offset:0
v_mfma_f32_32x32x16_bf16 v[208:223], a[176:179], a[172:175], v[208:223]
ds_read_b128 a[196:199], v12 offset:4096
v_mfma_f32_32x32x16_bf16 v[224:239], a[180:183], a[160:163], v[224:239]
ds_read_b128 a[200:203], v12 offset:8192
s_add_u32 m0, s32, 20480
v_mfma_f32_32x32x16_bf16 v[240:255], a[180:183], a[164:167], v[240:255]
ds_read_b128 a[204:207], v12 offset:12288
buffer_load_dwordx4 v2, s[12:15], s48 offen lds
v_mfma_f32_32x32x16_bf16 a[0:15], a[180:183], a[168:171], a[0:15]
ds_read_b64_tr_b16 a[212:213], v14 offset:4096
s_add_u32 s25, s38, 34816
v_mfma_f32_32x32x16_bf16 a[16:31], a[180:183], a[172:175], a[16:31]
ds_read_b64_tr_b16 a[214:215], v14 offset:5120
buffer_store_dwordx4 v[80:83], v17, s[8:11], s25 offen offset:0 sc1
v_mfma_f32_32x32x16_bf16 a[32:47], a[184:187], a[160:163], a[32:47]
ds_read_b64_tr_b16 a[216:217], v15 offset:4096
s_add_u32 m0, s32, 24576
v_mfma_f32_32x32x16_bf16 a[48:63], a[184:187], a[164:167], a[48:63]
ds_read_b64_tr_b16 a[218:219], v15 offset:5120
buffer_load_dwordx4 v3, s[12:15], s48 offen lds
v_mfma_f32_32x32x16_bf16 a[64:79], a[184:187], a[168:171], a[64:79]
ds_read_b64_tr_b16 a[220:221], v16 offset:4096
v_mfma_f32_32x32x16_bf16 a[80:95], a[184:187], a[172:175], a[80:95]
ds_read_b64_tr_b16 a[222:223], v16 offset:5120
v_add_u32 v9, 32768, v9
v_subrev_u32 v20, 98304, v9
v_cmp_le_u32 vcc, 163840, v9
v_add_u32 v13, 16384, v13
v_mfma_f32_32x32x16_bf16 a[96:111], a[188:191], a[160:163], a[96:111]
s_add_u32 m0, s32, 28672
v_and_b32 v13, 65535, v13
v_add_u32 v14, 16384, v14
v_and_b32 v14, 65535, v14
v_add_u32 v15, 16384, v15
v_mfma_f32_32x32x16_bf16 a[112:127], a[188:191], a[164:167], a[112:127]
buffer_load_dwordx4 v4, s[12:15], s48 offen lds
v_and_b32 v15, 65535, v15
v_add_u32 v16, 16384, v16
v_and_b32 v16, 65535, v16
v_mfma_f32_32x32x16_bf16 a[128:143], a[188:191], a[168:171], a[128:143]
s_add_u32 s30, s30, 128
s_add_u32 s32, s32, 32768
s_sub_u32 s24, s32, 98304
s_cmp_ge_u32 s32, 163840
s_cselect_b32 s32, s24, s32
s_add_u32 s25, s38, 34816
v_cndmask_b32 v9, v9, v20, vcc
v_xor_b32 v10, 32, v9
v_xor_b32 v11, 64, v9
v_xor_b32 v12, 96, v9
v_mfma_f32_32x32x16_bf16 a[144:159], a[188:191], a[172:175], a[144:159]
buffer_store_dwordx4 v[84:87], v17, s[8:11], s25 offen offset:1024 sc1
s_waitcnt vmcnt(22) lgkmcnt(0)
s_barrier
v_mfma_f32_32x32x16_bf16 v[160:175], a[208:211], a[192:195], v[160:175]
ds_read_b64_tr_b16 a[176:177], v13 offset:0
s_mov_b32 m0, s33
v_mfma_f32_32x32x16_bf16 v[176:191], a[208:211], a[196:199], v[176:191]
ds_read_b64_tr_b16 a[178:179], v13 offset:1024
buffer_load_dwordx4 v5, s[20:23], s31 offen offset:0 lds
v_mfma_f32_32x32x16_bf16 v[192:207], a[208:211], a[200:203], v[192:207]
ds_read_b128 a[160:163], v9 offset:0
v_mfma_f32_32x32x16_bf16 v[208:223], a[208:211], a[204:207], v[208:223]
ds_read_b128 a[164:167], v9 offset:4096
v_mfma_f32_32x32x16_bf16 v[224:239], a[212:215], a[192:195], v[224:239]
ds_read_b128 a[168:171], v9 offset:8192
v_mfma_f32_32x32x16_bf16 v[240:255], a[212:215], a[196:199], v[240:255]
ds_read_b128 a[172:175], v9 offset:12288
buffer_load_dwordx4 v6, s[20:23], s31 offen offset:1024 lds
v_mfma_f32_32x32x16_bf16 a[0:15], a[212:215], a[200:203], a[0:15]
ds_read_b64_tr_b16 a[180:181], v14 offset:0
s_add_u32 s25, s38, 51200
v_mfma_f32_32x32x16_bf16 a[16:31], a[212:215], a[204:207], a[16:31]
ds_read_b64_tr_b16 a[182:183], v14 offset:1024
buffer_store_dwordx4 v[88:91], v17, s[8:11], s25 offen offset:0 sc1
v_mfma_f32_32x32x16_bf16 a[32:47], a[216:219], a[192:195], a[32:47]
ds_read_b64_tr_b16 a[184:185], v15 offset:0
v_mfma_f32_32x32x16_bf16 a[48:63], a[216:219], a[196:199], a[48:63]
ds_read_b64_tr_b16 a[186:187], v15 offset:1024
buffer_load_dwordx4 v7, s[20:23], s31 offen offset:2048 lds
v_mfma_f32_32x32x16_bf16 a[64:79], a[216:219], a[200:203], a[64:79]
ds_read_b64_tr_b16 a[188:189], v16 offset:0
v_mfma_f32_32x32x16_bf16 a[80:95], a[216:219], a[204:207], a[80:95]
ds_read_b64_tr_b16 a[190:191], v16 offset:1024
v_mfma_f32_32x32x16_bf16 a[96:111], a[220:223], a[192:195], a[96:111]
v_mfma_f32_32x32x16_bf16 a[112:127], a[220:223], a[196:199], a[112:127]
buffer_load_dwordx4 v8, s[20:23], s31 offen offset:3072 lds
v_mfma_f32_32x32x16_bf16 a[128:143], a[220:223], a[200:203], a[128:143]
s_add_u32 s31, s31, 262144
s_add_u32 s33, s33, 16384
s_and_b32 s33, s33, 65535
v_mfma_f32_32x32x16_bf16 a[144:159], a[220:223], a[204:207], a[144:159]
s_waitcnt lgkmcnt(0)
v_mfma_f32_32x32x16_bf16 v[160:175], a[176:179], a[160:163], v[160:175]
ds_read_b64_tr_b16 a[208:209], v13 offset:4096
s_add_u32 m0, s32, 0
s_mov_b32 s48, s30
v_mfma_f32_32x32x16_bf16 v[176:191], a[176:179], a[164:167], v[176:191]
ds_read_b64_tr_b16 a[210:211], v13 offset:5120
buffer_load_dwordx4 v1, s[12:15], s48 offen lds
v_mfma_f32_32x32x16_bf16 v[192:207], a[176:179], a[168:171], v[192:207]
ds_read_b128 a[192:195], v10 offset:0
v_mfma_f32_32x32x16_bf16 v[208:223], a[176:179], a[172:175], v[208:223]
ds_read_b128 a[196:199], v10 offset:4096
v_mfma_f32_32x32x16_bf16 v[224:239], a[180:183], a[160:163], v[224:239]
ds_read_b128 a[200:203], v10 offset:8192
s_add_u32 m0, s32, 4096
v_mfma_f32_32x32x16_bf16 v[240:255], a[180:183], a[164:167], v[240:255]
ds_read_b128 a[204:207], v10 offset:12288
buffer_load_dwordx4 v2, s[12:15], s48 offen lds
v_mfma_f32_32x32x16_bf16 a[0:15], a[180:183], a[168:171], a[0:15]
ds_read_b64_tr_b16 a[212:213], v14 offset:4096
s_add_u32 s25, s38, 51200
v_mfma_f32_32x32x16_bf16 a[16:31], a[180:183], a[172:175], a[16:31]
ds_read_b64_tr_b16 a[214:215], v14 offset:5120
buffer_store_dwordx4 v[92:95], v17, s[8:11], s25 offen offset:1024 sc1
v_mfma_f32_32x32x16_bf16 a[32:47], a[184:187], a[160:163], a[32:47]
ds_read_b64_tr_b16 a[216:217], v15 offset:4096
s_add_u32 m0, s32, 8192
v_mfma_f32_32x32x16_bf16 a[48:63], a[184:187], a[164:167], a[48:63]
ds_read_b64_tr_b16 a[218:219], v15 offset:5120
buffer_load_dwordx4 v3, s[12:15], s48 offen lds
v_mfma_f32_32x32x16_bf16 a[64:79], a[184:187], a[168:171], a[64:79]
ds_read_b64_tr_b16 a[220:221], v16 offset:4096
v_mfma_f32_32x32x16_bf16 a[80:95], a[184:187], a[172:175], a[80:95]
ds_read_b64_tr_b16 a[222:223], v16 offset:5120
v_add_u32 v13, 16384, v13
v_and_b32 v13, 65535, v13
v_mfma_f32_32x32x16_bf16 a[96:111], a[188:191], a[160:163], a[96:111]
s_add_u32 m0, s32, 12288
v_add_u32 v14, 16384, v14
v_and_b32 v14, 65535, v14
v_mfma_f32_32x32x16_bf16 a[112:127], a[188:191], a[164:167], a[112:127]
buffer_load_dwordx4 v4, s[12:15], s48 offen lds
v_add_u32 v15, 16384, v15
v_and_b32 v15, 65535, v15
v_mfma_f32_32x32x16_bf16 a[128:143], a[188:191], a[168:171], a[128:143]
v_add_u32 v16, 16384, v16
v_and_b32 v16, 65535, v16
v_mfma_f32_32x32x16_bf16 a[144:159], a[188:191], a[172:175], a[144:159]
s_waitcnt vmcnt(21) lgkmcnt(0)
s_barrier
v_mfma_f32_32x32x16_bf16 v[160:175], a[208:211], a[192:195], v[160:175]
ds_read_b64_tr_b16 a[176:177], v13 offset:0
s_mov_b32 m0, s33
v_mfma_f32_32x32x16_bf16 v[176:191], a[208:211], a[196:199], v[176:191]
ds_read_b64_tr_b16 a[178:179], v13 offset:1024
buffer_load_dwordx4 v5, s[20:23], s31 offen offset:0 lds
v_mfma_f32_32x32x16_bf16 v[192:207], a[208:211], a[200:203], v[192:207]
ds_read_b128 a[160:163], v11 offset:0
v_mfma_f32_32x32x16_bf16 v[208:223], a[208:211], a[204:207], v[208:223]
ds_read_b128 a[164:167], v11 offset:4096
v_mfma_f32_32x32x16_bf16 v[224:239], a[212:215], a[192:195], v[224:239]
ds_read_b128 a[168:171], v11 offset:8192
v_mfma_f32_32x32x16_bf16 v[240:255], a[212:215], a[196:199], v[240:255]
ds_read_b128 a[172:175], v11 offset:12288
buffer_load_dwordx4 v6, s[20:23], s31 offen offset:1024 lds
v_mfma_f32_32x32x16_bf16 a[0:15], a[212:215], a[200:203], a[0:15]
ds_read_b64_tr_b16 a[180:181], v14 offset:0
s_add_u32 s25, s38, 4096
v_mfma_f32_32x32x16_bf16 a[16:31], a[212:215], a[204:207], a[16:31]
ds_read_b64_tr_b16 a[182:183], v14 offset:1024
buffer_store_dwordx4 v[96:99], v17, s[8:11], s25 offen offset:0 sc1
v_mfma_f32_32x32x16_bf16 a[32:47], a[216:219], a[192:195], a[32:47]
ds_read_b64_tr_b16 a[184:185], v15 offset:0
v_mfma_f32_32x32x16_bf16 a[48:63], a[216:219], a[196:199], a[48:63]
ds_read_b64_tr_b16 a[186:187], v15 offset:1024
buffer_load_dwordx4 v7, s[20:23], s31 offen offset:2048 lds
v_mfma_f32_32x32x16_bf16 a[64:79], a[216:219], a[200:203], a[64:79]
ds_read_b64_tr_b16 a[188:189], v16 offset:0
v_mfma_f32_32x32x16_bf16 a[80:95], a[216:219], a[204:207], a[80:95]
ds_read_b64_tr_b16 a[190:191], v16 offset:1024
v_mfma_f32_32x32x16_bf16 a[96:111], a[220:223], a[192:195], a[96:111]
v_mfma_f32_32x32x16_bf16 a[112:127], a[220:223], a[196:199], a[112:127]
buffer_load_dwordx4 v8, s[20:23], s31 offen offset:3072 lds
v_mfma_f32_32x32x16_bf16 a[128:143], a[220:223], a[200:203], a[128:143]
s_add_u32 s31, s31, 262144
s_add_u32 s33, s33, 16384
s_and_b32 s33, s33, 65535
s_add_u32 s25, s38, 4096
v_mfma_f32_32x32x16_bf16 a[144:159], a[220:223], a[204:207], a[144:159]
buffer_store_dwordx4 v[100:103], v17, s[8:11], s25 offen offset:1024 sc1
s_waitcnt lgkmcnt(0)
v_mfma_f32_32x32x16_bf16 v[160:175], a[176:179], a[160:163], v[160:175]
ds_read_b64_tr_b16 a[208:209], v13 offset:4096
s_add_u32 m0, s32, 16384
s_add_u32 s48, s30, s34
v_mfma_f32_32x32x16_bf16 v[176:191], a[176:179], a[164:167], v[176:191]
ds_read_b64_tr_b16 a[210:211], v13 offset:5120
buffer_load_dwordx4 v1, s[12:15], s48 offen lds
v_mfma_f32_32x32x16_bf16 v[192:207], a[176:179], a[168:171], v[192:207]
ds_read_b128 a[192:195], v12 offset:0
v_mfma_f32_32x32x16_bf16 v[208:223], a[176:179], a[172:175], v[208:223]
ds_read_b128 a[196:199], v12 offset:4096
v_mfma_f32_32x32x16_bf16 v[224:239], a[180:183], a[160:163], v[224:239]
ds_read_b128 a[200:203], v12 offset:8192
s_add_u32 m0, s32, 20480
v_mfma_f32_32x32x16_bf16 v[240:255], a[180:183], a[164:167], v[240:255]
ds_read_b128 a[204:207], v12 offset:12288
buffer_load_dwordx4 v2, s[12:15], s48 offen lds
v_mfma_f32_32x32x16_bf16 a[0:15], a[180:183], a[168:171], a[0:15]
ds_read_b64_tr_b16 a[212:213], v14 offset:4096
s_add_u32 s25, s38, 20480
v_mfma_f32_32x32x16_bf16 a[16:31], a[180:183], a[172:175], a[16:31]
ds_read_b64_tr_b16 a[214:215], v14 offset:5120
buffer_store_dwordx4 v[104:107], v17, s[8:11], s25 offen offset:0 sc1
v_mfma_f32_32x32x16_bf16 a[32:47], a[184:187], a[160:163], a[32:47]
ds_read_b64_tr_b16 a[216:217], v15 offset:4096
s_add_u32 m0, s32, 24576
v_mfma_f32_32x32x16_bf16 a[48:63], a[184:187], a[164:167], a[48:63]
ds_read_b64_tr_b16 a[218:219], v15 offset:5120
buffer_load_dwordx4 v3, s[12:15], s48 offen lds
v_mfma_f32_32x32x16_bf16 a[64:79], a[184:187], a[168:171], a[64:79]
ds_read_b64_tr_b16 a[220:221], v16 offset:4096
v_mfma_f32_32x32x16_bf16 a[80:95], a[184:187], a[172:175], a[80:95]
ds_read_b64_tr_b16 a[222:223], v16 offset:5120
v_add_u32 v9, 32768, v9
v_subrev_u32 v20, 98304, v9
v_cmp_le_u32 vcc, 163840, v9
v_add_u32 v13, 16384, v13
v_mfma_f32_32x32x16_bf16 a[96:111], a[188:191], a[160:163], a[96:111]
s_add_u32 m0, s32, 28672
v_and_b32 v13, 65535, v13
v_add_u32 v14, 16384, v14
v_and_b32 v14, 65535, v14
v_add_u32 v15, 16384, v15
v_mfma_f32_32x32x16_bf16 a[112:127], a[188:191], a[164:167], a[112:127]
buffer_load_dwordx4 v4, s[12:15], s48 offen lds
v_and_b32 v15, 65535, v15
v_add_u32 v16, 16384, v16
v_and_b32 v16, 65535, v16
v_mfma_f32_32x32x16_bf16 a[128:143], a[188:191], a[168:171], a[128:143]
s_add_u32 s30, s30, 128
s_add_u32 s32, s32, 32768
s_sub_u32 s24, s32, 98304
s_cmp_ge_u32 s32, 163840
s_cselect_b32 s32, s24, s32
v_cndmask_b32 v9, v9, v20, vcc
v_xor_b32 v10, 32, v9
v_xor_b32 v11, 64, v9
v_xor_b32 v12, 96, v9
v_mfma_f32_32x32x16_bf16 a[144:159], a[188:191], a[172:175], a[144:159]
s_waitcnt vmcnt(21) lgkmcnt(0)
s_barrier
v_mfma_f32_32x32x16_bf16 v[160:175], a[208:211], a[192:195], v[160:175]
ds_read_b64_tr_b16 a[176:177], v13 offset:0
s_mov_b32 m0, s33
v_mfma_f32_32x32x16_bf16 v[176:191], a[208:211], a[196:199], v[176:191]
ds_read_b64_tr_b16 a[178:179], v13 offset:1024
buffer_load_dwordx4 v5, s[20:23], s31 offen offset:0 lds
v_mfma_f32_32x32x16_bf16 v[192:207], a[208:211], a[200:203], v[192:207]
ds_read_b128 a[160:163], v9 offset:0
v_mfma_f32_32x32x16_bf16 v[208:223], a[208:211], a[204:207], v[208:223]
ds_read_b128 a[164:167], v9 offset:4096
v_mfma_f32_32x32x16_bf16 v[224:239], a[212:215], a[192:195], v[224:239]
ds_read_b128 a[168:171], v9 offset:8192
v_mfma_f32_32x32x16_bf16 v[240:255], a[212:215], a[196:199], v[240:255]
ds_read_b128 a[172:175], v9 offset:12288
buffer_load_dwordx4 v6, s[20:23], s31 offen offset:1024 lds
v_mfma_f32_32x32x16_bf16 a[0:15], a[212:215], a[200:203], a[0:15]
ds_read_b64_tr_b16 a[180:181], v14 offset:0
s_add_u32 s25, s38, 20480
v_mfma_f32_32x32x16_bf16 a[16:31], a[212:215], a[204:207], a[16:31]
ds_read_b64_tr_b16 a[182:183], v14 offset:1024
buffer_store_dwordx4 v[108:111], v17, s[8:11], s25 offen offset:1024 sc1
v_mfma_f32_32x32x16_bf16 a[32:47], a[216:219], a[192:195], a[32:47]
ds_read_b64_tr_b16 a[184:185], v15 offset:0
v_mfma_f32_32x32x16_bf16 a[48:63], a[216:219], a[196:199], a[48:63]
ds_read_b64_tr_b16 a[186:187], v15 offset:1024
buffer_load_dwordx4 v7, s[20:23], s31 offen offset:2048 lds
v_mfma_f32_32x32x16_bf16 a[64:79], a[216:219], a[200:203], a[64:79]
ds_read_b64_tr_b16 a[188:189], v16 offset:0
v_mfma_f32_32x32x16_bf16 a[80:95], a[216:219], a[204:207], a[80:95]
ds_read_b64_tr_b16 a[190:191], v16 offset:1024
v_mfma_f32_32x32x16_bf16 a[96:111], a[220:223], a[192:195], a[96:111]
v_mfma_f32_32x32x16_bf16 a[112:127], a[220:223], a[196:199], a[112:127]
buffer_load_dwordx4 v8, s[20:23], s31 offen offset:3072 lds
v_mfma_f32_32x32x16_bf16 a[128:143], a[220:223], a[200:203], a[128:143]
s_add_u32 s31, s31, 262144
s_add_u32 s33, s33, 16384
s_and_b32 s33, s33, 65535
v_mfma_f32_32x32x16_bf16 a[144:159], a[220:223], a[204:207], a[144:159]
s_waitcnt lgkmcnt(0)
v_mfma_f32_32x32x16_bf16 v[160:175], a[176:179], a[160:163], v[160:175]
ds_read_b64_tr_b16 a[208:209], v13 offset:4096
s_add_u32 m0, s32, 0
s_mov_b32 s48, s30
v_mfma_f32_32x32x16_bf16 v[176:191], a[176:179], a[164:167], v[176:191]
ds_read_b64_tr_b16 a[210:211], v13 offset:5120
buffer_load_dwordx4 v1, s[12:15], s48 offen lds
v_mfma_f32_32x32x16_bf16 v[192:207], a[176:179], a[168:171], v[192:207]
ds_read_b128 a[192:195], v10 offset:0
v_mfma_f32_32x32x16_bf16 v[208:223], a[176:179], a[172:175], v[208:223]
ds_read_b128 a[196:199], v10 offset:4096
v_mfma_f32_32x32x16_bf16 v[224:239], a[180:183], a[160:163], v[224:239]
ds_read_b128 a[200:203], v10 offset:8192
s_add_u32 m0, s32, 4096
v_mfma_f32_32x32x16_bf16 v[240:255], a[180:183], a[164:167], v[240:255]
ds_read_b128 a[204:207], v10 offset:12288
buffer_load_dwordx4 v2, s[12:15], s48 offen lds
v_mfma_f32_32x32x16_bf16 a[0:15], a[180:183], a[168:171], a[0:15]
ds_read_b64_tr_b16 a[212:213], v14 offset:4096
s_add_u32 s25, s38, 36864
v_mfma_f32_32x32x16_bf16 a[16:31], a[180:183], a[172:175], a[16:31]
ds_read_b64_tr_b16 a[214:215], v14 offset:5120
buffer_store_dwordx4 v[112:115], v17, s[8:11], s25 offen offset:0 sc1
v_mfma_f32_32x32x16_bf16 a[32:47], a[184:187], a[160:163], a[32:47]
ds_read_b64_tr_b16 a[216:217], v15 offset:4096
s_add_u32 m0, s32, 8192
v_mfma_f32_32x32x16_bf16 a[48:63], a[184:187], a[164:167], a[48:63]
ds_read_b64_tr_b16 a[218:219], v15 offset:5120
buffer_load_dwordx4 v3, s[12:15], s48 offen lds
v_mfma_f32_32x32x16_bf16 a[64:79], a[184:187], a[168:171], a[64:79]
ds_read_b64_tr_b16 a[220:221], v16 offset:4096
v_mfma_f32_32x32x16_bf16 a[80:95], a[184:187], a[172:175], a[80:95]
ds_read_b64_tr_b16 a[222:223], v16 offset:5120
v_add_u32 v13, 16384, v13
v_and_b32 v13, 65535, v13
v_mfma_f32_32x32x16_bf16 a[96:111], a[188:191], a[160:163], a[96:111]
s_add_u32 m0, s32, 12288
v_add_u32 v14, 16384, v14
v_and_b32 v14, 65535, v14
v_mfma_f32_32x32x16_bf16 a[112:127], a[188:191], a[164:167], a[112:127]
buffer_load_dwordx4 v4, s[12:15], s48 offen lds
v_add_u32 v15, 16384, v15
v_and_b32 v15, 65535, v15
v_mfma_f32_32x32x16_bf16 a[128:143], a[188:191], a[168:171], a[128:143]
s_add_u32 s25, s38, 36864
v_add_u32 v16, 16384, v16
v_and_b32 v16, 65535, v16
v_mfma_f32_32x32x16_bf16 a[144:159], a[188:191], a[172:175], a[144:159]
buffer_store_dwordx4 v[116:119], v17, s[8:11], s25 offen offset:1024 sc1
s_waitcnt vmcnt(22) lgkmcnt(0)
s_barrier
v_mfma_f32_32x32x16_bf16 v[160:175], a[208:211], a[192:195], v[160:175]
ds_read_b64_tr_b16 a[176:177], v13 offset:0
s_mov_b32 m0, s33
v_mfma_f32_32x32x16_bf16 v[176:191], a[208:211], a[196:199], v[176:191]
ds_read_b64_tr_b16 a[178:179], v13 offset:1024
buffer_load_dwordx4 v5, s[20:23], s31 offen offset:0 lds
v_mfma_f32_32x32x16_bf16 v[192:207], a[208:211], a[200:203], v[192:207]
ds_read_b128 a[160:163], v11 offset:0
v_mfma_f32_32x32x16_bf16 v[208:223], a[208:211], a[204:207], v[208:223]
ds_read_b128 a[164:167], v11 offset:4096
v_mfma_f32_32x32x16_bf16 v[224:239], a[212:215], a[192:195], v[224:239]
ds_read_b128 a[168:171], v11 offset:8192
v_mfma_f32_32x32x16_bf16 v[240:255], a[212:215], a[196:199], v[240:255]
ds_read_b128 a[172:175], v11 offset:12288
buffer_load_dwordx4 v6, s[20:23], s31 offen offset:1024 lds
v_mfma_f32_32x32x16_bf16 a[0:15], a[212:215], a[200:203], a[0:15]
ds_read_b64_tr_b16 a[180:181], v14 offset:0
s_add_u32 s25, s38, 53248
v_mfma_f32_32x32x16_bf16 a[16:31], a[212:215], a[204:207], a[16:31]
ds_read_b64_tr_b16 a[182:183], v14 offset:1024
buffer_store_dwordx4 v[120:123], v17, s[8:11], s25 offen offset:0 sc1
v_mfma_f32_32x32x16_bf16 a[32:47], a[216:219], a[192:195], a[32:47]
ds_read_b64_tr_b16 a[184:185], v15 offset:0
v_mfma_f32_32x32x16_bf16 a[48:63], a[216:219], a[196:199], a[48:63]
ds_read_b64_tr_b16 a[186:187], v15 offset:1024
buffer_load_dwordx4 v7, s[20:23], s31 offen offset:2048 lds
v_mfma_f32_32x32x16_bf16 a[64:79], a[216:219], a[200:203], a[64:79]
ds_read_b64_tr_b16 a[188:189], v16 offset:0
v_mfma_f32_32x32x16_bf16 a[80:95], a[216:219], a[204:207], a[80:95]
ds_read_b64_tr_b16 a[190:191], v16 offset:1024
v_mfma_f32_32x32x16_bf16 a[96:111], a[220:223], a[192:195], a[96:111]
v_mfma_f32_32x32x16_bf16 a[112:127], a[220:223], a[196:199], a[112:127]
buffer_load_dwordx4 v8, s[20:23], s31 offen offset:3072 lds
v_mfma_f32_32x32x16_bf16 a[128:143], a[220:223], a[200:203], a[128:143]
s_add_u32 s31, s31, 262144
s_add_u32 s33, s33, 16384
s_and_b32 s33, s33, 65535
v_mfma_f32_32x32x16_bf16 a[144:159], a[220:223], a[204:207], a[144:159]
s_waitcnt lgkmcnt(0)
v_mfma_f32_32x32x16_bf16 v[160:175], a[176:179], a[160:163], v[160:175]
ds_read_b64_tr_b16 a[208:209], v13 offset:4096
s_add_u32 m0, s32, 16384
s_add_u32 s48, s30, s34
v_mfma_f32_32x32x16_bf16 v[176:191], a[176:179], a[164:167], v[176:191]
ds_read_b64_tr_b16 a[210:211], v13 offset:5120
buffer_load_dwordx4 v1, s[12:15], s48 offen lds
v_mfma_f32_32x32x16_bf16 v[192:207], a[176:179], a[168:171], v[192:207]
ds_read_b128 a[192:195], v12 offset:0
v_mfma_f32_32x32x16_bf16 v[208:223], a[176:179], a[172:175], v[208:223]
ds_read_b128 a[196:199], v12 offset:4096
v_mfma_f32_32x32x16_bf16 v[224:239], a[180:183], a[160:163], v[224:239]
ds_read_b128 a[200:203], v12 offset:8192
s_add_u32 m0, s32, 20480
v_mfma_f32_32x32x16_bf16 v[240:255], a[180:183], a[164:167], v[240:255]
ds_read_b128 a[204:207], v12 offset:12288
buffer_load_dwordx4 v2, s[12:15], s48 offen lds
v_mfma_f32_32x32x16_bf16 a[0:15], a[180:183], a[168:171], a[0:15]
ds_read_b64_tr_b16 a[212:213], v14 offset:4096
s_add_u32 s25, s38, 53248
v_mfma_f32_32x32x16_bf16 a[16:31], a[180:183], a[172:175], a[16:31]
ds_read_b64_tr_b16 a[214:215], v14 offset:5120
buffer_store_dwordx4 v[124:127], v17, s[8:11], s25 offen offset:1024 sc1
v_mfma_f32_32x32x16_bf16 a[32:47], a[184:187], a[160:163], a[32:47]
ds_read_b64_tr_b16 a[216:217], v15 offset:4096
s_add_u32 m0, s32, 24576
v_mfma_f32_32x32x16_bf16 a[48:63], a[184:187], a[164:167], a[48:63]
ds_read_b64_tr_b16 a[218:219], v15 offset:5120
buffer_load_dwordx4 v3, s[12:15], s48 offen lds
v_mfma_f32_32x32x16_bf16 a[64:79], a[184:187], a[168:171], a[64:79]
ds_read_b64_tr_b16 a[220:221], v16 offset:4096
v_mfma_f32_32x32x16_bf16 a[80:95], a[184:187], a[172:175], a[80:95]
ds_read_b64_tr_b16 a[222:223], v16 offset:5120
v_add_u32 v9, 32768, v9
v_subrev_u32 v20, 98304, v9
v_cmp_le_u32 vcc, 163840, v9
v_add_u32 v13, 16384, v13
v_mfma_f32_32x32x16_bf16 a[96:111], a[188:191], a[160:163], a[96:111]
s_add_u32 m0, s32, 28672
v_and_b32 v13, 65535, v13
v_add_u32 v14, 16384, v14
v_and_b32 v14, 65535, v14
v_add_u32 v15, 16384, v15
v_mfma_f32_32x32x16_bf16 a[112:127], a[188:191], a[164:167], a[112:127]
buffer_load_dwordx4 v4, s[12:15], s48 offen lds
v_and_b32 v15, 65535, v15
v_add_u32 v16, 16384, v16
v_and_b32 v16, 65535, v16
v_mfma_f32_32x32x16_bf16 a[128:143], a[188:191], a[168:171], a[128:143]
s_add_u32 s30, s30, 128
s_add_u32 s32, s32, 32768
s_sub_u32 s24, s32, 98304
s_cmp_ge_u32 s32, 163840
s_cselect_b32 s32, s24, s32
v_cndmask_b32 v9, v9, v20, vcc
v_xor_b32 v10, 32, v9
v_xor_b32 v11, 64, v9
v_xor_b32 v12, 96, v9
v_mfma_f32_32x32x16_bf16 a[144:159], a[188:191], a[172:175], a[144:159]
s_waitcnt vmcnt(21) lgkmcnt(0)
s_barrier
v_mfma_f32_32x32x16_bf16 v[160:175], a[208:211], a[192:195], v[160:175]
ds_read_b64_tr_b16 a[176:177], v13 offset:0
s_mov_b32 m0, s33
v_mfma_f32_32x32x16_bf16 v[176:191], a[208:211], a[196:199], v[176:191]
ds_read_b64_tr_b16 a[178:179], v13 offset:1024
buffer_load_dwordx4 v5, s[20:23], s31 offen offset:0 lds
v_mfma_f32_32x32x16_bf16 v[192:207], a[208:211], a[200:203], v[192:207]
ds_read_b128 a[160:163], v9 offset:0
v_mfma_f32_32x32x16_bf16 v[208:223], a[208:211], a[204:207], v[208:223]
ds_read_b128 a[164:167], v9 offset:4096
v_mfma_f32_32x32x16_bf16 v[224:239], a[212:215], a[192:195], v[224:239]
ds_read_b128 a[168:171], v9 offset:8192
v_mfma_f32_32x32x16_bf16 v[240:255], a[212:215], a[196:199], v[240:255]
ds_read_b128 a[172:175], v9 offset:12288
buffer_load_dwordx4 v6, s[20:23], s31 offen offset:1024 lds
v_mfma_f32_32x32x16_bf16 a[0:15], a[212:215], a[200:203], a[0:15]
ds_read_b64_tr_b16 a[180:181], v14 offset:0
s_add_u32 s25, s38, 6144
v_mfma_f32_32x32x16_bf16 a[16:31], a[212:215], a[204:207], a[16:31]
ds_read_b64_tr_b16 a[182:183], v14 offset:1024
buffer_store_dwordx4 v[128:131], v17, s[8:11], s25 offen offset:0 sc1
v_mfma_f32_32x32x16_bf16 a[32:47], a[216:219], a[192:195], a[32:47]
ds_read_b64_tr_b16 a[184:185], v15 offset:0
v_mfma_f32_32x32x16_bf16 a[48:63], a[216:219], a[196:199], a[48:63]
ds_read_b64_tr_b16 a[186:187], v15 offset:1024
buffer_load_dwordx4 v7, s[20:23], s31 offen offset:2048 lds
v_mfma_f32_32x32x16_bf16 a[64:79], a[216:219], a[200:203], a[64:79]
ds_read_b64_tr_b16 a[188:189], v16 offset:0
v_mfma_f32_32x32x16_bf16 a[80:95], a[216:219], a[204:207], a[80:95]
ds_read_b64_tr_b16 a[190:191], v16 offset:1024
v_mfma_f32_32x32x16_bf16 a[96:111], a[220:223], a[192:195], a[96:111]
v_mfma_f32_32x32x16_bf16 a[112:127], a[220:223], a[196:199], a[112:127]
buffer_load_dwordx4 v8, s[20:23], s31 offen offset:3072 lds
v_mfma_f32_32x32x16_bf16 a[128:143], a[220:223], a[200:203], a[128:143]
s_add_u32 s31, s31, 262144
s_add_u32 s33, s33, 16384
s_and_b32 s33, s33, 65535
s_add_u32 s25, s38, 6144
v_mfma_f32_32x32x16_bf16 a[144:159], a[220:223], a[204:207], a[144:159]
buffer_store_dwordx4 v[132:135], v17, s[8:11], s25 offen offset:1024 sc1
s_cmp_eq_u32 s36, 0
s_cbranch_scc1 L_g_k6
s_waitcnt lgkmcnt(0)
v_mfma_f32_32x32x16_bf16 v[160:175], a[176:179], a[160:163], v[160:175]
ds_read_b64_tr_b16 a[208:209], v13 offset:4096
s_add_u32 m0, s32, 0
s_mov_b32 s48, s30
v_mfma_f32_32x32x16_bf16 v[176:191], a[176:179], a[164:167], v[176:191]
ds_read_b64_tr_b16 a[210:211], v13 offset:5120
buffer_load_dwordx4 v1, s[12:15], s48 offen lds
v_mfma_f32_32x32x16_bf16 v[192:207], a[176:179], a[168:171], v[192:207]
ds_read_b128 a[192:195], v10 offset:0
v_mfma_f32_32x32x16_bf16 v[208:223], a[176:179], a[172:175], v[208:223]
ds_read_b128 a[196:199], v10 offset:4096
v_mfma_f32_32x32x16_bf16 v[224:239], a[180:183], a[160:163], v[224:239]
ds_read_b128 a[200:203], v10 offset:8192
s_add_u32 m0, s32, 4096
v_mfma_f32_32x32x16_bf16 v[240:255], a[180:183], a[164:167], v[240:255]
ds_read_b128 a[204:207], v10 offset:12288
buffer_load_dwordx4 v2, s[12:15], s48 offen lds
v_mfma_f32_32x32x16_bf16 a[0:15], a[180:183], a[168:171], a[0:15]
ds_read_b64_tr_b16 a[212:213], v14 offset:4096
v_mfma_f32_32x32x16_bf16 a[16:31], a[180:183], a[172:175], a[16:31]
ds_read_b64_tr_b16 a[214:215], v14 offset:5120
v_mfma_f32_32x32x16_bf16 a[32:47], a[184:187], a[160:163], a[32:47]
ds_read_b64_tr_b16 a[216:217], v15 offset:4096
s_add_u32 m0, s32, 8192
v_mfma_f32_32x32x16_bf16 a[48:63], a[184:187], a[164:167], a[48:63]
ds_read_b64_tr_b16 a[218:219], v15 offset:5120
buffer_load_dwordx4 v3, s[12:15], s48 offen lds
v_mfma_f32_32x32x16_bf16 a[64:79], a[184:187], a[168:171], a[64:79]
ds_read_b64_tr_b16 a[220:221], v16 offset:4096
v_mfma_f32_32x32x16_bf16 a[80:95], a[184:187], a[172:175], a[80:95]
ds_read_b64_tr_b16 a[222:223], v16 offset:5120
v_add_u32 v13, 16384, v13
v_and_b32 v13, 65535, v13
v_mfma_f32_32x32x16_bf16 a[96:111], a[188:191], a[160:163], a[96:111]
s_add_u32 m0, s32, 12288
v_add_u32 v14, 16384, v14
v_and_b32 v14, 65535, v14
v_mfma_f32_32x32x16_bf16 a[112:127], a[188:191], a[164:167], a[112:127]
buffer_load_dwordx4 v4, s[12:15], s48 offen lds
v_add_u32 v15, 16384, v15
v_and_b32 v15, 65535, v15
v_mfma_f32_32x32x16_bf16 a[128:143], a[188:191], a[168:171], a[128:143]
v_add_u32 v16, 16384, v16
v_and_b32 v16, 65535, v16
v_mfma_f32_32x32x16_bf16 a[144:159], a[188:191], a[172:175], a[144:159]
s_waitcnt vmcnt(20) lgkmcnt(0)
s_barrier
v_mfma_f32_32x32x16_bf16 v[160:175], a[208:211], a[192:195], v[160:175]
ds_read_b64_tr_b16 a[176:177], v13 offset:0
s_mov_b32 m0, s33
v_mfma_f32_32x32x16_bf16 v[176:191], a[208:211], a[196:199], v[176:191]
ds_read_b64_tr_b16 a[178:179], v13 offset:1024
buffer_load_dwordx4 v5, s[20:23], s31 offen offset:0 lds
v_mfma_f32_32x32x16_bf16 v[192:207], a[208:211], a[200:203], v[192:207]
ds_read_b128 a[160:163], v11 offset:0
v_mfma_f32_32x32x16_bf16 v[208:223], a[208:211], a[204:207], v[208:223]
ds_read_b128 a[164:167], v11 offset:4096
v_mfma_f32_32x32x16_bf16 v[224:239], a[212:215], a[192:195], v[224:239]
ds_read_b128 a[168:171], v11 offset:8192
v_mfma_f32_32x32x16_bf16 v[240:255], a[212:215], a[196:199], v[240:255]
ds_read_b128 a[172:175], v11 offset:12288
buffer_load_dwordx4 v6, s[20:23], s31 offen offset:1024 lds
v_mfma_f32_32x32x16_bf16 a[0:15], a[212:215], a[200:203], a[0:15]
ds_read_b64_tr_b16 a[180:181], v14 offset:0
v_mfma_f32_32x32x16_bf16 a[16:31], a[212:215], a[204:207], a[16:31]
ds_read_b64_tr_b16 a[182:183], v14 offset:1024
v_mfma_f32_32x32x16_bf16 a[32:47], a[216:219], a[192:195], a[32:47]
ds_read_b64_tr_b16 a[184:185], v15 offset:0
v_mfma_f32_32x32x16_bf16 a[48:63], a[216:219], a[196:199], a[48:63]
ds_read_b64_tr_b16 a[186:187], v15 offset:1024
buffer_load_dwordx4 v7, s[20:23], s31 offen offset:2048 lds
v_mfma_f32_32x32x16_bf16 a[64:79], a[216:219], a[200:203], a[64:79]
ds_read_b64_tr_b16 a[188:189], v16 offset:0
v_mfma_f32_32x32x16_bf16 a[80:95], a[216:219], a[204:207], a[80:95]
ds_read_b64_tr_b16 a[190:191], v16 offset:1024
v_mfma_f32_32x32x16_bf16 a[96:111], a[220:223], a[192:195], a[96:111]
v_mfma_f32_32x32x16_bf16 a[112:127], a[220:223], a[196:199], a[112:127]
buffer_load_dwordx4 v8, s[20:23], s31 offen offset:3072 lds
v_mfma_f32_32x32x16_bf16 a[128:143], a[220:223], a[200:203], a[128:143]
s_add_u32 s31, s31, 262144
s_add_u32 s33, s33, 16384
s_and_b32 s33, s33, 65535
v_mfma_f32_32x32x16_bf16 a[144:159], a[220:223], a[204:207], a[144:159]
s_waitcnt lgkmcnt(0)
v_mfma_f32_32x32x16_bf16 v[160:175], a[176:179], a[160:163], v[160:175]
ds_read_b64_tr_b16 a[208:209], v13 offset:4096
s_add_u32 m0, s32, 16384
s_add_u32 s48, s30, s34
v_mfma_f32_32x32x16_bf16 v[176:191], a[176:179], a[164:167], v[176:191]
ds_read_b64_tr_b16 a[210:211], v13 offset:5120
buffer_load_dwordx4 v1, s[12:15], s48 offen lds
v_mfma_f32_32x32x16_bf16 v[192:207], a[176:179], a[168:171], v[192:207]
ds_read_b128 a[192:195], v12 offset:0
v_mfma_f32_32x32x16_bf16 v[208:223], a[176:179], a[172:175], v[208:223]
ds_read_b128 a[196:199], v12 offset:4096
v_mfma_f32_32x32x16_bf16 v[224:239], a[180:183], a[160:163], v[224:239]
ds_read_b128 a[200:203], v12 offset:8192
s_add_u32 m0, s32, 20480
v_mfma_f32_32x32x16_bf16 v[240:255], a[180:183], a[164:167], v[240:255]
ds_read_b128 a[204:207], v12 offset:12288
buffer_load_dwordx4 v2, s[12:15], s48 offen lds
v_mfma_f32_32x32x16_bf16 a[0:15], a[180:183], a[168:171], a[0:15]
ds_read_b64_tr_b16 a[212:213], v14 offset:4096
v_mfma_f32_32x32x16_bf16 a[16:31], a[180:183], a[172:175], a[16:31]
ds_read_b64_tr_b16 a[214:215], v14 offset:5120
v_mfma_f32_32x32x16_bf16 a[32:47], a[184:187], a[160:163], a[32:47]
ds_read_b64_tr_b16 a[216:217], v15 offset:4096
s_add_u32 m0, s32, 24576
v_mfma_f32_32x32x16_bf16 a[48:63], a[184:187], a[164:167], a[48:63]
ds_read_b64_tr_b16 a[218:219], v15 offset:5120
buffer_load_dwordx4 v3, s[12:15], s48 offen lds
v_mfma_f32_32x32x16_bf16 a[64:79], a[184:187], a[168:171], a[64:79]
ds_read_b64_tr_b16 a[220:221], v16 offset:4096
v_mfma_f32_32x32x16_bf16 a[80:95], a[184:187], a[172:175], a[80:95]
ds_read_b64_tr_b16 a[222:223], v16 offset:5120
v_add_u32 v9, 32768, v9
v_subrev_u32 v20, 98304, v9
v_cmp_le_u32 vcc, 163840, v9
v_add_u32 v13, 16384, v13
v_mfma_f32_32x32x16_bf16 a[96:111], a[188:191], a[160:163], a[96:111]
s_add_u32 m0, s32, 28672
v_and_b32 v13, 65535, v13
v_add_u32 v14, 16384, v14
v_and_b32 v14, 65535, v14
v_add_u32 v15, 16384, v15
v_mfma_f32_32x32x16_bf16 a[112:127], a[188:191], a[164:167], a[112:127]
buffer_load_dwordx4 v4, s[12:15], s48 offen lds
v_and_b32 v15, 65535, v15
v_add_u32 v16, 16384, v16
v_and_b32 v16, 65535, v16
v_mfma_f32_32x32x16_bf16 a[128:143], a[188:191], a[168:171], a[128:143]
s_add_u32 s30, s30, 128
s_add_u32 s32, s32, 32768
s_sub_u32 s24, s32, 98304
s_cmp_ge_u32 s32, 163840
s_cselect_b32 s32, s24, s32
v_cndmask_b32 v9, v9, v20, vcc
v_xor_b32 v10, 32, v9
v_xor_b32 v11, 64, v9
v_xor_b32 v12, 96, v9
v_mfma_f32_32x32x16_bf16 a[144:159], a[188:191], a[172:175], a[144:159]
s_waitcnt vmcnt(18) lgkmcnt(0)
s_barrier
v_mfma_f32_32x32x16_bf16 v[160:175], a[208:211], a[192:195], v[160:175]
ds_read_b64_tr_b16 a[176:177], v13 offset:0
s_mov_b32 m0, s33
v_mfma_f32_32x32x16_bf16 v[176:191], a[208:211], a[196:199], v[176:191]
ds_read_b64_tr_b16 a[178:179], v13 offset:1024
buffer_load_dwordx4 v5, s[20:23], s31 offen offset:0 lds
v_mfma_f32_32x32x16_bf16 v[192:207], a[208:211], a[200:203], v[192:207]
ds_read_b128 a[160:163], v9 offset:0
v_mfma_f32_32x32x16_bf16 v[208:223], a[208:211], a[204:207], v[208:223]
ds_read_b128 a[164:167], v9 offset:4096
v_mfma_f32_32x32x16_bf16 v[224:239], a[212:215], a[192:195], v[224:239]
ds_read_b128 a[168:171], v9 offset:8192
v_mfma_f32_32x32x16_bf16 v[240:255], a[212:215], a[196:199], v[240:255]
ds_read_b128 a[172:175], v9 offset:12288
buffer_load_dwordx4 v6, s[20:23], s31 offen offset:1024 lds
v_mfma_f32_32x32x16_bf16 a[0:15], a[212:215], a[200:203], a[0:15]
ds_read_b64_tr_b16 a[180:181], v14 offset:0
v_mfma_f32_32x32x16_bf16 a[16:31], a[212:215], a[204:207], a[16:31]
ds_read_b64_tr_b16 a[182:183], v14 offset:1024
v_mfma_f32_32x32x16_bf16 a[32:47], a[216:219], a[192:195], a[32:47]
ds_read_b64_tr_b16 a[184:185], v15 offset:0
v_mfma_f32_32x32x16_bf16 a[48:63], a[216:219], a[196:199], a[48:63]
ds_read_b64_tr_b16 a[186:187], v15 offset:1024
buffer_load_dwordx4 v7, s[20:23], s31 offen offset:2048 lds
v_mfma_f32_32x32x16_bf16 a[64:79], a[216:219], a[200:203], a[64:79]
ds_read_b64_tr_b16 a[188:189], v16 offset:0
v_mfma_f32_32x32x16_bf16 a[80:95], a[216:219], a[204:207], a[80:95]
ds_read_b64_tr_b16 a[190:191], v16 offset:1024
v_mfma_f32_32x32x16_bf16 a[96:111], a[220:223], a[192:195], a[96:111]
v_mfma_f32_32x32x16_bf16 a[112:127], a[220:223], a[196:199], a[112:127]
buffer_load_dwordx4 v8, s[20:23], s31 offen offset:3072 lds
v_mfma_f32_32x32x16_bf16 a[128:143], a[220:223], a[200:203], a[128:143]
s_add_u32 s31, s31, 262144
s_add_u32 s33, s33, 16384
s_and_b32 s33, s33, 65535
v_mfma_f32_32x32x16_bf16 a[144:159], a[220:223], a[204:207], a[144:159]
L_g_k6:
s_waitcnt lgkmcnt(0)
v_mfma_f32_32x32x16_bf16 v[160:175], a[176:179], a[160:163], v[160:175]
ds_read_b64_tr_b16 a[208:209], v13 offset:4096
s_add_u32 m0, s32, 0
s_mov_b32 s48, s30
v_mfma_f32_32x32x16_bf16 v[176:191], a[176:179], a[164:167], v[176:191]
ds_read_b64_tr_b16 a[210:211], v13 offset:5120
buffer_load_dwordx4 v1, s[12:15], s48 offen lds
v_mfma_f32_32x32x16_bf16 v[192:207], a[176:179], a[168:171], v[192:207]
ds_read_b128 a[192:195], v10 offset:0
v_mfma_f32_32x32x16_bf16 v[208:223], a[176:179], a[172:175], v[208:223]
ds_read_b128 a[196:199], v10 offset:4096
v_mfma_f32_32x32x16_bf16 v[224:239], a[180:183], a[160:163], v[224:239]
ds_read_b128 a[200:203], v10 offset:8192
s_add_u32 m0, s32, 4096
v_mfma_f32_32x32x16_bf16 v[240:255], a[180:183], a[164:167], v[240:255]
ds_read_b128 a[204:207], v10 offset:12288
buffer_load_dwordx4 v2, s[12:15], s48 offen lds
v_mfma_f32_32x32x16_bf16 a[0:15], a[180:183], a[168:171], a[0:15]
ds_read_b64_tr_b16 a[212:213], v14 offset:4096
s_add_u32 s25, s38, 22528
v_mfma_f32_32x32x16_bf16 a[16:31], a[180:183], a[172:175], a[16:31]
ds_read_b64_tr_b16 a[214:215], v14 offset:5120
buffer_store_dwordx4 v[136:139], v17, s[8:11], s25 offen offset:0 sc1
v_mfma_f32_32x32x16_bf16 a[32:47], a[184:187], a[160:163], a[32:47]
ds_read_b64_tr_b16 a[216:217], v15 offset:4096
s_add_u32 m0, s32, 8192
v_mfma_f32_32x32x16_bf16 a[48:63], a[184:187], a[164:167], a[48:63]
ds_read_b64_tr_b16 a[218:219], v15 offset:5120
buffer_load_dwordx4 v3, s[12:15], s48 offen lds
v_mfma_f32_32x32x16_bf16 a[64:79], a[184:187], a[168:171], a[64:79]
ds_read_b64_tr_b16 a[220:221], v16 offset:4096
v_mfma_f32_32x32x16_bf16 a[80:95], a[184:187], a[172:175], a[80:95]
ds_read_b64_tr_b16 a[222:223], v16 offset:5120
v_add_u32 v13, 16384, v13
v_and_b32 v13, 65535, v13
v_mfma_f32_32x32x16_bf16 a[96:111], a[188:191], a[160:163], a[96:111]
s_add_u32 m0, s32, 12288
v_add_u32 v14, 16384, v14
v_and_b32 v14, 65535, v14
v_mfma_f32_32x32x16_bf16 a[112:127], a[188:191], a[164:167], a[112:127]
buffer_load_dwordx4 v4, s[12:15], s48 offen lds
v_add_u32 v15, 16384, v15
v_and_b32 v15, 65535, v15
v_mfma_f32_32x32x16_bf16 a[128:143], a[188:191], a[168:171], a[128:143]
v_add_u32 v16, 16384, v16
v_and_b32 v16, 65535, v16
v_mfma_f32_32x32x16_bf16 a[144:159], a[188:191], a[172:175], a[144:159]
s_waitcnt vmcnt(17) lgkmcnt(0)
s_barrier
v_mfma_f32_32x32x16_bf16 v[160:175], a[208:211], a[192:195], v[160:175]
ds_read_b64_tr_b16 a[176:177], v13 offset:0
s_mov_b32 m0, s33
v_mfma_f32_32x32x16_bf16 v[176:191], a[208:211], a[196:199], v[176:191]
ds_read_b64_tr_b16 a[178:179], v13 offset:1024
buffer_load_dwordx4 v5, s[20:23], s31 offen offset:0 lds
v_mfma_f32_32x32x16_bf16 v[192:207], a[208:211], a[200:203], v[192:207]
ds_read_b128 a[160:163], v11 offset:0
v_mfma_f32_32x32x16_bf16 v[208:223], a[208:211], a[204:207], v[208:223]
ds_read_b128 a[164:167], v11 offset:4096
v_mfma_f32_32x32x16_bf16 v[224:239], a[212:215], a[192:195], v[224:239]
ds_read_b128 a[168:171], v11 offset:8192
v_mfma_f32_32x32x16_bf16 v[240:255], a[212:215], a[196:199], v[240:255]
ds_read_b128 a[172:175], v11 offset:12288
buffer_load_dwordx4 v6, s[20:23], s31 offen offset:1024 lds
v_mfma_f32_32x32x16_bf16 a[0:15], a[212:215], a[200:203], a[0:15]
ds_read_b64_tr_b16 a[180:181], v14 offset:0
s_add_u32 s25, s38, 22528
v_mfma_f32_32x32x16_bf16 a[16:31], a[212:215], a[204:207], a[16:31]
ds_read_b64_tr_b16 a[182:183], v14 offset:1024
buffer_store_dwordx4 v[140:143], v17, s[8:11], s25 offen offset:1024 sc1
v_mfma_f32_32x32x16_bf16 a[32:47], a[216:219], a[192:195], a[32:47]
ds_read_b64_tr_b16 a[184:185], v15 offset:0
v_mfma_f32_32x32x16_bf16 a[48:63], a[216:219], a[196:199], a[48:63]
ds_read_b64_tr_b16 a[186:187], v15 offset:1024
buffer_load_dwordx4 v7, s[20:23], s31 offen offset:2048 lds
v_mfma_f32_32x32x16_bf16 a[64:79], a[216:219], a[200:203], a[64:79]
ds_read_b64_tr_b16 a[188:189], v16 offset:0
v_mfma_f32_32x32x16_bf16 a[80:95], a[216:219], a[204:207], a[80:95]
ds_read_b64_tr_b16 a[190:191], v16 offset:1024
v_mfma_f32_32x32x16_bf16 a[96:111], a[220:223], a[192:195], a[96:111]
v_mfma_f32_32x32x16_bf16 a[112:127], a[220:223], a[196:199], a[112:127]
buffer_load_dwordx4 v8, s[20:23], s31 offen offset:3072 lds
v_mfma_f32_32x32x16_bf16 a[128:143], a[220:223], a[200:203], a[128:143]
s_add_u32 s31, s31, 262144
s_add_u32 s33, s33, 16384
s_and_b32 s33, s33, 65535
v_mfma_f32_32x32x16_bf16 a[144:159], a[220:223], a[204:207], a[144:159]
s_waitcnt lgkmcnt(0)
v_mfma_f32_32x32x16_bf16 v[160:175], a[176:179], a[160:163], v[160:175]
ds_read_b64_tr_b16 a[208:209], v13 offset:4096
s_add_u32 m0, s32, 16384
s_add_u32 s48, s30, s34
v_mfma_f32_32x32x16_bf16 v[176:191], a[176:179], a[164:167], v[176:191]
ds_read_b64_tr_b16 a[210:211], v13 offset:5120
buffer_load_dwordx4 v1, s[12:15], s48 offen lds
v_mfma_f32_32x32x16_bf16 v[192:207], a[176:179], a[168:171], v[192:207]
ds_read_b128 a[192:195], v12 offset:0
v_mfma_f32_32x32x16_bf16 v[208:223], a[176:179], a[172:175], v[208:223]
ds_read_b128 a[196:199], v12 offset:4096
v_mfma_f32_32x32x16_bf16 v[224:239], a[180:183], a[160:163], v[224:239]
ds_read_b128 a[200:203], v12 offset:8192
s_add_u32 m0, s32, 20480
v_mfma_f32_32x32x16_bf16 v[240:255], a[180:183], a[164:167], v[240:255]
ds_read_b128 a[204:207], v12 offset:12288
buffer_load_dwordx4 v2, s[12:15], s48 offen lds
v_mfma_f32_32x32x16_bf16 a[0:15], a[180:183], a[168:171], a[0:15]
ds_read_b64_tr_b16 a[212:213], v14 offset:4096
s_add_u32 s25, s38, 38912
v_mfma_f32_32x32x16_bf16 a[16:31], a[180:183], a[172:175], a[16:31]
ds_read_b64_tr_b16 a[214:215], v14 offset:5120
buffer_store_dwordx4 v[144:147], v17, s[8:11], s25 offen offset:0 sc1
v_mfma_f32_32x32x16_bf16 a[32:47], a[184:187], a[160:163], a[32:47]
ds_read_b64_tr_b16 a[216:217], v15 offset:4096
s_add_u32 m0, s32, 24576
v_mfma_f32_32x32x16_bf16 a[48:63], a[184:187], a[164:167], a[48:63]
ds_read_b64_tr_b16 a[218:219], v15 offset:5120
buffer_load_dwordx4 v3, s[12:15], s48 offen lds
v_mfma_f32_32x32x16_bf16 a[64:79], a[184:187], a[168:171], a[64:79]
ds_read_b64_tr_b16 a[220:221], v16 offset:4096
v_mfma_f32_32x32x16_bf16 a[80:95], a[184:187], a[172:175], a[80:95]
ds_read_b64_tr_b16 a[222:223], v16 offset:5120
v_add_u32 v9, 32768, v9
v_subrev_u32 v20, 98304, v9
v_cmp_le_u32 vcc, 163840, v9
v_add_u32 v13, 16384, v13
v_mfma_f32_32x32x16_bf16 a[96:111], a[188:191], a[160:163], a[96:111]
s_add_u32 m0, s32, 28672
v_and_b32 v13, 65535, v13
v_add_u32 v14, 16384, v14
v_and_b32 v14, 65535, v14
v_add_u32 v15, 16384, v15
v_mfma_f32_32x32x16_bf16 a[112:127], a[188:191], a[164:167], a[112:127]
buffer_load_dwordx4 v4, s[12:15], s48 offen lds
v_and_b32 v15, 65535, v15
v_add_u32 v16, 16384, v16
v_and_b32 v16, 65535, v16
v_mfma_f32_32x32x16_bf16 a[128:143], a[188:191], a[168:171], a[128:143]
s_add_u32 s30, s30, 128
s_add_u32 s32, s32, 32768
s_sub_u32 s24, s32, 98304
s_cmp_ge_u32 s32, 163840
s_cselect_b32 s32, s24, s32
s_add_u32 s25, s38, 38912
v_cndmask_b32 v9, v9, v20, vcc
v_xor_b32 v10, 32, v9
v_xor_b32 v11, 64, v9
v_xor_b32 v12, 96, v9
v_mfma_f32_32x32x16_bf16 a[144:159], a[188:191], a[172:175], a[144:159]
buffer_store_dwordx4 v[148:151], v17, s[8:11], s25 offen offset:1024 sc1
s_cmp_eq_u32 s61, 0
s_cbranch_scc1 L_px_6
s_lshl_b32 s24, s35, 2
s_lshr_b32 s26, 0xe64a20, s24
s_bfe_u32 s2, s26, 0x10003
s_and_b32 s26, s26, 7
s_add_u32 s24, s2, 1
s_sub_u32 s27, s3, 2
s_cmp_eq_u32 s3, 1
s_cbranch_scc0 L_px_8
s_mov_b32 s2, 1
s_mov_b32 s27, 0
s_branch L_px_8
L_px_6:
s_cmp_eq_u32 s35, 2
s_cselect_b32 s2, 1, 0
s_and_b32 s26, s35, 1
s_lshl_b32 s26, s26, 2
s_add_u32 s24, s2, 2
s_sub_u32 s27, s3, 4
L_px_8:
s_lshl_b32 s27, s27, 5
s_add_u32 s27, s27, s16
s_bfm_b32 s25, s24, 0
s_and_b32 s25, s25, s16
s_add_u32 s26, s26, s25
s_lshr_b32 s27, s27, s24
s_or_b32 s40, s2, s61
s_lshr_b32 s24, s17, 1
s_cmp_eq_u32 s2, 0
s_cselect_b32 s41, s24, 0
s_cselect_b64 s[4:5], s[52:53], s[54:55]
s_cselect_b32 s25, 0, s24
s_and_b32 s51, s41, s61
s_lshl_b32 s46, s27, s2
s_add_u32 s46, s46, s25
s_lshl_b32 s46, s46, 8
s_lshl_b32 s47, s40, 7
s_add_u32 s47, s47, 1024
s_mov_b32 s12, s4
s_and_b32 s13, s5, 0xffff
s_lshl_b32 s14, s47, 11
s_mov_b32 s15, 0x20000
s_mul_i32 s30, s26, s47
s_lshl_b32 s30, s30, 8
s_lshl_b32 s42, s27, 3
s_add_u32 s42, s42, s26
s_lshl_b32 s42, s42, 1
s_and_b32 s25, s17, 1
s_add_u32 s42, s42, s25
s_lshl_b32 s42, s42, 3
s_add_u32 s42, s42, s24
s_lshl_b32 s42, s42, 13
s_lshl_b32 s43, s27, 5
s_add_u32 s43, s43, s26
s_lshl_b32 s43, s43, 2
s_lshl_b32 s24, s2, 1
s_add_u32 s24, s24, s61
s_lshl_b32 s24, s24, 2
s_lshr_b32 s25, 0x8720, s24
s_and_b32 s25, s25, 15
s_lshl_b32 s25, s25, 24
s_add_u32 s42, s42, s25
s_lshr_b32 s25, 0x7604, s24
s_and_b32 s25, s25, 15
s_lshl_b32 s25, s25, 12
s_add_u32 s43, s43, s25
s_add_u32 s43, s43, 111149056
s_mov_b32 s44, 1
s_cmp_lt_u32 s35, s45
s_cselect_b32 s30, s30, 536870912
s_cselect_b32 s46, s46, 536870912
v_lshrrev_b32 v18, 3, v0
v_mul_lo_u32 v18, v18, s47
v_bfe_u32 v19, v0, 4, 3
v_and_b32 v20, 7, v0
v_xor_b32 v20, v20, v19
v_lshl_add_u32 v1, v20, 4, v18
s_lshl_b32 s24, s47, 5
s_lshl_b32 s34, s47, 7
v_add_u32 v2, s24, v1
v_add_u32 v3, s24, v2
v_add_u32 v4, s24, v3
s_waitcnt vmcnt(20) lgkmcnt(0)
s_barrier
v_mfma_f32_32x32x16_bf16 v[160:175], a[208:211], a[192:195], v[160:175]
ds_read_b64_tr_b16 a[176:177], v13 offset:0
s_mov_b32 m0, s33
v_mfma_f32_32x32x16_bf16 v[176:191], a[208:211], a[196:199], v[176:191]
ds_read_b64_tr_b16 a[178:179], v13 offset:1024
buffer_load_dwordx4 v5, s[20:23], s31 offen offset:0 lds
v_mfma_f32_32x32x16_bf16 v[192:207], a[208:211], a[200:203], v[192:207]
ds_read_b128 a[160:163], v9 offset:0
v_mfma_f32_32x32x16_bf16 v[208:223], a[208:211], a[204:207], v[208:223]
ds_read_b128 a[164:167], v9 offset:4096
v_mfma_f32_32x32x16_bf16 v[224:239], a[212:215], a[192:195], v[224:239]
ds_read_b128 a[168:171], v9 offset:8192
v_mfma_f32_32x32x16_bf16 v[240:255], a[212:215], a[196:199], v[240:255]
ds_read_b128 a[172:175], v9 offset:12288
buffer_load_dwordx4 v6, s[20:23], s31 offen offset:1024 lds
v_mfma_f32_32x32x16_bf16 a[0:15], a[212:215], a[200:203], a[0:15]
ds_read_b64_tr_b16 a[180:181], v14 offset:0
s_add_u32 s25, s38, 55296
v_mfma_f32_32x32x16_bf16 a[16:31], a[212:215], a[204:207], a[16:31]
ds_read_b64_tr_b16 a[182:183], v14 offset:1024
buffer_store_dwordx4 v[152:155], v17, s[8:11], s25 offen offset:0 sc1
v_mfma_f32_32x32x16_bf16 a[32:47], a[216:219], a[192:195], a[32:47]
ds_read_b64_tr_b16 a[184:185], v15 offset:0
v_mfma_f32_32x32x16_bf16 a[48:63], a[216:219], a[196:199], a[48:63]
ds_read_b64_tr_b16 a[186:187], v15 offset:1024
buffer_load_dwordx4 v7, s[20:23], s31 offen offset:2048 lds
v_mfma_f32_32x32x16_bf16 a[64:79], a[216:219], a[200:203], a[64:79]
ds_read_b64_tr_b16 a[188:189], v16 offset:0
v_mfma_f32_32x32x16_bf16 a[80:95], a[216:219], a[204:207], a[80:95]
ds_read_b64_tr_b16 a[190:191], v16 offset:1024
v_mfma_f32_32x32x16_bf16 a[96:111], a[220:223], a[192:195], a[96:111]
v_mfma_f32_32x32x16_bf16 a[112:127], a[220:223], a[196:199], a[112:127]
buffer_load_dwordx4 v8, s[20:23], s31 offen offset:3072 lds
v_mfma_f32_32x32x16_bf16 a[128:143], a[220:223], a[200:203], a[128:143]
s_add_u32 s31, s31, 262144
s_add_u32 s33, s33, 16384
s_and_b32 s33, s33, 65535
v_mfma_f32_32x32x16_bf16 a[144:159], a[220:223], a[204:207], a[144:159]
s_waitcnt lgkmcnt(0)
v_mfma_f32_32x32x16_bf16 v[160:175], a[176:179], a[160:163], v[160:175]
ds_read_b64_tr_b16 a[208:209], v13 offset:4096
s_add_u32 m0, s32, 0
s_mov_b32 s48, s30
v_mfma_f32_32x32x16_bf16 v[176:191], a[176:179], a[164:167], v[176:191]
ds_read_b64_tr_b16 a[210:211], v13 offset:5120
buffer_load_dwordx4 v1, s[12:15], s48 offen lds
v_mfma_f32_32x32x16_bf16 v[192:207], a[176:179], a[168:171], v[192:207]
ds_read_b128 a[192:195], v10 offset:0
v_mfma_f32_32x32x16_bf16 v[208:223], a[176:179], a[172:175], v[208:223]
ds_read_b128 a[196:199], v10 offset:4096
v_mfma_f32_32x32x16_bf16 v[224:239], a[180:183], a[160:163], v[224:239]
ds_read_b128 a[200:203], v10 offset:8192
s_add_u32 m0, s32, 4096
v_mfma_f32_32x32x16_bf16 v[240:255], a[180:183], a[164:167], v[240:255]
ds_read_b128 a[204:207], v10 offset:12288
buffer_load_dwordx4 v2, s[12:15], s48 offen lds
v_mfma_f32_32x32x16_bf16 a[0:15], a[180:183], a[168:171], a[0:15]
ds_read_b64_tr_b16 a[212:213], v14 offset:4096
s_add_u32 s25, s38, 55296
v_mfma_f32_32x32x16_bf16 a[16:31], a[180:183], a[172:175], a[16:31]
ds_read_b64_tr_b16 a[214:215], v14 offset:5120
buffer_store_dwordx4 v[156:159], v17, s[8:11], s25 offen offset:1024 sc1
v_mfma_f32_32x32x16_bf16 a[32:47], a[184:187], a[160:163], a[32:47]
ds_read_b64_tr_b16 a[216:217], v15 offset:4096
s_add_u32 m0, s32, 8192
v_mfma_f32_32x32x16_bf16 a[48:63], a[184:187], a[164:167], a[48:63]
ds_read_b64_tr_b16 a[218:219], v15 offset:5120
buffer_load_dwordx4 v3, s[12:15], s48 offen lds
v_mfma_f32_32x32x16_bf16 a[64:79], a[184:187], a[168:171], a[64:79]
ds_read_b64_tr_b16 a[220:221], v16 offset:4096
v_mfma_f32_32x32x16_bf16 a[80:95], a[184:187], a[172:175], a[80:95]
ds_read_b64_tr_b16 a[222:223], v16 offset:5120
v_add_u32 v13, 16384, v13
v_and_b32 v13, 65535, v13
v_mfma_f32_32x32x16_bf16 a[96:111], a[188:191], a[160:163], a[96:111]
s_add_u32 m0, s32, 12288
v_add_u32 v14, 16384, v14
v_and_b32 v14, 65535, v14
v_mfma_f32_32x32x16_bf16 a[112:127], a[188:191], a[164:167], a[112:127]
buffer_load_dwordx4 v4, s[12:15], s48 offen lds
v_add_u32 v15, 16384, v15
v_and_b32 v15, 65535, v15
v_mfma_f32_32x32x16_bf16 a[128:143], a[188:191], a[168:171], a[128:143]
v_add_u32 v16, 16384, v16
v_and_b32 v16, 65535, v16
v_mfma_f32_32x32x16_bf16 a[144:159], a[188:191], a[172:175], a[144:159]
s_cmp_eq_u32 s2, 0
s_cselect_b64 s[4:5], s[6:7], s[18:19]
s_mov_b32 s20, s4
s_and_b32 s21, s5, 0xffff
s_lshl_b32 s22, s47, 12
s_mov_b32 s23, 0x20000
s_mov_b32 s31, s46
s_waitcnt vmcnt(21) lgkmcnt(0)
s_barrier
v_mfma_f32_32x32x16_bf16 v[160:175], a[208:211], a[192:195], v[160:175]
ds_read_b64_tr_b16 a[176:177], v13 offset:0
s_mov_b32 m0, s33
v_mfma_f32_32x32x16_bf16 v[176:191], a[208:211], a[196:199], v[176:191]
ds_read_b64_tr_b16 a[178:179], v13 offset:1024
buffer_load_dwordx4 v5, s[20:23], s31 offen offset:0 lds
v_mfma_f32_32x32x16_bf16 v[192:207], a[208:211], a[200:203], v[192:207]
ds_read_b128 a[160:163], v11 offset:0
v_mfma_f32_32x32x16_bf16 v[208:223], a[208:211], a[204:207], v[208:223]
ds_read_b128 a[164:167], v11 offset:4096
v_mfma_f32_32x32x16_bf16 v[224:239], a[212:215], a[192:195], v[224:239]
ds_read_b128 a[168:171], v11 offset:8192
v_mfma_f32_32x32x16_bf16 v[240:255], a[212:215], a[196:199], v[240:255]
ds_read_b128 a[172:175], v11 offset:12288
buffer_load_dwordx4 v6, s[20:23], s31 offen offset:1024 lds
v_mfma_f32_32x32x16_bf16 a[0:15], a[212:215], a[200:203], a[0:15]
ds_read_b64_tr_b16 a[180:181], v14 offset:0
v_mfma_f32_32x32x16_bf16 a[16:31], a[212:215], a[204:207], a[16:31]
ds_read_b64_tr_b16 a[182:183], v14 offset:1024
v_mfma_f32_32x32x16_bf16 a[32:47], a[216:219], a[192:195], a[32:47]
ds_read_b64_tr_b16 a[184:185], v15 offset:0
v_mfma_f32_32x32x16_bf16 a[48:63], a[216:219], a[196:199], a[48:63]
ds_read_b64_tr_b16 a[186:187], v15 offset:1024
buffer_load_dwordx4 v7, s[20:23], s31 offen offset:2048 lds
v_mfma_f32_32x32x16_bf16 a[64:79], a[216:219], a[200:203], a[64:79]
ds_read_b64_tr_b16 a[188:189], v16 offset:0
v_mfma_f32_32x32x16_bf16 a[80:95], a[216:219], a[204:207], a[80:95]
ds_read_b64_tr_b16 a[190:191], v16 offset:1024
v_mfma_f32_32x32x16_bf16 a[96:111], a[220:223], a[192:195], a[96:111]
v_mfma_f32_32x32x16_bf16 a[112:127], a[220:223], a[196:199], a[112:127]
buffer_load_dwordx4 v8, s[20:23], s31 offen offset:3072 lds
v_mfma_f32_32x32x16_bf16 a[128:143], a[220:223], a[200:203], a[128:143]
s_add_u32 s31, s31, 262144
s_add_u32 s33, s33, 16384
s_and_b32 s33, s33, 65535
v_mfma_f32_32x32x16_bf16 a[144:159], a[220:223], a[204:207], a[144:159]
s_waitcnt lgkmcnt(0)
v_mfma_f32_32x32x16_bf16 v[160:175], a[176:179], a[160:163], v[160:175]
ds_read_b64_tr_b16 a[208:209], v13 offset:4096
s_add_u32 m0, s32, 16384
s_add_u32 s48, s30, s34
v_mfma_f32_32x32x16_bf16 v[176:191], a[176:179], a[164:167], v[176:191]
ds_read_b64_tr_b16 a[210:211], v13 offset:5120
buffer_load_dwordx4 v1, s[12:15], s48 offen lds
v_mfma_f32_32x32x16_bf16 v[192:207], a[176:179], a[168:171], v[192:207]
ds_read_b128 a[192:195], v12 offset:0
v_mfma_f32_32x32x16_bf16 v[208:223], a[176:179], a[172:175], v[208:223]
ds_read_b128 a[196:199], v12 offset:4096
v_mfma_f32_32x32x16_bf16 v[224:239], a[180:183], a[160:163], v[224:239]
ds_read_b128 a[200:203], v12 offset:8192
s_add_u32 m0, s32, 20480
v_mfma_f32_32x32x16_bf16 v[240:255], a[180:183], a[164:167], v[240:255]
ds_read_b128 a[204:207], v12 offset:12288
buffer_load_dwordx4 v2, s[12:15], s48 offen lds
v_mfma_f32_32x32x16_bf16 a[0:15], a[180:183], a[168:171], a[0:15]
ds_read_b64_tr_b16 a[212:213], v14 offset:4096
v_mfma_f32_32x32x16_bf16 a[16:31], a[180:183], a[172:175], a[16:31]
ds_read_b64_tr_b16 a[214:215], v14 offset:5120
v_mfma_f32_32x32x16_bf16 a[32:47], a[184:187], a[160:163], a[32:47]
ds_read_b64_tr_b16 a[216:217], v15 offset:4096
s_add_u32 m0, s32, 24576
v_mfma_f32_32x32x16_bf16 a[48:63], a[184:187], a[164:167], a[48:63]
ds_read_b64_tr_b16 a[218:219], v15 offset:5120
buffer_load_dwordx4 v3, s[12:15], s48 offen lds
v_mfma_f32_32x32x16_bf16 a[64:79], a[184:187], a[168:171], a[64:79]
ds_read_b64_tr_b16 a[220:221], v16 offset:4096
v_mfma_f32_32x32x16_bf16 a[80:95], a[184:187], a[172:175], a[80:95]
ds_read_b64_tr_b16 a[222:223], v16 offset:5120
v_add_u32 v9, 32768, v9
v_subrev_u32 v20, 98304, v9
v_cmp_le_u32 vcc, 163840, v9
v_add_u32 v13, 16384, v13
v_mfma_f32_32x32x16_bf16 a[96:111], a[188:191], a[160:163], a[96:111]
s_add_u32 m0, s32, 28672
v_and_b32 v13, 65535, v13
v_add_u32 v14, 16384, v14
v_and_b32 v14, 65535, v14
v_add_u32 v15, 16384, v15
v_mfma_f32_32x32x16_bf16 a[112:127], a[188:191], a[164:167], a[112:127]
buffer_load_dwordx4 v4, s[12:15], s48 offen lds
v_and_b32 v15, 65535, v15
v_add_u32 v16, 16384, v16
v_and_b32 v16, 65535, v16
v_mfma_f32_32x32x16_bf16 a[128:143], a[188:191], a[168:171], a[128:143]
s_add_u32 s30, s30, 128
s_add_u32 s32, s32, 32768
s_sub_u32 s24, s32, 98304
s_cmp_ge_u32 s32, 163840
s_cselect_b32 s32, s24, s32
v_cndmask_b32 v9, v9, v20, vcc
v_xor_b32 v10, 32, v9
v_xor_b32 v11, 64, v9
v_xor_b32 v12, 96, v9
v_mfma_f32_32x32x16_bf16 a[144:159], a[188:191], a[172:175], a[144:159]
s_waitcnt vmcnt(18) lgkmcnt(0)
s_barrier
v_mfma_f32_32x32x16_bf16 v[160:175], a[208:211], a[192:195], v[160:175]
ds_read_b64_tr_b16 a[176:177], v13 offset:0
s_mov_b32 m0, s33
v_mfma_f32_32x32x16_bf16 v[176:191], a[208:211], a[196:199], v[176:191]
ds_read_b64_tr_b16 a[178:179], v13 offset:1024
buffer_load_dwordx4 v5, s[20:23], s31 offen offset:0 lds
v_mfma_f32_32x32x16_bf16 v[192:207], a[208:211], a[200:203], v[192:207]
ds_read_b128 a[160:163], v9 offset:0
v_mfma_f32_32x32x16_bf16 v[208:223], a[208:211], a[204:207], v[208:223]
ds_read_b128 a[164:167], v9 offset:4096
v_mfma_f32_32x32x16_bf16 v[224:239], a[212:215], a[192:195], v[224:239]
ds_read_b128 a[168:171], v9 offset:8192
v_mfma_f32_32x32x16_bf16 v[240:255], a[212:215], a[196:199], v[240:255]
ds_read_b128 a[172:175], v9 offset:12288
buffer_load_dwordx4 v6, s[20:23], s31 offen offset:1024 lds
v_mfma_f32_32x32x16_bf16 a[0:15], a[212:215], a[200:203], a[0:15]
ds_read_b64_tr_b16 a[180:181], v14 offset:0
v_mfma_f32_32x32x16_bf16 a[16:31], a[212:215], a[204:207], a[16:31]
ds_read_b64_tr_b16 a[182:183], v14 offset:1024
v_mfma_f32_32x32x16_bf16 a[32:47], a[216:219], a[192:195], a[32:47]
ds_read_b64_tr_b16 a[184:185], v15 offset:0
v_mfma_f32_32x32x16_bf16 a[48:63], a[216:219], a[196:199], a[48:63]
ds_read_b64_tr_b16 a[186:187], v15 offset:1024
buffer_load_dwordx4 v7, s[20:23], s31 offen offset:2048 lds
v_mfma_f32_32x32x16_bf16 a[64:79], a[216:219], a[200:203], a[64:79]
ds_read_b64_tr_b16 a[188:189], v16 offset:0
v_mfma_f32_32x32x16_bf16 a[80:95], a[216:219], a[204:207], a[80:95]
ds_read_b64_tr_b16 a[190:191], v16 offset:1024
v_mfma_f32_32x32x16_bf16 a[96:111], a[220:223], a[192:195], a[96:111]
v_mfma_f32_32x32x16_bf16 a[112:127], a[220:223], a[196:199], a[112:127]
buffer_load_dwordx4 v8, s[20:23], s31 offen offset:3072 lds
v_mfma_f32_32x32x16_bf16 a[128:143], a[220:223], a[200:203], a[128:143]
s_add_u32 s31, s31, 262144
s_add_u32 s33, s33, 16384
s_and_b32 s33, s33, 65535
v_mfma_f32_32x32x16_bf16 a[144:159], a[220:223], a[204:207], a[144:159]
s_waitcnt lgkmcnt(0)
v_mfma_f32_32x32x16_bf16 v[160:175], a[176:179], a[160:163], v[160:175]
ds_read_b64_tr_b16 a[208:209], v13 offset:4096
s_add_u32 m0, s32, 0
s_mov_b32 s48, s30
v_mfma_f32_32x32x16_bf16 v[176:191], a[176:179], a[164:167], v[176:191]
ds_read_b64_tr_b16 a[210:211], v13 offset:5120
buffer_load_dwordx4 v1, s[12:15], s48 offen lds
v_mfma_f32_32x32x16_bf16 v[192:207], a[176:179], a[168:171], v[192:207]
ds_read_b128 a[192:195], v10 offset:0
v_mfma_f32_32x32x16_bf16 v[208:223], a[176:179], a[172:175], v[208:223]
ds_read_b128 a[196:199], v10 offset:4096
v_mfma_f32_32x32x16_bf16 v[224:239], a[180:183], a[160:163], v[224:239]
ds_read_b128 a[200:203], v10 offset:8192
s_add_u32 m0, s32, 4096
v_mfma_f32_32x32x16_bf16 v[240:255], a[180:183], a[164:167], v[240:255]
ds_read_b128 a[204:207], v10 offset:12288
buffer_load_dwordx4 v2, s[12:15], s48 offen lds
v_mfma_f32_32x32x16_bf16 a[0:15], a[180:183], a[168:171], a[0:15]
ds_read_b64_tr_b16 a[212:213], v14 offset:4096
v_mfma_f32_32x32x16_bf16 a[16:31], a[180:183], a[172:175], a[16:31]
ds_read_b64_tr_b16 a[214:215], v14 offset:5120
v_mfma_f32_32x32x16_bf16 a[32:47], a[184:187], a[160:163], a[32:47]
ds_read_b64_tr_b16 a[216:217], v15 offset:4096
s_add_u32 m0, s32, 8192
v_mfma_f32_32x32x16_bf16 a[48:63], a[184:187], a[164:167], a[48:63]
ds_read_b64_tr_b16 a[218:219], v15 offset:5120
buffer_load_dwordx4 v3, s[12:15], s48 offen lds
v_mfma_f32_32x32x16_bf16 a[64:79], a[184:187], a[168:171], a[64:79]
ds_read_b64_tr_b16 a[220:221], v16 offset:4096
v_mfma_f32_32x32x16_bf16 a[80:95], a[184:187], a[172:175], a[80:95]
ds_read_b64_tr_b16 a[222:223], v16 offset:5120
v_add_u32 v13, 16384, v13
v_and_b32 v13, 65535, v13
v_mfma_f32_32x32x16_bf16 a[96:111], a[188:191], a[160:163], a[96:111]
s_add_u32 m0, s32, 12288
v_add_u32 v14, 16384, v14
v_and_b32 v14, 65535, v14
v_mfma_f32_32x32x16_bf16 a[112:127], a[188:191], a[164:167], a[112:127]
buffer_load_dwordx4 v4, s[12:15], s48 offen lds
v_add_u32 v15, 16384, v15
v_and_b32 v15, 65535, v15
v_mfma_f32_32x32x16_bf16 a[128:143], a[188:191], a[168:171], a[128:143]
v_add_u32 v16, 16384, v16
v_and_b32 v16, 65535, v16
v_mfma_f32_32x32x16_bf16 a[144:159], a[188:191], a[172:175], a[144:159]
s_waitcnt vmcnt(16) lgkmcnt(0)
s_barrier
v_mfma_f32_32x32x16_bf16 v[160:175], a[208:211], a[192:195], v[160:175]
ds_read_b64_tr_b16 a[176:177], v13 offset:0
s_mov_b32 m0, s33
v_mfma_f32_32x32x16_bf16 v[176:191], a[208:211], a[196:199], v[176:191]
ds_read_b64_tr_b16 a[178:179], v13 offset:1024
buffer_load_dwordx4 v5, s[20:23], s31 offen offset:0 lds
v_mfma_f32_32x32x16_bf16 v[192:207], a[208:211], a[200:203], v[192:207]
ds_read_b128 a[160:163], v11 offset:0
v_mfma_f32_32x32x16_bf16 v[208:223], a[208:211], a[204:207], v[208:223]
ds_read_b128 a[164:167], v11 offset:4096
v_mfma_f32_32x32x16_bf16 v[224:239], a[212:215], a[192:195], v[224:239]
ds_read_b128 a[168:171], v11 offset:8192
v_mfma_f32_32x32x16_bf16 v[240:255], a[212:215], a[196:199], v[240:255]
ds_read_b128 a[172:175], v11 offset:12288
buffer_load_dwordx4 v6, s[20:23], s31 offen offset:1024 lds
v_mfma_f32_32x32x16_bf16 a[0:15], a[212:215], a[200:203], a[0:15]
ds_read_b64_tr_b16 a[180:181], v14 offset:0
v_mfma_f32_32x32x16_bf16 a[16:31], a[212:215], a[204:207], a[16:31]
ds_read_b64_tr_b16 a[182:183], v14 offset:1024
v_mfma_f32_32x32x16_bf16 a[32:47], a[216:219], a[192:195], a[32:47]
ds_read_b64_tr_b16 a[184:185], v15 offset:0
v_mfma_f32_32x32x16_bf16 a[48:63], a[216:219], a[196:199], a[48:63]
ds_read_b64_tr_b16 a[186:187], v15 offset:1024
buffer_load_dwordx4 v7, s[20:23], s31 offen offset:2048 lds
v_mfma_f32_32x32x16_bf16 a[64:79], a[216:219], a[200:203], a[64:79]
ds_read_b64_tr_b16 a[188:189], v16 offset:0
v_mfma_f32_32x32x16_bf16 a[80:95], a[216:219], a[204:207], a[80:95]
ds_read_b64_tr_b16 a[190:191], v16 offset:1024
v_mfma_f32_32x32x16_bf16 a[96:111], a[220:223], a[192:195], a[96:111]
v_mov_b32 v18, 0
v_mov_b32 v19, s29
s_cmp_eq_u32 s17, 0
s_cselect_b32 s25, s39, 536870912
s_mov_b64 exec, 1
buffer_store_dword v19, v18, s[8:11], s25 offen sc1
s_mov_b64 exec, -1
v_mfma_f32_32x32x16_bf16 a[112:127], a[220:223], a[196:199], a[112:127]
buffer_load_dwordx4 v8, s[20:23], s31 offen offset:3072 lds
v_mfma_f32_32x32x16_bf16 a[128:143], a[220:223], a[200:203], a[128:143]
s_add_u32 s31, s31, 262144
s_add_u32 s33, s33, 16384
s_and_b32 s33, s33, 65535
v_mfma_f32_32x32x16_bf16 a[144:159], a[220:223], a[204:207], a[144:159]
s_waitcnt lgkmcnt(0)
v_mfma_f32_32x32x16_bf16 v[160:175], a[176:179], a[160:163], v[160:175]
ds_read_b64_tr_b16 a[208:209], v13 offset:4096
s_add_u32 m0, s32, 16384
s_add_u32 s48, s30, s34
v_mfma_f32_32x32x16_bf16 v[176:191], a[176:179], a[164:167], v[176:191]
ds_read_b64_tr_b16 a[210:211], v13 offset:5120
buffer_load_dwordx4 v1, s[12:15], s48 offen lds
v_mfma_f32_32x32x16_bf16 v[192:207], a[176:179], a[168:171], v[192:207]
ds_read_b128 a[192:195], v12 offset:0
v_mfma_f32_32x32x16_bf16 v[208:223], a[176:179], a[172:175], v[208:223]
ds_read_b128 a[196:199], v12 offset:4096
v_mfma_f32_32x32x16_bf16 v[224:239], a[180:183], a[160:163], v[224:239]
ds_read_b128 a[200:203], v12 offset:8192
s_add_u32 m0, s32, 20480
v_mfma_f32_32x32x16_bf16 v[240:255], a[180:183], a[164:167], v[240:255]
ds_read_b128 a[204:207], v12 offset:12288
buffer_load_dwordx4 v2, s[12:15], s48 offen lds
v_mfma_f32_32x32x16_bf16 a[0:15], a[180:183], a[168:171], a[0:15]
ds_read_b64_tr_b16 a[212:213], v14 offset:4096
v_mfma_f32_32x32x16_bf16 a[16:31], a[180:183], a[172:175], a[16:31]
ds_read_b64_tr_b16 a[214:215], v14 offset:5120
v_mfma_f32_32x32x16_bf16 a[32:47], a[184:187], a[160:163], a[32:47]
ds_read_b64_tr_b16 a[216:217], v15 offset:4096
s_add_u32 m0, s32, 24576
v_mfma_f32_32x32x16_bf16 a[48:63], a[184:187], a[164:167], a[48:63]
ds_read_b64_tr_b16 a[218:219], v15 offset:5120
buffer_load_dwordx4 v3, s[12:15], s48 offen lds
v_mfma_f32_32x32x16_bf16 a[64:79], a[184:187], a[168:171], a[64:79]
ds_read_b64_tr_b16 a[220:221], v16 offset:4096
v_mfma_f32_32x32x16_bf16 a[80:95], a[184:187], a[172:175], a[80:95]
ds_read_b64_tr_b16 a[222:223], v16 offset:5120
v_add_u32 v9, 32768, v9
v_subrev_u32 v20, 98304, v9
v_cmp_le_u32 vcc, 163840, v9
v_add_u32 v13, 16384, v13
v_mfma_f32_32x32x16_bf16 a[96:111], a[188:191], a[160:163], a[96:111]
s_add_u32 m0, s32, 28672
v_and_b32 v13, 65535, v13
v_add_u32 v14, 16384, v14
v_and_b32 v14, 65535, v14
v_add_u32 v15, 16384, v15
v_mfma_f32_32x32x16_bf16 a[112:127], a[188:191], a[164:167], a[112:127]
buffer_load_dwordx4 v4, s[12:15], s48 offen lds
v_and_b32 v15, 65535, v15
v_add_u32 v16, 16384, v16
v_and_b32 v16, 65535, v16
v_mfma_f32_32x32x16_bf16 a[128:143], a[188:191], a[168:171], a[128:143]
s_add_u32 s30, s30, 128
s_add_u32 s32, s32, 32768
s_sub_u32 s24, s32, 98304
s_cmp_ge_u32 s32, 163840
s_cselect_b32 s32, s24, s32
v_cndmask_b32 v9, v9, v20, vcc
v_xor_b32 v10, 32, v9
v_xor_b32 v11, 64, v9
v_xor_b32 v12, 96, v9
v_mfma_f32_32x32x16_bf16 a[144:159], a[188:191], a[172:175], a[144:159]
s_waitcnt vmcnt(17) lgkmcnt(0)
s_barrier
v_mfma_f32_32x32x16_bf16 v[160:175], a[208:211], a[192:195], v[160:175]
ds_read_b64_tr_b16 a[176:177], v13 offset:0
s_mov_b32 m0, s33
v_mfma_f32_32x32x16_bf16 v[176:191], a[208:211], a[196:199], v[176:191]
ds_read_b64_tr_b16 a[178:179], v13 offset:1024
buffer_load_dwordx4 v5, s[20:23], s31 offen offset:0 lds
v_mfma_f32_32x32x16_bf16 v[192:207], a[208:211], a[200:203], v[192:207]
ds_read_b128 a[160:163], v9 offset:0
s_nop 4
v_cvt_pk_bf16_f32 v32, v160, v161
v_cvt_pk_bf16_f32 v33, v162, v163
v_cvt_pk_bf16_f32 v34, v164, v165
v_cvt_pk_bf16_f32 v35, v166, v167
v_cvt_pk_bf16_f32 v36, v168, v169
v_cvt_pk_bf16_f32 v37, v170, v171
v_cvt_pk_bf16_f32 v38, v172, v173
v_cvt_pk_bf16_f32 v39, v174, v175
v_mfma_f32_32x32x16_bf16 v[208:223], a[208:211], a[204:207], v[208:223]
ds_read_b128 a[164:167], v9 offset:4096
v_cvt_pk_bf16_f32 v40, v176, v177
v_cvt_pk_bf16_f32 v41, v178, v179
v_cvt_pk_bf16_f32 v42, v180, v181
v_cvt_pk_bf16_f32 v43, v182, v183
v_cvt_pk_bf16_f32 v44, v184, v185
v_cvt_pk_bf16_f32 v45, v186, v187
v_cvt_pk_bf16_f32 v46, v188, v189
v_cvt_pk_bf16_f32 v47, v190, v191
v_mfma_f32_32x32x16_bf16 v[224:239], a[212:215], a[192:195], v[224:239]
ds_read_b128 a[168:171], v9 offset:8192
v_cvt_pk_bf16_f32 v48, v192, v193
v_cvt_pk_bf16_f32 v49, v194, v195
v_cvt_pk_bf16_f32 v50, v196, v197
v_cvt_pk_bf16_f32 v51, v198, v199
v_cvt_pk_bf16_f32 v52, v200, v201
v_cvt_pk_bf16_f32 v53, v202, v203
v_cvt_pk_bf16_f32 v54, v204, v205
v_cvt_pk_bf16_f32 v55, v206, v207
v_mfma_f32_32x32x16_bf16 v[240:255], a[212:215], a[196:199], v[240:255]
ds_read_b128 a[172:175], v9 offset:12288
buffer_load_dwordx4 v6, s[20:23], s31 offen offset:1024 lds
v_cvt_pk_bf16_f32 v56, v208, v209
v_cvt_pk_bf16_f32 v57, v210, v211
v_cvt_pk_bf16_f32 v58, v212, v213
v_cvt_pk_bf16_f32 v59, v214, v215
v_cvt_pk_bf16_f32 v60, v216, v217
v_cvt_pk_bf16_f32 v61, v218, v219
v_cvt_pk_bf16_f32 v62, v220, v221
v_cvt_pk_bf16_f32 v63, v222, v223
v_mfma_f32_32x32x16_bf16 a[0:15], a[212:215], a[200:203], a[0:15]
ds_read_b64_tr_b16 a[180:181], v14 offset:0
v_cvt_pk_bf16_f32 v64, v224, v225
v_cvt_pk_bf16_f32 v65, v226, v227
v_cvt_pk_bf16_f32 v66, v228, v229
v_cvt_pk_bf16_f32 v67, v230, v231
v_cvt_pk_bf16_f32 v68, v232, v233
v_cvt_pk_bf16_f32 v69, v234, v235
v_cvt_pk_bf16_f32 v70, v236, v237
v_cvt_pk_bf16_f32 v71, v238, v239
v_mfma_f32_32x32x16_bf16 a[16:31], a[212:215], a[204:207], a[16:31]
ds_read_b64_tr_b16 a[182:183], v14 offset:1024
v_cvt_pk_bf16_f32 v72, v240, v241
v_cvt_pk_bf16_f32 v73, v242, v243
v_cvt_pk_bf16_f32 v74, v244, v245
v_cvt_pk_bf16_f32 v75, v246, v247
v_cvt_pk_bf16_f32 v76, v248, v249
v_cvt_pk_bf16_f32 v77, v250, v251
v_cvt_pk_bf16_f32 v78, v252, v253
v_cvt_pk_bf16_f32 v79, v254, v255
v_mfma_f32_32x32x16_bf16 a[32:47], a[216:219], a[192:195], a[32:47]
ds_read_b64_tr_b16 a[184:185], v15 offset:0
v_accvgpr_read_b32 v24, a0
v_accvgpr_read_b32 v25, a1
v_cvt_pk_bf16_f32 v80, v24, v25
v_accvgpr_read_b32 v26, a2
v_accvgpr_read_b32 v27, a3
v_cvt_pk_bf16_f32 v81, v26, v27
v_accvgpr_read_b32 v28, a4
v_accvgpr_read_b32 v29, a5
v_cvt_pk_bf16_f32 v82, v28, v29
v_accvgpr_read_b32 v30, a6
v_accvgpr_read_b32 v31, a7
v_cvt_pk_bf16_f32 v83, v30, v31
v_mfma_f32_32x32x16_bf16 a[48:63], a[216:219], a[196:199], a[48:63]
ds_read_b64_tr_b16 a[186:187], v15 offset:1024
buffer_load_dwordx4 v7, s[20:23], s31 offen offset:2048 lds
v_accvgpr_read_b32 v24, a8
v_accvgpr_read_b32 v25, a9
v_cvt_pk_bf16_f32 v84, v24, v25
v_accvgpr_read_b32 v26, a10
v_accvgpr_read_b32 v27, a11
v_cvt_pk_bf16_f32 v85, v26, v27
v_accvgpr_read_b32 v28, a12
v_accvgpr_read_b32 v29, a13
v_cvt_pk_bf16_f32 v86, v28, v29
v_accvgpr_read_b32 v30, a14
v_accvgpr_read_b32 v31, a15
v_cvt_pk_bf16_f32 v87, v30, v31
v_mfma_f32_32x32x16_bf16 a[64:79], a[216:219], a[200:203], a[64:79]
ds_read_b64_tr_b16 a[188:189], v16 offset:0
v_accvgpr_read_b32 v24, a16
v_accvgpr_read_b32 v25, a17
v_cvt_pk_bf16_f32 v88, v24, v25
v_accvgpr_read_b32 v26, a18
v_accvgpr_read_b32 v27, a19
v_cvt_pk_bf16_f32 v89, v26, v27
v_accvgpr_read_b32 v28, a20
v_accvgpr_read_b32 v29, a21
v_cvt_pk_bf16_f32 v90, v28, v29
v_accvgpr_read_b32 v30, a22
v_accvgpr_read_b32 v31, a23
v_cvt_pk_bf16_f32 v91, v30, v31
v_mfma_f32_32x32x16_bf16 a[80:95], a[216:219], a[204:207], a[80:95]
ds_read_b64_tr_b16 a[190:191], v16 offset:1024
v_accvgpr_read_b32 v24, a24
v_accvgpr_read_b32 v25, a25
v_cvt_pk_bf16_f32 v92, v24, v25
v_accvgpr_read_b32 v26, a26
v_accvgpr_read_b32 v27, a27
v_cvt_pk_bf16_f32 v93, v26, v27
v_accvgpr_read_b32 v28, a28
v_accvgpr_read_b32 v29, a29
v_cvt_pk_bf16_f32 v94, v28, v29
v_accvgpr_read_b32 v30, a30
v_accvgpr_read_b32 v31, a31
v_cvt_pk_bf16_f32 v95, v30, v31
v_mfma_f32_32x32x16_bf16 a[96:111], a[220:223], a[192:195], a[96:111]
v_accvgpr_read_b32 v24, a32
v_accvgpr_read_b32 v25, a33
v_cvt_pk_bf16_f32 v96, v24, v25
v_accvgpr_read_b32 v26, a34
v_accvgpr_read_b32 v27, a35
v_cvt_pk_bf16_f32 v97, v26, v27
v_accvgpr_read_b32 v28, a36
v_accvgpr_read_b32 v29, a37
v_cvt_pk_bf16_f32 v98, v28, v29
v_accvgpr_read_b32 v30, a38
v_accvgpr_read_b32 v31, a39
v_cvt_pk_bf16_f32 v99, v30, v31
v_mfma_f32_32x32x16_bf16 a[112:127], a[220:223], a[196:199], a[112:127]
buffer_load_dwordx4 v8, s[20:23], s31 offen offset:3072 lds
v_accvgpr_read_b32 v24, a40
v_accvgpr_read_b32 v25, a41
v_cvt_pk_bf16_f32 v100, v24, v25
v_accvgpr_read_b32 v26, a42
v_accvgpr_read_b32 v27, a43
v_cvt_pk_bf16_f32 v101, v26, v27
v_accvgpr_read_b32 v28, a44
v_accvgpr_read_b32 v29, a45
v_cvt_pk_bf16_f32 v102, v28, v29
v_accvgpr_read_b32 v30, a46
v_accvgpr_read_b32 v31, a47
v_cvt_pk_bf16_f32 v103, v30, v31
v_mfma_f32_32x32x16_bf16 a[128:143], a[220:223], a[200:203], a[128:143]
s_add_u32 s31, s31, 262144
s_add_u32 s33, s33, 16384
s_and_b32 s33, s33, 65535
v_accvgpr_read_b32 v24, a48
v_accvgpr_read_b32 v25, a49
v_cvt_pk_bf16_f32 v104, v24, v25
v_accvgpr_read_b32 v26, a50
v_accvgpr_read_b32 v27, a51
v_cvt_pk_bf16_f32 v105, v26, v27
v_accvgpr_read_b32 v28, a52
v_accvgpr_read_b32 v29, a53
v_cvt_pk_bf16_f32 v106, v28, v29
v_accvgpr_read_b32 v30, a54
v_accvgpr_read_b32 v31, a55
v_cvt_pk_bf16_f32 v107, v30, v31
v_mfma_f32_32x32x16_bf16 a[144:159], a[220:223], a[204:207], a[144:159]
v_accvgpr_read_b32 v24, a56
v_accvgpr_read_b32 v25, a57
v_cvt_pk_bf16_f32 v108, v24, v25
v_accvgpr_read_b32 v26, a58
v_accvgpr_read_b32 v27, a59
v_cvt_pk_bf16_f32 v109, v26, v27
v_accvgpr_read_b32 v28, a60
v_accvgpr_read_b32 v29, a61
v_cvt_pk_bf16_f32 v110, v28, v29
v_accvgpr_read_b32 v30, a62
v_accvgpr_read_b32 v31, a63
v_cvt_pk_bf16_f32 v111, v30, v31
v_accvgpr_read_b32 v24, a64
v_accvgpr_read_b32 v25, a65
v_cvt_pk_bf16_f32 v112, v24, v25
v_accvgpr_read_b32 v26, a66
v_accvgpr_read_b32 v27, a67
v_cvt_pk_bf16_f32 v113, v26, v27
v_accvgpr_read_b32 v28, a68
v_accvgpr_read_b32 v29, a69
v_cvt_pk_bf16_f32 v114, v28, v29
v_accvgpr_read_b32 v30, a70
v_accvgpr_read_b32 v31, a71
v_cvt_pk_bf16_f32 v115, v30, v31
s_cmp_lt_u32 s35, s45
s_cbranch_scc1 L_g_tile
s_branch L_g_end
.p2align 3
L_g_v:
s_waitcnt lgkmcnt(0)
v_mfma_f32_32x32x16_bf16 v[160:175], a[160:163], a[176:179], 0
ds_read_b64_tr_b16 a[208:209], v13 offset:4096
s_add_u32 m0, s32, 0
s_mov_b32 s48, s30
v_accvgpr_read_b32 v24, a72
v_accvgpr_read_b32 v25, a73
v_cvt_pk_bf16_f32 v116, v24, v25
v_accvgpr_read_b32 v26, a74
v_accvgpr_read_b32 v27, a75
v_cvt_pk_bf16_f32 v117, v26, v27
v_accvgpr_read_b32 v28, a76
v_accvgpr_read_b32 v29, a77
v_cvt_pk_bf16_f32 v118, v28, v29
v_accvgpr_read_b32 v30, a78
v_mfma_f32_32x32x16_bf16 v[176:191], a[164:167], a[176:179], 0
ds_read_b64_tr_b16 a[210:211], v13 offset:5120
buffer_load_dwordx4 v1, s[12:15], s48 offen lds
v_accvgpr_read_b32 v31, a79
v_cvt_pk_bf16_f32 v119, v30, v31
v_accvgpr_read_b32 v24, a80
v_accvgpr_read_b32 v25, a81
v_cvt_pk_bf16_f32 v120, v24, v25
v_accvgpr_read_b32 v26, a82
v_accvgpr_read_b32 v27, a83
v_cvt_pk_bf16_f32 v121, v26, v27
v_accvgpr_read_b32 v28, a84
v_accvgpr_read_b32 v29, a85
v_mfma_f32_32x32x16_bf16 v[192:207], a[168:171], a[176:179], 0
ds_read_b128 a[192:195], v10 offset:0
v_cvt_pk_bf16_f32 v122, v28, v29
v_accvgpr_read_b32 v30, a86
v_accvgpr_read_b32 v31, a87
v_cvt_pk_bf16_f32 v123, v30, v31
v_accvgpr_read_b32 v24, a88
v_accvgpr_read_b32 v25, a89
v_cvt_pk_bf16_f32 v124, v24, v25
v_accvgpr_read_b32 v26, a90
v_accvgpr_read_b32 v27, a91
v_cvt_pk_bf16_f32 v125, v26, v27
v_mfma_f32_32x32x16_bf16 v[208:223], a[172:175], a[176:179], 0
ds_read_b128 a[196:199], v10 offset:4096
v_accvgpr_read_b32 v28, a92
v_accvgpr_read_b32 v29, a93
v_cvt_pk_bf16_f32 v126, v28, v29
v_accvgpr_read_b32 v30, a94
v_accvgpr_read_b32 v31, a95
v_cvt_pk_bf16_f32 v127, v30, v31
v_accvgpr_read_b32 v24, a96
v_accvgpr_read_b32 v25, a97
v_cvt_pk_bf16_f32 v128, v24, v25
v_accvgpr_read_b32 v26, a98
v_mfma_f32_32x32x16_bf16 v[224:239], a[160:163], a[180:183], 0
ds_read_b128 a[200:203], v10 offset:8192
s_add_u32 m0, s32, 4096
v_accvgpr_read_b32 v27, a99
v_cvt_pk_bf16_f32 v129, v26, v27
v_accvgpr_read_b32 v28, a100
v_accvgpr_read_b32 v29, a101
v_cvt_pk_bf16_f32 v130, v28, v29
v_accvgpr_read_b32 v30, a102
v_accvgpr_read_b32 v31, a103
v_cvt_pk_bf16_f32 v131, v30, v31
v_accvgpr_read_b32 v24, a104
v_accvgpr_read_b32 v25, a105
v_mfma_f32_32x32x16_bf16 v[240:255], a[164:167], a[180:183], 0
ds_read_b128 a[204:207], v10 offset:12288
buffer_load_dwordx4 v2, s[12:15], s48 offen lds
v_cvt_pk_bf16_f32 v132, v24, v25
v_accvgpr_read_b32 v26, a106
v_accvgpr_read_b32 v27, a107
v_cvt_pk_bf16_f32 v133, v26, v27
v_accvgpr_read_b32 v28, a108
v_accvgpr_read_b32 v29, a109
v_cvt_pk_bf16_f32 v134, v28, v29
v_accvgpr_read_b32 v30, a110
v_accvgpr_read_b32 v31, a111
v_cvt_pk_bf16_f32 v135, v30, v31
v_mfma_f32_32x32x16_bf16 a[0:15], a[168:171], a[180:183], 0
ds_read_b64_tr_b16 a[212:213], v14 offset:4096
v_accvgpr_read_b32 v24, a112
v_accvgpr_read_b32 v25, a113
v_cvt_pk_bf16_f32 v136, v24, v25
v_accvgpr_read_b32 v26, a114
v_accvgpr_read_b32 v27, a115
v_cvt_pk_bf16_f32 v137, v26, v27
v_accvgpr_read_b32 v28, a116
v_accvgpr_read_b32 v29, a117
v_cvt_pk_bf16_f32 v138, v28, v29
v_accvgpr_read_b32 v30, a118
v_mfma_f32_32x32x16_bf16 a[16:31], a[172:175], a[180:183], 0
ds_read_b64_tr_b16 a[214:215], v14 offset:5120
v_accvgpr_read_b32 v31, a119
v_cvt_pk_bf16_f32 v139, v30, v31
v_accvgpr_read_b32 v24, a120
v_accvgpr_read_b32 v25, a121
v_cvt_pk_bf16_f32 v140, v24, v25
v_accvgpr_read_b32 v26, a122
v_accvgpr_read_b32 v27, a123
v_cvt_pk_bf16_f32 v141, v26, v27
v_accvgpr_read_b32 v28, a124
v_accvgpr_read_b32 v29, a125
v_mfma_f32_32x32x16_bf16 a[32:47], a[160:163], a[184:187], 0
ds_read_b64_tr_b16 a[216:217], v15 offset:4096
s_add_u32 m0, s32, 8192
v_cvt_pk_bf16_f32 v142, v28, v29
v_accvgpr_read_b32 v30, a126
v_accvgpr_read_b32 v31, a127
v_cvt_pk_bf16_f32 v143, v30, v31
v_accvgpr_read_b32 v24, a128
v_accvgpr_read_b32 v25, a129
v_cvt_pk_bf16_f32 v144, v24, v25
v_accvgpr_read_b32 v26, a130
v_accvgpr_read_b32 v27, a131
v_cvt_pk_bf16_f32 v145, v26, v27
v_mfma_f32_32x32x16_bf16 a[48:63], a[164:167], a[184:187], 0
ds_read_b64_tr_b16 a[218:219], v15 offset:5120
buffer_load_dwordx4 v3, s[12:15], s48 offen lds
v_accvgpr_read_b32 v28, a132
v_accvgpr_read_b32 v29, a133
v_cvt_pk_bf16_f32 v146, v28, v29
v_accvgpr_read_b32 v30, a134
v_accvgpr_read_b32 v31, a135
v_cvt_pk_bf16_f32 v147, v30, v31
v_accvgpr_read_b32 v24, a136
v_accvgpr_read_b32 v25, a137
v_cvt_pk_bf16_f32 v148, v24, v25
v_accvgpr_read_b32 v26, a138
v_mfma_f32_32x32x16_bf16 a[64:79], a[168:171], a[184:187], 0
ds_read_b64_tr_b16 a[220:221], v16 offset:4096
v_accvgpr_read_b32 v27, a139
v_cvt_pk_bf16_f32 v149, v26, v27
v_accvgpr_read_b32 v28, a140
v_accvgpr_read_b32 v29, a141
v_cvt_pk_bf16_f32 v150, v28, v29
v_accvgpr_read_b32 v30, a142
v_accvgpr_read_b32 v31, a143
v_cvt_pk_bf16_f32 v151, v30, v31
v_accvgpr_read_b32 v24, a144
v_accvgpr_read_b32 v25, a145
v_mfma_f32_32x32x16_bf16 a[80:95], a[172:175], a[184:187], 0
ds_read_b64_tr_b16 a[222:223], v16 offset:5120
v_cvt_pk_bf16_f32 v152, v24, v25
v_accvgpr_read_b32 v26, a146
v_accvgpr_read_b32 v27, a147
v_cvt_pk_bf16_f32 v153, v26, v27
v_accvgpr_read_b32 v28, a148
v_accvgpr_read_b32 v29, a149
v_cvt_pk_bf16_f32 v154, v28, v29
v_accvgpr_read_b32 v30, a150
v_accvgpr_read_b32 v31, a151
v_cvt_pk_bf16_f32 v155, v30, v31
v_mfma_f32_32x32x16_bf16 a[96:111], a[160:163], a[188:191], 0
s_add_u32 m0, s32, 12288
v_accvgpr_read_b32 v24, a152
v_accvgpr_read_b32 v25, a153
v_cvt_pk_bf16_f32 v156, v24, v25
v_accvgpr_read_b32 v26, a154
v_accvgpr_read_b32 v27, a155
v_cvt_pk_bf16_f32 v157, v26, v27
v_accvgpr_read_b32 v28, a156
v_accvgpr_read_b32 v29, a157
v_cvt_pk_bf16_f32 v158, v28, v29
v_accvgpr_read_b32 v30, a158
v_mfma_f32_32x32x16_bf16 a[112:127], a[164:167], a[188:191], 0
buffer_load_dwordx4 v4, s[12:15], s48 offen lds
v_accvgpr_read_b32 v31, a159
v_cvt_pk_bf16_f32 v159, v30, v31
v_mfma_f32_32x32x16_bf16 a[128:143], a[168:171], a[188:191], 0
v_mfma_f32_32x32x16_bf16 a[144:159], a[172:175], a[188:191], 0
v_add_u32 v13, 16384, v13
v_and_b32 v13, 65535, v13
v_add_u32 v14, 16384, v14
v_and_b32 v14, 65535, v14
v_add_u32 v15, 16384, v15
v_and_b32 v15, 65535, v15
v_add_u32 v16, 16384, v16
v_and_b32 v16, 65535, v16
v_and_b32 v18, 63, v0
v_bfe_u32 v19, v0, 1, 4
v_and_b32 v20, 1, v0
v_lshl_add_u32 v19, v20, 4, v19
v_and_or_b32 v19, v0, 32, v19
v_cmp_eq_u32 vcc, 0, s49
s_nop 1
v_cndmask_b32 v18, v19, v18, vcc
v_lshlrev_b32 v17, 4, v18
s_waitcnt vmcnt(17) lgkmcnt(0)
s_barrier
v_mfma_f32_32x32x16_bf16 v[160:175], a[192:195], a[208:211], v[160:175]
ds_read_b64_tr_b16 a[176:177], v13 offset:0
s_mov_b32 m0, s33
v_mfma_f32_32x32x16_bf16 v[176:191], a[196:199], a[208:211], v[176:191]
ds_read_b64_tr_b16 a[178:179], v13 offset:1024
buffer_load_dwordx4 v5, s[20:23], s31 offen offset:0 lds
v_mfma_f32_32x32x16_bf16 v[192:207], a[200:203], a[208:211], v[192:207]
ds_read_b128 a[160:163], v11 offset:0
v_mfma_f32_32x32x16_bf16 v[208:223], a[204:207], a[208:211], v[208:223]
ds_read_b128 a[164:167], v11 offset:4096
v_mfma_f32_32x32x16_bf16 v[224:239], a[192:195], a[212:215], v[224:239]
ds_read_b128 a[168:171], v11 offset:8192
v_mfma_f32_32x32x16_bf16 v[240:255], a[196:199], a[212:215], v[240:255]
ds_read_b128 a[172:175], v11 offset:12288
buffer_load_dwordx4 v6, s[20:23], s31 offen offset:1024 lds
v_mfma_f32_32x32x16_bf16 a[0:15], a[200:203], a[212:215], a[0:15]
ds_read_b64_tr_b16 a[180:181], v14 offset:0
s_add_u32 s25, s38, 0
v_mfma_f32_32x32x16_bf16 a[16:31], a[204:207], a[212:215], a[16:31]
ds_read_b64_tr_b16 a[182:183], v14 offset:1024
buffer_store_dwordx4 v[32:35], v17, s[8:11], s25 offen offset:0 sc1
v_mfma_f32_32x32x16_bf16 a[32:47], a[192:195], a[216:219], a[32:47]
ds_read_b64_tr_b16 a[184:185], v15 offset:0
v_mfma_f32_32x32x16_bf16 a[48:63], a[196:199], a[216:219], a[48:63]
ds_read_b64_tr_b16 a[186:187], v15 offset:1024
buffer_load_dwordx4 v7, s[20:23], s31 offen offset:2048 lds
v_mfma_f32_32x32x16_bf16 a[64:79], a[200:203], a[216:219], a[64:79]
ds_read_b64_tr_b16 a[188:189], v16 offset:0
v_mfma_f32_32x32x16_bf16 a[80:95], a[204:207], a[216:219], a[80:95]
ds_read_b64_tr_b16 a[190:191], v16 offset:1024
v_mfma_f32_32x32x16_bf16 a[96:111], a[192:195], a[220:223], a[96:111]
v_mfma_f32_32x32x16_bf16 a[112:127], a[196:199], a[220:223], a[112:127]
buffer_load_dwordx4 v8, s[20:23], s31 offen offset:3072 lds
v_mfma_f32_32x32x16_bf16 a[128:143], a[200:203], a[220:223], a[128:143]
s_add_u32 s31, s31, 262144
s_add_u32 s33, s33, 16384
s_and_b32 s33, s33, 65535
s_add_u32 s25, s38, 0
v_mfma_f32_32x32x16_bf16 a[144:159], a[204:207], a[220:223], a[144:159]
buffer_store_dwordx4 v[36:39], v17, s[8:11], s25 offen offset:1024 sc1
s_waitcnt lgkmcnt(0)
v_mfma_f32_32x32x16_bf16 v[160:175], a[160:163], a[176:179], v[160:175]
ds_read_b64_tr_b16 a[208:209], v13 offset:4096
s_add_u32 m0, s32, 16384
s_add_u32 s48, s30, s34
v_mfma_f32_32x32x16_bf16 v[176:191], a[164:167], a[176:179], v[176:191]
ds_read_b64_tr_b16 a[210:211], v13 offset:5120
buffer_load_dwordx4 v1, s[12:15], s48 offen lds
v_mfma_f32_32x32x16_bf16 v[192:207], a[168:171], a[176:179], v[192:207]
ds_read_b128 a[192:195], v12 offset:0
v_mfma_f32_32x32x16_bf16 v[208:223], a[172:175], a[176:179], v[208:223]
ds_read_b128 a[196:199], v12 offset:4096
v_mfma_f32_32x32x16_bf16 v[224:239], a[160:163], a[180:183], v[224:239]
ds_read_b128 a[200:203], v12 offset:8192
s_add_u32 m0, s32, 20480
v_mfma_f32_32x32x16_bf16 v[240:255], a[164:167], a[180:183], v[240:255]
ds_read_b128 a[204:207], v12 offset:12288
buffer_load_dwordx4 v2, s[12:15], s48 offen lds
v_mfma_f32_32x32x16_bf16 a[0:15], a[168:171], a[180:183], a[0:15]
ds_read_b64_tr_b16 a[212:213], v14 offset:4096
s_add_u32 s25, s38, 16384
v_mfma_f32_32x32x16_bf16 a[16:31], a[172:175], a[180:183], a[16:31]
ds_read_b64_tr_b16 a[214:215], v14 offset:5120
buffer_store_dwordx4 v[40:43], v17, s[8:11], s25 offen offset:0 sc1
v_mfma_f32_32x32x16_bf16 a[32:47], a[160:163], a[184:187], a[32:47]
ds_read_b64_tr_b16 a[216:217], v15 offset:4096
s_add_u32 m0, s32, 24576
v_mfma_f32_32x32x16_bf16 a[48:63], a[164:167], a[184:187], a[48:63]
ds_read_b64_tr_b16 a[218:219], v15 offset:5120
buffer_load_dwordx4 v3, s[12:15], s48 offen lds
v_mfma_f32_32x32x16_bf16 a[64:79], a[168:171], a[184:187], a[64:79]
ds_read_b64_tr_b16 a[220:221], v16 offset:4096
v_mfma_f32_32x32x16_bf16 a[80:95], a[172:175], a[184:187], a[80:95]
ds_read_b64_tr_b16 a[222:223], v16 offset:5120
v_add_u32 v9, 32768, v9
v_subrev_u32 v20, 98304, v9
v_cmp_le_u32 vcc, 163840, v9
v_add_u32 v13, 16384, v13
v_mfma_f32_32x32x16_bf16 a[96:111], a[160:163], a[188:191], a[96:111]
s_add_u32 m0, s32, 28672
v_and_b32 v13, 65535, v13
v_add_u32 v14, 16384, v14
v_and_b32 v14, 65535, v14
v_add_u32 v15, 16384, v15
v_mfma_f32_32x32x16_bf16 a[112:127], a[164:167], a[188:191], a[112:127]
buffer_load_dwordx4 v4, s[12:15], s48 offen lds
v_and_b32 v15, 65535, v15
v_add_u32 v16, 16384, v16
v_and_b32 v16, 65535, v16
v_mfma_f32_32x32x16_bf16 a[128:143], a[168:171], a[188:191], a[128:143]
s_add_u32 s30, s30, 128
s_add_u32 s32, s32, 32768
s_sub_u32 s24, s32, 98304
s_cmp_ge_u32 s32, 163840
s_cselect_b32 s32, s24, s32
v_cndmask_b32 v9, v9, v20, vcc
v_xor_b32 v10, 32, v9
v_xor_b32 v11, 64, v9
v_xor_b32 v12, 96, v9
v_mfma_f32_32x32x16_bf16 a[144:159], a[172:175], a[188:191], a[144:159]
s_waitcnt vmcnt(19) lgkmcnt(0)
s_barrier
v_mfma_f32_32x32x16_bf16 v[160:175], a[192:195], a[208:211], v[160:175]
ds_read_b64_tr_b16 a[176:177], v13 offset:0
s_mov_b32 m0, s33
v_mfma_f32_32x32x16_bf16 v[176:191], a[196:199], a[208:211], v[176:191]
ds_read_b64_tr_b16 a[178:179], v13 offset:1024
buffer_load_dwordx4 v5, s[20:23], s31 offen offset:0 lds
v_mfma_f32_32x32x16_bf16 v[192:207], a[200:203], a[208:211], v[192:207]
ds_read_b128 a[160:163], v9 offset:0
v_mfma_f32_32x32x16_bf16 v[208:223], a[204:207], a[208:211], v[208:223]
ds_read_b128 a[164:167], v9 offset:4096
v_mfma_f32_32x32x16_bf16 v[224:239], a[192:195], a[212:215], v[224:239]
ds_read_b128 a[168:171], v9 offset:8192
v_mfma_f32_32x32x16_bf16 v[240:255], a[196:199], a[212:215], v[240:255]
ds_read_b128 a[172:175], v9 offset:12288
buffer_load_dwordx4 v6, s[20:23], s31 offen offset:1024 lds
v_mfma_f32_32x32x16_bf16 a[0:15], a[200:203], a[212:215], a[0:15]
ds_read_b64_tr_b16 a[180:181], v14 offset:0
s_add_u32 s25, s38, 16384
v_mfma_f32_32x32x16_bf16 a[16:31], a[204:207], a[212:215], a[16:31]
ds_read_b64_tr_b16 a[182:183], v14 offset:1024
buffer_store_dwordx4 v[44:47], v17, s[8:11], s25 offen offset:1024 sc1
v_mfma_f32_32x32x16_bf16 a[32:47], a[192:195], a[216:219], a[32:47]
ds_read_b64_tr_b16 a[184:185], v15 offset:0
v_mfma_f32_32x32x16_bf16 a[48:63], a[196:199], a[216:219], a[48:63]
ds_read_b64_tr_b16 a[186:187], v15 offset:1024
buffer_load_dwordx4 v7, s[20:23], s31 offen offset:2048 lds
v_mfma_f32_32x32x16_bf16 a[64:79], a[200:203], a[216:219], a[64:79]
ds_read_b64_tr_b16 a[188:189], v16 offset:0
v_mfma_f32_32x32x16_bf16 a[80:95], a[204:207], a[216:219], a[80:95]
ds_read_b64_tr_b16 a[190:191], v16 offset:1024
v_mfma_f32_32x32x16_bf16 a[96:111], a[192:195], a[220:223], a[96:111]
v_mfma_f32_32x32x16_bf16 a[112:127], a[196:199], a[220:223], a[112:127]
buffer_load_dwordx4 v8, s[20:23], s31 offen offset:3072 lds
v_mfma_f32_32x32x16_bf16 a[128:143], a[200:203], a[220:223], a[128:143]
s_add_u32 s31, s31, 262144
s_add_u32 s33, s33, 16384
s_and_b32 s33, s33, 65535
v_mfma_f32_32x32x16_bf16 a[144:159], a[204:207], a[220:223], a[144:159]
s_waitcnt lgkmcnt(0)
v_mfma_f32_32x32x16_bf16 v[160:175], a[160:163], a[176:179], v[160:175]
ds_read_b64_tr_b16 a[208:209], v13 offset:4096
s_add_u32 m0, s32, 0
s_mov_b32 s48, s30
v_mfma_f32_32x32x16_bf16 v[176:191], a[164:167], a[176:179], v[176:191]
ds_read_b64_tr_b16 a[210:211], v13 offset:5120
buffer_load_dwordx4 v1, s[12:15], s48 offen lds
v_mfma_f32_32x32x16_bf16 v[192:207], a[168:171], a[176:179], v[192:207]
ds_read_b128 a[192:195], v10 offset:0
v_mfma_f32_32x32x16_bf16 v[208:223], a[172:175], a[176:179], v[208:223]
ds_read_b128 a[196:199], v10 offset:4096
v_mfma_f32_32x32x16_bf16 v[224:239], a[160:163], a[180:183], v[224:239]
ds_read_b128 a[200:203], v10 offset:8192
s_add_u32 m0, s32, 4096
v_mfma_f32_32x32x16_bf16 v[240:255], a[164:167], a[180:183], v[240:255]
ds_read_b128 a[204:207], v10 offset:12288
buffer_load_dwordx4 v2, s[12:15], s48 offen lds
v_mfma_f32_32x32x16_bf16 a[0:15], a[168:171], a[180:183], a[0:15]
ds_read_b64_tr_b16 a[212:213], v14 offset:4096
s_add_u32 s25, s38, 32768
v_mfma_f32_32x32x16_bf16 a[16:31], a[172:175], a[180:183], a[16:31]
ds_read_b64_tr_b16 a[214:215], v14 offset:5120
buffer_store_dwordx4 v[48:51], v17, s[8:11], s25 offen offset:0 sc1
v_mfma_f32_32x32x16_bf16 a[32:47], a[160:163], a[184:187], a[32:47]
ds_read_b64_tr_b16 a[216:217], v15 offset:4096
s_add_u32 m0, s32, 8192
v_mfma_f32_32x32x16_bf16 a[48:63], a[164:167], a[184:187], a[48:63]
ds_read_b64_tr_b16 a[218:219], v15 offset:5120
buffer_load_dwordx4 v3, s[12:15], s48 offen lds
v_mfma_f32_32x32x16_bf16 a[64:79], a[168:171], a[184:187], a[64:79]
ds_read_b64_tr_b16 a[220:221], v16 offset:4096
v_mfma_f32_32x32x16_bf16 a[80:95], a[172:175], a[184:187], a[80:95]
ds_read_b64_tr_b16 a[222:223], v16 offset:5120
v_add_u32 v13, 16384, v13
v_and_b32 v13, 65535, v13
v_mfma_f32_32x32x16_bf16 a[96:111], a[160:163], a[188:191], a[96:111]
s_add_u32 m0, s32, 12288
v_add_u32 v14, 16384, v14
v_and_b32 v14, 65535, v14
v_mfma_f32_32x32x16_bf16 a[112:127], a[164:167], a[188:191], a[112:127]
buffer_load_dwordx4 v4, s[12:15], s48 offen lds
v_add_u32 v15, 16384, v15
v_and_b32 v15, 65535, v15
v_mfma_f32_32x32x16_bf16 a[128:143], a[168:171], a[188:191], a[128:143]
s_add_u32 s25, s38, 32768
v_add_u32 v16, 16384, v16
v_and_b32 v16, 65535, v16
v_mfma_f32_32x32x16_bf16 a[144:159], a[172:175], a[188:191], a[144:159]
buffer_store_dwordx4 v[52:55], v17, s[8:11], s25 offen offset:1024 sc1
s_waitcnt vmcnt(22) lgkmcnt(0)
s_barrier
v_mfma_f32_32x32x16_bf16 v[160:175], a[192:195], a[208:211], v[160:175]
ds_read_b64_tr_b16 a[176:177], v13 offset:0
s_mov_b32 m0, s33
v_mfma_f32_32x32x16_bf16 v[176:191], a[196:199], a[208:211], v[176:191]
ds_read_b64_tr_b16 a[178:179], v13 offset:1024
buffer_load_dwordx4 v5, s[20:23], s31 offen offset:0 lds
v_mfma_f32_32x32x16_bf16 v[192:207], a[200:203], a[208:211], v[192:207]
ds_read_b128 a[160:163], v11 offset:0
v_mfma_f32_32x32x16_bf16 v[208:223], a[204:207], a[208:211], v[208:223]
ds_read_b128 a[164:167], v11 offset:4096
v_mfma_f32_32x32x16_bf16 v[224:239], a[192:195], a[212:215], v[224:239]
ds_read_b128 a[168:171], v11 offset:8192
v_mfma_f32_32x32x16_bf16 v[240:255], a[196:199], a[212:215], v[240:255]
ds_read_b128 a[172:175], v11 offset:12288
buffer_load_dwordx4 v6, s[20:23], s31 offen offset:1024 lds
v_mfma_f32_32x32x16_bf16 a[0:15], a[200:203], a[212:215], a[0:15]
ds_read_b64_tr_b16 a[180:181], v14 offset:0
s_add_u32 s25, s38, 49152
v_mfma_f32_32x32x16_bf16 a[16:31], a[204:207], a[212:215], a[16:31]
ds_read_b64_tr_b16 a[182:183], v14 offset:1024
buffer_store_dwordx4 v[56:59], v17, s[8:11], s25 offen offset:0 sc1
v_mfma_f32_32x32x16_bf16 a[32:47], a[192:195], a[216:219], a[32:47]
ds_read_b64_tr_b16 a[184:185], v15 offset:0
v_mfma_f32_32x32x16_bf16 a[48:63], a[196:199], a[216:219], a[48:63]
ds_read_b64_tr_b16 a[186:187], v15 offset:1024
buffer_load_dwordx4 v7, s[20:23], s31 offen offset:2048 lds
v_mfma_f32_32x32x16_bf16 a[64:79], a[200:203], a[216:219], a[64:79]
ds_read_b64_tr_b16 a[188:189], v16 offset:0
v_mfma_f32_32x32x16_bf16 a[80:95], a[204:207], a[216:219], a[80:95]
ds_read_b64_tr_b16 a[190:191], v16 offset:1024
v_mfma_f32_32x32x16_bf16 a[96:111], a[192:195], a[220:223], a[96:111]
v_mfma_f32_32x32x16_bf16 a[112:127], a[196:199], a[220:223], a[112:127]
buffer_load_dwordx4 v8, s[20:23], s31 offen offset:3072 lds
v_mfma_f32_32x32x16_bf16 a[128:143], a[200:203], a[220:223], a[128:143]
s_add_u32 s31, s31, 262144
s_add_u32 s33, s33, 16384
s_and_b32 s33, s33, 65535
v_mfma_f32_32x32x16_bf16 a[144:159], a[204:207], a[220:223], a[144:159]
s_waitcnt lgkmcnt(0)
v_mfma_f32_32x32x16_bf16 v[160:175], a[160:163], a[176:179], v[160:175]
ds_read_b64_tr_b16 a[208:209], v13 offset:4096
s_add_u32 m0, s32, 16384
s_add_u32 s48, s30, s34
v_mfma_f32_32x32x16_bf16 v[176:191], a[164:167], a[176:179], v[176:191]
ds_read_b64_tr_b16 a[210:211], v13 offset:5120
buffer_load_dwordx4 v1, s[12:15], s48 offen lds
v_mfma_f32_32x32x16_bf16 v[192:207], a[168:171], a[176:179], v[192:207]
ds_read_b128 a[192:195], v12 offset:0
v_mfma_f32_32x32x16_bf16 v[208:223], a[172:175], a[176:179], v[208:223]
ds_read_b128 a[196:199], v12 offset:4096
v_mfma_f32_32x32x16_bf16 v[224:239], a[160:163], a[180:183], v[224:239]
ds_read_b128 a[200:203], v12 offset:8192
s_add_u32 m0, s32, 20480
v_mfma_f32_32x32x16_bf16 v[240:255], a[164:167], a[180:183], v[240:255]
ds_read_b128 a[204:207], v12 offset:12288
buffer_load_dwordx4 v2, s[12:15], s48 offen lds
v_mfma_f32_32x32x16_bf16 a[0:15], a[168:171], a[180:183], a[0:15]
ds_read_b64_tr_b16 a[212:213], v14 offset:4096
s_add_u32 s25, s38, 49152
v_mfma_f32_32x32x16_bf16 a[16:31], a[172:175], a[180:183], a[16:31]
ds_read_b64_tr_b16 a[214:215], v14 offset:5120
buffer_store_dwordx4 v[60:63], v17, s[8:11], s25 offen offset:1024 sc1
v_mfma_f32_32x32x16_bf16 a[32:47], a[160:163], a[184:187], a[32:47]
ds_read_b64_tr_b16 a[216:217], v15 offset:4096
s_add_u32 m0, s32, 24576
v_mfma_f32_32x32x16_bf16 a[48:63], a[164:167], a[184:187], a[48:63]
ds_read_b64_tr_b16 a[218:219], v15 offset:5120
buffer_load_dwordx4 v3, s[12:15], s48 offen lds
v_mfma_f32_32x32x16_bf16 a[64:79], a[168:171], a[184:187], a[64:79]
ds_read_b64_tr_b16 a[220:221], v16 offset:4096
v_mfma_f32_32x32x16_bf16 a[80:95], a[172:175], a[184:187], a[80:95]
ds_read_b64_tr_b16 a[222:223], v16 offset:5120
v_add_u32 v9, 32768, v9
v_subrev_u32 v20, 98304, v9
v_cmp_le_u32 vcc, 163840, v9
v_add_u32 v13, 16384, v13
v_mfma_f32_32x32x16_bf16 a[96:111], a[160:163], a[188:191], a[96:111]
s_add_u32 m0, s32, 28672
v_and_b32 v13, 65535, v13
v_add_u32 v14, 16384, v14
v_and_b32 v14, 65535, v14
v_add_u32 v15, 16384, v15
v_mfma_f32_32x32x16_bf16 a[112:127], a[164:167], a[188:191], a[112:127]
buffer_load_dwordx4 v4, s[12:15], s48 offen lds
v_and_b32 v15, 65535, v15
v_add_u32 v16, 16384, v16
v_and_b32 v16, 65535, v16
v_mfma_f32_32x32x16_bf16 a[128:143], a[168:171], a[188:191], a[128:143]
s_add_u32 s30, s30, 128
s_add_u32 s32, s32, 32768
s_sub_u32 s24, s32, 98304
s_cmp_ge_u32 s32, 163840
s_cselect_b32 s32, s24, s32
v_cndmask_b32 v9, v9, v20, vcc
v_xor_b32 v10, 32, v9
v_xor_b32 v11, 64, v9
v_xor_b32 v12, 96, v9
v_mfma_f32_32x32x16_bf16 a[144:159], a[172:175], a[188:191], a[144:159]
s_waitcnt vmcnt(21) lgkmcnt(0)
s_barrier
v_mfma_f32_32x32x16_bf16 v[160:175], a[192:195], a[208:211], v[160:175]
ds_read_b64_tr_b16 a[176:177], v13 offset:0
s_mov_b32 m0, s33
v_mfma_f32_32x32x16_bf16 v[176:191], a[196:199], a[208:211], v[176:191]
ds_read_b64_tr_b16 a[178:179], v13 offset:1024
buffer_load_dwordx4 v5, s[20:23], s31 offen offset:0 lds
v_mfma_f32_32x32x16_bf16 v[192:207], a[200:203], a[208:211], v[192:207]
ds_read_b128 a[160:163], v9 offset:0
v_mfma_f32_32x32x16_bf16 v[208:223], a[204:207], a[208:211], v[208:223]
ds_read_b128 a[164:167], v9 offset:4096
v_mfma_f32_32x32x16_bf16 v[224:239], a[192:195], a[212:215], v[224:239]
ds_read_b128 a[168:171], v9 offset:8192
v_mfma_f32_32x32x16_bf16 v[240:255], a[196:199], a[212:215], v[240:255]
ds_read_b128 a[172:175], v9 offset:12288
buffer_load_dwordx4 v6, s[20:23], s31 offen offset:1024 lds
v_mfma_f32_32x32x16_bf16 a[0:15], a[200:203], a[212:215], a[0:15]
ds_read_b64_tr_b16 a[180:181], v14 offset:0
s_add_u32 s25, s38, 2048
v_mfma_f32_32x32x16_bf16 a[16:31], a[204:207], a[212:215], a[16:31]
ds_read_b64_tr_b16 a[182:183], v14 offset:1024
buffer_store_dwordx4 v[64:67], v17, s[8:11], s25 offen offset:0 sc1
v_mfma_f32_32x32x16_bf16 a[32:47], a[192:195], a[216:219], a[32:47]
ds_read_b64_tr_b16 a[184:185], v15 offset:0
v_mfma_f32_32x32x16_bf16 a[48:63], a[196:199], a[216:219], a[48:63]
ds_read_b64_tr_b16 a[186:187], v15 offset:1024
buffer_load_dwordx4 v7, s[20:23], s31 offen offset:2048 lds
v_mfma_f32_32x32x16_bf16 a[64:79], a[200:203], a[216:219], a[64:79]
ds_read_b64_tr_b16 a[188:189], v16 offset:0
v_mfma_f32_32x32x16_bf16 a[80:95], a[204:207], a[216:219], a[80:95]
ds_read_b64_tr_b16 a[190:191], v16 offset:1024
v_mfma_f32_32x32x16_bf16 a[96:111], a[192:195], a[220:223], a[96:111]
v_mfma_f32_32x32x16_bf16 a[112:127], a[196:199], a[220:223], a[112:127]
buffer_load_dwordx4 v8, s[20:23], s31 offen offset:3072 lds
v_mfma_f32_32x32x16_bf16 a[128:143], a[200:203], a[220:223], a[128:143]
s_add_u32 s31, s31, 262144
s_add_u32 s33, s33, 16384
s_and_b32 s33, s33, 65535
s_add_u32 s25, s38, 2048
v_mfma_f32_32x32x16_bf16 a[144:159], a[204:207], a[220:223], a[144:159]
buffer_store_dwordx4 v[68:71], v17, s[8:11], s25 offen offset:1024 sc1
s_waitcnt lgkmcnt(0)
v_mfma_f32_32x32x16_bf16 v[160:175], a[160:163], a[176:179], v[160:175]
ds_read_b64_tr_b16 a[208:209], v13 offset:4096
s_add_u32 m0, s32, 0
s_mov_b32 s48, s30
v_mfma_f32_32x32x16_bf16 v[176:191], a[164:167], a[176:179], v[176:191]
ds_read_b64_tr_b16 a[210:211], v13 offset:5120
buffer_load_dwordx4 v1, s[12:15], s48 offen lds
v_mfma_f32_32x32x16_bf16 v[192:207], a[168:171], a[176:179], v[192:207]
ds_read_b128 a[192:195], v10 offset:0
v_mfma_f32_32x32x16_bf16 v[208:223], a[172:175], a[176:179], v[208:223]
ds_read_b128 a[196:199], v10 offset:4096
v_mfma_f32_32x32x16_bf16 v[224:239], a[160:163], a[180:183], v[224:239]
ds_read_b128 a[200:203], v10 offset:8192
s_add_u32 m0, s32, 4096
v_mfma_f32_32x32x16_bf16 v[240:255], a[164:167], a[180:183], v[240:255]
ds_read_b128 a[204:207], v10 offset:12288
buffer_load_dwordx4 v2, s[12:15], s48 offen lds
v_mfma_f32_32x32x16_bf16 a[0:15], a[168:171], a[180:183], a[0:15]
ds_read_b64_tr_b16 a[212:213], v14 offset:4096
s_add_u32 s25, s38, 18432
v_mfma_f32_32x32x16_bf16 a[16:31], a[172:175], a[180:183], a[16:31]
ds_read_b64_tr_b16 a[214:215], v14 offset:5120
buffer_store_dwordx4 v[72:75], v17, s[8:11], s25 offen offset:0 sc1
v_mfma_f32_32x32x16_bf16 a[32:47], a[160:163], a[184:187], a[32:47]
ds_read_b64_tr_b16 a[216:217], v15 offset:4096
s_add_u32 m0, s32, 8192
v_mfma_f32_32x32x16_bf16 a[48:63], a[164:167], a[184:187], a[48:63]
ds_read_b64_tr_b16 a[218:219], v15 offset:5120
buffer_load_dwordx4 v3, s[12:15], s48 offen lds
v_mfma_f32_32x32x16_bf16 a[64:79], a[168:171], a[184:187], a[64:79]
ds_read_b64_tr_b16 a[220:221], v16 offset:4096
v_mfma_f32_32x32x16_bf16 a[80:95], a[172:175], a[184:187], a[80:95]
ds_read_b64_tr_b16 a[222:223], v16 offset:5120
v_add_u32 v13, 16384, v13
v_and_b32 v13, 65535, v13
v_mfma_f32_32x32x16_bf16 a[96:111], a[160:163], a[188:191], a[96:111]
s_add_u32 m0, s32, 12288
v_add_u32 v14, 16384, v14
v_and_b32 v14, 65535, v14
v_mfma_f32_32x32x16_bf16 a[112:127], a[164:167], a[188:191], a[112:127]
buffer_load_dwordx4 v4, s[12:15], s48 offen lds
v_add_u32 v15, 16384, v15
v_and_b32 v15, 65535, v15
v_mfma_f32_32x32x16_bf16 a[128:143], a[168:171], a[188:191], a[128:143]
v_add_u32 v16, 16384, v16
v_and_b32 v16, 65535, v16
v_mfma_f32_32x32x16_bf16 a[144:159], a[172:175], a[188:191], a[144:159]
s_waitcnt vmcnt(21) lgkmcnt(0)
s_barrier
v_mfma_f32_32x32x16_bf16 v[160:175], a[192:195], a[208:211], v[160:175]
ds_read_b64_tr_b16 a[176:177], v13 offset:0
s_mov_b32 m0, s33
v_mfma_f32_32x32x16_bf16 v[176:191], a[196:199], a[208:211], v[176:191]
ds_read_b64_tr_b16 a[178:179], v13 offset:1024
buffer_load_dwordx4 v5, s[20:23], s31 offen offset:0 lds
v_mfma_f32_32x32x16_bf16 v[192:207], a[200:203], a[208:211], v[192:207]
ds_read_b128 a[160:163], v11 offset:0
v_mfma_f32_32x32x16_bf16 v[208:223], a[204:207], a[208:211], v[208:223]
ds_read_b128 a[164:167], v11 offset:4096
v_mfma_f32_32x32x16_bf16 v[224:239], a[192:195], a[212:215], v[224:239]
ds_read_b128 a[168:171], v11 offset:8192
v_mfma_f32_32x32x16_bf16 v[240:255], a[196:199], a[212:215], v[240:255]
ds_read_b128 a[172:175], v11 offset:12288
buffer_load_dwordx4 v6, s[20:23], s31 offen offset:1024 lds
v_mfma_f32_32x32x16_bf16 a[0:15], a[200:203], a[212:215], a[0:15]
ds_read_b64_tr_b16 a[180:181], v14 offset:0
s_add_u32 s25, s38, 18432
v_mfma_f32_32x32x16_bf16 a[16:31], a[204:207], a[212:215], a[16:31]
ds_read_b64_tr_b16 a[182:183], v14 offset:1024
buffer_store_dwordx4 v[76:79], v17, s[8:11], s25 offen offset:1024 sc1
v_mfma_f32_32x32x16_bf16 a[32:47], a[192:195], a[216:219], a[32:47]
ds_read_b64_tr_b16 a[184:185], v15 offset:0
v_mfma_f32_32x32x16_bf16 a[48:63], a[196:199], a[216:219], a[48:63]
ds_read_b64_tr_b16 a[186:187], v15 offset:1024
buffer_load_dwordx4 v7, s[20:23], s31 offen offset:2048 lds
v_mfma_f32_32x32x16_bf16 a[64:79], a[200:203], a[216:219], a[64:79]
ds_read_b64_tr_b16 a[188:189], v16 offset:0
v_mfma_f32_32x32x16_bf16 a[80:95], a[204:207], a[216:219], a[80:95]
ds_read_b64_tr_b16 a[190:191], v16 offset:1024
v_mfma_f32_32x32x16_bf16 a[96:111], a[192:195], a[220:223], a[96:111]
v_mfma_f32_32x32x16_bf16 a[112:127], a[196:199], a[220:223], a[112:127]
buffer_load_dwordx4 v8, s[20:23], s31 offen offset:3072 lds
v_mfma_f32_32x32x16_bf16 a[128:143], a[200:203], a[220:223], a[128:143]
s_add_u32 s31, s31, 262144
s_add_u32 s33, s33, 16384
s_and_b32 s33, s33, 65535
v_mfma_f32_32x32x16_bf16 a[144:159], a[204:207], a[220:223], a[144:159]
s_waitcnt lgkmcnt(0)
v_mfma_f32_32x32x16_bf16 v[160:175], a[160:163], a[176:179], v[160:175]
ds_read_b64_tr_b16 a[208:209], v13 offset:4096
s_add_u32 m0, s32, 16384
s_add_u32 s48, s30, s34
v_mfma_f32_32x32x16_bf16 v[176:191], a[164:167], a[176:179], v[176:191]
ds_read_b64_tr_b16 a[210:211], v13 offset:5120
buffer_load_dwordx4 v1, s[12:15], s48 offen lds
v_mfma_f32_32x32x16_bf16 v[192:207], a[168:171], a[176:179], v[192:207]
ds_read_b128 a[192:195], v12 offset:0
v_mfma_f32_32x32x16_bf16 v[208:223], a[172:175], a[176:179], v[208:223]
ds_read_b128 a[196:199], v12 offset:4096
v_mfma_f32_32x32x16_bf16 v[224:239], a[160:163], a[180:183], v[224:239]
ds_read_b128 a[200:203], v12 offset:8192
s_add_u32 m0, s32, 20480
v_mfma_f32_32x32x16_bf16 v[240:255], a[164:167], a[180:183], v[240:255]
ds_read_b128 a[204:207], v12 offset:12288
buffer_load_dwordx4 v2, s[12:15], s48 offen lds
v_mfma_f32_32x32x16_bf16 a[0:15], a[168:171], a[180:183], a[0:15]
ds_read_b64_tr_b16 a[212:213], v14 offset:4096
s_add_u32 s25, s38, 34816
v_mfma_f32_32x32x16_bf16 a[16:31], a[172:175], a[180:183], a[16:31]
ds_read_b64_tr_b16 a[214:215], v14 offset:5120
buffer_store_dwordx4 v[80:83], v17, s[8:11], s25 offen offset:0 sc1
v_mfma_f32_32x32x16_bf16 a[32:47], a[160:163], a[184:187], a[32:47]
ds_read_b64_tr_b16 a[216:217], v15 offset:4096
s_add_u32 m0, s32, 24576
v_mfma_f32_32x32x16_bf16 a[48:63], a[164:167], a[184:187], a[48:63]
ds_read_b64_tr_b16 a[218:219], v15 offset:5120
buffer_load_dwordx4 v3, s[12:15], s48 offen lds
v_mfma_f32_32x32x16_bf16 a[64:79], a[168:171], a[184:187], a[64:79]
ds_read_b64_tr_b16 a[220:221], v16 offset:4096
v_mfma_f32_32x32x16_bf16 a[80:95], a[172:175], a[184:187], a[80:95]
ds_read_b64_tr_b16 a[222:223], v16 offset:5120
v_add_u32 v9, 32768, v9
v_subrev_u32 v20, 98304, v9
v_cmp_le_u32 vcc, 163840, v9
v_add_u32 v13, 16384, v13
v_mfma_f32_32x32x16_bf16 a[96:111], a[160:163], a[188:191], a[96:111]
s_add_u32 m0, s32, 28672
v_and_b32 v13, 65535, v13
v_add_u32 v14, 16384, v14
v_and_b32 v14, 65535, v14
v_add_u32 v15, 16384, v15
v_mfma_f32_32x32x16_bf16 a[112:127], a[164:167], a[188:191], a[112:127]
buffer_load_dwordx4 v4, s[12:15], s48 offen lds
v_and_b32 v15, 65535, v15
v_add_u32 v16, 16384, v16
v_and_b32 v16, 65535, v16
v_mfma_f32_32x32x16_bf16 a[128:143], a[168:171], a[188:191], a[128:143]
s_add_u32 s30, s30, 128
s_add_u32 s32, s32, 32768
s_sub_u32 s24, s32, 98304
s_cmp_ge_u32 s32, 163840
s_cselect_b32 s32, s24, s32
s_add_u32 s25, s38, 34816
v_cndmask_b32 v9, v9, v20, vcc
v_xor_b32 v10, 32, v9
v_xor_b32 v11, 64, v9
v_xor_b32 v12, 96, v9
v_mfma_f32_32x32x16_bf16 a[144:159], a[172:175], a[188:191], a[144:159]
buffer_store_dwordx4 v[84:87], v17, s[8:11], s25 offen offset:1024 sc1
s_waitcnt vmcnt(22) lgkmcnt(0)
s_barrier
v_mfma_f32_32x32x16_bf16 v[160:175], a[192:195], a[208:211], v[160:175]
ds_read_b64_tr_b16 a[176:177], v13 offset:0
s_mov_b32 m0, s33
v_mfma_f32_32x32x16_bf16 v[176:191], a[196:199], a[208:211], v[176:191]
ds_read_b64_tr_b16 a[178:179], v13 offset:1024
buffer_load_dwordx4 v5, s[20:23], s31 offen offset:0 lds
v_mfma_f32_32x32x16_bf16 v[192:207], a[200:203], a[208:211], v[192:207]
ds_read_b128 a[160:163], v9 offset:0
v_mfma_f32_32x32x16_bf16 v[208:223], a[204:207], a[208:211], v[208:223]
ds_read_b128 a[164:167], v9 offset:4096
v_mfma_f32_32x32x16_bf16 v[224:239], a[192:195], a[212:215], v[224:239]
ds_read_b128 a[168:171], v9 offset:8192
v_mfma_f32_32x32x16_bf16 v[240:255], a[196:199], a[212:215], v[240:255]
ds_read_b128 a[172:175], v9 offset:12288
buffer_load_dwordx4 v6, s[20:23], s31 offen offset:1024 lds
v_mfma_f32_32x32x16_bf16 a[0:15], a[200:203], a[212:215], a[0:15]
ds_read_b64_tr_b16 a[180:181], v14 offset:0
s_add_u32 s25, s38, 51200
v_mfma_f32_32x32x16_bf16 a[16:31], a[204:207], a[212:215], a[16:31]
ds_read_b64_tr_b16 a[182:183], v14 offset:1024
buffer_store_dwordx4 v[88:91], v17, s[8:11], s25 offen offset:0 sc1
v_mfma_f32_32x32x16_bf16 a[32:47], a[192:195], a[216:219], a[32:47]
ds_read_b64_tr_b16 a[184:185], v15 offset:0
v_mfma_f32_32x32x16_bf16 a[48:63], a[196:199], a[216:219], a[48:63]
ds_read_b64_tr_b16 a[186:187], v15 offset:1024
buffer_load_dwordx4 v7, s[20:23], s31 offen offset:2048 lds
v_mfma_f32_32x32x16_bf16 a[64:79], a[200:203], a[216:219], a[64:79]
ds_read_b64_tr_b16 a[188:189], v16 offset:0
v_mfma_f32_32x32x16_bf16 a[80:95], a[204:207], a[216:219], a[80:95]
ds_read_b64_tr_b16 a[190:191], v16 offset:1024
v_mfma_f32_32x32x16_bf16 a[96:111], a[192:195], a[220:223], a[96:111]
v_mfma_f32_32x32x16_bf16 a[112:127], a[196:199], a[220:223], a[112:127]
buffer_load_dwordx4 v8, s[20:23], s31 offen offset:3072 lds
v_mfma_f32_32x32x16_bf16 a[128:143], a[200:203], a[220:223], a[128:143]
s_add_u32 s31, s31, 262144
s_add_u32 s33, s33, 16384
s_and_b32 s33, s33, 65535
v_mfma_f32_32x32x16_bf16 a[144:159], a[204:207], a[220:223], a[144:159]
s_waitcnt lgkmcnt(0)
v_mfma_f32_32x32x16_bf16 v[160:175], a[160:163], a[176:179], v[160:175]
ds_read_b64_tr_b16 a[208:209], v13 offset:4096
s_add_u32 m0, s32, 0
s_mov_b32 s48, s30
v_mfma_f32_32x32x16_bf16 v[176:191], a[164:167], a[176:179], v[176:191]
ds_read_b64_tr_b16 a[210:211], v13 offset:5120
buffer_load_dwordx4 v1, s[12:15], s48 offen lds
v_mfma_f32_32x32x16_bf16 v[192:207], a[168:171], a[176:179], v[192:207]
ds_read_b128 a[192:195], v10 offset:0
v_mfma_f32_32x32x16_bf16 v[208:223], a[172:175], a[176:179], v[208:223]
ds_read_b128 a[196:199], v10 offset:4096
v_mfma_f32_32x32x16_bf16 v[224:239], a[160:163], a[180:183], v[224:239]
ds_read_b128 a[200:203], v10 offset:8192
s_add_u32 m0, s32, 4096
v_mfma_f32_32x32x16_bf16 v[240:255], a[164:167], a[180:183], v[240:255]
ds_read_b128 a[204:207], v10 offset:12288
buffer_load_dwordx4 v2, s[12:15], s48 offen lds
v_mfma_f32_32x32x16_bf16 a[0:15], a[168:171], a[180:183], a[0:15]
ds_read_b64_tr_b16 a[212:213], v14 offset:4096
s_add_u32 s25, s38, 51200
v_mfma_f32_32x32x16_bf16 a[16:31], a[172:175], a[180:183], a[16:31]
ds_read_b64_tr_b16 a[214:215], v14 offset:5120
buffer_store_dwordx4 v[92:95], v17, s[8:11], s25 offen offset:1024 sc1
v_mfma_f32_32x32x16_bf16 a[32:47], a[160:163], a[184:187], a[32:47]
ds_read_b64_tr_b16 a[216:217], v15 offset:4096
s_add_u32 m0, s32, 8192
v_mfma_f32_32x32x16_bf16 a[48:63], a[164:167], a[184:187], a[48:63]
ds_read_b64_tr_b16 a[218:219], v15 offset:5120
buffer_load_dwordx4 v3, s[12:15], s48 offen lds
v_mfma_f32_32x32x16_bf16 a[64:79], a[168:171], a[184:187], a[64:79]
ds_read_b64_tr_b16 a[220:221], v16 offset:4096
v_mfma_f32_32x32x16_bf16 a[80:95], a[172:175], a[184:187], a[80:95]
ds_read_b64_tr_b16 a[222:223], v16 offset:5120
v_add_u32 v13, 16384, v13
v_and_b32 v13, 65535, v13
v_mfma_f32_32x32x16_bf16 a[96:111], a[160:163], a[188:191], a[96:111]
s_add_u32 m0, s32, 12288
v_add_u32 v14, 16384, v14
v_and_b32 v14, 65535, v14
v_mfma_f32_32x32x16_bf16 a[112:127], a[164:167], a[188:191], a[112:127]
buffer_load_dwordx4 v4, s[12:15], s48 offen lds
v_add_u32 v15, 16384, v15
v_and_b32 v15, 65535, v15
v_mfma_f32_32x32x16_bf16 a[128:143], a[168:171], a[188:191], a[128:143]
v_add_u32 v16, 16384, v16
v_and_b32 v16, 65535, v16
v_mfma_f32_32x32x16_bf16 a[144:159], a[172:175], a[188:191], a[144:159]
s_waitcnt vmcnt(21) lgkmcnt(0)
s_barrier
v_mfma_f32_32x32x16_bf16 v[160:175], a[192:195], a[208:211], v[160:175]
ds_read_b64_tr_b16 a[176:177], v13 offset:0
s_mov_b32 m0, s33
v_mfma_f32_32x32x16_bf16 v[176:191], a[196:199], a[208:211], v[176:191]
ds_read_b64_tr_b16 a[178:179], v13 offset:1024
buffer_load_dwordx4 v5, s[20:23], s31 offen offset:0 lds
v_mfma_f32_32x32x16_bf16 v[192:207], a[200:203], a[208:211], v[192:207]
ds_read_b128 a[160:163], v11 offset:0
v_mfma_f32_32x32x16_bf16 v[208:223], a[204:207], a[208:211], v[208:223]
ds_read_b128 a[164:167], v11 offset:4096
v_mfma_f32_32x32x16_bf16 v[224:239], a[192:195], a[212:215], v[224:239]
ds_read_b128 a[168:171], v11 offset:8192
v_mfma_f32_32x32x16_bf16 v[240:255], a[196:199], a[212:215], v[240:255]
ds_read_b128 a[172:175], v11 offset:12288
buffer_load_dwordx4 v6, s[20:23], s31 offen offset:1024 lds
v_mfma_f32_32x32x16_bf16 a[0:15], a[200:203], a[212:215], a[0:15]
ds_read_b64_tr_b16 a[180:181], v14 offset:0
s_add_u32 s25, s38, 4096
v_mfma_f32_32x32x16_bf16 a[16:31], a[204:207], a[212:215], a[16:31]
ds_read_b64_tr_b16 a[182:183], v14 offset:1024
buffer_store_dwordx4 v[96:99], v17, s[8:11], s25 offen offset:0 sc1
v_mfma_f32_32x32x16_bf16 a[32:47], a[192:195], a[216:219], a[32:47]
ds_read_b64_tr_b16 a[184:185], v15 offset:0
v_mfma_f32_32x32x16_bf16 a[48:63], a[196:199], a[216:219], a[48:63]
ds_read_b64_tr_b16 a[186:187], v15 offset:1024
buffer_load_dwordx4 v7, s[20:23], s31 offen offset:2048 lds
v_mfma_f32_32x32x16_bf16 a[64:79], a[200:203], a[216:219], a[64:79]
ds_read_b64_tr_b16 a[188:189], v16 offset:0
v_mfma_f32_32x32x16_bf16 a[80:95], a[204:207], a[216:219], a[80:95]
ds_read_b64_tr_b16 a[190:191], v16 offset:1024
v_mfma_f32_32x32x16_bf16 a[96:111], a[192:195], a[220:223], a[96:111]
v_mfma_f32_32x32x16_bf16 a[112:127], a[196:199], a[220:223], a[112:127]
buffer_load_dwordx4 v8, s[20:23], s31 offen offset:3072 lds
v_mfma_f32_32x32x16_bf16 a[128:143], a[200:203], a[220:223], a[128:143]
s_add_u32 s31, s31, 262144
s_add_u32 s33, s33, 16384
s_and_b32 s33, s33, 65535
s_add_u32 s25, s38, 4096
v_mfma_f32_32x32x16_bf16 a[144:159], a[204:207], a[220:223], a[144:159]
buffer_store_dwordx4 v[100:103], v17, s[8:11], s25 offen offset:1024 sc1
s_waitcnt lgkmcnt(0)
v_mfma_f32_32x32x16_bf16 v[160:175], a[160:163], a[176:179], v[160:175]
ds_read_b64_tr_b16 a[208:209], v13 offset:4096
s_add_u32 m0, s32, 16384
s_add_u32 s48, s30, s34
v_mfma_f32_32x32x16_bf16 v[176:191], a[164:167], a[176:179], v[176:191]
ds_read_b64_tr_b16 a[210:211], v13 offset:5120
buffer_load_dwordx4 v1, s[12:15], s48 offen lds
v_mfma_f32_32x32x16_bf16 v[192:207], a[168:171], a[176:179], v[192:207]
ds_read_b128 a[192:195], v12 offset:0
v_mfma_f32_32x32x16_bf16 v[208:223], a[172:175], a[176:179], v[208:223]
ds_read_b128 a[196:199], v12 offset:4096
v_mfma_f32_32x32x16_bf16 v[224:239], a[160:163], a[180:183], v[224:239]
ds_read_b128 a[200:203], v12 offset:8192
s_add_u32 m0, s32, 20480
v_mfma_f32_32x32x16_bf16 v[240:255], a[164:167], a[180:183], v[240:255]
ds_read_b128 a[204:207], v12 offset:12288
buffer_load_dwordx4 v2, s[12:15], s48 offen lds
v_mfma_f32_32x32x16_bf16 a[0:15], a[168:171], a[180:183], a[0:15]
ds_read_b64_tr_b16 a[212:213], v14 offset:4096
s_add_u32 s25, s38, 20480
v_mfma_f32_32x32x16_bf16 a[16:31], a[172:175], a[180:183], a[16:31]
ds_read_b64_tr_b16 a[214:215], v14 offset:5120
buffer_store_dwordx4 v[104:107], v17, s[8:11], s25 offen offset:0 sc1
v_mfma_f32_32x32x16_bf16 a[32:47], a[160:163], a[184:187], a[32:47]
ds_read_b64_tr_b16 a[216:217], v15 offset:4096
s_add_u32 m0, s32, 24576
v_mfma_f32_32x32x16_bf16 a[48:63], a[164:167], a[184:187], a[48:63]
ds_read_b64_tr_b16 a[218:219], v15 offset:5120
buffer_load_dwordx4 v3, s[12:15], s48 offen lds
v_mfma_f32_32x32x16_bf16 a[64:79], a[168:171], a[184:187], a[64:79]
ds_read_b64_tr_b16 a[220:221], v16 offset:4096
v_mfma_f32_32x32x16_bf16 a[80:95], a[172:175], a[184:187], a[80:95]
ds_read_b64_tr_b16 a[222:223], v16 offset:5120
v_add_u32 v9, 32768, v9
v_subrev_u32 v20, 98304, v9
v_cmp_le_u32 vcc, 163840, v9
v_add_u32 v13, 16384, v13
v_mfma_f32_32x32x16_bf16 a[96:111], a[160:163], a[188:191], a[96:111]
s_add_u32 m0, s32, 28672
v_and_b32 v13, 65535, v13
v_add_u32 v14, 16384, v14
v_and_b32 v14, 65535, v14
v_add_u32 v15, 16384, v15
v_mfma_f32_32x32x16_bf16 a[112:127], a[164:167], a[188:191], a[112:127]
buffer_load_dwordx4 v4, s[12:15], s48 offen lds
v_and_b32 v15, 65535, v15
v_add_u32 v16, 16384, v16
v_and_b32 v16, 65535, v16
v_mfma_f32_32x32x16_bf16 a[128:143], a[168:171], a[188:191], a[128:143]
s_add_u32 s30, s30, 128
s_add_u32 s32, s32, 32768
s_sub_u32 s24, s32, 98304
s_cmp_ge_u32 s32, 163840
s_cselect_b32 s32, s24, s32
v_cndmask_b32 v9, v9, v20, vcc
v_xor_b32 v10, 32, v9
v_xor_b32 v11, 64, v9
v_xor_b32 v12, 96, v9
v_mfma_f32_32x32x16_bf16 a[144:159], a[172:175], a[188:191], a[144:159]
s_waitcnt vmcnt(21) lgkmcnt(0)
s_barrier
v_mfma_f32_32x32x16_bf16 v[160:175], a[192:195], a[208:211], v[160:175]
ds_read_b64_tr_b16 a[176:177], v13 offset:0
s_mov_b32 m0, s33
v_mfma_f32_32x32x16_bf16 v[176:191], a[196:199], a[208:211], v[176:191]
ds_read_b64_tr_b16 a[178:179], v13 offset:1024
buffer_load_dwordx4 v5, s[20:23], s31 offen offset:0 lds
v_mfma_f32_32x32x16_bf16 v[192:207], a[200:203], a[208:211], v[192:207]
ds_read_b128 a[160:163], v9 offset:0
v_mfma_f32_32x32x16_bf16 v[208:223], a[204:207], a[208:211], v[208:223]
ds_read_b128 a[164:167], v9 offset:4096
v_mfma_f32_32x32x16_bf16 v[224:239], a[192:195], a[212:215], v[224:239]
ds_read_b128 a[168:171], v9 offset:8192
v_mfma_f32_32x32x16_bf16 v[240:255], a[196:199], a[212:215], v[240:255]
ds_read_b128 a[172:175], v9 offset:12288
buffer_load_dwordx4 v6, s[20:23], s31 offen offset:1024 lds
v_mfma_f32_32x32x16_bf16 a[0:15], a[200:203], a[212:215], a[0:15]
ds_read_b64_tr_b16 a[180:181], v14 offset:0
s_add_u32 s25, s38, 20480
v_mfma_f32_32x32x16_bf16 a[16:31], a[204:207], a[212:215], a[16:31]
ds_read_b64_tr_b16 a[182:183], v14 offset:1024
buffer_store_dwordx4 v[108:111], v17, s[8:11], s25 offen offset:1024 sc1
v_mfma_f32_32x32x16_bf16 a[32:47], a[192:195], a[216:219], a[32:47]
ds_read_b64_tr_b16 a[184:185], v15 offset:0
v_mfma_f32_32x32x16_bf16 a[48:63], a[196:199], a[216:219], a[48:63]
ds_read_b64_tr_b16 a[186:187], v15 offset:1024
buffer_load_dwordx4 v7, s[20:23], s31 offen offset:2048 lds
v_mfma_f32_32x32x16_bf16 a[64:79], a[200:203], a[216:219], a[64:79]
ds_read_b64_tr_b16 a[188:189], v16 offset:0
v_mfma_f32_32x32x16_bf16 a[80:95], a[204:207], a[216:219], a[80:95]
ds_read_b64_tr_b16 a[190:191], v16 offset:1024
v_mfma_f32_32x32x16_bf16 a[96:111], a[192:195], a[220:223], a[96:111]
v_mfma_f32_32x32x16_bf16 a[112:127], a[196:199], a[220:223], a[112:127]
buffer_load_dwordx4 v8, s[20:23], s31 offen offset:3072 lds
v_mfma_f32_32x32x16_bf16 a[128:143], a[200:203], a[220:223], a[128:143]
s_add_u32 s31, s31, 262144
s_add_u32 s33, s33, 16384
s_and_b32 s33, s33, 65535
v_mfma_f32_32x32x16_bf16 a[144:159], a[204:207], a[220:223], a[144:159]
s_waitcnt lgkmcnt(0)
v_mfma_f32_32x32x16_bf16 v[160:175], a[160:163], a[176:179], v[160:175]
ds_read_b64_tr_b16 a[208:209], v13 offset:4096
s_add_u32 m0, s32, 0
s_mov_b32 s48, s30
v_mfma_f32_32x32x16_bf16 v[176:191], a[164:167], a[176:179], v[176:191]
ds_read_b64_tr_b16 a[210:211], v13 offset:5120
buffer_load_dwordx4 v1, s[12:15], s48 offen lds
v_mfma_f32_32x32x16_bf16 v[192:207], a[168:171], a[176:179], v[192:207]
ds_read_b128 a[192:195], v10 offset:0
v_mfma_f32_32x32x16_bf16 v[208:223], a[172:175], a[176:179], v[208:223]
ds_read_b128 a[196:199], v10 offset:4096
v_mfma_f32_32x32x16_bf16 v[224:239], a[160:163], a[180:183], v[224:239]
ds_read_b128 a[200:203], v10 offset:8192
s_add_u32 m0, s32, 4096
v_mfma_f32_32x32x16_bf16 v[240:255], a[164:167], a[180:183], v[240:255]
ds_read_b128 a[204:207], v10 offset:12288
buffer_load_dwordx4 v2, s[12:15], s48 offen lds
v_mfma_f32_32x32x16_bf16 a[0:15], a[168:171], a[180:183], a[0:15]
ds_read_b64_tr_b16 a[212:213], v14 offset:4096
s_add_u32 s25, s38, 36864
v_mfma_f32_32x32x16_bf16 a[16:31], a[172:175], a[180:183], a[16:31]
ds_read_b64_tr_b16 a[214:215], v14 offset:5120
buffer_store_dwordx4 v[112:115], v17, s[8:11], s25 offen offset:0 sc1
v_mfma_f32_32x32x16_bf16 a[32:47], a[160:163], a[184:187], a[32:47]
ds_read_b64_tr_b16 a[216:217], v15 offset:4096
s_add_u32 m0, s32, 8192
v_mfma_f32_32x32x16_bf16 a[48:63], a[164:167], a[184:187], a[48:63]
ds_read_b64_tr_b16 a[218:219], v15 offset:5120
buffer_load_dwordx4 v3, s[12:15], s48 offen lds
v_mfma_f32_32x32x16_bf16 a[64:79], a[168:171], a[184:187], a[64:79]
ds_read_b64_tr_b16 a[220:221], v16 offset:4096
v_mfma_f32_32x32x16_bf16 a[80:95], a[172:175], a[184:187], a[80:95]
ds_read_b64_tr_b16 a[222:223], v16 offset:5120
v_add_u32 v13, 16384, v13
v_and_b32 v13, 65535, v13
v_mfma_f32_32x32x16_bf16 a[96:111], a[160:163], a[188:191], a[96:111]
s_add_u32 m0, s32, 12288
v_add_u32 v14, 16384, v14
v_and_b32 v14, 65535, v14
v_mfma_f32_32x32x16_bf16 a[112:127], a[164:167], a[188:191], a[112:127]
buffer_load_dwordx4 v4, s[12:15], s48 offen lds
v_add_u32 v15, 16384, v15
v_and_b32 v15, 65535, v15
v_mfma_f32_32x32x16_bf16 a[128:143], a[168:171], a[188:191], a[128:143]
s_add_u32 s25, s38, 36864
v_add_u32 v16, 16384, v16
v_and_b32 v16, 65535, v16
v_mfma_f32_32x32x16_bf16 a[144:159], a[172:175], a[188:191], a[144:159]
buffer_store_dwordx4 v[116:119], v17, s[8:11], s25 offen offset:1024 sc1
s_waitcnt vmcnt(22) lgkmcnt(0)
s_barrier
v_mfma_f32_32x32x16_bf16 v[160:175], a[192:195], a[208:211], v[160:175]
ds_read_b64_tr_b16 a[176:177], v13 offset:0
s_mov_b32 m0, s33
v_mfma_f32_32x32x16_bf16 v[176:191], a[196:199], a[208:211], v[176:191]
ds_read_b64_tr_b16 a[178:179], v13 offset:1024
buffer_load_dwordx4 v5, s[20:23], s31 offen offset:0 lds
v_mfma_f32_32x32x16_bf16 v[192:207], a[200:203], a[208:211], v[192:207]
ds_read_b128 a[160:163], v11 offset:0
v_mfma_f32_32x32x16_bf16 v[208:223], a[204:207], a[208:211], v[208:223]
ds_read_b128 a[164:167], v11 offset:4096
v_mfma_f32_32x32x16_bf16 v[224:239], a[192:195], a[212:215], v[224:239]
ds_read_b128 a[168:171], v11 offset:8192
v_mfma_f32_32x32x16_bf16 v[240:255], a[196:199], a[212:215], v[240:255]
ds_read_b128 a[172:175], v11 offset:12288
buffer_load_dwordx4 v6, s[20:23], s31 offen offset:1024 lds
v_mfma_f32_32x32x16_bf16 a[0:15], a[200:203], a[212:215], a[0:15]
ds_read_b64_tr_b16 a[180:181], v14 offset:0
s_add_u32 s25, s38, 53248
v_mfma_f32_32x32x16_bf16 a[16:31], a[204:207], a[212:215], a[16:31]
ds_read_b64_tr_b16 a[182:183], v14 offset:1024
buffer_store_dwordx4 v[120:123], v17, s[8:11], s25 offen offset:0 sc1
v_mfma_f32_32x32x16_bf16 a[32:47], a[192:195], a[216:219], a[32:47]
ds_read_b64_tr_b16 a[184:185], v15 offset:0
v_mfma_f32_32x32x16_bf16 a[48:63], a[196:199], a[216:219], a[48:63]
ds_read_b64_tr_b16 a[186:187], v15 offset:1024
buffer_load_dwordx4 v7, s[20:23], s31 offen offset:2048 lds
v_mfma_f32_32x32x16_bf16 a[64:79], a[200:203], a[216:219], a[64:79]
ds_read_b64_tr_b16 a[188:189], v16 offset:0
v_mfma_f32_32x32x16_bf16 a[80:95], a[204:207], a[216:219], a[80:95]
ds_read_b64_tr_b16 a[190:191], v16 offset:1024
v_mfma_f32_32x32x16_bf16 a[96:111], a[192:195], a[220:223], a[96:111]
v_mfma_f32_32x32x16_bf16 a[112:127], a[196:199], a[220:223], a[112:127]
buffer_load_dwordx4 v8, s[20:23], s31 offen offset:3072 lds
v_mfma_f32_32x32x16_bf16 a[128:143], a[200:203], a[220:223], a[128:143]
s_add_u32 s31, s31, 262144
s_add_u32 s33, s33, 16384
s_and_b32 s33, s33, 65535
v_mfma_f32_32x32x16_bf16 a[144:159], a[204:207], a[220:223], a[144:159]
s_waitcnt lgkmcnt(0)
v_mfma_f32_32x32x16_bf16 v[160:175], a[160:163], a[176:179], v[160:175]
ds_read_b64_tr_b16 a[208:209], v13 offset:4096
s_add_u32 m0, s32, 16384
s_add_u32 s48, s30, s34
v_mfma_f32_32x32x16_bf16 v[176:191], a[164:167], a[176:179], v[176:191]
ds_read_b64_tr_b16 a[210:211], v13 offset:5120
buffer_load_dwordx4 v1, s[12:15], s48 offen lds
v_mfma_f32_32x32x16_bf16 v[192:207], a[168:171], a[176:179], v[192:207]
ds_read_b128 a[192:195], v12 offset:0
v_mfma_f32_32x32x16_bf16 v[208:223], a[172:175], a[176:179], v[208:223]
ds_read_b128 a[196:199], v12 offset:4096
v_mfma_f32_32x32x16_bf16 v[224:239], a[160:163], a[180:183], v[224:239]
ds_read_b128 a[200:203], v12 offset:8192
s_add_u32 m0, s32, 20480
v_mfma_f32_32x32x16_bf16 v[240:255], a[164:167], a[180:183], v[240:255]
ds_read_b128 a[204:207], v12 offset:12288
buffer_load_dwordx4 v2, s[12:15], s48 offen lds
v_mfma_f32_32x32x16_bf16 a[0:15], a[168:171], a[180:183], a[0:15]
ds_read_b64_tr_b16 a[212:213], v14 offset:4096
s_add_u32 s25, s38, 53248
v_mfma_f32_32x32x16_bf16 a[16:31], a[172:175], a[180:183], a[16:31]
ds_read_b64_tr_b16 a[214:215], v14 offset:5120
buffer_store_dwordx4 v[124:127], v17, s[8:11], s25 offen offset:1024 sc1
v_mfma_f32_32x32x16_bf16 a[32:47], a[160:163], a[184:187], a[32:47]
ds_read_b64_tr_b16 a[216:217], v15 offset:4096
s_add_u32 m0, s32, 24576
v_mfma_f32_32x32x16_bf16 a[48:63], a[164:167], a[184:187], a[48:63]
ds_read_b64_tr_b16 a[218:219], v15 offset:5120
buffer_load_dwordx4 v3, s[12:15], s48 offen lds
v_mfma_f32_32x32x16_bf16 a[64:79], a[168:171], a[184:187], a[64:79]
ds_read_b64_tr_b16 a[220:221], v16 offset:4096
v_mfma_f32_32x32x16_bf16 a[80:95], a[172:175], a[184:187], a[80:95]
ds_read_b64_tr_b16 a[222:223], v16 offset:5120
v_add_u32 v9, 32768, v9
v_subrev_u32 v20, 98304, v9
v_cmp_le_u32 vcc, 163840, v9
v_add_u32 v13, 16384, v13
v_mfma_f32_32x32x16_bf16 a[96:111], a[160:163], a[188:191], a[96:111]
s_add_u32 m0, s32, 28672
v_and_b32 v13, 65535, v13
v_add_u32 v14, 16384, v14
v_and_b32 v14, 65535, v14
v_add_u32 v15, 16384, v15
v_mfma_f32_32x32x16_bf16 a[112:127], a[164:167], a[188:191], a[112:127]
buffer_load_dwordx4 v4, s[12:15], s48 offen lds
v_and_b32 v15, 65535, v15
v_add_u32 v16, 16384, v16
v_and_b32 v16, 65535, v16
v_mfma_f32_32x32x16_bf16 a[128:143], a[168:171], a[188:191], a[128:143]
s_add_u32 s30, s30, 128
s_add_u32 s32, s32, 32768
s_sub_u32 s24, s32, 98304
s_cmp_ge_u32 s32, 163840
s_cselect_b32 s32, s24, s32
v_cndmask_b32 v9, v9, v20, vcc
v_xor_b32 v10, 32, v9
v_xor_b32 v11, 64, v9
v_xor_b32 v12, 96, v9
v_mfma_f32_32x32x16_bf16 a[144:159], a[172:175], a[188:191], a[144:159]
s_waitcnt vmcnt(21) lgkmcnt(0)
s_barrier
v_mfma_f32_32x32x16_bf16 v[160:175], a[192:195], a[208:211], v[160:175]
ds_read_b64_tr_b16 a[176:177], v13 offset:0
s_mov_b32 m0, s33
v_mfma_f32_32x32x16_bf16 v[176:191], a[196:199], a[208:211], v[176:191]
ds_read_b64_tr_b16 a[178:179], v13 offset:1024
buffer_load_dwordx4 v5, s[20:23], s31 offen offset:0 lds
v_mfma_f32_32x32x16_bf16 v[192:207], a[200:203], a[208:211], v[192:207]
ds_read_b128 a[160:163], v9 offset:0
v_mfma_f32_32x32x16_bf16 v[208:223], a[204:207], a[208:211], v[208:223]
ds_read_b128 a[164:167], v9 offset:4096
v_mfma_f32_32x32x16_bf16 v[224:239], a[192:195], a[212:215], v[224:239]
ds_read_b128 a[168:171], v9 offset:8192
v_mfma_f32_32x32x16_bf16 v[240:255], a[196:199], a[212:215], v[240:255]
ds_read_b128 a[172:175], v9 offset:12288
buffer_load_dwordx4 v6, s[20:23], s31 offen offset:1024 lds
v_mfma_f32_32x32x16_bf16 a[0:15], a[200:203], a[212:215], a[0:15]
ds_read_b64_tr_b16 a[180:181], v14 offset:0
s_add_u32 s25, s38, 6144
v_mfma_f32_32x32x16_bf16 a[16:31], a[204:207], a[212:215], a[16:31]
ds_read_b64_tr_b16 a[182:183], v14 offset:1024
buffer_store_dwordx4 v[128:131], v17, s[8:11], s25 offen offset:0 sc1
v_mfma_f32_32x32x16_bf16 a[32:47], a[192:195], a[216:219], a[32:47]
ds_read_b64_tr_b16 a[184:185], v15 offset:0
v_mfma_f32_32x32x16_bf16 a[48:63], a[196:199], a[216:219], a[48:63]
ds_read_b64_tr_b16 a[186:187], v15 offset:1024
buffer_load_dwordx4 v7, s[20:23], s31 offen offset:2048 lds
v_mfma_f32_32x32x16_bf16 a[64:79], a[200:203], a[216:219], a[64:79]
ds_read_b64_tr_b16 a[188:189], v16 offset:0
v_mfma_f32_32x32x16_bf16 a[80:95], a[204:207], a[216:219], a[80:95]
ds_read_b64_tr_b16 a[190:191], v16 offset:1024
v_mfma_f32_32x32x16_bf16 a[96:111], a[192:195], a[220:223], a[96:111]
v_mfma_f32_32x32x16_bf16 a[112:127], a[196:199], a[220:223], a[112:127]
buffer_load_dwordx4 v8, s[20:23], s31 offen offset:3072 lds
v_mfma_f32_32x32x16_bf16 a[128:143], a[200:203], a[220:223], a[128:143]
s_add_u32 s31, s31, 262144
s_add_u32 s33, s33, 16384
s_and_b32 s33, s33, 65535
s_add_u32 s25, s38, 6144
v_mfma_f32_32x32x16_bf16 a[144:159], a[204:207], a[220:223], a[144:159]
buffer_store_dwordx4 v[132:135], v17, s[8:11], s25 offen offset:1024 sc1
s_cmp_eq_u32 s36, 0
s_cbranch_scc1 L_g_v6
s_waitcnt lgkmcnt(0)
v_mfma_f32_32x32x16_bf16 v[160:175], a[160:163], a[176:179], v[160:175]
ds_read_b64_tr_b16 a[208:209], v13 offset:4096
s_add_u32 m0, s32, 0
s_mov_b32 s48, s30
v_mfma_f32_32x32x16_bf16 v[176:191], a[164:167], a[176:179], v[176:191]
ds_read_b64_tr_b16 a[210:211], v13 offset:5120
buffer_load_dwordx4 v1, s[12:15], s48 offen lds
v_mfma_f32_32x32x16_bf16 v[192:207], a[168:171], a[176:179], v[192:207]
ds_read_b128 a[192:195], v10 offset:0
v_mfma_f32_32x32x16_bf16 v[208:223], a[172:175], a[176:179], v[208:223]
ds_read_b128 a[196:199], v10 offset:4096
v_mfma_f32_32x32x16_bf16 v[224:239], a[160:163], a[180:183], v[224:239]
ds_read_b128 a[200:203], v10 offset:8192
s_add_u32 m0, s32, 4096
v_mfma_f32_32x32x16_bf16 v[240:255], a[164:167], a[180:183], v[240:255]
ds_read_b128 a[204:207], v10 offset:12288
buffer_load_dwordx4 v2, s[12:15], s48 offen lds
v_mfma_f32_32x32x16_bf16 a[0:15], a[168:171], a[180:183], a[0:15]
ds_read_b64_tr_b16 a[212:213], v14 offset:4096
v_mfma_f32_32x32x16_bf16 a[16:31], a[172:175], a[180:183], a[16:31]
ds_read_b64_tr_b16 a[214:215], v14 offset:5120
v_mfma_f32_32x32x16_bf16 a[32:47], a[160:163], a[184:187], a[32:47]
ds_read_b64_tr_b16 a[216:217], v15 offset:4096
s_add_u32 m0, s32, 8192
v_mfma_f32_32x32x16_bf16 a[48:63], a[164:167], a[184:187], a[48:63]
ds_read_b64_tr_b16 a[218:219], v15 offset:5120
buffer_load_dwordx4 v3, s[12:15], s48 offen lds
v_mfma_f32_32x32x16_bf16 a[64:79], a[168:171], a[184:187], a[64:79]
ds_read_b64_tr_b16 a[220:221], v16 offset:4096
v_mfma_f32_32x32x16_bf16 a[80:95], a[172:175], a[184:187], a[80:95]
ds_read_b64_tr_b16 a[222:223], v16 offset:5120
v_add_u32 v13, 16384, v13
v_and_b32 v13, 65535, v13
v_mfma_f32_32x32x16_bf16 a[96:111], a[160:163], a[188:191], a[96:111]
s_add_u32 m0, s32, 12288
v_add_u32 v14, 16384, v14
v_and_b32 v14, 65535, v14
v_mfma_f32_32x32x16_bf16 a[112:127], a[164:167], a[188:191], a[112:127]
buffer_load_dwordx4 v4, s[12:15], s48 offen lds
v_add_u32 v15, 16384, v15
v_and_b32 v15, 65535, v15
v_mfma_f32_32x32x16_bf16 a[128:143], a[168:171], a[188:191], a[128:143]
v_add_u32 v16, 16384, v16
v_and_b32 v16, 65535, v16
v_mfma_f32_32x32x16_bf16 a[144:159], a[172:175], a[188:191], a[144:159]
s_waitcnt vmcnt(20) lgkmcnt(0)
s_barrier
v_mfma_f32_32x32x16_bf16 v[160:175], a[192:195], a[208:211], v[160:175]
ds_read_b64_tr_b16 a[176:177], v13 offset:0
s_mov_b32 m0, s33
v_mfma_f32_32x32x16_bf16 v[176:191], a[196:199], a[208:211], v[176:191]
ds_read_b64_tr_b16 a[178:179], v13 offset:1024
buffer_load_dwordx4 v5, s[20:23], s31 offen offset:0 lds
v_mfma_f32_32x32x16_bf16 v[192:207], a[200:203], a[208:211], v[192:207]
ds_read_b128 a[160:163], v11 offset:0
v_mfma_f32_32x32x16_bf16 v[208:223], a[204:207], a[208:211], v[208:223]
ds_read_b128 a[164:167], v11 offset:4096
v_mfma_f32_32x32x16_bf16 v[224:239], a[192:195], a[212:215], v[224:239]
ds_read_b128 a[168:171], v11 offset:8192
v_mfma_f32_32x32x16_bf16 v[240:255], a[196:199], a[212:215], v[240:255]
ds_read_b128 a[172:175], v11 offset:12288
buffer_load_dwordx4 v6, s[20:23], s31 offen offset:1024 lds
v_mfma_f32_32x32x16_bf16 a[0:15], a[200:203], a[212:215], a[0:15]
ds_read_b64_tr_b16 a[180:181], v14 offset:0
v_mfma_f32_32x32x16_bf16 a[16:31], a[204:207], a[212:215], a[16:31]
ds_read_b64_tr_b16 a[182:183], v14 offset:1024
v_mfma_f32_32x32x16_bf16 a[32:47], a[192:195], a[216:219], a[32:47]
ds_read_b64_tr_b16 a[184:185], v15 offset:0
v_mfma_f32_32x32x16_bf16 a[48:63], a[196:199], a[216:219], a[48:63]
ds_read_b64_tr_b16 a[186:187], v15 offset:1024
buffer_load_dwordx4 v7, s[20:23], s31 offen offset:2048 lds
v_mfma_f32_32x32x16_bf16 a[64:79], a[200:203], a[216:219], a[64:79]
ds_read_b64_tr_b16 a[188:189], v16 offset:0
v_mfma_f32_32x32x16_bf16 a[80:95], a[204:207], a[216:219], a[80:95]
ds_read_b64_tr_b16 a[190:191], v16 offset:1024
v_mfma_f32_32x32x16_bf16 a[96:111], a[192:195], a[220:223], a[96:111]
v_mfma_f32_32x32x16_bf16 a[112:127], a[196:199], a[220:223], a[112:127]
buffer_load_dwordx4 v8, s[20:23], s31 offen offset:3072 lds
v_mfma_f32_32x32x16_bf16 a[128:143], a[200:203], a[220:223], a[128:143]
s_add_u32 s31, s31, 262144
s_add_u32 s33, s33, 16384
s_and_b32 s33, s33, 65535
v_mfma_f32_32x32x16_bf16 a[144:159], a[204:207], a[220:223], a[144:159]
s_waitcnt lgkmcnt(0)
v_mfma_f32_32x32x16_bf16 v[160:175], a[160:163], a[176:179], v[160:175]
ds_read_b64_tr_b16 a[208:209], v13 offset:4096
s_add_u32 m0, s32, 16384
s_add_u32 s48, s30, s34
v_mfma_f32_32x32x16_bf16 v[176:191], a[164:167], a[176:179], v[176:191]
ds_read_b64_tr_b16 a[210:211], v13 offset:5120
buffer_load_dwordx4 v1, s[12:15], s48 offen lds
v_mfma_f32_32x32x16_bf16 v[192:207], a[168:171], a[176:179], v[192:207]
ds_read_b128 a[192:195], v12 offset:0
v_mfma_f32_32x32x16_bf16 v[208:223], a[172:175], a[176:179], v[208:223]
ds_read_b128 a[196:199], v12 offset:4096
v_mfma_f32_32x32x16_bf16 v[224:239], a[160:163], a[180:183], v[224:239]
ds_read_b128 a[200:203], v12 offset:8192
s_add_u32 m0, s32, 20480
v_mfma_f32_32x32x16_bf16 v[240:255], a[164:167], a[180:183], v[240:255]
ds_read_b128 a[204:207], v12 offset:12288
buffer_load_dwordx4 v2, s[12:15], s48 offen lds
v_mfma_f32_32x32x16_bf16 a[0:15], a[168:171], a[180:183], a[0:15]
ds_read_b64_tr_b16 a[212:213], v14 offset:4096
v_mfma_f32_32x32x16_bf16 a[16:31], a[172:175], a[180:183], a[16:31]
ds_read_b64_tr_b16 a[214:215], v14 offset:5120
v_mfma_f32_32x32x16_bf16 a[32:47], a[160:163], a[184:187], a[32:47]
ds_read_b64_tr_b16 a[216:217], v15 offset:4096
s_add_u32 m0, s32, 24576
v_mfma_f32_32x32x16_bf16 a[48:63], a[164:167], a[184:187], a[48:63]
ds_read_b64_tr_b16 a[218:219], v15 offset:5120
buffer_load_dwordx4 v3, s[12:15], s48 offen lds
v_mfma_f32_32x32x16_bf16 a[64:79], a[168:171], a[184:187], a[64:79]
ds_read_b64_tr_b16 a[220:221], v16 offset:4096
v_mfma_f32_32x32x16_bf16 a[80:95], a[172:175], a[184:187], a[80:95]
ds_read_b64_tr_b16 a[222:223], v16 offset:5120
v_add_u32 v9, 32768, v9
v_subrev_u32 v20, 98304, v9
v_cmp_le_u32 vcc, 163840, v9
v_add_u32 v13, 16384, v13
v_mfma_f32_32x32x16_bf16 a[96:111], a[160:163], a[188:191], a[96:111]
s_add_u32 m0, s32, 28672
v_and_b32 v13, 65535, v13
v_add_u32 v14, 16384, v14
v_and_b32 v14, 65535, v14
v_add_u32 v15, 16384, v15
v_mfma_f32_32x32x16_bf16 a[112:127], a[164:167], a[188:191], a[112:127]
buffer_load_dwordx4 v4, s[12:15], s48 offen lds
v_and_b32 v15, 65535, v15
v_add_u32 v16, 16384, v16
v_and_b32 v16, 65535, v16
v_mfma_f32_32x32x16_bf16 a[128:143], a[168:171], a[188:191], a[128:143]
s_add_u32 s30, s30, 128
s_add_u32 s32, s32, 32768
s_sub_u32 s24, s32, 98304
s_cmp_ge_u32 s32, 163840
s_cselect_b32 s32, s24, s32
v_cndmask_b32 v9, v9, v20, vcc
v_xor_b32 v10, 32, v9
v_xor_b32 v11, 64, v9
v_xor_b32 v12, 96, v9
v_mfma_f32_32x32x16_bf16 a[144:159], a[172:175], a[188:191], a[144:159]
s_waitcnt vmcnt(18) lgkmcnt(0)
s_barrier
v_mfma_f32_32x32x16_bf16 v[160:175], a[192:195], a[208:211], v[160:175]
ds_read_b64_tr_b16 a[176:177], v13 offset:0
s_mov_b32 m0, s33
v_mfma_f32_32x32x16_bf16 v[176:191], a[196:199], a[208:211], v[176:191]
ds_read_b64_tr_b16 a[178:179], v13 offset:1024
buffer_load_dwordx4 v5, s[20:23], s31 offen offset:0 lds
v_mfma_f32_32x32x16_bf16 v[192:207], a[200:203], a[208:211], v[192:207]
ds_read_b128 a[160:163], v9 offset:0
v_mfma_f32_32x32x16_bf16 v[208:223], a[204:207], a[208:211], v[208:223]
ds_read_b128 a[164:167], v9 offset:4096
v_mfma_f32_32x32x16_bf16 v[224:239], a[192:195], a[212:215], v[224:239]
ds_read_b128 a[168:171], v9 offset:8192
v_mfma_f32_32x32x16_bf16 v[240:255], a[196:199], a[212:215], v[240:255]
ds_read_b128 a[172:175], v9 offset:12288
buffer_load_dwordx4 v6, s[20:23], s31 offen offset:1024 lds
v_mfma_f32_32x32x16_bf16 a[0:15], a[200:203], a[212:215], a[0:15]
ds_read_b64_tr_b16 a[180:181], v14 offset:0
v_mfma_f32_32x32x16_bf16 a[16:31], a[204:207], a[212:215], a[16:31]
ds_read_b64_tr_b16 a[182:183], v14 offset:1024
v_mfma_f32_32x32x16_bf16 a[32:47], a[192:195], a[216:219], a[32:47]
ds_read_b64_tr_b16 a[184:185], v15 offset:0
v_mfma_f32_32x32x16_bf16 a[48:63], a[196:199], a[216:219], a[48:63]
ds_read_b64_tr_b16 a[186:187], v15 offset:1024
buffer_load_dwordx4 v7, s[20:23], s31 offen offset:2048 lds
v_mfma_f32_32x32x16_bf16 a[64:79], a[200:203], a[216:219], a[64:79]
ds_read_b64_tr_b16 a[188:189], v16 offset:0
v_mfma_f32_32x32x16_bf16 a[80:95], a[204:207], a[216:219], a[80:95]
ds_read_b64_tr_b16 a[190:191], v16 offset:1024
v_mfma_f32_32x32x16_bf16 a[96:111], a[192:195], a[220:223], a[96:111]
v_mfma_f32_32x32x16_bf16 a[112:127], a[196:199], a[220:223], a[112:127]
buffer_load_dwordx4 v8, s[20:23], s31 offen offset:3072 lds
v_mfma_f32_32x32x16_bf16 a[128:143], a[200:203], a[220:223], a[128:143]
s_add_u32 s31, s31, 262144
s_add_u32 s33, s33, 16384
s_and_b32 s33, s33, 65535
v_mfma_f32_32x32x16_bf16 a[144:159], a[204:207], a[220:223], a[144:159]
L_g_v6:
s_waitcnt lgkmcnt(0)
v_mfma_f32_32x32x16_bf16 v[160:175], a[160:163], a[176:179], v[160:175]
ds_read_b64_tr_b16 a[208:209], v13 offset:4096
s_add_u32 m0, s32, 0
s_mov_b32 s48, s30
v_mfma_f32_32x32x16_bf16 v[176:191], a[164:167], a[176:179], v[176:191]
ds_read_b64_tr_b16 a[210:211], v13 offset:5120
buffer_load_dwordx4 v1, s[12:15], s48 offen lds
v_mfma_f32_32x32x16_bf16 v[192:207], a[168:171], a[176:179], v[192:207]
ds_read_b128 a[192:195], v10 offset:0
v_mfma_f32_32x32x16_bf16 v[208:223], a[172:175], a[176:179], v[208:223]
ds_read_b128 a[196:199], v10 offset:4096
v_mfma_f32_32x32x16_bf16 v[224:239], a[160:163], a[180:183], v[224:239]
ds_read_b128 a[200:203], v10 offset:8192
s_add_u32 m0, s32, 4096
v_mfma_f32_32x32x16_bf16 v[240:255], a[164:167], a[180:183], v[240:255]
ds_read_b128 a[204:207], v10 offset:12288
buffer_load_dwordx4 v2, s[12:15], s48 offen lds
v_mfma_f32_32x32x16_bf16 a[0:15], a[168:171], a[180:183], a[0:15]
ds_read_b64_tr_b16 a[212:213], v14 offset:4096
s_add_u32 s25, s38, 22528
v_mfma_f32_32x32x16_bf16 a[16:31], a[172:175], a[180:183], a[16:31]
ds_read_b64_tr_b16 a[214:215], v14 offset:5120
buffer_store_dwordx4 v[136:139], v17, s[8:11], s25 offen offset:0 sc1
v_mfma_f32_32x32x16_bf16 a[32:47], a[160:163], a[184:187], a[32:47]
ds_read_b64_tr_b16 a[216:217], v15 offset:4096
s_add_u32 m0, s32, 8192
v_mfma_f32_32x32x16_bf16 a[48:63], a[164:167], a[184:187], a[48:63]
ds_read_b64_tr_b16 a[218:219], v15 offset:5120
buffer_load_dwordx4 v3, s[12:15], s48 offen lds
v_mfma_f32_32x32x16_bf16 a[64:79], a[168:171], a[184:187], a[64:79]
ds_read_b64_tr_b16 a[220:221], v16 offset:4096
v_mfma_f32_32x32x16_bf16 a[80:95], a[172:175], a[184:187], a[80:95]
ds_read_b64_tr_b16 a[222:223], v16 offset:5120
v_add_u32 v13, 16384, v13
v_and_b32 v13, 65535, v13
v_mfma_f32_32x32x16_bf16 a[96:111], a[160:163], a[188:191], a[96:111]
s_add_u32 m0, s32, 12288
v_add_u32 v14, 16384, v14
v_and_b32 v14, 65535, v14
v_mfma_f32_32x32x16_bf16 a[112:127], a[164:167], a[188:191], a[112:127]
buffer_load_dwordx4 v4, s[12:15], s48 offen lds
v_add_u32 v15, 16384, v15
v_and_b32 v15, 65535, v15
v_mfma_f32_32x32x16_bf16 a[128:143], a[168:171], a[188:191], a[128:143]
v_add_u32 v16, 16384, v16
v_and_b32 v16, 65535, v16
v_mfma_f32_32x32x16_bf16 a[144:159], a[172:175], a[188:191], a[144:159]
s_waitcnt vmcnt(17) lgkmcnt(0)
s_barrier
v_mfma_f32_32x32x16_bf16 v[160:175], a[192:195], a[208:211], v[160:175]
ds_read_b64_tr_b16 a[176:177], v13 offset:0
s_mov_b32 m0, s33
v_mfma_f32_32x32x16_bf16 v[176:191], a[196:199], a[208:211], v[176:191]
ds_read_b64_tr_b16 a[178:179], v13 offset:1024
buffer_load_dwordx4 v5, s[20:23], s31 offen offset:0 lds
v_mfma_f32_32x32x16_bf16 v[192:207], a[200:203], a[208:211], v[192:207]
ds_read_b128 a[160:163], v11 offset:0
v_mfma_f32_32x32x16_bf16 v[208:223], a[204:207], a[208:211], v[208:223]
ds_read_b128 a[164:167], v11 offset:4096
v_mfma_f32_32x32x16_bf16 v[224:239], a[192:195], a[212:215], v[224:239]
ds_read_b128 a[168:171], v11 offset:8192
v_mfma_f32_32x32x16_bf16 v[240:255], a[196:199], a[212:215], v[240:255]
ds_read_b128 a[172:175], v11 offset:12288
buffer_load_dwordx4 v6, s[20:23], s31 offen offset:1024 lds
v_mfma_f32_32x32x16_bf16 a[0:15], a[200:203], a[212:215], a[0:15]
ds_read_b64_tr_b16 a[180:181], v14 offset:0
s_add_u32 s25, s38, 22528
v_mfma_f32_32x32x16_bf16 a[16:31], a[204:207], a[212:215], a[16:31]
ds_read_b64_tr_b16 a[182:183], v14 offset:1024
buffer_store_dwordx4 v[140:143], v17, s[8:11], s25 offen offset:1024 sc1
v_mfma_f32_32x32x16_bf16 a[32:47], a[192:195], a[216:219], a[32:47]
ds_read_b64_tr_b16 a[184:185], v15 offset:0
v_mfma_f32_32x32x16_bf16 a[48:63], a[196:199], a[216:219], a[48:63]
ds_read_b64_tr_b16 a[186:187], v15 offset:1024
buffer_load_dwordx4 v7, s[20:23], s31 offen offset:2048 lds
v_mfma_f32_32x32x16_bf16 a[64:79], a[200:203], a[216:219], a[64:79]
ds_read_b64_tr_b16 a[188:189], v16 offset:0
v_mfma_f32_32x32x16_bf16 a[80:95], a[204:207], a[216:219], a[80:95]
ds_read_b64_tr_b16 a[190:191], v16 offset:1024
v_mfma_f32_32x32x16_bf16 a[96:111], a[192:195], a[220:223], a[96:111]
v_mfma_f32_32x32x16_bf16 a[112:127], a[196:199], a[220:223], a[112:127]
buffer_load_dwordx4 v8, s[20:23], s31 offen offset:3072 lds
v_mfma_f32_32x32x16_bf16 a[128:143], a[200:203], a[220:223], a[128:143]
s_add_u32 s31, s31, 262144
s_add_u32 s33, s33, 16384
s_and_b32 s33, s33, 65535
v_mfma_f32_32x32x16_bf16 a[144:159], a[204:207], a[220:223], a[144:159]
s_waitcnt lgkmcnt(0)
v_mfma_f32_32x32x16_bf16 v[160:175], a[160:163], a[176:179], v[160:175]
ds_read_b64_tr_b16 a[208:209], v13 offset:4096
s_add_u32 m0, s32, 16384
s_add_u32 s48, s30, s34
v_mfma_f32_32x32x16_bf16 v[176:191], a[164:167], a[176:179], v[176:191]
ds_read_b64_tr_b16 a[210:211], v13 offset:5120
buffer_load_dwordx4 v1, s[12:15], s48 offen lds
v_mfma_f32_32x32x16_bf16 v[192:207], a[168:171], a[176:179], v[192:207]
ds_read_b128 a[192:195], v12 offset:0
v_mfma_f32_32x32x16_bf16 v[208:223], a[172:175], a[176:179], v[208:223]
ds_read_b128 a[196:199], v12 offset:4096
v_mfma_f32_32x32x16_bf16 v[224:239], a[160:163], a[180:183], v[224:239]
ds_read_b128 a[200:203], v12 offset:8192
s_add_u32 m0, s32, 20480
v_mfma_f32_32x32x16_bf16 v[240:255], a[164:167], a[180:183], v[240:255]
ds_read_b128 a[204:207], v12 offset:12288
buffer_load_dwordx4 v2, s[12:15], s48 offen lds
v_mfma_f32_32x32x16_bf16 a[0:15], a[168:171], a[180:183], a[0:15]
ds_read_b64_tr_b16 a[212:213], v14 offset:4096
s_add_u32 s25, s38, 38912
v_mfma_f32_32x32x16_bf16 a[16:31], a[172:175], a[180:183], a[16:31]
ds_read_b64_tr_b16 a[214:215], v14 offset:5120
buffer_store_dwordx4 v[144:147], v17, s[8:11], s25 offen offset:0 sc1
v_mfma_f32_32x32x16_bf16 a[32:47], a[160:163], a[184:187], a[32:47]
ds_read_b64_tr_b16 a[216:217], v15 offset:4096
s_add_u32 m0, s32, 24576
v_mfma_f32_32x32x16_bf16 a[48:63], a[164:167], a[184:187], a[48:63]
ds_read_b64_tr_b16 a[218:219], v15 offset:5120
buffer_load_dwordx4 v3, s[12:15], s48 offen lds
v_mfma_f32_32x32x16_bf16 a[64:79], a[168:171], a[184:187], a[64:79]
ds_read_b64_tr_b16 a[220:221], v16 offset:4096
v_mfma_f32_32x32x16_bf16 a[80:95], a[172:175], a[184:187], a[80:95]
ds_read_b64_tr_b16 a[222:223], v16 offset:5120
v_add_u32 v9, 32768, v9
v_subrev_u32 v20, 98304, v9
v_cmp_le_u32 vcc, 163840, v9
v_add_u32 v13, 16384, v13
v_mfma_f32_32x32x16_bf16 a[96:111], a[160:163], a[188:191], a[96:111]
s_add_u32 m0, s32, 28672
v_and_b32 v13, 65535, v13
v_add_u32 v14, 16384, v14
v_and_b32 v14, 65535, v14
v_add_u32 v15, 16384, v15
v_mfma_f32_32x32x16_bf16 a[112:127], a[164:167], a[188:191], a[112:127]
buffer_load_dwordx4 v4, s[12:15], s48 offen lds
v_and_b32 v15, 65535, v15
v_add_u32 v16, 16384, v16
v_and_b32 v16, 65535, v16
v_mfma_f32_32x32x16_bf16 a[128:143], a[168:171], a[188:191], a[128:143]
s_add_u32 s30, s30, 128
s_add_u32 s32, s32, 32768
s_sub_u32 s24, s32, 98304
s_cmp_ge_u32 s32, 163840
s_cselect_b32 s32, s24, s32
s_add_u32 s25, s38, 38912
v_cndmask_b32 v9, v9, v20, vcc
v_xor_b32 v10, 32, v9
v_xor_b32 v11, 64, v9
v_xor_b32 v12, 96, v9
v_mfma_f32_32x32x16_bf16 a[144:159], a[172:175], a[188:191], a[144:159]
buffer_store_dwordx4 v[148:151], v17, s[8:11], s25 offen offset:1024 sc1
s_cmp_eq_u32 s61, 0
s_cbranch_scc1 L_px_11
s_lshl_b32 s24, s35, 2
s_lshr_b32 s26, 0xe64a20, s24
s_bfe_u32 s2, s26, 0x10003
s_and_b32 s26, s26, 7
s_add_u32 s24, s2, 1
s_sub_u32 s27, s3, 2
s_cmp_eq_u32 s3, 1
s_cbranch_scc0 L_px_13
s_mov_b32 s2, 1
s_mov_b32 s27, 0
s_branch L_px_13
L_px_11:
s_cmp_eq_u32 s35, 2
s_cselect_b32 s2, 1, 0
s_and_b32 s26, s35, 1
s_lshl_b32 s26, s26, 2
s_add_u32 s24, s2, 2
s_sub_u32 s27, s3, 4
L_px_13:
s_lshl_b32 s27, s27, 5
s_add_u32 s27, s27, s16
s_bfm_b32 s25, s24, 0
s_and_b32 s25, s25, s16
s_add_u32 s26, s26, s25
s_lshr_b32 s27, s27, s24
s_or_b32 s40, s2, s61
s_lshr_b32 s24, s17, 1
s_cmp_eq_u32 s2, 0
s_cselect_b32 s41, s24, 0
s_cselect_b64 s[4:5], s[52:53], s[54:55]
s_cselect_b32 s25, 0, s24
s_and_b32 s51, s41, s61
s_lshl_b32 s46, s27, s2
s_add_u32 s46, s46, s25
s_lshl_b32 s46, s46, 8
s_lshl_b32 s47, s40, 7
s_add_u32 s47, s47, 1024
s_mov_b32 s12, s4
s_and_b32 s13, s5, 0xffff
s_lshl_b32 s14, s47, 11
s_mov_b32 s15, 0x20000
s_mul_i32 s30, s26, s47
s_lshl_b32 s30, s30, 8
s_lshl_b32 s42, s27, 3
s_add_u32 s42, s42, s26
s_lshl_b32 s42, s42, 1
s_and_b32 s25, s17, 1
s_add_u32 s42, s42, s25
s_lshl_b32 s42, s42, 3
s_add_u32 s42, s42, s24
s_lshl_b32 s42, s42, 13
s_lshl_b32 s43, s27, 5
s_add_u32 s43, s43, s26
s_lshl_b32 s43, s43, 2
s_lshl_b32 s24, s2, 1
s_add_u32 s24, s24, s61
s_lshl_b32 s24, s24, 2
s_lshr_b32 s25, 0x8720, s24
s_and_b32 s25, s25, 15
s_lshl_b32 s25, s25, 24
s_add_u32 s42, s42, s25
s_lshr_b32 s25, 0x7604, s24
s_and_b32 s25, s25, 15
s_lshl_b32 s25, s25, 12
s_add_u32 s43, s43, s25
s_add_u32 s43, s43, 111149056
s_mov_b32 s44, 1
s_cmp_lt_u32 s35, s45
s_cselect_b32 s30, s30, 536870912
s_cselect_b32 s46, s46, 536870912
v_lshrrev_b32 v18, 3, v0
v_mul_lo_u32 v18, v18, s47
v_bfe_u32 v19, v0, 4, 3
v_and_b32 v20, 7, v0
v_xor_b32 v20, v20, v19
v_lshl_add_u32 v1, v20, 4, v18
s_lshl_b32 s24, s47, 5
s_lshl_b32 s34, s47, 7
v_add_u32 v2, s24, v1
v_add_u32 v3, s24, v2
v_add_u32 v4, s24, v3
s_waitcnt vmcnt(20) lgkmcnt(0)
s_barrier
v_mfma_f32_32x32x16_bf16 v[160:175], a[192:195], a[208:211], v[160:175]
ds_read_b64_tr_b16 a[176:177], v13 offset:0
s_mov_b32 m0, s33
v_mfma_f32_32x32x16_bf16 v[176:191], a[196:199], a[208:211], v[176:191]
ds_read_b64_tr_b16 a[178:179], v13 offset:1024
buffer_load_dwordx4 v5, s[20:23], s31 offen offset:0 lds
v_mfma_f32_32x32x16_bf16 v[192:207], a[200:203], a[208:211], v[192:207]
ds_read_b128 a[160:163], v9 offset:0
v_mfma_f32_32x32x16_bf16 v[208:223], a[204:207], a[208:211], v[208:223]
ds_read_b128 a[164:167], v9 offset:4096
v_mfma_f32_32x32x16_bf16 v[224:239], a[192:195], a[212:215], v[224:239]
ds_read_b128 a[168:171], v9 offset:8192
v_mfma_f32_32x32x16_bf16 v[240:255], a[196:199], a[212:215], v[240:255]
ds_read_b128 a[172:175], v9 offset:12288
buffer_load_dwordx4 v6, s[20:23], s31 offen offset:1024 lds
v_mfma_f32_32x32x16_bf16 a[0:15], a[200:203], a[212:215], a[0:15]
ds_read_b64_tr_b16 a[180:181], v14 offset:0
s_add_u32 s25, s38, 55296
v_mfma_f32_32x32x16_bf16 a[16:31], a[204:207], a[212:215], a[16:31]
ds_read_b64_tr_b16 a[182:183], v14 offset:1024
buffer_store_dwordx4 v[152:155], v17, s[8:11], s25 offen offset:0 sc1
v_mfma_f32_32x32x16_bf16 a[32:47], a[192:195], a[216:219], a[32:47]
ds_read_b64_tr_b16 a[184:185], v15 offset:0
v_mfma_f32_32x32x16_bf16 a[48:63], a[196:199], a[216:219], a[48:63]
ds_read_b64_tr_b16 a[186:187], v15 offset:1024
buffer_load_dwordx4 v7, s[20:23], s31 offen offset:2048 lds
v_mfma_f32_32x32x16_bf16 a[64:79], a[200:203], a[216:219], a[64:79]
ds_read_b64_tr_b16 a[188:189], v16 offset:0
v_mfma_f32_32x32x16_bf16 a[80:95], a[204:207], a[216:219], a[80:95]
ds_read_b64_tr_b16 a[190:191], v16 offset:1024
v_mfma_f32_32x32x16_bf16 a[96:111], a[192:195], a[220:223], a[96:111]
v_mfma_f32_32x32x16_bf16 a[112:127], a[196:199], a[220:223], a[112:127]
buffer_load_dwordx4 v8, s[20:23], s31 offen offset:3072 lds
v_mfma_f32_32x32x16_bf16 a[128:143], a[200:203], a[220:223], a[128:143]
s_add_u32 s31, s31, 262144
s_add_u32 s33, s33, 16384
s_and_b32 s33, s33, 65535
v_mfma_f32_32x32x16_bf16 a[144:159], a[204:207], a[220:223], a[144:159]
s_waitcnt lgkmcnt(0)
v_mfma_f32_32x32x16_bf16 v[160:175], a[160:163], a[176:179], v[160:175]
ds_read_b64_tr_b16 a[208:209], v13 offset:4096
s_add_u32 m0, s32, 0
s_mov_b32 s48, s30
v_mfma_f32_32x32x16_bf16 v[176:191], a[164:167], a[176:179], v[176:191]
ds_read_b64_tr_b16 a[210:211], v13 offset:5120
buffer_load_dwordx4 v1, s[12:15], s48 offen lds
v_mfma_f32_32x32x16_bf16 v[192:207], a[168:171], a[176:179], v[192:207]
ds_read_b128 a[192:195], v10 offset:0
v_mfma_f32_32x32x16_bf16 v[208:223], a[172:175], a[176:179], v[208:223]
ds_read_b128 a[196:199], v10 offset:4096
v_mfma_f32_32x32x16_bf16 v[224:239], a[160:163], a[180:183], v[224:239]
ds_read_b128 a[200:203], v10 offset:8192
s_add_u32 m0, s32, 4096
v_mfma_f32_32x32x16_bf16 v[240:255], a[164:167], a[180:183], v[240:255]
ds_read_b128 a[204:207], v10 offset:12288
buffer_load_dwordx4 v2, s[12:15], s48 offen lds
v_mfma_f32_32x32x16_bf16 a[0:15], a[168:171], a[180:183], a[0:15]
ds_read_b64_tr_b16 a[212:213], v14 offset:4096
s_add_u32 s25, s38, 55296
v_mfma_f32_32x32x16_bf16 a[16:31], a[172:175], a[180:183], a[16:31]
ds_read_b64_tr_b16 a[214:215], v14 offset:5120
buffer_store_dwordx4 v[156:159], v17, s[8:11], s25 offen offset:1024 sc1
v_mfma_f32_32x32x16_bf16 a[32:47], a[160:163], a[184:187], a[32:47]
ds_read_b64_tr_b16 a[216:217], v15 offset:4096
s_add_u32 m0, s32, 8192
v_mfma_f32_32x32x16_bf16 a[48:63], a[164:167], a[184:187], a[48:63]
ds_read_b64_tr_b16 a[218:219], v15 offset:5120
buffer_load_dwordx4 v3, s[12:15], s48 offen lds
v_mfma_f32_32x32x16_bf16 a[64:79], a[168:171], a[184:187], a[64:79]
ds_read_b64_tr_b16 a[220:221], v16 offset:4096
v_mfma_f32_32x32x16_bf16 a[80:95], a[172:175], a[184:187], a[80:95]
ds_read_b64_tr_b16 a[222:223], v16 offset:5120
v_add_u32 v13, 16384, v13
v_and_b32 v13, 65535, v13
v_mfma_f32_32x32x16_bf16 a[96:111], a[160:163], a[188:191], a[96:111]
s_add_u32 m0, s32, 12288
v_add_u32 v14, 16384, v14
v_and_b32 v14, 65535, v14
v_mfma_f32_32x32x16_bf16 a[112:127], a[164:167], a[188:191], a[112:127]
buffer_load_dwordx4 v4, s[12:15], s48 offen lds
v_add_u32 v15, 16384, v15
v_and_b32 v15, 65535, v15
v_mfma_f32_32x32x16_bf16 a[128:143], a[168:171], a[188:191], a[128:143]
v_add_u32 v16, 16384, v16
v_and_b32 v16, 65535, v16
v_mfma_f32_32x32x16_bf16 a[144:159], a[172:175], a[188:191], a[144:159]
s_cmp_eq_u32 s2, 0
s_cselect_b64 s[4:5], s[6:7], s[18:19]
s_mov_b32 s20, s4
s_and_b32 s21, s5, 0xffff
s_lshl_b32 s22, s47, 12
s_mov_b32 s23, 0x20000
s_mov_b32 s31, s46
s_waitcnt vmcnt(21) lgkmcnt(0)
s_barrier
v_mfma_f32_32x32x16_bf16 v[160:175], a[192:195], a[208:211], v[160:175]
ds_read_b64_tr_b16 a[176:177], v13 offset:0
s_mov_b32 m0, s33
v_mfma_f32_32x32x16_bf16 v[176:191], a[196:199], a[208:211], v[176:191]
ds_read_b64_tr_b16 a[178:179], v13 offset:1024
buffer_load_dwordx4 v5, s[20:23], s31 offen offset:0 lds
v_mfma_f32_32x32x16_bf16 v[192:207], a[200:203], a[208:211], v[192:207]
ds_read_b128 a[160:163], v11 offset:0
v_mfma_f32_32x32x16_bf16 v[208:223], a[204:207], a[208:211], v[208:223]
ds_read_b128 a[164:167], v11 offset:4096
v_mfma_f32_32x32x16_bf16 v[224:239], a[192:195], a[212:215], v[224:239]
ds_read_b128 a[168:171], v11 offset:8192
v_mfma_f32_32x32x16_bf16 v[240:255], a[196:199], a[212:215], v[240:255]
ds_read_b128 a[172:175], v11 offset:12288
buffer_load_dwordx4 v6, s[20:23], s31 offen offset:1024 lds
v_mfma_f32_32x32x16_bf16 a[0:15], a[200:203], a[212:215], a[0:15]
ds_read_b64_tr_b16 a[180:181], v14 offset:0
v_mfma_f32_32x32x16_bf16 a[16:31], a[204:207], a[212:215], a[16:31]
ds_read_b64_tr_b16 a[182:183], v14 offset:1024
v_mfma_f32_32x32x16_bf16 a[32:47], a[192:195], a[216:219], a[32:47]
ds_read_b64_tr_b16 a[184:185], v15 offset:0
v_mfma_f32_32x32x16_bf16 a[48:63], a[196:199], a[216:219], a[48:63]
ds_read_b64_tr_b16 a[186:187], v15 offset:1024
buffer_load_dwordx4 v7, s[20:23], s31 offen offset:2048 lds
v_mfma_f32_32x32x16_bf16 a[64:79], a[200:203], a[216:219], a[64:79]
ds_read_b64_tr_b16 a[188:189], v16 offset:0
v_mfma_f32_32x32x16_bf16 a[80:95], a[204:207], a[216:219], a[80:95]
ds_read_b64_tr_b16 a[190:191], v16 offset:1024
v_mfma_f32_32x32x16_bf16 a[96:111], a[192:195], a[220:223], a[96:111]
v_mfma_f32_32x32x16_bf16 a[112:127], a[196:199], a[220:223], a[112:127]
buffer_load_dwordx4 v8, s[20:23], s31 offen offset:3072 lds
v_mfma_f32_32x32x16_bf16 a[128:143], a[200:203], a[220:223], a[128:143]
s_add_u32 s31, s31, 262144
s_add_u32 s33, s33, 16384
s_and_b32 s33, s33, 65535
v_mfma_f32_32x32x16_bf16 a[144:159], a[204:207], a[220:223], a[144:159]
s_waitcnt lgkmcnt(0)
v_mfma_f32_32x32x16_bf16 v[160:175], a[160:163], a[176:179], v[160:175]
ds_read_b64_tr_b16 a[208:209], v13 offset:4096
s_add_u32 m0, s32, 16384
s_add_u32 s48, s30, s34
v_mfma_f32_32x32x16_bf16 v[176:191], a[164:167], a[176:179], v[176:191]
ds_read_b64_tr_b16 a[210:211], v13 offset:5120
buffer_load_dwordx4 v1, s[12:15], s48 offen lds
v_mfma_f32_32x32x16_bf16 v[192:207], a[168:171], a[176:179], v[192:207]
ds_read_b128 a[192:195], v12 offset:0
v_mfma_f32_32x32x16_bf16 v[208:223], a[172:175], a[176:179], v[208:223]
ds_read_b128 a[196:199], v12 offset:4096
v_mfma_f32_32x32x16_bf16 v[224:239], a[160:163], a[180:183], v[224:239]
ds_read_b128 a[200:203], v12 offset:8192
s_add_u32 m0, s32, 20480
v_mfma_f32_32x32x16_bf16 v[240:255], a[164:167], a[180:183], v[240:255]
ds_read_b128 a[204:207], v12 offset:12288
buffer_load_dwordx4 v2, s[12:15], s48 offen lds
v_mfma_f32_32x32x16_bf16 a[0:15], a[168:171], a[180:183], a[0:15]
ds_read_b64_tr_b16 a[212:213], v14 offset:4096
v_mfma_f32_32x32x16_bf16 a[16:31], a[172:175], a[180:183], a[16:31]
ds_read_b64_tr_b16 a[214:215], v14 offset:5120
v_mfma_f32_32x32x16_bf16 a[32:47], a[160:163], a[184:187], a[32:47]
ds_read_b64_tr_b16 a[216:217], v15 offset:4096
s_add_u32 m0, s32, 24576
v_mfma_f32_32x32x16_bf16 a[48:63], a[164:167], a[184:187], a[48:63]
ds_read_b64_tr_b16 a[218:219], v15 offset:5120
buffer_load_dwordx4 v3, s[12:15], s48 offen lds
v_mfma_f32_32x32x16_bf16 a[64:79], a[168:171], a[184:187], a[64:79]
ds_read_b64_tr_b16 a[220:221], v16 offset:4096
v_mfma_f32_32x32x16_bf16 a[80:95], a[172:175], a[184:187], a[80:95]
ds_read_b64_tr_b16 a[222:223], v16 offset:5120
v_add_u32 v9, 32768, v9
v_subrev_u32 v20, 98304, v9
v_cmp_le_u32 vcc, 163840, v9
v_add_u32 v13, 16384, v13
v_mfma_f32_32x32x16_bf16 a[96:111], a[160:163], a[188:191], a[96:111]
s_add_u32 m0, s32, 28672
v_and_b32 v13, 65535, v13
v_add_u32 v14, 16384, v14
v_and_b32 v14, 65535, v14
v_add_u32 v15, 16384, v15
v_mfma_f32_32x32x16_bf16 a[112:127], a[164:167], a[188:191], a[112:127]
buffer_load_dwordx4 v4, s[12:15], s48 offen lds
v_and_b32 v15, 65535, v15
v_add_u32 v16, 16384, v16
v_and_b32 v16, 65535, v16
v_mfma_f32_32x32x16_bf16 a[128:143], a[168:171], a[188:191], a[128:143]
s_add_u32 s30, s30, 128
s_add_u32 s32, s32, 32768
s_sub_u32 s24, s32, 98304
s_cmp_ge_u32 s32, 163840
s_cselect_b32 s32, s24, s32
v_cndmask_b32 v9, v9, v20, vcc
v_xor_b32 v10, 32, v9
v_xor_b32 v11, 64, v9
v_xor_b32 v12, 96, v9
v_mfma_f32_32x32x16_bf16 a[144:159], a[172:175], a[188:191], a[144:159]
s_waitcnt vmcnt(18) lgkmcnt(0)
s_barrier
v_mfma_f32_32x32x16_bf16 v[160:175], a[192:195], a[208:211], v[160:175]
ds_read_b64_tr_b16 a[176:177], v13 offset:0
s_mov_b32 m0, s33
v_mfma_f32_32x32x16_bf16 v[176:191], a[196:199], a[208:211], v[176:191]
ds_read_b64_tr_b16 a[178:179], v13 offset:1024
buffer_load_dwordx4 v5, s[20:23], s31 offen offset:0 lds
v_mfma_f32_32x32x16_bf16 v[192:207], a[200:203], a[208:211], v[192:207]
ds_read_b128 a[160:163], v9 offset:0
v_mfma_f32_32x32x16_bf16 v[208:223], a[204:207], a[208:211], v[208:223]
ds_read_b128 a[164:167], v9 offset:4096
v_mfma_f32_32x32x16_bf16 v[224:239], a[192:195], a[212:215], v[224:239]
ds_read_b128 a[168:171], v9 offset:8192
v_mfma_f32_32x32x16_bf16 v[240:255], a[196:199], a[212:215], v[240:255]
ds_read_b128 a[172:175], v9 offset:12288
buffer_load_dwordx4 v6, s[20:23], s31 offen offset:1024 lds
v_mfma_f32_32x32x16_bf16 a[0:15], a[200:203], a[212:215], a[0:15]
ds_read_b64_tr_b16 a[180:181], v14 offset:0
v_mfma_f32_32x32x16_bf16 a[16:31], a[204:207], a[212:215], a[16:31]
ds_read_b64_tr_b16 a[182:183], v14 offset:1024
v_mfma_f32_32x32x16_bf16 a[32:47], a[192:195], a[216:219], a[32:47]
ds_read_b64_tr_b16 a[184:185], v15 offset:0
v_mfma_f32_32x32x16_bf16 a[48:63], a[196:199], a[216:219], a[48:63]
ds_read_b64_tr_b16 a[186:187], v15 offset:1024
buffer_load_dwordx4 v7, s[20:23], s31 offen offset:2048 lds
v_mfma_f32_32x32x16_bf16 a[64:79], a[200:203], a[216:219], a[64:79]
ds_read_b64_tr_b16 a[188:189], v16 offset:0
v_mfma_f32_32x32x16_bf16 a[80:95], a[204:207], a[216:219], a[80:95]
ds_read_b64_tr_b16 a[190:191], v16 offset:1024
v_mfma_f32_32x32x16_bf16 a[96:111], a[192:195], a[220:223], a[96:111]
v_mfma_f32_32x32x16_bf16 a[112:127], a[196:199], a[220:223], a[112:127]
buffer_load_dwordx4 v8, s[20:23], s31 offen offset:3072 lds
v_mfma_f32_32x32x16_bf16 a[128:143], a[200:203], a[220:223], a[128:143]
s_add_u32 s31, s31, 262144
s_add_u32 s33, s33, 16384
s_and_b32 s33, s33, 65535
v_mfma_f32_32x32x16_bf16 a[144:159], a[204:207], a[220:223], a[144:159]
s_waitcnt lgkmcnt(0)
v_mfma_f32_32x32x16_bf16 v[160:175], a[160:163], a[176:179], v[160:175]
ds_read_b64_tr_b16 a[208:209], v13 offset:4096
s_add_u32 m0, s32, 0
s_mov_b32 s48, s30
v_mfma_f32_32x32x16_bf16 v[176:191], a[164:167], a[176:179], v[176:191]
ds_read_b64_tr_b16 a[210:211], v13 offset:5120
buffer_load_dwordx4 v1, s[12:15], s48 offen lds
v_mfma_f32_32x32x16_bf16 v[192:207], a[168:171], a[176:179], v[192:207]
ds_read_b128 a[192:195], v10 offset:0
v_mfma_f32_32x32x16_bf16 v[208:223], a[172:175], a[176:179], v[208:223]
ds_read_b128 a[196:199], v10 offset:4096
v_mfma_f32_32x32x16_bf16 v[224:239], a[160:163], a[180:183], v[224:239]
ds_read_b128 a[200:203], v10 offset:8192
s_add_u32 m0, s32, 4096
v_mfma_f32_32x32x16_bf16 v[240:255], a[164:167], a[180:183], v[240:255]
ds_read_b128 a[204:207], v10 offset:12288
buffer_load_dwordx4 v2, s[12:15], s48 offen lds
v_mfma_f32_32x32x16_bf16 a[0:15], a[168:171], a[180:183], a[0:15]
ds_read_b64_tr_b16 a[212:213], v14 offset:4096
v_mfma_f32_32x32x16_bf16 a[16:31], a[172:175], a[180:183], a[16:31]
ds_read_b64_tr_b16 a[214:215], v14 offset:5120
v_mfma_f32_32x32x16_bf16 a[32:47], a[160:163], a[184:187], a[32:47]
ds_read_b64_tr_b16 a[216:217], v15 offset:4096
s_add_u32 m0, s32, 8192
v_mfma_f32_32x32x16_bf16 a[48:63], a[164:167], a[184:187], a[48:63]
ds_read_b64_tr_b16 a[218:219], v15 offset:5120
buffer_load_dwordx4 v3, s[12:15], s48 offen lds
v_mfma_f32_32x32x16_bf16 a[64:79], a[168:171], a[184:187], a[64:79]
ds_read_b64_tr_b16 a[220:221], v16 offset:4096
v_mfma_f32_32x32x16_bf16 a[80:95], a[172:175], a[184:187], a[80:95]
ds_read_b64_tr_b16 a[222:223], v16 offset:5120
v_add_u32 v13, 16384, v13
v_and_b32 v13, 65535, v13
v_mfma_f32_32x32x16_bf16 a[96:111], a[160:163], a[188:191], a[96:111]
s_add_u32 m0, s32, 12288
v_add_u32 v14, 16384, v14
v_and_b32 v14, 65535, v14
v_mfma_f32_32x32x16_bf16 a[112:127], a[164:167], a[188:191], a[112:127]
buffer_load_dwordx4 v4, s[12:15], s48 offen lds
v_add_u32 v15, 16384, v15
v_and_b32 v15, 65535, v15
v_mfma_f32_32x32x16_bf16 a[128:143], a[168:171], a[188:191], a[128:143]
v_add_u32 v16, 16384, v16
v_and_b32 v16, 65535, v16
v_mfma_f32_32x32x16_bf16 a[144:159], a[172:175], a[188:191], a[144:159]
s_waitcnt vmcnt(16) lgkmcnt(0)
s_barrier
v_mfma_f32_32x32x16_bf16 v[160:175], a[192:195], a[208:211], v[160:175]
ds_read_b64_tr_b16 a[176:177], v13 offset:0
s_mov_b32 m0, s33
v_mfma_f32_32x32x16_bf16 v[176:191], a[196:199], a[208:211], v[176:191]
ds_read_b64_tr_b16 a[178:179], v13 offset:1024
buffer_load_dwordx4 v5, s[20:23], s31 offen offset:0 lds
v_mfma_f32_32x32x16_bf16 v[192:207], a[200:203], a[208:211], v[192:207]
ds_read_b128 a[160:163], v11 offset:0
v_mfma_f32_32x32x16_bf16 v[208:223], a[204:207], a[208:211], v[208:223]
ds_read_b128 a[164:167], v11 offset:4096
v_mfma_f32_32x32x16_bf16 v[224:239], a[192:195], a[212:215], v[224:239]
ds_read_b128 a[168:171], v11 offset:8192
v_mfma_f32_32x32x16_bf16 v[240:255], a[196:199], a[212:215], v[240:255]
ds_read_b128 a[172:175], v11 offset:12288
buffer_load_dwordx4 v6, s[20:23], s31 offen offset:1024 lds
v_mfma_f32_32x32x16_bf16 a[0:15], a[200:203], a[212:215], a[0:15]
ds_read_b64_tr_b16 a[180:181], v14 offset:0
v_mfma_f32_32x32x16_bf16 a[16:31], a[204:207], a[212:215], a[16:31]
ds_read_b64_tr_b16 a[182:183], v14 offset:1024
v_mfma_f32_32x32x16_bf16 a[32:47], a[192:195], a[216:219], a[32:47]
ds_read_b64_tr_b16 a[184:185], v15 offset:0
v_mfma_f32_32x32x16_bf16 a[48:63], a[196:199], a[216:219], a[48:63]
ds_read_b64_tr_b16 a[186:187], v15 offset:1024
buffer_load_dwordx4 v7, s[20:23], s31 offen offset:2048 lds
v_mfma_f32_32x32x16_bf16 a[64:79], a[200:203], a[216:219], a[64:79]
ds_read_b64_tr_b16 a[188:189], v16 offset:0
v_mfma_f32_32x32x16_bf16 a[80:95], a[204:207], a[216:219], a[80:95]
ds_read_b64_tr_b16 a[190:191], v16 offset:1024
v_mfma_f32_32x32x16_bf16 a[96:111], a[192:195], a[220:223], a[96:111]
v_mov_b32 v18, 0
v_mov_b32 v19, s29
s_cmp_eq_u32 s17, 0
s_cselect_b32 s25, s39, 536870912
s_mov_b64 exec, 1
buffer_store_dword v19, v18, s[8:11], s25 offen sc1
s_mov_b64 exec, -1
v_mfma_f32_32x32x16_bf16 a[112:127], a[196:199], a[220:223], a[112:127]
buffer_load_dwordx4 v8, s[20:23], s31 offen offset:3072 lds
v_mfma_f32_32x32x16_bf16 a[128:143], a[200:203], a[220:223], a[128:143]
s_add_u32 s31, s31, 262144
s_add_u32 s33, s33, 16384
s_and_b32 s33, s33, 65535
v_mfma_f32_32x32x16_bf16 a[144:159], a[204:207], a[220:223], a[144:159]
s_waitcnt lgkmcnt(0)
v_mfma_f32_32x32x16_bf16 v[160:175], a[160:163], a[176:179], v[160:175]
ds_read_b64_tr_b16 a[208:209], v13 offset:4096
s_add_u32 m0, s32, 16384
s_add_u32 s48, s30, s34
v_mfma_f32_32x32x16_bf16 v[176:191], a[164:167], a[176:179], v[176:191]
ds_read_b64_tr_b16 a[210:211], v13 offset:5120
buffer_load_dwordx4 v1, s[12:15], s48 offen lds
v_mfma_f32_32x32x16_bf16 v[192:207], a[168:171], a[176:179], v[192:207]
ds_read_b128 a[192:195], v12 offset:0
v_mfma_f32_32x32x16_bf16 v[208:223], a[172:175], a[176:179], v[208:223]
ds_read_b128 a[196:199], v12 offset:4096
v_mfma_f32_32x32x16_bf16 v[224:239], a[160:163], a[180:183], v[224:239]
ds_read_b128 a[200:203], v12 offset:8192
s_add_u32 m0, s32, 20480
v_mfma_f32_32x32x16_bf16 v[240:255], a[164:167], a[180:183], v[240:255]
ds_read_b128 a[204:207], v12 offset:12288
buffer_load_dwordx4 v2, s[12:15], s48 offen lds
v_mfma_f32_32x32x16_bf16 a[0:15], a[168:171], a[180:183], a[0:15]
ds_read_b64_tr_b16 a[212:213], v14 offset:4096
v_mfma_f32_32x32x16_bf16 a[16:31], a[172:175], a[180:183], a[16:31]
ds_read_b64_tr_b16 a[214:215], v14 offset:5120
v_mfma_f32_32x32x16_bf16 a[32:47], a[160:163], a[184:187], a[32:47]
ds_read_b64_tr_b16 a[216:217], v15 offset:4096
s_add_u32 m0, s32, 24576
v_mfma_f32_32x32x16_bf16 a[48:63], a[164:167], a[184:187], a[48:63]
ds_read_b64_tr_b16 a[218:219], v15 offset:5120
buffer_load_dwordx4 v3, s[12:15], s48 offen lds
v_mfma_f32_32x32x16_bf16 a[64:79], a[168:171], a[184:187], a[64:79]
ds_read_b64_tr_b16 a[220:221], v16 offset:4096
v_mfma_f32_32x32x16_bf16 a[80:95], a[172:175], a[184:187], a[80:95]
ds_read_b64_tr_b16 a[222:223], v16 offset:5120
v_add_u32 v9, 32768, v9
v_subrev_u32 v20, 98304, v9
v_cmp_le_u32 vcc, 163840, v9
v_add_u32 v13, 16384, v13
v_mfma_f32_32x32x16_bf16 a[96:111], a[160:163], a[188:191], a[96:111]
s_add_u32 m0, s32, 28672
v_and_b32 v13, 65535, v13
v_add_u32 v14, 16384, v14
v_and_b32 v14, 65535, v14
v_add_u32 v15, 16384, v15
v_mfma_f32_32x32x16_bf16 a[112:127], a[164:167], a[188:191], a[112:127]
buffer_load_dwordx4 v4, s[12:15], s48 offen lds
v_and_b32 v15, 65535, v15
v_add_u32 v16, 16384, v16
v_and_b32 v16, 65535, v16
v_mfma_f32_32x32x16_bf16 a[128:143], a[168:171], a[188:191], a[128:143]
s_add_u32 s30, s30, 128
s_add_u32 s32, s32, 32768
s_sub_u32 s24, s32, 98304
s_cmp_ge_u32 s32, 163840
s_cselect_b32 s32, s24, s32
v_cndmask_b32 v9, v9, v20, vcc
v_xor_b32 v10, 32, v9
v_xor_b32 v11, 64, v9
v_xor_b32 v12, 96, v9
v_mfma_f32_32x32x16_bf16 a[144:159], a[172:175], a[188:191], a[144:159]
s_waitcnt vmcnt(17) lgkmcnt(0)
s_barrier
v_mfma_f32_32x32x16_bf16 v[160:175], a[192:195], a[208:211], v[160:175]
ds_read_b64_tr_b16 a[176:177], v13 offset:0
s_mov_b32 m0, s33
v_mfma_f32_32x32x16_bf16 v[176:191], a[196:199], a[208:211], v[176:191]
ds_read_b64_tr_b16 a[178:179], v13 offset:1024
buffer_load_dwordx4 v5, s[20:23], s31 offen offset:0 lds
v_mfma_f32_32x32x16_bf16 v[192:207], a[200:203], a[208:211], v[192:207]
ds_read_b128 a[160:163], v9 offset:0
s_nop 4
v_cvt_pk_bf16_f32 v32, v160, v161
v_cvt_pk_bf16_f32 v33, v162, v163
v_cvt_pk_bf16_f32 v34, v164, v165
v_cvt_pk_bf16_f32 v35, v166, v167
v_cvt_pk_bf16_f32 v36, v168, v169
v_cvt_pk_bf16_f32 v37, v170, v171
v_cvt_pk_bf16_f32 v38, v172, v173
v_cvt_pk_bf16_f32 v39, v174, v175
v_mfma_f32_32x32x16_bf16 v[208:223], a[204:207], a[208:211], v[208:223]
ds_read_b128 a[164:167], v9 offset:4096
v_cvt_pk_bf16_f32 v40, v176, v177
v_cvt_pk_bf16_f32 v41, v178, v179
v_cvt_pk_bf16_f32 v42, v180, v181
v_cvt_pk_bf16_f32 v43, v182, v183
v_cvt_pk_bf16_f32 v44, v184, v185
v_cvt_pk_bf16_f32 v45, v186, v187
v_cvt_pk_bf16_f32 v46, v188, v189
v_cvt_pk_bf16_f32 v47, v190, v191
v_mfma_f32_32x32x16_bf16 v[224:239], a[192:195], a[212:215], v[224:239]
ds_read_b128 a[168:171], v9 offset:8192
v_cvt_pk_bf16_f32 v48, v192, v193
v_cvt_pk_bf16_f32 v49, v194, v195
v_cvt_pk_bf16_f32 v50, v196, v197
v_cvt_pk_bf16_f32 v51, v198, v199
v_cvt_pk_bf16_f32 v52, v200, v201
v_cvt_pk_bf16_f32 v53, v202, v203
v_cvt_pk_bf16_f32 v54, v204, v205
v_cvt_pk_bf16_f32 v55, v206, v207
v_mfma_f32_32x32x16_bf16 v[240:255], a[196:199], a[212:215], v[240:255]
ds_read_b128 a[172:175], v9 offset:12288
buffer_load_dwordx4 v6, s[20:23], s31 offen offset:1024 lds
v_cvt_pk_bf16_f32 v56, v208, v209
v_cvt_pk_bf16_f32 v57, v210, v211
v_cvt_pk_bf16_f32 v58, v212, v213
v_cvt_pk_bf16_f32 v59, v214, v215
v_cvt_pk_bf16_f32 v60, v216, v217
v_cvt_pk_bf16_f32 v61, v218, v219
v_cvt_pk_bf16_f32 v62, v220, v221
v_cvt_pk_bf16_f32 v63, v222, v223
v_mfma_f32_32x32x16_bf16 a[0:15], a[200:203], a[212:215], a[0:15]
ds_read_b64_tr_b16 a[180:181], v14 offset:0
v_cvt_pk_bf16_f32 v64, v224, v225
v_cvt_pk_bf16_f32 v65, v226, v227
v_cvt_pk_bf16_f32 v66, v228, v229
v_cvt_pk_bf16_f32 v67, v230, v231
v_cvt_pk_bf16_f32 v68, v232, v233
v_cvt_pk_bf16_f32 v69, v234, v235
v_cvt_pk_bf16_f32 v70, v236, v237
v_cvt_pk_bf16_f32 v71, v238, v239
v_mfma_f32_32x32x16_bf16 a[16:31], a[204:207], a[212:215], a[16:31]
ds_read_b64_tr_b16 a[182:183], v14 offset:1024
v_cvt_pk_bf16_f32 v72, v240, v241
v_cvt_pk_bf16_f32 v73, v242, v243
v_cvt_pk_bf16_f32 v74, v244, v245
v_cvt_pk_bf16_f32 v75, v246, v247
v_cvt_pk_bf16_f32 v76, v248, v249
v_cvt_pk_bf16_f32 v77, v250, v251
v_cvt_pk_bf16_f32 v78, v252, v253
v_cvt_pk_bf16_f32 v79, v254, v255
v_mfma_f32_32x32x16_bf16 a[32:47], a[192:195], a[216:219], a[32:47]
ds_read_b64_tr_b16 a[184:185], v15 offset:0
v_accvgpr_read_b32 v24, a0
v_accvgpr_read_b32 v25, a1
v_cvt_pk_bf16_f32 v80, v24, v25
v_accvgpr_read_b32 v26, a2
v_accvgpr_read_b32 v27, a3
v_cvt_pk_bf16_f32 v81, v26, v27
v_accvgpr_read_b32 v28, a4
v_accvgpr_read_b32 v29, a5
v_cvt_pk_bf16_f32 v82, v28, v29
v_accvgpr_read_b32 v30, a6
v_accvgpr_read_b32 v31, a7
v_cvt_pk_bf16_f32 v83, v30, v31
v_mfma_f32_32x32x16_bf16 a[48:63], a[196:199], a[216:219], a[48:63]
ds_read_b64_tr_b16 a[186:187], v15 offset:1024
buffer_load_dwordx4 v7, s[20:23], s31 offen offset:2048 lds
v_accvgpr_read_b32 v24, a8
v_accvgpr_read_b32 v25, a9
v_cvt_pk_bf16_f32 v84, v24, v25
v_accvgpr_read_b32 v26, a10
v_accvgpr_read_b32 v27, a11
v_cvt_pk_bf16_f32 v85, v26, v27
v_accvgpr_read_b32 v28, a12
v_accvgpr_read_b32 v29, a13
v_cvt_pk_bf16_f32 v86, v28, v29
v_accvgpr_read_b32 v30, a14
v_accvgpr_read_b32 v31, a15
v_cvt_pk_bf16_f32 v87, v30, v31
v_mfma_f32_32x32x16_bf16 a[64:79], a[200:203], a[216:219], a[64:79]
ds_read_b64_tr_b16 a[188:189], v16 offset:0
v_accvgpr_read_b32 v24, a16
v_accvgpr_read_b32 v25, a17
v_cvt_pk_bf16_f32 v88, v24, v25
v_accvgpr_read_b32 v26, a18
v_accvgpr_read_b32 v27, a19
v_cvt_pk_bf16_f32 v89, v26, v27
v_accvgpr_read_b32 v28, a20
v_accvgpr_read_b32 v29, a21
v_cvt_pk_bf16_f32 v90, v28, v29
v_accvgpr_read_b32 v30, a22
v_accvgpr_read_b32 v31, a23
v_cvt_pk_bf16_f32 v91, v30, v31
v_mfma_f32_32x32x16_bf16 a[80:95], a[204:207], a[216:219], a[80:95]
ds_read_b64_tr_b16 a[190:191], v16 offset:1024
v_accvgpr_read_b32 v24, a24
v_accvgpr_read_b32 v25, a25
v_cvt_pk_bf16_f32 v92, v24, v25
v_accvgpr_read_b32 v26, a26
v_accvgpr_read_b32 v27, a27
v_cvt_pk_bf16_f32 v93, v26, v27
v_accvgpr_read_b32 v28, a28
v_accvgpr_read_b32 v29, a29
v_cvt_pk_bf16_f32 v94, v28, v29
v_accvgpr_read_b32 v30, a30
v_accvgpr_read_b32 v31, a31
v_cvt_pk_bf16_f32 v95, v30, v31
v_mfma_f32_32x32x16_bf16 a[96:111], a[192:195], a[220:223], a[96:111]
v_accvgpr_read_b32 v24, a32
v_accvgpr_read_b32 v25, a33
v_cvt_pk_bf16_f32 v96, v24, v25
v_accvgpr_read_b32 v26, a34
v_accvgpr_read_b32 v27, a35
v_cvt_pk_bf16_f32 v97, v26, v27
v_accvgpr_read_b32 v28, a36
v_accvgpr_read_b32 v29, a37
v_cvt_pk_bf16_f32 v98, v28, v29
v_accvgpr_read_b32 v30, a38
v_accvgpr_read_b32 v31, a39
v_cvt_pk_bf16_f32 v99, v30, v31
v_mfma_f32_32x32x16_bf16 a[112:127], a[196:199], a[220:223], a[112:127]
buffer_load_dwordx4 v8, s[20:23], s31 offen offset:3072 lds
v_accvgpr_read_b32 v24, a40
v_accvgpr_read_b32 v25, a41
v_cvt_pk_bf16_f32 v100, v24, v25
v_accvgpr_read_b32 v26, a42
v_accvgpr_read_b32 v27, a43
v_cvt_pk_bf16_f32 v101, v26, v27
v_accvgpr_read_b32 v28, a44
v_accvgpr_read_b32 v29, a45
v_cvt_pk_bf16_f32 v102, v28, v29
v_accvgpr_read_b32 v30, a46
v_accvgpr_read_b32 v31, a47
v_cvt_pk_bf16_f32 v103, v30, v31
v_mfma_f32_32x32x16_bf16 a[128:143], a[200:203], a[220:223], a[128:143]
s_add_u32 s31, s31, 262144
s_add_u32 s33, s33, 16384
s_and_b32 s33, s33, 65535
v_accvgpr_read_b32 v24, a48
v_accvgpr_read_b32 v25, a49
v_cvt_pk_bf16_f32 v104, v24, v25
v_accvgpr_read_b32 v26, a50
v_accvgpr_read_b32 v27, a51
v_cvt_pk_bf16_f32 v105, v26, v27
v_accvgpr_read_b32 v28, a52
v_accvgpr_read_b32 v29, a53
v_cvt_pk_bf16_f32 v106, v28, v29
v_accvgpr_read_b32 v30, a54
v_accvgpr_read_b32 v31, a55
v_cvt_pk_bf16_f32 v107, v30, v31
v_mfma_f32_32x32x16_bf16 a[144:159], a[204:207], a[220:223], a[144:159]
v_accvgpr_read_b32 v24, a56
v_accvgpr_read_b32 v25, a57
v_cvt_pk_bf16_f32 v108, v24, v25
v_accvgpr_read_b32 v26, a58
v_accvgpr_read_b32 v27, a59
v_cvt_pk_bf16_f32 v109, v26, v27
v_accvgpr_read_b32 v28, a60
v_accvgpr_read_b32 v29, a61
v_cvt_pk_bf16_f32 v110, v28, v29
v_accvgpr_read_b32 v30, a62
v_accvgpr_read_b32 v31, a63
v_cvt_pk_bf16_f32 v111, v30, v31
v_accvgpr_read_b32 v24, a64
v_accvgpr_read_b32 v25, a65
v_cvt_pk_bf16_f32 v112, v24, v25
v_accvgpr_read_b32 v26, a66
v_accvgpr_read_b32 v27, a67
v_cvt_pk_bf16_f32 v113, v26, v27
v_accvgpr_read_b32 v28, a68
v_accvgpr_read_b32 v29, a69
v_cvt_pk_bf16_f32 v114, v28, v29
v_accvgpr_read_b32 v30, a70
v_accvgpr_read_b32 v31, a71
v_cvt_pk_bf16_f32 v115, v30, v31
s_cmp_lt_u32 s35, s45
s_cbranch_scc1 L_g_tile
s_branch L_g_end
L_g_first:
v_mov_b32 v20, 128
s_mov_b32 s28, 0
L_poll_16:
buffer_load_dword v21, v20, s[56:59], 0 offen sc1
s_add_u32 s28, s28, 1
s_cmp_gt_u32 s28, 40000
s_cbranch_scc1 L_end
s_waitcnt vmcnt(0)
v_cmp_ne_u32 vcc, 8, v21
s_cbranch_vccz L_pd_17
s_sleep 1
s_branch L_poll_16
L_pd_17:
s_cmp_eq_u32 s61, 0
s_cbranch_scc1 L_g_go
v_accvgpr_read_b32 v24, a72
v_accvgpr_read_b32 v25, a73
v_cvt_pk_bf16_f32 v116, v24, v25
v_accvgpr_read_b32 v26, a74
v_accvgpr_read_b32 v27, a75
v_cvt_pk_bf16_f32 v117, v26, v27
v_accvgpr_read_b32 v28, a76
v_accvgpr_read_b32 v29, a77
v_cvt_pk_bf16_f32 v118, v28, v29
v_accvgpr_read_b32 v30, a78
v_accvgpr_read_b32 v31, a79
v_cvt_pk_bf16_f32 v119, v30, v31
v_accvgpr_read_b32 v24, a80
v_accvgpr_read_b32 v25, a81
v_cvt_pk_bf16_f32 v120, v24, v25
v_accvgpr_read_b32 v26, a82
v_accvgpr_read_b32 v27, a83
v_cvt_pk_bf16_f32 v121, v26, v27
v_accvgpr_read_b32 v28, a84
v_accvgpr_read_b32 v29, a85
v_cvt_pk_bf16_f32 v122, v28, v29
v_accvgpr_read_b32 v30, a86
v_accvgpr_read_b32 v31, a87
v_cvt_pk_bf16_f32 v123, v30, v31
v_accvgpr_read_b32 v24, a88
v_accvgpr_read_b32 v25, a89
v_cvt_pk_bf16_f32 v124, v24, v25
v_accvgpr_read_b32 v26, a90
v_accvgpr_read_b32 v27, a91
v_cvt_pk_bf16_f32 v125, v26, v27
v_accvgpr_read_b32 v28, a92
v_accvgpr_read_b32 v29, a93
v_cvt_pk_bf16_f32 v126, v28, v29
v_accvgpr_read_b32 v30, a94
v_accvgpr_read_b32 v31, a95
v_cvt_pk_bf16_f32 v127, v30, v31
v_accvgpr_read_b32 v24, a96
v_accvgpr_read_b32 v25, a97
v_cvt_pk_bf16_f32 v128, v24, v25
v_accvgpr_read_b32 v26, a98
v_accvgpr_read_b32 v27, a99
v_cvt_pk_bf16_f32 v129, v26, v27
v_accvgpr_read_b32 v28, a100
v_accvgpr_read_b32 v29, a101
v_cvt_pk_bf16_f32 v130, v28, v29
v_accvgpr_read_b32 v30, a102
v_accvgpr_read_b32 v31, a103
v_cvt_pk_bf16_f32 v131, v30, v31
v_accvgpr_read_b32 v24, a104
v_accvgpr_read_b32 v25, a105
v_cvt_pk_bf16_f32 v132, v24, v25
v_accvgpr_read_b32 v26, a106
v_accvgpr_read_b32 v27, a107
v_cvt_pk_bf16_f32 v133, v26, v27
v_accvgpr_read_b32 v28, a108
v_accvgpr_read_b32 v29, a109
v_cvt_pk_bf16_f32 v134, v28, v29
v_accvgpr_read_b32 v30, a110
v_accvgpr_read_b32 v31, a111
v_cvt_pk_bf16_f32 v135, v30, v31
v_accvgpr_read_b32 v24, a112
v_accvgpr_read_b32 v25, a113
v_cvt_pk_bf16_f32 v136, v24, v25
v_accvgpr_read_b32 v26, a114
v_accvgpr_read_b32 v27, a115
v_cvt_pk_bf16_f32 v137, v26, v27
v_accvgpr_read_b32 v28, a116
v_accvgpr_read_b32 v29, a117
v_cvt_pk_bf16_f32 v138, v28, v29
v_accvgpr_read_b32 v30, a118
v_accvgpr_read_b32 v31, a119
v_cvt_pk_bf16_f32 v139, v30, v31
v_accvgpr_read_b32 v24, a120
v_accvgpr_read_b32 v25, a121
v_cvt_pk_bf16_f32 v140, v24, v25
v_accvgpr_read_b32 v26, a122
v_accvgpr_read_b32 v27, a123
v_cvt_pk_bf16_f32 v141, v26, v27
v_accvgpr_read_b32 v28, a124
v_accvgpr_read_b32 v29, a125
v_cvt_pk_bf16_f32 v142, v28, v29
v_accvgpr_read_b32 v30, a126
v_accvgpr_read_b32 v31, a127
v_cvt_pk_bf16_f32 v143, v30, v31
v_accvgpr_read_b32 v24, a128
v_accvgpr_read_b32 v25, a129
v_cvt_pk_bf16_f32 v144, v24, v25
v_accvgpr_read_b32 v26, a130
v_accvgpr_read_b32 v27, a131
v_cvt_pk_bf16_f32 v145, v26, v27
v_accvgpr_read_b32 v28, a132
v_accvgpr_read_b32 v29, a133
v_cvt_pk_bf16_f32 v146, v28, v29
v_accvgpr_read_b32 v30, a134
v_accvgpr_read_b32 v31, a135
v_cvt_pk_bf16_f32 v147, v30, v31
v_accvgpr_read_b32 v24, a136
v_accvgpr_read_b32 v25, a137
v_cvt_pk_bf16_f32 v148, v24, v25
v_accvgpr_read_b32 v26, a138
v_accvgpr_read_b32 v27, a139
v_cvt_pk_bf16_f32 v149, v26, v27
v_accvgpr_read_b32 v28, a140
v_accvgpr_read_b32 v29, a141
v_cvt_pk_bf16_f32 v150, v28, v29
v_accvgpr_read_b32 v30, a142
v_accvgpr_read_b32 v31, a143
v_cvt_pk_bf16_f32 v151, v30, v31
v_accvgpr_read_b32 v24, a144
v_accvgpr_read_b32 v25, a145
v_cvt_pk_bf16_f32 v152, v24, v25
v_accvgpr_read_b32 v26, a146
v_accvgpr_read_b32 v27, a147
v_cvt_pk_bf16_f32 v153, v26, v27
v_accvgpr_read_b32 v28, a148
v_accvgpr_read_b32 v29, a149
v_cvt_pk_bf16_f32 v154, v28, v29
v_accvgpr_read_b32 v30, a150
v_accvgpr_read_b32 v31, a151
v_cvt_pk_bf16_f32 v155, v30, v31
v_accvgpr_read_b32 v24, a152
v_accvgpr_read_b32 v25, a153
v_cvt_pk_bf16_f32 v156, v24, v25
v_accvgpr_read_b32 v26, a154
v_accvgpr_read_b32 v27, a155
v_cvt_pk_bf16_f32 v157, v26, v27
v_accvgpr_read_b32 v28, a156
v_accvgpr_read_b32 v29, a157
v_cvt_pk_bf16_f32 v158, v28, v29
v_accvgpr_read_b32 v30, a158
v_accvgpr_read_b32 v31, a159
v_cvt_pk_bf16_f32 v159, v30, v31
v_and_b32 v18, 63, v0
v_bfe_u32 v19, v0, 1, 4
v_and_b32 v20, 1, v0
v_lshl_add_u32 v19, v20, 4, v19
v_and_or_b32 v19, v0, 32, v19
v_cmp_eq_u32 vcc, 0, s49
s_nop 1
v_cndmask_b32 v18, v19, v18, vcc
v_lshlrev_b32 v17, 4, v18
s_add_u32 s25, s38, 0
buffer_store_dwordx4 v[32:35], v17, s[8:11], s25 offen offset:0 sc1
s_add_u32 s25, s38, 0
buffer_store_dwordx4 v[36:39], v17, s[8:11], s25 offen offset:1024 sc1
s_add_u32 s25, s38, 16384
buffer_store_dwordx4 v[40:43], v17, s[8:11], s25 offen offset:0 sc1
s_add_u32 s25, s38, 16384
buffer_store_dwordx4 v[44:47], v17, s[8:11], s25 offen offset:1024 sc1
s_add_u32 s25, s38, 32768
buffer_store_dwordx4 v[48:51], v17, s[8:11], s25 offen offset:0 sc1
s_add_u32 s25, s38, 32768
buffer_store_dwordx4 v[52:55], v17, s[8:11], s25 offen offset:1024 sc1
s_add_u32 s25, s38, 49152
buffer_store_dwordx4 v[56:59], v17, s[8:11], s25 offen offset:0 sc1
s_add_u32 s25, s38, 49152
buffer_store_dwordx4 v[60:63], v17, s[8:11], s25 offen offset:1024 sc1
s_add_u32 s25, s38, 2048
buffer_store_dwordx4 v[64:67], v17, s[8:11], s25 offen offset:0 sc1
s_add_u32 s25, s38, 2048
buffer_store_dwordx4 v[68:71], v17, s[8:11], s25 offen offset:1024 sc1
s_add_u32 s25, s38, 18432
buffer_store_dwordx4 v[72:75], v17, s[8:11], s25 offen offset:0 sc1
s_add_u32 s25, s38, 18432
buffer_store_dwordx4 v[76:79], v17, s[8:11], s25 offen offset:1024 sc1
s_add_u32 s25, s38, 34816
buffer_store_dwordx4 v[80:83], v17, s[8:11], s25 offen offset:0 sc1
s_add_u32 s25, s38, 34816
buffer_store_dwordx4 v[84:87], v17, s[8:11], s25 offen offset:1024 sc1
s_add_u32 s25, s38, 51200
buffer_store_dwordx4 v[88:91], v17, s[8:11], s25 offen offset:0 sc1
s_add_u32 s25, s38, 51200
buffer_store_dwordx4 v[92:95], v17, s[8:11], s25 offen offset:1024 sc1
s_add_u32 s25, s38, 4096
buffer_store_dwordx4 v[96:99], v17, s[8:11], s25 offen offset:0 sc1
s_add_u32 s25, s38, 4096
buffer_store_dwordx4 v[100:103], v17, s[8:11], s25 offen offset:1024 sc1
s_add_u32 s25, s38, 20480
buffer_store_dwordx4 v[104:107], v17, s[8:11], s25 offen offset:0 sc1
s_add_u32 s25, s38, 20480
buffer_store_dwordx4 v[108:111], v17, s[8:11], s25 offen offset:1024 sc1
s_add_u32 s25, s38, 36864
buffer_store_dwordx4 v[112:115], v17, s[8:11], s25 offen offset:0 sc1
s_add_u32 s25, s38, 36864
buffer_store_dwordx4 v[116:119], v17, s[8:11], s25 offen offset:1024 sc1
s_add_u32 s25, s38, 53248
buffer_store_dwordx4 v[120:123], v17, s[8:11], s25 offen offset:0 sc1
s_add_u32 s25, s38, 53248
buffer_store_dwordx4 v[124:127], v17, s[8:11], s25 offen offset:1024 sc1
s_add_u32 s25, s38, 6144
buffer_store_dwordx4 v[128:131], v17, s[8:11], s25 offen offset:0 sc1
s_add_u32 s25, s38, 6144
buffer_store_dwordx4 v[132:135], v17, s[8:11], s25 offen offset:1024 sc1
s_add_u32 s25, s38, 22528
buffer_store_dwordx4 v[136:139], v17, s[8:11], s25 offen offset:0 sc1
s_add_u32 s25, s38, 22528
buffer_store_dwordx4 v[140:143], v17, s[8:11], s25 offen offset:1024 sc1
s_add_u32 s25, s38, 38912
buffer_store_dwordx4 v[144:147], v17, s[8:11], s25 offen offset:0 sc1
s_add_u32 s25, s38, 38912
buffer_store_dwordx4 v[148:151], v17, s[8:11], s25 offen offset:1024 sc1
s_add_u32 s25, s38, 55296
buffer_store_dwordx4 v[152:155], v17, s[8:11], s25 offen offset:0 sc1
s_add_u32 s25, s38, 55296
buffer_store_dwordx4 v[156:159], v17, s[8:11], s25 offen offset:1024 sc1
s_waitcnt vmcnt(0)
s_barrier
v_mov_b32 v18, 0
v_mov_b32 v19, s29
s_cmp_eq_u32 s17, 0
s_cselect_b32 s25, s39, 536870912
s_mov_b64 exec, 1
buffer_store_dword v19, v18, s[8:11], s25 offen sc1
s_mov_b64 exec, -1
s_mov_b32 s38, 536870912
s_mov_b32 s39, 536870912
s_branch L_g_go
L_g_end:
v_accvgpr_read_b32 v24, a72
v_accvgpr_read_b32 v25, a73
v_cvt_pk_bf16_f32 v116, v24, v25
v_accvgpr_read_b32 v26, a74
v_accvgpr_read_b32 v27, a75
v_cvt_pk_bf16_f32 v117, v26, v27
v_accvgpr_read_b32 v28, a76
v_accvgpr_read_b32 v29, a77
v_cvt_pk_bf16_f32 v118, v28, v29
v_accvgpr_read_b32 v30, a78
v_accvgpr_read_b32 v31, a79
v_cvt_pk_bf16_f32 v119, v30, v31
v_accvgpr_read_b32 v24, a80
v_accvgpr_read_b32 v25, a81
v_cvt_pk_bf16_f32 v120, v24, v25
v_accvgpr_read_b32 v26, a82
v_accvgpr_read_b32 v27, a83
v_cvt_pk_bf16_f32 v121, v26, v27
v_accvgpr_read_b32 v28, a84
v_accvgpr_read_b32 v29, a85
v_cvt_pk_bf16_f32 v122, v28, v29
v_accvgpr_read_b32 v30, a86
v_accvgpr_read_b32 v31, a87
v_cvt_pk_bf16_f32 v123, v30, v31
v_accvgpr_read_b32 v24, a88
v_accvgpr_read_b32 v25, a89
v_cvt_pk_bf16_f32 v124, v24, v25
v_accvgpr_read_b32 v26, a90
v_accvgpr_read_b32 v27, a91
v_cvt_pk_bf16_f32 v125, v26, v27
v_accvgpr_read_b32 v28, a92
v_accvgpr_read_b32 v29, a93
v_cvt_pk_bf16_f32 v126, v28, v29
v_accvgpr_read_b32 v30, a94
v_accvgpr_read_b32 v31, a95
v_cvt_pk_bf16_f32 v127, v30, v31
v_accvgpr_read_b32 v24, a96
v_accvgpr_read_b32 v25, a97
v_cvt_pk_bf16_f32 v128, v24, v25
v_accvgpr_read_b32 v26, a98
v_accvgpr_read_b32 v27, a99
v_cvt_pk_bf16_f32 v129, v26, v27
v_accvgpr_read_b32 v28, a100
v_accvgpr_read_b32 v29, a101
v_cvt_pk_bf16_f32 v130, v28, v29
v_accvgpr_read_b32 v30, a102
v_accvgpr_read_b32 v31, a103
v_cvt_pk_bf16_f32 v131, v30, v31
v_accvgpr_read_b32 v24, a104
v_accvgpr_read_b32 v25, a105
v_cvt_pk_bf16_f32 v132, v24, v25
v_accvgpr_read_b32 v26, a106
v_accvgpr_read_b32 v27, a107
v_cvt_pk_bf16_f32 v133, v26, v27
v_accvgpr_read_b32 v28, a108
v_accvgpr_read_b32 v29, a109
v_cvt_pk_bf16_f32 v134, v28, v29
v_accvgpr_read_b32 v30, a110
v_accvgpr_read_b32 v31, a111
v_cvt_pk_bf16_f32 v135, v30, v31
v_accvgpr_read_b32 v24, a112
v_accvgpr_read_b32 v25, a113
v_cvt_pk_bf16_f32 v136, v24, v25
v_accvgpr_read_b32 v26, a114
v_accvgpr_read_b32 v27, a115
v_cvt_pk_bf16_f32 v137, v26, v27
v_accvgpr_read_b32 v28, a116
v_accvgpr_read_b32 v29, a117
v_cvt_pk_bf16_f32 v138, v28, v29
v_accvgpr_read_b32 v30, a118
v_accvgpr_read_b32 v31, a119
v_cvt_pk_bf16_f32 v139, v30, v31
v_accvgpr_read_b32 v24, a120
v_accvgpr_read_b32 v25, a121
v_cvt_pk_bf16_f32 v140, v24, v25
v_accvgpr_read_b32 v26, a122
v_accvgpr_read_b32 v27, a123
v_cvt_pk_bf16_f32 v141, v26, v27
v_accvgpr_read_b32 v28, a124
v_accvgpr_read_b32 v29, a125
v_cvt_pk_bf16_f32 v142, v28, v29
v_accvgpr_read_b32 v30, a126
v_accvgpr_read_b32 v31, a127
v_cvt_pk_bf16_f32 v143, v30, v31
v_accvgpr_read_b32 v24, a128
v_accvgpr_read_b32 v25, a129
v_cvt_pk_bf16_f32 v144, v24, v25
v_accvgpr_read_b32 v26, a130
v_accvgpr_read_b32 v27, a131
v_cvt_pk_bf16_f32 v145, v26, v27
v_accvgpr_read_b32 v28, a132
v_accvgpr_read_b32 v29, a133
v_cvt_pk_bf16_f32 v146, v28, v29
v_accvgpr_read_b32 v30, a134
v_accvgpr_read_b32 v31, a135
v_cvt_pk_bf16_f32 v147, v30, v31
v_accvgpr_read_b32 v24, a136
v_accvgpr_read_b32 v25, a137
v_cvt_pk_bf16_f32 v148, v24, v25
v_accvgpr_read_b32 v26, a138
v_accvgpr_read_b32 v27, a139
v_cvt_pk_bf16_f32 v149, v26, v27
v_accvgpr_read_b32 v28, a140
v_accvgpr_read_b32 v29, a141
v_cvt_pk_bf16_f32 v150, v28, v29
v_accvgpr_read_b32 v30, a142
v_accvgpr_read_b32 v31, a143
v_cvt_pk_bf16_f32 v151, v30, v31
v_accvgpr_read_b32 v24, a144
v_accvgpr_read_b32 v25, a145
v_cvt_pk_bf16_f32 v152, v24, v25
v_accvgpr_read_b32 v26, a146
v_accvgpr_read_b32 v27, a147
v_cvt_pk_bf16_f32 v153, v26, v27
v_accvgpr_read_b32 v28, a148
v_accvgpr_read_b32 v29, a149
v_cvt_pk_bf16_f32 v154, v28, v29
v_accvgpr_read_b32 v30, a150
v_accvgpr_read_b32 v31, a151
v_cvt_pk_bf16_f32 v155, v30, v31
v_accvgpr_read_b32 v24, a152
v_accvgpr_read_b32 v25, a153
v_cvt_pk_bf16_f32 v156, v24, v25
v_accvgpr_read_b32 v26, a154
v_accvgpr_read_b32 v27, a155
v_cvt_pk_bf16_f32 v157, v26, v27
v_accvgpr_read_b32 v28, a156
v_accvgpr_read_b32 v29, a157
v_cvt_pk_bf16_f32 v158, v28, v29
v_accvgpr_read_b32 v30, a158
v_accvgpr_read_b32 v31, a159
v_cvt_pk_bf16_f32 v159, v30, v31
v_and_b32 v18, 63, v0
v_bfe_u32 v19, v0, 1, 4
v_and_b32 v20, 1, v0
v_lshl_add_u32 v19, v20, 4, v19
v_and_or_b32 v19, v0, 32, v19
v_cmp_eq_u32 vcc, 0, s50
s_nop 1
v_cndmask_b32 v18, v19, v18, vcc
v_lshlrev_b32 v17, 4, v18
s_add_u32 s25, s62, 0
buffer_store_dwordx4 v[32:35], v17, s[8:11], s25 offen offset:0 sc1
s_add_u32 s25, s62, 0
buffer_store_dwordx4 v[36:39], v17, s[8:11], s25 offen offset:1024 sc1
s_add_u32 s25, s62, 16384
buffer_store_dwordx4 v[40:43], v17, s[8:11], s25 offen offset:0 sc1
s_add_u32 s25, s62, 16384
buffer_store_dwordx4 v[44:47], v17, s[8:11], s25 offen offset:1024 sc1
s_add_u32 s25, s62, 32768
buffer_store_dwordx4 v[48:51], v17, s[8:11], s25 offen offset:0 sc1
s_add_u32 s25, s62, 32768
buffer_store_dwordx4 v[52:55], v17, s[8:11], s25 offen offset:1024 sc1
s_add_u32 s25, s62, 49152
buffer_store_dwordx4 v[56:59], v17, s[8:11], s25 offen offset:0 sc1
s_add_u32 s25, s62, 49152
buffer_store_dwordx4 v[60:63], v17, s[8:11], s25 offen offset:1024 sc1
s_add_u32 s25, s62, 2048
buffer_store_dwordx4 v[64:67], v17, s[8:11], s25 offen offset:0 sc1
s_add_u32 s25, s62, 2048
buffer_store_dwordx4 v[68:71], v17, s[8:11], s25 offen offset:1024 sc1
s_add_u32 s25, s62, 18432
buffer_store_dwordx4 v[72:75], v17, s[8:11], s25 offen offset:0 sc1
s_add_u32 s25, s62, 18432
buffer_store_dwordx4 v[76:79], v17, s[8:11], s25 offen offset:1024 sc1
s_add_u32 s25, s62, 34816
buffer_store_dwordx4 v[80:83], v17, s[8:11], s25 offen offset:0 sc1
s_add_u32 s25, s62, 34816
buffer_store_dwordx4 v[84:87], v17, s[8:11], s25 offen offset:1024 sc1
s_add_u32 s25, s62, 51200
buffer_store_dwordx4 v[88:91], v17, s[8:11], s25 offen offset:0 sc1
s_add_u32 s25, s62, 51200
buffer_store_dwordx4 v[92:95], v17, s[8:11], s25 offen offset:1024 sc1
s_add_u32 s25, s62, 4096
buffer_store_dwordx4 v[96:99], v17, s[8:11], s25 offen offset:0 sc1
s_add_u32 s25, s62, 4096
buffer_store_dwordx4 v[100:103], v17, s[8:11], s25 offen offset:1024 sc1
s_add_u32 s25, s62, 20480
buffer_store_dwordx4 v[104:107], v17, s[8:11], s25 offen offset:0 sc1
s_add_u32 s25, s62, 20480
buffer_store_dwordx4 v[108:111], v17, s[8:11], s25 offen offset:1024 sc1
s_add_u32 s25, s62, 36864
buffer_store_dwordx4 v[112:115], v17, s[8:11], s25 offen offset:0 sc1
s_add_u32 s25, s62, 36864
buffer_store_dwordx4 v[116:119], v17, s[8:11], s25 offen offset:1024 sc1
s_add_u32 s25, s62, 53248
buffer_store_dwordx4 v[120:123], v17, s[8:11], s25 offen offset:0 sc1
s_add_u32 s25, s62, 53248
buffer_store_dwordx4 v[124:127], v17, s[8:11], s25 offen offset:1024 sc1
s_add_u32 s25, s62, 6144
buffer_store_dwordx4 v[128:131], v17, s[8:11], s25 offen offset:0 sc1
s_add_u32 s25, s62, 6144
buffer_store_dwordx4 v[132:135], v17, s[8:11], s25 offen offset:1024 sc1
s_add_u32 s25, s62, 22528
buffer_store_dwordx4 v[136:139], v17, s[8:11], s25 offen offset:0 sc1
s_add_u32 s25, s62, 22528
buffer_store_dwordx4 v[140:143], v17, s[8:11], s25 offen offset:1024 sc1
s_add_u32 s25, s62, 38912
buffer_store_dwordx4 v[144:147], v17, s[8:11], s25 offen offset:0 sc1
s_add_u32 s25, s62, 38912
buffer_store_dwordx4 v[148:151], v17, s[8:11], s25 offen offset:1024 sc1
s_add_u32 s25, s62, 55296
buffer_store_dwordx4 v[152:155], v17, s[8:11], s25 offen offset:0 sc1
s_add_u32 s25, s62, 55296
buffer_store_dwordx4 v[156:159], v17, s[8:11], s25 offen offset:1024 sc1
v_mov_b32 v20, 128
s_mov_b32 s28, 0
L_poll_18:
buffer_load_dword v21, v20, s[56:59], 0 offen sc1
s_add_u32 s28, s28, 1
s_cmp_gt_u32 s28, 40000
s_cbranch_scc1 L_end
s_waitcnt vmcnt(0)
v_cmp_ne_u32 vcc, 8, v21
s_cbranch_vccz L_pd_19
s_sleep 1
s_branch L_poll_18
L_pd_19:
s_waitcnt vmcnt(0) lgkmcnt(0)
s_barrier
v_mov_b32 v18, 0
v_mov_b32 v19, s60
s_cmp_eq_u32 s17, 0
s_cselect_b32 s25, s63, 536870912
s_mov_b64 exec, 1
buffer_store_dword v19, v18, s[8:11], s25 offen sc1
s_mov_b64 exec, -1
s_cmp_eq_u32 s3, 1
s_cbranch_scc1 L_part
s_cmp_eq_u32 s61, 1
s_cbranch_scc1 L_aop
s_sub_u32 s24, s3, 4
s_lshl_b32 s24, s24, 3
s_lshr_b32 s42, s16, 2
s_add_u32 s42, s42, s24
s_and_b32 s62, s16, 3
s_mov_b32 s40, 0x3e0293ee
s_mov_b32 s50, 0xf149f2ca
s_mov_b32 s51, 0x41a00000
v_and_b32 v20, 7, v0
v_lshlrev_b32 v20, 2, v20
v_bfe_u32 v21, v0, 3, 1
s_lshl_b32 s25, s42, 7
s_add_u32 s25, s25, 111165440
s_lshr_b32 s24, s42, 1
s_lshl_b32 s24, s24, 7
s_add_u32 s24, s24, 111173632
s_sub_u32 s24, s24, s25
v_mad_u32_u24 v20, v21, s24, v20
s_mov_b32 s28, 0
L_poll_20:
buffer_load_dword v21, v20, s[8:11], s25 offen sc1
s_add_u32 s28, s28, 1
s_cmp_gt_u32 s28, 40000
s_cbranch_scc1 L_end
s_waitcnt vmcnt(0)
v_cmp_ne_u32 vcc, 1, v21
s_cbranch_vccz L_pd_21
s_sleep 1
s_branch L_poll_20
L_pd_21:
s_sub_u32 s41, 7, s62
s_mov_b32 s60, 0
L_aat:
v_and_b32 v5, 31, v0
v_bfe_u32 v26, v0, 5, 1
v_lshlrev_b32 v27, 2, v26
v_sub_u32 v5, v5, v27
v_bfe_u32 v27, v0, 4, 1
v_lshlrev_b32 v6, 17, v27
v_lshl_add_u32 v6, v26, 8, v6
v_and_b32 v27, 15, v0
v_lshl_add_u32 v6, v27, 4, v6
v_and_b32 v2, 63, v0
v_lshlrev_b32 v2, 4, v2
s_lshl_b32 s24, s17, 13
v_add_u32 v1, s24, v2
v_add_u32 v3, 32768, v2
v_mov_b32 v4, v2
s_lshl_b32 s46, s42, 20
s_add_u32 s46, s46, 0
s_mov_b32 s47, s24
s_lshl_b32 s44, s41, 2
s_add_u32 s45, s44, 4
s_add_u32 s44, s44, s17
s_mov_b32 s43, 0
s_mov_b32 s48, 0
s_barrier
s_lshr_b32 s26, s42, 1
s_lshl_b32 s26, s26, 6
s_lshl_b32 s27, s44, 1
s_add_u32 s26, s26, s27
s_lshl_b32 s26, s26, 1
s_and_b32 s27, s42, 1
s_add_u32 s26, s26, s27
s_lshl_b32 s26, s26, 13
s_add_u32 s26, s26, 117440512
s_add_u32 s27, s26, 0
buffer_load_dwordx4 a[0:3], v2, s[8:11], s27 offen offset:0 sc1
buffer_load_dwordx4 a[4:7], v2, s[8:11], s27 offen offset:1024 sc1
buffer_load_dwordx4 a[8:11], v2, s[8:11], s27 offen offset:2048 sc1
buffer_load_dwordx4 a[12:15], v2, s[8:11], s27 offen offset:3072 sc1
s_add_u32 s27, s26, 4096
buffer_load_dwordx4 a[16:19], v2, s[8:11], s27 offen offset:0 sc1
buffer_load_dwordx4 a[20:23], v2, s[8:11], s27 offen offset:1024 sc1
buffer_load_dwordx4 a[24:27], v2, s[8:11], s27 offen offset:2048 sc1
buffer_load_dwordx4 a[28:31], v2, s[8:11], s27 offen offset:3072 sc1
s_add_u32 s27, s26, 16384
buffer_load_dwordx4 a[32:35], v2, s[8:11], s27 offen offset:0 sc1
buffer_load_dwordx4 a[36:39], v2, s[8:11], s27 offen offset:1024 sc1
buffer_load_dwordx4 a[40:43], v2, s[8:11], s27 offen offset:2048 sc1
buffer_load_dwordx4 a[44:47], v2, s[8:11], s27 offen offset:3072 sc1
s_add_u32 s27, s26, 20480
buffer_load_dwordx4 a[48:51], v2, s[8:11], s27 offen offset:0 sc1
buffer_load_dwordx4 a[52:55], v2, s[8:11], s27 offen offset:1024 sc1
buffer_load_dwordx4 a[56:59], v2, s[8:11], s27 offen offset:2048 sc1
buffer_load_dwordx4 a[60:63], v2, s[8:11], s27 offen offset:3072 sc1
s_mov_b32 m0, s47
s_add_u32 s24, s46, 4096
buffer_load_dwordx4 v1, s[8:11], s46 offen offset:0 sc1 lds
buffer_load_dwordx4 v1, s[8:11], s46 offen offset:1024 sc1 lds
buffer_load_dwordx4 v1, s[8:11], s46 offen offset:2048 sc1 lds
buffer_load_dwordx4 v1, s[8:11], s46 offen offset:3072 sc1 lds
s_add_u32 m0, s47, 4096
s_nop 0
buffer_load_dwordx4 v1, s[8:11], s24 offen offset:0 sc1 lds
buffer_load_dwordx4 v1, s[8:11], s24 offen offset:1024 sc1 lds
buffer_load_dwordx4 v1, s[8:11], s24 offen offset:2048 sc1 lds
buffer_load_dwordx4 v1, s[8:11], s24 offen offset:3072 sc1 lds
s_add_u32 s46, s46, 32768
s_add_u32 s47, s47, 32768
s_and_b32 s47, s47, 131071
s_mov_b32 m0, s47
s_add_u32 s24, s46, 4096
buffer_load_dwordx4 v1, s[8:11], s46 offen offset:0 sc1 lds
buffer_load_dwordx4 v1, s[8:11], s46 offen offset:1024 sc1 lds
buffer_load_dwordx4 v1, s[8:11], s46 offen offset:2048 sc1 lds
buffer_load_dwordx4 v1, s[8:11], s46 offen offset:3072 sc1 lds
s_add_u32 m0, s47, 4096
s_nop 0
buffer_load_dwordx4 v1, s[8:11], s24 offen offset:0 sc1 lds
buffer_load_dwordx4 v1, s[8:11], s24 offen offset:1024 sc1 lds
buffer_load_dwordx4 v1, s[8:11], s24 offen offset:2048 sc1 lds
buffer_load_dwordx4 v1, s[8:11], s24 offen offset:3072 sc1 lds
s_add_u32 s46, s46, 32768
s_add_u32 s47, s47, 32768
s_and_b32 s47, s47, 131071
s_mov_b32 m0, s47
s_add_u32 s24, s46, 4096
buffer_load_dwordx4 v1, s[8:11], s46 offen offset:0 sc1 lds
buffer_load_dwordx4 v1, s[8:11], s46 offen offset:1024 sc1 lds
buffer_load_dwordx4 v1, s[8:11], s46 offen offset:2048 sc1 lds
buffer_load_dwordx4 v1, s[8:11], s46 offen offset:3072 sc1 lds
s_add_u32 m0, s47, 4096
s_nop 0
buffer_load_dwordx4 v1, s[8:11], s24 offen offset:0 sc1 lds
buffer_load_dwordx4 v1, s[8:11], s24 offen offset:1024 sc1 lds
buffer_load_dwordx4 v1, s[8:11], s24 offen offset:2048 sc1 lds
buffer_load_dwordx4 v1, s[8:11], s24 offen offset:3072 sc1 lds
s_add_u32 s46, s46, 32768
s_add_u32 s47, s47, 32768
s_and_b32 s47, s47, 131071
v_mov_b64 v[128:129], 0
v_mov_b64 v[130:131], 0
v_mov_b64 v[132:133], 0
v_mov_b64 v[134:135], 0
v_mov_b64 v[136:137], 0
v_mov_b64 v[138:139], 0
v_mov_b64 v[140:141], 0
v_mov_b64 v[142:143], 0
v_mov_b64 v[144:145], 0
v_mov_b64 v[146:147], 0
v_mov_b64 v[148:149], 0
v_mov_b64 v[150:151], 0
v_mov_b64 v[152:153], 0
v_mov_b64 v[154:155], 0
v_mov_b64 v[156:157], 0
v_mov_b64 v[158:159], 0
v_mov_b64 v[160:161], 0
v_mov_b64 v[162:163], 0
v_mov_b64 v[164:165], 0
v_mov_b64 v[166:167], 0
v_mov_b64 v[168:169], 0
v_mov_b64 v[170:171], 0
v_mov_b64 v[172:173], 0
v_mov_b64 v[174:175], 0
v_mov_b64 v[176:177], 0
v_mov_b64 v[178:179], 0
v_mov_b64 v[180:181], 0
v_mov_b64 v[182:183], 0
v_mov_b64 v[184:185], 0
v_mov_b64 v[186:187], 0
v_mov_b64 v[188:189], 0
v_mov_b64 v[190:191], 0
v_mov_b64 v[192:193], 0
v_mov_b64 v[194:195], 0
v_mov_b64 v[196:197], 0
v_mov_b64 v[198:199], 0
v_mov_b64 v[200:201], 0
v_mov_b64 v[202:203], 0
v_mov_b64 v[204:205], 0
v_mov_b64 v[206:207], 0
v_mov_b64 v[208:209], 0
v_mov_b64 v[210:211], 0
v_mov_b64 v[212:213], 0
v_mov_b64 v[214:215], 0
v_mov_b64 v[216:217], 0
v_mov_b64 v[218:219], 0
v_mov_b64 v[220:221], 0
v_mov_b64 v[222:223], 0
v_mov_b64 v[224:225], 0
v_mov_b64 v[226:227], 0
v_mov_b64 v[228:229], 0
v_mov_b64 v[230:231], 0
v_mov_b64 v[232:233], 0
v_mov_b64 v[234:235], 0
v_mov_b64 v[236:237], 0
v_mov_b64 v[238:239], 0
v_mov_b64 v[240:241], 0
v_mov_b64 v[242:243], 0
v_mov_b64 v[244:245], 0
v_mov_b64 v[246:247], 0
v_mov_b64 v[248:249], 0
v_mov_b64 v[250:251], 0
v_mov_b64 v[252:253], 0
v_mov_b64 v[254:255], 0
v_mov_b64 v[112:113], 0
v_mov_b64 v[114:115], 0
v_mov_b64 v[116:117], 0
v_mov_b64 v[118:119], 0
v_mov_b64 v[120:121], 0
v_mov_b64 v[122:123], 0
v_mov_b64 v[124:125], 0
v_mov_b64 v[126:127], 0
v_mov_b32 v20, s50
v_mov_b32 v21, s50
v_mov_b64 v[22:23], 0
s_waitcnt vmcnt(16)
s_barrier
ds_read_b128 a[64:67], v2 offset:0
ds_read_b128 a[68:71], v2 offset:1024
ds_read_b128 a[72:75], v2 offset:2048
ds_read_b128 a[76:79], v2 offset:3072
s_waitcnt lgkmcnt(3)
v_mfma_f32_32x32x16_bf16 v[32:47], a[64:67], a[0:3], 0
ds_read_b128 a[80:83], v2 offset:4096
v_mfma_f32_32x32x16_bf16 v[48:63], a[64:67], a[32:35], 0
s_waitcnt lgkmcnt(3)
v_mfma_f32_32x32x16_bf16 v[32:47], a[68:71], a[4:7], v[32:47]
ds_read_b128 a[84:87], v2 offset:5120
v_mfma_f32_32x32x16_bf16 v[48:63], a[68:71], a[36:39], v[48:63]
s_waitcnt lgkmcnt(3)
v_mfma_f32_32x32x16_bf16 v[32:47], a[72:75], a[8:11], v[32:47]
ds_read_b128 a[88:91], v2 offset:6144
v_mfma_f32_32x32x16_bf16 v[48:63], a[72:75], a[40:43], v[48:63]
s_waitcnt lgkmcnt(3)
v_mfma_f32_32x32x16_bf16 v[32:47], a[76:79], a[12:15], v[32:47]
ds_read_b128 a[92:95], v2 offset:7168
v_mfma_f32_32x32x16_bf16 v[48:63], a[76:79], a[44:47], v[48:63]
s_waitcnt lgkmcnt(3)
v_mfma_f32_32x32x16_bf16 v[32:47], a[80:83], a[16:19], v[32:47]
ds_read_b128 a[64:67], v4 offset:24576
v_mfma_f32_32x32x16_bf16 v[48:63], a[80:83], a[48:51], v[48:63]
s_waitcnt lgkmcnt(3)
v_mfma_f32_32x32x16_bf16 v[32:47], a[84:87], a[20:23], v[32:47]
ds_read_b128 a[68:71], v4 offset:25600
v_mfma_f32_32x32x16_bf16 v[48:63], a[84:87], a[52:55], v[48:63]
s_waitcnt lgkmcnt(3)
v_mfma_f32_32x32x16_bf16 v[32:47], a[88:91], a[24:27], v[32:47]
ds_read_b128 a[72:75], v4 offset:26624
v_mfma_f32_32x32x16_bf16 v[48:63], a[88:91], a[56:59], v[48:63]
s_waitcnt lgkmcnt(3)
v_mfma_f32_32x32x16_bf16 v[32:47], a[92:95], a[28:31], v[32:47]
ds_read_b128 a[76:79], v4 offset:27648
v_mfma_f32_32x32x16_bf16 v[48:63], a[92:95], a[60:63], v[48:63]
s_cmp_eq_u32 s44, 0
s_cbranch_scc1 L_at_last
.p2align 3
L_at_loop:
s_waitcnt lgkmcnt(3)
v_mfma_f32_32x32x16_bf16 v[128:143], a[64:67], v[112:115], v[128:143]
ds_read_b128 a[80:83], v4 offset:28672
v_mfma_f32_32x32x16_bf16 v[144:159], a[64:67], v[120:123], v[144:159]
s_add_u32 s24, s43, 3
s_cmp_lt_u32 s24, s45
s_cselect_b32 s46, s46, 536870912
s_waitcnt lgkmcnt(3)
v_mfma_f32_32x32x16_bf16 v[128:143], a[68:71], v[116:119], v[128:143]
ds_read_b128 a[84:87], v4 offset:29696
v_max3_f32 v26, v32, v33, v34
v_max3_f32 v26, v26, v35, v36
v_max3_f32 v26, v26, v37, v38
v_max3_f32 v26, v26, v39, v40
v_max3_f32 v26, v26, v41, v42
v_max3_f32 v26, v26, v43, v44
v_mfma_f32_32x32x16_bf16 v[144:159], a[68:71], v[124:127], v[144:159]
v_max3_f32 v26, v26, v45, v46
v_max_f32 v26, v26, v47
v_max3_f32 v27, v48, v49, v50
v_max3_f32 v27, v27, v51, v52
v_max3_f32 v27, v27, v53, v54
s_waitcnt lgkmcnt(3)
v_mfma_f32_32x32x16_bf16 v[160:175], a[72:75], v[112:115], v[160:175]
ds_read_b128 a[88:91], v4 offset:30720
v_max3_f32 v27, v27, v55, v56
v_max3_f32 v27, v27, v57, v58
v_max3_f32 v27, v27, v59, v60
v_max3_f32 v27, v27, v61, v62
v_max_f32 v27, v27, v63
v_fma_f32 v28, v26, s40, -v20
v_mfma_f32_32x32x16_bf16 v[176:191], a[72:75], v[120:123], v[176:191]
v_fma_f32 v29, v27, s40, -v21
v_max_f32 v28, v28, v29
v_cmp_lt_f32 vcc, s51, v28
s_cbranch_vccnz L_at_upa
L_at_upra:
v_fma_f32 v32, v32, s40, -v20
s_waitcnt lgkmcnt(3)
v_mfma_f32_32x32x16_bf16 v[160:175], a[76:79], v[116:119], v[160:175]
ds_read_b128 a[92:95], v4 offset:31744
v_fma_f32 v33, v33, s40, -v20
v_fma_f32 v34, v34, s40, -v20
v_fma_f32 v35, v35, s40, -v20
v_exp_f32 v32, v32
v_mfma_f32_32x32x16_bf16 v[176:191], a[76:79], v[124:127], v[176:191]
v_exp_f32 v33, v33
v_fma_f32 v36, v36, s40, -v20
v_fma_f32 v37, v37, s40, -v20
v_exp_f32 v34, v34
s_waitcnt lgkmcnt(3)
v_mfma_f32_32x32x16_bf16 v[192:207], a[80:83], v[112:115], v[192:207]
ds_read_b128 a[64:67], v2 offset:16384
v_exp_f32 v35, v35
v_add_f32 v22, v22, v32
v_cvt_pk_bf16_f32 v96, v32, v33
v_add_f32 v22, v22, v33
v_fma_f32 v38, v38, s40, -v20
v_mfma_f32_32x32x16_bf16 v[208:223], a[80:83], v[120:123], v[208:223]
v_fma_f32 v39, v39, s40, -v20
v_exp_f32 v36, v36
v_exp_f32 v37, v37
s_waitcnt lgkmcnt(3)
v_mfma_f32_32x32x16_bf16 v[192:207], a[84:87], v[116:119], v[192:207]
ds_read_b128 a[68:71], v2 offset:17408
v_add_f32 v22, v22, v34
v_cvt_pk_bf16_f32 v97, v34, v35
v_add_f32 v22, v22, v35
v_fma_f32 v40, v40, s40, -v20
v_fma_f32 v41, v41, s40, -v20
v_mfma_f32_32x32x16_bf16 v[208:223], a[84:87], v[124:127], v[208:223]
v_exp_f32 v38, v38
v_exp_f32 v39, v39
v_add_f32 v22, v22, v36
v_cvt_pk_bf16_f32 v98, v36, v37
s_waitcnt lgkmcnt(3)
v_mfma_f32_32x32x16_bf16 v[224:239], a[88:91], v[112:115], v[224:239]
ds_read_b128 a[72:75], v2 offset:18432
v_add_f32 v22, v22, v37
v_fma_f32 v42, v42, s40, -v20
v_fma_f32 v43, v43, s40, -v20
v_exp_f32 v40, v40
v_mfma_f32_32x32x16_bf16 v[240:255], a[88:91], v[120:123], v[240:255]
v_exp_f32 v41, v41
v_add_f32 v22, v22, v38
v_cvt_pk_bf16_f32 v99, v38, v39
v_add_f32 v22, v22, v39
v_fma_f32 v44, v44, s40, -v20
s_waitcnt lgkmcnt(3)
v_mfma_f32_32x32x16_bf16 v[224:239], a[92:95], v[116:119], v[224:239]
ds_read_b128 a[76:79], v2 offset:19456
v_fma_f32 v45, v45, s40, -v20
v_exp_f32 v42, v42
v_exp_f32 v43, v43
v_add_f32 v22, v22, v40
v_mfma_f32_32x32x16_bf16 v[240:255], a[92:95], v[124:127], v[240:255]
s_cmp_eq_u32 s48, 0
s_cbranch_scc0 L_at_rsa
L_at_rsra:
v_cvt_pk_bf16_f32 v100, v40, v41
v_add_f32 v22, v22, v41
v_fma_f32 v46, v46, s40, -v20
v_fma_f32 v47, v47, s40, -v20
v_exp_f32 v44, v44
s_waitcnt lgkmcnt(3)
v_mfma_f32_32x32x16_bf16 v[64:79], a[64:67], a[0:3], 0
ds_read_b128 a[80:83], v2 offset:20480
v_exp_f32 v45, v45
v_add_f32 v22, v22, v42
v_cvt_pk_bf16_f32 v101, v42, v43
v_add_f32 v22, v22, v43
v_mfma_f32_32x32x16_bf16 v[80:95], a[64:67], a[32:35], 0
v_fma_f32 v48, v48, s40, -v21
v_fma_f32 v49, v49, s40, -v21
v_exp_f32 v46, v46
v_exp_f32 v47, v47
s_waitcnt lgkmcnt(3)
v_mfma_f32_32x32x16_bf16 v[64:79], a[68:71], a[4:7], v[64:79]
ds_read_b128 a[84:87], v2 offset:21504
v_add_f32 v22, v22, v44
v_cvt_pk_bf16_f32 v102, v44, v45
v_add_f32 v22, v22, v45
v_fma_f32 v50, v50, s40, -v21
v_fma_f32 v51, v51, s40, -v21
v_mfma_f32_32x32x16_bf16 v[80:95], a[68:71], a[36:39], v[80:95]
v_exp_f32 v48, v48
v_exp_f32 v49, v49
v_add_f32 v22, v22, v46
s_waitcnt lgkmcnt(3)
v_mfma_f32_32x32x16_bf16 v[64:79], a[72:75], a[8:11], v[64:79]
ds_read_b128 a[88:91], v2 offset:22528
v_cvt_pk_bf16_f32 v103, v46, v47
v_add_f32 v22, v22, v47
v_fma_f32 v52, v52, s40, -v21
v_fma_f32 v53, v53, s40, -v21
v_exp_f32 v50, v50
v_mfma_f32_32x32x16_bf16 v[80:95], a[72:75], a[40:43], v[80:95]
v_exp_f32 v51, v51
v_add_f32 v23, v23, v48
v_cvt_pk_bf16_f32 v104, v48, v49
v_add_f32 v23, v23, v49
s_waitcnt lgkmcnt(3)
v_mfma_f32_32x32x16_bf16 v[64:79], a[76:79], a[12:15], v[64:79]
ds_read_b128 a[92:95], v2 offset:23552
v_fma_f32 v54, v54, s40, -v21
v_fma_f32 v55, v55, s40, -v21
v_exp_f32 v52, v52
v_exp_f32 v53, v53
v_mfma_f32_32x32x16_bf16 v[80:95], a[76:79], a[44:47], v[80:95]
v_add_f32 v23, v23, v50
v_cvt_pk_bf16_f32 v105, v50, v51
v_add_f32 v23, v23, v51
v_fma_f32 v56, v56, s40, -v21
v_fma_f32 v57, v57, s40, -v21
s_waitcnt lgkmcnt(3)
v_mfma_f32_32x32x16_bf16 v[64:79], a[80:83], a[16:19], v[64:79]
ds_read_b128 a[64:67], v2 offset:8192
v_exp_f32 v54, v54
v_exp_f32 v55, v55
v_add_f32 v23, v23, v52
v_cvt_pk_bf16_f32 v106, v52, v53
v_mfma_f32_32x32x16_bf16 v[80:95], a[80:83], a[48:51], v[80:95]
v_add_f32 v23, v23, v53
v_fma_f32 v58, v58, s40, -v21
v_fma_f32 v59, v59, s40, -v21
v_exp_f32 v56, v56
s_waitcnt lgkmcnt(3)
v_mfma_f32_32x32x16_bf16 v[64:79], a[84:87], a[20:23], v[64:79]
ds_read_b128 a[68:71], v2 offset:9216
v_exp_f32 v57, v57
v_add_f32 v23, v23, v54
v_cvt_pk_bf16_f32 v107, v54, v55
v_add_f32 v23, v23, v55
v_fma_f32 v60, v60, s40, -v21
v_mfma_f32_32x32x16_bf16 v[80:95], a[84:87], a[52:55], v[80:95]
v_fma_f32 v61, v61, s40, -v21
v_exp_f32 v58, v58
v_exp_f32 v59, v59
s_waitcnt lgkmcnt(3)
v_mfma_f32_32x32x16_bf16 v[64:79], a[88:91], a[24:27], v[64:79]
ds_read_b128 a[72:75], v2 offset:10240
v_add_f32 v23, v23, v56
v_cvt_pk_bf16_f32 v108, v56, v57
v_add_f32 v23, v23, v57
v_fma_f32 v62, v62, s40, -v21
v_fma_f32 v63, v63, s40, -v21
v_mfma_f32_32x32x16_bf16 v[80:95], a[88:91], a[56:59], v[80:95]
v_exp_f32 v60, v60
v_exp_f32 v61, v61
v_add_f32 v23, v23, v58
v_cvt_pk_bf16_f32 v109, v58, v59
s_waitcnt lgkmcnt(3)
v_mfma_f32_32x32x16_bf16 v[64:79], a[92:95], a[28:31], v[64:79]
ds_read_b128 a[76:79], v2 offset:11264
v_add_f32 v23, v23, v59
v_exp_f32 v62, v62
v_exp_f32 v63, v63
v_add_f32 v23, v23, v60
v_mfma_f32_32x32x16_bf16 v[80:95], a[92:95], a[60:63], v[80:95]
v_cvt_pk_bf16_f32 v110, v60, v61
v_add_f32 v23, v23, v61
v_add_f32 v23, v23, v62
v_cvt_pk_bf16_f32 v111, v62, v63
v_add_f32 v23, v23, v63
s_waitcnt vmcnt(8)
s_barrier
s_waitcnt lgkmcnt(3)
v_mfma_f32_32x32x16_bf16 v[128:143], a[64:67], v[96:99], v[128:143]
ds_read_b128 a[80:83], v2 offset:12288
v_mfma_f32_32x32x16_bf16 v[144:159], a[64:67], v[104:107], v[144:159]
s_mov_b32 m0, s47
s_add_u32 s24, s46, 4096
s_waitcnt lgkmcnt(3)
v_mfma_f32_32x32x16_bf16 v[128:143], a[68:71], v[100:103], v[128:143]
ds_read_b128 a[84:87], v2 offset:13312
v_max3_f32 v26, v64, v65, v66
v_max3_f32 v26, v26, v67, v68
v_max3_f32 v26, v26, v69, v70
v_max3_f32 v26, v26, v71, v72
v_max3_f32 v26, v26, v73, v74
v_max3_f32 v26, v26, v75, v76
v_mfma_f32_32x32x16_bf16 v[144:159], a[68:71], v[108:111], v[144:159]
buffer_load_dwordx4 v1, s[8:11], s46 offen offset:0 sc1 lds
v_max3_f32 v26, v26, v77, v78
v_max_f32 v26, v26, v79
v_max3_f32 v27, v80, v81, v82
v_max3_f32 v27, v27, v83, v84
v_max3_f32 v27, v27, v85, v86
s_waitcnt lgkmcnt(3)
v_mfma_f32_32x32x16_bf16 v[160:175], a[72:75], v[96:99], v[160:175]
ds_read_b128 a[88:91], v2 offset:14336
v_max3_f32 v27, v27, v87, v88
v_max3_f32 v27, v27, v89, v90
v_max3_f32 v27, v27, v91, v92
v_max3_f32 v27, v27, v93, v94
v_max_f32 v27, v27, v95
v_fma_f32 v28, v26, s40, -v20
v_mfma_f32_32x32x16_bf16 v[176:191], a[72:75], v[104:107], v[176:191]
buffer_load_dwordx4 v1, s[8:11], s46 offen offset:1024 sc1 lds
v_fma_f32 v29, v27, s40, -v21
v_max_f32 v28, v28, v29
v_cmp_lt_f32 vcc, s51, v28
s_cbranch_vccnz L_at_upb
L_at_uprb:
v_fma_f32 v64, v64, s40, -v20
s_waitcnt lgkmcnt(3)
v_mfma_f32_32x32x16_bf16 v[160:175], a[76:79], v[100:103], v[160:175]
ds_read_b128 a[92:95], v2 offset:15360
v_fma_f32 v65, v65, s40, -v20
v_fma_f32 v66, v66, s40, -v20
v_fma_f32 v67, v67, s40, -v20
v_exp_f32 v64, v64
v_mfma_f32_32x32x16_bf16 v[176:191], a[76:79], v[108:111], v[176:191]
buffer_load_dwordx4 v1, s[8:11], s46 offen offset:2048 sc1 lds
v_exp_f32 v65, v65
v_fma_f32 v68, v68, s40, -v20
v_fma_f32 v69, v69, s40, -v20
v_exp_f32 v66, v66
s_waitcnt lgkmcnt(3)
v_mfma_f32_32x32x16_bf16 v[192:207], a[80:83], v[96:99], v[192:207]
ds_read_b128 a[64:67], v3 offset:0
v_exp_f32 v67, v67
v_add_f32 v22, v22, v64
v_cvt_pk_bf16_f32 v112, v64, v65
v_add_f32 v22, v22, v65
v_fma_f32 v70, v70, s40, -v20
v_mfma_f32_32x32x16_bf16 v[208:223], a[80:83], v[104:107], v[208:223]
buffer_load_dwordx4 v1, s[8:11], s46 offen offset:3072 sc1 lds
s_add_u32 m0, s47, 4096
v_fma_f32 v71, v71, s40, -v20
v_exp_f32 v68, v68
v_exp_f32 v69, v69
s_waitcnt lgkmcnt(3)
v_mfma_f32_32x32x16_bf16 v[192:207], a[84:87], v[100:103], v[192:207]
ds_read_b128 a[68:71], v3 offset:1024
v_add_f32 v22, v22, v66
v_cvt_pk_bf16_f32 v113, v66, v67
v_add_f32 v22, v22, v67
v_fma_f32 v72, v72, s40, -v20
v_fma_f32 v73, v73, s40, -v20
v_mfma_f32_32x32x16_bf16 v[208:223], a[84:87], v[108:111], v[208:223]
buffer_load_dwordx4 v1, s[8:11], s24 offen offset:0 sc1 lds
v_exp_f32 v70, v70
v_exp_f32 v71, v71
v_add_f32 v22, v22, v68
v_cvt_pk_bf16_f32 v114, v68, v69
s_waitcnt lgkmcnt(3)
v_mfma_f32_32x32x16_bf16 v[224:239], a[88:91], v[96:99], v[224:239]
ds_read_b128 a[72:75], v3 offset:2048
v_add_f32 v22, v22, v69
v_fma_f32 v74, v74, s40, -v20
v_fma_f32 v75, v75, s40, -v20
v_exp_f32 v72, v72
v_mfma_f32_32x32x16_bf16 v[240:255], a[88:91], v[104:107], v[240:255]
buffer_load_dwordx4 v1, s[8:11], s24 offen offset:1024 sc1 lds
v_exp_f32 v73, v73
v_add_f32 v22, v22, v70
v_cvt_pk_bf16_f32 v115, v70, v71
v_add_f32 v22, v22, v71
v_fma_f32 v76, v76, s40, -v20
s_waitcnt lgkmcnt(3)
v_mfma_f32_32x32x16_bf16 v[224:239], a[92:95], v[100:103], v[224:239]
ds_read_b128 a[76:79], v3 offset:3072
v_fma_f32 v77, v77, s40, -v20
v_exp_f32 v74, v74
v_exp_f32 v75, v75
v_add_f32 v22, v22, v72
v_mfma_f32_32x32x16_bf16 v[240:255], a[92:95], v[108:111], v[240:255]
s_cmp_eq_u32 s48, 0
s_cbranch_scc0 L_at_rsb
L_at_rsrb:
buffer_load_dwordx4 v1, s[8:11], s24 offen offset:2048 sc1 lds
v_cvt_pk_bf16_f32 v116, v72, v73
v_add_f32 v22, v22, v73
v_fma_f32 v78, v78, s40, -v20
v_fma_f32 v79, v79, s40, -v20
v_exp_f32 v76, v76
s_waitcnt lgkmcnt(3)
v_mfma_f32_32x32x16_bf16 v[32:47], a[64:67], a[0:3], 0
ds_read_b128 a[80:83], v3 offset:4096
v_exp_f32 v77, v77
v_add_f32 v22, v22, v74
v_cvt_pk_bf16_f32 v117, v74, v75
v_add_f32 v22, v22, v75
v_mfma_f32_32x32x16_bf16 v[48:63], a[64:67], a[32:35], 0
buffer_load_dwordx4 v1, s[8:11], s24 offen offset:3072 sc1 lds
s_add_u32 s46, s46, 32768
s_add_u32 s47, s47, 32768
s_and_b32 s47, s47, 131071
v_fma_f32 v80, v80, s40, -v21
v_fma_f32 v81, v81, s40, -v21
v_exp_f32 v78, v78
v_exp_f32 v79, v79
s_waitcnt lgkmcnt(3)
v_mfma_f32_32x32x16_bf16 v[32:47], a[68:71], a[4:7], v[32:47]
ds_read_b128 a[84:87], v3 offset:5120
v_add_f32 v22, v22, v76
v_cvt_pk_bf16_f32 v118, v76, v77
v_add_f32 v22, v22, v77
v_fma_f32 v82, v82, s40, -v21
v_fma_f32 v83, v83, s40, -v21
v_mfma_f32_32x32x16_bf16 v[48:63], a[68:71], a[36:39], v[48:63]
v_exp_f32 v80, v80
v_exp_f32 v81, v81
v_add_f32 v22, v22, v78
s_waitcnt lgkmcnt(3)
v_mfma_f32_32x32x16_bf16 v[32:47], a[72:75], a[8:11], v[32:47]
ds_read_b128 a[88:91], v3 offset:6144
v_cvt_pk_bf16_f32 v119, v78, v79
v_add_f32 v22, v22, v79
v_fma_f32 v84, v84, s40, -v21
v_fma_f32 v85, v85, s40, -v21
v_exp_f32 v82, v82
v_mfma_f32_32x32x16_bf16 v[48:63], a[72:75], a[40:43], v[48:63]
v_exp_f32 v83, v83
v_add_f32 v23, v23, v80
v_cvt_pk_bf16_f32 v120, v80, v81
v_add_f32 v23, v23, v81
s_waitcnt lgkmcnt(3)
v_mfma_f32_32x32x16_bf16 v[32:47], a[76:79], a[12:15], v[32:47]
ds_read_b128 a[92:95], v3 offset:7168
v_fma_f32 v86, v86, s40, -v21
v_fma_f32 v87, v87, s40, -v21
v_exp_f32 v84, v84
v_exp_f32 v85, v85
v_mfma_f32_32x32x16_bf16 v[48:63], a[76:79], a[44:47], v[48:63]
v_add_f32 v23, v23, v82
v_cvt_pk_bf16_f32 v121, v82, v83
v_add_f32 v23, v23, v83
v_fma_f32 v88, v88, s40, -v21
v_fma_f32 v89, v89, s40, -v21
s_waitcnt lgkmcnt(3)
v_mfma_f32_32x32x16_bf16 v[32:47], a[80:83], a[16:19], v[32:47]
ds_read_b128 a[64:67], v2 offset:24576
v_exp_f32 v86, v86
v_exp_f32 v87, v87
v_add_f32 v23, v23, v84
v_cvt_pk_bf16_f32 v122, v84, v85
v_mfma_f32_32x32x16_bf16 v[48:63], a[80:83], a[48:51], v[48:63]
v_add_f32 v23, v23, v85
v_fma_f32 v90, v90, s40, -v21
v_fma_f32 v91, v91, s40, -v21
v_exp_f32 v88, v88
s_waitcnt lgkmcnt(3)
v_mfma_f32_32x32x16_bf16 v[32:47], a[84:87], a[20:23], v[32:47]
ds_read_b128 a[68:71], v2 offset:25600
v_exp_f32 v89, v89
v_add_f32 v23, v23, v86
v_cvt_pk_bf16_f32 v123, v86, v87
v_add_f32 v23, v23, v87
v_fma_f32 v92, v92, s40, -v21
v_mfma_f32_32x32x16_bf16 v[48:63], a[84:87], a[52:55], v[48:63]
v_fma_f32 v93, v93, s40, -v21
v_exp_f32 v90, v90
v_exp_f32 v91, v91
s_waitcnt lgkmcnt(3)
v_mfma_f32_32x32x16_bf16 v[32:47], a[88:91], a[24:27], v[32:47]
ds_read_b128 a[72:75], v2 offset:26624
v_add_f32 v23, v23, v88
v_cvt_pk_bf16_f32 v124, v88, v89
v_add_f32 v23, v23, v89
v_fma_f32 v94, v94, s40, -v21
v_fma_f32 v95, v95, s40, -v21
v_mfma_f32_32x32x16_bf16 v[48:63], a[88:91], a[56:59], v[48:63]
v_exp_f32 v92, v92
v_exp_f32 v93, v93
v_add_f32 v23, v23, v90
v_cvt_pk_bf16_f32 v125, v90, v91
s_waitcnt lgkmcnt(3)
v_mfma_f32_32x32x16_bf16 v[32:47], a[92:95], a[28:31], v[32:47]
ds_read_b128 a[76:79], v2 offset:27648
v_add_f32 v23, v23, v91
v_exp_f32 v94, v94
v_exp_f32 v95, v95
v_add_f32 v23, v23, v92
v_mfma_f32_32x32x16_bf16 v[48:63], a[92:95], a[60:63], v[48:63]
v_cvt_pk_bf16_f32 v126, v92, v93
v_add_f32 v23, v23, v93
v_add_f32 v23, v23, v94
v_cvt_pk_bf16_f32 v127, v94, v95
v_add_f32 v23, v23, v95
v_mov_b32 v4, v2
v_mov_b32 v2, v3
v_add_u32 v3, 32768, v3
v_and_b32 v3, 131071, v3
s_add_u32 s43, s43, 1
s_cmp_lt_u32 s43, s44
s_cbranch_scc1 L_at_loop
L_at_last:
s_waitcnt lgkmcnt(3)
v_mfma_f32_32x32x16_bf16 v[128:143], a[64:67], v[112:115], v[128:143]
ds_read_b128 a[80:83], v4 offset:28672
v_mfma_f32_32x32x16_bf16 v[144:159], a[64:67], v[120:123], v[144:159]
s_add_u32 s24, s43, 3
s_cmp_lt_u32 s24, s45
s_cselect_b32 s46, s46, 536870912
s_waitcnt lgkmcnt(3)
v_mfma_f32_32x32x16_bf16 v[128:143], a[68:71], v[116:119], v[128:143]
ds_read_b128 a[84:87], v4 offset:29696
v_mov_b32 v31, s50
v_cmp_le_i32 vcc, 0, v5
s_nop 1
v_cndmask_b32 v32, v31, v32, vcc
v_cmp_le_i32 vcc, 1, v5
s_nop 1
v_cndmask_b32 v33, v31, v33, vcc
v_mfma_f32_32x32x16_bf16 v[144:159], a[68:71], v[124:127], v[144:159]
v_cmp_le_i32 vcc, 2, v5
s_nop 1
v_cndmask_b32 v34, v31, v34, vcc
v_cmp_le_i32 vcc, 3, v5
s_nop 1
v_cndmask_b32 v35, v31, v35, vcc
s_waitcnt lgkmcnt(3)
v_mfma_f32_32x32x16_bf16 v[160:175], a[72:75], v[112:115], v[160:175]
ds_read_b128 a[88:91], v4 offset:30720
v_cmp_le_i32 vcc, 8, v5
s_nop 1
v_cndmask_b32 v36, v31, v36, vcc
v_cmp_le_i32 vcc, 9, v5
s_nop 1
v_cndmask_b32 v37, v31, v37, vcc
v_cmp_le_i32 vcc, 10, v5
v_mfma_f32_32x32x16_bf16 v[176:191], a[72:75], v[120:123], v[176:191]
s_nop 0
v_cndmask_b32 v38, v31, v38, vcc
v_cmp_le_i32 vcc, 11, v5
s_nop 1
v_cndmask_b32 v39, v31, v39, vcc
v_cmp_le_i32 vcc, 16, v5
s_waitcnt lgkmcnt(3)
v_mfma_f32_32x32x16_bf16 v[160:175], a[76:79], v[116:119], v[160:175]
ds_read_b128 a[92:95], v4 offset:31744
v_cndmask_b32 v40, v31, v40, vcc
v_cmp_le_i32 vcc, 17, v5
s_nop 1
v_cndmask_b32 v41, v31, v41, vcc
v_cmp_le_i32 vcc, 18, v5
s_nop 1
v_cndmask_b32 v42, v31, v42, vcc
v_mfma_f32_32x32x16_bf16 v[176:191], a[76:79], v[124:127], v[176:191]
v_cmp_le_i32 vcc, 19, v5
s_nop 1
v_cndmask_b32 v43, v31, v43, vcc
v_cmp_le_i32 vcc, 24, v5
s_nop 1
v_cndmask_b32 v44, v31, v44, vcc
s_waitcnt lgkmcnt(3)
v_mfma_f32_32x32x16_bf16 v[192:207], a[80:83], v[112:115], v[192:207]
ds_read_b128 a[64:67], v2 offset:16384
v_cmp_le_i32 vcc, 25, v5
s_nop 1
v_cndmask_b32 v45, v31, v45, vcc
v_cmp_le_i32 vcc, 26, v5
s_nop 1
v_cndmask_b32 v46, v31, v46, vcc
v_cmp_le_i32 vcc, 27, v5
v_mfma_f32_32x32x16_bf16 v[208:223], a[80:83], v[120:123], v[208:223]
s_nop 0
v_cndmask_b32 v47, v31, v47, vcc
v_max3_f32 v26, v32, v33, v34
v_max3_f32 v26, v26, v35, v36
v_max3_f32 v26, v26, v37, v38
s_waitcnt lgkmcnt(3)
v_mfma_f32_32x32x16_bf16 v[192:207], a[84:87], v[116:119], v[192:207]
ds_read_b128 a[68:71], v2 offset:17408
v_max3_f32 v26, v26, v39, v40
v_max3_f32 v26, v26, v41, v42
v_max3_f32 v26, v26, v43, v44
v_max3_f32 v26, v26, v45, v46
v_max_f32 v26, v26, v47
v_mfma_f32_32x32x16_bf16 v[208:223], a[84:87], v[124:127], v[208:223]
v_max3_f32 v27, v48, v49, v50
v_max3_f32 v27, v27, v51, v52
v_max3_f32 v27, v27, v53, v54
v_max3_f32 v27, v27, v55, v56
s_waitcnt lgkmcnt(3)
v_mfma_f32_32x32x16_bf16 v[224:239], a[88:91], v[112:115], v[224:239]
ds_read_b128 a[72:75], v2 offset:18432
v_max3_f32 v27, v27, v57, v58
v_max3_f32 v27, v27, v59, v60
v_max3_f32 v27, v27, v61, v62
v_max_f32 v27, v27, v63
v_fma_f32 v28, v26, s40, -v20
v_mfma_f32_32x32x16_bf16 v[240:255], a[88:91], v[120:123], v[240:255]
v_fma_f32 v29, v27, s40, -v21
v_max_f32 v28, v28, v29
v_cmp_lt_f32 vcc, s51, v28
s_cbranch_vccnz L_at_upc
L_at_uprc:
s_waitcnt lgkmcnt(3)
v_mfma_f32_32x32x16_bf16 v[224:239], a[92:95], v[116:119], v[224:239]
ds_read_b128 a[76:79], v2 offset:19456
v_fma_f32 v32, v32, s40, -v20
v_fma_f32 v33, v33, s40, -v20
v_fma_f32 v34, v34, s40, -v20
v_fma_f32 v35, v35, s40, -v20
v_exp_f32 v32, v32
v_exp_f32 v33, v33
v_mfma_f32_32x32x16_bf16 v[240:255], a[92:95], v[124:127], v[240:255]
s_cmp_eq_u32 s48, 0
s_cbranch_scc0 L_at_rsc
L_at_rsrc:
v_fma_f32 v36, v36, s40, -v20
v_fma_f32 v37, v37, s40, -v20
v_exp_f32 v34, v34
v_exp_f32 v35, v35
v_add_f32 v22, v22, v32
v_cvt_pk_bf16_f32 v96, v32, v33
s_waitcnt lgkmcnt(3)
v_mfma_f32_32x32x16_bf16 v[64:79], a[64:67], a[0:3], 0
ds_read_b128 a[80:83], v2 offset:20480
v_add_f32 v22, v22, v33
v_fma_f32 v38, v38, s40, -v20
v_fma_f32 v39, v39, s40, -v20
v_exp_f32 v36, v36
v_exp_f32 v37, v37
v_add_f32 v22, v22, v34
v_mfma_f32_32x32x16_bf16 v[80:95], a[64:67], a[32:35], 0
v_cvt_pk_bf16_f32 v97, v34, v35
v_add_f32 v22, v22, v35
v_fma_f32 v40, v40, s40, -v20
v_fma_f32 v41, v41, s40, -v20
v_exp_f32 v38, v38
v_exp_f32 v39, v39
s_waitcnt lgkmcnt(3)
v_mfma_f32_32x32x16_bf16 v[64:79], a[68:71], a[4:7], v[64:79]
ds_read_b128 a[84:87], v2 offset:21504
v_add_f32 v22, v22, v36
v_cvt_pk_bf16_f32 v98, v36, v37
v_add_f32 v22, v22, v37
v_fma_f32 v42, v42, s40, -v20
v_fma_f32 v43, v43, s40, -v20
v_exp_f32 v40, v40
v_exp_f32 v41, v41
v_mfma_f32_32x32x16_bf16 v[80:95], a[68:71], a[36:39], v[80:95]
v_add_f32 v22, v22, v38
v_cvt_pk_bf16_f32 v99, v38, v39
v_add_f32 v22, v22, v39
v_fma_f32 v44, v44, s40, -v20
v_fma_f32 v45, v45, s40, -v20
v_exp_f32 v42, v42
s_waitcnt lgkmcnt(3)
v_mfma_f32_32x32x16_bf16 v[64:79], a[72:75], a[8:11], v[64:79]
ds_read_b128 a[88:91], v2 offset:22528
v_exp_f32 v43, v43
v_add_f32 v22, v22, v40
v_cvt_pk_bf16_f32 v100, v40, v41
v_add_f32 v22, v22, v41
v_fma_f32 v46, v46, s40, -v20
v_fma_f32 v47, v47, s40, -v20
v_exp_f32 v44, v44
v_mfma_f32_32x32x16_bf16 v[80:95], a[72:75], a[40:43], v[80:95]
v_exp_f32 v45, v45
v_add_f32 v22, v22, v42
v_cvt_pk_bf16_f32 v101, v42, v43
v_add_f32 v22, v22, v43
v_fma_f32 v48, v48, s40, -v21
v_fma_f32 v49, v49, s40, -v21
s_waitcnt lgkmcnt(3)
v_mfma_f32_32x32x16_bf16 v[64:79], a[76:79], a[12:15], v[64:79]
ds_read_b128 a[92:95], v2 offset:23552
v_exp_f32 v46, v46
v_exp_f32 v47, v47
v_add_f32 v22, v22, v44
v_cvt_pk_bf16_f32 v102, v44, v45
v_add_f32 v22, v22, v45
v_fma_f32 v50, v50, s40, -v21
v_mfma_f32_32x32x16_bf16 v[80:95], a[76:79], a[44:47], v[80:95]
v_fma_f32 v51, v51, s40, -v21
v_exp_f32 v48, v48
v_exp_f32 v49, v49
v_add_f32 v22, v22, v46
v_cvt_pk_bf16_f32 v103, v46, v47
v_add_f32 v22, v22, v47
s_waitcnt lgkmcnt(3)
v_mfma_f32_32x32x16_bf16 v[64:79], a[80:83], a[16:19], v[64:79]
ds_read_b128 a[64:67], v2 offset:8192
v_fma_f32 v52, v52, s40, -v21
v_fma_f32 v53, v53, s40, -v21
v_exp_f32 v50, v50
v_exp_f32 v51, v51
v_add_f32 v23, v23, v48
v_cvt_pk_bf16_f32 v104, v48, v49
v_mfma_f32_32x32x16_bf16 v[80:95], a[80:83], a[48:51], v[80:95]
v_add_f32 v23, v23, v49
v_fma_f32 v54, v54, s40, -v21
v_fma_f32 v55, v55, s40, -v21
v_exp_f32 v52, v52
v_exp_f32 v53, v53
v_add_f32 v23, v23, v50
s_waitcnt lgkmcnt(3)
v_mfma_f32_32x32x16_bf16 v[64:79], a[84:87], a[20:23], v[64:79]
ds_read_b128 a[68:71], v2 offset:9216
v_cvt_pk_bf16_f32 v105, v50, v51
v_add_f32 v23, v23, v51
v_fma_f32 v56, v56, s40, -v21
v_fma_f32 v57, v57, s40, -v21
v_exp_f32 v54, v54
v_exp_f32 v55, v55
v_mfma_f32_32x32x16_bf16 v[80:95], a[84:87], a[52:55], v[80:95]
v_add_f32 v23, v23, v52
v_cvt_pk_bf16_f32 v106, v52, v53
v_add_f32 v23, v23, v53
v_fma_f32 v58, v58, s40, -v21
v_fma_f32 v59, v59, s40, -v21
v_exp_f32 v56, v56
v_exp_f32 v57, v57
s_waitcnt lgkmcnt(3)
v_mfma_f32_32x32x16_bf16 v[64:79], a[88:91], a[24:27], v[64:79]
ds_read_b128 a[72:75], v2 offset:10240
v_add_f32 v23, v23, v54
v_cvt_pk_bf16_f32 v107, v54, v55
v_add_f32 v23, v23, v55
v_fma_f32 v60, v60, s40, -v21
v_fma_f32 v61, v61, s40, -v21
v_exp_f32 v58, v58
v_mfma_f32_32x32x16_bf16 v[80:95], a[88:91], a[56:59], v[80:95]
v_exp_f32 v59, v59
v_add_f32 v23, v23, v56
v_cvt_pk_bf16_f32 v108, v56, v57
v_add_f32 v23, v23, v57
v_fma_f32 v62, v62, s40, -v21
v_fma_f32 v63, v63, s40, -v21
v_exp_f32 v60, v60
s_waitcnt lgkmcnt(3)
v_mfma_f32_32x32x16_bf16 v[64:79], a[92:95], a[28:31], v[64:79]
ds_read_b128 a[76:79], v2 offset:11264
v_exp_f32 v61, v61
v_add_f32 v23, v23, v58
v_cvt_pk_bf16_f32 v109, v58, v59
v_add_f32 v23, v23, v59
v_exp_f32 v62, v62
v_mfma_f32_32x32x16_bf16 v[80:95], a[92:95], a[60:63], v[80:95]
v_exp_f32 v63, v63
v_add_f32 v23, v23, v60
v_cvt_pk_bf16_f32 v110, v60, v61
v_add_f32 v23, v23, v61
v_add_f32 v23, v23, v62
v_cvt_pk_bf16_f32 v111, v62, v63
v_add_f32 v23, v23, v63
s_waitcnt vmcnt(8)
s_barrier
s_waitcnt lgkmcnt(3)
v_mfma_f32_32x32x16_bf16 v[128:143], a[64:67], v[96:99], v[128:143]
ds_read_b128 a[80:83], v2 offset:12288
v_mfma_f32_32x32x16_bf16 v[144:159], a[64:67], v[104:107], v[144:159]
s_mov_b32 m0, s47
s_add_u32 s24, s46, 4096
s_nop 0
buffer_load_dwordx4 v1, s[8:11], s46 offen offset:0 sc1 lds
s_waitcnt lgkmcnt(3)
v_mfma_f32_32x32x16_bf16 v[128:143], a[68:71], v[100:103], v[128:143]
ds_read_b128 a[84:87], v2 offset:13312
v_mov_b32 v31, s50
v_cmp_le_i32 vcc, 0, v5
s_nop 1
v_cndmask_b32 v80, v31, v80, vcc
v_cmp_le_i32 vcc, 1, v5
s_nop 1
v_cndmask_b32 v81, v31, v81, vcc
v_cmp_le_i32 vcc, 2, v5
v_mfma_f32_32x32x16_bf16 v[144:159], a[68:71], v[108:111], v[144:159]
buffer_load_dwordx4 v1, s[8:11], s46 offen offset:1024 sc1 lds
v_cndmask_b32 v82, v31, v82, vcc
v_cmp_le_i32 vcc, 3, v5
s_nop 1
v_cndmask_b32 v83, v31, v83, vcc
v_cmp_le_i32 vcc, 8, v5
s_nop 1
v_cndmask_b32 v84, v31, v84, vcc
v_cmp_le_i32 vcc, 9, v5
s_waitcnt lgkmcnt(3)
v_mfma_f32_32x32x16_bf16 v[160:175], a[72:75], v[96:99], v[160:175]
ds_read_b128 a[88:91], v2 offset:14336
v_cndmask_b32 v85, v31, v85, vcc
v_cmp_le_i32 vcc, 10, v5
s_nop 1
v_cndmask_b32 v86, v31, v86, vcc
v_cmp_le_i32 vcc, 11, v5
s_nop 1
v_cndmask_b32 v87, v31, v87, vcc
v_cmp_le_i32 vcc, 16, v5
v_mfma_f32_32x32x16_bf16 v[176:191], a[72:75], v[104:107], v[176:191]
buffer_load_dwordx4 v1, s[8:11], s46 offen offset:2048 sc1 lds
v_cndmask_b32 v88, v31, v88, vcc
v_cmp_le_i32 vcc, 17, v5
s_nop 1
v_cndmask_b32 v89, v31, v89, vcc
v_cmp_le_i32 vcc, 18, v5
s_nop 1
v_cndmask_b32 v90, v31, v90, vcc
s_waitcnt lgkmcnt(3)
v_mfma_f32_32x32x16_bf16 v[160:175], a[76:79], v[100:103], v[160:175]
ds_read_b128 a[92:95], v2 offset:15360
v_cmp_le_i32 vcc, 19, v5
s_nop 1
v_cndmask_b32 v91, v31, v91, vcc
v_cmp_le_i32 vcc, 24, v5
s_nop 1
v_cndmask_b32 v92, v31, v92, vcc
v_cmp_le_i32 vcc, 25, v5
s_nop 1
v_cndmask_b32 v93, v31, v93, vcc
v_mfma_f32_32x32x16_bf16 v[176:191], a[76:79], v[108:111], v[176:191]
buffer_load_dwordx4 v1, s[8:11], s46 offen offset:3072 sc1 lds
s_add_u32 m0, s47, 4096
v_cmp_le_i32 vcc, 26, v5
s_nop 1
v_cndmask_b32 v94, v31, v94, vcc
v_cmp_le_i32 vcc, 27, v5
s_nop 1
v_cndmask_b32 v95, v31, v95, vcc
v_mov_b32 v64, v31
v_mov_b32 v65, v31
s_waitcnt lgkmcnt(3)
v_mfma_f32_32x32x16_bf16 v[192:207], a[80:83], v[96:99], v[192:207]
ds_read_b128 a[64:67], v2 offset:24576
v_mov_b32 v66, v31
v_mov_b32 v67, v31
v_mov_b32 v68, v31
v_mov_b32 v69, v31
v_mov_b32 v70, v31
v_mov_b32 v71, v31
v_mfma_f32_32x32x16_bf16 v[208:223], a[80:83], v[104:107], v[208:223]
buffer_load_dwordx4 v1, s[8:11], s24 offen offset:0 sc1 lds
v_mov_b32 v72, v31
v_mov_b32 v73, v31
v_mov_b32 v74, v31
v_mov_b32 v75, v31
v_mov_b32 v76, v31
v_mov_b32 v77, v31
s_waitcnt lgkmcnt(3)
v_mfma_f32_32x32x16_bf16 v[192:207], a[84:87], v[100:103], v[192:207]
ds_read_b128 a[68:71], v2 offset:25600
v_mov_b32 v78, v31
v_mov_b32 v79, v31
v_max3_f32 v26, v64, v65, v66
v_max3_f32 v26, v26, v67, v68
v_max3_f32 v26, v26, v69, v70
v_max3_f32 v26, v26, v71, v72
v_mfma_f32_32x32x16_bf16 v[208:223], a[84:87], v[108:111], v[208:223]
buffer_load_dwordx4 v1, s[8:11], s24 offen offset:1024 sc1 lds
v_max3_f32 v26, v26, v73, v74
v_max3_f32 v26, v26, v75, v76
v_max3_f32 v26, v26, v77, v78
v_max_f32 v26, v26, v79
v_max3_f32 v27, v80, v81, v82
s_waitcnt lgkmcnt(3)
v_mfma_f32_32x32x16_bf16 v[224:239], a[88:91], v[96:99], v[224:239]
ds_read_b128 a[72:75], v2 offset:26624
v_max3_f32 v27, v27, v83, v84
v_max3_f32 v27, v27, v85, v86
v_max3_f32 v27, v27, v87, v88
v_max3_f32 v27, v27, v89, v90
v_max3_f32 v27, v27, v91, v92
v_max3_f32 v27, v27, v93, v94
v_mfma_f32_32x32x16_bf16 v[240:255], a[88:91], v[104:107], v[240:255]
buffer_load_dwordx4 v1, s[8:11], s24 offen offset:2048 sc1 lds
v_max_f32 v27, v27, v95
v_fma_f32 v28, v26, s40, -v20
v_fma_f32 v29, v27, s40, -v21
v_max_f32 v28, v28, v29
v_cmp_lt_f32 vcc, s51, v28
s_cbranch_vccnz L_at_upd
L_at_uprd:
s_waitcnt lgkmcnt(3)
v_mfma_f32_32x32x16_bf16 v[224:239], a[92:95], v[100:103], v[224:239]
ds_read_b128 a[76:79], v2 offset:27648
v_fma_f32 v64, v64, s40, -v20
v_fma_f32 v65, v65, s40, -v20
v_fma_f32 v66, v66, s40, -v20
v_fma_f32 v67, v67, s40, -v20
v_exp_f32 v64, v64
v_exp_f32 v65, v65
v_fma_f32 v68, v68, s40, -v20
v_fma_f32 v69, v69, s40, -v20
v_exp_f32 v66, v66
v_exp_f32 v67, v67
v_add_f32 v22, v22, v64
v_cvt_pk_bf16_f32 v112, v64, v65
v_add_f32 v22, v22, v65
v_fma_f32 v70, v70, s40, -v20
v_fma_f32 v71, v71, s40, -v20
v_exp_f32 v68, v68
v_exp_f32 v69, v69
v_add_f32 v22, v22, v66
v_cvt_pk_bf16_f32 v113, v66, v67
v_add_f32 v22, v22, v67
v_fma_f32 v72, v72, s40, -v20
v_fma_f32 v73, v73, s40, -v20
v_exp_f32 v70, v70
v_exp_f32 v71, v71
v_add_f32 v22, v22, v68
v_cvt_pk_bf16_f32 v114, v68, v69
v_add_f32 v22, v22, v69
v_fma_f32 v74, v74, s40, -v20
v_fma_f32 v75, v75, s40, -v20
v_exp_f32 v72, v72
v_exp_f32 v73, v73
v_add_f32 v22, v22, v70
v_cvt_pk_bf16_f32 v115, v70, v71
v_add_f32 v22, v22, v71
v_fma_f32 v76, v76, s40, -v20
v_fma_f32 v77, v77, s40, -v20
v_exp_f32 v74, v74
v_exp_f32 v75, v75
v_add_f32 v22, v22, v72
v_cvt_pk_bf16_f32 v116, v72, v73
v_add_f32 v22, v22, v73
v_fma_f32 v78, v78, s40, -v20
v_fma_f32 v79, v79, s40, -v20
v_exp_f32 v76, v76
v_exp_f32 v77, v77
v_add_f32 v22, v22, v74
v_cvt_pk_bf16_f32 v117, v74, v75
v_add_f32 v22, v22, v75
v_fma_f32 v80, v80, s40, -v21
v_fma_f32 v81, v81, s40, -v21
v_exp_f32 v78, v78
v_exp_f32 v79, v79
v_add_f32 v22, v22, v76
v_cvt_pk_bf16_f32 v118, v76, v77
v_add_f32 v22, v22, v77
v_fma_f32 v82, v82, s40, -v21
v_mfma_f32_32x32x16_bf16 v[240:255], a[92:95], v[108:111], v[240:255]
s_cmp_eq_u32 s48, 0
s_cbranch_scc0 L_at_rsd
L_at_rsrd:
buffer_load_dwordx4 v1, s[8:11], s24 offen offset:3072 sc1 lds
s_add_u32 s46, s46, 32768
s_add_u32 s47, s47, 32768
s_and_b32 s47, s47, 131071
v_fma_f32 v83, v83, s40, -v21
v_exp_f32 v80, v80
v_exp_f32 v81, v81
v_add_f32 v22, v22, v78
v_cvt_pk_bf16_f32 v119, v78, v79
v_add_f32 v22, v22, v79
v_fma_f32 v84, v84, s40, -v21
v_fma_f32 v85, v85, s40, -v21
v_exp_f32 v82, v82
v_exp_f32 v83, v83
v_add_f32 v23, v23, v80
v_cvt_pk_bf16_f32 v120, v80, v81
v_add_f32 v23, v23, v81
v_fma_f32 v86, v86, s40, -v21
v_fma_f32 v87, v87, s40, -v21
v_exp_f32 v84, v84
v_exp_f32 v85, v85
v_add_f32 v23, v23, v82
v_cvt_pk_bf16_f32 v121, v82, v83
v_add_f32 v23, v23, v83
v_fma_f32 v88, v88, s40, -v21
v_fma_f32 v89, v89, s40, -v21
v_exp_f32 v86, v86
v_exp_f32 v87, v87
v_add_f32 v23, v23, v84
v_cvt_pk_bf16_f32 v122, v84, v85
v_add_f32 v23, v23, v85
v_fma_f32 v90, v90, s40, -v21
v_fma_f32 v91, v91, s40, -v21
v_exp_f32 v88, v88
v_exp_f32 v89, v89
v_add_f32 v23, v23, v86
v_cvt_pk_bf16_f32 v123, v86, v87
v_add_f32 v23, v23, v87
v_fma_f32 v92, v92, s40, -v21
v_fma_f32 v93, v93, s40, -v21
v_exp_f32 v90, v90
v_exp_f32 v91, v91
v_add_f32 v23, v23, v88
v_cvt_pk_bf16_f32 v124, v88, v89
v_add_f32 v23, v23, v89
v_fma_f32 v94, v94, s40, -v21
v_fma_f32 v95, v95, s40, -v21
v_exp_f32 v92, v92
v_exp_f32 v93, v93
v_add_f32 v23, v23, v90
v_cvt_pk_bf16_f32 v125, v90, v91
v_add_f32 v23, v23, v91
v_exp_f32 v94, v94
v_exp_f32 v95, v95
v_add_f32 v23, v23, v92
v_cvt_pk_bf16_f32 v126, v92, v93
v_add_f32 v23, v23, v93
v_add_f32 v23, v23, v94
v_cvt_pk_bf16_f32 v127, v94, v95
v_add_f32 v23, v23, v95
s_waitcnt lgkmcnt(3)
v_mfma_f32_32x32x16_bf16 v[128:143], a[64:67], v[112:115], v[128:143]
ds_read_b128 a[80:83], v2 offset:28672
v_mfma_f32_32x32x16_bf16 v[144:159], a[64:67], v[120:123], v[144:159]
s_waitcnt lgkmcnt(3)
v_mfma_f32_32x32x16_bf16 v[128:143], a[68:71], v[116:119], v[128:143]
ds_read_b128 a[84:87], v2 offset:29696
v_mfma_f32_32x32x16_bf16 v[144:159], a[68:71], v[124:127], v[144:159]
s_waitcnt lgkmcnt(3)
v_mfma_f32_32x32x16_bf16 v[160:175], a[72:75], v[112:115], v[160:175]
ds_read_b128 a[88:91], v2 offset:30720
v_mfma_f32_32x32x16_bf16 v[176:191], a[72:75], v[120:123], v[176:191]
s_waitcnt lgkmcnt(3)
v_mfma_f32_32x32x16_bf16 v[160:175], a[76:79], v[116:119], v[160:175]
ds_read_b128 a[92:95], v2 offset:31744
v_mfma_f32_32x32x16_bf16 v[176:191], a[76:79], v[124:127], v[176:191]
s_waitcnt lgkmcnt(3)
v_mfma_f32_32x32x16_bf16 v[192:207], a[80:83], v[112:115], v[192:207]
v_mfma_f32_32x32x16_bf16 v[208:223], a[80:83], v[120:123], v[208:223]
s_waitcnt lgkmcnt(2)
v_mfma_f32_32x32x16_bf16 v[192:207], a[84:87], v[116:119], v[192:207]
v_mfma_f32_32x32x16_bf16 v[208:223], a[84:87], v[124:127], v[208:223]
s_waitcnt lgkmcnt(1)
v_mfma_f32_32x32x16_bf16 v[224:239], a[88:91], v[112:115], v[224:239]
v_mfma_f32_32x32x16_bf16 v[240:255], a[88:91], v[120:123], v[240:255]
s_waitcnt lgkmcnt(0)
v_mfma_f32_32x32x16_bf16 v[224:239], a[92:95], v[116:119], v[224:239]
v_mfma_f32_32x32x16_bf16 v[240:255], a[92:95], v[124:127], v[240:255]
L_at_idle:
s_add_u32 s43, s43, 1
s_cmp_ge_u32 s43, s45
s_cbranch_scc1 L_at_fin
s_waitcnt vmcnt(0)
s_barrier
s_branch L_at_idle
L_at_upa:
v_mov_b32 v28, v26
s_nop 1
v_permlane32_swap_b32 v28, v26
v_max_f32 v26, v26, v28
v_mul_f32 v26, s40, v26
v_max_f32 v26, v26, v20
v_sub_f32 v28, v20, v26
v_exp_f32 v24, v28
v_mov_b32 v20, v26
v_mul_f32 v22, v22, v24
v_mov_b32 v29, v27
s_nop 1
v_permlane32_swap_b32 v29, v27
v_max_f32 v27, v27, v29
v_mul_f32 v27, s40, v27
v_max_f32 v27, v27, v21
v_sub_f32 v29, v21, v27
v_exp_f32 v25, v29
v_mov_b32 v21, v27
v_mul_f32 v23, v23, v25
s_mov_b32 s48, 1
s_branch L_at_upra
L_at_rsa:
s_nop 7
s_nop 3
v_pk_mul_f32 v[128:129], v[128:129], v[24:25] op_sel:[0,0] op_sel_hi:[1,0]
v_pk_mul_f32 v[130:131], v[130:131], v[24:25] op_sel:[0,0] op_sel_hi:[1,0]
v_pk_mul_f32 v[132:133], v[132:133], v[24:25] op_sel:[0,0] op_sel_hi:[1,0]
v_pk_mul_f32 v[134:135], v[134:135], v[24:25] op_sel:[0,0] op_sel_hi:[1,0]
v_pk_mul_f32 v[136:137], v[136:137], v[24:25] op_sel:[0,0] op_sel_hi:[1,0]
v_pk_mul_f32 v[138:139], v[138:139], v[24:25] op_sel:[0,0] op_sel_hi:[1,0]
v_pk_mul_f32 v[140:141], v[140:141], v[24:25] op_sel:[0,0] op_sel_hi:[1,0]
v_pk_mul_f32 v[142:143], v[142:143], v[24:25] op_sel:[0,0] op_sel_hi:[1,0]
v_pk_mul_f32 v[144:145], v[144:145], v[24:25] op_sel:[0,1] op_sel_hi:[1,1]
v_pk_mul_f32 v[146:147], v[146:147], v[24:25] op_sel:[0,1] op_sel_hi:[1,1]
v_pk_mul_f32 v[148:149], v[148:149], v[24:25] op_sel:[0,1] op_sel_hi:[1,1]
v_pk_mul_f32 v[150:151], v[150:151], v[24:25] op_sel:[0,1] op_sel_hi:[1,1]
v_pk_mul_f32 v[152:153], v[152:153], v[24:25] op_sel:[0,1] op_sel_hi:[1,1]
v_pk_mul_f32 v[154:155], v[154:155], v[24:25] op_sel:[0,1] op_sel_hi:[1,1]
v_pk_mul_f32 v[156:157], v[156:157], v[24:25] op_sel:[0,1] op_sel_hi:[1,1]
v_pk_mul_f32 v[158:159], v[158:159], v[24:25] op_sel:[0,1] op_sel_hi:[1,1]
v_pk_mul_f32 v[160:161], v[160:161], v[24:25] op_sel:[0,0] op_sel_hi:[1,0]
v_pk_mul_f32 v[162:163], v[162:163], v[24:25] op_sel:[0,0] op_sel_hi:[1,0]
v_pk_mul_f32 v[164:165], v[164:165], v[24:25] op_sel:[0,0] op_sel_hi:[1,0]
v_pk_mul_f32 v[166:167], v[166:167], v[24:25] op_sel:[0,0] op_sel_hi:[1,0]
v_pk_mul_f32 v[168:169], v[168:169], v[24:25] op_sel:[0,0] op_sel_hi:[1,0]
v_pk_mul_f32 v[170:171], v[170:171], v[24:25] op_sel:[0,0] op_sel_hi:[1,0]
v_pk_mul_f32 v[172:173], v[172:173], v[24:25] op_sel:[0,0] op_sel_hi:[1,0]
v_pk_mul_f32 v[174:175], v[174:175], v[24:25] op_sel:[0,0] op_sel_hi:[1,0]
v_pk_mul_f32 v[176:177], v[176:177], v[24:25] op_sel:[0,1] op_sel_hi:[1,1]
v_pk_mul_f32 v[178:179], v[178:179], v[24:25] op_sel:[0,1] op_sel_hi:[1,1]
v_pk_mul_f32 v[180:181], v[180:181], v[24:25] op_sel:[0,1] op_sel_hi:[1,1]
v_pk_mul_f32 v[182:183], v[182:183], v[24:25] op_sel:[0,1] op_sel_hi:[1,1]
v_pk_mul_f32 v[184:185], v[184:185], v[24:25] op_sel:[0,1] op_sel_hi:[1,1]
v_pk_mul_f32 v[186:187], v[186:187], v[24:25] op_sel:[0,1] op_sel_hi:[1,1]
v_pk_mul_f32 v[188:189], v[188:189], v[24:25] op_sel:[0,1] op_sel_hi:[1,1]
v_pk_mul_f32 v[190:191], v[190:191], v[24:25] op_sel:[0,1] op_sel_hi:[1,1]
v_pk_mul_f32 v[192:193], v[192:193], v[24:25] op_sel:[0,0] op_sel_hi:[1,0]
v_pk_mul_f32 v[194:195], v[194:195], v[24:25] op_sel:[0,0] op_sel_hi:[1,0]
v_pk_mul_f32 v[196:197], v[196:197], v[24:25] op_sel:[0,0] op_sel_hi:[1,0]
v_pk_mul_f32 v[198:199], v[198:199], v[24:25] op_sel:[0,0] op_sel_hi:[1,0]
v_pk_mul_f32 v[200:201], v[200:201], v[24:25] op_sel:[0,0] op_sel_hi:[1,0]
v_pk_mul_f32 v[202:203], v[202:203], v[24:25] op_sel:[0,0] op_sel_hi:[1,0]
v_pk_mul_f32 v[204:205], v[204:205], v[24:25] op_sel:[0,0] op_sel_hi:[1,0]
v_pk_mul_f32 v[206:207], v[206:207], v[24:25] op_sel:[0,0] op_sel_hi:[1,0]
v_pk_mul_f32 v[208:209], v[208:209], v[24:25] op_sel:[0,1] op_sel_hi:[1,1]
v_pk_mul_f32 v[210:211], v[210:211], v[24:25] op_sel:[0,1] op_sel_hi:[1,1]
v_pk_mul_f32 v[212:213], v[212:213], v[24:25] op_sel:[0,1] op_sel_hi:[1,1]
v_pk_mul_f32 v[214:215], v[214:215], v[24:25] op_sel:[0,1] op_sel_hi:[1,1]
v_pk_mul_f32 v[216:217], v[216:217], v[24:25] op_sel:[0,1] op_sel_hi:[1,1]
v_pk_mul_f32 v[218:219], v[218:219], v[24:25] op_sel:[0,1] op_sel_hi:[1,1]
v_pk_mul_f32 v[220:221], v[220:221], v[24:25] op_sel:[0,1] op_sel_hi:[1,1]
v_pk_mul_f32 v[222:223], v[222:223], v[24:25] op_sel:[0,1] op_sel_hi:[1,1]
v_pk_mul_f32 v[224:225], v[224:225], v[24:25] op_sel:[0,0] op_sel_hi:[1,0]
v_pk_mul_f32 v[226:227], v[226:227], v[24:25] op_sel:[0,0] op_sel_hi:[1,0]
v_pk_mul_f32 v[228:229], v[228:229], v[24:25] op_sel:[0,0] op_sel_hi:[1,0]
v_pk_mul_f32 v[230:231], v[230:231], v[24:25] op_sel:[0,0] op_sel_hi:[1,0]
v_pk_mul_f32 v[232:233], v[232:233], v[24:25] op_sel:[0,0] op_sel_hi:[1,0]
v_pk_mul_f32 v[234:235], v[234:235], v[24:25] op_sel:[0,0] op_sel_hi:[1,0]
v_pk_mul_f32 v[236:237], v[236:237], v[24:25] op_sel:[0,0] op_sel_hi:[1,0]
v_pk_mul_f32 v[238:239], v[238:239], v[24:25] op_sel:[0,0] op_sel_hi:[1,0]
v_pk_mul_f32 v[240:241], v[240:241], v[24:25] op_sel:[0,1] op_sel_hi:[1,1]
v_pk_mul_f32 v[242:243], v[242:243], v[24:25] op_sel:[0,1] op_sel_hi:[1,1]
v_pk_mul_f32 v[244:245], v[244:245], v[24:25] op_sel:[0,1] op_sel_hi:[1,1]
v_pk_mul_f32 v[246:247], v[246:247], v[24:25] op_sel:[0,1] op_sel_hi:[1,1]
v_pk_mul_f32 v[248:249], v[248:249], v[24:25] op_sel:[0,1] op_sel_hi:[1,1]
v_pk_mul_f32 v[250:251], v[250:251], v[24:25] op_sel:[0,1] op_sel_hi:[1,1]
v_pk_mul_f32 v[252:253], v[252:253], v[24:25] op_sel:[0,1] op_sel_hi:[1,1]
v_pk_mul_f32 v[254:255], v[254:255], v[24:25] op_sel:[0,1] op_sel_hi:[1,1]
s_mov_b32 s48, 0
s_nop 1
s_branch L_at_rsra
L_at_upb:
v_mov_b32 v28, v26
s_nop 1
v_permlane32_swap_b32 v28, v26
v_max_f32 v26, v26, v28
v_mul_f32 v26, s40, v26
v_max_f32 v26, v26, v20
v_sub_f32 v28, v20, v26
v_exp_f32 v24, v28
v_mov_b32 v20, v26
v_mul_f32 v22, v22, v24
v_mov_b32 v29, v27
s_nop 1
v_permlane32_swap_b32 v29, v27
v_max_f32 v27, v27, v29
v_mul_f32 v27, s40, v27
v_max_f32 v27, v27, v21
v_sub_f32 v29, v21, v27
v_exp_f32 v25, v29
v_mov_b32 v21, v27
v_mul_f32 v23, v23, v25
s_mov_b32 s48, 1
s_branch L_at_uprb
L_at_rsb:
s_nop 7
s_nop 3
v_pk_mul_f32 v[128:129], v[128:129], v[24:25] op_sel:[0,0] op_sel_hi:[1,0]
v_pk_mul_f32 v[130:131], v[130:131], v[24:25] op_sel:[0,0] op_sel_hi:[1,0]
v_pk_mul_f32 v[132:133], v[132:133], v[24:25] op_sel:[0,0] op_sel_hi:[1,0]
v_pk_mul_f32 v[134:135], v[134:135], v[24:25] op_sel:[0,0] op_sel_hi:[1,0]
v_pk_mul_f32 v[136:137], v[136:137], v[24:25] op_sel:[0,0] op_sel_hi:[1,0]
v_pk_mul_f32 v[138:139], v[138:139], v[24:25] op_sel:[0,0] op_sel_hi:[1,0]
v_pk_mul_f32 v[140:141], v[140:141], v[24:25] op_sel:[0,0] op_sel_hi:[1,0]
v_pk_mul_f32 v[142:143], v[142:143], v[24:25] op_sel:[0,0] op_sel_hi:[1,0]
v_pk_mul_f32 v[144:145], v[144:145], v[24:25] op_sel:[0,1] op_sel_hi:[1,1]
v_pk_mul_f32 v[146:147], v[146:147], v[24:25] op_sel:[0,1] op_sel_hi:[1,1]
v_pk_mul_f32 v[148:149], v[148:149], v[24:25] op_sel:[0,1] op_sel_hi:[1,1]
v_pk_mul_f32 v[150:151], v[150:151], v[24:25] op_sel:[0,1] op_sel_hi:[1,1]
v_pk_mul_f32 v[152:153], v[152:153], v[24:25] op_sel:[0,1] op_sel_hi:[1,1]
v_pk_mul_f32 v[154:155], v[154:155], v[24:25] op_sel:[0,1] op_sel_hi:[1,1]
v_pk_mul_f32 v[156:157], v[156:157], v[24:25] op_sel:[0,1] op_sel_hi:[1,1]
v_pk_mul_f32 v[158:159], v[158:159], v[24:25] op_sel:[0,1] op_sel_hi:[1,1]
v_pk_mul_f32 v[160:161], v[160:161], v[24:25] op_sel:[0,0] op_sel_hi:[1,0]
v_pk_mul_f32 v[162:163], v[162:163], v[24:25] op_sel:[0,0] op_sel_hi:[1,0]
v_pk_mul_f32 v[164:165], v[164:165], v[24:25] op_sel:[0,0] op_sel_hi:[1,0]
v_pk_mul_f32 v[166:167], v[166:167], v[24:25] op_sel:[0,0] op_sel_hi:[1,0]
v_pk_mul_f32 v[168:169], v[168:169], v[24:25] op_sel:[0,0] op_sel_hi:[1,0]
v_pk_mul_f32 v[170:171], v[170:171], v[24:25] op_sel:[0,0] op_sel_hi:[1,0]
v_pk_mul_f32 v[172:173], v[172:173], v[24:25] op_sel:[0,0] op_sel_hi:[1,0]
v_pk_mul_f32 v[174:175], v[174:175], v[24:25] op_sel:[0,0] op_sel_hi:[1,0]
v_pk_mul_f32 v[176:177], v[176:177], v[24:25] op_sel:[0,1] op_sel_hi:[1,1]
v_pk_mul_f32 v[178:179], v[178:179], v[24:25] op_sel:[0,1] op_sel_hi:[1,1]
v_pk_mul_f32 v[180:181], v[180:181], v[24:25] op_sel:[0,1] op_sel_hi:[1,1]
v_pk_mul_f32 v[182:183], v[182:183], v[24:25] op_sel:[0,1] op_sel_hi:[1,1]
v_pk_mul_f32 v[184:185], v[184:185], v[24:25] op_sel:[0,1] op_sel_hi:[1,1]
v_pk_mul_f32 v[186:187], v[186:187], v[24:25] op_sel:[0,1] op_sel_hi:[1,1]
v_pk_mul_f32 v[188:189], v[188:189], v[24:25] op_sel:[0,1] op_sel_hi:[1,1]
v_pk_mul_f32 v[190:191], v[190:191], v[24:25] op_sel:[0,1] op_sel_hi:[1,1]
v_pk_mul_f32 v[192:193], v[192:193], v[24:25] op_sel:[0,0] op_sel_hi:[1,0]
v_pk_mul_f32 v[194:195], v[194:195], v[24:25] op_sel:[0,0] op_sel_hi:[1,0]
v_pk_mul_f32 v[196:197], v[196:197], v[24:25] op_sel:[0,0] op_sel_hi:[1,0]
v_pk_mul_f32 v[198:199], v[198:199], v[24:25] op_sel:[0,0] op_sel_hi:[1,0]
v_pk_mul_f32 v[200:201], v[200:201], v[24:25] op_sel:[0,0] op_sel_hi:[1,0]
v_pk_mul_f32 v[202:203], v[202:203], v[24:25] op_sel:[0,0] op_sel_hi:[1,0]
v_pk_mul_f32 v[204:205], v[204:205], v[24:25] op_sel:[0,0] op_sel_hi:[1,0]
v_pk_mul_f32 v[206:207], v[206:207], v[24:25] op_sel:[0,0] op_sel_hi:[1,0]
v_pk_mul_f32 v[208:209], v[208:209], v[24:25] op_sel:[0,1] op_sel_hi:[1,1]
v_pk_mul_f32 v[210:211], v[210:211], v[24:25] op_sel:[0,1] op_sel_hi:[1,1]
v_pk_mul_f32 v[212:213], v[212:213], v[24:25] op_sel:[0,1] op_sel_hi:[1,1]
v_pk_mul_f32 v[214:215], v[214:215], v[24:25] op_sel:[0,1] op_sel_hi:[1,1]
v_pk_mul_f32 v[216:217], v[216:217], v[24:25] op_sel:[0,1] op_sel_hi:[1,1]
v_pk_mul_f32 v[218:219], v[218:219], v[24:25] op_sel:[0,1] op_sel_hi:[1,1]
v_pk_mul_f32 v[220:221], v[220:221], v[24:25] op_sel:[0,1] op_sel_hi:[1,1]
v_pk_mul_f32 v[222:223], v[222:223], v[24:25] op_sel:[0,1] op_sel_hi:[1,1]
v_pk_mul_f32 v[224:225], v[224:225], v[24:25] op_sel:[0,0] op_sel_hi:[1,0]
v_pk_mul_f32 v[226:227], v[226:227], v[24:25] op_sel:[0,0] op_sel_hi:[1,0]
v_pk_mul_f32 v[228:229], v[228:229], v[24:25] op_sel:[0,0] op_sel_hi:[1,0]
v_pk_mul_f32 v[230:231], v[230:231], v[24:25] op_sel:[0,0] op_sel_hi:[1,0]
v_pk_mul_f32 v[232:233], v[232:233], v[24:25] op_sel:[0,0] op_sel_hi:[1,0]
v_pk_mul_f32 v[234:235], v[234:235], v[24:25] op_sel:[0,0] op_sel_hi:[1,0]
v_pk_mul_f32 v[236:237], v[236:237], v[24:25] op_sel:[0,0] op_sel_hi:[1,0]
v_pk_mul_f32 v[238:239], v[238:239], v[24:25] op_sel:[0,0] op_sel_hi:[1,0]
v_pk_mul_f32 v[240:241], v[240:241], v[24:25] op_sel:[0,1] op_sel_hi:[1,1]
v_pk_mul_f32 v[242:243], v[242:243], v[24:25] op_sel:[0,1] op_sel_hi:[1,1]
v_pk_mul_f32 v[244:245], v[244:245], v[24:25] op_sel:[0,1] op_sel_hi:[1,1]
v_pk_mul_f32 v[246:247], v[246:247], v[24:25] op_sel:[0,1] op_sel_hi:[1,1]
v_pk_mul_f32 v[248:249], v[248:249], v[24:25] op_sel:[0,1] op_sel_hi:[1,1]
v_pk_mul_f32 v[250:251], v[250:251], v[24:25] op_sel:[0,1] op_sel_hi:[1,1]
v_pk_mul_f32 v[252:253], v[252:253], v[24:25] op_sel:[0,1] op_sel_hi:[1,1]
v_pk_mul_f32 v[254:255], v[254:255], v[24:25] op_sel:[0,1] op_sel_hi:[1,1]
s_mov_b32 s48, 0
s_nop 1
s_branch L_at_rsrb
L_at_upc:
v_mov_b32 v28, v26
s_nop 1
v_permlane32_swap_b32 v28, v26
v_max_f32 v26, v26, v28
v_mul_f32 v26, s40, v26
v_max_f32 v26, v26, v20
v_sub_f32 v28, v20, v26
v_exp_f32 v24, v28
v_mov_b32 v20, v26
v_mul_f32 v22, v22, v24
v_mov_b32 v29, v27
s_nop 1
v_permlane32_swap_b32 v29, v27
v_max_f32 v27, v27, v29
v_mul_f32 v27, s40, v27
v_max_f32 v27, v27, v21
v_sub_f32 v29, v21, v27
v_exp_f32 v25, v29
v_mov_b32 v21, v27
v_mul_f32 v23, v23, v25
s_mov_b32 s48, 1
s_branch L_at_uprc
L_at_rsc:
s_nop 7
s_nop 3
v_pk_mul_f32 v[128:129], v[128:129], v[24:25] op_sel:[0,0] op_sel_hi:[1,0]
v_pk_mul_f32 v[130:131], v[130:131], v[24:25] op_sel:[0,0] op_sel_hi:[1,0]
v_pk_mul_f32 v[132:133], v[132:133], v[24:25] op_sel:[0,0] op_sel_hi:[1,0]
v_pk_mul_f32 v[134:135], v[134:135], v[24:25] op_sel:[0,0] op_sel_hi:[1,0]
v_pk_mul_f32 v[136:137], v[136:137], v[24:25] op_sel:[0,0] op_sel_hi:[1,0]
v_pk_mul_f32 v[138:139], v[138:139], v[24:25] op_sel:[0,0] op_sel_hi:[1,0]
v_pk_mul_f32 v[140:141], v[140:141], v[24:25] op_sel:[0,0] op_sel_hi:[1,0]
v_pk_mul_f32 v[142:143], v[142:143], v[24:25] op_sel:[0,0] op_sel_hi:[1,0]
v_pk_mul_f32 v[144:145], v[144:145], v[24:25] op_sel:[0,1] op_sel_hi:[1,1]
v_pk_mul_f32 v[146:147], v[146:147], v[24:25] op_sel:[0,1] op_sel_hi:[1,1]
v_pk_mul_f32 v[148:149], v[148:149], v[24:25] op_sel:[0,1] op_sel_hi:[1,1]
v_pk_mul_f32 v[150:151], v[150:151], v[24:25] op_sel:[0,1] op_sel_hi:[1,1]
v_pk_mul_f32 v[152:153], v[152:153], v[24:25] op_sel:[0,1] op_sel_hi:[1,1]
v_pk_mul_f32 v[154:155], v[154:155], v[24:25] op_sel:[0,1] op_sel_hi:[1,1]
v_pk_mul_f32 v[156:157], v[156:157], v[24:25] op_sel:[0,1] op_sel_hi:[1,1]
v_pk_mul_f32 v[158:159], v[158:159], v[24:25] op_sel:[0,1] op_sel_hi:[1,1]
v_pk_mul_f32 v[160:161], v[160:161], v[24:25] op_sel:[0,0] op_sel_hi:[1,0]
v_pk_mul_f32 v[162:163], v[162:163], v[24:25] op_sel:[0,0] op_sel_hi:[1,0]
v_pk_mul_f32 v[164:165], v[164:165], v[24:25] op_sel:[0,0] op_sel_hi:[1,0]
v_pk_mul_f32 v[166:167], v[166:167], v[24:25] op_sel:[0,0] op_sel_hi:[1,0]
v_pk_mul_f32 v[168:169], v[168:169], v[24:25] op_sel:[0,0] op_sel_hi:[1,0]
v_pk_mul_f32 v[170:171], v[170:171], v[24:25] op_sel:[0,0] op_sel_hi:[1,0]
v_pk_mul_f32 v[172:173], v[172:173], v[24:25] op_sel:[0,0] op_sel_hi:[1,0]
v_pk_mul_f32 v[174:175], v[174:175], v[24:25] op_sel:[0,0] op_sel_hi:[1,0]
v_pk_mul_f32 v[176:177], v[176:177], v[24:25] op_sel:[0,1] op_sel_hi:[1,1]
v_pk_mul_f32 v[178:179], v[178:179], v[24:25] op_sel:[0,1] op_sel_hi:[1,1]
v_pk_mul_f32 v[180:181], v[180:181], v[24:25] op_sel:[0,1] op_sel_hi:[1,1]
v_pk_mul_f32 v[182:183], v[182:183], v[24:25] op_sel:[0,1] op_sel_hi:[1,1]
v_pk_mul_f32 v[184:185], v[184:185], v[24:25] op_sel:[0,1] op_sel_hi:[1,1]
v_pk_mul_f32 v[186:187], v[186:187], v[24:25] op_sel:[0,1] op_sel_hi:[1,1]
v_pk_mul_f32 v[188:189], v[188:189], v[24:25] op_sel:[0,1] op_sel_hi:[1,1]
v_pk_mul_f32 v[190:191], v[190:191], v[24:25] op_sel:[0,1] op_sel_hi:[1,1]
v_pk_mul_f32 v[192:193], v[192:193], v[24:25] op_sel:[0,0] op_sel_hi:[1,0]
v_pk_mul_f32 v[194:195], v[194:195], v[24:25] op_sel:[0,0] op_sel_hi:[1,0]
v_pk_mul_f32 v[196:197], v[196:197], v[24:25] op_sel:[0,0] op_sel_hi:[1,0]
v_pk_mul_f32 v[198:199], v[198:199], v[24:25] op_sel:[0,0] op_sel_hi:[1,0]
v_pk_mul_f32 v[200:201], v[200:201], v[24:25] op_sel:[0,0] op_sel_hi:[1,0]
v_pk_mul_f32 v[202:203], v[202:203], v[24:25] op_sel:[0,0] op_sel_hi:[1,0]
v_pk_mul_f32 v[204:205], v[204:205], v[24:25] op_sel:[0,0] op_sel_hi:[1,0]
v_pk_mul_f32 v[206:207], v[206:207], v[24:25] op_sel:[0,0] op_sel_hi:[1,0]
v_pk_mul_f32 v[208:209], v[208:209], v[24:25] op_sel:[0,1] op_sel_hi:[1,1]
v_pk_mul_f32 v[210:211], v[210:211], v[24:25] op_sel:[0,1] op_sel_hi:[1,1]
v_pk_mul_f32 v[212:213], v[212:213], v[24:25] op_sel:[0,1] op_sel_hi:[1,1]
v_pk_mul_f32 v[214:215], v[214:215], v[24:25] op_sel:[0,1] op_sel_hi:[1,1]
v_pk_mul_f32 v[216:217], v[216:217], v[24:25] op_sel:[0,1] op_sel_hi:[1,1]
v_pk_mul_f32 v[218:219], v[218:219], v[24:25] op_sel:[0,1] op_sel_hi:[1,1]
v_pk_mul_f32 v[220:221], v[220:221], v[24:25] op_sel:[0,1] op_sel_hi:[1,1]
v_pk_mul_f32 v[222:223], v[222:223], v[24:25] op_sel:[0,1] op_sel_hi:[1,1]
v_pk_mul_f32 v[224:225], v[224:225], v[24:25] op_sel:[0,0] op_sel_hi:[1,0]
v_pk_mul_f32 v[226:227], v[226:227], v[24:25] op_sel:[0,0] op_sel_hi:[1,0]
v_pk_mul_f32 v[228:229], v[228:229], v[24:25] op_sel:[0,0] op_sel_hi:[1,0]
v_pk_mul_f32 v[230:231], v[230:231], v[24:25] op_sel:[0,0] op_sel_hi:[1,0]
v_pk_mul_f32 v[232:233], v[232:233], v[24:25] op_sel:[0,0] op_sel_hi:[1,0]
v_pk_mul_f32 v[234:235], v[234:235], v[24:25] op_sel:[0,0] op_sel_hi:[1,0]
v_pk_mul_f32 v[236:237], v[236:237], v[24:25] op_sel:[0,0] op_sel_hi:[1,0]
v_pk_mul_f32 v[238:239], v[238:239], v[24:25] op_sel:[0,0] op_sel_hi:[1,0]
v_pk_mul_f32 v[240:241], v[240:241], v[24:25] op_sel:[0,1] op_sel_hi:[1,1]
v_pk_mul_f32 v[242:243], v[242:243], v[24:25] op_sel:[0,1] op_sel_hi:[1,1]
v_pk_mul_f32 v[244:245], v[244:245], v[24:25] op_sel:[0,1] op_sel_hi:[1,1]
v_pk_mul_f32 v[246:247], v[246:247], v[24:25] op_sel:[0,1] op_sel_hi:[1,1]
v_pk_mul_f32 v[248:249], v[248:249], v[24:25] op_sel:[0,1] op_sel_hi:[1,1]
v_pk_mul_f32 v[250:251], v[250:251], v[24:25] op_sel:[0,1] op_sel_hi:[1,1]
v_pk_mul_f32 v[252:253], v[252:253], v[24:25] op_sel:[0,1] op_sel_hi:[1,1]
v_pk_mul_f32 v[254:255], v[254:255], v[24:25] op_sel:[0,1] op_sel_hi:[1,1]
s_mov_b32 s48, 0
s_nop 1
s_branch L_at_rsrc
L_at_upd:
v_mov_b32 v28, v26
s_nop 1
v_permlane32_swap_b32 v28, v26
v_max_f32 v26, v26, v28
v_mul_f32 v26, s40, v26
v_max_f32 v26, v26, v20
v_sub_f32 v28, v20, v26
v_exp_f32 v24, v28
v_mov_b32 v20, v26
v_mul_f32 v22, v22, v24
v_mov_b32 v29, v27
s_nop 1
v_permlane32_swap_b32 v29, v27
v_max_f32 v27, v27, v29
v_mul_f32 v27, s40, v27
v_max_f32 v27, v27, v21
v_sub_f32 v29, v21, v27
v_exp_f32 v25, v29
v_mov_b32 v21, v27
v_mul_f32 v23, v23, v25
s_mov_b32 s48, 1
s_branch L_at_uprd
L_at_rsd:
s_nop 7
s_nop 3
v_pk_mul_f32 v[128:129], v[128:129], v[24:25] op_sel:[0,0] op_sel_hi:[1,0]
v_pk_mul_f32 v[130:131], v[130:131], v[24:25] op_sel:[0,0] op_sel_hi:[1,0]
v_pk_mul_f32 v[132:133], v[132:133], v[24:25] op_sel:[0,0] op_sel_hi:[1,0]
v_pk_mul_f32 v[134:135], v[134:135], v[24:25] op_sel:[0,0] op_sel_hi:[1,0]
v_pk_mul_f32 v[136:137], v[136:137], v[24:25] op_sel:[0,0] op_sel_hi:[1,0]
v_pk_mul_f32 v[138:139], v[138:139], v[24:25] op_sel:[0,0] op_sel_hi:[1,0]
v_pk_mul_f32 v[140:141], v[140:141], v[24:25] op_sel:[0,0] op_sel_hi:[1,0]
v_pk_mul_f32 v[142:143], v[142:143], v[24:25] op_sel:[0,0] op_sel_hi:[1,0]
v_pk_mul_f32 v[144:145], v[144:145], v[24:25] op_sel:[0,1] op_sel_hi:[1,1]
v_pk_mul_f32 v[146:147], v[146:147], v[24:25] op_sel:[0,1] op_sel_hi:[1,1]
v_pk_mul_f32 v[148:149], v[148:149], v[24:25] op_sel:[0,1] op_sel_hi:[1,1]
v_pk_mul_f32 v[150:151], v[150:151], v[24:25] op_sel:[0,1] op_sel_hi:[1,1]
v_pk_mul_f32 v[152:153], v[152:153], v[24:25] op_sel:[0,1] op_sel_hi:[1,1]
v_pk_mul_f32 v[154:155], v[154:155], v[24:25] op_sel:[0,1] op_sel_hi:[1,1]
v_pk_mul_f32 v[156:157], v[156:157], v[24:25] op_sel:[0,1] op_sel_hi:[1,1]
v_pk_mul_f32 v[158:159], v[158:159], v[24:25] op_sel:[0,1] op_sel_hi:[1,1]
v_pk_mul_f32 v[160:161], v[160:161], v[24:25] op_sel:[0,0] op_sel_hi:[1,0]
v_pk_mul_f32 v[162:163], v[162:163], v[24:25] op_sel:[0,0] op_sel_hi:[1,0]
v_pk_mul_f32 v[164:165], v[164:165], v[24:25] op_sel:[0,0] op_sel_hi:[1,0]
v_pk_mul_f32 v[166:167], v[166:167], v[24:25] op_sel:[0,0] op_sel_hi:[1,0]
v_pk_mul_f32 v[168:169], v[168:169], v[24:25] op_sel:[0,0] op_sel_hi:[1,0]
v_pk_mul_f32 v[170:171], v[170:171], v[24:25] op_sel:[0,0] op_sel_hi:[1,0]
v_pk_mul_f32 v[172:173], v[172:173], v[24:25] op_sel:[0,0] op_sel_hi:[1,0]
v_pk_mul_f32 v[174:175], v[174:175], v[24:25] op_sel:[0,0] op_sel_hi:[1,0]
v_pk_mul_f32 v[176:177], v[176:177], v[24:25] op_sel:[0,1] op_sel_hi:[1,1]
v_pk_mul_f32 v[178:179], v[178:179], v[24:25] op_sel:[0,1] op_sel_hi:[1,1]
v_pk_mul_f32 v[180:181], v[180:181], v[24:25] op_sel:[0,1] op_sel_hi:[1,1]
v_pk_mul_f32 v[182:183], v[182:183], v[24:25] op_sel:[0,1] op_sel_hi:[1,1]
v_pk_mul_f32 v[184:185], v[184:185], v[24:25] op_sel:[0,1] op_sel_hi:[1,1]
v_pk_mul_f32 v[186:187], v[186:187], v[24:25] op_sel:[0,1] op_sel_hi:[1,1]
v_pk_mul_f32 v[188:189], v[188:189], v[24:25] op_sel:[0,1] op_sel_hi:[1,1]
v_pk_mul_f32 v[190:191], v[190:191], v[24:25] op_sel:[0,1] op_sel_hi:[1,1]
v_pk_mul_f32 v[192:193], v[192:193], v[24:25] op_sel:[0,0] op_sel_hi:[1,0]
v_pk_mul_f32 v[194:195], v[194:195], v[24:25] op_sel:[0,0] op_sel_hi:[1,0]
v_pk_mul_f32 v[196:197], v[196:197], v[24:25] op_sel:[0,0] op_sel_hi:[1,0]
v_pk_mul_f32 v[198:199], v[198:199], v[24:25] op_sel:[0,0] op_sel_hi:[1,0]
v_pk_mul_f32 v[200:201], v[200:201], v[24:25] op_sel:[0,0] op_sel_hi:[1,0]
v_pk_mul_f32 v[202:203], v[202:203], v[24:25] op_sel:[0,0] op_sel_hi:[1,0]
v_pk_mul_f32 v[204:205], v[204:205], v[24:25] op_sel:[0,0] op_sel_hi:[1,0]
v_pk_mul_f32 v[206:207], v[206:207], v[24:25] op_sel:[0,0] op_sel_hi:[1,0]
v_pk_mul_f32 v[208:209], v[208:209], v[24:25] op_sel:[0,1] op_sel_hi:[1,1]
v_pk_mul_f32 v[210:211], v[210:211], v[24:25] op_sel:[0,1] op_sel_hi:[1,1]
v_pk_mul_f32 v[212:213], v[212:213], v[24:25] op_sel:[0,1] op_sel_hi:[1,1]
v_pk_mul_f32 v[214:215], v[214:215], v[24:25] op_sel:[0,1] op_sel_hi:[1,1]
v_pk_mul_f32 v[216:217], v[216:217], v[24:25] op_sel:[0,1] op_sel_hi:[1,1]
v_pk_mul_f32 v[218:219], v[218:219], v[24:25] op_sel:[0,1] op_sel_hi:[1,1]
v_pk_mul_f32 v[220:221], v[220:221], v[24:25] op_sel:[0,1] op_sel_hi:[1,1]
v_pk_mul_f32 v[222:223], v[222:223], v[24:25] op_sel:[0,1] op_sel_hi:[1,1]
v_pk_mul_f32 v[224:225], v[224:225], v[24:25] op_sel:[0,0] op_sel_hi:[1,0]
v_pk_mul_f32 v[226:227], v[226:227], v[24:25] op_sel:[0,0] op_sel_hi:[1,0]
v_pk_mul_f32 v[228:229], v[228:229], v[24:25] op_sel:[0,0] op_sel_hi:[1,0]
v_pk_mul_f32 v[230:231], v[230:231], v[24:25] op_sel:[0,0] op_sel_hi:[1,0]
v_pk_mul_f32 v[232:233], v[232:233], v[24:25] op_sel:[0,0] op_sel_hi:[1,0]
v_pk_mul_f32 v[234:235], v[234:235], v[24:25] op_sel:[0,0] op_sel_hi:[1,0]
v_pk_mul_f32 v[236:237], v[236:237], v[24:25] op_sel:[0,0] op_sel_hi:[1,0]
v_pk_mul_f32 v[238:239], v[238:239], v[24:25] op_sel:[0,0] op_sel_hi:[1,0]
v_pk_mul_f32 v[240:241], v[240:241], v[24:25] op_sel:[0,1] op_sel_hi:[1,1]
v_pk_mul_f32 v[242:243], v[242:243], v[24:25] op_sel:[0,1] op_sel_hi:[1,1]
v_pk_mul_f32 v[244:245], v[244:245], v[24:25] op_sel:[0,1] op_sel_hi:[1,1]
v_pk_mul_f32 v[246:247], v[246:247], v[24:25] op_sel:[0,1] op_sel_hi:[1,1]
v_pk_mul_f32 v[248:249], v[248:249], v[24:25] op_sel:[0,1] op_sel_hi:[1,1]
v_pk_mul_f32 v[250:251], v[250:251], v[24:25] op_sel:[0,1] op_sel_hi:[1,1]
v_pk_mul_f32 v[252:253], v[252:253], v[24:25] op_sel:[0,1] op_sel_hi:[1,1]
v_pk_mul_f32 v[254:255], v[254:255], v[24:25] op_sel:[0,1] op_sel_hi:[1,1]
s_mov_b32 s48, 0
s_nop 1
s_branch L_at_rsrd
L_at_fin:
s_lshl_b32 s26, s41, 4
s_lshl_b32 s27, s17, 2
s_add_u32 s26, s26, s27
s_lshl_b32 s26, s26, 17
s_lshl_b32 s27, s42, 12
s_add_u32 s26, s26, s27
s_add_u32 s26, s26, 67108864
s_add_u32 s27, s26, 262144
v_mov_b32 v26, v22
s_nop 1
v_permlane32_swap_b32 v26, v22
v_add_f32 v26, v26, v22
v_rcp_f32 v26, v26
s_nop 0
v_pk_mul_f32 v[128:129], v[128:129], v[26:27] op_sel_hi:[1,0]
v_pk_mul_f32 v[130:131], v[130:131], v[26:27] op_sel_hi:[1,0]
v_pk_mul_f32 v[132:133], v[132:133], v[26:27] op_sel_hi:[1,0]
v_pk_mul_f32 v[134:135], v[134:135], v[26:27] op_sel_hi:[1,0]
v_pk_mul_f32 v[136:137], v[136:137], v[26:27] op_sel_hi:[1,0]
v_pk_mul_f32 v[138:139], v[138:139], v[26:27] op_sel_hi:[1,0]
v_pk_mul_f32 v[140:141], v[140:141], v[26:27] op_sel_hi:[1,0]
v_pk_mul_f32 v[142:143], v[142:143], v[26:27] op_sel_hi:[1,0]
v_cvt_pk_bf16_f32 v128, v128, v129
v_cvt_pk_bf16_f32 v129, v130, v131
v_cvt_pk_bf16_f32 v130, v132, v133
v_cvt_pk_bf16_f32 v131, v134, v135
buffer_store_dwordx4 v[128:131], v6, s[8:11], s26 offen offset:0 sc1
v_cvt_pk_bf16_f32 v136, v136, v137
v_cvt_pk_bf16_f32 v137, v138, v139
v_cvt_pk_bf16_f32 v138, v140, v141
v_cvt_pk_bf16_f32 v139, v142, v143
buffer_store_dwordx4 v[136:139], v6, s[8:11], s26 offen offset:512 sc1
v_pk_mul_f32 v[160:161], v[160:161], v[26:27] op_sel_hi:[1,0]
v_pk_mul_f32 v[162:163], v[162:163], v[26:27] op_sel_hi:[1,0]
v_pk_mul_f32 v[164:165], v[164:165], v[26:27] op_sel_hi:[1,0]
v_pk_mul_f32 v[166:167], v[166:167], v[26:27] op_sel_hi:[1,0]
v_pk_mul_f32 v[168:169], v[168:169], v[26:27] op_sel_hi:[1,0]
v_pk_mul_f32 v[170:171], v[170:171], v[26:27] op_sel_hi:[1,0]
v_pk_mul_f32 v[172:173], v[172:173], v[26:27] op_sel_hi:[1,0]
v_pk_mul_f32 v[174:175], v[174:175], v[26:27] op_sel_hi:[1,0]
v_cvt_pk_bf16_f32 v160, v160, v161
v_cvt_pk_bf16_f32 v161, v162, v163
v_cvt_pk_bf16_f32 v162, v164, v165
v_cvt_pk_bf16_f32 v163, v166, v167
buffer_store_dwordx4 v[160:163], v6, s[8:11], s26 offen offset:1024 sc1
v_cvt_pk_bf16_f32 v168, v168, v169
v_cvt_pk_bf16_f32 v169, v170, v171
v_cvt_pk_bf16_f32 v170, v172, v173
v_cvt_pk_bf16_f32 v171, v174, v175
buffer_store_dwordx4 v[168:171], v6, s[8:11], s26 offen offset:1536 sc1
v_pk_mul_f32 v[192:193], v[192:193], v[26:27] op_sel_hi:[1,0]
v_pk_mul_f32 v[194:195], v[194:195], v[26:27] op_sel_hi:[1,0]
v_pk_mul_f32 v[196:197], v[196:197], v[26:27] op_sel_hi:[1,0]
v_pk_mul_f32 v[198:199], v[198:199], v[26:27] op_sel_hi:[1,0]
v_pk_mul_f32 v[200:201], v[200:201], v[26:27] op_sel_hi:[1,0]
v_pk_mul_f32 v[202:203], v[202:203], v[26:27] op_sel_hi:[1,0]
v_pk_mul_f32 v[204:205], v[204:205], v[26:27] op_sel_hi:[1,0]
v_pk_mul_f32 v[206:207], v[206:207], v[26:27] op_sel_hi:[1,0]
v_cvt_pk_bf16_f32 v192, v192, v193
v_cvt_pk_bf16_f32 v193, v194, v195
v_cvt_pk_bf16_f32 v194, v196, v197
v_cvt_pk_bf16_f32 v195, v198, v199
buffer_store_dwordx4 v[192:195], v6, s[8:11], s26 offen offset:2048 sc1
v_cvt_pk_bf16_f32 v200, v200, v201
v_cvt_pk_bf16_f32 v201, v202, v203
v_cvt_pk_bf16_f32 v202, v204, v205
v_cvt_pk_bf16_f32 v203, v206, v207
buffer_store_dwordx4 v[200:203], v6, s[8:11], s26 offen offset:2560 sc1
v_pk_mul_f32 v[224:225], v[224:225], v[26:27] op_sel_hi:[1,0]
v_pk_mul_f32 v[226:227], v[226:227], v[26:27] op_sel_hi:[1,0]
v_pk_mul_f32 v[228:229], v[228:229], v[26:27] op_sel_hi:[1,0]
v_pk_mul_f32 v[230:231], v[230:231], v[26:27] op_sel_hi:[1,0]
v_pk_mul_f32 v[232:233], v[232:233], v[26:27] op_sel_hi:[1,0]
v_pk_mul_f32 v[234:235], v[234:235], v[26:27] op_sel_hi:[1,0]
v_pk_mul_f32 v[236:237], v[236:237], v[26:27] op_sel_hi:[1,0]
v_pk_mul_f32 v[238:239], v[238:239], v[26:27] op_sel_hi:[1,0]
v_cvt_pk_bf16_f32 v224, v224, v225
v_cvt_pk_bf16_f32 v225, v226, v227
v_cvt_pk_bf16_f32 v226, v228, v229
v_cvt_pk_bf16_f32 v227, v230, v231
buffer_store_dwordx4 v[224:227], v6, s[8:11], s26 offen offset:3072 sc1
v_cvt_pk_bf16_f32 v232, v232, v233
v_cvt_pk_bf16_f32 v233, v234, v235
v_cvt_pk_bf16_f32 v234, v236, v237
v_cvt_pk_bf16_f32 v235, v238, v239
buffer_store_dwordx4 v[232:235], v6, s[8:11], s26 offen offset:3584 sc1
v_mov_b32 v26, v23
s_nop 1
v_permlane32_swap_b32 v26, v23
v_add_f32 v26, v26, v23
v_rcp_f32 v26, v26
s_nop 0
v_pk_mul_f32 v[144:145], v[144:145], v[26:27] op_sel_hi:[1,0]
v_pk_mul_f32 v[146:147], v[146:147], v[26:27] op_sel_hi:[1,0]
v_pk_mul_f32 v[148:149], v[148:149], v[26:27] op_sel_hi:[1,0]
v_pk_mul_f32 v[150:151], v[150:151], v[26:27] op_sel_hi:[1,0]
v_pk_mul_f32 v[152:153], v[152:153], v[26:27] op_sel_hi:[1,0]
v_pk_mul_f32 v[154:155], v[154:155], v[26:27] op_sel_hi:[1,0]
v_pk_mul_f32 v[156:157], v[156:157], v[26:27] op_sel_hi:[1,0]
v_pk_mul_f32 v[158:159], v[158:159], v[26:27] op_sel_hi:[1,0]
v_cvt_pk_bf16_f32 v144, v144, v145
v_cvt_pk_bf16_f32 v145, v146, v147
v_cvt_pk_bf16_f32 v146, v148, v149
v_cvt_pk_bf16_f32 v147, v150, v151
buffer_store_dwordx4 v[144:147], v6, s[8:11], s27 offen offset:0 sc1
v_cvt_pk_bf16_f32 v152, v152, v153
v_cvt_pk_bf16_f32 v153, v154, v155
v_cvt_pk_bf16_f32 v154, v156, v157
v_cvt_pk_bf16_f32 v155, v158, v159
buffer_store_dwordx4 v[152:155], v6, s[8:11], s27 offen offset:512 sc1
v_pk_mul_f32 v[176:177], v[176:177], v[26:27] op_sel_hi:[1,0]
v_pk_mul_f32 v[178:179], v[178:179], v[26:27] op_sel_hi:[1,0]
v_pk_mul_f32 v[180:181], v[180:181], v[26:27] op_sel_hi:[1,0]
v_pk_mul_f32 v[182:183], v[182:183], v[26:27] op_sel_hi:[1,0]
v_pk_mul_f32 v[184:185], v[184:185], v[26:27] op_sel_hi:[1,0]
v_pk_mul_f32 v[186:187], v[186:187], v[26:27] op_sel_hi:[1,0]
v_pk_mul_f32 v[188:189], v[188:189], v[26:27] op_sel_hi:[1,0]
v_pk_mul_f32 v[190:191], v[190:191], v[26:27] op_sel_hi:[1,0]
v_cvt_pk_bf16_f32 v176, v176, v177
v_cvt_pk_bf16_f32 v177, v178, v179
v_cvt_pk_bf16_f32 v178, v180, v181
v_cvt_pk_bf16_f32 v179, v182, v183
buffer_store_dwordx4 v[176:179], v6, s[8:11], s27 offen offset:1024 sc1
v_cvt_pk_bf16_f32 v184, v184, v185
v_cvt_pk_bf16_f32 v185, v186, v187
v_cvt_pk_bf16_f32 v186, v188, v189
v_cvt_pk_bf16_f32 v187, v190, v191
buffer_store_dwordx4 v[184:187], v6, s[8:11], s27 offen offset:1536 sc1
v_pk_mul_f32 v[208:209], v[208:209], v[26:27] op_sel_hi:[1,0]
v_pk_mul_f32 v[210:211], v[210:211], v[26:27] op_sel_hi:[1,0]
v_pk_mul_f32 v[212:213], v[212:213], v[26:27] op_sel_hi:[1,0]
v_pk_mul_f32 v[214:215], v[214:215], v[26:27] op_sel_hi:[1,0]
v_pk_mul_f32 v[216:217], v[216:217], v[26:27] op_sel_hi:[1,0]
v_pk_mul_f32 v[218:219], v[218:219], v[26:27] op_sel_hi:[1,0]
v_pk_mul_f32 v[220:221], v[220:221], v[26:27] op_sel_hi:[1,0]
v_pk_mul_f32 v[222:223], v[222:223], v[26:27] op_sel_hi:[1,0]
v_cvt_pk_bf16_f32 v208, v208, v209
v_cvt_pk_bf16_f32 v209, v210, v211
v_cvt_pk_bf16_f32 v210, v212, v213
v_cvt_pk_bf16_f32 v211, v214, v215
buffer_store_dwordx4 v[208:211], v6, s[8:11], s27 offen offset:2048 sc1
v_cvt_pk_bf16_f32 v216, v216, v217
v_cvt_pk_bf16_f32 v217, v218, v219
v_cvt_pk_bf16_f32 v218, v220, v221
v_cvt_pk_bf16_f32 v219, v222, v223
buffer_store_dwordx4 v[216:219], v6, s[8:11], s27 offen offset:2560 sc1
v_pk_mul_f32 v[240:241], v[240:241], v[26:27] op_sel_hi:[1,0]
v_pk_mul_f32 v[242:243], v[242:243], v[26:27] op_sel_hi:[1,0]
v_pk_mul_f32 v[244:245], v[244:245], v[26:27] op_sel_hi:[1,0]
v_pk_mul_f32 v[246:247], v[246:247], v[26:27] op_sel_hi:[1,0]
v_pk_mul_f32 v[248:249], v[248:249], v[26:27] op_sel_hi:[1,0]
v_pk_mul_f32 v[250:251], v[250:251], v[26:27] op_sel_hi:[1,0]
v_pk_mul_f32 v[252:253], v[252:253], v[26:27] op_sel_hi:[1,0]
v_pk_mul_f32 v[254:255], v[254:255], v[26:27] op_sel_hi:[1,0]
v_cvt_pk_bf16_f32 v240, v240, v241
v_cvt_pk_bf16_f32 v241, v242, v243
v_cvt_pk_bf16_f32 v242, v244, v245
v_cvt_pk_bf16_f32 v243, v246, v247
buffer_store_dwordx4 v[240:243], v6, s[8:11], s27 offen offset:3072 sc1
v_cvt_pk_bf16_f32 v248, v248, v249
v_cvt_pk_bf16_f32 v249, v250, v251
v_cvt_pk_bf16_f32 v250, v252, v253
v_cvt_pk_bf16_f32 v251, v254, v255
buffer_store_dwordx4 v[248:251], v6, s[8:11], s27 offen offset:3584 sc1
s_lshl_b32 s61, s41, 5
s_add_u32 s61, s61, s42
s_lshl_b32 s61, s61, 2
s_add_u32 s61, s61, 111169536
s_waitcnt vmcnt(0)
s_barrier
s_cmp_lg_u32 s17, 0
s_cbranch_scc1 L_sf_22
v_mov_b32 v20, 0
v_mov_b32 v21, 1
s_mov_b64 exec, 1
buffer_store_dword v21, v20, s[8:11], s61 offen sc1
s_mov_b64 exec, -1
L_sf_22:
s_mov_b32 s41, s62
s_add_u32 s60, s60, 1
s_cmp_lt_u32 s60, 2
s_cbranch_scc1 L_aat
L_aop:
s_cmp_ge_u32 s16, 27
s_cbranch_scc1 L_done
s_load_dwordx2 s[4:5], s[0:1], 40
s_waitcnt lgkmcnt(0)
s_mov_b32 s20, s4
s_and_b32 s21, s5, 0xffff
s_mov_b32 s22, 4718592
s_mov_b32 s23, 0x20000
s_mul_i32 s24, s16, 57
s_lshr_b32 s24, s24, 9
s_mul_i32 s25, s24, 9
s_sub_u32 s40, s16, s25
s_cmp_lt_u32 s3, 4
s_cselect_b32 s25, 2, 4
s_cselect_b32 s43, 6, 12
s_cselect_b32 s26, 0, 80
s_mov_b32 s27, 128
s_cselect_b32 s27, 80, s27
s_sub_u32 s25, s3, s25
s_mul_i32 s25, s25, 3
s_add_u32 s25, s25, s24
s_add_u32 s26, s26, s25
s_add_u32 s41, s26, 64
s_and_b32 s41, s41, 127
s_mov_b32 s42, 0
s_cmp_ge_u32 s26, s27
s_cbranch_scc1 L_done
L_cnt:
s_add_u32 s42, s42, 1
s_add_u32 s26, s26, s43
s_cmp_lt_u32 s26, s27
s_cbranch_scc1 L_cnt
s_mov_b32 s44, 67108864
s_mov_b32 s45, 111169536
s_mov_b32 s46, 4
s_mov_b32 s47, 0
s_branch L_op
L_part:
s_cmp_lt_u32 s16, 18
s_cbranch_scc1 L_bo
s_sub_u32 s41, s16, 18
s_mul_i32 s24, s17, 14
s_add_u32 s41, s41, s24
s_mov_b32 s40, 0x3e0293ee
s_mov_b32 s50, 0xf149f2ca
s_mov_b32 s51, 0x41a00000
v_and_b32 v5, 31, v0
v_bfe_u32 v26, v0, 5, 1
v_lshlrev_b32 v27, 2, v26
v_sub_u32 v5, v5, v27
v_bfe_u32 v27, v0, 4, 1
v_lshlrev_b32 v6, 17, v27
v_lshl_add_u32 v6, v26, 8, v6
v_and_b32 v27, 15, v0
v_lshl_add_u32 v6, v27, 4, v6
v_and_b32 v1, 63, v0
v_min_u32 v17, 47, v1
v_lshlrev_b32 v1, 4, v1
v_bfe_u32 v26, v0, 5, 1
v_and_b32 v27, 7, v0
v_xor_b32 v27, v27, v26
v_lshlrev_b32 v27, 4, v27
v_lshl_add_u32 v2, v26, 7, v27
v_xor_b32 v7, 64, v2
v_and_b32 v27, 31, v0
v_lshlrev_b32 v27, 2, v27
v_lshl_add_u32 v3, v26, 8, v27
v_mov_b32 v4, 0
v_lshlrev_b32 v17, 7, v17
v_mul_u32_u24 v26, 24576, v26
v_add_u32 v17, v17, v26
v_add_u32 v17, 111149056, v17
v_bfe_u32 v26, v0, 1, 4
v_and_b32 v27, 1, v0
v_lshl_add_u32 v26, v27, 4, v26
v_and_or_b32 v26, v0, 32, v26
v_lshlrev_b32 v16, 4, v26
v_mov_b32 v31, s50
s_mov_b32 s45, -1
v_cmp_le_i32 s[64:65], 0, v5
v_cmp_le_i32 s[66:67], 1, v5
v_cmp_le_i32 s[68:69], 2, v5
v_cmp_le_i32 s[70:71], 3, v5
v_cmp_le_i32 s[72:73], 8, v5
v_cmp_le_i32 s[74:75], 9, v5
v_cmp_le_i32 s[76:77], 10, v5
v_cmp_le_i32 s[78:79], 11, v5
v_cmp_le_i32 s[80:81], 16, v5
v_cmp_le_i32 s[82:83], 17, v5
v_cmp_le_i32 s[84:85], 18, v5
v_cmp_le_i32 s[86:87], 19, v5
v_cmp_le_i32 s[88:89], 24, v5
v_cmp_le_i32 s[90:91], 25, v5
v_cmp_le_i32 s[92:93], 26, v5
v_cmp_le_i32 s[94:95], 27, v5
s_and_b32 s24, s41, 31
s_lshr_b32 s25, s41, 5
s_lshl_b32 s46, s24, 6
s_add_u32 s46, s46, s25
s_lshl_b32 s46, s46, 14
s_add_u32 s46, s46, 33554432
s_lshr_b32 s44, s24, 1
s_lshl_b32 s44, s44, 6
s_add_u32 s44, s44, s25
s_lshl_b32 s44, s44, 1
s_and_b32 s24, s24, 1
s_add_u32 s44, s44, s24
s_lshl_b32 s44, s44, 13
s_add_u32 s44, s44, 134217728
s_cmp_ge_u32 s41, 2048
s_cselect_b32 s44, 536870912, s44
s_cselect_b32 s46, 536870912, s46
s_cbranch_scc1 L_nb_23
s_lshr_b32 s25, s41, 8
s_lshl_b32 s25, s25, 2
s_cmp_eq_u32 s25, s45
s_cbranch_scc1 L_nb_23
s_mov_b32 s45, s25
s_mov_b32 s28, 0
L_poll_24:
buffer_load_dword v26, v17, s[8:11], s45 offen sc1
s_add_u32 s28, s28, 1
s_cmp_gt_u32 s28, 40000
s_cbranch_scc1 L_end
s_waitcnt vmcnt(0)
v_cmp_ne_u32 vcc, 1, v26
s_cbranch_vccz L_pd_25
s_sleep 8
s_branch L_poll_24
L_pd_25:
L_nb_23:
s_add_u32 s25, s44, 0
buffer_load_dwordx4 a[0:3], v1, s[8:11], s25 offen offset:0 sc1
buffer_load_dwordx4 a[4:7], v1, s[8:11], s25 offen offset:1024 sc1
buffer_load_dwordx4 a[8:11], v1, s[8:11], s25 offen offset:2048 sc1
buffer_load_dwordx4 a[12:15], v1, s[8:11], s25 offen offset:3072 sc1
s_add_u32 s25, s44, 4096
buffer_load_dwordx4 a[16:19], v1, s[8:11], s25 offen offset:0 sc1
buffer_load_dwordx4 a[20:23], v1, s[8:11], s25 offen offset:1024 sc1
buffer_load_dwordx4 a[24:27], v1, s[8:11], s25 offen offset:2048 sc1
buffer_load_dwordx4 a[28:31], v1, s[8:11], s25 offen offset:3072 sc1
s_add_u32 s25, s46, 0
buffer_load_dwordx4 a[32:35], v1, s[8:11], s25 offen offset:0 sc1
buffer_load_dwordx4 a[36:39], v1, s[8:11], s25 offen offset:1024 sc1
buffer_load_dwordx4 a[40:43], v1, s[8:11], s25 offen offset:2048 sc1
buffer_load_dwordx4 a[44:47], v1, s[8:11], s25 offen offset:3072 sc1
s_add_u32 s25, s46, 4096
buffer_load_dwordx4 a[48:51], v1, s[8:11], s25 offen offset:0 sc1
buffer_load_dwordx4 a[52:55], v1, s[8:11], s25 offen offset:1024 sc1
buffer_load_dwordx4 a[56:59], v1, s[8:11], s25 offen offset:2048 sc1
buffer_load_dwordx4 a[60:63], v1, s[8:11], s25 offen offset:3072 sc1
s_add_u32 s25, s46, 8192
buffer_load_dwordx4 a[64:67], v16, s[8:11], s25 offen offset:0 sc1
buffer_load_dwordx4 a[68:71], v16, s[8:11], s25 offen offset:1024 sc1
buffer_load_dwordx4 a[72:75], v16, s[8:11], s25 offen offset:2048 sc1
buffer_load_dwordx4 a[76:79], v16, s[8:11], s25 offen offset:3072 sc1
s_add_u32 s25, s46, 12288
buffer_load_dwordx4 a[80:83], v16, s[8:11], s25 offen offset:0 sc1
buffer_load_dwordx4 a[84:87], v16, s[8:11], s25 offen offset:1024 sc1
buffer_load_dwordx4 a[88:91], v16, s[8:11], s25 offen offset:2048 sc1
buffer_load_dwordx4 a[92:95], v16, s[8:11], s25 offen offset:3072 sc1
s_waitcnt vmcnt(0)
L_bt:
v_mfma_f32_32x32x16_bf16 v[32:47], a[32:35], a[0:3], 0
v_mfma_f32_32x32x16_bf16 v[32:47], a[36:39], a[4:7], v[32:47]
v_mfma_f32_32x32x16_bf16 v[32:47], a[40:43], a[8:11], v[32:47]
v_mfma_f32_32x32x16_bf16 v[32:47], a[44:47], a[12:15], v[32:47]
v_mfma_f32_32x32x16_bf16 v[32:47], a[48:51], a[16:19], v[32:47]
v_mfma_f32_32x32x16_bf16 v[32:47], a[52:55], a[20:23], v[32:47]
v_mfma_f32_32x32x16_bf16 v[32:47], a[56:59], a[24:27], v[32:47]
v_mfma_f32_32x32x16_bf16 v[32:47], a[60:63], a[28:31], v[32:47]
s_and_b32 s42, s41, 31
s_lshr_b32 s43, s41, 5
s_add_u32 s48, s41, 56
s_and_b32 s24, s48, 31
s_lshr_b32 s25, s48, 5
s_lshl_b32 s46, s24, 6
s_add_u32 s46, s46, s25
s_lshl_b32 s46, s46, 14
s_add_u32 s46, s46, 33554432
s_lshr_b32 s44, s24, 1
s_lshl_b32 s44, s44, 6
s_add_u32 s44, s44, s25
s_lshl_b32 s44, s44, 1
s_and_b32 s24, s24, 1
s_add_u32 s44, s44, s24
s_lshl_b32 s44, s44, 13
s_add_u32 s44, s44, 134217728
s_cmp_ge_u32 s48, 2048
s_cselect_b32 s44, 536870912, s44
s_cselect_b32 s46, 536870912, s46
s_cbranch_scc1 L_nb_26
s_lshr_b32 s25, s48, 8
s_lshl_b32 s25, s25, 2
s_cmp_eq_u32 s25, s45
s_cbranch_scc1 L_nb_26
s_mov_b32 s45, s25
s_mov_b32 s28, 0
L_poll_27:
buffer_load_dword v26, v17, s[8:11], s45 offen sc1
s_add_u32 s28, s28, 1
s_cmp_gt_u32 s28, 40000
s_cbranch_scc1 L_end
s_waitcnt vmcnt(0)
v_cmp_ne_u32 vcc, 1, v26
s_cbranch_vccz L_pd_28
s_sleep 8
s_branch L_poll_27
L_pd_28:
L_nb_26:
v_cndmask_b32 v32, v31, v32, s[64:65]
v_cndmask_b32 v33, v31, v33, s[66:67]
v_cndmask_b32 v34, v31, v34, s[68:69]
v_cndmask_b32 v35, v31, v35, s[70:71]
v_cndmask_b32 v36, v31, v36, s[72:73]
v_cndmask_b32 v37, v31, v37, s[74:75]
v_cndmask_b32 v38, v31, v38, s[76:77]
v_cndmask_b32 v39, v31, v39, s[78:79]
v_cndmask_b32 v40, v31, v40, s[80:81]
v_cndmask_b32 v41, v31, v41, s[82:83]
v_cndmask_b32 v42, v31, v42, s[84:85]
v_cndmask_b32 v43, v31, v43, s[86:87]
v_cndmask_b32 v44, v31, v44, s[88:89]
v_cndmask_b32 v45, v31, v45, s[90:91]
v_cndmask_b32 v46, v31, v46, s[92:93]
v_cndmask_b32 v47, v31, v47, s[94:95]
v_max3_f32 v20, v32, v33, v34
v_max3_f32 v20, v20, v35, v36
v_max3_f32 v20, v20, v37, v38
v_max3_f32 v20, v20, v39, v40
v_max3_f32 v20, v20, v41, v42
v_max3_f32 v20, v20, v43, v44
v_max3_f32 v20, v20, v45, v46
v_max_f32 v20, v20, v47
s_lshl_b32 s25, s42, 7
s_add_u32 s25, s25, 111153152
s_lshl_b32 s24, s41, 12
s_add_u32 s24, s24, 100663296
s_mov_b32 s28, 0
L_poll_29:
buffer_load_dword v26, v4, s[8:11], s25 offen sc1
s_add_u32 s28, s28, 1
s_cmp_gt_u32 s28, 40000
s_cbranch_scc1 L_end
s_waitcnt vmcnt(0)
v_cmp_ge_u32 vcc, s43, v26
s_cbranch_vccz L_pd_30
s_sleep 1
s_branch L_poll_29
L_pd_30:
buffer_load_dwordx4 v[96:99], v2, s[8:11], s24 offen offset:0 sc1
buffer_load_dwordx4 v[100:103], v7, s[8:11], s24 offen offset:256 sc1
buffer_load_dwordx4 v[104:107], v2, s[8:11], s24 offen offset:512 sc1
buffer_load_dwordx4 v[108:111], v7, s[8:11], s24 offen offset:768 sc1
buffer_load_dwordx4 v[112:115], v2, s[8:11], s24 offen offset:1024 sc1
buffer_load_dwordx4 v[116:119], v7, s[8:11], s24 offen offset:1280 sc1
buffer_load_dwordx4 v[120:123], v2, s[8:11], s24 offen offset:1536 sc1
buffer_load_dwordx4 v[124:127], v7, s[8:11], s24 offen offset:1792 sc1
buffer_load_dword v8, v3, s[8:11], s24 offen offset:2048 sc1
buffer_load_dword v9, v3, s[8:11], s24 offen offset:2176 sc1
buffer_load_dword v10, v3, s[8:11], s24 offen offset:2560 sc1
buffer_load_dword v11, v3, s[8:11], s24 offen offset:2688 sc1
buffer_load_dword v12, v3, s[8:11], s24 offen offset:3072 sc1
buffer_load_dword v13, v3, s[8:11], s24 offen offset:3200 sc1
buffer_load_dword v14, v3, s[8:11], s24 offen offset:3584 sc1
buffer_load_dword v15, v3, s[8:11], s24 offen offset:3712 sc1
s_add_u32 s25, s44, 0
buffer_load_dwordx4 a[96:99], v1, s[8:11], s25 offen offset:0 sc1
buffer_load_dwordx4 a[100:103], v1, s[8:11], s25 offen offset:1024 sc1
buffer_load_dwordx4 a[104:107], v1, s[8:11], s25 offen offset:2048 sc1
buffer_load_dwordx4 a[108:111], v1, s[8:11], s25 offen offset:3072 sc1
s_add_u32 s25, s44, 4096
buffer_load_dwordx4 a[112:115], v1, s[8:11], s25 offen offset:0 sc1
buffer_load_dwordx4 a[116:119], v1, s[8:11], s25 offen offset:1024 sc1
s_waitcnt vmcnt(21)
v_mfma_f32_32x32x16_bf16 v[64:79], v[96:99], a[0:3], 0
s_waitcnt vmcnt(20)
v_mfma_f32_32x32x16_bf16 v[64:79], v[100:103], a[4:7], v[64:79]
buffer_load_dwordx4 a[120:123], v1, s[8:11], s25 offen offset:2048 sc1
s_waitcnt vmcnt(20)
v_mfma_f32_32x32x16_bf16 v[64:79], v[104:107], a[8:11], v[64:79]
s_waitcnt vmcnt(19)
v_mfma_f32_32x32x16_bf16 v[64:79], v[108:111], a[12:15], v[64:79]
buffer_load_dwordx4 a[124:127], v1, s[8:11], s25 offen offset:3072 sc1
s_waitcnt vmcnt(19)
v_mfma_f32_32x32x16_bf16 v[64:79], v[112:115], a[16:19], v[64:79]
s_waitcnt vmcnt(18)
v_mfma_f32_32x32x16_bf16 v[64:79], v[116:119], a[20:23], v[64:79]
s_add_u32 s25, s46, 0
buffer_load_dwordx4 a[128:131], v1, s[8:11], s25 offen offset:0 sc1
s_waitcnt vmcnt(18)
v_mfma_f32_32x32x16_bf16 v[64:79], v[120:123], a[24:27], v[64:79]
s_waitcnt vmcnt(17)
v_mfma_f32_32x32x16_bf16 v[64:79], v[124:127], a[28:31], v[64:79]
buffer_load_dwordx4 a[132:135], v1, s[8:11], s25 offen offset:1024 sc1
s_nop 10
v_max3_f32 v20, v20, v64, v65
v_max3_f32 v20, v20, v66, v67
v_mov_b32 v26, v20
s_nop 1
v_permlane32_swap_b32 v26, v20
v_max_f32 v20, v20, v26
v_mul_f32 v20, s40, v20
v_fma_f32 v64, v64, s40, -v20
v_fma_f32 v65, v65, s40, -v20
v_fma_f32 v66, v66, s40, -v20
v_fma_f32 v67, v67, s40, -v20
v_fma_f32 v32, v32, s40, -v20
v_fma_f32 v33, v33, s40, -v20
v_fma_f32 v34, v34, s40, -v20
v_fma_f32 v35, v35, s40, -v20
v_fma_f32 v36, v36, s40, -v20
v_fma_f32 v37, v37, s40, -v20
v_fma_f32 v38, v38, s40, -v20
v_fma_f32 v39, v39, s40, -v20
v_fma_f32 v40, v40, s40, -v20
v_fma_f32 v41, v41, s40, -v20
v_fma_f32 v42, v42, s40, -v20
v_fma_f32 v43, v43, s40, -v20
v_fma_f32 v44, v44, s40, -v20
v_fma_f32 v45, v45, s40, -v20
v_fma_f32 v46, v46, s40, -v20
v_fma_f32 v47, v47, s40, -v20
v_exp_f32 v64, v64
buffer_load_dwordx4 a[136:139], v1, s[8:11], s25 offen offset:2048 sc1
v_exp_f32 v65, v65
v_exp_f32 v66, v66
v_exp_f32 v67, v67
v_exp_f32 v32, v32
v_exp_f32 v33, v33
buffer_load_dwordx4 a[140:143], v1, s[8:11], s25 offen offset:3072 sc1
v_exp_f32 v34, v34
v_exp_f32 v35, v35
v_exp_f32 v36, v36
v_exp_f32 v37, v37
v_exp_f32 v38, v38
s_add_u32 s25, s46, 4096
buffer_load_dwordx4 a[144:147], v1, s[8:11], s25 offen offset:0 sc1
v_exp_f32 v39, v39
v_exp_f32 v40, v40
v_exp_f32 v41, v41
v_exp_f32 v42, v42
v_exp_f32 v43, v43
buffer_load_dwordx4 a[148:151], v1, s[8:11], s25 offen offset:1024 sc1
v_exp_f32 v44, v44
v_exp_f32 v45, v45
v_exp_f32 v46, v46
v_exp_f32 v47, v47
v_cvt_pk_bf16_f32 v88, v64, v65
v_cvt_pk_bf16_f32 v89, v66, v67
v_cvt_pk_bf16_f32 v80, v32, v33
v_cvt_pk_bf16_f32 v81, v34, v35
v_cvt_pk_bf16_f32 v82, v36, v37
v_cvt_pk_bf16_f32 v83, v38, v39
v_cvt_pk_bf16_f32 v84, v40, v41
v_cvt_pk_bf16_f32 v85, v42, v43
v_cvt_pk_bf16_f32 v86, v44, v45
v_cvt_pk_bf16_f32 v87, v46, v47
s_waitcnt vmcnt(14)
v_mfma_f32_32x32x8_bf16 v[128:143], v[8:9], v[88:89], 0
buffer_load_dwordx4 a[152:155], v1, s[8:11], s25 offen offset:2048 sc1
v_add_f32 v22, v64, v65
v_add_f32 v22, v22, v66
v_mfma_f32_32x32x16_bf16 v[128:143], a[64:67], v[80:83], v[128:143]
buffer_load_dwordx4 a[156:159], v1, s[8:11], s25 offen offset:3072 sc1
v_add_f32 v22, v22, v67
v_add_f32 v22, v22, v32
v_add_f32 v22, v22, v33
v_mfma_f32_32x32x16_bf16 v[128:143], a[68:71], v[84:87], v[128:143]
s_add_u32 s25, s46, 8192
buffer_load_dwordx4 a[160:163], v16, s[8:11], s25 offen offset:0 sc1
v_add_f32 v22, v22, v34
v_add_f32 v22, v22, v35
v_mfma_f32_32x32x8_bf16 v[160:175], v[10:11], v[88:89], 0
buffer_load_dwordx4 a[164:167], v16, s[8:11], s25 offen offset:1024 sc1
v_add_f32 v22, v22, v36
v_add_f32 v22, v22, v37
v_add_f32 v22, v22, v38
v_mfma_f32_32x32x16_bf16 v[160:175], a[72:75], v[80:83], v[160:175]
buffer_load_dwordx4 a[168:171], v16, s[8:11], s25 offen offset:2048 sc1
v_add_f32 v22, v22, v39
v_add_f32 v22, v22, v40
v_mfma_f32_32x32x16_bf16 v[160:175], a[76:79], v[84:87], v[160:175]
buffer_load_dwordx4 a[172:175], v16, s[8:11], s25 offen offset:3072 sc1
v_add_f32 v22, v22, v41
v_add_f32 v22, v22, v42
v_mfma_f32_32x32x8_bf16 v[192:207], v[12:13], v[88:89], 0
s_add_u32 s25, s46, 12288
buffer_load_dwordx4 a[176:179], v16, s[8:11], s25 offen offset:0 sc1
v_add_f32 v22, v22, v43
v_add_f32 v22, v22, v44
v_add_f32 v22, v22, v45
v_mfma_f32_32x32x16_bf16 v[192:207], a[80:83], v[80:83], v[192:207]
buffer_load_dwordx4 a[180:183], v16, s[8:11], s25 offen offset:1024 sc1
v_add_f32 v22, v22, v46
v_add_f32 v22, v22, v47
v_mfma_f32_32x32x16_bf16 v[192:207], a[84:87], v[84:87], v[192:207]
buffer_load_dwordx4 a[184:187], v16, s[8:11], s25 offen offset:2048 sc1
v_mfma_f32_32x32x8_bf16 v[224:239], v[14:15], v[88:89], 0
buffer_load_dwordx4 a[188:191], v16, s[8:11], s25 offen offset:3072 sc1
v_mfma_f32_32x32x16_bf16 v[224:239], a[88:91], v[80:83], v[224:239]
v_mfma_f32_32x32x16_bf16 v[224:239], a[92:95], v[84:87], v[224:239]
s_lshl_b32 s26, s43, 18
s_lshl_b32 s27, s42, 12
s_add_u32 s26, s26, s27
s_add_u32 s26, s26, 83886080
v_mov_b32 v26, v22
s_nop 1
v_permlane32_swap_b32 v26, v22
v_add_f32 v26, v26, v22
v_rcp_f32 v26, v26
s_nop 0
v_pk_mul_f32 v[128:129], v[128:129], v[26:27] op_sel_hi:[1,0]
v_pk_mul_f32 v[130:131], v[130:131], v[26:27] op_sel_hi:[1,0]
v_pk_mul_f32 v[132:133], v[132:133], v[26:27] op_sel_hi:[1,0]
v_pk_mul_f32 v[134:135], v[134:135], v[26:27] op_sel_hi:[1,0]
v_pk_mul_f32 v[136:137], v[136:137], v[26:27] op_sel_hi:[1,0]
v_pk_mul_f32 v[138:139], v[138:139], v[26:27] op_sel_hi:[1,0]
v_pk_mul_f32 v[140:141], v[140:141], v[26:27] op_sel_hi:[1,0]
v_pk_mul_f32 v[142:143], v[142:143], v[26:27] op_sel_hi:[1,0]
v_cvt_pk_bf16_f32 v128, v128, v129
v_cvt_pk_bf16_f32 v129, v130, v131
v_cvt_pk_bf16_f32 v130, v132, v133
v_cvt_pk_bf16_f32 v131, v134, v135
buffer_store_dwordx4 v[128:131], v6, s[8:11], s26 offen offset:0 sc1
v_cvt_pk_bf16_f32 v136, v136, v137
v_cvt_pk_bf16_f32 v137, v138, v139
v_cvt_pk_bf16_f32 v138, v140, v141
v_cvt_pk_bf16_f32 v139, v142, v143
buffer_store_dwordx4 v[136:139], v6, s[8:11], s26 offen offset:512 sc1
v_pk_mul_f32 v[160:161], v[160:161], v[26:27] op_sel_hi:[1,0]
v_pk_mul_f32 v[162:163], v[162:163], v[26:27] op_sel_hi:[1,0]
v_pk_mul_f32 v[164:165], v[164:165], v[26:27] op_sel_hi:[1,0]
v_pk_mul_f32 v[166:167], v[166:167], v[26:27] op_sel_hi:[1,0]
v_pk_mul_f32 v[168:169], v[168:169], v[26:27] op_sel_hi:[1,0]
v_pk_mul_f32 v[170:171], v[170:171], v[26:27] op_sel_hi:[1,0]
v_pk_mul_f32 v[172:173], v[172:173], v[26:27] op_sel_hi:[1,0]
v_pk_mul_f32 v[174:175], v[174:175], v[26:27] op_sel_hi:[1,0]
v_cvt_pk_bf16_f32 v160, v160, v161
v_cvt_pk_bf16_f32 v161, v162, v163
v_cvt_pk_bf16_f32 v162, v164, v165
v_cvt_pk_bf16_f32 v163, v166, v167
buffer_store_dwordx4 v[160:163], v6, s[8:11], s26 offen offset:1024 sc1
v_cvt_pk_bf16_f32 v168, v168, v169
v_cvt_pk_bf16_f32 v169, v170, v171
v_cvt_pk_bf16_f32 v170, v172, v173
v_cvt_pk_bf16_f32 v171, v174, v175
buffer_store_dwordx4 v[168:171], v6, s[8:11], s26 offen offset:1536 sc1
v_pk_mul_f32 v[192:193], v[192:193], v[26:27] op_sel_hi:[1,0]
v_pk_mul_f32 v[194:195], v[194:195], v[26:27] op_sel_hi:[1,0]
v_pk_mul_f32 v[196:197], v[196:197], v[26:27] op_sel_hi:[1,0]
v_pk_mul_f32 v[198:199], v[198:199], v[26:27] op_sel_hi:[1,0]
v_pk_mul_f32 v[200:201], v[200:201], v[26:27] op_sel_hi:[1,0]
v_pk_mul_f32 v[202:203], v[202:203], v[26:27] op_sel_hi:[1,0]
v_pk_mul_f32 v[204:205], v[204:205], v[26:27] op_sel_hi:[1,0]
v_pk_mul_f32 v[206:207], v[206:207], v[26:27] op_sel_hi:[1,0]
v_cvt_pk_bf16_f32 v192, v192, v193
v_cvt_pk_bf16_f32 v193, v194, v195
v_cvt_pk_bf16_f32 v194, v196, v197
v_cvt_pk_bf16_f32 v195, v198, v199
buffer_store_dwordx4 v[192:195], v6, s[8:11], s26 offen offset:2048 sc1
v_cvt_pk_bf16_f32 v200, v200, v201
v_cvt_pk_bf16_f32 v201, v202, v203
v_cvt_pk_bf16_f32 v202, v204, v205
v_cvt_pk_bf16_f32 v203, v206, v207
buffer_store_dwordx4 v[200:203], v6, s[8:11], s26 offen offset:2560 sc1
v_pk_mul_f32 v[224:225], v[224:225], v[26:27] op_sel_hi:[1,0]
v_pk_mul_f32 v[226:227], v[226:227], v[26:27] op_sel_hi:[1,0]
v_pk_mul_f32 v[228:229], v[228:229], v[26:27] op_sel_hi:[1,0]
v_pk_mul_f32 v[230:231], v[230:231], v[26:27] op_sel_hi:[1,0]
v_pk_mul_f32 v[232:233], v[232:233], v[26:27] op_sel_hi:[1,0]
v_pk_mul_f32 v[234:235], v[234:235], v[26:27] op_sel_hi:[1,0]
v_pk_mul_f32 v[236:237], v[236:237], v[26:27] op_sel_hi:[1,0]
v_pk_mul_f32 v[238:239], v[238:239], v[26:27] op_sel_hi:[1,0]
v_cvt_pk_bf16_f32 v224, v224, v225
v_cvt_pk_bf16_f32 v225, v226, v227
v_cvt_pk_bf16_f32 v226, v228, v229
v_cvt_pk_bf16_f32 v227, v230, v231
buffer_store_dwordx4 v[224:227], v6, s[8:11], s26 offen offset:3072 sc1
v_cvt_pk_bf16_f32 v232, v232, v233
v_cvt_pk_bf16_f32 v233, v234, v235
v_cvt_pk_bf16_f32 v234, v236, v237
v_cvt_pk_bf16_f32 v235, v238, v239
buffer_store_dwordx4 v[232:235], v6, s[8:11], s26 offen offset:3584 sc1
s_lshl_b32 s26, s41, 2
s_add_u32 s26, s26, 111157248
v_mov_b32 v26, 1
s_waitcnt vmcnt(0)
s_mov_b64 exec, 1
buffer_store_dword v26, v4, s[8:11], s26 offen sc1
s_mov_b64 exec, -1
s_mov_b32 s41, s48
s_cmp_lt_u32 s41, 2048
s_cbranch_scc0 L_bt_x
v_mfma_f32_32x32x16_bf16 v[32:47], a[128:131], a[96:99], 0
v_mfma_f32_32x32x16_bf16 v[32:47], a[132:135], a[100:103], v[32:47]
v_mfma_f32_32x32x16_bf16 v[32:47], a[136:139], a[104:107], v[32:47]
v_mfma_f32_32x32x16_bf16 v[32:47], a[140:143], a[108:111], v[32:47]
v_mfma_f32_32x32x16_bf16 v[32:47], a[144:147], a[112:115], v[32:47]
v_mfma_f32_32x32x16_bf16 v[32:47], a[148:151], a[116:119], v[32:47]
v_mfma_f32_32x32x16_bf16 v[32:47], a[152:155], a[120:123], v[32:47]
v_mfma_f32_32x32x16_bf16 v[32:47], a[156:159], a[124:127], v[32:47]
s_and_b32 s42, s41, 31
s_lshr_b32 s43, s41, 5
s_add_u32 s48, s41, 56
s_and_b32 s24, s48, 31
s_lshr_b32 s25, s48, 5
s_lshl_b32 s46, s24, 6
s_add_u32 s46, s46, s25
s_lshl_b32 s46, s46, 14
s_add_u32 s46, s46, 33554432
s_lshr_b32 s44, s24, 1
s_lshl_b32 s44, s44, 6
s_add_u32 s44, s44, s25
s_lshl_b32 s44, s44, 1
s_and_b32 s24, s24, 1
s_add_u32 s44, s44, s24
s_lshl_b32 s44, s44, 13
s_add_u32 s44, s44, 134217728
s_cmp_ge_u32 s48, 2048
s_cselect_b32 s44, 536870912, s44
s_cselect_b32 s46, 536870912, s46
s_cbranch_scc1 L_nb_31
s_lshr_b32 s25, s48, 8
s_lshl_b32 s25, s25, 2
s_cmp_eq_u32 s25, s45
s_cbranch_scc1 L_nb_31
s_mov_b32 s45, s25
s_mov_b32 s28, 0
L_poll_32:
buffer_load_dword v26, v17, s[8:11], s45 offen sc1
s_add_u32 s28, s28, 1
s_cmp_gt_u32 s28, 40000
s_cbranch_scc1 L_end
s_waitcnt vmcnt(0)
v_cmp_ne_u32 vcc, 1, v26
s_cbranch_vccz L_pd_33
s_sleep 8
s_branch L_poll_32
L_pd_33:
L_nb_31:
v_cndmask_b32 v32, v31, v32, s[64:65]
v_cndmask_b32 v33, v31, v33, s[66:67]
v_cndmask_b32 v34, v31, v34, s[68:69]
v_cndmask_b32 v35, v31, v35, s[70:71]
v_cndmask_b32 v36, v31, v36, s[72:73]
v_cndmask_b32 v37, v31, v37, s[74:75]
v_cndmask_b32 v38, v31, v38, s[76:77]
v_cndmask_b32 v39, v31, v39, s[78:79]
v_cndmask_b32 v40, v31, v40, s[80:81]
v_cndmask_b32 v41, v31, v41, s[82:83]
v_cndmask_b32 v42, v31, v42, s[84:85]
v_cndmask_b32 v43, v31, v43, s[86:87]
v_cndmask_b32 v44, v31, v44, s[88:89]
v_cndmask_b32 v45, v31, v45, s[90:91]
v_cndmask_b32 v46, v31, v46, s[92:93]
v_cndmask_b32 v47, v31, v47, s[94:95]
v_max3_f32 v20, v32, v33, v34
v_max3_f32 v20, v20, v35, v36
v_max3_f32 v20, v20, v37, v38
v_max3_f32 v20, v20, v39, v40
v_max3_f32 v20, v20, v41, v42
v_max3_f32 v20, v20, v43, v44
v_max3_f32 v20, v20, v45, v46
v_max_f32 v20, v20, v47
s_lshl_b32 s25, s42, 7
s_add_u32 s25, s25, 111153152
s_lshl_b32 s24, s41, 12
s_add_u32 s24, s24, 100663296
s_mov_b32 s28, 0
L_poll_34:
buffer_load_dword v26, v4, s[8:11], s25 offen sc1
s_add_u32 s28, s28, 1
s_cmp_gt_u32 s28, 40000
s_cbranch_scc1 L_end
s_waitcnt vmcnt(0)
v_cmp_ge_u32 vcc, s43, v26
s_cbranch_vccz L_pd_35
s_sleep 1
s_branch L_poll_34
L_pd_35:
buffer_load_dwordx4 v[96:99], v2, s[8:11], s24 offen offset:0 sc1
buffer_load_dwordx4 v[100:103], v7, s[8:11], s24 offen offset:256 sc1
buffer_load_dwordx4 v[104:107], v2, s[8:11], s24 offen offset:512 sc1
buffer_load_dwordx4 v[108:111], v7, s[8:11], s24 offen offset:768 sc1
buffer_load_dwordx4 v[112:115], v2, s[8:11], s24 offen offset:1024 sc1
buffer_load_dwordx4 v[116:119], v7, s[8:11], s24 offen offset:1280 sc1
buffer_load_dwordx4 v[120:123], v2, s[8:11], s24 offen offset:1536 sc1
buffer_load_dwordx4 v[124:127], v7, s[8:11], s24 offen offset:1792 sc1
buffer_load_dword v8, v3, s[8:11], s24 offen offset:2048 sc1
buffer_load_dword v9, v3, s[8:11], s24 offen offset:2176 sc1
buffer_load_dword v10, v3, s[8:11], s24 offen offset:2560 sc1
buffer_load_dword v11, v3, s[8:11], s24 offen offset:2688 sc1
buffer_load_dword v12, v3, s[8:11], s24 offen offset:3072 sc1
buffer_load_dword v13, v3, s[8:11], s24 offen offset:3200 sc1
buffer_load_dword v14, v3, s[8:11], s24 offen offset:3584 sc1
buffer_load_dword v15, v3, s[8:11], s24 offen offset:3712 sc1
s_add_u32 s25, s44, 0
buffer_load_dwordx4 a[0:3], v1, s[8:11], s25 offen offset:0 sc1
buffer_load_dwordx4 a[4:7], v1, s[8:11], s25 offen offset:1024 sc1
buffer_load_dwordx4 a[8:11], v1, s[8:11], s25 offen offset:2048 sc1
buffer_load_dwordx4 a[12:15], v1, s[8:11], s25 offen offset:3072 sc1
s_add_u32 s25, s44, 4096
buffer_load_dwordx4 a[16:19], v1, s[8:11], s25 offen offset:0 sc1
buffer_load_dwordx4 a[20:23], v1, s[8:11], s25 offen offset:1024 sc1
s_waitcnt vmcnt(21)
v_mfma_f32_32x32x16_bf16 v[64:79], v[96:99], a[96:99], 0
s_waitcnt vmcnt(20)
v_mfma_f32_32x32x16_bf16 v[64:79], v[100:103], a[100:103], v[64:79]
buffer_load_dwordx4 a[24:27], v1, s[8:11], s25 offen offset:2048 sc1
s_waitcnt vmcnt(20)
v_mfma_f32_32x32x16_bf16 v[64:79], v[104:107], a[104:107], v[64:79]
s_waitcnt vmcnt(19)
v_mfma_f32_32x32x16_bf16 v[64:79], v[108:111], a[108:111], v[64:79]
buffer_load_dwordx4 a[28:31], v1, s[8:11], s25 offen offset:3072 sc1
s_waitcnt vmcnt(19)
v_mfma_f32_32x32x16_bf16 v[64:79], v[112:115], a[112:115], v[64:79]
s_waitcnt vmcnt(18)
v_mfma_f32_32x32x16_bf16 v[64:79], v[116:119], a[116:119], v[64:79]
s_add_u32 s25, s46, 0
buffer_load_dwordx4 a[32:35], v1, s[8:11], s25 offen offset:0 sc1
s_waitcnt vmcnt(18)
v_mfma_f32_32x32x16_bf16 v[64:79], v[120:123], a[120:123], v[64:79]
s_waitcnt vmcnt(17)
v_mfma_f32_32x32x16_bf16 v[64:79], v[124:127], a[124:127], v[64:79]
buffer_load_dwordx4 a[36:39], v1, s[8:11], s25 offen offset:1024 sc1
s_nop 10
v_max3_f32 v20, v20, v64, v65
v_max3_f32 v20, v20, v66, v67
v_mov_b32 v26, v20
s_nop 1
v_permlane32_swap_b32 v26, v20
v_max_f32 v20, v20, v26
v_mul_f32 v20, s40, v20
v_fma_f32 v64, v64, s40, -v20
v_fma_f32 v65, v65, s40, -v20
v_fma_f32 v66, v66, s40, -v20
v_fma_f32 v67, v67, s40, -v20
v_fma_f32 v32, v32, s40, -v20
v_fma_f32 v33, v33, s40, -v20
v_fma_f32 v34, v34, s40, -v20
v_fma_f32 v35, v35, s40, -v20
v_fma_f32 v36, v36, s40, -v20
v_fma_f32 v37, v37, s40, -v20
v_fma_f32 v38, v38, s40, -v20
v_fma_f32 v39, v39, s40, -v20
v_fma_f32 v40, v40, s40, -v20
v_fma_f32 v41, v41, s40, -v20
v_fma_f32 v42, v42, s40, -v20
v_fma_f32 v43, v43, s40, -v20
v_fma_f32 v44, v44, s40, -v20
v_fma_f32 v45, v45, s40, -v20
v_fma_f32 v46, v46, s40, -v20
v_fma_f32 v47, v47, s40, -v20
v_exp_f32 v64, v64
buffer_load_dwordx4 a[40:43], v1, s[8:11], s25 offen offset:2048 sc1
v_exp_f32 v65, v65
v_exp_f32 v66, v66
v_exp_f32 v67, v67
v_exp_f32 v32, v32
v_exp_f32 v33, v33
buffer_load_dwordx4 a[44:47], v1, s[8:11], s25 offen offset:3072 sc1
v_exp_f32 v34, v34
v_exp_f32 v35, v35
v_exp_f32 v36, v36
v_exp_f32 v37, v37
v_exp_f32 v38, v38
s_add_u32 s25, s46, 4096
buffer_load_dwordx4 a[48:51], v1, s[8:11], s25 offen offset:0 sc1
v_exp_f32 v39, v39
v_exp_f32 v40, v40
v_exp_f32 v41, v41
v_exp_f32 v42, v42
v_exp_f32 v43, v43
buffer_load_dwordx4 a[52:55], v1, s[8:11], s25 offen offset:1024 sc1
v_exp_f32 v44, v44
v_exp_f32 v45, v45
v_exp_f32 v46, v46
v_exp_f32 v47, v47
v_cvt_pk_bf16_f32 v88, v64, v65
v_cvt_pk_bf16_f32 v89, v66, v67
v_cvt_pk_bf16_f32 v80, v32, v33
v_cvt_pk_bf16_f32 v81, v34, v35
v_cvt_pk_bf16_f32 v82, v36, v37
v_cvt_pk_bf16_f32 v83, v38, v39
v_cvt_pk_bf16_f32 v84, v40, v41
v_cvt_pk_bf16_f32 v85, v42, v43
v_cvt_pk_bf16_f32 v86, v44, v45
v_cvt_pk_bf16_f32 v87, v46, v47
s_waitcnt vmcnt(14)
v_mfma_f32_32x32x8_bf16 v[128:143], v[8:9], v[88:89], 0
buffer_load_dwordx4 a[56:59], v1, s[8:11], s25 offen offset:2048 sc1
v_add_f32 v22, v64, v65
v_add_f32 v22, v22, v66
v_mfma_f32_32x32x16_bf16 v[128:143], a[160:163], v[80:83], v[128:143]
buffer_load_dwordx4 a[60:63], v1, s[8:11], s25 offen offset:3072 sc1
v_add_f32 v22, v22, v67
v_add_f32 v22, v22, v32
v_add_f32 v22, v22, v33
v_mfma_f32_32x32x16_bf16 v[128:143], a[164:167], v[84:87], v[128:143]
s_add_u32 s25, s46, 8192
buffer_load_dwordx4 a[64:67], v16, s[8:11], s25 offen offset:0 sc1
v_add_f32 v22, v22, v34
v_add_f32 v22, v22, v35
v_mfma_f32_32x32x8_bf16 v[160:175], v[10:11], v[88:89], 0
buffer_load_dwordx4 a[68:71], v16, s[8:11], s25 offen offset:1024 sc1
v_add_f32 v22, v22, v36
v_add_f32 v22, v22, v37
v_add_f32 v22, v22, v38
v_mfma_f32_32x32x16_bf16 v[160:175], a[168:171], v[80:83], v[160:175]
buffer_load_dwordx4 a[72:75], v16, s[8:11], s25 offen offset:2048 sc1
v_add_f32 v22, v22, v39
v_add_f32 v22, v22, v40
v_mfma_f32_32x32x16_bf16 v[160:175], a[172:175], v[84:87], v[160:175]
buffer_load_dwordx4 a[76:79], v16, s[8:11], s25 offen offset:3072 sc1
v_add_f32 v22, v22, v41
v_add_f32 v22, v22, v42
v_mfma_f32_32x32x8_bf16 v[192:207], v[12:13], v[88:89], 0
s_add_u32 s25, s46, 12288
buffer_load_dwordx4 a[80:83], v16, s[8:11], s25 offen offset:0 sc1
v_add_f32 v22, v22, v43
v_add_f32 v22, v22, v44
v_add_f32 v22, v22, v45
v_mfma_f32_32x32x16_bf16 v[192:207], a[176:179], v[80:83], v[192:207]
buffer_load_dwordx4 a[84:87], v16, s[8:11], s25 offen offset:1024 sc1
v_add_f32 v22, v22, v46
v_add_f32 v22, v22, v47
v_mfma_f32_32x32x16_bf16 v[192:207], a[180:183], v[84:87], v[192:207]
buffer_load_dwordx4 a[88:91], v16, s[8:11], s25 offen offset:2048 sc1
v_mfma_f32_32x32x8_bf16 v[224:239], v[14:15], v[88:89], 0
buffer_load_dwordx4 a[92:95], v16, s[8:11], s25 offen offset:3072 sc1
v_mfma_f32_32x32x16_bf16 v[224:239], a[184:187], v[80:83], v[224:239]
v_mfma_f32_32x32x16_bf16 v[224:239], a[188:191], v[84:87], v[224:239]
s_lshl_b32 s26, s43, 18
s_lshl_b32 s27, s42, 12
s_add_u32 s26, s26, s27
s_add_u32 s26, s26, 83886080
v_mov_b32 v26, v22
s_nop 1
v_permlane32_swap_b32 v26, v22
v_add_f32 v26, v26, v22
v_rcp_f32 v26, v26
s_nop 0
v_pk_mul_f32 v[128:129], v[128:129], v[26:27] op_sel_hi:[1,0]
v_pk_mul_f32 v[130:131], v[130:131], v[26:27] op_sel_hi:[1,0]
v_pk_mul_f32 v[132:133], v[132:133], v[26:27] op_sel_hi:[1,0]
v_pk_mul_f32 v[134:135], v[134:135], v[26:27] op_sel_hi:[1,0]
v_pk_mul_f32 v[136:137], v[136:137], v[26:27] op_sel_hi:[1,0]
v_pk_mul_f32 v[138:139], v[138:139], v[26:27] op_sel_hi:[1,0]
v_pk_mul_f32 v[140:141], v[140:141], v[26:27] op_sel_hi:[1,0]
v_pk_mul_f32 v[142:143], v[142:143], v[26:27] op_sel_hi:[1,0]
v_cvt_pk_bf16_f32 v128, v128, v129
v_cvt_pk_bf16_f32 v129, v130, v131
v_cvt_pk_bf16_f32 v130, v132, v133
v_cvt_pk_bf16_f32 v131, v134, v135
buffer_store_dwordx4 v[128:131], v6, s[8:11], s26 offen offset:0 sc1
v_cvt_pk_bf16_f32 v136, v136, v137
v_cvt_pk_bf16_f32 v137, v138, v139
v_cvt_pk_bf16_f32 v138, v140, v141
v_cvt_pk_bf16_f32 v139, v142, v143
buffer_store_dwordx4 v[136:139], v6, s[8:11], s26 offen offset:512 sc1
v_pk_mul_f32 v[160:161], v[160:161], v[26:27] op_sel_hi:[1,0]
v_pk_mul_f32 v[162:163], v[162:163], v[26:27] op_sel_hi:[1,0]
v_pk_mul_f32 v[164:165], v[164:165], v[26:27] op_sel_hi:[1,0]
v_pk_mul_f32 v[166:167], v[166:167], v[26:27] op_sel_hi:[1,0]
v_pk_mul_f32 v[168:169], v[168:169], v[26:27] op_sel_hi:[1,0]
v_pk_mul_f32 v[170:171], v[170:171], v[26:27] op_sel_hi:[1,0]
v_pk_mul_f32 v[172:173], v[172:173], v[26:27] op_sel_hi:[1,0]
v_pk_mul_f32 v[174:175], v[174:175], v[26:27] op_sel_hi:[1,0]
v_cvt_pk_bf16_f32 v160, v160, v161
v_cvt_pk_bf16_f32 v161, v162, v163
v_cvt_pk_bf16_f32 v162, v164, v165
v_cvt_pk_bf16_f32 v163, v166, v167
buffer_store_dwordx4 v[160:163], v6, s[8:11], s26 offen offset:1024 sc1
v_cvt_pk_bf16_f32 v168, v168, v169
v_cvt_pk_bf16_f32 v169, v170, v171
v_cvt_pk_bf16_f32 v170, v172, v173
v_cvt_pk_bf16_f32 v171, v174, v175
buffer_store_dwordx4 v[168:171], v6, s[8:11], s26 offen offset:1536 sc1
v_pk_mul_f32 v[192:193], v[192:193], v[26:27] op_sel_hi:[1,0]
v_pk_mul_f32 v[194:195], v[194:195], v[26:27] op_sel_hi:[1,0]
v_pk_mul_f32 v[196:197], v[196:197], v[26:27] op_sel_hi:[1,0]
v_pk_mul_f32 v[198:199], v[198:199], v[26:27] op_sel_hi:[1,0]
v_pk_mul_f32 v[200:201], v[200:201], v[26:27] op_sel_hi:[1,0]
v_pk_mul_f32 v[202:203], v[202:203], v[26:27] op_sel_hi:[1,0]
v_pk_mul_f32 v[204:205], v[204:205], v[26:27] op_sel_hi:[1,0]
v_pk_mul_f32 v[206:207], v[206:207], v[26:27] op_sel_hi:[1,0]
v_cvt_pk_bf16_f32 v192, v192, v193
v_cvt_pk_bf16_f32 v193, v194, v195
v_cvt_pk_bf16_f32 v194, v196, v197
v_cvt_pk_bf16_f32 v195, v198, v199
buffer_store_dwordx4 v[192:195], v6, s[8:11], s26 offen offset:2048 sc1
v_cvt_pk_bf16_f32 v200, v200, v201
v_cvt_pk_bf16_f32 v201, v202, v203
v_cvt_pk_bf16_f32 v202, v204, v205
v_cvt_pk_bf16_f32 v203, v206, v207
buffer_store_dwordx4 v[200:203], v6, s[8:11], s26 offen offset:2560 sc1
v_pk_mul_f32 v[224:225], v[224:225], v[26:27] op_sel_hi:[1,0]
v_pk_mul_f32 v[226:227], v[226:227], v[26:27] op_sel_hi:[1,0]
v_pk_mul_f32 v[228:229], v[228:229], v[26:27] op_sel_hi:[1,0]
v_pk_mul_f32 v[230:231], v[230:231], v[26:27] op_sel_hi:[1,0]
v_pk_mul_f32 v[232:233], v[232:233], v[26:27] op_sel_hi:[1,0]
v_pk_mul_f32 v[234:235], v[234:235], v[26:27] op_sel_hi:[1,0]
v_pk_mul_f32 v[236:237], v[236:237], v[26:27] op_sel_hi:[1,0]
v_pk_mul_f32 v[238:239], v[238:239], v[26:27] op_sel_hi:[1,0]
v_cvt_pk_bf16_f32 v224, v224, v225
v_cvt_pk_bf16_f32 v225, v226, v227
v_cvt_pk_bf16_f32 v226, v228, v229
v_cvt_pk_bf16_f32 v227, v230, v231
buffer_store_dwordx4 v[224:227], v6, s[8:11], s26 offen offset:3072 sc1
v_cvt_pk_bf16_f32 v232, v232, v233
v_cvt_pk_bf16_f32 v233, v234, v235
v_cvt_pk_bf16_f32 v234, v236, v237
v_cvt_pk_bf16_f32 v235, v238, v239
buffer_store_dwordx4 v[232:235], v6, s[8:11], s26 offen offset:3584 sc1
s_lshl_b32 s26, s41, 2
s_add_u32 s26, s26, 111157248
v_mov_b32 v26, 1
s_waitcnt vmcnt(0)
s_mov_b64 exec, 1
buffer_store_dword v26, v4, s[8:11], s26 offen sc1
s_mov_b64 exec, -1
s_mov_b32 s41, s48
s_cmp_lt_u32 s41, 2048
s_cbranch_scc1 L_bt
L_bt_x:
s_branch L_done
L_bo:
s_load_dwordx2 s[4:5], s[0:1], 88
s_waitcnt lgkmcnt(0)
s_mov_b32 s20, s4
s_and_b32 s21, s5, 0xffff
s_mov_b32 s22, 4718592
s_mov_b32 s23, 0x20000
s_cmp_ge_u32 s16, 9
s_cselect_b32 s41, 1, 0
s_mul_i32 s25, s41, 9
s_sub_u32 s40, s16, s25
s_mov_b32 s43, 2
s_mov_b32 s42, 64
s_mov_b32 s44, 83886080
s_mov_b32 s45, 111157248
s_mov_b32 s46, 1
s_mov_b32 s47, 1152
L_op:
s_load_dwordx2 s[4:5], s[0:1], 104
s_waitcnt lgkmcnt(0)
s_mov_b32 s12, s4
s_and_b32 s13, s5, 0xffff
s_mov_b32 s14, 4718592
s_mov_b32 s15, 0x20000
v_and_b32 v1, 63, v0
v_lshlrev_b32 v1, 4, v1
v_bfe_u32 v12, v0, 3, 3
v_mul_u32_u24 v12, 1152, v12
v_bfe_u32 v13, v0, 4, 2
v_lshlrev_b32 v13, 1, v13
v_and_b32 v14, 7, v0
v_xor_b32 v13, v13, v14
v_lshl_add_u32 v12, v13, 4, v12
s_mul_i32 s24, s17, 1179648
s_lshl_b32 s25, s40, 7
s_add_u32 s24, s24, s25
v_add_u32 v2, s24, v12
s_lshl_b32 s26, s17, 15
v_bfe_u32 v12, v0, 2, 3
v_lshlrev_b32 v12, 7, v12
v_bfe_u32 v13, v0, 5, 1
v_lshl_add_u32 v12, v13, 11, v12
v_bfe_u32 v13, v0, 3, 2
v_lshl_add_u32 v12, v13, 5, v12
v_and_b32 v13, 3, v0
v_lshl_add_u32 v12, v13, 3, v12
v_add_u32 v8, s26, v12
v_xor_b32 v9, 32, v8
v_xor_b32 v10, 64, v8
v_xor_b32 v11, 96, v8
s_add_u32 s24, s40, 0
s_and_b32 s24, s24, 7
s_lshl_b32 s30, s24, 12
s_add_u32 s24, s40, 1
s_and_b32 s24, s24, 7
s_lshl_b32 s31, s24, 12
s_add_u32 s24, s40, 2
s_and_b32 s24, s24, 7
s_lshl_b32 s32, s24, 12
s_add_u32 s24, s40, 3
s_and_b32 s24, s24, 7
s_lshl_b32 s33, s24, 12
s_add_u32 s24, s40, 4
s_and_b32 s24, s24, 7
s_lshl_b32 s34, s24, 12
s_add_u32 s24, s40, 5
s_and_b32 s24, s24, 7
s_lshl_b32 s35, s24, 12
s_add_u32 s24, s40, 6
s_and_b32 s24, s24, 7
s_lshl_b32 s36, s24, 12
s_add_u32 s24, s40, 7
s_and_b32 s24, s24, 7
s_lshl_b32 s37, s24, 12
s_mul_i32 s25, s30, 36
s_add_u32 m0, s26, 0
s_add_u32 s24, s25, 0
buffer_load_dwordx4 v2, s[20:23], s24 offen lds
s_add_u32 m0, s26, 1024
s_add_u32 s24, s25, 9216
buffer_load_dwordx4 v2, s[20:23], s24 offen lds
s_add_u32 m0, s26, 2048
s_add_u32 s24, s25, 18432
buffer_load_dwordx4 v2, s[20:23], s24 offen lds
s_add_u32 m0, s26, 3072
s_add_u32 s24, s25, 27648
buffer_load_dwordx4 v2, s[20:23], s24 offen lds
s_mul_i32 s25, s30, 36
s_add_u32 m0, s26, 4096
s_add_u32 s24, s25, 36864
buffer_load_dwordx4 v2, s[20:23], s24 offen lds
s_add_u32 m0, s26, 5120
s_add_u32 s24, s25, 46080
buffer_load_dwordx4 v2, s[20:23], s24 offen lds
s_add_u32 m0, s26, 6144
s_add_u32 s24, s25, 55296
buffer_load_dwordx4 v2, s[20:23], s24 offen lds
s_add_u32 m0, s26, 7168
s_add_u32 s24, s25, 64512
buffer_load_dwordx4 v2, s[20:23], s24 offen lds
s_mul_i32 s25, s30, 36
s_add_u32 m0, s26, 8192
s_add_u32 s24, s25, 73728
buffer_load_dwordx4 v2, s[20:23], s24 offen lds
s_add_u32 m0, s26, 9216
s_add_u32 s24, s25, 82944
buffer_load_dwordx4 v2, s[20:23], s24 offen lds
s_add_u32 m0, s26, 10240
s_add_u32 s24, s25, 92160
buffer_load_dwordx4 v2, s[20:23], s24 offen lds
s_add_u32 m0, s26, 11264
s_add_u32 s24, s25, 101376
buffer_load_dwordx4 v2, s[20:23], s24 offen lds
s_mul_i32 s25, s31, 36
s_add_u32 m0, s26, 12288
s_add_u32 s24, s25, 0
buffer_load_dwordx4 v2, s[20:23], s24 offen lds
s_add_u32 m0, s26, 13312
s_add_u32 s24, s25, 9216
buffer_load_dwordx4 v2, s[20:23], s24 offen lds
s_add_u32 m0, s26, 14336
s_add_u32 s24, s25, 18432
buffer_load_dwordx4 v2, s[20:23], s24 offen lds
s_add_u32 m0, s26, 15360
s_add_u32 s24, s25, 27648
buffer_load_dwordx4 v2, s[20:23], s24 offen lds
s_mul_i32 s25, s31, 36
s_add_u32 m0, s26, 16384
s_add_u32 s24, s25, 36864
buffer_load_dwordx4 v2, s[20:23], s24 offen lds
s_add_u32 m0, s26, 17408
s_add_u32 s24, s25, 46080
buffer_load_dwordx4 v2, s[20:23], s24 offen lds
s_add_u32 m0, s26, 18432
s_add_u32 s24, s25, 55296
buffer_load_dwordx4 v2, s[20:23], s24 offen lds
s_add_u32 m0, s26, 19456
s_add_u32 s24, s25, 64512
buffer_load_dwordx4 v2, s[20:23], s24 offen lds
s_mul_i32 s25, s31, 36
s_add_u32 m0, s26, 20480
s_add_u32 s24, s25, 73728
buffer_load_dwordx4 v2, s[20:23], s24 offen lds
s_add_u32 m0, s26, 21504
s_add_u32 s24, s25, 82944
buffer_load_dwordx4 v2, s[20:23], s24 offen lds
s_add_u32 m0, s26, 22528
s_add_u32 s24, s25, 92160
buffer_load_dwordx4 v2, s[20:23], s24 offen lds
s_add_u32 m0, s26, 23552
s_add_u32 s24, s25, 101376
buffer_load_dwordx4 v2, s[20:23], s24 offen lds
s_mul_i32 s25, s32, 36
s_add_u32 m0, s26, 24576
s_add_u32 s24, s25, 0
buffer_load_dwordx4 v2, s[20:23], s24 offen lds
s_add_u32 m0, s26, 25600
s_add_u32 s24, s25, 9216
buffer_load_dwordx4 v2, s[20:23], s24 offen lds
s_add_u32 m0, s26, 26624
s_add_u32 s24, s25, 18432
buffer_load_dwordx4 v2, s[20:23], s24 offen lds
s_add_u32 m0, s26, 27648
s_add_u32 s24, s25, 27648
buffer_load_dwordx4 v2, s[20:23], s24 offen lds
s_mul_i32 s25, s32, 36
s_add_u32 m0, s26, 28672
s_add_u32 s24, s25, 36864
buffer_load_dwordx4 v2, s[20:23], s24 offen lds
s_add_u32 m0, s26, 29696
s_add_u32 s24, s25, 46080
buffer_load_dwordx4 v2, s[20:23], s24 offen lds
s_add_u32 m0, s26, 30720
s_add_u32 s24, s25, 55296
buffer_load_dwordx4 v2, s[20:23], s24 offen lds
s_add_u32 m0, s26, 31744
s_add_u32 s24, s25, 64512
buffer_load_dwordx4 v2, s[20:23], s24 offen lds
s_waitcnt vmcnt(28)
ds_read_b64_tr_b16 v[128:129], v8 offset:0
ds_read_b64_tr_b16 v[130:131], v8 offset:1024
ds_read_b64_tr_b16 v[132:133], v9 offset:0
ds_read_b64_tr_b16 v[134:135], v9 offset:1024
ds_read_b64_tr_b16 v[136:137], v10 offset:0
ds_read_b64_tr_b16 v[138:139], v10 offset:1024
ds_read_b64_tr_b16 v[140:141], v11 offset:0
ds_read_b64_tr_b16 v[142:143], v11 offset:1024
s_waitcnt lgkmcnt(0)
s_mul_i32 s25, s32, 36
s_add_u32 m0, s26, 0
s_add_u32 s24, s25, 73728
buffer_load_dwordx4 v2, s[20:23], s24 offen lds
s_add_u32 m0, s26, 1024
s_add_u32 s24, s25, 82944
buffer_load_dwordx4 v2, s[20:23], s24 offen lds
s_add_u32 m0, s26, 2048
s_add_u32 s24, s25, 92160
buffer_load_dwordx4 v2, s[20:23], s24 offen lds
s_add_u32 m0, s26, 3072
s_add_u32 s24, s25, 101376
buffer_load_dwordx4 v2, s[20:23], s24 offen lds
s_waitcnt vmcnt(28)
ds_read_b64_tr_b16 v[144:145], v8 offset:4096
ds_read_b64_tr_b16 v[146:147], v8 offset:5120
ds_read_b64_tr_b16 v[148:149], v9 offset:4096
ds_read_b64_tr_b16 v[150:151], v9 offset:5120
ds_read_b64_tr_b16 v[152:153], v10 offset:4096
ds_read_b64_tr_b16 v[154:155], v10 offset:5120
ds_read_b64_tr_b16 v[156:157], v11 offset:4096
ds_read_b64_tr_b16 v[158:159], v11 offset:5120
s_waitcnt lgkmcnt(0)
s_mul_i32 s25, s33, 36
s_add_u32 m0, s26, 4096
s_add_u32 s24, s25, 0
buffer_load_dwordx4 v2, s[20:23], s24 offen lds
s_add_u32 m0, s26, 5120
s_add_u32 s24, s25, 9216
buffer_load_dwordx4 v2, s[20:23], s24 offen lds
s_add_u32 m0, s26, 6144
s_add_u32 s24, s25, 18432
buffer_load_dwordx4 v2, s[20:23], s24 offen lds
s_add_u32 m0, s26, 7168
s_add_u32 s24, s25, 27648
buffer_load_dwordx4 v2, s[20:23], s24 offen lds
s_waitcnt vmcnt(28)
ds_read_b64_tr_b16 v[160:161], v8 offset:8192
ds_read_b64_tr_b16 v[162:163], v8 offset:9216
ds_read_b64_tr_b16 v[164:165], v9 offset:8192
ds_read_b64_tr_b16 v[166:167], v9 offset:9216
ds_read_b64_tr_b16 v[168:169], v10 offset:8192
ds_read_b64_tr_b16 v[170:171], v10 offset:9216
ds_read_b64_tr_b16 v[172:173], v11 offset:8192
ds_read_b64_tr_b16 v[174:175], v11 offset:9216
s_waitcnt lgkmcnt(0)
s_mul_i32 s25, s33, 36
s_add_u32 m0, s26, 8192
s_add_u32 s24, s25, 36864
buffer_load_dwordx4 v2, s[20:23], s24 offen lds
s_add_u32 m0, s26, 9216
s_add_u32 s24, s25, 46080
buffer_load_dwordx4 v2, s[20:23], s24 offen lds
s_add_u32 m0, s26, 10240
s_add_u32 s24, s25, 55296
buffer_load_dwordx4 v2, s[20:23], s24 offen lds
s_add_u32 m0, s26, 11264
s_add_u32 s24, s25, 64512
buffer_load_dwordx4 v2, s[20:23], s24 offen lds
s_waitcnt vmcnt(28)
ds_read_b64_tr_b16 v[176:177], v8 offset:12288
ds_read_b64_tr_b16 v[178:179], v8 offset:13312
ds_read_b64_tr_b16 v[180:181], v9 offset:12288
ds_read_b64_tr_b16 v[182:183], v9 offset:13312
ds_read_b64_tr_b16 v[184:185], v10 offset:12288
ds_read_b64_tr_b16 v[186:187], v10 offset:13312
ds_read_b64_tr_b16 v[188:189], v11 offset:12288
ds_read_b64_tr_b16 v[190:191], v11 offset:13312
s_waitcnt lgkmcnt(0)
s_mul_i32 s25, s33, 36
s_add_u32 m0, s26, 12288
s_add_u32 s24, s25, 73728
buffer_load_dwordx4 v2, s[20:23], s24 offen lds
s_add_u32 m0, s26, 13312
s_add_u32 s24, s25, 82944
buffer_load_dwordx4 v2, s[20:23], s24 offen lds
s_add_u32 m0, s26, 14336
s_add_u32 s24, s25, 92160
buffer_load_dwordx4 v2, s[20:23], s24 offen lds
s_add_u32 m0, s26, 15360
s_add_u32 s24, s25, 101376
buffer_load_dwordx4 v2, s[20:23], s24 offen lds
s_waitcnt vmcnt(28)
ds_read_b64_tr_b16 v[192:193], v8 offset:16384
ds_read_b64_tr_b16 v[194:195], v8 offset:17408
ds_read_b64_tr_b16 v[196:197], v9 offset:16384
ds_read_b64_tr_b16 v[198:199], v9 offset:17408
ds_read_b64_tr_b16 v[200:201], v10 offset:16384
ds_read_b64_tr_b16 v[202:203], v10 offset:17408
ds_read_b64_tr_b16 v[204:205], v11 offset:16384
ds_read_b64_tr_b16 v[206:207], v11 offset:17408
s_waitcnt lgkmcnt(0)
s_mul_i32 s25, s34, 36
s_add_u32 m0, s26, 16384
s_add_u32 s24, s25, 0
buffer_load_dwordx4 v2, s[20:23], s24 offen lds
s_add_u32 m0, s26, 17408
s_add_u32 s24, s25, 9216
buffer_load_dwordx4 v2, s[20:23], s24 offen lds
s_add_u32 m0, s26, 18432
s_add_u32 s24, s25, 18432
buffer_load_dwordx4 v2, s[20:23], s24 offen lds
s_add_u32 m0, s26, 19456
s_add_u32 s24, s25, 27648
buffer_load_dwordx4 v2, s[20:23], s24 offen lds
s_waitcnt vmcnt(28)
ds_read_b64_tr_b16 v[208:209], v8 offset:20480
ds_read_b64_tr_b16 v[210:211], v8 offset:21504
ds_read_b64_tr_b16 v[212:213], v9 offset:20480
ds_read_b64_tr_b16 v[214:215], v9 offset:21504
ds_read_b64_tr_b16 v[216:217], v10 offset:20480
ds_read_b64_tr_b16 v[218:219], v10 offset:21504
ds_read_b64_tr_b16 v[220:221], v11 offset:20480
ds_read_b64_tr_b16 v[222:223], v11 offset:21504
s_waitcnt lgkmcnt(0)
s_mul_i32 s25, s34, 36
s_add_u32 m0, s26, 20480
s_add_u32 s24, s25, 36864
buffer_load_dwordx4 v2, s[20:23], s24 offen lds
s_add_u32 m0, s26, 21504
s_add_u32 s24, s25, 46080
buffer_load_dwordx4 v2, s[20:23], s24 offen lds
s_add_u32 m0, s26, 22528
s_add_u32 s24, s25, 55296
buffer_load_dwordx4 v2, s[20:23], s24 offen lds
s_add_u32 m0, s26, 23552
s_add_u32 s24, s25, 64512
buffer_load_dwordx4 v2, s[20:23], s24 offen lds
s_waitcnt vmcnt(28)
ds_read_b64_tr_b16 v[224:225], v8 offset:24576
ds_read_b64_tr_b16 v[226:227], v8 offset:25600
ds_read_b64_tr_b16 v[228:229], v9 offset:24576
ds_read_b64_tr_b16 v[230:231], v9 offset:25600
ds_read_b64_tr_b16 v[232:233], v10 offset:24576
ds_read_b64_tr_b16 v[234:235], v10 offset:25600
ds_read_b64_tr_b16 v[236:237], v11 offset:24576
ds_read_b64_tr_b16 v[238:239], v11 offset:25600
s_waitcnt lgkmcnt(0)
s_mul_i32 s25, s34, 36
s_add_u32 m0, s26, 24576
s_add_u32 s24, s25, 73728
buffer_load_dwordx4 v2, s[20:23], s24 offen lds
s_add_u32 m0, s26, 25600
s_add_u32 s24, s25, 82944
buffer_load_dwordx4 v2, s[20:23], s24 offen lds
s_add_u32 m0, s26, 26624
s_add_u32 s24, s25, 92160
buffer_load_dwordx4 v2, s[20:23], s24 offen lds
s_add_u32 m0, s26, 27648
s_add_u32 s24, s25, 101376
buffer_load_dwordx4 v2, s[20:23], s24 offen lds
s_waitcnt vmcnt(28)
ds_read_b64_tr_b16 v[240:241], v8 offset:28672
ds_read_b64_tr_b16 v[242:243], v8 offset:29696
ds_read_b64_tr_b16 v[244:245], v9 offset:28672
ds_read_b64_tr_b16 v[246:247], v9 offset:29696
ds_read_b64_tr_b16 v[248:249], v10 offset:28672
ds_read_b64_tr_b16 v[250:251], v10 offset:29696
ds_read_b64_tr_b16 v[252:253], v11 offset:28672
ds_read_b64_tr_b16 v[254:255], v11 offset:29696
s_waitcnt lgkmcnt(0)
s_mul_i32 s25, s35, 36
s_add_u32 m0, s26, 28672
s_add_u32 s24, s25, 0
buffer_load_dwordx4 v2, s[20:23], s24 offen lds
s_add_u32 m0, s26, 29696
s_add_u32 s24, s25, 9216
buffer_load_dwordx4 v2, s[20:23], s24 offen lds
s_add_u32 m0, s26, 30720
s_add_u32 s24, s25, 18432
buffer_load_dwordx4 v2, s[20:23], s24 offen lds
s_add_u32 m0, s26, 31744
s_add_u32 s24, s25, 27648
buffer_load_dwordx4 v2, s[20:23], s24 offen lds
s_waitcnt vmcnt(28)
ds_read_b64_tr_b16 a[0:1], v8 offset:0
ds_read_b64_tr_b16 a[2:3], v8 offset:1024
ds_read_b64_tr_b16 a[4:5], v9 offset:0
ds_read_b64_tr_b16 a[6:7], v9 offset:1024
ds_read_b64_tr_b16 a[8:9], v10 offset:0
ds_read_b64_tr_b16 a[10:11], v10 offset:1024
ds_read_b64_tr_b16 a[12:13], v11 offset:0
ds_read_b64_tr_b16 a[14:15], v11 offset:1024
s_waitcnt lgkmcnt(0)
s_mul_i32 s25, s35, 36
s_add_u32 m0, s26, 0
s_add_u32 s24, s25, 36864
buffer_load_dwordx4 v2, s[20:23], s24 offen lds
s_add_u32 m0, s26, 1024
s_add_u32 s24, s25, 46080
buffer_load_dwordx4 v2, s[20:23], s24 offen lds
s_add_u32 m0, s26, 2048
s_add_u32 s24, s25, 55296
buffer_load_dwordx4 v2, s[20:23], s24 offen lds
s_add_u32 m0, s26, 3072
s_add_u32 s24, s25, 64512
buffer_load_dwordx4 v2, s[20:23], s24 offen lds
s_waitcnt vmcnt(28)
ds_read_b64_tr_b16 a[16:17], v8 offset:4096
ds_read_b64_tr_b16 a[18:19], v8 offset:5120
ds_read_b64_tr_b16 a[20:21], v9 offset:4096
ds_read_b64_tr_b16 a[22:23], v9 offset:5120
ds_read_b64_tr_b16 a[24:25], v10 offset:4096
ds_read_b64_tr_b16 a[26:27], v10 offset:5120
ds_read_b64_tr_b16 a[28:29], v11 offset:4096
ds_read_b64_tr_b16 a[30:31], v11 offset:5120
s_waitcnt lgkmcnt(0)
s_mul_i32 s25, s35, 36
s_add_u32 m0, s26, 4096
s_add_u32 s24, s25, 73728
buffer_load_dwordx4 v2, s[20:23], s24 offen lds
s_add_u32 m0, s26, 5120
s_add_u32 s24, s25, 82944
buffer_load_dwordx4 v2, s[20:23], s24 offen lds
s_add_u32 m0, s26, 6144
s_add_u32 s24, s25, 92160
buffer_load_dwordx4 v2, s[20:23], s24 offen lds
s_add_u32 m0, s26, 7168
s_add_u32 s24, s25, 101376
buffer_load_dwordx4 v2, s[20:23], s24 offen lds
s_waitcnt vmcnt(28)
ds_read_b64_tr_b16 a[32:33], v8 offset:8192
ds_read_b64_tr_b16 a[34:35], v8 offset:9216
ds_read_b64_tr_b16 a[36:37], v9 offset:8192
ds_read_b64_tr_b16 a[38:39], v9 offset:9216
ds_read_b64_tr_b16 a[40:41], v10 offset:8192
ds_read_b64_tr_b16 a[42:43], v10 offset:9216
ds_read_b64_tr_b16 a[44:45], v11 offset:8192
ds_read_b64_tr_b16 a[46:47], v11 offset:9216
s_waitcnt lgkmcnt(0)
s_mul_i32 s25, s36, 36
s_add_u32 m0, s26, 8192
s_add_u32 s24, s25, 0
buffer_load_dwordx4 v2, s[20:23], s24 offen lds
s_add_u32 m0, s26, 9216
s_add_u32 s24, s25, 9216
buffer_load_dwordx4 v2, s[20:23], s24 offen lds
s_add_u32 m0, s26, 10240
s_add_u32 s24, s25, 18432
buffer_load_dwordx4 v2, s[20:23], s24 offen lds
s_add_u32 m0, s26, 11264
s_add_u32 s24, s25, 27648
buffer_load_dwordx4 v2, s[20:23], s24 offen lds
s_waitcnt vmcnt(28)
ds_read_b64_tr_b16 a[48:49], v8 offset:12288
ds_read_b64_tr_b16 a[50:51], v8 offset:13312
ds_read_b64_tr_b16 a[52:53], v9 offset:12288
ds_read_b64_tr_b16 a[54:55], v9 offset:13312
ds_read_b64_tr_b16 a[56:57], v10 offset:12288
ds_read_b64_tr_b16 a[58:59], v10 offset:13312
ds_read_b64_tr_b16 a[60:61], v11 offset:12288
ds_read_b64_tr_b16 a[62:63], v11 offset:13312
s_waitcnt lgkmcnt(0)
s_mul_i32 s25, s36, 36
s_add_u32 m0, s26, 12288
s_add_u32 s24, s25, 36864
buffer_load_dwordx4 v2, s[20:23], s24 offen lds
s_add_u32 m0, s26, 13312
s_add_u32 s24, s25, 46080
buffer_load_dwordx4 v2, s[20:23], s24 offen lds
s_add_u32 m0, s26, 14336
s_add_u32 s24, s25, 55296
buffer_load_dwordx4 v2, s[20:23], s24 offen lds
s_add_u32 m0, s26, 15360
s_add_u32 s24, s25, 64512
buffer_load_dwordx4 v2, s[20:23], s24 offen lds
s_waitcnt vmcnt(28)
ds_read_b64_tr_b16 a[64:65], v8 offset:16384
ds_read_b64_tr_b16 a[66:67], v8 offset:17408
ds_read_b64_tr_b16 a[68:69], v9 offset:16384
ds_read_b64_tr_b16 a[70:71], v9 offset:17408
ds_read_b64_tr_b16 a[72:73], v10 offset:16384
ds_read_b64_tr_b16 a[74:75], v10 offset:17408
ds_read_b64_tr_b16 a[76:77], v11 offset:16384
ds_read_b64_tr_b16 a[78:79], v11 offset:17408
s_waitcnt lgkmcnt(0)
s_mul_i32 s25, s36, 36
s_add_u32 m0, s26, 16384
s_add_u32 s24, s25, 73728
buffer_load_dwordx4 v2, s[20:23], s24 offen lds
s_add_u32 m0, s26, 17408
s_add_u32 s24, s25, 82944
buffer_load_dwordx4 v2, s[20:23], s24 offen lds
s_add_u32 m0, s26, 18432
s_add_u32 s24, s25, 92160
buffer_load_dwordx4 v2, s[20:23], s24 offen lds
s_add_u32 m0, s26, 19456
s_add_u32 s24, s25, 101376
buffer_load_dwordx4 v2, s[20:23], s24 offen lds
s_waitcnt vmcnt(28)
ds_read_b64_tr_b16 a[80:81], v8 offset:20480
ds_read_b64_tr_b16 a[82:83], v8 offset:21504
ds_read_b64_tr_b16 a[84:85], v9 offset:20480
ds_read_b64_tr_b16 a[86:87], v9 offset:21504
ds_read_b64_tr_b16 a[88:89], v10 offset:20480
ds_read_b64_tr_b16 a[90:91], v10 offset:21504
ds_read_b64_tr_b16 a[92:93], v11 offset:20480
ds_read_b64_tr_b16 a[94:95], v11 offset:21504
s_waitcnt lgkmcnt(0)
s_mul_i32 s25, s37, 36
s_add_u32 m0, s26, 20480
s_add_u32 s24, s25, 0
buffer_load_dwordx4 v2, s[20:23], s24 offen lds
s_add_u32 m0, s26, 21504
s_add_u32 s24, s25, 9216
buffer_load_dwordx4 v2, s[20:23], s24 offen lds
s_add_u32 m0, s26, 22528
s_add_u32 s24, s25, 18432
buffer_load_dwordx4 v2, s[20:23], s24 offen lds
s_add_u32 m0, s26, 23552
s_add_u32 s24, s25, 27648
buffer_load_dwordx4 v2, s[20:23], s24 offen lds
s_waitcnt vmcnt(28)
ds_read_b64_tr_b16 a[96:97], v8 offset:24576
ds_read_b64_tr_b16 a[98:99], v8 offset:25600
ds_read_b64_tr_b16 a[100:101], v9 offset:24576
ds_read_b64_tr_b16 a[102:103], v9 offset:25600
ds_read_b64_tr_b16 a[104:105], v10 offset:24576
ds_read_b64_tr_b16 a[106:107], v10 offset:25600
ds_read_b64_tr_b16 a[108:109], v11 offset:24576
ds_read_b64_tr_b16 a[110:111], v11 offset:25600
s_waitcnt lgkmcnt(0)
s_mul_i32 s25, s37, 36
s_add_u32 m0, s26, 24576
s_add_u32 s24, s25, 36864
buffer_load_dwordx4 v2, s[20:23], s24 offen lds
s_add_u32 m0, s26, 25600
s_add_u32 s24, s25, 46080
buffer_load_dwordx4 v2, s[20:23], s24 offen lds
s_add_u32 m0, s26, 26624
s_add_u32 s24, s25, 55296
buffer_load_dwordx4 v2, s[20:23], s24 offen lds
s_add_u32 m0, s26, 27648
s_add_u32 s24, s25, 64512
buffer_load_dwordx4 v2, s[20:23], s24 offen lds
s_waitcnt vmcnt(28)
ds_read_b64_tr_b16 a[112:113], v8 offset:28672
ds_read_b64_tr_b16 a[114:115], v8 offset:29696
ds_read_b64_tr_b16 a[116:117], v9 offset:28672
ds_read_b64_tr_b16 a[118:119], v9 offset:29696
ds_read_b64_tr_b16 a[120:121], v10 offset:28672
ds_read_b64_tr_b16 a[122:123], v10 offset:29696
ds_read_b64_tr_b16 a[124:125], v11 offset:28672
ds_read_b64_tr_b16 a[126:127], v11 offset:29696
s_waitcnt lgkmcnt(0)
s_mul_i32 s25, s37, 36
s_add_u32 m0, s26, 28672
s_add_u32 s24, s25, 73728
buffer_load_dwordx4 v2, s[20:23], s24 offen lds
s_add_u32 m0, s26, 29696
s_add_u32 s24, s25, 82944
buffer_load_dwordx4 v2, s[20:23], s24 offen lds
s_add_u32 m0, s26, 30720
s_add_u32 s24, s25, 92160
buffer_load_dwordx4 v2, s[20:23], s24 offen lds
s_add_u32 m0, s26, 31744
s_add_u32 s24, s25, 101376
buffer_load_dwordx4 v2, s[20:23], s24 offen lds
s_waitcnt vmcnt(28)
ds_read_b64_tr_b16 a[128:129], v8 offset:0
ds_read_b64_tr_b16 a[130:131], v8 offset:1024
ds_read_b64_tr_b16 a[132:133], v9 offset:0
ds_read_b64_tr_b16 a[134:135], v9 offset:1024
ds_read_b64_tr_b16 a[136:137], v10 offset:0
ds_read_b64_tr_b16 a[138:139], v10 offset:1024
ds_read_b64_tr_b16 a[140:141], v11 offset:0
ds_read_b64_tr_b16 a[142:143], v11 offset:1024
s_waitcnt lgkmcnt(0)
s_mul_i32 s25, s30, 36
s_add_u32 m0, s26, 0
s_add_u32 s24, s25, 110592
buffer_load_dwordx4 v2, s[20:23], s24 offen lds
s_add_u32 m0, s26, 1024
s_add_u32 s24, s25, 119808
buffer_load_dwordx4 v2, s[20:23], s24 offen lds
s_add_u32 m0, s26, 2048
s_add_u32 s24, s25, 129024
buffer_load_dwordx4 v2, s[20:23], s24 offen lds
s_add_u32 m0, s26, 3072
s_add_u32 s24, s25, 138240
buffer_load_dwordx4 v2, s[20:23], s24 offen lds
s_waitcnt vmcnt(28)
ds_read_b64_tr_b16 a[144:145], v8 offset:4096
ds_read_b64_tr_b16 a[146:147], v8 offset:5120
ds_read_b64_tr_b16 a[148:149], v9 offset:4096
ds_read_b64_tr_b16 a[150:151], v9 offset:5120
ds_read_b64_tr_b16 a[152:153], v10 offset:4096
ds_read_b64_tr_b16 a[154:155], v10 offset:5120
ds_read_b64_tr_b16 a[156:157], v11 offset:4096
ds_read_b64_tr_b16 a[158:159], v11 offset:5120
s_waitcnt lgkmcnt(0)
s_mul_i32 s25, s31, 36
s_add_u32 m0, s26, 4096
s_add_u32 s24, s25, 110592
buffer_load_dwordx4 v2, s[20:23], s24 offen lds
s_add_u32 m0, s26, 5120
s_add_u32 s24, s25, 119808
buffer_load_dwordx4 v2, s[20:23], s24 offen lds
s_add_u32 m0, s26, 6144
s_add_u32 s24, s25, 129024
buffer_load_dwordx4 v2, s[20:23], s24 offen lds
s_add_u32 m0, s26, 7168
s_add_u32 s24, s25, 138240
buffer_load_dwordx4 v2, s[20:23], s24 offen lds
s_waitcnt vmcnt(28)
ds_read_b64_tr_b16 a[160:161], v8 offset:8192
ds_read_b64_tr_b16 a[162:163], v8 offset:9216
ds_read_b64_tr_b16 a[164:165], v9 offset:8192
ds_read_b64_tr_b16 a[166:167], v9 offset:9216
ds_read_b64_tr_b16 a[168:169], v10 offset:8192
ds_read_b64_tr_b16 a[170:171], v10 offset:9216
ds_read_b64_tr_b16 a[172:173], v11 offset:8192
ds_read_b64_tr_b16 a[174:175], v11 offset:9216
s_waitcnt lgkmcnt(0)
s_mul_i32 s25, s32, 36
s_add_u32 m0, s26, 8192
s_add_u32 s24, s25, 110592
buffer_load_dwordx4 v2, s[20:23], s24 offen lds
s_add_u32 m0, s26, 9216
s_add_u32 s24, s25, 119808
buffer_load_dwordx4 v2, s[20:23], s24 offen lds
s_add_u32 m0, s26, 10240
s_add_u32 s24, s25, 129024
buffer_load_dwordx4 v2, s[20:23], s24 offen lds
s_add_u32 m0, s26, 11264
s_add_u32 s24, s25, 138240
buffer_load_dwordx4 v2, s[20:23], s24 offen lds
s_waitcnt vmcnt(28)
ds_read_b64_tr_b16 a[176:177], v8 offset:12288
ds_read_b64_tr_b16 a[178:179], v8 offset:13312
ds_read_b64_tr_b16 a[180:181], v9 offset:12288
ds_read_b64_tr_b16 a[182:183], v9 offset:13312
ds_read_b64_tr_b16 a[184:185], v10 offset:12288
ds_read_b64_tr_b16 a[186:187], v10 offset:13312
ds_read_b64_tr_b16 a[188:189], v11 offset:12288
ds_read_b64_tr_b16 a[190:191], v11 offset:13312
s_waitcnt lgkmcnt(0)
s_mul_i32 s25, s33, 36
s_add_u32 m0, s26, 12288
s_add_u32 s24, s25, 110592
buffer_load_dwordx4 v2, s[20:23], s24 offen lds
s_add_u32 m0, s26, 13312
s_add_u32 s24, s25, 119808
buffer_load_dwordx4 v2, s[20:23], s24 offen lds
s_add_u32 m0, s26, 14336
s_add_u32 s24, s25, 129024
buffer_load_dwordx4 v2, s[20:23], s24 offen lds
s_add_u32 m0, s26, 15360
s_add_u32 s24, s25, 138240
buffer_load_dwordx4 v2, s[20:23], s24 offen lds
s_waitcnt vmcnt(28)
ds_read_b64_tr_b16 a[192:193], v8 offset:16384
ds_read_b64_tr_b16 a[194:195], v8 offset:17408
ds_read_b64_tr_b16 a[196:197], v9 offset:16384
ds_read_b64_tr_b16 a[198:199], v9 offset:17408
ds_read_b64_tr_b16 a[200:201], v10 offset:16384
ds_read_b64_tr_b16 a[202:203], v10 offset:17408
ds_read_b64_tr_b16 a[204:205], v11 offset:16384
ds_read_b64_tr_b16 a[206:207], v11 offset:17408
s_waitcnt lgkmcnt(0)
s_mul_i32 s25, s34, 36
s_add_u32 m0, s26, 16384
s_add_u32 s24, s25, 110592
buffer_load_dwordx4 v2, s[20:23], s24 offen lds
s_add_u32 m0, s26, 17408
s_add_u32 s24, s25, 119808
buffer_load_dwordx4 v2, s[20:23], s24 offen lds
s_add_u32 m0, s26, 18432
s_add_u32 s24, s25, 129024
buffer_load_dwordx4 v2, s[20:23], s24 offen lds
s_add_u32 m0, s26, 19456
s_add_u32 s24, s25, 138240
buffer_load_dwordx4 v2, s[20:23], s24 offen lds
s_waitcnt vmcnt(28)
ds_read_b64_tr_b16 a[208:209], v8 offset:20480
ds_read_b64_tr_b16 a[210:211], v8 offset:21504
ds_read_b64_tr_b16 a[212:213], v9 offset:20480
ds_read_b64_tr_b16 a[214:215], v9 offset:21504
ds_read_b64_tr_b16 a[216:217], v10 offset:20480
ds_read_b64_tr_b16 a[218:219], v10 offset:21504
ds_read_b64_tr_b16 a[220:221], v11 offset:20480
ds_read_b64_tr_b16 a[222:223], v11 offset:21504
s_waitcnt lgkmcnt(0)
s_mul_i32 s25, s35, 36
s_add_u32 m0, s26, 20480
s_add_u32 s24, s25, 110592
buffer_load_dwordx4 v2, s[20:23], s24 offen lds
s_add_u32 m0, s26, 21504
s_add_u32 s24, s25, 119808
buffer_load_dwordx4 v2, s[20:23], s24 offen lds
s_add_u32 m0, s26, 22528
s_add_u32 s24, s25, 129024
buffer_load_dwordx4 v2, s[20:23], s24 offen lds
s_add_u32 m0, s26, 23552
s_add_u32 s24, s25, 138240
buffer_load_dwordx4 v2, s[20:23], s24 offen lds
s_waitcnt vmcnt(28)
ds_read_b64_tr_b16 a[224:225], v8 offset:24576
ds_read_b64_tr_b16 a[226:227], v8 offset:25600
ds_read_b64_tr_b16 a[228:229], v9 offset:24576
ds_read_b64_tr_b16 a[230:231], v9 offset:25600
ds_read_b64_tr_b16 a[232:233], v10 offset:24576
ds_read_b64_tr_b16 a[234:235], v10 offset:25600
ds_read_b64_tr_b16 a[236:237], v11 offset:24576
ds_read_b64_tr_b16 a[238:239], v11 offset:25600
s_waitcnt lgkmcnt(0)
s_mul_i32 s25, s36, 36
s_add_u32 m0, s26, 24576
s_add_u32 s24, s25, 110592
buffer_load_dwordx4 v2, s[20:23], s24 offen lds
s_add_u32 m0, s26, 25600
s_add_u32 s24, s25, 119808
buffer_load_dwordx4 v2, s[20:23], s24 offen lds
s_add_u32 m0, s26, 26624
s_add_u32 s24, s25, 129024
buffer_load_dwordx4 v2, s[20:23], s24 offen lds
s_add_u32 m0, s26, 27648
s_add_u32 s24, s25, 138240
buffer_load_dwordx4 v2, s[20:23], s24 offen lds
s_waitcnt vmcnt(28)
ds_read_b64_tr_b16 a[240:241], v8 offset:28672
ds_read_b64_tr_b16 a[242:243], v8 offset:29696
ds_read_b64_tr_b16 a[244:245], v9 offset:28672
ds_read_b64_tr_b16 a[246:247], v9 offset:29696
ds_read_b64_tr_b16 a[248:249], v10 offset:28672
ds_read_b64_tr_b16 a[250:251], v10 offset:29696
ds_read_b64_tr_b16 a[252:253], v11 offset:28672
ds_read_b64_tr_b16 a[254:255], v11 offset:29696
s_waitcnt lgkmcnt(0)
s_mul_i32 s25, s37, 36
s_add_u32 m0, s26, 28672
s_add_u32 s24, s25, 110592
buffer_load_dwordx4 v2, s[20:23], s24 offen lds
s_add_u32 m0, s26, 29696
s_add_u32 s24, s25, 119808
buffer_load_dwordx4 v2, s[20:23], s24 offen lds
s_add_u32 m0, s26, 30720
s_add_u32 s24, s25, 129024
buffer_load_dwordx4 v2, s[20:23], s24 offen lds
s_add_u32 m0, s26, 31744
s_add_u32 s24, s25, 138240
buffer_load_dwordx4 v2, s[20:23], s24 offen lds
s_waitcnt vmcnt(0)
v_and_b32 v12, 15, v0
v_mul_u32_u24 v12, 2304, v12
v_lshrrev_b32 v13, 4, v0
v_lshl_add_u32 v12, v13, 3, v12
s_lshl_b32 s24, s40, 7
s_add_u32 s24, s24, s47
v_add_u32 v4, s24, v12
v_and_b32 v5, 31, v0
v_lshlrev_b32 v5, 2, v5
v_lshlrev_b32 v3, 4, v0
v_add_u32 v3, 131072, v3
s_lshl_b32 s24, s17, 12
s_add_u32 s24, s24, 131072
v_add_u32 v7, s24, v1
s_lshl_b32 s24, s17, 15
s_add_u32 s44, s44, s24
ds_read_b64_tr_b16 v[112:113], v8 offset:0
ds_read_b64_tr_b16 v[114:115], v8 offset:1024
ds_read_b64_tr_b16 v[116:117], v9 offset:0
ds_read_b64_tr_b16 v[118:119], v9 offset:1024
ds_read_b64_tr_b16 v[120:121], v10 offset:0
ds_read_b64_tr_b16 v[122:123], v10 offset:1024
ds_read_b64_tr_b16 v[124:125], v11 offset:0
ds_read_b64_tr_b16 v[126:127], v11 offset:1024
L_opl_w:
s_lshr_b32 s25, s41, s46
s_lshl_b32 s25, s25, 7
s_add_u32 s25, s25, s45
s_mov_b32 s28, 0
L_poll_36:
buffer_load_dword v6, v5, s[8:11], s25 offen sc1
s_add_u32 s28, s28, 1
s_cmp_gt_u32 s28, 40000
s_cbranch_scc1 L_end
s_waitcnt vmcnt(0)
v_cmp_ne_u32 vcc, 1, v6
s_cbranch_vccz L_pd_37
s_sleep 1
s_branch L_poll_36
L_pd_37:
s_lshl_b32 s48, s41, 17
s_add_u32 s48, s48, s44
s_add_u32 s24, s48, s30
buffer_load_dwordx4 v[16:19], v1, s[8:11], s24 offen offset:0 sc1
buffer_load_dwordx4 v[20:23], v1, s[8:11], s24 offen offset:1024 sc1
buffer_load_dwordx4 v[24:27], v1, s[8:11], s24 offen offset:2048 sc1
buffer_load_dwordx4 v[28:31], v1, s[8:11], s24 offen offset:3072 sc1
s_add_u32 s24, s48, s31
buffer_load_dwordx4 v[32:35], v1, s[8:11], s24 offen offset:0 sc1
buffer_load_dwordx4 v[36:39], v1, s[8:11], s24 offen offset:1024 sc1
buffer_load_dwordx4 v[40:43], v1, s[8:11], s24 offen offset:2048 sc1
buffer_load_dwordx4 v[44:47], v1, s[8:11], s24 offen offset:3072 sc1
s_add_u32 s24, s48, s32
buffer_load_dwordx4 v[48:51], v1, s[8:11], s24 offen offset:0 sc1
buffer_load_dwordx4 v[52:55], v1, s[8:11], s24 offen offset:1024 sc1
buffer_load_dwordx4 v[56:59], v1, s[8:11], s24 offen offset:2048 sc1
buffer_load_dwordx4 v[60:63], v1, s[8:11], s24 offen offset:3072 sc1
s_add_u32 s24, s48, s33
buffer_load_dwordx4 v[64:67], v1, s[8:11], s24 offen offset:0 sc1
buffer_load_dwordx4 v[68:71], v1, s[8:11], s24 offen offset:1024 sc1
buffer_load_dwordx4 v[72:75], v1, s[8:11], s24 offen offset:2048 sc1
buffer_load_dwordx4 v[76:79], v1, s[8:11], s24 offen offset:3072 sc1
s_add_u32 s24, s48, s34
buffer_load_dwordx4 v[80:83], v1, s[8:11], s24 offen offset:0 sc1
buffer_load_dwordx4 v[84:87], v1, s[8:11], s24 offen offset:1024 sc1
buffer_load_dwordx4 v[88:91], v1, s[8:11], s24 offen offset:2048 sc1
buffer_load_dwordx4 v[92:95], v1, s[8:11], s24 offen offset:3072 sc1
buffer_load_dword v6, v5, s[8:11], s25 offen sc1
L_opl_r0:
s_add_u32 s27, s41, s43
s_and_b32 s27, s27, 127
s_lshr_b32 s25, s27, s46
s_lshl_b32 s25, s25, 7
s_add_u32 s25, s25, s45
buffer_load_dword v6, v5, s[8:11], s25 offen sc1
s_lshl_b32 s49, s27, 17
s_add_u32 s49, s49, s44
s_waitcnt vmcnt(21)
v_mfma_f32_16x16x32_bf16 v[96:99], v[128:131], v[16:19], 0
v_mfma_f32_16x16x32_bf16 v[100:103], v[132:135], v[16:19], 0
v_mfma_f32_16x16x32_bf16 v[104:107], v[136:139], v[16:19], 0
v_mfma_f32_16x16x32_bf16 v[108:111], v[140:143], v[16:19], 0
s_add_u32 s24, s48, s35
buffer_load_dwordx4 v[16:19], v1, s[8:11], s24 offen offset:0 sc1
s_waitcnt vmcnt(21)
v_mfma_f32_16x16x32_bf16 v[96:99], v[144:147], v[20:23], v[96:99]
v_mfma_f32_16x16x32_bf16 v[100:103], v[148:151], v[20:23], v[100:103]
v_mfma_f32_16x16x32_bf16 v[104:107], v[152:155], v[20:23], v[104:107]
v_mfma_f32_16x16x32_bf16 v[108:111], v[156:159], v[20:23], v[108:111]
buffer_load_dwordx4 v[20:23], v1, s[8:11], s24 offen offset:1024 sc1
s_waitcnt vmcnt(21)
v_mfma_f32_16x16x32_bf16 v[96:99], v[160:163], v[24:27], v[96:99]
v_mfma_f32_16x16x32_bf16 v[100:103], v[164:167], v[24:27], v[100:103]
v_mfma_f32_16x16x32_bf16 v[104:107], v[168:171], v[24:27], v[104:107]
v_mfma_f32_16x16x32_bf16 v[108:111], v[172:175], v[24:27], v[108:111]
buffer_load_dwordx4 v[24:27], v1, s[8:11], s24 offen offset:2048 sc1
s_waitcnt vmcnt(21) lgkmcnt(0)
v_mfma_f32_16x16x32_bf16 v[96:99], v[112:115], v[28:31], v[96:99]
v_mfma_f32_16x16x32_bf16 v[100:103], v[116:119], v[28:31], v[100:103]
v_mfma_f32_16x16x32_bf16 v[104:107], v[120:123], v[28:31], v[104:107]
v_mfma_f32_16x16x32_bf16 v[108:111], v[124:127], v[28:31], v[108:111]
buffer_load_dwordx4 v[28:31], v1, s[8:11], s24 offen offset:3072 sc1
s_waitcnt vmcnt(21)
v_mfma_f32_16x16x32_bf16 v[96:99], v[176:179], v[32:35], v[96:99]
ds_read_b64_tr_b16 v[112:113], v8 offset:4096
v_mfma_f32_16x16x32_bf16 v[100:103], v[180:183], v[32:35], v[100:103]
ds_read_b64_tr_b16 v[114:115], v8 offset:5120
v_mfma_f32_16x16x32_bf16 v[104:107], v[184:187], v[32:35], v[104:107]
ds_read_b64_tr_b16 v[116:117], v9 offset:4096
v_mfma_f32_16x16x32_bf16 v[108:111], v[188:191], v[32:35], v[108:111]
ds_read_b64_tr_b16 v[118:119], v9 offset:5120
s_add_u32 s24, s48, s36
buffer_load_dwordx4 v[32:35], v1, s[8:11], s24 offen offset:0 sc1
s_waitcnt vmcnt(21)
v_mfma_f32_16x16x32_bf16 v[96:99], v[192:195], v[36:39], v[96:99]
ds_read_b64_tr_b16 v[120:121], v10 offset:4096
v_mfma_f32_16x16x32_bf16 v[100:103], v[196:199], v[36:39], v[100:103]
ds_read_b64_tr_b16 v[122:123], v10 offset:5120
v_mfma_f32_16x16x32_bf16 v[104:107], v[200:203], v[36:39], v[104:107]
ds_read_b64_tr_b16 v[124:125], v11 offset:4096
v_mfma_f32_16x16x32_bf16 v[108:111], v[204:207], v[36:39], v[108:111]
ds_read_b64_tr_b16 v[126:127], v11 offset:5120
buffer_load_dwordx4 v[36:39], v1, s[8:11], s24 offen offset:1024 sc1
s_waitcnt vmcnt(21)
v_mfma_f32_16x16x32_bf16 v[96:99], v[208:211], v[40:43], v[96:99]
v_mfma_f32_16x16x32_bf16 v[100:103], v[212:215], v[40:43], v[100:103]
v_mfma_f32_16x16x32_bf16 v[104:107], v[216:219], v[40:43], v[104:107]
v_mfma_f32_16x16x32_bf16 v[108:111], v[220:223], v[40:43], v[108:111]
buffer_load_dwordx4 v[40:43], v1, s[8:11], s24 offen offset:2048 sc1
s_waitcnt vmcnt(21) lgkmcnt(0)
v_mfma_f32_16x16x32_bf16 v[96:99], v[112:115], v[44:47], v[96:99]
v_mfma_f32_16x16x32_bf16 v[100:103], v[116:119], v[44:47], v[100:103]
v_mfma_f32_16x16x32_bf16 v[104:107], v[120:123], v[44:47], v[104:107]
v_mfma_f32_16x16x32_bf16 v[108:111], v[124:127], v[44:47], v[108:111]
buffer_load_dwordx4 v[44:47], v1, s[8:11], s24 offen offset:3072 sc1
s_waitcnt vmcnt(21)
v_mfma_f32_16x16x32_bf16 v[96:99], v[224:227], v[48:51], v[96:99]
ds_read_b64_tr_b16 v[112:113], v8 offset:8192
v_mfma_f32_16x16x32_bf16 v[100:103], v[228:231], v[48:51], v[100:103]
ds_read_b64_tr_b16 v[114:115], v8 offset:9216
v_mfma_f32_16x16x32_bf16 v[104:107], v[232:235], v[48:51], v[104:107]
ds_read_b64_tr_b16 v[116:117], v9 offset:8192
v_mfma_f32_16x16x32_bf16 v[108:111], v[236:239], v[48:51], v[108:111]
ds_read_b64_tr_b16 v[118:119], v9 offset:9216
s_add_u32 s24, s48, s37
buffer_load_dwordx4 v[48:51], v1, s[8:11], s24 offen offset:0 sc1
s_waitcnt vmcnt(21)
v_mfma_f32_16x16x32_bf16 v[96:99], v[240:243], v[52:55], v[96:99]
ds_read_b64_tr_b16 v[120:121], v10 offset:8192
v_mfma_f32_16x16x32_bf16 v[100:103], v[244:247], v[52:55], v[100:103]
ds_read_b64_tr_b16 v[122:123], v10 offset:9216
v_mfma_f32_16x16x32_bf16 v[104:107], v[248:251], v[52:55], v[104:107]
ds_read_b64_tr_b16 v[124:125], v11 offset:8192
v_mfma_f32_16x16x32_bf16 v[108:111], v[252:255], v[52:55], v[108:111]
ds_read_b64_tr_b16 v[126:127], v11 offset:9216
buffer_load_dwordx4 v[52:55], v1, s[8:11], s24 offen offset:1024 sc1
s_waitcnt vmcnt(21)
v_mfma_f32_16x16x32_bf16 v[96:99], a[0:3], v[56:59], v[96:99]
v_mfma_f32_16x16x32_bf16 v[100:103], a[4:7], v[56:59], v[100:103]
v_mfma_f32_16x16x32_bf16 v[104:107], a[8:11], v[56:59], v[104:107]
v_mfma_f32_16x16x32_bf16 v[108:111], a[12:15], v[56:59], v[108:111]
buffer_load_dwordx4 v[56:59], v1, s[8:11], s24 offen offset:2048 sc1
s_waitcnt vmcnt(21) lgkmcnt(0)
v_mfma_f32_16x16x32_bf16 v[96:99], v[112:115], v[60:63], v[96:99]
v_mfma_f32_16x16x32_bf16 v[100:103], v[116:119], v[60:63], v[100:103]
v_mfma_f32_16x16x32_bf16 v[104:107], v[120:123], v[60:63], v[104:107]
v_mfma_f32_16x16x32_bf16 v[108:111], v[124:127], v[60:63], v[108:111]
buffer_load_dwordx4 v[60:63], v1, s[8:11], s24 offen offset:3072 sc1
s_waitcnt vmcnt(21)
v_mfma_f32_16x16x32_bf16 v[96:99], a[16:19], v[64:67], v[96:99]
ds_read_b64_tr_b16 v[112:113], v8 offset:12288
v_mfma_f32_16x16x32_bf16 v[100:103], a[20:23], v[64:67], v[100:103]
ds_read_b64_tr_b16 v[114:115], v8 offset:13312
v_mfma_f32_16x16x32_bf16 v[104:107], a[24:27], v[64:67], v[104:107]
ds_read_b64_tr_b16 v[116:117], v9 offset:12288
v_mfma_f32_16x16x32_bf16 v[108:111], a[28:31], v[64:67], v[108:111]
ds_read_b64_tr_b16 v[118:119], v9 offset:13312
s_waitcnt vmcnt(12)
v_cmp_ne_u32 vcc, 1, v6
s_cmp_gt_u32 s42, 1
s_cselect_b32 s50, 1, 0
s_cmp_eq_u64 vcc, 0
s_cselect_b32 s50, s50, 0
s_cmp_eq_u32 s50, 1
s_cselect_b32 s49, s49, 536870912
s_add_u32 s24, s49, s30
buffer_load_dwordx4 v[64:67], v1, s[8:11], s24 offen offset:0 sc1
s_waitcnt vmcnt(21)
v_mfma_f32_16x16x32_bf16 v[96:99], a[32:35], v[68:71], v[96:99]
ds_read_b64_tr_b16 v[120:121], v10 offset:12288
v_mfma_f32_16x16x32_bf16 v[100:103], a[36:39], v[68:71], v[100:103]
ds_read_b64_tr_b16 v[122:123], v10 offset:13312
v_mfma_f32_16x16x32_bf16 v[104:107], a[40:43], v[68:71], v[104:107]
ds_read_b64_tr_b16 v[124:125], v11 offset:12288
v_mfma_f32_16x16x32_bf16 v[108:111], a[44:47], v[68:71], v[108:111]
ds_read_b64_tr_b16 v[126:127], v11 offset:13312
buffer_load_dwordx4 v[68:71], v1, s[8:11], s24 offen offset:1024 sc1
s_waitcnt vmcnt(21)
v_mfma_f32_16x16x32_bf16 v[96:99], a[48:51], v[72:75], v[96:99]
v_mfma_f32_16x16x32_bf16 v[100:103], a[52:55], v[72:75], v[100:103]
v_mfma_f32_16x16x32_bf16 v[104:107], a[56:59], v[72:75], v[104:107]
v_mfma_f32_16x16x32_bf16 v[108:111], a[60:63], v[72:75], v[108:111]
buffer_load_dwordx4 v[72:75], v1, s[8:11], s24 offen offset:2048 sc1
s_waitcnt vmcnt(21) lgkmcnt(0)
v_mfma_f32_16x16x32_bf16 v[96:99], v[112:115], v[76:79], v[96:99]
v_mfma_f32_16x16x32_bf16 v[100:103], v[116:119], v[76:79], v[100:103]
v_mfma_f32_16x16x32_bf16 v[104:107], v[120:123], v[76:79], v[104:107]
v_mfma_f32_16x16x32_bf16 v[108:111], v[124:127], v[76:79], v[108:111]
buffer_load_dwordx4 v[76:79], v1, s[8:11], s24 offen offset:3072 sc1
s_waitcnt vmcnt(21)
v_mfma_f32_16x16x32_bf16 v[96:99], a[64:67], v[80:83], v[96:99]
ds_read_b64_tr_b16 v[112:113], v8 offset:16384
v_mfma_f32_16x16x32_bf16 v[100:103], a[68:71], v[80:83], v[100:103]
ds_read_b64_tr_b16 v[114:115], v8 offset:17408
v_mfma_f32_16x16x32_bf16 v[104:107], a[72:75], v[80:83], v[104:107]
ds_read_b64_tr_b16 v[116:117], v9 offset:16384
v_mfma_f32_16x16x32_bf16 v[108:111], a[76:79], v[80:83], v[108:111]
ds_read_b64_tr_b16 v[118:119], v9 offset:17408
s_add_u32 s24, s49, s31
buffer_load_dwordx4 v[80:83], v1, s[8:11], s24 offen offset:0 sc1
s_waitcnt vmcnt(21)
v_mfma_f32_16x16x32_bf16 v[96:99], a[80:83], v[84:87], v[96:99]
ds_read_b64_tr_b16 v[120:121], v10 offset:16384
v_mfma_f32_16x16x32_bf16 v[100:103], a[84:87], v[84:87], v[100:103]
ds_read_b64_tr_b16 v[122:123], v10 offset:17408
v_mfma_f32_16x16x32_bf16 v[104:107], a[88:91], v[84:87], v[104:107]
ds_read_b64_tr_b16 v[124:125], v11 offset:16384
v_mfma_f32_16x16x32_bf16 v[108:111], a[92:95], v[84:87], v[108:111]
ds_read_b64_tr_b16 v[126:127], v11 offset:17408
buffer_load_dwordx4 v[84:87], v1, s[8:11], s24 offen offset:1024 sc1
s_waitcnt vmcnt(21)
v_mfma_f32_16x16x32_bf16 v[96:99], a[96:99], v[88:91], v[96:99]
v_mfma_f32_16x16x32_bf16 v[100:103], a[100:103], v[88:91], v[100:103]
v_mfma_f32_16x16x32_bf16 v[104:107], a[104:107], v[88:91], v[104:107]
v_mfma_f32_16x16x32_bf16 v[108:111], a[108:111], v[88:91], v[108:111]
buffer_load_dwordx4 v[88:91], v1, s[8:11], s24 offen offset:2048 sc1
s_waitcnt vmcnt(21) lgkmcnt(0)
v_mfma_f32_16x16x32_bf16 v[96:99], v[112:115], v[92:95], v[96:99]
v_mfma_f32_16x16x32_bf16 v[100:103], v[116:119], v[92:95], v[100:103]
v_mfma_f32_16x16x32_bf16 v[104:107], v[120:123], v[92:95], v[104:107]
v_mfma_f32_16x16x32_bf16 v[108:111], v[124:127], v[92:95], v[108:111]
buffer_load_dwordx4 v[92:95], v1, s[8:11], s24 offen offset:3072 sc1
s_waitcnt vmcnt(19)
v_mfma_f32_16x16x32_bf16 v[96:99], a[112:115], v[16:19], v[96:99]
ds_read_b64_tr_b16 v[112:113], v8 offset:20480
v_mfma_f32_16x16x32_bf16 v[100:103], a[116:119], v[16:19], v[100:103]
ds_read_b64_tr_b16 v[114:115], v8 offset:21504
v_mfma_f32_16x16x32_bf16 v[104:107], a[120:123], v[16:19], v[104:107]
ds_read_b64_tr_b16 v[116:117], v9 offset:20480
v_mfma_f32_16x16x32_bf16 v[108:111], a[124:127], v[16:19], v[108:111]
ds_read_b64_tr_b16 v[118:119], v9 offset:21504
s_add_u32 s24, s49, s32
buffer_load_dwordx4 v[16:19], v1, s[8:11], s24 offen offset:0 sc1
s_waitcnt vmcnt(19)
v_mfma_f32_16x16x32_bf16 v[96:99], a[128:131], v[20:23], v[96:99]
ds_read_b64_tr_b16 v[120:121], v10 offset:20480
v_mfma_f32_16x16x32_bf16 v[100:103], a[132:135], v[20:23], v[100:103]
ds_read_b64_tr_b16 v[122:123], v10 offset:21504
v_mfma_f32_16x16x32_bf16 v[104:107], a[136:139], v[20:23], v[104:107]
ds_read_b64_tr_b16 v[124:125], v11 offset:20480
v_mfma_f32_16x16x32_bf16 v[108:111], a[140:143], v[20:23], v[108:111]
ds_read_b64_tr_b16 v[126:127], v11 offset:21504
buffer_load_dwordx4 v[20:23], v1, s[8:11], s24 offen offset:1024 sc1
s_waitcnt vmcnt(19)
v_mfma_f32_16x16x32_bf16 v[96:99], a[144:147], v[24:27], v[96:99]
v_mfma_f32_16x16x32_bf16 v[100:103], a[148:151], v[24:27], v[100:103]
v_mfma_f32_16x16x32_bf16 v[104:107], a[152:155], v[24:27], v[104:107]
v_mfma_f32_16x16x32_bf16 v[108:111], a[156:159], v[24:27], v[108:111]
buffer_load_dwordx4 v[24:27], v1, s[8:11], s24 offen offset:2048 sc1
s_waitcnt vmcnt(19) lgkmcnt(0)
v_mfma_f32_16x16x32_bf16 v[96:99], v[112:115], v[28:31], v[96:99]
v_mfma_f32_16x16x32_bf16 v[100:103], v[116:119], v[28:31], v[100:103]
v_mfma_f32_16x16x32_bf16 v[104:107], v[120:123], v[28:31], v[104:107]
v_mfma_f32_16x16x32_bf16 v[108:111], v[124:127], v[28:31], v[108:111]
buffer_load_dwordx4 v[28:31], v1, s[8:11], s24 offen offset:3072 sc1
s_waitcnt vmcnt(19)
v_mfma_f32_16x16x32_bf16 v[96:99], a[160:163], v[32:35], v[96:99]
ds_read_b64_tr_b16 v[112:113], v8 offset:24576
v_mfma_f32_16x16x32_bf16 v[100:103], a[164:167], v[32:35], v[100:103]
ds_read_b64_tr_b16 v[114:115], v8 offset:25600
v_mfma_f32_16x16x32_bf16 v[104:107], a[168:171], v[32:35], v[104:107]
ds_read_b64_tr_b16 v[116:117], v9 offset:24576
v_mfma_f32_16x16x32_bf16 v[108:111], a[172:175], v[32:35], v[108:111]
ds_read_b64_tr_b16 v[118:119], v9 offset:25600
s_add_u32 s24, s49, s33
buffer_load_dwordx4 v[32:35], v1, s[8:11], s24 offen offset:0 sc1
s_waitcnt vmcnt(19)
v_mfma_f32_16x16x32_bf16 v[96:99], a[176:179], v[36:39], v[96:99]
ds_read_b64_tr_b16 v[120:121], v10 offset:24576
v_mfma_f32_16x16x32_bf16 v[100:103], a[180:183], v[36:39], v[100:103]
ds_read_b64_tr_b16 v[122:123], v10 offset:25600
v_mfma_f32_16x16x32_bf16 v[104:107], a[184:187], v[36:39], v[104:107]
ds_read_b64_tr_b16 v[124:125], v11 offset:24576
v_mfma_f32_16x16x32_bf16 v[108:111], a[188:191], v[36:39], v[108:111]
ds_read_b64_tr_b16 v[126:127], v11 offset:25600
buffer_load_dwordx4 v[36:39], v1, s[8:11], s24 offen offset:1024 sc1
s_waitcnt vmcnt(19)
v_mfma_f32_16x16x32_bf16 v[96:99], a[192:195], v[40:43], v[96:99]
v_mfma_f32_16x16x32_bf16 v[100:103], a[196:199], v[40:43], v[100:103]
v_mfma_f32_16x16x32_bf16 v[104:107], a[200:203], v[40:43], v[104:107]
v_mfma_f32_16x16x32_bf16 v[108:111], a[204:207], v[40:43], v[108:111]
buffer_load_dwordx4 v[40:43], v1, s[8:11], s24 offen offset:2048 sc1
s_waitcnt vmcnt(19) lgkmcnt(0)
v_mfma_f32_16x16x32_bf16 v[96:99], v[112:115], v[44:47], v[96:99]
v_mfma_f32_16x16x32_bf16 v[100:103], v[116:119], v[44:47], v[100:103]
v_mfma_f32_16x16x32_bf16 v[104:107], v[120:123], v[44:47], v[104:107]
v_mfma_f32_16x16x32_bf16 v[108:111], v[124:127], v[44:47], v[108:111]
buffer_load_dwordx4 v[44:47], v1, s[8:11], s24 offen offset:3072 sc1
s_waitcnt vmcnt(19)
v_mfma_f32_16x16x32_bf16 v[96:99], a[208:211], v[48:51], v[96:99]
ds_read_b64_tr_b16 v[112:113], v8 offset:28672
v_mfma_f32_16x16x32_bf16 v[100:103], a[212:215], v[48:51], v[100:103]
ds_read_b64_tr_b16 v[114:115], v8 offset:29696
v_mfma_f32_16x16x32_bf16 v[104:107], a[216:219], v[48:51], v[104:107]
ds_read_b64_tr_b16 v[116:117], v9 offset:28672
v_mfma_f32_16x16x32_bf16 v[108:111], a[220:223], v[48:51], v[108:111]
ds_read_b64_tr_b16 v[118:119], v9 offset:29696
s_add_u32 s24, s49, s34
buffer_load_dwordx4 v[48:51], v1, s[8:11], s24 offen offset:0 sc1
s_waitcnt vmcnt(19)
v_mfma_f32_16x16x32_bf16 v[96:99], a[224:227], v[52:55], v[96:99]
ds_read_b64_tr_b16 v[120:121], v10 offset:28672
v_mfma_f32_16x16x32_bf16 v[100:103], a[228:231], v[52:55], v[100:103]
ds_read_b64_tr_b16 v[122:123], v10 offset:29696
v_mfma_f32_16x16x32_bf16 v[104:107], a[232:235], v[52:55], v[104:107]
ds_read_b64_tr_b16 v[124:125], v11 offset:28672
v_mfma_f32_16x16x32_bf16 v[108:111], a[236:239], v[52:55], v[108:111]
ds_read_b64_tr_b16 v[126:127], v11 offset:29696
buffer_load_dwordx4 v[52:55], v1, s[8:11], s24 offen offset:1024 sc1
s_waitcnt vmcnt(19)
v_mfma_f32_16x16x32_bf16 v[96:99], a[240:243], v[56:59], v[96:99]
v_mfma_f32_16x16x32_bf16 v[100:103], a[244:247], v[56:59], v[100:103]
v_mfma_f32_16x16x32_bf16 v[104:107], a[248:251], v[56:59], v[104:107]
v_mfma_f32_16x16x32_bf16 v[108:111], a[252:255], v[56:59], v[108:111]
buffer_load_dwordx4 v[56:59], v1, s[8:11], s24 offen offset:2048 sc1
s_waitcnt vmcnt(19) lgkmcnt(0)
v_mfma_f32_16x16x32_bf16 v[96:99], v[112:115], v[60:63], v[96:99]
v_mfma_f32_16x16x32_bf16 v[100:103], v[116:119], v[60:63], v[100:103]
v_mfma_f32_16x16x32_bf16 v[104:107], v[120:123], v[60:63], v[104:107]
v_mfma_f32_16x16x32_bf16 v[108:111], v[124:127], v[60:63], v[108:111]
buffer_load_dwordx4 v[60:63], v1, s[8:11], s24 offen offset:3072 sc1
s_nop 3
ds_write_b128 v3, v[96:99] offset:0
ds_write_b128 v3, v[100:103] offset:4096
ds_write_b128 v3, v[104:107] offset:8192
ds_write_b128 v3, v[108:111] offset:12288
s_waitcnt lgkmcnt(0)
s_barrier
ds_read_b128 v[96:99], v7 offset:0
ds_read_b128 v[100:103], v7 offset:1024
ds_read_b128 v[104:107], v7 offset:2048
ds_read_b128 v[108:111], v7 offset:3072
ds_read_b64_tr_b16 v[112:113], v8 offset:0
ds_read_b64_tr_b16 v[114:115], v8 offset:1024
ds_read_b64_tr_b16 v[116:117], v9 offset:0
ds_read_b64_tr_b16 v[118:119], v9 offset:1024
ds_read_b64_tr_b16 v[120:121], v10 offset:0
ds_read_b64_tr_b16 v[122:123], v10 offset:1024
ds_read_b64_tr_b16 v[124:125], v11 offset:0
ds_read_b64_tr_b16 v[126:127], v11 offset:1024
s_mul_i32 s24, s41, 36864
s_waitcnt lgkmcnt(10)
v_pk_add_f32 v[96:97], v[96:97], v[100:101]
v_pk_add_f32 v[98:99], v[98:99], v[102:103]
s_waitcnt lgkmcnt(9)
v_pk_add_f32 v[96:97], v[96:97], v[104:105]
v_pk_add_f32 v[98:99], v[98:99], v[106:107]
s_waitcnt lgkmcnt(8)
v_pk_add_f32 v[96:97], v[96:97], v[108:109]
v_pk_add_f32 v[98:99], v[98:99], v[110:111]
v_cvt_pk_bf16_f32 v12, v96, v97
v_cvt_pk_bf16_f32 v13, v98, v99
buffer_store_dwordx2 v[12:13], v4, s[12:15], s24 offen
v_xor_b32 v3, 16384, v3
v_xor_b32 v7, 16384, v7
s_mov_b32 s41, s27
s_mov_b32 s48, s49
s_sub_u32 s42, s42, 1
s_cmp_eq_u32 s50, 0
s_cbranch_scc1 L_opl_c
L_opl_r1:
s_add_u32 s27, s41, s43
s_and_b32 s27, s27, 127
s_lshr_b32 s25, s27, s46
s_lshl_b32 s25, s25, 7
s_add_u32 s25, s25, s45
buffer_load_dword v6, v5, s[8:11], s25 offen sc1
s_lshl_b32 s49, s27, 17
s_add_u32 s49, s49, s44
s_waitcnt vmcnt(21)
v_mfma_f32_16x16x32_bf16 v[96:99], v[128:131], v[64:67], 0
v_mfma_f32_16x16x32_bf16 v[100:103], v[132:135], v[64:67], 0
v_mfma_f32_16x16x32_bf16 v[104:107], v[136:139], v[64:67], 0
v_mfma_f32_16x16x32_bf16 v[108:111], v[140:143], v[64:67], 0
s_add_u32 s24, s48, s35
buffer_load_dwordx4 v[64:67], v1, s[8:11], s24 offen offset:0 sc1
s_waitcnt vmcnt(21)
v_mfma_f32_16x16x32_bf16 v[96:99], v[144:147], v[68:71], v[96:99]
v_mfma_f32_16x16x32_bf16 v[100:103], v[148:151], v[68:71], v[100:103]
v_mfma_f32_16x16x32_bf16 v[104:107], v[152:155], v[68:71], v[104:107]
v_mfma_f32_16x16x32_bf16 v[108:111], v[156:159], v[68:71], v[108:111]
buffer_load_dwordx4 v[68:71], v1, s[8:11], s24 offen offset:1024 sc1
s_waitcnt vmcnt(21)
v_mfma_f32_16x16x32_bf16 v[96:99], v[160:163], v[72:75], v[96:99]
v_mfma_f32_16x16x32_bf16 v[100:103], v[164:167], v[72:75], v[100:103]
v_mfma_f32_16x16x32_bf16 v[104:107], v[168:171], v[72:75], v[104:107]
v_mfma_f32_16x16x32_bf16 v[108:111], v[172:175], v[72:75], v[108:111]
buffer_load_dwordx4 v[72:75], v1, s[8:11], s24 offen offset:2048 sc1
s_waitcnt vmcnt(21) lgkmcnt(0)
v_mfma_f32_16x16x32_bf16 v[96:99], v[112:115], v[76:79], v[96:99]
v_mfma_f32_16x16x32_bf16 v[100:103], v[116:119], v[76:79], v[100:103]
v_mfma_f32_16x16x32_bf16 v[104:107], v[120:123], v[76:79], v[104:107]
v_mfma_f32_16x16x32_bf16 v[108:111], v[124:127], v[76:79], v[108:111]
buffer_load_dwordx4 v[76:79], v1, s[8:11], s24 offen offset:3072 sc1
s_waitcnt vmcnt(21)
v_mfma_f32_16x16x32_bf16 v[96:99], v[176:179], v[80:83], v[96:99]
ds_read_b64_tr_b16 v[112:113], v8 offset:4096
v_mfma_f32_16x16x32_bf16 v[100:103], v[180:183], v[80:83], v[100:103]
ds_read_b64_tr_b16 v[114:115], v8 offset:5120
v_mfma_f32_16x16x32_bf16 v[104:107], v[184:187], v[80:83], v[104:107]
ds_read_b64_tr_b16 v[116:117], v9 offset:4096
v_mfma_f32_16x16x32_bf16 v[108:111], v[188:191], v[80:83], v[108:111]
ds_read_b64_tr_b16 v[118:119], v9 offset:5120
s_add_u32 s24, s48, s36
buffer_load_dwordx4 v[80:83], v1, s[8:11], s24 offen offset:0 sc1
s_waitcnt vmcnt(21)
v_mfma_f32_16x16x32_bf16 v[96:99], v[192:195], v[84:87], v[96:99]
ds_read_b64_tr_b16 v[120:121], v10 offset:4096
v_mfma_f32_16x16x32_bf16 v[100:103], v[196:199], v[84:87], v[100:103]
ds_read_b64_tr_b16 v[122:123], v10 offset:5120
v_mfma_f32_16x16x32_bf16 v[104:107], v[200:203], v[84:87], v[104:107]
ds_read_b64_tr_b16 v[124:125], v11 offset:4096
v_mfma_f32_16x16x32_bf16 v[108:111], v[204:207], v[84:87], v[108:111]
ds_read_b64_tr_b16 v[126:127], v11 offset:5120
buffer_load_dwordx4 v[84:87], v1, s[8:11], s24 offen offset:1024 sc1
s_waitcnt vmcnt(21)
v_mfma_f32_16x16x32_bf16 v[96:99], v[208:211], v[88:91], v[96:99]
v_mfma_f32_16x16x32_bf16 v[100:103], v[212:215], v[88:91], v[100:103]
v_mfma_f32_16x16x32_bf16 v[104:107], v[216:219], v[88:91], v[104:107]
v_mfma_f32_16x16x32_bf16 v[108:111], v[220:223], v[88:91], v[108:111]
buffer_load_dwordx4 v[88:91], v1, s[8:11], s24 offen offset:2048 sc1
s_waitcnt vmcnt(21) lgkmcnt(0)
v_mfma_f32_16x16x32_bf16 v[96:99], v[112:115], v[92:95], v[96:99]
v_mfma_f32_16x16x32_bf16 v[100:103], v[116:119], v[92:95], v[100:103]
v_mfma_f32_16x16x32_bf16 v[104:107], v[120:123], v[92:95], v[104:107]
v_mfma_f32_16x16x32_bf16 v[108:111], v[124:127], v[92:95], v[108:111]
buffer_load_dwordx4 v[92:95], v1, s[8:11], s24 offen offset:3072 sc1
s_waitcnt vmcnt(21)
v_mfma_f32_16x16x32_bf16 v[96:99], v[224:227], v[16:19], v[96:99]
ds_read_b64_tr_b16 v[112:113], v8 offset:8192
v_mfma_f32_16x16x32_bf16 v[100:103], v[228:231], v[16:19], v[100:103]
ds_read_b64_tr_b16 v[114:115], v8 offset:9216
v_mfma_f32_16x16x32_bf16 v[104:107], v[232:235], v[16:19], v[104:107]
ds_read_b64_tr_b16 v[116:117], v9 offset:8192
v_mfma_f32_16x16x32_bf16 v[108:111], v[236:239], v[16:19], v[108:111]
ds_read_b64_tr_b16 v[118:119], v9 offset:9216
s_add_u32 s24, s48, s37
buffer_load_dwordx4 v[16:19], v1, s[8:11], s24 offen offset:0 sc1
s_waitcnt vmcnt(21)
v_mfma_f32_16x16x32_bf16 v[96:99], v[240:243], v[20:23], v[96:99]
ds_read_b64_tr_b16 v[120:121], v10 offset:8192
v_mfma_f32_16x16x32_bf16 v[100:103], v[244:247], v[20:23], v[100:103]
ds_read_b64_tr_b16 v[122:123], v10 offset:9216
v_mfma_f32_16x16x32_bf16 v[104:107], v[248:251], v[20:23], v[104:107]
ds_read_b64_tr_b16 v[124:125], v11 offset:8192
v_mfma_f32_16x16x32_bf16 v[108:111], v[252:255], v[20:23], v[108:111]
ds_read_b64_tr_b16 v[126:127], v11 offset:9216
buffer_load_dwordx4 v[20:23], v1, s[8:11], s24 offen offset:1024 sc1
s_waitcnt vmcnt(21)
v_mfma_f32_16x16x32_bf16 v[96:99], a[0:3], v[24:27], v[96:99]
v_mfma_f32_16x16x32_bf16 v[100:103], a[4:7], v[24:27], v[100:103]
v_mfma_f32_16x16x32_bf16 v[104:107], a[8:11], v[24:27], v[104:107]
v_mfma_f32_16x16x32_bf16 v[108:111], a[12:15], v[24:27], v[108:111]
buffer_load_dwordx4 v[24:27], v1, s[8:11], s24 offen offset:2048 sc1
s_waitcnt vmcnt(21) lgkmcnt(0)
v_mfma_f32_16x16x32_bf16 v[96:99], v[112:115], v[28:31], v[96:99]
v_mfma_f32_16x16x32_bf16 v[100:103], v[116:119], v[28:31], v[100:103]
v_mfma_f32_16x16x32_bf16 v[104:107], v[120:123], v[28:31], v[104:107]
v_mfma_f32_16x16x32_bf16 v[108:111], v[124:127], v[28:31], v[108:111]
buffer_load_dwordx4 v[28:31], v1, s[8:11], s24 offen offset:3072 sc1
s_waitcnt vmcnt(21)
v_mfma_f32_16x16x32_bf16 v[96:99], a[16:19], v[32:35], v[96:99]
ds_read_b64_tr_b16 v[112:113], v8 offset:12288
v_mfma_f32_16x16x32_bf16 v[100:103], a[20:23], v[32:35], v[100:103]
ds_read_b64_tr_b16 v[114:115], v8 offset:13312
v_mfma_f32_16x16x32_bf16 v[104:107], a[24:27], v[32:35], v[104:107]
ds_read_b64_tr_b16 v[116:117], v9 offset:12288
v_mfma_f32_16x16x32_bf16 v[108:111], a[28:31], v[32:35], v[108:111]
ds_read_b64_tr_b16 v[118:119], v9 offset:13312
s_waitcnt vmcnt(12)
v_cmp_ne_u32 vcc, 1, v6
s_cmp_gt_u32 s42, 1
s_cselect_b32 s50, 1, 0
s_cmp_eq_u64 vcc, 0
s_cselect_b32 s50, s50, 0
s_cmp_eq_u32 s50, 1
s_cselect_b32 s49, s49, 536870912
s_add_u32 s24, s49, s30
buffer_load_dwordx4 v[32:35], v1, s[8:11], s24 offen offset:0 sc1
s_waitcnt vmcnt(21)
v_mfma_f32_16x16x32_bf16 v[96:99], a[32:35], v[36:39], v[96:99]
ds_read_b64_tr_b16 v[120:121], v10 offset:12288
v_mfma_f32_16x16x32_bf16 v[100:103], a[36:39], v[36:39], v[100:103]
ds_read_b64_tr_b16 v[122:123], v10 offset:13312
v_mfma_f32_16x16x32_bf16 v[104:107], a[40:43], v[36:39], v[104:107]
ds_read_b64_tr_b16 v[124:125], v11 offset:12288
v_mfma_f32_16x16x32_bf16 v[108:111], a[44:47], v[36:39], v[108:111]
ds_read_b64_tr_b16 v[126:127], v11 offset:13312
buffer_load_dwordx4 v[36:39], v1, s[8:11], s24 offen offset:1024 sc1
s_waitcnt vmcnt(21)
v_mfma_f32_16x16x32_bf16 v[96:99], a[48:51], v[40:43], v[96:99]
v_mfma_f32_16x16x32_bf16 v[100:103], a[52:55], v[40:43], v[100:103]
v_mfma_f32_16x16x32_bf16 v[104:107], a[56:59], v[40:43], v[104:107]
v_mfma_f32_16x16x32_bf16 v[108:111], a[60:63], v[40:43], v[108:111]
buffer_load_dwordx4 v[40:43], v1, s[8:11], s24 offen offset:2048 sc1
s_waitcnt vmcnt(21) lgkmcnt(0)
v_mfma_f32_16x16x32_bf16 v[96:99], v[112:115], v[44:47], v[96:99]
v_mfma_f32_16x16x32_bf16 v[100:103], v[116:119], v[44:47], v[100:103]
v_mfma_f32_16x16x32_bf16 v[104:107], v[120:123], v[44:47], v[104:107]
v_mfma_f32_16x16x32_bf16 v[108:111], v[124:127], v[44:47], v[108:111]
buffer_load_dwordx4 v[44:47], v1, s[8:11], s24 offen offset:3072 sc1
s_waitcnt vmcnt(21)
v_mfma_f32_16x16x32_bf16 v[96:99], a[64:67], v[48:51], v[96:99]
ds_read_b64_tr_b16 v[112:113], v8 offset:16384
v_mfma_f32_16x16x32_bf16 v[100:103], a[68:71], v[48:51], v[100:103]
ds_read_b64_tr_b16 v[114:115], v8 offset:17408
v_mfma_f32_16x16x32_bf16 v[104:107], a[72:75], v[48:51], v[104:107]
ds_read_b64_tr_b16 v[116:117], v9 offset:16384
v_mfma_f32_16x16x32_bf16 v[108:111], a[76:79], v[48:51], v[108:111]
ds_read_b64_tr_b16 v[118:119], v9 offset:17408
s_add_u32 s24, s49, s31
buffer_load_dwordx4 v[48:51], v1, s[8:11], s24 offen offset:0 sc1
s_waitcnt vmcnt(21)
v_mfma_f32_16x16x32_bf16 v[96:99], a[80:83], v[52:55], v[96:99]
ds_read_b64_tr_b16 v[120:121], v10 offset:16384
v_mfma_f32_16x16x32_bf16 v[100:103], a[84:87], v[52:55], v[100:103]
ds_read_b64_tr_b16 v[122:123], v10 offset:17408
v_mfma_f32_16x16x32_bf16 v[104:107], a[88:91], v[52:55], v[104:107]
ds_read_b64_tr_b16 v[124:125], v11 offset:16384
v_mfma_f32_16x16x32_bf16 v[108:111], a[92:95], v[52:55], v[108:111]
ds_read_b64_tr_b16 v[126:127], v11 offset:17408
buffer_load_dwordx4 v[52:55], v1, s[8:11], s24 offen offset:1024 sc1
s_waitcnt vmcnt(21)
v_mfma_f32_16x16x32_bf16 v[96:99], a[96:99], v[56:59], v[96:99]
v_mfma_f32_16x16x32_bf16 v[100:103], a[100:103], v[56:59], v[100:103]
v_mfma_f32_16x16x32_bf16 v[104:107], a[104:107], v[56:59], v[104:107]
v_mfma_f32_16x16x32_bf16 v[108:111], a[108:111], v[56:59], v[108:111]
buffer_load_dwordx4 v[56:59], v1, s[8:11], s24 offen offset:2048 sc1
s_waitcnt vmcnt(21) lgkmcnt(0)
v_mfma_f32_16x16x32_bf16 v[96:99], v[112:115], v[60:63], v[96:99]
v_mfma_f32_16x16x32_bf16 v[100:103], v[116:119], v[60:63], v[100:103]
v_mfma_f32_16x16x32_bf16 v[104:107], v[120:123], v[60:63], v[104:107]
v_mfma_f32_16x16x32_bf16 v[108:111], v[124:127], v[60:63], v[108:111]
buffer_load_dwordx4 v[60:63], v1, s[8:11], s24 offen offset:3072 sc1
s_waitcnt vmcnt(19)
v_mfma_f32_16x16x32_bf16 v[96:99], a[112:115], v[64:67], v[96:99]
ds_read_b64_tr_b16 v[112:113], v8 offset:20480
v_mfma_f32_16x16x32_bf16 v[100:103], a[116:119], v[64:67], v[100:103]
ds_read_b64_tr_b16 v[114:115], v8 offset:21504
v_mfma_f32_16x16x32_bf16 v[104:107], a[120:123], v[64:67], v[104:107]
ds_read_b64_tr_b16 v[116:117], v9 offset:20480
v_mfma_f32_16x16x32_bf16 v[108:111], a[124:127], v[64:67], v[108:111]
ds_read_b64_tr_b16 v[118:119], v9 offset:21504
s_add_u32 s24, s49, s32
buffer_load_dwordx4 v[64:67], v1, s[8:11], s24 offen offset:0 sc1
s_waitcnt vmcnt(19)
v_mfma_f32_16x16x32_bf16 v[96:99], a[128:131], v[68:71], v[96:99]
ds_read_b64_tr_b16 v[120:121], v10 offset:20480
v_mfma_f32_16x16x32_bf16 v[100:103], a[132:135], v[68:71], v[100:103]
ds_read_b64_tr_b16 v[122:123], v10 offset:21504
v_mfma_f32_16x16x32_bf16 v[104:107], a[136:139], v[68:71], v[104:107]
ds_read_b64_tr_b16 v[124:125], v11 offset:20480
v_mfma_f32_16x16x32_bf16 v[108:111], a[140:143], v[68:71], v[108:111]
ds_read_b64_tr_b16 v[126:127], v11 offset:21504
buffer_load_dwordx4 v[68:71], v1, s[8:11], s24 offen offset:1024 sc1
s_waitcnt vmcnt(19)
v_mfma_f32_16x16x32_bf16 v[96:99], a[144:147], v[72:75], v[96:99]
v_mfma_f32_16x16x32_bf16 v[100:103], a[148:151], v[72:75], v[100:103]
v_mfma_f32_16x16x32_bf16 v[104:107], a[152:155], v[72:75], v[104:107]
v_mfma_f32_16x16x32_bf16 v[108:111], a[156:159], v[72:75], v[108:111]
buffer_load_dwordx4 v[72:75], v1, s[8:11], s24 offen offset:2048 sc1
s_waitcnt vmcnt(19) lgkmcnt(0)
v_mfma_f32_16x16x32_bf16 v[96:99], v[112:115], v[76:79], v[96:99]
v_mfma_f32_16x16x32_bf16 v[100:103], v[116:119], v[76:79], v[100:103]
v_mfma_f32_16x16x32_bf16 v[104:107], v[120:123], v[76:79], v[104:107]
v_mfma_f32_16x16x32_bf16 v[108:111], v[124:127], v[76:79], v[108:111]
buffer_load_dwordx4 v[76:79], v1, s[8:11], s24 offen offset:3072 sc1
s_waitcnt vmcnt(19)
v_mfma_f32_16x16x32_bf16 v[96:99], a[160:163], v[80:83], v[96:99]
ds_read_b64_tr_b16 v[112:113], v8 offset:24576
v_mfma_f32_16x16x32_bf16 v[100:103], a[164:167], v[80:83], v[100:103]
ds_read_b64_tr_b16 v[114:115], v8 offset:25600
v_mfma_f32_16x16x32_bf16 v[104:107], a[168:171], v[80:83], v[104:107]
ds_read_b64_tr_b16 v[116:117], v9 offset:24576
v_mfma_f32_16x16x32_bf16 v[108:111], a[172:175], v[80:83], v[108:111]
ds_read_b64_tr_b16 v[118:119], v9 offset:25600
s_add_u32 s24, s49, s33
buffer_load_dwordx4 v[80:83], v1, s[8:11], s24 offen offset:0 sc1
s_waitcnt vmcnt(19)
v_mfma_f32_16x16x32_bf16 v[96:99], a[176:179], v[84:87], v[96:99]
ds_read_b64_tr_b16 v[120:121], v10 offset:24576
v_mfma_f32_16x16x32_bf16 v[100:103], a[180:183], v[84:87], v[100:103]
ds_read_b64_tr_b16 v[122:123], v10 offset:25600
v_mfma_f32_16x16x32_bf16 v[104:107], a[184:187], v[84:87], v[104:107]
ds_read_b64_tr_b16 v[124:125], v11 offset:24576
v_mfma_f32_16x16x32_bf16 v[108:111], a[188:191], v[84:87], v[108:111]
ds_read_b64_tr_b16 v[126:127], v11 offset:25600
buffer_load_dwordx4 v[84:87], v1, s[8:11], s24 offen offset:1024 sc1
s_waitcnt vmcnt(19)
v_mfma_f32_16x16x32_bf16 v[96:99], a[192:195], v[88:91], v[96:99]
v_mfma_f32_16x16x32_bf16 v[100:103], a[196:199], v[88:91], v[100:103]
v_mfma_f32_16x16x32_bf16 v[104:107], a[200:203], v[88:91], v[104:107]
v_mfma_f32_16x16x32_bf16 v[108:111], a[204:207], v[88:91], v[108:111]
buffer_load_dwordx4 v[88:91], v1, s[8:11], s24 offen offset:2048 sc1
s_waitcnt vmcnt(19) lgkmcnt(0)
v_mfma_f32_16x16x32_bf16 v[96:99], v[112:115], v[92:95], v[96:99]
v_mfma_f32_16x16x32_bf16 v[100:103], v[116:119], v[92:95], v[100:103]
v_mfma_f32_16x16x32_bf16 v[104:107], v[120:123], v[92:95], v[104:107]
v_mfma_f32_16x16x32_bf16 v[108:111], v[124:127], v[92:95], v[108:111]
buffer_load_dwordx4 v[92:95], v1, s[8:11], s24 offen offset:3072 sc1
s_waitcnt vmcnt(19)
v_mfma_f32_16x16x32_bf16 v[96:99], a[208:211], v[16:19], v[96:99]
ds_read_b64_tr_b16 v[112:113], v8 offset:28672
v_mfma_f32_16x16x32_bf16 v[100:103], a[212:215], v[16:19], v[100:103]
ds_read_b64_tr_b16 v[114:115], v8 offset:29696
v_mfma_f32_16x16x32_bf16 v[104:107], a[216:219], v[16:19], v[104:107]
ds_read_b64_tr_b16 v[116:117], v9 offset:28672
v_mfma_f32_16x16x32_bf16 v[108:111], a[220:223], v[16:19], v[108:111]
ds_read_b64_tr_b16 v[118:119], v9 offset:29696
s_add_u32 s24, s49, s34
buffer_load_dwordx4 v[16:19], v1, s[8:11], s24 offen offset:0 sc1
s_waitcnt vmcnt(19)
v_mfma_f32_16x16x32_bf16 v[96:99], a[224:227], v[20:23], v[96:99]
ds_read_b64_tr_b16 v[120:121], v10 offset:28672
v_mfma_f32_16x16x32_bf16 v[100:103], a[228:231], v[20:23], v[100:103]
ds_read_b64_tr_b16 v[122:123], v10 offset:29696
v_mfma_f32_16x16x32_bf16 v[104:107], a[232:235], v[20:23], v[104:107]
ds_read_b64_tr_b16 v[124:125], v11 offset:28672
v_mfma_f32_16x16x32_bf16 v[108:111], a[236:239], v[20:23], v[108:111]
ds_read_b64_tr_b16 v[126:127], v11 offset:29696
buffer_load_dwordx4 v[20:23], v1, s[8:11], s24 offen offset:1024 sc1
s_waitcnt vmcnt(19)
v_mfma_f32_16x16x32_bf16 v[96:99], a[240:243], v[24:27], v[96:99]
v_mfma_f32_16x16x32_bf16 v[100:103], a[244:247], v[24:27], v[100:103]
v_mfma_f32_16x16x32_bf16 v[104:107], a[248:251], v[24:27], v[104:107]
v_mfma_f32_16x16x32_bf16 v[108:111], a[252:255], v[24:27], v[108:111]
buffer_load_dwordx4 v[24:27], v1, s[8:11], s24 offen offset:2048 sc1
s_waitcnt vmcnt(19) lgkmcnt(0)
v_mfma_f32_16x16x32_bf16 v[96:99], v[112:115], v[28:31], v[96:99]
v_mfma_f32_16x16x32_bf16 v[100:103], v[116:119], v[28:31], v[100:103]
v_mfma_f32_16x16x32_bf16 v[104:107], v[120:123], v[28:31], v[104:107]
v_mfma_f32_16x16x32_bf16 v[108:111], v[124:127], v[28:31], v[108:111]
buffer_load_dwordx4 v[28:31], v1, s[8:11], s24 offen offset:3072 sc1
s_nop 3
ds_write_b128 v3, v[96:99] offset:0
ds_write_b128 v3, v[100:103] offset:4096
ds_write_b128 v3, v[104:107] offset:8192
ds_write_b128 v3, v[108:111] offset:12288
s_waitcnt lgkmcnt(0)
s_barrier
ds_read_b128 v[96:99], v7 offset:0
ds_read_b128 v[100:103], v7 offset:1024
ds_read_b128 v[104:107], v7 offset:2048
ds_read_b128 v[108:111], v7 offset:3072
ds_read_b64_tr_b16 v[112:113], v8 offset:0
ds_read_b64_tr_b16 v[114:115], v8 offset:1024
ds_read_b64_tr_b16 v[116:117], v9 offset:0
ds_read_b64_tr_b16 v[118:119], v9 offset:1024
ds_read_b64_tr_b16 v[120:121], v10 offset:0
ds_read_b64_tr_b16 v[122:123], v10 offset:1024
ds_read_b64_tr_b16 v[124:125], v11 offset:0
ds_read_b64_tr_b16 v[126:127], v11 offset:1024
s_mul_i32 s24, s41, 36864
s_waitcnt lgkmcnt(10)
v_pk_add_f32 v[96:97], v[96:97], v[100:101]
v_pk_add_f32 v[98:99], v[98:99], v[102:103]
s_waitcnt lgkmcnt(9)
v_pk_add_f32 v[96:97], v[96:97], v[104:105]
v_pk_add_f32 v[98:99], v[98:99], v[106:107]
s_waitcnt lgkmcnt(8)
v_pk_add_f32 v[96:97], v[96:97], v[108:109]
v_pk_add_f32 v[98:99], v[98:99], v[110:111]
v_cvt_pk_bf16_f32 v12, v96, v97
v_cvt_pk_bf16_f32 v13, v98, v99
buffer_store_dwordx2 v[12:13], v4, s[12:15], s24 offen
v_xor_b32 v3, 16384, v3
v_xor_b32 v7, 16384, v7
s_mov_b32 s41, s27
s_mov_b32 s48, s49
s_sub_u32 s42, s42, 1
s_cmp_eq_u32 s50, 0
s_cbranch_scc1 L_opl_c
L_opl_r2:
s_add_u32 s27, s41, s43
s_and_b32 s27, s27, 127
s_lshr_b32 s25, s27, s46
s_lshl_b32 s25, s25, 7
s_add_u32 s25, s25, s45
buffer_load_dword v6, v5, s[8:11], s25 offen sc1
s_lshl_b32 s49, s27, 17
s_add_u32 s49, s49, s44
s_waitcnt vmcnt(21)
v_mfma_f32_16x16x32_bf16 v[96:99], v[128:131], v[32:35], 0
v_mfma_f32_16x16x32_bf16 v[100:103], v[132:135], v[32:35], 0
v_mfma_f32_16x16x32_bf16 v[104:107], v[136:139], v[32:35], 0
v_mfma_f32_16x16x32_bf16 v[108:111], v[140:143], v[32:35], 0
s_add_u32 s24, s48, s35
buffer_load_dwordx4 v[32:35], v1, s[8:11], s24 offen offset:0 sc1
s_waitcnt vmcnt(21)
v_mfma_f32_16x16x32_bf16 v[96:99], v[144:147], v[36:39], v[96:99]
v_mfma_f32_16x16x32_bf16 v[100:103], v[148:151], v[36:39], v[100:103]
v_mfma_f32_16x16x32_bf16 v[104:107], v[152:155], v[36:39], v[104:107]
v_mfma_f32_16x16x32_bf16 v[108:111], v[156:159], v[36:39], v[108:111]
buffer_load_dwordx4 v[36:39], v1, s[8:11], s24 offen offset:1024 sc1
s_waitcnt vmcnt(21)
v_mfma_f32_16x16x32_bf16 v[96:99], v[160:163], v[40:43], v[96:99]
v_mfma_f32_16x16x32_bf16 v[100:103], v[164:167], v[40:43], v[100:103]
v_mfma_f32_16x16x32_bf16 v[104:107], v[168:171], v[40:43], v[104:107]
v_mfma_f32_16x16x32_bf16 v[108:111], v[172:175], v[40:43], v[108:111]
buffer_load_dwordx4 v[40:43], v1, s[8:11], s24 offen offset:2048 sc1
s_waitcnt vmcnt(21) lgkmcnt(0)
v_mfma_f32_16x16x32_bf16 v[96:99], v[112:115], v[44:47], v[96:99]
v_mfma_f32_16x16x32_bf16 v[100:103], v[116:119], v[44:47], v[100:103]
v_mfma_f32_16x16x32_bf16 v[104:107], v[120:123], v[44:47], v[104:107]
v_mfma_f32_16x16x32_bf16 v[108:111], v[124:127], v[44:47], v[108:111]
buffer_load_dwordx4 v[44:47], v1, s[8:11], s24 offen offset:3072 sc1
s_waitcnt vmcnt(21)
v_mfma_f32_16x16x32_bf16 v[96:99], v[176:179], v[48:51], v[96:99]
ds_read_b64_tr_b16 v[112:113], v8 offset:4096
v_mfma_f32_16x16x32_bf16 v[100:103], v[180:183], v[48:51], v[100:103]
ds_read_b64_tr_b16 v[114:115], v8 offset:5120
v_mfma_f32_16x16x32_bf16 v[104:107], v[184:187], v[48:51], v[104:107]
ds_read_b64_tr_b16 v[116:117], v9 offset:4096
v_mfma_f32_16x16x32_bf16 v[108:111], v[188:191], v[48:51], v[108:111]
ds_read_b64_tr_b16 v[118:119], v9 offset:5120
s_add_u32 s24, s48, s36
buffer_load_dwordx4 v[48:51], v1, s[8:11], s24 offen offset:0 sc1
s_waitcnt vmcnt(21)
v_mfma_f32_16x16x32_bf16 v[96:99], v[192:195], v[52:55], v[96:99]
ds_read_b64_tr_b16 v[120:121], v10 offset:4096
v_mfma_f32_16x16x32_bf16 v[100:103], v[196:199], v[52:55], v[100:103]
ds_read_b64_tr_b16 v[122:123], v10 offset:5120
v_mfma_f32_16x16x32_bf16 v[104:107], v[200:203], v[52:55], v[104:107]
ds_read_b64_tr_b16 v[124:125], v11 offset:4096
v_mfma_f32_16x16x32_bf16 v[108:111], v[204:207], v[52:55], v[108:111]
ds_read_b64_tr_b16 v[126:127], v11 offset:5120
buffer_load_dwordx4 v[52:55], v1, s[8:11], s24 offen offset:1024 sc1
s_waitcnt vmcnt(21)
v_mfma_f32_16x16x32_bf16 v[96:99], v[208:211], v[56:59], v[96:99]
v_mfma_f32_16x16x32_bf16 v[100:103], v[212:215], v[56:59], v[100:103]
v_mfma_f32_16x16x32_bf16 v[104:107], v[216:219], v[56:59], v[104:107]
v_mfma_f32_16x16x32_bf16 v[108:111], v[220:223], v[56:59], v[108:111]
buffer_load_dwordx4 v[56:59], v1, s[8:11], s24 offen offset:2048 sc1
s_waitcnt vmcnt(21) lgkmcnt(0)
v_mfma_f32_16x16x32_bf16 v[96:99], v[112:115], v[60:63], v[96:99]
v_mfma_f32_16x16x32_bf16 v[100:103], v[116:119], v[60:63], v[100:103]
v_mfma_f32_16x16x32_bf16 v[104:107], v[120:123], v[60:63], v[104:107]
v_mfma_f32_16x16x32_bf16 v[108:111], v[124:127], v[60:63], v[108:111]
buffer_load_dwordx4 v[60:63], v1, s[8:11], s24 offen offset:3072 sc1
s_waitcnt vmcnt(21)
v_mfma_f32_16x16x32_bf16 v[96:99], v[224:227], v[64:67], v[96:99]
ds_read_b64_tr_b16 v[112:113], v8 offset:8192
v_mfma_f32_16x16x32_bf16 v[100:103], v[228:231], v[64:67], v[100:103]
ds_read_b64_tr_b16 v[114:115], v8 offset:9216
v_mfma_f32_16x16x32_bf16 v[104:107], v[232:235], v[64:67], v[104:107]
ds_read_b64_tr_b16 v[116:117], v9 offset:8192
v_mfma_f32_16x16x32_bf16 v[108:111], v[236:239], v[64:67], v[108:111]
ds_read_b64_tr_b16 v[118:119], v9 offset:9216
s_add_u32 s24, s48, s37
buffer_load_dwordx4 v[64:67], v1, s[8:11], s24 offen offset:0 sc1
s_waitcnt vmcnt(21)
v_mfma_f32_16x16x32_bf16 v[96:99], v[240:243], v[68:71], v[96:99]
ds_read_b64_tr_b16 v[120:121], v10 offset:8192
v_mfma_f32_16x16x32_bf16 v[100:103], v[244:247], v[68:71], v[100:103]
ds_read_b64_tr_b16 v[122:123], v10 offset:9216
v_mfma_f32_16x16x32_bf16 v[104:107], v[248:251], v[68:71], v[104:107]
ds_read_b64_tr_b16 v[124:125], v11 offset:8192
v_mfma_f32_16x16x32_bf16 v[108:111], v[252:255], v[68:71], v[108:111]
ds_read_b64_tr_b16 v[126:127], v11 offset:9216
buffer_load_dwordx4 v[68:71], v1, s[8:11], s24 offen offset:1024 sc1
s_waitcnt vmcnt(21)
v_mfma_f32_16x16x32_bf16 v[96:99], a[0:3], v[72:75], v[96:99]
v_mfma_f32_16x16x32_bf16 v[100:103], a[4:7], v[72:75], v[100:103]
v_mfma_f32_16x16x32_bf16 v[104:107], a[8:11], v[72:75], v[104:107]
v_mfma_f32_16x16x32_bf16 v[108:111], a[12:15], v[72:75], v[108:111]
buffer_load_dwordx4 v[72:75], v1, s[8:11], s24 offen offset:2048 sc1
s_waitcnt vmcnt(21) lgkmcnt(0)
v_mfma_f32_16x16x32_bf16 v[96:99], v[112:115], v[76:79], v[96:99]
v_mfma_f32_16x16x32_bf16 v[100:103], v[116:119], v[76:79], v[100:103]
v_mfma_f32_16x16x32_bf16 v[104:107], v[120:123], v[76:79], v[104:107]
v_mfma_f32_16x16x32_bf16 v[108:111], v[124:127], v[76:79], v[108:111]
buffer_load_dwordx4 v[76:79], v1, s[8:11], s24 offen offset:3072 sc1
s_waitcnt vmcnt(21)
v_mfma_f32_16x16x32_bf16 v[96:99], a[16:19], v[80:83], v[96:99]
ds_read_b64_tr_b16 v[112:113], v8 offset:12288
v_mfma_f32_16x16x32_bf16 v[100:103], a[20:23], v[80:83], v[100:103]
ds_read_b64_tr_b16 v[114:115], v8 offset:13312
v_mfma_f32_16x16x32_bf16 v[104:107], a[24:27], v[80:83], v[104:107]
ds_read_b64_tr_b16 v[116:117], v9 offset:12288
v_mfma_f32_16x16x32_bf16 v[108:111], a[28:31], v[80:83], v[108:111]
ds_read_b64_tr_b16 v[118:119], v9 offset:13312
s_waitcnt vmcnt(12)
v_cmp_ne_u32 vcc, 1, v6
s_cmp_gt_u32 s42, 1
s_cselect_b32 s50, 1, 0
s_cmp_eq_u64 vcc, 0
s_cselect_b32 s50, s50, 0
s_cmp_eq_u32 s50, 1
s_cselect_b32 s49, s49, 536870912
s_add_u32 s24, s49, s30
buffer_load_dwordx4 v[80:83], v1, s[8:11], s24 offen offset:0 sc1
s_waitcnt vmcnt(21)
v_mfma_f32_16x16x32_bf16 v[96:99], a[32:35], v[84:87], v[96:99]
ds_read_b64_tr_b16 v[120:121], v10 offset:12288
v_mfma_f32_16x16x32_bf16 v[100:103], a[36:39], v[84:87], v[100:103]
ds_read_b64_tr_b16 v[122:123], v10 offset:13312
v_mfma_f32_16x16x32_bf16 v[104:107], a[40:43], v[84:87], v[104:107]
ds_read_b64_tr_b16 v[124:125], v11 offset:12288
v_mfma_f32_16x16x32_bf16 v[108:111], a[44:47], v[84:87], v[108:111]
ds_read_b64_tr_b16 v[126:127], v11 offset:13312
buffer_load_dwordx4 v[84:87], v1, s[8:11], s24 offen offset:1024 sc1
s_waitcnt vmcnt(21)
v_mfma_f32_16x16x32_bf16 v[96:99], a[48:51], v[88:91], v[96:99]
v_mfma_f32_16x16x32_bf16 v[100:103], a[52:55], v[88:91], v[100:103]
v_mfma_f32_16x16x32_bf16 v[104:107], a[56:59], v[88:91], v[104:107]
v_mfma_f32_16x16x32_bf16 v[108:111], a[60:63], v[88:91], v[108:111]
buffer_load_dwordx4 v[88:91], v1, s[8:11], s24 offen offset:2048 sc1
s_waitcnt vmcnt(21) lgkmcnt(0)
v_mfma_f32_16x16x32_bf16 v[96:99], v[112:115], v[92:95], v[96:99]
v_mfma_f32_16x16x32_bf16 v[100:103], v[116:119], v[92:95], v[100:103]
v_mfma_f32_16x16x32_bf16 v[104:107], v[120:123], v[92:95], v[104:107]
v_mfma_f32_16x16x32_bf16 v[108:111], v[124:127], v[92:95], v[108:111]
buffer_load_dwordx4 v[92:95], v1, s[8:11], s24 offen offset:3072 sc1
s_waitcnt vmcnt(21)
v_mfma_f32_16x16x32_bf16 v[96:99], a[64:67], v[16:19], v[96:99]
ds_read_b64_tr_b16 v[112:113], v8 offset:16384
v_mfma_f32_16x16x32_bf16 v[100:103], a[68:71], v[16:19], v[100:103]
ds_read_b64_tr_b16 v[114:115], v8 offset:17408
v_mfma_f32_16x16x32_bf16 v[104:107], a[72:75], v[16:19], v[104:107]
ds_read_b64_tr_b16 v[116:117], v9 offset:16384
v_mfma_f32_16x16x32_bf16 v[108:111], a[76:79], v[16:19], v[108:111]
ds_read_b64_tr_b16 v[118:119], v9 offset:17408
s_add_u32 s24, s49, s31
buffer_load_dwordx4 v[16:19], v1, s[8:11], s24 offen offset:0 sc1
s_waitcnt vmcnt(21)
v_mfma_f32_16x16x32_bf16 v[96:99], a[80:83], v[20:23], v[96:99]
ds_read_b64_tr_b16 v[120:121], v10 offset:16384
v_mfma_f32_16x16x32_bf16 v[100:103], a[84:87], v[20:23], v[100:103]
ds_read_b64_tr_b16 v[122:123], v10 offset:17408
v_mfma_f32_16x16x32_bf16 v[104:107], a[88:91], v[20:23], v[104:107]
ds_read_b64_tr_b16 v[124:125], v11 offset:16384
v_mfma_f32_16x16x32_bf16 v[108:111], a[92:95], v[20:23], v[108:111]
ds_read_b64_tr_b16 v[126:127], v11 offset:17408
buffer_load_dwordx4 v[20:23], v1, s[8:11], s24 offen offset:1024 sc1
s_waitcnt vmcnt(21)
v_mfma_f32_16x16x32_bf16 v[96:99], a[96:99], v[24:27], v[96:99]
v_mfma_f32_16x16x32_bf16 v[100:103], a[100:103], v[24:27], v[100:103]
v_mfma_f32_16x16x32_bf16 v[104:107], a[104:107], v[24:27], v[104:107]
v_mfma_f32_16x16x32_bf16 v[108:111], a[108:111], v[24:27], v[108:111]
buffer_load_dwordx4 v[24:27], v1, s[8:11], s24 offen offset:2048 sc1
s_waitcnt vmcnt(21) lgkmcnt(0)
v_mfma_f32_16x16x32_bf16 v[96:99], v[112:115], v[28:31], v[96:99]
v_mfma_f32_16x16x32_bf16 v[100:103], v[116:119], v[28:31], v[100:103]
v_mfma_f32_16x16x32_bf16 v[104:107], v[120:123], v[28:31], v[104:107]
v_mfma_f32_16x16x32_bf16 v[108:111], v[124:127], v[28:31], v[108:111]
buffer_load_dwordx4 v[28:31], v1, s[8:11], s24 offen offset:3072 sc1
s_waitcnt vmcnt(19)
v_mfma_f32_16x16x32_bf16 v[96:99], a[112:115], v[32:35], v[96:99]
ds_read_b64_tr_b16 v[112:113], v8 offset:20480
v_mfma_f32_16x16x32_bf16 v[100:103], a[116:119], v[32:35], v[100:103]
ds_read_b64_tr_b16 v[114:115], v8 offset:21504
v_mfma_f32_16x16x32_bf16 v[104:107], a[120:123], v[32:35], v[104:107]
ds_read_b64_tr_b16 v[116:117], v9 offset:20480
v_mfma_f32_16x16x32_bf16 v[108:111], a[124:127], v[32:35], v[108:111]
ds_read_b64_tr_b16 v[118:119], v9 offset:21504
s_add_u32 s24, s49, s32
buffer_load_dwordx4 v[32:35], v1, s[8:11], s24 offen offset:0 sc1
s_waitcnt vmcnt(19)
v_mfma_f32_16x16x32_bf16 v[96:99], a[128:131], v[36:39], v[96:99]
ds_read_b64_tr_b16 v[120:121], v10 offset:20480
v_mfma_f32_16x16x32_bf16 v[100:103], a[132:135], v[36:39], v[100:103]
ds_read_b64_tr_b16 v[122:123], v10 offset:21504
v_mfma_f32_16x16x32_bf16 v[104:107], a[136:139], v[36:39], v[104:107]
ds_read_b64_tr_b16 v[124:125], v11 offset:20480
v_mfma_f32_16x16x32_bf16 v[108:111], a[140:143], v[36:39], v[108:111]
ds_read_b64_tr_b16 v[126:127], v11 offset:21504
buffer_load_dwordx4 v[36:39], v1, s[8:11], s24 offen offset:1024 sc1
s_waitcnt vmcnt(19)
v_mfma_f32_16x16x32_bf16 v[96:99], a[144:147], v[40:43], v[96:99]
v_mfma_f32_16x16x32_bf16 v[100:103], a[148:151], v[40:43], v[100:103]
v_mfma_f32_16x16x32_bf16 v[104:107], a[152:155], v[40:43], v[104:107]
v_mfma_f32_16x16x32_bf16 v[108:111], a[156:159], v[40:43], v[108:111]
buffer_load_dwordx4 v[40:43], v1, s[8:11], s24 offen offset:2048 sc1
s_waitcnt vmcnt(19) lgkmcnt(0)
v_mfma_f32_16x16x32_bf16 v[96:99], v[112:115], v[44:47], v[96:99]
v_mfma_f32_16x16x32_bf16 v[100:103], v[116:119], v[44:47], v[100:103]
v_mfma_f32_16x16x32_bf16 v[104:107], v[120:123], v[44:47], v[104:107]
v_mfma_f32_16x16x32_bf16 v[108:111], v[124:127], v[44:47], v[108:111]
buffer_load_dwordx4 v[44:47], v1, s[8:11], s24 offen offset:3072 sc1
s_waitcnt vmcnt(19)
v_mfma_f32_16x16x32_bf16 v[96:99], a[160:163], v[48:51], v[96:99]
ds_read_b64_tr_b16 v[112:113], v8 offset:24576
v_mfma_f32_16x16x32_bf16 v[100:103], a[164:167], v[48:51], v[100:103]
ds_read_b64_tr_b16 v[114:115], v8 offset:25600
v_mfma_f32_16x16x32_bf16 v[104:107], a[168:171], v[48:51], v[104:107]
ds_read_b64_tr_b16 v[116:117], v9 offset:24576
v_mfma_f32_16x16x32_bf16 v[108:111], a[172:175], v[48:51], v[108:111]
ds_read_b64_tr_b16 v[118:119], v9 offset:25600
s_add_u32 s24, s49, s33
buffer_load_dwordx4 v[48:51], v1, s[8:11], s24 offen offset:0 sc1
s_waitcnt vmcnt(19)
v_mfma_f32_16x16x32_bf16 v[96:99], a[176:179], v[52:55], v[96:99]
ds_read_b64_tr_b16 v[120:121], v10 offset:24576
v_mfma_f32_16x16x32_bf16 v[100:103], a[180:183], v[52:55], v[100:103]
ds_read_b64_tr_b16 v[122:123], v10 offset:25600
v_mfma_f32_16x16x32_bf16 v[104:107], a[184:187], v[52:55], v[104:107]
ds_read_b64_tr_b16 v[124:125], v11 offset:24576
v_mfma_f32_16x16x32_bf16 v[108:111], a[188:191], v[52:55], v[108:111]
ds_read_b64_tr_b16 v[126:127], v11 offset:25600
buffer_load_dwordx4 v[52:55], v1, s[8:11], s24 offen offset:1024 sc1
s_waitcnt vmcnt(19)
v_mfma_f32_16x16x32_bf16 v[96:99], a[192:195], v[56:59], v[96:99]
v_mfma_f32_16x16x32_bf16 v[100:103], a[196:199], v[56:59], v[100:103]
v_mfma_f32_16x16x32_bf16 v[104:107], a[200:203], v[56:59], v[104:107]
v_mfma_f32_16x16x32_bf16 v[108:111], a[204:207], v[56:59], v[108:111]
buffer_load_dwordx4 v[56:59], v1, s[8:11], s24 offen offset:2048 sc1
s_waitcnt vmcnt(19) lgkmcnt(0)
v_mfma_f32_16x16x32_bf16 v[96:99], v[112:115], v[60:63], v[96:99]
v_mfma_f32_16x16x32_bf16 v[100:103], v[116:119], v[60:63], v[100:103]
v_mfma_f32_16x16x32_bf16 v[104:107], v[120:123], v[60:63], v[104:107]
v_mfma_f32_16x16x32_bf16 v[108:111], v[124:127], v[60:63], v[108:111]
buffer_load_dwordx4 v[60:63], v1, s[8:11], s24 offen offset:3072 sc1
s_waitcnt vmcnt(19)
v_mfma_f32_16x16x32_bf16 v[96:99], a[208:211], v[64:67], v[96:99]
ds_read_b64_tr_b16 v[112:113], v8 offset:28672
v_mfma_f32_16x16x32_bf16 v[100:103], a[212:215], v[64:67], v[100:103]
ds_read_b64_tr_b16 v[114:115], v8 offset:29696
v_mfma_f32_16x16x32_bf16 v[104:107], a[216:219], v[64:67], v[104:107]
ds_read_b64_tr_b16 v[116:117], v9 offset:28672
v_mfma_f32_16x16x32_bf16 v[108:111], a[220:223], v[64:67], v[108:111]
ds_read_b64_tr_b16 v[118:119], v9 offset:29696
s_add_u32 s24, s49, s34
buffer_load_dwordx4 v[64:67], v1, s[8:11], s24 offen offset:0 sc1
s_waitcnt vmcnt(19)
v_mfma_f32_16x16x32_bf16 v[96:99], a[224:227], v[68:71], v[96:99]
ds_read_b64_tr_b16 v[120:121], v10 offset:28672
v_mfma_f32_16x16x32_bf16 v[100:103], a[228:231], v[68:71], v[100:103]
ds_read_b64_tr_b16 v[122:123], v10 offset:29696
v_mfma_f32_16x16x32_bf16 v[104:107], a[232:235], v[68:71], v[104:107]
ds_read_b64_tr_b16 v[124:125], v11 offset:28672
v_mfma_f32_16x16x32_bf16 v[108:111], a[236:239], v[68:71], v[108:111]
ds_read_b64_tr_b16 v[126:127], v11 offset:29696
buffer_load_dwordx4 v[68:71], v1, s[8:11], s24 offen offset:1024 sc1
s_waitcnt vmcnt(19)
v_mfma_f32_16x16x32_bf16 v[96:99], a[240:243], v[72:75], v[96:99]
v_mfma_f32_16x16x32_bf16 v[100:103], a[244:247], v[72:75], v[100:103]
v_mfma_f32_16x16x32_bf16 v[104:107], a[248:251], v[72:75], v[104:107]
v_mfma_f32_16x16x32_bf16 v[108:111], a[252:255], v[72:75], v[108:111]
buffer_load_dwordx4 v[72:75], v1, s[8:11], s24 offen offset:2048 sc1
s_waitcnt vmcnt(19) lgkmcnt(0)
v_mfma_f32_16x16x32_bf16 v[96:99], v[112:115], v[76:79], v[96:99]
v_mfma_f32_16x16x32_bf16 v[100:103], v[116:119], v[76:79], v[100:103]
v_mfma_f32_16x16x32_bf16 v[104:107], v[120:123], v[76:79], v[104:107]
v_mfma_f32_16x16x32_bf16 v[108:111], v[124:127], v[76:79], v[108:111]
buffer_load_dwordx4 v[76:79], v1, s[8:11], s24 offen offset:3072 sc1
s_nop 3
ds_write_b128 v3, v[96:99] offset:0
ds_write_b128 v3, v[100:103] offset:4096
ds_write_b128 v3, v[104:107] offset:8192
ds_write_b128 v3, v[108:111] offset:12288
s_waitcnt lgkmcnt(0)
s_barrier
ds_read_b128 v[96:99], v7 offset:0
ds_read_b128 v[100:103], v7 offset:1024
ds_read_b128 v[104:107], v7 offset:2048
ds_read_b128 v[108:111], v7 offset:3072
ds_read_b64_tr_b16 v[112:113], v8 offset:0
ds_read_b64_tr_b16 v[114:115], v8 offset:1024
ds_read_b64_tr_b16 v[116:117], v9 offset:0
ds_read_b64_tr_b16 v[118:119], v9 offset:1024
ds_read_b64_tr_b16 v[120:121], v10 offset:0
ds_read_b64_tr_b16 v[122:123], v10 offset:1024
ds_read_b64_tr_b16 v[124:125], v11 offset:0
ds_read_b64_tr_b16 v[126:127], v11 offset:1024
s_mul_i32 s24, s41, 36864
s_waitcnt lgkmcnt(10)
v_pk_add_f32 v[96:97], v[96:97], v[100:101]
v_pk_add_f32 v[98:99], v[98:99], v[102:103]
s_waitcnt lgkmcnt(9)
v_pk_add_f32 v[96:97], v[96:97], v[104:105]
v_pk_add_f32 v[98:99], v[98:99], v[106:107]
s_waitcnt lgkmcnt(8)
v_pk_add_f32 v[96:97], v[96:97], v[108:109]
v_pk_add_f32 v[98:99], v[98:99], v[110:111]
v_cvt_pk_bf16_f32 v12, v96, v97
v_cvt_pk_bf16_f32 v13, v98, v99
buffer_store_dwordx2 v[12:13], v4, s[12:15], s24 offen
v_xor_b32 v3, 16384, v3
v_xor_b32 v7, 16384, v7
s_mov_b32 s41, s27
s_mov_b32 s48, s49
s_sub_u32 s42, s42, 1
s_cmp_eq_u32 s50, 0
s_cbranch_scc1 L_opl_c
L_opl_r3:
s_add_u32 s27, s41, s43
s_and_b32 s27, s27, 127
s_lshr_b32 s25, s27, s46
s_lshl_b32 s25, s25, 7
s_add_u32 s25, s25, s45
buffer_load_dword v6, v5, s[8:11], s25 offen sc1
s_lshl_b32 s49, s27, 17
s_add_u32 s49, s49, s44
s_waitcnt vmcnt(21)
v_mfma_f32_16x16x32_bf16 v[96:99], v[128:131], v[80:83], 0
v_mfma_f32_16x16x32_bf16 v[100:103], v[132:135], v[80:83], 0
v_mfma_f32_16x16x32_bf16 v[104:107], v[136:139], v[80:83], 0
v_mfma_f32_16x16x32_bf16 v[108:111], v[140:143], v[80:83], 0
s_add_u32 s24, s48, s35
buffer_load_dwordx4 v[80:83], v1, s[8:11], s24 offen offset:0 sc1
s_waitcnt vmcnt(21)
v_mfma_f32_16x16x32_bf16 v[96:99], v[144:147], v[84:87], v[96:99]
v_mfma_f32_16x16x32_bf16 v[100:103], v[148:151], v[84:87], v[100:103]
v_mfma_f32_16x16x32_bf16 v[104:107], v[152:155], v[84:87], v[104:107]
v_mfma_f32_16x16x32_bf16 v[108:111], v[156:159], v[84:87], v[108:111]
buffer_load_dwordx4 v[84:87], v1, s[8:11], s24 offen offset:1024 sc1
s_waitcnt vmcnt(21)
v_mfma_f32_16x16x32_bf16 v[96:99], v[160:163], v[88:91], v[96:99]
v_mfma_f32_16x16x32_bf16 v[100:103], v[164:167], v[88:91], v[100:103]
v_mfma_f32_16x16x32_bf16 v[104:107], v[168:171], v[88:91], v[104:107]
v_mfma_f32_16x16x32_bf16 v[108:111], v[172:175], v[88:91], v[108:111]
buffer_load_dwordx4 v[88:91], v1, s[8:11], s24 offen offset:2048 sc1
s_waitcnt vmcnt(21) lgkmcnt(0)
v_mfma_f32_16x16x32_bf16 v[96:99], v[112:115], v[92:95], v[96:99]
v_mfma_f32_16x16x32_bf16 v[100:103], v[116:119], v[92:95], v[100:103]
v_mfma_f32_16x16x32_bf16 v[104:107], v[120:123], v[92:95], v[104:107]
v_mfma_f32_16x16x32_bf16 v[108:111], v[124:127], v[92:95], v[108:111]
buffer_load_dwordx4 v[92:95], v1, s[8:11], s24 offen offset:3072 sc1
s_waitcnt vmcnt(21)
v_mfma_f32_16x16x32_bf16 v[96:99], v[176:179], v[16:19], v[96:99]
ds_read_b64_tr_b16 v[112:113], v8 offset:4096
v_mfma_f32_16x16x32_bf16 v[100:103], v[180:183], v[16:19], v[100:103]
ds_read_b64_tr_b16 v[114:115], v8 offset:5120
v_mfma_f32_16x16x32_bf16 v[104:107], v[184:187], v[16:19], v[104:107]
ds_read_b64_tr_b16 v[116:117], v9 offset:4096
v_mfma_f32_16x16x32_bf16 v[108:111], v[188:191], v[16:19], v[108:111]
ds_read_b64_tr_b16 v[118:119], v9 offset:5120
s_add_u32 s24, s48, s36
buffer_load_dwordx4 v[16:19], v1, s[8:11], s24 offen offset:0 sc1
s_waitcnt vmcnt(21)
v_mfma_f32_16x16x32_bf16 v[96:99], v[192:195], v[20:23], v[96:99]
ds_read_b64_tr_b16 v[120:121], v10 offset:4096
v_mfma_f32_16x16x32_bf16 v[100:103], v[196:199], v[20:23], v[100:103]
ds_read_b64_tr_b16 v[122:123], v10 offset:5120
v_mfma_f32_16x16x32_bf16 v[104:107], v[200:203], v[20:23], v[104:107]
ds_read_b64_tr_b16 v[124:125], v11 offset:4096
v_mfma_f32_16x16x32_bf16 v[108:111], v[204:207], v[20:23], v[108:111]
ds_read_b64_tr_b16 v[126:127], v11 offset:5120
buffer_load_dwordx4 v[20:23], v1, s[8:11], s24 offen offset:1024 sc1
s_waitcnt vmcnt(21)
v_mfma_f32_16x16x32_bf16 v[96:99], v[208:211], v[24:27], v[96:99]
v_mfma_f32_16x16x32_bf16 v[100:103], v[212:215], v[24:27], v[100:103]
v_mfma_f32_16x16x32_bf16 v[104:107], v[216:219], v[24:27], v[104:107]
v_mfma_f32_16x16x32_bf16 v[108:111], v[220:223], v[24:27], v[108:111]
buffer_load_dwordx4 v[24:27], v1, s[8:11], s24 offen offset:2048 sc1
s_waitcnt vmcnt(21) lgkmcnt(0)
v_mfma_f32_16x16x32_bf16 v[96:99], v[112:115], v[28:31], v[96:99]
v_mfma_f32_16x16x32_bf16 v[100:103], v[116:119], v[28:31], v[100:103]
v_mfma_f32_16x16x32_bf16 v[104:107], v[120:123], v[28:31], v[104:107]
v_mfma_f32_16x16x32_bf16 v[108:111], v[124:127], v[28:31], v[108:111]
buffer_load_dwordx4 v[28:31], v1, s[8:11], s24 offen offset:3072 sc1
s_waitcnt vmcnt(21)
v_mfma_f32_16x16x32_bf16 v[96:99], v[224:227], v[32:35], v[96:99]
ds_read_b64_tr_b16 v[112:113], v8 offset:8192
v_mfma_f32_16x16x32_bf16 v[100:103], v[228:231], v[32:35], v[100:103]
ds_read_b64_tr_b16 v[114:115], v8 offset:9216
v_mfma_f32_16x16x32_bf16 v[104:107], v[232:235], v[32:35], v[104:107]
ds_read_b64_tr_b16 v[116:117], v9 offset:8192
v_mfma_f32_16x16x32_bf16 v[108:111], v[236:239], v[32:35], v[108:111]
ds_read_b64_tr_b16 v[118:119], v9 offset:9216
s_add_u32 s24, s48, s37
buffer_load_dwordx4 v[32:35], v1, s[8:11], s24 offen offset:0 sc1
s_waitcnt vmcnt(21)
v_mfma_f32_16x16x32_bf16 v[96:99], v[240:243], v[36:39], v[96:99]
ds_read_b64_tr_b16 v[120:121], v10 offset:8192
v_mfma_f32_16x16x32_bf16 v[100:103], v[244:247], v[36:39], v[100:103]
ds_read_b64_tr_b16 v[122:123], v10 offset:9216
v_mfma_f32_16x16x32_bf16 v[104:107], v[248:251], v[36:39], v[104:107]
ds_read_b64_tr_b16 v[124:125], v11 offset:8192
v_mfma_f32_16x16x32_bf16 v[108:111], v[252:255], v[36:39], v[108:111]
ds_read_b64_tr_b16 v[126:127], v11 offset:9216
buffer_load_dwordx4 v[36:39], v1, s[8:11], s24 offen offset:1024 sc1
s_waitcnt vmcnt(21)
v_mfma_f32_16x16x32_bf16 v[96:99], a[0:3], v[40:43], v[96:99]
v_mfma_f32_16x16x32_bf16 v[100:103], a[4:7], v[40:43], v[100:103]
v_mfma_f32_16x16x32_bf16 v[104:107], a[8:11], v[40:43], v[104:107]
v_mfma_f32_16x16x32_bf16 v[108:111], a[12:15], v[40:43], v[108:111]
buffer_load_dwordx4 v[40:43], v1, s[8:11], s24 offen offset:2048 sc1
s_waitcnt vmcnt(21) lgkmcnt(0)
v_mfma_f32_16x16x32_bf16 v[96:99], v[112:115], v[44:47], v[96:99]
v_mfma_f32_16x16x32_bf16 v[100:103], v[116:119], v[44:47], v[100:103]
v_mfma_f32_16x16x32_bf16 v[104:107], v[120:123], v[44:47], v[104:107]
v_mfma_f32_16x16x32_bf16 v[108:111], v[124:127], v[44:47], v[108:111]
buffer_load_dwordx4 v[44:47], v1, s[8:11], s24 offen offset:3072 sc1
s_waitcnt vmcnt(21)
v_mfma_f32_16x16x32_bf16 v[96:99], a[16:19], v[48:51], v[96:99]
ds_read_b64_tr_b16 v[112:113], v8 offset:12288
v_mfma_f32_16x16x32_bf16 v[100:103], a[20:23], v[48:51], v[100:103]
ds_read_b64_tr_b16 v[114:115], v8 offset:13312
v_mfma_f32_16x16x32_bf16 v[104:107], a[24:27], v[48:51], v[104:107]
ds_read_b64_tr_b16 v[116:117], v9 offset:12288
v_mfma_f32_16x16x32_bf16 v[108:111], a[28:31], v[48:51], v[108:111]
ds_read_b64_tr_b16 v[118:119], v9 offset:13312
s_waitcnt vmcnt(12)
v_cmp_ne_u32 vcc, 1, v6
s_cmp_gt_u32 s42, 1
s_cselect_b32 s50, 1, 0
s_cmp_eq_u64 vcc, 0
s_cselect_b32 s50, s50, 0
s_cmp_eq_u32 s50, 1
s_cselect_b32 s49, s49, 536870912
s_add_u32 s24, s49, s30
buffer_load_dwordx4 v[48:51], v1, s[8:11], s24 offen offset:0 sc1
s_waitcnt vmcnt(21)
v_mfma_f32_16x16x32_bf16 v[96:99], a[32:35], v[52:55], v[96:99]
ds_read_b64_tr_b16 v[120:121], v10 offset:12288
v_mfma_f32_16x16x32_bf16 v[100:103], a[36:39], v[52:55], v[100:103]
ds_read_b64_tr_b16 v[122:123], v10 offset:13312
v_mfma_f32_16x16x32_bf16 v[104:107], a[40:43], v[52:55], v[104:107]
ds_read_b64_tr_b16 v[124:125], v11 offset:12288
v_mfma_f32_16x16x32_bf16 v[108:111], a[44:47], v[52:55], v[108:111]
ds_read_b64_tr_b16 v[126:127], v11 offset:13312
buffer_load_dwordx4 v[52:55], v1, s[8:11], s24 offen offset:1024 sc1
s_waitcnt vmcnt(21)
v_mfma_f32_16x16x32_bf16 v[96:99], a[48:51], v[56:59], v[96:99]
v_mfma_f32_16x16x32_bf16 v[100:103], a[52:55], v[56:59], v[100:103]
v_mfma_f32_16x16x32_bf16 v[104:107], a[56:59], v[56:59], v[104:107]
v_mfma_f32_16x16x32_bf16 v[108:111], a[60:63], v[56:59], v[108:111]
buffer_load_dwordx4 v[56:59], v1, s[8:11], s24 offen offset:2048 sc1
s_waitcnt vmcnt(21) lgkmcnt(0)
v_mfma_f32_16x16x32_bf16 v[96:99], v[112:115], v[60:63], v[96:99]
v_mfma_f32_16x16x32_bf16 v[100:103], v[116:119], v[60:63], v[100:103]
v_mfma_f32_16x16x32_bf16 v[104:107], v[120:123], v[60:63], v[104:107]
v_mfma_f32_16x16x32_bf16 v[108:111], v[124:127], v[60:63], v[108:111]
buffer_load_dwordx4 v[60:63], v1, s[8:11], s24 offen offset:3072 sc1
s_waitcnt vmcnt(21)
v_mfma_f32_16x16x32_bf16 v[96:99], a[64:67], v[64:67], v[96:99]
ds_read_b64_tr_b16 v[112:113], v8 offset:16384
v_mfma_f32_16x16x32_bf16 v[100:103], a[68:71], v[64:67], v[100:103]
ds_read_b64_tr_b16 v[114:115], v8 offset:17408
v_mfma_f32_16x16x32_bf16 v[104:107], a[72:75], v[64:67], v[104:107]
ds_read_b64_tr_b16 v[116:117], v9 offset:16384
v_mfma_f32_16x16x32_bf16 v[108:111], a[76:79], v[64:67], v[108:111]
ds_read_b64_tr_b16 v[118:119], v9 offset:17408
s_add_u32 s24, s49, s31
buffer_load_dwordx4 v[64:67], v1, s[8:11], s24 offen offset:0 sc1
s_waitcnt vmcnt(21)
v_mfma_f32_16x16x32_bf16 v[96:99], a[80:83], v[68:71], v[96:99]
ds_read_b64_tr_b16 v[120:121], v10 offset:16384
v_mfma_f32_16x16x32_bf16 v[100:103], a[84:87], v[68:71], v[100:103]
ds_read_b64_tr_b16 v[122:123], v10 offset:17408
v_mfma_f32_16x16x32_bf16 v[104:107], a[88:91], v[68:71], v[104:107]
ds_read_b64_tr_b16 v[124:125], v11 offset:16384
v_mfma_f32_16x16x32_bf16 v[108:111], a[92:95], v[68:71], v[108:111]
ds_read_b64_tr_b16 v[126:127], v11 offset:17408
buffer_load_dwordx4 v[68:71], v1, s[8:11], s24 offen offset:1024 sc1
s_waitcnt vmcnt(21)
v_mfma_f32_16x16x32_bf16 v[96:99], a[96:99], v[72:75], v[96:99]
v_mfma_f32_16x16x32_bf16 v[100:103], a[100:103], v[72:75], v[100:103]
v_mfma_f32_16x16x32_bf16 v[104:107], a[104:107], v[72:75], v[104:107]
v_mfma_f32_16x16x32_bf16 v[108:111], a[108:111], v[72:75], v[108:111]
buffer_load_dwordx4 v[72:75], v1, s[8:11], s24 offen offset:2048 sc1
s_waitcnt vmcnt(21) lgkmcnt(0)
v_mfma_f32_16x16x32_bf16 v[96:99], v[112:115], v[76:79], v[96:99]
v_mfma_f32_16x16x32_bf16 v[100:103], v[116:119], v[76:79], v[100:103]
v_mfma_f32_16x16x32_bf16 v[104:107], v[120:123], v[76:79], v[104:107]
v_mfma_f32_16x16x32_bf16 v[108:111], v[124:127], v[76:79], v[108:111]
buffer_load_dwordx4 v[76:79], v1, s[8:11], s24 offen offset:3072 sc1
s_waitcnt vmcnt(19)
v_mfma_f32_16x16x32_bf16 v[96:99], a[112:115], v[80:83], v[96:99]
ds_read_b64_tr_b16 v[112:113], v8 offset:20480
v_mfma_f32_16x16x32_bf16 v[100:103], a[116:119], v[80:83], v[100:103]
ds_read_b64_tr_b16 v[114:115], v8 offset:21504
v_mfma_f32_16x16x32_bf16 v[104:107], a[120:123], v[80:83], v[104:107]
ds_read_b64_tr_b16 v[116:117], v9 offset:20480
v_mfma_f32_16x16x32_bf16 v[108:111], a[124:127], v[80:83], v[108:111]
ds_read_b64_tr_b16 v[118:119], v9 offset:21504
s_add_u32 s24, s49, s32
buffer_load_dwordx4 v[80:83], v1, s[8:11], s24 offen offset:0 sc1
s_waitcnt vmcnt(19)
v_mfma_f32_16x16x32_bf16 v[96:99], a[128:131], v[84:87], v[96:99]
ds_read_b64_tr_b16 v[120:121], v10 offset:20480
v_mfma_f32_16x16x32_bf16 v[100:103], a[132:135], v[84:87], v[100:103]
ds_read_b64_tr_b16 v[122:123], v10 offset:21504
v_mfma_f32_16x16x32_bf16 v[104:107], a[136:139], v[84:87], v[104:107]
ds_read_b64_tr_b16 v[124:125], v11 offset:20480
v_mfma_f32_16x16x32_bf16 v[108:111], a[140:143], v[84:87], v[108:111]
ds_read_b64_tr_b16 v[126:127], v11 offset:21504
buffer_load_dwordx4 v[84:87], v1, s[8:11], s24 offen offset:1024 sc1
s_waitcnt vmcnt(19)
v_mfma_f32_16x16x32_bf16 v[96:99], a[144:147], v[88:91], v[96:99]
v_mfma_f32_16x16x32_bf16 v[100:103], a[148:151], v[88:91], v[100:103]
v_mfma_f32_16x16x32_bf16 v[104:107], a[152:155], v[88:91], v[104:107]
v_mfma_f32_16x16x32_bf16 v[108:111], a[156:159], v[88:91], v[108:111]
buffer_load_dwordx4 v[88:91], v1, s[8:11], s24 offen offset:2048 sc1
s_waitcnt vmcnt(19) lgkmcnt(0)
v_mfma_f32_16x16x32_bf16 v[96:99], v[112:115], v[92:95], v[96:99]
v_mfma_f32_16x16x32_bf16 v[100:103], v[116:119], v[92:95], v[100:103]
v_mfma_f32_16x16x32_bf16 v[104:107], v[120:123], v[92:95], v[104:107]
v_mfma_f32_16x16x32_bf16 v[108:111], v[124:127], v[92:95], v[108:111]
buffer_load_dwordx4 v[92:95], v1, s[8:11], s24 offen offset:3072 sc1
s_waitcnt vmcnt(19)
v_mfma_f32_16x16x32_bf16 v[96:99], a[160:163], v[16:19], v[96:99]
ds_read_b64_tr_b16 v[112:113], v8 offset:24576
v_mfma_f32_16x16x32_bf16 v[100:103], a[164:167], v[16:19], v[100:103]
ds_read_b64_tr_b16 v[114:115], v8 offset:25600
v_mfma_f32_16x16x32_bf16 v[104:107], a[168:171], v[16:19], v[104:107]
ds_read_b64_tr_b16 v[116:117], v9 offset:24576
v_mfma_f32_16x16x32_bf16 v[108:111], a[172:175], v[16:19], v[108:111]
ds_read_b64_tr_b16 v[118:119], v9 offset:25600
s_add_u32 s24, s49, s33
buffer_load_dwordx4 v[16:19], v1, s[8:11], s24 offen offset:0 sc1
s_waitcnt vmcnt(19)
v_mfma_f32_16x16x32_bf16 v[96:99], a[176:179], v[20:23], v[96:99]
ds_read_b64_tr_b16 v[120:121], v10 offset:24576
v_mfma_f32_16x16x32_bf16 v[100:103], a[180:183], v[20:23], v[100:103]
ds_read_b64_tr_b16 v[122:123], v10 offset:25600
v_mfma_f32_16x16x32_bf16 v[104:107], a[184:187], v[20:23], v[104:107]
ds_read_b64_tr_b16 v[124:125], v11 offset:24576
v_mfma_f32_16x16x32_bf16 v[108:111], a[188:191], v[20:23], v[108:111]
ds_read_b64_tr_b16 v[126:127], v11 offset:25600
buffer_load_dwordx4 v[20:23], v1, s[8:11], s24 offen offset:1024 sc1
s_waitcnt vmcnt(19)
v_mfma_f32_16x16x32_bf16 v[96:99], a[192:195], v[24:27], v[96:99]
v_mfma_f32_16x16x32_bf16 v[100:103], a[196:199], v[24:27], v[100:103]
v_mfma_f32_16x16x32_bf16 v[104:107], a[200:203], v[24:27], v[104:107]
v_mfma_f32_16x16x32_bf16 v[108:111], a[204:207], v[24:27], v[108:111]
buffer_load_dwordx4 v[24:27], v1, s[8:11], s24 offen offset:2048 sc1
s_waitcnt vmcnt(19) lgkmcnt(0)
v_mfma_f32_16x16x32_bf16 v[96:99], v[112:115], v[28:31], v[96:99]
v_mfma_f32_16x16x32_bf16 v[100:103], v[116:119], v[28:31], v[100:103]
v_mfma_f32_16x16x32_bf16 v[104:107], v[120:123], v[28:31], v[104:107]
v_mfma_f32_16x16x32_bf16 v[108:111], v[124:127], v[28:31], v[108:111]
buffer_load_dwordx4 v[28:31], v1, s[8:11], s24 offen offset:3072 sc1
s_waitcnt vmcnt(19)
v_mfma_f32_16x16x32_bf16 v[96:99], a[208:211], v[32:35], v[96:99]
ds_read_b64_tr_b16 v[112:113], v8 offset:28672
v_mfma_f32_16x16x32_bf16 v[100:103], a[212:215], v[32:35], v[100:103]
ds_read_b64_tr_b16 v[114:115], v8 offset:29696
v_mfma_f32_16x16x32_bf16 v[104:107], a[216:219], v[32:35], v[104:107]
ds_read_b64_tr_b16 v[116:117], v9 offset:28672
v_mfma_f32_16x16x32_bf16 v[108:111], a[220:223], v[32:35], v[108:111]
ds_read_b64_tr_b16 v[118:119], v9 offset:29696
s_add_u32 s24, s49, s34
buffer_load_dwordx4 v[32:35], v1, s[8:11], s24 offen offset:0 sc1
s_waitcnt vmcnt(19)
v_mfma_f32_16x16x32_bf16 v[96:99], a[224:227], v[36:39], v[96:99]
ds_read_b64_tr_b16 v[120:121], v10 offset:28672
v_mfma_f32_16x16x32_bf16 v[100:103], a[228:231], v[36:39], v[100:103]
ds_read_b64_tr_b16 v[122:123], v10 offset:29696
v_mfma_f32_16x16x32_bf16 v[104:107], a[232:235], v[36:39], v[104:107]
ds_read_b64_tr_b16 v[124:125], v11 offset:28672
v_mfma_f32_16x16x32_bf16 v[108:111], a[236:239], v[36:39], v[108:111]
ds_read_b64_tr_b16 v[126:127], v11 offset:29696
buffer_load_dwordx4 v[36:39], v1, s[8:11], s24 offen offset:1024 sc1
s_waitcnt vmcnt(19)
v_mfma_f32_16x16x32_bf16 v[96:99], a[240:243], v[40:43], v[96:99]
v_mfma_f32_16x16x32_bf16 v[100:103], a[244:247], v[40:43], v[100:103]
v_mfma_f32_16x16x32_bf16 v[104:107], a[248:251], v[40:43], v[104:107]
v_mfma_f32_16x16x32_bf16 v[108:111], a[252:255], v[40:43], v[108:111]
buffer_load_dwordx4 v[40:43], v1, s[8:11], s24 offen offset:2048 sc1
s_waitcnt vmcnt(19) lgkmcnt(0)
v_mfma_f32_16x16x32_bf16 v[96:99], v[112:115], v[44:47], v[96:99]
v_mfma_f32_16x16x32_bf16 v[100:103], v[116:119], v[44:47], v[100:103]
v_mfma_f32_16x16x32_bf16 v[104:107], v[120:123], v[44:47], v[104:107]
v_mfma_f32_16x16x32_bf16 v[108:111], v[124:127], v[44:47], v[108:111]
buffer_load_dwordx4 v[44:47], v1, s[8:11], s24 offen offset:3072 sc1
s_nop 3
ds_write_b128 v3, v[96:99] offset:0
ds_write_b128 v3, v[100:103] offset:4096
ds_write_b128 v3, v[104:107] offset:8192
ds_write_b128 v3, v[108:111] offset:12288
s_waitcnt lgkmcnt(0)
s_barrier
ds_read_b128 v[96:99], v7 offset:0
ds_read_b128 v[100:103], v7 offset:1024
ds_read_b128 v[104:107], v7 offset:2048
ds_read_b128 v[108:111], v7 offset:3072
ds_read_b64_tr_b16 v[112:113], v8 offset:0
ds_read_b64_tr_b16 v[114:115], v8 offset:1024
ds_read_b64_tr_b16 v[116:117], v9 offset:0
ds_read_b64_tr_b16 v[118:119], v9 offset:1024
ds_read_b64_tr_b16 v[120:121], v10 offset:0
ds_read_b64_tr_b16 v[122:123], v10 offset:1024
ds_read_b64_tr_b16 v[124:125], v11 offset:0
ds_read_b64_tr_b16 v[126:127], v11 offset:1024
s_mul_i32 s24, s41, 36864
s_waitcnt lgkmcnt(10)
v_pk_add_f32 v[96:97], v[96:97], v[100:101]
v_pk_add_f32 v[98:99], v[98:99], v[102:103]
s_waitcnt lgkmcnt(9)
v_pk_add_f32 v[96:97], v[96:97], v[104:105]
v_pk_add_f32 v[98:99], v[98:99], v[106:107]
s_waitcnt lgkmcnt(8)
v_pk_add_f32 v[96:97], v[96:97], v[108:109]
v_pk_add_f32 v[98:99], v[98:99], v[110:111]
v_cvt_pk_bf16_f32 v12, v96, v97
v_cvt_pk_bf16_f32 v13, v98, v99
buffer_store_dwordx2 v[12:13], v4, s[12:15], s24 offen
v_xor_b32 v3, 16384, v3
v_xor_b32 v7, 16384, v7
s_mov_b32 s41, s27
s_mov_b32 s48, s49
s_sub_u32 s42, s42, 1
s_cmp_eq_u32 s50, 0
s_cbranch_scc1 L_opl_c
L_opl_r4:
s_add_u32 s27, s41, s43
s_and_b32 s27, s27, 127
s_lshr_b32 s25, s27, s46
s_lshl_b32 s25, s25, 7
s_add_u32 s25, s25, s45
buffer_load_dword v6, v5, s[8:11], s25 offen sc1
s_lshl_b32 s49, s27, 17
s_add_u32 s49, s49, s44
s_waitcnt vmcnt(21)
v_mfma_f32_16x16x32_bf16 v[96:99], v[128:131], v[48:51], 0
v_mfma_f32_16x16x32_bf16 v[100:103], v[132:135], v[48:51], 0
v_mfma_f32_16x16x32_bf16 v[104:107], v[136:139], v[48:51], 0
v_mfma_f32_16x16x32_bf16 v[108:111], v[140:143], v[48:51], 0
s_add_u32 s24, s48, s35
buffer_load_dwordx4 v[48:51], v1, s[8:11], s24 offen offset:0 sc1
s_waitcnt vmcnt(21)
v_mfma_f32_16x16x32_bf16 v[96:99], v[144:147], v[52:55], v[96:99]
v_mfma_f32_16x16x32_bf16 v[100:103], v[148:151], v[52:55], v[100:103]
v_mfma_f32_16x16x32_bf16 v[104:107], v[152:155], v[52:55], v[104:107]
v_mfma_f32_16x16x32_bf16 v[108:111], v[156:159], v[52:55], v[108:111]
buffer_load_dwordx4 v[52:55], v1, s[8:11], s24 offen offset:1024 sc1
s_waitcnt vmcnt(21)
v_mfma_f32_16x16x32_bf16 v[96:99], v[160:163], v[56:59], v[96:99]
v_mfma_f32_16x16x32_bf16 v[100:103], v[164:167], v[56:59], v[100:103]
v_mfma_f32_16x16x32_bf16 v[104:107], v[168:171], v[56:59], v[104:107]
v_mfma_f32_16x16x32_bf16 v[108:111], v[172:175], v[56:59], v[108:111]
buffer_load_dwordx4 v[56:59], v1, s[8:11], s24 offen offset:2048 sc1
s_waitcnt vmcnt(21) lgkmcnt(0)
v_mfma_f32_16x16x32_bf16 v[96:99], v[112:115], v[60:63], v[96:99]
v_mfma_f32_16x16x32_bf16 v[100:103], v[116:119], v[60:63], v[100:103]
v_mfma_f32_16x16x32_bf16 v[104:107], v[120:123], v[60:63], v[104:107]
v_mfma_f32_16x16x32_bf16 v[108:111], v[124:127], v[60:63], v[108:111]
buffer_load_dwordx4 v[60:63], v1, s[8:11], s24 offen offset:3072 sc1
s_waitcnt vmcnt(21)
v_mfma_f32_16x16x32_bf16 v[96:99], v[176:179], v[64:67], v[96:99]
ds_read_b64_tr_b16 v[112:113], v8 offset:4096
v_mfma_f32_16x16x32_bf16 v[100:103], v[180:183], v[64:67], v[100:103]
ds_read_b64_tr_b16 v[114:115], v8 offset:5120
v_mfma_f32_16x16x32_bf16 v[104:107], v[184:187], v[64:67], v[104:107]
ds_read_b64_tr_b16 v[116:117], v9 offset:4096
v_mfma_f32_16x16x32_bf16 v[108:111], v[188:191], v[64:67], v[108:111]
ds_read_b64_tr_b16 v[118:119], v9 offset:5120
s_add_u32 s24, s48, s36
buffer_load_dwordx4 v[64:67], v1, s[8:11], s24 offen offset:0 sc1
s_waitcnt vmcnt(21)
v_mfma_f32_16x16x32_bf16 v[96:99], v[192:195], v[68:71], v[96:99]
ds_read_b64_tr_b16 v[120:121], v10 offset:4096
v_mfma_f32_16x16x32_bf16 v[100:103], v[196:199], v[68:71], v[100:103]
ds_read_b64_tr_b16 v[122:123], v10 offset:5120
v_mfma_f32_16x16x32_bf16 v[104:107], v[200:203], v[68:71], v[104:107]
ds_read_b64_tr_b16 v[124:125], v11 offset:4096
v_mfma_f32_16x16x32_bf16 v[108:111], v[204:207], v[68:71], v[108:111]
ds_read_b64_tr_b16 v[126:127], v11 offset:5120
buffer_load_dwordx4 v[68:71], v1, s[8:11], s24 offen offset:1024 sc1
s_waitcnt vmcnt(21)
v_mfma_f32_16x16x32_bf16 v[96:99], v[208:211], v[72:75], v[96:99]
v_mfma_f32_16x16x32_bf16 v[100:103], v[212:215], v[72:75], v[100:103]
v_mfma_f32_16x16x32_bf16 v[104:107], v[216:219], v[72:75], v[104:107]
v_mfma_f32_16x16x32_bf16 v[108:111], v[220:223], v[72:75], v[108:111]
buffer_load_dwordx4 v[72:75], v1, s[8:11], s24 offen offset:2048 sc1
s_waitcnt vmcnt(21) lgkmcnt(0)
v_mfma_f32_16x16x32_bf16 v[96:99], v[112:115], v[76:79], v[96:99]
v_mfma_f32_16x16x32_bf16 v[100:103], v[116:119], v[76:79], v[100:103]
v_mfma_f32_16x16x32_bf16 v[104:107], v[120:123], v[76:79], v[104:107]
v_mfma_f32_16x16x32_bf16 v[108:111], v[124:127], v[76:79], v[108:111]
buffer_load_dwordx4 v[76:79], v1, s[8:11], s24 offen offset:3072 sc1
s_waitcnt vmcnt(21)
v_mfma_f32_16x16x32_bf16 v[96:99], v[224:227], v[80:83], v[96:99]
ds_read_b64_tr_b16 v[112:113], v8 offset:8192
v_mfma_f32_16x16x32_bf16 v[100:103], v[228:231], v[80:83], v[100:103]
ds_read_b64_tr_b16 v[114:115], v8 offset:9216
v_mfma_f32_16x16x32_bf16 v[104:107], v[232:235], v[80:83], v[104:107]
ds_read_b64_tr_b16 v[116:117], v9 offset:8192
v_mfma_f32_16x16x32_bf16 v[108:111], v[236:239], v[80:83], v[108:111]
ds_read_b64_tr_b16 v[118:119], v9 offset:9216
s_add_u32 s24, s48, s37
buffer_load_dwordx4 v[80:83], v1, s[8:11], s24 offen offset:0 sc1
s_waitcnt vmcnt(21)
v_mfma_f32_16x16x32_bf16 v[96:99], v[240:243], v[84:87], v[96:99]
ds_read_b64_tr_b16 v[120:121], v10 offset:8192
v_mfma_f32_16x16x32_bf16 v[100:103], v[244:247], v[84:87], v[100:103]
ds_read_b64_tr_b16 v[122:123], v10 offset:9216
v_mfma_f32_16x16x32_bf16 v[104:107], v[248:251], v[84:87], v[104:107]
ds_read_b64_tr_b16 v[124:125], v11 offset:8192
v_mfma_f32_16x16x32_bf16 v[108:111], v[252:255], v[84:87], v[108:111]
ds_read_b64_tr_b16 v[126:127], v11 offset:9216
buffer_load_dwordx4 v[84:87], v1, s[8:11], s24 offen offset:1024 sc1
s_waitcnt vmcnt(21)
v_mfma_f32_16x16x32_bf16 v[96:99], a[0:3], v[88:91], v[96:99]
v_mfma_f32_16x16x32_bf16 v[100:103], a[4:7], v[88:91], v[100:103]
v_mfma_f32_16x16x32_bf16 v[104:107], a[8:11], v[88:91], v[104:107]
v_mfma_f32_16x16x32_bf16 v[108:111], a[12:15], v[88:91], v[108:111]
buffer_load_dwordx4 v[88:91], v1, s[8:11], s24 offen offset:2048 sc1
s_waitcnt vmcnt(21) lgkmcnt(0)
v_mfma_f32_16x16x32_bf16 v[96:99], v[112:115], v[92:95], v[96:99]
v_mfma_f32_16x16x32_bf16 v[100:103], v[116:119], v[92:95], v[100:103]
v_mfma_f32_16x16x32_bf16 v[104:107], v[120:123], v[92:95], v[104:107]
v_mfma_f32_16x16x32_bf16 v[108:111], v[124:127], v[92:95], v[108:111]
buffer_load_dwordx4 v[92:95], v1, s[8:11], s24 offen offset:3072 sc1
s_waitcnt vmcnt(21)
v_mfma_f32_16x16x32_bf16 v[96:99], a[16:19], v[16:19], v[96:99]
ds_read_b64_tr_b16 v[112:113], v8 offset:12288
v_mfma_f32_16x16x32_bf16 v[100:103], a[20:23], v[16:19], v[100:103]
ds_read_b64_tr_b16 v[114:115], v8 offset:13312
v_mfma_f32_16x16x32_bf16 v[104:107], a[24:27], v[16:19], v[104:107]
ds_read_b64_tr_b16 v[116:117], v9 offset:12288
v_mfma_f32_16x16x32_bf16 v[108:111], a[28:31], v[16:19], v[108:111]
ds_read_b64_tr_b16 v[118:119], v9 offset:13312
s_waitcnt vmcnt(12)
v_cmp_ne_u32 vcc, 1, v6
s_cmp_gt_u32 s42, 1
s_cselect_b32 s50, 1, 0
s_cmp_eq_u64 vcc, 0
s_cselect_b32 s50, s50, 0
s_cmp_eq_u32 s50, 1
s_cselect_b32 s49, s49, 536870912
s_add_u32 s24, s49, s30
buffer_load_dwordx4 v[16:19], v1, s[8:11], s24 offen offset:0 sc1
s_waitcnt vmcnt(21)
v_mfma_f32_16x16x32_bf16 v[96:99], a[32:35], v[20:23], v[96:99]
ds_read_b64_tr_b16 v[120:121], v10 offset:12288
v_mfma_f32_16x16x32_bf16 v[100:103], a[36:39], v[20:23], v[100:103]
ds_read_b64_tr_b16 v[122:123], v10 offset:13312
v_mfma_f32_16x16x32_bf16 v[104:107], a[40:43], v[20:23], v[104:107]
ds_read_b64_tr_b16 v[124:125], v11 offset:12288
v_mfma_f32_16x16x32_bf16 v[108:111], a[44:47], v[20:23], v[108:111]
ds_read_b64_tr_b16 v[126:127], v11 offset:13312
buffer_load_dwordx4 v[20:23], v1, s[8:11], s24 offen offset:1024 sc1
s_waitcnt vmcnt(21)
v_mfma_f32_16x16x32_bf16 v[96:99], a[48:51], v[24:27], v[96:99]
v_mfma_f32_16x16x32_bf16 v[100:103], a[52:55], v[24:27], v[100:103]
v_mfma_f32_16x16x32_bf16 v[104:107], a[56:59], v[24:27], v[104:107]
v_mfma_f32_16x16x32_bf16 v[108:111], a[60:63], v[24:27], v[108:111]
buffer_load_dwordx4 v[24:27], v1, s[8:11], s24 offen offset:2048 sc1
s_waitcnt vmcnt(21) lgkmcnt(0)
v_mfma_f32_16x16x32_bf16 v[96:99], v[112:115], v[28:31], v[96:99]
v_mfma_f32_16x16x32_bf16 v[100:103], v[116:119], v[28:31], v[100:103]
v_mfma_f32_16x16x32_bf16 v[104:107], v[120:123], v[28:31], v[104:107]
v_mfma_f32_16x16x32_bf16 v[108:111], v[124:127], v[28:31], v[108:111]
buffer_load_dwordx4 v[28:31], v1, s[8:11], s24 offen offset:3072 sc1
s_waitcnt vmcnt(21)
v_mfma_f32_16x16x32_bf16 v[96:99], a[64:67], v[32:35], v[96:99]
ds_read_b64_tr_b16 v[112:113], v8 offset:16384
v_mfma_f32_16x16x32_bf16 v[100:103], a[68:71], v[32:35], v[100:103]
ds_read_b64_tr_b16 v[114:115], v8 offset:17408
v_mfma_f32_16x16x32_bf16 v[104:107], a[72:75], v[32:35], v[104:107]
ds_read_b64_tr_b16 v[116:117], v9 offset:16384
v_mfma_f32_16x16x32_bf16 v[108:111], a[76:79], v[32:35], v[108:111]
ds_read_b64_tr_b16 v[118:119], v9 offset:17408
s_add_u32 s24, s49, s31
buffer_load_dwordx4 v[32:35], v1, s[8:11], s24 offen offset:0 sc1
s_waitcnt vmcnt(21)
v_mfma_f32_16x16x32_bf16 v[96:99], a[80:83], v[36:39], v[96:99]
ds_read_b64_tr_b16 v[120:121], v10 offset:16384
v_mfma_f32_16x16x32_bf16 v[100:103], a[84:87], v[36:39], v[100:103]
ds_read_b64_tr_b16 v[122:123], v10 offset:17408
v_mfma_f32_16x16x32_bf16 v[104:107], a[88:91], v[36:39], v[104:107]
ds_read_b64_tr_b16 v[124:125], v11 offset:16384
v_mfma_f32_16x16x32_bf16 v[108:111], a[92:95], v[36:39], v[108:111]
ds_read_b64_tr_b16 v[126:127], v11 offset:17408
buffer_load_dwordx4 v[36:39], v1, s[8:11], s24 offen offset:1024 sc1
s_waitcnt vmcnt(21)
v_mfma_f32_16x16x32_bf16 v[96:99], a[96:99], v[40:43], v[96:99]
v_mfma_f32_16x16x32_bf16 v[100:103], a[100:103], v[40:43], v[100:103]
v_mfma_f32_16x16x32_bf16 v[104:107], a[104:107], v[40:43], v[104:107]
v_mfma_f32_16x16x32_bf16 v[108:111], a[108:111], v[40:43], v[108:111]
buffer_load_dwordx4 v[40:43], v1, s[8:11], s24 offen offset:2048 sc1
s_waitcnt vmcnt(21) lgkmcnt(0)
v_mfma_f32_16x16x32_bf16 v[96:99], v[112:115], v[44:47], v[96:99]
v_mfma_f32_16x16x32_bf16 v[100:103], v[116:119], v[44:47], v[100:103]
v_mfma_f32_16x16x32_bf16 v[104:107], v[120:123], v[44:47], v[104:107]
v_mfma_f32_16x16x32_bf16 v[108:111], v[124:127], v[44:47], v[108:111]
buffer_load_dwordx4 v[44:47], v1, s[8:11], s24 offen offset:3072 sc1
s_waitcnt vmcnt(19)
v_mfma_f32_16x16x32_bf16 v[96:99], a[112:115], v[48:51], v[96:99]
ds_read_b64_tr_b16 v[112:113], v8 offset:20480
v_mfma_f32_16x16x32_bf16 v[100:103], a[116:119], v[48:51], v[100:103]
ds_read_b64_tr_b16 v[114:115], v8 offset:21504
v_mfma_f32_16x16x32_bf16 v[104:107], a[120:123], v[48:51], v[104:107]
ds_read_b64_tr_b16 v[116:117], v9 offset:20480
v_mfma_f32_16x16x32_bf16 v[108:111], a[124:127], v[48:51], v[108:111]
ds_read_b64_tr_b16 v[118:119], v9 offset:21504
s_add_u32 s24, s49, s32
buffer_load_dwordx4 v[48:51], v1, s[8:11], s24 offen offset:0 sc1
s_waitcnt vmcnt(19)
v_mfma_f32_16x16x32_bf16 v[96:99], a[128:131], v[52:55], v[96:99]
ds_read_b64_tr_b16 v[120:121], v10 offset:20480
v_mfma_f32_16x16x32_bf16 v[100:103], a[132:135], v[52:55], v[100:103]
ds_read_b64_tr_b16 v[122:123], v10 offset:21504
v_mfma_f32_16x16x32_bf16 v[104:107], a[136:139], v[52:55], v[104:107]
ds_read_b64_tr_b16 v[124:125], v11 offset:20480
v_mfma_f32_16x16x32_bf16 v[108:111], a[140:143], v[52:55], v[108:111]
ds_read_b64_tr_b16 v[126:127], v11 offset:21504
buffer_load_dwordx4 v[52:55], v1, s[8:11], s24 offen offset:1024 sc1
s_waitcnt vmcnt(19)
v_mfma_f32_16x16x32_bf16 v[96:99], a[144:147], v[56:59], v[96:99]
v_mfma_f32_16x16x32_bf16 v[100:103], a[148:151], v[56:59], v[100:103]
v_mfma_f32_16x16x32_bf16 v[104:107], a[152:155], v[56:59], v[104:107]
v_mfma_f32_16x16x32_bf16 v[108:111], a[156:159], v[56:59], v[108:111]
buffer_load_dwordx4 v[56:59], v1, s[8:11], s24 offen offset:2048 sc1
s_waitcnt vmcnt(19) lgkmcnt(0)
v_mfma_f32_16x16x32_bf16 v[96:99], v[112:115], v[60:63], v[96:99]
v_mfma_f32_16x16x32_bf16 v[100:103], v[116:119], v[60:63], v[100:103]
v_mfma_f32_16x16x32_bf16 v[104:107], v[120:123], v[60:63], v[104:107]
v_mfma_f32_16x16x32_bf16 v[108:111], v[124:127], v[60:63], v[108:111]
buffer_load_dwordx4 v[60:63], v1, s[8:11], s24 offen offset:3072 sc1
s_waitcnt vmcnt(19)
v_mfma_f32_16x16x32_bf16 v[96:99], a[160:163], v[64:67], v[96:99]
ds_read_b64_tr_b16 v[112:113], v8 offset:24576
v_mfma_f32_16x16x32_bf16 v[100:103], a[164:167], v[64:67], v[100:103]
ds_read_b64_tr_b16 v[114:115], v8 offset:25600
v_mfma_f32_16x16x32_bf16 v[104:107], a[168:171], v[64:67], v[104:107]
ds_read_b64_tr_b16 v[116:117], v9 offset:24576
v_mfma_f32_16x16x32_bf16 v[108:111], a[172:175], v[64:67], v[108:111]
ds_read_b64_tr_b16 v[118:119], v9 offset:25600
s_add_u32 s24, s49, s33
buffer_load_dwordx4 v[64:67], v1, s[8:11], s24 offen offset:0 sc1
s_waitcnt vmcnt(19)
v_mfma_f32_16x16x32_bf16 v[96:99], a[176:179], v[68:71], v[96:99]
ds_read_b64_tr_b16 v[120:121], v10 offset:24576
v_mfma_f32_16x16x32_bf16 v[100:103], a[180:183], v[68:71], v[100:103]
ds_read_b64_tr_b16 v[122:123], v10 offset:25600
v_mfma_f32_16x16x32_bf16 v[104:107], a[184:187], v[68:71], v[104:107]
ds_read_b64_tr_b16 v[124:125], v11 offset:24576
v_mfma_f32_16x16x32_bf16 v[108:111], a[188:191], v[68:71], v[108:111]
ds_read_b64_tr_b16 v[126:127], v11 offset:25600
buffer_load_dwordx4 v[68:71], v1, s[8:11], s24 offen offset:1024 sc1
s_waitcnt vmcnt(19)
v_mfma_f32_16x16x32_bf16 v[96:99], a[192:195], v[72:75], v[96:99]
v_mfma_f32_16x16x32_bf16 v[100:103], a[196:199], v[72:75], v[100:103]
v_mfma_f32_16x16x32_bf16 v[104:107], a[200:203], v[72:75], v[104:107]
v_mfma_f32_16x16x32_bf16 v[108:111], a[204:207], v[72:75], v[108:111]
buffer_load_dwordx4 v[72:75], v1, s[8:11], s24 offen offset:2048 sc1
s_waitcnt vmcnt(19) lgkmcnt(0)
v_mfma_f32_16x16x32_bf16 v[96:99], v[112:115], v[76:79], v[96:99]
v_mfma_f32_16x16x32_bf16 v[100:103], v[116:119], v[76:79], v[100:103]
v_mfma_f32_16x16x32_bf16 v[104:107], v[120:123], v[76:79], v[104:107]
v_mfma_f32_16x16x32_bf16 v[108:111], v[124:127], v[76:79], v[108:111]
buffer_load_dwordx4 v[76:79], v1, s[8:11], s24 offen offset:3072 sc1
s_waitcnt vmcnt(19)
v_mfma_f32_16x16x32_bf16 v[96:99], a[208:211], v[80:83], v[96:99]
ds_read_b64_tr_b16 v[112:113], v8 offset:28672
v_mfma_f32_16x16x32_bf16 v[100:103], a[212:215], v[80:83], v[100:103]
ds_read_b64_tr_b16 v[114:115], v8 offset:29696
v_mfma_f32_16x16x32_bf16 v[104:107], a[216:219], v[80:83], v[104:107]
ds_read_b64_tr_b16 v[116:117], v9 offset:28672
v_mfma_f32_16x16x32_bf16 v[108:111], a[220:223], v[80:83], v[108:111]
ds_read_b64_tr_b16 v[118:119], v9 offset:29696
s_add_u32 s24, s49, s34
buffer_load_dwordx4 v[80:83], v1, s[8:11], s24 offen offset:0 sc1
s_waitcnt vmcnt(19)
v_mfma_f32_16x16x32_bf16 v[96:99], a[224:227], v[84:87], v[96:99]
ds_read_b64_tr_b16 v[120:121], v10 offset:28672
v_mfma_f32_16x16x32_bf16 v[100:103], a[228:231], v[84:87], v[100:103]
ds_read_b64_tr_b16 v[122:123], v10 offset:29696
v_mfma_f32_16x16x32_bf16 v[104:107], a[232:235], v[84:87], v[104:107]
ds_read_b64_tr_b16 v[124:125], v11 offset:28672
v_mfma_f32_16x16x32_bf16 v[108:111], a[236:239], v[84:87], v[108:111]
ds_read_b64_tr_b16 v[126:127], v11 offset:29696
buffer_load_dwordx4 v[84:87], v1, s[8:11], s24 offen offset:1024 sc1
s_waitcnt vmcnt(19)
v_mfma_f32_16x16x32_bf16 v[96:99], a[240:243], v[88:91], v[96:99]
v_mfma_f32_16x16x32_bf16 v[100:103], a[244:247], v[88:91], v[100:103]
v_mfma_f32_16x16x32_bf16 v[104:107], a[248:251], v[88:91], v[104:107]
v_mfma_f32_16x16x32_bf16 v[108:111], a[252:255], v[88:91], v[108:111]
buffer_load_dwordx4 v[88:91], v1, s[8:11], s24 offen offset:2048 sc1
s_waitcnt vmcnt(19) lgkmcnt(0)
v_mfma_f32_16x16x32_bf16 v[96:99], v[112:115], v[92:95], v[96:99]
v_mfma_f32_16x16x32_bf16 v[100:103], v[116:119], v[92:95], v[100:103]
v_mfma_f32_16x16x32_bf16 v[104:107], v[120:123], v[92:95], v[104:107]
v_mfma_f32_16x16x32_bf16 v[108:111], v[124:127], v[92:95], v[108:111]
buffer_load_dwordx4 v[92:95], v1, s[8:11], s24 offen offset:3072 sc1
s_nop 3
ds_write_b128 v3, v[96:99] offset:0
ds_write_b128 v3, v[100:103] offset:4096
ds_write_b128 v3, v[104:107] offset:8192
ds_write_b128 v3, v[108:111] offset:12288
s_waitcnt lgkmcnt(0)
s_barrier
ds_read_b128 v[96:99], v7 offset:0
ds_read_b128 v[100:103], v7 offset:1024
ds_read_b128 v[104:107], v7 offset:2048
ds_read_b128 v[108:111], v7 offset:3072
ds_read_b64_tr_b16 v[112:113], v8 offset:0
ds_read_b64_tr_b16 v[114:115], v8 offset:1024
ds_read_b64_tr_b16 v[116:117], v9 offset:0
ds_read_b64_tr_b16 v[118:119], v9 offset:1024
ds_read_b64_tr_b16 v[120:121], v10 offset:0
ds_read_b64_tr_b16 v[122:123], v10 offset:1024
ds_read_b64_tr_b16 v[124:125], v11 offset:0
ds_read_b64_tr_b16 v[126:127], v11 offset:1024
s_mul_i32 s24, s41, 36864
s_waitcnt lgkmcnt(10)
v_pk_add_f32 v[96:97], v[96:97], v[100:101]
v_pk_add_f32 v[98:99], v[98:99], v[102:103]
s_waitcnt lgkmcnt(9)
v_pk_add_f32 v[96:97], v[96:97], v[104:105]
v_pk_add_f32 v[98:99], v[98:99], v[106:107]
s_waitcnt lgkmcnt(8)
v_pk_add_f32 v[96:97], v[96:97], v[108:109]
v_pk_add_f32 v[98:99], v[98:99], v[110:111]
v_cvt_pk_bf16_f32 v12, v96, v97
v_cvt_pk_bf16_f32 v13, v98, v99
buffer_store_dwordx2 v[12:13], v4, s[12:15], s24 offen
v_xor_b32 v3, 16384, v3
v_xor_b32 v7, 16384, v7
s_mov_b32 s41, s27
s_mov_b32 s48, s49
s_sub_u32 s42, s42, 1
s_cmp_eq_u32 s50, 0
s_cbranch_scc1 L_opl_c
s_branch L_opl_r0
L_opl_c:
s_cmp_lg_u32 s42, 0
s_cbranch_scc1 L_opl_w
s_waitcnt lgkmcnt(0)
s_branch L_done
L_team:
v_mov_b32 v12, v0
v_and_b32 v13, 15, v0
v_bfe_u32 v14, v0, 4, 2
v_lshlrev_b32 v1, 4, v12
v_and_b32 v2, 0x3f0, v1
s_mul_i32 s20, s17, 34816
s_add_u32 s20, s20, 24576
v_add_u32 v2, s20, v2
v_and_b32 v15, 1, v12
v_mul_u32_u24 v0, 0xaaaa, v15
v_add_u32 v0, 0xffff4444, v0
v_lshrrev_b32 v18, 2, v13
v_lshl_add_u32 v18, v18, 1, v15
v_bfe_u32 v19, v13, 1, 1
v_lshrrev_b32 v16, 5, v12
v_lshlrev_b32 v16, 8, v16
v_lshl_add_u32 v16, v18, 5, v16
v_and_b32 v17, 1, v14
v_lshl_add_u32 v16, v17, 4, v16
v_and_b32 v17, 0x7f, v16
v_xor_b32 v17, 16, v17
v_add_u32 v16, 4224, v16
v_add_u32 v17, 6272, v17
v_cmp_eq_u32 vcc, 1, v19
s_nop 1
v_cndmask_b32 v7, v17, v16, vcc
v_and_b32 v16, 1, v14
v_xor_b32 v16, v18, v16
v_and_b32 v17, 2, v14
v_lshlrev_b32 v17, 1, v17
v_xor_b32 v16, v16, v17
v_lshlrev_b32 v16, 4, v16
v_lshl_add_u32 v16, v14, 7, v16
v_mul_u32_u24 v17, 2176, v19
v_add_u32 v16, v16, v17
v_add_u32 v5, 0, v16
v_bfe_u32 v20, v13, 3, 1
v_bfe_u32 v21, v13, 1, 1
v_lshlrev_b32 v16, 1, v14
v_xor_b32 v16, v16, v21
v_lshlrev_b32 v17, 2, v20
v_xor_b32 v16, v16, v17
v_lshlrev_b32 v16, 4, v16
v_lshl_add_u32 v16, v20, 8, v16
v_lshl_add_u32 v16, v21, 7, v16
v_bfe_u32 v17, v13, 2, 1
v_lshl_add_u32 v16, v17, 3, v16
v_lshl_add_u32 v16, v15, 2, v16
s_lshl_b32 s20, s17, 9
s_add_u32 s20, s20, 0
v_add_u32 v4, s20, v16
v_xor_b32 v3, 16, v4
v_lshrrev_b32 v16, 4, v12
v_xor_b32 v17, s16, v16
v_lshlrev_b32 v16, 12, v16
v_lshl_add_u32 v16, v17, 7, v16
v_lshl_add_u32 v9, v13, 3, v16
s_lshr_b32 s20, s17, 1
s_lshl_b32 s20, s20, 2
v_add_u32 v16, s20, v14
v_xor_b32 v17, s16, v16
v_lshlrev_b32 v16, 12, v16
v_lshl_add_u32 v16, v17, 7, v16
v_lshl_add_u32 v16, v13, 2, v16
s_and_b32 s20, s17, 1
s_lshl_b32 s20, s20, 6
s_add_u32 s20, s20, 262144
v_add_u32 v10, s20, v16
v_bfe_u32 v16, v13, 2, 1
v_lshlrev_b32 v16, 5, v16
v_and_b32 v17, 1, v14
v_lshl_add_u32 v16, v17, 8, v16
v_lshrrev_b32 v17, 1, v14
v_lshl_add_u32 v16, v17, 4, v16
v_and_b32 v17, 3, v13
v_lshl_add_u32 v11, v17, 2, v16
v_lshlrev_b32 v6, 6, v12
v_lshlrev_b32 v8, 2, v12
s_mov_b32 s36, 0x11111111
s_mov_b32 s37, 0x11111111
s_mov_b32 s38, 0x22222222
s_mov_b32 s39, 0x22222222
s_mov_b32 s40, 0x44444444
s_mov_b32 s41, 0x44444444
s_mov_b32 s42, 0x88888888
s_mov_b32 s43, 0x88888888
s_mov_b32 s44, 0xf0f0f0f0
s_mov_b32 s45, 0xf0f0f0f0
s_mov_b32 s18, 0x3e0293ee
s_lshl_b32 s20, s17, 5
s_add_u32 s20, s20, s16
s_cmp_lt_u32 s20, 72
s_cselect_b32 s48, 1, 0
s_lshl_b32 s23, s20, 12
s_lshl_b32 s21, s17, 10
s_sub_u32 s23, s23, s21
s_lshr_b32 s24, s20, 2
s_lshl_b32 s24, s24, 9
s_and_b32 s21, s20, 3
s_lshl_b32 s21, s21, 6
s_add_u32 s24, s24, s21
s_add_u32 s24, s24, 110100480
s_cmp_lt_u32 s20, 72
s_cselect_b32 s24, s24, 536870912
s_lshl_b32 s25, s16, 12
s_add_u32 s26, s25, 131072
s_add_u32 s27, s25, 262144
s_cmp_lt_u32 s16, 8
s_cselect_b32 s27, s27, 536870912
s_mov_b32 s28, 109051904
s_mov_b32 s29, 109346816
s_lshl_b32 s30, s16, 20
s_add_u32 s30, s30, 33554432
s_lshl_b32 s31, s16, 12
s_add_u32 s31, s31, 100663296
s_add_u32 s35, s24, 32768
s_mov_b32 s53, 0x3f803f80
s_mov_b32 s86, 0x33333333
s_mov_b32 s87, 0x33333333
s_lshl_b32 s82, s16, 7
s_add_u32 s83, s82, 111152384
s_add_u32 s82, s82, 111148288
s_mov_b32 s19, 0
v_mov_b32 v64, -1
v_mov_b32 v65, -1
v_mov_b32 v66, -1
v_mov_b32 v67, -1
s_add_u32 s20, s28, s25
buffer_store_dwordx4 v[64:67], v1, s[8:11], s20 offen
s_add_u32 s20, s28, s26
buffer_store_dwordx4 v[64:67], v1, s[8:11], s20 offen
s_add_u32 s20, s28, s27
buffer_store_dwordx4 v[64:67], v1, s[8:11], s20 offen
s_add_u32 s20, s29, s25
buffer_store_dwordx4 v[64:67], v1, s[8:11], s20 offen
s_add_u32 s20, s29, s26
buffer_store_dwordx4 v[64:67], v1, s[8:11], s20 offen
s_add_u32 s20, s29, s27
buffer_store_dwordx4 v[64:67], v1, s[8:11], s20 offen
s_add_u32 s20, s24, 16384
buffer_store_dword v64, v11, s[8:11], s20 offen
v_lshrrev_b32 v0, 4, v1
s_waitcnt vmcnt(0)
s_barrier
s_cmp_eq_u32 s17, 0
s_cbranch_scc0 L_tw
s_mov_b64 exec, 1
v_mov_b32 v1, 1
v_mov_b32 v2, 64
buffer_atomic_add v1, v2, s[56:59], 0 offen
s_mov_b64 exec, -1
L_tw:
s_mov_b32 s46, 0x05040100
s_mov_b32 s47, 0x07060302
v_and_b32 v3, 63, v0
v_lshlrev_b32 v3, 4, v3
s_mul_i32 s20, s17, 34816
s_add_u32 s20, s20, 24576
v_add_u32 v3, s20, v3
v_bfe_u32 v64, v0, 5, 1
v_bfe_u32 v65, v0, 4, 1
v_and_b32 v66, 15, v0
v_lshlrev_b32 v1, 17, v64
v_lshl_add_u32 v1, v65, 14, v1
v_lshl_add_u32 v1, v66, 2, v1
s_lshl_b32 s20, s16, 8
s_lshl_b32 s21, s17, 6
s_add_u32 s20, s20, s21
v_add_u32 v1, s20, v1
v_lshlrev_b32 v2, 4, v64
v_lshl_add_u32 v2, v65, 2, v2
v_mul_u32_u24 v2, 1152, v2
s_mul_i32 s20, s16, 147456
v_add_u32 v2, s20, v2
s_load_dwordx2 s[50:51], s[0:1], 64
s_waitcnt lgkmcnt(0)
s_mov_b32 s12, s50
s_and_b32 s13, s51, 0xffff
s_mov_b32 s14, 4718592
s_mov_b32 s15, 0x20000
s_mov_b32 s20, 0
buffer_load_dword v4, v1, s[12:15], s20 offen
s_mov_b32 s21, 32768
buffer_load_dword v5, v1, s[12:15], s21 offen
s_mov_b32 s20, 65536
buffer_load_dword v6, v1, s[12:15], s20 offen
s_mov_b32 s21, 98304
buffer_load_dword v7, v1, s[12:15], s21 offen
s_mov_b32 s20, 8192
buffer_load_dword v8, v1, s[12:15], s20 offen
s_mov_b32 s21, 40960
buffer_load_dword v9, v1, s[12:15], s21 offen
s_mov_b32 s20, 73728
buffer_load_dword v10, v1, s[12:15], s20 offen
s_mov_b32 s21, 106496
buffer_load_dword v11, v1, s[12:15], s21 offen
s_mov_b32 s20, 262144
buffer_load_dword v12, v1, s[12:15], s20 offen
s_mov_b32 s21, 294912
buffer_load_dword v13, v1, s[12:15], s21 offen
s_mov_b32 s20, 327680
buffer_load_dword v14, v1, s[12:15], s20 offen
s_mov_b32 s21, 360448
buffer_load_dword v15, v1, s[12:15], s21 offen
s_mov_b32 s20, 270336
buffer_load_dword v16, v1, s[12:15], s20 offen
s_mov_b32 s21, 303104
buffer_load_dword v17, v1, s[12:15], s21 offen
s_mov_b32 s20, 335872
buffer_load_dword v18, v1, s[12:15], s20 offen
s_mov_b32 s21, 368640
buffer_load_dword v19, v1, s[12:15], s21 offen
s_mov_b32 s20, 524288
buffer_load_dword v20, v1, s[12:15], s20 offen
s_mov_b32 s21, 557056
buffer_load_dword v21, v1, s[12:15], s21 offen
s_mov_b32 s20, 589824
buffer_load_dword v22, v1, s[12:15], s20 offen
s_mov_b32 s21, 622592
buffer_load_dword v23, v1, s[12:15], s21 offen
s_mov_b32 s20, 532480
buffer_load_dword v24, v1, s[12:15], s20 offen
s_mov_b32 s21, 565248
buffer_load_dword v25, v1, s[12:15], s21 offen
s_mov_b32 s20, 598016
buffer_load_dword v26, v1, s[12:15], s20 offen
s_mov_b32 s21, 630784
buffer_load_dword v27, v1, s[12:15], s21 offen
s_mov_b32 s20, 786432
buffer_load_dword v28, v1, s[12:15], s20 offen
s_mov_b32 s21, 819200
buffer_load_dword v29, v1, s[12:15], s21 offen
s_mov_b32 s20, 851968
buffer_load_dword v30, v1, s[12:15], s20 offen
s_mov_b32 s21, 884736
buffer_load_dword v31, v1, s[12:15], s21 offen
s_mov_b32 s20, 794624
buffer_load_dword v32, v1, s[12:15], s20 offen
s_mov_b32 s21, 827392
buffer_load_dword v33, v1, s[12:15], s21 offen
s_mov_b32 s20, 860160
buffer_load_dword v34, v1, s[12:15], s20 offen
s_mov_b32 s21, 892928
buffer_load_dword v35, v1, s[12:15], s21 offen
s_mov_b32 s20, 1048576
buffer_load_dword v36, v1, s[12:15], s20 offen
s_mov_b32 s21, 1081344
buffer_load_dword v37, v1, s[12:15], s21 offen
s_mov_b32 s20, 1114112
buffer_load_dword v38, v1, s[12:15], s20 offen
s_mov_b32 s21, 1146880
buffer_load_dword v39, v1, s[12:15], s21 offen
s_mov_b32 s20, 1056768
buffer_load_dword v40, v1, s[12:15], s20 offen
s_mov_b32 s21, 1089536
buffer_load_dword v41, v1, s[12:15], s21 offen
s_mov_b32 s20, 1122304
buffer_load_dword v42, v1, s[12:15], s20 offen
s_mov_b32 s21, 1155072
buffer_load_dword v43, v1, s[12:15], s21 offen
s_mov_b32 s20, 1310720
buffer_load_dword v44, v1, s[12:15], s20 offen
s_mov_b32 s21, 1343488
buffer_load_dword v45, v1, s[12:15], s21 offen
s_mov_b32 s20, 1376256
buffer_load_dword v46, v1, s[12:15], s20 offen
s_mov_b32 s21, 1409024
buffer_load_dword v47, v1, s[12:15], s21 offen
s_mov_b32 s20, 1318912
buffer_load_dword v48, v1, s[12:15], s20 offen
s_mov_b32 s21, 1351680
buffer_load_dword v49, v1, s[12:15], s21 offen
s_mov_b32 s20, 1384448
buffer_load_dword v50, v1, s[12:15], s20 offen
s_mov_b32 s21, 1417216
buffer_load_dword v51, v1, s[12:15], s21 offen
s_mov_b32 s20, 1572864
buffer_load_dword v52, v1, s[12:15], s20 offen
s_mov_b32 s21, 1605632
buffer_load_dword v53, v1, s[12:15], s21 offen
s_mov_b32 s20, 1638400
buffer_load_dword v54, v1, s[12:15], s20 offen
s_mov_b32 s21, 1671168
buffer_load_dword v55, v1, s[12:15], s21 offen
s_mov_b32 s20, 1581056
buffer_load_dword v56, v1, s[12:15], s20 offen
s_mov_b32 s21, 1613824
buffer_load_dword v57, v1, s[12:15], s21 offen
s_mov_b32 s20, 1646592
buffer_load_dword v58, v1, s[12:15], s20 offen
s_mov_b32 s21, 1679360
buffer_load_dword v59, v1, s[12:15], s21 offen
s_mov_b32 s20, 1835008
buffer_load_dword v60, v1, s[12:15], s20 offen
s_mov_b32 s21, 1867776
buffer_load_dword v61, v1, s[12:15], s21 offen
s_mov_b32 s20, 1900544
buffer_load_dword v62, v1, s[12:15], s20 offen
s_mov_b32 s21, 1933312
buffer_load_dword v63, v1, s[12:15], s21 offen
s_waitcnt vmcnt(58)
v_perm_b32 v72, v5, v4, s46
v_perm_b32 v80, v5, v4, s47
s_mov_b32 s20, 1843200
buffer_load_dword v4, v1, s[12:15], s20 offen
s_mov_b32 s21, 1875968
buffer_load_dword v5, v1, s[12:15], s21 offen
s_waitcnt vmcnt(58)
v_perm_b32 v73, v7, v6, s46
v_perm_b32 v81, v7, v6, s47
s_mov_b32 s20, 1908736
buffer_load_dword v6, v1, s[12:15], s20 offen
s_mov_b32 s21, 1941504
buffer_load_dword v7, v1, s[12:15], s21 offen
s_waitcnt vmcnt(58)
v_perm_b32 v74, v9, v8, s46
v_perm_b32 v82, v9, v8, s47
s_mov_b32 s20, 2097152
buffer_load_dword v8, v1, s[12:15], s20 offen
s_mov_b32 s21, 2129920
buffer_load_dword v9, v1, s[12:15], s21 offen
s_waitcnt vmcnt(58)
v_perm_b32 v75, v11, v10, s46
v_perm_b32 v83, v11, v10, s47
s_mov_b32 s20, 2162688
buffer_load_dword v10, v1, s[12:15], s20 offen
s_mov_b32 s21, 2195456
buffer_load_dword v11, v1, s[12:15], s21 offen
s_waitcnt vmcnt(58)
v_perm_b32 v76, v13, v12, s46
v_perm_b32 v84, v13, v12, s47
s_mov_b32 s20, 2105344
buffer_load_dword v12, v1, s[12:15], s20 offen
s_mov_b32 s21, 2138112
buffer_load_dword v13, v1, s[12:15], s21 offen
s_waitcnt vmcnt(58)
v_perm_b32 v77, v15, v14, s46
v_perm_b32 v85, v15, v14, s47
s_mov_b32 s20, 2170880
buffer_load_dword v14, v1, s[12:15], s20 offen
s_mov_b32 s21, 2203648
buffer_load_dword v15, v1, s[12:15], s21 offen
s_waitcnt vmcnt(58)
v_perm_b32 v78, v17, v16, s46
v_perm_b32 v86, v17, v16, s47
s_mov_b32 s20, 2359296
buffer_load_dword v16, v1, s[12:15], s20 offen
s_mov_b32 s21, 2392064
buffer_load_dword v17, v1, s[12:15], s21 offen
s_waitcnt vmcnt(58)
v_perm_b32 v79, v19, v18, s46
v_perm_b32 v87, v19, v18, s47
s_mov_b32 s20, 2424832
buffer_load_dword v18, v1, s[12:15], s20 offen
s_mov_b32 s21, 2457600
buffer_load_dword v19, v1, s[12:15], s21 offen
s_waitcnt vmcnt(58)
v_perm_b32 v96, v21, v20, s46
v_perm_b32 v104, v21, v20, s47
s_mov_b32 s20, 2367488
buffer_load_dword v20, v1, s[12:15], s20 offen
s_mov_b32 s21, 2400256
buffer_load_dword v21, v1, s[12:15], s21 offen
s_waitcnt vmcnt(58)
v_perm_b32 v97, v23, v22, s46
v_perm_b32 v105, v23, v22, s47
s_mov_b32 s20, 2433024
buffer_load_dword v22, v1, s[12:15], s20 offen
s_mov_b32 s21, 2465792
buffer_load_dword v23, v1, s[12:15], s21 offen
s_waitcnt vmcnt(58)
v_perm_b32 v98, v25, v24, s46
v_perm_b32 v106, v25, v24, s47
s_mov_b32 s20, 2621440
buffer_load_dword v24, v1, s[12:15], s20 offen
s_mov_b32 s21, 2654208
buffer_load_dword v25, v1, s[12:15], s21 offen
s_waitcnt vmcnt(58)
v_perm_b32 v99, v27, v26, s46
v_perm_b32 v107, v27, v26, s47
s_mov_b32 s20, 2686976
buffer_load_dword v26, v1, s[12:15], s20 offen
s_mov_b32 s21, 2719744
buffer_load_dword v27, v1, s[12:15], s21 offen
s_waitcnt vmcnt(58)
v_perm_b32 v100, v29, v28, s46
v_perm_b32 v108, v29, v28, s47
s_mov_b32 s20, 2629632
buffer_load_dword v28, v1, s[12:15], s20 offen
s_mov_b32 s21, 2662400
buffer_load_dword v29, v1, s[12:15], s21 offen
s_waitcnt vmcnt(58)
v_perm_b32 v101, v31, v30, s46
v_perm_b32 v109, v31, v30, s47
s_mov_b32 s20, 2695168
buffer_load_dword v30, v1, s[12:15], s20 offen
s_mov_b32 s21, 2727936
buffer_load_dword v31, v1, s[12:15], s21 offen
s_waitcnt vmcnt(58)
v_perm_b32 v102, v33, v32, s46
v_perm_b32 v110, v33, v32, s47
s_mov_b32 s20, 2883584
buffer_load_dword v32, v1, s[12:15], s20 offen
s_mov_b32 s21, 2916352
buffer_load_dword v33, v1, s[12:15], s21 offen
s_waitcnt vmcnt(58)
v_perm_b32 v103, v35, v34, s46
v_perm_b32 v111, v35, v34, s47
s_mov_b32 s20, 2949120
buffer_load_dword v34, v1, s[12:15], s20 offen
s_mov_b32 s21, 2981888
buffer_load_dword v35, v1, s[12:15], s21 offen
s_waitcnt vmcnt(58)
v_perm_b32 v120, v37, v36, s46
v_perm_b32 v128, v37, v36, s47
s_mov_b32 s20, 2891776
buffer_load_dword v36, v1, s[12:15], s20 offen
s_mov_b32 s21, 2924544
buffer_load_dword v37, v1, s[12:15], s21 offen
s_waitcnt vmcnt(58)
v_perm_b32 v121, v39, v38, s46
v_perm_b32 v129, v39, v38, s47
s_mov_b32 s20, 2957312
buffer_load_dword v38, v1, s[12:15], s20 offen
s_mov_b32 s21, 2990080
buffer_load_dword v39, v1, s[12:15], s21 offen
s_waitcnt vmcnt(58)
v_perm_b32 v122, v41, v40, s46
v_perm_b32 v130, v41, v40, s47
s_mov_b32 s20, 3145728
buffer_load_dword v40, v1, s[12:15], s20 offen
s_mov_b32 s21, 3178496
buffer_load_dword v41, v1, s[12:15], s21 offen
s_waitcnt vmcnt(58)
v_perm_b32 v123, v43, v42, s46
v_perm_b32 v131, v43, v42, s47
s_mov_b32 s20, 3211264
buffer_load_dword v42, v1, s[12:15], s20 offen
s_mov_b32 s21, 3244032
buffer_load_dword v43, v1, s[12:15], s21 offen
s_waitcnt vmcnt(58)
v_perm_b32 v124, v45, v44, s46
v_perm_b32 v132, v45, v44, s47
s_mov_b32 s20, 3153920
buffer_load_dword v44, v1, s[12:15], s20 offen
s_mov_b32 s21, 3186688
buffer_load_dword v45, v1, s[12:15], s21 offen
s_waitcnt vmcnt(58)
v_perm_b32 v125, v47, v46, s46
v_perm_b32 v133, v47, v46, s47
s_mov_b32 s20, 3219456
buffer_load_dword v46, v1, s[12:15], s20 offen
s_mov_b32 s21, 3252224
buffer_load_dword v47, v1, s[12:15], s21 offen
s_waitcnt vmcnt(58)
v_perm_b32 v126, v49, v48, s46
v_perm_b32 v134, v49, v48, s47
s_mov_b32 s20, 3407872
buffer_load_dword v48, v1, s[12:15], s20 offen
s_mov_b32 s21, 3440640
buffer_load_dword v49, v1, s[12:15], s21 offen
s_waitcnt vmcnt(58)
v_perm_b32 v127, v51, v50, s46
v_perm_b32 v135, v51, v50, s47
s_mov_b32 s20, 3473408
buffer_load_dword v50, v1, s[12:15], s20 offen
s_mov_b32 s21, 3506176
buffer_load_dword v51, v1, s[12:15], s21 offen
s_waitcnt vmcnt(58)
v_perm_b32 v144, v53, v52, s46
v_perm_b32 v152, v53, v52, s47
s_mov_b32 s20, 3416064
buffer_load_dword v52, v1, s[12:15], s20 offen
s_mov_b32 s21, 3448832
buffer_load_dword v53, v1, s[12:15], s21 offen
s_waitcnt vmcnt(58)
v_perm_b32 v145, v55, v54, s46
v_perm_b32 v153, v55, v54, s47
s_mov_b32 s20, 3481600
buffer_load_dword v54, v1, s[12:15], s20 offen
s_mov_b32 s21, 3514368
buffer_load_dword v55, v1, s[12:15], s21 offen
s_waitcnt vmcnt(58)
v_perm_b32 v146, v57, v56, s46
v_perm_b32 v154, v57, v56, s47
s_mov_b32 s20, 3670016
buffer_load_dword v56, v1, s[12:15], s20 offen
s_mov_b32 s21, 3702784
buffer_load_dword v57, v1, s[12:15], s21 offen
s_waitcnt vmcnt(58)
v_perm_b32 v147, v59, v58, s46
v_perm_b32 v155, v59, v58, s47
s_mov_b32 s20, 3735552
buffer_load_dword v58, v1, s[12:15], s20 offen
s_mov_b32 s21, 3768320
buffer_load_dword v59, v1, s[12:15], s21 offen
s_waitcnt vmcnt(58)
v_perm_b32 v148, v61, v60, s46
v_perm_b32 v156, v61, v60, s47
s_mov_b32 s20, 3678208
buffer_load_dword v60, v1, s[12:15], s20 offen
s_mov_b32 s21, 3710976
buffer_load_dword v61, v1, s[12:15], s21 offen
s_waitcnt vmcnt(58)
v_perm_b32 v149, v63, v62, s46
v_perm_b32 v157, v63, v62, s47
s_mov_b32 s20, 3743744
buffer_load_dword v62, v1, s[12:15], s20 offen
s_mov_b32 s21, 3776512
buffer_load_dword v63, v1, s[12:15], s21 offen
s_waitcnt vmcnt(58)
v_perm_b32 v150, v5, v4, s46
v_perm_b32 v158, v5, v4, s47
s_mov_b32 s20, 3932160
buffer_load_dword v4, v1, s[12:15], s20 offen
s_mov_b32 s21, 3964928
buffer_load_dword v5, v1, s[12:15], s21 offen
s_waitcnt vmcnt(58)
v_perm_b32 v151, v7, v6, s46
v_perm_b32 v159, v7, v6, s47
s_mov_b32 s20, 3997696
buffer_load_dword v6, v1, s[12:15], s20 offen
s_mov_b32 s21, 4030464
buffer_load_dword v7, v1, s[12:15], s21 offen
s_waitcnt vmcnt(58)
v_perm_b32 v168, v9, v8, s46
v_perm_b32 v176, v9, v8, s47
s_mov_b32 s20, 3940352
buffer_load_dword v8, v1, s[12:15], s20 offen
s_mov_b32 s21, 3973120
buffer_load_dword v9, v1, s[12:15], s21 offen
s_waitcnt vmcnt(58)
v_perm_b32 v169, v11, v10, s46
v_perm_b32 v177, v11, v10, s47
s_mov_b32 s20, 4005888
buffer_load_dword v10, v1, s[12:15], s20 offen
s_mov_b32 s21, 4038656
buffer_load_dword v11, v1, s[12:15], s21 offen
s_waitcnt vmcnt(58)
v_perm_b32 v170, v13, v12, s46
v_perm_b32 v178, v13, v12, s47
s_mov_b32 s20, 4194304
buffer_load_dword v12, v1, s[12:15], s20 offen
s_mov_b32 s21, 4227072
buffer_load_dword v13, v1, s[12:15], s21 offen
s_waitcnt vmcnt(58)
v_perm_b32 v171, v15, v14, s46
v_perm_b32 v179, v15, v14, s47
s_mov_b32 s20, 4259840
buffer_load_dword v14, v1, s[12:15], s20 offen
s_mov_b32 s21, 4292608
buffer_load_dword v15, v1, s[12:15], s21 offen
s_waitcnt vmcnt(58)
v_perm_b32 v172, v17, v16, s46
v_perm_b32 v180, v17, v16, s47
s_mov_b32 s20, 4202496
buffer_load_dword v16, v1, s[12:15], s20 offen
s_mov_b32 s21, 4235264
buffer_load_dword v17, v1, s[12:15], s21 offen
s_waitcnt vmcnt(58)
v_perm_b32 v173, v19, v18, s46
v_perm_b32 v181, v19, v18, s47
s_mov_b32 s20, 4268032
buffer_load_dword v18, v1, s[12:15], s20 offen
s_mov_b32 s21, 4300800
buffer_load_dword v19, v1, s[12:15], s21 offen
s_waitcnt vmcnt(58)
v_perm_b32 v174, v21, v20, s46
v_perm_b32 v182, v21, v20, s47
s_mov_b32 s20, 4456448
buffer_load_dword v20, v1, s[12:15], s20 offen
s_mov_b32 s21, 4489216
buffer_load_dword v21, v1, s[12:15], s21 offen
s_waitcnt vmcnt(58)
v_perm_b32 v175, v23, v22, s46
v_perm_b32 v183, v23, v22, s47
s_mov_b32 s20, 4521984
buffer_load_dword v22, v1, s[12:15], s20 offen
s_mov_b32 s21, 4554752
buffer_load_dword v23, v1, s[12:15], s21 offen
s_waitcnt vmcnt(58)
v_perm_b32 v192, v25, v24, s46
v_perm_b32 v200, v25, v24, s47
s_mov_b32 s20, 4464640
buffer_load_dword v24, v1, s[12:15], s20 offen
s_mov_b32 s21, 4497408
buffer_load_dword v25, v1, s[12:15], s21 offen
s_waitcnt vmcnt(58)
v_perm_b32 v193, v27, v26, s46
v_perm_b32 v201, v27, v26, s47
s_mov_b32 s20, 4530176
buffer_load_dword v26, v1, s[12:15], s20 offen
s_mov_b32 s21, 4562944
buffer_load_dword v27, v1, s[12:15], s21 offen
s_waitcnt vmcnt(58)
v_perm_b32 v194, v29, v28, s46
v_perm_b32 v202, v29, v28, s47
s_load_dwordx2 s[50:51], s[0:1], 72
s_waitcnt lgkmcnt(0)
s_mov_b32 s12, s50
s_and_b32 s13, s51, 0xffff
s_mov_b32 s14, 4718592
s_mov_b32 s15, 0x20000
s_mov_b32 s20, 0
buffer_load_dword v28, v1, s[12:15], s20 offen
s_mov_b32 s21, 32768
buffer_load_dword v29, v1, s[12:15], s21 offen
s_waitcnt vmcnt(58)
v_perm_b32 v195, v31, v30, s46
v_perm_b32 v203, v31, v30, s47
s_mov_b32 s20, 65536
buffer_load_dword v30, v1, s[12:15], s20 offen
s_mov_b32 s21, 98304
buffer_load_dword v31, v1, s[12:15], s21 offen
s_waitcnt vmcnt(58)
v_perm_b32 v196, v33, v32, s46
v_perm_b32 v204, v33, v32, s47
s_mov_b32 s20, 8192
buffer_load_dword v32, v1, s[12:15], s20 offen
s_mov_b32 s21, 40960
buffer_load_dword v33, v1, s[12:15], s21 offen
s_waitcnt vmcnt(58)
v_perm_b32 v197, v35, v34, s46
v_perm_b32 v205, v35, v34, s47
s_mov_b32 s20, 73728
buffer_load_dword v34, v1, s[12:15], s20 offen
s_mov_b32 s21, 106496
buffer_load_dword v35, v1, s[12:15], s21 offen
s_waitcnt vmcnt(58)
v_perm_b32 v198, v37, v36, s46
v_perm_b32 v206, v37, v36, s47
s_mov_b32 s20, 262144
buffer_load_dword v36, v1, s[12:15], s20 offen
s_mov_b32 s21, 294912
buffer_load_dword v37, v1, s[12:15], s21 offen
s_waitcnt vmcnt(58)
v_perm_b32 v199, v39, v38, s46
v_perm_b32 v207, v39, v38, s47
s_mov_b32 s20, 327680
buffer_load_dword v38, v1, s[12:15], s20 offen
s_mov_b32 s21, 360448
buffer_load_dword v39, v1, s[12:15], s21 offen
s_waitcnt vmcnt(58)
v_perm_b32 v216, v41, v40, s46
v_perm_b32 v224, v41, v40, s47
s_mov_b32 s20, 270336
buffer_load_dword v40, v1, s[12:15], s20 offen
s_mov_b32 s21, 303104
buffer_load_dword v41, v1, s[12:15], s21 offen
s_waitcnt vmcnt(58)
v_perm_b32 v217, v43, v42, s46
v_perm_b32 v225, v43, v42, s47
s_mov_b32 s20, 335872
buffer_load_dword v42, v1, s[12:15], s20 offen
s_mov_b32 s21, 368640
buffer_load_dword v43, v1, s[12:15], s21 offen
s_waitcnt vmcnt(58)
v_perm_b32 v218, v45, v44, s46
v_perm_b32 v226, v45, v44, s47
s_mov_b32 s20, 524288
buffer_load_dword v44, v1, s[12:15], s20 offen
s_mov_b32 s21, 557056
buffer_load_dword v45, v1, s[12:15], s21 offen
s_waitcnt vmcnt(58)
v_perm_b32 v219, v47, v46, s46
v_perm_b32 v227, v47, v46, s47
s_mov_b32 s20, 589824
buffer_load_dword v46, v1, s[12:15], s20 offen
s_mov_b32 s21, 622592
buffer_load_dword v47, v1, s[12:15], s21 offen
s_waitcnt vmcnt(58)
v_perm_b32 v220, v49, v48, s46
v_perm_b32 v228, v49, v48, s47
s_mov_b32 s20, 532480
buffer_load_dword v48, v1, s[12:15], s20 offen
s_mov_b32 s21, 565248
buffer_load_dword v49, v1, s[12:15], s21 offen
s_waitcnt vmcnt(58)
v_perm_b32 v221, v51, v50, s46
v_perm_b32 v229, v51, v50, s47
s_mov_b32 s20, 598016
buffer_load_dword v50, v1, s[12:15], s20 offen
s_mov_b32 s21, 630784
buffer_load_dword v51, v1, s[12:15], s21 offen
s_waitcnt vmcnt(58)
v_perm_b32 v222, v53, v52, s46
v_perm_b32 v230, v53, v52, s47
s_mov_b32 s20, 786432
buffer_load_dword v52, v1, s[12:15], s20 offen
s_mov_b32 s21, 819200
buffer_load_dword v53, v1, s[12:15], s21 offen
s_waitcnt vmcnt(58)
v_perm_b32 v223, v55, v54, s46
v_perm_b32 v231, v55, v54, s47
s_mov_b32 s20, 851968
buffer_load_dword v54, v1, s[12:15], s20 offen
s_mov_b32 s21, 884736
buffer_load_dword v55, v1, s[12:15], s21 offen
s_waitcnt vmcnt(58)
v_perm_b32 v240, v57, v56, s46
v_perm_b32 v248, v57, v56, s47
s_mov_b32 s20, 794624
buffer_load_dword v56, v1, s[12:15], s20 offen
s_mov_b32 s21, 827392
buffer_load_dword v57, v1, s[12:15], s21 offen
s_waitcnt vmcnt(58)
v_perm_b32 v241, v59, v58, s46
v_perm_b32 v249, v59, v58, s47
s_mov_b32 s20, 860160
buffer_load_dword v58, v1, s[12:15], s20 offen
s_mov_b32 s21, 892928
buffer_load_dword v59, v1, s[12:15], s21 offen
s_waitcnt vmcnt(58)
v_perm_b32 v242, v61, v60, s46
v_perm_b32 v250, v61, v60, s47
s_mov_b32 s20, 1048576
buffer_load_dword v60, v1, s[12:15], s20 offen
s_mov_b32 s21, 1081344
buffer_load_dword v61, v1, s[12:15], s21 offen
s_waitcnt vmcnt(58)
v_perm_b32 v243, v63, v62, s46
v_perm_b32 v251, v63, v62, s47
s_mov_b32 s20, 1114112
buffer_load_dword v62, v1, s[12:15], s20 offen
s_mov_b32 s21, 1146880
buffer_load_dword v63, v1, s[12:15], s21 offen
s_waitcnt vmcnt(58)
v_perm_b32 v244, v5, v4, s46
v_perm_b32 v252, v5, v4, s47
s_mov_b32 s20, 1056768
buffer_load_dword v4, v1, s[12:15], s20 offen
s_mov_b32 s21, 1089536
buffer_load_dword v5, v1, s[12:15], s21 offen
s_waitcnt vmcnt(58)
v_perm_b32 v245, v7, v6, s46
v_perm_b32 v253, v7, v6, s47
s_mov_b32 s20, 1122304
buffer_load_dword v6, v1, s[12:15], s20 offen
s_mov_b32 s21, 1155072
buffer_load_dword v7, v1, s[12:15], s21 offen
s_waitcnt vmcnt(58)
v_perm_b32 v246, v9, v8, s46
v_perm_b32 v254, v9, v8, s47
s_mov_b32 s20, 1310720
buffer_load_dword v8, v1, s[12:15], s20 offen
s_mov_b32 s21, 1343488
buffer_load_dword v9, v1, s[12:15], s21 offen
s_waitcnt vmcnt(58)
v_perm_b32 v247, v11, v10, s46
v_perm_b32 v255, v11, v10, s47
s_mov_b32 s20, 1376256
buffer_load_dword v10, v1, s[12:15], s20 offen
s_mov_b32 s21, 1409024
buffer_load_dword v11, v1, s[12:15], s21 offen
s_waitcnt vmcnt(58)
v_perm_b32 v64, v13, v12, s46
v_accvgpr_write_b32 a8, v64
v_perm_b32 v68, v13, v12, s47
v_accvgpr_write_b32 a16, v68
s_mov_b32 s20, 1318912
buffer_load_dword v12, v1, s[12:15], s20 offen
s_mov_b32 s21, 1351680
buffer_load_dword v13, v1, s[12:15], s21 offen
s_waitcnt vmcnt(58)
v_perm_b32 v65, v15, v14, s46
v_accvgpr_write_b32 a9, v65
v_perm_b32 v69, v15, v14, s47
v_accvgpr_write_b32 a17, v69
s_mov_b32 s20, 1384448
buffer_load_dword v14, v1, s[12:15], s20 offen
s_mov_b32 s21, 1417216
buffer_load_dword v15, v1, s[12:15], s21 offen
s_waitcnt vmcnt(58)
v_perm_b32 v66, v17, v16, s46
v_accvgpr_write_b32 a10, v66
v_perm_b32 v70, v17, v16, s47
v_accvgpr_write_b32 a18, v70
s_mov_b32 s20, 1572864
buffer_load_dword v16, v1, s[12:15], s20 offen
s_mov_b32 s21, 1605632
buffer_load_dword v17, v1, s[12:15], s21 offen
s_waitcnt vmcnt(58)
v_perm_b32 v67, v19, v18, s46
v_accvgpr_write_b32 a11, v67
v_perm_b32 v71, v19, v18, s47
v_accvgpr_write_b32 a19, v71
s_mov_b32 s20, 1638400
buffer_load_dword v18, v1, s[12:15], s20 offen
s_mov_b32 s21, 1671168
buffer_load_dword v19, v1, s[12:15], s21 offen
s_waitcnt vmcnt(58)
v_perm_b32 v64, v21, v20, s46
v_accvgpr_write_b32 a12, v64
v_perm_b32 v68, v21, v20, s47
v_accvgpr_write_b32 a20, v68
s_mov_b32 s20, 1581056
buffer_load_dword v20, v1, s[12:15], s20 offen
s_mov_b32 s21, 1613824
buffer_load_dword v21, v1, s[12:15], s21 offen
s_waitcnt vmcnt(58)
v_perm_b32 v65, v23, v22, s46
v_accvgpr_write_b32 a13, v65
v_perm_b32 v69, v23, v22, s47
v_accvgpr_write_b32 a21, v69
s_mov_b32 s20, 1646592
buffer_load_dword v22, v1, s[12:15], s20 offen
s_mov_b32 s21, 1679360
buffer_load_dword v23, v1, s[12:15], s21 offen
s_waitcnt vmcnt(58)
v_perm_b32 v66, v25, v24, s46
v_accvgpr_write_b32 a14, v66
v_perm_b32 v70, v25, v24, s47
v_accvgpr_write_b32 a22, v70
s_mov_b32 s20, 1835008
buffer_load_dword v24, v1, s[12:15], s20 offen
s_mov_b32 s21, 1867776
buffer_load_dword v25, v1, s[12:15], s21 offen
s_waitcnt vmcnt(58)
v_perm_b32 v67, v27, v26, s46
v_accvgpr_write_b32 a15, v67
v_perm_b32 v71, v27, v26, s47
v_accvgpr_write_b32 a23, v71
s_mov_b32 s20, 1900544
buffer_load_dword v26, v1, s[12:15], s20 offen
s_mov_b32 s21, 1933312
buffer_load_dword v27, v1, s[12:15], s21 offen
s_waitcnt vmcnt(58)
v_perm_b32 v88, v29, v28, s46
v_perm_b32 v68, v29, v28, s47
s_mov_b32 s20, 1843200
buffer_load_dword v28, v1, s[12:15], s20 offen
s_mov_b32 s21, 1875968
buffer_load_dword v29, v1, s[12:15], s21 offen
s_waitcnt vmcnt(58)
v_perm_b32 v89, v31, v30, s46
v_perm_b32 v69, v31, v30, s47
s_mov_b32 s20, 1908736
buffer_load_dword v30, v1, s[12:15], s20 offen
s_mov_b32 s21, 1941504
buffer_load_dword v31, v1, s[12:15], s21 offen
s_waitcnt vmcnt(58)
v_perm_b32 v90, v33, v32, s46
v_perm_b32 v70, v33, v32, s47
s_mov_b32 s20, 2097152
buffer_load_dword v32, v1, s[12:15], s20 offen
s_mov_b32 s21, 2129920
buffer_load_dword v33, v1, s[12:15], s21 offen
s_waitcnt vmcnt(58)
v_perm_b32 v91, v35, v34, s46
v_perm_b32 v71, v35, v34, s47
ds_write_b128 v3, v[68:71] offset:0
s_waitcnt lgkmcnt(0)
s_mov_b32 s20, 2162688
buffer_load_dword v34, v1, s[12:15], s20 offen
s_mov_b32 s21, 2195456
buffer_load_dword v35, v1, s[12:15], s21 offen
s_waitcnt vmcnt(58)
v_perm_b32 v92, v37, v36, s46
v_perm_b32 v68, v37, v36, s47
s_mov_b32 s20, 2105344
buffer_load_dword v36, v1, s[12:15], s20 offen
s_mov_b32 s21, 2138112
buffer_load_dword v37, v1, s[12:15], s21 offen
s_waitcnt vmcnt(58)
v_perm_b32 v93, v39, v38, s46
v_perm_b32 v69, v39, v38, s47
s_mov_b32 s20, 2170880
buffer_load_dword v38, v1, s[12:15], s20 offen
s_mov_b32 s21, 2203648
buffer_load_dword v39, v1, s[12:15], s21 offen
s_waitcnt vmcnt(58)
v_perm_b32 v94, v41, v40, s46
v_perm_b32 v70, v41, v40, s47
s_mov_b32 s20, 2359296
buffer_load_dword v40, v1, s[12:15], s20 offen
s_mov_b32 s21, 2392064
buffer_load_dword v41, v1, s[12:15], s21 offen
s_waitcnt vmcnt(58)
v_perm_b32 v95, v43, v42, s46
v_perm_b32 v71, v43, v42, s47
ds_write_b128 v3, v[68:71] offset:1024
s_waitcnt lgkmcnt(0)
s_mov_b32 s20, 2424832
buffer_load_dword v42, v1, s[12:15], s20 offen
s_mov_b32 s21, 2457600
buffer_load_dword v43, v1, s[12:15], s21 offen
s_waitcnt vmcnt(58)
v_perm_b32 v112, v45, v44, s46
v_perm_b32 v68, v45, v44, s47
s_mov_b32 s20, 2367488
buffer_load_dword v44, v1, s[12:15], s20 offen
s_mov_b32 s21, 2400256
buffer_load_dword v45, v1, s[12:15], s21 offen
s_waitcnt vmcnt(58)
v_perm_b32 v113, v47, v46, s46
v_perm_b32 v69, v47, v46, s47
s_mov_b32 s20, 2433024
buffer_load_dword v46, v1, s[12:15], s20 offen
s_mov_b32 s21, 2465792
buffer_load_dword v47, v1, s[12:15], s21 offen
s_waitcnt vmcnt(58)
v_perm_b32 v114, v49, v48, s46
v_perm_b32 v70, v49, v48, s47
s_mov_b32 s20, 2621440
buffer_load_dword v48, v1, s[12:15], s20 offen
s_mov_b32 s21, 2654208
buffer_load_dword v49, v1, s[12:15], s21 offen
s_waitcnt vmcnt(58)
v_perm_b32 v115, v51, v50, s46
v_perm_b32 v71, v51, v50, s47
ds_write_b128 v3, v[68:71] offset:2048
s_waitcnt lgkmcnt(0)
s_mov_b32 s20, 2686976
buffer_load_dword v50, v1, s[12:15], s20 offen
s_mov_b32 s21, 2719744
buffer_load_dword v51, v1, s[12:15], s21 offen
s_waitcnt vmcnt(58)
v_perm_b32 v116, v53, v52, s46
v_perm_b32 v68, v53, v52, s47
s_mov_b32 s20, 2629632
buffer_load_dword v52, v1, s[12:15], s20 offen
s_mov_b32 s21, 2662400
buffer_load_dword v53, v1, s[12:15], s21 offen
s_waitcnt vmcnt(58)
v_perm_b32 v117, v55, v54, s46
v_perm_b32 v69, v55, v54, s47
s_mov_b32 s20, 2695168
buffer_load_dword v54, v1, s[12:15], s20 offen
s_mov_b32 s21, 2727936
buffer_load_dword v55, v1, s[12:15], s21 offen
s_waitcnt vmcnt(58)
v_perm_b32 v118, v57, v56, s46
v_perm_b32 v70, v57, v56, s47
s_mov_b32 s20, 2883584
buffer_load_dword v56, v1, s[12:15], s20 offen
s_mov_b32 s21, 2916352
buffer_load_dword v57, v1, s[12:15], s21 offen
s_waitcnt vmcnt(58)
v_perm_b32 v119, v59, v58, s46
v_perm_b32 v71, v59, v58, s47
ds_write_b128 v3, v[68:71] offset:3072
s_waitcnt lgkmcnt(0)
s_mov_b32 s20, 2949120
buffer_load_dword v58, v1, s[12:15], s20 offen
s_mov_b32 s21, 2981888
buffer_load_dword v59, v1, s[12:15], s21 offen
s_waitcnt vmcnt(58)
v_perm_b32 v136, v61, v60, s46
v_perm_b32 v68, v61, v60, s47
s_mov_b32 s20, 2891776
buffer_load_dword v60, v1, s[12:15], s20 offen
s_mov_b32 s21, 2924544
buffer_load_dword v61, v1, s[12:15], s21 offen
s_waitcnt vmcnt(58)
v_perm_b32 v137, v63, v62, s46
v_perm_b32 v69, v63, v62, s47
s_mov_b32 s20, 2957312
buffer_load_dword v62, v1, s[12:15], s20 offen
s_mov_b32 s21, 2990080
buffer_load_dword v63, v1, s[12:15], s21 offen
s_waitcnt vmcnt(58)
v_perm_b32 v138, v5, v4, s46
v_perm_b32 v70, v5, v4, s47
s_mov_b32 s20, 3145728
buffer_load_dword v4, v1, s[12:15], s20 offen
s_mov_b32 s21, 3178496
buffer_load_dword v5, v1, s[12:15], s21 offen
s_waitcnt vmcnt(58)
v_perm_b32 v139, v7, v6, s46
v_perm_b32 v71, v7, v6, s47
ds_write_b128 v3, v[68:71] offset:4096
s_waitcnt lgkmcnt(0)
s_mov_b32 s20, 3211264
buffer_load_dword v6, v1, s[12:15], s20 offen
s_mov_b32 s21, 3244032
buffer_load_dword v7, v1, s[12:15], s21 offen
s_waitcnt vmcnt(58)
v_perm_b32 v140, v9, v8, s46
v_perm_b32 v68, v9, v8, s47
s_mov_b32 s20, 3153920
buffer_load_dword v8, v1, s[12:15], s20 offen
s_mov_b32 s21, 3186688
buffer_load_dword v9, v1, s[12:15], s21 offen
s_waitcnt vmcnt(58)
v_perm_b32 v141, v11, v10, s46
v_perm_b32 v69, v11, v10, s47
s_mov_b32 s20, 3219456
buffer_load_dword v10, v1, s[12:15], s20 offen
s_mov_b32 s21, 3252224
buffer_load_dword v11, v1, s[12:15], s21 offen
s_waitcnt vmcnt(58)
v_perm_b32 v142, v13, v12, s46
v_perm_b32 v70, v13, v12, s47
s_mov_b32 s20, 3407872
buffer_load_dword v12, v1, s[12:15], s20 offen
s_mov_b32 s21, 3440640
buffer_load_dword v13, v1, s[12:15], s21 offen
s_waitcnt vmcnt(58)
v_perm_b32 v143, v15, v14, s46
v_perm_b32 v71, v15, v14, s47
ds_write_b128 v3, v[68:71] offset:5120
s_waitcnt lgkmcnt(0)
s_mov_b32 s20, 3473408
buffer_load_dword v14, v1, s[12:15], s20 offen
s_mov_b32 s21, 3506176
buffer_load_dword v15, v1, s[12:15], s21 offen
s_waitcnt vmcnt(58)
v_perm_b32 v160, v17, v16, s46
v_perm_b32 v68, v17, v16, s47
s_mov_b32 s20, 3416064
buffer_load_dword v16, v1, s[12:15], s20 offen
s_mov_b32 s21, 3448832
buffer_load_dword v17, v1, s[12:15], s21 offen
s_waitcnt vmcnt(58)
v_perm_b32 v161, v19, v18, s46
v_perm_b32 v69, v19, v18, s47
s_mov_b32 s20, 3481600
buffer_load_dword v18, v1, s[12:15], s20 offen
s_mov_b32 s21, 3514368
buffer_load_dword v19, v1, s[12:15], s21 offen
s_waitcnt vmcnt(58)
v_perm_b32 v162, v21, v20, s46
v_perm_b32 v70, v21, v20, s47
s_mov_b32 s20, 3670016
buffer_load_dword v20, v1, s[12:15], s20 offen
s_mov_b32 s21, 3702784
buffer_load_dword v21, v1, s[12:15], s21 offen
s_waitcnt vmcnt(58)
v_perm_b32 v163, v23, v22, s46
v_perm_b32 v71, v23, v22, s47
ds_write_b128 v3, v[68:71] offset:6144
s_waitcnt lgkmcnt(0)
s_mov_b32 s20, 3735552
buffer_load_dword v22, v1, s[12:15], s20 offen
s_mov_b32 s21, 3768320
buffer_load_dword v23, v1, s[12:15], s21 offen
s_waitcnt vmcnt(58)
v_perm_b32 v164, v25, v24, s46
v_perm_b32 v68, v25, v24, s47
s_mov_b32 s20, 3678208
buffer_load_dword v24, v1, s[12:15], s20 offen
s_mov_b32 s21, 3710976
buffer_load_dword v25, v1, s[12:15], s21 offen
s_waitcnt vmcnt(58)
v_perm_b32 v165, v27, v26, s46
v_perm_b32 v69, v27, v26, s47
s_mov_b32 s20, 3743744
buffer_load_dword v26, v1, s[12:15], s20 offen
s_mov_b32 s21, 3776512
buffer_load_dword v27, v1, s[12:15], s21 offen
s_waitcnt vmcnt(58)
v_perm_b32 v166, v29, v28, s46
v_perm_b32 v70, v29, v28, s47
s_mov_b32 s20, 3932160
buffer_load_dword v28, v1, s[12:15], s20 offen
s_mov_b32 s21, 3964928
buffer_load_dword v29, v1, s[12:15], s21 offen
s_waitcnt vmcnt(58)
v_perm_b32 v167, v31, v30, s46
v_perm_b32 v71, v31, v30, s47
ds_write_b128 v3, v[68:71] offset:7168
s_waitcnt lgkmcnt(0)
s_mov_b32 s20, 3997696
buffer_load_dword v30, v1, s[12:15], s20 offen
s_mov_b32 s21, 4030464
buffer_load_dword v31, v1, s[12:15], s21 offen
s_waitcnt vmcnt(58)
v_perm_b32 v184, v33, v32, s46
v_perm_b32 v68, v33, v32, s47
s_mov_b32 s20, 3940352
buffer_load_dword v32, v1, s[12:15], s20 offen
s_mov_b32 s21, 3973120
buffer_load_dword v33, v1, s[12:15], s21 offen
s_waitcnt vmcnt(58)
v_perm_b32 v185, v35, v34, s46
v_perm_b32 v69, v35, v34, s47
s_mov_b32 s20, 4005888
buffer_load_dword v34, v1, s[12:15], s20 offen
s_mov_b32 s21, 4038656
buffer_load_dword v35, v1, s[12:15], s21 offen
s_waitcnt vmcnt(58)
v_perm_b32 v186, v37, v36, s46
v_perm_b32 v70, v37, v36, s47
s_mov_b32 s20, 4194304
buffer_load_dword v36, v1, s[12:15], s20 offen
s_mov_b32 s21, 4227072
buffer_load_dword v37, v1, s[12:15], s21 offen
s_waitcnt vmcnt(58)
v_perm_b32 v187, v39, v38, s46
v_perm_b32 v71, v39, v38, s47
ds_write_b128 v3, v[68:71] offset:8192
s_waitcnt lgkmcnt(0)
s_mov_b32 s20, 4259840
buffer_load_dword v38, v1, s[12:15], s20 offen
s_mov_b32 s21, 4292608
buffer_load_dword v39, v1, s[12:15], s21 offen
s_waitcnt vmcnt(58)
v_perm_b32 v188, v41, v40, s46
v_perm_b32 v68, v41, v40, s47
s_mov_b32 s20, 4202496
buffer_load_dword v40, v1, s[12:15], s20 offen
s_mov_b32 s21, 4235264
buffer_load_dword v41, v1, s[12:15], s21 offen
s_waitcnt vmcnt(58)
v_perm_b32 v189, v43, v42, s46
v_perm_b32 v69, v43, v42, s47
s_mov_b32 s20, 4268032
buffer_load_dword v42, v1, s[12:15], s20 offen
s_mov_b32 s21, 4300800
buffer_load_dword v43, v1, s[12:15], s21 offen
s_waitcnt vmcnt(58)
v_perm_b32 v190, v45, v44, s46
v_perm_b32 v70, v45, v44, s47
s_mov_b32 s20, 4456448
buffer_load_dword v44, v1, s[12:15], s20 offen
s_mov_b32 s21, 4489216
buffer_load_dword v45, v1, s[12:15], s21 offen
s_waitcnt vmcnt(58)
v_perm_b32 v191, v47, v46, s46
v_perm_b32 v71, v47, v46, s47
ds_write_b128 v3, v[68:71] offset:9216
s_waitcnt lgkmcnt(0)
s_mov_b32 s20, 4521984
buffer_load_dword v46, v1, s[12:15], s20 offen
s_mov_b32 s21, 4554752
buffer_load_dword v47, v1, s[12:15], s21 offen
s_waitcnt vmcnt(58)
v_perm_b32 v208, v49, v48, s46
v_perm_b32 v68, v49, v48, s47
s_mov_b32 s20, 4464640
buffer_load_dword v48, v1, s[12:15], s20 offen
s_mov_b32 s21, 4497408
buffer_load_dword v49, v1, s[12:15], s21 offen
s_waitcnt vmcnt(58)
v_perm_b32 v209, v51, v50, s46
v_perm_b32 v69, v51, v50, s47
s_mov_b32 s20, 4530176
buffer_load_dword v50, v1, s[12:15], s20 offen
s_mov_b32 s21, 4562944
buffer_load_dword v51, v1, s[12:15], s21 offen
s_waitcnt vmcnt(58)
v_perm_b32 v210, v53, v52, s46
v_perm_b32 v70, v53, v52, s47
s_load_dwordx2 s[50:51], s[0:1], 80
s_waitcnt lgkmcnt(0)
s_mov_b32 s12, s50
s_and_b32 s13, s51, 0xffff
s_mov_b32 s14, 4718592
s_mov_b32 s15, 0x20000
s_mov_b32 s20, 0
buffer_load_dword v52, v1, s[12:15], s20 offen
s_mov_b32 s21, 32768
buffer_load_dword v53, v1, s[12:15], s21 offen
s_waitcnt vmcnt(58)
v_perm_b32 v211, v55, v54, s46
v_perm_b32 v71, v55, v54, s47
ds_write_b128 v3, v[68:71] offset:10240
s_waitcnt lgkmcnt(0)
s_mov_b32 s20, 65536
buffer_load_dword v54, v1, s[12:15], s20 offen
s_mov_b32 s21, 98304
buffer_load_dword v55, v1, s[12:15], s21 offen
s_waitcnt vmcnt(58)
v_perm_b32 v212, v57, v56, s46
v_perm_b32 v68, v57, v56, s47
s_mov_b32 s20, 8192
buffer_load_dword v56, v1, s[12:15], s20 offen
s_mov_b32 s21, 40960
buffer_load_dword v57, v1, s[12:15], s21 offen
s_waitcnt vmcnt(58)
v_perm_b32 v213, v59, v58, s46
v_perm_b32 v69, v59, v58, s47
s_mov_b32 s20, 73728
buffer_load_dword v58, v1, s[12:15], s20 offen
s_mov_b32 s21, 106496
buffer_load_dword v59, v1, s[12:15], s21 offen
s_waitcnt vmcnt(58)
v_perm_b32 v214, v61, v60, s46
v_perm_b32 v70, v61, v60, s47
s_mov_b32 s20, 262144
buffer_load_dword v60, v1, s[12:15], s20 offen
s_mov_b32 s21, 294912
buffer_load_dword v61, v1, s[12:15], s21 offen
s_waitcnt vmcnt(58)
v_perm_b32 v215, v63, v62, s46
v_perm_b32 v71, v63, v62, s47
ds_write_b128 v3, v[68:71] offset:11264
s_waitcnt lgkmcnt(0)
s_mov_b32 s20, 327680
buffer_load_dword v62, v1, s[12:15], s20 offen
s_mov_b32 s21, 360448
buffer_load_dword v63, v1, s[12:15], s21 offen
s_waitcnt vmcnt(58)
v_perm_b32 v232, v5, v4, s46
v_perm_b32 v68, v5, v4, s47
s_mov_b32 s20, 270336
buffer_load_dword v4, v1, s[12:15], s20 offen
s_mov_b32 s21, 303104
buffer_load_dword v5, v1, s[12:15], s21 offen
s_waitcnt vmcnt(58)
v_perm_b32 v233, v7, v6, s46
v_perm_b32 v69, v7, v6, s47
s_mov_b32 s20, 335872
buffer_load_dword v6, v1, s[12:15], s20 offen
s_mov_b32 s21, 368640
buffer_load_dword v7, v1, s[12:15], s21 offen
s_waitcnt vmcnt(58)
v_perm_b32 v234, v9, v8, s46
v_perm_b32 v70, v9, v8, s47
s_mov_b32 s20, 524288
buffer_load_dword v8, v1, s[12:15], s20 offen
s_mov_b32 s21, 557056
buffer_load_dword v9, v1, s[12:15], s21 offen
s_waitcnt vmcnt(58)
v_perm_b32 v235, v11, v10, s46
v_perm_b32 v71, v11, v10, s47
ds_write_b128 v3, v[68:71] offset:12288
s_waitcnt lgkmcnt(0)
s_mov_b32 s20, 589824
buffer_load_dword v10, v1, s[12:15], s20 offen
s_mov_b32 s21, 622592
buffer_load_dword v11, v1, s[12:15], s21 offen
s_waitcnt vmcnt(58)
v_perm_b32 v236, v13, v12, s46
v_perm_b32 v68, v13, v12, s47
s_mov_b32 s20, 532480
buffer_load_dword v12, v1, s[12:15], s20 offen
s_mov_b32 s21, 565248
buffer_load_dword v13, v1, s[12:15], s21 offen
s_waitcnt vmcnt(58)
v_perm_b32 v237, v15, v14, s46
v_perm_b32 v69, v15, v14, s47
s_mov_b32 s20, 598016
buffer_load_dword v14, v1, s[12:15], s20 offen
s_mov_b32 s21, 630784
buffer_load_dword v15, v1, s[12:15], s21 offen
s_waitcnt vmcnt(58)
v_perm_b32 v238, v17, v16, s46
v_perm_b32 v70, v17, v16, s47
s_mov_b32 s20, 786432
buffer_load_dword v16, v1, s[12:15], s20 offen
s_mov_b32 s21, 819200
buffer_load_dword v17, v1, s[12:15], s21 offen
s_waitcnt vmcnt(58)
v_perm_b32 v239, v19, v18, s46
v_perm_b32 v71, v19, v18, s47
ds_write_b128 v3, v[68:71] offset:13312
s_waitcnt lgkmcnt(0)
s_mov_b32 s20, 851968
buffer_load_dword v18, v1, s[12:15], s20 offen
s_mov_b32 s21, 884736
buffer_load_dword v19, v1, s[12:15], s21 offen
s_waitcnt vmcnt(58)
v_perm_b32 v64, v21, v20, s46
v_accvgpr_write_b32 a0, v64
v_perm_b32 v68, v21, v20, s47
s_mov_b32 s20, 794624
buffer_load_dword v20, v1, s[12:15], s20 offen
s_mov_b32 s21, 827392
buffer_load_dword v21, v1, s[12:15], s21 offen
s_waitcnt vmcnt(58)
v_perm_b32 v65, v23, v22, s46
v_accvgpr_write_b32 a1, v65
v_perm_b32 v69, v23, v22, s47
s_mov_b32 s20, 860160
buffer_load_dword v22, v1, s[12:15], s20 offen
s_mov_b32 s21, 892928
buffer_load_dword v23, v1, s[12:15], s21 offen
s_waitcnt vmcnt(58)
v_perm_b32 v66, v25, v24, s46
v_accvgpr_write_b32 a2, v66
v_perm_b32 v70, v25, v24, s47
s_mov_b32 s20, 1048576
buffer_load_dword v24, v1, s[12:15], s20 offen
s_mov_b32 s21, 1081344
buffer_load_dword v25, v1, s[12:15], s21 offen
s_waitcnt vmcnt(58)
v_perm_b32 v67, v27, v26, s46
v_accvgpr_write_b32 a3, v67
v_perm_b32 v71, v27, v26, s47
ds_write_b128 v3, v[68:71] offset:14336
s_waitcnt lgkmcnt(0)
s_mov_b32 s20, 1114112
buffer_load_dword v26, v1, s[12:15], s20 offen
s_mov_b32 s21, 1146880
buffer_load_dword v27, v1, s[12:15], s21 offen
s_waitcnt vmcnt(58)
v_perm_b32 v64, v29, v28, s46
v_accvgpr_write_b32 a4, v64
v_perm_b32 v68, v29, v28, s47
s_mov_b32 s20, 1056768
buffer_load_dword v28, v1, s[12:15], s20 offen
s_mov_b32 s21, 1089536
buffer_load_dword v29, v1, s[12:15], s21 offen
s_waitcnt vmcnt(58)
v_perm_b32 v65, v31, v30, s46
v_accvgpr_write_b32 a5, v65
v_perm_b32 v69, v31, v30, s47
s_mov_b32 s20, 1122304
buffer_load_dword v30, v1, s[12:15], s20 offen
s_mov_b32 s21, 1155072
buffer_load_dword v31, v1, s[12:15], s21 offen
s_waitcnt vmcnt(58)
v_perm_b32 v66, v33, v32, s46
v_accvgpr_write_b32 a6, v66
v_perm_b32 v70, v33, v32, s47
s_mov_b32 s20, 1310720
buffer_load_dword v32, v1, s[12:15], s20 offen
s_mov_b32 s21, 1343488
buffer_load_dword v33, v1, s[12:15], s21 offen
s_waitcnt vmcnt(58)
v_perm_b32 v67, v35, v34, s46
v_accvgpr_write_b32 a7, v67
v_perm_b32 v71, v35, v34, s47
ds_write_b128 v3, v[68:71] offset:15360
s_waitcnt lgkmcnt(0)
s_mov_b32 s20, 1376256
buffer_load_dword v34, v1, s[12:15], s20 offen
s_mov_b32 s21, 1409024
buffer_load_dword v35, v1, s[12:15], s21 offen
s_waitcnt vmcnt(58)
v_perm_b32 v64, v37, v36, s46
v_accvgpr_write_b32 a24, v64
v_perm_b32 v68, v37, v36, s47
s_mov_b32 s20, 1318912
buffer_load_dword v36, v1, s[12:15], s20 offen
s_mov_b32 s21, 1351680
buffer_load_dword v37, v1, s[12:15], s21 offen
s_waitcnt vmcnt(58)
v_perm_b32 v65, v39, v38, s46
v_accvgpr_write_b32 a25, v65
v_perm_b32 v69, v39, v38, s47
s_mov_b32 s20, 1384448
buffer_load_dword v38, v1, s[12:15], s20 offen
s_mov_b32 s21, 1417216
buffer_load_dword v39, v1, s[12:15], s21 offen
s_waitcnt vmcnt(58)
v_perm_b32 v66, v41, v40, s46
v_accvgpr_write_b32 a26, v66
v_perm_b32 v70, v41, v40, s47
s_mov_b32 s20, 1572864
buffer_load_dword v40, v1, s[12:15], s20 offen
s_mov_b32 s21, 1605632
buffer_load_dword v41, v1, s[12:15], s21 offen
s_waitcnt vmcnt(58)
v_perm_b32 v67, v43, v42, s46
v_accvgpr_write_b32 a27, v67
v_perm_b32 v71, v43, v42, s47
ds_write_b128 v3, v[68:71] offset:16384
s_waitcnt lgkmcnt(0)
s_mov_b32 s20, 1638400
buffer_load_dword v42, v1, s[12:15], s20 offen
s_mov_b32 s21, 1671168
buffer_load_dword v43, v1, s[12:15], s21 offen
s_waitcnt vmcnt(58)
v_perm_b32 v64, v45, v44, s46
v_accvgpr_write_b32 a28, v64
v_perm_b32 v68, v45, v44, s47
s_mov_b32 s20, 1581056
buffer_load_dword v44, v1, s[12:15], s20 offen
s_mov_b32 s21, 1613824
buffer_load_dword v45, v1, s[12:15], s21 offen
s_waitcnt vmcnt(58)
v_perm_b32 v65, v47, v46, s46
v_accvgpr_write_b32 a29, v65
v_perm_b32 v69, v47, v46, s47
s_mov_b32 s20, 1646592
buffer_load_dword v46, v1, s[12:15], s20 offen
s_mov_b32 s21, 1679360
buffer_load_dword v47, v1, s[12:15], s21 offen
s_waitcnt vmcnt(58)
v_perm_b32 v66, v49, v48, s46
v_accvgpr_write_b32 a30, v66
v_perm_b32 v70, v49, v48, s47
s_mov_b32 s20, 1835008
buffer_load_dword v48, v1, s[12:15], s20 offen
s_mov_b32 s21, 1867776
buffer_load_dword v49, v1, s[12:15], s21 offen
s_waitcnt vmcnt(58)
v_perm_b32 v67, v51, v50, s46
v_accvgpr_write_b32 a31, v67
v_perm_b32 v71, v51, v50, s47
ds_write_b128 v3, v[68:71] offset:17408
s_waitcnt lgkmcnt(0)
s_mov_b32 s20, 1900544
buffer_load_dword v50, v1, s[12:15], s20 offen
s_mov_b32 s21, 1933312
buffer_load_dword v51, v1, s[12:15], s21 offen
s_waitcnt vmcnt(58)
v_perm_b32 v64, v53, v52, s46
v_accvgpr_write_b32 a32, v64
v_perm_b32 v68, v53, v52, s47
v_accvgpr_write_b32 a40, v68
s_mov_b32 s20, 1843200
buffer_load_dword v52, v1, s[12:15], s20 offen
s_mov_b32 s21, 1875968
buffer_load_dword v53, v1, s[12:15], s21 offen
s_waitcnt vmcnt(58)
v_perm_b32 v65, v55, v54, s46
v_accvgpr_write_b32 a33, v65
v_perm_b32 v69, v55, v54, s47
v_accvgpr_write_b32 a41, v69
s_mov_b32 s20, 1908736
buffer_load_dword v54, v1, s[12:15], s20 offen
s_mov_b32 s21, 1941504
buffer_load_dword v55, v1, s[12:15], s21 offen
s_waitcnt vmcnt(58)
v_perm_b32 v66, v57, v56, s46
v_accvgpr_write_b32 a34, v66
v_perm_b32 v70, v57, v56, s47
v_accvgpr_write_b32 a42, v70
s_mov_b32 s20, 2097152
buffer_load_dword v56, v1, s[12:15], s20 offen
s_mov_b32 s21, 2129920
buffer_load_dword v57, v1, s[12:15], s21 offen
s_waitcnt vmcnt(58)
v_perm_b32 v67, v59, v58, s46
v_accvgpr_write_b32 a35, v67
v_perm_b32 v71, v59, v58, s47
v_accvgpr_write_b32 a43, v71
s_mov_b32 s20, 2162688
buffer_load_dword v58, v1, s[12:15], s20 offen
s_mov_b32 s21, 2195456
buffer_load_dword v59, v1, s[12:15], s21 offen
s_waitcnt vmcnt(58)
v_perm_b32 v64, v61, v60, s46
v_accvgpr_write_b32 a36, v64
v_perm_b32 v68, v61, v60, s47
v_accvgpr_write_b32 a44, v68
s_mov_b32 s20, 2105344
buffer_load_dword v60, v1, s[12:15], s20 offen
s_mov_b32 s21, 2138112
buffer_load_dword v61, v1, s[12:15], s21 offen
s_waitcnt vmcnt(58)
v_perm_b32 v65, v63, v62, s46
v_accvgpr_write_b32 a37, v65
v_perm_b32 v69, v63, v62, s47
v_accvgpr_write_b32 a45, v69
s_mov_b32 s20, 2170880
buffer_load_dword v62, v1, s[12:15], s20 offen
s_mov_b32 s21, 2203648
buffer_load_dword v63, v1, s[12:15], s21 offen
s_waitcnt vmcnt(58)
v_perm_b32 v66, v5, v4, s46
v_accvgpr_write_b32 a38, v66
v_perm_b32 v70, v5, v4, s47
v_accvgpr_write_b32 a46, v70
s_mov_b32 s20, 2359296
buffer_load_dword v4, v1, s[12:15], s20 offen
s_mov_b32 s21, 2392064
buffer_load_dword v5, v1, s[12:15], s21 offen
s_waitcnt vmcnt(58)
v_perm_b32 v67, v7, v6, s46
v_accvgpr_write_b32 a39, v67
v_perm_b32 v71, v7, v6, s47
v_accvgpr_write_b32 a47, v71
s_mov_b32 s20, 2424832
buffer_load_dword v6, v1, s[12:15], s20 offen
s_mov_b32 s21, 2457600
buffer_load_dword v7, v1, s[12:15], s21 offen
s_waitcnt vmcnt(58)
v_perm_b32 v64, v9, v8, s46
v_accvgpr_write_b32 a48, v64
v_perm_b32 v68, v9, v8, s47
v_accvgpr_write_b32 a56, v68
s_mov_b32 s20, 2367488
buffer_load_dword v8, v1, s[12:15], s20 offen
s_mov_b32 s21, 2400256
buffer_load_dword v9, v1, s[12:15], s21 offen
s_waitcnt vmcnt(58)
v_perm_b32 v65, v11, v10, s46
v_accvgpr_write_b32 a49, v65
v_perm_b32 v69, v11, v10, s47
v_accvgpr_write_b32 a57, v69
s_mov_b32 s20, 2433024
buffer_load_dword v10, v1, s[12:15], s20 offen
s_mov_b32 s21, 2465792
buffer_load_dword v11, v1, s[12:15], s21 offen
s_waitcnt vmcnt(58)
v_perm_b32 v66, v13, v12, s46
v_accvgpr_write_b32 a50, v66
v_perm_b32 v70, v13, v12, s47
v_accvgpr_write_b32 a58, v70
s_mov_b32 s20, 2621440
buffer_load_dword v12, v1, s[12:15], s20 offen
s_mov_b32 s21, 2654208
buffer_load_dword v13, v1, s[12:15], s21 offen
s_waitcnt vmcnt(58)
v_perm_b32 v67, v15, v14, s46
v_accvgpr_write_b32 a51, v67
v_perm_b32 v71, v15, v14, s47
v_accvgpr_write_b32 a59, v71
s_mov_b32 s20, 2686976
buffer_load_dword v14, v1, s[12:15], s20 offen
s_mov_b32 s21, 2719744
buffer_load_dword v15, v1, s[12:15], s21 offen
s_waitcnt vmcnt(58)
v_perm_b32 v64, v17, v16, s46
v_accvgpr_write_b32 a52, v64
v_perm_b32 v68, v17, v16, s47
v_accvgpr_write_b32 a60, v68
s_mov_b32 s20, 2629632
buffer_load_dword v16, v1, s[12:15], s20 offen
s_mov_b32 s21, 2662400
buffer_load_dword v17, v1, s[12:15], s21 offen
s_waitcnt vmcnt(58)
v_perm_b32 v65, v19, v18, s46
v_accvgpr_write_b32 a53, v65
v_perm_b32 v69, v19, v18, s47
v_accvgpr_write_b32 a61, v69
s_mov_b32 s20, 2695168
buffer_load_dword v18, v1, s[12:15], s20 offen
s_mov_b32 s21, 2727936
buffer_load_dword v19, v1, s[12:15], s21 offen
s_waitcnt vmcnt(58)
v_perm_b32 v66, v21, v20, s46
v_accvgpr_write_b32 a54, v66
v_perm_b32 v70, v21, v20, s47
v_accvgpr_write_b32 a62, v70
s_mov_b32 s20, 2883584
buffer_load_dword v20, v1, s[12:15], s20 offen
s_mov_b32 s21, 2916352
buffer_load_dword v21, v1, s[12:15], s21 offen
s_waitcnt vmcnt(58)
v_perm_b32 v67, v23, v22, s46
v_accvgpr_write_b32 a55, v67
v_perm_b32 v71, v23, v22, s47
v_accvgpr_write_b32 a63, v71
s_mov_b32 s20, 2949120
buffer_load_dword v22, v1, s[12:15], s20 offen
s_mov_b32 s21, 2981888
buffer_load_dword v23, v1, s[12:15], s21 offen
s_waitcnt vmcnt(58)
v_perm_b32 v64, v25, v24, s46
v_accvgpr_write_b32 a64, v64
v_perm_b32 v68, v25, v24, s47
v_accvgpr_write_b32 a72, v68
s_mov_b32 s20, 2891776
buffer_load_dword v24, v1, s[12:15], s20 offen
s_mov_b32 s21, 2924544
buffer_load_dword v25, v1, s[12:15], s21 offen
s_waitcnt vmcnt(58)
v_perm_b32 v65, v27, v26, s46
v_accvgpr_write_b32 a65, v65
v_perm_b32 v69, v27, v26, s47
v_accvgpr_write_b32 a73, v69
s_mov_b32 s20, 2957312
buffer_load_dword v26, v1, s[12:15], s20 offen
s_mov_b32 s21, 2990080
buffer_load_dword v27, v1, s[12:15], s21 offen
s_waitcnt vmcnt(58)
v_perm_b32 v66, v29, v28, s46
v_accvgpr_write_b32 a66, v66
v_perm_b32 v70, v29, v28, s47
v_accvgpr_write_b32 a74, v70
s_mov_b32 s20, 3145728
buffer_load_dword v28, v1, s[12:15], s20 offen
s_mov_b32 s21, 3178496
buffer_load_dword v29, v1, s[12:15], s21 offen
s_waitcnt vmcnt(58)
v_perm_b32 v67, v31, v30, s46
v_accvgpr_write_b32 a67, v67
v_perm_b32 v71, v31, v30, s47
v_accvgpr_write_b32 a75, v71
s_mov_b32 s20, 3211264
buffer_load_dword v30, v1, s[12:15], s20 offen
s_mov_b32 s21, 3244032
buffer_load_dword v31, v1, s[12:15], s21 offen
s_waitcnt vmcnt(58)
v_perm_b32 v64, v33, v32, s46
v_accvgpr_write_b32 a68, v64
v_perm_b32 v68, v33, v32, s47
v_accvgpr_write_b32 a76, v68
s_mov_b32 s20, 3153920
buffer_load_dword v32, v1, s[12:15], s20 offen
s_mov_b32 s21, 3186688
buffer_load_dword v33, v1, s[12:15], s21 offen
s_waitcnt vmcnt(58)
v_perm_b32 v65, v35, v34, s46
v_accvgpr_write_b32 a69, v65
v_perm_b32 v69, v35, v34, s47
v_accvgpr_write_b32 a77, v69
s_mov_b32 s20, 3219456
buffer_load_dword v34, v1, s[12:15], s20 offen
s_mov_b32 s21, 3252224
buffer_load_dword v35, v1, s[12:15], s21 offen
s_waitcnt vmcnt(58)
v_perm_b32 v66, v37, v36, s46
v_accvgpr_write_b32 a70, v66
v_perm_b32 v70, v37, v36, s47
v_accvgpr_write_b32 a78, v70
s_mov_b32 s20, 3407872
buffer_load_dword v36, v1, s[12:15], s20 offen
s_mov_b32 s21, 3440640
buffer_load_dword v37, v1, s[12:15], s21 offen
s_waitcnt vmcnt(58)
v_perm_b32 v67, v39, v38, s46
v_accvgpr_write_b32 a71, v67
v_perm_b32 v71, v39, v38, s47
v_accvgpr_write_b32 a79, v71
s_mov_b32 s20, 3473408
buffer_load_dword v38, v1, s[12:15], s20 offen
s_mov_b32 s21, 3506176
buffer_load_dword v39, v1, s[12:15], s21 offen
s_waitcnt vmcnt(58)
v_perm_b32 v64, v41, v40, s46
v_accvgpr_write_b32 a80, v64
v_perm_b32 v68, v41, v40, s47
v_accvgpr_write_b32 a88, v68
s_mov_b32 s20, 3416064
buffer_load_dword v40, v1, s[12:15], s20 offen
s_mov_b32 s21, 3448832
buffer_load_dword v41, v1, s[12:15], s21 offen
s_waitcnt vmcnt(58)
v_perm_b32 v65, v43, v42, s46
v_accvgpr_write_b32 a81, v65
v_perm_b32 v69, v43, v42, s47
v_accvgpr_write_b32 a89, v69
s_mov_b32 s20, 3481600
buffer_load_dword v42, v1, s[12:15], s20 offen
s_mov_b32 s21, 3514368
buffer_load_dword v43, v1, s[12:15], s21 offen
s_waitcnt vmcnt(58)
v_perm_b32 v66, v45, v44, s46
v_accvgpr_write_b32 a82, v66
v_perm_b32 v70, v45, v44, s47
v_accvgpr_write_b32 a90, v70
s_mov_b32 s20, 3670016
buffer_load_dword v44, v1, s[12:15], s20 offen
s_mov_b32 s21, 3702784
buffer_load_dword v45, v1, s[12:15], s21 offen
s_waitcnt vmcnt(58)
v_perm_b32 v67, v47, v46, s46
v_accvgpr_write_b32 a83, v67
v_perm_b32 v71, v47, v46, s47
v_accvgpr_write_b32 a91, v71
s_mov_b32 s20, 3735552
buffer_load_dword v46, v1, s[12:15], s20 offen
s_mov_b32 s21, 3768320
buffer_load_dword v47, v1, s[12:15], s21 offen
s_waitcnt vmcnt(58)
v_perm_b32 v64, v49, v48, s46
v_accvgpr_write_b32 a84, v64
v_perm_b32 v68, v49, v48, s47
v_accvgpr_write_b32 a92, v68
s_mov_b32 s20, 3678208
buffer_load_dword v48, v1, s[12:15], s20 offen
s_mov_b32 s21, 3710976
buffer_load_dword v49, v1, s[12:15], s21 offen
s_waitcnt vmcnt(58)
v_perm_b32 v65, v51, v50, s46
v_accvgpr_write_b32 a85, v65
v_perm_b32 v69, v51, v50, s47
v_accvgpr_write_b32 a93, v69
s_mov_b32 s20, 3743744
buffer_load_dword v50, v1, s[12:15], s20 offen
s_mov_b32 s21, 3776512
buffer_load_dword v51, v1, s[12:15], s21 offen
s_waitcnt vmcnt(58)
v_perm_b32 v66, v53, v52, s46
v_accvgpr_write_b32 a86, v66
v_perm_b32 v70, v53, v52, s47
v_accvgpr_write_b32 a94, v70
s_mov_b32 s20, 3932160
buffer_load_dword v52, v1, s[12:15], s20 offen
s_mov_b32 s21, 3964928
buffer_load_dword v53, v1, s[12:15], s21 offen
s_waitcnt vmcnt(58)
v_perm_b32 v67, v55, v54, s46
v_accvgpr_write_b32 a87, v67
v_perm_b32 v71, v55, v54, s47
v_accvgpr_write_b32 a95, v71
s_mov_b32 s20, 3997696
buffer_load_dword v54, v1, s[12:15], s20 offen
s_mov_b32 s21, 4030464
buffer_load_dword v55, v1, s[12:15], s21 offen
s_waitcnt vmcnt(58)
v_perm_b32 v64, v57, v56, s46
v_accvgpr_write_b32 a96, v64
v_perm_b32 v68, v57, v56, s47
v_accvgpr_write_b32 a104, v68
s_mov_b32 s20, 3940352
buffer_load_dword v56, v1, s[12:15], s20 offen
s_mov_b32 s21, 3973120
buffer_load_dword v57, v1, s[12:15], s21 offen
s_waitcnt vmcnt(58)
v_perm_b32 v65, v59, v58, s46
v_accvgpr_write_b32 a97, v65
v_perm_b32 v69, v59, v58, s47
v_accvgpr_write_b32 a105, v69
s_mov_b32 s20, 4005888
buffer_load_dword v58, v1, s[12:15], s20 offen
s_mov_b32 s21, 4038656
buffer_load_dword v59, v1, s[12:15], s21 offen
s_waitcnt vmcnt(58)
v_perm_b32 v66, v61, v60, s46
v_accvgpr_write_b32 a98, v66
v_perm_b32 v70, v61, v60, s47
v_accvgpr_write_b32 a106, v70
s_mov_b32 s20, 4194304
buffer_load_dword v60, v1, s[12:15], s20 offen
s_mov_b32 s21, 4227072
buffer_load_dword v61, v1, s[12:15], s21 offen
s_waitcnt vmcnt(58)
v_perm_b32 v67, v63, v62, s46
v_accvgpr_write_b32 a99, v67
v_perm_b32 v71, v63, v62, s47
v_accvgpr_write_b32 a107, v71
s_mov_b32 s20, 4259840
buffer_load_dword v62, v1, s[12:15], s20 offen
s_mov_b32 s21, 4292608
buffer_load_dword v63, v1, s[12:15], s21 offen
s_waitcnt vmcnt(58)
v_perm_b32 v64, v5, v4, s46
v_accvgpr_write_b32 a100, v64
v_perm_b32 v68, v5, v4, s47
v_accvgpr_write_b32 a108, v68
s_mov_b32 s20, 4202496
buffer_load_dword v4, v1, s[12:15], s20 offen
s_mov_b32 s21, 4235264
buffer_load_dword v5, v1, s[12:15], s21 offen
s_waitcnt vmcnt(58)
v_perm_b32 v65, v7, v6, s46
v_accvgpr_write_b32 a101, v65
v_perm_b32 v69, v7, v6, s47
v_accvgpr_write_b32 a109, v69
s_mov_b32 s20, 4268032
buffer_load_dword v6, v1, s[12:15], s20 offen
s_mov_b32 s21, 4300800
buffer_load_dword v7, v1, s[12:15], s21 offen
s_waitcnt vmcnt(58)
v_perm_b32 v66, v9, v8, s46
v_accvgpr_write_b32 a102, v66
v_perm_b32 v70, v9, v8, s47
v_accvgpr_write_b32 a110, v70
s_mov_b32 s20, 4456448
buffer_load_dword v8, v1, s[12:15], s20 offen
s_mov_b32 s21, 4489216
buffer_load_dword v9, v1, s[12:15], s21 offen
s_waitcnt vmcnt(58)
v_perm_b32 v67, v11, v10, s46
v_accvgpr_write_b32 a103, v67
v_perm_b32 v71, v11, v10, s47
v_accvgpr_write_b32 a111, v71
s_mov_b32 s20, 4521984
buffer_load_dword v10, v1, s[12:15], s20 offen
s_mov_b32 s21, 4554752
buffer_load_dword v11, v1, s[12:15], s21 offen
s_waitcnt vmcnt(58)
v_perm_b32 v64, v13, v12, s46
v_accvgpr_write_b32 a112, v64
v_perm_b32 v68, v13, v12, s47
v_accvgpr_write_b32 a120, v68
s_mov_b32 s20, 4464640
buffer_load_dword v12, v1, s[12:15], s20 offen
s_mov_b32 s21, 4497408
buffer_load_dword v13, v1, s[12:15], s21 offen
s_waitcnt vmcnt(58)
v_perm_b32 v65, v15, v14, s46
v_accvgpr_write_b32 a113, v65
v_perm_b32 v69, v15, v14, s47
v_accvgpr_write_b32 a121, v69
s_mov_b32 s20, 4530176
buffer_load_dword v14, v1, s[12:15], s20 offen
s_mov_b32 s21, 4562944
buffer_load_dword v15, v1, s[12:15], s21 offen
s_waitcnt vmcnt(58)
v_perm_b32 v66, v17, v16, s46
v_accvgpr_write_b32 a114, v66
v_perm_b32 v70, v17, v16, s47
v_accvgpr_write_b32 a122, v70
s_load_dwordx2 s[50:51], s[0:1], 88
s_waitcnt lgkmcnt(0)
s_mov_b32 s12, s50
s_and_b32 s13, s51, 0xffff
s_mov_b32 s14, 4718592
s_mov_b32 s15, 0x20000
v_and_b32 v1, 15, v0
s_lshl_b32 s20, s17, 4
v_add_u32 v1, s20, v1
v_lshlrev_b32 v1, 1, v1
v_add_u32 v2, v2, v1
v_add_u32 v1, v2, v1
s_mov_b32 s20, 0
buffer_load_dword v16, v1, s[12:15], s20 offen
s_mov_b32 s21, 1152
buffer_load_dword v17, v1, s[12:15], s21 offen
s_waitcnt vmcnt(58)
v_perm_b32 v67, v19, v18, s46
v_accvgpr_write_b32 a115, v67
v_perm_b32 v71, v19, v18, s47
v_accvgpr_write_b32 a123, v71
s_mov_b32 s20, 9216
buffer_load_dword v18, v1, s[12:15], s20 offen
s_mov_b32 s21, 10368
buffer_load_dword v19, v1, s[12:15], s21 offen
s_waitcnt vmcnt(58)
v_perm_b32 v64, v21, v20, s46
v_accvgpr_write_b32 a116, v64
v_perm_b32 v68, v21, v20, s47
v_accvgpr_write_b32 a124, v68
s_mov_b32 s20, 2304
buffer_load_dword v20, v1, s[12:15], s20 offen
s_mov_b32 s21, 3456
buffer_load_dword v21, v1, s[12:15], s21 offen
s_waitcnt vmcnt(58)
v_perm_b32 v65, v23, v22, s46
v_accvgpr_write_b32 a117, v65
v_perm_b32 v69, v23, v22, s47
v_accvgpr_write_b32 a125, v69
s_mov_b32 s20, 11520
buffer_load_dword v22, v1, s[12:15], s20 offen
s_mov_b32 s21, 12672
buffer_load_dword v23, v1, s[12:15], s21 offen
s_waitcnt vmcnt(58)
v_perm_b32 v66, v25, v24, s46
v_accvgpr_write_b32 a118, v66
v_perm_b32 v70, v25, v24, s47
v_accvgpr_write_b32 a126, v70
s_mov_b32 s20, 36864
buffer_load_dword v24, v1, s[12:15], s20 offen
s_mov_b32 s21, 38016
buffer_load_dword v25, v1, s[12:15], s21 offen
s_waitcnt vmcnt(58)
v_perm_b32 v67, v27, v26, s46
v_accvgpr_write_b32 a119, v67
v_perm_b32 v71, v27, v26, s47
v_accvgpr_write_b32 a127, v71
s_mov_b32 s20, 46080
buffer_load_dword v26, v1, s[12:15], s20 offen
s_mov_b32 s21, 47232
buffer_load_dword v27, v1, s[12:15], s21 offen
s_waitcnt vmcnt(58)
v_perm_b32 v64, v29, v28, s46
v_accvgpr_write_b32 a128, v64
v_perm_b32 v68, v29, v28, s47
v_accvgpr_write_b32 a136, v68
s_mov_b32 s20, 39168
buffer_load_dword v28, v1, s[12:15], s20 offen
s_mov_b32 s21, 40320
buffer_load_dword v29, v1, s[12:15], s21 offen
s_waitcnt vmcnt(58)
v_perm_b32 v65, v31, v30, s46
v_accvgpr_write_b32 a129, v65
v_perm_b32 v69, v31, v30, s47
v_accvgpr_write_b32 a137, v69
s_mov_b32 s20, 48384
buffer_load_dword v30, v1, s[12:15], s20 offen
s_mov_b32 s21, 49536
buffer_load_dword v31, v1, s[12:15], s21 offen
s_waitcnt vmcnt(58)
v_perm_b32 v66, v33, v32, s46
v_accvgpr_write_b32 a130, v66
v_perm_b32 v70, v33, v32, s47
v_accvgpr_write_b32 a138, v70
s_mov_b32 s20, 73728
buffer_load_dword v32, v1, s[12:15], s20 offen
s_mov_b32 s21, 74880
buffer_load_dword v33, v1, s[12:15], s21 offen
s_waitcnt vmcnt(58)
v_perm_b32 v67, v35, v34, s46
v_accvgpr_write_b32 a131, v67
v_perm_b32 v71, v35, v34, s47
v_accvgpr_write_b32 a139, v71
s_mov_b32 s20, 82944
buffer_load_dword v34, v1, s[12:15], s20 offen
s_mov_b32 s21, 84096
buffer_load_dword v35, v1, s[12:15], s21 offen
s_waitcnt vmcnt(58)
v_perm_b32 v64, v37, v36, s46
v_accvgpr_write_b32 a132, v64
v_perm_b32 v68, v37, v36, s47
v_accvgpr_write_b32 a140, v68
s_mov_b32 s20, 76032
buffer_load_dword v36, v1, s[12:15], s20 offen
s_mov_b32 s21, 77184
buffer_load_dword v37, v1, s[12:15], s21 offen
s_waitcnt vmcnt(58)
v_perm_b32 v65, v39, v38, s46
v_accvgpr_write_b32 a133, v65
v_perm_b32 v69, v39, v38, s47
v_accvgpr_write_b32 a141, v69
s_mov_b32 s20, 85248
buffer_load_dword v38, v1, s[12:15], s20 offen
s_mov_b32 s21, 86400
buffer_load_dword v39, v1, s[12:15], s21 offen
s_waitcnt vmcnt(58)
v_perm_b32 v66, v41, v40, s46
v_accvgpr_write_b32 a134, v66
v_perm_b32 v70, v41, v40, s47
v_accvgpr_write_b32 a142, v70
s_mov_b32 s20, 110592
buffer_load_dword v40, v1, s[12:15], s20 offen
s_mov_b32 s21, 111744
buffer_load_dword v41, v1, s[12:15], s21 offen
s_waitcnt vmcnt(58)
v_perm_b32 v67, v43, v42, s46
v_accvgpr_write_b32 a135, v67
v_perm_b32 v71, v43, v42, s47
v_accvgpr_write_b32 a143, v71
s_mov_b32 s20, 119808
buffer_load_dword v42, v1, s[12:15], s20 offen
s_mov_b32 s21, 120960
buffer_load_dword v43, v1, s[12:15], s21 offen
s_waitcnt vmcnt(58)
v_perm_b32 v64, v45, v44, s46
v_accvgpr_write_b32 a144, v64
v_perm_b32 v68, v45, v44, s47
v_accvgpr_write_b32 a152, v68
s_mov_b32 s20, 112896
buffer_load_dword v44, v1, s[12:15], s20 offen
s_mov_b32 s21, 114048
buffer_load_dword v45, v1, s[12:15], s21 offen
s_waitcnt vmcnt(58)
v_perm_b32 v65, v47, v46, s46
v_accvgpr_write_b32 a145, v65
v_perm_b32 v69, v47, v46, s47
v_accvgpr_write_b32 a153, v69
s_mov_b32 s20, 122112
buffer_load_dword v46, v1, s[12:15], s20 offen
s_mov_b32 s21, 123264
buffer_load_dword v47, v1, s[12:15], s21 offen
s_waitcnt vmcnt(58)
v_perm_b32 v66, v49, v48, s46
v_accvgpr_write_b32 a146, v66
v_perm_b32 v70, v49, v48, s47
v_accvgpr_write_b32 a154, v70
s_mov_b32 s20, 256
buffer_load_dword v48, v1, s[12:15], s20 offen
s_mov_b32 s21, 1408
buffer_load_dword v49, v1, s[12:15], s21 offen
s_waitcnt vmcnt(58)
v_perm_b32 v67, v51, v50, s46
v_accvgpr_write_b32 a147, v67
v_perm_b32 v71, v51, v50, s47
v_accvgpr_write_b32 a155, v71
s_mov_b32 s20, 9472
buffer_load_dword v50, v1, s[12:15], s20 offen
s_mov_b32 s21, 10624
buffer_load_dword v51, v1, s[12:15], s21 offen
s_waitcnt vmcnt(58)
v_perm_b32 v64, v53, v52, s46
v_accvgpr_write_b32 a148, v64
v_perm_b32 v68, v53, v52, s47
v_accvgpr_write_b32 a156, v68
s_mov_b32 s20, 2560
buffer_load_dword v52, v1, s[12:15], s20 offen
s_mov_b32 s21, 3712
buffer_load_dword v53, v1, s[12:15], s21 offen
s_waitcnt vmcnt(58)
v_perm_b32 v65, v55, v54, s46
v_accvgpr_write_b32 a149, v65
v_perm_b32 v69, v55, v54, s47
v_accvgpr_write_b32 a157, v69
s_mov_b32 s20, 11776
buffer_load_dword v54, v1, s[12:15], s20 offen
s_mov_b32 s21, 12928
buffer_load_dword v55, v1, s[12:15], s21 offen
s_waitcnt vmcnt(58)
v_perm_b32 v66, v57, v56, s46
v_accvgpr_write_b32 a150, v66
v_perm_b32 v70, v57, v56, s47
v_accvgpr_write_b32 a158, v70
s_mov_b32 s20, 37120
buffer_load_dword v56, v1, s[12:15], s20 offen
s_mov_b32 s21, 38272
buffer_load_dword v57, v1, s[12:15], s21 offen
s_waitcnt vmcnt(58)
v_perm_b32 v67, v59, v58, s46
v_accvgpr_write_b32 a151, v67
v_perm_b32 v71, v59, v58, s47
v_accvgpr_write_b32 a159, v71
s_mov_b32 s20, 46336
buffer_load_dword v58, v1, s[12:15], s20 offen
s_mov_b32 s21, 47488
buffer_load_dword v59, v1, s[12:15], s21 offen
s_waitcnt vmcnt(58)
v_perm_b32 v64, v61, v60, s46
v_accvgpr_write_b32 a160, v64
v_perm_b32 v68, v61, v60, s47
v_accvgpr_write_b32 a168, v68
s_mov_b32 s20, 39424
buffer_load_dword v60, v1, s[12:15], s20 offen
s_mov_b32 s21, 40576
buffer_load_dword v61, v1, s[12:15], s21 offen
s_waitcnt vmcnt(58)
v_perm_b32 v65, v63, v62, s46
v_accvgpr_write_b32 a161, v65
v_perm_b32 v69, v63, v62, s47
v_accvgpr_write_b32 a169, v69
s_mov_b32 s20, 48640
buffer_load_dword v62, v1, s[12:15], s20 offen
s_mov_b32 s21, 49792
buffer_load_dword v63, v1, s[12:15], s21 offen
s_waitcnt vmcnt(58)
v_perm_b32 v66, v5, v4, s46
v_accvgpr_write_b32 a162, v66
v_perm_b32 v70, v5, v4, s47
v_accvgpr_write_b32 a170, v70
s_mov_b32 s20, 73984
buffer_load_dword v4, v1, s[12:15], s20 offen
s_mov_b32 s21, 75136
buffer_load_dword v5, v1, s[12:15], s21 offen
s_waitcnt vmcnt(58)
v_perm_b32 v67, v7, v6, s46
v_accvgpr_write_b32 a163, v67
v_perm_b32 v71, v7, v6, s47
v_accvgpr_write_b32 a171, v71
s_mov_b32 s20, 83200
buffer_load_dword v6, v1, s[12:15], s20 offen
s_mov_b32 s21, 84352
buffer_load_dword v7, v1, s[12:15], s21 offen
s_waitcnt vmcnt(58)
v_perm_b32 v64, v9, v8, s46
v_accvgpr_write_b32 a164, v64
v_perm_b32 v68, v9, v8, s47
v_accvgpr_write_b32 a172, v68
s_mov_b32 s20, 76288
buffer_load_dword v8, v1, s[12:15], s20 offen
s_mov_b32 s21, 77440
buffer_load_dword v9, v1, s[12:15], s21 offen
s_waitcnt vmcnt(58)
v_perm_b32 v65, v11, v10, s46
v_accvgpr_write_b32 a165, v65
v_perm_b32 v69, v11, v10, s47
v_accvgpr_write_b32 a173, v69
s_mov_b32 s20, 85504
buffer_load_dword v10, v1, s[12:15], s20 offen
s_mov_b32 s21, 86656
buffer_load_dword v11, v1, s[12:15], s21 offen
s_waitcnt vmcnt(58)
v_perm_b32 v66, v13, v12, s46
v_accvgpr_write_b32 a166, v66
v_perm_b32 v70, v13, v12, s47
v_accvgpr_write_b32 a174, v70
s_mov_b32 s20, 110848
buffer_load_dword v12, v1, s[12:15], s20 offen
s_mov_b32 s21, 112000
buffer_load_dword v13, v1, s[12:15], s21 offen
s_waitcnt vmcnt(58)
v_perm_b32 v67, v15, v14, s46
v_accvgpr_write_b32 a167, v67
v_perm_b32 v71, v15, v14, s47
v_accvgpr_write_b32 a175, v71
s_mov_b32 s20, 120064
buffer_load_dword v14, v1, s[12:15], s20 offen
s_mov_b32 s21, 121216
buffer_load_dword v15, v1, s[12:15], s21 offen
s_waitcnt vmcnt(58)
v_perm_b32 v64, v17, v16, s46
v_accvgpr_write_b32 a176, v64
v_perm_b32 v68, v17, v16, s47
v_accvgpr_write_b32 a184, v68
s_mov_b32 s20, 113152
buffer_load_dword v16, v1, s[12:15], s20 offen
s_mov_b32 s21, 114304
buffer_load_dword v17, v1, s[12:15], s21 offen
s_waitcnt vmcnt(58)
v_perm_b32 v65, v19, v18, s46
v_accvgpr_write_b32 a177, v65
v_perm_b32 v69, v19, v18, s47
v_accvgpr_write_b32 a185, v69
s_mov_b32 s20, 122368
buffer_load_dword v18, v1, s[12:15], s20 offen
s_mov_b32 s21, 123520
buffer_load_dword v19, v1, s[12:15], s21 offen
s_waitcnt vmcnt(58)
v_perm_b32 v66, v21, v20, s46
v_accvgpr_write_b32 a178, v66
v_perm_b32 v70, v21, v20, s47
v_accvgpr_write_b32 a186, v70
s_mov_b32 s20, 512
buffer_load_dword v20, v1, s[12:15], s20 offen
s_mov_b32 s21, 1664
buffer_load_dword v21, v1, s[12:15], s21 offen
s_waitcnt vmcnt(58)
v_perm_b32 v67, v23, v22, s46
v_accvgpr_write_b32 a179, v67
v_perm_b32 v71, v23, v22, s47
v_accvgpr_write_b32 a187, v71
s_mov_b32 s20, 9728
buffer_load_dword v22, v1, s[12:15], s20 offen
s_mov_b32 s21, 10880
buffer_load_dword v23, v1, s[12:15], s21 offen
s_waitcnt vmcnt(58)
v_perm_b32 v64, v25, v24, s46
v_accvgpr_write_b32 a180, v64
v_perm_b32 v68, v25, v24, s47
v_accvgpr_write_b32 a188, v68
s_mov_b32 s20, 2816
buffer_load_dword v24, v1, s[12:15], s20 offen
s_mov_b32 s21, 3968
buffer_load_dword v25, v1, s[12:15], s21 offen
s_waitcnt vmcnt(58)
v_perm_b32 v65, v27, v26, s46
v_accvgpr_write_b32 a181, v65
v_perm_b32 v69, v27, v26, s47
v_accvgpr_write_b32 a189, v69
s_mov_b32 s20, 12032
buffer_load_dword v26, v1, s[12:15], s20 offen
s_mov_b32 s21, 13184
buffer_load_dword v27, v1, s[12:15], s21 offen
s_waitcnt vmcnt(58)
v_perm_b32 v66, v29, v28, s46
v_accvgpr_write_b32 a182, v66
v_perm_b32 v70, v29, v28, s47
v_accvgpr_write_b32 a190, v70
s_mov_b32 s20, 37376
buffer_load_dword v28, v1, s[12:15], s20 offen
s_mov_b32 s21, 38528
buffer_load_dword v29, v1, s[12:15], s21 offen
s_waitcnt vmcnt(58)
v_perm_b32 v67, v31, v30, s46
v_accvgpr_write_b32 a183, v67
v_perm_b32 v71, v31, v30, s47
v_accvgpr_write_b32 a191, v71
s_mov_b32 s20, 46592
buffer_load_dword v30, v1, s[12:15], s20 offen
s_mov_b32 s21, 47744
buffer_load_dword v31, v1, s[12:15], s21 offen
s_waitcnt vmcnt(58)
v_perm_b32 v64, v33, v32, s46
v_perm_b32 v68, v33, v32, s47
s_mov_b32 s20, 39680
buffer_load_dword v32, v1, s[12:15], s20 offen
s_mov_b32 s21, 40832
buffer_load_dword v33, v1, s[12:15], s21 offen
s_waitcnt vmcnt(58)
v_perm_b32 v65, v35, v34, s46
v_perm_b32 v69, v35, v34, s47
s_mov_b32 s20, 48896
buffer_load_dword v34, v1, s[12:15], s20 offen
s_mov_b32 s21, 50048
buffer_load_dword v35, v1, s[12:15], s21 offen
s_waitcnt vmcnt(58)
v_perm_b32 v66, v37, v36, s46
v_perm_b32 v70, v37, v36, s47
s_mov_b32 s20, 74240
buffer_load_dword v36, v1, s[12:15], s20 offen
s_mov_b32 s21, 75392
buffer_load_dword v37, v1, s[12:15], s21 offen
s_waitcnt vmcnt(58)
v_perm_b32 v67, v39, v38, s46
ds_write_b128 v3, v[64:67] offset:20480
s_waitcnt lgkmcnt(0)
v_perm_b32 v71, v39, v38, s47
ds_write_b128 v3, v[68:71] offset:22528
s_waitcnt lgkmcnt(0)
s_mov_b32 s20, 83456
buffer_load_dword v38, v1, s[12:15], s20 offen
s_mov_b32 s21, 84608
buffer_load_dword v39, v1, s[12:15], s21 offen
s_waitcnt vmcnt(58)
v_perm_b32 v64, v41, v40, s46
v_perm_b32 v68, v41, v40, s47
s_mov_b32 s20, 76544
buffer_load_dword v40, v1, s[12:15], s20 offen
s_mov_b32 s21, 77696
buffer_load_dword v41, v1, s[12:15], s21 offen
s_waitcnt vmcnt(58)
v_perm_b32 v65, v43, v42, s46
v_perm_b32 v69, v43, v42, s47
s_mov_b32 s20, 85760
buffer_load_dword v42, v1, s[12:15], s20 offen
s_mov_b32 s21, 86912
buffer_load_dword v43, v1, s[12:15], s21 offen
s_waitcnt vmcnt(58)
v_perm_b32 v66, v45, v44, s46
v_perm_b32 v70, v45, v44, s47
s_mov_b32 s20, 111104
buffer_load_dword v44, v1, s[12:15], s20 offen
s_mov_b32 s21, 112256
buffer_load_dword v45, v1, s[12:15], s21 offen
s_waitcnt vmcnt(58)
v_perm_b32 v67, v47, v46, s46
ds_write_b128 v3, v[64:67] offset:21504
s_waitcnt lgkmcnt(0)
v_perm_b32 v71, v47, v46, s47
ds_write_b128 v3, v[68:71] offset:23552
s_waitcnt lgkmcnt(0)
s_mov_b32 s20, 120320
buffer_load_dword v46, v1, s[12:15], s20 offen
s_mov_b32 s21, 121472
buffer_load_dword v47, v1, s[12:15], s21 offen
s_waitcnt vmcnt(58)
v_perm_b32 v64, v49, v48, s46
v_accvgpr_write_b32 a192, v64
v_perm_b32 v68, v49, v48, s47
v_accvgpr_write_b32 a200, v68
s_mov_b32 s20, 113408
buffer_load_dword v48, v1, s[12:15], s20 offen
s_mov_b32 s21, 114560
buffer_load_dword v49, v1, s[12:15], s21 offen
s_waitcnt vmcnt(58)
v_perm_b32 v65, v51, v50, s46
v_accvgpr_write_b32 a193, v65
v_perm_b32 v69, v51, v50, s47
v_accvgpr_write_b32 a201, v69
s_mov_b32 s20, 122624
buffer_load_dword v50, v1, s[12:15], s20 offen
s_mov_b32 s21, 123776
buffer_load_dword v51, v1, s[12:15], s21 offen
s_waitcnt vmcnt(58)
v_perm_b32 v66, v53, v52, s46
v_accvgpr_write_b32 a194, v66
v_perm_b32 v70, v53, v52, s47
v_accvgpr_write_b32 a202, v70
s_mov_b32 s20, 768
buffer_load_dword v52, v1, s[12:15], s20 offen
s_mov_b32 s21, 1920
buffer_load_dword v53, v1, s[12:15], s21 offen
s_waitcnt vmcnt(58)
v_perm_b32 v67, v55, v54, s46
v_accvgpr_write_b32 a195, v67
v_perm_b32 v71, v55, v54, s47
v_accvgpr_write_b32 a203, v71
s_mov_b32 s20, 9984
buffer_load_dword v54, v1, s[12:15], s20 offen
s_mov_b32 s21, 11136
buffer_load_dword v55, v1, s[12:15], s21 offen
s_waitcnt vmcnt(58)
v_perm_b32 v64, v57, v56, s46
v_accvgpr_write_b32 a196, v64
v_perm_b32 v68, v57, v56, s47
v_accvgpr_write_b32 a204, v68
s_mov_b32 s20, 3072
buffer_load_dword v56, v1, s[12:15], s20 offen
s_mov_b32 s21, 4224
buffer_load_dword v57, v1, s[12:15], s21 offen
s_waitcnt vmcnt(58)
v_perm_b32 v65, v59, v58, s46
v_accvgpr_write_b32 a197, v65
v_perm_b32 v69, v59, v58, s47
v_accvgpr_write_b32 a205, v69
s_mov_b32 s20, 12288
buffer_load_dword v58, v1, s[12:15], s20 offen
s_mov_b32 s21, 13440
buffer_load_dword v59, v1, s[12:15], s21 offen
s_waitcnt vmcnt(58)
v_perm_b32 v66, v61, v60, s46
v_accvgpr_write_b32 a198, v66
v_perm_b32 v70, v61, v60, s47
v_accvgpr_write_b32 a206, v70
s_mov_b32 s20, 37632
buffer_load_dword v60, v1, s[12:15], s20 offen
s_mov_b32 s21, 38784
buffer_load_dword v61, v1, s[12:15], s21 offen
s_waitcnt vmcnt(58)
v_perm_b32 v67, v63, v62, s46
v_accvgpr_write_b32 a199, v67
v_perm_b32 v71, v63, v62, s47
v_accvgpr_write_b32 a207, v71
s_mov_b32 s20, 46848
buffer_load_dword v62, v1, s[12:15], s20 offen
s_mov_b32 s21, 48000
buffer_load_dword v63, v1, s[12:15], s21 offen
s_waitcnt vmcnt(58)
v_perm_b32 v64, v5, v4, s46
v_perm_b32 v68, v5, v4, s47
s_mov_b32 s20, 39936
buffer_load_dword v4, v1, s[12:15], s20 offen
s_mov_b32 s21, 41088
buffer_load_dword v5, v1, s[12:15], s21 offen
s_waitcnt vmcnt(58)
v_perm_b32 v65, v7, v6, s46
v_perm_b32 v69, v7, v6, s47
s_mov_b32 s20, 49152
buffer_load_dword v6, v1, s[12:15], s20 offen
s_mov_b32 s21, 50304
buffer_load_dword v7, v1, s[12:15], s21 offen
s_waitcnt vmcnt(58)
v_perm_b32 v66, v9, v8, s46
v_perm_b32 v70, v9, v8, s47
s_mov_b32 s20, 74496
buffer_load_dword v8, v1, s[12:15], s20 offen
s_mov_b32 s21, 75648
buffer_load_dword v9, v1, s[12:15], s21 offen
s_waitcnt vmcnt(58)
v_perm_b32 v67, v11, v10, s46
ds_write_b128 v3, v[64:67] offset:24576
s_waitcnt lgkmcnt(0)
v_perm_b32 v71, v11, v10, s47
ds_write_b128 v3, v[68:71] offset:26624
s_waitcnt lgkmcnt(0)
s_mov_b32 s20, 83712
buffer_load_dword v10, v1, s[12:15], s20 offen
s_mov_b32 s21, 84864
buffer_load_dword v11, v1, s[12:15], s21 offen
s_waitcnt vmcnt(58)
v_perm_b32 v64, v13, v12, s46
v_perm_b32 v68, v13, v12, s47
s_mov_b32 s20, 76800
buffer_load_dword v12, v1, s[12:15], s20 offen
s_mov_b32 s21, 77952
buffer_load_dword v13, v1, s[12:15], s21 offen
s_waitcnt vmcnt(58)
v_perm_b32 v65, v15, v14, s46
v_perm_b32 v69, v15, v14, s47
s_mov_b32 s20, 86016
buffer_load_dword v14, v1, s[12:15], s20 offen
s_mov_b32 s21, 87168
buffer_load_dword v15, v1, s[12:15], s21 offen
s_waitcnt vmcnt(58)
v_perm_b32 v66, v17, v16, s46
v_perm_b32 v70, v17, v16, s47
s_mov_b32 s20, 111360
buffer_load_dword v16, v1, s[12:15], s20 offen
s_mov_b32 s21, 112512
buffer_load_dword v17, v1, s[12:15], s21 offen
s_waitcnt vmcnt(58)
v_perm_b32 v67, v19, v18, s46
ds_write_b128 v3, v[64:67] offset:25600
s_waitcnt lgkmcnt(0)
v_perm_b32 v71, v19, v18, s47
ds_write_b128 v3, v[68:71] offset:27648
s_waitcnt lgkmcnt(0)
s_mov_b32 s20, 120576
buffer_load_dword v18, v1, s[12:15], s20 offen
s_mov_b32 s21, 121728
buffer_load_dword v19, v1, s[12:15], s21 offen
s_waitcnt vmcnt(58)
v_perm_b32 v64, v21, v20, s46
v_accvgpr_write_b32 a208, v64
v_perm_b32 v68, v21, v20, s47
v_accvgpr_write_b32 a216, v68
s_mov_b32 s20, 113664
buffer_load_dword v20, v1, s[12:15], s20 offen
s_mov_b32 s21, 114816
buffer_load_dword v21, v1, s[12:15], s21 offen
s_waitcnt vmcnt(58)
v_perm_b32 v65, v23, v22, s46
v_accvgpr_write_b32 a209, v65
v_perm_b32 v69, v23, v22, s47
v_accvgpr_write_b32 a217, v69
s_mov_b32 s20, 122880
buffer_load_dword v22, v1, s[12:15], s20 offen
s_mov_b32 s21, 124032
buffer_load_dword v23, v1, s[12:15], s21 offen
s_waitcnt vmcnt(58)
v_perm_b32 v66, v25, v24, s46
v_accvgpr_write_b32 a210, v66
v_perm_b32 v70, v25, v24, s47
v_accvgpr_write_b32 a218, v70
s_mov_b32 s20, 1024
buffer_load_ushort v24, v2, s[12:15], s20 offen
s_mov_b32 s21, 2176
buffer_load_ushort v25, v2, s[12:15], s21 offen
s_waitcnt vmcnt(58)
v_perm_b32 v67, v27, v26, s46
v_accvgpr_write_b32 a211, v67
v_perm_b32 v71, v27, v26, s47
v_accvgpr_write_b32 a219, v71
s_mov_b32 s20, 10240
buffer_load_ushort v26, v2, s[12:15], s20 offen
s_mov_b32 s21, 11392
buffer_load_ushort v27, v2, s[12:15], s21 offen
s_waitcnt vmcnt(58)
v_perm_b32 v64, v29, v28, s46
v_accvgpr_write_b32 a212, v64
v_perm_b32 v68, v29, v28, s47
v_accvgpr_write_b32 a220, v68
s_mov_b32 s20, 3328
buffer_load_ushort v28, v2, s[12:15], s20 offen
s_mov_b32 s21, 4480
buffer_load_ushort v29, v2, s[12:15], s21 offen
s_waitcnt vmcnt(58)
v_perm_b32 v65, v31, v30, s46
v_accvgpr_write_b32 a213, v65
v_perm_b32 v69, v31, v30, s47
v_accvgpr_write_b32 a221, v69
s_mov_b32 s20, 12544
buffer_load_ushort v30, v2, s[12:15], s20 offen
s_mov_b32 s21, 13696
buffer_load_ushort v31, v2, s[12:15], s21 offen
s_waitcnt vmcnt(58)
v_perm_b32 v66, v33, v32, s46
v_accvgpr_write_b32 a214, v66
v_perm_b32 v70, v33, v32, s47
v_accvgpr_write_b32 a222, v70
s_mov_b32 s20, 37888
buffer_load_ushort v32, v2, s[12:15], s20 offen
s_mov_b32 s21, 39040
buffer_load_ushort v33, v2, s[12:15], s21 offen
s_waitcnt vmcnt(58)
v_perm_b32 v67, v35, v34, s46
v_accvgpr_write_b32 a215, v67
v_perm_b32 v71, v35, v34, s47
v_accvgpr_write_b32 a223, v71
s_mov_b32 s20, 47104
buffer_load_ushort v34, v2, s[12:15], s20 offen
s_mov_b32 s21, 48256
buffer_load_ushort v35, v2, s[12:15], s21 offen
s_waitcnt vmcnt(58)
v_perm_b32 v64, v37, v36, s46
v_perm_b32 v68, v37, v36, s47
s_mov_b32 s20, 40192
buffer_load_ushort v36, v2, s[12:15], s20 offen
s_mov_b32 s21, 41344
buffer_load_ushort v37, v2, s[12:15], s21 offen
s_waitcnt vmcnt(58)
v_perm_b32 v65, v39, v38, s46
v_perm_b32 v69, v39, v38, s47
s_mov_b32 s20, 49408
buffer_load_ushort v38, v2, s[12:15], s20 offen
s_mov_b32 s21, 50560
buffer_load_ushort v39, v2, s[12:15], s21 offen
s_waitcnt vmcnt(58)
v_perm_b32 v66, v41, v40, s46
v_perm_b32 v70, v41, v40, s47
s_mov_b32 s20, 74752
buffer_load_ushort v40, v2, s[12:15], s20 offen
s_mov_b32 s21, 75904
buffer_load_ushort v41, v2, s[12:15], s21 offen
s_waitcnt vmcnt(58)
v_perm_b32 v67, v43, v42, s46
ds_write_b128 v3, v[64:67] offset:28672
s_waitcnt lgkmcnt(0)
v_perm_b32 v71, v43, v42, s47
ds_write_b128 v3, v[68:71] offset:30720
s_waitcnt lgkmcnt(0)
s_mov_b32 s20, 83968
buffer_load_ushort v42, v2, s[12:15], s20 offen
s_mov_b32 s21, 85120
buffer_load_ushort v43, v2, s[12:15], s21 offen
s_waitcnt vmcnt(58)
v_perm_b32 v64, v45, v44, s46
v_perm_b32 v68, v45, v44, s47
s_mov_b32 s20, 77056
buffer_load_ushort v44, v2, s[12:15], s20 offen
s_mov_b32 s21, 78208
buffer_load_ushort v45, v2, s[12:15], s21 offen
s_waitcnt vmcnt(58)
v_perm_b32 v65, v47, v46, s46
v_perm_b32 v69, v47, v46, s47
s_mov_b32 s20, 86272
buffer_load_ushort v46, v2, s[12:15], s20 offen
s_mov_b32 s21, 87424
buffer_load_ushort v47, v2, s[12:15], s21 offen
s_waitcnt vmcnt(58)
v_perm_b32 v66, v49, v48, s46
v_perm_b32 v70, v49, v48, s47
s_mov_b32 s20, 111616
buffer_load_ushort v48, v2, s[12:15], s20 offen
s_mov_b32 s21, 112768
buffer_load_ushort v49, v2, s[12:15], s21 offen
s_waitcnt vmcnt(58)
v_perm_b32 v67, v51, v50, s46
ds_write_b128 v3, v[64:67] offset:29696
s_waitcnt lgkmcnt(0)
v_perm_b32 v71, v51, v50, s47
ds_write_b128 v3, v[68:71] offset:31744
s_waitcnt lgkmcnt(0)
s_mov_b32 s20, 120832
buffer_load_ushort v50, v2, s[12:15], s20 offen
s_mov_b32 s21, 121984
buffer_load_ushort v51, v2, s[12:15], s21 offen
s_waitcnt vmcnt(58)
v_perm_b32 v64, v53, v52, s46
v_accvgpr_write_b32 a224, v64
v_perm_b32 v68, v53, v52, s47
v_accvgpr_write_b32 a232, v68
s_mov_b32 s20, 113920
buffer_load_ushort v52, v2, s[12:15], s20 offen
s_mov_b32 s21, 115072
buffer_load_ushort v53, v2, s[12:15], s21 offen
s_waitcnt vmcnt(58)
v_perm_b32 v65, v55, v54, s46
v_accvgpr_write_b32 a225, v65
v_perm_b32 v69, v55, v54, s47
v_accvgpr_write_b32 a233, v69
s_mov_b32 s20, 123136
buffer_load_ushort v54, v2, s[12:15], s20 offen
s_mov_b32 s21, 124288
buffer_load_ushort v55, v2, s[12:15], s21 offen
s_waitcnt vmcnt(58)
v_perm_b32 v66, v57, v56, s46
v_accvgpr_write_b32 a226, v66
v_perm_b32 v70, v57, v56, s47
v_accvgpr_write_b32 a234, v70
s_waitcnt vmcnt(56)
v_perm_b32 v67, v59, v58, s46
v_accvgpr_write_b32 a227, v67
v_perm_b32 v71, v59, v58, s47
v_accvgpr_write_b32 a235, v71
s_waitcnt vmcnt(54)
v_perm_b32 v64, v61, v60, s46
v_accvgpr_write_b32 a228, v64
v_perm_b32 v68, v61, v60, s47
v_accvgpr_write_b32 a236, v68
s_waitcnt vmcnt(52)
v_perm_b32 v65, v63, v62, s46
v_accvgpr_write_b32 a229, v65
v_perm_b32 v69, v63, v62, s47
v_accvgpr_write_b32 a237, v69
s_waitcnt vmcnt(50)
v_perm_b32 v66, v5, v4, s46
v_accvgpr_write_b32 a230, v66
v_perm_b32 v70, v5, v4, s47
v_accvgpr_write_b32 a238, v70
s_waitcnt vmcnt(48)
v_perm_b32 v67, v7, v6, s46
v_accvgpr_write_b32 a231, v67
v_perm_b32 v71, v7, v6, s47
v_accvgpr_write_b32 a239, v71
s_waitcnt vmcnt(46)
v_perm_b32 v64, v9, v8, s46
v_perm_b32 v68, v9, v8, s47
v_accvgpr_write_b32 a240, v68
s_waitcnt vmcnt(44)
v_perm_b32 v65, v11, v10, s46
v_perm_b32 v69, v11, v10, s47
v_accvgpr_write_b32 a241, v69
s_waitcnt vmcnt(42)
v_perm_b32 v66, v13, v12, s46
v_perm_b32 v70, v13, v12, s47
v_accvgpr_write_b32 a242, v70
s_waitcnt vmcnt(40)
v_perm_b32 v67, v15, v14, s46
ds_write_b128 v3, v[64:67] offset:32768
s_waitcnt lgkmcnt(0)
v_perm_b32 v71, v15, v14, s47
v_accvgpr_write_b32 a243, v71
s_waitcnt vmcnt(38)
v_perm_b32 v64, v17, v16, s46
v_perm_b32 v68, v17, v16, s47
v_accvgpr_write_b32 a244, v68
s_waitcnt vmcnt(36)
v_perm_b32 v65, v19, v18, s46
v_perm_b32 v69, v19, v18, s47
v_accvgpr_write_b32 a245, v69
s_waitcnt vmcnt(34)
v_perm_b32 v66, v21, v20, s46
v_perm_b32 v70, v21, v20, s47
v_accvgpr_write_b32 a246, v70
s_waitcnt vmcnt(32)
v_perm_b32 v67, v23, v22, s46
ds_write_b128 v3, v[64:67] offset:33792
s_waitcnt lgkmcnt(0)
v_perm_b32 v71, v23, v22, s47
v_accvgpr_write_b32 a247, v71
s_waitcnt vmcnt(30)
v_perm_b32 v64, v25, v24, s46
v_accvgpr_write_b32 a248, v64
s_waitcnt vmcnt(28)
v_perm_b32 v65, v27, v26, s46
v_accvgpr_write_b32 a249, v65
s_waitcnt vmcnt(26)
v_perm_b32 v66, v29, v28, s46
v_accvgpr_write_b32 a250, v66
s_waitcnt vmcnt(24)
v_perm_b32 v67, v31, v30, s46
v_accvgpr_write_b32 a251, v67
s_waitcnt vmcnt(22)
v_perm_b32 v64, v33, v32, s46
v_accvgpr_write_b32 a252, v64
s_waitcnt vmcnt(20)
v_perm_b32 v65, v35, v34, s46
v_accvgpr_write_b32 a253, v65
s_waitcnt vmcnt(18)
v_perm_b32 v66, v37, v36, s46
v_accvgpr_write_b32 a254, v66
s_waitcnt vmcnt(16)
v_perm_b32 v67, v39, v38, s46
v_accvgpr_write_b32 a255, v67
s_waitcnt vmcnt(14)
v_perm_b32 v64, v41, v40, s46
s_waitcnt vmcnt(12)
v_perm_b32 v65, v43, v42, s46
s_waitcnt vmcnt(10)
v_perm_b32 v66, v45, v44, s46
s_waitcnt vmcnt(8)
v_perm_b32 v67, v47, v46, s46
ds_write_b128 v3, v[64:67] offset:18432
s_waitcnt lgkmcnt(0)
s_waitcnt vmcnt(6)
v_perm_b32 v64, v49, v48, s46
s_waitcnt vmcnt(4)
v_perm_b32 v65, v51, v50, s46
s_waitcnt vmcnt(2)
v_perm_b32 v66, v53, v52, s46
s_waitcnt vmcnt(0)
v_perm_b32 v67, v55, v54, s46
ds_write_b128 v3, v[64:67] offset:19456
s_waitcnt lgkmcnt(0)
v_mov_b32 v20, 64
s_mov_b32 s28, 0
L_poll_38:
buffer_load_dword v21, v20, s[56:59], 0 offen sc1
s_add_u32 s28, s28, 1
s_cmp_gt_u32 s28, 40000
s_cbranch_scc1 L_end
s_waitcnt vmcnt(0)
v_cmp_ne_u32 vcc, 32, v21
s_cbranch_vccz L_pd_39
s_sleep 1
s_branch L_poll_38
L_pd_39:
v_mov_b32 v20, 128
s_mov_b32 s28, 0
L_poll_40:
buffer_load_dword v21, v20, s[56:59], 0 offen sc1
s_add_u32 s28, s28, 1
s_cmp_gt_u32 s28, 40000
s_cbranch_scc1 L_end
s_waitcnt vmcnt(0)
v_cmp_ne_u32 vcc, 8, v21
s_cbranch_vccz L_pd_41
s_sleep 1
s_branch L_poll_40
L_pd_41:
v_mov_b32 v20, 0
s_lshl_b32 s25, s16, 7
s_add_u32 s25, s25, 111149056
s_mov_b32 s28, 0
L_poll_42:
buffer_load_dword v21, v20, s[8:11], s25 offen sc1
s_add_u32 s28, s28, 1
s_cmp_gt_u32 s28, 40000
s_cbranch_scc1 L_end
s_waitcnt vmcnt(0)
v_cmp_ne_u32 vcc, 1, v21
s_cbranch_vccz L_pd_43
s_sleep 1
s_branch L_poll_42
L_pd_43:
v_mov_b32 v12, v0
v_and_b32 v13, 15, v0
v_bfe_u32 v14, v0, 4, 2
v_lshlrev_b32 v1, 4, v12
v_and_b32 v2, 0x3f0, v1
s_mul_i32 s20, s17, 34816
s_add_u32 s20, s20, 24576
v_add_u32 v2, s20, v2
v_and_b32 v15, 1, v12
v_mul_u32_u24 v0, 0xaaaa, v15
v_add_u32 v0, 0xffff4444, v0
v_lshrrev_b32 v18, 2, v13
v_lshl_add_u32 v18, v18, 1, v15
v_bfe_u32 v19, v13, 1, 1
v_lshrrev_b32 v16, 5, v12
v_lshlrev_b32 v16, 8, v16
v_lshl_add_u32 v16, v18, 5, v16
v_and_b32 v17, 1, v14
v_lshl_add_u32 v16, v17, 4, v16
v_and_b32 v17, 0x7f, v16
v_xor_b32 v17, 16, v17
v_add_u32 v16, 4224, v16
v_add_u32 v17, 6272, v17
v_cmp_eq_u32 vcc, 1, v19
s_nop 1
v_cndmask_b32 v7, v17, v16, vcc
v_and_b32 v16, 1, v14
v_xor_b32 v16, v18, v16
v_and_b32 v17, 2, v14
v_lshlrev_b32 v17, 1, v17
v_xor_b32 v16, v16, v17
v_lshlrev_b32 v16, 4, v16
v_lshl_add_u32 v16, v14, 7, v16
v_mul_u32_u24 v17, 2176, v19
v_add_u32 v16, v16, v17
v_add_u32 v5, 0, v16
v_bfe_u32 v20, v13, 3, 1
v_bfe_u32 v21, v13, 1, 1
v_lshlrev_b32 v16, 1, v14
v_xor_b32 v16, v16, v21
v_lshlrev_b32 v17, 2, v20
v_xor_b32 v16, v16, v17
v_lshlrev_b32 v16, 4, v16
v_lshl_add_u32 v16, v20, 8, v16
v_lshl_add_u32 v16, v21, 7, v16
v_bfe_u32 v17, v13, 2, 1
v_lshl_add_u32 v16, v17, 3, v16
v_lshl_add_u32 v16, v15, 2, v16
s_lshl_b32 s20, s17, 9
s_add_u32 s20, s20, 0
v_add_u32 v4, s20, v16
v_xor_b32 v3, 16, v4
v_lshrrev_b32 v16, 4, v12
v_xor_b32 v17, s16, v16
v_lshlrev_b32 v16, 12, v16
v_lshl_add_u32 v16, v17, 7, v16
v_lshl_add_u32 v9, v13, 3, v16
s_lshr_b32 s20, s17, 1
s_lshl_b32 s20, s20, 2
v_add_u32 v16, s20, v14
v_xor_b32 v17, s16, v16
v_lshlrev_b32 v16, 12, v16
v_lshl_add_u32 v16, v17, 7, v16
v_lshl_add_u32 v16, v13, 2, v16
s_and_b32 s20, s17, 1
s_lshl_b32 s20, s20, 6
s_add_u32 s20, s20, 262144
v_add_u32 v10, s20, v16
v_bfe_u32 v16, v13, 2, 1
v_lshlrev_b32 v16, 5, v16
v_and_b32 v17, 1, v14
v_lshl_add_u32 v16, v17, 8, v16
v_lshrrev_b32 v17, 1, v14
v_lshl_add_u32 v16, v17, 4, v16
v_and_b32 v17, 3, v13
v_lshl_add_u32 v11, v17, 2, v16
v_lshlrev_b32 v6, 6, v12
v_lshlrev_b32 v8, 2, v12
s_mov_b32 s36, 0x11111111
s_mov_b32 s37, 0x11111111
s_mov_b32 s38, 0x22222222
s_mov_b32 s39, 0x22222222
s_mov_b32 s40, 0x44444444
s_mov_b32 s41, 0x44444444
s_mov_b32 s42, 0x88888888
s_mov_b32 s43, 0x88888888
s_mov_b32 s44, 0xf0f0f0f0
s_mov_b32 s45, 0xf0f0f0f0
s_mov_b32 s18, 0x3e0293ee
s_lshl_b32 s20, s17, 5
s_add_u32 s20, s20, s16
s_cmp_lt_u32 s20, 72
s_cselect_b32 s48, 1, 0
s_lshl_b32 s23, s20, 12
s_lshl_b32 s21, s17, 10
s_sub_u32 s23, s23, s21
s_lshr_b32 s24, s20, 2
s_lshl_b32 s24, s24, 9
s_and_b32 s21, s20, 3
s_lshl_b32 s21, s21, 6
s_add_u32 s24, s24, s21
s_add_u32 s24, s24, 110100480
s_cmp_lt_u32 s20, 72
s_cselect_b32 s24, s24, 536870912
s_lshl_b32 s25, s16, 12
s_add_u32 s26, s25, 131072
s_add_u32 s27, s25, 262144
s_cmp_lt_u32 s16, 8
s_cselect_b32 s27, s27, 536870912
s_mov_b32 s28, 109051904
s_mov_b32 s29, 109346816
s_lshl_b32 s30, s16, 20
s_add_u32 s30, s30, 33554432
s_lshl_b32 s31, s16, 12
s_add_u32 s31, s31, 100663296
s_add_u32 s35, s24, 32768
s_mov_b32 s53, 0x3f803f80
s_mov_b32 s86, 0x33333333
s_mov_b32 s87, 0x33333333
s_lshl_b32 s82, s16, 7
s_add_u32 s83, s82, 111152384
s_add_u32 s82, s82, 111148288
s_mov_b32 s19, 0
s_load_dwordx2 s[50:51], s[0:1], 56
s_waitcnt lgkmcnt(0)
s_mov_b32 s12, s50
s_and_b32 s13, s51, 0xffff
s_mov_b32 s14, 9216
s_mov_b32 s15, 0x20000
v_bfe_u32 v64, v1, 5, 3
v_mul_u32_u24 v64, 1152, v64
v_lshrrev_b32 v65, 8, v1
v_lshl_add_u32 v64, v65, 5, v64
v_and_b32 v65, 16, v1
v_add_u32 v64, v64, v65
buffer_load_dwordx4 v[24:27], v64, s[12:15], 0 offen offset:0
buffer_load_dwordx4 v[28:31], v64, s[12:15], 0 offen offset:512
buffer_load_dwordx4 v[32:35], v64, s[12:15], 0 offen offset:1024
s_waitcnt vmcnt(0)
v_perm_b32 v12, v26, v24, s46
v_perm_b32 v13, v26, v24, s47
v_perm_b32 v14, v27, v25, s46
v_perm_b32 v15, v27, v25, s47
v_min_u32 v12, 0xfffeffff, v12
v_min_u32 v13, 0xfffeffff, v13
v_min_u32 v14, 0xfffeffff, v14
v_min_u32 v15, 0xfffeffff, v15
v_perm_b32 v16, v30, v28, s46
v_perm_b32 v17, v30, v28, s47
v_perm_b32 v18, v31, v29, s46
v_perm_b32 v19, v31, v29, s47
v_min_u32 v16, 0xfffeffff, v16
v_min_u32 v17, 0xfffeffff, v17
v_min_u32 v18, 0xfffeffff, v18
v_min_u32 v19, 0xfffeffff, v19
v_perm_b32 v20, v34, v32, s46
v_perm_b32 v21, v34, v32, s47
v_perm_b32 v22, v35, v33, s46
v_perm_b32 v23, v35, v33, s47
v_min_u32 v20, 0xfffeffff, v20
v_min_u32 v21, 0xfffeffff, v21
v_min_u32 v22, 0xfffeffff, v22
v_min_u32 v23, 0xfffeffff, v23
s_cmp_lg_u32 s17, 0
s_cbranch_scc1 L_m0_44
ds_write_b128 v1, v[20:23] offset:14848
v_mov_b32 v64, 6528
v_mov_b32 v56, 0
v_mov_b32 v57, 0
v_mov_b32 v58, 0
v_mov_b32 v59, 0
ds_write_b128 v64, v[56:59]
L_m0_44:
s_waitcnt lgkmcnt(0)
s_barrier
ds_read_b32 v20, v8 offset:14848
s_waitcnt lgkmcnt(0)
s_mov_b32 s33, 110100480
s_mov_b32 s6, 110100480
s_mov_b32 s7, 110100480
s_mov_b32 s22, 0
s_cmp_eq_u32 s17, 0
s_cbranch_scc1 L_ent0
s_cmp_eq_u32 s17, 1
s_cbranch_scc1 L_ent1
s_cmp_eq_u32 s17, 2
s_cbranch_scc1 L_ent2
s_cmp_eq_u32 s17, 3
s_cbranch_scc1 L_ent3
s_branch L_end
L_ent0:
v_lshlrev_b32 v6, 3, v1
v_mov_b64 v[24:25], 0
v_mov_b64 v[26:27], 0
v_mov_b64 v[28:29], 0
v_mov_b64 v[30:31], 0
v_and_b32 v69, 0x380, v1
v_add_u32 v69, v69, v1
v_and_b32 v70, 0xf00, v1
v_add_u32 v70, v70, v1
v_mov_b64 v[64:65], -1
v_mov_b64 v[66:67], -1
v_xor_b32 v3, 16, v4
ds_read_b128 v[48:51], v2 offset:8192
ds_read_b128 v[52:55], v2 offset:9216
ds_read_b128 v[40:43], v2 offset:0
ds_read_b128 v[44:47], v2 offset:1024
v_mov_b64 v[32:33], 0
v_mov_b64 v[34:35], 0
v_mov_b64 v[36:37], 0
v_mov_b64 v[38:39], 0
v_mov_b64 v[56:57], 0
v_mov_b64 v[58:59], 0
v_mov_b64 v[60:61], 0
v_mov_b64 v[62:63], 0
s_add_u32 s20, s30, 0
s_add_u32 s21, s30, 8192
s_add_u32 s49, s29, s25
s_add_u32 s50, s29, s26
s_add_u32 s51, s29, s27
s_add_u32 s52, s30, 16384
s_mov_b32 m0, 15872
s_waitcnt vmcnt(0) lgkmcnt(0)
s_branch L_step0
L_gr0:
buffer_load_dwordx4 v[12:15], v1, s[8:11], s33 offen sc1
buffer_load_dword v20, v8, s[8:11], s7 offen sc1
buffer_load_dwordx4 v[16:19], v1, s[8:11], s6 offen sc1
s_add_u32 s22, s22, 1
s_cmp_gt_u32 s22, 40000
s_cbranch_scc1 L_end
s_nop 0
v_mov_b64 v[24:25], 0
v_mov_b64 v[26:27], 0
v_mov_b64 v[28:29], 0
v_mov_b64 v[30:31], 0
v_mov_b64 v[32:33], 0
v_mov_b64 v[34:35], 0
v_mov_b64 v[36:37], 0
v_mov_b64 v[38:39], 0
v_mov_b64 v[56:57], 0
v_mov_b64 v[58:59], 0
v_mov_b64 v[60:61], 0
v_mov_b64 v[62:63], 0
s_waitcnt lgkmcnt(0)
s_branch L_step0
.p2align 3
L_gat0:
buffer_load_dwordx4 v[12:15], v1, s[8:11], s33 offen sc1
buffer_load_dword v20, v8, s[8:11], s7 offen sc1
buffer_load_dwordx4 v[16:19], v1, s[8:11], s6 offen sc1
s_add_u32 s20, s30, 0
s_add_u32 s21, s30, 8192
s_add_u32 s49, s29, s25
s_add_u32 s50, s29, s26
s_add_u32 s51, s29, s27
s_add_u32 s52, s30, 16384
s_mov_b32 m0, 15872
s_waitcnt lgkmcnt(0)
L_step0:
s_waitcnt vmcnt(2)
v_smfmac_f32_16x16x64_bf16 v[24:27], v[12:15], v[72:79], v0
ds_write_b128 v1, v[12:15] offset:6656
v_smfmac_f32_16x16x64_bf16 v[28:31], v[12:15], v[80:87], v0
s_waitcnt vmcnt(1)
ds_write_b32 v8, v20 offset:14848
v_smfmac_f32_16x16x64_bf16 v[32:35], v[12:15], v[88:95], v0
s_waitcnt vmcnt(0)
ds_write_b128 v1, v[16:19] offset:10752
v_smfmac_f32_16x16x64_bf16 v[56:59], v[12:15], a[32:39], v0
v_max3_u32 v21, v12, v13, v14
v_max3_u32 v21, v21, v15, v20
v_smfmac_f32_16x16x64_bf16 v[60:63], v[12:15], a[40:47], v0
v_max3_u32 v21, v21, v16, v17
v_max3_u32 v21, v21, v18, v19
v_smfmac_f32_16x16x64_bf16 v[36:39], v[12:15], v[40:47], v0
v_cmp_le_u32 vcc, 0xffff0000, v21
v_smfmac_f32_16x16x64_bf16 v[24:27], v[16:19], v[168:175], v0
s_cbranch_vccnz L_gr0
v_smfmac_f32_16x16x64_bf16 v[28:31], v[16:19], v[176:183], v0
s_waitcnt lgkmcnt(0)
s_barrier
ds_read_b128 v[20:23], v1 offset:7680
v_smfmac_f32_16x16x64_bf16 v[32:35], v[16:19], v[184:191], v0
ds_read_b128 v[12:15], v1 offset:8704
buffer_load_dwordx4 v69, s[8:11], s20 offen sc1 lds
v_smfmac_f32_16x16x64_bf16 v[56:59], v[16:19], a[96:103], v0
ds_read_b128 v[40:43], v2 offset:2048
s_mov_b32 m0, 16768
v_smfmac_f32_16x16x64_bf16 v[60:63], v[16:19], a[104:111], v0
ds_read_b128 v[44:47], v2 offset:3072
v_smfmac_f32_16x16x64_bf16 v[36:39], v[16:19], v[48:55], v0
ds_read_b128 v[16:19], v1 offset:9728
s_waitcnt lgkmcnt(4)
v_smfmac_f32_16x16x64_bf16 v[24:27], v[20:23], v[96:103], v0
ds_read_b128 v[48:51], v2 offset:4096
buffer_load_dwordx4 v69, s[8:11], s20 offen offset:128 sc1 lds
v_smfmac_f32_16x16x64_bf16 v[28:31], v[20:23], v[104:111], v0
ds_read_b128 v[52:55], v2 offset:5120
s_mov_b32 m0, 6272
v_smfmac_f32_16x16x64_bf16 v[32:35], v[20:23], v[112:119], v0
buffer_store_dword v0, v11, s[8:11], s35 offen
s_waitcnt lgkmcnt(3)
v_smfmac_f32_16x16x64_bf16 v[36:39], v[20:23], v[40:47], v0
ds_read_b128 v[20:23], v1 offset:11776
v_smfmac_f32_16x16x64_bf16 v[24:27], v[12:15], v[120:127], v0
ds_read_b128 v[40:43], v2 offset:6144
buffer_store_dwordx4 v[64:67], v1, s[8:11], s49 offen
v_smfmac_f32_16x16x64_bf16 v[28:31], v[12:15], v[128:135], v0
ds_read_b128 v[44:47], v2 offset:7168
v_smfmac_f32_16x16x64_bf16 v[32:35], v[12:15], v[136:143], v0
s_waitcnt lgkmcnt(3)
v_smfmac_f32_16x16x64_bf16 v[36:39], v[12:15], v[48:55], v0
ds_read_b128 v[12:15], v1 offset:12800
v_smfmac_f32_16x16x64_bf16 v[24:27], v[16:19], v[144:151], v0
ds_read_b128 v[48:51], v2 offset:10240
buffer_store_dwordx4 v[64:67], v1, s[8:11], s50 offen
v_smfmac_f32_16x16x64_bf16 v[28:31], v[16:19], v[152:159], v0
ds_read_b128 v[52:55], v2 offset:11264
v_smfmac_f32_16x16x64_bf16 v[32:35], v[16:19], v[160:167], v0
s_waitcnt lgkmcnt(3)
v_smfmac_f32_16x16x64_bf16 v[36:39], v[16:19], v[40:47], v0
ds_read_b128 v[16:19], v1 offset:13824
v_smfmac_f32_16x16x64_bf16 v[24:27], v[20:23], v[192:199], v0
ds_read_b128 v[40:43], v2 offset:12288
buffer_store_dwordx4 v[64:67], v1, s[8:11], s51 offen
v_smfmac_f32_16x16x64_bf16 v[28:31], v[20:23], v[200:207], v0
ds_read_b128 v[44:47], v2 offset:13312
v_smfmac_f32_16x16x64_bf16 v[32:35], v[20:23], v[208:215], v0
s_waitcnt lgkmcnt(3)
v_smfmac_f32_16x16x64_bf16 v[36:39], v[20:23], v[48:55], v0
ds_read_b128 v[20:23], v1 offset:14848
v_smfmac_f32_16x16x64_bf16 v[24:27], v[12:15], v[216:223], v0
ds_read_b128 v[48:51], v2 offset:14336
buffer_load_dwordx4 v[64:67], v70, s[8:11], s21 offen sc1
v_smfmac_f32_16x16x64_bf16 v[28:31], v[12:15], v[224:231], v0
ds_read_b128 v[52:55], v2 offset:15360
v_smfmac_f32_16x16x64_bf16 v[32:35], v[12:15], v[232:239], v0
s_waitcnt lgkmcnt(3)
v_smfmac_f32_16x16x64_bf16 v[36:39], v[12:15], v[40:47], v0
ds_read_b128 v[12:15], v1 offset:7680
v_smfmac_f32_16x16x64_bf16 v[24:27], v[16:19], v[240:247], v0
ds_read_b128 v[40:43], v2 offset:16384
buffer_load_dwordx4 v[68:71], v70, s[8:11], s21 offen offset:256 sc1
v_smfmac_f32_16x16x64_bf16 v[28:31], v[16:19], v[248:255], v0
ds_read_b128 v[44:47], v2 offset:17408
v_smfmac_f32_16x16x64_bf16 v[32:35], v[16:19], a[0:7], v0
s_waitcnt lgkmcnt(3)
v_smfmac_f32_16x16x64_bf16 v[36:39], v[16:19], v[48:55], v0
ds_read_b128 v[16:19], v1 offset:8704
v_smfmac_f32_16x16x64_bf16 v[24:27], v[20:23], a[8:15], v0
v_smfmac_f32_16x16x64_bf16 v[28:31], v[20:23], a[16:23], v0
buffer_load_dword v6, s[8:11], s52 offen sc1 lds
v_smfmac_f32_16x16x64_bf16 v[32:35], v[20:23], a[24:31], v0
s_waitcnt lgkmcnt(1)
v_smfmac_f32_16x16x64_bf16 v[36:39], v[20:23], v[40:47], v0
ds_read_b128 v[20:23], v1 offset:9728
v_smfmac_f32_16x16x64_bf16 v[56:59], v[12:15], a[48:55], v0
s_nop 0
v_add_f32 v24, v24, v25
v_add_f32 v26, v26, v27
v_add_f32 v28, v28, v29
v_add_f32 v30, v30, v31
v_cvt_pk_bf16_f32 v24, v24, v28
v_cvt_pk_bf16_f32 v26, v26, v30
ds_write_b32 v4, v24 offset:2176
v_add_f32 v32, v32, v33
v_add_f32 v34, v34, v35
v_add_f32 v36, v36, v37
v_add_f32 v38, v38, v39
ds_write_b32 v3, v26 offset:2176
v_cvt_pk_bf16_f32 v32, v32, v36
v_cvt_pk_bf16_f32 v34, v34, v38
ds_write_b32 v4, v32
v_smfmac_f32_16x16x64_bf16 v[60:63], v[12:15], a[56:63], v0
ds_write_b32 v3, v34
s_waitcnt lgkmcnt(5)
v_smfmac_f32_16x16x64_bf16 v[56:59], v[16:19], a[64:71], v0
ds_read_b128 v[12:15], v1 offset:11776
v_smfmac_f32_16x16x64_bf16 v[60:63], v[16:19], a[72:79], v0
ds_read_b128 v[16:19], v1 offset:12800
s_waitcnt lgkmcnt(6)
v_smfmac_f32_16x16x64_bf16 v[56:59], v[20:23], a[80:87], v0
s_waitcnt lgkmcnt(2) vmcnt(7)
s_barrier
ds_read_b128 v[24:27], v5 offset:0
v_smfmac_f32_16x16x64_bf16 v[60:63], v[20:23], a[88:95], v0
ds_read_b128 v[20:23], v1 offset:13824
s_waitcnt lgkmcnt(3)
v_smfmac_f32_16x16x64_bf16 v[56:59], v[12:15], a[112:119], v0
ds_read_b128 v[40:43], v1 offset:15872
v_smfmac_f32_16x16x64_bf16 v[60:63], v[12:15], a[120:127], v0
ds_read_b128 v[12:15], v1 offset:14848
s_waitcnt lgkmcnt(4)
v_smfmac_f32_16x16x64_bf16 v[56:59], v[16:19], a[128:135], v0
ds_read_b128 v[28:31], v5 offset:512
v_smfmac_f32_16x16x64_bf16 v[60:63], v[16:19], a[136:143], v0
ds_read_b128 v[44:47], v1 offset:17920
s_waitcnt lgkmcnt(4)
v_smfmac_f32_16x16x64_bf16 v[56:59], v[20:23], a[144:151], v0
ds_read_b128 v[32:35], v5 offset:1024
s_mov_b64 exec, s[86:87]
buffer_store_dwordx4 v[24:27], v5, s[8:11], s31 offen offset:0 sc1
s_mov_b64 exec, -1
v_smfmac_f32_16x16x64_bf16 v[60:63], v[20:23], a[152:159], v0
ds_read_b128 v[48:51], v1 offset:19968
s_waitcnt lgkmcnt(4)
v_smfmac_f32_16x16x64_bf16 v[56:59], v[12:15], a[160:167], v0
ds_read_b128 v[36:39], v5 offset:1536
v_smfmac_f32_16x16x64_bf16 v[60:63], v[12:15], a[168:175], v0
ds_read_b128 v[52:55], v1 offset:22016
v_mfma_f32_16x16x32_bf16 v[16:19], v[40:43], v[24:27], 0
ds_read_b128 v[40:43], v1 offset:16896
s_waitcnt lgkmcnt(5)
v_mfma_f32_16x16x32_bf16 v[16:19], v[44:47], v[28:31], v[16:19]
ds_read_b128 v[44:47], v1 offset:18944
s_waitcnt lgkmcnt(4)
v_mfma_f32_16x16x32_bf16 v[16:19], v[48:51], v[32:35], v[16:19]
ds_read_b128 v[48:51], v1 offset:20992
s_waitcnt lgkmcnt(3)
v_mfma_f32_16x16x32_bf16 v[16:19], v[52:55], v[36:39], v[16:19]
ds_read_b128 v[52:55], v1 offset:23040
v_mfma_f32_16x16x32_bf16 v[20:23], v[24:27], v[24:27], 0
v_add_f32 v56, v56, v57
v_add_f32 v58, v58, v59
v_mfma_f32_16x16x32_bf16 v[20:23], v[28:31], v[28:31], v[20:23]
v_add_f32 v60, v60, v61
v_add_f32 v62, v62, v63
v_mfma_f32_16x16x32_bf16 v[20:23], v[32:35], v[32:35], v[20:23]
v_cvt_pk_bf16_f32 v56, v56, v58
v_cvt_pk_bf16_f32 v57, v60, v62
v_mfma_f32_16x16x32_bf16 v[20:23], v[36:39], v[36:39], v[20:23]
v_lshrrev_b32 v58, 1, v1
v_max3_f32 v59, v16, v17, v18
s_waitcnt lgkmcnt(3)
v_mfma_f32_16x16x32_bf16 v[12:15], v[40:43], v[24:27], 0
ds_read_b128 v[40:43], v2 offset:18432
buffer_store_dwordx2 v[56:57], v58, s[8:11], s31 offen offset:2048 sc1
s_waitcnt lgkmcnt(3)
v_mfma_f32_16x16x32_bf16 v[12:15], v[44:47], v[28:31], v[12:15]
ds_read_b128 v[44:47], v2 offset:19456
s_waitcnt lgkmcnt(3)
v_mfma_f32_16x16x32_bf16 v[12:15], v[48:51], v[32:35], v[12:15]
ds_read_b128 v[48:51], v2 offset:20480
v_max3_f32 v59, v59, v19, v20
v_max_f32 v59, v59, v21
s_waitcnt lgkmcnt(3)
v_mfma_f32_16x16x32_bf16 v[12:15], v[52:55], v[36:39], v[12:15]
ds_read_b128 v[52:55], v2 offset:21504
v_mov_b32 v60, s53
s_add_u32 s49, s28, s23
v_mov_b32 v61, s53
s_add_u32 s50, s28, 65536
v_mov_b32 v62, s53
ds_read_b128 v[32:35], v2 offset:22528
v_mov_b32 v63, s53
v_max3_f32 v59, v59, v12, v13
v_max3_f32 v22, v59, v14, v15
v_max3_f32 v59, v59, v14, v15
s_add_u32 s51, s28, 131072
s_add_u32 s52, s28, 196608
v_permlane32_swap_b32 v22, v59
v_max_f32 v23, v59, v22
v_max_f32 v59, v59, v22
v_mov_b32 v22, 0
ds_read_b128 v[36:39], v2 offset:23552
v_permlane16_swap_b32 v23, v59
v_max_f32 v59, v59, v23
v_mul_f32 v58, s18, v59
v_pk_fma_f32 v[20:21], v[20:21], s[18:19], v[58:59] op_sel_hi:[1,0,0] neg_lo:[0,0,1] neg_hi:[0,0,1]
v_pk_fma_f32 v[16:17], v[16:17], s[18:19], v[58:59] op_sel_hi:[1,0,0] neg_lo:[0,0,1] neg_hi:[0,0,1]
v_pk_fma_f32 v[18:19], v[18:19], s[18:19], v[58:59] op_sel_hi:[1,0,0] neg_lo:[0,0,1] neg_hi:[0,0,1]
v_pk_fma_f32 v[12:13], v[12:13], s[18:19], v[58:59] op_sel_hi:[1,0,0] neg_lo:[0,0,1] neg_hi:[0,0,1]
v_pk_fma_f32 v[14:15], v[14:15], s[18:19], v[58:59] op_sel_hi:[1,0,0] neg_lo:[0,0,1] neg_hi:[0,0,1]
v_exp_f32 v20, v20
v_exp_f32 v21, v21
v_exp_f32 v16, v16
v_cvt_pk_bf16_f32 v23, v20, v21
v_cvt_pk_bf16_f32 v20, v20, v21
v_mov_b32 v21, 0
v_exp_f32 v17, v17
v_exp_f32 v18, v18
v_mfma_f32_16x16x16_bf16 v[24:27], v[56:57], v[20:21], 0
v_exp_f32 v19, v19
v_mfma_f32_16x16x16_bf16 v[28:31], v[56:57], v[22:23], 0
v_exp_f32 v12, v12
v_exp_f32 v13, v13
v_cvt_pk_bf16_f32 v16, v16, v17
v_cvt_pk_bf16_f32 v17, v18, v19
v_exp_f32 v14, v14
v_exp_f32 v15, v15
v_cvt_pk_bf16_f32 v18, v12, v13
v_cvt_pk_bf16_f32 v19, v14, v15
v_mfma_f32_16x16x16_bf16 v[12:15], v[60:61], v[20:21], 0
s_waitcnt vmcnt(3)
v_mfma_f32_16x16x32_bf16 v[12:15], v[60:63], v[16:19], v[12:15]
v_mov_b32 v20, 0
v_mov_b32 v23, 0
v_mfma_f32_16x16x32_bf16 v[24:27], v[64:67], v[16:19], v[24:27]
s_nop 1
v_mfma_f32_16x16x32_bf16 v[28:31], v[68:71], v[16:19], v[28:31]
v_mov_b32 v16, 0
v_mov_b32 v17, 0
v_rcp_f32 v12, v12
v_mov_b32 v18, 0
v_mov_b32 v19, 0
v_pk_mul_f32 v[24:25], v[24:25], v[12:13] op_sel_hi:[1,0]
v_pk_mul_f32 v[26:27], v[26:27], v[12:13] op_sel_hi:[1,0]
v_mov_b32 v15, 0
v_pk_mul_f32 v[28:29], v[28:29], v[12:13] op_sel_hi:[1,0]
v_pk_mul_f32 v[30:31], v[30:31], v[12:13] op_sel_hi:[1,0]
v_cvt_pk_bf16_f32 v24, v24, v28
v_cvt_pk_bf16_f32 v25, v25, v29
v_cvt_pk_bf16_f32 v26, v26, v30
v_cvt_pk_bf16_f32 v27, v27, v31
v_mfma_f32_16x16x32_bf16 v[56:59], v[20:23], v[20:23], 0
ds_write_b128 v7, v[24:27]
v_mfma_f32_16x16x32_bf16 v[60:63], v[20:23], v[20:23], 0
v_mov_b32 v12, 0
v_mov_b32 v13, 0
v_mov_b32 v14, 0
v_mov_b32 v3, 6528
s_nop 1
v_mfma_f32_16x16x32_bf16 v[64:67], v[20:23], v[20:23], 0
s_cmp_eq_u32 s19, 63
s_cbranch_scc1 L_texit
s_waitcnt lgkmcnt(0)
s_barrier
ds_read_b128 v[24:27], v1 offset:4224
v_mfma_f32_16x16x32_bf16 v[68:71], v[20:23], v[20:23], 0
ds_read_b128 v[28:31], v1 offset:5248
s_nop 2
v_mfma_f32_16x16x32_bf16 v[68:71], v[20:23], v[20:23], 0
s_waitcnt lgkmcnt(1)
v_smfmac_f32_16x16x64_bf16 v[12:15], v[24:27], a[248:255], v0
v_smfmac_f32_16x16x64_bf16 v[16:19], v[24:27], a[176:183], v0
s_waitcnt lgkmcnt(0)
v_smfmac_f32_16x16x64_bf16 v[12:15], v[28:31], v[40:47], v0
ds_read_b128 v[40:43], v2 offset:24576
v_smfmac_f32_16x16x64_bf16 v[16:19], v[28:31], v[48:55], v0
ds_read_b128 v[44:47], v2 offset:25600
v_smfmac_f32_16x16x64_bf16 v[20:23], v[24:27], a[184:191], v0
ds_read_b128 v[48:51], v2 offset:26624
v_smfmac_f32_16x16x64_bf16 v[20:23], v[28:31], v[32:39], v0
ds_read_b128 v[52:55], v2 offset:27648
s_nop 0
v_add_f32 v12, v12, v13
v_add_f32 v14, v14, v15
v_smfmac_f32_16x16x64_bf16 v[56:59], v[24:27], a[192:199], v0
ds_read_b128 v[32:35], v2 offset:28672
s_waitcnt lgkmcnt(3)
v_cvt_pk_bf16_f32 v12, v12, v14
buffer_store_dword v12, v10, s[8:11], s28 offen
v_smfmac_f32_16x16x64_bf16 v[56:59], v[28:31], v[40:47], v0
ds_read_b128 v[36:39], v2 offset:29696
v_add_f32 v16, v16, v17
v_add_f32 v18, v18, v19
v_smfmac_f32_16x16x64_bf16 v[60:63], v[24:27], a[200:207], v0
ds_read_b128 v[12:15], v3
s_waitcnt lgkmcnt(3)
v_cvt_pk_bf16_f32 v16, v16, v18
v_add_f32 v20, v20, v21
v_smfmac_f32_16x16x64_bf16 v[60:63], v[28:31], v[48:55], v0
ds_read_b128 v[40:43], v2 offset:30720
v_add_f32 v22, v22, v23
v_cvt_pk_bf16_f32 v17, v20, v22
v_smfmac_f32_16x16x64_bf16 v[64:67], v[24:27], a[208:215], v0
ds_read_b128 v[44:47], v2 offset:31744
s_waitcnt lgkmcnt(3)
buffer_store_dwordx2 v[16:17], v9, s[8:11], s28 offen
v_add_f32 v56, v56, v57
v_smfmac_f32_16x16x64_bf16 v[64:67], v[28:31], v[32:39], v0
ds_read_b128 v[48:51], v2 offset:32768
v_add_f32 v58, v58, v59
v_cvt_pk_bf16_f32 v56, v56, v58
v_smfmac_f32_16x16x64_bf16 v[68:71], v[24:27], a[216:223], v0
ds_read_b128 v[52:55], v2 offset:33792
s_waitcnt lgkmcnt(2)
v_add_f32 v60, v60, v61
v_add_f32 v62, v62, v63
v_smfmac_f32_16x16x64_bf16 v[68:71], v[28:31], v[40:47], v0
ds_read_b128 v[20:23], v3
v_cvt_pk_bf16_f32 v57, v60, v62
buffer_store_dwordx2 v[56:57], v9, s[8:11], s50 offen
v_smfmac_f32_16x16x64_bf16 v[12:15], v[24:27], a[224:231], v0
s_waitcnt lgkmcnt(1)
v_add_f32 v64, v64, v65
v_add_f32 v66, v66, v67
v_smfmac_f32_16x16x64_bf16 v[12:15], v[28:31], v[48:55], v0
s_waitcnt lgkmcnt(0)
v_cvt_pk_bf16_f32 v64, v64, v66
v_smfmac_f32_16x16x64_bf16 v[20:23], v[24:27], a[232:239], v0
v_add_f32 v68, v68, v69
v_add_f32 v70, v70, v71
v_smfmac_f32_16x16x64_bf16 v[20:23], v[28:31], a[240:247], v0
v_cvt_pk_bf16_f32 v65, v68, v70
buffer_store_dwordx2 v[64:65], v9, s[8:11], s51 offen
v_add_f32 v12, v12, v13
v_add_f32 v14, v14, v15
v_cvt_pk_bf16_f32 v12, v12, v14
s_nop 2
v_add_f32 v20, v20, v21
v_add_f32 v22, v22, v23
v_cvt_pk_bf16_f32 v13, v20, v22
buffer_store_dwordx2 v[12:13], v9, s[8:11], s52 offen
s_add_u32 s19, s19, 1
s_mov_b32 s20, s28
s_mov_b32 s28, s29
s_mov_b32 s29, s20
s_and_b32 s20, s19, 3
s_lshl_b32 s20, s20, 14
s_add_u32 s33, s20, 110100480
s_add_u32 s34, s20, s24
s_xor_b32 s20, s20, 32768
s_add_u32 s35, s20, s24
s_add_u32 s30, s30, 16384
s_add_u32 s31, s31, 131072
s_add_u32 s6, s33, 4096
s_add_u32 s7, s33, 8192
s_mov_b32 s22, 0
v_mov_b64 v[24:25], 0
v_mov_b64 v[26:27], 0
v_mov_b64 v[28:29], 0
v_mov_b64 v[30:31], 0
v_and_b32 v69, 0x380, v1
v_add_u32 v69, v69, v1
v_and_b32 v70, 0xf00, v1
v_add_u32 v70, v70, v1
v_mov_b64 v[64:65], -1
v_mov_b64 v[66:67], -1
v_xor_b32 v3, 16, v4
ds_read_b128 v[48:51], v2 offset:8192
ds_read_b128 v[52:55], v2 offset:9216
v_mov_b32 v56, 0x3f80
v_cndmask_b32 v56, v56, 1.0, s[44:45]
v_cndmask_b32 v60, 0, v56, s[36:37]
v_cndmask_b32 v61, 0, v56, s[38:39]
v_cndmask_b32 v62, 0, v56, s[40:41]
v_cndmask_b32 v63, 0, v56, s[42:43]
s_nop 5
buffer_load_dwordx4 v[32:35], v1, s[8:11], s49 offen offset:0 sc1
buffer_load_dwordx4 v[36:39], v1, s[8:11], s49 offen offset:1024 sc1
buffer_load_dwordx4 v[40:43], v1, s[8:11], s49 offen offset:2048 sc1
buffer_load_dwordx4 v[44:47], v1, s[8:11], s49 offen offset:3072 sc1
s_waitcnt vmcnt(3)
v_mfma_f32_16x16x32_bf16 v[56:59], v[32:35], v[60:63], 0
v_max3_u32 v16, v32, v33, v34
v_max_u32 v16, v16, v35
s_waitcnt vmcnt(2)
v_mfma_f32_16x16x32_bf16 v[56:59], v[36:39], v[60:63], v[56:59]
v_max3_u32 v16, v16, v36, v37
v_max3_u32 v16, v16, v38, v39
s_waitcnt vmcnt(1)
v_mfma_f32_16x16x32_bf16 v[56:59], v[40:43], v[60:63], v[56:59]
v_max3_u32 v16, v16, v40, v41
v_max3_u32 v16, v16, v42, v43
s_waitcnt vmcnt(0)
v_mfma_f32_16x16x32_bf16 v[56:59], v[44:47], v[60:63], v[56:59]
v_max3_u32 v16, v16, v44, v45
v_max3_u32 v16, v16, v46, v47
v_cmp_le_u32 vcc, 0xffff0000, v16
s_cbranch_vccnz L_red0
L_redb0:
s_nop 3
v_permlane32_swap_b32 v56, v58
v_permlane32_swap_b32 v57, v59
v_pk_add_f32 v[56:57], v[56:57], v[58:59]
v_cvt_pk_bf16_f32 v56, v56, v57
buffer_store_dword v56, v11, s[8:11], s34 offen
s_barrier
ds_read_b128 v[40:43], v2 offset:0
ds_read_b128 v[44:47], v2 offset:1024
v_mov_b64 v[32:33], 0
v_mov_b64 v[34:35], 0
v_mov_b64 v[36:37], 0
v_mov_b64 v[38:39], 0
v_mov_b64 v[56:57], 0
v_mov_b64 v[58:59], 0
v_mov_b64 v[60:61], 0
v_mov_b64 v[62:63], 0
s_nop 15
s_nop 13
s_branch L_gat0
L_red0:
L_red0b:
buffer_load_dwordx4 v[32:35], v1, s[8:11], s49 offen offset:0 sc1
buffer_load_dwordx4 v[36:39], v1, s[8:11], s49 offen offset:1024 sc1
buffer_load_dwordx4 v[40:43], v1, s[8:11], s49 offen offset:2048 sc1
buffer_load_dwordx4 v[44:47], v1, s[8:11], s49 offen offset:3072 sc1
s_add_u32 s22, s22, 1
s_cmp_gt_u32 s22, 40000
s_cbranch_scc1 L_end
s_waitcnt vmcnt(3)
v_mfma_f32_16x16x32_bf16 v[56:59], v[32:35], v[60:63], 0
v_max3_u32 v16, v32, v33, v34
v_max_u32 v16, v16, v35
s_waitcnt vmcnt(2)
v_mfma_f32_16x16x32_bf16 v[56:59], v[36:39], v[60:63], v[56:59]
v_max3_u32 v16, v16, v36, v37
v_max3_u32 v16, v16, v38, v39
s_waitcnt vmcnt(1)
v_mfma_f32_16x16x32_bf16 v[56:59], v[40:43], v[60:63], v[56:59]
v_max3_u32 v16, v16, v40, v41
v_max3_u32 v16, v16, v42, v43
s_waitcnt vmcnt(0)
v_mfma_f32_16x16x32_bf16 v[56:59], v[44:47], v[60:63], v[56:59]
v_max3_u32 v16, v16, v44, v45
v_max3_u32 v16, v16, v46, v47
v_cmp_le_u32 vcc, 0xffff0000, v16
s_cbranch_vccz L_redb0
s_branch L_red0b
L_ent1:
v_lshlrev_b32 v6, 3, v1
v_mov_b64 v[24:25], 0
v_mov_b64 v[26:27], 0
v_mov_b64 v[28:29], 0
v_mov_b64 v[30:31], 0
v_and_b32 v69, 0x380, v1
v_add_u32 v69, v69, v1
v_and_b32 v70, 0xf00, v1
v_add_u32 v70, v70, v1
v_mov_b64 v[64:65], -1
v_mov_b64 v[66:67], -1
v_xor_b32 v3, 16, v4
ds_read_b128 v[48:51], v2 offset:10240
ds_read_b128 v[52:55], v2 offset:11264
ds_read_b128 v[40:43], v2 offset:2048
ds_read_b128 v[44:47], v2 offset:3072
v_mov_b64 v[32:33], 0
v_mov_b64 v[34:35], 0
v_mov_b64 v[36:37], 0
v_mov_b64 v[38:39], 0
v_mov_b64 v[56:57], 0
v_mov_b64 v[58:59], 0
v_mov_b64 v[60:61], 0
v_mov_b64 v[62:63], 0
s_add_u32 s20, s30, 1024
s_add_u32 s21, s30, 8192
s_add_u32 s49, s29, s25
s_add_u32 s50, s29, s26
s_add_u32 s51, s29, s27
s_add_u32 s52, s30, 16384
s_mov_b32 m0, 17920
s_waitcnt vmcnt(0) lgkmcnt(0)
s_branch L_step1
L_gr1:
buffer_load_dwordx4 v[12:15], v1, s[8:11], s33 offen sc1
buffer_load_dword v20, v8, s[8:11], s7 offen sc1
buffer_load_dwordx4 v[16:19], v1, s[8:11], s6 offen sc1
s_add_u32 s22, s22, 1
s_cmp_gt_u32 s22, 40000
s_cbranch_scc1 L_end
s_nop 0
v_mov_b64 v[24:25], 0
v_mov_b64 v[26:27], 0
v_mov_b64 v[28:29], 0
v_mov_b64 v[30:31], 0
v_mov_b64 v[32:33], 0
v_mov_b64 v[34:35], 0
v_mov_b64 v[36:37], 0
v_mov_b64 v[38:39], 0
v_mov_b64 v[56:57], 0
v_mov_b64 v[58:59], 0
v_mov_b64 v[60:61], 0
v_mov_b64 v[62:63], 0
s_waitcnt lgkmcnt(0)
s_branch L_step1
.p2align 3
L_gat1:
buffer_load_dwordx4 v[12:15], v1, s[8:11], s33 offen sc1
buffer_load_dword v20, v8, s[8:11], s7 offen sc1
buffer_load_dwordx4 v[16:19], v1, s[8:11], s6 offen sc1
s_add_u32 s20, s30, 1024
s_add_u32 s21, s30, 8192
s_add_u32 s49, s29, s25
s_add_u32 s50, s29, s26
s_add_u32 s51, s29, s27
s_add_u32 s52, s30, 16384
s_mov_b32 m0, 17920
s_waitcnt lgkmcnt(0)
L_step1:
s_waitcnt vmcnt(2)
v_smfmac_f32_16x16x64_bf16 v[24:27], v[12:15], v[96:103], v0
ds_write_b128 v1, v[12:15] offset:6656
v_smfmac_f32_16x16x64_bf16 v[28:31], v[12:15], v[104:111], v0
s_waitcnt vmcnt(1)
ds_write_b32 v8, v20 offset:14848
v_smfmac_f32_16x16x64_bf16 v[32:35], v[12:15], v[112:119], v0
s_waitcnt vmcnt(0)
ds_write_b128 v1, v[16:19] offset:10752
v_smfmac_f32_16x16x64_bf16 v[56:59], v[12:15], a[48:55], v0
v_max3_u32 v21, v12, v13, v14
v_max3_u32 v21, v21, v15, v20
v_smfmac_f32_16x16x64_bf16 v[60:63], v[12:15], a[56:63], v0
v_max3_u32 v21, v21, v16, v17
v_max3_u32 v21, v21, v18, v19
v_smfmac_f32_16x16x64_bf16 v[36:39], v[12:15], v[40:47], v0
v_cmp_le_u32 vcc, 0xffff0000, v21
v_smfmac_f32_16x16x64_bf16 v[24:27], v[16:19], v[192:199], v0
s_cbranch_vccnz L_gr1
v_smfmac_f32_16x16x64_bf16 v[28:31], v[16:19], v[200:207], v0
s_waitcnt lgkmcnt(0)
s_barrier
ds_read_b128 v[20:23], v1 offset:5632
v_smfmac_f32_16x16x64_bf16 v[32:35], v[16:19], v[208:215], v0
ds_read_b128 v[12:15], v1 offset:7680
buffer_load_dwordx4 v69, s[8:11], s20 offen sc1 lds
v_smfmac_f32_16x16x64_bf16 v[56:59], v[16:19], a[112:119], v0
ds_read_b128 v[40:43], v2 offset:0
s_mov_b32 m0, 18816
v_smfmac_f32_16x16x64_bf16 v[60:63], v[16:19], a[120:127], v0
ds_read_b128 v[44:47], v2 offset:1024
v_smfmac_f32_16x16x64_bf16 v[36:39], v[16:19], v[48:55], v0
ds_read_b128 v[16:19], v1 offset:8704
s_waitcnt lgkmcnt(4)
v_smfmac_f32_16x16x64_bf16 v[24:27], v[20:23], v[72:79], v0
ds_read_b128 v[48:51], v2 offset:4096
buffer_load_dwordx4 v69, s[8:11], s20 offen offset:128 sc1 lds
v_smfmac_f32_16x16x64_bf16 v[28:31], v[20:23], v[80:87], v0
ds_read_b128 v[52:55], v2 offset:5120
s_mov_b32 m0, 6272
v_smfmac_f32_16x16x64_bf16 v[32:35], v[20:23], v[88:95], v0
buffer_store_dword v0, v11, s[8:11], s35 offen
s_waitcnt lgkmcnt(3)
v_smfmac_f32_16x16x64_bf16 v[36:39], v[20:23], v[40:47], v0
ds_read_b128 v[20:23], v1 offset:9728
v_smfmac_f32_16x16x64_bf16 v[24:27], v[12:15], v[120:127], v0
ds_read_b128 v[40:43], v2 offset:6144
v_smfmac_f32_16x16x64_bf16 v[28:31], v[12:15], v[128:135], v0
ds_read_b128 v[44:47], v2 offset:7168
buffer_store_dwordx4 v[64:67], v1, s[8:11], s49 offen
v_smfmac_f32_16x16x64_bf16 v[32:35], v[12:15], v[136:143], v0
s_waitcnt lgkmcnt(3)
v_smfmac_f32_16x16x64_bf16 v[36:39], v[12:15], v[48:55], v0
ds_read_b128 v[12:15], v1 offset:11776
v_smfmac_f32_16x16x64_bf16 v[24:27], v[16:19], v[144:151], v0
ds_read_b128 v[48:51], v2 offset:8192
v_smfmac_f32_16x16x64_bf16 v[28:31], v[16:19], v[152:159], v0
ds_read_b128 v[52:55], v2 offset:9216
buffer_store_dwordx4 v[64:67], v1, s[8:11], s50 offen
v_smfmac_f32_16x16x64_bf16 v[32:35], v[16:19], v[160:167], v0
s_waitcnt lgkmcnt(3)
v_smfmac_f32_16x16x64_bf16 v[36:39], v[16:19], v[40:47], v0
ds_read_b128 v[16:19], v1 offset:12800
v_smfmac_f32_16x16x64_bf16 v[24:27], v[20:23], v[168:175], v0
ds_read_b128 v[40:43], v2 offset:12288
v_smfmac_f32_16x16x64_bf16 v[28:31], v[20:23], v[176:183], v0
ds_read_b128 v[44:47], v2 offset:13312
buffer_store_dwordx4 v[64:67], v1, s[8:11], s51 offen
v_smfmac_f32_16x16x64_bf16 v[32:35], v[20:23], v[184:191], v0
s_waitcnt lgkmcnt(3)
v_smfmac_f32_16x16x64_bf16 v[36:39], v[20:23], v[48:55], v0
ds_read_b128 v[20:23], v1 offset:13824
v_smfmac_f32_16x16x64_bf16 v[24:27], v[12:15], v[216:223], v0
ds_read_b128 v[48:51], v2 offset:14336
buffer_load_dwordx4 v[64:67], v70, s[8:11], s21 offen sc1
v_smfmac_f32_16x16x64_bf16 v[28:31], v[12:15], v[224:231], v0
ds_read_b128 v[52:55], v2 offset:15360
v_smfmac_f32_16x16x64_bf16 v[32:35], v[12:15], v[232:239], v0
s_waitcnt lgkmcnt(3)
v_smfmac_f32_16x16x64_bf16 v[36:39], v[12:15], v[40:47], v0
ds_read_b128 v[12:15], v1 offset:5632
v_smfmac_f32_16x16x64_bf16 v[24:27], v[16:19], v[240:247], v0
ds_read_b128 v[40:43], v2 offset:16384
buffer_load_dwordx4 v[68:71], v70, s[8:11], s21 offen offset:256 sc1
v_smfmac_f32_16x16x64_bf16 v[28:31], v[16:19], v[248:255], v0
ds_read_b128 v[44:47], v2 offset:17408
v_smfmac_f32_16x16x64_bf16 v[32:35], v[16:19], a[0:7], v0
s_waitcnt lgkmcnt(3)
v_smfmac_f32_16x16x64_bf16 v[36:39], v[16:19], v[48:55], v0
ds_read_b128 v[16:19], v1 offset:7680
v_smfmac_f32_16x16x64_bf16 v[24:27], v[20:23], a[8:15], v0
v_smfmac_f32_16x16x64_bf16 v[28:31], v[20:23], a[16:23], v0
buffer_load_dword v6, s[8:11], s52 offen sc1 lds
v_smfmac_f32_16x16x64_bf16 v[32:35], v[20:23], a[24:31], v0
s_waitcnt lgkmcnt(1)
v_smfmac_f32_16x16x64_bf16 v[36:39], v[20:23], v[40:47], v0
ds_read_b128 v[20:23], v1 offset:8704
v_smfmac_f32_16x16x64_bf16 v[56:59], v[12:15], a[32:39], v0
s_nop 0
v_add_f32 v24, v24, v25
v_add_f32 v26, v26, v27
v_add_f32 v28, v28, v29
v_add_f32 v30, v30, v31
v_cvt_pk_bf16_f32 v24, v24, v28
v_cvt_pk_bf16_f32 v26, v26, v30
ds_write_b32 v4, v24 offset:2176
v_add_f32 v32, v32, v33
v_add_f32 v34, v34, v35
v_add_f32 v36, v36, v37
v_add_f32 v38, v38, v39
ds_write_b32 v3, v26 offset:2176
v_cvt_pk_bf16_f32 v32, v32, v36
v_cvt_pk_bf16_f32 v34, v34, v38
ds_write_b32 v4, v32
v_smfmac_f32_16x16x64_bf16 v[60:63], v[12:15], a[40:47], v0
ds_write_b32 v3, v34
s_waitcnt lgkmcnt(5)
v_smfmac_f32_16x16x64_bf16 v[56:59], v[16:19], a[64:71], v0
ds_read_b128 v[12:15], v1 offset:9728
v_smfmac_f32_16x16x64_bf16 v[60:63], v[16:19], a[72:79], v0
ds_read_b128 v[16:19], v1 offset:11776
s_waitcnt lgkmcnt(6)
v_smfmac_f32_16x16x64_bf16 v[56:59], v[20:23], a[80:87], v0
s_waitcnt lgkmcnt(2) vmcnt(7)
s_barrier
ds_read_b128 v[28:31], v5 offset:512
v_smfmac_f32_16x16x64_bf16 v[60:63], v[20:23], a[88:95], v0
ds_read_b128 v[20:23], v1 offset:12800
s_waitcnt lgkmcnt(3)
v_smfmac_f32_16x16x64_bf16 v[56:59], v[12:15], a[96:103], v0
ds_read_b128 v[44:47], v1 offset:16896
v_smfmac_f32_16x16x64_bf16 v[60:63], v[12:15], a[104:111], v0
ds_read_b128 v[12:15], v1 offset:13824
s_waitcnt lgkmcnt(4)
v_smfmac_f32_16x16x64_bf16 v[56:59], v[16:19], a[128:135], v0
ds_read_b128 v[32:35], v5 offset:1024
v_smfmac_f32_16x16x64_bf16 v[60:63], v[16:19], a[136:143], v0
ds_read_b128 v[48:51], v1 offset:18944
s_waitcnt lgkmcnt(4)
v_smfmac_f32_16x16x64_bf16 v[56:59], v[20:23], a[144:151], v0
ds_read_b128 v[36:39], v5 offset:1536
v_smfmac_f32_16x16x64_bf16 v[60:63], v[20:23], a[152:159], v0
ds_read_b128 v[52:55], v1 offset:20992
s_mov_b64 exec, s[86:87]
buffer_store_dwordx4 v[28:31], v5, s[8:11], s31 offen offset:512 sc1
s_mov_b64 exec, -1
s_waitcnt lgkmcnt(4)
v_smfmac_f32_16x16x64_bf16 v[56:59], v[12:15], a[160:167], v0
ds_read_b128 v[24:27], v5 offset:0
v_smfmac_f32_16x16x64_bf16 v[60:63], v[12:15], a[168:175], v0
ds_read_b128 v[40:43], v1 offset:14848
v_mfma_f32_16x16x32_bf16 v[16:19], v[44:47], v[28:31], 0
ds_read_b128 v[44:47], v1 offset:17920
s_waitcnt lgkmcnt(5)
v_mfma_f32_16x16x32_bf16 v[16:19], v[48:51], v[32:35], v[16:19]
ds_read_b128 v[48:51], v1 offset:19968
s_waitcnt lgkmcnt(4)
v_mfma_f32_16x16x32_bf16 v[16:19], v[52:55], v[36:39], v[16:19]
ds_read_b128 v[52:55], v1 offset:22016
s_waitcnt lgkmcnt(3)
v_mfma_f32_16x16x32_bf16 v[16:19], v[40:43], v[24:27], v[16:19]
ds_read_b128 v[40:43], v1 offset:15872
v_mfma_f32_16x16x32_bf16 v[20:23], v[28:31], v[28:31], 0
v_add_f32 v56, v56, v57
v_add_f32 v58, v58, v59
v_mfma_f32_16x16x32_bf16 v[20:23], v[32:35], v[32:35], v[20:23]
v_add_f32 v60, v60, v61
v_add_f32 v62, v62, v63
v_mfma_f32_16x16x32_bf16 v[20:23], v[36:39], v[36:39], v[20:23]
v_cvt_pk_bf16_f32 v56, v56, v58
v_cvt_pk_bf16_f32 v57, v60, v62
v_mfma_f32_16x16x32_bf16 v[20:23], v[24:27], v[24:27], v[20:23]
v_lshrrev_b32 v58, 1, v1
v_max3_f32 v59, v16, v17, v18
s_waitcnt lgkmcnt(3)
v_mfma_f32_16x16x32_bf16 v[12:15], v[44:47], v[28:31], 0
ds_read_b128 v[44:47], v2 offset:19456
s_waitcnt lgkmcnt(3)
v_mfma_f32_16x16x32_bf16 v[12:15], v[48:51], v[32:35], v[12:15]
ds_read_b128 v[48:51], v2 offset:20480
buffer_store_dwordx2 v[56:57], v58, s[8:11], s31 offen offset:2048 sc1
s_waitcnt lgkmcnt(3)
v_mfma_f32_16x16x32_bf16 v[12:15], v[52:55], v[36:39], v[12:15]
ds_read_b128 v[52:55], v2 offset:21504
v_max3_f32 v59, v59, v19, v20
v_max_f32 v59, v59, v21
s_waitcnt lgkmcnt(3)
v_mfma_f32_16x16x32_bf16 v[12:15], v[40:43], v[24:27], v[12:15]
ds_read_b128 v[40:43], v2 offset:18432
v_mov_b32 v60, s53
s_add_u32 s49, s28, s23
v_mov_b32 v61, s53
s_add_u32 s50, s28, 65536
v_mov_b32 v62, s53
ds_read_b128 v[32:35], v2 offset:22528
v_mov_b32 v63, s53
v_max3_f32 v59, v59, v12, v13
v_max3_f32 v22, v59, v14, v15
v_max3_f32 v59, v59, v14, v15
s_add_u32 s51, s28, 131072
s_add_u32 s52, s28, 196608
v_permlane32_swap_b32 v22, v59
v_max_f32 v23, v59, v22
v_max_f32 v59, v59, v22
v_mov_b32 v22, 0
ds_read_b128 v[36:39], v2 offset:23552
v_permlane16_swap_b32 v23, v59
v_max_f32 v59, v59, v23
v_mul_f32 v58, s18, v59
v_pk_fma_f32 v[20:21], v[20:21], s[18:19], v[58:59] op_sel_hi:[1,0,0] neg_lo:[0,0,1] neg_hi:[0,0,1]
v_pk_fma_f32 v[16:17], v[16:17], s[18:19], v[58:59] op_sel_hi:[1,0,0] neg_lo:[0,0,1] neg_hi:[0,0,1]
v_pk_fma_f32 v[18:19], v[18:19], s[18:19], v[58:59] op_sel_hi:[1,0,0] neg_lo:[0,0,1] neg_hi:[0,0,1]
v_pk_fma_f32 v[12:13], v[12:13], s[18:19], v[58:59] op_sel_hi:[1,0,0] neg_lo:[0,0,1] neg_hi:[0,0,1]
v_pk_fma_f32 v[14:15], v[14:15], s[18:19], v[58:59] op_sel_hi:[1,0,0] neg_lo:[0,0,1] neg_hi:[0,0,1]
v_exp_f32 v20, v20
v_exp_f32 v21, v21
v_exp_f32 v16, v16
v_cvt_pk_bf16_f32 v23, v20, v21
v_cvt_pk_bf16_f32 v20, v20, v21
v_mov_b32 v21, 0
v_exp_f32 v17, v17
v_exp_f32 v18, v18
v_mfma_f32_16x16x16_bf16 v[24:27], v[56:57], v[20:21], 0
v_exp_f32 v19, v19
v_mfma_f32_16x16x16_bf16 v[28:31], v[56:57], v[22:23], 0
v_exp_f32 v12, v12
v_exp_f32 v13, v13
v_cvt_pk_bf16_f32 v16, v16, v17
v_cvt_pk_bf16_f32 v17, v18, v19
v_exp_f32 v14, v14
v_exp_f32 v15, v15
v_cvt_pk_bf16_f32 v18, v12, v13
v_cvt_pk_bf16_f32 v19, v14, v15
v_mfma_f32_16x16x16_bf16 v[12:15], v[60:61], v[20:21], 0
s_waitcnt vmcnt(3)
v_mfma_f32_16x16x32_bf16 v[12:15], v[60:63], v[16:19], v[12:15]
v_mov_b32 v20, 0
v_mov_b32 v23, 0
v_mfma_f32_16x16x32_bf16 v[24:27], v[64:67], v[16:19], v[24:27]
s_nop 1
v_mfma_f32_16x16x32_bf16 v[28:31], v[68:71], v[16:19], v[28:31]
v_mov_b32 v16, 0
v_mov_b32 v17, 0
v_rcp_f32 v12, v12
v_mov_b32 v18, 0
v_mov_b32 v19, 0
v_pk_mul_f32 v[24:25], v[24:25], v[12:13] op_sel_hi:[1,0]
v_pk_mul_f32 v[26:27], v[26:27], v[12:13] op_sel_hi:[1,0]
v_mov_b32 v15, 0
v_pk_mul_f32 v[28:29], v[28:29], v[12:13] op_sel_hi:[1,0]
v_pk_mul_f32 v[30:31], v[30:31], v[12:13] op_sel_hi:[1,0]
v_cvt_pk_bf16_f32 v24, v24, v28
v_cvt_pk_bf16_f32 v25, v25, v29
v_cvt_pk_bf16_f32 v26, v26, v30
v_cvt_pk_bf16_f32 v27, v27, v31
v_mfma_f32_16x16x32_bf16 v[56:59], v[20:23], v[20:23], 0
ds_write_b128 v7, v[24:27]
v_mfma_f32_16x16x32_bf16 v[60:63], v[20:23], v[20:23], 0
v_mov_b32 v12, 0
v_mov_b32 v13, 0
v_mov_b32 v14, 0
v_mov_b32 v3, 6528
s_nop 1
v_mfma_f32_16x16x32_bf16 v[64:67], v[20:23], v[20:23], 0
s_cmp_eq_u32 s19, 63
s_cbranch_scc1 L_texit
s_waitcnt lgkmcnt(0)
s_barrier
ds_read_b128 v[24:27], v1 offset:3200
v_mfma_f32_16x16x32_bf16 v[68:71], v[20:23], v[20:23], 0
ds_read_b128 v[28:31], v1 offset:4224
s_nop 2
v_mfma_f32_16x16x32_bf16 v[68:71], v[20:23], v[20:23], 0
s_waitcnt lgkmcnt(1)
v_smfmac_f32_16x16x64_bf16 v[12:15], v[24:27], a[248:255], v0
v_smfmac_f32_16x16x64_bf16 v[16:19], v[24:27], a[176:183], v0
s_waitcnt lgkmcnt(0)
v_smfmac_f32_16x16x64_bf16 v[12:15], v[28:31], v[40:47], v0
ds_read_b128 v[40:43], v2 offset:24576
v_smfmac_f32_16x16x64_bf16 v[16:19], v[28:31], v[48:55], v0
ds_read_b128 v[44:47], v2 offset:25600
v_smfmac_f32_16x16x64_bf16 v[20:23], v[24:27], a[184:191], v0
ds_read_b128 v[48:51], v2 offset:26624
v_smfmac_f32_16x16x64_bf16 v[20:23], v[28:31], v[32:39], v0
ds_read_b128 v[52:55], v2 offset:27648
s_nop 0
v_add_f32 v12, v12, v13
v_add_f32 v14, v14, v15
v_smfmac_f32_16x16x64_bf16 v[56:59], v[24:27], a[192:199], v0
ds_read_b128 v[32:35], v2 offset:28672
s_waitcnt lgkmcnt(3)
v_cvt_pk_bf16_f32 v12, v12, v14
buffer_store_dword v12, v10, s[8:11], s28 offen
v_smfmac_f32_16x16x64_bf16 v[56:59], v[28:31], v[40:47], v0
ds_read_b128 v[36:39], v2 offset:29696
v_add_f32 v16, v16, v17
v_add_f32 v18, v18, v19
v_smfmac_f32_16x16x64_bf16 v[60:63], v[24:27], a[200:207], v0
ds_read_b128 v[12:15], v3
s_waitcnt lgkmcnt(3)
v_cvt_pk_bf16_f32 v16, v16, v18
v_add_f32 v20, v20, v21
v_smfmac_f32_16x16x64_bf16 v[60:63], v[28:31], v[48:55], v0
ds_read_b128 v[40:43], v2 offset:30720
v_add_f32 v22, v22, v23
v_cvt_pk_bf16_f32 v17, v20, v22
v_smfmac_f32_16x16x64_bf16 v[64:67], v[24:27], a[208:215], v0
ds_read_b128 v[44:47], v2 offset:31744
s_waitcnt lgkmcnt(3)
buffer_store_dwordx2 v[16:17], v9, s[8:11], s28 offen
v_add_f32 v56, v56, v57
v_smfmac_f32_16x16x64_bf16 v[64:67], v[28:31], v[32:39], v0
ds_read_b128 v[48:51], v2 offset:32768
v_add_f32 v58, v58, v59
v_cvt_pk_bf16_f32 v56, v56, v58
v_smfmac_f32_16x16x64_bf16 v[68:71], v[24:27], a[216:223], v0
ds_read_b128 v[52:55], v2 offset:33792
s_waitcnt lgkmcnt(2)
v_add_f32 v60, v60, v61
v_add_f32 v62, v62, v63
v_smfmac_f32_16x16x64_bf16 v[68:71], v[28:31], v[40:47], v0
ds_read_b128 v[20:23], v3
v_cvt_pk_bf16_f32 v57, v60, v62
buffer_store_dwordx2 v[56:57], v9, s[8:11], s50 offen
v_smfmac_f32_16x16x64_bf16 v[12:15], v[24:27], a[224:231], v0
s_waitcnt lgkmcnt(1)
v_add_f32 v64, v64, v65
v_add_f32 v66, v66, v67
v_smfmac_f32_16x16x64_bf16 v[12:15], v[28:31], v[48:55], v0
s_waitcnt lgkmcnt(0)
v_cvt_pk_bf16_f32 v64, v64, v66
v_smfmac_f32_16x16x64_bf16 v[20:23], v[24:27], a[232:239], v0
v_add_f32 v68, v68, v69
v_add_f32 v70, v70, v71
v_smfmac_f32_16x16x64_bf16 v[20:23], v[28:31], a[240:247], v0
v_cvt_pk_bf16_f32 v65, v68, v70
buffer_store_dwordx2 v[64:65], v9, s[8:11], s51 offen
v_add_f32 v12, v12, v13
v_add_f32 v14, v14, v15
v_cvt_pk_bf16_f32 v12, v12, v14
s_nop 2
v_add_f32 v20, v20, v21
v_add_f32 v22, v22, v23
v_cvt_pk_bf16_f32 v13, v20, v22
buffer_store_dwordx2 v[12:13], v9, s[8:11], s52 offen
s_add_u32 s19, s19, 1
s_mov_b32 s20, s28
s_mov_b32 s28, s29
s_mov_b32 s29, s20
s_and_b32 s20, s19, 3
s_lshl_b32 s20, s20, 14
s_add_u32 s33, s20, 110100480
s_add_u32 s34, s20, s24
s_xor_b32 s20, s20, 32768
s_add_u32 s35, s20, s24
s_add_u32 s30, s30, 16384
s_add_u32 s31, s31, 131072
s_add_u32 s6, s33, 4096
s_add_u32 s7, s33, 8192
s_mov_b32 s22, 0
v_mov_b64 v[24:25], 0
v_mov_b64 v[26:27], 0
v_mov_b64 v[28:29], 0
v_mov_b64 v[30:31], 0
v_and_b32 v69, 0x380, v1
v_add_u32 v69, v69, v1
v_and_b32 v70, 0xf00, v1
v_add_u32 v70, v70, v1
v_mov_b64 v[64:65], -1
v_mov_b64 v[66:67], -1
v_xor_b32 v3, 16, v4
ds_read_b128 v[48:51], v2 offset:10240
ds_read_b128 v[52:55], v2 offset:11264
v_mov_b32 v56, 0x3f80
v_cndmask_b32 v56, v56, 1.0, s[44:45]
v_cndmask_b32 v60, 0, v56, s[36:37]
v_cndmask_b32 v61, 0, v56, s[38:39]
v_cndmask_b32 v62, 0, v56, s[40:41]
v_cndmask_b32 v63, 0, v56, s[42:43]
s_nop 5
buffer_load_dwordx4 v[32:35], v1, s[8:11], s49 offen offset:0 sc1
buffer_load_dwordx4 v[36:39], v1, s[8:11], s49 offen offset:1024 sc1
buffer_load_dwordx4 v[40:43], v1, s[8:11], s49 offen offset:2048 sc1
buffer_load_dwordx4 v[44:47], v1, s[8:11], s49 offen offset:3072 sc1
s_waitcnt vmcnt(3)
v_mfma_f32_16x16x32_bf16 v[56:59], v[32:35], v[60:63], 0
v_max3_u32 v16, v32, v33, v34
v_max_u32 v16, v16, v35
s_waitcnt vmcnt(2)
v_mfma_f32_16x16x32_bf16 v[56:59], v[36:39], v[60:63], v[56:59]
v_max3_u32 v16, v16, v36, v37
v_max3_u32 v16, v16, v38, v39
s_waitcnt vmcnt(1)
v_mfma_f32_16x16x32_bf16 v[56:59], v[40:43], v[60:63], v[56:59]
v_max3_u32 v16, v16, v40, v41
v_max3_u32 v16, v16, v42, v43
s_waitcnt vmcnt(0)
v_mfma_f32_16x16x32_bf16 v[56:59], v[44:47], v[60:63], v[56:59]
v_max3_u32 v16, v16, v44, v45
v_max3_u32 v16, v16, v46, v47
v_cmp_le_u32 vcc, 0xffff0000, v16
s_cbranch_vccnz L_red1
L_redb1:
s_nop 3
v_permlane32_swap_b32 v56, v58
v_permlane32_swap_b32 v57, v59
v_pk_add_f32 v[56:57], v[56:57], v[58:59]
v_cvt_pk_bf16_f32 v56, v56, v57
buffer_store_dword v56, v11, s[8:11], s34 offen
s_barrier
ds_read_b128 v[40:43], v2 offset:2048
ds_read_b128 v[44:47], v2 offset:3072
v_mov_b64 v[32:33], 0
v_mov_b64 v[34:35], 0
v_mov_b64 v[36:37], 0
v_mov_b64 v[38:39], 0
v_mov_b64 v[56:57], 0
v_mov_b64 v[58:59], 0
v_mov_b64 v[60:61], 0
v_mov_b64 v[62:63], 0
s_nop 15
s_nop 13
s_branch L_gat1
L_red1:
L_red1b:
buffer_load_dwordx4 v[32:35], v1, s[8:11], s49 offen offset:0 sc1
buffer_load_dwordx4 v[36:39], v1, s[8:11], s49 offen offset:1024 sc1
buffer_load_dwordx4 v[40:43], v1, s[8:11], s49 offen offset:2048 sc1
buffer_load_dwordx4 v[44:47], v1, s[8:11], s49 offen offset:3072 sc1
s_add_u32 s22, s22, 1
s_cmp_gt_u32 s22, 40000
s_cbranch_scc1 L_end
s_waitcnt vmcnt(3)
v_mfma_f32_16x16x32_bf16 v[56:59], v[32:35], v[60:63], 0
v_max3_u32 v16, v32, v33, v34
v_max_u32 v16, v16, v35
s_waitcnt vmcnt(2)
v_mfma_f32_16x16x32_bf16 v[56:59], v[36:39], v[60:63], v[56:59]
v_max3_u32 v16, v16, v36, v37
v_max3_u32 v16, v16, v38, v39
s_waitcnt vmcnt(1)
v_mfma_f32_16x16x32_bf16 v[56:59], v[40:43], v[60:63], v[56:59]
v_max3_u32 v16, v16, v40, v41
v_max3_u32 v16, v16, v42, v43
s_waitcnt vmcnt(0)
v_mfma_f32_16x16x32_bf16 v[56:59], v[44:47], v[60:63], v[56:59]
v_max3_u32 v16, v16, v44, v45
v_max3_u32 v16, v16, v46, v47
v_cmp_le_u32 vcc, 0xffff0000, v16
s_cbranch_vccz L_redb1
s_branch L_red1b
L_ent2:
v_lshlrev_b32 v6, 3, v1
v_mov_b64 v[24:25], 0
v_mov_b64 v[26:27], 0
v_mov_b64 v[28:29], 0
v_mov_b64 v[30:31], 0
v_and_b32 v69, 0x380, v1
v_add_u32 v69, v69, v1
v_and_b32 v70, 0xf00, v1
v_add_u32 v70, v70, v1
v_mov_b64 v[64:65], -1
v_mov_b64 v[66:67], -1
v_xor_b32 v3, 16, v4
ds_read_b128 v[48:51], v2 offset:12288
ds_read_b128 v[52:55], v2 offset:13312
ds_read_b128 v[40:43], v2 offset:4096
ds_read_b128 v[44:47], v2 offset:5120
v_mov_b64 v[32:33], 0
v_mov_b64 v[34:35], 0
v_mov_b64 v[36:37], 0
v_mov_b64 v[38:39], 0
v_mov_b64 v[56:57], 0
v_mov_b64 v[58:59], 0
v_mov_b64 v[60:61], 0
v_mov_b64 v[62:63], 0
s_add_u32 s20, s30, 2048
s_add_u32 s21, s30, 8192
s_add_u32 s49, s29, s25
s_add_u32 s50, s29, s26
s_add_u32 s51, s29, s27
s_add_u32 s52, s30, 16384
s_mov_b32 m0, 19968
s_waitcnt vmcnt(0) lgkmcnt(0)
s_branch L_step2
L_gr2:
buffer_load_dwordx4 v[12:15], v1, s[8:11], s33 offen sc1
buffer_load_dword v20, v8, s[8:11], s7 offen sc1
buffer_load_dwordx4 v[16:19], v1, s[8:11], s6 offen sc1
s_add_u32 s22, s22, 1
s_cmp_gt_u32 s22, 40000
s_cbranch_scc1 L_end
s_nop 0
v_mov_b64 v[24:25], 0
v_mov_b64 v[26:27], 0
v_mov_b64 v[28:29], 0
v_mov_b64 v[30:31], 0
v_mov_b64 v[32:33], 0
v_mov_b64 v[34:35], 0
v_mov_b64 v[36:37], 0
v_mov_b64 v[38:39], 0
v_mov_b64 v[56:57], 0
v_mov_b64 v[58:59], 0
v_mov_b64 v[60:61], 0
v_mov_b64 v[62:63], 0
s_waitcnt lgkmcnt(0)
s_branch L_step2
.p2align 3
L_gat2:
buffer_load_dwordx4 v[12:15], v1, s[8:11], s33 offen sc1
buffer_load_dword v20, v8, s[8:11], s7 offen sc1
buffer_load_dwordx4 v[16:19], v1, s[8:11], s6 offen sc1
s_add_u32 s20, s30, 2048
s_add_u32 s21, s30, 8192
s_add_u32 s49, s29, s25
s_add_u32 s50, s29, s26
s_add_u32 s51, s29, s27
s_add_u32 s52, s30, 16384
s_mov_b32 m0, 19968
s_waitcnt lgkmcnt(0)
L_step2:
s_waitcnt vmcnt(2)
v_smfmac_f32_16x16x64_bf16 v[24:27], v[12:15], v[120:127], v0
ds_write_b128 v1, v[12:15] offset:6656
v_smfmac_f32_16x16x64_bf16 v[28:31], v[12:15], v[128:135], v0
s_waitcnt vmcnt(1)
ds_write_b32 v8, v20 offset:14848
v_smfmac_f32_16x16x64_bf16 v[32:35], v[12:15], v[136:143], v0
s_waitcnt vmcnt(0)
ds_write_b128 v1, v[16:19] offset:10752
v_smfmac_f32_16x16x64_bf16 v[56:59], v[12:15], a[64:71], v0
v_max3_u32 v21, v12, v13, v14
v_max3_u32 v21, v21, v15, v20
v_smfmac_f32_16x16x64_bf16 v[60:63], v[12:15], a[72:79], v0
v_max3_u32 v21, v21, v16, v17
v_max3_u32 v21, v21, v18, v19
v_smfmac_f32_16x16x64_bf16 v[36:39], v[12:15], v[40:47], v0
v_cmp_le_u32 vcc, 0xffff0000, v21
v_smfmac_f32_16x16x64_bf16 v[24:27], v[16:19], v[216:223], v0
s_cbranch_vccnz L_gr2
v_smfmac_f32_16x16x64_bf16 v[28:31], v[16:19], v[224:231], v0
s_waitcnt lgkmcnt(0)
s_barrier
ds_read_b128 v[20:23], v1 offset:4608
v_smfmac_f32_16x16x64_bf16 v[32:35], v[16:19], v[232:239], v0
ds_read_b128 v[12:15], v1 offset:5632
buffer_load_dwordx4 v69, s[8:11], s20 offen sc1 lds
v_smfmac_f32_16x16x64_bf16 v[56:59], v[16:19], a[128:135], v0
ds_read_b128 v[40:43], v2 offset:0
s_mov_b32 m0, 20864
v_smfmac_f32_16x16x64_bf16 v[60:63], v[16:19], a[136:143], v0
ds_read_b128 v[44:47], v2 offset:1024
v_smfmac_f32_16x16x64_bf16 v[36:39], v[16:19], v[48:55], v0
ds_read_b128 v[16:19], v1 offset:7680
s_waitcnt lgkmcnt(4)
v_smfmac_f32_16x16x64_bf16 v[24:27], v[20:23], v[72:79], v0
ds_read_b128 v[48:51], v2 offset:2048
buffer_load_dwordx4 v69, s[8:11], s20 offen offset:128 sc1 lds
v_smfmac_f32_16x16x64_bf16 v[28:31], v[20:23], v[80:87], v0
ds_read_b128 v[52:55], v2 offset:3072
s_mov_b32 m0, 6272
v_smfmac_f32_16x16x64_bf16 v[32:35], v[20:23], v[88:95], v0
buffer_store_dword v0, v11, s[8:11], s35 offen
s_waitcnt lgkmcnt(3)
v_smfmac_f32_16x16x64_bf16 v[36:39], v[20:23], v[40:47], v0
ds_read_b128 v[20:23], v1 offset:8704
v_smfmac_f32_16x16x64_bf16 v[24:27], v[12:15], v[96:103], v0
ds_read_b128 v[40:43], v2 offset:6144
v_smfmac_f32_16x16x64_bf16 v[28:31], v[12:15], v[104:111], v0
ds_read_b128 v[44:47], v2 offset:7168
v_smfmac_f32_16x16x64_bf16 v[32:35], v[12:15], v[112:119], v0
buffer_store_dwordx4 v[64:67], v1, s[8:11], s49 offen
s_waitcnt lgkmcnt(3)
v_smfmac_f32_16x16x64_bf16 v[36:39], v[12:15], v[48:55], v0
ds_read_b128 v[12:15], v1 offset:9728
v_smfmac_f32_16x16x64_bf16 v[24:27], v[16:19], v[144:151], v0
ds_read_b128 v[48:51], v2 offset:8192
v_smfmac_f32_16x16x64_bf16 v[28:31], v[16:19], v[152:159], v0
ds_read_b128 v[52:55], v2 offset:9216
v_smfmac_f32_16x16x64_bf16 v[32:35], v[16:19], v[160:167], v0
buffer_store_dwordx4 v[64:67], v1, s[8:11], s50 offen
s_waitcnt lgkmcnt(3)
v_smfmac_f32_16x16x64_bf16 v[36:39], v[16:19], v[40:47], v0
ds_read_b128 v[16:19], v1 offset:11776
v_smfmac_f32_16x16x64_bf16 v[24:27], v[20:23], v[168:175], v0
ds_read_b128 v[40:43], v2 offset:10240
v_smfmac_f32_16x16x64_bf16 v[28:31], v[20:23], v[176:183], v0
ds_read_b128 v[44:47], v2 offset:11264
v_smfmac_f32_16x16x64_bf16 v[32:35], v[20:23], v[184:191], v0
buffer_store_dwordx4 v[64:67], v1, s[8:11], s51 offen
s_waitcnt lgkmcnt(3)
v_smfmac_f32_16x16x64_bf16 v[36:39], v[20:23], v[48:55], v0
ds_read_b128 v[20:23], v1 offset:12800
v_smfmac_f32_16x16x64_bf16 v[24:27], v[12:15], v[192:199], v0
ds_read_b128 v[48:51], v2 offset:14336
buffer_load_dwordx4 v[64:67], v70, s[8:11], s21 offen sc1
v_smfmac_f32_16x16x64_bf16 v[28:31], v[12:15], v[200:207], v0
ds_read_b128 v[52:55], v2 offset:15360
v_smfmac_f32_16x16x64_bf16 v[32:35], v[12:15], v[208:215], v0
s_waitcnt lgkmcnt(3)
v_smfmac_f32_16x16x64_bf16 v[36:39], v[12:15], v[40:47], v0
ds_read_b128 v[12:15], v1 offset:4608
v_smfmac_f32_16x16x64_bf16 v[24:27], v[16:19], v[240:247], v0
ds_read_b128 v[40:43], v2 offset:16384
buffer_load_dwordx4 v[68:71], v70, s[8:11], s21 offen offset:256 sc1
v_smfmac_f32_16x16x64_bf16 v[28:31], v[16:19], v[248:255], v0
ds_read_b128 v[44:47], v2 offset:17408
v_smfmac_f32_16x16x64_bf16 v[32:35], v[16:19], a[0:7], v0
s_waitcnt lgkmcnt(3)
v_smfmac_f32_16x16x64_bf16 v[36:39], v[16:19], v[48:55], v0
ds_read_b128 v[16:19], v1 offset:5632
v_smfmac_f32_16x16x64_bf16 v[24:27], v[20:23], a[8:15], v0
v_smfmac_f32_16x16x64_bf16 v[28:31], v[20:23], a[16:23], v0
v_smfmac_f32_16x16x64_bf16 v[32:35], v[20:23], a[24:31], v0
s_waitcnt lgkmcnt(1)
v_smfmac_f32_16x16x64_bf16 v[36:39], v[20:23], v[40:47], v0
ds_read_b128 v[20:23], v1 offset:7680
v_smfmac_f32_16x16x64_bf16 v[56:59], v[12:15], a[32:39], v0
s_nop 1
v_add_f32 v24, v24, v25
v_add_f32 v26, v26, v27
v_add_f32 v28, v28, v29
v_add_f32 v30, v30, v31
v_cvt_pk_bf16_f32 v24, v24, v28
v_cvt_pk_bf16_f32 v26, v26, v30
ds_write_b32 v4, v24 offset:2176
v_add_f32 v32, v32, v33
v_add_f32 v34, v34, v35
v_add_f32 v36, v36, v37
v_add_f32 v38, v38, v39
ds_write_b32 v3, v26 offset:2176
v_cvt_pk_bf16_f32 v32, v32, v36
v_cvt_pk_bf16_f32 v34, v34, v38
ds_write_b32 v4, v32
v_smfmac_f32_16x16x64_bf16 v[60:63], v[12:15], a[40:47], v0
ds_write_b32 v3, v34
s_waitcnt lgkmcnt(5)
v_smfmac_f32_16x16x64_bf16 v[56:59], v[16:19], a[48:55], v0
ds_read_b128 v[12:15], v1 offset:8704
v_smfmac_f32_16x16x64_bf16 v[60:63], v[16:19], a[56:63], v0
ds_read_b128 v[16:19], v1 offset:9728
s_waitcnt lgkmcnt(6)
v_smfmac_f32_16x16x64_bf16 v[56:59], v[20:23], a[80:87], v0
s_waitcnt lgkmcnt(2) vmcnt(6)
s_barrier
ds_read_b128 v[32:35], v5 offset:1024
v_smfmac_f32_16x16x64_bf16 v[60:63], v[20:23], a[88:95], v0
ds_read_b128 v[20:23], v1 offset:11776
s_waitcnt lgkmcnt(3)
v_smfmac_f32_16x16x64_bf16 v[56:59], v[12:15], a[96:103], v0
ds_read_b128 v[48:51], v1 offset:17920
v_smfmac_f32_16x16x64_bf16 v[60:63], v[12:15], a[104:111], v0
ds_read_b128 v[12:15], v1 offset:12800
s_waitcnt lgkmcnt(4)
v_smfmac_f32_16x16x64_bf16 v[56:59], v[16:19], a[112:119], v0
ds_read_b128 v[36:39], v5 offset:1536
v_smfmac_f32_16x16x64_bf16 v[60:63], v[16:19], a[120:127], v0
ds_read_b128 v[52:55], v1 offset:19968
s_waitcnt lgkmcnt(4)
v_smfmac_f32_16x16x64_bf16 v[56:59], v[20:23], a[144:151], v0
ds_read_b128 v[24:27], v5 offset:0
v_smfmac_f32_16x16x64_bf16 v[60:63], v[20:23], a[152:159], v0
ds_read_b128 v[40:43], v1 offset:13824
s_waitcnt lgkmcnt(4)
v_smfmac_f32_16x16x64_bf16 v[56:59], v[12:15], a[160:167], v0
ds_read_b128 v[28:31], v5 offset:512
s_mov_b64 exec, s[86:87]
buffer_store_dwordx4 v[32:35], v5, s[8:11], s31 offen offset:1024 sc1
s_mov_b64 exec, -1
v_smfmac_f32_16x16x64_bf16 v[60:63], v[12:15], a[168:175], v0
ds_read_b128 v[44:47], v1 offset:15872
v_mfma_f32_16x16x32_bf16 v[16:19], v[48:51], v[32:35], 0
ds_read_b128 v[48:51], v1 offset:18944
s_waitcnt lgkmcnt(5)
v_mfma_f32_16x16x32_bf16 v[16:19], v[52:55], v[36:39], v[16:19]
ds_read_b128 v[52:55], v1 offset:20992
s_waitcnt lgkmcnt(4)
v_mfma_f32_16x16x32_bf16 v[16:19], v[40:43], v[24:27], v[16:19]
ds_read_b128 v[40:43], v1 offset:14848
s_waitcnt lgkmcnt(3)
v_mfma_f32_16x16x32_bf16 v[16:19], v[44:47], v[28:31], v[16:19]
ds_read_b128 v[44:47], v1 offset:16896
v_mfma_f32_16x16x32_bf16 v[20:23], v[32:35], v[32:35], 0
v_add_f32 v56, v56, v57
v_add_f32 v58, v58, v59
v_mfma_f32_16x16x32_bf16 v[20:23], v[36:39], v[36:39], v[20:23]
v_add_f32 v60, v60, v61
v_add_f32 v62, v62, v63
v_mfma_f32_16x16x32_bf16 v[20:23], v[24:27], v[24:27], v[20:23]
v_cvt_pk_bf16_f32 v56, v56, v58
v_cvt_pk_bf16_f32 v57, v60, v62
v_mfma_f32_16x16x32_bf16 v[20:23], v[28:31], v[28:31], v[20:23]
v_lshrrev_b32 v58, 1, v1
v_max3_f32 v59, v16, v17, v18
s_waitcnt lgkmcnt(3)
v_mfma_f32_16x16x32_bf16 v[12:15], v[48:51], v[32:35], 0
ds_read_b128 v[48:51], v2 offset:20480
s_waitcnt lgkmcnt(3)
v_mfma_f32_16x16x32_bf16 v[12:15], v[52:55], v[36:39], v[12:15]
ds_read_b128 v[52:55], v2 offset:21504
s_waitcnt lgkmcnt(3)
v_mfma_f32_16x16x32_bf16 v[12:15], v[40:43], v[24:27], v[12:15]
ds_read_b128 v[40:43], v2 offset:18432
buffer_store_dwordx2 v[56:57], v58, s[8:11], s31 offen offset:2048 sc1
s_waitcnt lgkmcnt(3)
v_mfma_f32_16x16x32_bf16 v[12:15], v[44:47], v[28:31], v[12:15]
ds_read_b128 v[44:47], v2 offset:19456
v_max3_f32 v59, v59, v19, v20
v_max_f32 v59, v59, v21
v_mov_b32 v60, s53
s_add_u32 s49, s28, s23
v_mov_b32 v61, s53
s_add_u32 s50, s28, 65536
v_mov_b32 v62, s53
ds_read_b128 v[32:35], v2 offset:22528
v_mov_b32 v63, s53
v_max3_f32 v59, v59, v12, v13
v_max3_f32 v22, v59, v14, v15
v_max3_f32 v59, v59, v14, v15
s_add_u32 s51, s28, 131072
s_add_u32 s52, s28, 196608
v_permlane32_swap_b32 v22, v59
v_max_f32 v23, v59, v22
v_max_f32 v59, v59, v22
v_mov_b32 v22, 0
ds_read_b128 v[36:39], v2 offset:23552
v_permlane16_swap_b32 v23, v59
v_max_f32 v59, v59, v23
v_mul_f32 v58, s18, v59
v_pk_fma_f32 v[20:21], v[20:21], s[18:19], v[58:59] op_sel_hi:[1,0,0] neg_lo:[0,0,1] neg_hi:[0,0,1]
v_pk_fma_f32 v[16:17], v[16:17], s[18:19], v[58:59] op_sel_hi:[1,0,0] neg_lo:[0,0,1] neg_hi:[0,0,1]
v_pk_fma_f32 v[18:19], v[18:19], s[18:19], v[58:59] op_sel_hi:[1,0,0] neg_lo:[0,0,1] neg_hi:[0,0,1]
v_pk_fma_f32 v[12:13], v[12:13], s[18:19], v[58:59] op_sel_hi:[1,0,0] neg_lo:[0,0,1] neg_hi:[0,0,1]
v_pk_fma_f32 v[14:15], v[14:15], s[18:19], v[58:59] op_sel_hi:[1,0,0] neg_lo:[0,0,1] neg_hi:[0,0,1]
v_exp_f32 v20, v20
v_exp_f32 v21, v21
v_exp_f32 v16, v16
v_cvt_pk_bf16_f32 v23, v20, v21
v_cvt_pk_bf16_f32 v20, v20, v21
v_mov_b32 v21, 0
v_exp_f32 v17, v17
v_exp_f32 v18, v18
v_mfma_f32_16x16x16_bf16 v[24:27], v[56:57], v[20:21], 0
v_exp_f32 v19, v19
v_mfma_f32_16x16x16_bf16 v[28:31], v[56:57], v[22:23], 0
v_exp_f32 v12, v12
v_exp_f32 v13, v13
v_cvt_pk_bf16_f32 v16, v16, v17
v_cvt_pk_bf16_f32 v17, v18, v19
v_exp_f32 v14, v14
v_exp_f32 v15, v15
v_cvt_pk_bf16_f32 v18, v12, v13
v_cvt_pk_bf16_f32 v19, v14, v15
v_mfma_f32_16x16x16_bf16 v[12:15], v[60:61], v[20:21], 0
s_waitcnt vmcnt(2)
v_mfma_f32_16x16x32_bf16 v[12:15], v[60:63], v[16:19], v[12:15]
v_mov_b32 v20, 0
v_mov_b32 v23, 0
v_mfma_f32_16x16x32_bf16 v[24:27], v[64:67], v[16:19], v[24:27]
s_nop 1
v_mfma_f32_16x16x32_bf16 v[28:31], v[68:71], v[16:19], v[28:31]
v_mov_b32 v16, 0
v_mov_b32 v17, 0
v_rcp_f32 v12, v12
v_mov_b32 v18, 0
v_mov_b32 v19, 0
v_pk_mul_f32 v[24:25], v[24:25], v[12:13] op_sel_hi:[1,0]
v_pk_mul_f32 v[26:27], v[26:27], v[12:13] op_sel_hi:[1,0]
v_mov_b32 v15, 0
v_pk_mul_f32 v[28:29], v[28:29], v[12:13] op_sel_hi:[1,0]
v_pk_mul_f32 v[30:31], v[30:31], v[12:13] op_sel_hi:[1,0]
v_cvt_pk_bf16_f32 v24, v24, v28
v_cvt_pk_bf16_f32 v25, v25, v29
v_cvt_pk_bf16_f32 v26, v26, v30
v_cvt_pk_bf16_f32 v27, v27, v31
v_mfma_f32_16x16x32_bf16 v[56:59], v[20:23], v[20:23], 0
ds_write_b128 v7, v[24:27]
v_mfma_f32_16x16x32_bf16 v[60:63], v[20:23], v[20:23], 0
v_mov_b32 v12, 0
v_mov_b32 v13, 0
v_mov_b32 v14, 0
v_mov_b32 v3, 6528
s_nop 1
v_mfma_f32_16x16x32_bf16 v[64:67], v[20:23], v[20:23], 0
s_cmp_eq_u32 s19, 63
s_cbranch_scc1 L_texit
s_waitcnt lgkmcnt(0)
s_barrier
ds_read_b128 v[24:27], v1 offset:2176
v_mfma_f32_16x16x32_bf16 v[68:71], v[20:23], v[20:23], 0
ds_read_b128 v[28:31], v1 offset:3200
s_nop 2
v_mfma_f32_16x16x32_bf16 v[68:71], v[20:23], v[20:23], 0
s_waitcnt lgkmcnt(1)
v_smfmac_f32_16x16x64_bf16 v[12:15], v[24:27], a[248:255], v0
v_smfmac_f32_16x16x64_bf16 v[16:19], v[24:27], a[176:183], v0
s_waitcnt lgkmcnt(0)
v_smfmac_f32_16x16x64_bf16 v[12:15], v[28:31], v[40:47], v0
ds_read_b128 v[40:43], v2 offset:24576
v_smfmac_f32_16x16x64_bf16 v[16:19], v[28:31], v[48:55], v0
ds_read_b128 v[44:47], v2 offset:25600
v_smfmac_f32_16x16x64_bf16 v[20:23], v[24:27], a[184:191], v0
ds_read_b128 v[48:51], v2 offset:26624
v_smfmac_f32_16x16x64_bf16 v[20:23], v[28:31], v[32:39], v0
ds_read_b128 v[52:55], v2 offset:27648
s_nop 0
v_add_f32 v12, v12, v13
v_add_f32 v14, v14, v15
v_smfmac_f32_16x16x64_bf16 v[56:59], v[24:27], a[192:199], v0
ds_read_b128 v[32:35], v2 offset:28672
s_waitcnt lgkmcnt(3)
v_cvt_pk_bf16_f32 v12, v12, v14
buffer_store_dword v12, v10, s[8:11], s28 offen
v_smfmac_f32_16x16x64_bf16 v[56:59], v[28:31], v[40:47], v0
ds_read_b128 v[36:39], v2 offset:29696
v_add_f32 v16, v16, v17
v_add_f32 v18, v18, v19
v_smfmac_f32_16x16x64_bf16 v[60:63], v[24:27], a[200:207], v0
ds_read_b128 v[12:15], v3
s_waitcnt lgkmcnt(3)
v_cvt_pk_bf16_f32 v16, v16, v18
v_add_f32 v20, v20, v21
v_smfmac_f32_16x16x64_bf16 v[60:63], v[28:31], v[48:55], v0
ds_read_b128 v[40:43], v2 offset:30720
v_add_f32 v22, v22, v23
v_cvt_pk_bf16_f32 v17, v20, v22
v_smfmac_f32_16x16x64_bf16 v[64:67], v[24:27], a[208:215], v0
ds_read_b128 v[44:47], v2 offset:31744
s_waitcnt lgkmcnt(3)
buffer_store_dwordx2 v[16:17], v9, s[8:11], s28 offen
v_add_f32 v56, v56, v57
v_smfmac_f32_16x16x64_bf16 v[64:67], v[28:31], v[32:39], v0
ds_read_b128 v[48:51], v2 offset:32768
v_add_f32 v58, v58, v59
v_cvt_pk_bf16_f32 v56, v56, v58
v_smfmac_f32_16x16x64_bf16 v[68:71], v[24:27], a[216:223], v0
ds_read_b128 v[52:55], v2 offset:33792
s_waitcnt lgkmcnt(2)
v_add_f32 v60, v60, v61
v_add_f32 v62, v62, v63
v_smfmac_f32_16x16x64_bf16 v[68:71], v[28:31], v[40:47], v0
ds_read_b128 v[20:23], v3
v_cvt_pk_bf16_f32 v57, v60, v62
buffer_store_dwordx2 v[56:57], v9, s[8:11], s50 offen
v_smfmac_f32_16x16x64_bf16 v[12:15], v[24:27], a[224:231], v0
s_waitcnt lgkmcnt(1)
v_add_f32 v64, v64, v65
v_add_f32 v66, v66, v67
v_smfmac_f32_16x16x64_bf16 v[12:15], v[28:31], v[48:55], v0
s_waitcnt lgkmcnt(0)
v_cvt_pk_bf16_f32 v64, v64, v66
v_smfmac_f32_16x16x64_bf16 v[20:23], v[24:27], a[232:239], v0
v_add_f32 v68, v68, v69
v_add_f32 v70, v70, v71
v_smfmac_f32_16x16x64_bf16 v[20:23], v[28:31], a[240:247], v0
v_cvt_pk_bf16_f32 v65, v68, v70
buffer_store_dwordx2 v[64:65], v9, s[8:11], s51 offen
v_add_f32 v12, v12, v13
v_add_f32 v14, v14, v15
v_cvt_pk_bf16_f32 v12, v12, v14
s_nop 2
v_add_f32 v20, v20, v21
v_add_f32 v22, v22, v23
v_cvt_pk_bf16_f32 v13, v20, v22
buffer_store_dwordx2 v[12:13], v9, s[8:11], s52 offen
s_cmp_eq_u32 s48, 0
s_cbranch_scc1 L_nojob2
s_add_u32 s19, s19, 1
s_mov_b32 s20, s28
s_mov_b32 s28, s29
s_mov_b32 s29, s20
s_and_b32 s20, s19, 3
s_lshl_b32 s20, s20, 14
s_add_u32 s33, s20, 110100480
s_add_u32 s34, s20, s24
s_xor_b32 s20, s20, 32768
s_add_u32 s35, s20, s24
s_add_u32 s30, s30, 16384
s_add_u32 s31, s31, 131072
s_add_u32 s6, s33, 4096
s_add_u32 s7, s33, 8192
s_mov_b32 s22, 0
v_mov_b64 v[24:25], 0
v_mov_b64 v[26:27], 0
v_mov_b64 v[28:29], 0
v_mov_b64 v[30:31], 0
v_and_b32 v69, 0x380, v1
v_add_u32 v69, v69, v1
v_and_b32 v70, 0xf00, v1
v_add_u32 v70, v70, v1
v_mov_b64 v[64:65], -1
v_mov_b64 v[66:67], -1
v_xor_b32 v3, 16, v4
ds_read_b128 v[48:51], v2 offset:12288
ds_read_b128 v[52:55], v2 offset:13312
v_mov_b32 v56, 0x3f80
v_cndmask_b32 v56, v56, 1.0, s[44:45]
v_cndmask_b32 v60, 0, v56, s[36:37]
v_cndmask_b32 v61, 0, v56, s[38:39]
v_cndmask_b32 v62, 0, v56, s[40:41]
v_cndmask_b32 v63, 0, v56, s[42:43]
s_nop 5
buffer_load_dwordx4 v[32:35], v1, s[8:11], s49 offen offset:0 sc1
buffer_load_dwordx4 v[36:39], v1, s[8:11], s49 offen offset:1024 sc1
buffer_load_dwordx4 v[40:43], v1, s[8:11], s49 offen offset:2048 sc1
buffer_load_dwordx4 v[44:47], v1, s[8:11], s49 offen offset:3072 sc1
s_waitcnt vmcnt(3)
v_mfma_f32_16x16x32_bf16 v[56:59], v[32:35], v[60:63], 0
v_max3_u32 v16, v32, v33, v34
v_max_u32 v16, v16, v35
s_waitcnt vmcnt(2)
v_mfma_f32_16x16x32_bf16 v[56:59], v[36:39], v[60:63], v[56:59]
v_max3_u32 v16, v16, v36, v37
v_max3_u32 v16, v16, v38, v39
s_waitcnt vmcnt(1)
v_mfma_f32_16x16x32_bf16 v[56:59], v[40:43], v[60:63], v[56:59]
v_max3_u32 v16, v16, v40, v41
v_max3_u32 v16, v16, v42, v43
s_waitcnt vmcnt(0)
v_mfma_f32_16x16x32_bf16 v[56:59], v[44:47], v[60:63], v[56:59]
v_max3_u32 v16, v16, v44, v45
v_max3_u32 v16, v16, v46, v47
v_cmp_le_u32 vcc, 0xffff0000, v16
s_cbranch_vccnz L_red2
L_redb2:
s_nop 3
v_permlane32_swap_b32 v56, v58
v_permlane32_swap_b32 v57, v59
v_pk_add_f32 v[56:57], v[56:57], v[58:59]
v_cvt_pk_bf16_f32 v56, v56, v57
buffer_store_dword v56, v11, s[8:11], s34 offen
s_barrier
ds_read_b128 v[40:43], v2 offset:4096
ds_read_b128 v[44:47], v2 offset:5120
v_mov_b64 v[32:33], 0
v_mov_b64 v[34:35], 0
v_mov_b64 v[36:37], 0
v_mov_b64 v[38:39], 0
v_mov_b64 v[56:57], 0
v_mov_b64 v[58:59], 0
v_mov_b64 v[60:61], 0
v_mov_b64 v[62:63], 0
s_nop 15
s_nop 13
s_branch L_gat2
L_red2:
L_red2b:
buffer_load_dwordx4 v[32:35], v1, s[8:11], s49 offen offset:0 sc1
buffer_load_dwordx4 v[36:39], v1, s[8:11], s49 offen offset:1024 sc1
buffer_load_dwordx4 v[40:43], v1, s[8:11], s49 offen offset:2048 sc1
buffer_load_dwordx4 v[44:47], v1, s[8:11], s49 offen offset:3072 sc1
s_add_u32 s22, s22, 1
s_cmp_gt_u32 s22, 40000
s_cbranch_scc1 L_end
s_waitcnt vmcnt(3)
v_mfma_f32_16x16x32_bf16 v[56:59], v[32:35], v[60:63], 0
v_max3_u32 v16, v32, v33, v34
v_max_u32 v16, v16, v35
s_waitcnt vmcnt(2)
v_mfma_f32_16x16x32_bf16 v[56:59], v[36:39], v[60:63], v[56:59]
v_max3_u32 v16, v16, v36, v37
v_max3_u32 v16, v16, v38, v39
s_waitcnt vmcnt(1)
v_mfma_f32_16x16x32_bf16 v[56:59], v[40:43], v[60:63], v[56:59]
v_max3_u32 v16, v16, v40, v41
v_max3_u32 v16, v16, v42, v43
s_waitcnt vmcnt(0)
v_mfma_f32_16x16x32_bf16 v[56:59], v[44:47], v[60:63], v[56:59]
v_max3_u32 v16, v16, v44, v45
v_max3_u32 v16, v16, v46, v47
v_cmp_le_u32 vcc, 0xffff0000, v16
s_cbranch_vccz L_redb2
s_branch L_red2b
L_nojob2:
s_add_u32 s19, s19, 1
s_mov_b32 s20, s28
s_mov_b32 s28, s29
s_mov_b32 s29, s20
s_and_b32 s20, s19, 3
s_lshl_b32 s20, s20, 14
s_add_u32 s33, s20, 110100480
s_add_u32 s34, s20, s24
s_xor_b32 s20, s20, 32768
s_add_u32 s35, s20, s24
s_add_u32 s30, s30, 16384
s_add_u32 s31, s31, 131072
s_add_u32 s6, s33, 4096
s_add_u32 s7, s33, 8192
s_mov_b32 s22, 0
v_mov_b64 v[24:25], 0
v_mov_b64 v[26:27], 0
v_mov_b64 v[28:29], 0
v_mov_b64 v[30:31], 0
v_and_b32 v69, 0x380, v1
v_add_u32 v69, v69, v1
v_and_b32 v70, 0xf00, v1
v_add_u32 v70, v70, v1
v_mov_b64 v[64:65], -1
v_mov_b64 v[66:67], -1
v_xor_b32 v3, 16, v4
ds_read_b128 v[48:51], v2 offset:12288
ds_read_b128 v[52:55], v2 offset:13312
ds_read_b128 v[40:43], v2 offset:4096
ds_read_b128 v[44:47], v2 offset:5120
v_mov_b64 v[32:33], 0
v_mov_b64 v[34:35], 0
v_mov_b64 v[36:37], 0
v_mov_b64 v[38:39], 0
v_mov_b64 v[56:57], 0
v_mov_b64 v[58:59], 0
v_mov_b64 v[60:61], 0
v_mov_b64 v[62:63], 0
s_barrier
s_nop 15
s_nop 15
s_nop 7
s_branch L_gat2
L_ent3:
v_lshlrev_b32 v6, 3, v1
v_mov_b64 v[24:25], 0
v_mov_b64 v[26:27], 0
v_mov_b64 v[28:29], 0
v_mov_b64 v[30:31], 0
v_and_b32 v69, 0x380, v1
v_add_u32 v69, v69, v1
v_and_b32 v70, 0xf00, v1
v_add_u32 v70, v70, v1
v_mov_b64 v[64:65], -1
v_mov_b64 v[66:67], -1
v_xor_b32 v3, 16, v4
ds_read_b128 v[48:51], v2 offset:14336
ds_read_b128 v[52:55], v2 offset:15360
ds_read_b128 v[40:43], v2 offset:6144
ds_read_b128 v[44:47], v2 offset:7168
v_mov_b64 v[32:33], 0
v_mov_b64 v[34:35], 0
v_mov_b64 v[36:37], 0
v_mov_b64 v[38:39], 0
v_mov_b64 v[56:57], 0
v_mov_b64 v[58:59], 0
v_mov_b64 v[60:61], 0
v_mov_b64 v[62:63], 0
s_add_u32 s20, s30, 3072
s_add_u32 s21, s30, 8192
s_add_u32 s49, s29, s25
s_add_u32 s50, s29, s26
s_add_u32 s51, s29, s27
s_add_u32 s52, s30, 16384
s_mov_b32 m0, 22016
s_waitcnt vmcnt(0) lgkmcnt(0)
s_branch L_step3
L_gr3:
buffer_load_dwordx4 v[12:15], v1, s[8:11], s33 offen sc1
buffer_load_dword v20, v8, s[8:11], s7 offen sc1
buffer_load_dwordx4 v[16:19], v1, s[8:11], s6 offen sc1
s_add_u32 s22, s22, 1
s_cmp_gt_u32 s22, 40000
s_cbranch_scc1 L_end
s_nop 0
v_mov_b64 v[24:25], 0
v_mov_b64 v[26:27], 0
v_mov_b64 v[28:29], 0
v_mov_b64 v[30:31], 0
v_mov_b64 v[32:33], 0
v_mov_b64 v[34:35], 0
v_mov_b64 v[36:37], 0
v_mov_b64 v[38:39], 0
v_mov_b64 v[56:57], 0
v_mov_b64 v[58:59], 0
v_mov_b64 v[60:61], 0
v_mov_b64 v[62:63], 0
s_waitcnt lgkmcnt(0)
s_branch L_step3
.p2align 3
L_gat3:
buffer_load_dwordx4 v[12:15], v1, s[8:11], s33 offen sc1
buffer_load_dword v20, v8, s[8:11], s7 offen sc1
buffer_load_dwordx4 v[16:19], v1, s[8:11], s6 offen sc1
s_add_u32 s20, s30, 3072
s_add_u32 s21, s30, 8192
s_add_u32 s49, s29, s25
s_add_u32 s50, s29, s26
s_add_u32 s51, s29, s27
s_add_u32 s52, s30, 16384
s_mov_b32 m0, 22016
s_waitcnt lgkmcnt(0)
L_step3:
s_waitcnt vmcnt(2)
v_smfmac_f32_16x16x64_bf16 v[24:27], v[12:15], v[144:151], v0
ds_write_b128 v1, v[12:15] offset:6656
v_smfmac_f32_16x16x64_bf16 v[28:31], v[12:15], v[152:159], v0
s_waitcnt vmcnt(1)
ds_write_b32 v8, v20 offset:14848
v_smfmac_f32_16x16x64_bf16 v[32:35], v[12:15], v[160:167], v0
s_waitcnt vmcnt(0)
ds_write_b128 v1, v[16:19] offset:10752
v_smfmac_f32_16x16x64_bf16 v[56:59], v[12:15], a[80:87], v0
v_max3_u32 v21, v12, v13, v14
v_max3_u32 v21, v21, v15, v20
v_smfmac_f32_16x16x64_bf16 v[60:63], v[12:15], a[88:95], v0
v_max3_u32 v21, v21, v16, v17
v_max3_u32 v21, v21, v18, v19
v_smfmac_f32_16x16x64_bf16 v[36:39], v[12:15], v[40:47], v0
v_cmp_le_u32 vcc, 0xffff0000, v21
v_smfmac_f32_16x16x64_bf16 v[24:27], v[16:19], v[240:247], v0
s_cbranch_vccnz L_gr3
v_smfmac_f32_16x16x64_bf16 v[28:31], v[16:19], v[248:255], v0
s_waitcnt lgkmcnt(0)
s_barrier
ds_read_b128 v[20:23], v1 offset:3584
v_smfmac_f32_16x16x64_bf16 v[32:35], v[16:19], a[0:7], v0
ds_read_b128 v[12:15], v1 offset:4608
buffer_load_dwordx4 v69, s[8:11], s20 offen sc1 lds
v_smfmac_f32_16x16x64_bf16 v[56:59], v[16:19], a[144:151], v0
ds_read_b128 v[40:43], v2 offset:0
s_mov_b32 m0, 22912
v_smfmac_f32_16x16x64_bf16 v[60:63], v[16:19], a[152:159], v0
ds_read_b128 v[44:47], v2 offset:1024
v_smfmac_f32_16x16x64_bf16 v[36:39], v[16:19], v[48:55], v0
ds_read_b128 v[16:19], v1 offset:5632
s_waitcnt lgkmcnt(4)
v_smfmac_f32_16x16x64_bf16 v[24:27], v[20:23], v[72:79], v0
ds_read_b128 v[48:51], v2 offset:2048
buffer_load_dwordx4 v69, s[8:11], s20 offen offset:128 sc1 lds
v_smfmac_f32_16x16x64_bf16 v[28:31], v[20:23], v[80:87], v0
ds_read_b128 v[52:55], v2 offset:3072
s_mov_b32 m0, 6272
v_smfmac_f32_16x16x64_bf16 v[32:35], v[20:23], v[88:95], v0
s_waitcnt lgkmcnt(3)
v_smfmac_f32_16x16x64_bf16 v[36:39], v[20:23], v[40:47], v0
ds_read_b128 v[20:23], v1 offset:7680
v_smfmac_f32_16x16x64_bf16 v[24:27], v[12:15], v[96:103], v0
ds_read_b128 v[40:43], v2 offset:4096
v_smfmac_f32_16x16x64_bf16 v[28:31], v[12:15], v[104:111], v0
ds_read_b128 v[44:47], v2 offset:5120
v_smfmac_f32_16x16x64_bf16 v[32:35], v[12:15], v[112:119], v0
s_waitcnt lgkmcnt(3)
v_smfmac_f32_16x16x64_bf16 v[36:39], v[12:15], v[48:55], v0
ds_read_b128 v[12:15], v1 offset:8704
buffer_store_dwordx4 v[64:67], v1, s[8:11], s49 offen
v_smfmac_f32_16x16x64_bf16 v[24:27], v[16:19], v[120:127], v0
ds_read_b128 v[48:51], v2 offset:8192
v_smfmac_f32_16x16x64_bf16 v[28:31], v[16:19], v[128:135], v0
ds_read_b128 v[52:55], v2 offset:9216
v_smfmac_f32_16x16x64_bf16 v[32:35], v[16:19], v[136:143], v0
s_waitcnt lgkmcnt(3)
v_smfmac_f32_16x16x64_bf16 v[36:39], v[16:19], v[40:47], v0
ds_read_b128 v[16:19], v1 offset:9728
buffer_store_dwordx4 v[64:67], v1, s[8:11], s50 offen
v_smfmac_f32_16x16x64_bf16 v[24:27], v[20:23], v[168:175], v0
ds_read_b128 v[40:43], v2 offset:10240
v_smfmac_f32_16x16x64_bf16 v[28:31], v[20:23], v[176:183], v0
ds_read_b128 v[44:47], v2 offset:11264
v_smfmac_f32_16x16x64_bf16 v[32:35], v[20:23], v[184:191], v0
s_waitcnt lgkmcnt(3)
v_smfmac_f32_16x16x64_bf16 v[36:39], v[20:23], v[48:55], v0
ds_read_b128 v[20:23], v1 offset:11776
buffer_store_dwordx4 v[64:67], v1, s[8:11], s51 offen
v_smfmac_f32_16x16x64_bf16 v[24:27], v[12:15], v[192:199], v0
ds_read_b128 v[48:51], v2 offset:12288
buffer_load_dwordx4 v[64:67], v70, s[8:11], s21 offen sc1
v_smfmac_f32_16x16x64_bf16 v[28:31], v[12:15], v[200:207], v0
ds_read_b128 v[52:55], v2 offset:13312
v_smfmac_f32_16x16x64_bf16 v[32:35], v[12:15], v[208:215], v0
s_waitcnt lgkmcnt(3)
v_smfmac_f32_16x16x64_bf16 v[36:39], v[12:15], v[40:47], v0
ds_read_b128 v[12:15], v1 offset:3584
v_smfmac_f32_16x16x64_bf16 v[24:27], v[16:19], v[216:223], v0
ds_read_b128 v[40:43], v2 offset:16384
buffer_load_dwordx4 v[68:71], v70, s[8:11], s21 offen offset:256 sc1
v_smfmac_f32_16x16x64_bf16 v[28:31], v[16:19], v[224:231], v0
ds_read_b128 v[44:47], v2 offset:17408
v_smfmac_f32_16x16x64_bf16 v[32:35], v[16:19], v[232:239], v0
s_waitcnt lgkmcnt(3)
v_smfmac_f32_16x16x64_bf16 v[36:39], v[16:19], v[48:55], v0
ds_read_b128 v[16:19], v1 offset:4608
v_mov_b32 v11, s19
v_smfmac_f32_16x16x64_bf16 v[24:27], v[20:23], a[8:15], v0
v_smfmac_f32_16x16x64_bf16 v[28:31], v[20:23], a[16:23], v0
s_mov_b64 exec, 1
buffer_store_dword v11, v8, s[8:11], s83 offen sc1
s_mov_b64 exec, 0xff
buffer_load_dword v11, v8, s[8:11], s82 offen sc1
s_mov_b64 exec, -1
v_smfmac_f32_16x16x64_bf16 v[32:35], v[20:23], a[24:31], v0
s_waitcnt lgkmcnt(1)
v_smfmac_f32_16x16x64_bf16 v[36:39], v[20:23], v[40:47], v0
ds_read_b128 v[20:23], v1 offset:5632
v_smfmac_f32_16x16x64_bf16 v[56:59], v[12:15], a[32:39], v0
v_add_f32 v24, v24, v25
v_add_f32 v26, v26, v27
v_add_f32 v28, v28, v29
v_add_f32 v30, v30, v31
v_cvt_pk_bf16_f32 v24, v24, v28
v_cvt_pk_bf16_f32 v26, v26, v30
ds_write_b32 v4, v24 offset:2176
v_add_f32 v32, v32, v33
v_add_f32 v34, v34, v35
v_add_f32 v36, v36, v37
v_add_f32 v38, v38, v39
ds_write_b32 v3, v26 offset:2176
v_cvt_pk_bf16_f32 v32, v32, v36
v_cvt_pk_bf16_f32 v34, v34, v38
ds_write_b32 v4, v32
v_smfmac_f32_16x16x64_bf16 v[60:63], v[12:15], a[40:47], v0
ds_write_b32 v3, v34
s_waitcnt lgkmcnt(5)
v_smfmac_f32_16x16x64_bf16 v[56:59], v[16:19], a[48:55], v0
ds_read_b128 v[12:15], v1 offset:7680
v_smfmac_f32_16x16x64_bf16 v[60:63], v[16:19], a[56:63], v0
ds_read_b128 v[16:19], v1 offset:8704
s_waitcnt lgkmcnt(6)
v_smfmac_f32_16x16x64_bf16 v[56:59], v[20:23], a[64:71], v0
s_waitcnt lgkmcnt(2) vmcnt(7)
s_barrier
ds_read_b128 v[36:39], v5 offset:1536
v_smfmac_f32_16x16x64_bf16 v[60:63], v[20:23], a[72:79], v0
ds_read_b128 v[20:23], v1 offset:9728
s_waitcnt lgkmcnt(3)
v_smfmac_f32_16x16x64_bf16 v[56:59], v[12:15], a[96:103], v0
ds_read_b128 v[52:55], v1 offset:18944
v_smfmac_f32_16x16x64_bf16 v[60:63], v[12:15], a[104:111], v0
ds_read_b128 v[12:15], v1 offset:11776
s_waitcnt lgkmcnt(4)
v_smfmac_f32_16x16x64_bf16 v[56:59], v[16:19], a[112:119], v0
ds_read_b128 v[24:27], v5 offset:0
v_smfmac_f32_16x16x64_bf16 v[60:63], v[16:19], a[120:127], v0
ds_read_b128 v[40:43], v1 offset:12800
s_waitcnt lgkmcnt(4)
v_smfmac_f32_16x16x64_bf16 v[56:59], v[20:23], a[128:135], v0
ds_read_b128 v[28:31], v5 offset:512
v_smfmac_f32_16x16x64_bf16 v[60:63], v[20:23], a[136:143], v0
ds_read_b128 v[44:47], v1 offset:14848
s_waitcnt lgkmcnt(4)
v_smfmac_f32_16x16x64_bf16 v[56:59], v[12:15], a[160:167], v0
ds_read_b128 v[32:35], v5 offset:1024
v_smfmac_f32_16x16x64_bf16 v[60:63], v[12:15], a[168:175], v0
ds_read_b128 v[48:51], v1 offset:16896
s_mov_b64 exec, s[86:87]
buffer_store_dwordx4 v[36:39], v5, s[8:11], s31 offen offset:1536 sc1
s_mov_b64 exec, -1
v_mfma_f32_16x16x32_bf16 v[16:19], v[52:55], v[36:39], 0
ds_read_b128 v[52:55], v1 offset:19968
s_waitcnt lgkmcnt(5)
v_mfma_f32_16x16x32_bf16 v[16:19], v[40:43], v[24:27], v[16:19]
ds_read_b128 v[40:43], v1 offset:13824
s_waitcnt lgkmcnt(4)
v_mfma_f32_16x16x32_bf16 v[16:19], v[44:47], v[28:31], v[16:19]
ds_read_b128 v[44:47], v1 offset:15872
s_waitcnt lgkmcnt(3)
v_mfma_f32_16x16x32_bf16 v[16:19], v[48:51], v[32:35], v[16:19]
ds_read_b128 v[48:51], v1 offset:17920
v_mfma_f32_16x16x32_bf16 v[20:23], v[36:39], v[36:39], 0
v_add_f32 v56, v56, v57
v_add_f32 v58, v58, v59
v_mfma_f32_16x16x32_bf16 v[20:23], v[24:27], v[24:27], v[20:23]
v_add_f32 v60, v60, v61
v_add_f32 v62, v62, v63
v_mfma_f32_16x16x32_bf16 v[20:23], v[28:31], v[28:31], v[20:23]
v_cvt_pk_bf16_f32 v56, v56, v58
v_cvt_pk_bf16_f32 v57, v60, v62
v_mfma_f32_16x16x32_bf16 v[20:23], v[32:35], v[32:35], v[20:23]
v_lshrrev_b32 v58, 1, v1
v_max3_f32 v59, v16, v17, v18
s_waitcnt lgkmcnt(3)
v_mfma_f32_16x16x32_bf16 v[12:15], v[52:55], v[36:39], 0
ds_read_b128 v[52:55], v2 offset:21504
s_waitcnt lgkmcnt(3)
v_mfma_f32_16x16x32_bf16 v[12:15], v[40:43], v[24:27], v[12:15]
ds_read_b128 v[40:43], v2 offset:18432
s_waitcnt lgkmcnt(3)
v_mfma_f32_16x16x32_bf16 v[12:15], v[44:47], v[28:31], v[12:15]
ds_read_b128 v[44:47], v2 offset:19456
v_max3_f32 v59, v59, v19, v20
v_max_f32 v59, v59, v21
s_waitcnt lgkmcnt(3)
v_mfma_f32_16x16x32_bf16 v[12:15], v[48:51], v[32:35], v[12:15]
ds_read_b128 v[48:51], v2 offset:20480
buffer_store_dwordx2 v[56:57], v58, s[8:11], s31 offen offset:2048 sc1
v_mov_b32 v60, s53
s_add_u32 s49, s28, s23
v_mov_b32 v61, s53
s_add_u32 s50, s28, 65536
v_mov_b32 v62, s53
ds_read_b128 v[32:35], v2 offset:22528
v_mov_b32 v63, s53
v_max3_f32 v59, v59, v12, v13
v_max3_f32 v22, v59, v14, v15
v_max3_f32 v59, v59, v14, v15
s_add_u32 s51, s28, 131072
s_add_u32 s52, s28, 196608
v_permlane32_swap_b32 v22, v59
v_max_f32 v23, v59, v22
v_max_f32 v59, v59, v22
v_mov_b32 v22, 0
ds_read_b128 v[36:39], v2 offset:23552
v_permlane16_swap_b32 v23, v59
v_max_f32 v59, v59, v23
v_mul_f32 v58, s18, v59
v_pk_fma_f32 v[20:21], v[20:21], s[18:19], v[58:59] op_sel_hi:[1,0,0] neg_lo:[0,0,1] neg_hi:[0,0,1]
v_pk_fma_f32 v[16:17], v[16:17], s[18:19], v[58:59] op_sel_hi:[1,0,0] neg_lo:[0,0,1] neg_hi:[0,0,1]
v_pk_fma_f32 v[18:19], v[18:19], s[18:19], v[58:59] op_sel_hi:[1,0,0] neg_lo:[0,0,1] neg_hi:[0,0,1]
v_pk_fma_f32 v[12:13], v[12:13], s[18:19], v[58:59] op_sel_hi:[1,0,0] neg_lo:[0,0,1] neg_hi:[0,0,1]
v_pk_fma_f32 v[14:15], v[14:15], s[18:19], v[58:59] op_sel_hi:[1,0,0] neg_lo:[0,0,1] neg_hi:[0,0,1]
v_exp_f32 v20, v20
v_exp_f32 v21, v21
v_exp_f32 v16, v16
v_cvt_pk_bf16_f32 v23, v20, v21
v_cvt_pk_bf16_f32 v20, v20, v21
v_mov_b32 v21, 0
v_exp_f32 v17, v17
v_exp_f32 v18, v18
v_mfma_f32_16x16x16_bf16 v[24:27], v[56:57], v[20:21], 0
v_exp_f32 v19, v19
v_mfma_f32_16x16x16_bf16 v[28:31], v[56:57], v[22:23], 0
v_exp_f32 v12, v12
v_exp_f32 v13, v13
v_cvt_pk_bf16_f32 v16, v16, v17
v_cvt_pk_bf16_f32 v17, v18, v19
v_exp_f32 v14, v14
v_exp_f32 v15, v15
v_cvt_pk_bf16_f32 v18, v12, v13
v_cvt_pk_bf16_f32 v19, v14, v15
v_mfma_f32_16x16x16_bf16 v[12:15], v[60:61], v[20:21], 0
s_waitcnt vmcnt(4)
v_mfma_f32_16x16x32_bf16 v[12:15], v[60:63], v[16:19], v[12:15]
v_mov_b32 v20, 0
v_mov_b32 v23, 0
v_mfma_f32_16x16x32_bf16 v[24:27], v[64:67], v[16:19], v[24:27]
s_nop 1
v_mfma_f32_16x16x32_bf16 v[28:31], v[68:71], v[16:19], v[28:31]
v_mov_b32 v16, 0
v_mov_b32 v17, 0
v_rcp_f32 v12, v12
v_mov_b32 v18, 0
v_mov_b32 v19, 0
v_pk_mul_f32 v[24:25], v[24:25], v[12:13] op_sel_hi:[1,0]
v_pk_mul_f32 v[26:27], v[26:27], v[12:13] op_sel_hi:[1,0]
v_mov_b32 v15, 0
v_pk_mul_f32 v[28:29], v[28:29], v[12:13] op_sel_hi:[1,0]
v_pk_mul_f32 v[30:31], v[30:31], v[12:13] op_sel_hi:[1,0]
v_cvt_pk_bf16_f32 v24, v24, v28
v_cvt_pk_bf16_f32 v25, v25, v29
v_cvt_pk_bf16_f32 v26, v26, v30
v_cvt_pk_bf16_f32 v27, v27, v31
v_mfma_f32_16x16x32_bf16 v[56:59], v[20:23], v[20:23], 0
ds_write_b128 v7, v[24:27]
v_mfma_f32_16x16x32_bf16 v[60:63], v[20:23], v[20:23], 0
v_mov_b32 v12, 0
v_mov_b32 v13, 0
v_mov_b32 v14, 0
v_mov_b32 v3, 6528
s_nop 1
v_mfma_f32_16x16x32_bf16 v[64:67], v[20:23], v[20:23], 0
s_cmp_eq_u32 s19, 63
s_cbranch_scc1 L_texit
s_waitcnt lgkmcnt(0)
s_barrier
ds_read_b128 v[24:27], v1 offset:1152
v_mfma_f32_16x16x32_bf16 v[68:71], v[20:23], v[20:23], 0
ds_read_b128 v[28:31], v1 offset:2176
s_nop 2
v_mfma_f32_16x16x32_bf16 v[68:71], v[20:23], v[20:23], 0
s_waitcnt lgkmcnt(1)
v_smfmac_f32_16x16x64_bf16 v[12:15], v[24:27], a[248:255], v0
v_smfmac_f32_16x16x64_bf16 v[16:19], v[24:27], a[176:183], v0
s_waitcnt lgkmcnt(0)
v_smfmac_f32_16x16x64_bf16 v[12:15], v[28:31], v[40:47], v0
ds_read_b128 v[40:43], v2 offset:24576
v_smfmac_f32_16x16x64_bf16 v[16:19], v[28:31], v[48:55], v0
ds_read_b128 v[44:47], v2 offset:25600
v_smfmac_f32_16x16x64_bf16 v[20:23], v[24:27], a[184:191], v0
ds_read_b128 v[48:51], v2 offset:26624
v_smfmac_f32_16x16x64_bf16 v[20:23], v[28:31], v[32:39], v0
ds_read_b128 v[52:55], v2 offset:27648
s_nop 0
v_add_f32 v12, v12, v13
v_add_f32 v14, v14, v15
v_smfmac_f32_16x16x64_bf16 v[56:59], v[24:27], a[192:199], v0
ds_read_b128 v[32:35], v2 offset:28672
s_waitcnt lgkmcnt(3)
v_cvt_pk_bf16_f32 v12, v12, v14
buffer_store_dword v12, v10, s[8:11], s28 offen
v_smfmac_f32_16x16x64_bf16 v[56:59], v[28:31], v[40:47], v0
ds_read_b128 v[36:39], v2 offset:29696
v_add_f32 v16, v16, v17
v_add_f32 v18, v18, v19
v_smfmac_f32_16x16x64_bf16 v[60:63], v[24:27], a[200:207], v0
ds_read_b128 v[12:15], v3
s_waitcnt lgkmcnt(3)
v_cvt_pk_bf16_f32 v16, v16, v18
v_add_f32 v20, v20, v21
v_smfmac_f32_16x16x64_bf16 v[60:63], v[28:31], v[48:55], v0
ds_read_b128 v[40:43], v2 offset:30720
v_add_f32 v22, v22, v23
v_cvt_pk_bf16_f32 v17, v20, v22
v_smfmac_f32_16x16x64_bf16 v[64:67], v[24:27], a[208:215], v0
ds_read_b128 v[44:47], v2 offset:31744
s_waitcnt lgkmcnt(3)
buffer_store_dwordx2 v[16:17], v9, s[8:11], s28 offen
v_add_f32 v56, v56, v57
v_smfmac_f32_16x16x64_bf16 v[64:67], v[28:31], v[32:39], v0
ds_read_b128 v[48:51], v2 offset:32768
v_add_f32 v58, v58, v59
v_cvt_pk_bf16_f32 v56, v56, v58
v_smfmac_f32_16x16x64_bf16 v[68:71], v[24:27], a[216:223], v0
ds_read_b128 v[52:55], v2 offset:33792
s_waitcnt lgkmcnt(2)
v_add_f32 v60, v60, v61
v_add_f32 v62, v62, v63
v_smfmac_f32_16x16x64_bf16 v[68:71], v[28:31], v[40:47], v0
ds_read_b128 v[20:23], v3
v_cvt_pk_bf16_f32 v57, v60, v62
buffer_store_dwordx2 v[56:57], v9, s[8:11], s50 offen
v_smfmac_f32_16x16x64_bf16 v[12:15], v[24:27], a[224:231], v0
s_waitcnt lgkmcnt(1)
v_add_f32 v64, v64, v65
v_add_f32 v66, v66, v67
v_smfmac_f32_16x16x64_bf16 v[12:15], v[28:31], v[48:55], v0
s_waitcnt lgkmcnt(0)
v_cvt_pk_bf16_f32 v64, v64, v66
v_smfmac_f32_16x16x64_bf16 v[20:23], v[24:27], a[232:239], v0
v_add_f32 v68, v68, v69
v_add_f32 v70, v70, v71
v_smfmac_f32_16x16x64_bf16 v[20:23], v[28:31], a[240:247], v0
v_cvt_pk_bf16_f32 v65, v68, v70
buffer_store_dwordx2 v[64:65], v9, s[8:11], s51 offen
v_add_f32 v12, v12, v13
v_add_f32 v14, v14, v15
v_cvt_pk_bf16_f32 v12, v12, v14
s_nop 2
v_add_f32 v20, v20, v21
v_add_f32 v22, v22, v23
v_cvt_pk_bf16_f32 v13, v20, v22
buffer_store_dwordx2 v[12:13], v9, s[8:11], s52 offen
s_add_u32 s19, s19, 1
s_mov_b32 s20, s28
s_mov_b32 s28, s29
s_mov_b32 s29, s20
s_and_b32 s20, s19, 3
s_lshl_b32 s20, s20, 14
s_add_u32 s33, s20, 110100480
s_add_u32 s34, s20, s24
s_xor_b32 s20, s20, 32768
s_add_u32 s35, s20, s24
s_add_u32 s30, s30, 16384
s_add_u32 s31, s31, 131072
s_add_u32 s6, s33, 4096
s_add_u32 s7, s33, 8192
s_mov_b32 s22, 0
v_mov_b64 v[24:25], 0
v_mov_b64 v[26:27], 0
v_mov_b64 v[28:29], 0
v_mov_b64 v[30:31], 0
v_and_b32 v69, 0x380, v1
v_add_u32 v69, v69, v1
v_and_b32 v70, 0xf00, v1
v_add_u32 v70, v70, v1
v_mov_b64 v[64:65], -1
v_mov_b64 v[66:67], -1
v_xor_b32 v3, 16, v4
ds_read_b128 v[48:51], v2 offset:14336
ds_read_b128 v[52:55], v2 offset:15360
ds_read_b128 v[40:43], v2 offset:6144
ds_read_b128 v[44:47], v2 offset:7168
v_mov_b64 v[32:33], 0
v_mov_b64 v[34:35], 0
v_mov_b64 v[36:37], 0
v_mov_b64 v[38:39], 0
v_mov_b64 v[56:57], 0
v_mov_b64 v[58:59], 0
v_mov_b64 v[60:61], 0
v_mov_b64 v[62:63], 0
s_add_u32 s20, s19, 1
s_lshr_b32 s20, s20, 3
s_min_u32 s20, s20, 7
s_waitcnt vmcnt(7)
L_kvw:
v_readlane_b32 s21, v11, s20
s_nop 0
s_cmp_eq_u32 s21, 1
s_cbranch_scc0 L_kvp
s_barrier
s_nop 15
s_nop 15
s_nop 7
s_branch L_gat3
L_kvp:
s_mov_b64 exec, 0xff
buffer_load_dword v11, v8, s[8:11], s82 offen sc1
s_mov_b64 exec, -1
s_add_u32 s22, s22, 1
s_cmp_gt_u32 s22, 40000
s_cbranch_scc1 L_end
s_waitcnt vmcnt(0)
s_branch L_kvw
L_texit:
s_lshl_b32 s61, s16, 7
s_add_u32 s61, s61, 111153152
s_waitcnt vmcnt(0)
s_barrier
s_cmp_lg_u32 s17, 0
s_cbranch_scc1 L_sf_45
v_mov_b32 v20, 0
v_mov_b32 v21, 64
s_mov_b64 exec, 1
buffer_store_dword v21, v20, s[8:11], s61 offen sc1
s_mov_b64 exec, -1
L_sf_45:
L_done:
L_end:
s_endpgm
.section .rodata,"a"
.p2align 6
.amdhsa_kernel concat_heads__compressed_kv_cla__memory_aug_recurrent_mem_tr__prompt_kernel
  .amdhsa_next_free_vgpr 512
  .amdhsa_next_free_sgpr 102
  .amdhsa_accum_offset 256
  .amdhsa_group_segment_fixed_size 0
  .amdhsa_kernarg_size 128
  .amdhsa_user_sgpr_count 2
  .amdhsa_user_sgpr_kernarg_segment_ptr 1
  .amdhsa_system_sgpr_workgroup_id_x 1
.end_amdhsa_kernel
```

```asm
; @launch grid=(256,1,1) block=(256,1,1) lds=163840
.amdgcn_target "amdgcn-amd-amdhsa--gfx950"
.text
.globl concat_heads__compressed_kv_cla__memory_aug_recurrent_mem_tr__prompt_kernel
.p2align 8
.type concat_heads__compressed_kv_cla__memory_aug_recurrent_mem_tr__prompt_kernel,@function
concat_heads__compressed_kv_cla__memory_aug_recurrent_mem_tr__prompt_kernel:
s_cmp_ge_u32 s2, 256
s_cbranch_scc1 L_end
s_getreg_b32 s3, hwreg(HW_REG_XCC_ID)
s_and_b32 s3, s3, 7
s_load_dwordx2 s[4:5], s[0:1], 120
s_load_dwordx2 s[6:7], s[0:1], 112
v_lshrrev_b32 v1, 6, v0
s_nop 0
v_readfirstlane_b32 s17, v1
s_waitcnt lgkmcnt(0)
s_mov_b32 s8, s4
s_and_b32 s9, s5, 0xffff
s_mov_b32 s10, 268435456
s_mov_b32 s11, 0x20000
s_mov_b32 s56, s6
s_and_b32 s57, s7, 0xffff
s_mov_b32 s58, 256
s_mov_b32 s59, 0x20000
s_lshl_b32 s24, s3, 2
s_cmp_eq_u32 s17, 0
s_cbranch_scc0 L_tk
s_mov_b64 exec, 1
v_mov_b32 v1, 1
v_mov_b32 v2, 0
buffer_atomic_add v1, v2, s[56:59], s24 offen sc0
s_waitcnt vmcnt(0)
ds_write_b32 v2, v1
s_waitcnt lgkmcnt(0)
s_mov_b64 exec, -1
L_tk:
s_barrier
v_mov_b32 v2, 0
ds_read_b32 v1, v2
s_lshr_b32 s3, 0x76530142, s24
s_and_b32 s3, s3, 7
s_waitcnt lgkmcnt(0)
v_readfirstlane_b32 s16, v1
s_barrier
s_cmp_ge_u32 s16, 32
s_cbranch_scc1 L_end
s_cmp_eq_u32 s3, 0
s_cbranch_scc1 L_team
s_cmp_eq_u32 s3, 1
s_cbranch_scc0 L_np
s_cmp_lt_u32 s16, 24
s_cbranch_scc1 L_np
v_lshlrev_b32 v1, 4, v0
v_mov_b64 v[4:5], 0
v_mov_b64 v[6:7], 0
s_sub_u32 s24, s16, 24
s_lshl_b32 s24, s24, 12
s_add_u32 s24, s24, 111149056
buffer_store_dwordx4 v[4:7], v1, s[8:11], s24 offen sc1
s_waitcnt vmcnt(0)
s_barrier
s_cmp_lg_u32 s17, 0
s_cbranch_scc1 L_np
v_mov_b32 v1, 1
v_mov_b32 v2, 128
s_mov_b64 exec, 1
buffer_atomic_add v1, v2, s[56:59], 0 offen
s_mov_b64 exec, -1
L_np:
s_cmp_lt_u32 s3, 4
s_cselect_b32 s61, 1, 0
s_cbranch_scc1 L_pb
s_load_dwordx2 s[52:53], s[0:1], 8
s_load_dwordx2 s[54:55], s[0:1], 0
s_load_dwordx2 s[6:7], s[0:1], 24
s_load_dwordx2 s[4:5], s[0:1], 32
s_load_dwordx2 s[18:19], s[0:1], 16
s_mov_b32 s45, 3
s_branch L_pg
L_pb:
s_load_dwordx2 s[52:53], s[0:1], 48
s_load_dwordx2 s[54:55], s[0:1], 48
s_load_dwordx2 s[6:7], s[0:1], 72
s_load_dwordx2 s[4:5], s[0:1], 80
s_load_dwordx2 s[18:19], s[0:1], 64
s_mov_b32 s45, 6
s_bitcmp1_b32 s16, 1
s_cselect_b32 s45, 5, 6
s_cmp_eq_u32 s3, 1
s_cselect_b32 s45, 1, s45
L_pg:
s_waitcnt lgkmcnt(0)
s_cmp_ge_u32 s17, 2
s_cselect_b64 s[6:7], s[4:5], s[6:7]
s_sub_u32 s24, s3, 1
s_lshl_b32 s24, s24, 5
s_add_u32 s24, s24, s16
s_cmp_ge_u32 s24, 16
s_cbranch_scc1 L_pf_1
s_load_dwordx2 s[4:5], s[0:1], 8
s_sub_u32 s100, s24, 0
s_lshl_b32 s100, s100, 16
s_add_u32 s100, s100, 1048576
s_mov_b32 s98, 2097152
s_branch L_pfd
L_pf_1:
s_cmp_ge_u32 s24, 43
s_cbranch_scc1 L_pf_2
s_load_dwordx2 s[4:5], s[0:1], 48
s_sub_u32 s100, s24, 16
s_lshl_b32 s100, s100, 16
s_add_u32 s100, s100, 589824
s_mov_b32 s98, 2359296
s_branch L_pfd
L_pf_2:
s_cmp_ge_u32 s24, 79
s_cbranch_scc1 L_pf_3
s_load_dwordx2 s[4:5], s[0:1], 0
s_sub_u32 s100, s24, 43
s_lshl_b32 s100, s100, 16
s_add_u32 s100, s100, 0
s_mov_b32 s98, 2359296
s_branch L_pfd
L_pf_3:
s_cmp_ge_u32 s24, 151
s_cbranch_scc1 L_pf_4
s_load_dwordx2 s[4:5], s[0:1], 16
s_sub_u32 s100, s24, 79
s_lshl_b32 s100, s100, 16
s_add_u32 s100, s100, 0
s_mov_b32 s98, 4718592
s_branch L_pfd
L_pf_4:
s_load_dwordx2 s[4:5], s[0:1], 40
s_sub_u32 s100, s24, 151
s_lshl_b32 s100, s100, 16
s_add_u32 s100, s100, 0
s_mov_b32 s98, 4718592
s_branch L_pfd
L_pf_5:
L_pfd:
s_waitcnt lgkmcnt(0)
s_mov_b32 s96, s4
s_and_b32 s97, s5, 0xffff
s_mov_b32 s99, 0x20000
v_lshlrev_b32 v23, 5, v0
s_cmp_eq_u32 s61, 0
s_cselect_b32 s94, 0x3e0293ee, 1.0
v_bfe_u32 v19, v0, 4, 2
v_bfe_u32 v18, v0, 2, 2
v_xor_b32 v18, v18, v19
v_lshlrev_b32 v18, 6, v18
v_and_b32 v20, 3, v0
v_lshl_add_u32 v18, v20, 4, v18
v_lshl_add_u32 v18, v19, 13, v18
s_and_b32 s24, s17, 1
s_lshl_b32 s25, s24, 17
v_add_u32 v5, s25, v18
v_add_u32 v6, 31744, v5
v_add_u32 v7, 63488, v5
v_add_u32 v8, 95232, v5
s_lshl_b32 s33, s17, 12
s_lshl_b32 s32, s17, 10
s_add_u32 s32, s32, 65536
v_and_b32 v18, 31, v0
v_lshlrev_b32 v18, 7, v18
v_bfe_u32 v19, v0, 1, 3
v_bfe_u32 v20, v0, 5, 1
v_xor_b32 v19, v19, v20
v_lshl_add_u32 v18, v19, 4, v18
s_lshl_b32 s24, s24, 14
s_add_u32 s24, s24, 65536
v_add_u32 v9, s24, v18
v_xor_b32 v10, 32, v9
v_xor_b32 v11, 64, v9
v_xor_b32 v12, 96, v9
v_bfe_u32 v19, v0, 2, 2
v_mul_u32_u24 v18, 320, v19
v_lshl_add_u32 v18, v20, 11, v18
v_bfe_u32 v19, v0, 4, 1
v_lshl_add_u32 v18, v19, 5, v18
v_and_b32 v19, 3, v0
v_lshl_add_u32 v18, v19, 3, v18
s_lshr_b32 s24, s17, 1
s_lshl_b32 s24, s24, 13
v_add_u32 v13, s24, v18
v_xor_b32 v14, 64, v13
v_xor_b32 v15, 128, v13
v_xor_b32 v16, 192, v13
s_mov_b32 s35, 0
s_cmp_eq_u32 s61, 0
s_cbranch_scc1 L_px_6
s_lshl_b32 s24, s35, 2
s_lshr_b32 s26, 0xe64a20, s24
s_bfe_u32 s2, s26, 0x10003
s_and_b32 s26, s26, 7
s_add_u32 s24, s2, 1
s_sub_u32 s27, s3, 2
s_cmp_eq_u32 s3, 1
s_cbranch_scc0 L_px_8
s_mov_b32 s2, 1
s_mov_b32 s27, 0
s_branch L_px_8
L_px_6:
s_cmp_eq_u32 s35, 2
s_cselect_b32 s2, 1, 0
s_and_b32 s26, s35, 1
s_lshl_b32 s26, s26, 2
s_add_u32 s24, s2, 2
s_sub_u32 s27, s3, 4
L_px_8:
s_lshl_b32 s27, s27, 5
s_add_u32 s27, s27, s16
s_bfm_b32 s25, s24, 0
s_and_b32 s25, s25, s16
s_add_u32 s26, s26, s25
s_lshr_b32 s27, s27, s24
s_or_b32 s40, s2, s61
s_lshr_b32 s24, s17, 1
s_cmp_eq_u32 s2, 0
s_cselect_b32 s41, s24, 0
s_cselect_b64 s[4:5], s[52:53], s[54:55]
s_cselect_b32 s25, 0, s24
s_and_b32 s51, s41, s61
s_lshl_b32 s46, s27, s2
s_add_u32 s46, s46, s25
s_lshl_b32 s46, s46, 8
s_lshl_b32 s47, s40, 7
s_add_u32 s47, s47, 1024
s_mov_b32 s12, s4
s_and_b32 s13, s5, 0xffff
s_lshl_b32 s14, s47, 11
s_mov_b32 s15, 0x20000
s_mul_i32 s30, s26, s47
s_lshl_b32 s30, s30, 8
s_lshl_b32 s42, s27, 3
s_add_u32 s42, s42, s26
s_lshl_b32 s42, s42, 1
s_and_b32 s25, s17, 1
s_add_u32 s42, s42, s25
s_lshl_b32 s42, s42, 3
s_add_u32 s42, s42, s24
s_lshl_b32 s42, s42, 13
s_lshl_b32 s43, s27, 5
s_add_u32 s43, s43, s26
s_lshl_b32 s43, s43, 2
s_lshl_b32 s24, s2, 1
s_add_u32 s24, s24, s61
s_lshl_b32 s24, s24, 2
s_lshr_b32 s25, 0x8720, s24
s_and_b32 s25, s25, 15
s_lshl_b32 s25, s25, 24
s_add_u32 s42, s42, s25
s_lshr_b32 s25, 0x7604, s24
s_and_b32 s25, s25, 15
s_lshl_b32 s25, s25, 12
s_add_u32 s43, s43, s25
s_add_u32 s43, s43, 111149056
s_mov_b32 s44, 1
s_cmp_lt_u32 s35, s45
s_cselect_b32 s30, s30, 536870912
s_cselect_b32 s46, s46, 536870912
v_lshrrev_b32 v18, 3, v0
v_mul_lo_u32 v18, v18, s47
v_bfe_u32 v19, v0, 4, 3
v_and_b32 v20, 7, v0
v_xor_b32 v20, v20, v19
v_lshl_add_u32 v1, v20, 4, v18
s_lshl_b32 s24, s47, 5
s_lshl_b32 s34, s47, 7
v_add_u32 v2, s24, v1
v_add_u32 v3, s24, v2
v_add_u32 v4, s24, v3
s_cmp_eq_u32 s2, 0
s_cselect_b64 s[4:5], s[6:7], s[18:19]
s_mov_b32 s20, s4
s_and_b32 s21, s5, 0xffff
s_lshl_b32 s22, s47, 12
s_mov_b32 s23, 0x20000
s_mov_b32 s31, s46
s_add_u32 m0, s32, 0
s_mov_b32 s48, s30
buffer_load_dwordx4 v1, s[12:15], s48 offen lds
s_add_u32 m0, s32, 4096
s_nop 0
buffer_load_dwordx4 v2, s[12:15], s48 offen lds
s_add_u32 m0, s32, 8192
s_nop 0
buffer_load_dwordx4 v3, s[12:15], s48 offen lds
s_add_u32 m0, s32, 12288
s_nop 0
buffer_load_dwordx4 v4, s[12:15], s48 offen lds
s_add_u32 m0, s32, 16384
s_add_u32 s48, s30, s34
buffer_load_dwordx4 v1, s[12:15], s48 offen lds
s_add_u32 m0, s32, 20480
s_nop 0
buffer_load_dwordx4 v2, s[12:15], s48 offen lds
s_add_u32 m0, s32, 24576
s_nop 0
buffer_load_dwordx4 v3, s[12:15], s48 offen lds
s_add_u32 m0, s32, 28672
s_nop 0
buffer_load_dwordx4 v4, s[12:15], s48 offen lds
s_add_u32 s30, s30, 128
s_add_u32 s32, s32, 32768
s_sub_u32 s24, s32, 98304
s_cmp_ge_u32 s32, 163840
s_cselect_b32 s32, s24, s32
s_mov_b32 m0, s33
s_nop 0
buffer_load_dwordx4 v5, s[20:23], s31 offen offset:0 lds
buffer_load_dwordx4 v6, s[20:23], s31 offen offset:1024 lds
buffer_load_dwordx4 v7, s[20:23], s31 offen offset:2048 lds
buffer_load_dwordx4 v8, s[20:23], s31 offen offset:3072 lds
s_add_u32 s31, s31, 262144
s_add_u32 s33, s33, 16384
s_and_b32 s33, s33, 65535
s_mov_b32 m0, s33
s_nop 0
buffer_load_dwordx4 v5, s[20:23], s31 offen offset:0 lds
buffer_load_dwordx4 v6, s[20:23], s31 offen offset:1024 lds
buffer_load_dwordx4 v7, s[20:23], s31 offen offset:2048 lds
buffer_load_dwordx4 v8, s[20:23], s31 offen offset:3072 lds
s_add_u32 s31, s31, 262144
s_add_u32 s33, s33, 16384
s_and_b32 s33, s33, 65535
s_add_u32 m0, s32, 0
s_mov_b32 s48, s30
buffer_load_dwordx4 v1, s[12:15], s48 offen lds
s_add_u32 m0, s32, 4096
s_nop 0
buffer_load_dwordx4 v2, s[12:15], s48 offen lds
s_add_u32 m0, s32, 8192
s_nop 0
buffer_load_dwordx4 v3, s[12:15], s48 offen lds
s_add_u32 m0, s32, 12288
s_nop 0
buffer_load_dwordx4 v4, s[12:15], s48 offen lds
s_mov_b32 m0, s33
s_nop 0
buffer_load_dwordx4 v5, s[20:23], s31 offen offset:0 lds
buffer_load_dwordx4 v6, s[20:23], s31 offen offset:1024 lds
buffer_load_dwordx4 v7, s[20:23], s31 offen offset:2048 lds
buffer_load_dwordx4 v8, s[20:23], s31 offen offset:3072 lds
s_add_u32 s31, s31, 262144
s_add_u32 s33, s33, 16384
s_and_b32 s33, s33, 65535
s_add_u32 m0, s32, 16384
s_add_u32 s48, s30, s34
buffer_load_dwordx4 v1, s[12:15], s48 offen lds
s_add_u32 m0, s32, 20480
s_nop 0
buffer_load_dwordx4 v2, s[12:15], s48 offen lds
s_add_u32 m0, s32, 24576
s_nop 0
buffer_load_dwordx4 v3, s[12:15], s48 offen lds
s_add_u32 m0, s32, 28672
s_nop 0
buffer_load_dwordx4 v4, s[12:15], s48 offen lds
s_add_u32 s30, s30, 128
s_add_u32 s32, s32, 32768
s_sub_u32 s24, s32, 98304
s_cmp_ge_u32 s32, 163840
s_cselect_b32 s32, s24, s32
s_mov_b32 m0, s33
s_nop 0
buffer_load_dwordx4 v5, s[20:23], s31 offen offset:0 lds
buffer_load_dwordx4 v6, s[20:23], s31 offen offset:1024 lds
buffer_load_dwordx4 v7, s[20:23], s31 offen offset:2048 lds
buffer_load_dwordx4 v8, s[20:23], s31 offen offset:3072 lds
s_add_u32 s31, s31, 262144
s_add_u32 s33, s33, 16384
s_and_b32 s33, s33, 65535
s_mov_b32 s62, 536870912
s_mov_b32 s63, 536870912
s_mov_b32 s60, 0
s_mov_b32 s50, 0
s_waitcnt vmcnt(20)
s_barrier
ds_read_b64_tr_b16 a[176:177], v13 offset:0
ds_read_b64_tr_b16 a[178:179], v13 offset:1024
ds_read_b128 a[160:163], v9 offset:0
ds_read_b128 a[164:167], v9 offset:4096
ds_read_b128 a[168:171], v9 offset:8192
ds_read_b128 a[172:175], v9 offset:12288
ds_read_b64_tr_b16 a[180:181], v14 offset:0
ds_read_b64_tr_b16 a[182:183], v14 offset:1024
ds_read_b64_tr_b16 a[184:185], v15 offset:0
ds_read_b64_tr_b16 a[186:187], v15 offset:1024
ds_read_b64_tr_b16 a[188:189], v16 offset:0
ds_read_b64_tr_b16 a[190:191], v16 offset:1024
L_g_tile:
s_mov_b32 s38, s62
s_mov_b32 s39, s63
s_mov_b32 s29, s60
s_mov_b32 s49, s50
s_mov_b32 s62, s42
s_mov_b32 s63, s43
s_mov_b32 s60, s44
s_mov_b32 s50, s51
s_mov_b32 s36, s40
s_add_u32 s35, s35, 1
s_cmp_eq_u32 s35, 2
s_cbranch_scc1 L_g_first
L_g_go:
s_cmp_eq_u32 s41, 0
s_cbranch_scc0 L_g_v
.p2align 3
L_g_k:
s_waitcnt lgkmcnt(0)
v_mfma_f32_32x32x16_bf16 v[160:175], a[176:179], a[160:163], 0
ds_read_b64_tr_b16 a[208:209], v13 offset:4096
s_add_u32 m0, s32, 0
s_mov_b32 s48, s30
v_accvgpr_read_b32 v24, a72
v_accvgpr_read_b32 v25, a73
v_cvt_pk_bf16_f32 v116, v24, v25
v_accvgpr_read_b32 v26, a74
v_accvgpr_read_b32 v27, a75
v_cvt_pk_bf16_f32 v117, v26, v27
v_accvgpr_read_b32 v28, a76
v_accvgpr_read_b32 v29, a77
v_cvt_pk_bf16_f32 v118, v28, v29
v_accvgpr_read_b32 v30, a78
v_mfma_f32_32x32x16_bf16 v[176:191], a[176:179], a[164:167], 0
ds_read_b64_tr_b16 a[210:211], v13 offset:5120
buffer_load_dwordx4 v1, s[12:15], s48 offen lds
v_accvgpr_read_b32 v31, a79
v_cvt_pk_bf16_f32 v119, v30, v31
v_accvgpr_read_b32 v24, a80
v_accvgpr_read_b32 v25, a81
v_cvt_pk_bf16_f32 v120, v24, v25
v_accvgpr_read_b32 v26, a82
v_accvgpr_read_b32 v27, a83
v_cvt_pk_bf16_f32 v121, v26, v27
v_accvgpr_read_b32 v28, a84
v_accvgpr_read_b32 v29, a85
v_mfma_f32_32x32x16_bf16 v[192:207], a[176:179], a[168:171], 0
ds_read_b128 a[192:195], v10 offset:0
v_cvt_pk_bf16_f32 v122, v28, v29
v_accvgpr_read_b32 v30, a86
v_accvgpr_read_b32 v31, a87
v_cvt_pk_bf16_f32 v123, v30, v31
v_accvgpr_read_b32 v24, a88
v_accvgpr_read_b32 v25, a89
v_cvt_pk_bf16_f32 v124, v24, v25
v_accvgpr_read_b32 v26, a90
v_accvgpr_read_b32 v27, a91
v_cvt_pk_bf16_f32 v125, v26, v27
v_mfma_f32_32x32x16_bf16 v[208:223], a[176:179], a[172:175], 0
ds_read_b128 a[196:199], v10 offset:4096
v_accvgpr_read_b32 v28, a92
v_accvgpr_read_b32 v29, a93
v_cvt_pk_bf16_f32 v126, v28, v29
v_accvgpr_read_b32 v30, a94
v_accvgpr_read_b32 v31, a95
v_cvt_pk_bf16_f32 v127, v30, v31
v_accvgpr_read_b32 v24, a96
v_accvgpr_read_b32 v25, a97
v_cvt_pk_bf16_f32 v128, v24, v25
v_accvgpr_read_b32 v26, a98
v_mfma_f32_32x32x16_bf16 v[224:239], a[180:183], a[160:163], 0
ds_read_b128 a[200:203], v10 offset:8192
s_add_u32 m0, s32, 4096
v_accvgpr_read_b32 v27, a99
v_cvt_pk_bf16_f32 v129, v26, v27
v_accvgpr_read_b32 v28, a100
v_accvgpr_read_b32 v29, a101
v_cvt_pk_bf16_f32 v130, v28, v29
v_accvgpr_read_b32 v30, a102
v_accvgpr_read_b32 v31, a103
v_cvt_pk_bf16_f32 v131, v30, v31
v_accvgpr_read_b32 v24, a104
v_accvgpr_read_b32 v25, a105
v_mfma_f32_32x32x16_bf16 v[240:255], a[180:183], a[164:167], 0
ds_read_b128 a[204:207], v10 offset:12288
buffer_load_dwordx4 v2, s[12:15], s48 offen lds
v_cvt_pk_bf16_f32 v132, v24, v25
v_accvgpr_read_b32 v26, a106
v_accvgpr_read_b32 v27, a107
v_cvt_pk_bf16_f32 v133, v26, v27
v_accvgpr_read_b32 v28, a108
v_accvgpr_read_b32 v29, a109
v_cvt_pk_bf16_f32 v134, v28, v29
v_accvgpr_read_b32 v30, a110
v_accvgpr_read_b32 v31, a111
v_cvt_pk_bf16_f32 v135, v30, v31
v_mfma_f32_32x32x16_bf16 a[0:15], a[180:183], a[168:171], 0
ds_read_b64_tr_b16 a[212:213], v14 offset:4096
v_accvgpr_read_b32 v24, a112
v_accvgpr_read_b32 v25, a113
v_cvt_pk_bf16_f32 v136, v24, v25
v_accvgpr_read_b32 v26, a114
v_accvgpr_read_b32 v27, a115
v_cvt_pk_bf16_f32 v137, v26, v27
v_accvgpr_read_b32 v28, a116
v_accvgpr_read_b32 v29, a117
v_cvt_pk_bf16_f32 v138, v28, v29
v_accvgpr_read_b32 v30, a118
v_mfma_f32_32x32x16_bf16 a[16:31], a[180:183], a[172:175], 0
ds_read_b64_tr_b16 a[214:215], v14 offset:5120
v_accvgpr_read_b32 v31, a119
v_cvt_pk_bf16_f32 v139, v30, v31
v_accvgpr_read_b32 v24, a120
v_accvgpr_read_b32 v25, a121
v_cvt_pk_bf16_f32 v140, v24, v25
v_accvgpr_read_b32 v26, a122
v_accvgpr_read_b32 v27, a123
v_cvt_pk_bf16_f32 v141, v26, v27
v_accvgpr_read_b32 v28, a124
v_accvgpr_read_b32 v29, a125
v_mfma_f32_32x32x16_bf16 a[32:47], a[184:187], a[160:163], 0
ds_read_b64_tr_b16 a[216:217], v15 offset:4096
s_add_u32 m0, s32, 8192
v_cvt_pk_bf16_f32 v142, v28, v29
v_accvgpr_read_b32 v30, a126
v_accvgpr_read_b32 v31, a127
v_cvt_pk_bf16_f32 v143, v30, v31
v_accvgpr_read_b32 v24, a128
v_accvgpr_read_b32 v25, a129
v_cvt_pk_bf16_f32 v144, v24, v25
v_accvgpr_read_b32 v26, a130
v_accvgpr_read_b32 v27, a131
v_cvt_pk_bf16_f32 v145, v26, v27
v_mfma_f32_32x32x16_bf16 a[48:63], a[184:187], a[164:167], 0
ds_read_b64_tr_b16 a[218:219], v15 offset:5120
buffer_load_dwordx4 v3, s[12:15], s48 offen lds
v_accvgpr_read_b32 v28, a132
v_accvgpr_read_b32 v29, a133
v_cvt_pk_bf16_f32 v146, v28, v29
v_accvgpr_read_b32 v30, a134
v_accvgpr_read_b32 v31, a135
v_cvt_pk_bf16_f32 v147, v30, v31
v_accvgpr_read_b32 v24, a136
v_accvgpr_read_b32 v25, a137
v_cvt_pk_bf16_f32 v148, v24, v25
v_accvgpr_read_b32 v26, a138
v_mfma_f32_32x32x16_bf16 a[64:79], a[184:187], a[168:171], 0
ds_read_b64_tr_b16 a[220:221], v16 offset:4096
v_accvgpr_read_b32 v27, a139
v_cvt_pk_bf16_f32 v149, v26, v27
v_accvgpr_read_b32 v28, a140
v_accvgpr_read_b32 v29, a141
v_cvt_pk_bf16_f32 v150, v28, v29
v_accvgpr_read_b32 v30, a142
v_accvgpr_read_b32 v31, a143
v_cvt_pk_bf16_f32 v151, v30, v31
v_accvgpr_read_b32 v24, a144
v_accvgpr_read_b32 v25, a145
v_mfma_f32_32x32x16_bf16 a[80:95], a[184:187], a[172:175], 0
ds_read_b64_tr_b16 a[222:223], v16 offset:5120
v_cvt_pk_bf16_f32 v152, v24, v25
v_accvgpr_read_b32 v26, a146
v_accvgpr_read_b32 v27, a147
v_cvt_pk_bf16_f32 v153, v26, v27
v_accvgpr_read_b32 v28, a148
v_accvgpr_read_b32 v29, a149
v_cvt_pk_bf16_f32 v154, v28, v29
v_accvgpr_read_b32 v30, a150
v_accvgpr_read_b32 v31, a151
v_cvt_pk_bf16_f32 v155, v30, v31
v_mfma_f32_32x32x16_bf16 a[96:111], a[188:191], a[160:163], 0
s_add_u32 m0, s32, 12288
v_accvgpr_read_b32 v24, a152
v_accvgpr_read_b32 v25, a153
v_cvt_pk_bf16_f32 v156, v24, v25
v_accvgpr_read_b32 v26, a154
v_accvgpr_read_b32 v27, a155
v_cvt_pk_bf16_f32 v157, v26, v27
v_accvgpr_read_b32 v28, a156
v_accvgpr_read_b32 v29, a157
v_cvt_pk_bf16_f32 v158, v28, v29
v_accvgpr_read_b32 v30, a158
v_mfma_f32_32x32x16_bf16 a[112:127], a[188:191], a[164:167], 0
buffer_load_dwordx4 v4, s[12:15], s48 offen lds
v_accvgpr_read_b32 v31, a159
v_cvt_pk_bf16_f32 v159, v30, v31
v_mfma_f32_32x32x16_bf16 a[128:143], a[188:191], a[168:171], 0
v_mfma_f32_32x32x16_bf16 a[144:159], a[188:191], a[172:175], 0
v_add_u32 v13, 16384, v13
v_and_b32 v13, 65535, v13
v_add_u32 v14, 16384, v14
v_and_b32 v14, 65535, v14
v_add_u32 v15, 16384, v15
v_and_b32 v15, 65535, v15
v_add_u32 v16, 16384, v16
v_and_b32 v16, 65535, v16
v_and_b32 v18, 63, v0
v_bfe_u32 v19, v0, 1, 4
v_and_b32 v20, 1, v0
v_lshl_add_u32 v19, v20, 4, v19
v_and_or_b32 v19, v0, 32, v19
v_cmp_eq_u32 vcc, 0, s49
s_nop 1
v_cndmask_b32 v18, v19, v18, vcc
v_lshlrev_b32 v17, 4, v18
s_waitcnt vmcnt(17) lgkmcnt(0)
s_barrier
v_mfma_f32_32x32x16_bf16 v[160:175], a[208:211], a[192:195], v[160:175]
ds_read_b64_tr_b16 a[176:177], v13 offset:0
s_mov_b32 m0, s33
v_mfma_f32_32x32x16_bf16 v[176:191], a[208:211], a[196:199], v[176:191]
ds_read_b64_tr_b16 a[178:179], v13 offset:1024
buffer_load_dwordx4 v5, s[20:23], s31 offen offset:0 lds
v_mfma_f32_32x32x16_bf16 v[192:207], a[208:211], a[200:203], v[192:207]
ds_read_b128 a[160:163], v11 offset:0
v_mfma_f32_32x32x16_bf16 v[208:223], a[208:211], a[204:207], v[208:223]
ds_read_b128 a[164:167], v11 offset:4096
v_mfma_f32_32x32x16_bf16 v[224:239], a[212:215], a[192:195], v[224:239]
ds_read_b128 a[168:171], v11 offset:8192
v_mfma_f32_32x32x16_bf16 v[240:255], a[212:215], a[196:199], v[240:255]
ds_read_b128 a[172:175], v11 offset:12288
buffer_load_dwordx4 v6, s[20:23], s31 offen offset:1024 lds
v_mfma_f32_32x32x16_bf16 a[0:15], a[212:215], a[200:203], a[0:15]
ds_read_b64_tr_b16 a[180:181], v14 offset:0
s_add_u32 s25, s38, 0
v_mfma_f32_32x32x16_bf16 a[16:31], a[212:215], a[204:207], a[16:31]
ds_read_b64_tr_b16 a[182:183], v14 offset:1024
buffer_store_dwordx4 v[32:35], v17, s[8:11], s25 offen offset:0 sc1
v_mfma_f32_32x32x16_bf16 a[32:47], a[216:219], a[192:195], a[32:47]
ds_read_b64_tr_b16 a[184:185], v15 offset:0
v_mfma_f32_32x32x16_bf16 a[48:63], a[216:219], a[196:199], a[48:63]
ds_read_b64_tr_b16 a[186:187], v15 offset:1024
buffer_load_dwordx4 v7, s[20:23], s31 offen offset:2048 lds
v_mfma_f32_32x32x16_bf16 a[64:79], a[216:219], a[200:203], a[64:79]
ds_read_b64_tr_b16 a[188:189], v16 offset:0
v_mfma_f32_32x32x16_bf16 a[80:95], a[216:219], a[204:207], a[80:95]
ds_read_b64_tr_b16 a[190:191], v16 offset:1024
v_mfma_f32_32x32x16_bf16 a[96:111], a[220:223], a[192:195], a[96:111]
v_mfma_f32_32x32x16_bf16 a[112:127], a[220:223], a[196:199], a[112:127]
buffer_load_dwordx4 v8, s[20:23], s31 offen offset:3072 lds
v_mfma_f32_32x32x16_bf16 a[128:143], a[220:223], a[200:203], a[128:143]
s_add_u32 s31, s31, 262144
s_add_u32 s33, s33, 16384
s_and_b32 s33, s33, 65535
s_add_u32 s25, s38, 0
v_mfma_f32_32x32x16_bf16 a[144:159], a[220:223], a[204:207], a[144:159]
buffer_store_dwordx4 v[36:39], v17, s[8:11], s25 offen offset:1024 sc1
s_waitcnt lgkmcnt(0)
v_mfma_f32_32x32x16_bf16 v[160:175], a[176:179], a[160:163], v[160:175]
ds_read_b64_tr_b16 a[208:209], v13 offset:4096
s_add_u32 m0, s32, 16384
s_add_u32 s48, s30, s34
v_mfma_f32_32x32x16_bf16 v[176:191], a[176:179], a[164:167], v[176:191]
ds_read_b64_tr_b16 a[210:211], v13 offset:5120
buffer_load_dwordx4 v1, s[12:15], s48 offen lds
v_mfma_f32_32x32x16_bf16 v[192:207], a[176:179], a[168:171], v[192:207]
ds_read_b128 a[192:195], v12 offset:0
v_mfma_f32_32x32x16_bf16 v[208:223], a[176:179], a[172:175], v[208:223]
ds_read_b128 a[196:199], v12 offset:4096
v_mfma_f32_32x32x16_bf16 v[224:239], a[180:183], a[160:163], v[224:239]
ds_read_b128 a[200:203], v12 offset:8192
s_add_u32 m0, s32, 20480
v_mfma_f32_32x32x16_bf16 v[240:255], a[180:183], a[164:167], v[240:255]
ds_read_b128 a[204:207], v12 offset:12288
buffer_load_dwordx4 v2, s[12:15], s48 offen lds
v_mfma_f32_32x32x16_bf16 a[0:15], a[180:183], a[168:171], a[0:15]
ds_read_b64_tr_b16 a[212:213], v14 offset:4096
s_add_u32 s25, s38, 16384
v_mfma_f32_32x32x16_bf16 a[16:31], a[180:183], a[172:175], a[16:31]
ds_read_b64_tr_b16 a[214:215], v14 offset:5120
buffer_store_dwordx4 v[40:43], v17, s[8:11], s25 offen offset:0 sc1
v_mfma_f32_32x32x16_bf16 a[32:47], a[184:187], a[160:163], a[32:47]
ds_read_b64_tr_b16 a[216:217], v15 offset:4096
s_add_u32 m0, s32, 24576
v_mfma_f32_32x32x16_bf16 a[48:63], a[184:187], a[164:167], a[48:63]
ds_read_b64_tr_b16 a[218:219], v15 offset:5120
buffer_load_dwordx4 v3, s[12:15], s48 offen lds
v_mfma_f32_32x32x16_bf16 a[64:79], a[184:187], a[168:171], a[64:79]
ds_read_b64_tr_b16 a[220:221], v16 offset:4096
v_mfma_f32_32x32x16_bf16 a[80:95], a[184:187], a[172:175], a[80:95]
ds_read_b64_tr_b16 a[222:223], v16 offset:5120
v_add_u32 v9, 32768, v9
v_subrev_u32 v20, 98304, v9
v_cmp_le_u32 vcc, 163840, v9
v_add_u32 v13, 16384, v13
v_mfma_f32_32x32x16_bf16 a[96:111], a[188:191], a[160:163], a[96:111]
s_add_u32 m0, s32, 28672
v_and_b32 v13, 65535, v13
v_add_u32 v14, 16384, v14
v_and_b32 v14, 65535, v14
v_add_u32 v15, 16384, v15
v_mfma_f32_32x32x16_bf16 a[112:127], a[188:191], a[164:167], a[112:127]
buffer_load_dwordx4 v4, s[12:15], s48 offen lds
v_and_b32 v15, 65535, v15
v_add_u32 v16, 16384, v16
v_and_b32 v16, 65535, v16
v_mfma_f32_32x32x16_bf16 a[128:143], a[188:191], a[168:171], a[128:143]
s_add_u32 s30, s30, 128
s_add_u32 s32, s32, 32768
s_sub_u32 s24, s32, 98304
s_cmp_ge_u32 s32, 163840
s_cselect_b32 s32, s24, s32
v_cndmask_b32 v9, v9, v20, vcc
v_xor_b32 v10, 32, v9
v_xor_b32 v11, 64, v9
v_xor_b32 v12, 96, v9
v_mfma_f32_32x32x16_bf16 a[144:159], a[188:191], a[172:175], a[144:159]
s_waitcnt vmcnt(19) lgkmcnt(0)
s_barrier
v_mfma_f32_32x32x16_bf16 v[160:175], a[208:211], a[192:195], v[160:175]
ds_read_b64_tr_b16 a[176:177], v13 offset:0
s_mov_b32 m0, s33
v_mfma_f32_32x32x16_bf16 v[176:191], a[208:211], a[196:199], v[176:191]
ds_read_b64_tr_b16 a[178:179], v13 offset:1024
buffer_load_dwordx4 v5, s[20:23], s31 offen offset:0 lds
v_mfma_f32_32x32x16_bf16 v[192:207], a[208:211], a[200:203], v[192:207]
ds_read_b128 a[160:163], v9 offset:0
v_mfma_f32_32x32x16_bf16 v[208:223], a[208:211], a[204:207], v[208:223]
ds_read_b128 a[164:167], v9 offset:4096
v_mfma_f32_32x32x16_bf16 v[224:239], a[212:215], a[192:195], v[224:239]
ds_read_b128 a[168:171], v9 offset:8192
v_mfma_f32_32x32x16_bf16 v[240:255], a[212:215], a[196:199], v[240:255]
ds_read_b128 a[172:175], v9 offset:12288
buffer_load_dwordx4 v6, s[20:23], s31 offen offset:1024 lds
v_mfma_f32_32x32x16_bf16 a[0:15], a[212:215], a[200:203], a[0:15]
ds_read_b64_tr_b16 a[180:181], v14 offset:0
s_add_u32 s25, s38, 16384
v_mfma_f32_32x32x16_bf16 a[16:31], a[212:215], a[204:207], a[16:31]
ds_read_b64_tr_b16 a[182:183], v14 offset:1024
buffer_store_dwordx4 v[44:47], v17, s[8:11], s25 offen offset:1024 sc1
v_mfma_f32_32x32x16_bf16 a[32:47], a[216:219], a[192:195], a[32:47]
ds_read_b64_tr_b16 a[184:185], v15 offset:0
v_mfma_f32_32x32x16_bf16 a[48:63], a[216:219], a[196:199], a[48:63]
ds_read_b64_tr_b16 a[186:187], v15 offset:1024
buffer_load_dwordx4 v7, s[20:23], s31 offen offset:2048 lds
v_mfma_f32_32x32x16_bf16 a[64:79], a[216:219], a[200:203], a[64:79]
ds_read_b64_tr_b16 a[188:189], v16 offset:0
v_mfma_f32_32x32x16_bf16 a[80:95], a[216:219], a[204:207], a[80:95]
ds_read_b64_tr_b16 a[190:191], v16 offset:1024
buffer_load_dword v22, v23, s[96:99], s100 offen
s_add_u32 s100, s100, 8192
v_mfma_f32_32x32x16_bf16 a[96:111], a[220:223], a[192:195], a[96:111]
v_mfma_f32_32x32x16_bf16 a[112:127], a[220:223], a[196:199], a[112:127]
buffer_load_dwordx4 v8, s[20:23], s31 offen offset:3072 lds
v_mfma_f32_32x32x16_bf16 a[128:143], a[220:223], a[200:203], a[128:143]
s_add_u32 s31, s31, 262144
s_add_u32 s33, s33, 16384
s_and_b32 s33, s33, 65535
v_mfma_f32_32x32x16_bf16 a[144:159], a[220:223], a[204:207], a[144:159]
s_waitcnt lgkmcnt(0)
v_mfma_f32_32x32x16_bf16 v[160:175], a[176:179], a[160:163], v[160:175]
ds_read_b64_tr_b16 a[208:209], v13 offset:4096
s_add_u32 m0, s32, 0
s_mov_b32 s48, s30
v_mfma_f32_32x32x16_bf16 v[176:191], a[176:179], a[164:167], v[176:191]
ds_read_b64_tr_b16 a[210:211], v13 offset:5120
buffer_load_dwordx4 v1, s[12:15], s48 offen lds
v_mfma_f32_32x32x16_bf16 v[192:207], a[176:179], a[168:171], v[192:207]
ds_read_b128 a[192:195], v10 offset:0
v_mfma_f32_32x32x16_bf16 v[208:223], a[176:179], a[172:175], v[208:223]
ds_read_b128 a[196:199], v10 offset:4096
v_mfma_f32_32x32x16_bf16 v[224:239], a[180:183], a[160:163], v[224:239]
ds_read_b128 a[200:203], v10 offset:8192
s_add_u32 m0, s32, 4096
v_mfma_f32_32x32x16_bf16 v[240:255], a[180:183], a[164:167], v[240:255]
ds_read_b128 a[204:207], v10 offset:12288
buffer_load_dwordx4 v2, s[12:15], s48 offen lds
v_mfma_f32_32x32x16_bf16 a[0:15], a[180:183], a[168:171], a[0:15]
ds_read_b64_tr_b16 a[212:213], v14 offset:4096
s_add_u32 s25, s38, 32768
v_mfma_f32_32x32x16_bf16 a[16:31], a[180:183], a[172:175], a[16:31]
ds_read_b64_tr_b16 a[214:215], v14 offset:5120
buffer_store_dwordx4 v[48:51], v17, s[8:11], s25 offen offset:0 sc1
v_mfma_f32_32x32x16_bf16 a[32:47], a[184:187], a[160:163], a[32:47]
ds_read_b64_tr_b16 a[216:217], v15 offset:4096
s_add_u32 m0, s32, 8192
v_mfma_f32_32x32x16_bf16 a[48:63], a[184:187], a[164:167], a[48:63]
ds_read_b64_tr_b16 a[218:219], v15 offset:5120
buffer_load_dwordx4 v3, s[12:15], s48 offen lds
v_mfma_f32_32x32x16_bf16 a[64:79], a[184:187], a[168:171], a[64:79]
ds_read_b64_tr_b16 a[220:221], v16 offset:4096
v_mfma_f32_32x32x16_bf16 a[80:95], a[184:187], a[172:175], a[80:95]
ds_read_b64_tr_b16 a[222:223], v16 offset:5120
v_add_u32 v13, 16384, v13
v_and_b32 v13, 65535, v13
v_mfma_f32_32x32x16_bf16 a[96:111], a[188:191], a[160:163], a[96:111]
s_add_u32 m0, s32, 12288
v_add_u32 v14, 16384, v14
v_and_b32 v14, 65535, v14
v_mfma_f32_32x32x16_bf16 a[112:127], a[188:191], a[164:167], a[112:127]
buffer_load_dwordx4 v4, s[12:15], s48 offen lds
v_add_u32 v15, 16384, v15
v_and_b32 v15, 65535, v15
v_mfma_f32_32x32x16_bf16 a[128:143], a[188:191], a[168:171], a[128:143]
s_add_u32 s25, s38, 32768
v_add_u32 v16, 16384, v16
v_and_b32 v16, 65535, v16
v_mfma_f32_32x32x16_bf16 a[144:159], a[188:191], a[172:175], a[144:159]
buffer_store_dwordx4 v[52:55], v17, s[8:11], s25 offen offset:1024 sc1
s_waitcnt vmcnt(23) lgkmcnt(0)
s_barrier
v_mfma_f32_32x32x16_bf16 v[160:175], a[208:211], a[192:195], v[160:175]
ds_read_b64_tr_b16 a[176:177], v13 offset:0
s_mov_b32 m0, s33
v_mfma_f32_32x32x16_bf16 v[176:191], a[208:211], a[196:199], v[176:191]
ds_read_b64_tr_b16 a[178:179], v13 offset:1024
buffer_load_dwordx4 v5, s[20:23], s31 offen offset:0 lds
v_mfma_f32_32x32x16_bf16 v[192:207], a[208:211], a[200:203], v[192:207]
ds_read_b128 a[160:163], v11 offset:0
v_mfma_f32_32x32x16_bf16 v[208:223], a[208:211], a[204:207], v[208:223]
ds_read_b128 a[164:167], v11 offset:4096
v_mfma_f32_32x32x16_bf16 v[224:239], a[212:215], a[192:195], v[224:239]
ds_read_b128 a[168:171], v11 offset:8192
v_mfma_f32_32x32x16_bf16 v[240:255], a[212:215], a[196:199], v[240:255]
ds_read_b128 a[172:175], v11 offset:12288
buffer_load_dwordx4 v6, s[20:23], s31 offen offset:1024 lds
v_mfma_f32_32x32x16_bf16 a[0:15], a[212:215], a[200:203], a[0:15]
ds_read_b64_tr_b16 a[180:181], v14 offset:0
s_add_u32 s25, s38, 49152
v_mfma_f32_32x32x16_bf16 a[16:31], a[212:215], a[204:207], a[16:31]
ds_read_b64_tr_b16 a[182:183], v14 offset:1024
buffer_store_dwordx4 v[56:59], v17, s[8:11], s25 offen offset:0 sc1
v_mfma_f32_32x32x16_bf16 a[32:47], a[216:219], a[192:195], a[32:47]
ds_read_b64_tr_b16 a[184:185], v15 offset:0
v_mfma_f32_32x32x16_bf16 a[48:63], a[216:219], a[196:199], a[48:63]
ds_read_b64_tr_b16 a[186:187], v15 offset:1024
buffer_load_dwordx4 v7, s[20:23], s31 offen offset:2048 lds
v_mfma_f32_32x32x16_bf16 a[64:79], a[216:219], a[200:203], a[64:79]
ds_read_b64_tr_b16 a[188:189], v16 offset:0
v_mfma_f32_32x32x16_bf16 a[80:95], a[216:219], a[204:207], a[80:95]
ds_read_b64_tr_b16 a[190:191], v16 offset:1024
buffer_load_dword v22, v23, s[96:99], s100 offen
s_add_u32 s100, s100, 8192
v_mfma_f32_32x32x16_bf16 a[96:111], a[220:223], a[192:195], a[96:111]
v_mfma_f32_32x32x16_bf16 a[112:127], a[220:223], a[196:199], a[112:127]
buffer_load_dwordx4 v8, s[20:23], s31 offen offset:3072 lds
v_mfma_f32_32x32x16_bf16 a[128:143], a[220:223], a[200:203], a[128:143]
s_add_u32 s31, s31, 262144
s_add_u32 s33, s33, 16384
s_and_b32 s33, s33, 65535
v_mfma_f32_32x32x16_bf16 a[144:159], a[220:223], a[204:207], a[144:159]
s_waitcnt lgkmcnt(0)
v_mfma_f32_32x32x16_bf16 v[160:175], a[176:179], a[160:163], v[160:175]
ds_read_b64_tr_b16 a[208:209], v13 offset:4096
s_add_u32 m0, s32, 16384
s_add_u32 s48, s30, s34
v_mfma_f32_32x32x16_bf16 v[176:191], a[176:179], a[164:167], v[176:191]
ds_read_b64_tr_b16 a[210:211], v13 offset:5120
buffer_load_dwordx4 v1, s[12:15], s48 offen lds
v_mfma_f32_32x32x16_bf16 v[192:207], a[176:179], a[168:171], v[192:207]
ds_read_b128 a[192:195], v12 offset:0
v_mfma_f32_32x32x16_bf16 v[208:223], a[176:179], a[172:175], v[208:223]
ds_read_b128 a[196:199], v12 offset:4096
v_mfma_f32_32x32x16_bf16 v[224:239], a[180:183], a[160:163], v[224:239]
ds_read_b128 a[200:203], v12 offset:8192
s_add_u32 m0, s32, 20480
v_mfma_f32_32x32x16_bf16 v[240:255], a[180:183], a[164:167], v[240:255]
ds_read_b128 a[204:207], v12 offset:12288
buffer_load_dwordx4 v2, s[12:15], s48 offen lds
v_mfma_f32_32x32x16_bf16 a[0:15], a[180:183], a[168:171], a[0:15]
ds_read_b64_tr_b16 a[212:213], v14 offset:4096
s_add_u32 s25, s38, 49152
v_mfma_f32_32x32x16_bf16 a[16:31], a[180:183], a[172:175], a[16:31]
ds_read_b64_tr_b16 a[214:215], v14 offset:5120
buffer_store_dwordx4 v[60:63], v17, s[8:11], s25 offen offset:1024 sc1
v_mfma_f32_32x32x16_bf16 a[32:47], a[184:187], a[160:163], a[32:47]
ds_read_b64_tr_b16 a[216:217], v15 offset:4096
s_add_u32 m0, s32, 24576
v_mfma_f32_32x32x16_bf16 a[48:63], a[184:187], a[164:167], a[48:63]
ds_read_b64_tr_b16 a[218:219], v15 offset:5120
buffer_load_dwordx4 v3, s[12:15], s48 offen lds
v_mfma_f32_32x32x16_bf16 a[64:79], a[184:187], a[168:171], a[64:79]
ds_read_b64_tr_b16 a[220:221], v16 offset:4096
v_mfma_f32_32x32x16_bf16 a[80:95], a[184:187], a[172:175], a[80:95]
ds_read_b64_tr_b16 a[222:223], v16 offset:5120
v_add_u32 v9, 32768, v9
v_subrev_u32 v20, 98304, v9
v_cmp_le_u32 vcc, 163840, v9
v_add_u32 v13, 16384, v13
v_mfma_f32_32x32x16_bf16 a[96:111], a[188:191], a[160:163], a[96:111]
s_add_u32 m0, s32, 28672
v_and_b32 v13, 65535, v13
v_add_u32 v14, 16384, v14
v_and_b32 v14, 65535, v14
v_add_u32 v15, 16384, v15
v_mfma_f32_32x32x16_bf16 a[112:127], a[188:191], a[164:167], a[112:127]
buffer_load_dwordx4 v4, s[12:15], s48 offen lds
v_and_b32 v15, 65535, v15
v_add_u32 v16, 16384, v16
v_and_b32 v16, 65535, v16
v_mfma_f32_32x32x16_bf16 a[128:143], a[188:191], a[168:171], a[128:143]
s_add_u32 s30, s30, 128
s_add_u32 s32, s32, 32768
s_sub_u32 s24, s32, 98304
s_cmp_ge_u32 s32, 163840
s_cselect_b32 s32, s24, s32
v_cndmask_b32 v9, v9, v20, vcc
v_xor_b32 v10, 32, v9
v_xor_b32 v11, 64, v9
v_xor_b32 v12, 96, v9
v_mfma_f32_32x32x16_bf16 a[144:159], a[188:191], a[172:175], a[144:159]
s_waitcnt vmcnt(23) lgkmcnt(0)
s_barrier
v_mfma_f32_32x32x16_bf16 v[160:175], a[208:211], a[192:195], v[160:175]
ds_read_b64_tr_b16 a[176:177], v13 offset:0
s_mov_b32 m0, s33
v_mfma_f32_32x32x16_bf16 v[176:191], a[208:211], a[196:199], v[176:191]
ds_read_b64_tr_b16 a[178:179], v13 offset:1024
buffer_load_dwordx4 v5, s[20:23], s31 offen offset:0 lds
v_mfma_f32_32x32x16_bf16 v[192:207], a[208:211], a[200:203], v[192:207]
ds_read_b128 a[160:163], v9 offset:0
v_mfma_f32_32x32x16_bf16 v[208:223], a[208:211], a[204:207], v[208:223]
ds_read_b128 a[164:167], v9 offset:4096
v_mfma_f32_32x32x16_bf16 v[224:239], a[212:215], a[192:195], v[224:239]
ds_read_b128 a[168:171], v9 offset:8192
v_mfma_f32_32x32x16_bf16 v[240:255], a[212:215], a[196:199], v[240:255]
ds_read_b128 a[172:175], v9 offset:12288
buffer_load_dwordx4 v6, s[20:23], s31 offen offset:1024 lds
v_mfma_f32_32x32x16_bf16 a[0:15], a[212:215], a[200:203], a[0:15]
ds_read_b64_tr_b16 a[180:181], v14 offset:0
s_add_u32 s25, s38, 2048
v_mfma_f32_32x32x16_bf16 a[16:31], a[212:215], a[204:207], a[16:31]
ds_read_b64_tr_b16 a[182:183], v14 offset:1024
buffer_store_dwordx4 v[64:67], v17, s[8:11], s25 offen offset:0 sc1
v_mfma_f32_32x32x16_bf16 a[32:47], a[216:219], a[192:195], a[32:47]
ds_read_b64_tr_b16 a[184:185], v15 offset:0
v_mfma_f32_32x32x16_bf16 a[48:63], a[216:219], a[196:199], a[48:63]
ds_read_b64_tr_b16 a[186:187], v15 offset:1024
buffer_load_dwordx4 v7, s[20:23], s31 offen offset:2048 lds
v_mfma_f32_32x32x16_bf16 a[64:79], a[216:219], a[200:203], a[64:79]
ds_read_b64_tr_b16 a[188:189], v16 offset:0
v_mfma_f32_32x32x16_bf16 a[80:95], a[216:219], a[204:207], a[80:95]
ds_read_b64_tr_b16 a[190:191], v16 offset:1024
buffer_load_dword v22, v23, s[96:99], s100 offen
s_add_u32 s100, s100, 8192
v_mfma_f32_32x32x16_bf16 a[96:111], a[220:223], a[192:195], a[96:111]
v_mfma_f32_32x32x16_bf16 a[112:127], a[220:223], a[196:199], a[112:127]
buffer_load_dwordx4 v8, s[20:23], s31 offen offset:3072 lds
v_mfma_f32_32x32x16_bf16 a[128:143], a[220:223], a[200:203], a[128:143]
s_add_u32 s31, s31, 262144
s_add_u32 s33, s33, 16384
s_and_b32 s33, s33, 65535
s_add_u32 s25, s38, 2048
v_mfma_f32_32x32x16_bf16 a[144:159], a[220:223], a[204:207], a[144:159]
buffer_store_dwordx4 v[68:71], v17, s[8:11], s25 offen offset:1024 sc1
s_waitcnt lgkmcnt(0)
v_mfma_f32_32x32x16_bf16 v[160:175], a[176:179], a[160:163], v[160:175]
ds_read_b64_tr_b16 a[208:209], v13 offset:4096
s_add_u32 m0, s32, 0
s_mov_b32 s48, s30
v_mfma_f32_32x32x16_bf16 v[176:191], a[176:179], a[164:167], v[176:191]
ds_read_b64_tr_b16 a[210:211], v13 offset:5120
buffer_load_dwordx4 v1, s[12:15], s48 offen lds
v_mfma_f32_32x32x16_bf16 v[192:207], a[176:179], a[168:171], v[192:207]
ds_read_b128 a[192:195], v10 offset:0
v_mfma_f32_32x32x16_bf16 v[208:223], a[176:179], a[172:175], v[208:223]
ds_read_b128 a[196:199], v10 offset:4096
v_mfma_f32_32x32x16_bf16 v[224:239], a[180:183], a[160:163], v[224:239]
ds_read_b128 a[200:203], v10 offset:8192
s_add_u32 m0, s32, 4096
v_mfma_f32_32x32x16_bf16 v[240:255], a[180:183], a[164:167], v[240:255]
ds_read_b128 a[204:207], v10 offset:12288
buffer_load_dwordx4 v2, s[12:15], s48 offen lds
v_mfma_f32_32x32x16_bf16 a[0:15], a[180:183], a[168:171], a[0:15]
ds_read_b64_tr_b16 a[212:213], v14 offset:4096
s_add_u32 s25, s38, 18432
v_mfma_f32_32x32x16_bf16 a[16:31], a[180:183], a[172:175], a[16:31]
ds_read_b64_tr_b16 a[214:215], v14 offset:5120
buffer_store_dwordx4 v[72:75], v17, s[8:11], s25 offen offset:0 sc1
v_mfma_f32_32x32x16_bf16 a[32:47], a[184:187], a[160:163], a[32:47]
ds_read_b64_tr_b16 a[216:217], v15 offset:4096
s_add_u32 m0, s32, 8192
v_mfma_f32_32x32x16_bf16 a[48:63], a[184:187], a[164:167], a[48:63]
ds_read_b64_tr_b16 a[218:219], v15 offset:5120
buffer_load_dwordx4 v3, s[12:15], s48 offen lds
v_mfma_f32_32x32x16_bf16 a[64:79], a[184:187], a[168:171], a[64:79]
ds_read_b64_tr_b16 a[220:221], v16 offset:4096
v_mfma_f32_32x32x16_bf16 a[80:95], a[184:187], a[172:175], a[80:95]
ds_read_b64_tr_b16 a[222:223], v16 offset:5120
v_add_u32 v13, 16384, v13
v_and_b32 v13, 65535, v13
v_mfma_f32_32x32x16_bf16 a[96:111], a[188:191], a[160:163], a[96:111]
s_add_u32 m0, s32, 12288
v_add_u32 v14, 16384, v14
v_and_b32 v14, 65535, v14
v_mfma_f32_32x32x16_bf16 a[112:127], a[188:191], a[164:167], a[112:127]
buffer_load_dwordx4 v4, s[12:15], s48 offen lds
v_add_u32 v15, 16384, v15
v_and_b32 v15, 65535, v15
v_mfma_f32_32x32x16_bf16 a[128:143], a[188:191], a[168:171], a[128:143]
v_add_u32 v16, 16384, v16
v_and_b32 v16, 65535, v16
v_mfma_f32_32x32x16_bf16 a[144:159], a[188:191], a[172:175], a[144:159]
s_waitcnt vmcnt(23) lgkmcnt(0)
s_barrier
v_mfma_f32_32x32x16_bf16 v[160:175], a[208:211], a[192:195], v[160:175]
ds_read_b64_tr_b16 a[176:177], v13 offset:0
s_mov_b32 m0, s33
v_mfma_f32_32x32x16_bf16 v[176:191], a[208:211], a[196:199], v[176:191]
ds_read_b64_tr_b16 a[178:179], v13 offset:1024
buffer_load_dwordx4 v5, s[20:23], s31 offen offset:0 lds
v_mfma_f32_32x32x16_bf16 v[192:207], a[208:211], a[200:203], v[192:207]
ds_read_b128 a[160:163], v11 offset:0
v_mfma_f32_32x32x16_bf16 v[208:223], a[208:211], a[204:207], v[208:223]
ds_read_b128 a[164:167], v11 offset:4096
v_mfma_f32_32x32x16_bf16 v[224:239], a[212:215], a[192:195], v[224:239]
ds_read_b128 a[168:171], v11 offset:8192
v_mfma_f32_32x32x16_bf16 v[240:255], a[212:215], a[196:199], v[240:255]
ds_read_b128 a[172:175], v11 offset:12288
buffer_load_dwordx4 v6, s[20:23], s31 offen offset:1024 lds
v_mfma_f32_32x32x16_bf16 a[0:15], a[212:215], a[200:203], a[0:15]
ds_read_b64_tr_b16 a[180:181], v14 offset:0
s_add_u32 s25, s38, 18432
v_mfma_f32_32x32x16_bf16 a[16:31], a[212:215], a[204:207], a[16:31]
ds_read_b64_tr_b16 a[182:183], v14 offset:1024
buffer_store_dwordx4 v[76:79], v17, s[8:11], s25 offen offset:1024 sc1
v_mfma_f32_32x32x16_bf16 a[32:47], a[216:219], a[192:195], a[32:47]
ds_read_b64_tr_b16 a[184:185], v15 offset:0
v_mfma_f32_32x32x16_bf16 a[48:63], a[216:219], a[196:199], a[48:63]
ds_read_b64_tr_b16 a[186:187], v15 offset:1024
buffer_load_dwordx4 v7, s[20:23], s31 offen offset:2048 lds
v_mfma_f32_32x32x16_bf16 a[64:79], a[216:219], a[200:203], a[64:79]
ds_read_b64_tr_b16 a[188:189], v16 offset:0
v_mfma_f32_32x32x16_bf16 a[80:95], a[216:219], a[204:207], a[80:95]
ds_read_b64_tr_b16 a[190:191], v16 offset:1024
buffer_load_dword v22, v23, s[96:99], s100 offen
s_add_u32 s100, s100, 8192
v_mfma_f32_32x32x16_bf16 a[96:111], a[220:223], a[192:195], a[96:111]
v_mfma_f32_32x32x16_bf16 a[112:127], a[220:223], a[196:199], a[112:127]
buffer_load_dwordx4 v8, s[20:23], s31 offen offset:3072 lds
v_mfma_f32_32x32x16_bf16 a[128:143], a[220:223], a[200:203], a[128:143]
s_add_u32 s31, s31, 262144
s_add_u32 s33, s33, 16384
s_and_b32 s33, s33, 65535
v_mfma_f32_32x32x16_bf16 a[144:159], a[220:223], a[204:207], a[144:159]
s_waitcnt lgkmcnt(0)
v_mfma_f32_32x32x16_bf16 v[160:175], a[176:179], a[160:163], v[160:175]
ds_read_b64_tr_b16 a[208:209], v13 offset:4096
s_add_u32 m0, s32, 16384
s_add_u32 s48, s30, s34
v_mfma_f32_32x32x16_bf16 v[176:191], a[176:179], a[164:167], v[176:191]
ds_read_b64_tr_b16 a[210:211], v13 offset:5120
buffer_load_dwordx4 v1, s[12:15], s48 offen lds
v_mfma_f32_32x32x16_bf16 v[192:207], a[176:179], a[168:171], v[192:207]
ds_read_b128 a[192:195], v12 offset:0
v_mfma_f32_32x32x16_bf16 v[208:223], a[176:179], a[172:175], v[208:223]
ds_read_b128 a[196:199], v12 offset:4096
v_mfma_f32_32x32x16_bf16 v[224:239], a[180:183], a[160:163], v[224:239]
ds_read_b128 a[200:203], v12 offset:8192
s_add_u32 m0, s32, 20480
v_mfma_f32_32x32x16_bf16 v[240:255], a[180:183], a[164:167], v[240:255]
ds_read_b128 a[204:207], v12 offset:12288
buffer_load_dwordx4 v2, s[12:15], s48 offen lds
v_mfma_f32_32x32x16_bf16 a[0:15], a[180:183], a[168:171], a[0:15]
ds_read_b64_tr_b16 a[212:213], v14 offset:4096
s_add_u32 s25, s38, 34816
v_mfma_f32_32x32x16_bf16 a[16:31], a[180:183], a[172:175], a[16:31]
ds_read_b64_tr_b16 a[214:215], v14 offset:5120
buffer_store_dwordx4 v[80:83], v17, s[8:11], s25 offen offset:0 sc1
v_mfma_f32_32x32x16_bf16 a[32:47], a[184:187], a[160:163], a[32:47]
ds_read_b64_tr_b16 a[216:217], v15 offset:4096
s_add_u32 m0, s32, 24576
v_mfma_f32_32x32x16_bf16 a[48:63], a[184:187], a[164:167], a[48:63]
ds_read_b64_tr_b16 a[218:219], v15 offset:5120
buffer_load_dwordx4 v3, s[12:15], s48 offen lds
v_mfma_f32_32x32x16_bf16 a[64:79], a[184:187], a[168:171], a[64:79]
ds_read_b64_tr_b16 a[220:221], v16 offset:4096
v_mfma_f32_32x32x16_bf16 a[80:95], a[184:187], a[172:175], a[80:95]
ds_read_b64_tr_b16 a[222:223], v16 offset:5120
v_add_u32 v9, 32768, v9
v_subrev_u32 v20, 98304, v9
v_cmp_le_u32 vcc, 163840, v9
v_add_u32 v13, 16384, v13
v_mfma_f32_32x32x16_bf16 a[96:111], a[188:191], a[160:163], a[96:111]
s_add_u32 m0, s32, 28672
v_and_b32 v13, 65535, v13
v_add_u32 v14, 16384, v14
v_and_b32 v14, 65535, v14
v_add_u32 v15, 16384, v15
v_mfma_f32_32x32x16_bf16 a[112:127], a[188:191], a[164:167], a[112:127]
buffer_load_dwordx4 v4, s[12:15], s48 offen lds
v_and_b32 v15, 65535, v15
v_add_u32 v16, 16384, v16
v_and_b32 v16, 65535, v16
v_mfma_f32_32x32x16_bf16 a[128:143], a[188:191], a[168:171], a[128:143]
s_add_u32 s30, s30, 128
s_add_u32 s32, s32, 32768
s_sub_u32 s24, s32, 98304
s_cmp_ge_u32 s32, 163840
s_cselect_b32 s32, s24, s32
s_add_u32 s25, s38, 34816
v_cndmask_b32 v9, v9, v20, vcc
v_xor_b32 v10, 32, v9
v_xor_b32 v11, 64, v9
v_xor_b32 v12, 96, v9
v_mfma_f32_32x32x16_bf16 a[144:159], a[188:191], a[172:175], a[144:159]
buffer_store_dwordx4 v[84:87], v17, s[8:11], s25 offen offset:1024 sc1
s_waitcnt vmcnt(24) lgkmcnt(0)
s_barrier
v_mfma_f32_32x32x16_bf16 v[160:175], a[208:211], a[192:195], v[160:175]
ds_read_b64_tr_b16 a[176:177], v13 offset:0
s_mov_b32 m0, s33
v_mfma_f32_32x32x16_bf16 v[176:191], a[208:211], a[196:199], v[176:191]
ds_read_b64_tr_b16 a[178:179], v13 offset:1024
buffer_load_dwordx4 v5, s[20:23], s31 offen offset:0 lds
v_mfma_f32_32x32x16_bf16 v[192:207], a[208:211], a[200:203], v[192:207]
ds_read_b128 a[160:163], v9 offset:0
v_mfma_f32_32x32x16_bf16 v[208:223], a[208:211], a[204:207], v[208:223]
ds_read_b128 a[164:167], v9 offset:4096
v_mfma_f32_32x32x16_bf16 v[224:239], a[212:215], a[192:195], v[224:239]
ds_read_b128 a[168:171], v9 offset:8192
v_mfma_f32_32x32x16_bf16 v[240:255], a[212:215], a[196:199], v[240:255]
ds_read_b128 a[172:175], v9 offset:12288
buffer_load_dwordx4 v6, s[20:23], s31 offen offset:1024 lds
v_mfma_f32_32x32x16_bf16 a[0:15], a[212:215], a[200:203], a[0:15]
ds_read_b64_tr_b16 a[180:181], v14 offset:0
s_add_u32 s25, s38, 51200
v_mfma_f32_32x32x16_bf16 a[16:31], a[212:215], a[204:207], a[16:31]
ds_read_b64_tr_b16 a[182:183], v14 offset:1024
buffer_store_dwordx4 v[88:91], v17, s[8:11], s25 offen offset:0 sc1
v_mfma_f32_32x32x16_bf16 a[32:47], a[216:219], a[192:195], a[32:47]
ds_read_b64_tr_b16 a[184:185], v15 offset:0
v_mfma_f32_32x32x16_bf16 a[48:63], a[216:219], a[196:199], a[48:63]
ds_read_b64_tr_b16 a[186:187], v15 offset:1024
buffer_load_dwordx4 v7, s[20:23], s31 offen offset:2048 lds
v_mfma_f32_32x32x16_bf16 a[64:79], a[216:219], a[200:203], a[64:79]
ds_read_b64_tr_b16 a[188:189], v16 offset:0
v_mfma_f32_32x32x16_bf16 a[80:95], a[216:219], a[204:207], a[80:95]
ds_read_b64_tr_b16 a[190:191], v16 offset:1024
buffer_load_dword v22, v23, s[96:99], s100 offen
s_add_u32 s100, s100, 8192
v_mfma_f32_32x32x16_bf16 a[96:111], a[220:223], a[192:195], a[96:111]
v_mfma_f32_32x32x16_bf16 a[112:127], a[220:223], a[196:199], a[112:127]
buffer_load_dwordx4 v8, s[20:23], s31 offen offset:3072 lds
v_mfma_f32_32x32x16_bf16 a[128:143], a[220:223], a[200:203], a[128:143]
s_add_u32 s31, s31, 262144
s_add_u32 s33, s33, 16384
s_and_b32 s33, s33, 65535
v_mfma_f32_32x32x16_bf16 a[144:159], a[220:223], a[204:207], a[144:159]
s_waitcnt lgkmcnt(0)
v_mfma_f32_32x32x16_bf16 v[160:175], a[176:179], a[160:163], v[160:175]
ds_read_b64_tr_b16 a[208:209], v13 offset:4096
s_add_u32 m0, s32, 0
s_mov_b32 s48, s30
v_mfma_f32_32x32x16_bf16 v[176:191], a[176:179], a[164:167], v[176:191]
ds_read_b64_tr_b16 a[210:211], v13 offset:5120
buffer_load_dwordx4 v1, s[12:15], s48 offen lds
v_mfma_f32_32x32x16_bf16 v[192:207], a[176:179], a[168:171], v[192:207]
ds_read_b128 a[192:195], v10 offset:0
v_mfma_f32_32x32x16_bf16 v[208:223], a[176:179], a[172:175], v[208:223]
ds_read_b128 a[196:199], v10 offset:4096
v_mfma_f32_32x32x16_bf16 v[224:239], a[180:183], a[160:163], v[224:239]
ds_read_b128 a[200:203], v10 offset:8192
s_add_u32 m0, s32, 4096
v_mfma_f32_32x32x16_bf16 v[240:255], a[180:183], a[164:167], v[240:255]
ds_read_b128 a[204:207], v10 offset:12288
buffer_load_dwordx4 v2, s[12:15], s48 offen lds
v_mfma_f32_32x32x16_bf16 a[0:15], a[180:183], a[168:171], a[0:15]
ds_read_b64_tr_b16 a[212:213], v14 offset:4096
s_add_u32 s25, s38, 51200
v_mfma_f32_32x32x16_bf16 a[16:31], a[180:183], a[172:175], a[16:31]
ds_read_b64_tr_b16 a[214:215], v14 offset:5120
buffer_store_dwordx4 v[92:95], v17, s[8:11], s25 offen offset:1024 sc1
v_mfma_f32_32x32x16_bf16 a[32:47], a[184:187], a[160:163], a[32:47]
ds_read_b64_tr_b16 a[216:217], v15 offset:4096
s_add_u32 m0, s32, 8192
v_mfma_f32_32x32x16_bf16 a[48:63], a[184:187], a[164:167], a[48:63]
ds_read_b64_tr_b16 a[218:219], v15 offset:5120
buffer_load_dwordx4 v3, s[12:15], s48 offen lds
v_mfma_f32_32x32x16_bf16 a[64:79], a[184:187], a[168:171], a[64:79]
ds_read_b64_tr_b16 a[220:221], v16 offset:4096
v_mfma_f32_32x32x16_bf16 a[80:95], a[184:187], a[172:175], a[80:95]
ds_read_b64_tr_b16 a[222:223], v16 offset:5120
v_add_u32 v13, 16384, v13
v_and_b32 v13, 65535, v13
v_mfma_f32_32x32x16_bf16 a[96:111], a[188:191], a[160:163], a[96:111]
s_add_u32 m0, s32, 12288
v_add_u32 v14, 16384, v14
v_and_b32 v14, 65535, v14
v_mfma_f32_32x32x16_bf16 a[112:127], a[188:191], a[164:167], a[112:127]
buffer_load_dwordx4 v4, s[12:15], s48 offen lds
v_add_u32 v15, 16384, v15
v_and_b32 v15, 65535, v15
v_mfma_f32_32x32x16_bf16 a[128:143], a[188:191], a[168:171], a[128:143]
v_add_u32 v16, 16384, v16
v_and_b32 v16, 65535, v16
v_mfma_f32_32x32x16_bf16 a[144:159], a[188:191], a[172:175], a[144:159]
s_waitcnt vmcnt(23) lgkmcnt(0)
s_barrier
v_mfma_f32_32x32x16_bf16 v[160:175], a[208:211], a[192:195], v[160:175]
ds_read_b64_tr_b16 a[176:177], v13 offset:0
s_mov_b32 m0, s33
v_mfma_f32_32x32x16_bf16 v[176:191], a[208:211], a[196:199], v[176:191]
ds_read_b64_tr_b16 a[178:179], v13 offset:1024
buffer_load_dwordx4 v5, s[20:23], s31 offen offset:0 lds
v_mfma_f32_32x32x16_bf16 v[192:207], a[208:211], a[200:203], v[192:207]
ds_read_b128 a[160:163], v11 offset:0
v_mfma_f32_32x32x16_bf16 v[208:223], a[208:211], a[204:207], v[208:223]
ds_read_b128 a[164:167], v11 offset:4096
v_mfma_f32_32x32x16_bf16 v[224:239], a[212:215], a[192:195], v[224:239]
ds_read_b128 a[168:171], v11 offset:8192
v_mfma_f32_32x32x16_bf16 v[240:255], a[212:215], a[196:199], v[240:255]
ds_read_b128 a[172:175], v11 offset:12288
buffer_load_dwordx4 v6, s[20:23], s31 offen offset:1024 lds
v_mfma_f32_32x32x16_bf16 a[0:15], a[212:215], a[200:203], a[0:15]
ds_read_b64_tr_b16 a[180:181], v14 offset:0
s_add_u32 s25, s38, 4096
v_mfma_f32_32x32x16_bf16 a[16:31], a[212:215], a[204:207], a[16:31]
ds_read_b64_tr_b16 a[182:183], v14 offset:1024
buffer_store_dwordx4 v[96:99], v17, s[8:11], s25 offen offset:0 sc1
v_mfma_f32_32x32x16_bf16 a[32:47], a[216:219], a[192:195], a[32:47]
ds_read_b64_tr_b16 a[184:185], v15 offset:0
v_mfma_f32_32x32x16_bf16 a[48:63], a[216:219], a[196:199], a[48:63]
ds_read_b64_tr_b16 a[186:187], v15 offset:1024
buffer_load_dwordx4 v7, s[20:23], s31 offen offset:2048 lds
v_mfma_f32_32x32x16_bf16 a[64:79], a[216:219], a[200:203], a[64:79]
ds_read_b64_tr_b16 a[188:189], v16 offset:0
v_mfma_f32_32x32x16_bf16 a[80:95], a[216:219], a[204:207], a[80:95]
ds_read_b64_tr_b16 a[190:191], v16 offset:1024
buffer_load_dword v22, v23, s[96:99], s100 offen
s_add_u32 s100, s100, 8192
v_mfma_f32_32x32x16_bf16 a[96:111], a[220:223], a[192:195], a[96:111]
v_mfma_f32_32x32x16_bf16 a[112:127], a[220:223], a[196:199], a[112:127]
buffer_load_dwordx4 v8, s[20:23], s31 offen offset:3072 lds
v_mfma_f32_32x32x16_bf16 a[128:143], a[220:223], a[200:203], a[128:143]
s_add_u32 s31, s31, 262144
s_add_u32 s33, s33, 16384
s_and_b32 s33, s33, 65535
s_add_u32 s25, s38, 4096
v_mfma_f32_32x32x16_bf16 a[144:159], a[220:223], a[204:207], a[144:159]
buffer_store_dwordx4 v[100:103], v17, s[8:11], s25 offen offset:1024 sc1
s_waitcnt lgkmcnt(0)
v_mfma_f32_32x32x16_bf16 v[160:175], a[176:179], a[160:163], v[160:175]
ds_read_b64_tr_b16 a[208:209], v13 offset:4096
s_add_u32 m0, s32, 16384
s_add_u32 s48, s30, s34
v_mfma_f32_32x32x16_bf16 v[176:191], a[176:179], a[164:167], v[176:191]
ds_read_b64_tr_b16 a[210:211], v13 offset:5120
buffer_load_dwordx4 v1, s[12:15], s48 offen lds
v_mfma_f32_32x32x16_bf16 v[192:207], a[176:179], a[168:171], v[192:207]
ds_read_b128 a[192:195], v12 offset:0
v_mfma_f32_32x32x16_bf16 v[208:223], a[176:179], a[172:175], v[208:223]
ds_read_b128 a[196:199], v12 offset:4096
v_mfma_f32_32x32x16_bf16 v[224:239], a[180:183], a[160:163], v[224:239]
ds_read_b128 a[200:203], v12 offset:8192
s_add_u32 m0, s32, 20480
v_mfma_f32_32x32x16_bf16 v[240:255], a[180:183], a[164:167], v[240:255]
ds_read_b128 a[204:207], v12 offset:12288
buffer_load_dwordx4 v2, s[12:15], s48 offen lds
v_mfma_f32_32x32x16_bf16 a[0:15], a[180:183], a[168:171], a[0:15]
ds_read_b64_tr_b16 a[212:213], v14 offset:4096
s_add_u32 s25, s38, 20480
v_mfma_f32_32x32x16_bf16 a[16:31], a[180:183], a[172:175], a[16:31]
ds_read_b64_tr_b16 a[214:215], v14 offset:5120
buffer_store_dwordx4 v[104:107], v17, s[8:11], s25 offen offset:0 sc1
v_mfma_f32_32x32x16_bf16 a[32:47], a[184:187], a[160:163], a[32:47]
ds_read_b64_tr_b16 a[216:217], v15 offset:4096
s_add_u32 m0, s32, 24576
v_mfma_f32_32x32x16_bf16 a[48:63], a[184:187], a[164:167], a[48:63]
ds_read_b64_tr_b16 a[218:219], v15 offset:5120
buffer_load_dwordx4 v3, s[12:15], s48 offen lds
v_mfma_f32_32x32x16_bf16 a[64:79], a[184:187], a[168:171], a[64:79]
ds_read_b64_tr_b16 a[220:221], v16 offset:4096
v_mfma_f32_32x32x16_bf16 a[80:95], a[184:187], a[172:175], a[80:95]
ds_read_b64_tr_b16 a[222:223], v16 offset:5120
v_add_u32 v9, 32768, v9
v_subrev_u32 v20, 98304, v9
v_cmp_le_u32 vcc, 163840, v9
v_add_u32 v13, 16384, v13
v_mfma_f32_32x32x16_bf16 a[96:111], a[188:191], a[160:163], a[96:111]
s_add_u32 m0, s32, 28672
v_and_b32 v13, 65535, v13
v_add_u32 v14, 16384, v14
v_and_b32 v14, 65535, v14
v_add_u32 v15, 16384, v15
v_mfma_f32_32x32x16_bf16 a[112:127], a[188:191], a[164:167], a[112:127]
buffer_load_dwordx4 v4, s[12:15], s48 offen lds
v_and_b32 v15, 65535, v15
v_add_u32 v16, 16384, v16
v_and_b32 v16, 65535, v16
v_mfma_f32_32x32x16_bf16 a[128:143], a[188:191], a[168:171], a[128:143]
s_add_u32 s30, s30, 128
s_add_u32 s32, s32, 32768
s_sub_u32 s24, s32, 98304
s_cmp_ge_u32 s32, 163840
s_cselect_b32 s32, s24, s32
v_cndmask_b32 v9, v9, v20, vcc
v_xor_b32 v10, 32, v9
v_xor_b32 v11, 64, v9
v_xor_b32 v12, 96, v9
v_mfma_f32_32x32x16_bf16 a[144:159], a[188:191], a[172:175], a[144:159]
s_waitcnt vmcnt(23) lgkmcnt(0)
s_barrier
v_mfma_f32_32x32x16_bf16 v[160:175], a[208:211], a[192:195], v[160:175]
ds_read_b64_tr_b16 a[176:177], v13 offset:0
s_mov_b32 m0, s33
v_mfma_f32_32x32x16_bf16 v[176:191], a[208:211], a[196:199], v[176:191]
ds_read_b64_tr_b16 a[178:179], v13 offset:1024
buffer_load_dwordx4 v5, s[20:23], s31 offen offset:0 lds
v_mfma_f32_32x32x16_bf16 v[192:207], a[208:211], a[200:203], v[192:207]
ds_read_b128 a[160:163], v9 offset:0
v_mfma_f32_32x32x16_bf16 v[208:223], a[208:211], a[204:207], v[208:223]
ds_read_b128 a[164:167], v9 offset:4096
v_mfma_f32_32x32x16_bf16 v[224:239], a[212:215], a[192:195], v[224:239]
ds_read_b128 a[168:171], v9 offset:8192
v_mfma_f32_32x32x16_bf16 v[240:255], a[212:215], a[196:199], v[240:255]
ds_read_b128 a[172:175], v9 offset:12288
buffer_load_dwordx4 v6, s[20:23], s31 offen offset:1024 lds
v_mfma_f32_32x32x16_bf16 a[0:15], a[212:215], a[200:203], a[0:15]
ds_read_b64_tr_b16 a[180:181], v14 offset:0
s_add_u32 s25, s38, 20480
v_mfma_f32_32x32x16_bf16 a[16:31], a[212:215], a[204:207], a[16:31]
ds_read_b64_tr_b16 a[182:183], v14 offset:1024
buffer_store_dwordx4 v[108:111], v17, s[8:11], s25 offen offset:1024 sc1
v_mfma_f32_32x32x16_bf16 a[32:47], a[216:219], a[192:195], a[32:47]
ds_read_b64_tr_b16 a[184:185], v15 offset:0
v_mfma_f32_32x32x16_bf16 a[48:63], a[216:219], a[196:199], a[48:63]
ds_read_b64_tr_b16 a[186:187], v15 offset:1024
buffer_load_dwordx4 v7, s[20:23], s31 offen offset:2048 lds
v_mfma_f32_32x32x16_bf16 a[64:79], a[216:219], a[200:203], a[64:79]
ds_read_b64_tr_b16 a[188:189], v16 offset:0
v_mfma_f32_32x32x16_bf16 a[80:95], a[216:219], a[204:207], a[80:95]
ds_read_b64_tr_b16 a[190:191], v16 offset:1024
buffer_load_dword v22, v23, s[96:99], s100 offen
s_add_u32 s100, s100, 8192
v_mfma_f32_32x32x16_bf16 a[96:111], a[220:223], a[192:195], a[96:111]
v_mfma_f32_32x32x16_bf16 a[112:127], a[220:223], a[196:199], a[112:127]
buffer_load_dwordx4 v8, s[20:23], s31 offen offset:3072 lds
v_mfma_f32_32x32x16_bf16 a[128:143], a[220:223], a[200:203], a[128:143]
s_add_u32 s31, s31, 262144
s_add_u32 s33, s33, 16384
s_and_b32 s33, s33, 65535
v_mfma_f32_32x32x16_bf16 a[144:159], a[220:223], a[204:207], a[144:159]
s_waitcnt lgkmcnt(0)
v_mfma_f32_32x32x16_bf16 v[160:175], a[176:179], a[160:163], v[160:175]
ds_read_b64_tr_b16 a[208:209], v13 offset:4096
s_add_u32 m0, s32, 0
s_mov_b32 s48, s30
v_mfma_f32_32x32x16_bf16 v[176:191], a[176:179], a[164:167], v[176:191]
ds_read_b64_tr_b16 a[210:211], v13 offset:5120
buffer_load_dwordx4 v1, s[12:15], s48 offen lds
v_mfma_f32_32x32x16_bf16 v[192:207], a[176:179], a[168:171], v[192:207]
ds_read_b128 a[192:195], v10 offset:0
v_mfma_f32_32x32x16_bf16 v[208:223], a[176:179], a[172:175], v[208:223]
ds_read_b128 a[196:199], v10 offset:4096
v_mfma_f32_32x32x16_bf16 v[224:239], a[180:183], a[160:163], v[224:239]
ds_read_b128 a[200:203], v10 offset:8192
s_add_u32 m0, s32, 4096
v_mfma_f32_32x32x16_bf16 v[240:255], a[180:183], a[164:167], v[240:255]
ds_read_b128 a[204:207], v10 offset:12288
buffer_load_dwordx4 v2, s[12:15], s48 offen lds
v_mfma_f32_32x32x16_bf16 a[0:15], a[180:183], a[168:171], a[0:15]
ds_read_b64_tr_b16 a[212:213], v14 offset:4096
s_add_u32 s25, s38, 36864
v_mfma_f32_32x32x16_bf16 a[16:31], a[180:183], a[172:175], a[16:31]
ds_read_b64_tr_b16 a[214:215], v14 offset:5120
buffer_store_dwordx4 v[112:115], v17, s[8:11], s25 offen offset:0 sc1
v_mfma_f32_32x32x16_bf16 a[32:47], a[184:187], a[160:163], a[32:47]
ds_read_b64_tr_b16 a[216:217], v15 offset:4096
s_add_u32 m0, s32, 8192
v_mfma_f32_32x32x16_bf16 a[48:63], a[184:187], a[164:167], a[48:63]
ds_read_b64_tr_b16 a[218:219], v15 offset:5120
buffer_load_dwordx4 v3, s[12:15], s48 offen lds
v_mfma_f32_32x32x16_bf16 a[64:79], a[184:187], a[168:171], a[64:79]
ds_read_b64_tr_b16 a[220:221], v16 offset:4096
v_mfma_f32_32x32x16_bf16 a[80:95], a[184:187], a[172:175], a[80:95]
ds_read_b64_tr_b16 a[222:223], v16 offset:5120
v_add_u32 v13, 16384, v13
v_and_b32 v13, 65535, v13
v_mfma_f32_32x32x16_bf16 a[96:111], a[188:191], a[160:163], a[96:111]
s_add_u32 m0, s32, 12288
v_add_u32 v14, 16384, v14
v_and_b32 v14, 65535, v14
v_mfma_f32_32x32x16_bf16 a[112:127], a[188:191], a[164:167], a[112:127]
buffer_load_dwordx4 v4, s[12:15], s48 offen lds
v_add_u32 v15, 16384, v15
v_and_b32 v15, 65535, v15
v_mfma_f32_32x32x16_bf16 a[128:143], a[188:191], a[168:171], a[128:143]
s_add_u32 s25, s38, 36864
v_add_u32 v16, 16384, v16
v_and_b32 v16, 65535, v16
v_mfma_f32_32x32x16_bf16 a[144:159], a[188:191], a[172:175], a[144:159]
buffer_store_dwordx4 v[116:119], v17, s[8:11], s25 offen offset:1024 sc1
s_waitcnt vmcnt(24) lgkmcnt(0)
s_barrier
v_mfma_f32_32x32x16_bf16 v[160:175], a[208:211], a[192:195], v[160:175]
ds_read_b64_tr_b16 a[176:177], v13 offset:0
s_mov_b32 m0, s33
v_mfma_f32_32x32x16_bf16 v[176:191], a[208:211], a[196:199], v[176:191]
ds_read_b64_tr_b16 a[178:179], v13 offset:1024
buffer_load_dwordx4 v5, s[20:23], s31 offen offset:0 lds
v_mfma_f32_32x32x16_bf16 v[192:207], a[208:211], a[200:203], v[192:207]
ds_read_b128 a[160:163], v11 offset:0
v_mfma_f32_32x32x16_bf16 v[208:223], a[208:211], a[204:207], v[208:223]
ds_read_b128 a[164:167], v11 offset:4096
v_mfma_f32_32x32x16_bf16 v[224:239], a[212:215], a[192:195], v[224:239]
ds_read_b128 a[168:171], v11 offset:8192
v_mfma_f32_32x32x16_bf16 v[240:255], a[212:215], a[196:199], v[240:255]
ds_read_b128 a[172:175], v11 offset:12288
buffer_load_dwordx4 v6, s[20:23], s31 offen offset:1024 lds
v_mfma_f32_32x32x16_bf16 a[0:15], a[212:215], a[200:203], a[0:15]
ds_read_b64_tr_b16 a[180:181], v14 offset:0
s_add_u32 s25, s38, 53248
v_mfma_f32_32x32x16_bf16 a[16:31], a[212:215], a[204:207], a[16:31]
ds_read_b64_tr_b16 a[182:183], v14 offset:1024
buffer_store_dwordx4 v[120:123], v17, s[8:11], s25 offen offset:0 sc1
v_mfma_f32_32x32x16_bf16 a[32:47], a[216:219], a[192:195], a[32:47]
ds_read_b64_tr_b16 a[184:185], v15 offset:0
v_mfma_f32_32x32x16_bf16 a[48:63], a[216:219], a[196:199], a[48:63]
ds_read_b64_tr_b16 a[186:187], v15 offset:1024
buffer_load_dwordx4 v7, s[20:23], s31 offen offset:2048 lds
v_mfma_f32_32x32x16_bf16 a[64:79], a[216:219], a[200:203], a[64:79]
ds_read_b64_tr_b16 a[188:189], v16 offset:0
v_mfma_f32_32x32x16_bf16 a[80:95], a[216:219], a[204:207], a[80:95]
ds_read_b64_tr_b16 a[190:191], v16 offset:1024
buffer_load_dword v22, v23, s[96:99], s100 offen
s_add_u32 s100, s100, 8192
v_mfma_f32_32x32x16_bf16 a[96:111], a[220:223], a[192:195], a[96:111]
v_mfma_f32_32x32x16_bf16 a[112:127], a[220:223], a[196:199], a[112:127]
buffer_load_dwordx4 v8, s[20:23], s31 offen offset:3072 lds
v_mfma_f32_32x32x16_bf16 a[128:143], a[220:223], a[200:203], a[128:143]
s_add_u32 s31, s31, 262144
s_add_u32 s33, s33, 16384
s_and_b32 s33, s33, 65535
v_mfma_f32_32x32x16_bf16 a[144:159], a[220:223], a[204:207], a[144:159]
s_waitcnt lgkmcnt(0)
v_mfma_f32_32x32x16_bf16 v[160:175], a[176:179], a[160:163], v[160:175]
ds_read_b64_tr_b16 a[208:209], v13 offset:4096
s_add_u32 m0, s32, 16384
s_add_u32 s48, s30, s34
v_mfma_f32_32x32x16_bf16 v[176:191], a[176:179], a[164:167], v[176:191]
ds_read_b64_tr_b16 a[210:211], v13 offset:5120
buffer_load_dwordx4 v1, s[12:15], s48 offen lds
v_mfma_f32_32x32x16_bf16 v[192:207], a[176:179], a[168:171], v[192:207]
ds_read_b128 a[192:195], v12 offset:0
v_mfma_f32_32x32x16_bf16 v[208:223], a[176:179], a[172:175], v[208:223]
ds_read_b128 a[196:199], v12 offset:4096
v_mfma_f32_32x32x16_bf16 v[224:239], a[180:183], a[160:163], v[224:239]
ds_read_b128 a[200:203], v12 offset:8192
s_add_u32 m0, s32, 20480
v_mfma_f32_32x32x16_bf16 v[240:255], a[180:183], a[164:167], v[240:255]
ds_read_b128 a[204:207], v12 offset:12288
buffer_load_dwordx4 v2, s[12:15], s48 offen lds
v_mfma_f32_32x32x16_bf16 a[0:15], a[180:183], a[168:171], a[0:15]
ds_read_b64_tr_b16 a[212:213], v14 offset:4096
s_add_u32 s25, s38, 53248
v_mfma_f32_32x32x16_bf16 a[16:31], a[180:183], a[172:175], a[16:31]
ds_read_b64_tr_b16 a[214:215], v14 offset:5120
buffer_store_dwordx4 v[124:127], v17, s[8:11], s25 offen offset:1024 sc1
v_mfma_f32_32x32x16_bf16 a[32:47], a[184:187], a[160:163], a[32:47]
ds_read_b64_tr_b16 a[216:217], v15 offset:4096
s_add_u32 m0, s32, 24576
v_mfma_f32_32x32x16_bf16 a[48:63], a[184:187], a[164:167], a[48:63]
ds_read_b64_tr_b16 a[218:219], v15 offset:5120
buffer_load_dwordx4 v3, s[12:15], s48 offen lds
v_mfma_f32_32x32x16_bf16 a[64:79], a[184:187], a[168:171], a[64:79]
ds_read_b64_tr_b16 a[220:221], v16 offset:4096
v_mfma_f32_32x32x16_bf16 a[80:95], a[184:187], a[172:175], a[80:95]
ds_read_b64_tr_b16 a[222:223], v16 offset:5120
v_add_u32 v9, 32768, v9
v_subrev_u32 v20, 98304, v9
v_cmp_le_u32 vcc, 163840, v9
v_add_u32 v13, 16384, v13
v_mfma_f32_32x32x16_bf16 a[96:111], a[188:191], a[160:163], a[96:111]
s_add_u32 m0, s32, 28672
v_and_b32 v13, 65535, v13
v_add_u32 v14, 16384, v14
v_and_b32 v14, 65535, v14
v_add_u32 v15, 16384, v15
v_mfma_f32_32x32x16_bf16 a[112:127], a[188:191], a[164:167], a[112:127]
buffer_load_dwordx4 v4, s[12:15], s48 offen lds
v_and_b32 v15, 65535, v15
v_add_u32 v16, 16384, v16
v_and_b32 v16, 65535, v16
v_mfma_f32_32x32x16_bf16 a[128:143], a[188:191], a[168:171], a[128:143]
s_add_u32 s30, s30, 128
s_add_u32 s32, s32, 32768
s_sub_u32 s24, s32, 98304
s_cmp_ge_u32 s32, 163840
s_cselect_b32 s32, s24, s32
v_cndmask_b32 v9, v9, v20, vcc
v_xor_b32 v10, 32, v9
v_xor_b32 v11, 64, v9
v_xor_b32 v12, 96, v9
v_mfma_f32_32x32x16_bf16 a[144:159], a[188:191], a[172:175], a[144:159]
s_waitcnt vmcnt(23) lgkmcnt(0)
s_barrier
v_mfma_f32_32x32x16_bf16 v[160:175], a[208:211], a[192:195], v[160:175]
ds_read_b64_tr_b16 a[176:177], v13 offset:0
s_mov_b32 m0, s33
v_mfma_f32_32x32x16_bf16 v[176:191], a[208:211], a[196:199], v[176:191]
ds_read_b64_tr_b16 a[178:179], v13 offset:1024
buffer_load_dwordx4 v5, s[20:23], s31 offen offset:0 lds
v_mfma_f32_32x32x16_bf16 v[192:207], a[208:211], a[200:203], v[192:207]
ds_read_b128 a[160:163], v9 offset:0
v_mfma_f32_32x32x16_bf16 v[208:223], a[208:211], a[204:207], v[208:223]
ds_read_b128 a[164:167], v9 offset:4096
v_mfma_f32_32x32x16_bf16 v[224:239], a[212:215], a[192:195], v[224:239]
ds_read_b128 a[168:171], v9 offset:8192
v_mfma_f32_32x32x16_bf16 v[240:255], a[212:215], a[196:199], v[240:255]
ds_read_b128 a[172:175], v9 offset:12288
buffer_load_dwordx4 v6, s[20:23], s31 offen offset:1024 lds
v_mfma_f32_32x32x16_bf16 a[0:15], a[212:215], a[200:203], a[0:15]
ds_read_b64_tr_b16 a[180:181], v14 offset:0
s_add_u32 s25, s38, 6144
v_mfma_f32_32x32x16_bf16 a[16:31], a[212:215], a[204:207], a[16:31]
ds_read_b64_tr_b16 a[182:183], v14 offset:1024
buffer_store_dwordx4 v[128:131], v17, s[8:11], s25 offen offset:0 sc1
v_mfma_f32_32x32x16_bf16 a[32:47], a[216:219], a[192:195], a[32:47]
ds_read_b64_tr_b16 a[184:185], v15 offset:0
v_mfma_f32_32x32x16_bf16 a[48:63], a[216:219], a[196:199], a[48:63]
ds_read_b64_tr_b16 a[186:187], v15 offset:1024
buffer_load_dwordx4 v7, s[20:23], s31 offen offset:2048 lds
v_mfma_f32_32x32x16_bf16 a[64:79], a[216:219], a[200:203], a[64:79]
ds_read_b64_tr_b16 a[188:189], v16 offset:0
v_mfma_f32_32x32x16_bf16 a[80:95], a[216:219], a[204:207], a[80:95]
ds_read_b64_tr_b16 a[190:191], v16 offset:1024
v_mfma_f32_32x32x16_bf16 a[96:111], a[220:223], a[192:195], a[96:111]
v_mfma_f32_32x32x16_bf16 a[112:127], a[220:223], a[196:199], a[112:127]
buffer_load_dwordx4 v8, s[20:23], s31 offen offset:3072 lds
v_mfma_f32_32x32x16_bf16 a[128:143], a[220:223], a[200:203], a[128:143]
s_add_u32 s31, s31, 262144
s_add_u32 s33, s33, 16384
s_and_b32 s33, s33, 65535
s_add_u32 s25, s38, 6144
v_mfma_f32_32x32x16_bf16 a[144:159], a[220:223], a[204:207], a[144:159]
buffer_store_dwordx4 v[132:135], v17, s[8:11], s25 offen offset:1024 sc1
s_cmp_eq_u32 s36, 0
s_cbranch_scc1 L_g_k6
s_waitcnt lgkmcnt(0)
v_mfma_f32_32x32x16_bf16 v[160:175], a[176:179], a[160:163], v[160:175]
ds_read_b64_tr_b16 a[208:209], v13 offset:4096
s_add_u32 m0, s32, 0
s_mov_b32 s48, s30
v_mfma_f32_32x32x16_bf16 v[176:191], a[176:179], a[164:167], v[176:191]
ds_read_b64_tr_b16 a[210:211], v13 offset:5120
buffer_load_dwordx4 v1, s[12:15], s48 offen lds
v_mfma_f32_32x32x16_bf16 v[192:207], a[176:179], a[168:171], v[192:207]
ds_read_b128 a[192:195], v10 offset:0
v_mfma_f32_32x32x16_bf16 v[208:223], a[176:179], a[172:175], v[208:223]
ds_read_b128 a[196:199], v10 offset:4096
v_mfma_f32_32x32x16_bf16 v[224:239], a[180:183], a[160:163], v[224:239]
ds_read_b128 a[200:203], v10 offset:8192
s_add_u32 m0, s32, 4096
v_mfma_f32_32x32x16_bf16 v[240:255], a[180:183], a[164:167], v[240:255]
ds_read_b128 a[204:207], v10 offset:12288
buffer_load_dwordx4 v2, s[12:15], s48 offen lds
v_mfma_f32_32x32x16_bf16 a[0:15], a[180:183], a[168:171], a[0:15]
ds_read_b64_tr_b16 a[212:213], v14 offset:4096
v_mfma_f32_32x32x16_bf16 a[16:31], a[180:183], a[172:175], a[16:31]
ds_read_b64_tr_b16 a[214:215], v14 offset:5120
v_mfma_f32_32x32x16_bf16 a[32:47], a[184:187], a[160:163], a[32:47]
ds_read_b64_tr_b16 a[216:217], v15 offset:4096
s_add_u32 m0, s32, 8192
v_mfma_f32_32x32x16_bf16 a[48:63], a[184:187], a[164:167], a[48:63]
ds_read_b64_tr_b16 a[218:219], v15 offset:5120
buffer_load_dwordx4 v3, s[12:15], s48 offen lds
v_mfma_f32_32x32x16_bf16 a[64:79], a[184:187], a[168:171], a[64:79]
ds_read_b64_tr_b16 a[220:221], v16 offset:4096
v_mfma_f32_32x32x16_bf16 a[80:95], a[184:187], a[172:175], a[80:95]
ds_read_b64_tr_b16 a[222:223], v16 offset:5120
v_add_u32 v13, 16384, v13
v_and_b32 v13, 65535, v13
v_mfma_f32_32x32x16_bf16 a[96:111], a[188:191], a[160:163], a[96:111]
s_add_u32 m0, s32, 12288
v_add_u32 v14, 16384, v14
v_and_b32 v14, 65535, v14
v_mfma_f32_32x32x16_bf16 a[112:127], a[188:191], a[164:167], a[112:127]
buffer_load_dwordx4 v4, s[12:15], s48 offen lds
v_add_u32 v15, 16384, v15
v_and_b32 v15, 65535, v15
v_mfma_f32_32x32x16_bf16 a[128:143], a[188:191], a[168:171], a[128:143]
v_add_u32 v16, 16384, v16
v_and_b32 v16, 65535, v16
v_mfma_f32_32x32x16_bf16 a[144:159], a[188:191], a[172:175], a[144:159]
s_waitcnt vmcnt(21) lgkmcnt(0)
s_barrier
v_mfma_f32_32x32x16_bf16 v[160:175], a[208:211], a[192:195], v[160:175]
ds_read_b64_tr_b16 a[176:177], v13 offset:0
s_mov_b32 m0, s33
v_mfma_f32_32x32x16_bf16 v[176:191], a[208:211], a[196:199], v[176:191]
ds_read_b64_tr_b16 a[178:179], v13 offset:1024
buffer_load_dwordx4 v5, s[20:23], s31 offen offset:0 lds
v_mfma_f32_32x32x16_bf16 v[192:207], a[208:211], a[200:203], v[192:207]
ds_read_b128 a[160:163], v11 offset:0
v_mfma_f32_32x32x16_bf16 v[208:223], a[208:211], a[204:207], v[208:223]
ds_read_b128 a[164:167], v11 offset:4096
v_mfma_f32_32x32x16_bf16 v[224:239], a[212:215], a[192:195], v[224:239]
ds_read_b128 a[168:171], v11 offset:8192
v_mfma_f32_32x32x16_bf16 v[240:255], a[212:215], a[196:199], v[240:255]
ds_read_b128 a[172:175], v11 offset:12288
buffer_load_dwordx4 v6, s[20:23], s31 offen offset:1024 lds
v_mfma_f32_32x32x16_bf16 a[0:15], a[212:215], a[200:203], a[0:15]
ds_read_b64_tr_b16 a[180:181], v14 offset:0
v_mfma_f32_32x32x16_bf16 a[16:31], a[212:215], a[204:207], a[16:31]
ds_read_b64_tr_b16 a[182:183], v14 offset:1024
v_mfma_f32_32x32x16_bf16 a[32:47], a[216:219], a[192:195], a[32:47]
ds_read_b64_tr_b16 a[184:185], v15 offset:0
v_mfma_f32_32x32x16_bf16 a[48:63], a[216:219], a[196:199], a[48:63]
ds_read_b64_tr_b16 a[186:187], v15 offset:1024
buffer_load_dwordx4 v7, s[20:23], s31 offen offset:2048 lds
v_mfma_f32_32x32x16_bf16 a[64:79], a[216:219], a[200:203], a[64:79]
ds_read_b64_tr_b16 a[188:189], v16 offset:0
v_mfma_f32_32x32x16_bf16 a[80:95], a[216:219], a[204:207], a[80:95]
ds_read_b64_tr_b16 a[190:191], v16 offset:1024
v_mfma_f32_32x32x16_bf16 a[96:111], a[220:223], a[192:195], a[96:111]
v_mfma_f32_32x32x16_bf16 a[112:127], a[220:223], a[196:199], a[112:127]
buffer_load_dwordx4 v8, s[20:23], s31 offen offset:3072 lds
v_mfma_f32_32x32x16_bf16 a[128:143], a[220:223], a[200:203], a[128:143]
s_add_u32 s31, s31, 262144
s_add_u32 s33, s33, 16384
s_and_b32 s33, s33, 65535
v_mfma_f32_32x32x16_bf16 a[144:159], a[220:223], a[204:207], a[144:159]
s_waitcnt lgkmcnt(0)
v_mfma_f32_32x32x16_bf16 v[160:175], a[176:179], a[160:163], v[160:175]
ds_read_b64_tr_b16 a[208:209], v13 offset:4096
s_add_u32 m0, s32, 16384
s_add_u32 s48, s30, s34
v_mfma_f32_32x32x16_bf16 v[176:191], a[176:179], a[164:167], v[176:191]
ds_read_b64_tr_b16 a[210:211], v13 offset:5120
buffer_load_dwordx4 v1, s[12:15], s48 offen lds
v_mfma_f32_32x32x16_bf16 v[192:207], a[176:179], a[168:171], v[192:207]
ds_read_b128 a[192:195], v12 offset:0
v_mfma_f32_32x32x16_bf16 v[208:223], a[176:179], a[172:175], v[208:223]
ds_read_b128 a[196:199], v12 offset:4096
v_mfma_f32_32x32x16_bf16 v[224:239], a[180:183], a[160:163], v[224:239]
ds_read_b128 a[200:203], v12 offset:8192
s_add_u32 m0, s32, 20480
v_mfma_f32_32x32x16_bf16 v[240:255], a[180:183], a[164:167], v[240:255]
ds_read_b128 a[204:207], v12 offset:12288
buffer_load_dwordx4 v2, s[12:15], s48 offen lds
v_mfma_f32_32x32x16_bf16 a[0:15], a[180:183], a[168:171], a[0:15]
ds_read_b64_tr_b16 a[212:213], v14 offset:4096
v_mfma_f32_32x32x16_bf16 a[16:31], a[180:183], a[172:175], a[16:31]
ds_read_b64_tr_b16 a[214:215], v14 offset:5120
v_mfma_f32_32x32x16_bf16 a[32:47], a[184:187], a[160:163], a[32:47]
ds_read_b64_tr_b16 a[216:217], v15 offset:4096
s_add_u32 m0, s32, 24576
v_mfma_f32_32x32x16_bf16 a[48:63], a[184:187], a[164:167], a[48:63]
ds_read_b64_tr_b16 a[218:219], v15 offset:5120
buffer_load_dwordx4 v3, s[12:15], s48 offen lds
v_mfma_f32_32x32x16_bf16 a[64:79], a[184:187], a[168:171], a[64:79]
ds_read_b64_tr_b16 a[220:221], v16 offset:4096
v_mfma_f32_32x32x16_bf16 a[80:95], a[184:187], a[172:175], a[80:95]
ds_read_b64_tr_b16 a[222:223], v16 offset:5120
v_add_u32 v9, 32768, v9
v_subrev_u32 v20, 98304, v9
v_cmp_le_u32 vcc, 163840, v9
v_add_u32 v13, 16384, v13
v_mfma_f32_32x32x16_bf16 a[96:111], a[188:191], a[160:163], a[96:111]
s_add_u32 m0, s32, 28672
v_and_b32 v13, 65535, v13
v_add_u32 v14, 16384, v14
v_and_b32 v14, 65535, v14
v_add_u32 v15, 16384, v15
v_mfma_f32_32x32x16_bf16 a[112:127], a[188:191], a[164:167], a[112:127]
buffer_load_dwordx4 v4, s[12:15], s48 offen lds
v_and_b32 v15, 65535, v15
v_add_u32 v16, 16384, v16
v_and_b32 v16, 65535, v16
v_mfma_f32_32x32x16_bf16 a[128:143], a[188:191], a[168:171], a[128:143]
s_add_u32 s30, s30, 128
s_add_u32 s32, s32, 32768
s_sub_u32 s24, s32, 98304
s_cmp_ge_u32 s32, 163840
s_cselect_b32 s32, s24, s32
v_cndmask_b32 v9, v9, v20, vcc
v_xor_b32 v10, 32, v9
v_xor_b32 v11, 64, v9
v_xor_b32 v12, 96, v9
v_mfma_f32_32x32x16_bf16 a[144:159], a[188:191], a[172:175], a[144:159]
s_waitcnt vmcnt(18) lgkmcnt(0)
s_barrier
v_mfma_f32_32x32x16_bf16 v[160:175], a[208:211], a[192:195], v[160:175]
ds_read_b64_tr_b16 a[176:177], v13 offset:0
s_mov_b32 m0, s33
v_mfma_f32_32x32x16_bf16 v[176:191], a[208:211], a[196:199], v[176:191]
ds_read_b64_tr_b16 a[178:179], v13 offset:1024
buffer_load_dwordx4 v5, s[20:23], s31 offen offset:0 lds
v_mfma_f32_32x32x16_bf16 v[192:207], a[208:211], a[200:203], v[192:207]
ds_read_b128 a[160:163], v9 offset:0
v_mfma_f32_32x32x16_bf16 v[208:223], a[208:211], a[204:207], v[208:223]
ds_read_b128 a[164:167], v9 offset:4096
v_mfma_f32_32x32x16_bf16 v[224:239], a[212:215], a[192:195], v[224:239]
ds_read_b128 a[168:171], v9 offset:8192
v_mfma_f32_32x32x16_bf16 v[240:255], a[212:215], a[196:199], v[240:255]
ds_read_b128 a[172:175], v9 offset:12288
buffer_load_dwordx4 v6, s[20:23], s31 offen offset:1024 lds
v_mfma_f32_32x32x16_bf16 a[0:15], a[212:215], a[200:203], a[0:15]
ds_read_b64_tr_b16 a[180:181], v14 offset:0
v_mfma_f32_32x32x16_bf16 a[16:31], a[212:215], a[204:207], a[16:31]
ds_read_b64_tr_b16 a[182:183], v14 offset:1024
v_mfma_f32_32x32x16_bf16 a[32:47], a[216:219], a[192:195], a[32:47]
ds_read_b64_tr_b16 a[184:185], v15 offset:0
v_mfma_f32_32x32x16_bf16 a[48:63], a[216:219], a[196:199], a[48:63]
ds_read_b64_tr_b16 a[186:187], v15 offset:1024
buffer_load_dwordx4 v7, s[20:23], s31 offen offset:2048 lds
v_mfma_f32_32x32x16_bf16 a[64:79], a[216:219], a[200:203], a[64:79]
ds_read_b64_tr_b16 a[188:189], v16 offset:0
v_mfma_f32_32x32x16_bf16 a[80:95], a[216:219], a[204:207], a[80:95]
ds_read_b64_tr_b16 a[190:191], v16 offset:1024
v_mfma_f32_32x32x16_bf16 a[96:111], a[220:223], a[192:195], a[96:111]
v_mfma_f32_32x32x16_bf16 a[112:127], a[220:223], a[196:199], a[112:127]
buffer_load_dwordx4 v8, s[20:23], s31 offen offset:3072 lds
v_mfma_f32_32x32x16_bf16 a[128:143], a[220:223], a[200:203], a[128:143]
s_add_u32 s31, s31, 262144
s_add_u32 s33, s33, 16384
s_and_b32 s33, s33, 65535
v_mfma_f32_32x32x16_bf16 a[144:159], a[220:223], a[204:207], a[144:159]
L_g_k6:
s_waitcnt lgkmcnt(0)
v_mfma_f32_32x32x16_bf16 v[160:175], a[176:179], a[160:163], v[160:175]
ds_read_b64_tr_b16 a[208:209], v13 offset:4096
s_add_u32 m0, s32, 0
s_mov_b32 s48, s30
v_mfma_f32_32x32x16_bf16 v[176:191], a[176:179], a[164:167], v[176:191]
ds_read_b64_tr_b16 a[210:211], v13 offset:5120
buffer_load_dwordx4 v1, s[12:15], s48 offen lds
v_mfma_f32_32x32x16_bf16 v[192:207], a[176:179], a[168:171], v[192:207]
ds_read_b128 a[192:195], v10 offset:0
v_mfma_f32_32x32x16_bf16 v[208:223], a[176:179], a[172:175], v[208:223]
ds_read_b128 a[196:199], v10 offset:4096
v_mfma_f32_32x32x16_bf16 v[224:239], a[180:183], a[160:163], v[224:239]
ds_read_b128 a[200:203], v10 offset:8192
s_add_u32 m0, s32, 4096
v_mfma_f32_32x32x16_bf16 v[240:255], a[180:183], a[164:167], v[240:255]
ds_read_b128 a[204:207], v10 offset:12288
buffer_load_dwordx4 v2, s[12:15], s48 offen lds
v_mfma_f32_32x32x16_bf16 a[0:15], a[180:183], a[168:171], a[0:15]
ds_read_b64_tr_b16 a[212:213], v14 offset:4096
s_add_u32 s25, s38, 22528
v_mfma_f32_32x32x16_bf16 a[16:31], a[180:183], a[172:175], a[16:31]
ds_read_b64_tr_b16 a[214:215], v14 offset:5120
buffer_store_dwordx4 v[136:139], v17, s[8:11], s25 offen offset:0 sc1
v_mfma_f32_32x32x16_bf16 a[32:47], a[184:187], a[160:163], a[32:47]
ds_read_b64_tr_b16 a[216:217], v15 offset:4096
s_add_u32 m0, s32, 8192
v_mfma_f32_32x32x16_bf16 a[48:63], a[184:187], a[164:167], a[48:63]
ds_read_b64_tr_b16 a[218:219], v15 offset:5120
buffer_load_dwordx4 v3, s[12:15], s48 offen lds
v_mfma_f32_32x32x16_bf16 a[64:79], a[184:187], a[168:171], a[64:79]
ds_read_b64_tr_b16 a[220:221], v16 offset:4096
v_mfma_f32_32x32x16_bf16 a[80:95], a[184:187], a[172:175], a[80:95]
ds_read_b64_tr_b16 a[222:223], v16 offset:5120
v_add_u32 v13, 16384, v13
v_and_b32 v13, 65535, v13
v_mfma_f32_32x32x16_bf16 a[96:111], a[188:191], a[160:163], a[96:111]
s_add_u32 m0, s32, 12288
v_add_u32 v14, 16384, v14
v_and_b32 v14, 65535, v14
v_mfma_f32_32x32x16_bf16 a[112:127], a[188:191], a[164:167], a[112:127]
buffer_load_dwordx4 v4, s[12:15], s48 offen lds
v_add_u32 v15, 16384, v15
v_and_b32 v15, 65535, v15
v_mfma_f32_32x32x16_bf16 a[128:143], a[188:191], a[168:171], a[128:143]
v_add_u32 v16, 16384, v16
v_and_b32 v16, 65535, v16
v_mfma_f32_32x32x16_bf16 a[144:159], a[188:191], a[172:175], a[144:159]
s_waitcnt vmcnt(17) lgkmcnt(0)
s_barrier
v_mfma_f32_32x32x16_bf16 v[160:175], a[208:211], a[192:195], v[160:175]
ds_read_b64_tr_b16 a[176:177], v13 offset:0
s_mov_b32 m0, s33
v_mfma_f32_32x32x16_bf16 v[176:191], a[208:211], a[196:199], v[176:191]
ds_read_b64_tr_b16 a[178:179], v13 offset:1024
buffer_load_dwordx4 v5, s[20:23], s31 offen offset:0 lds
v_mfma_f32_32x32x16_bf16 v[192:207], a[208:211], a[200:203], v[192:207]
ds_read_b128 a[160:163], v11 offset:0
v_mfma_f32_32x32x16_bf16 v[208:223], a[208:211], a[204:207], v[208:223]
ds_read_b128 a[164:167], v11 offset:4096
v_mfma_f32_32x32x16_bf16 v[224:239], a[212:215], a[192:195], v[224:239]
ds_read_b128 a[168:171], v11 offset:8192
v_mfma_f32_32x32x16_bf16 v[240:255], a[212:215], a[196:199], v[240:255]
ds_read_b128 a[172:175], v11 offset:12288
buffer_load_dwordx4 v6, s[20:23], s31 offen offset:1024 lds
v_mfma_f32_32x32x16_bf16 a[0:15], a[212:215], a[200:203], a[0:15]
ds_read_b64_tr_b16 a[180:181], v14 offset:0
s_add_u32 s25, s38, 22528
v_mfma_f32_32x32x16_bf16 a[16:31], a[212:215], a[204:207], a[16:31]
ds_read_b64_tr_b16 a[182:183], v14 offset:1024
buffer_store_dwordx4 v[140:143], v17, s[8:11], s25 offen offset:1024 sc1
v_mfma_f32_32x32x16_bf16 a[32:47], a[216:219], a[192:195], a[32:47]
ds_read_b64_tr_b16 a[184:185], v15 offset:0
v_mfma_f32_32x32x16_bf16 a[48:63], a[216:219], a[196:199], a[48:63]
ds_read_b64_tr_b16 a[186:187], v15 offset:1024
buffer_load_dwordx4 v7, s[20:23], s31 offen offset:2048 lds
v_mfma_f32_32x32x16_bf16 a[64:79], a[216:219], a[200:203], a[64:79]
ds_read_b64_tr_b16 a[188:189], v16 offset:0
v_mfma_f32_32x32x16_bf16 a[80:95], a[216:219], a[204:207], a[80:95]
ds_read_b64_tr_b16 a[190:191], v16 offset:1024
v_mfma_f32_32x32x16_bf16 a[96:111], a[220:223], a[192:195], a[96:111]
v_mfma_f32_32x32x16_bf16 a[112:127], a[220:223], a[196:199], a[112:127]
buffer_load_dwordx4 v8, s[20:23], s31 offen offset:3072 lds
v_mfma_f32_32x32x16_bf16 a[128:143], a[220:223], a[200:203], a[128:143]
s_add_u32 s31, s31, 262144
s_add_u32 s33, s33, 16384
s_and_b32 s33, s33, 65535
v_mfma_f32_32x32x16_bf16 a[144:159], a[220:223], a[204:207], a[144:159]
s_waitcnt lgkmcnt(0)
v_mfma_f32_32x32x16_bf16 v[160:175], a[176:179], a[160:163], v[160:175]
ds_read_b64_tr_b16 a[208:209], v13 offset:4096
s_add_u32 m0, s32, 16384
s_add_u32 s48, s30, s34
v_mfma_f32_32x32x16_bf16 v[176:191], a[176:179], a[164:167], v[176:191]
ds_read_b64_tr_b16 a[210:211], v13 offset:5120
buffer_load_dwordx4 v1, s[12:15], s48 offen lds
v_mfma_f32_32x32x16_bf16 v[192:207], a[176:179], a[168:171], v[192:207]
ds_read_b128 a[192:195], v12 offset:0
v_mfma_f32_32x32x16_bf16 v[208:223], a[176:179], a[172:175], v[208:223]
ds_read_b128 a[196:199], v12 offset:4096
v_mfma_f32_32x32x16_bf16 v[224:239], a[180:183], a[160:163], v[224:239]
ds_read_b128 a[200:203], v12 offset:8192
s_add_u32 m0, s32, 20480
v_mfma_f32_32x32x16_bf16 v[240:255], a[180:183], a[164:167], v[240:255]
ds_read_b128 a[204:207], v12 offset:12288
buffer_load_dwordx4 v2, s[12:15], s48 offen lds
v_mfma_f32_32x32x16_bf16 a[0:15], a[180:183], a[168:171], a[0:15]
ds_read_b64_tr_b16 a[212:213], v14 offset:4096
s_add_u32 s25, s38, 38912
v_mfma_f32_32x32x16_bf16 a[16:31], a[180:183], a[172:175], a[16:31]
ds_read_b64_tr_b16 a[214:215], v14 offset:5120
buffer_store_dwordx4 v[144:147], v17, s[8:11], s25 offen offset:0 sc1
v_mfma_f32_32x32x16_bf16 a[32:47], a[184:187], a[160:163], a[32:47]
ds_read_b64_tr_b16 a[216:217], v15 offset:4096
s_add_u32 m0, s32, 24576
v_mfma_f32_32x32x16_bf16 a[48:63], a[184:187], a[164:167], a[48:63]
ds_read_b64_tr_b16 a[218:219], v15 offset:5120
buffer_load_dwordx4 v3, s[12:15], s48 offen lds
v_mfma_f32_32x32x16_bf16 a[64:79], a[184:187], a[168:171], a[64:79]
ds_read_b64_tr_b16 a[220:221], v16 offset:4096
v_mfma_f32_32x32x16_bf16 a[80:95], a[184:187], a[172:175], a[80:95]
ds_read_b64_tr_b16 a[222:223], v16 offset:5120
v_add_u32 v9, 32768, v9
v_subrev_u32 v20, 98304, v9
v_cmp_le_u32 vcc, 163840, v9
v_add_u32 v13, 16384, v13
v_mfma_f32_32x32x16_bf16 a[96:111], a[188:191], a[160:163], a[96:111]
s_add_u32 m0, s32, 28672
v_and_b32 v13, 65535, v13
v_add_u32 v14, 16384, v14
v_and_b32 v14, 65535, v14
v_add_u32 v15, 16384, v15
v_mfma_f32_32x32x16_bf16 a[112:127], a[188:191], a[164:167], a[112:127]
buffer_load_dwordx4 v4, s[12:15], s48 offen lds
v_and_b32 v15, 65535, v15
v_add_u32 v16, 16384, v16
v_and_b32 v16, 65535, v16
v_mfma_f32_32x32x16_bf16 a[128:143], a[188:191], a[168:171], a[128:143]
s_add_u32 s30, s30, 128
s_add_u32 s32, s32, 32768
s_sub_u32 s24, s32, 98304
s_cmp_ge_u32 s32, 163840
s_cselect_b32 s32, s24, s32
s_add_u32 s25, s38, 38912
v_cndmask_b32 v9, v9, v20, vcc
v_xor_b32 v10, 32, v9
v_xor_b32 v11, 64, v9
v_xor_b32 v12, 96, v9
v_mfma_f32_32x32x16_bf16 a[144:159], a[188:191], a[172:175], a[144:159]
buffer_store_dwordx4 v[148:151], v17, s[8:11], s25 offen offset:1024 sc1
s_cmp_eq_u32 s61, 0
s_cbranch_scc1 L_px_11
s_lshl_b32 s24, s35, 2
s_lshr_b32 s26, 0xe64a20, s24
s_bfe_u32 s2, s26, 0x10003
s_and_b32 s26, s26, 7
s_add_u32 s24, s2, 1
s_sub_u32 s27, s3, 2
s_cmp_eq_u32 s3, 1
s_cbranch_scc0 L_px_13
s_mov_b32 s2, 1
s_mov_b32 s27, 0
s_branch L_px_13
L_px_11:
s_cmp_eq_u32 s35, 2
s_cselect_b32 s2, 1, 0
s_and_b32 s26, s35, 1
s_lshl_b32 s26, s26, 2
s_add_u32 s24, s2, 2
s_sub_u32 s27, s3, 4
L_px_13:
s_lshl_b32 s27, s27, 5
s_add_u32 s27, s27, s16
s_bfm_b32 s25, s24, 0
s_and_b32 s25, s25, s16
s_add_u32 s26, s26, s25
s_lshr_b32 s27, s27, s24
s_or_b32 s40, s2, s61
s_lshr_b32 s24, s17, 1
s_cmp_eq_u32 s2, 0
s_cselect_b32 s41, s24, 0
s_cselect_b64 s[4:5], s[52:53], s[54:55]
s_cselect_b32 s25, 0, s24
s_and_b32 s51, s41, s61
s_lshl_b32 s46, s27, s2
s_add_u32 s46, s46, s25
s_lshl_b32 s46, s46, 8
s_lshl_b32 s47, s40, 7
s_add_u32 s47, s47, 1024
s_mov_b32 s12, s4
s_and_b32 s13, s5, 0xffff
s_lshl_b32 s14, s47, 11
s_mov_b32 s15, 0x20000
s_mul_i32 s30, s26, s47
s_lshl_b32 s30, s30, 8
s_lshl_b32 s42, s27, 3
s_add_u32 s42, s42, s26
s_lshl_b32 s42, s42, 1
s_and_b32 s25, s17, 1
s_add_u32 s42, s42, s25
s_lshl_b32 s42, s42, 3
s_add_u32 s42, s42, s24
s_lshl_b32 s42, s42, 13
s_lshl_b32 s43, s27, 5
s_add_u32 s43, s43, s26
s_lshl_b32 s43, s43, 2
s_lshl_b32 s24, s2, 1
s_add_u32 s24, s24, s61
s_lshl_b32 s24, s24, 2
s_lshr_b32 s25, 0x8720, s24
s_and_b32 s25, s25, 15
s_lshl_b32 s25, s25, 24
s_add_u32 s42, s42, s25
s_lshr_b32 s25, 0x7604, s24
s_and_b32 s25, s25, 15
s_lshl_b32 s25, s25, 12
s_add_u32 s43, s43, s25
s_add_u32 s43, s43, 111149056
s_mov_b32 s44, 1
s_cmp_lt_u32 s35, s45
s_cselect_b32 s30, s30, 536870912
s_cselect_b32 s46, s46, 536870912
v_lshrrev_b32 v18, 3, v0
v_mul_lo_u32 v18, v18, s47
v_bfe_u32 v19, v0, 4, 3
v_and_b32 v20, 7, v0
v_xor_b32 v20, v20, v19
v_lshl_add_u32 v1, v20, 4, v18
s_lshl_b32 s24, s47, 5
s_lshl_b32 s34, s47, 7
v_add_u32 v2, s24, v1
v_add_u32 v3, s24, v2
v_add_u32 v4, s24, v3
s_waitcnt vmcnt(20) lgkmcnt(0)
s_barrier
v_mfma_f32_32x32x16_bf16 v[160:175], a[208:211], a[192:195], v[160:175]
ds_read_b64_tr_b16 a[176:177], v13 offset:0
s_mov_b32 m0, s33
v_mfma_f32_32x32x16_bf16 v[176:191], a[208:211], a[196:199], v[176:191]
ds_read_b64_tr_b16 a[178:179], v13 offset:1024
buffer_load_dwordx4 v5, s[20:23], s31 offen offset:0 lds
v_mfma_f32_32x32x16_bf16 v[192:207], a[208:211], a[200:203], v[192:207]
ds_read_b128 a[160:163], v9 offset:0
v_mfma_f32_32x32x16_bf16 v[208:223], a[208:211], a[204:207], v[208:223]
ds_read_b128 a[164:167], v9 offset:4096
v_mfma_f32_32x32x16_bf16 v[224:239], a[212:215], a[192:195], v[224:239]
ds_read_b128 a[168:171], v9 offset:8192
v_mfma_f32_32x32x16_bf16 v[240:255], a[212:215], a[196:199], v[240:255]
ds_read_b128 a[172:175], v9 offset:12288
buffer_load_dwordx4 v6, s[20:23], s31 offen offset:1024 lds
v_mfma_f32_32x32x16_bf16 a[0:15], a[212:215], a[200:203], a[0:15]
ds_read_b64_tr_b16 a[180:181], v14 offset:0
s_add_u32 s25, s38, 55296
v_mfma_f32_32x32x16_bf16 a[16:31], a[212:215], a[204:207], a[16:31]
ds_read_b64_tr_b16 a[182:183], v14 offset:1024
buffer_store_dwordx4 v[152:155], v17, s[8:11], s25 offen offset:0 sc1
v_mfma_f32_32x32x16_bf16 a[32:47], a[216:219], a[192:195], a[32:47]
ds_read_b64_tr_b16 a[184:185], v15 offset:0
v_mfma_f32_32x32x16_bf16 a[48:63], a[216:219], a[196:199], a[48:63]
ds_read_b64_tr_b16 a[186:187], v15 offset:1024
buffer_load_dwordx4 v7, s[20:23], s31 offen offset:2048 lds
v_mfma_f32_32x32x16_bf16 a[64:79], a[216:219], a[200:203], a[64:79]
ds_read_b64_tr_b16 a[188:189], v16 offset:0
v_mfma_f32_32x32x16_bf16 a[80:95], a[216:219], a[204:207], a[80:95]
ds_read_b64_tr_b16 a[190:191], v16 offset:1024
v_mfma_f32_32x32x16_bf16 a[96:111], a[220:223], a[192:195], a[96:111]
v_mfma_f32_32x32x16_bf16 a[112:127], a[220:223], a[196:199], a[112:127]
buffer_load_dwordx4 v8, s[20:23], s31 offen offset:3072 lds
v_mfma_f32_32x32x16_bf16 a[128:143], a[220:223], a[200:203], a[128:143]
s_add_u32 s31, s31, 262144
s_add_u32 s33, s33, 16384
s_and_b32 s33, s33, 65535
v_mfma_f32_32x32x16_bf16 a[144:159], a[220:223], a[204:207], a[144:159]
s_waitcnt lgkmcnt(0)
v_mfma_f32_32x32x16_bf16 v[160:175], a[176:179], a[160:163], v[160:175]
ds_read_b64_tr_b16 a[208:209], v13 offset:4096
s_add_u32 m0, s32, 0
s_mov_b32 s48, s30
v_mfma_f32_32x32x16_bf16 v[176:191], a[176:179], a[164:167], v[176:191]
ds_read_b64_tr_b16 a[210:211], v13 offset:5120
buffer_load_dwordx4 v1, s[12:15], s48 offen lds
v_mfma_f32_32x32x16_bf16 v[192:207], a[176:179], a[168:171], v[192:207]
ds_read_b128 a[192:195], v10 offset:0
v_mfma_f32_32x32x16_bf16 v[208:223], a[176:179], a[172:175], v[208:223]
ds_read_b128 a[196:199], v10 offset:4096
v_mfma_f32_32x32x16_bf16 v[224:239], a[180:183], a[160:163], v[224:239]
ds_read_b128 a[200:203], v10 offset:8192
s_add_u32 m0, s32, 4096
v_mfma_f32_32x32x16_bf16 v[240:255], a[180:183], a[164:167], v[240:255]
ds_read_b128 a[204:207], v10 offset:12288
buffer_load_dwordx4 v2, s[12:15], s48 offen lds
v_mfma_f32_32x32x16_bf16 a[0:15], a[180:183], a[168:171], a[0:15]
ds_read_b64_tr_b16 a[212:213], v14 offset:4096
s_add_u32 s25, s38, 55296
v_mfma_f32_32x32x16_bf16 a[16:31], a[180:183], a[172:175], a[16:31]
ds_read_b64_tr_b16 a[214:215], v14 offset:5120
buffer_store_dwordx4 v[156:159], v17, s[8:11], s25 offen offset:1024 sc1
v_mfma_f32_32x32x16_bf16 a[32:47], a[184:187], a[160:163], a[32:47]
ds_read_b64_tr_b16 a[216:217], v15 offset:4096
s_add_u32 m0, s32, 8192
v_mfma_f32_32x32x16_bf16 a[48:63], a[184:187], a[164:167], a[48:63]
ds_read_b64_tr_b16 a[218:219], v15 offset:5120
buffer_load_dwordx4 v3, s[12:15], s48 offen lds
v_mfma_f32_32x32x16_bf16 a[64:79], a[184:187], a[168:171], a[64:79]
ds_read_b64_tr_b16 a[220:221], v16 offset:4096
v_mfma_f32_32x32x16_bf16 a[80:95], a[184:187], a[172:175], a[80:95]
ds_read_b64_tr_b16 a[222:223], v16 offset:5120
v_add_u32 v13, 16384, v13
v_and_b32 v13, 65535, v13
v_mfma_f32_32x32x16_bf16 a[96:111], a[188:191], a[160:163], a[96:111]
s_add_u32 m0, s32, 12288
v_add_u32 v14, 16384, v14
v_and_b32 v14, 65535, v14
v_mfma_f32_32x32x16_bf16 a[112:127], a[188:191], a[164:167], a[112:127]
buffer_load_dwordx4 v4, s[12:15], s48 offen lds
v_add_u32 v15, 16384, v15
v_and_b32 v15, 65535, v15
v_mfma_f32_32x32x16_bf16 a[128:143], a[188:191], a[168:171], a[128:143]
v_add_u32 v16, 16384, v16
v_and_b32 v16, 65535, v16
v_mfma_f32_32x32x16_bf16 a[144:159], a[188:191], a[172:175], a[144:159]
s_cmp_eq_u32 s2, 0
s_cselect_b64 s[4:5], s[6:7], s[18:19]
s_mov_b32 s20, s4
s_and_b32 s21, s5, 0xffff
s_lshl_b32 s22, s47, 12
s_mov_b32 s23, 0x20000
s_mov_b32 s31, s46
s_waitcnt vmcnt(21) lgkmcnt(0)
s_barrier
v_mfma_f32_32x32x16_bf16 v[160:175], a[208:211], a[192:195], v[160:175]
ds_read_b64_tr_b16 a[176:177], v13 offset:0
s_mov_b32 m0, s33
v_mfma_f32_32x32x16_bf16 v[176:191], a[208:211], a[196:199], v[176:191]
ds_read_b64_tr_b16 a[178:179], v13 offset:1024
buffer_load_dwordx4 v5, s[20:23], s31 offen offset:0 lds
v_mfma_f32_32x32x16_bf16 v[192:207], a[208:211], a[200:203], v[192:207]
ds_read_b128 a[160:163], v11 offset:0
v_mfma_f32_32x32x16_bf16 v[208:223], a[208:211], a[204:207], v[208:223]
ds_read_b128 a[164:167], v11 offset:4096
v_mfma_f32_32x32x16_bf16 v[224:239], a[212:215], a[192:195], v[224:239]
ds_read_b128 a[168:171], v11 offset:8192
v_mfma_f32_32x32x16_bf16 v[240:255], a[212:215], a[196:199], v[240:255]
ds_read_b128 a[172:175], v11 offset:12288
buffer_load_dwordx4 v6, s[20:23], s31 offen offset:1024 lds
v_mfma_f32_32x32x16_bf16 a[0:15], a[212:215], a[200:203], a[0:15]
ds_read_b64_tr_b16 a[180:181], v14 offset:0
v_mfma_f32_32x32x16_bf16 a[16:31], a[212:215], a[204:207], a[16:31]
ds_read_b64_tr_b16 a[182:183], v14 offset:1024
v_mfma_f32_32x32x16_bf16 a[32:47], a[216:219], a[192:195], a[32:47]
ds_read_b64_tr_b16 a[184:185], v15 offset:0
v_mfma_f32_32x32x16_bf16 a[48:63], a[216:219], a[196:199], a[48:63]
ds_read_b64_tr_b16 a[186:187], v15 offset:1024
buffer_load_dwordx4 v7, s[20:23], s31 offen offset:2048 lds
v_mfma_f32_32x32x16_bf16 a[64:79], a[216:219], a[200:203], a[64:79]
ds_read_b64_tr_b16 a[188:189], v16 offset:0
v_mfma_f32_32x32x16_bf16 a[80:95], a[216:219], a[204:207], a[80:95]
ds_read_b64_tr_b16 a[190:191], v16 offset:1024
v_mfma_f32_32x32x16_bf16 a[96:111], a[220:223], a[192:195], a[96:111]
v_mfma_f32_32x32x16_bf16 a[112:127], a[220:223], a[196:199], a[112:127]
buffer_load_dwordx4 v8, s[20:23], s31 offen offset:3072 lds
v_mfma_f32_32x32x16_bf16 a[128:143], a[220:223], a[200:203], a[128:143]
s_add_u32 s31, s31, 262144
s_add_u32 s33, s33, 16384
s_and_b32 s33, s33, 65535
v_mfma_f32_32x32x16_bf16 a[144:159], a[220:223], a[204:207], a[144:159]
s_waitcnt lgkmcnt(0)
v_mfma_f32_32x32x16_bf16 v[160:175], a[176:179], a[160:163], v[160:175]
ds_read_b64_tr_b16 a[208:209], v13 offset:4096
s_add_u32 m0, s32, 16384
s_add_u32 s48, s30, s34
v_mfma_f32_32x32x16_bf16 v[176:191], a[176:179], a[164:167], v[176:191]
ds_read_b64_tr_b16 a[210:211], v13 offset:5120
buffer_load_dwordx4 v1, s[12:15], s48 offen lds
v_mfma_f32_32x32x16_bf16 v[192:207], a[176:179], a[168:171], v[192:207]
ds_read_b128 a[192:195], v12 offset:0
v_mfma_f32_32x32x16_bf16 v[208:223], a[176:179], a[172:175], v[208:223]
ds_read_b128 a[196:199], v12 offset:4096
v_mfma_f32_32x32x16_bf16 v[224:239], a[180:183], a[160:163], v[224:239]
ds_read_b128 a[200:203], v12 offset:8192
s_add_u32 m0, s32, 20480
v_mfma_f32_32x32x16_bf16 v[240:255], a[180:183], a[164:167], v[240:255]
ds_read_b128 a[204:207], v12 offset:12288
buffer_load_dwordx4 v2, s[12:15], s48 offen lds
v_mfma_f32_32x32x16_bf16 a[0:15], a[180:183], a[168:171], a[0:15]
ds_read_b64_tr_b16 a[212:213], v14 offset:4096
v_mfma_f32_32x32x16_bf16 a[16:31], a[180:183], a[172:175], a[16:31]
ds_read_b64_tr_b16 a[214:215], v14 offset:5120
v_mfma_f32_32x32x16_bf16 a[32:47], a[184:187], a[160:163], a[32:47]
ds_read_b64_tr_b16 a[216:217], v15 offset:4096
s_add_u32 m0, s32, 24576
v_mfma_f32_32x32x16_bf16 a[48:63], a[184:187], a[164:167], a[48:63]
ds_read_b64_tr_b16 a[218:219], v15 offset:5120
buffer_load_dwordx4 v3, s[12:15], s48 offen lds
v_mfma_f32_32x32x16_bf16 a[64:79], a[184:187], a[168:171], a[64:79]
ds_read_b64_tr_b16 a[220:221], v16 offset:4096
v_mfma_f32_32x32x16_bf16 a[80:95], a[184:187], a[172:175], a[80:95]
ds_read_b64_tr_b16 a[222:223], v16 offset:5120
v_add_u32 v9, 32768, v9
v_subrev_u32 v20, 98304, v9
v_cmp_le_u32 vcc, 163840, v9
v_add_u32 v13, 16384, v13
v_mfma_f32_32x32x16_bf16 a[96:111], a[188:191], a[160:163], a[96:111]
s_add_u32 m0, s32, 28672
v_and_b32 v13, 65535, v13
v_add_u32 v14, 16384, v14
v_and_b32 v14, 65535, v14
v_add_u32 v15, 16384, v15
v_mfma_f32_32x32x16_bf16 a[112:127], a[188:191], a[164:167], a[112:127]
buffer_load_dwordx4 v4, s[12:15], s48 offen lds
v_and_b32 v15, 65535, v15
v_add_u32 v16, 16384, v16
v_and_b32 v16, 65535, v16
v_mfma_f32_32x32x16_bf16 a[128:143], a[188:191], a[168:171], a[128:143]
s_add_u32 s30, s30, 128
s_add_u32 s32, s32, 32768
s_sub_u32 s24, s32, 98304
s_cmp_ge_u32 s32, 163840
s_cselect_b32 s32, s24, s32
v_cndmask_b32 v9, v9, v20, vcc
v_xor_b32 v10, 32, v9
v_xor_b32 v11, 64, v9
v_xor_b32 v12, 96, v9
v_mfma_f32_32x32x16_bf16 a[144:159], a[188:191], a[172:175], a[144:159]
s_waitcnt vmcnt(18) lgkmcnt(0)
s_barrier
v_mfma_f32_32x32x16_bf16 v[160:175], a[208:211], a[192:195], v[160:175]
ds_read_b64_tr_b16 a[176:177], v13 offset:0
s_mov_b32 m0, s33
v_mfma_f32_32x32x16_bf16 v[176:191], a[208:211], a[196:199], v[176:191]
ds_read_b64_tr_b16 a[178:179], v13 offset:1024
buffer_load_dwordx4 v5, s[20:23], s31 offen offset:0 lds
v_mfma_f32_32x32x16_bf16 v[192:207], a[208:211], a[200:203], v[192:207]
ds_read_b128 a[160:163], v9 offset:0
v_mfma_f32_32x32x16_bf16 v[208:223], a[208:211], a[204:207], v[208:223]
ds_read_b128 a[164:167], v9 offset:4096
v_mfma_f32_32x32x16_bf16 v[224:239], a[212:215], a[192:195], v[224:239]
ds_read_b128 a[168:171], v9 offset:8192
v_mfma_f32_32x32x16_bf16 v[240:255], a[212:215], a[196:199], v[240:255]
ds_read_b128 a[172:175], v9 offset:12288
buffer_load_dwordx4 v6, s[20:23], s31 offen offset:1024 lds
v_mfma_f32_32x32x16_bf16 a[0:15], a[212:215], a[200:203], a[0:15]
ds_read_b64_tr_b16 a[180:181], v14 offset:0
v_mfma_f32_32x32x16_bf16 a[16:31], a[212:215], a[204:207], a[16:31]
ds_read_b64_tr_b16 a[182:183], v14 offset:1024
v_mfma_f32_32x32x16_bf16 a[32:47], a[216:219], a[192:195], a[32:47]
ds_read_b64_tr_b16 a[184:185], v15 offset:0
v_mfma_f32_32x32x16_bf16 a[48:63], a[216:219], a[196:199], a[48:63]
ds_read_b64_tr_b16 a[186:187], v15 offset:1024
buffer_load_dwordx4 v7, s[20:23], s31 offen offset:2048 lds
v_mfma_f32_32x32x16_bf16 a[64:79], a[216:219], a[200:203], a[64:79]
ds_read_b64_tr_b16 a[188:189], v16 offset:0
v_mfma_f32_32x32x16_bf16 a[80:95], a[216:219], a[204:207], a[80:95]
ds_read_b64_tr_b16 a[190:191], v16 offset:1024
v_mfma_f32_32x32x16_bf16 a[96:111], a[220:223], a[192:195], a[96:111]
v_mfma_f32_32x32x16_bf16 a[112:127], a[220:223], a[196:199], a[112:127]
buffer_load_dwordx4 v8, s[20:23], s31 offen offset:3072 lds
v_mfma_f32_32x32x16_bf16 a[128:143], a[220:223], a[200:203], a[128:143]
s_add_u32 s31, s31, 262144
s_add_u32 s33, s33, 16384
s_and_b32 s33, s33, 65535
v_mfma_f32_32x32x16_bf16 a[144:159], a[220:223], a[204:207], a[144:159]
s_waitcnt lgkmcnt(0)
v_mfma_f32_32x32x16_bf16 v[160:175], a[176:179], a[160:163], v[160:175]
ds_read_b64_tr_b16 a[208:209], v13 offset:4096
s_add_u32 m0, s32, 0
s_mov_b32 s48, s30
v_mfma_f32_32x32x16_bf16 v[176:191], a[176:179], a[164:167], v[176:191]
ds_read_b64_tr_b16 a[210:211], v13 offset:5120
buffer_load_dwordx4 v1, s[12:15], s48 offen lds
v_mfma_f32_32x32x16_bf16 v[192:207], a[176:179], a[168:171], v[192:207]
ds_read_b128 a[192:195], v10 offset:0
v_mfma_f32_32x32x16_bf16 v[208:223], a[176:179], a[172:175], v[208:223]
ds_read_b128 a[196:199], v10 offset:4096
v_mfma_f32_32x32x16_bf16 v[224:239], a[180:183], a[160:163], v[224:239]
ds_read_b128 a[200:203], v10 offset:8192
s_add_u32 m0, s32, 4096
v_mfma_f32_32x32x16_bf16 v[240:255], a[180:183], a[164:167], v[240:255]
ds_read_b128 a[204:207], v10 offset:12288
buffer_load_dwordx4 v2, s[12:15], s48 offen lds
v_mfma_f32_32x32x16_bf16 a[0:15], a[180:183], a[168:171], a[0:15]
ds_read_b64_tr_b16 a[212:213], v14 offset:4096
v_mfma_f32_32x32x16_bf16 a[16:31], a[180:183], a[172:175], a[16:31]
ds_read_b64_tr_b16 a[214:215], v14 offset:5120
v_mfma_f32_32x32x16_bf16 a[32:47], a[184:187], a[160:163], a[32:47]
ds_read_b64_tr_b16 a[216:217], v15 offset:4096
s_add_u32 m0, s32, 8192
v_mfma_f32_32x32x16_bf16 a[48:63], a[184:187], a[164:167], a[48:63]
ds_read_b64_tr_b16 a[218:219], v15 offset:5120
buffer_load_dwordx4 v3, s[12:15], s48 offen lds
v_mfma_f32_32x32x16_bf16 a[64:79], a[184:187], a[168:171], a[64:79]
ds_read_b64_tr_b16 a[220:221], v16 offset:4096
v_mfma_f32_32x32x16_bf16 a[80:95], a[184:187], a[172:175], a[80:95]
ds_read_b64_tr_b16 a[222:223], v16 offset:5120
v_add_u32 v13, 16384, v13
v_and_b32 v13, 65535, v13
v_mfma_f32_32x32x16_bf16 a[96:111], a[188:191], a[160:163], a[96:111]
s_add_u32 m0, s32, 12288
v_add_u32 v14, 16384, v14
v_and_b32 v14, 65535, v14
v_mfma_f32_32x32x16_bf16 a[112:127], a[188:191], a[164:167], a[112:127]
buffer_load_dwordx4 v4, s[12:15], s48 offen lds
v_add_u32 v15, 16384, v15
v_and_b32 v15, 65535, v15
v_mfma_f32_32x32x16_bf16 a[128:143], a[188:191], a[168:171], a[128:143]
v_add_u32 v16, 16384, v16
v_and_b32 v16, 65535, v16
v_mfma_f32_32x32x16_bf16 a[144:159], a[188:191], a[172:175], a[144:159]
s_waitcnt vmcnt(16) lgkmcnt(0)
s_barrier
v_mfma_f32_32x32x16_bf16 v[160:175], a[208:211], a[192:195], v[160:175]
ds_read_b64_tr_b16 a[176:177], v13 offset:0
s_mov_b32 m0, s33
v_mfma_f32_32x32x16_bf16 v[176:191], a[208:211], a[196:199], v[176:191]
ds_read_b64_tr_b16 a[178:179], v13 offset:1024
buffer_load_dwordx4 v5, s[20:23], s31 offen offset:0 lds
v_mfma_f32_32x32x16_bf16 v[192:207], a[208:211], a[200:203], v[192:207]
ds_read_b128 a[160:163], v11 offset:0
v_mfma_f32_32x32x16_bf16 v[208:223], a[208:211], a[204:207], v[208:223]
ds_read_b128 a[164:167], v11 offset:4096
v_mfma_f32_32x32x16_bf16 v[224:239], a[212:215], a[192:195], v[224:239]
ds_read_b128 a[168:171], v11 offset:8192
v_mfma_f32_32x32x16_bf16 v[240:255], a[212:215], a[196:199], v[240:255]
ds_read_b128 a[172:175], v11 offset:12288
buffer_load_dwordx4 v6, s[20:23], s31 offen offset:1024 lds
v_mfma_f32_32x32x16_bf16 a[0:15], a[212:215], a[200:203], a[0:15]
ds_read_b64_tr_b16 a[180:181], v14 offset:0
v_mfma_f32_32x32x16_bf16 a[16:31], a[212:215], a[204:207], a[16:31]
ds_read_b64_tr_b16 a[182:183], v14 offset:1024
v_mfma_f32_32x32x16_bf16 a[32:47], a[216:219], a[192:195], a[32:47]
ds_read_b64_tr_b16 a[184:185], v15 offset:0
v_mfma_f32_32x32x16_bf16 a[48:63], a[216:219], a[196:199], a[48:63]
ds_read_b64_tr_b16 a[186:187], v15 offset:1024
buffer_load_dwordx4 v7, s[20:23], s31 offen offset:2048 lds
v_mfma_f32_32x32x16_bf16 a[64:79], a[216:219], a[200:203], a[64:79]
ds_read_b64_tr_b16 a[188:189], v16 offset:0
v_mfma_f32_32x32x16_bf16 a[80:95], a[216:219], a[204:207], a[80:95]
ds_read_b64_tr_b16 a[190:191], v16 offset:1024
v_mfma_f32_32x32x16_bf16 a[96:111], a[220:223], a[192:195], a[96:111]
v_mov_b32 v18, 0
v_mov_b32 v19, s29
s_cmp_eq_u32 s17, 0
s_cselect_b32 s25, s39, 536870912
s_mov_b64 exec, 1
buffer_store_dword v19, v18, s[8:11], s25 offen sc1
s_mov_b64 exec, -1
v_mfma_f32_32x32x16_bf16 a[112:127], a[220:223], a[196:199], a[112:127]
buffer_load_dwordx4 v8, s[20:23], s31 offen offset:3072 lds
v_mfma_f32_32x32x16_bf16 a[128:143], a[220:223], a[200:203], a[128:143]
s_add_u32 s31, s31, 262144
s_add_u32 s33, s33, 16384
s_and_b32 s33, s33, 65535
v_mfma_f32_32x32x16_bf16 a[144:159], a[220:223], a[204:207], a[144:159]
s_waitcnt lgkmcnt(0)
v_mfma_f32_32x32x16_bf16 v[160:175], a[176:179], a[160:163], v[160:175]
ds_read_b64_tr_b16 a[208:209], v13 offset:4096
s_add_u32 m0, s32, 16384
s_add_u32 s48, s30, s34
v_mfma_f32_32x32x16_bf16 v[176:191], a[176:179], a[164:167], v[176:191]
ds_read_b64_tr_b16 a[210:211], v13 offset:5120
buffer_load_dwordx4 v1, s[12:15], s48 offen lds
v_mfma_f32_32x32x16_bf16 v[192:207], a[176:179], a[168:171], v[192:207]
ds_read_b128 a[192:195], v12 offset:0
v_mfma_f32_32x32x16_bf16 v[208:223], a[176:179], a[172:175], v[208:223]
ds_read_b128 a[196:199], v12 offset:4096
v_mfma_f32_32x32x16_bf16 v[224:239], a[180:183], a[160:163], v[224:239]
ds_read_b128 a[200:203], v12 offset:8192
s_add_u32 m0, s32, 20480
v_mfma_f32_32x32x16_bf16 v[240:255], a[180:183], a[164:167], v[240:255]
ds_read_b128 a[204:207], v12 offset:12288
buffer_load_dwordx4 v2, s[12:15], s48 offen lds
v_mfma_f32_32x32x16_bf16 a[0:15], a[180:183], a[168:171], a[0:15]
ds_read_b64_tr_b16 a[212:213], v14 offset:4096
v_mfma_f32_32x32x16_bf16 a[16:31], a[180:183], a[172:175], a[16:31]
ds_read_b64_tr_b16 a[214:215], v14 offset:5120
v_mfma_f32_32x32x16_bf16 a[32:47], a[184:187], a[160:163], a[32:47]
ds_read_b64_tr_b16 a[216:217], v15 offset:4096
s_add_u32 m0, s32, 24576
v_mfma_f32_32x32x16_bf16 a[48:63], a[184:187], a[164:167], a[48:63]
ds_read_b64_tr_b16 a[218:219], v15 offset:5120
buffer_load_dwordx4 v3, s[12:15], s48 offen lds
v_mfma_f32_32x32x16_bf16 a[64:79], a[184:187], a[168:171], a[64:79]
ds_read_b64_tr_b16 a[220:221], v16 offset:4096
v_mfma_f32_32x32x16_bf16 a[80:95], a[184:187], a[172:175], a[80:95]
ds_read_b64_tr_b16 a[222:223], v16 offset:5120
v_add_u32 v9, 32768, v9
v_subrev_u32 v20, 98304, v9
v_cmp_le_u32 vcc, 163840, v9
v_add_u32 v13, 16384, v13
v_mfma_f32_32x32x16_bf16 a[96:111], a[188:191], a[160:163], a[96:111]
s_add_u32 m0, s32, 28672
v_and_b32 v13, 65535, v13
v_add_u32 v14, 16384, v14
v_and_b32 v14, 65535, v14
v_add_u32 v15, 16384, v15
v_mfma_f32_32x32x16_bf16 a[112:127], a[188:191], a[164:167], a[112:127]
buffer_load_dwordx4 v4, s[12:15], s48 offen lds
v_and_b32 v15, 65535, v15
v_add_u32 v16, 16384, v16
v_and_b32 v16, 65535, v16
v_mfma_f32_32x32x16_bf16 a[128:143], a[188:191], a[168:171], a[128:143]
s_add_u32 s30, s30, 128
s_add_u32 s32, s32, 32768
s_sub_u32 s24, s32, 98304
s_cmp_ge_u32 s32, 163840
s_cselect_b32 s32, s24, s32
v_cndmask_b32 v9, v9, v20, vcc
v_xor_b32 v10, 32, v9
v_xor_b32 v11, 64, v9
v_xor_b32 v12, 96, v9
v_mfma_f32_32x32x16_bf16 a[144:159], a[188:191], a[172:175], a[144:159]
s_waitcnt vmcnt(17) lgkmcnt(0)
s_barrier
v_mfma_f32_32x32x16_bf16 v[160:175], a[208:211], a[192:195], v[160:175]
ds_read_b64_tr_b16 a[176:177], v13 offset:0
s_mov_b32 m0, s33
v_mfma_f32_32x32x16_bf16 v[176:191], a[208:211], a[196:199], v[176:191]
ds_read_b64_tr_b16 a[178:179], v13 offset:1024
buffer_load_dwordx4 v5, s[20:23], s31 offen offset:0 lds
v_mfma_f32_32x32x16_bf16 v[192:207], a[208:211], a[200:203], v[192:207]
ds_read_b128 a[160:163], v9 offset:0
s_nop 4
v_cvt_pk_bf16_f32 v32, v160, v161
v_cvt_pk_bf16_f32 v33, v162, v163
v_cvt_pk_bf16_f32 v34, v164, v165
v_cvt_pk_bf16_f32 v35, v166, v167
v_cvt_pk_bf16_f32 v36, v168, v169
v_cvt_pk_bf16_f32 v37, v170, v171
v_cvt_pk_bf16_f32 v38, v172, v173
v_cvt_pk_bf16_f32 v39, v174, v175
v_mfma_f32_32x32x16_bf16 v[208:223], a[208:211], a[204:207], v[208:223]
ds_read_b128 a[164:167], v9 offset:4096
v_cvt_pk_bf16_f32 v40, v176, v177
v_cvt_pk_bf16_f32 v41, v178, v179
v_cvt_pk_bf16_f32 v42, v180, v181
v_cvt_pk_bf16_f32 v43, v182, v183
v_cvt_pk_bf16_f32 v44, v184, v185
v_cvt_pk_bf16_f32 v45, v186, v187
v_cvt_pk_bf16_f32 v46, v188, v189
v_cvt_pk_bf16_f32 v47, v190, v191
v_mfma_f32_32x32x16_bf16 v[224:239], a[212:215], a[192:195], v[224:239]
ds_read_b128 a[168:171], v9 offset:8192
v_cvt_pk_bf16_f32 v48, v192, v193
v_cvt_pk_bf16_f32 v49, v194, v195
v_cvt_pk_bf16_f32 v50, v196, v197
v_cvt_pk_bf16_f32 v51, v198, v199
v_cvt_pk_bf16_f32 v52, v200, v201
v_cvt_pk_bf16_f32 v53, v202, v203
v_cvt_pk_bf16_f32 v54, v204, v205
v_cvt_pk_bf16_f32 v55, v206, v207
v_mfma_f32_32x32x16_bf16 v[240:255], a[212:215], a[196:199], v[240:255]
ds_read_b128 a[172:175], v9 offset:12288
buffer_load_dwordx4 v6, s[20:23], s31 offen offset:1024 lds
v_cvt_pk_bf16_f32 v56, v208, v209
v_cvt_pk_bf16_f32 v57, v210, v211
v_cvt_pk_bf16_f32 v58, v212, v213
v_cvt_pk_bf16_f32 v59, v214, v215
v_cvt_pk_bf16_f32 v60, v216, v217
v_cvt_pk_bf16_f32 v61, v218, v219
v_cvt_pk_bf16_f32 v62, v220, v221
v_cvt_pk_bf16_f32 v63, v222, v223
v_mfma_f32_32x32x16_bf16 a[0:15], a[212:215], a[200:203], a[0:15]
ds_read_b64_tr_b16 a[180:181], v14 offset:0
v_cvt_pk_bf16_f32 v64, v224, v225
v_cvt_pk_bf16_f32 v65, v226, v227
v_cvt_pk_bf16_f32 v66, v228, v229
v_cvt_pk_bf16_f32 v67, v230, v231
v_cvt_pk_bf16_f32 v68, v232, v233
v_cvt_pk_bf16_f32 v69, v234, v235
v_cvt_pk_bf16_f32 v70, v236, v237
v_cvt_pk_bf16_f32 v71, v238, v239
v_mfma_f32_32x32x16_bf16 a[16:31], a[212:215], a[204:207], a[16:31]
ds_read_b64_tr_b16 a[182:183], v14 offset:1024
v_cvt_pk_bf16_f32 v72, v240, v241
v_cvt_pk_bf16_f32 v73, v242, v243
v_cvt_pk_bf16_f32 v74, v244, v245
v_cvt_pk_bf16_f32 v75, v246, v247
v_cvt_pk_bf16_f32 v76, v248, v249
v_cvt_pk_bf16_f32 v77, v250, v251
v_cvt_pk_bf16_f32 v78, v252, v253
v_cvt_pk_bf16_f32 v79, v254, v255
v_mfma_f32_32x32x16_bf16 a[32:47], a[216:219], a[192:195], a[32:47]
ds_read_b64_tr_b16 a[184:185], v15 offset:0
v_accvgpr_read_b32 v24, a0
v_accvgpr_read_b32 v25, a1
v_cvt_pk_bf16_f32 v80, v24, v25
v_accvgpr_read_b32 v26, a2
v_accvgpr_read_b32 v27, a3
v_cvt_pk_bf16_f32 v81, v26, v27
v_accvgpr_read_b32 v28, a4
v_accvgpr_read_b32 v29, a5
v_cvt_pk_bf16_f32 v82, v28, v29
v_accvgpr_read_b32 v30, a6
v_accvgpr_read_b32 v31, a7
v_cvt_pk_bf16_f32 v83, v30, v31
v_mfma_f32_32x32x16_bf16 a[48:63], a[216:219], a[196:199], a[48:63]
ds_read_b64_tr_b16 a[186:187], v15 offset:1024
buffer_load_dwordx4 v7, s[20:23], s31 offen offset:2048 lds
v_accvgpr_read_b32 v24, a8
v_accvgpr_read_b32 v25, a9
v_cvt_pk_bf16_f32 v84, v24, v25
v_accvgpr_read_b32 v26, a10
v_accvgpr_read_b32 v27, a11
v_cvt_pk_bf16_f32 v85, v26, v27
v_accvgpr_read_b32 v28, a12
v_accvgpr_read_b32 v29, a13
v_cvt_pk_bf16_f32 v86, v28, v29
v_accvgpr_read_b32 v30, a14
v_accvgpr_read_b32 v31, a15
v_cvt_pk_bf16_f32 v87, v30, v31
v_mfma_f32_32x32x16_bf16 a[64:79], a[216:219], a[200:203], a[64:79]
ds_read_b64_tr_b16 a[188:189], v16 offset:0
v_accvgpr_read_b32 v24, a16
v_accvgpr_read_b32 v25, a17
v_cvt_pk_bf16_f32 v88, v24, v25
v_accvgpr_read_b32 v26, a18
v_accvgpr_read_b32 v27, a19
v_cvt_pk_bf16_f32 v89, v26, v27
v_accvgpr_read_b32 v28, a20
v_accvgpr_read_b32 v29, a21
v_cvt_pk_bf16_f32 v90, v28, v29
v_accvgpr_read_b32 v30, a22
v_accvgpr_read_b32 v31, a23
v_cvt_pk_bf16_f32 v91, v30, v31
v_mfma_f32_32x32x16_bf16 a[80:95], a[216:219], a[204:207], a[80:95]
ds_read_b64_tr_b16 a[190:191], v16 offset:1024
v_accvgpr_read_b32 v24, a24
v_accvgpr_read_b32 v25, a25
v_cvt_pk_bf16_f32 v92, v24, v25
v_accvgpr_read_b32 v26, a26
v_accvgpr_read_b32 v27, a27
v_cvt_pk_bf16_f32 v93, v26, v27
v_accvgpr_read_b32 v28, a28
v_accvgpr_read_b32 v29, a29
v_cvt_pk_bf16_f32 v94, v28, v29
v_accvgpr_read_b32 v30, a30
v_accvgpr_read_b32 v31, a31
v_cvt_pk_bf16_f32 v95, v30, v31
v_mfma_f32_32x32x16_bf16 a[96:111], a[220:223], a[192:195], a[96:111]
v_accvgpr_read_b32 v24, a32
v_accvgpr_read_b32 v25, a33
v_cvt_pk_bf16_f32 v96, v24, v25
v_accvgpr_read_b32 v26, a34
v_accvgpr_read_b32 v27, a35
v_cvt_pk_bf16_f32 v97, v26, v27
v_accvgpr_read_b32 v28, a36
v_accvgpr_read_b32 v29, a37
v_cvt_pk_bf16_f32 v98, v28, v29
v_accvgpr_read_b32 v30, a38
v_accvgpr_read_b32 v31, a39
v_cvt_pk_bf16_f32 v99, v30, v31
v_mfma_f32_32x32x16_bf16 a[112:127], a[220:223], a[196:199], a[112:127]
buffer_load_dwordx4 v8, s[20:23], s31 offen offset:3072 lds
v_accvgpr_read_b32 v24, a40
v_accvgpr_read_b32 v25, a41
v_cvt_pk_bf16_f32 v100, v24, v25
v_accvgpr_read_b32 v26, a42
v_accvgpr_read_b32 v27, a43
v_cvt_pk_bf16_f32 v101, v26, v27
v_accvgpr_read_b32 v28, a44
v_accvgpr_read_b32 v29, a45
v_cvt_pk_bf16_f32 v102, v28, v29
v_accvgpr_read_b32 v30, a46
v_accvgpr_read_b32 v31, a47
v_cvt_pk_bf16_f32 v103, v30, v31
v_mfma_f32_32x32x16_bf16 a[128:143], a[220:223], a[200:203], a[128:143]
s_add_u32 s31, s31, 262144
s_add_u32 s33, s33, 16384
s_and_b32 s33, s33, 65535
v_accvgpr_read_b32 v24, a48
v_accvgpr_read_b32 v25, a49
v_cvt_pk_bf16_f32 v104, v24, v25
v_accvgpr_read_b32 v26, a50
v_accvgpr_read_b32 v27, a51
v_cvt_pk_bf16_f32 v105, v26, v27
v_accvgpr_read_b32 v28, a52
v_accvgpr_read_b32 v29, a53
v_cvt_pk_bf16_f32 v106, v28, v29
v_accvgpr_read_b32 v30, a54
v_accvgpr_read_b32 v31, a55
v_cvt_pk_bf16_f32 v107, v30, v31
v_mfma_f32_32x32x16_bf16 a[144:159], a[220:223], a[204:207], a[144:159]
v_accvgpr_read_b32 v24, a56
v_accvgpr_read_b32 v25, a57
v_cvt_pk_bf16_f32 v108, v24, v25
v_accvgpr_read_b32 v26, a58
v_accvgpr_read_b32 v27, a59
v_cvt_pk_bf16_f32 v109, v26, v27
v_accvgpr_read_b32 v28, a60
v_accvgpr_read_b32 v29, a61
v_cvt_pk_bf16_f32 v110, v28, v29
v_accvgpr_read_b32 v30, a62
v_accvgpr_read_b32 v31, a63
v_cvt_pk_bf16_f32 v111, v30, v31
v_accvgpr_read_b32 v24, a64
v_accvgpr_read_b32 v25, a65
v_cvt_pk_bf16_f32 v112, v24, v25
v_accvgpr_read_b32 v26, a66
v_accvgpr_read_b32 v27, a67
v_cvt_pk_bf16_f32 v113, v26, v27
v_accvgpr_read_b32 v28, a68
v_accvgpr_read_b32 v29, a69
v_cvt_pk_bf16_f32 v114, v28, v29
v_accvgpr_read_b32 v30, a70
v_accvgpr_read_b32 v31, a71
v_cvt_pk_bf16_f32 v115, v30, v31
s_cmp_lt_u32 s35, s45
s_cbranch_scc1 L_g_tile
s_branch L_g_end
.p2align 3
L_g_v:
s_waitcnt lgkmcnt(0)
v_mfma_f32_32x32x16_bf16 v[160:175], a[160:163], a[176:179], 0
ds_read_b64_tr_b16 a[208:209], v13 offset:4096
s_add_u32 m0, s32, 0
s_mov_b32 s48, s30
v_accvgpr_read_b32 v24, a72
v_accvgpr_read_b32 v25, a73
v_cvt_pk_bf16_f32 v116, v24, v25
v_accvgpr_read_b32 v26, a74
v_accvgpr_read_b32 v27, a75
v_cvt_pk_bf16_f32 v117, v26, v27
v_accvgpr_read_b32 v28, a76
v_accvgpr_read_b32 v29, a77
v_cvt_pk_bf16_f32 v118, v28, v29
v_accvgpr_read_b32 v30, a78
v_mfma_f32_32x32x16_bf16 v[176:191], a[164:167], a[176:179], 0
ds_read_b64_tr_b16 a[210:211], v13 offset:5120
buffer_load_dwordx4 v1, s[12:15], s48 offen lds
v_accvgpr_read_b32 v31, a79
v_cvt_pk_bf16_f32 v119, v30, v31
v_accvgpr_read_b32 v24, a80
v_accvgpr_read_b32 v25, a81
v_cvt_pk_bf16_f32 v120, v24, v25
v_accvgpr_read_b32 v26, a82
v_accvgpr_read_b32 v27, a83
v_cvt_pk_bf16_f32 v121, v26, v27
v_accvgpr_read_b32 v28, a84
v_accvgpr_read_b32 v29, a85
v_mfma_f32_32x32x16_bf16 v[192:207], a[168:171], a[176:179], 0
ds_read_b128 a[192:195], v10 offset:0
v_cvt_pk_bf16_f32 v122, v28, v29
v_accvgpr_read_b32 v30, a86
v_accvgpr_read_b32 v31, a87
v_cvt_pk_bf16_f32 v123, v30, v31
v_accvgpr_read_b32 v24, a88
v_accvgpr_read_b32 v25, a89
v_cvt_pk_bf16_f32 v124, v24, v25
v_accvgpr_read_b32 v26, a90
v_accvgpr_read_b32 v27, a91
v_cvt_pk_bf16_f32 v125, v26, v27
v_mfma_f32_32x32x16_bf16 v[208:223], a[172:175], a[176:179], 0
ds_read_b128 a[196:199], v10 offset:4096
v_accvgpr_read_b32 v28, a92
v_accvgpr_read_b32 v29, a93
v_cvt_pk_bf16_f32 v126, v28, v29
v_accvgpr_read_b32 v30, a94
v_accvgpr_read_b32 v31, a95
v_cvt_pk_bf16_f32 v127, v30, v31
v_accvgpr_read_b32 v24, a96
v_accvgpr_read_b32 v25, a97
v_cvt_pk_bf16_f32 v128, v24, v25
v_accvgpr_read_b32 v26, a98
v_mfma_f32_32x32x16_bf16 v[224:239], a[160:163], a[180:183], 0
ds_read_b128 a[200:203], v10 offset:8192
s_add_u32 m0, s32, 4096
v_accvgpr_read_b32 v27, a99
v_cvt_pk_bf16_f32 v129, v26, v27
v_accvgpr_read_b32 v28, a100
v_accvgpr_read_b32 v29, a101
v_cvt_pk_bf16_f32 v130, v28, v29
v_accvgpr_read_b32 v30, a102
v_accvgpr_read_b32 v31, a103
v_cvt_pk_bf16_f32 v131, v30, v31
v_accvgpr_read_b32 v24, a104
v_accvgpr_read_b32 v25, a105
v_mfma_f32_32x32x16_bf16 v[240:255], a[164:167], a[180:183], 0
ds_read_b128 a[204:207], v10 offset:12288
buffer_load_dwordx4 v2, s[12:15], s48 offen lds
v_cvt_pk_bf16_f32 v132, v24, v25
v_accvgpr_read_b32 v26, a106
v_accvgpr_read_b32 v27, a107
v_cvt_pk_bf16_f32 v133, v26, v27
v_accvgpr_read_b32 v28, a108
v_accvgpr_read_b32 v29, a109
v_cvt_pk_bf16_f32 v134, v28, v29
v_accvgpr_read_b32 v30, a110
v_accvgpr_read_b32 v31, a111
v_cvt_pk_bf16_f32 v135, v30, v31
v_mfma_f32_32x32x16_bf16 a[0:15], a[168:171], a[180:183], 0
ds_read_b64_tr_b16 a[212:213], v14 offset:4096
v_accvgpr_read_b32 v24, a112
v_accvgpr_read_b32 v25, a113
v_cvt_pk_bf16_f32 v136, v24, v25
v_accvgpr_read_b32 v26, a114
v_accvgpr_read_b32 v27, a115
v_cvt_pk_bf16_f32 v137, v26, v27
v_accvgpr_read_b32 v28, a116
v_accvgpr_read_b32 v29, a117
v_cvt_pk_bf16_f32 v138, v28, v29
v_accvgpr_read_b32 v30, a118
v_mfma_f32_32x32x16_bf16 a[16:31], a[172:175], a[180:183], 0
ds_read_b64_tr_b16 a[214:215], v14 offset:5120
v_accvgpr_read_b32 v31, a119
v_cvt_pk_bf16_f32 v139, v30, v31
v_accvgpr_read_b32 v24, a120
v_accvgpr_read_b32 v25, a121
v_cvt_pk_bf16_f32 v140, v24, v25
v_accvgpr_read_b32 v26, a122
v_accvgpr_read_b32 v27, a123
v_cvt_pk_bf16_f32 v141, v26, v27
v_accvgpr_read_b32 v28, a124
v_accvgpr_read_b32 v29, a125
v_mfma_f32_32x32x16_bf16 a[32:47], a[160:163], a[184:187], 0
ds_read_b64_tr_b16 a[216:217], v15 offset:4096
s_add_u32 m0, s32, 8192
v_cvt_pk_bf16_f32 v142, v28, v29
v_accvgpr_read_b32 v30, a126
v_accvgpr_read_b32 v31, a127
v_cvt_pk_bf16_f32 v143, v30, v31
v_accvgpr_read_b32 v24, a128
v_accvgpr_read_b32 v25, a129
v_cvt_pk_bf16_f32 v144, v24, v25
v_accvgpr_read_b32 v26, a130
v_accvgpr_read_b32 v27, a131
v_cvt_pk_bf16_f32 v145, v26, v27
v_mfma_f32_32x32x16_bf16 a[48:63], a[164:167], a[184:187], 0
ds_read_b64_tr_b16 a[218:219], v15 offset:5120
buffer_load_dwordx4 v3, s[12:15], s48 offen lds
v_accvgpr_read_b32 v28, a132
v_accvgpr_read_b32 v29, a133
v_cvt_pk_bf16_f32 v146, v28, v29
v_accvgpr_read_b32 v30, a134
v_accvgpr_read_b32 v31, a135
v_cvt_pk_bf16_f32 v147, v30, v31
v_accvgpr_read_b32 v24, a136
v_accvgpr_read_b32 v25, a137
v_cvt_pk_bf16_f32 v148, v24, v25
v_accvgpr_read_b32 v26, a138
v_mfma_f32_32x32x16_bf16 a[64:79], a[168:171], a[184:187], 0
ds_read_b64_tr_b16 a[220:221], v16 offset:4096
v_accvgpr_read_b32 v27, a139
v_cvt_pk_bf16_f32 v149, v26, v27
v_accvgpr_read_b32 v28, a140
v_accvgpr_read_b32 v29, a141
v_cvt_pk_bf16_f32 v150, v28, v29
v_accvgpr_read_b32 v30, a142
v_accvgpr_read_b32 v31, a143
v_cvt_pk_bf16_f32 v151, v30, v31
v_accvgpr_read_b32 v24, a144
v_accvgpr_read_b32 v25, a145
v_mfma_f32_32x32x16_bf16 a[80:95], a[172:175], a[184:187], 0
ds_read_b64_tr_b16 a[222:223], v16 offset:5120
v_cvt_pk_bf16_f32 v152, v24, v25
v_accvgpr_read_b32 v26, a146
v_accvgpr_read_b32 v27, a147
v_cvt_pk_bf16_f32 v153, v26, v27
v_accvgpr_read_b32 v28, a148
v_accvgpr_read_b32 v29, a149
v_cvt_pk_bf16_f32 v154, v28, v29
v_accvgpr_read_b32 v30, a150
v_accvgpr_read_b32 v31, a151
v_cvt_pk_bf16_f32 v155, v30, v31
v_mfma_f32_32x32x16_bf16 a[96:111], a[160:163], a[188:191], 0
s_add_u32 m0, s32, 12288
v_accvgpr_read_b32 v24, a152
v_accvgpr_read_b32 v25, a153
v_cvt_pk_bf16_f32 v156, v24, v25
v_accvgpr_read_b32 v26, a154
v_accvgpr_read_b32 v27, a155
v_cvt_pk_bf16_f32 v157, v26, v27
v_accvgpr_read_b32 v28, a156
v_accvgpr_read_b32 v29, a157
v_cvt_pk_bf16_f32 v158, v28, v29
v_accvgpr_read_b32 v30, a158
v_mfma_f32_32x32x16_bf16 a[112:127], a[164:167], a[188:191], 0
buffer_load_dwordx4 v4, s[12:15], s48 offen lds
v_accvgpr_read_b32 v31, a159
v_cvt_pk_bf16_f32 v159, v30, v31
v_mfma_f32_32x32x16_bf16 a[128:143], a[168:171], a[188:191], 0
v_mfma_f32_32x32x16_bf16 a[144:159], a[172:175], a[188:191], 0
v_add_u32 v13, 16384, v13
v_and_b32 v13, 65535, v13
v_add_u32 v14, 16384, v14
v_and_b32 v14, 65535, v14
v_add_u32 v15, 16384, v15
v_and_b32 v15, 65535, v15
v_add_u32 v16, 16384, v16
v_and_b32 v16, 65535, v16
v_and_b32 v18, 63, v0
v_bfe_u32 v19, v0, 1, 4
v_and_b32 v20, 1, v0
v_lshl_add_u32 v19, v20, 4, v19
v_and_or_b32 v19, v0, 32, v19
v_cmp_eq_u32 vcc, 0, s49
s_nop 1
v_cndmask_b32 v18, v19, v18, vcc
v_lshlrev_b32 v17, 4, v18
s_waitcnt vmcnt(17) lgkmcnt(0)
s_barrier
v_mfma_f32_32x32x16_bf16 v[160:175], a[192:195], a[208:211], v[160:175]
ds_read_b64_tr_b16 a[176:177], v13 offset:0
s_mov_b32 m0, s33
v_mfma_f32_32x32x16_bf16 v[176:191], a[196:199], a[208:211], v[176:191]
ds_read_b64_tr_b16 a[178:179], v13 offset:1024
buffer_load_dwordx4 v5, s[20:23], s31 offen offset:0 lds
v_mfma_f32_32x32x16_bf16 v[192:207], a[200:203], a[208:211], v[192:207]
ds_read_b128 a[160:163], v11 offset:0
v_mfma_f32_32x32x16_bf16 v[208:223], a[204:207], a[208:211], v[208:223]
ds_read_b128 a[164:167], v11 offset:4096
v_mfma_f32_32x32x16_bf16 v[224:239], a[192:195], a[212:215], v[224:239]
ds_read_b128 a[168:171], v11 offset:8192
v_mfma_f32_32x32x16_bf16 v[240:255], a[196:199], a[212:215], v[240:255]
ds_read_b128 a[172:175], v11 offset:12288
buffer_load_dwordx4 v6, s[20:23], s31 offen offset:1024 lds
v_mfma_f32_32x32x16_bf16 a[0:15], a[200:203], a[212:215], a[0:15]
ds_read_b64_tr_b16 a[180:181], v14 offset:0
s_add_u32 s25, s38, 0
v_mfma_f32_32x32x16_bf16 a[16:31], a[204:207], a[212:215], a[16:31]
ds_read_b64_tr_b16 a[182:183], v14 offset:1024
buffer_store_dwordx4 v[32:35], v17, s[8:11], s25 offen offset:0 sc1
v_mfma_f32_32x32x16_bf16 a[32:47], a[192:195], a[216:219], a[32:47]
ds_read_b64_tr_b16 a[184:185], v15 offset:0
v_mfma_f32_32x32x16_bf16 a[48:63], a[196:199], a[216:219], a[48:63]
ds_read_b64_tr_b16 a[186:187], v15 offset:1024
buffer_load_dwordx4 v7, s[20:23], s31 offen offset:2048 lds
v_mfma_f32_32x32x16_bf16 a[64:79], a[200:203], a[216:219], a[64:79]
ds_read_b64_tr_b16 a[188:189], v16 offset:0
v_mfma_f32_32x32x16_bf16 a[80:95], a[204:207], a[216:219], a[80:95]
ds_read_b64_tr_b16 a[190:191], v16 offset:1024
v_mfma_f32_32x32x16_bf16 a[96:111], a[192:195], a[220:223], a[96:111]
v_mfma_f32_32x32x16_bf16 a[112:127], a[196:199], a[220:223], a[112:127]
buffer_load_dwordx4 v8, s[20:23], s31 offen offset:3072 lds
v_mfma_f32_32x32x16_bf16 a[128:143], a[200:203], a[220:223], a[128:143]
s_add_u32 s31, s31, 262144
s_add_u32 s33, s33, 16384
s_and_b32 s33, s33, 65535
s_add_u32 s25, s38, 0
v_mfma_f32_32x32x16_bf16 a[144:159], a[204:207], a[220:223], a[144:159]
buffer_store_dwordx4 v[36:39], v17, s[8:11], s25 offen offset:1024 sc1
s_waitcnt lgkmcnt(0)
v_mfma_f32_32x32x16_bf16 v[160:175], a[160:163], a[176:179], v[160:175]
ds_read_b64_tr_b16 a[208:209], v13 offset:4096
s_add_u32 m0, s32, 16384
s_add_u32 s48, s30, s34
v_mfma_f32_32x32x16_bf16 v[176:191], a[164:167], a[176:179], v[176:191]
ds_read_b64_tr_b16 a[210:211], v13 offset:5120
buffer_load_dwordx4 v1, s[12:15], s48 offen lds
v_mfma_f32_32x32x16_bf16 v[192:207], a[168:171], a[176:179], v[192:207]
ds_read_b128 a[192:195], v12 offset:0
v_mfma_f32_32x32x16_bf16 v[208:223], a[172:175], a[176:179], v[208:223]
ds_read_b128 a[196:199], v12 offset:4096
v_mfma_f32_32x32x16_bf16 v[224:239], a[160:163], a[180:183], v[224:239]
ds_read_b128 a[200:203], v12 offset:8192
s_add_u32 m0, s32, 20480
v_mfma_f32_32x32x16_bf16 v[240:255], a[164:167], a[180:183], v[240:255]
ds_read_b128 a[204:207], v12 offset:12288
buffer_load_dwordx4 v2, s[12:15], s48 offen lds
v_mfma_f32_32x32x16_bf16 a[0:15], a[168:171], a[180:183], a[0:15]
ds_read_b64_tr_b16 a[212:213], v14 offset:4096
s_add_u32 s25, s38, 16384
v_mfma_f32_32x32x16_bf16 a[16:31], a[172:175], a[180:183], a[16:31]
ds_read_b64_tr_b16 a[214:215], v14 offset:5120
buffer_store_dwordx4 v[40:43], v17, s[8:11], s25 offen offset:0 sc1
v_mfma_f32_32x32x16_bf16 a[32:47], a[160:163], a[184:187], a[32:47]
ds_read_b64_tr_b16 a[216:217], v15 offset:4096
s_add_u32 m0, s32, 24576
v_mfma_f32_32x32x16_bf16 a[48:63], a[164:167], a[184:187], a[48:63]
ds_read_b64_tr_b16 a[218:219], v15 offset:5120
buffer_load_dwordx4 v3, s[12:15], s48 offen lds
v_mfma_f32_32x32x16_bf16 a[64:79], a[168:171], a[184:187], a[64:79]
ds_read_b64_tr_b16 a[220:221], v16 offset:4096
v_mfma_f32_32x32x16_bf16 a[80:95], a[172:175], a[184:187], a[80:95]
ds_read_b64_tr_b16 a[222:223], v16 offset:5120
v_add_u32 v9, 32768, v9
v_subrev_u32 v20, 98304, v9
v_cmp_le_u32 vcc, 163840, v9
v_add_u32 v13, 16384, v13
v_mfma_f32_32x32x16_bf16 a[96:111], a[160:163], a[188:191], a[96:111]
s_add_u32 m0, s32, 28672
v_and_b32 v13, 65535, v13
v_add_u32 v14, 16384, v14
v_and_b32 v14, 65535, v14
v_add_u32 v15, 16384, v15
v_mfma_f32_32x32x16_bf16 a[112:127], a[164:167], a[188:191], a[112:127]
buffer_load_dwordx4 v4, s[12:15], s48 offen lds
v_and_b32 v15, 65535, v15
v_add_u32 v16, 16384, v16
v_and_b32 v16, 65535, v16
v_mfma_f32_32x32x16_bf16 a[128:143], a[168:171], a[188:191], a[128:143]
s_add_u32 s30, s30, 128
s_add_u32 s32, s32, 32768
s_sub_u32 s24, s32, 98304
s_cmp_ge_u32 s32, 163840
s_cselect_b32 s32, s24, s32
v_cndmask_b32 v9, v9, v20, vcc
v_xor_b32 v10, 32, v9
v_xor_b32 v11, 64, v9
v_xor_b32 v12, 96, v9
v_mfma_f32_32x32x16_bf16 a[144:159], a[172:175], a[188:191], a[144:159]
s_waitcnt vmcnt(19) lgkmcnt(0)
s_barrier
v_mfma_f32_32x32x16_bf16 v[160:175], a[192:195], a[208:211], v[160:175]
ds_read_b64_tr_b16 a[176:177], v13 offset:0
s_mov_b32 m0, s33
v_mfma_f32_32x32x16_bf16 v[176:191], a[196:199], a[208:211], v[176:191]
ds_read_b64_tr_b16 a[178:179], v13 offset:1024
buffer_load_dwordx4 v5, s[20:23], s31 offen offset:0 lds
v_mfma_f32_32x32x16_bf16 v[192:207], a[200:203], a[208:211], v[192:207]
ds_read_b128 a[160:163], v9 offset:0
v_mfma_f32_32x32x16_bf16 v[208:223], a[204:207], a[208:211], v[208:223]
ds_read_b128 a[164:167], v9 offset:4096
v_mfma_f32_32x32x16_bf16 v[224:239], a[192:195], a[212:215], v[224:239]
ds_read_b128 a[168:171], v9 offset:8192
v_mfma_f32_32x32x16_bf16 v[240:255], a[196:199], a[212:215], v[240:255]
ds_read_b128 a[172:175], v9 offset:12288
buffer_load_dwordx4 v6, s[20:23], s31 offen offset:1024 lds
v_mfma_f32_32x32x16_bf16 a[0:15], a[200:203], a[212:215], a[0:15]
ds_read_b64_tr_b16 a[180:181], v14 offset:0
s_add_u32 s25, s38, 16384
v_mfma_f32_32x32x16_bf16 a[16:31], a[204:207], a[212:215], a[16:31]
ds_read_b64_tr_b16 a[182:183], v14 offset:1024
buffer_store_dwordx4 v[44:47], v17, s[8:11], s25 offen offset:1024 sc1
v_mfma_f32_32x32x16_bf16 a[32:47], a[192:195], a[216:219], a[32:47]
ds_read_b64_tr_b16 a[184:185], v15 offset:0
v_mfma_f32_32x32x16_bf16 a[48:63], a[196:199], a[216:219], a[48:63]
ds_read_b64_tr_b16 a[186:187], v15 offset:1024
buffer_load_dwordx4 v7, s[20:23], s31 offen offset:2048 lds
v_mfma_f32_32x32x16_bf16 a[64:79], a[200:203], a[216:219], a[64:79]
ds_read_b64_tr_b16 a[188:189], v16 offset:0
v_mfma_f32_32x32x16_bf16 a[80:95], a[204:207], a[216:219], a[80:95]
ds_read_b64_tr_b16 a[190:191], v16 offset:1024
buffer_load_dword v22, v23, s[96:99], s100 offen
s_add_u32 s100, s100, 8192
v_mfma_f32_32x32x16_bf16 a[96:111], a[192:195], a[220:223], a[96:111]
v_mfma_f32_32x32x16_bf16 a[112:127], a[196:199], a[220:223], a[112:127]
buffer_load_dwordx4 v8, s[20:23], s31 offen offset:3072 lds
v_mfma_f32_32x32x16_bf16 a[128:143], a[200:203], a[220:223], a[128:143]
s_add_u32 s31, s31, 262144
s_add_u32 s33, s33, 16384
s_and_b32 s33, s33, 65535
v_mfma_f32_32x32x16_bf16 a[144:159], a[204:207], a[220:223], a[144:159]
s_waitcnt lgkmcnt(0)
v_mfma_f32_32x32x16_bf16 v[160:175], a[160:163], a[176:179], v[160:175]
ds_read_b64_tr_b16 a[208:209], v13 offset:4096
s_add_u32 m0, s32, 0
s_mov_b32 s48, s30
v_mfma_f32_32x32x16_bf16 v[176:191], a[164:167], a[176:179], v[176:191]
ds_read_b64_tr_b16 a[210:211], v13 offset:5120
buffer_load_dwordx4 v1, s[12:15], s48 offen lds
v_mfma_f32_32x32x16_bf16 v[192:207], a[168:171], a[176:179], v[192:207]
ds_read_b128 a[192:195], v10 offset:0
v_mfma_f32_32x32x16_bf16 v[208:223], a[172:175], a[176:179], v[208:223]
ds_read_b128 a[196:199], v10 offset:4096
v_mfma_f32_32x32x16_bf16 v[224:239], a[160:163], a[180:183], v[224:239]
ds_read_b128 a[200:203], v10 offset:8192
s_add_u32 m0, s32, 4096
v_mfma_f32_32x32x16_bf16 v[240:255], a[164:167], a[180:183], v[240:255]
ds_read_b128 a[204:207], v10 offset:12288
buffer_load_dwordx4 v2, s[12:15], s48 offen lds
v_mfma_f32_32x32x16_bf16 a[0:15], a[168:171], a[180:183], a[0:15]
ds_read_b64_tr_b16 a[212:213], v14 offset:4096
s_add_u32 s25, s38, 32768
v_mfma_f32_32x32x16_bf16 a[16:31], a[172:175], a[180:183], a[16:31]
ds_read_b64_tr_b16 a[214:215], v14 offset:5120
buffer_store_dwordx4 v[48:51], v17, s[8:11], s25 offen offset:0 sc1
v_mfma_f32_32x32x16_bf16 a[32:47], a[160:163], a[184:187], a[32:47]
ds_read_b64_tr_b16 a[216:217], v15 offset:4096
s_add_u32 m0, s32, 8192
v_mfma_f32_32x32x16_bf16 a[48:63], a[164:167], a[184:187], a[48:63]
ds_read_b64_tr_b16 a[218:219], v15 offset:5120
buffer_load_dwordx4 v3, s[12:15], s48 offen lds
v_mfma_f32_32x32x16_bf16 a[64:79], a[168:171], a[184:187], a[64:79]
ds_read_b64_tr_b16 a[220:221], v16 offset:4096
v_mfma_f32_32x32x16_bf16 a[80:95], a[172:175], a[184:187], a[80:95]
ds_read_b64_tr_b16 a[222:223], v16 offset:5120
v_add_u32 v13, 16384, v13
v_and_b32 v13, 65535, v13
v_mfma_f32_32x32x16_bf16 a[96:111], a[160:163], a[188:191], a[96:111]
s_add_u32 m0, s32, 12288
v_add_u32 v14, 16384, v14
v_and_b32 v14, 65535, v14
v_mfma_f32_32x32x16_bf16 a[112:127], a[164:167], a[188:191], a[112:127]
buffer_load_dwordx4 v4, s[12:15], s48 offen lds
v_add_u32 v15, 16384, v15
v_and_b32 v15, 65535, v15
v_mfma_f32_32x32x16_bf16 a[128:143], a[168:171], a[188:191], a[128:143]
s_add_u32 s25, s38, 32768
v_add_u32 v16, 16384, v16
v_and_b32 v16, 65535, v16
v_mfma_f32_32x32x16_bf16 a[144:159], a[172:175], a[188:191], a[144:159]
buffer_store_dwordx4 v[52:55], v17, s[8:11], s25 offen offset:1024 sc1
s_waitcnt vmcnt(23) lgkmcnt(0)
s_barrier
v_mfma_f32_32x32x16_bf16 v[160:175], a[192:195], a[208:211], v[160:175]
ds_read_b64_tr_b16 a[176:177], v13 offset:0
s_mov_b32 m0, s33
v_mfma_f32_32x32x16_bf16 v[176:191], a[196:199], a[208:211], v[176:191]
ds_read_b64_tr_b16 a[178:179], v13 offset:1024
buffer_load_dwordx4 v5, s[20:23], s31 offen offset:0 lds
v_mfma_f32_32x32x16_bf16 v[192:207], a[200:203], a[208:211], v[192:207]
ds_read_b128 a[160:163], v11 offset:0
v_mfma_f32_32x32x16_bf16 v[208:223], a[204:207], a[208:211], v[208:223]
ds_read_b128 a[164:167], v11 offset:4096
v_mfma_f32_32x32x16_bf16 v[224:239], a[192:195], a[212:215], v[224:239]
ds_read_b128 a[168:171], v11 offset:8192
v_mfma_f32_32x32x16_bf16 v[240:255], a[196:199], a[212:215], v[240:255]
ds_read_b128 a[172:175], v11 offset:12288
buffer_load_dwordx4 v6, s[20:23], s31 offen offset:1024 lds
v_mfma_f32_32x32x16_bf16 a[0:15], a[200:203], a[212:215], a[0:15]
ds_read_b64_tr_b16 a[180:181], v14 offset:0
s_add_u32 s25, s38, 49152
v_mfma_f32_32x32x16_bf16 a[16:31], a[204:207], a[212:215], a[16:31]
ds_read_b64_tr_b16 a[182:183], v14 offset:1024
buffer_store_dwordx4 v[56:59], v17, s[8:11], s25 offen offset:0 sc1
v_mfma_f32_32x32x16_bf16 a[32:47], a[192:195], a[216:219], a[32:47]
ds_read_b64_tr_b16 a[184:185], v15 offset:0
v_mfma_f32_32x32x16_bf16 a[48:63], a[196:199], a[216:219], a[48:63]
ds_read_b64_tr_b16 a[186:187], v15 offset:1024
buffer_load_dwordx4 v7, s[20:23], s31 offen offset:2048 lds
v_mfma_f32_32x32x16_bf16 a[64:79], a[200:203], a[216:219], a[64:79]
ds_read_b64_tr_b16 a[188:189], v16 offset:0
v_mfma_f32_32x32x16_bf16 a[80:95], a[204:207], a[216:219], a[80:95]
ds_read_b64_tr_b16 a[190:191], v16 offset:1024
buffer_load_dword v22, v23, s[96:99], s100 offen
s_add_u32 s100, s100, 8192
v_mfma_f32_32x32x16_bf16 a[96:111], a[192:195], a[220:223], a[96:111]
v_mfma_f32_32x32x16_bf16 a[112:127], a[196:199], a[220:223], a[112:127]
buffer_load_dwordx4 v8, s[20:23], s31 offen offset:3072 lds
v_mfma_f32_32x32x16_bf16 a[128:143], a[200:203], a[220:223], a[128:143]
s_add_u32 s31, s31, 262144
s_add_u32 s33, s33, 16384
s_and_b32 s33, s33, 65535
v_mfma_f32_32x32x16_bf16 a[144:159], a[204:207], a[220:223], a[144:159]
s_waitcnt lgkmcnt(0)
v_mfma_f32_32x32x16_bf16 v[160:175], a[160:163], a[176:179], v[160:175]
ds_read_b64_tr_b16 a[208:209], v13 offset:4096
s_add_u32 m0, s32, 16384
s_add_u32 s48, s30, s34
v_mfma_f32_32x32x16_bf16 v[176:191], a[164:167], a[176:179], v[176:191]
ds_read_b64_tr_b16 a[210:211], v13 offset:5120
buffer_load_dwordx4 v1, s[12:15], s48 offen lds
v_mfma_f32_32x32x16_bf16 v[192:207], a[168:171], a[176:179], v[192:207]
ds_read_b128 a[192:195], v12 offset:0
v_mfma_f32_32x32x16_bf16 v[208:223], a[172:175], a[176:179], v[208:223]
ds_read_b128 a[196:199], v12 offset:4096
v_mfma_f32_32x32x16_bf16 v[224:239], a[160:163], a[180:183], v[224:239]
ds_read_b128 a[200:203], v12 offset:8192
s_add_u32 m0, s32, 20480
v_mfma_f32_32x32x16_bf16 v[240:255], a[164:167], a[180:183], v[240:255]
ds_read_b128 a[204:207], v12 offset:12288
buffer_load_dwordx4 v2, s[12:15], s48 offen lds
v_mfma_f32_32x32x16_bf16 a[0:15], a[168:171], a[180:183], a[0:15]
ds_read_b64_tr_b16 a[212:213], v14 offset:4096
s_add_u32 s25, s38, 49152
v_mfma_f32_32x32x16_bf16 a[16:31], a[172:175], a[180:183], a[16:31]
ds_read_b64_tr_b16 a[214:215], v14 offset:5120
buffer_store_dwordx4 v[60:63], v17, s[8:11], s25 offen offset:1024 sc1
v_mfma_f32_32x32x16_bf16 a[32:47], a[160:163], a[184:187], a[32:47]
ds_read_b64_tr_b16 a[216:217], v15 offset:4096
s_add_u32 m0, s32, 24576
v_mfma_f32_32x32x16_bf16 a[48:63], a[164:167], a[184:187], a[48:63]
ds_read_b64_tr_b16 a[218:219], v15 offset:5120
buffer_load_dwordx4 v3, s[12:15], s48 offen lds
v_mfma_f32_32x32x16_bf16 a[64:79], a[168:171], a[184:187], a[64:79]
ds_read_b64_tr_b16 a[220:221], v16 offset:4096
v_mfma_f32_32x32x16_bf16 a[80:95], a[172:175], a[184:187], a[80:95]
ds_read_b64_tr_b16 a[222:223], v16 offset:5120
v_add_u32 v9, 32768, v9
v_subrev_u32 v20, 98304, v9
v_cmp_le_u32 vcc, 163840, v9
v_add_u32 v13, 16384, v13
v_mfma_f32_32x32x16_bf16 a[96:111], a[160:163], a[188:191], a[96:111]
s_add_u32 m0, s32, 28672
v_and_b32 v13, 65535, v13
v_add_u32 v14, 16384, v14
v_and_b32 v14, 65535, v14
v_add_u32 v15, 16384, v15
v_mfma_f32_32x32x16_bf16 a[112:127], a[164:167], a[188:191], a[112:127]
buffer_load_dwordx4 v4, s[12:15], s48 offen lds
v_and_b32 v15, 65535, v15
v_add_u32 v16, 16384, v16
v_and_b32 v16, 65535, v16
v_mfma_f32_32x32x16_bf16 a[128:143], a[168:171], a[188:191], a[128:143]
s_add_u32 s30, s30, 128
s_add_u32 s32, s32, 32768
s_sub_u32 s24, s32, 98304
s_cmp_ge_u32 s32, 163840
s_cselect_b32 s32, s24, s32
v_cndmask_b32 v9, v9, v20, vcc
v_xor_b32 v10, 32, v9
v_xor_b32 v11, 64, v9
v_xor_b32 v12, 96, v9
v_mfma_f32_32x32x16_bf16 a[144:159], a[172:175], a[188:191], a[144:159]
s_waitcnt vmcnt(23) lgkmcnt(0)
s_barrier
v_mfma_f32_32x32x16_bf16 v[160:175], a[192:195], a[208:211], v[160:175]
ds_read_b64_tr_b16 a[176:177], v13 offset:0
s_mov_b32 m0, s33
v_mfma_f32_32x32x16_bf16 v[176:191], a[196:199], a[208:211], v[176:191]
ds_read_b64_tr_b16 a[178:179], v13 offset:1024
buffer_load_dwordx4 v5, s[20:23], s31 offen offset:0 lds
v_mfma_f32_32x32x16_bf16 v[192:207], a[200:203], a[208:211], v[192:207]
ds_read_b128 a[160:163], v9 offset:0
v_mfma_f32_32x32x16_bf16 v[208:223], a[204:207], a[208:211], v[208:223]
ds_read_b128 a[164:167], v9 offset:4096
v_mfma_f32_32x32x16_bf16 v[224:239], a[192:195], a[212:215], v[224:239]
ds_read_b128 a[168:171], v9 offset:8192
v_mfma_f32_32x32x16_bf16 v[240:255], a[196:199], a[212:215], v[240:255]
ds_read_b128 a[172:175], v9 offset:12288
buffer_load_dwordx4 v6, s[20:23], s31 offen offset:1024 lds
v_mfma_f32_32x32x16_bf16 a[0:15], a[200:203], a[212:215], a[0:15]
ds_read_b64_tr_b16 a[180:181], v14 offset:0
s_add_u32 s25, s38, 2048
v_mfma_f32_32x32x16_bf16 a[16:31], a[204:207], a[212:215], a[16:31]
ds_read_b64_tr_b16 a[182:183], v14 offset:1024
buffer_store_dwordx4 v[64:67], v17, s[8:11], s25 offen offset:0 sc1
v_mfma_f32_32x32x16_bf16 a[32:47], a[192:195], a[216:219], a[32:47]
ds_read_b64_tr_b16 a[184:185], v15 offset:0
v_mfma_f32_32x32x16_bf16 a[48:63], a[196:199], a[216:219], a[48:63]
ds_read_b64_tr_b16 a[186:187], v15 offset:1024
buffer_load_dwordx4 v7, s[20:23], s31 offen offset:2048 lds
v_mfma_f32_32x32x16_bf16 a[64:79], a[200:203], a[216:219], a[64:79]
ds_read_b64_tr_b16 a[188:189], v16 offset:0
v_mfma_f32_32x32x16_bf16 a[80:95], a[204:207], a[216:219], a[80:95]
ds_read_b64_tr_b16 a[190:191], v16 offset:1024
buffer_load_dword v22, v23, s[96:99], s100 offen
s_add_u32 s100, s100, 8192
v_mfma_f32_32x32x16_bf16 a[96:111], a[192:195], a[220:223], a[96:111]
v_mfma_f32_32x32x16_bf16 a[112:127], a[196:199], a[220:223], a[112:127]
buffer_load_dwordx4 v8, s[20:23], s31 offen offset:3072 lds
v_mfma_f32_32x32x16_bf16 a[128:143], a[200:203], a[220:223], a[128:143]
s_add_u32 s31, s31, 262144
s_add_u32 s33, s33, 16384
s_and_b32 s33, s33, 65535
s_add_u32 s25, s38, 2048
v_mfma_f32_32x32x16_bf16 a[144:159], a[204:207], a[220:223], a[144:159]
buffer_store_dwordx4 v[68:71], v17, s[8:11], s25 offen offset:1024 sc1
s_waitcnt lgkmcnt(0)
v_mfma_f32_32x32x16_bf16 v[160:175], a[160:163], a[176:179], v[160:175]
ds_read_b64_tr_b16 a[208:209], v13 offset:4096
s_add_u32 m0, s32, 0
s_mov_b32 s48, s30
v_mfma_f32_32x32x16_bf16 v[176:191], a[164:167], a[176:179], v[176:191]
ds_read_b64_tr_b16 a[210:211], v13 offset:5120
buffer_load_dwordx4 v1, s[12:15], s48 offen lds
v_mfma_f32_32x32x16_bf16 v[192:207], a[168:171], a[176:179], v[192:207]
ds_read_b128 a[192:195], v10 offset:0
v_mfma_f32_32x32x16_bf16 v[208:223], a[172:175], a[176:179], v[208:223]
ds_read_b128 a[196:199], v10 offset:4096
v_mfma_f32_32x32x16_bf16 v[224:239], a[160:163], a[180:183], v[224:239]
ds_read_b128 a[200:203], v10 offset:8192
s_add_u32 m0, s32, 4096
v_mfma_f32_32x32x16_bf16 v[240:255], a[164:167], a[180:183], v[240:255]
ds_read_b128 a[204:207], v10 offset:12288
buffer_load_dwordx4 v2, s[12:15], s48 offen lds
v_mfma_f32_32x32x16_bf16 a[0:15], a[168:171], a[180:183], a[0:15]
ds_read_b64_tr_b16 a[212:213], v14 offset:4096
s_add_u32 s25, s38, 18432
v_mfma_f32_32x32x16_bf16 a[16:31], a[172:175], a[180:183], a[16:31]
ds_read_b64_tr_b16 a[214:215], v14 offset:5120
buffer_store_dwordx4 v[72:75], v17, s[8:11], s25 offen offset:0 sc1
v_mfma_f32_32x32x16_bf16 a[32:47], a[160:163], a[184:187], a[32:47]
ds_read_b64_tr_b16 a[216:217], v15 offset:4096
s_add_u32 m0, s32, 8192
v_mfma_f32_32x32x16_bf16 a[48:63], a[164:167], a[184:187], a[48:63]
ds_read_b64_tr_b16 a[218:219], v15 offset:5120
buffer_load_dwordx4 v3, s[12:15], s48 offen lds
v_mfma_f32_32x32x16_bf16 a[64:79], a[168:171], a[184:187], a[64:79]
ds_read_b64_tr_b16 a[220:221], v16 offset:4096
v_mfma_f32_32x32x16_bf16 a[80:95], a[172:175], a[184:187], a[80:95]
ds_read_b64_tr_b16 a[222:223], v16 offset:5120
v_add_u32 v13, 16384, v13
v_and_b32 v13, 65535, v13
v_mfma_f32_32x32x16_bf16 a[96:111], a[160:163], a[188:191], a[96:111]
s_add_u32 m0, s32, 12288
v_add_u32 v14, 16384, v14
v_and_b32 v14, 65535, v14
v_mfma_f32_32x32x16_bf16 a[112:127], a[164:167], a[188:191], a[112:127]
buffer_load_dwordx4 v4, s[12:15], s48 offen lds
v_add_u32 v15, 16384, v15
v_and_b32 v15, 65535, v15
v_mfma_f32_32x32x16_bf16 a[128:143], a[168:171], a[188:191], a[128:143]
v_add_u32 v16, 16384, v16
v_and_b32 v16, 65535, v16
v_mfma_f32_32x32x16_bf16 a[144:159], a[172:175], a[188:191], a[144:159]
s_waitcnt vmcnt(23) lgkmcnt(0)
s_barrier
v_mfma_f32_32x32x16_bf16 v[160:175], a[192:195], a[208:211], v[160:175]
ds_read_b64_tr_b16 a[176:177], v13 offset:0
s_mov_b32 m0, s33
v_mfma_f32_32x32x16_bf16 v[176:191], a[196:199], a[208:211], v[176:191]
ds_read_b64_tr_b16 a[178:179], v13 offset:1024
buffer_load_dwordx4 v5, s[20:23], s31 offen offset:0 lds
v_mfma_f32_32x32x16_bf16 v[192:207], a[200:203], a[208:211], v[192:207]
ds_read_b128 a[160:163], v11 offset:0
v_mfma_f32_32x32x16_bf16 v[208:223], a[204:207], a[208:211], v[208:223]
ds_read_b128 a[164:167], v11 offset:4096
v_mfma_f32_32x32x16_bf16 v[224:239], a[192:195], a[212:215], v[224:239]
ds_read_b128 a[168:171], v11 offset:8192
v_mfma_f32_32x32x16_bf16 v[240:255], a[196:199], a[212:215], v[240:255]
ds_read_b128 a[172:175], v11 offset:12288
buffer_load_dwordx4 v6, s[20:23], s31 offen offset:1024 lds
v_mfma_f32_32x32x16_bf16 a[0:15], a[200:203], a[212:215], a[0:15]
ds_read_b64_tr_b16 a[180:181], v14 offset:0
s_add_u32 s25, s38, 18432
v_mfma_f32_32x32x16_bf16 a[16:31], a[204:207], a[212:215], a[16:31]
ds_read_b64_tr_b16 a[182:183], v14 offset:1024
buffer_store_dwordx4 v[76:79], v17, s[8:11], s25 offen offset:1024 sc1
v_mfma_f32_32x32x16_bf16 a[32:47], a[192:195], a[216:219], a[32:47]
ds_read_b64_tr_b16 a[184:185], v15 offset:0
v_mfma_f32_32x32x16_bf16 a[48:63], a[196:199], a[216:219], a[48:63]
ds_read_b64_tr_b16 a[186:187], v15 offset:1024
buffer_load_dwordx4 v7, s[20:23], s31 offen offset:2048 lds
v_mfma_f32_32x32x16_bf16 a[64:79], a[200:203], a[216:219], a[64:79]
ds_read_b64_tr_b16 a[188:189], v16 offset:0
v_mfma_f32_32x32x16_bf16 a[80:95], a[204:207], a[216:219], a[80:95]
ds_read_b64_tr_b16 a[190:191], v16 offset:1024
buffer_load_dword v22, v23, s[96:99], s100 offen
s_add_u32 s100, s100, 8192
v_mfma_f32_32x32x16_bf16 a[96:111], a[192:195], a[220:223], a[96:111]
v_mfma_f32_32x32x16_bf16 a[112:127], a[196:199], a[220:223], a[112:127]
buffer_load_dwordx4 v8, s[20:23], s31 offen offset:3072 lds
v_mfma_f32_32x32x16_bf16 a[128:143], a[200:203], a[220:223], a[128:143]
s_add_u32 s31, s31, 262144
s_add_u32 s33, s33, 16384
s_and_b32 s33, s33, 65535
v_mfma_f32_32x32x16_bf16 a[144:159], a[204:207], a[220:223], a[144:159]
s_waitcnt lgkmcnt(0)
v_mfma_f32_32x32x16_bf16 v[160:175], a[160:163], a[176:179], v[160:175]
ds_read_b64_tr_b16 a[208:209], v13 offset:4096
s_add_u32 m0, s32, 16384
s_add_u32 s48, s30, s34
v_mfma_f32_32x32x16_bf16 v[176:191], a[164:167], a[176:179], v[176:191]
ds_read_b64_tr_b16 a[210:211], v13 offset:5120
buffer_load_dwordx4 v1, s[12:15], s48 offen lds
v_mfma_f32_32x32x16_bf16 v[192:207], a[168:171], a[176:179], v[192:207]
ds_read_b128 a[192:195], v12 offset:0
v_mfma_f32_32x32x16_bf16 v[208:223], a[172:175], a[176:179], v[208:223]
ds_read_b128 a[196:199], v12 offset:4096
v_mfma_f32_32x32x16_bf16 v[224:239], a[160:163], a[180:183], v[224:239]
ds_read_b128 a[200:203], v12 offset:8192
s_add_u32 m0, s32, 20480
v_mfma_f32_32x32x16_bf16 v[240:255], a[164:167], a[180:183], v[240:255]
ds_read_b128 a[204:207], v12 offset:12288
buffer_load_dwordx4 v2, s[12:15], s48 offen lds
v_mfma_f32_32x32x16_bf16 a[0:15], a[168:171], a[180:183], a[0:15]
ds_read_b64_tr_b16 a[212:213], v14 offset:4096
s_add_u32 s25, s38, 34816
v_mfma_f32_32x32x16_bf16 a[16:31], a[172:175], a[180:183], a[16:31]
ds_read_b64_tr_b16 a[214:215], v14 offset:5120
buffer_store_dwordx4 v[80:83], v17, s[8:11], s25 offen offset:0 sc1
v_mfma_f32_32x32x16_bf16 a[32:47], a[160:163], a[184:187], a[32:47]
ds_read_b64_tr_b16 a[216:217], v15 offset:4096
s_add_u32 m0, s32, 24576
v_mfma_f32_32x32x16_bf16 a[48:63], a[164:167], a[184:187], a[48:63]
ds_read_b64_tr_b16 a[218:219], v15 offset:5120
buffer_load_dwordx4 v3, s[12:15], s48 offen lds
v_mfma_f32_32x32x16_bf16 a[64:79], a[168:171], a[184:187], a[64:79]
ds_read_b64_tr_b16 a[220:221], v16 offset:4096
v_mfma_f32_32x32x16_bf16 a[80:95], a[172:175], a[184:187], a[80:95]
ds_read_b64_tr_b16 a[222:223], v16 offset:5120
v_add_u32 v9, 32768, v9
v_subrev_u32 v20, 98304, v9
v_cmp_le_u32 vcc, 163840, v9
v_add_u32 v13, 16384, v13
v_mfma_f32_32x32x16_bf16 a[96:111], a[160:163], a[188:191], a[96:111]
s_add_u32 m0, s32, 28672
v_and_b32 v13, 65535, v13
v_add_u32 v14, 16384, v14
v_and_b32 v14, 65535, v14
v_add_u32 v15, 16384, v15
v_mfma_f32_32x32x16_bf16 a[112:127], a[164:167], a[188:191], a[112:127]
buffer_load_dwordx4 v4, s[12:15], s48 offen lds
v_and_b32 v15, 65535, v15
v_add_u32 v16, 16384, v16
v_and_b32 v16, 65535, v16
v_mfma_f32_32x32x16_bf16 a[128:143], a[168:171], a[188:191], a[128:143]
s_add_u32 s30, s30, 128
s_add_u32 s32, s32, 32768
s_sub_u32 s24, s32, 98304
s_cmp_ge_u32 s32, 163840
s_cselect_b32 s32, s24, s32
s_add_u32 s25, s38, 34816
v_cndmask_b32 v9, v9, v20, vcc
v_xor_b32 v10, 32, v9
v_xor_b32 v11, 64, v9
v_xor_b32 v12, 96, v9
v_mfma_f32_32x32x16_bf16 a[144:159], a[172:175], a[188:191], a[144:159]
buffer_store_dwordx4 v[84:87], v17, s[8:11], s25 offen offset:1024 sc1
s_waitcnt vmcnt(24) lgkmcnt(0)
s_barrier
v_mfma_f32_32x32x16_bf16 v[160:175], a[192:195], a[208:211], v[160:175]
ds_read_b64_tr_b16 a[176:177], v13 offset:0
s_mov_b32 m0, s33
v_mfma_f32_32x32x16_bf16 v[176:191], a[196:199], a[208:211], v[176:191]
ds_read_b64_tr_b16 a[178:179], v13 offset:1024
buffer_load_dwordx4 v5, s[20:23], s31 offen offset:0 lds
v_mfma_f32_32x32x16_bf16 v[192:207], a[200:203], a[208:211], v[192:207]
ds_read_b128 a[160:163], v9 offset:0
v_mfma_f32_32x32x16_bf16 v[208:223], a[204:207], a[208:211], v[208:223]
ds_read_b128 a[164:167], v9 offset:4096
v_mfma_f32_32x32x16_bf16 v[224:239], a[192:195], a[212:215], v[224:239]
ds_read_b128 a[168:171], v9 offset:8192
v_mfma_f32_32x32x16_bf16 v[240:255], a[196:199], a[212:215], v[240:255]
ds_read_b128 a[172:175], v9 offset:12288
buffer_load_dwordx4 v6, s[20:23], s31 offen offset:1024 lds
v_mfma_f32_32x32x16_bf16 a[0:15], a[200:203], a[212:215], a[0:15]
ds_read_b64_tr_b16 a[180:181], v14 offset:0
s_add_u32 s25, s38, 51200
v_mfma_f32_32x32x16_bf16 a[16:31], a[204:207], a[212:215], a[16:31]
ds_read_b64_tr_b16 a[182:183], v14 offset:1024
buffer_store_dwordx4 v[88:91], v17, s[8:11], s25 offen offset:0 sc1
v_mfma_f32_32x32x16_bf16 a[32:47], a[192:195], a[216:219], a[32:47]
ds_read_b64_tr_b16 a[184:185], v15 offset:0
v_mfma_f32_32x32x16_bf16 a[48:63], a[196:199], a[216:219], a[48:63]
ds_read_b64_tr_b16 a[186:187], v15 offset:1024
buffer_load_dwordx4 v7, s[20:23], s31 offen offset:2048 lds
v_mfma_f32_32x32x16_bf16 a[64:79], a[200:203], a[216:219], a[64:79]
ds_read_b64_tr_b16 a[188:189], v16 offset:0
v_mfma_f32_32x32x16_bf16 a[80:95], a[204:207], a[216:219], a[80:95]
ds_read_b64_tr_b16 a[190:191], v16 offset:1024
buffer_load_dword v22, v23, s[96:99], s100 offen
s_add_u32 s100, s100, 8192
v_mfma_f32_32x32x16_bf16 a[96:111], a[192:195], a[220:223], a[96:111]
v_mfma_f32_32x32x16_bf16 a[112:127], a[196:199], a[220:223], a[112:127]
buffer_load_dwordx4 v8, s[20:23], s31 offen offset:3072 lds
v_mfma_f32_32x32x16_bf16 a[128:143], a[200:203], a[220:223], a[128:143]
s_add_u32 s31, s31, 262144
s_add_u32 s33, s33, 16384
s_and_b32 s33, s33, 65535
v_mfma_f32_32x32x16_bf16 a[144:159], a[204:207], a[220:223], a[144:159]
s_waitcnt lgkmcnt(0)
v_mfma_f32_32x32x16_bf16 v[160:175], a[160:163], a[176:179], v[160:175]
ds_read_b64_tr_b16 a[208:209], v13 offset:4096
s_add_u32 m0, s32, 0
s_mov_b32 s48, s30
v_mfma_f32_32x32x16_bf16 v[176:191], a[164:167], a[176:179], v[176:191]
ds_read_b64_tr_b16 a[210:211], v13 offset:5120
buffer_load_dwordx4 v1, s[12:15], s48 offen lds
v_mfma_f32_32x32x16_bf16 v[192:207], a[168:171], a[176:179], v[192:207]
ds_read_b128 a[192:195], v10 offset:0
v_mfma_f32_32x32x16_bf16 v[208:223], a[172:175], a[176:179], v[208:223]
ds_read_b128 a[196:199], v10 offset:4096
v_mfma_f32_32x32x16_bf16 v[224:239], a[160:163], a[180:183], v[224:239]
ds_read_b128 a[200:203], v10 offset:8192
s_add_u32 m0, s32, 4096
v_mfma_f32_32x32x16_bf16 v[240:255], a[164:167], a[180:183], v[240:255]
ds_read_b128 a[204:207], v10 offset:12288
buffer_load_dwordx4 v2, s[12:15], s48 offen lds
v_mfma_f32_32x32x16_bf16 a[0:15], a[168:171], a[180:183], a[0:15]
ds_read_b64_tr_b16 a[212:213], v14 offset:4096
s_add_u32 s25, s38, 51200
v_mfma_f32_32x32x16_bf16 a[16:31], a[172:175], a[180:183], a[16:31]
ds_read_b64_tr_b16 a[214:215], v14 offset:5120
buffer_store_dwordx4 v[92:95], v17, s[8:11], s25 offen offset:1024 sc1
v_mfma_f32_32x32x16_bf16 a[32:47], a[160:163], a[184:187], a[32:47]
ds_read_b64_tr_b16 a[216:217], v15 offset:4096
s_add_u32 m0, s32, 8192
v_mfma_f32_32x32x16_bf16 a[48:63], a[164:167], a[184:187], a[48:63]
ds_read_b64_tr_b16 a[218:219], v15 offset:5120
buffer_load_dwordx4 v3, s[12:15], s48 offen lds
v_mfma_f32_32x32x16_bf16 a[64:79], a[168:171], a[184:187], a[64:79]
ds_read_b64_tr_b16 a[220:221], v16 offset:4096
v_mfma_f32_32x32x16_bf16 a[80:95], a[172:175], a[184:187], a[80:95]
ds_read_b64_tr_b16 a[222:223], v16 offset:5120
v_add_u32 v13, 16384, v13
v_and_b32 v13, 65535, v13
v_mfma_f32_32x32x16_bf16 a[96:111], a[160:163], a[188:191], a[96:111]
s_add_u32 m0, s32, 12288
v_add_u32 v14, 16384, v14
v_and_b32 v14, 65535, v14
v_mfma_f32_32x32x16_bf16 a[112:127], a[164:167], a[188:191], a[112:127]
buffer_load_dwordx4 v4, s[12:15], s48 offen lds
v_add_u32 v15, 16384, v15
v_and_b32 v15, 65535, v15
v_mfma_f32_32x32x16_bf16 a[128:143], a[168:171], a[188:191], a[128:143]
v_add_u32 v16, 16384, v16
v_and_b32 v16, 65535, v16
v_mfma_f32_32x32x16_bf16 a[144:159], a[172:175], a[188:191], a[144:159]
s_waitcnt vmcnt(23) lgkmcnt(0)
s_barrier
v_mfma_f32_32x32x16_bf16 v[160:175], a[192:195], a[208:211], v[160:175]
ds_read_b64_tr_b16 a[176:177], v13 offset:0
s_mov_b32 m0, s33
v_mfma_f32_32x32x16_bf16 v[176:191], a[196:199], a[208:211], v[176:191]
ds_read_b64_tr_b16 a[178:179], v13 offset:1024
buffer_load_dwordx4 v5, s[20:23], s31 offen offset:0 lds
v_mfma_f32_32x32x16_bf16 v[192:207], a[200:203], a[208:211], v[192:207]
ds_read_b128 a[160:163], v11 offset:0
v_mfma_f32_32x32x16_bf16 v[208:223], a[204:207], a[208:211], v[208:223]
ds_read_b128 a[164:167], v11 offset:4096
v_mfma_f32_32x32x16_bf16 v[224:239], a[192:195], a[212:215], v[224:239]
ds_read_b128 a[168:171], v11 offset:8192
v_mfma_f32_32x32x16_bf16 v[240:255], a[196:199], a[212:215], v[240:255]
ds_read_b128 a[172:175], v11 offset:12288
buffer_load_dwordx4 v6, s[20:23], s31 offen offset:1024 lds
v_mfma_f32_32x32x16_bf16 a[0:15], a[200:203], a[212:215], a[0:15]
ds_read_b64_tr_b16 a[180:181], v14 offset:0
s_add_u32 s25, s38, 4096
v_mfma_f32_32x32x16_bf16 a[16:31], a[204:207], a[212:215], a[16:31]
ds_read_b64_tr_b16 a[182:183], v14 offset:1024
buffer_store_dwordx4 v[96:99], v17, s[8:11], s25 offen offset:0 sc1
v_mfma_f32_32x32x16_bf16 a[32:47], a[192:195], a[216:219], a[32:47]
ds_read_b64_tr_b16 a[184:185], v15 offset:0
v_mfma_f32_32x32x16_bf16 a[48:63], a[196:199], a[216:219], a[48:63]
ds_read_b64_tr_b16 a[186:187], v15 offset:1024
buffer_load_dwordx4 v7, s[20:23], s31 offen offset:2048 lds
v_mfma_f32_32x32x16_bf16 a[64:79], a[200:203], a[216:219], a[64:79]
ds_read_b64_tr_b16 a[188:189], v16 offset:0
v_mfma_f32_32x32x16_bf16 a[80:95], a[204:207], a[216:219], a[80:95]
ds_read_b64_tr_b16 a[190:191], v16 offset:1024
buffer_load_dword v22, v23, s[96:99], s100 offen
s_add_u32 s100, s100, 8192
v_mfma_f32_32x32x16_bf16 a[96:111], a[192:195], a[220:223], a[96:111]
v_mfma_f32_32x32x16_bf16 a[112:127], a[196:199], a[220:223], a[112:127]
buffer_load_dwordx4 v8, s[20:23], s31 offen offset:3072 lds
v_mfma_f32_32x32x16_bf16 a[128:143], a[200:203], a[220:223], a[128:143]
s_add_u32 s31, s31, 262144
s_add_u32 s33, s33, 16384
s_and_b32 s33, s33, 65535
s_add_u32 s25, s38, 4096
v_mfma_f32_32x32x16_bf16 a[144:159], a[204:207], a[220:223], a[144:159]
buffer_store_dwordx4 v[100:103], v17, s[8:11], s25 offen offset:1024 sc1
s_waitcnt lgkmcnt(0)
v_mfma_f32_32x32x16_bf16 v[160:175], a[160:163], a[176:179], v[160:175]
ds_read_b64_tr_b16 a[208:209], v13 offset:4096
s_add_u32 m0, s32, 16384
s_add_u32 s48, s30, s34
v_mfma_f32_32x32x16_bf16 v[176:191], a[164:167], a[176:179], v[176:191]
ds_read_b64_tr_b16 a[210:211], v13 offset:5120
buffer_load_dwordx4 v1, s[12:15], s48 offen lds
v_mfma_f32_32x32x16_bf16 v[192:207], a[168:171], a[176:179], v[192:207]
ds_read_b128 a[192:195], v12 offset:0
v_mfma_f32_32x32x16_bf16 v[208:223], a[172:175], a[176:179], v[208:223]
ds_read_b128 a[196:199], v12 offset:4096
v_mfma_f32_32x32x16_bf16 v[224:239], a[160:163], a[180:183], v[224:239]
ds_read_b128 a[200:203], v12 offset:8192
s_add_u32 m0, s32, 20480
v_mfma_f32_32x32x16_bf16 v[240:255], a[164:167], a[180:183], v[240:255]
ds_read_b128 a[204:207], v12 offset:12288
buffer_load_dwordx4 v2, s[12:15], s48 offen lds
v_mfma_f32_32x32x16_bf16 a[0:15], a[168:171], a[180:183], a[0:15]
ds_read_b64_tr_b16 a[212:213], v14 offset:4096
s_add_u32 s25, s38, 20480
v_mfma_f32_32x32x16_bf16 a[16:31], a[172:175], a[180:183], a[16:31]
ds_read_b64_tr_b16 a[214:215], v14 offset:5120
buffer_store_dwordx4 v[104:107], v17, s[8:11], s25 offen offset:0 sc1
v_mfma_f32_32x32x16_bf16 a[32:47], a[160:163], a[184:187], a[32:47]
ds_read_b64_tr_b16 a[216:217], v15 offset:4096
s_add_u32 m0, s32, 24576
v_mfma_f32_32x32x16_bf16 a[48:63], a[164:167], a[184:187], a[48:63]
ds_read_b64_tr_b16 a[218:219], v15 offset:5120
buffer_load_dwordx4 v3, s[12:15], s48 offen lds
v_mfma_f32_32x32x16_bf16 a[64:79], a[168:171], a[184:187], a[64:79]
ds_read_b64_tr_b16 a[220:221], v16 offset:4096
v_mfma_f32_32x32x16_bf16 a[80:95], a[172:175], a[184:187], a[80:95]
ds_read_b64_tr_b16 a[222:223], v16 offset:5120
v_add_u32 v9, 32768, v9
v_subrev_u32 v20, 98304, v9
v_cmp_le_u32 vcc, 163840, v9
v_add_u32 v13, 16384, v13
v_mfma_f32_32x32x16_bf16 a[96:111], a[160:163], a[188:191], a[96:111]
s_add_u32 m0, s32, 28672
v_and_b32 v13, 65535, v13
v_add_u32 v14, 16384, v14
v_and_b32 v14, 65535, v14
v_add_u32 v15, 16384, v15
v_mfma_f32_32x32x16_bf16 a[112:127], a[164:167], a[188:191], a[112:127]
buffer_load_dwordx4 v4, s[12:15], s48 offen lds
v_and_b32 v15, 65535, v15
v_add_u32 v16, 16384, v16
v_and_b32 v16, 65535, v16
v_mfma_f32_32x32x16_bf16 a[128:143], a[168:171], a[188:191], a[128:143]
s_add_u32 s30, s30, 128
s_add_u32 s32, s32, 32768
s_sub_u32 s24, s32, 98304
s_cmp_ge_u32 s32, 163840
s_cselect_b32 s32, s24, s32
v_cndmask_b32 v9, v9, v20, vcc
v_xor_b32 v10, 32, v9
v_xor_b32 v11, 64, v9
v_xor_b32 v12, 96, v9
v_mfma_f32_32x32x16_bf16 a[144:159], a[172:175], a[188:191], a[144:159]
s_waitcnt vmcnt(23) lgkmcnt(0)
s_barrier
v_mfma_f32_32x32x16_bf16 v[160:175], a[192:195], a[208:211], v[160:175]
ds_read_b64_tr_b16 a[176:177], v13 offset:0
s_mov_b32 m0, s33
v_mfma_f32_32x32x16_bf16 v[176:191], a[196:199], a[208:211], v[176:191]
ds_read_b64_tr_b16 a[178:179], v13 offset:1024
buffer_load_dwordx4 v5, s[20:23], s31 offen offset:0 lds
v_mfma_f32_32x32x16_bf16 v[192:207], a[200:203], a[208:211], v[192:207]
ds_read_b128 a[160:163], v9 offset:0
v_mfma_f32_32x32x16_bf16 v[208:223], a[204:207], a[208:211], v[208:223]
ds_read_b128 a[164:167], v9 offset:4096
v_mfma_f32_32x32x16_bf16 v[224:239], a[192:195], a[212:215], v[224:239]
ds_read_b128 a[168:171], v9 offset:8192
v_mfma_f32_32x32x16_bf16 v[240:255], a[196:199], a[212:215], v[240:255]
ds_read_b128 a[172:175], v9 offset:12288
buffer_load_dwordx4 v6, s[20:23], s31 offen offset:1024 lds
v_mfma_f32_32x32x16_bf16 a[0:15], a[200:203], a[212:215], a[0:15]
ds_read_b64_tr_b16 a[180:181], v14 offset:0
s_add_u32 s25, s38, 20480
v_mfma_f32_32x32x16_bf16 a[16:31], a[204:207], a[212:215], a[16:31]
ds_read_b64_tr_b16 a[182:183], v14 offset:1024
buffer_store_dwordx4 v[108:111], v17, s[8:11], s25 offen offset:1024 sc1
v_mfma_f32_32x32x16_bf16 a[32:47], a[192:195], a[216:219], a[32:47]
ds_read_b64_tr_b16 a[184:185], v15 offset:0
v_mfma_f32_32x32x16_bf16 a[48:63], a[196:199], a[216:219], a[48:63]
ds_read_b64_tr_b16 a[186:187], v15 offset:1024
buffer_load_dwordx4 v7, s[20:23], s31 offen offset:2048 lds
v_mfma_f32_32x32x16_bf16 a[64:79], a[200:203], a[216:219], a[64:79]
ds_read_b64_tr_b16 a[188:189], v16 offset:0
v_mfma_f32_32x32x16_bf16 a[80:95], a[204:207], a[216:219], a[80:95]
ds_read_b64_tr_b16 a[190:191], v16 offset:1024
buffer_load_dword v22, v23, s[96:99], s100 offen
s_add_u32 s100, s100, 8192
v_mfma_f32_32x32x16_bf16 a[96:111], a[192:195], a[220:223], a[96:111]
v_mfma_f32_32x32x16_bf16 a[112:127], a[196:199], a[220:223], a[112:127]
buffer_load_dwordx4 v8, s[20:23], s31 offen offset:3072 lds
v_mfma_f32_32x32x16_bf16 a[128:143], a[200:203], a[220:223], a[128:143]
s_add_u32 s31, s31, 262144
s_add_u32 s33, s33, 16384
s_and_b32 s33, s33, 65535
v_mfma_f32_32x32x16_bf16 a[144:159], a[204:207], a[220:223], a[144:159]
s_waitcnt lgkmcnt(0)
v_mfma_f32_32x32x16_bf16 v[160:175], a[160:163], a[176:179], v[160:175]
ds_read_b64_tr_b16 a[208:209], v13 offset:4096
s_add_u32 m0, s32, 0
s_mov_b32 s48, s30
v_mfma_f32_32x32x16_bf16 v[176:191], a[164:167], a[176:179], v[176:191]
ds_read_b64_tr_b16 a[210:211], v13 offset:5120
buffer_load_dwordx4 v1, s[12:15], s48 offen lds
v_mfma_f32_32x32x16_bf16 v[192:207], a[168:171], a[176:179], v[192:207]
ds_read_b128 a[192:195], v10 offset:0
v_mfma_f32_32x32x16_bf16 v[208:223], a[172:175], a[176:179], v[208:223]
ds_read_b128 a[196:199], v10 offset:4096
v_mfma_f32_32x32x16_bf16 v[224:239], a[160:163], a[180:183], v[224:239]
ds_read_b128 a[200:203], v10 offset:8192
s_add_u32 m0, s32, 4096
v_mfma_f32_32x32x16_bf16 v[240:255], a[164:167], a[180:183], v[240:255]
ds_read_b128 a[204:207], v10 offset:12288
buffer_load_dwordx4 v2, s[12:15], s48 offen lds
v_mfma_f32_32x32x16_bf16 a[0:15], a[168:171], a[180:183], a[0:15]
ds_read_b64_tr_b16 a[212:213], v14 offset:4096
s_add_u32 s25, s38, 36864
v_mfma_f32_32x32x16_bf16 a[16:31], a[172:175], a[180:183], a[16:31]
ds_read_b64_tr_b16 a[214:215], v14 offset:5120
buffer_store_dwordx4 v[112:115], v17, s[8:11], s25 offen offset:0 sc1
v_mfma_f32_32x32x16_bf16 a[32:47], a[160:163], a[184:187], a[32:47]
ds_read_b64_tr_b16 a[216:217], v15 offset:4096
s_add_u32 m0, s32, 8192
v_mfma_f32_32x32x16_bf16 a[48:63], a[164:167], a[184:187], a[48:63]
ds_read_b64_tr_b16 a[218:219], v15 offset:5120
buffer_load_dwordx4 v3, s[12:15], s48 offen lds
v_mfma_f32_32x32x16_bf16 a[64:79], a[168:171], a[184:187], a[64:79]
ds_read_b64_tr_b16 a[220:221], v16 offset:4096
v_mfma_f32_32x32x16_bf16 a[80:95], a[172:175], a[184:187], a[80:95]
ds_read_b64_tr_b16 a[222:223], v16 offset:5120
v_add_u32 v13, 16384, v13
v_and_b32 v13, 65535, v13
v_mfma_f32_32x32x16_bf16 a[96:111], a[160:163], a[188:191], a[96:111]
s_add_u32 m0, s32, 12288
v_add_u32 v14, 16384, v14
v_and_b32 v14, 65535, v14
v_mfma_f32_32x32x16_bf16 a[112:127], a[164:167], a[188:191], a[112:127]
buffer_load_dwordx4 v4, s[12:15], s48 offen lds
v_add_u32 v15, 16384, v15
v_and_b32 v15, 65535, v15
v_mfma_f32_32x32x16_bf16 a[128:143], a[168:171], a[188:191], a[128:143]
s_add_u32 s25, s38, 36864
v_add_u32 v16, 16384, v16
v_and_b32 v16, 65535, v16
v_mfma_f32_32x32x16_bf16 a[144:159], a[172:175], a[188:191], a[144:159]
buffer_store_dwordx4 v[116:119], v17, s[8:11], s25 offen offset:1024 sc1
s_waitcnt vmcnt(24) lgkmcnt(0)
s_barrier
v_mfma_f32_32x32x16_bf16 v[160:175], a[192:195], a[208:211], v[160:175]
ds_read_b64_tr_b16 a[176:177], v13 offset:0
s_mov_b32 m0, s33
v_mfma_f32_32x32x16_bf16 v[176:191], a[196:199], a[208:211], v[176:191]
ds_read_b64_tr_b16 a[178:179], v13 offset:1024
buffer_load_dwordx4 v5, s[20:23], s31 offen offset:0 lds
v_mfma_f32_32x32x16_bf16 v[192:207], a[200:203], a[208:211], v[192:207]
ds_read_b128 a[160:163], v11 offset:0
v_mfma_f32_32x32x16_bf16 v[208:223], a[204:207], a[208:211], v[208:223]
ds_read_b128 a[164:167], v11 offset:4096
v_mfma_f32_32x32x16_bf16 v[224:239], a[192:195], a[212:215], v[224:239]
ds_read_b128 a[168:171], v11 offset:8192
v_mfma_f32_32x32x16_bf16 v[240:255], a[196:199], a[212:215], v[240:255]
ds_read_b128 a[172:175], v11 offset:12288
buffer_load_dwordx4 v6, s[20:23], s31 offen offset:1024 lds
v_mfma_f32_32x32x16_bf16 a[0:15], a[200:203], a[212:215], a[0:15]
ds_read_b64_tr_b16 a[180:181], v14 offset:0
s_add_u32 s25, s38, 53248
v_mfma_f32_32x32x16_bf16 a[16:31], a[204:207], a[212:215], a[16:31]
ds_read_b64_tr_b16 a[182:183], v14 offset:1024
buffer_store_dwordx4 v[120:123], v17, s[8:11], s25 offen offset:0 sc1
v_mfma_f32_32x32x16_bf16 a[32:47], a[192:195], a[216:219], a[32:47]
ds_read_b64_tr_b16 a[184:185], v15 offset:0
v_mfma_f32_32x32x16_bf16 a[48:63], a[196:199], a[216:219], a[48:63]
ds_read_b64_tr_b16 a[186:187], v15 offset:1024
buffer_load_dwordx4 v7, s[20:23], s31 offen offset:2048 lds
v_mfma_f32_32x32x16_bf16 a[64:79], a[200:203], a[216:219], a[64:79]
ds_read_b64_tr_b16 a[188:189], v16 offset:0
v_mfma_f32_32x32x16_bf16 a[80:95], a[204:207], a[216:219], a[80:95]
ds_read_b64_tr_b16 a[190:191], v16 offset:1024
buffer_load_dword v22, v23, s[96:99], s100 offen
s_add_u32 s100, s100, 8192
v_mfma_f32_32x32x16_bf16 a[96:111], a[192:195], a[220:223], a[96:111]
v_mfma_f32_32x32x16_bf16 a[112:127], a[196:199], a[220:223], a[112:127]
buffer_load_dwordx4 v8, s[20:23], s31 offen offset:3072 lds
v_mfma_f32_32x32x16_bf16 a[128:143], a[200:203], a[220:223], a[128:143]
s_add_u32 s31, s31, 262144
s_add_u32 s33, s33, 16384
s_and_b32 s33, s33, 65535
v_mfma_f32_32x32x16_bf16 a[144:159], a[204:207], a[220:223], a[144:159]
s_waitcnt lgkmcnt(0)
v_mfma_f32_32x32x16_bf16 v[160:175], a[160:163], a[176:179], v[160:175]
ds_read_b64_tr_b16 a[208:209], v13 offset:4096
s_add_u32 m0, s32, 16384
s_add_u32 s48, s30, s34
v_mfma_f32_32x32x16_bf16 v[176:191], a[164:167], a[176:179], v[176:191]
ds_read_b64_tr_b16 a[210:211], v13 offset:5120
buffer_load_dwordx4 v1, s[12:15], s48 offen lds
v_mfma_f32_32x32x16_bf16 v[192:207], a[168:171], a[176:179], v[192:207]
ds_read_b128 a[192:195], v12 offset:0
v_mfma_f32_32x32x16_bf16 v[208:223], a[172:175], a[176:179], v[208:223]
ds_read_b128 a[196:199], v12 offset:4096
v_mfma_f32_32x32x16_bf16 v[224:239], a[160:163], a[180:183], v[224:239]
ds_read_b128 a[200:203], v12 offset:8192
s_add_u32 m0, s32, 20480
v_mfma_f32_32x32x16_bf16 v[240:255], a[164:167], a[180:183], v[240:255]
ds_read_b128 a[204:207], v12 offset:12288
buffer_load_dwordx4 v2, s[12:15], s48 offen lds
v_mfma_f32_32x32x16_bf16 a[0:15], a[168:171], a[180:183], a[0:15]
ds_read_b64_tr_b16 a[212:213], v14 offset:4096
s_add_u32 s25, s38, 53248
v_mfma_f32_32x32x16_bf16 a[16:31], a[172:175], a[180:183], a[16:31]
ds_read_b64_tr_b16 a[214:215], v14 offset:5120
buffer_store_dwordx4 v[124:127], v17, s[8:11], s25 offen offset:1024 sc1
v_mfma_f32_32x32x16_bf16 a[32:47], a[160:163], a[184:187], a[32:47]
ds_read_b64_tr_b16 a[216:217], v15 offset:4096
s_add_u32 m0, s32, 24576
v_mfma_f32_32x32x16_bf16 a[48:63], a[164:167], a[184:187], a[48:63]
ds_read_b64_tr_b16 a[218:219], v15 offset:5120
buffer_load_dwordx4 v3, s[12:15], s48 offen lds
v_mfma_f32_32x32x16_bf16 a[64:79], a[168:171], a[184:187], a[64:79]
ds_read_b64_tr_b16 a[220:221], v16 offset:4096
v_mfma_f32_32x32x16_bf16 a[80:95], a[172:175], a[184:187], a[80:95]
ds_read_b64_tr_b16 a[222:223], v16 offset:5120
v_add_u32 v9, 32768, v9
v_subrev_u32 v20, 98304, v9
v_cmp_le_u32 vcc, 163840, v9
v_add_u32 v13, 16384, v13
v_mfma_f32_32x32x16_bf16 a[96:111], a[160:163], a[188:191], a[96:111]
s_add_u32 m0, s32, 28672
v_and_b32 v13, 65535, v13
v_add_u32 v14, 16384, v14
v_and_b32 v14, 65535, v14
v_add_u32 v15, 16384, v15
v_mfma_f32_32x32x16_bf16 a[112:127], a[164:167], a[188:191], a[112:127]
buffer_load_dwordx4 v4, s[12:15], s48 offen lds
v_and_b32 v15, 65535, v15
v_add_u32 v16, 16384, v16
v_and_b32 v16, 65535, v16
v_mfma_f32_32x32x16_bf16 a[128:143], a[168:171], a[188:191], a[128:143]
s_add_u32 s30, s30, 128
s_add_u32 s32, s32, 32768
s_sub_u32 s24, s32, 98304
s_cmp_ge_u32 s32, 163840
s_cselect_b32 s32, s24, s32
v_cndmask_b32 v9, v9, v20, vcc
v_xor_b32 v10, 32, v9
v_xor_b32 v11, 64, v9
v_xor_b32 v12, 96, v9
v_mfma_f32_32x32x16_bf16 a[144:159], a[172:175], a[188:191], a[144:159]
s_waitcnt vmcnt(23) lgkmcnt(0)
s_barrier
v_mfma_f32_32x32x16_bf16 v[160:175], a[192:195], a[208:211], v[160:175]
ds_read_b64_tr_b16 a[176:177], v13 offset:0
s_mov_b32 m0, s33
v_mfma_f32_32x32x16_bf16 v[176:191], a[196:199], a[208:211], v[176:191]
ds_read_b64_tr_b16 a[178:179], v13 offset:1024
buffer_load_dwordx4 v5, s[20:23], s31 offen offset:0 lds
v_mfma_f32_32x32x16_bf16 v[192:207], a[200:203], a[208:211], v[192:207]
ds_read_b128 a[160:163], v9 offset:0
v_mfma_f32_32x32x16_bf16 v[208:223], a[204:207], a[208:211], v[208:223]
ds_read_b128 a[164:167], v9 offset:4096
v_mfma_f32_32x32x16_bf16 v[224:239], a[192:195], a[212:215], v[224:239]
ds_read_b128 a[168:171], v9 offset:8192
v_mfma_f32_32x32x16_bf16 v[240:255], a[196:199], a[212:215], v[240:255]
ds_read_b128 a[172:175], v9 offset:12288
buffer_load_dwordx4 v6, s[20:23], s31 offen offset:1024 lds
v_mfma_f32_32x32x16_bf16 a[0:15], a[200:203], a[212:215], a[0:15]
ds_read_b64_tr_b16 a[180:181], v14 offset:0
s_add_u32 s25, s38, 6144
v_mfma_f32_32x32x16_bf16 a[16:31], a[204:207], a[212:215], a[16:31]
ds_read_b64_tr_b16 a[182:183], v14 offset:1024
buffer_store_dwordx4 v[128:131], v17, s[8:11], s25 offen offset:0 sc1
v_mfma_f32_32x32x16_bf16 a[32:47], a[192:195], a[216:219], a[32:47]
ds_read_b64_tr_b16 a[184:185], v15 offset:0
v_mfma_f32_32x32x16_bf16 a[48:63], a[196:199], a[216:219], a[48:63]
ds_read_b64_tr_b16 a[186:187], v15 offset:1024
buffer_load_dwordx4 v7, s[20:23], s31 offen offset:2048 lds
v_mfma_f32_32x32x16_bf16 a[64:79], a[200:203], a[216:219], a[64:79]
ds_read_b64_tr_b16 a[188:189], v16 offset:0
v_mfma_f32_32x32x16_bf16 a[80:95], a[204:207], a[216:219], a[80:95]
ds_read_b64_tr_b16 a[190:191], v16 offset:1024
v_mfma_f32_32x32x16_bf16 a[96:111], a[192:195], a[220:223], a[96:111]
v_mfma_f32_32x32x16_bf16 a[112:127], a[196:199], a[220:223], a[112:127]
buffer_load_dwordx4 v8, s[20:23], s31 offen offset:3072 lds
v_mfma_f32_32x32x16_bf16 a[128:143], a[200:203], a[220:223], a[128:143]
s_add_u32 s31, s31, 262144
s_add_u32 s33, s33, 16384
s_and_b32 s33, s33, 65535
s_add_u32 s25, s38, 6144
v_mfma_f32_32x32x16_bf16 a[144:159], a[204:207], a[220:223], a[144:159]
buffer_store_dwordx4 v[132:135], v17, s[8:11], s25 offen offset:1024 sc1
s_cmp_eq_u32 s36, 0
s_cbranch_scc1 L_g_v6
s_waitcnt lgkmcnt(0)
v_mfma_f32_32x32x16_bf16 v[160:175], a[160:163], a[176:179], v[160:175]
ds_read_b64_tr_b16 a[208:209], v13 offset:4096
s_add_u32 m0, s32, 0
s_mov_b32 s48, s30
v_mfma_f32_32x32x16_bf16 v[176:191], a[164:167], a[176:179], v[176:191]
ds_read_b64_tr_b16 a[210:211], v13 offset:5120
buffer_load_dwordx4 v1, s[12:15], s48 offen lds
v_mfma_f32_32x32x16_bf16 v[192:207], a[168:171], a[176:179], v[192:207]
ds_read_b128 a[192:195], v10 offset:0
v_mfma_f32_32x32x16_bf16 v[208:223], a[172:175], a[176:179], v[208:223]
ds_read_b128 a[196:199], v10 offset:4096
v_mfma_f32_32x32x16_bf16 v[224:239], a[160:163], a[180:183], v[224:239]
ds_read_b128 a[200:203], v10 offset:8192
s_add_u32 m0, s32, 4096
v_mfma_f32_32x32x16_bf16 v[240:255], a[164:167], a[180:183], v[240:255]
ds_read_b128 a[204:207], v10 offset:12288
buffer_load_dwordx4 v2, s[12:15], s48 offen lds
v_mfma_f32_32x32x16_bf16 a[0:15], a[168:171], a[180:183], a[0:15]
ds_read_b64_tr_b16 a[212:213], v14 offset:4096
v_mfma_f32_32x32x16_bf16 a[16:31], a[172:175], a[180:183], a[16:31]
ds_read_b64_tr_b16 a[214:215], v14 offset:5120
v_mfma_f32_32x32x16_bf16 a[32:47], a[160:163], a[184:187], a[32:47]
ds_read_b64_tr_b16 a[216:217], v15 offset:4096
s_add_u32 m0, s32, 8192
v_mfma_f32_32x32x16_bf16 a[48:63], a[164:167], a[184:187], a[48:63]
ds_read_b64_tr_b16 a[218:219], v15 offset:5120
buffer_load_dwordx4 v3, s[12:15], s48 offen lds
v_mfma_f32_32x32x16_bf16 a[64:79], a[168:171], a[184:187], a[64:79]
ds_read_b64_tr_b16 a[220:221], v16 offset:4096
v_mfma_f32_32x32x16_bf16 a[80:95], a[172:175], a[184:187], a[80:95]
ds_read_b64_tr_b16 a[222:223], v16 offset:5120
v_add_u32 v13, 16384, v13
v_and_b32 v13, 65535, v13
v_mfma_f32_32x32x16_bf16 a[96:111], a[160:163], a[188:191], a[96:111]
s_add_u32 m0, s32, 12288
v_add_u32 v14, 16384, v14
v_and_b32 v14, 65535, v14
v_mfma_f32_32x32x16_bf16 a[112:127], a[164:167], a[188:191], a[112:127]
buffer_load_dwordx4 v4, s[12:15], s48 offen lds
v_add_u32 v15, 16384, v15
v_and_b32 v15, 65535, v15
v_mfma_f32_32x32x16_bf16 a[128:143], a[168:171], a[188:191], a[128:143]
v_add_u32 v16, 16384, v16
v_and_b32 v16, 65535, v16
v_mfma_f32_32x32x16_bf16 a[144:159], a[172:175], a[188:191], a[144:159]
s_waitcnt vmcnt(21) lgkmcnt(0)
s_barrier
v_mfma_f32_32x32x16_bf16 v[160:175], a[192:195], a[208:211], v[160:175]
ds_read_b64_tr_b16 a[176:177], v13 offset:0
s_mov_b32 m0, s33
v_mfma_f32_32x32x16_bf16 v[176:191], a[196:199], a[208:211], v[176:191]
ds_read_b64_tr_b16 a[178:179], v13 offset:1024
buffer_load_dwordx4 v5, s[20:23], s31 offen offset:0 lds
v_mfma_f32_32x32x16_bf16 v[192:207], a[200:203], a[208:211], v[192:207]
ds_read_b128 a[160:163], v11 offset:0
v_mfma_f32_32x32x16_bf16 v[208:223], a[204:207], a[208:211], v[208:223]
ds_read_b128 a[164:167], v11 offset:4096
v_mfma_f32_32x32x16_bf16 v[224:239], a[192:195], a[212:215], v[224:239]
ds_read_b128 a[168:171], v11 offset:8192
v_mfma_f32_32x32x16_bf16 v[240:255], a[196:199], a[212:215], v[240:255]
ds_read_b128 a[172:175], v11 offset:12288
buffer_load_dwordx4 v6, s[20:23], s31 offen offset:1024 lds
v_mfma_f32_32x32x16_bf16 a[0:15], a[200:203], a[212:215], a[0:15]
ds_read_b64_tr_b16 a[180:181], v14 offset:0
v_mfma_f32_32x32x16_bf16 a[16:31], a[204:207], a[212:215], a[16:31]
ds_read_b64_tr_b16 a[182:183], v14 offset:1024
v_mfma_f32_32x32x16_bf16 a[32:47], a[192:195], a[216:219], a[32:47]
ds_read_b64_tr_b16 a[184:185], v15 offset:0
v_mfma_f32_32x32x16_bf16 a[48:63], a[196:199], a[216:219], a[48:63]
ds_read_b64_tr_b16 a[186:187], v15 offset:1024
buffer_load_dwordx4 v7, s[20:23], s31 offen offset:2048 lds
v_mfma_f32_32x32x16_bf16 a[64:79], a[200:203], a[216:219], a[64:79]
ds_read_b64_tr_b16 a[188:189], v16 offset:0
v_mfma_f32_32x32x16_bf16 a[80:95], a[204:207], a[216:219], a[80:95]
ds_read_b64_tr_b16 a[190:191], v16 offset:1024
v_mfma_f32_32x32x16_bf16 a[96:111], a[192:195], a[220:223], a[96:111]
v_mfma_f32_32x32x16_bf16 a[112:127], a[196:199], a[220:223], a[112:127]
buffer_load_dwordx4 v8, s[20:23], s31 offen offset:3072 lds
v_mfma_f32_32x32x16_bf16 a[128:143], a[200:203], a[220:223], a[128:143]
s_add_u32 s31, s31, 262144
s_add_u32 s33, s33, 16384
s_and_b32 s33, s33, 65535
v_mfma_f32_32x32x16_bf16 a[144:159], a[204:207], a[220:223], a[144:159]
s_waitcnt lgkmcnt(0)
v_mfma_f32_32x32x16_bf16 v[160:175], a[160:163], a[176:179], v[160:175]
ds_read_b64_tr_b16 a[208:209], v13 offset:4096
s_add_u32 m0, s32, 16384
s_add_u32 s48, s30, s34
v_mfma_f32_32x32x16_bf16 v[176:191], a[164:167], a[176:179], v[176:191]
ds_read_b64_tr_b16 a[210:211], v13 offset:5120
buffer_load_dwordx4 v1, s[12:15], s48 offen lds
v_mfma_f32_32x32x16_bf16 v[192:207], a[168:171], a[176:179], v[192:207]
ds_read_b128 a[192:195], v12 offset:0
v_mfma_f32_32x32x16_bf16 v[208:223], a[172:175], a[176:179], v[208:223]
ds_read_b128 a[196:199], v12 offset:4096
v_mfma_f32_32x32x16_bf16 v[224:239], a[160:163], a[180:183], v[224:239]
ds_read_b128 a[200:203], v12 offset:8192
s_add_u32 m0, s32, 20480
v_mfma_f32_32x32x16_bf16 v[240:255], a[164:167], a[180:183], v[240:255]
ds_read_b128 a[204:207], v12 offset:12288
buffer_load_dwordx4 v2, s[12:15], s48 offen lds
v_mfma_f32_32x32x16_bf16 a[0:15], a[168:171], a[180:183], a[0:15]
ds_read_b64_tr_b16 a[212:213], v14 offset:4096
v_mfma_f32_32x32x16_bf16 a[16:31], a[172:175], a[180:183], a[16:31]
ds_read_b64_tr_b16 a[214:215], v14 offset:5120
v_mfma_f32_32x32x16_bf16 a[32:47], a[160:163], a[184:187], a[32:47]
ds_read_b64_tr_b16 a[216:217], v15 offset:4096
s_add_u32 m0, s32, 24576
v_mfma_f32_32x32x16_bf16 a[48:63], a[164:167], a[184:187], a[48:63]
ds_read_b64_tr_b16 a[218:219], v15 offset:5120
buffer_load_dwordx4 v3, s[12:15], s48 offen lds
v_mfma_f32_32x32x16_bf16 a[64:79], a[168:171], a[184:187], a[64:79]
ds_read_b64_tr_b16 a[220:221], v16 offset:4096
v_mfma_f32_32x32x16_bf16 a[80:95], a[172:175], a[184:187], a[80:95]
ds_read_b64_tr_b16 a[222:223], v16 offset:5120
v_add_u32 v9, 32768, v9
v_subrev_u32 v20, 98304, v9
v_cmp_le_u32 vcc, 163840, v9
v_add_u32 v13, 16384, v13
v_mfma_f32_32x32x16_bf16 a[96:111], a[160:163], a[188:191], a[96:111]
s_add_u32 m0, s32, 28672
v_and_b32 v13, 65535, v13
v_add_u32 v14, 16384, v14
v_and_b32 v14, 65535, v14
v_add_u32 v15, 16384, v15
v_mfma_f32_32x32x16_bf16 a[112:127], a[164:167], a[188:191], a[112:127]
buffer_load_dwordx4 v4, s[12:15], s48 offen lds
v_and_b32 v15, 65535, v15
v_add_u32 v16, 16384, v16
v_and_b32 v16, 65535, v16
v_mfma_f32_32x32x16_bf16 a[128:143], a[168:171], a[188:191], a[128:143]
s_add_u32 s30, s30, 128
s_add_u32 s32, s32, 32768
s_sub_u32 s24, s32, 98304
s_cmp_ge_u32 s32, 163840
s_cselect_b32 s32, s24, s32
v_cndmask_b32 v9, v9, v20, vcc
v_xor_b32 v10, 32, v9
v_xor_b32 v11, 64, v9
v_xor_b32 v12, 96, v9
v_mfma_f32_32x32x16_bf16 a[144:159], a[172:175], a[188:191], a[144:159]
s_waitcnt vmcnt(18) lgkmcnt(0)
s_barrier
v_mfma_f32_32x32x16_bf16 v[160:175], a[192:195], a[208:211], v[160:175]
ds_read_b64_tr_b16 a[176:177], v13 offset:0
s_mov_b32 m0, s33
v_mfma_f32_32x32x16_bf16 v[176:191], a[196:199], a[208:211], v[176:191]
ds_read_b64_tr_b16 a[178:179], v13 offset:1024
buffer_load_dwordx4 v5, s[20:23], s31 offen offset:0 lds
v_mfma_f32_32x32x16_bf16 v[192:207], a[200:203], a[208:211], v[192:207]
ds_read_b128 a[160:163], v9 offset:0
v_mfma_f32_32x32x16_bf16 v[208:223], a[204:207], a[208:211], v[208:223]
ds_read_b128 a[164:167], v9 offset:4096
v_mfma_f32_32x32x16_bf16 v[224:239], a[192:195], a[212:215], v[224:239]
ds_read_b128 a[168:171], v9 offset:8192
v_mfma_f32_32x32x16_bf16 v[240:255], a[196:199], a[212:215], v[240:255]
ds_read_b128 a[172:175], v9 offset:12288
buffer_load_dwordx4 v6, s[20:23], s31 offen offset:1024 lds
v_mfma_f32_32x32x16_bf16 a[0:15], a[200:203], a[212:215], a[0:15]
ds_read_b64_tr_b16 a[180:181], v14 offset:0
v_mfma_f32_32x32x16_bf16 a[16:31], a[204:207], a[212:215], a[16:31]
ds_read_b64_tr_b16 a[182:183], v14 offset:1024
v_mfma_f32_32x32x16_bf16 a[32:47], a[192:195], a[216:219], a[32:47]
ds_read_b64_tr_b16 a[184:185], v15 offset:0
v_mfma_f32_32x32x16_bf16 a[48:63], a[196:199], a[216:219], a[48:63]
ds_read_b64_tr_b16 a[186:187], v15 offset:1024
buffer_load_dwordx4 v7, s[20:23], s31 offen offset:2048 lds
v_mfma_f32_32x32x16_bf16 a[64:79], a[200:203], a[216:219], a[64:79]
ds_read_b64_tr_b16 a[188:189], v16 offset:0
v_mfma_f32_32x32x16_bf16 a[80:95], a[204:207], a[216:219], a[80:95]
ds_read_b64_tr_b16 a[190:191], v16 offset:1024
v_mfma_f32_32x32x16_bf16 a[96:111], a[192:195], a[220:223], a[96:111]
v_mfma_f32_32x32x16_bf16 a[112:127], a[196:199], a[220:223], a[112:127]
buffer_load_dwordx4 v8, s[20:23], s31 offen offset:3072 lds
v_mfma_f32_32x32x16_bf16 a[128:143], a[200:203], a[220:223], a[128:143]
s_add_u32 s31, s31, 262144
s_add_u32 s33, s33, 16384
s_and_b32 s33, s33, 65535
v_mfma_f32_32x32x16_bf16 a[144:159], a[204:207], a[220:223], a[144:159]
L_g_v6:
s_waitcnt lgkmcnt(0)
v_mfma_f32_32x32x16_bf16 v[160:175], a[160:163], a[176:179], v[160:175]
ds_read_b64_tr_b16 a[208:209], v13 offset:4096
s_add_u32 m0, s32, 0
s_mov_b32 s48, s30
v_mfma_f32_32x32x16_bf16 v[176:191], a[164:167], a[176:179], v[176:191]
ds_read_b64_tr_b16 a[210:211], v13 offset:5120
buffer_load_dwordx4 v1, s[12:15], s48 offen lds
v_mfma_f32_32x32x16_bf16 v[192:207], a[168:171], a[176:179], v[192:207]
ds_read_b128 a[192:195], v10 offset:0
v_mfma_f32_32x32x16_bf16 v[208:223], a[172:175], a[176:179], v[208:223]
ds_read_b128 a[196:199], v10 offset:4096
v_mfma_f32_32x32x16_bf16 v[224:239], a[160:163], a[180:183], v[224:239]
ds_read_b128 a[200:203], v10 offset:8192
s_add_u32 m0, s32, 4096
v_mfma_f32_32x32x16_bf16 v[240:255], a[164:167], a[180:183], v[240:255]
ds_read_b128 a[204:207], v10 offset:12288
buffer_load_dwordx4 v2, s[12:15], s48 offen lds
v_mfma_f32_32x32x16_bf16 a[0:15], a[168:171], a[180:183], a[0:15]
ds_read_b64_tr_b16 a[212:213], v14 offset:4096
s_add_u32 s25, s38, 22528
v_mfma_f32_32x32x16_bf16 a[16:31], a[172:175], a[180:183], a[16:31]
ds_read_b64_tr_b16 a[214:215], v14 offset:5120
buffer_store_dwordx4 v[136:139], v17, s[8:11], s25 offen offset:0 sc1
v_mfma_f32_32x32x16_bf16 a[32:47], a[160:163], a[184:187], a[32:47]
ds_read_b64_tr_b16 a[216:217], v15 offset:4096
s_add_u32 m0, s32, 8192
v_mfma_f32_32x32x16_bf16 a[48:63], a[164:167], a[184:187], a[48:63]
ds_read_b64_tr_b16 a[218:219], v15 offset:5120
buffer_load_dwordx4 v3, s[12:15], s48 offen lds
v_mfma_f32_32x32x16_bf16 a[64:79], a[168:171], a[184:187], a[64:79]
ds_read_b64_tr_b16 a[220:221], v16 offset:4096
v_mfma_f32_32x32x16_bf16 a[80:95], a[172:175], a[184:187], a[80:95]
ds_read_b64_tr_b16 a[222:223], v16 offset:5120
v_add_u32 v13, 16384, v13
v_and_b32 v13, 65535, v13
v_mfma_f32_32x32x16_bf16 a[96:111], a[160:163], a[188:191], a[96:111]
s_add_u32 m0, s32, 12288
v_add_u32 v14, 16384, v14
v_and_b32 v14, 65535, v14
v_mfma_f32_32x32x16_bf16 a[112:127], a[164:167], a[188:191], a[112:127]
buffer_load_dwordx4 v4, s[12:15], s48 offen lds
v_add_u32 v15, 16384, v15
v_and_b32 v15, 65535, v15
v_mfma_f32_32x32x16_bf16 a[128:143], a[168:171], a[188:191], a[128:143]
v_add_u32 v16, 16384, v16
v_and_b32 v16, 65535, v16
v_mfma_f32_32x32x16_bf16 a[144:159], a[172:175], a[188:191], a[144:159]
s_waitcnt vmcnt(17) lgkmcnt(0)
s_barrier
v_mfma_f32_32x32x16_bf16 v[160:175], a[192:195], a[208:211], v[160:175]
ds_read_b64_tr_b16 a[176:177], v13 offset:0
s_mov_b32 m0, s33
v_mfma_f32_32x32x16_bf16 v[176:191], a[196:199], a[208:211], v[176:191]
ds_read_b64_tr_b16 a[178:179], v13 offset:1024
buffer_load_dwordx4 v5, s[20:23], s31 offen offset:0 lds
v_mfma_f32_32x32x16_bf16 v[192:207], a[200:203], a[208:211], v[192:207]
ds_read_b128 a[160:163], v11 offset:0
v_mfma_f32_32x32x16_bf16 v[208:223], a[204:207], a[208:211], v[208:223]
ds_read_b128 a[164:167], v11 offset:4096
v_mfma_f32_32x32x16_bf16 v[224:239], a[192:195], a[212:215], v[224:239]
ds_read_b128 a[168:171], v11 offset:8192
v_mfma_f32_32x32x16_bf16 v[240:255], a[196:199], a[212:215], v[240:255]
ds_read_b128 a[172:175], v11 offset:12288
buffer_load_dwordx4 v6, s[20:23], s31 offen offset:1024 lds
v_mfma_f32_32x32x16_bf16 a[0:15], a[200:203], a[212:215], a[0:15]
ds_read_b64_tr_b16 a[180:181], v14 offset:0
s_add_u32 s25, s38, 22528
v_mfma_f32_32x32x16_bf16 a[16:31], a[204:207], a[212:215], a[16:31]
ds_read_b64_tr_b16 a[182:183], v14 offset:1024
buffer_store_dwordx4 v[140:143], v17, s[8:11], s25 offen offset:1024 sc1
v_mfma_f32_32x32x16_bf16 a[32:47], a[192:195], a[216:219], a[32:47]
ds_read_b64_tr_b16 a[184:185], v15 offset:0
v_mfma_f32_32x32x16_bf16 a[48:63], a[196:199], a[216:219], a[48:63]
ds_read_b64_tr_b16 a[186:187], v15 offset:1024
buffer_load_dwordx4 v7, s[20:23], s31 offen offset:2048 lds
v_mfma_f32_32x32x16_bf16 a[64:79], a[200:203], a[216:219], a[64:79]
ds_read_b64_tr_b16 a[188:189], v16 offset:0
v_mfma_f32_32x32x16_bf16 a[80:95], a[204:207], a[216:219], a[80:95]
ds_read_b64_tr_b16 a[190:191], v16 offset:1024
v_mfma_f32_32x32x16_bf16 a[96:111], a[192:195], a[220:223], a[96:111]
v_mfma_f32_32x32x16_bf16 a[112:127], a[196:199], a[220:223], a[112:127]
buffer_load_dwordx4 v8, s[20:23], s31 offen offset:3072 lds
v_mfma_f32_32x32x16_bf16 a[128:143], a[200:203], a[220:223], a[128:143]
s_add_u32 s31, s31, 262144
s_add_u32 s33, s33, 16384
s_and_b32 s33, s33, 65535
v_mfma_f32_32x32x16_bf16 a[144:159], a[204:207], a[220:223], a[144:159]
s_waitcnt lgkmcnt(0)
v_mfma_f32_32x32x16_bf16 v[160:175], a[160:163], a[176:179], v[160:175]
ds_read_b64_tr_b16 a[208:209], v13 offset:4096
s_add_u32 m0, s32, 16384
s_add_u32 s48, s30, s34
v_mfma_f32_32x32x16_bf16 v[176:191], a[164:167], a[176:179], v[176:191]
ds_read_b64_tr_b16 a[210:211], v13 offset:5120
buffer_load_dwordx4 v1, s[12:15], s48 offen lds
v_mfma_f32_32x32x16_bf16 v[192:207], a[168:171], a[176:179], v[192:207]
ds_read_b128 a[192:195], v12 offset:0
v_mfma_f32_32x32x16_bf16 v[208:223], a[172:175], a[176:179], v[208:223]
ds_read_b128 a[196:199], v12 offset:4096
v_mfma_f32_32x32x16_bf16 v[224:239], a[160:163], a[180:183], v[224:239]
ds_read_b128 a[200:203], v12 offset:8192
s_add_u32 m0, s32, 20480
v_mfma_f32_32x32x16_bf16 v[240:255], a[164:167], a[180:183], v[240:255]
ds_read_b128 a[204:207], v12 offset:12288
buffer_load_dwordx4 v2, s[12:15], s48 offen lds
v_mfma_f32_32x32x16_bf16 a[0:15], a[168:171], a[180:183], a[0:15]
ds_read_b64_tr_b16 a[212:213], v14 offset:4096
s_add_u32 s25, s38, 38912
v_mfma_f32_32x32x16_bf16 a[16:31], a[172:175], a[180:183], a[16:31]
ds_read_b64_tr_b16 a[214:215], v14 offset:5120
buffer_store_dwordx4 v[144:147], v17, s[8:11], s25 offen offset:0 sc1
v_mfma_f32_32x32x16_bf16 a[32:47], a[160:163], a[184:187], a[32:47]
ds_read_b64_tr_b16 a[216:217], v15 offset:4096
s_add_u32 m0, s32, 24576
v_mfma_f32_32x32x16_bf16 a[48:63], a[164:167], a[184:187], a[48:63]
ds_read_b64_tr_b16 a[218:219], v15 offset:5120
buffer_load_dwordx4 v3, s[12:15], s48 offen lds
v_mfma_f32_32x32x16_bf16 a[64:79], a[168:171], a[184:187], a[64:79]
ds_read_b64_tr_b16 a[220:221], v16 offset:4096
v_mfma_f32_32x32x16_bf16 a[80:95], a[172:175], a[184:187], a[80:95]
ds_read_b64_tr_b16 a[222:223], v16 offset:5120
v_add_u32 v9, 32768, v9
v_subrev_u32 v20, 98304, v9
v_cmp_le_u32 vcc, 163840, v9
v_add_u32 v13, 16384, v13
v_mfma_f32_32x32x16_bf16 a[96:111], a[160:163], a[188:191], a[96:111]
s_add_u32 m0, s32, 28672
v_and_b32 v13, 65535, v13
v_add_u32 v14, 16384, v14
v_and_b32 v14, 65535, v14
v_add_u32 v15, 16384, v15
v_mfma_f32_32x32x16_bf16 a[112:127], a[164:167], a[188:191], a[112:127]
buffer_load_dwordx4 v4, s[12:15], s48 offen lds
v_and_b32 v15, 65535, v15
v_add_u32 v16, 16384, v16
v_and_b32 v16, 65535, v16
v_mfma_f32_32x32x16_bf16 a[128:143], a[168:171], a[188:191], a[128:143]
s_add_u32 s30, s30, 128
s_add_u32 s32, s32, 32768
s_sub_u32 s24, s32, 98304
s_cmp_ge_u32 s32, 163840
s_cselect_b32 s32, s24, s32
s_add_u32 s25, s38, 38912
v_cndmask_b32 v9, v9, v20, vcc
v_xor_b32 v10, 32, v9
v_xor_b32 v11, 64, v9
v_xor_b32 v12, 96, v9
v_mfma_f32_32x32x16_bf16 a[144:159], a[172:175], a[188:191], a[144:159]
buffer_store_dwordx4 v[148:151], v17, s[8:11], s25 offen offset:1024 sc1
s_cmp_eq_u32 s61, 0
s_cbranch_scc1 L_px_16
s_lshl_b32 s24, s35, 2
s_lshr_b32 s26, 0xe64a20, s24
s_bfe_u32 s2, s26, 0x10003
s_and_b32 s26, s26, 7
s_add_u32 s24, s2, 1
s_sub_u32 s27, s3, 2
s_cmp_eq_u32 s3, 1
s_cbranch_scc0 L_px_18
s_mov_b32 s2, 1
s_mov_b32 s27, 0
s_branch L_px_18
L_px_16:
s_cmp_eq_u32 s35, 2
s_cselect_b32 s2, 1, 0
s_and_b32 s26, s35, 1
s_lshl_b32 s26, s26, 2
s_add_u32 s24, s2, 2
s_sub_u32 s27, s3, 4
L_px_18:
s_lshl_b32 s27, s27, 5
s_add_u32 s27, s27, s16
s_bfm_b32 s25, s24, 0
s_and_b32 s25, s25, s16
s_add_u32 s26, s26, s25
s_lshr_b32 s27, s27, s24
s_or_b32 s40, s2, s61
s_lshr_b32 s24, s17, 1
s_cmp_eq_u32 s2, 0
s_cselect_b32 s41, s24, 0
s_cselect_b64 s[4:5], s[52:53], s[54:55]
s_cselect_b32 s25, 0, s24
s_and_b32 s51, s41, s61
s_lshl_b32 s46, s27, s2
s_add_u32 s46, s46, s25
s_lshl_b32 s46, s46, 8
s_lshl_b32 s47, s40, 7
s_add_u32 s47, s47, 1024
s_mov_b32 s12, s4
s_and_b32 s13, s5, 0xffff
s_lshl_b32 s14, s47, 11
s_mov_b32 s15, 0x20000
s_mul_i32 s30, s26, s47
s_lshl_b32 s30, s30, 8
s_lshl_b32 s42, s27, 3
s_add_u32 s42, s42, s26
s_lshl_b32 s42, s42, 1
s_and_b32 s25, s17, 1
s_add_u32 s42, s42, s25
s_lshl_b32 s42, s42, 3
s_add_u32 s42, s42, s24
s_lshl_b32 s42, s42, 13
s_lshl_b32 s43, s27, 5
s_add_u32 s43, s43, s26
s_lshl_b32 s43, s43, 2
s_lshl_b32 s24, s2, 1
s_add_u32 s24, s24, s61
s_lshl_b32 s24, s24, 2
s_lshr_b32 s25, 0x8720, s24
s_and_b32 s25, s25, 15
s_lshl_b32 s25, s25, 24
s_add_u32 s42, s42, s25
s_lshr_b32 s25, 0x7604, s24
s_and_b32 s25, s25, 15
s_lshl_b32 s25, s25, 12
s_add_u32 s43, s43, s25
s_add_u32 s43, s43, 111149056
s_mov_b32 s44, 1
s_cmp_lt_u32 s35, s45
s_cselect_b32 s30, s30, 536870912
s_cselect_b32 s46, s46, 536870912
v_lshrrev_b32 v18, 3, v0
v_mul_lo_u32 v18, v18, s47
v_bfe_u32 v19, v0, 4, 3
v_and_b32 v20, 7, v0
v_xor_b32 v20, v20, v19
v_lshl_add_u32 v1, v20, 4, v18
s_lshl_b32 s24, s47, 5
s_lshl_b32 s34, s47, 7
v_add_u32 v2, s24, v1
v_add_u32 v3, s24, v2
v_add_u32 v4, s24, v3
s_waitcnt vmcnt(20) lgkmcnt(0)
s_barrier
v_mfma_f32_32x32x16_bf16 v[160:175], a[192:195], a[208:211], v[160:175]
ds_read_b64_tr_b16 a[176:177], v13 offset:0
s_mov_b32 m0, s33
v_mfma_f32_32x32x16_bf16 v[176:191], a[196:199], a[208:211], v[176:191]
ds_read_b64_tr_b16 a[178:179], v13 offset:1024
buffer_load_dwordx4 v5, s[20:23], s31 offen offset:0 lds
v_mfma_f32_32x32x16_bf16 v[192:207], a[200:203], a[208:211], v[192:207]
ds_read_b128 a[160:163], v9 offset:0
v_mfma_f32_32x32x16_bf16 v[208:223], a[204:207], a[208:211], v[208:223]
ds_read_b128 a[164:167], v9 offset:4096
v_mfma_f32_32x32x16_bf16 v[224:239], a[192:195], a[212:215], v[224:239]
ds_read_b128 a[168:171], v9 offset:8192
v_mfma_f32_32x32x16_bf16 v[240:255], a[196:199], a[212:215], v[240:255]
ds_read_b128 a[172:175], v9 offset:12288
buffer_load_dwordx4 v6, s[20:23], s31 offen offset:1024 lds
v_mfma_f32_32x32x16_bf16 a[0:15], a[200:203], a[212:215], a[0:15]
ds_read_b64_tr_b16 a[180:181], v14 offset:0
s_add_u32 s25, s38, 55296
v_mfma_f32_32x32x16_bf16 a[16:31], a[204:207], a[212:215], a[16:31]
ds_read_b64_tr_b16 a[182:183], v14 offset:1024
buffer_store_dwordx4 v[152:155], v17, s[8:11], s25 offen offset:0 sc1
v_mfma_f32_32x32x16_bf16 a[32:47], a[192:195], a[216:219], a[32:47]
ds_read_b64_tr_b16 a[184:185], v15 offset:0
v_mfma_f32_32x32x16_bf16 a[48:63], a[196:199], a[216:219], a[48:63]
ds_read_b64_tr_b16 a[186:187], v15 offset:1024
buffer_load_dwordx4 v7, s[20:23], s31 offen offset:2048 lds
v_mfma_f32_32x32x16_bf16 a[64:79], a[200:203], a[216:219], a[64:79]
ds_read_b64_tr_b16 a[188:189], v16 offset:0
v_mfma_f32_32x32x16_bf16 a[80:95], a[204:207], a[216:219], a[80:95]
ds_read_b64_tr_b16 a[190:191], v16 offset:1024
v_mfma_f32_32x32x16_bf16 a[96:111], a[192:195], a[220:223], a[96:111]
v_mfma_f32_32x32x16_bf16 a[112:127], a[196:199], a[220:223], a[112:127]
buffer_load_dwordx4 v8, s[20:23], s31 offen offset:3072 lds
v_mfma_f32_32x32x16_bf16 a[128:143], a[200:203], a[220:223], a[128:143]
s_add_u32 s31, s31, 262144
s_add_u32 s33, s33, 16384
s_and_b32 s33, s33, 65535
v_mfma_f32_32x32x16_bf16 a[144:159], a[204:207], a[220:223], a[144:159]
s_waitcnt lgkmcnt(0)
v_mfma_f32_32x32x16_bf16 v[160:175], a[160:163], a[176:179], v[160:175]
ds_read_b64_tr_b16 a[208:209], v13 offset:4096
s_add_u32 m0, s32, 0
s_mov_b32 s48, s30
v_mfma_f32_32x32x16_bf16 v[176:191], a[164:167], a[176:179], v[176:191]
ds_read_b64_tr_b16 a[210:211], v13 offset:5120
buffer_load_dwordx4 v1, s[12:15], s48 offen lds
v_mfma_f32_32x32x16_bf16 v[192:207], a[168:171], a[176:179], v[192:207]
ds_read_b128 a[192:195], v10 offset:0
v_mfma_f32_32x32x16_bf16 v[208:223], a[172:175], a[176:179], v[208:223]
ds_read_b128 a[196:199], v10 offset:4096
v_mfma_f32_32x32x16_bf16 v[224:239], a[160:163], a[180:183], v[224:239]
ds_read_b128 a[200:203], v10 offset:8192
s_add_u32 m0, s32, 4096
v_mfma_f32_32x32x16_bf16 v[240:255], a[164:167], a[180:183], v[240:255]
ds_read_b128 a[204:207], v10 offset:12288
buffer_load_dwordx4 v2, s[12:15], s48 offen lds
v_mfma_f32_32x32x16_bf16 a[0:15], a[168:171], a[180:183], a[0:15]
ds_read_b64_tr_b16 a[212:213], v14 offset:4096
s_add_u32 s25, s38, 55296
v_mfma_f32_32x32x16_bf16 a[16:31], a[172:175], a[180:183], a[16:31]
ds_read_b64_tr_b16 a[214:215], v14 offset:5120
buffer_store_dwordx4 v[156:159], v17, s[8:11], s25 offen offset:1024 sc1
v_mfma_f32_32x32x16_bf16 a[32:47], a[160:163], a[184:187], a[32:47]
ds_read_b64_tr_b16 a[216:217], v15 offset:4096
s_add_u32 m0, s32, 8192
v_mfma_f32_32x32x16_bf16 a[48:63], a[164:167], a[184:187], a[48:63]
ds_read_b64_tr_b16 a[218:219], v15 offset:5120
buffer_load_dwordx4 v3, s[12:15], s48 offen lds
v_mfma_f32_32x32x16_bf16 a[64:79], a[168:171], a[184:187], a[64:79]
ds_read_b64_tr_b16 a[220:221], v16 offset:4096
v_mfma_f32_32x32x16_bf16 a[80:95], a[172:175], a[184:187], a[80:95]
ds_read_b64_tr_b16 a[222:223], v16 offset:5120
v_add_u32 v13, 16384, v13
v_and_b32 v13, 65535, v13
v_mfma_f32_32x32x16_bf16 a[96:111], a[160:163], a[188:191], a[96:111]
s_add_u32 m0, s32, 12288
v_add_u32 v14, 16384, v14
v_and_b32 v14, 65535, v14
v_mfma_f32_32x32x16_bf16 a[112:127], a[164:167], a[188:191], a[112:127]
buffer_load_dwordx4 v4, s[12:15], s48 offen lds
v_add_u32 v15, 16384, v15
v_and_b32 v15, 65535, v15
v_mfma_f32_32x32x16_bf16 a[128:143], a[168:171], a[188:191], a[128:143]
v_add_u32 v16, 16384, v16
v_and_b32 v16, 65535, v16
v_mfma_f32_32x32x16_bf16 a[144:159], a[172:175], a[188:191], a[144:159]
s_cmp_eq_u32 s2, 0
s_cselect_b64 s[4:5], s[6:7], s[18:19]
s_mov_b32 s20, s4
s_and_b32 s21, s5, 0xffff
s_lshl_b32 s22, s47, 12
s_mov_b32 s23, 0x20000
s_mov_b32 s31, s46
s_waitcnt vmcnt(21) lgkmcnt(0)
s_barrier
v_mfma_f32_32x32x16_bf16 v[160:175], a[192:195], a[208:211], v[160:175]
ds_read_b64_tr_b16 a[176:177], v13 offset:0
s_mov_b32 m0, s33
v_mfma_f32_32x32x16_bf16 v[176:191], a[196:199], a[208:211], v[176:191]
ds_read_b64_tr_b16 a[178:179], v13 offset:1024
buffer_load_dwordx4 v5, s[20:23], s31 offen offset:0 lds
v_mfma_f32_32x32x16_bf16 v[192:207], a[200:203], a[208:211], v[192:207]
ds_read_b128 a[160:163], v11 offset:0
v_mfma_f32_32x32x16_bf16 v[208:223], a[204:207], a[208:211], v[208:223]
ds_read_b128 a[164:167], v11 offset:4096
v_mfma_f32_32x32x16_bf16 v[224:239], a[192:195], a[212:215], v[224:239]
ds_read_b128 a[168:171], v11 offset:8192
v_mfma_f32_32x32x16_bf16 v[240:255], a[196:199], a[212:215], v[240:255]
ds_read_b128 a[172:175], v11 offset:12288
buffer_load_dwordx4 v6, s[20:23], s31 offen offset:1024 lds
v_mfma_f32_32x32x16_bf16 a[0:15], a[200:203], a[212:215], a[0:15]
ds_read_b64_tr_b16 a[180:181], v14 offset:0
v_mfma_f32_32x32x16_bf16 a[16:31], a[204:207], a[212:215], a[16:31]
ds_read_b64_tr_b16 a[182:183], v14 offset:1024
v_mfma_f32_32x32x16_bf16 a[32:47], a[192:195], a[216:219], a[32:47]
ds_read_b64_tr_b16 a[184:185], v15 offset:0
v_mfma_f32_32x32x16_bf16 a[48:63], a[196:199], a[216:219], a[48:63]
ds_read_b64_tr_b16 a[186:187], v15 offset:1024
buffer_load_dwordx4 v7, s[20:23], s31 offen offset:2048 lds
v_mfma_f32_32x32x16_bf16 a[64:79], a[200:203], a[216:219], a[64:79]
ds_read_b64_tr_b16 a[188:189], v16 offset:0
v_mfma_f32_32x32x16_bf16 a[80:95], a[204:207], a[216:219], a[80:95]
ds_read_b64_tr_b16 a[190:191], v16 offset:1024
v_mfma_f32_32x32x16_bf16 a[96:111], a[192:195], a[220:223], a[96:111]
v_mfma_f32_32x32x16_bf16 a[112:127], a[196:199], a[220:223], a[112:127]
buffer_load_dwordx4 v8, s[20:23], s31 offen offset:3072 lds
v_mfma_f32_32x32x16_bf16 a[128:143], a[200:203], a[220:223], a[128:143]
s_add_u32 s31, s31, 262144
s_add_u32 s33, s33, 16384
s_and_b32 s33, s33, 65535
v_mfma_f32_32x32x16_bf16 a[144:159], a[204:207], a[220:223], a[144:159]
s_waitcnt lgkmcnt(0)
v_mfma_f32_32x32x16_bf16 v[160:175], a[160:163], a[176:179], v[160:175]
ds_read_b64_tr_b16 a[208:209], v13 offset:4096
s_add_u32 m0, s32, 16384
s_add_u32 s48, s30, s34
v_mfma_f32_32x32x16_bf16 v[176:191], a[164:167], a[176:179], v[176:191]
ds_read_b64_tr_b16 a[210:211], v13 offset:5120
buffer_load_dwordx4 v1, s[12:15], s48 offen lds
v_mfma_f32_32x32x16_bf16 v[192:207], a[168:171], a[176:179], v[192:207]
ds_read_b128 a[192:195], v12 offset:0
v_mfma_f32_32x32x16_bf16 v[208:223], a[172:175], a[176:179], v[208:223]
ds_read_b128 a[196:199], v12 offset:4096
v_mfma_f32_32x32x16_bf16 v[224:239], a[160:163], a[180:183], v[224:239]
ds_read_b128 a[200:203], v12 offset:8192
s_add_u32 m0, s32, 20480
v_mfma_f32_32x32x16_bf16 v[240:255], a[164:167], a[180:183], v[240:255]
ds_read_b128 a[204:207], v12 offset:12288
buffer_load_dwordx4 v2, s[12:15], s48 offen lds
v_mfma_f32_32x32x16_bf16 a[0:15], a[168:171], a[180:183], a[0:15]
ds_read_b64_tr_b16 a[212:213], v14 offset:4096
v_mfma_f32_32x32x16_bf16 a[16:31], a[172:175], a[180:183], a[16:31]
ds_read_b64_tr_b16 a[214:215], v14 offset:5120
v_mfma_f32_32x32x16_bf16 a[32:47], a[160:163], a[184:187], a[32:47]
ds_read_b64_tr_b16 a[216:217], v15 offset:4096
s_add_u32 m0, s32, 24576
v_mfma_f32_32x32x16_bf16 a[48:63], a[164:167], a[184:187], a[48:63]
ds_read_b64_tr_b16 a[218:219], v15 offset:5120
buffer_load_dwordx4 v3, s[12:15], s48 offen lds
v_mfma_f32_32x32x16_bf16 a[64:79], a[168:171], a[184:187], a[64:79]
ds_read_b64_tr_b16 a[220:221], v16 offset:4096
v_mfma_f32_32x32x16_bf16 a[80:95], a[172:175], a[184:187], a[80:95]
ds_read_b64_tr_b16 a[222:223], v16 offset:5120
v_add_u32 v9, 32768, v9
v_subrev_u32 v20, 98304, v9
v_cmp_le_u32 vcc, 163840, v9
v_add_u32 v13, 16384, v13
v_mfma_f32_32x32x16_bf16 a[96:111], a[160:163], a[188:191], a[96:111]
s_add_u32 m0, s32, 28672
v_and_b32 v13, 65535, v13
v_add_u32 v14, 16384, v14
v_and_b32 v14, 65535, v14
v_add_u32 v15, 16384, v15
v_mfma_f32_32x32x16_bf16 a[112:127], a[164:167], a[188:191], a[112:127]
buffer_load_dwordx4 v4, s[12:15], s48 offen lds
v_and_b32 v15, 65535, v15
v_add_u32 v16, 16384, v16
v_and_b32 v16, 65535, v16
v_mfma_f32_32x32x16_bf16 a[128:143], a[168:171], a[188:191], a[128:143]
s_add_u32 s30, s30, 128
s_add_u32 s32, s32, 32768
s_sub_u32 s24, s32, 98304
s_cmp_ge_u32 s32, 163840
s_cselect_b32 s32, s24, s32
v_cndmask_b32 v9, v9, v20, vcc
v_xor_b32 v10, 32, v9
v_xor_b32 v11, 64, v9
v_xor_b32 v12, 96, v9
v_mfma_f32_32x32x16_bf16 a[144:159], a[172:175], a[188:191], a[144:159]
s_waitcnt vmcnt(18) lgkmcnt(0)
s_barrier
v_mfma_f32_32x32x16_bf16 v[160:175], a[192:195], a[208:211], v[160:175]
ds_read_b64_tr_b16 a[176:177], v13 offset:0
s_mov_b32 m0, s33
v_mfma_f32_32x32x16_bf16 v[176:191], a[196:199], a[208:211], v[176:191]
ds_read_b64_tr_b16 a[178:179], v13 offset:1024
buffer_load_dwordx4 v5, s[20:23], s31 offen offset:0 lds
v_mfma_f32_32x32x16_bf16 v[192:207], a[200:203], a[208:211], v[192:207]
ds_read_b128 a[160:163], v9 offset:0
v_mfma_f32_32x32x16_bf16 v[208:223], a[204:207], a[208:211], v[208:223]
ds_read_b128 a[164:167], v9 offset:4096
v_mfma_f32_32x32x16_bf16 v[224:239], a[192:195], a[212:215], v[224:239]
ds_read_b128 a[168:171], v9 offset:8192
v_mfma_f32_32x32x16_bf16 v[240:255], a[196:199], a[212:215], v[240:255]
ds_read_b128 a[172:175], v9 offset:12288
buffer_load_dwordx4 v6, s[20:23], s31 offen offset:1024 lds
v_mfma_f32_32x32x16_bf16 a[0:15], a[200:203], a[212:215], a[0:15]
ds_read_b64_tr_b16 a[180:181], v14 offset:0
v_mfma_f32_32x32x16_bf16 a[16:31], a[204:207], a[212:215], a[16:31]
ds_read_b64_tr_b16 a[182:183], v14 offset:1024
v_mfma_f32_32x32x16_bf16 a[32:47], a[192:195], a[216:219], a[32:47]
ds_read_b64_tr_b16 a[184:185], v15 offset:0
v_mfma_f32_32x32x16_bf16 a[48:63], a[196:199], a[216:219], a[48:63]
ds_read_b64_tr_b16 a[186:187], v15 offset:1024
buffer_load_dwordx4 v7, s[20:23], s31 offen offset:2048 lds
v_mfma_f32_32x32x16_bf16 a[64:79], a[200:203], a[216:219], a[64:79]
ds_read_b64_tr_b16 a[188:189], v16 offset:0
v_mfma_f32_32x32x16_bf16 a[80:95], a[204:207], a[216:219], a[80:95]
ds_read_b64_tr_b16 a[190:191], v16 offset:1024
v_mfma_f32_32x32x16_bf16 a[96:111], a[192:195], a[220:223], a[96:111]
v_mfma_f32_32x32x16_bf16 a[112:127], a[196:199], a[220:223], a[112:127]
buffer_load_dwordx4 v8, s[20:23], s31 offen offset:3072 lds
v_mfma_f32_32x32x16_bf16 a[128:143], a[200:203], a[220:223], a[128:143]
s_add_u32 s31, s31, 262144
s_add_u32 s33, s33, 16384
s_and_b32 s33, s33, 65535
v_mfma_f32_32x32x16_bf16 a[144:159], a[204:207], a[220:223], a[144:159]
s_waitcnt lgkmcnt(0)
v_mfma_f32_32x32x16_bf16 v[160:175], a[160:163], a[176:179], v[160:175]
ds_read_b64_tr_b16 a[208:209], v13 offset:4096
s_add_u32 m0, s32, 0
s_mov_b32 s48, s30
v_mfma_f32_32x32x16_bf16 v[176:191], a[164:167], a[176:179], v[176:191]
ds_read_b64_tr_b16 a[210:211], v13 offset:5120
buffer_load_dwordx4 v1, s[12:15], s48 offen lds
v_mfma_f32_32x32x16_bf16 v[192:207], a[168:171], a[176:179], v[192:207]
ds_read_b128 a[192:195], v10 offset:0
v_mfma_f32_32x32x16_bf16 v[208:223], a[172:175], a[176:179], v[208:223]
ds_read_b128 a[196:199], v10 offset:4096
v_mfma_f32_32x32x16_bf16 v[224:239], a[160:163], a[180:183], v[224:239]
ds_read_b128 a[200:203], v10 offset:8192
s_add_u32 m0, s32, 4096
v_mfma_f32_32x32x16_bf16 v[240:255], a[164:167], a[180:183], v[240:255]
ds_read_b128 a[204:207], v10 offset:12288
buffer_load_dwordx4 v2, s[12:15], s48 offen lds
v_mfma_f32_32x32x16_bf16 a[0:15], a[168:171], a[180:183], a[0:15]
ds_read_b64_tr_b16 a[212:213], v14 offset:4096
v_mfma_f32_32x32x16_bf16 a[16:31], a[172:175], a[180:183], a[16:31]
ds_read_b64_tr_b16 a[214:215], v14 offset:5120
v_mfma_f32_32x32x16_bf16 a[32:47], a[160:163], a[184:187], a[32:47]
ds_read_b64_tr_b16 a[216:217], v15 offset:4096
s_add_u32 m0, s32, 8192
v_mfma_f32_32x32x16_bf16 a[48:63], a[164:167], a[184:187], a[48:63]
ds_read_b64_tr_b16 a[218:219], v15 offset:5120
buffer_load_dwordx4 v3, s[12:15], s48 offen lds
v_mfma_f32_32x32x16_bf16 a[64:79], a[168:171], a[184:187], a[64:79]
ds_read_b64_tr_b16 a[220:221], v16 offset:4096
v_mfma_f32_32x32x16_bf16 a[80:95], a[172:175], a[184:187], a[80:95]
ds_read_b64_tr_b16 a[222:223], v16 offset:5120
v_add_u32 v13, 16384, v13
v_and_b32 v13, 65535, v13
v_mfma_f32_32x32x16_bf16 a[96:111], a[160:163], a[188:191], a[96:111]
s_add_u32 m0, s32, 12288
v_add_u32 v14, 16384, v14
v_and_b32 v14, 65535, v14
v_mfma_f32_32x32x16_bf16 a[112:127], a[164:167], a[188:191], a[112:127]
buffer_load_dwordx4 v4, s[12:15], s48 offen lds
v_add_u32 v15, 16384, v15
v_and_b32 v15, 65535, v15
v_mfma_f32_32x32x16_bf16 a[128:143], a[168:171], a[188:191], a[128:143]
v_add_u32 v16, 16384, v16
v_and_b32 v16, 65535, v16
v_mfma_f32_32x32x16_bf16 a[144:159], a[172:175], a[188:191], a[144:159]
s_waitcnt vmcnt(16) lgkmcnt(0)
s_barrier
v_mfma_f32_32x32x16_bf16 v[160:175], a[192:195], a[208:211], v[160:175]
ds_read_b64_tr_b16 a[176:177], v13 offset:0
s_mov_b32 m0, s33
v_mfma_f32_32x32x16_bf16 v[176:191], a[196:199], a[208:211], v[176:191]
ds_read_b64_tr_b16 a[178:179], v13 offset:1024
buffer_load_dwordx4 v5, s[20:23], s31 offen offset:0 lds
v_mfma_f32_32x32x16_bf16 v[192:207], a[200:203], a[208:211], v[192:207]
ds_read_b128 a[160:163], v11 offset:0
v_mfma_f32_32x32x16_bf16 v[208:223], a[204:207], a[208:211], v[208:223]
ds_read_b128 a[164:167], v11 offset:4096
v_mfma_f32_32x32x16_bf16 v[224:239], a[192:195], a[212:215], v[224:239]
ds_read_b128 a[168:171], v11 offset:8192
v_mfma_f32_32x32x16_bf16 v[240:255], a[196:199], a[212:215], v[240:255]
ds_read_b128 a[172:175], v11 offset:12288
buffer_load_dwordx4 v6, s[20:23], s31 offen offset:1024 lds
v_mfma_f32_32x32x16_bf16 a[0:15], a[200:203], a[212:215], a[0:15]
ds_read_b64_tr_b16 a[180:181], v14 offset:0
v_mfma_f32_32x32x16_bf16 a[16:31], a[204:207], a[212:215], a[16:31]
ds_read_b64_tr_b16 a[182:183], v14 offset:1024
v_mfma_f32_32x32x16_bf16 a[32:47], a[192:195], a[216:219], a[32:47]
ds_read_b64_tr_b16 a[184:185], v15 offset:0
v_mfma_f32_32x32x16_bf16 a[48:63], a[196:199], a[216:219], a[48:63]
ds_read_b64_tr_b16 a[186:187], v15 offset:1024
buffer_load_dwordx4 v7, s[20:23], s31 offen offset:2048 lds
v_mfma_f32_32x32x16_bf16 a[64:79], a[200:203], a[216:219], a[64:79]
ds_read_b64_tr_b16 a[188:189], v16 offset:0
v_mfma_f32_32x32x16_bf16 a[80:95], a[204:207], a[216:219], a[80:95]
ds_read_b64_tr_b16 a[190:191], v16 offset:1024
v_mfma_f32_32x32x16_bf16 a[96:111], a[192:195], a[220:223], a[96:111]
v_mov_b32 v18, 0
v_mov_b32 v19, s29
s_cmp_eq_u32 s17, 0
s_cselect_b32 s25, s39, 536870912
s_mov_b64 exec, 1
buffer_store_dword v19, v18, s[8:11], s25 offen sc1
s_mov_b64 exec, -1
v_mfma_f32_32x32x16_bf16 a[112:127], a[196:199], a[220:223], a[112:127]
buffer_load_dwordx4 v8, s[20:23], s31 offen offset:3072 lds
v_mfma_f32_32x32x16_bf16 a[128:143], a[200:203], a[220:223], a[128:143]
s_add_u32 s31, s31, 262144
s_add_u32 s33, s33, 16384
s_and_b32 s33, s33, 65535
v_mfma_f32_32x32x16_bf16 a[144:159], a[204:207], a[220:223], a[144:159]
s_waitcnt lgkmcnt(0)
v_mfma_f32_32x32x16_bf16 v[160:175], a[160:163], a[176:179], v[160:175]
ds_read_b64_tr_b16 a[208:209], v13 offset:4096
s_add_u32 m0, s32, 16384
s_add_u32 s48, s30, s34
v_mfma_f32_32x32x16_bf16 v[176:191], a[164:167], a[176:179], v[176:191]
ds_read_b64_tr_b16 a[210:211], v13 offset:5120
buffer_load_dwordx4 v1, s[12:15], s48 offen lds
v_mfma_f32_32x32x16_bf16 v[192:207], a[168:171], a[176:179], v[192:207]
ds_read_b128 a[192:195], v12 offset:0
v_mfma_f32_32x32x16_bf16 v[208:223], a[172:175], a[176:179], v[208:223]
ds_read_b128 a[196:199], v12 offset:4096
v_mfma_f32_32x32x16_bf16 v[224:239], a[160:163], a[180:183], v[224:239]
ds_read_b128 a[200:203], v12 offset:8192
s_add_u32 m0, s32, 20480
v_mfma_f32_32x32x16_bf16 v[240:255], a[164:167], a[180:183], v[240:255]
ds_read_b128 a[204:207], v12 offset:12288
buffer_load_dwordx4 v2, s[12:15], s48 offen lds
v_mfma_f32_32x32x16_bf16 a[0:15], a[168:171], a[180:183], a[0:15]
ds_read_b64_tr_b16 a[212:213], v14 offset:4096
v_mfma_f32_32x32x16_bf16 a[16:31], a[172:175], a[180:183], a[16:31]
ds_read_b64_tr_b16 a[214:215], v14 offset:5120
v_mfma_f32_32x32x16_bf16 a[32:47], a[160:163], a[184:187], a[32:47]
ds_read_b64_tr_b16 a[216:217], v15 offset:4096
s_add_u32 m0, s32, 24576
v_mfma_f32_32x32x16_bf16 a[48:63], a[164:167], a[184:187], a[48:63]
ds_read_b64_tr_b16 a[218:219], v15 offset:5120
buffer_load_dwordx4 v3, s[12:15], s48 offen lds
v_mfma_f32_32x32x16_bf16 a[64:79], a[168:171], a[184:187], a[64:79]
ds_read_b64_tr_b16 a[220:221], v16 offset:4096
v_mfma_f32_32x32x16_bf16 a[80:95], a[172:175], a[184:187], a[80:95]
ds_read_b64_tr_b16 a[222:223], v16 offset:5120
v_add_u32 v9, 32768, v9
v_subrev_u32 v20, 98304, v9
v_cmp_le_u32 vcc, 163840, v9
v_add_u32 v13, 16384, v13
v_mfma_f32_32x32x16_bf16 a[96:111], a[160:163], a[188:191], a[96:111]
s_add_u32 m0, s32, 28672
v_and_b32 v13, 65535, v13
v_add_u32 v14, 16384, v14
v_and_b32 v14, 65535, v14
v_add_u32 v15, 16384, v15
v_mfma_f32_32x32x16_bf16 a[112:127], a[164:167], a[188:191], a[112:127]
buffer_load_dwordx4 v4, s[12:15], s48 offen lds
v_and_b32 v15, 65535, v15
v_add_u32 v16, 16384, v16
v_and_b32 v16, 65535, v16
v_mfma_f32_32x32x16_bf16 a[128:143], a[168:171], a[188:191], a[128:143]
s_add_u32 s30, s30, 128
s_add_u32 s32, s32, 32768
s_sub_u32 s24, s32, 98304
s_cmp_ge_u32 s32, 163840
s_cselect_b32 s32, s24, s32
v_cndmask_b32 v9, v9, v20, vcc
v_xor_b32 v10, 32, v9
v_xor_b32 v11, 64, v9
v_xor_b32 v12, 96, v9
v_mfma_f32_32x32x16_bf16 a[144:159], a[172:175], a[188:191], a[144:159]
s_waitcnt vmcnt(17) lgkmcnt(0)
s_barrier
v_mfma_f32_32x32x16_bf16 v[160:175], a[192:195], a[208:211], v[160:175]
ds_read_b64_tr_b16 a[176:177], v13 offset:0
s_mov_b32 m0, s33
v_mfma_f32_32x32x16_bf16 v[176:191], a[196:199], a[208:211], v[176:191]
ds_read_b64_tr_b16 a[178:179], v13 offset:1024
buffer_load_dwordx4 v5, s[20:23], s31 offen offset:0 lds
v_mfma_f32_32x32x16_bf16 v[192:207], a[200:203], a[208:211], v[192:207]
ds_read_b128 a[160:163], v9 offset:0
s_nop 4
v_cvt_pk_bf16_f32 v32, v160, v161
v_cvt_pk_bf16_f32 v33, v162, v163
v_cvt_pk_bf16_f32 v34, v164, v165
v_cvt_pk_bf16_f32 v35, v166, v167
v_cvt_pk_bf16_f32 v36, v168, v169
v_cvt_pk_bf16_f32 v37, v170, v171
v_cvt_pk_bf16_f32 v38, v172, v173
v_cvt_pk_bf16_f32 v39, v174, v175
v_mfma_f32_32x32x16_bf16 v[208:223], a[204:207], a[208:211], v[208:223]
ds_read_b128 a[164:167], v9 offset:4096
v_cvt_pk_bf16_f32 v40, v176, v177
v_cvt_pk_bf16_f32 v41, v178, v179
v_cvt_pk_bf16_f32 v42, v180, v181
v_cvt_pk_bf16_f32 v43, v182, v183
v_cvt_pk_bf16_f32 v44, v184, v185
v_cvt_pk_bf16_f32 v45, v186, v187
v_cvt_pk_bf16_f32 v46, v188, v189
v_cvt_pk_bf16_f32 v47, v190, v191
v_mfma_f32_32x32x16_bf16 v[224:239], a[192:195], a[212:215], v[224:239]
ds_read_b128 a[168:171], v9 offset:8192
v_cvt_pk_bf16_f32 v48, v192, v193
v_cvt_pk_bf16_f32 v49, v194, v195
v_cvt_pk_bf16_f32 v50, v196, v197
v_cvt_pk_bf16_f32 v51, v198, v199
v_cvt_pk_bf16_f32 v52, v200, v201
v_cvt_pk_bf16_f32 v53, v202, v203
v_cvt_pk_bf16_f32 v54, v204, v205
v_cvt_pk_bf16_f32 v55, v206, v207
v_mfma_f32_32x32x16_bf16 v[240:255], a[196:199], a[212:215], v[240:255]
ds_read_b128 a[172:175], v9 offset:12288
buffer_load_dwordx4 v6, s[20:23], s31 offen offset:1024 lds
v_cvt_pk_bf16_f32 v56, v208, v209
v_cvt_pk_bf16_f32 v57, v210, v211
v_cvt_pk_bf16_f32 v58, v212, v213
v_cvt_pk_bf16_f32 v59, v214, v215
v_cvt_pk_bf16_f32 v60, v216, v217
v_cvt_pk_bf16_f32 v61, v218, v219
v_cvt_pk_bf16_f32 v62, v220, v221
v_cvt_pk_bf16_f32 v63, v222, v223
v_mfma_f32_32x32x16_bf16 a[0:15], a[200:203], a[212:215], a[0:15]
ds_read_b64_tr_b16 a[180:181], v14 offset:0
v_cvt_pk_bf16_f32 v64, v224, v225
v_cvt_pk_bf16_f32 v65, v226, v227
v_cvt_pk_bf16_f32 v66, v228, v229
v_cvt_pk_bf16_f32 v67, v230, v231
v_cvt_pk_bf16_f32 v68, v232, v233
v_cvt_pk_bf16_f32 v69, v234, v235
v_cvt_pk_bf16_f32 v70, v236, v237
v_cvt_pk_bf16_f32 v71, v238, v239
v_mfma_f32_32x32x16_bf16 a[16:31], a[204:207], a[212:215], a[16:31]
ds_read_b64_tr_b16 a[182:183], v14 offset:1024
v_cvt_pk_bf16_f32 v72, v240, v241
v_cvt_pk_bf16_f32 v73, v242, v243
v_cvt_pk_bf16_f32 v74, v244, v245
v_cvt_pk_bf16_f32 v75, v246, v247
v_cvt_pk_bf16_f32 v76, v248, v249
v_cvt_pk_bf16_f32 v77, v250, v251
v_cvt_pk_bf16_f32 v78, v252, v253
v_cvt_pk_bf16_f32 v79, v254, v255
v_mfma_f32_32x32x16_bf16 a[32:47], a[192:195], a[216:219], a[32:47]
ds_read_b64_tr_b16 a[184:185], v15 offset:0
v_accvgpr_read_b32 v24, a0
v_accvgpr_read_b32 v25, a1
v_cvt_pk_bf16_f32 v80, v24, v25
v_accvgpr_read_b32 v26, a2
v_accvgpr_read_b32 v27, a3
v_cvt_pk_bf16_f32 v81, v26, v27
v_accvgpr_read_b32 v28, a4
v_accvgpr_read_b32 v29, a5
v_cvt_pk_bf16_f32 v82, v28, v29
v_accvgpr_read_b32 v30, a6
v_accvgpr_read_b32 v31, a7
v_cvt_pk_bf16_f32 v83, v30, v31
v_mfma_f32_32x32x16_bf16 a[48:63], a[196:199], a[216:219], a[48:63]
ds_read_b64_tr_b16 a[186:187], v15 offset:1024
buffer_load_dwordx4 v7, s[20:23], s31 offen offset:2048 lds
v_accvgpr_read_b32 v24, a8
v_accvgpr_read_b32 v25, a9
v_cvt_pk_bf16_f32 v84, v24, v25
v_accvgpr_read_b32 v26, a10
v_accvgpr_read_b32 v27, a11
v_cvt_pk_bf16_f32 v85, v26, v27
v_accvgpr_read_b32 v28, a12
v_accvgpr_read_b32 v29, a13
v_cvt_pk_bf16_f32 v86, v28, v29
v_accvgpr_read_b32 v30, a14
v_accvgpr_read_b32 v31, a15
v_cvt_pk_bf16_f32 v87, v30, v31
v_mfma_f32_32x32x16_bf16 a[64:79], a[200:203], a[216:219], a[64:79]
ds_read_b64_tr_b16 a[188:189], v16 offset:0
v_accvgpr_read_b32 v24, a16
v_accvgpr_read_b32 v25, a17
v_cvt_pk_bf16_f32 v88, v24, v25
v_accvgpr_read_b32 v26, a18
v_accvgpr_read_b32 v27, a19
v_cvt_pk_bf16_f32 v89, v26, v27
v_accvgpr_read_b32 v28, a20
v_accvgpr_read_b32 v29, a21
v_cvt_pk_bf16_f32 v90, v28, v29
v_accvgpr_read_b32 v30, a22
v_accvgpr_read_b32 v31, a23
v_cvt_pk_bf16_f32 v91, v30, v31
v_mfma_f32_32x32x16_bf16 a[80:95], a[204:207], a[216:219], a[80:95]
ds_read_b64_tr_b16 a[190:191], v16 offset:1024
v_accvgpr_read_b32 v24, a24
v_accvgpr_read_b32 v25, a25
v_cvt_pk_bf16_f32 v92, v24, v25
v_accvgpr_read_b32 v26, a26
v_accvgpr_read_b32 v27, a27
v_cvt_pk_bf16_f32 v93, v26, v27
v_accvgpr_read_b32 v28, a28
v_accvgpr_read_b32 v29, a29
v_cvt_pk_bf16_f32 v94, v28, v29
v_accvgpr_read_b32 v30, a30
v_accvgpr_read_b32 v31, a31
v_cvt_pk_bf16_f32 v95, v30, v31
v_mfma_f32_32x32x16_bf16 a[96:111], a[192:195], a[220:223], a[96:111]
v_accvgpr_read_b32 v24, a32
v_accvgpr_read_b32 v25, a33
v_cvt_pk_bf16_f32 v96, v24, v25
v_accvgpr_read_b32 v26, a34
v_accvgpr_read_b32 v27, a35
v_cvt_pk_bf16_f32 v97, v26, v27
v_accvgpr_read_b32 v28, a36
v_accvgpr_read_b32 v29, a37
v_cvt_pk_bf16_f32 v98, v28, v29
v_accvgpr_read_b32 v30, a38
v_accvgpr_read_b32 v31, a39
v_cvt_pk_bf16_f32 v99, v30, v31
v_mfma_f32_32x32x16_bf16 a[112:127], a[196:199], a[220:223], a[112:127]
buffer_load_dwordx4 v8, s[20:23], s31 offen offset:3072 lds
v_accvgpr_read_b32 v24, a40
v_accvgpr_read_b32 v25, a41
v_cvt_pk_bf16_f32 v100, v24, v25
v_accvgpr_read_b32 v26, a42
v_accvgpr_read_b32 v27, a43
v_cvt_pk_bf16_f32 v101, v26, v27
v_accvgpr_read_b32 v28, a44
v_accvgpr_read_b32 v29, a45
v_cvt_pk_bf16_f32 v102, v28, v29
v_accvgpr_read_b32 v30, a46
v_accvgpr_read_b32 v31, a47
v_cvt_pk_bf16_f32 v103, v30, v31
v_mfma_f32_32x32x16_bf16 a[128:143], a[200:203], a[220:223], a[128:143]
s_add_u32 s31, s31, 262144
s_add_u32 s33, s33, 16384
s_and_b32 s33, s33, 65535
v_accvgpr_read_b32 v24, a48
v_accvgpr_read_b32 v25, a49
v_cvt_pk_bf16_f32 v104, v24, v25
v_accvgpr_read_b32 v26, a50
v_accvgpr_read_b32 v27, a51
v_cvt_pk_bf16_f32 v105, v26, v27
v_accvgpr_read_b32 v28, a52
v_accvgpr_read_b32 v29, a53
v_cvt_pk_bf16_f32 v106, v28, v29
v_accvgpr_read_b32 v30, a54
v_accvgpr_read_b32 v31, a55
v_cvt_pk_bf16_f32 v107, v30, v31
v_mfma_f32_32x32x16_bf16 a[144:159], a[204:207], a[220:223], a[144:159]
v_accvgpr_read_b32 v24, a56
v_accvgpr_read_b32 v25, a57
v_cvt_pk_bf16_f32 v108, v24, v25
v_accvgpr_read_b32 v26, a58
v_accvgpr_read_b32 v27, a59
v_cvt_pk_bf16_f32 v109, v26, v27
v_accvgpr_read_b32 v28, a60
v_accvgpr_read_b32 v29, a61
v_cvt_pk_bf16_f32 v110, v28, v29
v_accvgpr_read_b32 v30, a62
v_accvgpr_read_b32 v31, a63
v_cvt_pk_bf16_f32 v111, v30, v31
v_accvgpr_read_b32 v24, a64
v_accvgpr_read_b32 v25, a65
v_cvt_pk_bf16_f32 v112, v24, v25
v_accvgpr_read_b32 v26, a66
v_accvgpr_read_b32 v27, a67
v_cvt_pk_bf16_f32 v113, v26, v27
v_accvgpr_read_b32 v28, a68
v_accvgpr_read_b32 v29, a69
v_cvt_pk_bf16_f32 v114, v28, v29
v_accvgpr_read_b32 v30, a70
v_accvgpr_read_b32 v31, a71
v_cvt_pk_bf16_f32 v115, v30, v31
s_cmp_lt_u32 s35, s45
s_cbranch_scc1 L_g_tile
s_branch L_g_end
L_g_first:
s_mov_b32 s100, 536870912
v_mov_b32 v20, 128
s_mov_b32 s28, 0
L_poll_21:
buffer_load_dword v21, v20, s[56:59], 0 offen sc1
s_add_u32 s28, s28, 1
s_cmp_gt_u32 s28, 40000
s_cbranch_scc1 L_end
s_waitcnt vmcnt(0)
v_cmp_ne_u32 vcc, 8, v21
s_cbranch_vccz L_pd_22
s_sleep 1
s_branch L_poll_21
L_pd_22:
s_cmp_eq_u32 s61, 0
s_cbranch_scc1 L_g_go
v_accvgpr_read_b32 v24, a72
v_accvgpr_read_b32 v25, a73
v_cvt_pk_bf16_f32 v116, v24, v25
v_accvgpr_read_b32 v26, a74
v_accvgpr_read_b32 v27, a75
v_cvt_pk_bf16_f32 v117, v26, v27
v_accvgpr_read_b32 v28, a76
v_accvgpr_read_b32 v29, a77
v_cvt_pk_bf16_f32 v118, v28, v29
v_accvgpr_read_b32 v30, a78
v_accvgpr_read_b32 v31, a79
v_cvt_pk_bf16_f32 v119, v30, v31
v_accvgpr_read_b32 v24, a80
v_accvgpr_read_b32 v25, a81
v_cvt_pk_bf16_f32 v120, v24, v25
v_accvgpr_read_b32 v26, a82
v_accvgpr_read_b32 v27, a83
v_cvt_pk_bf16_f32 v121, v26, v27
v_accvgpr_read_b32 v28, a84
v_accvgpr_read_b32 v29, a85
v_cvt_pk_bf16_f32 v122, v28, v29
v_accvgpr_read_b32 v30, a86
v_accvgpr_read_b32 v31, a87
v_cvt_pk_bf16_f32 v123, v30, v31
v_accvgpr_read_b32 v24, a88
v_accvgpr_read_b32 v25, a89
v_cvt_pk_bf16_f32 v124, v24, v25
v_accvgpr_read_b32 v26, a90
v_accvgpr_read_b32 v27, a91
v_cvt_pk_bf16_f32 v125, v26, v27
v_accvgpr_read_b32 v28, a92
v_accvgpr_read_b32 v29, a93
v_cvt_pk_bf16_f32 v126, v28, v29
v_accvgpr_read_b32 v30, a94
v_accvgpr_read_b32 v31, a95
v_cvt_pk_bf16_f32 v127, v30, v31
v_accvgpr_read_b32 v24, a96
v_accvgpr_read_b32 v25, a97
v_cvt_pk_bf16_f32 v128, v24, v25
v_accvgpr_read_b32 v26, a98
v_accvgpr_read_b32 v27, a99
v_cvt_pk_bf16_f32 v129, v26, v27
v_accvgpr_read_b32 v28, a100
v_accvgpr_read_b32 v29, a101
v_cvt_pk_bf16_f32 v130, v28, v29
v_accvgpr_read_b32 v30, a102
v_accvgpr_read_b32 v31, a103
v_cvt_pk_bf16_f32 v131, v30, v31
v_accvgpr_read_b32 v24, a104
v_accvgpr_read_b32 v25, a105
v_cvt_pk_bf16_f32 v132, v24, v25
v_accvgpr_read_b32 v26, a106
v_accvgpr_read_b32 v27, a107
v_cvt_pk_bf16_f32 v133, v26, v27
v_accvgpr_read_b32 v28, a108
v_accvgpr_read_b32 v29, a109
v_cvt_pk_bf16_f32 v134, v28, v29
v_accvgpr_read_b32 v30, a110
v_accvgpr_read_b32 v31, a111
v_cvt_pk_bf16_f32 v135, v30, v31
v_accvgpr_read_b32 v24, a112
v_accvgpr_read_b32 v25, a113
v_cvt_pk_bf16_f32 v136, v24, v25
v_accvgpr_read_b32 v26, a114
v_accvgpr_read_b32 v27, a115
v_cvt_pk_bf16_f32 v137, v26, v27
v_accvgpr_read_b32 v28, a116
v_accvgpr_read_b32 v29, a117
v_cvt_pk_bf16_f32 v138, v28, v29
v_accvgpr_read_b32 v30, a118
v_accvgpr_read_b32 v31, a119
v_cvt_pk_bf16_f32 v139, v30, v31
v_accvgpr_read_b32 v24, a120
v_accvgpr_read_b32 v25, a121
v_cvt_pk_bf16_f32 v140, v24, v25
v_accvgpr_read_b32 v26, a122
v_accvgpr_read_b32 v27, a123
v_cvt_pk_bf16_f32 v141, v26, v27
v_accvgpr_read_b32 v28, a124
v_accvgpr_read_b32 v29, a125
v_cvt_pk_bf16_f32 v142, v28, v29
v_accvgpr_read_b32 v30, a126
v_accvgpr_read_b32 v31, a127
v_cvt_pk_bf16_f32 v143, v30, v31
v_accvgpr_read_b32 v24, a128
v_accvgpr_read_b32 v25, a129
v_cvt_pk_bf16_f32 v144, v24, v25
v_accvgpr_read_b32 v26, a130
v_accvgpr_read_b32 v27, a131
v_cvt_pk_bf16_f32 v145, v26, v27
v_accvgpr_read_b32 v28, a132
v_accvgpr_read_b32 v29, a133
v_cvt_pk_bf16_f32 v146, v28, v29
v_accvgpr_read_b32 v30, a134
v_accvgpr_read_b32 v31, a135
v_cvt_pk_bf16_f32 v147, v30, v31
v_accvgpr_read_b32 v24, a136
v_accvgpr_read_b32 v25, a137
v_cvt_pk_bf16_f32 v148, v24, v25
v_accvgpr_read_b32 v26, a138
v_accvgpr_read_b32 v27, a139
v_cvt_pk_bf16_f32 v149, v26, v27
v_accvgpr_read_b32 v28, a140
v_accvgpr_read_b32 v29, a141
v_cvt_pk_bf16_f32 v150, v28, v29
v_accvgpr_read_b32 v30, a142
v_accvgpr_read_b32 v31, a143
v_cvt_pk_bf16_f32 v151, v30, v31
v_accvgpr_read_b32 v24, a144
v_accvgpr_read_b32 v25, a145
v_cvt_pk_bf16_f32 v152, v24, v25
v_accvgpr_read_b32 v26, a146
v_accvgpr_read_b32 v27, a147
v_cvt_pk_bf16_f32 v153, v26, v27
v_accvgpr_read_b32 v28, a148
v_accvgpr_read_b32 v29, a149
v_cvt_pk_bf16_f32 v154, v28, v29
v_accvgpr_read_b32 v30, a150
v_accvgpr_read_b32 v31, a151
v_cvt_pk_bf16_f32 v155, v30, v31
v_accvgpr_read_b32 v24, a152
v_accvgpr_read_b32 v25, a153
v_cvt_pk_bf16_f32 v156, v24, v25
v_accvgpr_read_b32 v26, a154
v_accvgpr_read_b32 v27, a155
v_cvt_pk_bf16_f32 v157, v26, v27
v_accvgpr_read_b32 v28, a156
v_accvgpr_read_b32 v29, a157
v_cvt_pk_bf16_f32 v158, v28, v29
v_accvgpr_read_b32 v30, a158
v_accvgpr_read_b32 v31, a159
v_cvt_pk_bf16_f32 v159, v30, v31
v_and_b32 v18, 63, v0
v_bfe_u32 v19, v0, 1, 4
v_and_b32 v20, 1, v0
v_lshl_add_u32 v19, v20, 4, v19
v_and_or_b32 v19, v0, 32, v19
v_cmp_eq_u32 vcc, 0, s49
s_nop 1
v_cndmask_b32 v18, v19, v18, vcc
v_lshlrev_b32 v17, 4, v18
s_add_u32 s25, s38, 0
buffer_store_dwordx4 v[32:35], v17, s[8:11], s25 offen offset:0 sc1
s_add_u32 s25, s38, 0
buffer_store_dwordx4 v[36:39], v17, s[8:11], s25 offen offset:1024 sc1
s_add_u32 s25, s38, 16384
buffer_store_dwordx4 v[40:43], v17, s[8:11], s25 offen offset:0 sc1
s_add_u32 s25, s38, 16384
buffer_store_dwordx4 v[44:47], v17, s[8:11], s25 offen offset:1024 sc1
s_add_u32 s25, s38, 32768
buffer_store_dwordx4 v[48:51], v17, s[8:11], s25 offen offset:0 sc1
s_add_u32 s25, s38, 32768
buffer_store_dwordx4 v[52:55], v17, s[8:11], s25 offen offset:1024 sc1
s_add_u32 s25, s38, 49152
buffer_store_dwordx4 v[56:59], v17, s[8:11], s25 offen offset:0 sc1
s_add_u32 s25, s38, 49152
buffer_store_dwordx4 v[60:63], v17, s[8:11], s25 offen offset:1024 sc1
s_add_u32 s25, s38, 2048
buffer_store_dwordx4 v[64:67], v17, s[8:11], s25 offen offset:0 sc1
s_add_u32 s25, s38, 2048
buffer_store_dwordx4 v[68:71], v17, s[8:11], s25 offen offset:1024 sc1
s_add_u32 s25, s38, 18432
buffer_store_dwordx4 v[72:75], v17, s[8:11], s25 offen offset:0 sc1
s_add_u32 s25, s38, 18432
buffer_store_dwordx4 v[76:79], v17, s[8:11], s25 offen offset:1024 sc1
s_add_u32 s25, s38, 34816
buffer_store_dwordx4 v[80:83], v17, s[8:11], s25 offen offset:0 sc1
s_add_u32 s25, s38, 34816
buffer_store_dwordx4 v[84:87], v17, s[8:11], s25 offen offset:1024 sc1
s_add_u32 s25, s38, 51200
buffer_store_dwordx4 v[88:91], v17, s[8:11], s25 offen offset:0 sc1
s_add_u32 s25, s38, 51200
buffer_store_dwordx4 v[92:95], v17, s[8:11], s25 offen offset:1024 sc1
s_add_u32 s25, s38, 4096
buffer_store_dwordx4 v[96:99], v17, s[8:11], s25 offen offset:0 sc1
s_add_u32 s25, s38, 4096
buffer_store_dwordx4 v[100:103], v17, s[8:11], s25 offen offset:1024 sc1
s_add_u32 s25, s38, 20480
buffer_store_dwordx4 v[104:107], v17, s[8:11], s25 offen offset:0 sc1
s_add_u32 s25, s38, 20480
buffer_store_dwordx4 v[108:111], v17, s[8:11], s25 offen offset:1024 sc1
s_add_u32 s25, s38, 36864
buffer_store_dwordx4 v[112:115], v17, s[8:11], s25 offen offset:0 sc1
s_add_u32 s25, s38, 36864
buffer_store_dwordx4 v[116:119], v17, s[8:11], s25 offen offset:1024 sc1
s_add_u32 s25, s38, 53248
buffer_store_dwordx4 v[120:123], v17, s[8:11], s25 offen offset:0 sc1
s_add_u32 s25, s38, 53248
buffer_store_dwordx4 v[124:127], v17, s[8:11], s25 offen offset:1024 sc1
s_add_u32 s25, s38, 6144
buffer_store_dwordx4 v[128:131], v17, s[8:11], s25 offen offset:0 sc1
s_add_u32 s25, s38, 6144
buffer_store_dwordx4 v[132:135], v17, s[8:11], s25 offen offset:1024 sc1
s_add_u32 s25, s38, 22528
buffer_store_dwordx4 v[136:139], v17, s[8:11], s25 offen offset:0 sc1
s_add_u32 s25, s38, 22528
buffer_store_dwordx4 v[140:143], v17, s[8:11], s25 offen offset:1024 sc1
s_add_u32 s25, s38, 38912
buffer_store_dwordx4 v[144:147], v17, s[8:11], s25 offen offset:0 sc1
s_add_u32 s25, s38, 38912
buffer_store_dwordx4 v[148:151], v17, s[8:11], s25 offen offset:1024 sc1
s_add_u32 s25, s38, 55296
buffer_store_dwordx4 v[152:155], v17, s[8:11], s25 offen offset:0 sc1
s_add_u32 s25, s38, 55296
buffer_store_dwordx4 v[156:159], v17, s[8:11], s25 offen offset:1024 sc1
s_waitcnt vmcnt(0)
s_barrier
v_mov_b32 v18, 0
v_mov_b32 v19, s29
s_cmp_eq_u32 s17, 0
s_cselect_b32 s25, s39, 536870912
s_mov_b64 exec, 1
buffer_store_dword v19, v18, s[8:11], s25 offen sc1
s_mov_b64 exec, -1
s_mov_b32 s38, 536870912
s_mov_b32 s39, 536870912
s_branch L_g_go
L_g_end:
v_pk_mul_f32 v[24:25], v[160:161], s[94:95] op_sel_hi:[1,0]
v_cvt_pk_bf16_f32 v32, v24, v25
v_pk_mul_f32 v[26:27], v[162:163], s[94:95] op_sel_hi:[1,0]
v_cvt_pk_bf16_f32 v33, v26, v27
v_pk_mul_f32 v[28:29], v[164:165], s[94:95] op_sel_hi:[1,0]
v_cvt_pk_bf16_f32 v34, v28, v29
v_pk_mul_f32 v[30:31], v[166:167], s[94:95] op_sel_hi:[1,0]
v_cvt_pk_bf16_f32 v35, v30, v31
v_pk_mul_f32 v[24:25], v[168:169], s[94:95] op_sel_hi:[1,0]
v_cvt_pk_bf16_f32 v36, v24, v25
v_pk_mul_f32 v[26:27], v[170:171], s[94:95] op_sel_hi:[1,0]
v_cvt_pk_bf16_f32 v37, v26, v27
v_pk_mul_f32 v[28:29], v[172:173], s[94:95] op_sel_hi:[1,0]
v_cvt_pk_bf16_f32 v38, v28, v29
v_pk_mul_f32 v[30:31], v[174:175], s[94:95] op_sel_hi:[1,0]
v_cvt_pk_bf16_f32 v39, v30, v31
v_and_b32 v18, 63, v0
v_bfe_u32 v19, v0, 1, 4
v_and_b32 v20, 1, v0
v_lshl_add_u32 v19, v20, 4, v19
v_and_or_b32 v19, v0, 32, v19
v_cmp_eq_u32 vcc, 0, s50
s_nop 1
v_cndmask_b32 v18, v19, v18, vcc
v_lshlrev_b32 v17, 4, v18
s_add_u32 s25, s62, 0
buffer_store_dwordx4 v[32:35], v17, s[8:11], s25 offen offset:0 sc1
s_add_u32 s25, s62, 0
buffer_store_dwordx4 v[36:39], v17, s[8:11], s25 offen offset:1024 sc1
v_pk_mul_f32 v[24:25], v[176:177], s[94:95] op_sel_hi:[1,0]
v_cvt_pk_bf16_f32 v40, v24, v25
v_pk_mul_f32 v[26:27], v[178:179], s[94:95] op_sel_hi:[1,0]
v_cvt_pk_bf16_f32 v41, v26, v27
v_pk_mul_f32 v[28:29], v[180:181], s[94:95] op_sel_hi:[1,0]
v_cvt_pk_bf16_f32 v42, v28, v29
v_pk_mul_f32 v[30:31], v[182:183], s[94:95] op_sel_hi:[1,0]
v_cvt_pk_bf16_f32 v43, v30, v31
v_pk_mul_f32 v[24:25], v[184:185], s[94:95] op_sel_hi:[1,0]
v_cvt_pk_bf16_f32 v44, v24, v25
v_pk_mul_f32 v[26:27], v[186:187], s[94:95] op_sel_hi:[1,0]
v_cvt_pk_bf16_f32 v45, v26, v27
v_pk_mul_f32 v[28:29], v[188:189], s[94:95] op_sel_hi:[1,0]
v_cvt_pk_bf16_f32 v46, v28, v29
v_pk_mul_f32 v[30:31], v[190:191], s[94:95] op_sel_hi:[1,0]
v_cvt_pk_bf16_f32 v47, v30, v31
s_add_u32 s25, s62, 16384
buffer_store_dwordx4 v[40:43], v17, s[8:11], s25 offen offset:0 sc1
s_add_u32 s25, s62, 16384
buffer_store_dwordx4 v[44:47], v17, s[8:11], s25 offen offset:1024 sc1
v_pk_mul_f32 v[24:25], v[192:193], s[94:95] op_sel_hi:[1,0]
v_cvt_pk_bf16_f32 v48, v24, v25
v_pk_mul_f32 v[26:27], v[194:195], s[94:95] op_sel_hi:[1,0]
v_cvt_pk_bf16_f32 v49, v26, v27
v_pk_mul_f32 v[28:29], v[196:197], s[94:95] op_sel_hi:[1,0]
v_cvt_pk_bf16_f32 v50, v28, v29
v_pk_mul_f32 v[30:31], v[198:199], s[94:95] op_sel_hi:[1,0]
v_cvt_pk_bf16_f32 v51, v30, v31
v_pk_mul_f32 v[24:25], v[200:201], s[94:95] op_sel_hi:[1,0]
v_cvt_pk_bf16_f32 v52, v24, v25
v_pk_mul_f32 v[26:27], v[202:203], s[94:95] op_sel_hi:[1,0]
v_cvt_pk_bf16_f32 v53, v26, v27
v_pk_mul_f32 v[28:29], v[204:205], s[94:95] op_sel_hi:[1,0]
v_cvt_pk_bf16_f32 v54, v28, v29
v_pk_mul_f32 v[30:31], v[206:207], s[94:95] op_sel_hi:[1,0]
v_cvt_pk_bf16_f32 v55, v30, v31
s_add_u32 s25, s62, 32768
buffer_store_dwordx4 v[48:51], v17, s[8:11], s25 offen offset:0 sc1
s_add_u32 s25, s62, 32768
buffer_store_dwordx4 v[52:55], v17, s[8:11], s25 offen offset:1024 sc1
v_pk_mul_f32 v[24:25], v[208:209], s[94:95] op_sel_hi:[1,0]
v_cvt_pk_bf16_f32 v56, v24, v25
v_pk_mul_f32 v[26:27], v[210:211], s[94:95] op_sel_hi:[1,0]
v_cvt_pk_bf16_f32 v57, v26, v27
v_pk_mul_f32 v[28:29], v[212:213], s[94:95] op_sel_hi:[1,0]
v_cvt_pk_bf16_f32 v58, v28, v29
v_pk_mul_f32 v[30:31], v[214:215], s[94:95] op_sel_hi:[1,0]
v_cvt_pk_bf16_f32 v59, v30, v31
v_pk_mul_f32 v[24:25], v[216:217], s[94:95] op_sel_hi:[1,0]
v_cvt_pk_bf16_f32 v60, v24, v25
v_pk_mul_f32 v[26:27], v[218:219], s[94:95] op_sel_hi:[1,0]
v_cvt_pk_bf16_f32 v61, v26, v27
v_pk_mul_f32 v[28:29], v[220:221], s[94:95] op_sel_hi:[1,0]
v_cvt_pk_bf16_f32 v62, v28, v29
v_pk_mul_f32 v[30:31], v[222:223], s[94:95] op_sel_hi:[1,0]
v_cvt_pk_bf16_f32 v63, v30, v31
s_add_u32 s25, s62, 49152
buffer_store_dwordx4 v[56:59], v17, s[8:11], s25 offen offset:0 sc1
s_add_u32 s25, s62, 49152
buffer_store_dwordx4 v[60:63], v17, s[8:11], s25 offen offset:1024 sc1
v_pk_mul_f32 v[24:25], v[224:225], s[94:95] op_sel_hi:[1,0]
v_cvt_pk_bf16_f32 v64, v24, v25
v_pk_mul_f32 v[26:27], v[226:227], s[94:95] op_sel_hi:[1,0]
v_cvt_pk_bf16_f32 v65, v26, v27
v_pk_mul_f32 v[28:29], v[228:229], s[94:95] op_sel_hi:[1,0]
v_cvt_pk_bf16_f32 v66, v28, v29
v_pk_mul_f32 v[30:31], v[230:231], s[94:95] op_sel_hi:[1,0]
v_cvt_pk_bf16_f32 v67, v30, v31
v_pk_mul_f32 v[24:25], v[232:233], s[94:95] op_sel_hi:[1,0]
v_cvt_pk_bf16_f32 v68, v24, v25
v_pk_mul_f32 v[26:27], v[234:235], s[94:95] op_sel_hi:[1,0]
v_cvt_pk_bf16_f32 v69, v26, v27
v_pk_mul_f32 v[28:29], v[236:237], s[94:95] op_sel_hi:[1,0]
v_cvt_pk_bf16_f32 v70, v28, v29
v_pk_mul_f32 v[30:31], v[238:239], s[94:95] op_sel_hi:[1,0]
v_cvt_pk_bf16_f32 v71, v30, v31
s_add_u32 s25, s62, 2048
buffer_store_dwordx4 v[64:67], v17, s[8:11], s25 offen offset:0 sc1
s_add_u32 s25, s62, 2048
buffer_store_dwordx4 v[68:71], v17, s[8:11], s25 offen offset:1024 sc1
v_pk_mul_f32 v[24:25], v[240:241], s[94:95] op_sel_hi:[1,0]
v_cvt_pk_bf16_f32 v72, v24, v25
v_pk_mul_f32 v[26:27], v[242:243], s[94:95] op_sel_hi:[1,0]
v_cvt_pk_bf16_f32 v73, v26, v27
v_pk_mul_f32 v[28:29], v[244:245], s[94:95] op_sel_hi:[1,0]
v_cvt_pk_bf16_f32 v74, v28, v29
v_pk_mul_f32 v[30:31], v[246:247], s[94:95] op_sel_hi:[1,0]
v_cvt_pk_bf16_f32 v75, v30, v31
v_pk_mul_f32 v[24:25], v[248:249], s[94:95] op_sel_hi:[1,0]
v_cvt_pk_bf16_f32 v76, v24, v25
v_pk_mul_f32 v[26:27], v[250:251], s[94:95] op_sel_hi:[1,0]
v_cvt_pk_bf16_f32 v77, v26, v27
v_pk_mul_f32 v[28:29], v[252:253], s[94:95] op_sel_hi:[1,0]
v_cvt_pk_bf16_f32 v78, v28, v29
v_pk_mul_f32 v[30:31], v[254:255], s[94:95] op_sel_hi:[1,0]
v_cvt_pk_bf16_f32 v79, v30, v31
s_add_u32 s25, s62, 18432
buffer_store_dwordx4 v[72:75], v17, s[8:11], s25 offen offset:0 sc1
s_add_u32 s25, s62, 18432
buffer_store_dwordx4 v[76:79], v17, s[8:11], s25 offen offset:1024 sc1
v_accvgpr_read_b32 v24, a0
v_accvgpr_read_b32 v25, a1
v_pk_mul_f32 v[24:25], v[24:25], s[94:95] op_sel_hi:[1,0]
v_cvt_pk_bf16_f32 v80, v24, v25
v_accvgpr_read_b32 v26, a2
v_accvgpr_read_b32 v27, a3
v_pk_mul_f32 v[26:27], v[26:27], s[94:95] op_sel_hi:[1,0]
v_cvt_pk_bf16_f32 v81, v26, v27
v_accvgpr_read_b32 v28, a4
v_accvgpr_read_b32 v29, a5
v_pk_mul_f32 v[28:29], v[28:29], s[94:95] op_sel_hi:[1,0]
v_cvt_pk_bf16_f32 v82, v28, v29
v_accvgpr_read_b32 v30, a6
v_accvgpr_read_b32 v31, a7
v_pk_mul_f32 v[30:31], v[30:31], s[94:95] op_sel_hi:[1,0]
v_cvt_pk_bf16_f32 v83, v30, v31
v_accvgpr_read_b32 v24, a8
v_accvgpr_read_b32 v25, a9
v_pk_mul_f32 v[24:25], v[24:25], s[94:95] op_sel_hi:[1,0]
v_cvt_pk_bf16_f32 v84, v24, v25
v_accvgpr_read_b32 v26, a10
v_accvgpr_read_b32 v27, a11
v_pk_mul_f32 v[26:27], v[26:27], s[94:95] op_sel_hi:[1,0]
v_cvt_pk_bf16_f32 v85, v26, v27
v_accvgpr_read_b32 v28, a12
v_accvgpr_read_b32 v29, a13
v_pk_mul_f32 v[28:29], v[28:29], s[94:95] op_sel_hi:[1,0]
v_cvt_pk_bf16_f32 v86, v28, v29
v_accvgpr_read_b32 v30, a14
v_accvgpr_read_b32 v31, a15
v_pk_mul_f32 v[30:31], v[30:31], s[94:95] op_sel_hi:[1,0]
v_cvt_pk_bf16_f32 v87, v30, v31
s_add_u32 s25, s62, 34816
buffer_store_dwordx4 v[80:83], v17, s[8:11], s25 offen offset:0 sc1
s_add_u32 s25, s62, 34816
buffer_store_dwordx4 v[84:87], v17, s[8:11], s25 offen offset:1024 sc1
v_accvgpr_read_b32 v24, a16
v_accvgpr_read_b32 v25, a17
v_pk_mul_f32 v[24:25], v[24:25], s[94:95] op_sel_hi:[1,0]
v_cvt_pk_bf16_f32 v88, v24, v25
v_accvgpr_read_b32 v26, a18
v_accvgpr_read_b32 v27, a19
v_pk_mul_f32 v[26:27], v[26:27], s[94:95] op_sel_hi:[1,0]
v_cvt_pk_bf16_f32 v89, v26, v27
v_accvgpr_read_b32 v28, a20
v_accvgpr_read_b32 v29, a21
v_pk_mul_f32 v[28:29], v[28:29], s[94:95] op_sel_hi:[1,0]
v_cvt_pk_bf16_f32 v90, v28, v29
v_accvgpr_read_b32 v30, a22
v_accvgpr_read_b32 v31, a23
v_pk_mul_f32 v[30:31], v[30:31], s[94:95] op_sel_hi:[1,0]
v_cvt_pk_bf16_f32 v91, v30, v31
v_accvgpr_read_b32 v24, a24
v_accvgpr_read_b32 v25, a25
v_pk_mul_f32 v[24:25], v[24:25], s[94:95] op_sel_hi:[1,0]
v_cvt_pk_bf16_f32 v92, v24, v25
v_accvgpr_read_b32 v26, a26
v_accvgpr_read_b32 v27, a27
v_pk_mul_f32 v[26:27], v[26:27], s[94:95] op_sel_hi:[1,0]
v_cvt_pk_bf16_f32 v93, v26, v27
v_accvgpr_read_b32 v28, a28
v_accvgpr_read_b32 v29, a29
v_pk_mul_f32 v[28:29], v[28:29], s[94:95] op_sel_hi:[1,0]
v_cvt_pk_bf16_f32 v94, v28, v29
v_accvgpr_read_b32 v30, a30
v_accvgpr_read_b32 v31, a31
v_pk_mul_f32 v[30:31], v[30:31], s[94:95] op_sel_hi:[1,0]
v_cvt_pk_bf16_f32 v95, v30, v31
s_add_u32 s25, s62, 51200
buffer_store_dwordx4 v[88:91], v17, s[8:11], s25 offen offset:0 sc1
s_add_u32 s25, s62, 51200
buffer_store_dwordx4 v[92:95], v17, s[8:11], s25 offen offset:1024 sc1
v_accvgpr_read_b32 v24, a32
v_accvgpr_read_b32 v25, a33
v_pk_mul_f32 v[24:25], v[24:25], s[94:95] op_sel_hi:[1,0]
v_cvt_pk_bf16_f32 v96, v24, v25
v_accvgpr_read_b32 v26, a34
v_accvgpr_read_b32 v27, a35
v_pk_mul_f32 v[26:27], v[26:27], s[94:95] op_sel_hi:[1,0]
v_cvt_pk_bf16_f32 v97, v26, v27
v_accvgpr_read_b32 v28, a36
v_accvgpr_read_b32 v29, a37
v_pk_mul_f32 v[28:29], v[28:29], s[94:95] op_sel_hi:[1,0]
v_cvt_pk_bf16_f32 v98, v28, v29
v_accvgpr_read_b32 v30, a38
v_accvgpr_read_b32 v31, a39
v_pk_mul_f32 v[30:31], v[30:31], s[94:95] op_sel_hi:[1,0]
v_cvt_pk_bf16_f32 v99, v30, v31
v_accvgpr_read_b32 v24, a40
v_accvgpr_read_b32 v25, a41
v_pk_mul_f32 v[24:25], v[24:25], s[94:95] op_sel_hi:[1,0]
v_cvt_pk_bf16_f32 v100, v24, v25
v_accvgpr_read_b32 v26, a42
v_accvgpr_read_b32 v27, a43
v_pk_mul_f32 v[26:27], v[26:27], s[94:95] op_sel_hi:[1,0]
v_cvt_pk_bf16_f32 v101, v26, v27
v_accvgpr_read_b32 v28, a44
v_accvgpr_read_b32 v29, a45
v_pk_mul_f32 v[28:29], v[28:29], s[94:95] op_sel_hi:[1,0]
v_cvt_pk_bf16_f32 v102, v28, v29
v_accvgpr_read_b32 v30, a46
v_accvgpr_read_b32 v31, a47
v_pk_mul_f32 v[30:31], v[30:31], s[94:95] op_sel_hi:[1,0]
v_cvt_pk_bf16_f32 v103, v30, v31
s_add_u32 s25, s62, 4096
buffer_store_dwordx4 v[96:99], v17, s[8:11], s25 offen offset:0 sc1
s_add_u32 s25, s62, 4096
buffer_store_dwordx4 v[100:103], v17, s[8:11], s25 offen offset:1024 sc1
v_accvgpr_read_b32 v24, a48
v_accvgpr_read_b32 v25, a49
v_pk_mul_f32 v[24:25], v[24:25], s[94:95] op_sel_hi:[1,0]
v_cvt_pk_bf16_f32 v104, v24, v25
v_accvgpr_read_b32 v26, a50
v_accvgpr_read_b32 v27, a51
v_pk_mul_f32 v[26:27], v[26:27], s[94:95] op_sel_hi:[1,0]
v_cvt_pk_bf16_f32 v105, v26, v27
v_accvgpr_read_b32 v28, a52
v_accvgpr_read_b32 v29, a53
v_pk_mul_f32 v[28:29], v[28:29], s[94:95] op_sel_hi:[1,0]
v_cvt_pk_bf16_f32 v106, v28, v29
v_accvgpr_read_b32 v30, a54
v_accvgpr_read_b32 v31, a55
v_pk_mul_f32 v[30:31], v[30:31], s[94:95] op_sel_hi:[1,0]
v_cvt_pk_bf16_f32 v107, v30, v31
v_accvgpr_read_b32 v24, a56
v_accvgpr_read_b32 v25, a57
v_pk_mul_f32 v[24:25], v[24:25], s[94:95] op_sel_hi:[1,0]
v_cvt_pk_bf16_f32 v108, v24, v25
v_accvgpr_read_b32 v26, a58
v_accvgpr_read_b32 v27, a59
v_pk_mul_f32 v[26:27], v[26:27], s[94:95] op_sel_hi:[1,0]
v_cvt_pk_bf16_f32 v109, v26, v27
v_accvgpr_read_b32 v28, a60
v_accvgpr_read_b32 v29, a61
v_pk_mul_f32 v[28:29], v[28:29], s[94:95] op_sel_hi:[1,0]
v_cvt_pk_bf16_f32 v110, v28, v29
v_accvgpr_read_b32 v30, a62
v_accvgpr_read_b32 v31, a63
v_pk_mul_f32 v[30:31], v[30:31], s[94:95] op_sel_hi:[1,0]
v_cvt_pk_bf16_f32 v111, v30, v31
s_add_u32 s25, s62, 20480
buffer_store_dwordx4 v[104:107], v17, s[8:11], s25 offen offset:0 sc1
s_add_u32 s25, s62, 20480
buffer_store_dwordx4 v[108:111], v17, s[8:11], s25 offen offset:1024 sc1
v_accvgpr_read_b32 v24, a64
v_accvgpr_read_b32 v25, a65
v_pk_mul_f32 v[24:25], v[24:25], s[94:95] op_sel_hi:[1,0]
v_cvt_pk_bf16_f32 v112, v24, v25
v_accvgpr_read_b32 v26, a66
v_accvgpr_read_b32 v27, a67
v_pk_mul_f32 v[26:27], v[26:27], s[94:95] op_sel_hi:[1,0]
v_cvt_pk_bf16_f32 v113, v26, v27
v_accvgpr_read_b32 v28, a68
v_accvgpr_read_b32 v29, a69
v_pk_mul_f32 v[28:29], v[28:29], s[94:95] op_sel_hi:[1,0]
v_cvt_pk_bf16_f32 v114, v28, v29
v_accvgpr_read_b32 v30, a70
v_accvgpr_read_b32 v31, a71
v_pk_mul_f32 v[30:31], v[30:31], s[94:95] op_sel_hi:[1,0]
v_cvt_pk_bf16_f32 v115, v30, v31
v_accvgpr_read_b32 v24, a72
v_accvgpr_read_b32 v25, a73
v_pk_mul_f32 v[24:25], v[24:25], s[94:95] op_sel_hi:[1,0]
v_cvt_pk_bf16_f32 v116, v24, v25
v_accvgpr_read_b32 v26, a74
v_accvgpr_read_b32 v27, a75
v_pk_mul_f32 v[26:27], v[26:27], s[94:95] op_sel_hi:[1,0]
v_cvt_pk_bf16_f32 v117, v26, v27
v_accvgpr_read_b32 v28, a76
v_accvgpr_read_b32 v29, a77
v_pk_mul_f32 v[28:29], v[28:29], s[94:95] op_sel_hi:[1,0]
v_cvt_pk_bf16_f32 v118, v28, v29
v_accvgpr_read_b32 v30, a78
v_accvgpr_read_b32 v31, a79
v_pk_mul_f32 v[30:31], v[30:31], s[94:95] op_sel_hi:[1,0]
v_cvt_pk_bf16_f32 v119, v30, v31
s_add_u32 s25, s62, 36864
buffer_store_dwordx4 v[112:115], v17, s[8:11], s25 offen offset:0 sc1
s_add_u32 s25, s62, 36864
buffer_store_dwordx4 v[116:119], v17, s[8:11], s25 offen offset:1024 sc1
v_accvgpr_read_b32 v24, a80
v_accvgpr_read_b32 v25, a81
v_pk_mul_f32 v[24:25], v[24:25], s[94:95] op_sel_hi:[1,0]
v_cvt_pk_bf16_f32 v120, v24, v25
v_accvgpr_read_b32 v26, a82
v_accvgpr_read_b32 v27, a83
v_pk_mul_f32 v[26:27], v[26:27], s[94:95] op_sel_hi:[1,0]
v_cvt_pk_bf16_f32 v121, v26, v27
v_accvgpr_read_b32 v28, a84
v_accvgpr_read_b32 v29, a85
v_pk_mul_f32 v[28:29], v[28:29], s[94:95] op_sel_hi:[1,0]
v_cvt_pk_bf16_f32 v122, v28, v29
v_accvgpr_read_b32 v30, a86
v_accvgpr_read_b32 v31, a87
v_pk_mul_f32 v[30:31], v[30:31], s[94:95] op_sel_hi:[1,0]
v_cvt_pk_bf16_f32 v123, v30, v31
v_accvgpr_read_b32 v24, a88
v_accvgpr_read_b32 v25, a89
v_pk_mul_f32 v[24:25], v[24:25], s[94:95] op_sel_hi:[1,0]
v_cvt_pk_bf16_f32 v124, v24, v25
v_accvgpr_read_b32 v26, a90
v_accvgpr_read_b32 v27, a91
v_pk_mul_f32 v[26:27], v[26:27], s[94:95] op_sel_hi:[1,0]
v_cvt_pk_bf16_f32 v125, v26, v27
v_accvgpr_read_b32 v28, a92
v_accvgpr_read_b32 v29, a93
v_pk_mul_f32 v[28:29], v[28:29], s[94:95] op_sel_hi:[1,0]
v_cvt_pk_bf16_f32 v126, v28, v29
v_accvgpr_read_b32 v30, a94
v_accvgpr_read_b32 v31, a95
v_pk_mul_f32 v[30:31], v[30:31], s[94:95] op_sel_hi:[1,0]
v_cvt_pk_bf16_f32 v127, v30, v31
s_add_u32 s25, s62, 53248
buffer_store_dwordx4 v[120:123], v17, s[8:11], s25 offen offset:0 sc1
s_add_u32 s25, s62, 53248
buffer_store_dwordx4 v[124:127], v17, s[8:11], s25 offen offset:1024 sc1
v_accvgpr_read_b32 v24, a96
v_accvgpr_read_b32 v25, a97
v_pk_mul_f32 v[24:25], v[24:25], s[94:95] op_sel_hi:[1,0]
v_cvt_pk_bf16_f32 v128, v24, v25
v_accvgpr_read_b32 v26, a98
v_accvgpr_read_b32 v27, a99
v_pk_mul_f32 v[26:27], v[26:27], s[94:95] op_sel_hi:[1,0]
v_cvt_pk_bf16_f32 v129, v26, v27
v_accvgpr_read_b32 v28, a100
v_accvgpr_read_b32 v29, a101
v_pk_mul_f32 v[28:29], v[28:29], s[94:95] op_sel_hi:[1,0]
v_cvt_pk_bf16_f32 v130, v28, v29
v_accvgpr_read_b32 v30, a102
v_accvgpr_read_b32 v31, a103
v_pk_mul_f32 v[30:31], v[30:31], s[94:95] op_sel_hi:[1,0]
v_cvt_pk_bf16_f32 v131, v30, v31
v_accvgpr_read_b32 v24, a104
v_accvgpr_read_b32 v25, a105
v_pk_mul_f32 v[24:25], v[24:25], s[94:95] op_sel_hi:[1,0]
v_cvt_pk_bf16_f32 v132, v24, v25
v_accvgpr_read_b32 v26, a106
v_accvgpr_read_b32 v27, a107
v_pk_mul_f32 v[26:27], v[26:27], s[94:95] op_sel_hi:[1,0]
v_cvt_pk_bf16_f32 v133, v26, v27
v_accvgpr_read_b32 v28, a108
v_accvgpr_read_b32 v29, a109
v_pk_mul_f32 v[28:29], v[28:29], s[94:95] op_sel_hi:[1,0]
v_cvt_pk_bf16_f32 v134, v28, v29
v_accvgpr_read_b32 v30, a110
v_accvgpr_read_b32 v31, a111
v_pk_mul_f32 v[30:31], v[30:31], s[94:95] op_sel_hi:[1,0]
v_cvt_pk_bf16_f32 v135, v30, v31
s_add_u32 s25, s62, 6144
buffer_store_dwordx4 v[128:131], v17, s[8:11], s25 offen offset:0 sc1
s_add_u32 s25, s62, 6144
buffer_store_dwordx4 v[132:135], v17, s[8:11], s25 offen offset:1024 sc1
v_accvgpr_read_b32 v24, a112
v_accvgpr_read_b32 v25, a113
v_pk_mul_f32 v[24:25], v[24:25], s[94:95] op_sel_hi:[1,0]
v_cvt_pk_bf16_f32 v136, v24, v25
v_accvgpr_read_b32 v26, a114
v_accvgpr_read_b32 v27, a115
v_pk_mul_f32 v[26:27], v[26:27], s[94:95] op_sel_hi:[1,0]
v_cvt_pk_bf16_f32 v137, v26, v27
v_accvgpr_read_b32 v28, a116
v_accvgpr_read_b32 v29, a117
v_pk_mul_f32 v[28:29], v[28:29], s[94:95] op_sel_hi:[1,0]
v_cvt_pk_bf16_f32 v138, v28, v29
v_accvgpr_read_b32 v30, a118
v_accvgpr_read_b32 v31, a119
v_pk_mul_f32 v[30:31], v[30:31], s[94:95] op_sel_hi:[1,0]
v_cvt_pk_bf16_f32 v139, v30, v31
v_accvgpr_read_b32 v24, a120
v_accvgpr_read_b32 v25, a121
v_pk_mul_f32 v[24:25], v[24:25], s[94:95] op_sel_hi:[1,0]
v_cvt_pk_bf16_f32 v140, v24, v25
v_accvgpr_read_b32 v26, a122
v_accvgpr_read_b32 v27, a123
v_pk_mul_f32 v[26:27], v[26:27], s[94:95] op_sel_hi:[1,0]
v_cvt_pk_bf16_f32 v141, v26, v27
v_accvgpr_read_b32 v28, a124
v_accvgpr_read_b32 v29, a125
v_pk_mul_f32 v[28:29], v[28:29], s[94:95] op_sel_hi:[1,0]
v_cvt_pk_bf16_f32 v142, v28, v29
v_accvgpr_read_b32 v30, a126
v_accvgpr_read_b32 v31, a127
v_pk_mul_f32 v[30:31], v[30:31], s[94:95] op_sel_hi:[1,0]
v_cvt_pk_bf16_f32 v143, v30, v31
s_add_u32 s25, s62, 22528
buffer_store_dwordx4 v[136:139], v17, s[8:11], s25 offen offset:0 sc1
s_add_u32 s25, s62, 22528
buffer_store_dwordx4 v[140:143], v17, s[8:11], s25 offen offset:1024 sc1
v_accvgpr_read_b32 v24, a128
v_accvgpr_read_b32 v25, a129
v_pk_mul_f32 v[24:25], v[24:25], s[94:95] op_sel_hi:[1,0]
v_cvt_pk_bf16_f32 v144, v24, v25
v_accvgpr_read_b32 v26, a130
v_accvgpr_read_b32 v27, a131
v_pk_mul_f32 v[26:27], v[26:27], s[94:95] op_sel_hi:[1,0]
v_cvt_pk_bf16_f32 v145, v26, v27
v_accvgpr_read_b32 v28, a132
v_accvgpr_read_b32 v29, a133
v_pk_mul_f32 v[28:29], v[28:29], s[94:95] op_sel_hi:[1,0]
v_cvt_pk_bf16_f32 v146, v28, v29
v_accvgpr_read_b32 v30, a134
v_accvgpr_read_b32 v31, a135
v_pk_mul_f32 v[30:31], v[30:31], s[94:95] op_sel_hi:[1,0]
v_cvt_pk_bf16_f32 v147, v30, v31
v_accvgpr_read_b32 v24, a136
v_accvgpr_read_b32 v25, a137
v_pk_mul_f32 v[24:25], v[24:25], s[94:95] op_sel_hi:[1,0]
v_cvt_pk_bf16_f32 v148, v24, v25
v_accvgpr_read_b32 v26, a138
v_accvgpr_read_b32 v27, a139
v_pk_mul_f32 v[26:27], v[26:27], s[94:95] op_sel_hi:[1,0]
v_cvt_pk_bf16_f32 v149, v26, v27
v_accvgpr_read_b32 v28, a140
v_accvgpr_read_b32 v29, a141
v_pk_mul_f32 v[28:29], v[28:29], s[94:95] op_sel_hi:[1,0]
v_cvt_pk_bf16_f32 v150, v28, v29
v_accvgpr_read_b32 v30, a142
v_accvgpr_read_b32 v31, a143
v_pk_mul_f32 v[30:31], v[30:31], s[94:95] op_sel_hi:[1,0]
v_cvt_pk_bf16_f32 v151, v30, v31
s_add_u32 s25, s62, 38912
buffer_store_dwordx4 v[144:147], v17, s[8:11], s25 offen offset:0 sc1
s_add_u32 s25, s62, 38912
buffer_store_dwordx4 v[148:151], v17, s[8:11], s25 offen offset:1024 sc1
v_accvgpr_read_b32 v24, a144
v_accvgpr_read_b32 v25, a145
v_pk_mul_f32 v[24:25], v[24:25], s[94:95] op_sel_hi:[1,0]
v_cvt_pk_bf16_f32 v152, v24, v25
v_accvgpr_read_b32 v26, a146
v_accvgpr_read_b32 v27, a147
v_pk_mul_f32 v[26:27], v[26:27], s[94:95] op_sel_hi:[1,0]
v_cvt_pk_bf16_f32 v153, v26, v27
v_accvgpr_read_b32 v28, a148
v_accvgpr_read_b32 v29, a149
v_pk_mul_f32 v[28:29], v[28:29], s[94:95] op_sel_hi:[1,0]
v_cvt_pk_bf16_f32 v154, v28, v29
v_accvgpr_read_b32 v30, a150
v_accvgpr_read_b32 v31, a151
v_pk_mul_f32 v[30:31], v[30:31], s[94:95] op_sel_hi:[1,0]
v_cvt_pk_bf16_f32 v155, v30, v31
v_accvgpr_read_b32 v24, a152
v_accvgpr_read_b32 v25, a153
v_pk_mul_f32 v[24:25], v[24:25], s[94:95] op_sel_hi:[1,0]
v_cvt_pk_bf16_f32 v156, v24, v25
v_accvgpr_read_b32 v26, a154
v_accvgpr_read_b32 v27, a155
v_pk_mul_f32 v[26:27], v[26:27], s[94:95] op_sel_hi:[1,0]
v_cvt_pk_bf16_f32 v157, v26, v27
v_accvgpr_read_b32 v28, a156
v_accvgpr_read_b32 v29, a157
v_pk_mul_f32 v[28:29], v[28:29], s[94:95] op_sel_hi:[1,0]
v_cvt_pk_bf16_f32 v158, v28, v29
v_accvgpr_read_b32 v30, a158
v_accvgpr_read_b32 v31, a159
v_pk_mul_f32 v[30:31], v[30:31], s[94:95] op_sel_hi:[1,0]
v_cvt_pk_bf16_f32 v159, v30, v31
s_add_u32 s25, s62, 55296
buffer_store_dwordx4 v[152:155], v17, s[8:11], s25 offen offset:0 sc1
s_add_u32 s25, s62, 55296
buffer_store_dwordx4 v[156:159], v17, s[8:11], s25 offen offset:1024 sc1
v_mov_b32 v20, 128
s_mov_b32 s28, 0
L_poll_23:
buffer_load_dword v21, v20, s[56:59], 0 offen sc1
s_add_u32 s28, s28, 1
s_cmp_gt_u32 s28, 40000
s_cbranch_scc1 L_end
s_waitcnt vmcnt(0)
v_cmp_ne_u32 vcc, 8, v21
s_cbranch_vccz L_pd_24
s_sleep 1
s_branch L_poll_23
L_pd_24:
s_waitcnt vmcnt(0) lgkmcnt(0)
s_barrier
v_mov_b32 v18, 0
v_mov_b32 v19, s60
s_cmp_eq_u32 s17, 0
s_cselect_b32 s25, s63, 536870912
s_mov_b64 exec, 1
buffer_store_dword v19, v18, s[8:11], s25 offen sc1
s_mov_b64 exec, -1
s_cmp_eq_u32 s3, 1
s_cbranch_scc1 L_part
s_cmp_eq_u32 s61, 1
s_cbranch_scc1 L_aop
s_sub_u32 s24, s3, 4
s_lshl_b32 s24, s24, 3
s_lshr_b32 s42, s16, 2
s_add_u32 s42, s42, s24
s_and_b32 s62, s16, 3
s_mov_b32 s40, 0x3e0293ee
s_mov_b32 s50, 0xf149f2ca
s_mov_b32 s51, 0x41a00000
v_and_b32 v20, 7, v0
v_lshlrev_b32 v20, 2, v20
v_bfe_u32 v21, v0, 3, 1
s_lshl_b32 s25, s42, 7
s_add_u32 s25, s25, 111165440
s_lshr_b32 s24, s42, 1
s_lshl_b32 s24, s24, 7
s_add_u32 s24, s24, 111173632
s_sub_u32 s24, s24, s25
v_mad_u32_u24 v20, v21, s24, v20
s_mov_b32 s28, 0
L_poll_25:
buffer_load_dword v21, v20, s[8:11], s25 offen sc1
s_add_u32 s28, s28, 1
s_cmp_gt_u32 s28, 40000
s_cbranch_scc1 L_end
s_waitcnt vmcnt(0)
v_cmp_ne_u32 vcc, 1, v21
s_cbranch_vccz L_pd_26
s_sleep 1
s_branch L_poll_25
L_pd_26:
s_sub_u32 s41, 7, s62
s_mov_b32 s60, 0
L_aat:
v_and_b32 v5, 31, v0
v_bfe_u32 v26, v0, 5, 1
v_lshlrev_b32 v27, 2, v26
v_sub_u32 v5, v5, v27
v_bfe_u32 v27, v0, 4, 1
v_lshlrev_b32 v6, 17, v27
v_lshl_add_u32 v6, v26, 8, v6
v_and_b32 v27, 15, v0
v_lshl_add_u32 v6, v27, 4, v6
v_and_b32 v2, 63, v0
v_lshlrev_b32 v2, 4, v2
s_lshl_b32 s24, s17, 13
v_add_u32 v1, s24, v2
v_add_u32 v3, 32768, v2
v_mov_b32 v4, v2
s_lshl_b32 s46, s42, 20
s_add_u32 s46, s46, 0
s_mov_b32 s47, s24
s_lshl_b32 s44, s41, 2
s_add_u32 s45, s44, 4
s_add_u32 s44, s44, s17
s_mov_b32 s43, 0
s_mov_b32 s48, 0
s_mov_b32 s54, s50
s_mov_b32 s55, s50
s_barrier
s_lshr_b32 s26, s42, 1
s_lshl_b32 s26, s26, 6
s_lshl_b32 s27, s44, 1
s_add_u32 s26, s26, s27
s_lshl_b32 s26, s26, 1
s_and_b32 s27, s42, 1
s_add_u32 s26, s26, s27
s_lshl_b32 s26, s26, 13
s_add_u32 s26, s26, 117440512
s_add_u32 s27, s26, 0
buffer_load_dwordx4 a[0:3], v2, s[8:11], s27 offen offset:0 sc1
buffer_load_dwordx4 a[4:7], v2, s[8:11], s27 offen offset:1024 sc1
buffer_load_dwordx4 a[8:11], v2, s[8:11], s27 offen offset:2048 sc1
buffer_load_dwordx4 a[12:15], v2, s[8:11], s27 offen offset:3072 sc1
s_add_u32 s27, s26, 4096
buffer_load_dwordx4 a[16:19], v2, s[8:11], s27 offen offset:0 sc1
buffer_load_dwordx4 a[20:23], v2, s[8:11], s27 offen offset:1024 sc1
buffer_load_dwordx4 a[24:27], v2, s[8:11], s27 offen offset:2048 sc1
buffer_load_dwordx4 a[28:31], v2, s[8:11], s27 offen offset:3072 sc1
s_add_u32 s27, s26, 16384
buffer_load_dwordx4 a[32:35], v2, s[8:11], s27 offen offset:0 sc1
buffer_load_dwordx4 a[36:39], v2, s[8:11], s27 offen offset:1024 sc1
buffer_load_dwordx4 a[40:43], v2, s[8:11], s27 offen offset:2048 sc1
buffer_load_dwordx4 a[44:47], v2, s[8:11], s27 offen offset:3072 sc1
s_add_u32 s27, s26, 20480
buffer_load_dwordx4 a[48:51], v2, s[8:11], s27 offen offset:0 sc1
buffer_load_dwordx4 a[52:55], v2, s[8:11], s27 offen offset:1024 sc1
buffer_load_dwordx4 a[56:59], v2, s[8:11], s27 offen offset:2048 sc1
buffer_load_dwordx4 a[60:63], v2, s[8:11], s27 offen offset:3072 sc1
s_mov_b32 m0, s47
s_add_u32 s24, s46, 4096
buffer_load_dwordx4 v1, s[8:11], s46 offen offset:0 sc1 lds
buffer_load_dwordx4 v1, s[8:11], s46 offen offset:1024 sc1 lds
buffer_load_dwordx4 v1, s[8:11], s46 offen offset:2048 sc1 lds
buffer_load_dwordx4 v1, s[8:11], s46 offen offset:3072 sc1 lds
s_add_u32 m0, s47, 4096
s_nop 0
buffer_load_dwordx4 v1, s[8:11], s24 offen offset:0 sc1 lds
buffer_load_dwordx4 v1, s[8:11], s24 offen offset:1024 sc1 lds
buffer_load_dwordx4 v1, s[8:11], s24 offen offset:2048 sc1 lds
buffer_load_dwordx4 v1, s[8:11], s24 offen offset:3072 sc1 lds
s_add_u32 s46, s46, 32768
s_add_u32 s47, s47, 32768
s_and_b32 s47, s47, 131071
s_mov_b32 m0, s47
s_add_u32 s24, s46, 4096
buffer_load_dwordx4 v1, s[8:11], s46 offen offset:0 sc1 lds
buffer_load_dwordx4 v1, s[8:11], s46 offen offset:1024 sc1 lds
buffer_load_dwordx4 v1, s[8:11], s46 offen offset:2048 sc1 lds
buffer_load_dwordx4 v1, s[8:11], s46 offen offset:3072 sc1 lds
s_add_u32 m0, s47, 4096
s_nop 0
buffer_load_dwordx4 v1, s[8:11], s24 offen offset:0 sc1 lds
buffer_load_dwordx4 v1, s[8:11], s24 offen offset:1024 sc1 lds
buffer_load_dwordx4 v1, s[8:11], s24 offen offset:2048 sc1 lds
buffer_load_dwordx4 v1, s[8:11], s24 offen offset:3072 sc1 lds
s_add_u32 s46, s46, 32768
s_add_u32 s47, s47, 32768
s_and_b32 s47, s47, 131071
s_mov_b32 m0, s47
s_add_u32 s24, s46, 4096
buffer_load_dwordx4 v1, s[8:11], s46 offen offset:0 sc1 lds
buffer_load_dwordx4 v1, s[8:11], s46 offen offset:1024 sc1 lds
buffer_load_dwordx4 v1, s[8:11], s46 offen offset:2048 sc1 lds
buffer_load_dwordx4 v1, s[8:11], s46 offen offset:3072 sc1 lds
s_add_u32 m0, s47, 4096
s_nop 0
buffer_load_dwordx4 v1, s[8:11], s24 offen offset:0 sc1 lds
buffer_load_dwordx4 v1, s[8:11], s24 offen offset:1024 sc1 lds
buffer_load_dwordx4 v1, s[8:11], s24 offen offset:2048 sc1 lds
buffer_load_dwordx4 v1, s[8:11], s24 offen offset:3072 sc1 lds
s_add_u32 s46, s46, 32768
s_add_u32 s47, s47, 32768
s_and_b32 s47, s47, 131071
v_accvgpr_write_b32 a96, 0
v_accvgpr_write_b32 a97, 0
v_accvgpr_write_b32 a98, 0
v_accvgpr_write_b32 a99, 0
v_accvgpr_write_b32 a100, 0
v_accvgpr_write_b32 a101, 0
v_accvgpr_write_b32 a102, 0
v_accvgpr_write_b32 a103, 0
v_accvgpr_write_b32 a104, 0
v_accvgpr_write_b32 a105, 0
v_accvgpr_write_b32 a106, 0
v_accvgpr_write_b32 a107, 0
v_accvgpr_write_b32 a108, 0
v_accvgpr_write_b32 a109, 0
v_accvgpr_write_b32 a110, 0
v_accvgpr_write_b32 a111, 0
v_accvgpr_write_b32 a112, 0
v_accvgpr_write_b32 a113, 0
v_accvgpr_write_b32 a114, 0
v_accvgpr_write_b32 a115, 0
v_accvgpr_write_b32 a116, 0
v_accvgpr_write_b32 a117, 0
v_accvgpr_write_b32 a118, 0
v_accvgpr_write_b32 a119, 0
v_accvgpr_write_b32 a120, 0
v_accvgpr_write_b32 a121, 0
v_accvgpr_write_b32 a122, 0
v_accvgpr_write_b32 a123, 0
v_accvgpr_write_b32 a124, 0
v_accvgpr_write_b32 a125, 0
v_accvgpr_write_b32 a126, 0
v_accvgpr_write_b32 a127, 0
v_accvgpr_write_b32 a128, 0
v_accvgpr_write_b32 a129, 0
v_accvgpr_write_b32 a130, 0
v_accvgpr_write_b32 a131, 0
v_accvgpr_write_b32 a132, 0
v_accvgpr_write_b32 a133, 0
v_accvgpr_write_b32 a134, 0
v_accvgpr_write_b32 a135, 0
v_accvgpr_write_b32 a136, 0
v_accvgpr_write_b32 a137, 0
v_accvgpr_write_b32 a138, 0
v_accvgpr_write_b32 a139, 0
v_accvgpr_write_b32 a140, 0
v_accvgpr_write_b32 a141, 0
v_accvgpr_write_b32 a142, 0
v_accvgpr_write_b32 a143, 0
v_accvgpr_write_b32 a144, 0
v_accvgpr_write_b32 a145, 0
v_accvgpr_write_b32 a146, 0
v_accvgpr_write_b32 a147, 0
v_accvgpr_write_b32 a148, 0
v_accvgpr_write_b32 a149, 0
v_accvgpr_write_b32 a150, 0
v_accvgpr_write_b32 a151, 0
v_accvgpr_write_b32 a152, 0
v_accvgpr_write_b32 a153, 0
v_accvgpr_write_b32 a154, 0
v_accvgpr_write_b32 a155, 0
v_accvgpr_write_b32 a156, 0
v_accvgpr_write_b32 a157, 0
v_accvgpr_write_b32 a158, 0
v_accvgpr_write_b32 a159, 0
v_accvgpr_write_b32 a160, 0
v_accvgpr_write_b32 a161, 0
v_accvgpr_write_b32 a162, 0
v_accvgpr_write_b32 a163, 0
v_accvgpr_write_b32 a164, 0
v_accvgpr_write_b32 a165, 0
v_accvgpr_write_b32 a166, 0
v_accvgpr_write_b32 a167, 0
v_accvgpr_write_b32 a168, 0
v_accvgpr_write_b32 a169, 0
v_accvgpr_write_b32 a170, 0
v_accvgpr_write_b32 a171, 0
v_accvgpr_write_b32 a172, 0
v_accvgpr_write_b32 a173, 0
v_accvgpr_write_b32 a174, 0
v_accvgpr_write_b32 a175, 0
v_accvgpr_write_b32 a176, 0
v_accvgpr_write_b32 a177, 0
v_accvgpr_write_b32 a178, 0
v_accvgpr_write_b32 a179, 0
v_accvgpr_write_b32 a180, 0
v_accvgpr_write_b32 a181, 0
v_accvgpr_write_b32 a182, 0
v_accvgpr_write_b32 a183, 0
v_accvgpr_write_b32 a184, 0
v_accvgpr_write_b32 a185, 0
v_accvgpr_write_b32 a186, 0
v_accvgpr_write_b32 a187, 0
v_accvgpr_write_b32 a188, 0
v_accvgpr_write_b32 a189, 0
v_accvgpr_write_b32 a190, 0
v_accvgpr_write_b32 a191, 0
v_accvgpr_write_b32 a192, 0
v_accvgpr_write_b32 a193, 0
v_accvgpr_write_b32 a194, 0
v_accvgpr_write_b32 a195, 0
v_accvgpr_write_b32 a196, 0
v_accvgpr_write_b32 a197, 0
v_accvgpr_write_b32 a198, 0
v_accvgpr_write_b32 a199, 0
v_accvgpr_write_b32 a200, 0
v_accvgpr_write_b32 a201, 0
v_accvgpr_write_b32 a202, 0
v_accvgpr_write_b32 a203, 0
v_accvgpr_write_b32 a204, 0
v_accvgpr_write_b32 a205, 0
v_accvgpr_write_b32 a206, 0
v_accvgpr_write_b32 a207, 0
v_accvgpr_write_b32 a208, 0
v_accvgpr_write_b32 a209, 0
v_accvgpr_write_b32 a210, 0
v_accvgpr_write_b32 a211, 0
v_accvgpr_write_b32 a212, 0
v_accvgpr_write_b32 a213, 0
v_accvgpr_write_b32 a214, 0
v_accvgpr_write_b32 a215, 0
v_accvgpr_write_b32 a216, 0
v_accvgpr_write_b32 a217, 0
v_accvgpr_write_b32 a218, 0
v_accvgpr_write_b32 a219, 0
v_accvgpr_write_b32 a220, 0
v_accvgpr_write_b32 a221, 0
v_accvgpr_write_b32 a222, 0
v_accvgpr_write_b32 a223, 0
v_mov_b64 v[112:113], 0
v_mov_b64 v[114:115], 0
v_mov_b64 v[116:117], 0
v_mov_b64 v[118:119], 0
v_mov_b64 v[120:121], 0
v_mov_b64 v[122:123], 0
v_mov_b64 v[124:125], 0
v_mov_b64 v[126:127], 0
v_mov_b64 v[128:129], 0
v_mov_b64 v[130:131], 0
v_mov_b64 v[132:133], 0
v_mov_b64 v[134:135], 0
v_mov_b64 v[136:137], 0
v_mov_b64 v[138:139], 0
v_mov_b64 v[140:141], 0
v_mov_b64 v[142:143], 0
v_mov_b64 v[144:145], 0
v_mov_b64 v[146:147], 0
v_mov_b64 v[148:149], 0
v_mov_b64 v[150:151], 0
v_mov_b64 v[152:153], 0
v_mov_b64 v[154:155], 0
v_mov_b64 v[156:157], 0
v_mov_b64 v[158:159], 0
v_mov_b64 v[22:23], 0
s_waitcnt vmcnt(16)
s_barrier
ds_read_b128 a[64:67], v2 offset:0
ds_read_b128 a[68:71], v2 offset:1024
ds_read_b128 a[72:75], v2 offset:2048
ds_read_b128 a[76:79], v2 offset:3072
s_waitcnt lgkmcnt(3)
v_mfma_f32_32x32x16_bf16 v[32:47], a[64:67], a[0:3], v[128:143]
ds_read_b128 a[80:83], v2 offset:4096
v_mfma_f32_32x32x16_bf16 v[48:63], a[64:67], a[32:35], v[144:159]
s_waitcnt lgkmcnt(3)
v_mfma_f32_32x32x16_bf16 v[32:47], a[68:71], a[4:7], v[32:47]
ds_read_b128 a[84:87], v2 offset:5120
v_mfma_f32_32x32x16_bf16 v[48:63], a[68:71], a[36:39], v[48:63]
s_waitcnt lgkmcnt(3)
v_mfma_f32_32x32x16_bf16 v[32:47], a[72:75], a[8:11], v[32:47]
ds_read_b128 a[88:91], v2 offset:6144
v_mfma_f32_32x32x16_bf16 v[48:63], a[72:75], a[40:43], v[48:63]
s_waitcnt lgkmcnt(3)
v_mfma_f32_32x32x16_bf16 v[32:47], a[76:79], a[12:15], v[32:47]
ds_read_b128 a[92:95], v2 offset:7168
v_mfma_f32_32x32x16_bf16 v[48:63], a[76:79], a[44:47], v[48:63]
s_waitcnt lgkmcnt(3)
v_mfma_f32_32x32x16_bf16 v[32:47], a[80:83], a[16:19], v[32:47]
ds_read_b128 a[64:67], v4 offset:24576
v_mfma_f32_32x32x16_bf16 v[48:63], a[80:83], a[48:51], v[48:63]
s_waitcnt lgkmcnt(3)
v_mfma_f32_32x32x16_bf16 v[32:47], a[84:87], a[20:23], v[32:47]
ds_read_b128 a[68:71], v4 offset:25600
v_mfma_f32_32x32x16_bf16 v[48:63], a[84:87], a[52:55], v[48:63]
s_waitcnt lgkmcnt(3)
v_mfma_f32_32x32x16_bf16 v[32:47], a[88:91], a[24:27], v[32:47]
ds_read_b128 a[72:75], v4 offset:26624
v_mfma_f32_32x32x16_bf16 v[48:63], a[88:91], a[56:59], v[48:63]
s_waitcnt lgkmcnt(3)
v_mfma_f32_32x32x16_bf16 v[32:47], a[92:95], a[28:31], v[32:47]
ds_read_b128 a[76:79], v4 offset:27648
v_mfma_f32_32x32x16_bf16 v[48:63], a[92:95], a[60:63], v[48:63]
s_waitcnt lgkmcnt(3)
s_cmp_eq_u32 s44, 0
s_cbranch_scc1 L_at_last
.p2align 3
L_at_loop:
v_mfma_f32_32x32x16_bf16 a[96:111], a[64:67], v[112:115], a[96:111]
ds_read_b128 a[80:83], v4 offset:28672
v_mfma_f32_32x32x16_bf16 a[112:127], a[64:67], v[120:123], a[112:127]
s_waitcnt lgkmcnt(3)
s_add_u32 s24, s43, 3
v_mfma_f32_32x32x16_bf16 a[96:111], a[68:71], v[116:119], a[96:111]
ds_read_b128 a[84:87], v4 offset:29696
v_max3_f32 v26, v32, v33, v34
v_max3_f32 v26, v26, v35, v36
v_max3_f32 v26, v26, v37, v38
v_max3_f32 v26, v26, v39, v40
v_mfma_f32_32x32x16_bf16 a[112:127], a[68:71], v[124:127], a[112:127]
s_waitcnt lgkmcnt(3)
s_cmp_lt_u32 s24, s45
s_cselect_b32 s46, s46, 536870912
v_max3_f32 v26, v26, v41, v42
v_max3_f32 v26, v26, v43, v44
v_max3_f32 v26, v26, v45, v46
v_max3_f32 v26, v26, v47, v48
v_max3_f32 v26, v26, v49, v50
v_mfma_f32_32x32x16_bf16 a[128:143], a[72:75], v[112:115], a[128:143]
ds_read_b128 a[88:91], v4 offset:30720
v_max3_f32 v26, v26, v51, v52
v_max3_f32 v26, v26, v53, v54
v_max3_f32 v26, v26, v55, v56
v_max3_f32 v26, v26, v57, v58
v_mfma_f32_32x32x16_bf16 a[144:159], a[72:75], v[120:123], a[144:159]
s_waitcnt lgkmcnt(3)
v_max3_f32 v26, v26, v59, v60
v_max3_f32 v26, v26, v61, v62
v_max_f32 v26, v26, v63
v_cmp_lt_f32 vcc, s54, v26
v_mfma_f32_32x32x16_bf16 a[128:143], a[76:79], v[116:119], a[128:143]
ds_read_b128 a[92:95], v4 offset:31744
s_cbranch_vccnz L_at_upa
L_at_upra:
v_exp_f32 v32, v32
v_exp_f32 v33, v33
v_mfma_f32_32x32x16_bf16 a[144:159], a[76:79], v[124:127], a[144:159]
s_waitcnt lgkmcnt(3)
v_exp_f32 v34, v34
v_add_f32 v22, v22, v32
v_add_f32 v22, v22, v33
v_mfma_f32_32x32x16_bf16 a[160:175], a[80:83], v[112:115], a[160:175]
ds_read_b128 a[64:67], v2 offset:16384
v_exp_f32 v35, v35
v_cvt_pk_bf16_f32 v96, v32, v33
v_exp_f32 v36, v36
v_mfma_f32_32x32x16_bf16 a[176:191], a[80:83], v[120:123], a[176:191]
s_waitcnt lgkmcnt(3)
v_add_f32 v22, v22, v34
v_add_f32 v22, v22, v35
v_exp_f32 v37, v37
v_mfma_f32_32x32x16_bf16 a[160:175], a[84:87], v[116:119], a[160:175]
ds_read_b128 a[68:71], v2 offset:17408
v_cvt_pk_bf16_f32 v97, v34, v35
v_exp_f32 v38, v38
v_add_f32 v22, v22, v36
v_add_f32 v22, v22, v37
v_mfma_f32_32x32x16_bf16 a[176:191], a[84:87], v[124:127], a[176:191]
s_waitcnt lgkmcnt(3)
v_exp_f32 v39, v39
v_cvt_pk_bf16_f32 v98, v36, v37
v_mfma_f32_32x32x16_bf16 a[192:207], a[88:91], v[112:115], a[192:207]
ds_read_b128 a[72:75], v2 offset:18432
v_exp_f32 v40, v40
v_add_f32 v22, v22, v38
v_add_f32 v22, v22, v39
v_exp_f32 v41, v41
v_mfma_f32_32x32x16_bf16 a[208:223], a[88:91], v[120:123], a[208:223]
s_waitcnt lgkmcnt(3)
v_cvt_pk_bf16_f32 v99, v38, v39
v_exp_f32 v42, v42
v_mfma_f32_32x32x16_bf16 a[192:207], a[92:95], v[116:119], a[192:207]
ds_read_b128 a[76:79], v2 offset:19456
v_add_f32 v22, v22, v40
v_add_f32 v22, v22, v41
v_exp_f32 v43, v43
v_cvt_pk_bf16_f32 v100, v40, v41
v_mfma_f32_32x32x16_bf16 a[208:223], a[92:95], v[124:127], a[208:223]
s_waitcnt lgkmcnt(3)
s_cmp_eq_u32 s48, 0
s_cbranch_scc0 L_at_rsa
L_at_rsra:
v_exp_f32 v44, v44
v_add_f32 v22, v22, v42
v_add_f32 v22, v22, v43
v_mfma_f32_32x32x16_bf16 v[64:79], a[64:67], a[0:3], v[128:143]
ds_read_b128 a[80:83], v2 offset:20480
v_exp_f32 v45, v45
v_cvt_pk_bf16_f32 v101, v42, v43
v_exp_f32 v46, v46
v_mfma_f32_32x32x16_bf16 v[80:95], a[64:67], a[32:35], v[144:159]
s_waitcnt lgkmcnt(3)
v_add_f32 v22, v22, v44
v_add_f32 v22, v22, v45
v_exp_f32 v47, v47
v_mfma_f32_32x32x16_bf16 v[64:79], a[68:71], a[4:7], v[64:79]
ds_read_b128 a[84:87], v2 offset:21504
v_cvt_pk_bf16_f32 v102, v44, v45
v_exp_f32 v48, v48
v_add_f32 v22, v22, v46
v_mfma_f32_32x32x16_bf16 v[80:95], a[68:71], a[36:39], v[80:95]
s_waitcnt lgkmcnt(3)
v_add_f32 v22, v22, v47
v_exp_f32 v49, v49
v_cvt_pk_bf16_f32 v103, v46, v47
v_mfma_f32_32x32x16_bf16 v[64:79], a[72:75], a[8:11], v[64:79]
ds_read_b128 a[88:91], v2 offset:22528
v_exp_f32 v50, v50
v_add_f32 v23, v23, v48
v_add_f32 v23, v23, v49
v_mfma_f32_32x32x16_bf16 v[80:95], a[72:75], a[40:43], v[80:95]
s_waitcnt lgkmcnt(3)
v_exp_f32 v51, v51
v_cvt_pk_bf16_f32 v104, v48, v49
v_exp_f32 v52, v52
v_mfma_f32_32x32x16_bf16 v[64:79], a[76:79], a[12:15], v[64:79]
ds_read_b128 a[92:95], v2 offset:23552
v_add_f32 v23, v23, v50
v_add_f32 v23, v23, v51
v_exp_f32 v53, v53
v_mfma_f32_32x32x16_bf16 v[80:95], a[76:79], a[44:47], v[80:95]
s_waitcnt lgkmcnt(3)
v_cvt_pk_bf16_f32 v105, v50, v51
v_exp_f32 v54, v54
v_add_f32 v23, v23, v52
v_add_f32 v23, v23, v53
v_mfma_f32_32x32x16_bf16 v[64:79], a[80:83], a[16:19], v[64:79]
ds_read_b128 a[64:67], v2 offset:8192
v_exp_f32 v55, v55
v_cvt_pk_bf16_f32 v106, v52, v53
v_mfma_f32_32x32x16_bf16 v[80:95], a[80:83], a[48:51], v[80:95]
s_waitcnt lgkmcnt(3)
v_exp_f32 v56, v56
v_add_f32 v23, v23, v54
v_add_f32 v23, v23, v55
v_exp_f32 v57, v57
v_mfma_f32_32x32x16_bf16 v[64:79], a[84:87], a[20:23], v[64:79]
ds_read_b128 a[68:71], v2 offset:9216
v_cvt_pk_bf16_f32 v107, v54, v55
v_exp_f32 v58, v58
v_mfma_f32_32x32x16_bf16 v[80:95], a[84:87], a[52:55], v[80:95]
s_waitcnt lgkmcnt(3)
v_add_f32 v23, v23, v56
v_add_f32 v23, v23, v57
v_exp_f32 v59, v59
v_cvt_pk_bf16_f32 v108, v56, v57
v_mfma_f32_32x32x16_bf16 v[64:79], a[88:91], a[24:27], v[64:79]
ds_read_b128 a[72:75], v2 offset:10240
v_exp_f32 v60, v60
v_add_f32 v23, v23, v58
v_add_f32 v23, v23, v59
v_mfma_f32_32x32x16_bf16 v[80:95], a[88:91], a[56:59], v[80:95]
s_waitcnt lgkmcnt(3)
v_exp_f32 v61, v61
v_cvt_pk_bf16_f32 v109, v58, v59
v_exp_f32 v62, v62
v_mfma_f32_32x32x16_bf16 v[64:79], a[92:95], a[28:31], v[64:79]
ds_read_b128 a[76:79], v2 offset:11264
v_add_f32 v23, v23, v60
v_add_f32 v23, v23, v61
v_exp_f32 v63, v63
v_mfma_f32_32x32x16_bf16 v[80:95], a[92:95], a[60:63], v[80:95]
s_waitcnt lgkmcnt(3)
v_cvt_pk_bf16_f32 v110, v60, v61
v_add_f32 v23, v23, v62
v_add_f32 v23, v23, v63
v_cvt_pk_bf16_f32 v111, v62, v63
s_waitcnt vmcnt(8)
s_barrier
v_mfma_f32_32x32x16_bf16 a[96:111], a[64:67], v[96:99], a[96:111]
ds_read_b128 a[80:83], v2 offset:12288
v_mfma_f32_32x32x16_bf16 a[112:127], a[64:67], v[104:107], a[112:127]
s_waitcnt lgkmcnt(3)
s_mov_b32 m0, s47
v_mfma_f32_32x32x16_bf16 a[96:111], a[68:71], v[100:103], a[96:111]
ds_read_b128 a[84:87], v2 offset:13312
v_max3_f32 v26, v64, v65, v66
v_max3_f32 v26, v26, v67, v68
v_max3_f32 v26, v26, v69, v70
v_max3_f32 v26, v26, v71, v72
v_mfma_f32_32x32x16_bf16 a[112:127], a[68:71], v[108:111], a[112:127]
s_waitcnt lgkmcnt(3)
s_add_u32 s24, s46, 4096
v_max3_f32 v26, v26, v73, v74
v_max3_f32 v26, v26, v75, v76
v_max3_f32 v26, v26, v77, v78
v_max3_f32 v26, v26, v79, v80
v_max3_f32 v26, v26, v81, v82
v_mfma_f32_32x32x16_bf16 a[128:143], a[72:75], v[96:99], a[128:143]
ds_read_b128 a[88:91], v2 offset:14336
v_max3_f32 v26, v26, v83, v84
v_max3_f32 v26, v26, v85, v86
v_max3_f32 v26, v26, v87, v88
v_max3_f32 v26, v26, v89, v90
v_mfma_f32_32x32x16_bf16 a[144:159], a[72:75], v[104:107], a[144:159]
s_waitcnt lgkmcnt(3)
buffer_load_dwordx4 v1, s[8:11], s46 offen offset:0 sc1 lds
v_max3_f32 v26, v26, v91, v92
v_max3_f32 v26, v26, v93, v94
v_max_f32 v26, v26, v95
v_cmp_lt_f32 vcc, s54, v26
v_mfma_f32_32x32x16_bf16 a[128:143], a[76:79], v[100:103], a[128:143]
ds_read_b128 a[92:95], v2 offset:15360
s_cbranch_vccnz L_at_upb
L_at_uprb:
v_exp_f32 v64, v64
v_exp_f32 v65, v65
v_mfma_f32_32x32x16_bf16 a[144:159], a[76:79], v[108:111], a[144:159]
s_waitcnt lgkmcnt(3)
buffer_load_dwordx4 v1, s[8:11], s46 offen offset:1024 sc1 lds
v_exp_f32 v66, v66
v_add_f32 v22, v22, v64
v_add_f32 v22, v22, v65
v_mfma_f32_32x32x16_bf16 a[160:175], a[80:83], v[96:99], a[160:175]
ds_read_b128 a[64:67], v3 offset:0
v_exp_f32 v67, v67
v_cvt_pk_bf16_f32 v112, v64, v65
v_exp_f32 v68, v68
v_mfma_f32_32x32x16_bf16 a[176:191], a[80:83], v[104:107], a[176:191]
s_waitcnt lgkmcnt(3)
buffer_load_dwordx4 v1, s[8:11], s46 offen offset:2048 sc1 lds
v_add_f32 v22, v22, v66
v_add_f32 v22, v22, v67
v_exp_f32 v69, v69
v_cvt_pk_bf16_f32 v113, v66, v67
v_mfma_f32_32x32x16_bf16 a[160:175], a[84:87], v[100:103], a[160:175]
ds_read_b128 a[68:71], v3 offset:1024
v_exp_f32 v70, v70
v_add_f32 v22, v22, v68
v_add_f32 v22, v22, v69
v_mfma_f32_32x32x16_bf16 a[176:191], a[84:87], v[108:111], a[176:191]
s_waitcnt lgkmcnt(3)
buffer_load_dwordx4 v1, s[8:11], s46 offen offset:3072 sc1 lds
v_exp_f32 v71, v71
v_cvt_pk_bf16_f32 v114, v68, v69
v_exp_f32 v72, v72
v_mfma_f32_32x32x16_bf16 a[192:207], a[88:91], v[96:99], a[192:207]
ds_read_b128 a[72:75], v3 offset:2048
v_add_f32 v22, v22, v70
v_add_f32 v22, v22, v71
v_exp_f32 v73, v73
v_mfma_f32_32x32x16_bf16 a[208:223], a[88:91], v[104:107], a[208:223]
s_waitcnt lgkmcnt(3)
s_add_u32 m0, s47, 4096
v_cvt_pk_bf16_f32 v115, v70, v71
v_exp_f32 v74, v74
v_add_f32 v22, v22, v72
v_add_f32 v22, v22, v73
v_mfma_f32_32x32x16_bf16 a[192:207], a[92:95], v[100:103], a[192:207]
ds_read_b128 a[76:79], v3 offset:3072
v_exp_f32 v75, v75
v_cvt_pk_bf16_f32 v116, v72, v73
v_exp_f32 v76, v76
v_mfma_f32_32x32x16_bf16 a[208:223], a[92:95], v[108:111], a[208:223]
s_waitcnt lgkmcnt(3)
buffer_load_dwordx4 v1, s[8:11], s24 offen offset:0 sc1 lds
s_cmp_eq_u32 s48, 0
s_cbranch_scc0 L_at_rsb
L_at_rsrb:
v_add_f32 v22, v22, v74
v_add_f32 v22, v22, v75
v_exp_f32 v77, v77
v_mfma_f32_32x32x16_bf16 v[32:47], a[64:67], a[0:3], v[128:143]
ds_read_b128 a[80:83], v3 offset:4096
v_cvt_pk_bf16_f32 v117, v74, v75
v_exp_f32 v78, v78
v_add_f32 v22, v22, v76
v_mfma_f32_32x32x16_bf16 v[48:63], a[64:67], a[32:35], v[144:159]
s_waitcnt lgkmcnt(3)
buffer_load_dwordx4 v1, s[8:11], s24 offen offset:1024 sc1 lds
v_add_f32 v22, v22, v77
v_exp_f32 v79, v79
v_cvt_pk_bf16_f32 v118, v76, v77
v_mfma_f32_32x32x16_bf16 v[32:47], a[68:71], a[4:7], v[32:47]
ds_read_b128 a[84:87], v3 offset:5120
v_exp_f32 v80, v80
v_add_f32 v22, v22, v78
v_add_f32 v22, v22, v79
v_exp_f32 v81, v81
v_mfma_f32_32x32x16_bf16 v[48:63], a[68:71], a[36:39], v[48:63]
s_waitcnt lgkmcnt(3)
buffer_load_dwordx4 v1, s[8:11], s24 offen offset:2048 sc1 lds
v_cvt_pk_bf16_f32 v119, v78, v79
v_exp_f32 v82, v82
v_mfma_f32_32x32x16_bf16 v[32:47], a[72:75], a[8:11], v[32:47]
ds_read_b128 a[88:91], v3 offset:6144
v_add_f32 v23, v23, v80
v_add_f32 v23, v23, v81
v_exp_f32 v83, v83
v_cvt_pk_bf16_f32 v120, v80, v81
v_mfma_f32_32x32x16_bf16 v[48:63], a[72:75], a[40:43], v[48:63]
s_waitcnt lgkmcnt(3)
buffer_load_dwordx4 v1, s[8:11], s24 offen offset:3072 sc1 lds
v_exp_f32 v84, v84
v_add_f32 v23, v23, v82
v_add_f32 v23, v23, v83
v_mfma_f32_32x32x16_bf16 v[32:47], a[76:79], a[12:15], v[32:47]
ds_read_b128 a[92:95], v3 offset:7168
v_exp_f32 v85, v85
v_cvt_pk_bf16_f32 v121, v82, v83
v_exp_f32 v86, v86
v_mfma_f32_32x32x16_bf16 v[48:63], a[76:79], a[44:47], v[48:63]
s_waitcnt lgkmcnt(3)
s_add_u32 s46, s46, 32768
v_add_f32 v23, v23, v84
v_add_f32 v23, v23, v85
v_exp_f32 v87, v87
v_mfma_f32_32x32x16_bf16 v[32:47], a[80:83], a[16:19], v[32:47]
ds_read_b128 a[64:67], v2 offset:24576
v_cvt_pk_bf16_f32 v122, v84, v85
v_exp_f32 v88, v88
v_add_f32 v23, v23, v86
v_add_f32 v23, v23, v87
v_mfma_f32_32x32x16_bf16 v[48:63], a[80:83], a[48:51], v[48:63]
s_waitcnt lgkmcnt(3)
s_add_u32 s47, s47, 32768
v_exp_f32 v89, v89
v_cvt_pk_bf16_f32 v123, v86, v87
v_exp_f32 v90, v90
v_mfma_f32_32x32x16_bf16 v[32:47], a[84:87], a[20:23], v[32:47]
ds_read_b128 a[68:71], v2 offset:25600
v_add_f32 v23, v23, v88
v_add_f32 v23, v23, v89
v_exp_f32 v91, v91
v_mfma_f32_32x32x16_bf16 v[48:63], a[84:87], a[52:55], v[48:63]
s_waitcnt lgkmcnt(3)
s_and_b32 s47, s47, 131071
v_cvt_pk_bf16_f32 v124, v88, v89
v_exp_f32 v92, v92
v_add_f32 v23, v23, v90
v_mfma_f32_32x32x16_bf16 v[32:47], a[88:91], a[24:27], v[32:47]
ds_read_b128 a[72:75], v2 offset:26624
v_add_f32 v23, v23, v91
v_exp_f32 v93, v93
v_cvt_pk_bf16_f32 v125, v90, v91
v_mfma_f32_32x32x16_bf16 v[48:63], a[88:91], a[56:59], v[48:63]
s_waitcnt lgkmcnt(3)
s_add_u32 s43, s43, 1
v_exp_f32 v94, v94
v_add_f32 v23, v23, v92
v_add_f32 v23, v23, v93
v_exp_f32 v95, v95
v_mfma_f32_32x32x16_bf16 v[32:47], a[92:95], a[28:31], v[32:47]
ds_read_b128 a[76:79], v2 offset:27648
v_cvt_pk_bf16_f32 v126, v92, v93
v_add_f32 v23, v23, v94
v_add_f32 v23, v23, v95
v_cvt_pk_bf16_f32 v127, v94, v95
v_mfma_f32_32x32x16_bf16 v[48:63], a[92:95], a[60:63], v[48:63]
s_waitcnt lgkmcnt(3)
s_cmp_lt_u32 s43, s44
v_mov_b32 v4, v2
v_mov_b32 v2, v3
v_add_u32 v3, 32768, v3
v_and_b32 v3, 131071, v3
s_cbranch_scc1 L_at_loop
L_at_last:
v_mfma_f32_32x32x16_bf16 a[96:111], a[64:67], v[112:115], a[96:111]
ds_read_b128 a[80:83], v4 offset:28672
v_mfma_f32_32x32x16_bf16 a[112:127], a[64:67], v[120:123], a[112:127]
s_waitcnt lgkmcnt(3)
s_add_u32 s24, s43, 3
v_mfma_f32_32x32x16_bf16 a[96:111], a[68:71], v[116:119], a[96:111]
ds_read_b128 a[84:87], v4 offset:29696
v_mov_b32 v31, s50
v_cmp_le_i32 vcc, 0, v5
s_nop 1
v_cndmask_b32 v32, v31, v32, vcc
v_cmp_le_i32 vcc, 1, v5
v_mfma_f32_32x32x16_bf16 a[112:127], a[68:71], v[124:127], a[112:127]
s_waitcnt lgkmcnt(3)
s_cmp_lt_u32 s24, s45
s_cselect_b32 s46, s46, 536870912
v_cndmask_b32 v33, v31, v33, vcc
v_cmp_le_i32 vcc, 2, v5
s_nop 1
v_cndmask_b32 v34, v31, v34, vcc
v_cmp_le_i32 vcc, 3, v5
v_mfma_f32_32x32x16_bf16 a[128:143], a[72:75], v[112:115], a[128:143]
ds_read_b128 a[88:91], v4 offset:30720
v_cndmask_b32 v35, v31, v35, vcc
v_cmp_le_i32 vcc, 8, v5
s_nop 1
v_cndmask_b32 v36, v31, v36, vcc
v_cmp_le_i32 vcc, 9, v5
s_nop 1
v_cndmask_b32 v37, v31, v37, vcc
v_mfma_f32_32x32x16_bf16 a[144:159], a[72:75], v[120:123], a[144:159]
s_waitcnt lgkmcnt(3)
v_cmp_le_i32 vcc, 10, v5
s_nop 1
v_cndmask_b32 v38, v31, v38, vcc
v_cmp_le_i32 vcc, 11, v5
s_nop 1
v_cndmask_b32 v39, v31, v39, vcc
v_mfma_f32_32x32x16_bf16 a[128:143], a[76:79], v[116:119], a[128:143]
ds_read_b128 a[92:95], v4 offset:31744
v_cmp_le_i32 vcc, 16, v5
s_nop 1
v_cndmask_b32 v40, v31, v40, vcc
v_cmp_le_i32 vcc, 17, v5
s_nop 1
v_cndmask_b32 v41, v31, v41, vcc
v_mfma_f32_32x32x16_bf16 a[144:159], a[76:79], v[124:127], a[144:159]
s_waitcnt lgkmcnt(3)
v_cmp_le_i32 vcc, 18, v5
s_nop 1
v_cndmask_b32 v42, v31, v42, vcc
v_cmp_le_i32 vcc, 19, v5
s_nop 1
v_cndmask_b32 v43, v31, v43, vcc
v_mfma_f32_32x32x16_bf16 a[160:175], a[80:83], v[112:115], a[160:175]
ds_read_b128 a[64:67], v2 offset:16384
v_cmp_le_i32 vcc, 24, v5
s_nop 1
v_cndmask_b32 v44, v31, v44, vcc
v_cmp_le_i32 vcc, 25, v5
s_nop 1
v_cndmask_b32 v45, v31, v45, vcc
v_mfma_f32_32x32x16_bf16 a[176:191], a[80:83], v[120:123], a[176:191]
s_waitcnt lgkmcnt(3)
v_cmp_le_i32 vcc, 26, v5
s_nop 1
v_cndmask_b32 v46, v31, v46, vcc
v_cmp_le_i32 vcc, 27, v5
s_nop 1
v_cndmask_b32 v47, v31, v47, vcc
v_mfma_f32_32x32x16_bf16 a[160:175], a[84:87], v[116:119], a[160:175]
ds_read_b128 a[68:71], v2 offset:17408
v_max3_f32 v26, v32, v33, v34
v_max3_f32 v26, v26, v35, v36
v_max3_f32 v26, v26, v37, v38
v_max3_f32 v26, v26, v39, v40
v_max3_f32 v26, v26, v41, v42
v_mfma_f32_32x32x16_bf16 a[176:191], a[84:87], v[124:127], a[176:191]
s_waitcnt lgkmcnt(3)
v_max3_f32 v26, v26, v43, v44
v_max3_f32 v26, v26, v45, v46
v_max3_f32 v26, v26, v47, v48
v_max3_f32 v26, v26, v49, v50
v_mfma_f32_32x32x16_bf16 a[192:207], a[88:91], v[112:115], a[192:207]
ds_read_b128 a[72:75], v2 offset:18432
v_max3_f32 v26, v26, v51, v52
v_max3_f32 v26, v26, v53, v54
v_max3_f32 v26, v26, v55, v56
v_max3_f32 v26, v26, v57, v58
v_mfma_f32_32x32x16_bf16 a[208:223], a[88:91], v[120:123], a[208:223]
s_waitcnt lgkmcnt(3)
v_max3_f32 v26, v26, v59, v60
v_max3_f32 v26, v26, v61, v62
v_max_f32 v26, v26, v63
v_cmp_lt_f32 vcc, s54, v26
v_mfma_f32_32x32x16_bf16 a[192:207], a[92:95], v[116:119], a[192:207]
ds_read_b128 a[76:79], v2 offset:19456
s_cbranch_vccnz L_at_upc
L_at_uprc:
v_exp_f32 v32, v32
v_exp_f32 v33, v33
v_exp_f32 v34, v34
v_mfma_f32_32x32x16_bf16 a[208:223], a[92:95], v[124:127], a[208:223]
s_waitcnt lgkmcnt(3)
s_cmp_eq_u32 s48, 0
s_cbranch_scc0 L_at_rsc
L_at_rsrc:
v_add_f32 v22, v22, v32
v_add_f32 v22, v22, v33
v_exp_f32 v35, v35
v_cvt_pk_bf16_f32 v96, v32, v33
v_exp_f32 v36, v36
v_mfma_f32_32x32x16_bf16 v[64:79], a[64:67], a[0:3], v[128:143]
ds_read_b128 a[80:83], v2 offset:20480
v_add_f32 v22, v22, v34
v_add_f32 v22, v22, v35
v_exp_f32 v37, v37
v_cvt_pk_bf16_f32 v97, v34, v35
v_mfma_f32_32x32x16_bf16 v[80:95], a[64:67], a[32:35], v[144:159]
s_waitcnt lgkmcnt(3)
v_exp_f32 v38, v38
v_add_f32 v22, v22, v36
v_add_f32 v22, v22, v37
v_exp_f32 v39, v39
v_cvt_pk_bf16_f32 v98, v36, v37
v_mfma_f32_32x32x16_bf16 v[64:79], a[68:71], a[4:7], v[64:79]
ds_read_b128 a[84:87], v2 offset:21504
v_exp_f32 v40, v40
v_add_f32 v22, v22, v38
v_add_f32 v22, v22, v39
v_exp_f32 v41, v41
v_mfma_f32_32x32x16_bf16 v[80:95], a[68:71], a[36:39], v[80:95]
s_waitcnt lgkmcnt(3)
v_cvt_pk_bf16_f32 v99, v38, v39
v_exp_f32 v42, v42
v_add_f32 v22, v22, v40
v_add_f32 v22, v22, v41
v_exp_f32 v43, v43
v_mfma_f32_32x32x16_bf16 v[64:79], a[72:75], a[8:11], v[64:79]
ds_read_b128 a[88:91], v2 offset:22528
v_cvt_pk_bf16_f32 v100, v40, v41
v_exp_f32 v44, v44
v_add_f32 v22, v22, v42
v_add_f32 v22, v22, v43
v_mfma_f32_32x32x16_bf16 v[80:95], a[72:75], a[40:43], v[80:95]
s_waitcnt lgkmcnt(3)
v_exp_f32 v45, v45
v_cvt_pk_bf16_f32 v101, v42, v43
v_exp_f32 v46, v46
v_add_f32 v22, v22, v44
v_add_f32 v22, v22, v45
v_mfma_f32_32x32x16_bf16 v[64:79], a[76:79], a[12:15], v[64:79]
ds_read_b128 a[92:95], v2 offset:23552
v_exp_f32 v47, v47
v_cvt_pk_bf16_f32 v102, v44, v45
v_exp_f32 v48, v48
v_add_f32 v22, v22, v46
v_mfma_f32_32x32x16_bf16 v[80:95], a[76:79], a[44:47], v[80:95]
s_waitcnt lgkmcnt(3)
v_add_f32 v22, v22, v47
v_exp_f32 v49, v49
v_cvt_pk_bf16_f32 v103, v46, v47
v_exp_f32 v50, v50
v_mfma_f32_32x32x16_bf16 v[64:79], a[80:83], a[16:19], v[64:79]
ds_read_b128 a[64:67], v2 offset:8192
v_add_f32 v23, v23, v48
v_add_f32 v23, v23, v49
v_exp_f32 v51, v51
v_cvt_pk_bf16_f32 v104, v48, v49
v_exp_f32 v52, v52
v_mfma_f32_32x32x16_bf16 v[80:95], a[80:83], a[48:51], v[80:95]
s_waitcnt lgkmcnt(3)
v_add_f32 v23, v23, v50
v_add_f32 v23, v23, v51
v_exp_f32 v53, v53
v_cvt_pk_bf16_f32 v105, v50, v51
v_mfma_f32_32x32x16_bf16 v[64:79], a[84:87], a[20:23], v[64:79]
ds_read_b128 a[68:71], v2 offset:9216
v_exp_f32 v54, v54
v_add_f32 v23, v23, v52
v_add_f32 v23, v23, v53
v_exp_f32 v55, v55
v_cvt_pk_bf16_f32 v106, v52, v53
v_mfma_f32_32x32x16_bf16 v[80:95], a[84:87], a[52:55], v[80:95]
s_waitcnt lgkmcnt(3)
v_exp_f32 v56, v56
v_add_f32 v23, v23, v54
v_add_f32 v23, v23, v55
v_exp_f32 v57, v57
v_mfma_f32_32x32x16_bf16 v[64:79], a[88:91], a[24:27], v[64:79]
ds_read_b128 a[72:75], v2 offset:10240
v_cvt_pk_bf16_f32 v107, v54, v55
v_exp_f32 v58, v58
v_add_f32 v23, v23, v56
v_add_f32 v23, v23, v57
v_exp_f32 v59, v59
v_mfma_f32_32x32x16_bf16 v[80:95], a[88:91], a[56:59], v[80:95]
s_waitcnt lgkmcnt(3)
v_cvt_pk_bf16_f32 v108, v56, v57
v_exp_f32 v60, v60
v_add_f32 v23, v23, v58
v_add_f32 v23, v23, v59
v_mfma_f32_32x32x16_bf16 v[64:79], a[92:95], a[28:31], v[64:79]
ds_read_b128 a[76:79], v2 offset:11264
v_exp_f32 v61, v61
v_cvt_pk_bf16_f32 v109, v58, v59
v_exp_f32 v62, v62
v_add_f32 v23, v23, v60
v_add_f32 v23, v23, v61
v_mfma_f32_32x32x16_bf16 v[80:95], a[92:95], a[60:63], v[80:95]
s_waitcnt lgkmcnt(3)
v_exp_f32 v63, v63
v_cvt_pk_bf16_f32 v110, v60, v61
v_add_f32 v23, v23, v62
v_add_f32 v23, v23, v63
v_cvt_pk_bf16_f32 v111, v62, v63
s_waitcnt vmcnt(8)
s_barrier
v_mfma_f32_32x32x16_bf16 a[96:111], a[64:67], v[96:99], a[96:111]
ds_read_b128 a[80:83], v2 offset:12288
s_mov_b32 m0, s47
v_mfma_f32_32x32x16_bf16 a[112:127], a[64:67], v[104:107], a[112:127]
s_waitcnt lgkmcnt(3)
s_add_u32 s24, s46, 4096
v_mfma_f32_32x32x16_bf16 a[96:111], a[68:71], v[100:103], a[96:111]
ds_read_b128 a[84:87], v2 offset:13312
buffer_load_dwordx4 v1, s[8:11], s46 offen offset:0 sc1 lds
v_mov_b32 v31, s50
v_cmp_le_i32 vcc, 0, v5
s_nop 1
v_cndmask_b32 v80, v31, v80, vcc
v_cmp_le_i32 vcc, 1, v5
s_nop 1
v_cndmask_b32 v81, v31, v81, vcc
v_cmp_le_i32 vcc, 2, v5
v_mfma_f32_32x32x16_bf16 a[112:127], a[68:71], v[108:111], a[112:127]
s_waitcnt lgkmcnt(3)
buffer_load_dwordx4 v1, s[8:11], s46 offen offset:1024 sc1 lds
v_cndmask_b32 v82, v31, v82, vcc
v_cmp_le_i32 vcc, 3, v5
s_nop 1
v_cndmask_b32 v83, v31, v83, vcc
v_cmp_le_i32 vcc, 8, v5
s_nop 1
v_cndmask_b32 v84, v31, v84, vcc
v_mfma_f32_32x32x16_bf16 a[128:143], a[72:75], v[96:99], a[128:143]
ds_read_b128 a[88:91], v2 offset:14336
buffer_load_dwordx4 v1, s[8:11], s46 offen offset:2048 sc1 lds
v_cmp_le_i32 vcc, 9, v5
s_nop 1
v_cndmask_b32 v85, v31, v85, vcc
v_cmp_le_i32 vcc, 10, v5
s_nop 1
v_cndmask_b32 v86, v31, v86, vcc
v_cmp_le_i32 vcc, 11, v5
s_nop 1
v_cndmask_b32 v87, v31, v87, vcc
v_mfma_f32_32x32x16_bf16 a[144:159], a[72:75], v[104:107], a[144:159]
s_waitcnt lgkmcnt(3)
buffer_load_dwordx4 v1, s[8:11], s46 offen offset:3072 sc1 lds
v_cmp_le_i32 vcc, 16, v5
s_nop 1
v_cndmask_b32 v88, v31, v88, vcc
v_cmp_le_i32 vcc, 17, v5
s_nop 1
v_cndmask_b32 v89, v31, v89, vcc
v_cmp_le_i32 vcc, 18, v5
v_mfma_f32_32x32x16_bf16 a[128:143], a[76:79], v[100:103], a[128:143]
ds_read_b128 a[92:95], v2 offset:15360
s_add_u32 m0, s47, 4096
v_cndmask_b32 v90, v31, v90, vcc
v_cmp_le_i32 vcc, 19, v5
s_nop 1
v_cndmask_b32 v91, v31, v91, vcc
v_cmp_le_i32 vcc, 24, v5
s_nop 1
v_cndmask_b32 v92, v31, v92, vcc
v_cmp_le_i32 vcc, 25, v5
v_mfma_f32_32x32x16_bf16 a[144:159], a[76:79], v[108:111], a[144:159]
s_waitcnt lgkmcnt(3)
buffer_load_dwordx4 v1, s[8:11], s24 offen offset:0 sc1 lds
v_cndmask_b32 v93, v31, v93, vcc
v_cmp_le_i32 vcc, 26, v5
s_nop 1
v_cndmask_b32 v94, v31, v94, vcc
v_cmp_le_i32 vcc, 27, v5
s_nop 1
v_cndmask_b32 v95, v31, v95, vcc
v_mfma_f32_32x32x16_bf16 a[160:175], a[80:83], v[96:99], a[160:175]
ds_read_b128 a[64:67], v2 offset:24576
buffer_load_dwordx4 v1, s[8:11], s24 offen offset:1024 sc1 lds
v_mov_b32 v64, v31
v_mov_b32 v65, v31
v_mov_b32 v66, v31
v_mov_b32 v67, v31
v_mov_b32 v68, v31
v_mov_b32 v69, v31
v_mfma_f32_32x32x16_bf16 a[176:191], a[80:83], v[104:107], a[176:191]
s_waitcnt lgkmcnt(3)
buffer_load_dwordx4 v1, s[8:11], s24 offen offset:2048 sc1 lds
v_mov_b32 v70, v31
v_mov_b32 v71, v31
v_mov_b32 v72, v31
v_mov_b32 v73, v31
v_mov_b32 v74, v31
v_mfma_f32_32x32x16_bf16 a[160:175], a[84:87], v[100:103], a[160:175]
ds_read_b128 a[68:71], v2 offset:25600
buffer_load_dwordx4 v1, s[8:11], s24 offen offset:3072 sc1 lds
v_mov_b32 v75, v31
v_mov_b32 v76, v31
v_mov_b32 v77, v31
v_mov_b32 v78, v31
v_mov_b32 v79, v31
v_max3_f32 v26, v64, v65, v66
v_mfma_f32_32x32x16_bf16 a[176:191], a[84:87], v[108:111], a[176:191]
s_waitcnt lgkmcnt(3)
s_add_u32 s46, s46, 32768
v_max3_f32 v26, v26, v67, v68
v_max3_f32 v26, v26, v69, v70
v_max3_f32 v26, v26, v71, v72
v_max3_f32 v26, v26, v73, v74
v_max3_f32 v26, v26, v75, v76
v_mfma_f32_32x32x16_bf16 a[192:207], a[88:91], v[96:99], a[192:207]
ds_read_b128 a[72:75], v2 offset:26624
s_add_u32 s47, s47, 32768
v_max3_f32 v26, v26, v77, v78
v_max3_f32 v26, v26, v79, v80
v_max3_f32 v26, v26, v81, v82
v_max3_f32 v26, v26, v83, v84
v_max3_f32 v26, v26, v85, v86
v_max3_f32 v26, v26, v87, v88
v_mfma_f32_32x32x16_bf16 a[208:223], a[88:91], v[104:107], a[208:223]
s_waitcnt lgkmcnt(3)
s_and_b32 s47, s47, 131071
v_max3_f32 v26, v26, v89, v90
v_max3_f32 v26, v26, v91, v92
v_max3_f32 v26, v26, v93, v94
v_max_f32 v26, v26, v95
v_cmp_lt_f32 vcc, s54, v26
v_mfma_f32_32x32x16_bf16 a[192:207], a[92:95], v[100:103], a[192:207]
ds_read_b128 a[76:79], v2 offset:27648
s_cbranch_vccnz L_at_upd
L_at_uprd:
v_exp_f32 v64, v64
v_exp_f32 v65, v65
v_exp_f32 v66, v66
v_add_f32 v22, v22, v64
v_add_f32 v22, v22, v65
v_exp_f32 v67, v67
v_cvt_pk_bf16_f32 v112, v64, v65
v_exp_f32 v68, v68
v_add_f32 v22, v22, v66
v_add_f32 v22, v22, v67
v_exp_f32 v69, v69
v_cvt_pk_bf16_f32 v113, v66, v67
v_exp_f32 v70, v70
v_add_f32 v22, v22, v68
v_add_f32 v22, v22, v69
v_exp_f32 v71, v71
v_cvt_pk_bf16_f32 v114, v68, v69
v_exp_f32 v72, v72
v_add_f32 v22, v22, v70
v_add_f32 v22, v22, v71
v_exp_f32 v73, v73
v_cvt_pk_bf16_f32 v115, v70, v71
v_exp_f32 v74, v74
v_add_f32 v22, v22, v72
v_add_f32 v22, v22, v73
v_exp_f32 v75, v75
v_cvt_pk_bf16_f32 v116, v72, v73
v_exp_f32 v76, v76
v_add_f32 v22, v22, v74
v_add_f32 v22, v22, v75
v_exp_f32 v77, v77
v_cvt_pk_bf16_f32 v117, v74, v75
v_exp_f32 v78, v78
v_add_f32 v22, v22, v76
v_add_f32 v22, v22, v77
v_exp_f32 v79, v79
v_cvt_pk_bf16_f32 v118, v76, v77
v_exp_f32 v80, v80
v_add_f32 v22, v22, v78
v_mfma_f32_32x32x16_bf16 a[208:223], a[92:95], v[108:111], a[208:223]
s_waitcnt lgkmcnt(3)
s_cmp_eq_u32 s48, 0
s_cbranch_scc0 L_at_rsd
L_at_rsrd:
v_add_f32 v22, v22, v79
v_exp_f32 v81, v81
v_cvt_pk_bf16_f32 v119, v78, v79
v_exp_f32 v82, v82
v_add_f32 v23, v23, v80
v_add_f32 v23, v23, v81
v_exp_f32 v83, v83
v_cvt_pk_bf16_f32 v120, v80, v81
v_exp_f32 v84, v84
v_add_f32 v23, v23, v82
v_add_f32 v23, v23, v83
v_exp_f32 v85, v85
v_cvt_pk_bf16_f32 v121, v82, v83
v_exp_f32 v86, v86
v_add_f32 v23, v23, v84
v_add_f32 v23, v23, v85
v_exp_f32 v87, v87
v_cvt_pk_bf16_f32 v122, v84, v85
v_exp_f32 v88, v88
v_add_f32 v23, v23, v86
v_add_f32 v23, v23, v87
v_exp_f32 v89, v89
v_cvt_pk_bf16_f32 v123, v86, v87
v_exp_f32 v90, v90
v_add_f32 v23, v23, v88
v_add_f32 v23, v23, v89
v_exp_f32 v91, v91
v_cvt_pk_bf16_f32 v124, v88, v89
v_exp_f32 v92, v92
v_add_f32 v23, v23, v90
v_add_f32 v23, v23, v91
v_exp_f32 v93, v93
v_cvt_pk_bf16_f32 v125, v90, v91
v_exp_f32 v94, v94
v_add_f32 v23, v23, v92
v_add_f32 v23, v23, v93
v_exp_f32 v95, v95
v_cvt_pk_bf16_f32 v126, v92, v93
v_add_f32 v23, v23, v94
v_add_f32 v23, v23, v95
v_cvt_pk_bf16_f32 v127, v94, v95
v_mfma_f32_32x32x16_bf16 a[96:111], a[64:67], v[112:115], a[96:111]
ds_read_b128 a[80:83], v2 offset:28672
v_mfma_f32_32x32x16_bf16 a[112:127], a[64:67], v[120:123], a[112:127]
s_waitcnt lgkmcnt(3)
v_mfma_f32_32x32x16_bf16 a[96:111], a[68:71], v[116:119], a[96:111]
ds_read_b128 a[84:87], v2 offset:29696
v_mfma_f32_32x32x16_bf16 a[112:127], a[68:71], v[124:127], a[112:127]
s_waitcnt lgkmcnt(3)
v_mfma_f32_32x32x16_bf16 a[128:143], a[72:75], v[112:115], a[128:143]
ds_read_b128 a[88:91], v2 offset:30720
v_mfma_f32_32x32x16_bf16 a[144:159], a[72:75], v[120:123], a[144:159]
s_waitcnt lgkmcnt(3)
v_mfma_f32_32x32x16_bf16 a[128:143], a[76:79], v[116:119], a[128:143]
ds_read_b128 a[92:95], v2 offset:31744
v_mfma_f32_32x32x16_bf16 a[144:159], a[76:79], v[124:127], a[144:159]
s_waitcnt lgkmcnt(3)
v_mfma_f32_32x32x16_bf16 a[160:175], a[80:83], v[112:115], a[160:175]
v_mfma_f32_32x32x16_bf16 a[176:191], a[80:83], v[120:123], a[176:191]
s_waitcnt lgkmcnt(2)
v_mfma_f32_32x32x16_bf16 a[160:175], a[84:87], v[116:119], a[160:175]
v_mfma_f32_32x32x16_bf16 a[176:191], a[84:87], v[124:127], a[176:191]
s_waitcnt lgkmcnt(1)
v_mfma_f32_32x32x16_bf16 a[192:207], a[88:91], v[112:115], a[192:207]
v_mfma_f32_32x32x16_bf16 a[208:223], a[88:91], v[120:123], a[208:223]
s_waitcnt lgkmcnt(0)
v_mfma_f32_32x32x16_bf16 a[192:207], a[92:95], v[116:119], a[192:207]
v_mfma_f32_32x32x16_bf16 a[208:223], a[92:95], v[124:127], a[208:223]
s_lshl_b32 s26, s44, 19
s_lshl_b32 s27, s42, 12
s_add_u32 s26, s26, s27
s_add_u32 s26, s26, 67108864
s_add_u32 s27, s26, 262144
L_at_idle:
s_add_u32 s43, s43, 1
s_cmp_ge_u32 s43, s45
s_cbranch_scc1 L_at_fin
s_waitcnt vmcnt(0)
s_barrier
s_branch L_at_idle
L_at_upa:
v_max3_f32 v26, v32, v33, v34
v_max3_f32 v26, v26, v35, v36
v_max3_f32 v26, v26, v37, v38
v_max3_f32 v26, v26, v39, v40
v_max3_f32 v26, v26, v41, v42
v_max3_f32 v26, v26, v43, v44
v_max3_f32 v26, v26, v45, v46
v_max_f32 v26, v26, v47
v_mov_b32 v27, v26
s_nop 1
v_permlane32_swap_b32 v27, v26
v_max3_f32 v26, v26, v27, s55
v_exp_f32 v24, -v26
v_sub_f32 v32, v32, v26
v_sub_f32 v128, v128, v26
v_sub_f32 v33, v33, v26
v_sub_f32 v129, v129, v26
v_sub_f32 v34, v34, v26
v_sub_f32 v130, v130, v26
v_sub_f32 v35, v35, v26
v_sub_f32 v131, v131, v26
v_sub_f32 v36, v36, v26
v_sub_f32 v132, v132, v26
v_sub_f32 v37, v37, v26
v_sub_f32 v133, v133, v26
v_sub_f32 v38, v38, v26
v_sub_f32 v134, v134, v26
v_sub_f32 v39, v39, v26
v_sub_f32 v135, v135, v26
v_sub_f32 v40, v40, v26
v_sub_f32 v136, v136, v26
v_sub_f32 v41, v41, v26
v_sub_f32 v137, v137, v26
v_sub_f32 v42, v42, v26
v_sub_f32 v138, v138, v26
v_sub_f32 v43, v43, v26
v_sub_f32 v139, v139, v26
v_sub_f32 v44, v44, v26
v_sub_f32 v140, v140, v26
v_sub_f32 v45, v45, v26
v_sub_f32 v141, v141, v26
v_sub_f32 v46, v46, v26
v_sub_f32 v142, v142, v26
v_sub_f32 v47, v47, v26
v_sub_f32 v143, v143, v26
v_min_f32 v24, 1.0, v24
v_mul_f32 v22, v22, v24
v_max3_f32 v26, v48, v49, v50
v_max3_f32 v26, v26, v51, v52
v_max3_f32 v26, v26, v53, v54
v_max3_f32 v26, v26, v55, v56
v_max3_f32 v26, v26, v57, v58
v_max3_f32 v26, v26, v59, v60
v_max3_f32 v26, v26, v61, v62
v_max_f32 v26, v26, v63
v_mov_b32 v27, v26
s_nop 1
v_permlane32_swap_b32 v27, v26
v_max3_f32 v26, v26, v27, s55
v_exp_f32 v25, -v26
v_sub_f32 v48, v48, v26
v_sub_f32 v144, v144, v26
v_sub_f32 v49, v49, v26
v_sub_f32 v145, v145, v26
v_sub_f32 v50, v50, v26
v_sub_f32 v146, v146, v26
v_sub_f32 v51, v51, v26
v_sub_f32 v147, v147, v26
v_sub_f32 v52, v52, v26
v_sub_f32 v148, v148, v26
v_sub_f32 v53, v53, v26
v_sub_f32 v149, v149, v26
v_sub_f32 v54, v54, v26
v_sub_f32 v150, v150, v26
v_sub_f32 v55, v55, v26
v_sub_f32 v151, v151, v26
v_sub_f32 v56, v56, v26
v_sub_f32 v152, v152, v26
v_sub_f32 v57, v57, v26
v_sub_f32 v153, v153, v26
v_sub_f32 v58, v58, v26
v_sub_f32 v154, v154, v26
v_sub_f32 v59, v59, v26
v_sub_f32 v155, v155, v26
v_sub_f32 v60, v60, v26
v_sub_f32 v156, v156, v26
v_sub_f32 v61, v61, v26
v_sub_f32 v157, v157, v26
v_sub_f32 v62, v62, v26
v_sub_f32 v158, v158, v26
v_sub_f32 v63, v63, v26
v_sub_f32 v159, v159, v26
v_min_f32 v25, 1.0, v25
v_mul_f32 v23, v23, v25
s_cmp_eq_u32 s55, 0
s_cselect_b32 s48, 1, 0
s_mov_b32 s55, 0
s_mov_b32 s54, s51
s_branch L_at_upra
L_at_rsa:
s_getpc_b64 s[52:53]
s_add_u32 s52, s52, 12
s_addc_u32 s53, s53, 0
s_branch L_at_rescale
s_branch L_at_rsra
L_at_upb:
v_max3_f32 v26, v64, v65, v66
v_max3_f32 v26, v26, v67, v68
v_max3_f32 v26, v26, v69, v70
v_max3_f32 v26, v26, v71, v72
v_max3_f32 v26, v26, v73, v74
v_max3_f32 v26, v26, v75, v76
v_max3_f32 v26, v26, v77, v78
v_max_f32 v26, v26, v79
v_mov_b32 v27, v26
s_nop 1
v_permlane32_swap_b32 v27, v26
v_max3_f32 v26, v26, v27, s55
v_exp_f32 v24, -v26
v_sub_f32 v64, v64, v26
v_sub_f32 v128, v128, v26
v_sub_f32 v65, v65, v26
v_sub_f32 v129, v129, v26
v_sub_f32 v66, v66, v26
v_sub_f32 v130, v130, v26
v_sub_f32 v67, v67, v26
v_sub_f32 v131, v131, v26
v_sub_f32 v68, v68, v26
v_sub_f32 v132, v132, v26
v_sub_f32 v69, v69, v26
v_sub_f32 v133, v133, v26
v_sub_f32 v70, v70, v26
v_sub_f32 v134, v134, v26
v_sub_f32 v71, v71, v26
v_sub_f32 v135, v135, v26
v_sub_f32 v72, v72, v26
v_sub_f32 v136, v136, v26
v_sub_f32 v73, v73, v26
v_sub_f32 v137, v137, v26
v_sub_f32 v74, v74, v26
v_sub_f32 v138, v138, v26
v_sub_f32 v75, v75, v26
v_sub_f32 v139, v139, v26
v_sub_f32 v76, v76, v26
v_sub_f32 v140, v140, v26
v_sub_f32 v77, v77, v26
v_sub_f32 v141, v141, v26
v_sub_f32 v78, v78, v26
v_sub_f32 v142, v142, v26
v_sub_f32 v79, v79, v26
v_sub_f32 v143, v143, v26
v_min_f32 v24, 1.0, v24
v_mul_f32 v22, v22, v24
v_max3_f32 v26, v80, v81, v82
v_max3_f32 v26, v26, v83, v84
v_max3_f32 v26, v26, v85, v86
v_max3_f32 v26, v26, v87, v88
v_max3_f32 v26, v26, v89, v90
v_max3_f32 v26, v26, v91, v92
v_max3_f32 v26, v26, v93, v94
v_max_f32 v26, v26, v95
v_mov_b32 v27, v26
s_nop 1
v_permlane32_swap_b32 v27, v26
v_max3_f32 v26, v26, v27, s55
v_exp_f32 v25, -v26
v_sub_f32 v80, v80, v26
v_sub_f32 v144, v144, v26
v_sub_f32 v81, v81, v26
v_sub_f32 v145, v145, v26
v_sub_f32 v82, v82, v26
v_sub_f32 v146, v146, v26
v_sub_f32 v83, v83, v26
v_sub_f32 v147, v147, v26
v_sub_f32 v84, v84, v26
v_sub_f32 v148, v148, v26
v_sub_f32 v85, v85, v26
v_sub_f32 v149, v149, v26
v_sub_f32 v86, v86, v26
v_sub_f32 v150, v150, v26
v_sub_f32 v87, v87, v26
v_sub_f32 v151, v151, v26
v_sub_f32 v88, v88, v26
v_sub_f32 v152, v152, v26
v_sub_f32 v89, v89, v26
v_sub_f32 v153, v153, v26
v_sub_f32 v90, v90, v26
v_sub_f32 v154, v154, v26
v_sub_f32 v91, v91, v26
v_sub_f32 v155, v155, v26
v_sub_f32 v92, v92, v26
v_sub_f32 v156, v156, v26
v_sub_f32 v93, v93, v26
v_sub_f32 v157, v157, v26
v_sub_f32 v94, v94, v26
v_sub_f32 v158, v158, v26
v_sub_f32 v95, v95, v26
v_sub_f32 v159, v159, v26
v_min_f32 v25, 1.0, v25
v_mul_f32 v23, v23, v25
s_cmp_eq_u32 s55, 0
s_cselect_b32 s48, 1, 0
s_mov_b32 s55, 0
s_mov_b32 s54, s51
s_branch L_at_uprb
L_at_rsb:
s_getpc_b64 s[52:53]
s_add_u32 s52, s52, 12
s_addc_u32 s53, s53, 0
s_branch L_at_rescale
s_branch L_at_rsrb
L_at_upc:
v_max3_f32 v26, v32, v33, v34
v_max3_f32 v26, v26, v35, v36
v_max3_f32 v26, v26, v37, v38
v_max3_f32 v26, v26, v39, v40
v_max3_f32 v26, v26, v41, v42
v_max3_f32 v26, v26, v43, v44
v_max3_f32 v26, v26, v45, v46
v_max_f32 v26, v26, v47
v_mov_b32 v27, v26
s_nop 1
v_permlane32_swap_b32 v27, v26
v_max3_f32 v26, v26, v27, s55
v_exp_f32 v24, -v26
v_sub_f32 v32, v32, v26
v_sub_f32 v128, v128, v26
v_sub_f32 v33, v33, v26
v_sub_f32 v129, v129, v26
v_sub_f32 v34, v34, v26
v_sub_f32 v130, v130, v26
v_sub_f32 v35, v35, v26
v_sub_f32 v131, v131, v26
v_sub_f32 v36, v36, v26
v_sub_f32 v132, v132, v26
v_sub_f32 v37, v37, v26
v_sub_f32 v133, v133, v26
v_sub_f32 v38, v38, v26
v_sub_f32 v134, v134, v26
v_sub_f32 v39, v39, v26
v_sub_f32 v135, v135, v26
v_sub_f32 v40, v40, v26
v_sub_f32 v136, v136, v26
v_sub_f32 v41, v41, v26
v_sub_f32 v137, v137, v26
v_sub_f32 v42, v42, v26
v_sub_f32 v138, v138, v26
v_sub_f32 v43, v43, v26
v_sub_f32 v139, v139, v26
v_sub_f32 v44, v44, v26
v_sub_f32 v140, v140, v26
v_sub_f32 v45, v45, v26
v_sub_f32 v141, v141, v26
v_sub_f32 v46, v46, v26
v_sub_f32 v142, v142, v26
v_sub_f32 v47, v47, v26
v_sub_f32 v143, v143, v26
v_min_f32 v24, 1.0, v24
v_mul_f32 v22, v22, v24
v_max3_f32 v26, v48, v49, v50
v_max3_f32 v26, v26, v51, v52
v_max3_f32 v26, v26, v53, v54
v_max3_f32 v26, v26, v55, v56
v_max3_f32 v26, v26, v57, v58
v_max3_f32 v26, v26, v59, v60
v_max3_f32 v26, v26, v61, v62
v_max_f32 v26, v26, v63
v_mov_b32 v27, v26
s_nop 1
v_permlane32_swap_b32 v27, v26
v_max3_f32 v26, v26, v27, s55
v_exp_f32 v25, -v26
v_sub_f32 v48, v48, v26
v_sub_f32 v144, v144, v26
v_sub_f32 v49, v49, v26
v_sub_f32 v145, v145, v26
v_sub_f32 v50, v50, v26
v_sub_f32 v146, v146, v26
v_sub_f32 v51, v51, v26
v_sub_f32 v147, v147, v26
v_sub_f32 v52, v52, v26
v_sub_f32 v148, v148, v26
v_sub_f32 v53, v53, v26
v_sub_f32 v149, v149, v26
v_sub_f32 v54, v54, v26
v_sub_f32 v150, v150, v26
v_sub_f32 v55, v55, v26
v_sub_f32 v151, v151, v26
v_sub_f32 v56, v56, v26
v_sub_f32 v152, v152, v26
v_sub_f32 v57, v57, v26
v_sub_f32 v153, v153, v26
v_sub_f32 v58, v58, v26
v_sub_f32 v154, v154, v26
v_sub_f32 v59, v59, v26
v_sub_f32 v155, v155, v26
v_sub_f32 v60, v60, v26
v_sub_f32 v156, v156, v26
v_sub_f32 v61, v61, v26
v_sub_f32 v157, v157, v26
v_sub_f32 v62, v62, v26
v_sub_f32 v158, v158, v26
v_sub_f32 v63, v63, v26
v_sub_f32 v159, v159, v26
v_min_f32 v25, 1.0, v25
v_mul_f32 v23, v23, v25
s_cmp_eq_u32 s55, 0
s_cselect_b32 s48, 1, 0
s_mov_b32 s55, 0
s_mov_b32 s54, s51
s_branch L_at_uprc
L_at_rsc:
s_getpc_b64 s[52:53]
s_add_u32 s52, s52, 12
s_addc_u32 s53, s53, 0
s_branch L_at_rescale
s_branch L_at_rsrc
L_at_upd:
v_max3_f32 v26, v64, v65, v66
v_max3_f32 v26, v26, v67, v68
v_max3_f32 v26, v26, v69, v70
v_max3_f32 v26, v26, v71, v72
v_max3_f32 v26, v26, v73, v74
v_max3_f32 v26, v26, v75, v76
v_max3_f32 v26, v26, v77, v78
v_max_f32 v26, v26, v79
v_mov_b32 v27, v26
s_nop 1
v_permlane32_swap_b32 v27, v26
v_max3_f32 v26, v26, v27, s55
v_exp_f32 v24, -v26
v_sub_f32 v64, v64, v26
v_sub_f32 v128, v128, v26
v_sub_f32 v65, v65, v26
v_sub_f32 v129, v129, v26
v_sub_f32 v66, v66, v26
v_sub_f32 v130, v130, v26
v_sub_f32 v67, v67, v26
v_sub_f32 v131, v131, v26
v_sub_f32 v68, v68, v26
v_sub_f32 v132, v132, v26
v_sub_f32 v69, v69, v26
v_sub_f32 v133, v133, v26
v_sub_f32 v70, v70, v26
v_sub_f32 v134, v134, v26
v_sub_f32 v71, v71, v26
v_sub_f32 v135, v135, v26
v_sub_f32 v72, v72, v26
v_sub_f32 v136, v136, v26
v_sub_f32 v73, v73, v26
v_sub_f32 v137, v137, v26
v_sub_f32 v74, v74, v26
v_sub_f32 v138, v138, v26
v_sub_f32 v75, v75, v26
v_sub_f32 v139, v139, v26
v_sub_f32 v76, v76, v26
v_sub_f32 v140, v140, v26
v_sub_f32 v77, v77, v26
v_sub_f32 v141, v141, v26
v_sub_f32 v78, v78, v26
v_sub_f32 v142, v142, v26
v_sub_f32 v79, v79, v26
v_sub_f32 v143, v143, v26
v_min_f32 v24, 1.0, v24
v_mul_f32 v22, v22, v24
v_max3_f32 v26, v80, v81, v82
v_max3_f32 v26, v26, v83, v84
v_max3_f32 v26, v26, v85, v86
v_max3_f32 v26, v26, v87, v88
v_max3_f32 v26, v26, v89, v90
v_max3_f32 v26, v26, v91, v92
v_max3_f32 v26, v26, v93, v94
v_max_f32 v26, v26, v95
v_mov_b32 v27, v26
s_nop 1
v_permlane32_swap_b32 v27, v26
v_max3_f32 v26, v26, v27, s55
v_exp_f32 v25, -v26
v_sub_f32 v80, v80, v26
v_sub_f32 v144, v144, v26
v_sub_f32 v81, v81, v26
v_sub_f32 v145, v145, v26
v_sub_f32 v82, v82, v26
v_sub_f32 v146, v146, v26
v_sub_f32 v83, v83, v26
v_sub_f32 v147, v147, v26
v_sub_f32 v84, v84, v26
v_sub_f32 v148, v148, v26
v_sub_f32 v85, v85, v26
v_sub_f32 v149, v149, v26
v_sub_f32 v86, v86, v26
v_sub_f32 v150, v150, v26
v_sub_f32 v87, v87, v26
v_sub_f32 v151, v151, v26
v_sub_f32 v88, v88, v26
v_sub_f32 v152, v152, v26
v_sub_f32 v89, v89, v26
v_sub_f32 v153, v153, v26
v_sub_f32 v90, v90, v26
v_sub_f32 v154, v154, v26
v_sub_f32 v91, v91, v26
v_sub_f32 v155, v155, v26
v_sub_f32 v92, v92, v26
v_sub_f32 v156, v156, v26
v_sub_f32 v93, v93, v26
v_sub_f32 v157, v157, v26
v_sub_f32 v94, v94, v26
v_sub_f32 v158, v158, v26
v_sub_f32 v95, v95, v26
v_sub_f32 v159, v159, v26
v_min_f32 v25, 1.0, v25
v_mul_f32 v23, v23, v25
s_cmp_eq_u32 s55, 0
s_cselect_b32 s48, 1, 0
s_mov_b32 s55, 0
s_mov_b32 s54, s51
s_branch L_at_uprd
L_at_rsd:
s_getpc_b64 s[52:53]
s_add_u32 s52, s52, 12
s_addc_u32 s53, s53, 0
s_branch L_at_rescale
s_branch L_at_rsrd
L_at_rescale:
s_nop 7
s_nop 3
v_accvgpr_read_b32 v160, a96
v_accvgpr_read_b32 v161, a97
v_accvgpr_read_b32 v162, a98
v_accvgpr_read_b32 v163, a99
v_accvgpr_read_b32 v164, a100
v_accvgpr_read_b32 v165, a101
v_accvgpr_read_b32 v166, a102
v_accvgpr_read_b32 v167, a103
v_mul_f32 v160, v160, v24
v_mul_f32 v161, v161, v24
v_mul_f32 v162, v162, v24
v_mul_f32 v163, v163, v24
v_mul_f32 v164, v164, v24
v_mul_f32 v165, v165, v24
v_mul_f32 v166, v166, v24
v_mul_f32 v167, v167, v24
v_accvgpr_write_b32 a96, v160
v_accvgpr_write_b32 a97, v161
v_accvgpr_write_b32 a98, v162
v_accvgpr_write_b32 a99, v163
v_accvgpr_write_b32 a100, v164
v_accvgpr_write_b32 a101, v165
v_accvgpr_write_b32 a102, v166
v_accvgpr_write_b32 a103, v167
v_accvgpr_read_b32 v160, a104
v_accvgpr_read_b32 v161, a105
v_accvgpr_read_b32 v162, a106
v_accvgpr_read_b32 v163, a107
v_accvgpr_read_b32 v164, a108
v_accvgpr_read_b32 v165, a109
v_accvgpr_read_b32 v166, a110
v_accvgpr_read_b32 v167, a111
v_mul_f32 v160, v160, v24
v_mul_f32 v161, v161, v24
v_mul_f32 v162, v162, v24
v_mul_f32 v163, v163, v24
v_mul_f32 v164, v164, v24
v_mul_f32 v165, v165, v24
v_mul_f32 v166, v166, v24
v_mul_f32 v167, v167, v24
v_accvgpr_write_b32 a104, v160
v_accvgpr_write_b32 a105, v161
v_accvgpr_write_b32 a106, v162
v_accvgpr_write_b32 a107, v163
v_accvgpr_write_b32 a108, v164
v_accvgpr_write_b32 a109, v165
v_accvgpr_write_b32 a110, v166
v_accvgpr_write_b32 a111, v167
v_accvgpr_read_b32 v160, a112
v_accvgpr_read_b32 v161, a113
v_accvgpr_read_b32 v162, a114
v_accvgpr_read_b32 v163, a115
v_accvgpr_read_b32 v164, a116
v_accvgpr_read_b32 v165, a117
v_accvgpr_read_b32 v166, a118
v_accvgpr_read_b32 v167, a119
v_mul_f32 v160, v160, v25
v_mul_f32 v161, v161, v25
v_mul_f32 v162, v162, v25
v_mul_f32 v163, v163, v25
v_mul_f32 v164, v164, v25
v_mul_f32 v165, v165, v25
v_mul_f32 v166, v166, v25
v_mul_f32 v167, v167, v25
v_accvgpr_write_b32 a112, v160
v_accvgpr_write_b32 a113, v161
v_accvgpr_write_b32 a114, v162
v_accvgpr_write_b32 a115, v163
v_accvgpr_write_b32 a116, v164
v_accvgpr_write_b32 a117, v165
v_accvgpr_write_b32 a118, v166
v_accvgpr_write_b32 a119, v167
v_accvgpr_read_b32 v160, a120
v_accvgpr_read_b32 v161, a121
v_accvgpr_read_b32 v162, a122
v_accvgpr_read_b32 v163, a123
v_accvgpr_read_b32 v164, a124
v_accvgpr_read_b32 v165, a125
v_accvgpr_read_b32 v166, a126
v_accvgpr_read_b32 v167, a127
v_mul_f32 v160, v160, v25
v_mul_f32 v161, v161, v25
v_mul_f32 v162, v162, v25
v_mul_f32 v163, v163, v25
v_mul_f32 v164, v164, v25
v_mul_f32 v165, v165, v25
v_mul_f32 v166, v166, v25
v_mul_f32 v167, v167, v25
v_accvgpr_write_b32 a120, v160
v_accvgpr_write_b32 a121, v161
v_accvgpr_write_b32 a122, v162
v_accvgpr_write_b32 a123, v163
v_accvgpr_write_b32 a124, v164
v_accvgpr_write_b32 a125, v165
v_accvgpr_write_b32 a126, v166
v_accvgpr_write_b32 a127, v167
v_accvgpr_read_b32 v160, a128
v_accvgpr_read_b32 v161, a129
v_accvgpr_read_b32 v162, a130
v_accvgpr_read_b32 v163, a131
v_accvgpr_read_b32 v164, a132
v_accvgpr_read_b32 v165, a133
v_accvgpr_read_b32 v166, a134
v_accvgpr_read_b32 v167, a135
v_mul_f32 v160, v160, v24
v_mul_f32 v161, v161, v24
v_mul_f32 v162, v162, v24
v_mul_f32 v163, v163, v24
v_mul_f32 v164, v164, v24
v_mul_f32 v165, v165, v24
v_mul_f32 v166, v166, v24
v_mul_f32 v167, v167, v24
v_accvgpr_write_b32 a128, v160
v_accvgpr_write_b32 a129, v161
v_accvgpr_write_b32 a130, v162
v_accvgpr_write_b32 a131, v163
v_accvgpr_write_b32 a132, v164
v_accvgpr_write_b32 a133, v165
v_accvgpr_write_b32 a134, v166
v_accvgpr_write_b32 a135, v167
v_accvgpr_read_b32 v160, a136
v_accvgpr_read_b32 v161, a137
v_accvgpr_read_b32 v162, a138
v_accvgpr_read_b32 v163, a139
v_accvgpr_read_b32 v164, a140
v_accvgpr_read_b32 v165, a141
v_accvgpr_read_b32 v166, a142
v_accvgpr_read_b32 v167, a143
v_mul_f32 v160, v160, v24
v_mul_f32 v161, v161, v24
v_mul_f32 v162, v162, v24
v_mul_f32 v163, v163, v24
v_mul_f32 v164, v164, v24
v_mul_f32 v165, v165, v24
v_mul_f32 v166, v166, v24
v_mul_f32 v167, v167, v24
v_accvgpr_write_b32 a136, v160
v_accvgpr_write_b32 a137, v161
v_accvgpr_write_b32 a138, v162
v_accvgpr_write_b32 a139, v163
v_accvgpr_write_b32 a140, v164
v_accvgpr_write_b32 a141, v165
v_accvgpr_write_b32 a142, v166
v_accvgpr_write_b32 a143, v167
v_accvgpr_read_b32 v160, a144
v_accvgpr_read_b32 v161, a145
v_accvgpr_read_b32 v162, a146
v_accvgpr_read_b32 v163, a147
v_accvgpr_read_b32 v164, a148
v_accvgpr_read_b32 v165, a149
v_accvgpr_read_b32 v166, a150
v_accvgpr_read_b32 v167, a151
v_mul_f32 v160, v160, v25
v_mul_f32 v161, v161, v25
v_mul_f32 v162, v162, v25
v_mul_f32 v163, v163, v25
v_mul_f32 v164, v164, v25
v_mul_f32 v165, v165, v25
v_mul_f32 v166, v166, v25
v_mul_f32 v167, v167, v25
v_accvgpr_write_b32 a144, v160
v_accvgpr_write_b32 a145, v161
v_accvgpr_write_b32 a146, v162
v_accvgpr_write_b32 a147, v163
v_accvgpr_write_b32 a148, v164
v_accvgpr_write_b32 a149, v165
v_accvgpr_write_b32 a150, v166
v_accvgpr_write_b32 a151, v167
v_accvgpr_read_b32 v160, a152
v_accvgpr_read_b32 v161, a153
v_accvgpr_read_b32 v162, a154
v_accvgpr_read_b32 v163, a155
v_accvgpr_read_b32 v164, a156
v_accvgpr_read_b32 v165, a157
v_accvgpr_read_b32 v166, a158
v_accvgpr_read_b32 v167, a159
v_mul_f32 v160, v160, v25
v_mul_f32 v161, v161, v25
v_mul_f32 v162, v162, v25
v_mul_f32 v163, v163, v25
v_mul_f32 v164, v164, v25
v_mul_f32 v165, v165, v25
v_mul_f32 v166, v166, v25
v_mul_f32 v167, v167, v25
v_accvgpr_write_b32 a152, v160
v_accvgpr_write_b32 a153, v161
v_accvgpr_write_b32 a154, v162
v_accvgpr_write_b32 a155, v163
v_accvgpr_write_b32 a156, v164
v_accvgpr_write_b32 a157, v165
v_accvgpr_write_b32 a158, v166
v_accvgpr_write_b32 a159, v167
v_accvgpr_read_b32 v160, a160
v_accvgpr_read_b32 v161, a161
v_accvgpr_read_b32 v162, a162
v_accvgpr_read_b32 v163, a163
v_accvgpr_read_b32 v164, a164
v_accvgpr_read_b32 v165, a165
v_accvgpr_read_b32 v166, a166
v_accvgpr_read_b32 v167, a167
v_mul_f32 v160, v160, v24
v_mul_f32 v161, v161, v24
v_mul_f32 v162, v162, v24
v_mul_f32 v163, v163, v24
v_mul_f32 v164, v164, v24
v_mul_f32 v165, v165, v24
v_mul_f32 v166, v166, v24
v_mul_f32 v167, v167, v24
v_accvgpr_write_b32 a160, v160
v_accvgpr_write_b32 a161, v161
v_accvgpr_write_b32 a162, v162
v_accvgpr_write_b32 a163, v163
v_accvgpr_write_b32 a164, v164
v_accvgpr_write_b32 a165, v165
v_accvgpr_write_b32 a166, v166
v_accvgpr_write_b32 a167, v167
v_accvgpr_read_b32 v160, a168
v_accvgpr_read_b32 v161, a169
v_accvgpr_read_b32 v162, a170
v_accvgpr_read_b32 v163, a171
v_accvgpr_read_b32 v164, a172
v_accvgpr_read_b32 v165, a173
v_accvgpr_read_b32 v166, a174
v_accvgpr_read_b32 v167, a175
v_mul_f32 v160, v160, v24
v_mul_f32 v161, v161, v24
v_mul_f32 v162, v162, v24
v_mul_f32 v163, v163, v24
v_mul_f32 v164, v164, v24
v_mul_f32 v165, v165, v24
v_mul_f32 v166, v166, v24
v_mul_f32 v167, v167, v24
v_accvgpr_write_b32 a168, v160
v_accvgpr_write_b32 a169, v161
v_accvgpr_write_b32 a170, v162
v_accvgpr_write_b32 a171, v163
v_accvgpr_write_b32 a172, v164
v_accvgpr_write_b32 a173, v165
v_accvgpr_write_b32 a174, v166
v_accvgpr_write_b32 a175, v167
v_accvgpr_read_b32 v160, a176
v_accvgpr_read_b32 v161, a177
v_accvgpr_read_b32 v162, a178
v_accvgpr_read_b32 v163, a179
v_accvgpr_read_b32 v164, a180
v_accvgpr_read_b32 v165, a181
v_accvgpr_read_b32 v166, a182
v_accvgpr_read_b32 v167, a183
v_mul_f32 v160, v160, v25
v_mul_f32 v161, v161, v25
v_mul_f32 v162, v162, v25
v_mul_f32 v163, v163, v25
v_mul_f32 v164, v164, v25
v_mul_f32 v165, v165, v25
v_mul_f32 v166, v166, v25
v_mul_f32 v167, v167, v25
v_accvgpr_write_b32 a176, v160
v_accvgpr_write_b32 a177, v161
v_accvgpr_write_b32 a178, v162
v_accvgpr_write_b32 a179, v163
v_accvgpr_write_b32 a180, v164
v_accvgpr_write_b32 a181, v165
v_accvgpr_write_b32 a182, v166
v_accvgpr_write_b32 a183, v167
v_accvgpr_read_b32 v160, a184
v_accvgpr_read_b32 v161, a185
v_accvgpr_read_b32 v162, a186
v_accvgpr_read_b32 v163, a187
v_accvgpr_read_b32 v164, a188
v_accvgpr_read_b32 v165, a189
v_accvgpr_read_b32 v166, a190
v_accvgpr_read_b32 v167, a191
v_mul_f32 v160, v160, v25
v_mul_f32 v161, v161, v25
v_mul_f32 v162, v162, v25
v_mul_f32 v163, v163, v25
v_mul_f32 v164, v164, v25
v_mul_f32 v165, v165, v25
v_mul_f32 v166, v166, v25
v_mul_f32 v167, v167, v25
v_accvgpr_write_b32 a184, v160
v_accvgpr_write_b32 a185, v161
v_accvgpr_write_b32 a186, v162
v_accvgpr_write_b32 a187, v163
v_accvgpr_write_b32 a188, v164
v_accvgpr_write_b32 a189, v165
v_accvgpr_write_b32 a190, v166
v_accvgpr_write_b32 a191, v167
v_accvgpr_read_b32 v160, a192
v_accvgpr_read_b32 v161, a193
v_accvgpr_read_b32 v162, a194
v_accvgpr_read_b32 v163, a195
v_accvgpr_read_b32 v164, a196
v_accvgpr_read_b32 v165, a197
v_accvgpr_read_b32 v166, a198
v_accvgpr_read_b32 v167, a199
v_mul_f32 v160, v160, v24
v_mul_f32 v161, v161, v24
v_mul_f32 v162, v162, v24
v_mul_f32 v163, v163, v24
v_mul_f32 v164, v164, v24
v_mul_f32 v165, v165, v24
v_mul_f32 v166, v166, v24
v_mul_f32 v167, v167, v24
v_accvgpr_write_b32 a192, v160
v_accvgpr_write_b32 a193, v161
v_accvgpr_write_b32 a194, v162
v_accvgpr_write_b32 a195, v163
v_accvgpr_write_b32 a196, v164
v_accvgpr_write_b32 a197, v165
v_accvgpr_write_b32 a198, v166
v_accvgpr_write_b32 a199, v167
v_accvgpr_read_b32 v160, a200
v_accvgpr_read_b32 v161, a201
v_accvgpr_read_b32 v162, a202
v_accvgpr_read_b32 v163, a203
v_accvgpr_read_b32 v164, a204
v_accvgpr_read_b32 v165, a205
v_accvgpr_read_b32 v166, a206
v_accvgpr_read_b32 v167, a207
v_mul_f32 v160, v160, v24
v_mul_f32 v161, v161, v24
v_mul_f32 v162, v162, v24
v_mul_f32 v163, v163, v24
v_mul_f32 v164, v164, v24
v_mul_f32 v165, v165, v24
v_mul_f32 v166, v166, v24
v_mul_f32 v167, v167, v24
v_accvgpr_write_b32 a200, v160
v_accvgpr_write_b32 a201, v161
v_accvgpr_write_b32 a202, v162
v_accvgpr_write_b32 a203, v163
v_accvgpr_write_b32 a204, v164
v_accvgpr_write_b32 a205, v165
v_accvgpr_write_b32 a206, v166
v_accvgpr_write_b32 a207, v167
v_accvgpr_read_b32 v160, a208
v_accvgpr_read_b32 v161, a209
v_accvgpr_read_b32 v162, a210
v_accvgpr_read_b32 v163, a211
v_accvgpr_read_b32 v164, a212
v_accvgpr_read_b32 v165, a213
v_accvgpr_read_b32 v166, a214
v_accvgpr_read_b32 v167, a215
v_mul_f32 v160, v160, v25
v_mul_f32 v161, v161, v25
v_mul_f32 v162, v162, v25
v_mul_f32 v163, v163, v25
v_mul_f32 v164, v164, v25
v_mul_f32 v165, v165, v25
v_mul_f32 v166, v166, v25
v_mul_f32 v167, v167, v25
v_accvgpr_write_b32 a208, v160
v_accvgpr_write_b32 a209, v161
v_accvgpr_write_b32 a210, v162
v_accvgpr_write_b32 a211, v163
v_accvgpr_write_b32 a212, v164
v_accvgpr_write_b32 a213, v165
v_accvgpr_write_b32 a214, v166
v_accvgpr_write_b32 a215, v167
v_accvgpr_read_b32 v160, a216
v_accvgpr_read_b32 v161, a217
v_accvgpr_read_b32 v162, a218
v_accvgpr_read_b32 v163, a219
v_accvgpr_read_b32 v164, a220
v_accvgpr_read_b32 v165, a221
v_accvgpr_read_b32 v166, a222
v_accvgpr_read_b32 v167, a223
v_mul_f32 v160, v160, v25
v_mul_f32 v161, v161, v25
v_mul_f32 v162, v162, v25
v_mul_f32 v163, v163, v25
v_mul_f32 v164, v164, v25
v_mul_f32 v165, v165, v25
v_mul_f32 v166, v166, v25
v_mul_f32 v167, v167, v25
v_accvgpr_write_b32 a216, v160
v_accvgpr_write_b32 a217, v161
v_accvgpr_write_b32 a218, v162
v_accvgpr_write_b32 a219, v163
v_accvgpr_write_b32 a220, v164
v_accvgpr_write_b32 a221, v165
v_accvgpr_write_b32 a222, v166
v_accvgpr_write_b32 a223, v167
s_mov_b32 s48, 0
s_nop 1
s_setpc_b64 s[52:53]
L_at_fin:
v_accvgpr_read_b32 v128, a96
v_accvgpr_read_b32 v129, a97
v_accvgpr_read_b32 v130, a98
v_accvgpr_read_b32 v131, a99
v_accvgpr_read_b32 v132, a100
v_accvgpr_read_b32 v133, a101
v_accvgpr_read_b32 v134, a102
v_accvgpr_read_b32 v135, a103
v_accvgpr_read_b32 v136, a104
v_accvgpr_read_b32 v137, a105
v_accvgpr_read_b32 v138, a106
v_accvgpr_read_b32 v139, a107
v_accvgpr_read_b32 v140, a108
v_accvgpr_read_b32 v141, a109
v_accvgpr_read_b32 v142, a110
v_accvgpr_read_b32 v143, a111
v_accvgpr_read_b32 v144, a112
v_accvgpr_read_b32 v145, a113
v_accvgpr_read_b32 v146, a114
v_accvgpr_read_b32 v147, a115
v_accvgpr_read_b32 v148, a116
v_accvgpr_read_b32 v149, a117
v_accvgpr_read_b32 v150, a118
v_accvgpr_read_b32 v151, a119
v_accvgpr_read_b32 v152, a120
v_accvgpr_read_b32 v153, a121
v_accvgpr_read_b32 v154, a122
v_accvgpr_read_b32 v155, a123
v_accvgpr_read_b32 v156, a124
v_accvgpr_read_b32 v157, a125
v_accvgpr_read_b32 v158, a126
v_accvgpr_read_b32 v159, a127
v_accvgpr_read_b32 v160, a128
v_accvgpr_read_b32 v161, a129
v_accvgpr_read_b32 v162, a130
v_accvgpr_read_b32 v163, a131
v_accvgpr_read_b32 v164, a132
v_accvgpr_read_b32 v165, a133
v_accvgpr_read_b32 v166, a134
v_accvgpr_read_b32 v167, a135
v_accvgpr_read_b32 v168, a136
v_accvgpr_read_b32 v169, a137
v_accvgpr_read_b32 v170, a138
v_accvgpr_read_b32 v171, a139
v_accvgpr_read_b32 v172, a140
v_accvgpr_read_b32 v173, a141
v_accvgpr_read_b32 v174, a142
v_accvgpr_read_b32 v175, a143
v_accvgpr_read_b32 v176, a144
v_accvgpr_read_b32 v177, a145
v_accvgpr_read_b32 v178, a146
v_accvgpr_read_b32 v179, a147
v_accvgpr_read_b32 v180, a148
v_accvgpr_read_b32 v181, a149
v_accvgpr_read_b32 v182, a150
v_accvgpr_read_b32 v183, a151
v_accvgpr_read_b32 v184, a152
v_accvgpr_read_b32 v185, a153
v_accvgpr_read_b32 v186, a154
v_accvgpr_read_b32 v187, a155
v_accvgpr_read_b32 v188, a156
v_accvgpr_read_b32 v189, a157
v_accvgpr_read_b32 v190, a158
v_accvgpr_read_b32 v191, a159
v_accvgpr_read_b32 v192, a160
v_accvgpr_read_b32 v193, a161
v_accvgpr_read_b32 v194, a162
v_accvgpr_read_b32 v195, a163
v_accvgpr_read_b32 v196, a164
v_accvgpr_read_b32 v197, a165
v_accvgpr_read_b32 v198, a166
v_accvgpr_read_b32 v199, a167
v_accvgpr_read_b32 v200, a168
v_accvgpr_read_b32 v201, a169
v_accvgpr_read_b32 v202, a170
v_accvgpr_read_b32 v203, a171
v_accvgpr_read_b32 v204, a172
v_accvgpr_read_b32 v205, a173
v_accvgpr_read_b32 v206, a174
v_accvgpr_read_b32 v207, a175
v_accvgpr_read_b32 v208, a176
v_accvgpr_read_b32 v209, a177
v_accvgpr_read_b32 v210, a178
v_accvgpr_read_b32 v211, a179
v_accvgpr_read_b32 v212, a180
v_accvgpr_read_b32 v213, a181
v_accvgpr_read_b32 v214, a182
v_accvgpr_read_b32 v215, a183
v_accvgpr_read_b32 v216, a184
v_accvgpr_read_b32 v217, a185
v_accvgpr_read_b32 v218, a186
v_accvgpr_read_b32 v219, a187
v_accvgpr_read_b32 v220, a188
v_accvgpr_read_b32 v221, a189
v_accvgpr_read_b32 v222, a190
v_accvgpr_read_b32 v223, a191
v_accvgpr_read_b32 v224, a192
v_accvgpr_read_b32 v225, a193
v_accvgpr_read_b32 v226, a194
v_accvgpr_read_b32 v227, a195
v_accvgpr_read_b32 v228, a196
v_accvgpr_read_b32 v229, a197
v_accvgpr_read_b32 v230, a198
v_accvgpr_read_b32 v231, a199
v_accvgpr_read_b32 v232, a200
v_accvgpr_read_b32 v233, a201
v_accvgpr_read_b32 v234, a202
v_accvgpr_read_b32 v235, a203
v_accvgpr_read_b32 v236, a204
v_accvgpr_read_b32 v237, a205
v_accvgpr_read_b32 v238, a206
v_accvgpr_read_b32 v239, a207
v_accvgpr_read_b32 v240, a208
v_accvgpr_read_b32 v241, a209
v_accvgpr_read_b32 v242, a210
v_accvgpr_read_b32 v243, a211
v_accvgpr_read_b32 v244, a212
v_accvgpr_read_b32 v245, a213
v_accvgpr_read_b32 v246, a214
v_accvgpr_read_b32 v247, a215
v_accvgpr_read_b32 v248, a216
v_accvgpr_read_b32 v249, a217
v_accvgpr_read_b32 v250, a218
v_accvgpr_read_b32 v251, a219
v_accvgpr_read_b32 v252, a220
v_accvgpr_read_b32 v253, a221
v_accvgpr_read_b32 v254, a222
v_accvgpr_read_b32 v255, a223
v_mov_b32 v26, v22
s_nop 1
v_permlane32_swap_b32 v26, v22
v_add_f32 v26, v26, v22
v_rcp_f32 v26, v26
s_nop 0
v_pk_mul_f32 v[128:129], v[128:129], v[26:27] op_sel_hi:[1,0]
v_pk_mul_f32 v[130:131], v[130:131], v[26:27] op_sel_hi:[1,0]
v_pk_mul_f32 v[132:133], v[132:133], v[26:27] op_sel_hi:[1,0]
v_pk_mul_f32 v[134:135], v[134:135], v[26:27] op_sel_hi:[1,0]
v_pk_mul_f32 v[136:137], v[136:137], v[26:27] op_sel_hi:[1,0]
v_pk_mul_f32 v[138:139], v[138:139], v[26:27] op_sel_hi:[1,0]
v_pk_mul_f32 v[140:141], v[140:141], v[26:27] op_sel_hi:[1,0]
v_pk_mul_f32 v[142:143], v[142:143], v[26:27] op_sel_hi:[1,0]
v_cvt_pk_bf16_f32 v128, v128, v129
v_cvt_pk_bf16_f32 v129, v130, v131
v_cvt_pk_bf16_f32 v130, v132, v133
v_cvt_pk_bf16_f32 v131, v134, v135
buffer_store_dwordx4 v[128:131], v6, s[8:11], s26 offen offset:0 sc1
v_cvt_pk_bf16_f32 v136, v136, v137
v_cvt_pk_bf16_f32 v137, v138, v139
v_cvt_pk_bf16_f32 v138, v140, v141
v_cvt_pk_bf16_f32 v139, v142, v143
buffer_store_dwordx4 v[136:139], v6, s[8:11], s26 offen offset:512 sc1
v_pk_mul_f32 v[160:161], v[160:161], v[26:27] op_sel_hi:[1,0]
v_pk_mul_f32 v[162:163], v[162:163], v[26:27] op_sel_hi:[1,0]
v_pk_mul_f32 v[164:165], v[164:165], v[26:27] op_sel_hi:[1,0]
v_pk_mul_f32 v[166:167], v[166:167], v[26:27] op_sel_hi:[1,0]
v_pk_mul_f32 v[168:169], v[168:169], v[26:27] op_sel_hi:[1,0]
v_pk_mul_f32 v[170:171], v[170:171], v[26:27] op_sel_hi:[1,0]
v_pk_mul_f32 v[172:173], v[172:173], v[26:27] op_sel_hi:[1,0]
v_pk_mul_f32 v[174:175], v[174:175], v[26:27] op_sel_hi:[1,0]
v_cvt_pk_bf16_f32 v160, v160, v161
v_cvt_pk_bf16_f32 v161, v162, v163
v_cvt_pk_bf16_f32 v162, v164, v165
v_cvt_pk_bf16_f32 v163, v166, v167
buffer_store_dwordx4 v[160:163], v6, s[8:11], s26 offen offset:1024 sc1
v_cvt_pk_bf16_f32 v168, v168, v169
v_cvt_pk_bf16_f32 v169, v170, v171
v_cvt_pk_bf16_f32 v170, v172, v173
v_cvt_pk_bf16_f32 v171, v174, v175
buffer_store_dwordx4 v[168:171], v6, s[8:11], s26 offen offset:1536 sc1
v_pk_mul_f32 v[192:193], v[192:193], v[26:27] op_sel_hi:[1,0]
v_pk_mul_f32 v[194:195], v[194:195], v[26:27] op_sel_hi:[1,0]
v_pk_mul_f32 v[196:197], v[196:197], v[26:27] op_sel_hi:[1,0]
v_pk_mul_f32 v[198:199], v[198:199], v[26:27] op_sel_hi:[1,0]
v_pk_mul_f32 v[200:201], v[200:201], v[26:27] op_sel_hi:[1,0]
v_pk_mul_f32 v[202:203], v[202:203], v[26:27] op_sel_hi:[1,0]
v_pk_mul_f32 v[204:205], v[204:205], v[26:27] op_sel_hi:[1,0]
v_pk_mul_f32 v[206:207], v[206:207], v[26:27] op_sel_hi:[1,0]
v_cvt_pk_bf16_f32 v192, v192, v193
v_cvt_pk_bf16_f32 v193, v194, v195
v_cvt_pk_bf16_f32 v194, v196, v197
v_cvt_pk_bf16_f32 v195, v198, v199
buffer_store_dwordx4 v[192:195], v6, s[8:11], s26 offen offset:2048 sc1
v_cvt_pk_bf16_f32 v200, v200, v201
v_cvt_pk_bf16_f32 v201, v202, v203
v_cvt_pk_bf16_f32 v202, v204, v205
v_cvt_pk_bf16_f32 v203, v206, v207
buffer_store_dwordx4 v[200:203], v6, s[8:11], s26 offen offset:2560 sc1
v_pk_mul_f32 v[224:225], v[224:225], v[26:27] op_sel_hi:[1,0]
v_pk_mul_f32 v[226:227], v[226:227], v[26:27] op_sel_hi:[1,0]
v_pk_mul_f32 v[228:229], v[228:229], v[26:27] op_sel_hi:[1,0]
v_pk_mul_f32 v[230:231], v[230:231], v[26:27] op_sel_hi:[1,0]
v_pk_mul_f32 v[232:233], v[232:233], v[26:27] op_sel_hi:[1,0]
v_pk_mul_f32 v[234:235], v[234:235], v[26:27] op_sel_hi:[1,0]
v_pk_mul_f32 v[236:237], v[236:237], v[26:27] op_sel_hi:[1,0]
v_pk_mul_f32 v[238:239], v[238:239], v[26:27] op_sel_hi:[1,0]
v_cvt_pk_bf16_f32 v224, v224, v225
v_cvt_pk_bf16_f32 v225, v226, v227
v_cvt_pk_bf16_f32 v226, v228, v229
v_cvt_pk_bf16_f32 v227, v230, v231
buffer_store_dwordx4 v[224:227], v6, s[8:11], s26 offen offset:3072 sc1
v_cvt_pk_bf16_f32 v232, v232, v233
v_cvt_pk_bf16_f32 v233, v234, v235
v_cvt_pk_bf16_f32 v234, v236, v237
v_cvt_pk_bf16_f32 v235, v238, v239
buffer_store_dwordx4 v[232:235], v6, s[8:11], s26 offen offset:3584 sc1
v_mov_b32 v26, v23
s_nop 1
v_permlane32_swap_b32 v26, v23
v_add_f32 v26, v26, v23
v_rcp_f32 v26, v26
s_nop 0
v_pk_mul_f32 v[144:145], v[144:145], v[26:27] op_sel_hi:[1,0]
v_pk_mul_f32 v[146:147], v[146:147], v[26:27] op_sel_hi:[1,0]
v_pk_mul_f32 v[148:149], v[148:149], v[26:27] op_sel_hi:[1,0]
v_pk_mul_f32 v[150:151], v[150:151], v[26:27] op_sel_hi:[1,0]
v_pk_mul_f32 v[152:153], v[152:153], v[26:27] op_sel_hi:[1,0]
v_pk_mul_f32 v[154:155], v[154:155], v[26:27] op_sel_hi:[1,0]
v_pk_mul_f32 v[156:157], v[156:157], v[26:27] op_sel_hi:[1,0]
v_pk_mul_f32 v[158:159], v[158:159], v[26:27] op_sel_hi:[1,0]
v_cvt_pk_bf16_f32 v144, v144, v145
v_cvt_pk_bf16_f32 v145, v146, v147
v_cvt_pk_bf16_f32 v146, v148, v149
v_cvt_pk_bf16_f32 v147, v150, v151
buffer_store_dwordx4 v[144:147], v6, s[8:11], s27 offen offset:0 sc1
v_cvt_pk_bf16_f32 v152, v152, v153
v_cvt_pk_bf16_f32 v153, v154, v155
v_cvt_pk_bf16_f32 v154, v156, v157
v_cvt_pk_bf16_f32 v155, v158, v159
buffer_store_dwordx4 v[152:155], v6, s[8:11], s27 offen offset:512 sc1
v_pk_mul_f32 v[176:177], v[176:177], v[26:27] op_sel_hi:[1,0]
v_pk_mul_f32 v[178:179], v[178:179], v[26:27] op_sel_hi:[1,0]
v_pk_mul_f32 v[180:181], v[180:181], v[26:27] op_sel_hi:[1,0]
v_pk_mul_f32 v[182:183], v[182:183], v[26:27] op_sel_hi:[1,0]
v_pk_mul_f32 v[184:185], v[184:185], v[26:27] op_sel_hi:[1,0]
v_pk_mul_f32 v[186:187], v[186:187], v[26:27] op_sel_hi:[1,0]
v_pk_mul_f32 v[188:189], v[188:189], v[26:27] op_sel_hi:[1,0]
v_pk_mul_f32 v[190:191], v[190:191], v[26:27] op_sel_hi:[1,0]
v_cvt_pk_bf16_f32 v176, v176, v177
v_cvt_pk_bf16_f32 v177, v178, v179
v_cvt_pk_bf16_f32 v178, v180, v181
v_cvt_pk_bf16_f32 v179, v182, v183
buffer_store_dwordx4 v[176:179], v6, s[8:11], s27 offen offset:1024 sc1
v_cvt_pk_bf16_f32 v184, v184, v185
v_cvt_pk_bf16_f32 v185, v186, v187
v_cvt_pk_bf16_f32 v186, v188, v189
v_cvt_pk_bf16_f32 v187, v190, v191
buffer_store_dwordx4 v[184:187], v6, s[8:11], s27 offen offset:1536 sc1
v_pk_mul_f32 v[208:209], v[208:209], v[26:27] op_sel_hi:[1,0]
v_pk_mul_f32 v[210:211], v[210:211], v[26:27] op_sel_hi:[1,0]
v_pk_mul_f32 v[212:213], v[212:213], v[26:27] op_sel_hi:[1,0]
v_pk_mul_f32 v[214:215], v[214:215], v[26:27] op_sel_hi:[1,0]
v_pk_mul_f32 v[216:217], v[216:217], v[26:27] op_sel_hi:[1,0]
v_pk_mul_f32 v[218:219], v[218:219], v[26:27] op_sel_hi:[1,0]
v_pk_mul_f32 v[220:221], v[220:221], v[26:27] op_sel_hi:[1,0]
v_pk_mul_f32 v[222:223], v[222:223], v[26:27] op_sel_hi:[1,0]
v_cvt_pk_bf16_f32 v208, v208, v209
v_cvt_pk_bf16_f32 v209, v210, v211
v_cvt_pk_bf16_f32 v210, v212, v213
v_cvt_pk_bf16_f32 v211, v214, v215
buffer_store_dwordx4 v[208:211], v6, s[8:11], s27 offen offset:2048 sc1
v_cvt_pk_bf16_f32 v216, v216, v217
v_cvt_pk_bf16_f32 v217, v218, v219
v_cvt_pk_bf16_f32 v218, v220, v221
v_cvt_pk_bf16_f32 v219, v222, v223
buffer_store_dwordx4 v[216:219], v6, s[8:11], s27 offen offset:2560 sc1
v_pk_mul_f32 v[240:241], v[240:241], v[26:27] op_sel_hi:[1,0]
v_pk_mul_f32 v[242:243], v[242:243], v[26:27] op_sel_hi:[1,0]
v_pk_mul_f32 v[244:245], v[244:245], v[26:27] op_sel_hi:[1,0]
v_pk_mul_f32 v[246:247], v[246:247], v[26:27] op_sel_hi:[1,0]
v_pk_mul_f32 v[248:249], v[248:249], v[26:27] op_sel_hi:[1,0]
v_pk_mul_f32 v[250:251], v[250:251], v[26:27] op_sel_hi:[1,0]
v_pk_mul_f32 v[252:253], v[252:253], v[26:27] op_sel_hi:[1,0]
v_pk_mul_f32 v[254:255], v[254:255], v[26:27] op_sel_hi:[1,0]
v_cvt_pk_bf16_f32 v240, v240, v241
v_cvt_pk_bf16_f32 v241, v242, v243
v_cvt_pk_bf16_f32 v242, v244, v245
v_cvt_pk_bf16_f32 v243, v246, v247
buffer_store_dwordx4 v[240:243], v6, s[8:11], s27 offen offset:3072 sc1
v_cvt_pk_bf16_f32 v248, v248, v249
v_cvt_pk_bf16_f32 v249, v250, v251
v_cvt_pk_bf16_f32 v250, v252, v253
v_cvt_pk_bf16_f32 v251, v254, v255
buffer_store_dwordx4 v[248:251], v6, s[8:11], s27 offen offset:3584 sc1
s_lshl_b32 s61, s41, 5
s_add_u32 s61, s61, s42
s_lshl_b32 s61, s61, 2
s_add_u32 s61, s61, 111169536
s_waitcnt vmcnt(0)
s_barrier
s_cmp_lg_u32 s17, 0
s_cbranch_scc1 L_sf_27
v_mov_b32 v20, 0
v_mov_b32 v21, 1
s_mov_b64 exec, 1
buffer_store_dword v21, v20, s[8:11], s61 offen sc1
s_mov_b64 exec, -1
L_sf_27:
s_mov_b32 s41, s62
s_add_u32 s60, s60, 1
s_cmp_lt_u32 s60, 2
s_cbranch_scc1 L_aat
L_aop:
s_cmp_ge_u32 s16, 27
s_cbranch_scc1 L_done
s_load_dwordx2 s[4:5], s[0:1], 40
s_waitcnt lgkmcnt(0)
s_mov_b32 s20, s4
s_and_b32 s21, s5, 0xffff
s_mov_b32 s22, 4718592
s_mov_b32 s23, 0x20000
s_mul_i32 s24, s16, 57
s_lshr_b32 s24, s24, 9
s_mul_i32 s25, s24, 9
s_sub_u32 s40, s16, s25
s_cmp_lt_u32 s3, 4
s_cselect_b32 s25, 2, 4
s_cselect_b32 s43, 6, 12
s_cselect_b32 s26, 0, 80
s_mov_b32 s27, 128
s_cselect_b32 s27, 80, s27
s_sub_u32 s25, s3, s25
s_mul_i32 s25, s25, 3
s_add_u32 s25, s25, s24
s_add_u32 s26, s26, s25
s_add_u32 s41, s26, 64
s_and_b32 s41, s41, 127
s_mov_b32 s42, 0
s_cmp_ge_u32 s26, s27
s_cbranch_scc1 L_done
L_cnt:
s_add_u32 s42, s42, 1
s_add_u32 s26, s26, s43
s_cmp_lt_u32 s26, s27
s_cbranch_scc1 L_cnt
s_mov_b32 s44, 67108864
s_mov_b32 s45, 111169536
s_mov_b32 s46, 4
s_mov_b32 s47, 0
s_branch L_op
L_part:
s_cmp_lt_u32 s16, 18
s_cbranch_scc1 L_bo
s_sub_u32 s41, s16, 18
s_mul_i32 s24, s17, 14
s_add_u32 s41, s41, s24
s_mov_b32 s40, 0x3e0293ee
s_mov_b32 s50, 0xf149f2ca
s_mov_b32 s51, 0x41a00000
v_and_b32 v5, 31, v0
v_bfe_u32 v26, v0, 5, 1
v_lshlrev_b32 v27, 2, v26
v_sub_u32 v5, v5, v27
v_bfe_u32 v27, v0, 4, 1
v_lshlrev_b32 v6, 17, v27
v_lshl_add_u32 v6, v26, 8, v6
v_and_b32 v27, 15, v0
v_lshl_add_u32 v6, v27, 4, v6
v_and_b32 v1, 63, v0
v_min_u32 v17, 47, v1
v_lshlrev_b32 v1, 4, v1
v_bfe_u32 v26, v0, 5, 1
v_and_b32 v27, 7, v0
v_xor_b32 v27, v27, v26
v_lshlrev_b32 v27, 4, v27
v_lshl_add_u32 v2, v26, 7, v27
v_xor_b32 v7, 64, v2
v_and_b32 v27, 31, v0
v_lshlrev_b32 v27, 2, v27
v_lshl_add_u32 v3, v26, 8, v27
v_mov_b32 v4, 0
v_lshlrev_b32 v17, 7, v17
v_mul_u32_u24 v26, 24576, v26
v_add_u32 v17, v17, v26
v_add_u32 v17, 111149056, v17
v_bfe_u32 v26, v0, 1, 4
v_and_b32 v27, 1, v0
v_lshl_add_u32 v26, v27, 4, v26
v_and_or_b32 v26, v0, 32, v26
v_lshlrev_b32 v16, 4, v26
v_mov_b32 v31, s50
s_mov_b32 s45, -1
v_cmp_le_i32 s[64:65], 0, v5
v_cmp_le_i32 s[66:67], 1, v5
v_cmp_le_i32 s[68:69], 2, v5
v_cmp_le_i32 s[70:71], 3, v5
v_cmp_le_i32 s[72:73], 8, v5
v_cmp_le_i32 s[74:75], 9, v5
v_cmp_le_i32 s[76:77], 10, v5
v_cmp_le_i32 s[78:79], 11, v5
v_cmp_le_i32 s[80:81], 16, v5
v_cmp_le_i32 s[82:83], 17, v5
v_cmp_le_i32 s[84:85], 18, v5
v_cmp_le_i32 s[86:87], 19, v5
v_cmp_le_i32 s[88:89], 24, v5
v_cmp_le_i32 s[90:91], 25, v5
v_cmp_le_i32 s[92:93], 26, v5
v_cmp_le_i32 s[94:95], 27, v5
s_and_b32 s24, s41, 31
s_lshr_b32 s25, s41, 5
s_lshl_b32 s46, s24, 6
s_add_u32 s46, s46, s25
s_lshl_b32 s46, s46, 14
s_add_u32 s46, s46, 33554432
s_lshr_b32 s44, s24, 1
s_lshl_b32 s44, s44, 6
s_add_u32 s44, s44, s25
s_lshl_b32 s44, s44, 1
s_and_b32 s24, s24, 1
s_add_u32 s44, s44, s24
s_lshl_b32 s44, s44, 13
s_add_u32 s44, s44, 134217728
s_cmp_ge_u32 s41, 2048
s_cselect_b32 s44, 536870912, s44
s_cselect_b32 s46, 536870912, s46
s_cbranch_scc1 L_nb_28
s_lshr_b32 s25, s41, 8
s_lshl_b32 s25, s25, 2
s_cmp_eq_u32 s25, s45
s_cbranch_scc1 L_nb_28
s_mov_b32 s45, s25
s_mov_b32 s28, 0
L_poll_29:
buffer_load_dword v26, v17, s[8:11], s45 offen sc1
s_add_u32 s28, s28, 1
s_cmp_gt_u32 s28, 40000
s_cbranch_scc1 L_end
s_waitcnt vmcnt(0)
v_cmp_ne_u32 vcc, 1, v26
s_cbranch_vccz L_pd_30
s_sleep 8
s_branch L_poll_29
L_pd_30:
L_nb_28:
s_add_u32 s25, s44, 0
buffer_load_dwordx4 a[0:3], v1, s[8:11], s25 offen offset:0 sc1
buffer_load_dwordx4 a[4:7], v1, s[8:11], s25 offen offset:1024 sc1
buffer_load_dwordx4 a[8:11], v1, s[8:11], s25 offen offset:2048 sc1
buffer_load_dwordx4 a[12:15], v1, s[8:11], s25 offen offset:3072 sc1
s_add_u32 s25, s44, 4096
buffer_load_dwordx4 a[16:19], v1, s[8:11], s25 offen offset:0 sc1
buffer_load_dwordx4 a[20:23], v1, s[8:11], s25 offen offset:1024 sc1
buffer_load_dwordx4 a[24:27], v1, s[8:11], s25 offen offset:2048 sc1
buffer_load_dwordx4 a[28:31], v1, s[8:11], s25 offen offset:3072 sc1
s_add_u32 s25, s46, 0
buffer_load_dwordx4 a[32:35], v1, s[8:11], s25 offen offset:0 sc1
buffer_load_dwordx4 a[36:39], v1, s[8:11], s25 offen offset:1024 sc1
buffer_load_dwordx4 a[40:43], v1, s[8:11], s25 offen offset:2048 sc1
buffer_load_dwordx4 a[44:47], v1, s[8:11], s25 offen offset:3072 sc1
s_add_u32 s25, s46, 4096
buffer_load_dwordx4 a[48:51], v1, s[8:11], s25 offen offset:0 sc1
buffer_load_dwordx4 a[52:55], v1, s[8:11], s25 offen offset:1024 sc1
buffer_load_dwordx4 a[56:59], v1, s[8:11], s25 offen offset:2048 sc1
buffer_load_dwordx4 a[60:63], v1, s[8:11], s25 offen offset:3072 sc1
s_add_u32 s25, s46, 8192
buffer_load_dwordx4 a[64:67], v16, s[8:11], s25 offen offset:0 sc1
buffer_load_dwordx4 a[68:71], v16, s[8:11], s25 offen offset:1024 sc1
buffer_load_dwordx4 a[72:75], v16, s[8:11], s25 offen offset:2048 sc1
buffer_load_dwordx4 a[76:79], v16, s[8:11], s25 offen offset:3072 sc1
s_add_u32 s25, s46, 12288
buffer_load_dwordx4 a[80:83], v16, s[8:11], s25 offen offset:0 sc1
buffer_load_dwordx4 a[84:87], v16, s[8:11], s25 offen offset:1024 sc1
buffer_load_dwordx4 a[88:91], v16, s[8:11], s25 offen offset:2048 sc1
buffer_load_dwordx4 a[92:95], v16, s[8:11], s25 offen offset:3072 sc1
s_waitcnt vmcnt(0)
L_bt:
v_mfma_f32_32x32x16_bf16 v[32:47], a[32:35], a[0:3], 0
v_mfma_f32_32x32x16_bf16 v[32:47], a[36:39], a[4:7], v[32:47]
v_mfma_f32_32x32x16_bf16 v[32:47], a[40:43], a[8:11], v[32:47]
v_mfma_f32_32x32x16_bf16 v[32:47], a[44:47], a[12:15], v[32:47]
v_mfma_f32_32x32x16_bf16 v[32:47], a[48:51], a[16:19], v[32:47]
v_mfma_f32_32x32x16_bf16 v[32:47], a[52:55], a[20:23], v[32:47]
v_mfma_f32_32x32x16_bf16 v[32:47], a[56:59], a[24:27], v[32:47]
v_mfma_f32_32x32x16_bf16 v[32:47], a[60:63], a[28:31], v[32:47]
s_and_b32 s42, s41, 31
s_lshr_b32 s43, s41, 5
s_add_u32 s48, s41, 56
s_and_b32 s24, s48, 31
s_lshr_b32 s25, s48, 5
s_lshl_b32 s46, s24, 6
s_add_u32 s46, s46, s25
s_lshl_b32 s46, s46, 14
s_add_u32 s46, s46, 33554432
s_lshr_b32 s44, s24, 1
s_lshl_b32 s44, s44, 6
s_add_u32 s44, s44, s25
s_lshl_b32 s44, s44, 1
s_and_b32 s24, s24, 1
s_add_u32 s44, s44, s24
s_lshl_b32 s44, s44, 13
s_add_u32 s44, s44, 134217728
s_cmp_ge_u32 s48, 2048
s_cselect_b32 s44, 536870912, s44
s_cselect_b32 s46, 536870912, s46
s_cbranch_scc1 L_nb_31
s_lshr_b32 s25, s48, 8
s_lshl_b32 s25, s25, 2
s_cmp_eq_u32 s25, s45
s_cbranch_scc1 L_nb_31
s_mov_b32 s45, s25
s_mov_b32 s28, 0
L_poll_32:
buffer_load_dword v26, v17, s[8:11], s45 offen sc1
s_add_u32 s28, s28, 1
s_cmp_gt_u32 s28, 40000
s_cbranch_scc1 L_end
s_waitcnt vmcnt(0)
v_cmp_ne_u32 vcc, 1, v26
s_cbranch_vccz L_pd_33
s_sleep 8
s_branch L_poll_32
L_pd_33:
L_nb_31:
v_cndmask_b32 v32, v31, v32, s[64:65]
v_cndmask_b32 v33, v31, v33, s[66:67]
v_cndmask_b32 v34, v31, v34, s[68:69]
v_cndmask_b32 v35, v31, v35, s[70:71]
v_cndmask_b32 v36, v31, v36, s[72:73]
v_cndmask_b32 v37, v31, v37, s[74:75]
v_cndmask_b32 v38, v31, v38, s[76:77]
v_cndmask_b32 v39, v31, v39, s[78:79]
v_cndmask_b32 v40, v31, v40, s[80:81]
v_cndmask_b32 v41, v31, v41, s[82:83]
v_cndmask_b32 v42, v31, v42, s[84:85]
v_cndmask_b32 v43, v31, v43, s[86:87]
v_cndmask_b32 v44, v31, v44, s[88:89]
v_cndmask_b32 v45, v31, v45, s[90:91]
v_cndmask_b32 v46, v31, v46, s[92:93]
v_cndmask_b32 v47, v31, v47, s[94:95]
v_max3_f32 v20, v32, v33, v34
v_max3_f32 v20, v20, v35, v36
v_max3_f32 v20, v20, v37, v38
v_max3_f32 v20, v20, v39, v40
v_max3_f32 v20, v20, v41, v42
v_max3_f32 v20, v20, v43, v44
v_max3_f32 v20, v20, v45, v46
v_max_f32 v20, v20, v47
s_lshl_b32 s25, s42, 7
s_add_u32 s25, s25, 111153152
s_lshl_b32 s24, s41, 12
s_add_u32 s24, s24, 100663296
s_mov_b32 s28, 0
L_poll_34:
buffer_load_dword v26, v4, s[8:11], s25 offen sc1
s_add_u32 s28, s28, 1
s_cmp_gt_u32 s28, 40000
s_cbranch_scc1 L_end
s_waitcnt vmcnt(0)
v_cmp_ge_u32 vcc, s43, v26
s_cbranch_vccz L_pd_35
s_sleep 1
s_branch L_poll_34
L_pd_35:
buffer_load_dwordx4 v[96:99], v2, s[8:11], s24 offen offset:0 sc1
buffer_load_dwordx4 v[100:103], v7, s[8:11], s24 offen offset:256 sc1
buffer_load_dwordx4 v[104:107], v2, s[8:11], s24 offen offset:512 sc1
buffer_load_dwordx4 v[108:111], v7, s[8:11], s24 offen offset:768 sc1
buffer_load_dwordx4 v[112:115], v2, s[8:11], s24 offen offset:1024 sc1
buffer_load_dwordx4 v[116:119], v7, s[8:11], s24 offen offset:1280 sc1
buffer_load_dwordx4 v[120:123], v2, s[8:11], s24 offen offset:1536 sc1
buffer_load_dwordx4 v[124:127], v7, s[8:11], s24 offen offset:1792 sc1
buffer_load_dword v8, v3, s[8:11], s24 offen offset:2048 sc1
buffer_load_dword v9, v3, s[8:11], s24 offen offset:2176 sc1
buffer_load_dword v10, v3, s[8:11], s24 offen offset:2560 sc1
buffer_load_dword v11, v3, s[8:11], s24 offen offset:2688 sc1
buffer_load_dword v12, v3, s[8:11], s24 offen offset:3072 sc1
buffer_load_dword v13, v3, s[8:11], s24 offen offset:3200 sc1
buffer_load_dword v14, v3, s[8:11], s24 offen offset:3584 sc1
buffer_load_dword v15, v3, s[8:11], s24 offen offset:3712 sc1
s_add_u32 s25, s44, 0
buffer_load_dwordx4 a[96:99], v1, s[8:11], s25 offen offset:0 sc1
buffer_load_dwordx4 a[100:103], v1, s[8:11], s25 offen offset:1024 sc1
buffer_load_dwordx4 a[104:107], v1, s[8:11], s25 offen offset:2048 sc1
buffer_load_dwordx4 a[108:111], v1, s[8:11], s25 offen offset:3072 sc1
s_add_u32 s25, s44, 4096
buffer_load_dwordx4 a[112:115], v1, s[8:11], s25 offen offset:0 sc1
buffer_load_dwordx4 a[116:119], v1, s[8:11], s25 offen offset:1024 sc1
s_waitcnt vmcnt(21)
v_mfma_f32_32x32x16_bf16 v[64:79], v[96:99], a[0:3], 0
s_waitcnt vmcnt(20)
v_mfma_f32_32x32x16_bf16 v[64:79], v[100:103], a[4:7], v[64:79]
buffer_load_dwordx4 a[120:123], v1, s[8:11], s25 offen offset:2048 sc1
s_waitcnt vmcnt(20)
v_mfma_f32_32x32x16_bf16 v[64:79], v[104:107], a[8:11], v[64:79]
s_waitcnt vmcnt(19)
v_mfma_f32_32x32x16_bf16 v[64:79], v[108:111], a[12:15], v[64:79]
buffer_load_dwordx4 a[124:127], v1, s[8:11], s25 offen offset:3072 sc1
s_waitcnt vmcnt(19)
v_mfma_f32_32x32x16_bf16 v[64:79], v[112:115], a[16:19], v[64:79]
s_waitcnt vmcnt(18)
v_mfma_f32_32x32x16_bf16 v[64:79], v[116:119], a[20:23], v[64:79]
s_add_u32 s25, s46, 0
buffer_load_dwordx4 a[128:131], v1, s[8:11], s25 offen offset:0 sc1
s_waitcnt vmcnt(18)
v_mfma_f32_32x32x16_bf16 v[64:79], v[120:123], a[24:27], v[64:79]
s_waitcnt vmcnt(17)
v_mfma_f32_32x32x16_bf16 v[64:79], v[124:127], a[28:31], v[64:79]
buffer_load_dwordx4 a[132:135], v1, s[8:11], s25 offen offset:1024 sc1
s_nop 10
v_max3_f32 v20, v20, v64, v65
v_max3_f32 v20, v20, v66, v67
v_mov_b32 v26, v20
s_nop 1
v_permlane32_swap_b32 v26, v20
v_max_f32 v20, v20, v26
v_mul_f32 v20, s40, v20
v_fma_f32 v64, v64, s40, -v20
v_fma_f32 v65, v65, s40, -v20
v_fma_f32 v66, v66, s40, -v20
v_fma_f32 v67, v67, s40, -v20
v_fma_f32 v32, v32, s40, -v20
v_fma_f32 v33, v33, s40, -v20
v_fma_f32 v34, v34, s40, -v20
v_fma_f32 v35, v35, s40, -v20
v_fma_f32 v36, v36, s40, -v20
v_fma_f32 v37, v37, s40, -v20
v_fma_f32 v38, v38, s40, -v20
v_fma_f32 v39, v39, s40, -v20
v_fma_f32 v40, v40, s40, -v20
v_fma_f32 v41, v41, s40, -v20
v_fma_f32 v42, v42, s40, -v20
v_fma_f32 v43, v43, s40, -v20
v_fma_f32 v44, v44, s40, -v20
v_fma_f32 v45, v45, s40, -v20
v_fma_f32 v46, v46, s40, -v20
v_fma_f32 v47, v47, s40, -v20
v_exp_f32 v64, v64
buffer_load_dwordx4 a[136:139], v1, s[8:11], s25 offen offset:2048 sc1
v_exp_f32 v65, v65
v_exp_f32 v66, v66
v_exp_f32 v67, v67
v_exp_f32 v32, v32
v_exp_f32 v33, v33
buffer_load_dwordx4 a[140:143], v1, s[8:11], s25 offen offset:3072 sc1
v_exp_f32 v34, v34
v_exp_f32 v35, v35
v_exp_f32 v36, v36
v_exp_f32 v37, v37
v_exp_f32 v38, v38
s_add_u32 s25, s46, 4096
buffer_load_dwordx4 a[144:147], v1, s[8:11], s25 offen offset:0 sc1
v_exp_f32 v39, v39
v_exp_f32 v40, v40
v_exp_f32 v41, v41
v_exp_f32 v42, v42
v_exp_f32 v43, v43
buffer_load_dwordx4 a[148:151], v1, s[8:11], s25 offen offset:1024 sc1
v_exp_f32 v44, v44
v_exp_f32 v45, v45
v_exp_f32 v46, v46
v_exp_f32 v47, v47
v_cvt_pk_bf16_f32 v88, v64, v65
v_cvt_pk_bf16_f32 v89, v66, v67
v_cvt_pk_bf16_f32 v80, v32, v33
v_cvt_pk_bf16_f32 v81, v34, v35
v_cvt_pk_bf16_f32 v82, v36, v37
v_cvt_pk_bf16_f32 v83, v38, v39
v_cvt_pk_bf16_f32 v84, v40, v41
v_cvt_pk_bf16_f32 v85, v42, v43
v_cvt_pk_bf16_f32 v86, v44, v45
v_cvt_pk_bf16_f32 v87, v46, v47
s_waitcnt vmcnt(14)
v_mfma_f32_32x32x8_bf16 v[128:143], v[8:9], v[88:89], 0
buffer_load_dwordx4 a[152:155], v1, s[8:11], s25 offen offset:2048 sc1
v_add_f32 v22, v64, v65
v_add_f32 v22, v22, v66
v_mfma_f32_32x32x16_bf16 v[128:143], a[64:67], v[80:83], v[128:143]
buffer_load_dwordx4 a[156:159], v1, s[8:11], s25 offen offset:3072 sc1
v_add_f32 v22, v22, v67
v_add_f32 v22, v22, v32
v_add_f32 v22, v22, v33
v_mfma_f32_32x32x16_bf16 v[128:143], a[68:71], v[84:87], v[128:143]
s_add_u32 s25, s46, 8192
buffer_load_dwordx4 a[160:163], v16, s[8:11], s25 offen offset:0 sc1
v_add_f32 v22, v22, v34
v_add_f32 v22, v22, v35
v_mfma_f32_32x32x8_bf16 v[160:175], v[10:11], v[88:89], 0
buffer_load_dwordx4 a[164:167], v16, s[8:11], s25 offen offset:1024 sc1
v_add_f32 v22, v22, v36
v_add_f32 v22, v22, v37
v_add_f32 v22, v22, v38
v_mfma_f32_32x32x16_bf16 v[160:175], a[72:75], v[80:83], v[160:175]
buffer_load_dwordx4 a[168:171], v16, s[8:11], s25 offen offset:2048 sc1
v_add_f32 v22, v22, v39
v_add_f32 v22, v22, v40
v_mfma_f32_32x32x16_bf16 v[160:175], a[76:79], v[84:87], v[160:175]
buffer_load_dwordx4 a[172:175], v16, s[8:11], s25 offen offset:3072 sc1
v_add_f32 v22, v22, v41
v_add_f32 v22, v22, v42
v_mfma_f32_32x32x8_bf16 v[192:207], v[12:13], v[88:89], 0
s_add_u32 s25, s46, 12288
buffer_load_dwordx4 a[176:179], v16, s[8:11], s25 offen offset:0 sc1
v_add_f32 v22, v22, v43
v_add_f32 v22, v22, v44
v_add_f32 v22, v22, v45
v_mfma_f32_32x32x16_bf16 v[192:207], a[80:83], v[80:83], v[192:207]
buffer_load_dwordx4 a[180:183], v16, s[8:11], s25 offen offset:1024 sc1
v_add_f32 v22, v22, v46
v_add_f32 v22, v22, v47
v_mfma_f32_32x32x16_bf16 v[192:207], a[84:87], v[84:87], v[192:207]
buffer_load_dwordx4 a[184:187], v16, s[8:11], s25 offen offset:2048 sc1
v_mfma_f32_32x32x8_bf16 v[224:239], v[14:15], v[88:89], 0
buffer_load_dwordx4 a[188:191], v16, s[8:11], s25 offen offset:3072 sc1
v_mfma_f32_32x32x16_bf16 v[224:239], a[88:91], v[80:83], v[224:239]
v_mfma_f32_32x32x16_bf16 v[224:239], a[92:95], v[84:87], v[224:239]
s_lshl_b32 s26, s43, 18
s_lshl_b32 s27, s42, 12
s_add_u32 s26, s26, s27
s_add_u32 s26, s26, 83886080
v_mov_b32 v26, v22
s_nop 1
v_permlane32_swap_b32 v26, v22
v_add_f32 v26, v26, v22
v_rcp_f32 v26, v26
s_nop 0
v_pk_mul_f32 v[128:129], v[128:129], v[26:27] op_sel_hi:[1,0]
v_pk_mul_f32 v[130:131], v[130:131], v[26:27] op_sel_hi:[1,0]
v_pk_mul_f32 v[132:133], v[132:133], v[26:27] op_sel_hi:[1,0]
v_pk_mul_f32 v[134:135], v[134:135], v[26:27] op_sel_hi:[1,0]
v_pk_mul_f32 v[136:137], v[136:137], v[26:27] op_sel_hi:[1,0]
v_pk_mul_f32 v[138:139], v[138:139], v[26:27] op_sel_hi:[1,0]
v_pk_mul_f32 v[140:141], v[140:141], v[26:27] op_sel_hi:[1,0]
v_pk_mul_f32 v[142:143], v[142:143], v[26:27] op_sel_hi:[1,0]
v_cvt_pk_bf16_f32 v128, v128, v129
v_cvt_pk_bf16_f32 v129, v130, v131
v_cvt_pk_bf16_f32 v130, v132, v133
v_cvt_pk_bf16_f32 v131, v134, v135
buffer_store_dwordx4 v[128:131], v6, s[8:11], s26 offen offset:0 sc1
v_cvt_pk_bf16_f32 v136, v136, v137
v_cvt_pk_bf16_f32 v137, v138, v139
v_cvt_pk_bf16_f32 v138, v140, v141
v_cvt_pk_bf16_f32 v139, v142, v143
buffer_store_dwordx4 v[136:139], v6, s[8:11], s26 offen offset:512 sc1
v_pk_mul_f32 v[160:161], v[160:161], v[26:27] op_sel_hi:[1,0]
v_pk_mul_f32 v[162:163], v[162:163], v[26:27] op_sel_hi:[1,0]
v_pk_mul_f32 v[164:165], v[164:165], v[26:27] op_sel_hi:[1,0]
v_pk_mul_f32 v[166:167], v[166:167], v[26:27] op_sel_hi:[1,0]
v_pk_mul_f32 v[168:169], v[168:169], v[26:27] op_sel_hi:[1,0]
v_pk_mul_f32 v[170:171], v[170:171], v[26:27] op_sel_hi:[1,0]
v_pk_mul_f32 v[172:173], v[172:173], v[26:27] op_sel_hi:[1,0]
v_pk_mul_f32 v[174:175], v[174:175], v[26:27] op_sel_hi:[1,0]
v_cvt_pk_bf16_f32 v160, v160, v161
v_cvt_pk_bf16_f32 v161, v162, v163
v_cvt_pk_bf16_f32 v162, v164, v165
v_cvt_pk_bf16_f32 v163, v166, v167
buffer_store_dwordx4 v[160:163], v6, s[8:11], s26 offen offset:1024 sc1
v_cvt_pk_bf16_f32 v168, v168, v169
v_cvt_pk_bf16_f32 v169, v170, v171
v_cvt_pk_bf16_f32 v170, v172, v173
v_cvt_pk_bf16_f32 v171, v174, v175
buffer_store_dwordx4 v[168:171], v6, s[8:11], s26 offen offset:1536 sc1
v_pk_mul_f32 v[192:193], v[192:193], v[26:27] op_sel_hi:[1,0]
v_pk_mul_f32 v[194:195], v[194:195], v[26:27] op_sel_hi:[1,0]
v_pk_mul_f32 v[196:197], v[196:197], v[26:27] op_sel_hi:[1,0]
v_pk_mul_f32 v[198:199], v[198:199], v[26:27] op_sel_hi:[1,0]
v_pk_mul_f32 v[200:201], v[200:201], v[26:27] op_sel_hi:[1,0]
v_pk_mul_f32 v[202:203], v[202:203], v[26:27] op_sel_hi:[1,0]
v_pk_mul_f32 v[204:205], v[204:205], v[26:27] op_sel_hi:[1,0]
v_pk_mul_f32 v[206:207], v[206:207], v[26:27] op_sel_hi:[1,0]
v_cvt_pk_bf16_f32 v192, v192, v193
v_cvt_pk_bf16_f32 v193, v194, v195
v_cvt_pk_bf16_f32 v194, v196, v197
v_cvt_pk_bf16_f32 v195, v198, v199
buffer_store_dwordx4 v[192:195], v6, s[8:11], s26 offen offset:2048 sc1
v_cvt_pk_bf16_f32 v200, v200, v201
v_cvt_pk_bf16_f32 v201, v202, v203
v_cvt_pk_bf16_f32 v202, v204, v205
v_cvt_pk_bf16_f32 v203, v206, v207
buffer_store_dwordx4 v[200:203], v6, s[8:11], s26 offen offset:2560 sc1
v_pk_mul_f32 v[224:225], v[224:225], v[26:27] op_sel_hi:[1,0]
v_pk_mul_f32 v[226:227], v[226:227], v[26:27] op_sel_hi:[1,0]
v_pk_mul_f32 v[228:229], v[228:229], v[26:27] op_sel_hi:[1,0]
v_pk_mul_f32 v[230:231], v[230:231], v[26:27] op_sel_hi:[1,0]
v_pk_mul_f32 v[232:233], v[232:233], v[26:27] op_sel_hi:[1,0]
v_pk_mul_f32 v[234:235], v[234:235], v[26:27] op_sel_hi:[1,0]
v_pk_mul_f32 v[236:237], v[236:237], v[26:27] op_sel_hi:[1,0]
v_pk_mul_f32 v[238:239], v[238:239], v[26:27] op_sel_hi:[1,0]
v_cvt_pk_bf16_f32 v224, v224, v225
v_cvt_pk_bf16_f32 v225, v226, v227
v_cvt_pk_bf16_f32 v226, v228, v229
v_cvt_pk_bf16_f32 v227, v230, v231
buffer_store_dwordx4 v[224:227], v6, s[8:11], s26 offen offset:3072 sc1
v_cvt_pk_bf16_f32 v232, v232, v233
v_cvt_pk_bf16_f32 v233, v234, v235
v_cvt_pk_bf16_f32 v234, v236, v237
v_cvt_pk_bf16_f32 v235, v238, v239
buffer_store_dwordx4 v[232:235], v6, s[8:11], s26 offen offset:3584 sc1
s_lshl_b32 s26, s41, 2
s_add_u32 s26, s26, 111157248
v_mov_b32 v26, 1
s_waitcnt vmcnt(0)
s_mov_b64 exec, 1
buffer_store_dword v26, v4, s[8:11], s26 offen sc1
s_mov_b64 exec, -1
s_mov_b32 s41, s48
s_cmp_lt_u32 s41, 2048
s_cbranch_scc0 L_bt_x
v_mfma_f32_32x32x16_bf16 v[32:47], a[128:131], a[96:99], 0
v_mfma_f32_32x32x16_bf16 v[32:47], a[132:135], a[100:103], v[32:47]
v_mfma_f32_32x32x16_bf16 v[32:47], a[136:139], a[104:107], v[32:47]
v_mfma_f32_32x32x16_bf16 v[32:47], a[140:143], a[108:111], v[32:47]
v_mfma_f32_32x32x16_bf16 v[32:47], a[144:147], a[112:115], v[32:47]
v_mfma_f32_32x32x16_bf16 v[32:47], a[148:151], a[116:119], v[32:47]
v_mfma_f32_32x32x16_bf16 v[32:47], a[152:155], a[120:123], v[32:47]
v_mfma_f32_32x32x16_bf16 v[32:47], a[156:159], a[124:127], v[32:47]
s_and_b32 s42, s41, 31
s_lshr_b32 s43, s41, 5
s_add_u32 s48, s41, 56
s_and_b32 s24, s48, 31
s_lshr_b32 s25, s48, 5
s_lshl_b32 s46, s24, 6
s_add_u32 s46, s46, s25
s_lshl_b32 s46, s46, 14
s_add_u32 s46, s46, 33554432
s_lshr_b32 s44, s24, 1
s_lshl_b32 s44, s44, 6
s_add_u32 s44, s44, s25
s_lshl_b32 s44, s44, 1
s_and_b32 s24, s24, 1
s_add_u32 s44, s44, s24
s_lshl_b32 s44, s44, 13
s_add_u32 s44, s44, 134217728
s_cmp_ge_u32 s48, 2048
s_cselect_b32 s44, 536870912, s44
s_cselect_b32 s46, 536870912, s46
s_cbranch_scc1 L_nb_36
s_lshr_b32 s25, s48, 8
s_lshl_b32 s25, s25, 2
s_cmp_eq_u32 s25, s45
s_cbranch_scc1 L_nb_36
s_mov_b32 s45, s25
s_mov_b32 s28, 0
L_poll_37:
buffer_load_dword v26, v17, s[8:11], s45 offen sc1
s_add_u32 s28, s28, 1
s_cmp_gt_u32 s28, 40000
s_cbranch_scc1 L_end
s_waitcnt vmcnt(0)
v_cmp_ne_u32 vcc, 1, v26
s_cbranch_vccz L_pd_38
s_sleep 8
s_branch L_poll_37
L_pd_38:
L_nb_36:
v_cndmask_b32 v32, v31, v32, s[64:65]
v_cndmask_b32 v33, v31, v33, s[66:67]
v_cndmask_b32 v34, v31, v34, s[68:69]
v_cndmask_b32 v35, v31, v35, s[70:71]
v_cndmask_b32 v36, v31, v36, s[72:73]
v_cndmask_b32 v37, v31, v37, s[74:75]
v_cndmask_b32 v38, v31, v38, s[76:77]
v_cndmask_b32 v39, v31, v39, s[78:79]
v_cndmask_b32 v40, v31, v40, s[80:81]
v_cndmask_b32 v41, v31, v41, s[82:83]
v_cndmask_b32 v42, v31, v42, s[84:85]
v_cndmask_b32 v43, v31, v43, s[86:87]
v_cndmask_b32 v44, v31, v44, s[88:89]
v_cndmask_b32 v45, v31, v45, s[90:91]
v_cndmask_b32 v46, v31, v46, s[92:93]
v_cndmask_b32 v47, v31, v47, s[94:95]
v_max3_f32 v20, v32, v33, v34
v_max3_f32 v20, v20, v35, v36
v_max3_f32 v20, v20, v37, v38
v_max3_f32 v20, v20, v39, v40
v_max3_f32 v20, v20, v41, v42
v_max3_f32 v20, v20, v43, v44
v_max3_f32 v20, v20, v45, v46
v_max_f32 v20, v20, v47
s_lshl_b32 s25, s42, 7
s_add_u32 s25, s25, 111153152
s_lshl_b32 s24, s41, 12
s_add_u32 s24, s24, 100663296
s_mov_b32 s28, 0
L_poll_39:
buffer_load_dword v26, v4, s[8:11], s25 offen sc1
s_add_u32 s28, s28, 1
s_cmp_gt_u32 s28, 40000
s_cbranch_scc1 L_end
s_waitcnt vmcnt(0)
v_cmp_ge_u32 vcc, s43, v26
s_cbranch_vccz L_pd_40
s_sleep 1
s_branch L_poll_39
L_pd_40:
buffer_load_dwordx4 v[96:99], v2, s[8:11], s24 offen offset:0 sc1
buffer_load_dwordx4 v[100:103], v7, s[8:11], s24 offen offset:256 sc1
buffer_load_dwordx4 v[104:107], v2, s[8:11], s24 offen offset:512 sc1
buffer_load_dwordx4 v[108:111], v7, s[8:11], s24 offen offset:768 sc1
buffer_load_dwordx4 v[112:115], v2, s[8:11], s24 offen offset:1024 sc1
buffer_load_dwordx4 v[116:119], v7, s[8:11], s24 offen offset:1280 sc1
buffer_load_dwordx4 v[120:123], v2, s[8:11], s24 offen offset:1536 sc1
buffer_load_dwordx4 v[124:127], v7, s[8:11], s24 offen offset:1792 sc1
buffer_load_dword v8, v3, s[8:11], s24 offen offset:2048 sc1
buffer_load_dword v9, v3, s[8:11], s24 offen offset:2176 sc1
buffer_load_dword v10, v3, s[8:11], s24 offen offset:2560 sc1
buffer_load_dword v11, v3, s[8:11], s24 offen offset:2688 sc1
buffer_load_dword v12, v3, s[8:11], s24 offen offset:3072 sc1
buffer_load_dword v13, v3, s[8:11], s24 offen offset:3200 sc1
buffer_load_dword v14, v3, s[8:11], s24 offen offset:3584 sc1
buffer_load_dword v15, v3, s[8:11], s24 offen offset:3712 sc1
s_add_u32 s25, s44, 0
buffer_load_dwordx4 a[0:3], v1, s[8:11], s25 offen offset:0 sc1
buffer_load_dwordx4 a[4:7], v1, s[8:11], s25 offen offset:1024 sc1
buffer_load_dwordx4 a[8:11], v1, s[8:11], s25 offen offset:2048 sc1
buffer_load_dwordx4 a[12:15], v1, s[8:11], s25 offen offset:3072 sc1
s_add_u32 s25, s44, 4096
buffer_load_dwordx4 a[16:19], v1, s[8:11], s25 offen offset:0 sc1
buffer_load_dwordx4 a[20:23], v1, s[8:11], s25 offen offset:1024 sc1
s_waitcnt vmcnt(21)
v_mfma_f32_32x32x16_bf16 v[64:79], v[96:99], a[96:99], 0
s_waitcnt vmcnt(20)
v_mfma_f32_32x32x16_bf16 v[64:79], v[100:103], a[100:103], v[64:79]
buffer_load_dwordx4 a[24:27], v1, s[8:11], s25 offen offset:2048 sc1
s_waitcnt vmcnt(20)
v_mfma_f32_32x32x16_bf16 v[64:79], v[104:107], a[104:107], v[64:79]
s_waitcnt vmcnt(19)
v_mfma_f32_32x32x16_bf16 v[64:79], v[108:111], a[108:111], v[64:79]
buffer_load_dwordx4 a[28:31], v1, s[8:11], s25 offen offset:3072 sc1
s_waitcnt vmcnt(19)
v_mfma_f32_32x32x16_bf16 v[64:79], v[112:115], a[112:115], v[64:79]
s_waitcnt vmcnt(18)
v_mfma_f32_32x32x16_bf16 v[64:79], v[116:119], a[116:119], v[64:79]
s_add_u32 s25, s46, 0
buffer_load_dwordx4 a[32:35], v1, s[8:11], s25 offen offset:0 sc1
s_waitcnt vmcnt(18)
v_mfma_f32_32x32x16_bf16 v[64:79], v[120:123], a[120:123], v[64:79]
s_waitcnt vmcnt(17)
v_mfma_f32_32x32x16_bf16 v[64:79], v[124:127], a[124:127], v[64:79]
buffer_load_dwordx4 a[36:39], v1, s[8:11], s25 offen offset:1024 sc1
s_nop 10
v_max3_f32 v20, v20, v64, v65
v_max3_f32 v20, v20, v66, v67
v_mov_b32 v26, v20
s_nop 1
v_permlane32_swap_b32 v26, v20
v_max_f32 v20, v20, v26
v_mul_f32 v20, s40, v20
v_fma_f32 v64, v64, s40, -v20
v_fma_f32 v65, v65, s40, -v20
v_fma_f32 v66, v66, s40, -v20
v_fma_f32 v67, v67, s40, -v20
v_fma_f32 v32, v32, s40, -v20
v_fma_f32 v33, v33, s40, -v20
v_fma_f32 v34, v34, s40, -v20
v_fma_f32 v35, v35, s40, -v20
v_fma_f32 v36, v36, s40, -v20
v_fma_f32 v37, v37, s40, -v20
v_fma_f32 v38, v38, s40, -v20
v_fma_f32 v39, v39, s40, -v20
v_fma_f32 v40, v40, s40, -v20
v_fma_f32 v41, v41, s40, -v20
v_fma_f32 v42, v42, s40, -v20
v_fma_f32 v43, v43, s40, -v20
v_fma_f32 v44, v44, s40, -v20
v_fma_f32 v45, v45, s40, -v20
v_fma_f32 v46, v46, s40, -v20
v_fma_f32 v47, v47, s40, -v20
v_exp_f32 v64, v64
buffer_load_dwordx4 a[40:43], v1, s[8:11], s25 offen offset:2048 sc1
v_exp_f32 v65, v65
v_exp_f32 v66, v66
v_exp_f32 v67, v67
v_exp_f32 v32, v32
v_exp_f32 v33, v33
buffer_load_dwordx4 a[44:47], v1, s[8:11], s25 offen offset:3072 sc1
v_exp_f32 v34, v34
v_exp_f32 v35, v35
v_exp_f32 v36, v36
v_exp_f32 v37, v37
v_exp_f32 v38, v38
s_add_u32 s25, s46, 4096
buffer_load_dwordx4 a[48:51], v1, s[8:11], s25 offen offset:0 sc1
v_exp_f32 v39, v39
v_exp_f32 v40, v40
v_exp_f32 v41, v41
v_exp_f32 v42, v42
v_exp_f32 v43, v43
buffer_load_dwordx4 a[52:55], v1, s[8:11], s25 offen offset:1024 sc1
v_exp_f32 v44, v44
v_exp_f32 v45, v45
v_exp_f32 v46, v46
v_exp_f32 v47, v47
v_cvt_pk_bf16_f32 v88, v64, v65
v_cvt_pk_bf16_f32 v89, v66, v67
v_cvt_pk_bf16_f32 v80, v32, v33
v_cvt_pk_bf16_f32 v81, v34, v35
v_cvt_pk_bf16_f32 v82, v36, v37
v_cvt_pk_bf16_f32 v83, v38, v39
v_cvt_pk_bf16_f32 v84, v40, v41
v_cvt_pk_bf16_f32 v85, v42, v43
v_cvt_pk_bf16_f32 v86, v44, v45
v_cvt_pk_bf16_f32 v87, v46, v47
s_waitcnt vmcnt(14)
v_mfma_f32_32x32x8_bf16 v[128:143], v[8:9], v[88:89], 0
buffer_load_dwordx4 a[56:59], v1, s[8:11], s25 offen offset:2048 sc1
v_add_f32 v22, v64, v65
v_add_f32 v22, v22, v66
v_mfma_f32_32x32x16_bf16 v[128:143], a[160:163], v[80:83], v[128:143]
buffer_load_dwordx4 a[60:63], v1, s[8:11], s25 offen offset:3072 sc1
v_add_f32 v22, v22, v67
v_add_f32 v22, v22, v32
v_add_f32 v22, v22, v33
v_mfma_f32_32x32x16_bf16 v[128:143], a[164:167], v[84:87], v[128:143]
s_add_u32 s25, s46, 8192
buffer_load_dwordx4 a[64:67], v16, s[8:11], s25 offen offset:0 sc1
v_add_f32 v22, v22, v34
v_add_f32 v22, v22, v35
v_mfma_f32_32x32x8_bf16 v[160:175], v[10:11], v[88:89], 0
buffer_load_dwordx4 a[68:71], v16, s[8:11], s25 offen offset:1024 sc1
v_add_f32 v22, v22, v36
v_add_f32 v22, v22, v37
v_add_f32 v22, v22, v38
v_mfma_f32_32x32x16_bf16 v[160:175], a[168:171], v[80:83], v[160:175]
buffer_load_dwordx4 a[72:75], v16, s[8:11], s25 offen offset:2048 sc1
v_add_f32 v22, v22, v39
v_add_f32 v22, v22, v40
v_mfma_f32_32x32x16_bf16 v[160:175], a[172:175], v[84:87], v[160:175]
buffer_load_dwordx4 a[76:79], v16, s[8:11], s25 offen offset:3072 sc1
v_add_f32 v22, v22, v41
v_add_f32 v22, v22, v42
v_mfma_f32_32x32x8_bf16 v[192:207], v[12:13], v[88:89], 0
s_add_u32 s25, s46, 12288
buffer_load_dwordx4 a[80:83], v16, s[8:11], s25 offen offset:0 sc1
v_add_f32 v22, v22, v43
v_add_f32 v22, v22, v44
v_add_f32 v22, v22, v45
v_mfma_f32_32x32x16_bf16 v[192:207], a[176:179], v[80:83], v[192:207]
buffer_load_dwordx4 a[84:87], v16, s[8:11], s25 offen offset:1024 sc1
v_add_f32 v22, v22, v46
v_add_f32 v22, v22, v47
v_mfma_f32_32x32x16_bf16 v[192:207], a[180:183], v[84:87], v[192:207]
buffer_load_dwordx4 a[88:91], v16, s[8:11], s25 offen offset:2048 sc1
v_mfma_f32_32x32x8_bf16 v[224:239], v[14:15], v[88:89], 0
buffer_load_dwordx4 a[92:95], v16, s[8:11], s25 offen offset:3072 sc1
v_mfma_f32_32x32x16_bf16 v[224:239], a[184:187], v[80:83], v[224:239]
v_mfma_f32_32x32x16_bf16 v[224:239], a[188:191], v[84:87], v[224:239]
s_lshl_b32 s26, s43, 18
s_lshl_b32 s27, s42, 12
s_add_u32 s26, s26, s27
s_add_u32 s26, s26, 83886080
v_mov_b32 v26, v22
s_nop 1
v_permlane32_swap_b32 v26, v22
v_add_f32 v26, v26, v22
v_rcp_f32 v26, v26
s_nop 0
v_pk_mul_f32 v[128:129], v[128:129], v[26:27] op_sel_hi:[1,0]
v_pk_mul_f32 v[130:131], v[130:131], v[26:27] op_sel_hi:[1,0]
v_pk_mul_f32 v[132:133], v[132:133], v[26:27] op_sel_hi:[1,0]
v_pk_mul_f32 v[134:135], v[134:135], v[26:27] op_sel_hi:[1,0]
v_pk_mul_f32 v[136:137], v[136:137], v[26:27] op_sel_hi:[1,0]
v_pk_mul_f32 v[138:139], v[138:139], v[26:27] op_sel_hi:[1,0]
v_pk_mul_f32 v[140:141], v[140:141], v[26:27] op_sel_hi:[1,0]
v_pk_mul_f32 v[142:143], v[142:143], v[26:27] op_sel_hi:[1,0]
v_cvt_pk_bf16_f32 v128, v128, v129
v_cvt_pk_bf16_f32 v129, v130, v131
v_cvt_pk_bf16_f32 v130, v132, v133
v_cvt_pk_bf16_f32 v131, v134, v135
buffer_store_dwordx4 v[128:131], v6, s[8:11], s26 offen offset:0 sc1
v_cvt_pk_bf16_f32 v136, v136, v137
v_cvt_pk_bf16_f32 v137, v138, v139
v_cvt_pk_bf16_f32 v138, v140, v141
v_cvt_pk_bf16_f32 v139, v142, v143
buffer_store_dwordx4 v[136:139], v6, s[8:11], s26 offen offset:512 sc1
v_pk_mul_f32 v[160:161], v[160:161], v[26:27] op_sel_hi:[1,0]
v_pk_mul_f32 v[162:163], v[162:163], v[26:27] op_sel_hi:[1,0]
v_pk_mul_f32 v[164:165], v[164:165], v[26:27] op_sel_hi:[1,0]
v_pk_mul_f32 v[166:167], v[166:167], v[26:27] op_sel_hi:[1,0]
v_pk_mul_f32 v[168:169], v[168:169], v[26:27] op_sel_hi:[1,0]
v_pk_mul_f32 v[170:171], v[170:171], v[26:27] op_sel_hi:[1,0]
v_pk_mul_f32 v[172:173], v[172:173], v[26:27] op_sel_hi:[1,0]
v_pk_mul_f32 v[174:175], v[174:175], v[26:27] op_sel_hi:[1,0]
v_cvt_pk_bf16_f32 v160, v160, v161
v_cvt_pk_bf16_f32 v161, v162, v163
v_cvt_pk_bf16_f32 v162, v164, v165
v_cvt_pk_bf16_f32 v163, v166, v167
buffer_store_dwordx4 v[160:163], v6, s[8:11], s26 offen offset:1024 sc1
v_cvt_pk_bf16_f32 v168, v168, v169
v_cvt_pk_bf16_f32 v169, v170, v171
v_cvt_pk_bf16_f32 v170, v172, v173
v_cvt_pk_bf16_f32 v171, v174, v175
buffer_store_dwordx4 v[168:171], v6, s[8:11], s26 offen offset:1536 sc1
v_pk_mul_f32 v[192:193], v[192:193], v[26:27] op_sel_hi:[1,0]
v_pk_mul_f32 v[194:195], v[194:195], v[26:27] op_sel_hi:[1,0]
v_pk_mul_f32 v[196:197], v[196:197], v[26:27] op_sel_hi:[1,0]
v_pk_mul_f32 v[198:199], v[198:199], v[26:27] op_sel_hi:[1,0]
v_pk_mul_f32 v[200:201], v[200:201], v[26:27] op_sel_hi:[1,0]
v_pk_mul_f32 v[202:203], v[202:203], v[26:27] op_sel_hi:[1,0]
v_pk_mul_f32 v[204:205], v[204:205], v[26:27] op_sel_hi:[1,0]
v_pk_mul_f32 v[206:207], v[206:207], v[26:27] op_sel_hi:[1,0]
v_cvt_pk_bf16_f32 v192, v192, v193
v_cvt_pk_bf16_f32 v193, v194, v195
v_cvt_pk_bf16_f32 v194, v196, v197
v_cvt_pk_bf16_f32 v195, v198, v199
buffer_store_dwordx4 v[192:195], v6, s[8:11], s26 offen offset:2048 sc1
v_cvt_pk_bf16_f32 v200, v200, v201
v_cvt_pk_bf16_f32 v201, v202, v203
v_cvt_pk_bf16_f32 v202, v204, v205
v_cvt_pk_bf16_f32 v203, v206, v207
buffer_store_dwordx4 v[200:203], v6, s[8:11], s26 offen offset:2560 sc1
v_pk_mul_f32 v[224:225], v[224:225], v[26:27] op_sel_hi:[1,0]
v_pk_mul_f32 v[226:227], v[226:227], v[26:27] op_sel_hi:[1,0]
v_pk_mul_f32 v[228:229], v[228:229], v[26:27] op_sel_hi:[1,0]
v_pk_mul_f32 v[230:231], v[230:231], v[26:27] op_sel_hi:[1,0]
v_pk_mul_f32 v[232:233], v[232:233], v[26:27] op_sel_hi:[1,0]
v_pk_mul_f32 v[234:235], v[234:235], v[26:27] op_sel_hi:[1,0]
v_pk_mul_f32 v[236:237], v[236:237], v[26:27] op_sel_hi:[1,0]
v_pk_mul_f32 v[238:239], v[238:239], v[26:27] op_sel_hi:[1,0]
v_cvt_pk_bf16_f32 v224, v224, v225
v_cvt_pk_bf16_f32 v225, v226, v227
v_cvt_pk_bf16_f32 v226, v228, v229
v_cvt_pk_bf16_f32 v227, v230, v231
buffer_store_dwordx4 v[224:227], v6, s[8:11], s26 offen offset:3072 sc1
v_cvt_pk_bf16_f32 v232, v232, v233
v_cvt_pk_bf16_f32 v233, v234, v235
v_cvt_pk_bf16_f32 v234, v236, v237
v_cvt_pk_bf16_f32 v235, v238, v239
buffer_store_dwordx4 v[232:235], v6, s[8:11], s26 offen offset:3584 sc1
s_lshl_b32 s26, s41, 2
s_add_u32 s26, s26, 111157248
v_mov_b32 v26, 1
s_waitcnt vmcnt(0)
s_mov_b64 exec, 1
buffer_store_dword v26, v4, s[8:11], s26 offen sc1
s_mov_b64 exec, -1
s_mov_b32 s41, s48
s_cmp_lt_u32 s41, 2048
s_cbranch_scc1 L_bt
L_bt_x:
s_branch L_done
L_bo:
s_load_dwordx2 s[4:5], s[0:1], 88
s_waitcnt lgkmcnt(0)
s_mov_b32 s20, s4
s_and_b32 s21, s5, 0xffff
s_mov_b32 s22, 4718592
s_mov_b32 s23, 0x20000
s_cmp_ge_u32 s16, 9
s_cselect_b32 s41, 1, 0
s_mul_i32 s25, s41, 9
s_sub_u32 s40, s16, s25
s_mov_b32 s43, 2
s_mov_b32 s42, 64
s_mov_b32 s44, 83886080
s_mov_b32 s45, 111157248
s_mov_b32 s46, 1
s_mov_b32 s47, 1152
L_op:
s_load_dwordx2 s[4:5], s[0:1], 104
s_waitcnt lgkmcnt(0)
s_mov_b32 s12, s4
s_and_b32 s13, s5, 0xffff
s_mov_b32 s14, 4718592
s_mov_b32 s15, 0x20000
v_and_b32 v1, 63, v0
v_lshlrev_b32 v1, 4, v1
v_bfe_u32 v12, v0, 3, 3
v_mul_u32_u24 v12, 1152, v12
v_bfe_u32 v13, v0, 4, 2
v_lshlrev_b32 v13, 1, v13
v_and_b32 v14, 7, v0
v_xor_b32 v13, v13, v14
v_lshl_add_u32 v12, v13, 4, v12
s_mul_i32 s24, s17, 1179648
s_lshl_b32 s25, s40, 7
s_add_u32 s24, s24, s25
v_add_u32 v2, s24, v12
s_lshl_b32 s26, s17, 15
v_bfe_u32 v12, v0, 2, 3
v_lshlrev_b32 v12, 7, v12
v_bfe_u32 v13, v0, 5, 1
v_lshl_add_u32 v12, v13, 11, v12
v_bfe_u32 v13, v0, 3, 2
v_lshl_add_u32 v12, v13, 5, v12
v_and_b32 v13, 3, v0
v_lshl_add_u32 v12, v13, 3, v12
v_add_u32 v8, s26, v12
v_xor_b32 v9, 32, v8
v_xor_b32 v10, 64, v8
v_xor_b32 v11, 96, v8
s_add_u32 s24, s40, 0
s_and_b32 s24, s24, 7
s_lshl_b32 s30, s24, 12
s_add_u32 s24, s40, 1
s_and_b32 s24, s24, 7
s_lshl_b32 s31, s24, 12
s_add_u32 s24, s40, 2
s_and_b32 s24, s24, 7
s_lshl_b32 s32, s24, 12
s_add_u32 s24, s40, 3
s_and_b32 s24, s24, 7
s_lshl_b32 s33, s24, 12
s_add_u32 s24, s40, 4
s_and_b32 s24, s24, 7
s_lshl_b32 s34, s24, 12
s_add_u32 s24, s40, 5
s_and_b32 s24, s24, 7
s_lshl_b32 s35, s24, 12
s_add_u32 s24, s40, 6
s_and_b32 s24, s24, 7
s_lshl_b32 s36, s24, 12
s_add_u32 s24, s40, 7
s_and_b32 s24, s24, 7
s_lshl_b32 s37, s24, 12
s_mul_i32 s25, s30, 36
s_add_u32 m0, s26, 0
s_add_u32 s24, s25, 0
buffer_load_dwordx4 v2, s[20:23], s24 offen lds
s_add_u32 m0, s26, 1024
s_add_u32 s24, s25, 9216
buffer_load_dwordx4 v2, s[20:23], s24 offen lds
s_add_u32 m0, s26, 2048
s_add_u32 s24, s25, 18432
buffer_load_dwordx4 v2, s[20:23], s24 offen lds
s_add_u32 m0, s26, 3072
s_add_u32 s24, s25, 27648
buffer_load_dwordx4 v2, s[20:23], s24 offen lds
s_mul_i32 s25, s30, 36
s_add_u32 m0, s26, 4096
s_add_u32 s24, s25, 36864
buffer_load_dwordx4 v2, s[20:23], s24 offen lds
s_add_u32 m0, s26, 5120
s_add_u32 s24, s25, 46080
buffer_load_dwordx4 v2, s[20:23], s24 offen lds
s_add_u32 m0, s26, 6144
s_add_u32 s24, s25, 55296
buffer_load_dwordx4 v2, s[20:23], s24 offen lds
s_add_u32 m0, s26, 7168
s_add_u32 s24, s25, 64512
buffer_load_dwordx4 v2, s[20:23], s24 offen lds
s_mul_i32 s25, s30, 36
s_add_u32 m0, s26, 8192
s_add_u32 s24, s25, 73728
buffer_load_dwordx4 v2, s[20:23], s24 offen lds
s_add_u32 m0, s26, 9216
s_add_u32 s24, s25, 82944
buffer_load_dwordx4 v2, s[20:23], s24 offen lds
s_add_u32 m0, s26, 10240
s_add_u32 s24, s25, 92160
buffer_load_dwordx4 v2, s[20:23], s24 offen lds
s_add_u32 m0, s26, 11264
s_add_u32 s24, s25, 101376
buffer_load_dwordx4 v2, s[20:23], s24 offen lds
s_mul_i32 s25, s31, 36
s_add_u32 m0, s26, 12288
s_add_u32 s24, s25, 0
buffer_load_dwordx4 v2, s[20:23], s24 offen lds
s_add_u32 m0, s26, 13312
s_add_u32 s24, s25, 9216
buffer_load_dwordx4 v2, s[20:23], s24 offen lds
s_add_u32 m0, s26, 14336
s_add_u32 s24, s25, 18432
buffer_load_dwordx4 v2, s[20:23], s24 offen lds
s_add_u32 m0, s26, 15360
s_add_u32 s24, s25, 27648
buffer_load_dwordx4 v2, s[20:23], s24 offen lds
s_mul_i32 s25, s31, 36
s_add_u32 m0, s26, 16384
s_add_u32 s24, s25, 36864
buffer_load_dwordx4 v2, s[20:23], s24 offen lds
s_add_u32 m0, s26, 17408
s_add_u32 s24, s25, 46080
buffer_load_dwordx4 v2, s[20:23], s24 offen lds
s_add_u32 m0, s26, 18432
s_add_u32 s24, s25, 55296
buffer_load_dwordx4 v2, s[20:23], s24 offen lds
s_add_u32 m0, s26, 19456
s_add_u32 s24, s25, 64512
buffer_load_dwordx4 v2, s[20:23], s24 offen lds
s_mul_i32 s25, s31, 36
s_add_u32 m0, s26, 20480
s_add_u32 s24, s25, 73728
buffer_load_dwordx4 v2, s[20:23], s24 offen lds
s_add_u32 m0, s26, 21504
s_add_u32 s24, s25, 82944
buffer_load_dwordx4 v2, s[20:23], s24 offen lds
s_add_u32 m0, s26, 22528
s_add_u32 s24, s25, 92160
buffer_load_dwordx4 v2, s[20:23], s24 offen lds
s_add_u32 m0, s26, 23552
s_add_u32 s24, s25, 101376
buffer_load_dwordx4 v2, s[20:23], s24 offen lds
s_mul_i32 s25, s32, 36
s_add_u32 m0, s26, 24576
s_add_u32 s24, s25, 0
buffer_load_dwordx4 v2, s[20:23], s24 offen lds
s_add_u32 m0, s26, 25600
s_add_u32 s24, s25, 9216
buffer_load_dwordx4 v2, s[20:23], s24 offen lds
s_add_u32 m0, s26, 26624
s_add_u32 s24, s25, 18432
buffer_load_dwordx4 v2, s[20:23], s24 offen lds
s_add_u32 m0, s26, 27648
s_add_u32 s24, s25, 27648
buffer_load_dwordx4 v2, s[20:23], s24 offen lds
s_mul_i32 s25, s32, 36
s_add_u32 m0, s26, 28672
s_add_u32 s24, s25, 36864
buffer_load_dwordx4 v2, s[20:23], s24 offen lds
s_add_u32 m0, s26, 29696
s_add_u32 s24, s25, 46080
buffer_load_dwordx4 v2, s[20:23], s24 offen lds
s_add_u32 m0, s26, 30720
s_add_u32 s24, s25, 55296
buffer_load_dwordx4 v2, s[20:23], s24 offen lds
s_add_u32 m0, s26, 31744
s_add_u32 s24, s25, 64512
buffer_load_dwordx4 v2, s[20:23], s24 offen lds
s_waitcnt vmcnt(28)
ds_read_b64_tr_b16 v[128:129], v8 offset:0
ds_read_b64_tr_b16 v[130:131], v8 offset:1024
ds_read_b64_tr_b16 v[132:133], v9 offset:0
ds_read_b64_tr_b16 v[134:135], v9 offset:1024
ds_read_b64_tr_b16 v[136:137], v10 offset:0
ds_read_b64_tr_b16 v[138:139], v10 offset:1024
ds_read_b64_tr_b16 v[140:141], v11 offset:0
ds_read_b64_tr_b16 v[142:143], v11 offset:1024
s_waitcnt lgkmcnt(0)
s_mul_i32 s25, s32, 36
s_add_u32 m0, s26, 0
s_add_u32 s24, s25, 73728
buffer_load_dwordx4 v2, s[20:23], s24 offen lds
s_add_u32 m0, s26, 1024
s_add_u32 s24, s25, 82944
buffer_load_dwordx4 v2, s[20:23], s24 offen lds
s_add_u32 m0, s26, 2048
s_add_u32 s24, s25, 92160
buffer_load_dwordx4 v2, s[20:23], s24 offen lds
s_add_u32 m0, s26, 3072
s_add_u32 s24, s25, 101376
buffer_load_dwordx4 v2, s[20:23], s24 offen lds
s_waitcnt vmcnt(28)
ds_read_b64_tr_b16 v[144:145], v8 offset:4096
ds_read_b64_tr_b16 v[146:147], v8 offset:5120
ds_read_b64_tr_b16 v[148:149], v9 offset:4096
ds_read_b64_tr_b16 v[150:151], v9 offset:5120
ds_read_b64_tr_b16 v[152:153], v10 offset:4096
ds_read_b64_tr_b16 v[154:155], v10 offset:5120
ds_read_b64_tr_b16 v[156:157], v11 offset:4096
ds_read_b64_tr_b16 v[158:159], v11 offset:5120
s_waitcnt lgkmcnt(0)
s_mul_i32 s25, s33, 36
s_add_u32 m0, s26, 4096
s_add_u32 s24, s25, 0
buffer_load_dwordx4 v2, s[20:23], s24 offen lds
s_add_u32 m0, s26, 5120
s_add_u32 s24, s25, 9216
buffer_load_dwordx4 v2, s[20:23], s24 offen lds
s_add_u32 m0, s26, 6144
s_add_u32 s24, s25, 18432
buffer_load_dwordx4 v2, s[20:23], s24 offen lds
s_add_u32 m0, s26, 7168
s_add_u32 s24, s25, 27648
buffer_load_dwordx4 v2, s[20:23], s24 offen lds
s_waitcnt vmcnt(28)
ds_read_b64_tr_b16 v[160:161], v8 offset:8192
ds_read_b64_tr_b16 v[162:163], v8 offset:9216
ds_read_b64_tr_b16 v[164:165], v9 offset:8192
ds_read_b64_tr_b16 v[166:167], v9 offset:9216
ds_read_b64_tr_b16 v[168:169], v10 offset:8192
ds_read_b64_tr_b16 v[170:171], v10 offset:9216
ds_read_b64_tr_b16 v[172:173], v11 offset:8192
ds_read_b64_tr_b16 v[174:175], v11 offset:9216
s_waitcnt lgkmcnt(0)
s_mul_i32 s25, s33, 36
s_add_u32 m0, s26, 8192
s_add_u32 s24, s25, 36864
buffer_load_dwordx4 v2, s[20:23], s24 offen lds
s_add_u32 m0, s26, 9216
s_add_u32 s24, s25, 46080
buffer_load_dwordx4 v2, s[20:23], s24 offen lds
s_add_u32 m0, s26, 10240
s_add_u32 s24, s25, 55296
buffer_load_dwordx4 v2, s[20:23], s24 offen lds
s_add_u32 m0, s26, 11264
s_add_u32 s24, s25, 64512
buffer_load_dwordx4 v2, s[20:23], s24 offen lds
s_waitcnt vmcnt(28)
ds_read_b64_tr_b16 v[176:177], v8 offset:12288
ds_read_b64_tr_b16 v[178:179], v8 offset:13312
ds_read_b64_tr_b16 v[180:181], v9 offset:12288
ds_read_b64_tr_b16 v[182:183], v9 offset:13312
ds_read_b64_tr_b16 v[184:185], v10 offset:12288
ds_read_b64_tr_b16 v[186:187], v10 offset:13312
ds_read_b64_tr_b16 v[188:189], v11 offset:12288
ds_read_b64_tr_b16 v[190:191], v11 offset:13312
s_waitcnt lgkmcnt(0)
s_mul_i32 s25, s33, 36
s_add_u32 m0, s26, 12288
s_add_u32 s24, s25, 73728
buffer_load_dwordx4 v2, s[20:23], s24 offen lds
s_add_u32 m0, s26, 13312
s_add_u32 s24, s25, 82944
buffer_load_dwordx4 v2, s[20:23], s24 offen lds
s_add_u32 m0, s26, 14336
s_add_u32 s24, s25, 92160
buffer_load_dwordx4 v2, s[20:23], s24 offen lds
s_add_u32 m0, s26, 15360
s_add_u32 s24, s25, 101376
buffer_load_dwordx4 v2, s[20:23], s24 offen lds
s_waitcnt vmcnt(28)
ds_read_b64_tr_b16 v[192:193], v8 offset:16384
ds_read_b64_tr_b16 v[194:195], v8 offset:17408
ds_read_b64_tr_b16 v[196:197], v9 offset:16384
ds_read_b64_tr_b16 v[198:199], v9 offset:17408
ds_read_b64_tr_b16 v[200:201], v10 offset:16384
ds_read_b64_tr_b16 v[202:203], v10 offset:17408
ds_read_b64_tr_b16 v[204:205], v11 offset:16384
ds_read_b64_tr_b16 v[206:207], v11 offset:17408
s_waitcnt lgkmcnt(0)
s_mul_i32 s25, s34, 36
s_add_u32 m0, s26, 16384
s_add_u32 s24, s25, 0
buffer_load_dwordx4 v2, s[20:23], s24 offen lds
s_add_u32 m0, s26, 17408
s_add_u32 s24, s25, 9216
buffer_load_dwordx4 v2, s[20:23], s24 offen lds
s_add_u32 m0, s26, 18432
s_add_u32 s24, s25, 18432
buffer_load_dwordx4 v2, s[20:23], s24 offen lds
s_add_u32 m0, s26, 19456
s_add_u32 s24, s25, 27648
buffer_load_dwordx4 v2, s[20:23], s24 offen lds
s_waitcnt vmcnt(28)
ds_read_b64_tr_b16 v[208:209], v8 offset:20480
ds_read_b64_tr_b16 v[210:211], v8 offset:21504
ds_read_b64_tr_b16 v[212:213], v9 offset:20480
ds_read_b64_tr_b16 v[214:215], v9 offset:21504
ds_read_b64_tr_b16 v[216:217], v10 offset:20480
ds_read_b64_tr_b16 v[218:219], v10 offset:21504
ds_read_b64_tr_b16 v[220:221], v11 offset:20480
ds_read_b64_tr_b16 v[222:223], v11 offset:21504
s_waitcnt lgkmcnt(0)
s_mul_i32 s25, s34, 36
s_add_u32 m0, s26, 20480
s_add_u32 s24, s25, 36864
buffer_load_dwordx4 v2, s[20:23], s24 offen lds
s_add_u32 m0, s26, 21504
s_add_u32 s24, s25, 46080
buffer_load_dwordx4 v2, s[20:23], s24 offen lds
s_add_u32 m0, s26, 22528
s_add_u32 s24, s25, 55296
buffer_load_dwordx4 v2, s[20:23], s24 offen lds
s_add_u32 m0, s26, 23552
s_add_u32 s24, s25, 64512
buffer_load_dwordx4 v2, s[20:23], s24 offen lds
s_waitcnt vmcnt(28)
ds_read_b64_tr_b16 v[224:225], v8 offset:24576
ds_read_b64_tr_b16 v[226:227], v8 offset:25600
ds_read_b64_tr_b16 v[228:229], v9 offset:24576
ds_read_b64_tr_b16 v[230:231], v9 offset:25600
ds_read_b64_tr_b16 v[232:233], v10 offset:24576
ds_read_b64_tr_b16 v[234:235], v10 offset:25600
ds_read_b64_tr_b16 v[236:237], v11 offset:24576
ds_read_b64_tr_b16 v[238:239], v11 offset:25600
s_waitcnt lgkmcnt(0)
s_mul_i32 s25, s34, 36
s_add_u32 m0, s26, 24576
s_add_u32 s24, s25, 73728
buffer_load_dwordx4 v2, s[20:23], s24 offen lds
s_add_u32 m0, s26, 25600
s_add_u32 s24, s25, 82944
buffer_load_dwordx4 v2, s[20:23], s24 offen lds
s_add_u32 m0, s26, 26624
s_add_u32 s24, s25, 92160
buffer_load_dwordx4 v2, s[20:23], s24 offen lds
s_add_u32 m0, s26, 27648
s_add_u32 s24, s25, 101376
buffer_load_dwordx4 v2, s[20:23], s24 offen lds
s_waitcnt vmcnt(28)
ds_read_b64_tr_b16 v[240:241], v8 offset:28672
ds_read_b64_tr_b16 v[242:243], v8 offset:29696
ds_read_b64_tr_b16 v[244:245], v9 offset:28672
ds_read_b64_tr_b16 v[246:247], v9 offset:29696
ds_read_b64_tr_b16 v[248:249], v10 offset:28672
ds_read_b64_tr_b16 v[250:251], v10 offset:29696
ds_read_b64_tr_b16 v[252:253], v11 offset:28672
ds_read_b64_tr_b16 v[254:255], v11 offset:29696
s_waitcnt lgkmcnt(0)
s_mul_i32 s25, s35, 36
s_add_u32 m0, s26, 28672
s_add_u32 s24, s25, 0
buffer_load_dwordx4 v2, s[20:23], s24 offen lds
s_add_u32 m0, s26, 29696
s_add_u32 s24, s25, 9216
buffer_load_dwordx4 v2, s[20:23], s24 offen lds
s_add_u32 m0, s26, 30720
s_add_u32 s24, s25, 18432
buffer_load_dwordx4 v2, s[20:23], s24 offen lds
s_add_u32 m0, s26, 31744
s_add_u32 s24, s25, 27648
buffer_load_dwordx4 v2, s[20:23], s24 offen lds
s_waitcnt vmcnt(28)
ds_read_b64_tr_b16 a[0:1], v8 offset:0
ds_read_b64_tr_b16 a[2:3], v8 offset:1024
ds_read_b64_tr_b16 a[4:5], v9 offset:0
ds_read_b64_tr_b16 a[6:7], v9 offset:1024
ds_read_b64_tr_b16 a[8:9], v10 offset:0
ds_read_b64_tr_b16 a[10:11], v10 offset:1024
ds_read_b64_tr_b16 a[12:13], v11 offset:0
ds_read_b64_tr_b16 a[14:15], v11 offset:1024
s_waitcnt lgkmcnt(0)
s_mul_i32 s25, s35, 36
s_add_u32 m0, s26, 0
s_add_u32 s24, s25, 36864
buffer_load_dwordx4 v2, s[20:23], s24 offen lds
s_add_u32 m0, s26, 1024
s_add_u32 s24, s25, 46080
buffer_load_dwordx4 v2, s[20:23], s24 offen lds
s_add_u32 m0, s26, 2048
s_add_u32 s24, s25, 55296
buffer_load_dwordx4 v2, s[20:23], s24 offen lds
s_add_u32 m0, s26, 3072
s_add_u32 s24, s25, 64512
buffer_load_dwordx4 v2, s[20:23], s24 offen lds
s_waitcnt vmcnt(28)
ds_read_b64_tr_b16 a[16:17], v8 offset:4096
ds_read_b64_tr_b16 a[18:19], v8 offset:5120
ds_read_b64_tr_b16 a[20:21], v9 offset:4096
ds_read_b64_tr_b16 a[22:23], v9 offset:5120
ds_read_b64_tr_b16 a[24:25], v10 offset:4096
ds_read_b64_tr_b16 a[26:27], v10 offset:5120
ds_read_b64_tr_b16 a[28:29], v11 offset:4096
ds_read_b64_tr_b16 a[30:31], v11 offset:5120
s_waitcnt lgkmcnt(0)
s_mul_i32 s25, s35, 36
s_add_u32 m0, s26, 4096
s_add_u32 s24, s25, 73728
buffer_load_dwordx4 v2, s[20:23], s24 offen lds
s_add_u32 m0, s26, 5120
s_add_u32 s24, s25, 82944
buffer_load_dwordx4 v2, s[20:23], s24 offen lds
s_add_u32 m0, s26, 6144
s_add_u32 s24, s25, 92160
buffer_load_dwordx4 v2, s[20:23], s24 offen lds
s_add_u32 m0, s26, 7168
s_add_u32 s24, s25, 101376
buffer_load_dwordx4 v2, s[20:23], s24 offen lds
s_waitcnt vmcnt(28)
ds_read_b64_tr_b16 a[32:33], v8 offset:8192
ds_read_b64_tr_b16 a[34:35], v8 offset:9216
ds_read_b64_tr_b16 a[36:37], v9 offset:8192
ds_read_b64_tr_b16 a[38:39], v9 offset:9216
ds_read_b64_tr_b16 a[40:41], v10 offset:8192
ds_read_b64_tr_b16 a[42:43], v10 offset:9216
ds_read_b64_tr_b16 a[44:45], v11 offset:8192
ds_read_b64_tr_b16 a[46:47], v11 offset:9216
s_waitcnt lgkmcnt(0)
s_mul_i32 s25, s36, 36
s_add_u32 m0, s26, 8192
s_add_u32 s24, s25, 0
buffer_load_dwordx4 v2, s[20:23], s24 offen lds
s_add_u32 m0, s26, 9216
s_add_u32 s24, s25, 9216
buffer_load_dwordx4 v2, s[20:23], s24 offen lds
s_add_u32 m0, s26, 10240
s_add_u32 s24, s25, 18432
buffer_load_dwordx4 v2, s[20:23], s24 offen lds
s_add_u32 m0, s26, 11264
s_add_u32 s24, s25, 27648
buffer_load_dwordx4 v2, s[20:23], s24 offen lds
s_waitcnt vmcnt(28)
ds_read_b64_tr_b16 a[48:49], v8 offset:12288
ds_read_b64_tr_b16 a[50:51], v8 offset:13312
ds_read_b64_tr_b16 a[52:53], v9 offset:12288
ds_read_b64_tr_b16 a[54:55], v9 offset:13312
ds_read_b64_tr_b16 a[56:57], v10 offset:12288
ds_read_b64_tr_b16 a[58:59], v10 offset:13312
ds_read_b64_tr_b16 a[60:61], v11 offset:12288
ds_read_b64_tr_b16 a[62:63], v11 offset:13312
s_waitcnt lgkmcnt(0)
s_mul_i32 s25, s36, 36
s_add_u32 m0, s26, 12288
s_add_u32 s24, s25, 36864
buffer_load_dwordx4 v2, s[20:23], s24 offen lds
s_add_u32 m0, s26, 13312
s_add_u32 s24, s25, 46080
buffer_load_dwordx4 v2, s[20:23], s24 offen lds
s_add_u32 m0, s26, 14336
s_add_u32 s24, s25, 55296
buffer_load_dwordx4 v2, s[20:23], s24 offen lds
s_add_u32 m0, s26, 15360
s_add_u32 s24, s25, 64512
buffer_load_dwordx4 v2, s[20:23], s24 offen lds
s_waitcnt vmcnt(28)
ds_read_b64_tr_b16 a[64:65], v8 offset:16384
ds_read_b64_tr_b16 a[66:67], v8 offset:17408
ds_read_b64_tr_b16 a[68:69], v9 offset:16384
ds_read_b64_tr_b16 a[70:71], v9 offset:17408
ds_read_b64_tr_b16 a[72:73], v10 offset:16384
ds_read_b64_tr_b16 a[74:75], v10 offset:17408
ds_read_b64_tr_b16 a[76:77], v11 offset:16384
ds_read_b64_tr_b16 a[78:79], v11 offset:17408
s_waitcnt lgkmcnt(0)
s_mul_i32 s25, s36, 36
s_add_u32 m0, s26, 16384
s_add_u32 s24, s25, 73728
buffer_load_dwordx4 v2, s[20:23], s24 offen lds
s_add_u32 m0, s26, 17408
s_add_u32 s24, s25, 82944
buffer_load_dwordx4 v2, s[20:23], s24 offen lds
s_add_u32 m0, s26, 18432
s_add_u32 s24, s25, 92160
buffer_load_dwordx4 v2, s[20:23], s24 offen lds
s_add_u32 m0, s26, 19456
s_add_u32 s24, s25, 101376
buffer_load_dwordx4 v2, s[20:23], s24 offen lds
s_waitcnt vmcnt(28)
ds_read_b64_tr_b16 a[80:81], v8 offset:20480
ds_read_b64_tr_b16 a[82:83], v8 offset:21504
ds_read_b64_tr_b16 a[84:85], v9 offset:20480
ds_read_b64_tr_b16 a[86:87], v9 offset:21504
ds_read_b64_tr_b16 a[88:89], v10 offset:20480
ds_read_b64_tr_b16 a[90:91], v10 offset:21504
ds_read_b64_tr_b16 a[92:93], v11 offset:20480
ds_read_b64_tr_b16 a[94:95], v11 offset:21504
s_waitcnt lgkmcnt(0)
s_mul_i32 s25, s37, 36
s_add_u32 m0, s26, 20480
s_add_u32 s24, s25, 0
buffer_load_dwordx4 v2, s[20:23], s24 offen lds
s_add_u32 m0, s26, 21504
s_add_u32 s24, s25, 9216
buffer_load_dwordx4 v2, s[20:23], s24 offen lds
s_add_u32 m0, s26, 22528
s_add_u32 s24, s25, 18432
buffer_load_dwordx4 v2, s[20:23], s24 offen lds
s_add_u32 m0, s26, 23552
s_add_u32 s24, s25, 27648
buffer_load_dwordx4 v2, s[20:23], s24 offen lds
s_waitcnt vmcnt(28)
ds_read_b64_tr_b16 a[96:97], v8 offset:24576
ds_read_b64_tr_b16 a[98:99], v8 offset:25600
ds_read_b64_tr_b16 a[100:101], v9 offset:24576
ds_read_b64_tr_b16 a[102:103], v9 offset:25600
ds_read_b64_tr_b16 a[104:105], v10 offset:24576
ds_read_b64_tr_b16 a[106:107], v10 offset:25600
ds_read_b64_tr_b16 a[108:109], v11 offset:24576
ds_read_b64_tr_b16 a[110:111], v11 offset:25600
s_waitcnt lgkmcnt(0)
s_mul_i32 s25, s37, 36
s_add_u32 m0, s26, 24576
s_add_u32 s24, s25, 36864
buffer_load_dwordx4 v2, s[20:23], s24 offen lds
s_add_u32 m0, s26, 25600
s_add_u32 s24, s25, 46080
buffer_load_dwordx4 v2, s[20:23], s24 offen lds
s_add_u32 m0, s26, 26624
s_add_u32 s24, s25, 55296
buffer_load_dwordx4 v2, s[20:23], s24 offen lds
s_add_u32 m0, s26, 27648
s_add_u32 s24, s25, 64512
buffer_load_dwordx4 v2, s[20:23], s24 offen lds
s_waitcnt vmcnt(28)
ds_read_b64_tr_b16 a[112:113], v8 offset:28672
ds_read_b64_tr_b16 a[114:115], v8 offset:29696
ds_read_b64_tr_b16 a[116:117], v9 offset:28672
ds_read_b64_tr_b16 a[118:119], v9 offset:29696
ds_read_b64_tr_b16 a[120:121], v10 offset:28672
ds_read_b64_tr_b16 a[122:123], v10 offset:29696
ds_read_b64_tr_b16 a[124:125], v11 offset:28672
ds_read_b64_tr_b16 a[126:127], v11 offset:29696
s_waitcnt lgkmcnt(0)
s_mul_i32 s25, s37, 36
s_add_u32 m0, s26, 28672
s_add_u32 s24, s25, 73728
buffer_load_dwordx4 v2, s[20:23], s24 offen lds
s_add_u32 m0, s26, 29696
s_add_u32 s24, s25, 82944
buffer_load_dwordx4 v2, s[20:23], s24 offen lds
s_add_u32 m0, s26, 30720
s_add_u32 s24, s25, 92160
buffer_load_dwordx4 v2, s[20:23], s24 offen lds
s_add_u32 m0, s26, 31744
s_add_u32 s24, s25, 101376
buffer_load_dwordx4 v2, s[20:23], s24 offen lds
s_waitcnt vmcnt(28)
ds_read_b64_tr_b16 a[128:129], v8 offset:0
ds_read_b64_tr_b16 a[130:131], v8 offset:1024
ds_read_b64_tr_b16 a[132:133], v9 offset:0
ds_read_b64_tr_b16 a[134:135], v9 offset:1024
ds_read_b64_tr_b16 a[136:137], v10 offset:0
ds_read_b64_tr_b16 a[138:139], v10 offset:1024
ds_read_b64_tr_b16 a[140:141], v11 offset:0
ds_read_b64_tr_b16 a[142:143], v11 offset:1024
s_waitcnt lgkmcnt(0)
s_mul_i32 s25, s30, 36
s_add_u32 m0, s26, 0
s_add_u32 s24, s25, 110592
buffer_load_dwordx4 v2, s[20:23], s24 offen lds
s_add_u32 m0, s26, 1024
s_add_u32 s24, s25, 119808
buffer_load_dwordx4 v2, s[20:23], s24 offen lds
s_add_u32 m0, s26, 2048
s_add_u32 s24, s25, 129024
buffer_load_dwordx4 v2, s[20:23], s24 offen lds
s_add_u32 m0, s26, 3072
s_add_u32 s24, s25, 138240
buffer_load_dwordx4 v2, s[20:23], s24 offen lds
s_waitcnt vmcnt(28)
ds_read_b64_tr_b16 a[144:145], v8 offset:4096
ds_read_b64_tr_b16 a[146:147], v8 offset:5120
ds_read_b64_tr_b16 a[148:149], v9 offset:4096
ds_read_b64_tr_b16 a[150:151], v9 offset:5120
ds_read_b64_tr_b16 a[152:153], v10 offset:4096
ds_read_b64_tr_b16 a[154:155], v10 offset:5120
ds_read_b64_tr_b16 a[156:157], v11 offset:4096
ds_read_b64_tr_b16 a[158:159], v11 offset:5120
s_waitcnt lgkmcnt(0)
s_mul_i32 s25, s31, 36
s_add_u32 m0, s26, 4096
s_add_u32 s24, s25, 110592
buffer_load_dwordx4 v2, s[20:23], s24 offen lds
s_add_u32 m0, s26, 5120
s_add_u32 s24, s25, 119808
buffer_load_dwordx4 v2, s[20:23], s24 offen lds
s_add_u32 m0, s26, 6144
s_add_u32 s24, s25, 129024
buffer_load_dwordx4 v2, s[20:23], s24 offen lds
s_add_u32 m0, s26, 7168
s_add_u32 s24, s25, 138240
buffer_load_dwordx4 v2, s[20:23], s24 offen lds
s_waitcnt vmcnt(28)
ds_read_b64_tr_b16 a[160:161], v8 offset:8192
ds_read_b64_tr_b16 a[162:163], v8 offset:9216
ds_read_b64_tr_b16 a[164:165], v9 offset:8192
ds_read_b64_tr_b16 a[166:167], v9 offset:9216
ds_read_b64_tr_b16 a[168:169], v10 offset:8192
ds_read_b64_tr_b16 a[170:171], v10 offset:9216
ds_read_b64_tr_b16 a[172:173], v11 offset:8192
ds_read_b64_tr_b16 a[174:175], v11 offset:9216
s_waitcnt lgkmcnt(0)
s_mul_i32 s25, s32, 36
s_add_u32 m0, s26, 8192
s_add_u32 s24, s25, 110592
buffer_load_dwordx4 v2, s[20:23], s24 offen lds
s_add_u32 m0, s26, 9216
s_add_u32 s24, s25, 119808
buffer_load_dwordx4 v2, s[20:23], s24 offen lds
s_add_u32 m0, s26, 10240
s_add_u32 s24, s25, 129024
buffer_load_dwordx4 v2, s[20:23], s24 offen lds
s_add_u32 m0, s26, 11264
s_add_u32 s24, s25, 138240
buffer_load_dwordx4 v2, s[20:23], s24 offen lds
s_waitcnt vmcnt(28)
ds_read_b64_tr_b16 a[176:177], v8 offset:12288
ds_read_b64_tr_b16 a[178:179], v8 offset:13312
ds_read_b64_tr_b16 a[180:181], v9 offset:12288
ds_read_b64_tr_b16 a[182:183], v9 offset:13312
ds_read_b64_tr_b16 a[184:185], v10 offset:12288
ds_read_b64_tr_b16 a[186:187], v10 offset:13312
ds_read_b64_tr_b16 a[188:189], v11 offset:12288
ds_read_b64_tr_b16 a[190:191], v11 offset:13312
s_waitcnt lgkmcnt(0)
s_mul_i32 s25, s33, 36
s_add_u32 m0, s26, 12288
s_add_u32 s24, s25, 110592
buffer_load_dwordx4 v2, s[20:23], s24 offen lds
s_add_u32 m0, s26, 13312
s_add_u32 s24, s25, 119808
buffer_load_dwordx4 v2, s[20:23], s24 offen lds
s_add_u32 m0, s26, 14336
s_add_u32 s24, s25, 129024
buffer_load_dwordx4 v2, s[20:23], s24 offen lds
s_add_u32 m0, s26, 15360
s_add_u32 s24, s25, 138240
buffer_load_dwordx4 v2, s[20:23], s24 offen lds
s_waitcnt vmcnt(28)
ds_read_b64_tr_b16 a[192:193], v8 offset:16384
ds_read_b64_tr_b16 a[194:195], v8 offset:17408
ds_read_b64_tr_b16 a[196:197], v9 offset:16384
ds_read_b64_tr_b16 a[198:199], v9 offset:17408
ds_read_b64_tr_b16 a[200:201], v10 offset:16384
ds_read_b64_tr_b16 a[202:203], v10 offset:17408
ds_read_b64_tr_b16 a[204:205], v11 offset:16384
ds_read_b64_tr_b16 a[206:207], v11 offset:17408
s_waitcnt lgkmcnt(0)
s_mul_i32 s25, s34, 36
s_add_u32 m0, s26, 16384
s_add_u32 s24, s25, 110592
buffer_load_dwordx4 v2, s[20:23], s24 offen lds
s_add_u32 m0, s26, 17408
s_add_u32 s24, s25, 119808
buffer_load_dwordx4 v2, s[20:23], s24 offen lds
s_add_u32 m0, s26, 18432
s_add_u32 s24, s25, 129024
buffer_load_dwordx4 v2, s[20:23], s24 offen lds
s_add_u32 m0, s26, 19456
s_add_u32 s24, s25, 138240
buffer_load_dwordx4 v2, s[20:23], s24 offen lds
s_waitcnt vmcnt(28)
ds_read_b64_tr_b16 a[208:209], v8 offset:20480
ds_read_b64_tr_b16 a[210:211], v8 offset:21504
ds_read_b64_tr_b16 a[212:213], v9 offset:20480
ds_read_b64_tr_b16 a[214:215], v9 offset:21504
ds_read_b64_tr_b16 a[216:217], v10 offset:20480
ds_read_b64_tr_b16 a[218:219], v10 offset:21504
ds_read_b64_tr_b16 a[220:221], v11 offset:20480
ds_read_b64_tr_b16 a[222:223], v11 offset:21504
s_waitcnt lgkmcnt(0)
s_mul_i32 s25, s35, 36
s_add_u32 m0, s26, 20480
s_add_u32 s24, s25, 110592
buffer_load_dwordx4 v2, s[20:23], s24 offen lds
s_add_u32 m0, s26, 21504
s_add_u32 s24, s25, 119808
buffer_load_dwordx4 v2, s[20:23], s24 offen lds
s_add_u32 m0, s26, 22528
s_add_u32 s24, s25, 129024
buffer_load_dwordx4 v2, s[20:23], s24 offen lds
s_add_u32 m0, s26, 23552
s_add_u32 s24, s25, 138240
buffer_load_dwordx4 v2, s[20:23], s24 offen lds
s_waitcnt vmcnt(28)
ds_read_b64_tr_b16 a[224:225], v8 offset:24576
ds_read_b64_tr_b16 a[226:227], v8 offset:25600
ds_read_b64_tr_b16 a[228:229], v9 offset:24576
ds_read_b64_tr_b16 a[230:231], v9 offset:25600
ds_read_b64_tr_b16 a[232:233], v10 offset:24576
ds_read_b64_tr_b16 a[234:235], v10 offset:25600
ds_read_b64_tr_b16 a[236:237], v11 offset:24576
ds_read_b64_tr_b16 a[238:239], v11 offset:25600
s_waitcnt lgkmcnt(0)
s_mul_i32 s25, s36, 36
s_add_u32 m0, s26, 24576
s_add_u32 s24, s25, 110592
buffer_load_dwordx4 v2, s[20:23], s24 offen lds
s_add_u32 m0, s26, 25600
s_add_u32 s24, s25, 119808
buffer_load_dwordx4 v2, s[20:23], s24 offen lds
s_add_u32 m0, s26, 26624
s_add_u32 s24, s25, 129024
buffer_load_dwordx4 v2, s[20:23], s24 offen lds
s_add_u32 m0, s26, 27648
s_add_u32 s24, s25, 138240
buffer_load_dwordx4 v2, s[20:23], s24 offen lds
s_waitcnt vmcnt(28)
ds_read_b64_tr_b16 a[240:241], v8 offset:28672
ds_read_b64_tr_b16 a[242:243], v8 offset:29696
ds_read_b64_tr_b16 a[244:245], v9 offset:28672
ds_read_b64_tr_b16 a[246:247], v9 offset:29696
ds_read_b64_tr_b16 a[248:249], v10 offset:28672
ds_read_b64_tr_b16 a[250:251], v10 offset:29696
ds_read_b64_tr_b16 a[252:253], v11 offset:28672
ds_read_b64_tr_b16 a[254:255], v11 offset:29696
s_waitcnt lgkmcnt(0)
s_mul_i32 s25, s37, 36
s_add_u32 m0, s26, 28672
s_add_u32 s24, s25, 110592
buffer_load_dwordx4 v2, s[20:23], s24 offen lds
s_add_u32 m0, s26, 29696
s_add_u32 s24, s25, 119808
buffer_load_dwordx4 v2, s[20:23], s24 offen lds
s_add_u32 m0, s26, 30720
s_add_u32 s24, s25, 129024
buffer_load_dwordx4 v2, s[20:23], s24 offen lds
s_add_u32 m0, s26, 31744
s_add_u32 s24, s25, 138240
buffer_load_dwordx4 v2, s[20:23], s24 offen lds
s_waitcnt vmcnt(0)
v_and_b32 v12, 15, v0
v_mul_u32_u24 v12, 2304, v12
v_lshrrev_b32 v13, 4, v0
v_lshl_add_u32 v12, v13, 3, v12
s_lshl_b32 s24, s40, 7
s_add_u32 s24, s24, s47
v_add_u32 v4, s24, v12
v_and_b32 v5, 31, v0
v_lshlrev_b32 v5, 2, v5
v_lshlrev_b32 v3, 4, v0
v_add_u32 v3, 131072, v3
s_lshl_b32 s24, s17, 12
s_add_u32 s24, s24, 131072
v_add_u32 v7, s24, v1
s_lshl_b32 s24, s17, 15
s_add_u32 s44, s44, s24
ds_read_b64_tr_b16 v[112:113], v8 offset:0
ds_read_b64_tr_b16 v[114:115], v8 offset:1024
ds_read_b64_tr_b16 v[116:117], v9 offset:0
ds_read_b64_tr_b16 v[118:119], v9 offset:1024
ds_read_b64_tr_b16 v[120:121], v10 offset:0
ds_read_b64_tr_b16 v[122:123], v10 offset:1024
ds_read_b64_tr_b16 v[124:125], v11 offset:0
ds_read_b64_tr_b16 v[126:127], v11 offset:1024
L_opl_w:
s_lshr_b32 s25, s41, s46
s_lshl_b32 s25, s25, 7
s_add_u32 s25, s25, s45
s_mov_b32 s28, 0
L_poll_41:
buffer_load_dword v6, v5, s[8:11], s25 offen sc1
s_add_u32 s28, s28, 1
s_cmp_gt_u32 s28, 40000
s_cbranch_scc1 L_end
s_waitcnt vmcnt(0)
v_cmp_ne_u32 vcc, 1, v6
s_cbranch_vccz L_pd_42
s_sleep 1
s_branch L_poll_41
L_pd_42:
s_lshl_b32 s48, s41, 17
s_add_u32 s48, s48, s44
s_add_u32 s24, s48, s30
buffer_load_dwordx4 v[16:19], v1, s[8:11], s24 offen offset:0 sc1
buffer_load_dwordx4 v[20:23], v1, s[8:11], s24 offen offset:1024 sc1
buffer_load_dwordx4 v[24:27], v1, s[8:11], s24 offen offset:2048 sc1
buffer_load_dwordx4 v[28:31], v1, s[8:11], s24 offen offset:3072 sc1
s_add_u32 s24, s48, s31
buffer_load_dwordx4 v[32:35], v1, s[8:11], s24 offen offset:0 sc1
buffer_load_dwordx4 v[36:39], v1, s[8:11], s24 offen offset:1024 sc1
buffer_load_dwordx4 v[40:43], v1, s[8:11], s24 offen offset:2048 sc1
buffer_load_dwordx4 v[44:47], v1, s[8:11], s24 offen offset:3072 sc1
s_add_u32 s24, s48, s32
buffer_load_dwordx4 v[48:51], v1, s[8:11], s24 offen offset:0 sc1
buffer_load_dwordx4 v[52:55], v1, s[8:11], s24 offen offset:1024 sc1
buffer_load_dwordx4 v[56:59], v1, s[8:11], s24 offen offset:2048 sc1
buffer_load_dwordx4 v[60:63], v1, s[8:11], s24 offen offset:3072 sc1
s_add_u32 s24, s48, s33
buffer_load_dwordx4 v[64:67], v1, s[8:11], s24 offen offset:0 sc1
buffer_load_dwordx4 v[68:71], v1, s[8:11], s24 offen offset:1024 sc1
buffer_load_dwordx4 v[72:75], v1, s[8:11], s24 offen offset:2048 sc1
buffer_load_dwordx4 v[76:79], v1, s[8:11], s24 offen offset:3072 sc1
s_add_u32 s24, s48, s34
buffer_load_dwordx4 v[80:83], v1, s[8:11], s24 offen offset:0 sc1
buffer_load_dwordx4 v[84:87], v1, s[8:11], s24 offen offset:1024 sc1
buffer_load_dwordx4 v[88:91], v1, s[8:11], s24 offen offset:2048 sc1
buffer_load_dwordx4 v[92:95], v1, s[8:11], s24 offen offset:3072 sc1
buffer_load_dword v6, v5, s[8:11], s25 offen sc1
L_opl_r0:
s_add_u32 s27, s41, s43
s_and_b32 s27, s27, 127
s_lshr_b32 s25, s27, s46
s_lshl_b32 s25, s25, 7
s_add_u32 s25, s25, s45
buffer_load_dword v6, v5, s[8:11], s25 offen sc1
s_lshl_b32 s49, s27, 17
s_add_u32 s49, s49, s44
s_waitcnt vmcnt(21)
v_mfma_f32_16x16x32_bf16 v[96:99], v[128:131], v[16:19], 0
v_mfma_f32_16x16x32_bf16 v[100:103], v[132:135], v[16:19], 0
v_mfma_f32_16x16x32_bf16 v[104:107], v[136:139], v[16:19], 0
v_mfma_f32_16x16x32_bf16 v[108:111], v[140:143], v[16:19], 0
s_add_u32 s24, s48, s35
buffer_load_dwordx4 v[16:19], v1, s[8:11], s24 offen offset:0 sc1
s_waitcnt vmcnt(21)
v_mfma_f32_16x16x32_bf16 v[96:99], v[144:147], v[20:23], v[96:99]
v_mfma_f32_16x16x32_bf16 v[100:103], v[148:151], v[20:23], v[100:103]
v_mfma_f32_16x16x32_bf16 v[104:107], v[152:155], v[20:23], v[104:107]
v_mfma_f32_16x16x32_bf16 v[108:111], v[156:159], v[20:23], v[108:111]
buffer_load_dwordx4 v[20:23], v1, s[8:11], s24 offen offset:1024 sc1
s_waitcnt vmcnt(21)
v_mfma_f32_16x16x32_bf16 v[96:99], v[160:163], v[24:27], v[96:99]
v_mfma_f32_16x16x32_bf16 v[100:103], v[164:167], v[24:27], v[100:103]
v_mfma_f32_16x16x32_bf16 v[104:107], v[168:171], v[24:27], v[104:107]
v_mfma_f32_16x16x32_bf16 v[108:111], v[172:175], v[24:27], v[108:111]
buffer_load_dwordx4 v[24:27], v1, s[8:11], s24 offen offset:2048 sc1
s_waitcnt vmcnt(21) lgkmcnt(0)
v_mfma_f32_16x16x32_bf16 v[96:99], v[112:115], v[28:31], v[96:99]
v_mfma_f32_16x16x32_bf16 v[100:103], v[116:119], v[28:31], v[100:103]
v_mfma_f32_16x16x32_bf16 v[104:107], v[120:123], v[28:31], v[104:107]
v_mfma_f32_16x16x32_bf16 v[108:111], v[124:127], v[28:31], v[108:111]
buffer_load_dwordx4 v[28:31], v1, s[8:11], s24 offen offset:3072 sc1
s_waitcnt vmcnt(21)
v_mfma_f32_16x16x32_bf16 v[96:99], v[176:179], v[32:35], v[96:99]
ds_read_b64_tr_b16 v[112:113], v8 offset:4096
v_mfma_f32_16x16x32_bf16 v[100:103], v[180:183], v[32:35], v[100:103]
ds_read_b64_tr_b16 v[114:115], v8 offset:5120
v_mfma_f32_16x16x32_bf16 v[104:107], v[184:187], v[32:35], v[104:107]
ds_read_b64_tr_b16 v[116:117], v9 offset:4096
v_mfma_f32_16x16x32_bf16 v[108:111], v[188:191], v[32:35], v[108:111]
ds_read_b64_tr_b16 v[118:119], v9 offset:5120
s_add_u32 s24, s48, s36
buffer_load_dwordx4 v[32:35], v1, s[8:11], s24 offen offset:0 sc1
s_waitcnt vmcnt(21)
v_mfma_f32_16x16x32_bf16 v[96:99], v[192:195], v[36:39], v[96:99]
ds_read_b64_tr_b16 v[120:121], v10 offset:4096
v_mfma_f32_16x16x32_bf16 v[100:103], v[196:199], v[36:39], v[100:103]
ds_read_b64_tr_b16 v[122:123], v10 offset:5120
v_mfma_f32_16x16x32_bf16 v[104:107], v[200:203], v[36:39], v[104:107]
ds_read_b64_tr_b16 v[124:125], v11 offset:4096
v_mfma_f32_16x16x32_bf16 v[108:111], v[204:207], v[36:39], v[108:111]
ds_read_b64_tr_b16 v[126:127], v11 offset:5120
buffer_load_dwordx4 v[36:39], v1, s[8:11], s24 offen offset:1024 sc1
s_waitcnt vmcnt(21)
v_mfma_f32_16x16x32_bf16 v[96:99], v[208:211], v[40:43], v[96:99]
v_mfma_f32_16x16x32_bf16 v[100:103], v[212:215], v[40:43], v[100:103]
v_mfma_f32_16x16x32_bf16 v[104:107], v[216:219], v[40:43], v[104:107]
v_mfma_f32_16x16x32_bf16 v[108:111], v[220:223], v[40:43], v[108:111]
buffer_load_dwordx4 v[40:43], v1, s[8:11], s24 offen offset:2048 sc1
s_waitcnt vmcnt(21) lgkmcnt(0)
v_mfma_f32_16x16x32_bf16 v[96:99], v[112:115], v[44:47], v[96:99]
v_mfma_f32_16x16x32_bf16 v[100:103], v[116:119], v[44:47], v[100:103]
v_mfma_f32_16x16x32_bf16 v[104:107], v[120:123], v[44:47], v[104:107]
v_mfma_f32_16x16x32_bf16 v[108:111], v[124:127], v[44:47], v[108:111]
buffer_load_dwordx4 v[44:47], v1, s[8:11], s24 offen offset:3072 sc1
s_waitcnt vmcnt(21)
v_mfma_f32_16x16x32_bf16 v[96:99], v[224:227], v[48:51], v[96:99]
ds_read_b64_tr_b16 v[112:113], v8 offset:8192
v_mfma_f32_16x16x32_bf16 v[100:103], v[228:231], v[48:51], v[100:103]
ds_read_b64_tr_b16 v[114:115], v8 offset:9216
v_mfma_f32_16x16x32_bf16 v[104:107], v[232:235], v[48:51], v[104:107]
ds_read_b64_tr_b16 v[116:117], v9 offset:8192
v_mfma_f32_16x16x32_bf16 v[108:111], v[236:239], v[48:51], v[108:111]
ds_read_b64_tr_b16 v[118:119], v9 offset:9216
s_add_u32 s24, s48, s37
buffer_load_dwordx4 v[48:51], v1, s[8:11], s24 offen offset:0 sc1
s_waitcnt vmcnt(21)
v_mfma_f32_16x16x32_bf16 v[96:99], v[240:243], v[52:55], v[96:99]
ds_read_b64_tr_b16 v[120:121], v10 offset:8192
v_mfma_f32_16x16x32_bf16 v[100:103], v[244:247], v[52:55], v[100:103]
ds_read_b64_tr_b16 v[122:123], v10 offset:9216
v_mfma_f32_16x16x32_bf16 v[104:107], v[248:251], v[52:55], v[104:107]
ds_read_b64_tr_b16 v[124:125], v11 offset:8192
v_mfma_f32_16x16x32_bf16 v[108:111], v[252:255], v[52:55], v[108:111]
ds_read_b64_tr_b16 v[126:127], v11 offset:9216
buffer_load_dwordx4 v[52:55], v1, s[8:11], s24 offen offset:1024 sc1
s_waitcnt vmcnt(21)
v_mfma_f32_16x16x32_bf16 v[96:99], a[0:3], v[56:59], v[96:99]
v_mfma_f32_16x16x32_bf16 v[100:103], a[4:7], v[56:59], v[100:103]
v_mfma_f32_16x16x32_bf16 v[104:107], a[8:11], v[56:59], v[104:107]
v_mfma_f32_16x16x32_bf16 v[108:111], a[12:15], v[56:59], v[108:111]
buffer_load_dwordx4 v[56:59], v1, s[8:11], s24 offen offset:2048 sc1
s_waitcnt vmcnt(21) lgkmcnt(0)
v_mfma_f32_16x16x32_bf16 v[96:99], v[112:115], v[60:63], v[96:99]
v_mfma_f32_16x16x32_bf16 v[100:103], v[116:119], v[60:63], v[100:103]
v_mfma_f32_16x16x32_bf16 v[104:107], v[120:123], v[60:63], v[104:107]
v_mfma_f32_16x16x32_bf16 v[108:111], v[124:127], v[60:63], v[108:111]
buffer_load_dwordx4 v[60:63], v1, s[8:11], s24 offen offset:3072 sc1
s_waitcnt vmcnt(21)
v_mfma_f32_16x16x32_bf16 v[96:99], a[16:19], v[64:67], v[96:99]
ds_read_b64_tr_b16 v[112:113], v8 offset:12288
v_mfma_f32_16x16x32_bf16 v[100:103], a[20:23], v[64:67], v[100:103]
ds_read_b64_tr_b16 v[114:115], v8 offset:13312
v_mfma_f32_16x16x32_bf16 v[104:107], a[24:27], v[64:67], v[104:107]
ds_read_b64_tr_b16 v[116:117], v9 offset:12288
v_mfma_f32_16x16x32_bf16 v[108:111], a[28:31], v[64:67], v[108:111]
ds_read_b64_tr_b16 v[118:119], v9 offset:13312
s_waitcnt vmcnt(12)
v_cmp_ne_u32 vcc, 1, v6
s_cmp_gt_u32 s42, 1
s_cselect_b32 s50, 1, 0
s_cmp_eq_u64 vcc, 0
s_cselect_b32 s50, s50, 0
s_cmp_eq_u32 s50, 1
s_cselect_b32 s49, s49, 536870912
s_add_u32 s24, s49, s30
buffer_load_dwordx4 v[64:67], v1, s[8:11], s24 offen offset:0 sc1
s_waitcnt vmcnt(21)
v_mfma_f32_16x16x32_bf16 v[96:99], a[32:35], v[68:71], v[96:99]
ds_read_b64_tr_b16 v[120:121], v10 offset:12288
v_mfma_f32_16x16x32_bf16 v[100:103], a[36:39], v[68:71], v[100:103]
ds_read_b64_tr_b16 v[122:123], v10 offset:13312
v_mfma_f32_16x16x32_bf16 v[104:107], a[40:43], v[68:71], v[104:107]
ds_read_b64_tr_b16 v[124:125], v11 offset:12288
v_mfma_f32_16x16x32_bf16 v[108:111], a[44:47], v[68:71], v[108:111]
ds_read_b64_tr_b16 v[126:127], v11 offset:13312
buffer_load_dwordx4 v[68:71], v1, s[8:11], s24 offen offset:1024 sc1
s_waitcnt vmcnt(21)
v_mfma_f32_16x16x32_bf16 v[96:99], a[48:51], v[72:75], v[96:99]
v_mfma_f32_16x16x32_bf16 v[100:103], a[52:55], v[72:75], v[100:103]
v_mfma_f32_16x16x32_bf16 v[104:107], a[56:59], v[72:75], v[104:107]
v_mfma_f32_16x16x32_bf16 v[108:111], a[60:63], v[72:75], v[108:111]
buffer_load_dwordx4 v[72:75], v1, s[8:11], s24 offen offset:2048 sc1
s_waitcnt vmcnt(21) lgkmcnt(0)
v_mfma_f32_16x16x32_bf16 v[96:99], v[112:115], v[76:79], v[96:99]
v_mfma_f32_16x16x32_bf16 v[100:103], v[116:119], v[76:79], v[100:103]
v_mfma_f32_16x16x32_bf16 v[104:107], v[120:123], v[76:79], v[104:107]
v_mfma_f32_16x16x32_bf16 v[108:111], v[124:127], v[76:79], v[108:111]
buffer_load_dwordx4 v[76:79], v1, s[8:11], s24 offen offset:3072 sc1
s_waitcnt vmcnt(21)
v_mfma_f32_16x16x32_bf16 v[96:99], a[64:67], v[80:83], v[96:99]
ds_read_b64_tr_b16 v[112:113], v8 offset:16384
v_mfma_f32_16x16x32_bf16 v[100:103], a[68:71], v[80:83], v[100:103]
ds_read_b64_tr_b16 v[114:115], v8 offset:17408
v_mfma_f32_16x16x32_bf16 v[104:107], a[72:75], v[80:83], v[104:107]
ds_read_b64_tr_b16 v[116:117], v9 offset:16384
v_mfma_f32_16x16x32_bf16 v[108:111], a[76:79], v[80:83], v[108:111]
ds_read_b64_tr_b16 v[118:119], v9 offset:17408
s_add_u32 s24, s49, s31
buffer_load_dwordx4 v[80:83], v1, s[8:11], s24 offen offset:0 sc1
s_waitcnt vmcnt(21)
v_mfma_f32_16x16x32_bf16 v[96:99], a[80:83], v[84:87], v[96:99]
ds_read_b64_tr_b16 v[120:121], v10 offset:16384
v_mfma_f32_16x16x32_bf16 v[100:103], a[84:87], v[84:87], v[100:103]
ds_read_b64_tr_b16 v[122:123], v10 offset:17408
v_mfma_f32_16x16x32_bf16 v[104:107], a[88:91], v[84:87], v[104:107]
ds_read_b64_tr_b16 v[124:125], v11 offset:16384
v_mfma_f32_16x16x32_bf16 v[108:111], a[92:95], v[84:87], v[108:111]
ds_read_b64_tr_b16 v[126:127], v11 offset:17408
buffer_load_dwordx4 v[84:87], v1, s[8:11], s24 offen offset:1024 sc1
s_waitcnt vmcnt(21)
v_mfma_f32_16x16x32_bf16 v[96:99], a[96:99], v[88:91], v[96:99]
v_mfma_f32_16x16x32_bf16 v[100:103], a[100:103], v[88:91], v[100:103]
v_mfma_f32_16x16x32_bf16 v[104:107], a[104:107], v[88:91], v[104:107]
v_mfma_f32_16x16x32_bf16 v[108:111], a[108:111], v[88:91], v[108:111]
buffer_load_dwordx4 v[88:91], v1, s[8:11], s24 offen offset:2048 sc1
s_waitcnt vmcnt(21) lgkmcnt(0)
v_mfma_f32_16x16x32_bf16 v[96:99], v[112:115], v[92:95], v[96:99]
v_mfma_f32_16x16x32_bf16 v[100:103], v[116:119], v[92:95], v[100:103]
v_mfma_f32_16x16x32_bf16 v[104:107], v[120:123], v[92:95], v[104:107]
v_mfma_f32_16x16x32_bf16 v[108:111], v[124:127], v[92:95], v[108:111]
buffer_load_dwordx4 v[92:95], v1, s[8:11], s24 offen offset:3072 sc1
s_waitcnt vmcnt(19)
v_mfma_f32_16x16x32_bf16 v[96:99], a[112:115], v[16:19], v[96:99]
ds_read_b64_tr_b16 v[112:113], v8 offset:20480
v_mfma_f32_16x16x32_bf16 v[100:103], a[116:119], v[16:19], v[100:103]
ds_read_b64_tr_b16 v[114:115], v8 offset:21504
v_mfma_f32_16x16x32_bf16 v[104:107], a[120:123], v[16:19], v[104:107]
ds_read_b64_tr_b16 v[116:117], v9 offset:20480
v_mfma_f32_16x16x32_bf16 v[108:111], a[124:127], v[16:19], v[108:111]
ds_read_b64_tr_b16 v[118:119], v9 offset:21504
s_add_u32 s24, s49, s32
buffer_load_dwordx4 v[16:19], v1, s[8:11], s24 offen offset:0 sc1
s_waitcnt vmcnt(19)
v_mfma_f32_16x16x32_bf16 v[96:99], a[128:131], v[20:23], v[96:99]
ds_read_b64_tr_b16 v[120:121], v10 offset:20480
v_mfma_f32_16x16x32_bf16 v[100:103], a[132:135], v[20:23], v[100:103]
ds_read_b64_tr_b16 v[122:123], v10 offset:21504
v_mfma_f32_16x16x32_bf16 v[104:107], a[136:139], v[20:23], v[104:107]
ds_read_b64_tr_b16 v[124:125], v11 offset:20480
v_mfma_f32_16x16x32_bf16 v[108:111], a[140:143], v[20:23], v[108:111]
ds_read_b64_tr_b16 v[126:127], v11 offset:21504
buffer_load_dwordx4 v[20:23], v1, s[8:11], s24 offen offset:1024 sc1
s_waitcnt vmcnt(19)
v_mfma_f32_16x16x32_bf16 v[96:99], a[144:147], v[24:27], v[96:99]
v_mfma_f32_16x16x32_bf16 v[100:103], a[148:151], v[24:27], v[100:103]
v_mfma_f32_16x16x32_bf16 v[104:107], a[152:155], v[24:27], v[104:107]
v_mfma_f32_16x16x32_bf16 v[108:111], a[156:159], v[24:27], v[108:111]
buffer_load_dwordx4 v[24:27], v1, s[8:11], s24 offen offset:2048 sc1
s_waitcnt vmcnt(19) lgkmcnt(0)
v_mfma_f32_16x16x32_bf16 v[96:99], v[112:115], v[28:31], v[96:99]
v_mfma_f32_16x16x32_bf16 v[100:103], v[116:119], v[28:31], v[100:103]
v_mfma_f32_16x16x32_bf16 v[104:107], v[120:123], v[28:31], v[104:107]
v_mfma_f32_16x16x32_bf16 v[108:111], v[124:127], v[28:31], v[108:111]
buffer_load_dwordx4 v[28:31], v1, s[8:11], s24 offen offset:3072 sc1
s_waitcnt vmcnt(19)
v_mfma_f32_16x16x32_bf16 v[96:99], a[160:163], v[32:35], v[96:99]
ds_read_b64_tr_b16 v[112:113], v8 offset:24576
v_mfma_f32_16x16x32_bf16 v[100:103], a[164:167], v[32:35], v[100:103]
ds_read_b64_tr_b16 v[114:115], v8 offset:25600
v_mfma_f32_16x16x32_bf16 v[104:107], a[168:171], v[32:35], v[104:107]
ds_read_b64_tr_b16 v[116:117], v9 offset:24576
v_mfma_f32_16x16x32_bf16 v[108:111], a[172:175], v[32:35], v[108:111]
ds_read_b64_tr_b16 v[118:119], v9 offset:25600
s_add_u32 s24, s49, s33
buffer_load_dwordx4 v[32:35], v1, s[8:11], s24 offen offset:0 sc1
s_waitcnt vmcnt(19)
v_mfma_f32_16x16x32_bf16 v[96:99], a[176:179], v[36:39], v[96:99]
ds_read_b64_tr_b16 v[120:121], v10 offset:24576
v_mfma_f32_16x16x32_bf16 v[100:103], a[180:183], v[36:39], v[100:103]
ds_read_b64_tr_b16 v[122:123], v10 offset:25600
v_mfma_f32_16x16x32_bf16 v[104:107], a[184:187], v[36:39], v[104:107]
ds_read_b64_tr_b16 v[124:125], v11 offset:24576
v_mfma_f32_16x16x32_bf16 v[108:111], a[188:191], v[36:39], v[108:111]
ds_read_b64_tr_b16 v[126:127], v11 offset:25600
buffer_load_dwordx4 v[36:39], v1, s[8:11], s24 offen offset:1024 sc1
s_waitcnt vmcnt(19)
v_mfma_f32_16x16x32_bf16 v[96:99], a[192:195], v[40:43], v[96:99]
v_mfma_f32_16x16x32_bf16 v[100:103], a[196:199], v[40:43], v[100:103]
v_mfma_f32_16x16x32_bf16 v[104:107], a[200:203], v[40:43], v[104:107]
v_mfma_f32_16x16x32_bf16 v[108:111], a[204:207], v[40:43], v[108:111]
buffer_load_dwordx4 v[40:43], v1, s[8:11], s24 offen offset:2048 sc1
s_waitcnt vmcnt(19) lgkmcnt(0)
v_mfma_f32_16x16x32_bf16 v[96:99], v[112:115], v[44:47], v[96:99]
v_mfma_f32_16x16x32_bf16 v[100:103], v[116:119], v[44:47], v[100:103]
v_mfma_f32_16x16x32_bf16 v[104:107], v[120:123], v[44:47], v[104:107]
v_mfma_f32_16x16x32_bf16 v[108:111], v[124:127], v[44:47], v[108:111]
buffer_load_dwordx4 v[44:47], v1, s[8:11], s24 offen offset:3072 sc1
s_waitcnt vmcnt(19)
v_mfma_f32_16x16x32_bf16 v[96:99], a[208:211], v[48:51], v[96:99]
ds_read_b64_tr_b16 v[112:113], v8 offset:28672
v_mfma_f32_16x16x32_bf16 v[100:103], a[212:215], v[48:51], v[100:103]
ds_read_b64_tr_b16 v[114:115], v8 offset:29696
v_mfma_f32_16x16x32_bf16 v[104:107], a[216:219], v[48:51], v[104:107]
ds_read_b64_tr_b16 v[116:117], v9 offset:28672
v_mfma_f32_16x16x32_bf16 v[108:111], a[220:223], v[48:51], v[108:111]
ds_read_b64_tr_b16 v[118:119], v9 offset:29696
s_add_u32 s24, s49, s34
buffer_load_dwordx4 v[48:51], v1, s[8:11], s24 offen offset:0 sc1
s_waitcnt vmcnt(19)
v_mfma_f32_16x16x32_bf16 v[96:99], a[224:227], v[52:55], v[96:99]
ds_read_b64_tr_b16 v[120:121], v10 offset:28672
v_mfma_f32_16x16x32_bf16 v[100:103], a[228:231], v[52:55], v[100:103]
ds_read_b64_tr_b16 v[122:123], v10 offset:29696
v_mfma_f32_16x16x32_bf16 v[104:107], a[232:235], v[52:55], v[104:107]
ds_read_b64_tr_b16 v[124:125], v11 offset:28672
v_mfma_f32_16x16x32_bf16 v[108:111], a[236:239], v[52:55], v[108:111]
ds_read_b64_tr_b16 v[126:127], v11 offset:29696
buffer_load_dwordx4 v[52:55], v1, s[8:11], s24 offen offset:1024 sc1
s_waitcnt vmcnt(19)
v_mfma_f32_16x16x32_bf16 v[96:99], a[240:243], v[56:59], v[96:99]
v_mfma_f32_16x16x32_bf16 v[100:103], a[244:247], v[56:59], v[100:103]
v_mfma_f32_16x16x32_bf16 v[104:107], a[248:251], v[56:59], v[104:107]
v_mfma_f32_16x16x32_bf16 v[108:111], a[252:255], v[56:59], v[108:111]
buffer_load_dwordx4 v[56:59], v1, s[8:11], s24 offen offset:2048 sc1
s_waitcnt vmcnt(19) lgkmcnt(0)
v_mfma_f32_16x16x32_bf16 v[96:99], v[112:115], v[60:63], v[96:99]
v_mfma_f32_16x16x32_bf16 v[100:103], v[116:119], v[60:63], v[100:103]
v_mfma_f32_16x16x32_bf16 v[104:107], v[120:123], v[60:63], v[104:107]
v_mfma_f32_16x16x32_bf16 v[108:111], v[124:127], v[60:63], v[108:111]
buffer_load_dwordx4 v[60:63], v1, s[8:11], s24 offen offset:3072 sc1
s_nop 3
ds_write_b128 v3, v[96:99] offset:0
ds_write_b128 v3, v[100:103] offset:4096
ds_write_b128 v3, v[104:107] offset:8192
ds_write_b128 v3, v[108:111] offset:12288
s_waitcnt lgkmcnt(0)
s_barrier
ds_read_b128 v[96:99], v7 offset:0
ds_read_b128 v[100:103], v7 offset:1024
ds_read_b128 v[104:107], v7 offset:2048
ds_read_b128 v[108:111], v7 offset:3072
ds_read_b64_tr_b16 v[112:113], v8 offset:0
ds_read_b64_tr_b16 v[114:115], v8 offset:1024
ds_read_b64_tr_b16 v[116:117], v9 offset:0
ds_read_b64_tr_b16 v[118:119], v9 offset:1024
ds_read_b64_tr_b16 v[120:121], v10 offset:0
ds_read_b64_tr_b16 v[122:123], v10 offset:1024
ds_read_b64_tr_b16 v[124:125], v11 offset:0
ds_read_b64_tr_b16 v[126:127], v11 offset:1024
s_mul_i32 s24, s41, 36864
s_waitcnt lgkmcnt(10)
v_pk_add_f32 v[96:97], v[96:97], v[100:101]
v_pk_add_f32 v[98:99], v[98:99], v[102:103]
s_waitcnt lgkmcnt(9)
v_pk_add_f32 v[96:97], v[96:97], v[104:105]
v_pk_add_f32 v[98:99], v[98:99], v[106:107]
s_waitcnt lgkmcnt(8)
v_pk_add_f32 v[96:97], v[96:97], v[108:109]
v_pk_add_f32 v[98:99], v[98:99], v[110:111]
v_cvt_pk_bf16_f32 v12, v96, v97
v_cvt_pk_bf16_f32 v13, v98, v99
buffer_store_dwordx2 v[12:13], v4, s[12:15], s24 offen
v_xor_b32 v3, 16384, v3
v_xor_b32 v7, 16384, v7
s_mov_b32 s41, s27
s_mov_b32 s48, s49
s_sub_u32 s42, s42, 1
s_cmp_eq_u32 s50, 0
s_cbranch_scc1 L_opl_c
L_opl_r1:
s_add_u32 s27, s41, s43
s_and_b32 s27, s27, 127
s_lshr_b32 s25, s27, s46
s_lshl_b32 s25, s25, 7
s_add_u32 s25, s25, s45
buffer_load_dword v6, v5, s[8:11], s25 offen sc1
s_lshl_b32 s49, s27, 17
s_add_u32 s49, s49, s44
s_waitcnt vmcnt(21)
v_mfma_f32_16x16x32_bf16 v[96:99], v[128:131], v[64:67], 0
v_mfma_f32_16x16x32_bf16 v[100:103], v[132:135], v[64:67], 0
v_mfma_f32_16x16x32_bf16 v[104:107], v[136:139], v[64:67], 0
v_mfma_f32_16x16x32_bf16 v[108:111], v[140:143], v[64:67], 0
s_add_u32 s24, s48, s35
buffer_load_dwordx4 v[64:67], v1, s[8:11], s24 offen offset:0 sc1
s_waitcnt vmcnt(21)
v_mfma_f32_16x16x32_bf16 v[96:99], v[144:147], v[68:71], v[96:99]
v_mfma_f32_16x16x32_bf16 v[100:103], v[148:151], v[68:71], v[100:103]
v_mfma_f32_16x16x32_bf16 v[104:107], v[152:155], v[68:71], v[104:107]
v_mfma_f32_16x16x32_bf16 v[108:111], v[156:159], v[68:71], v[108:111]
buffer_load_dwordx4 v[68:71], v1, s[8:11], s24 offen offset:1024 sc1
s_waitcnt vmcnt(21)
v_mfma_f32_16x16x32_bf16 v[96:99], v[160:163], v[72:75], v[96:99]
v_mfma_f32_16x16x32_bf16 v[100:103], v[164:167], v[72:75], v[100:103]
v_mfma_f32_16x16x32_bf16 v[104:107], v[168:171], v[72:75], v[104:107]
v_mfma_f32_16x16x32_bf16 v[108:111], v[172:175], v[72:75], v[108:111]
buffer_load_dwordx4 v[72:75], v1, s[8:11], s24 offen offset:2048 sc1
s_waitcnt vmcnt(21) lgkmcnt(0)
v_mfma_f32_16x16x32_bf16 v[96:99], v[112:115], v[76:79], v[96:99]
v_mfma_f32_16x16x32_bf16 v[100:103], v[116:119], v[76:79], v[100:103]
v_mfma_f32_16x16x32_bf16 v[104:107], v[120:123], v[76:79], v[104:107]
v_mfma_f32_16x16x32_bf16 v[108:111], v[124:127], v[76:79], v[108:111]
buffer_load_dwordx4 v[76:79], v1, s[8:11], s24 offen offset:3072 sc1
s_waitcnt vmcnt(21)
v_mfma_f32_16x16x32_bf16 v[96:99], v[176:179], v[80:83], v[96:99]
ds_read_b64_tr_b16 v[112:113], v8 offset:4096
v_mfma_f32_16x16x32_bf16 v[100:103], v[180:183], v[80:83], v[100:103]
ds_read_b64_tr_b16 v[114:115], v8 offset:5120
v_mfma_f32_16x16x32_bf16 v[104:107], v[184:187], v[80:83], v[104:107]
ds_read_b64_tr_b16 v[116:117], v9 offset:4096
v_mfma_f32_16x16x32_bf16 v[108:111], v[188:191], v[80:83], v[108:111]
ds_read_b64_tr_b16 v[118:119], v9 offset:5120
s_add_u32 s24, s48, s36
buffer_load_dwordx4 v[80:83], v1, s[8:11], s24 offen offset:0 sc1
s_waitcnt vmcnt(21)
v_mfma_f32_16x16x32_bf16 v[96:99], v[192:195], v[84:87], v[96:99]
ds_read_b64_tr_b16 v[120:121], v10 offset:4096
v_mfma_f32_16x16x32_bf16 v[100:103], v[196:199], v[84:87], v[100:103]
ds_read_b64_tr_b16 v[122:123], v10 offset:5120
v_mfma_f32_16x16x32_bf16 v[104:107], v[200:203], v[84:87], v[104:107]
ds_read_b64_tr_b16 v[124:125], v11 offset:4096
v_mfma_f32_16x16x32_bf16 v[108:111], v[204:207], v[84:87], v[108:111]
ds_read_b64_tr_b16 v[126:127], v11 offset:5120
buffer_load_dwordx4 v[84:87], v1, s[8:11], s24 offen offset:1024 sc1
s_waitcnt vmcnt(21)
v_mfma_f32_16x16x32_bf16 v[96:99], v[208:211], v[88:91], v[96:99]
v_mfma_f32_16x16x32_bf16 v[100:103], v[212:215], v[88:91], v[100:103]
v_mfma_f32_16x16x32_bf16 v[104:107], v[216:219], v[88:91], v[104:107]
v_mfma_f32_16x16x32_bf16 v[108:111], v[220:223], v[88:91], v[108:111]
buffer_load_dwordx4 v[88:91], v1, s[8:11], s24 offen offset:2048 sc1
s_waitcnt vmcnt(21) lgkmcnt(0)
v_mfma_f32_16x16x32_bf16 v[96:99], v[112:115], v[92:95], v[96:99]
v_mfma_f32_16x16x32_bf16 v[100:103], v[116:119], v[92:95], v[100:103]
v_mfma_f32_16x16x32_bf16 v[104:107], v[120:123], v[92:95], v[104:107]
v_mfma_f32_16x16x32_bf16 v[108:111], v[124:127], v[92:95], v[108:111]
buffer_load_dwordx4 v[92:95], v1, s[8:11], s24 offen offset:3072 sc1
s_waitcnt vmcnt(21)
v_mfma_f32_16x16x32_bf16 v[96:99], v[224:227], v[16:19], v[96:99]
ds_read_b64_tr_b16 v[112:113], v8 offset:8192
v_mfma_f32_16x16x32_bf16 v[100:103], v[228:231], v[16:19], v[100:103]
ds_read_b64_tr_b16 v[114:115], v8 offset:9216
v_mfma_f32_16x16x32_bf16 v[104:107], v[232:235], v[16:19], v[104:107]
ds_read_b64_tr_b16 v[116:117], v9 offset:8192
v_mfma_f32_16x16x32_bf16 v[108:111], v[236:239], v[16:19], v[108:111]
ds_read_b64_tr_b16 v[118:119], v9 offset:9216
s_add_u32 s24, s48, s37
buffer_load_dwordx4 v[16:19], v1, s[8:11], s24 offen offset:0 sc1
s_waitcnt vmcnt(21)
v_mfma_f32_16x16x32_bf16 v[96:99], v[240:243], v[20:23], v[96:99]
ds_read_b64_tr_b16 v[120:121], v10 offset:8192
v_mfma_f32_16x16x32_bf16 v[100:103], v[244:247], v[20:23], v[100:103]
ds_read_b64_tr_b16 v[122:123], v10 offset:9216
v_mfma_f32_16x16x32_bf16 v[104:107], v[248:251], v[20:23], v[104:107]
ds_read_b64_tr_b16 v[124:125], v11 offset:8192
v_mfma_f32_16x16x32_bf16 v[108:111], v[252:255], v[20:23], v[108:111]
ds_read_b64_tr_b16 v[126:127], v11 offset:9216
buffer_load_dwordx4 v[20:23], v1, s[8:11], s24 offen offset:1024 sc1
s_waitcnt vmcnt(21)
v_mfma_f32_16x16x32_bf16 v[96:99], a[0:3], v[24:27], v[96:99]
v_mfma_f32_16x16x32_bf16 v[100:103], a[4:7], v[24:27], v[100:103]
v_mfma_f32_16x16x32_bf16 v[104:107], a[8:11], v[24:27], v[104:107]
v_mfma_f32_16x16x32_bf16 v[108:111], a[12:15], v[24:27], v[108:111]
buffer_load_dwordx4 v[24:27], v1, s[8:11], s24 offen offset:2048 sc1
s_waitcnt vmcnt(21) lgkmcnt(0)
v_mfma_f32_16x16x32_bf16 v[96:99], v[112:115], v[28:31], v[96:99]
v_mfma_f32_16x16x32_bf16 v[100:103], v[116:119], v[28:31], v[100:103]
v_mfma_f32_16x16x32_bf16 v[104:107], v[120:123], v[28:31], v[104:107]
v_mfma_f32_16x16x32_bf16 v[108:111], v[124:127], v[28:31], v[108:111]
buffer_load_dwordx4 v[28:31], v1, s[8:11], s24 offen offset:3072 sc1
s_waitcnt vmcnt(21)
v_mfma_f32_16x16x32_bf16 v[96:99], a[16:19], v[32:35], v[96:99]
ds_read_b64_tr_b16 v[112:113], v8 offset:12288
v_mfma_f32_16x16x32_bf16 v[100:103], a[20:23], v[32:35], v[100:103]
ds_read_b64_tr_b16 v[114:115], v8 offset:13312
v_mfma_f32_16x16x32_bf16 v[104:107], a[24:27], v[32:35], v[104:107]
ds_read_b64_tr_b16 v[116:117], v9 offset:12288
v_mfma_f32_16x16x32_bf16 v[108:111], a[28:31], v[32:35], v[108:111]
ds_read_b64_tr_b16 v[118:119], v9 offset:13312
s_waitcnt vmcnt(12)
v_cmp_ne_u32 vcc, 1, v6
s_cmp_gt_u32 s42, 1
s_cselect_b32 s50, 1, 0
s_cmp_eq_u64 vcc, 0
s_cselect_b32 s50, s50, 0
s_cmp_eq_u32 s50, 1
s_cselect_b32 s49, s49, 536870912
s_add_u32 s24, s49, s30
buffer_load_dwordx4 v[32:35], v1, s[8:11], s24 offen offset:0 sc1
s_waitcnt vmcnt(21)
v_mfma_f32_16x16x32_bf16 v[96:99], a[32:35], v[36:39], v[96:99]
ds_read_b64_tr_b16 v[120:121], v10 offset:12288
v_mfma_f32_16x16x32_bf16 v[100:103], a[36:39], v[36:39], v[100:103]
ds_read_b64_tr_b16 v[122:123], v10 offset:13312
v_mfma_f32_16x16x32_bf16 v[104:107], a[40:43], v[36:39], v[104:107]
ds_read_b64_tr_b16 v[124:125], v11 offset:12288
v_mfma_f32_16x16x32_bf16 v[108:111], a[44:47], v[36:39], v[108:111]
ds_read_b64_tr_b16 v[126:127], v11 offset:13312
buffer_load_dwordx4 v[36:39], v1, s[8:11], s24 offen offset:1024 sc1
s_waitcnt vmcnt(21)
v_mfma_f32_16x16x32_bf16 v[96:99], a[48:51], v[40:43], v[96:99]
v_mfma_f32_16x16x32_bf16 v[100:103], a[52:55], v[40:43], v[100:103]
v_mfma_f32_16x16x32_bf16 v[104:107], a[56:59], v[40:43], v[104:107]
v_mfma_f32_16x16x32_bf16 v[108:111], a[60:63], v[40:43], v[108:111]
buffer_load_dwordx4 v[40:43], v1, s[8:11], s24 offen offset:2048 sc1
s_waitcnt vmcnt(21) lgkmcnt(0)
v_mfma_f32_16x16x32_bf16 v[96:99], v[112:115], v[44:47], v[96:99]
v_mfma_f32_16x16x32_bf16 v[100:103], v[116:119], v[44:47], v[100:103]
v_mfma_f32_16x16x32_bf16 v[104:107], v[120:123], v[44:47], v[104:107]
v_mfma_f32_16x16x32_bf16 v[108:111], v[124:127], v[44:47], v[108:111]
buffer_load_dwordx4 v[44:47], v1, s[8:11], s24 offen offset:3072 sc1
s_waitcnt vmcnt(21)
v_mfma_f32_16x16x32_bf16 v[96:99], a[64:67], v[48:51], v[96:99]
ds_read_b64_tr_b16 v[112:113], v8 offset:16384
v_mfma_f32_16x16x32_bf16 v[100:103], a[68:71], v[48:51], v[100:103]
ds_read_b64_tr_b16 v[114:115], v8 offset:17408
v_mfma_f32_16x16x32_bf16 v[104:107], a[72:75], v[48:51], v[104:107]
ds_read_b64_tr_b16 v[116:117], v9 offset:16384
v_mfma_f32_16x16x32_bf16 v[108:111], a[76:79], v[48:51], v[108:111]
ds_read_b64_tr_b16 v[118:119], v9 offset:17408
s_add_u32 s24, s49, s31
buffer_load_dwordx4 v[48:51], v1, s[8:11], s24 offen offset:0 sc1
s_waitcnt vmcnt(21)
v_mfma_f32_16x16x32_bf16 v[96:99], a[80:83], v[52:55], v[96:99]
ds_read_b64_tr_b16 v[120:121], v10 offset:16384
v_mfma_f32_16x16x32_bf16 v[100:103], a[84:87], v[52:55], v[100:103]
ds_read_b64_tr_b16 v[122:123], v10 offset:17408
v_mfma_f32_16x16x32_bf16 v[104:107], a[88:91], v[52:55], v[104:107]
ds_read_b64_tr_b16 v[124:125], v11 offset:16384
v_mfma_f32_16x16x32_bf16 v[108:111], a[92:95], v[52:55], v[108:111]
ds_read_b64_tr_b16 v[126:127], v11 offset:17408
buffer_load_dwordx4 v[52:55], v1, s[8:11], s24 offen offset:1024 sc1
s_waitcnt vmcnt(21)
v_mfma_f32_16x16x32_bf16 v[96:99], a[96:99], v[56:59], v[96:99]
v_mfma_f32_16x16x32_bf16 v[100:103], a[100:103], v[56:59], v[100:103]
v_mfma_f32_16x16x32_bf16 v[104:107], a[104:107], v[56:59], v[104:107]
v_mfma_f32_16x16x32_bf16 v[108:111], a[108:111], v[56:59], v[108:111]
buffer_load_dwordx4 v[56:59], v1, s[8:11], s24 offen offset:2048 sc1
s_waitcnt vmcnt(21) lgkmcnt(0)
v_mfma_f32_16x16x32_bf16 v[96:99], v[112:115], v[60:63], v[96:99]
v_mfma_f32_16x16x32_bf16 v[100:103], v[116:119], v[60:63], v[100:103]
v_mfma_f32_16x16x32_bf16 v[104:107], v[120:123], v[60:63], v[104:107]
v_mfma_f32_16x16x32_bf16 v[108:111], v[124:127], v[60:63], v[108:111]
buffer_load_dwordx4 v[60:63], v1, s[8:11], s24 offen offset:3072 sc1
s_waitcnt vmcnt(19)
v_mfma_f32_16x16x32_bf16 v[96:99], a[112:115], v[64:67], v[96:99]
ds_read_b64_tr_b16 v[112:113], v8 offset:20480
v_mfma_f32_16x16x32_bf16 v[100:103], a[116:119], v[64:67], v[100:103]
ds_read_b64_tr_b16 v[114:115], v8 offset:21504
v_mfma_f32_16x16x32_bf16 v[104:107], a[120:123], v[64:67], v[104:107]
ds_read_b64_tr_b16 v[116:117], v9 offset:20480
v_mfma_f32_16x16x32_bf16 v[108:111], a[124:127], v[64:67], v[108:111]
ds_read_b64_tr_b16 v[118:119], v9 offset:21504
s_add_u32 s24, s49, s32
buffer_load_dwordx4 v[64:67], v1, s[8:11], s24 offen offset:0 sc1
s_waitcnt vmcnt(19)
v_mfma_f32_16x16x32_bf16 v[96:99], a[128:131], v[68:71], v[96:99]
ds_read_b64_tr_b16 v[120:121], v10 offset:20480
v_mfma_f32_16x16x32_bf16 v[100:103], a[132:135], v[68:71], v[100:103]
ds_read_b64_tr_b16 v[122:123], v10 offset:21504
v_mfma_f32_16x16x32_bf16 v[104:107], a[136:139], v[68:71], v[104:107]
ds_read_b64_tr_b16 v[124:125], v11 offset:20480
v_mfma_f32_16x16x32_bf16 v[108:111], a[140:143], v[68:71], v[108:111]
ds_read_b64_tr_b16 v[126:127], v11 offset:21504
buffer_load_dwordx4 v[68:71], v1, s[8:11], s24 offen offset:1024 sc1
s_waitcnt vmcnt(19)
v_mfma_f32_16x16x32_bf16 v[96:99], a[144:147], v[72:75], v[96:99]
v_mfma_f32_16x16x32_bf16 v[100:103], a[148:151], v[72:75], v[100:103]
v_mfma_f32_16x16x32_bf16 v[104:107], a[152:155], v[72:75], v[104:107]
v_mfma_f32_16x16x32_bf16 v[108:111], a[156:159], v[72:75], v[108:111]
buffer_load_dwordx4 v[72:75], v1, s[8:11], s24 offen offset:2048 sc1
s_waitcnt vmcnt(19) lgkmcnt(0)
v_mfma_f32_16x16x32_bf16 v[96:99], v[112:115], v[76:79], v[96:99]
v_mfma_f32_16x16x32_bf16 v[100:103], v[116:119], v[76:79], v[100:103]
v_mfma_f32_16x16x32_bf16 v[104:107], v[120:123], v[76:79], v[104:107]
v_mfma_f32_16x16x32_bf16 v[108:111], v[124:127], v[76:79], v[108:111]
buffer_load_dwordx4 v[76:79], v1, s[8:11], s24 offen offset:3072 sc1
s_waitcnt vmcnt(19)
v_mfma_f32_16x16x32_bf16 v[96:99], a[160:163], v[80:83], v[96:99]
ds_read_b64_tr_b16 v[112:113], v8 offset:24576
v_mfma_f32_16x16x32_bf16 v[100:103], a[164:167], v[80:83], v[100:103]
ds_read_b64_tr_b16 v[114:115], v8 offset:25600
v_mfma_f32_16x16x32_bf16 v[104:107], a[168:171], v[80:83], v[104:107]
ds_read_b64_tr_b16 v[116:117], v9 offset:24576
v_mfma_f32_16x16x32_bf16 v[108:111], a[172:175], v[80:83], v[108:111]
ds_read_b64_tr_b16 v[118:119], v9 offset:25600
s_add_u32 s24, s49, s33
buffer_load_dwordx4 v[80:83], v1, s[8:11], s24 offen offset:0 sc1
s_waitcnt vmcnt(19)
v_mfma_f32_16x16x32_bf16 v[96:99], a[176:179], v[84:87], v[96:99]
ds_read_b64_tr_b16 v[120:121], v10 offset:24576
v_mfma_f32_16x16x32_bf16 v[100:103], a[180:183], v[84:87], v[100:103]
ds_read_b64_tr_b16 v[122:123], v10 offset:25600
v_mfma_f32_16x16x32_bf16 v[104:107], a[184:187], v[84:87], v[104:107]
ds_read_b64_tr_b16 v[124:125], v11 offset:24576
v_mfma_f32_16x16x32_bf16 v[108:111], a[188:191], v[84:87], v[108:111]
ds_read_b64_tr_b16 v[126:127], v11 offset:25600
buffer_load_dwordx4 v[84:87], v1, s[8:11], s24 offen offset:1024 sc1
s_waitcnt vmcnt(19)
v_mfma_f32_16x16x32_bf16 v[96:99], a[192:195], v[88:91], v[96:99]
v_mfma_f32_16x16x32_bf16 v[100:103], a[196:199], v[88:91], v[100:103]
v_mfma_f32_16x16x32_bf16 v[104:107], a[200:203], v[88:91], v[104:107]
v_mfma_f32_16x16x32_bf16 v[108:111], a[204:207], v[88:91], v[108:111]
buffer_load_dwordx4 v[88:91], v1, s[8:11], s24 offen offset:2048 sc1
s_waitcnt vmcnt(19) lgkmcnt(0)
v_mfma_f32_16x16x32_bf16 v[96:99], v[112:115], v[92:95], v[96:99]
v_mfma_f32_16x16x32_bf16 v[100:103], v[116:119], v[92:95], v[100:103]
v_mfma_f32_16x16x32_bf16 v[104:107], v[120:123], v[92:95], v[104:107]
v_mfma_f32_16x16x32_bf16 v[108:111], v[124:127], v[92:95], v[108:111]
buffer_load_dwordx4 v[92:95], v1, s[8:11], s24 offen offset:3072 sc1
s_waitcnt vmcnt(19)
v_mfma_f32_16x16x32_bf16 v[96:99], a[208:211], v[16:19], v[96:99]
ds_read_b64_tr_b16 v[112:113], v8 offset:28672
v_mfma_f32_16x16x32_bf16 v[100:103], a[212:215], v[16:19], v[100:103]
ds_read_b64_tr_b16 v[114:115], v8 offset:29696
v_mfma_f32_16x16x32_bf16 v[104:107], a[216:219], v[16:19], v[104:107]
ds_read_b64_tr_b16 v[116:117], v9 offset:28672
v_mfma_f32_16x16x32_bf16 v[108:111], a[220:223], v[16:19], v[108:111]
ds_read_b64_tr_b16 v[118:119], v9 offset:29696
s_add_u32 s24, s49, s34
buffer_load_dwordx4 v[16:19], v1, s[8:11], s24 offen offset:0 sc1
s_waitcnt vmcnt(19)
v_mfma_f32_16x16x32_bf16 v[96:99], a[224:227], v[20:23], v[96:99]
ds_read_b64_tr_b16 v[120:121], v10 offset:28672
v_mfma_f32_16x16x32_bf16 v[100:103], a[228:231], v[20:23], v[100:103]
ds_read_b64_tr_b16 v[122:123], v10 offset:29696
v_mfma_f32_16x16x32_bf16 v[104:107], a[232:235], v[20:23], v[104:107]
ds_read_b64_tr_b16 v[124:125], v11 offset:28672
v_mfma_f32_16x16x32_bf16 v[108:111], a[236:239], v[20:23], v[108:111]
ds_read_b64_tr_b16 v[126:127], v11 offset:29696
buffer_load_dwordx4 v[20:23], v1, s[8:11], s24 offen offset:1024 sc1
s_waitcnt vmcnt(19)
v_mfma_f32_16x16x32_bf16 v[96:99], a[240:243], v[24:27], v[96:99]
v_mfma_f32_16x16x32_bf16 v[100:103], a[244:247], v[24:27], v[100:103]
v_mfma_f32_16x16x32_bf16 v[104:107], a[248:251], v[24:27], v[104:107]
v_mfma_f32_16x16x32_bf16 v[108:111], a[252:255], v[24:27], v[108:111]
buffer_load_dwordx4 v[24:27], v1, s[8:11], s24 offen offset:2048 sc1
s_waitcnt vmcnt(19) lgkmcnt(0)
v_mfma_f32_16x16x32_bf16 v[96:99], v[112:115], v[28:31], v[96:99]
v_mfma_f32_16x16x32_bf16 v[100:103], v[116:119], v[28:31], v[100:103]
v_mfma_f32_16x16x32_bf16 v[104:107], v[120:123], v[28:31], v[104:107]
v_mfma_f32_16x16x32_bf16 v[108:111], v[124:127], v[28:31], v[108:111]
buffer_load_dwordx4 v[28:31], v1, s[8:11], s24 offen offset:3072 sc1
s_nop 3
ds_write_b128 v3, v[96:99] offset:0
ds_write_b128 v3, v[100:103] offset:4096
ds_write_b128 v3, v[104:107] offset:8192
ds_write_b128 v3, v[108:111] offset:12288
s_waitcnt lgkmcnt(0)
s_barrier
ds_read_b128 v[96:99], v7 offset:0
ds_read_b128 v[100:103], v7 offset:1024
ds_read_b128 v[104:107], v7 offset:2048
ds_read_b128 v[108:111], v7 offset:3072
ds_read_b64_tr_b16 v[112:113], v8 offset:0
ds_read_b64_tr_b16 v[114:115], v8 offset:1024
ds_read_b64_tr_b16 v[116:117], v9 offset:0
ds_read_b64_tr_b16 v[118:119], v9 offset:1024
ds_read_b64_tr_b16 v[120:121], v10 offset:0
ds_read_b64_tr_b16 v[122:123], v10 offset:1024
ds_read_b64_tr_b16 v[124:125], v11 offset:0
ds_read_b64_tr_b16 v[126:127], v11 offset:1024
s_mul_i32 s24, s41, 36864
s_waitcnt lgkmcnt(10)
v_pk_add_f32 v[96:97], v[96:97], v[100:101]
v_pk_add_f32 v[98:99], v[98:99], v[102:103]
s_waitcnt lgkmcnt(9)
v_pk_add_f32 v[96:97], v[96:97], v[104:105]
v_pk_add_f32 v[98:99], v[98:99], v[106:107]
s_waitcnt lgkmcnt(8)
v_pk_add_f32 v[96:97], v[96:97], v[108:109]
v_pk_add_f32 v[98:99], v[98:99], v[110:111]
v_cvt_pk_bf16_f32 v12, v96, v97
v_cvt_pk_bf16_f32 v13, v98, v99
buffer_store_dwordx2 v[12:13], v4, s[12:15], s24 offen
v_xor_b32 v3, 16384, v3
v_xor_b32 v7, 16384, v7
s_mov_b32 s41, s27
s_mov_b32 s48, s49
s_sub_u32 s42, s42, 1
s_cmp_eq_u32 s50, 0
s_cbranch_scc1 L_opl_c
L_opl_r2:
s_add_u32 s27, s41, s43
s_and_b32 s27, s27, 127
s_lshr_b32 s25, s27, s46
s_lshl_b32 s25, s25, 7
s_add_u32 s25, s25, s45
buffer_load_dword v6, v5, s[8:11], s25 offen sc1
s_lshl_b32 s49, s27, 17
s_add_u32 s49, s49, s44
s_waitcnt vmcnt(21)
v_mfma_f32_16x16x32_bf16 v[96:99], v[128:131], v[32:35], 0
v_mfma_f32_16x16x32_bf16 v[100:103], v[132:135], v[32:35], 0
v_mfma_f32_16x16x32_bf16 v[104:107], v[136:139], v[32:35], 0
v_mfma_f32_16x16x32_bf16 v[108:111], v[140:143], v[32:35], 0
s_add_u32 s24, s48, s35
buffer_load_dwordx4 v[32:35], v1, s[8:11], s24 offen offset:0 sc1
s_waitcnt vmcnt(21)
v_mfma_f32_16x16x32_bf16 v[96:99], v[144:147], v[36:39], v[96:99]
v_mfma_f32_16x16x32_bf16 v[100:103], v[148:151], v[36:39], v[100:103]
v_mfma_f32_16x16x32_bf16 v[104:107], v[152:155], v[36:39], v[104:107]
v_mfma_f32_16x16x32_bf16 v[108:111], v[156:159], v[36:39], v[108:111]
buffer_load_dwordx4 v[36:39], v1, s[8:11], s24 offen offset:1024 sc1
s_waitcnt vmcnt(21)
v_mfma_f32_16x16x32_bf16 v[96:99], v[160:163], v[40:43], v[96:99]
v_mfma_f32_16x16x32_bf16 v[100:103], v[164:167], v[40:43], v[100:103]
v_mfma_f32_16x16x32_bf16 v[104:107], v[168:171], v[40:43], v[104:107]
v_mfma_f32_16x16x32_bf16 v[108:111], v[172:175], v[40:43], v[108:111]
buffer_load_dwordx4 v[40:43], v1, s[8:11], s24 offen offset:2048 sc1
s_waitcnt vmcnt(21) lgkmcnt(0)
v_mfma_f32_16x16x32_bf16 v[96:99], v[112:115], v[44:47], v[96:99]
v_mfma_f32_16x16x32_bf16 v[100:103], v[116:119], v[44:47], v[100:103]
v_mfma_f32_16x16x32_bf16 v[104:107], v[120:123], v[44:47], v[104:107]
v_mfma_f32_16x16x32_bf16 v[108:111], v[124:127], v[44:47], v[108:111]
buffer_load_dwordx4 v[44:47], v1, s[8:11], s24 offen offset:3072 sc1
s_waitcnt vmcnt(21)
v_mfma_f32_16x16x32_bf16 v[96:99], v[176:179], v[48:51], v[96:99]
ds_read_b64_tr_b16 v[112:113], v8 offset:4096
v_mfma_f32_16x16x32_bf16 v[100:103], v[180:183], v[48:51], v[100:103]
ds_read_b64_tr_b16 v[114:115], v8 offset:5120
v_mfma_f32_16x16x32_bf16 v[104:107], v[184:187], v[48:51], v[104:107]
ds_read_b64_tr_b16 v[116:117], v9 offset:4096
v_mfma_f32_16x16x32_bf16 v[108:111], v[188:191], v[48:51], v[108:111]
ds_read_b64_tr_b16 v[118:119], v9 offset:5120
s_add_u32 s24, s48, s36
buffer_load_dwordx4 v[48:51], v1, s[8:11], s24 offen offset:0 sc1
s_waitcnt vmcnt(21)
v_mfma_f32_16x16x32_bf16 v[96:99], v[192:195], v[52:55], v[96:99]
ds_read_b64_tr_b16 v[120:121], v10 offset:4096
v_mfma_f32_16x16x32_bf16 v[100:103], v[196:199], v[52:55], v[100:103]
ds_read_b64_tr_b16 v[122:123], v10 offset:5120
v_mfma_f32_16x16x32_bf16 v[104:107], v[200:203], v[52:55], v[104:107]
ds_read_b64_tr_b16 v[124:125], v11 offset:4096
v_mfma_f32_16x16x32_bf16 v[108:111], v[204:207], v[52:55], v[108:111]
ds_read_b64_tr_b16 v[126:127], v11 offset:5120
buffer_load_dwordx4 v[52:55], v1, s[8:11], s24 offen offset:1024 sc1
s_waitcnt vmcnt(21)
v_mfma_f32_16x16x32_bf16 v[96:99], v[208:211], v[56:59], v[96:99]
v_mfma_f32_16x16x32_bf16 v[100:103], v[212:215], v[56:59], v[100:103]
v_mfma_f32_16x16x32_bf16 v[104:107], v[216:219], v[56:59], v[104:107]
v_mfma_f32_16x16x32_bf16 v[108:111], v[220:223], v[56:59], v[108:111]
buffer_load_dwordx4 v[56:59], v1, s[8:11], s24 offen offset:2048 sc1
s_waitcnt vmcnt(21) lgkmcnt(0)
v_mfma_f32_16x16x32_bf16 v[96:99], v[112:115], v[60:63], v[96:99]
v_mfma_f32_16x16x32_bf16 v[100:103], v[116:119], v[60:63], v[100:103]
v_mfma_f32_16x16x32_bf16 v[104:107], v[120:123], v[60:63], v[104:107]
v_mfma_f32_16x16x32_bf16 v[108:111], v[124:127], v[60:63], v[108:111]
buffer_load_dwordx4 v[60:63], v1, s[8:11], s24 offen offset:3072 sc1
s_waitcnt vmcnt(21)
v_mfma_f32_16x16x32_bf16 v[96:99], v[224:227], v[64:67], v[96:99]
ds_read_b64_tr_b16 v[112:113], v8 offset:8192
v_mfma_f32_16x16x32_bf16 v[100:103], v[228:231], v[64:67], v[100:103]
ds_read_b64_tr_b16 v[114:115], v8 offset:9216
v_mfma_f32_16x16x32_bf16 v[104:107], v[232:235], v[64:67], v[104:107]
ds_read_b64_tr_b16 v[116:117], v9 offset:8192
v_mfma_f32_16x16x32_bf16 v[108:111], v[236:239], v[64:67], v[108:111]
ds_read_b64_tr_b16 v[118:119], v9 offset:9216
s_add_u32 s24, s48, s37
buffer_load_dwordx4 v[64:67], v1, s[8:11], s24 offen offset:0 sc1
s_waitcnt vmcnt(21)
v_mfma_f32_16x16x32_bf16 v[96:99], v[240:243], v[68:71], v[96:99]
ds_read_b64_tr_b16 v[120:121], v10 offset:8192
v_mfma_f32_16x16x32_bf16 v[100:103], v[244:247], v[68:71], v[100:103]
ds_read_b64_tr_b16 v[122:123], v10 offset:9216
v_mfma_f32_16x16x32_bf16 v[104:107], v[248:251], v[68:71], v[104:107]
ds_read_b64_tr_b16 v[124:125], v11 offset:8192
v_mfma_f32_16x16x32_bf16 v[108:111], v[252:255], v[68:71], v[108:111]
ds_read_b64_tr_b16 v[126:127], v11 offset:9216
buffer_load_dwordx4 v[68:71], v1, s[8:11], s24 offen offset:1024 sc1
s_waitcnt vmcnt(21)
v_mfma_f32_16x16x32_bf16 v[96:99], a[0:3], v[72:75], v[96:99]
v_mfma_f32_16x16x32_bf16 v[100:103], a[4:7], v[72:75], v[100:103]
v_mfma_f32_16x16x32_bf16 v[104:107], a[8:11], v[72:75], v[104:107]
v_mfma_f32_16x16x32_bf16 v[108:111], a[12:15], v[72:75], v[108:111]
buffer_load_dwordx4 v[72:75], v1, s[8:11], s24 offen offset:2048 sc1
s_waitcnt vmcnt(21) lgkmcnt(0)
v_mfma_f32_16x16x32_bf16 v[96:99], v[112:115], v[76:79], v[96:99]
v_mfma_f32_16x16x32_bf16 v[100:103], v[116:119], v[76:79], v[100:103]
v_mfma_f32_16x16x32_bf16 v[104:107], v[120:123], v[76:79], v[104:107]
v_mfma_f32_16x16x32_bf16 v[108:111], v[124:127], v[76:79], v[108:111]
buffer_load_dwordx4 v[76:79], v1, s[8:11], s24 offen offset:3072 sc1
s_waitcnt vmcnt(21)
v_mfma_f32_16x16x32_bf16 v[96:99], a[16:19], v[80:83], v[96:99]
ds_read_b64_tr_b16 v[112:113], v8 offset:12288
v_mfma_f32_16x16x32_bf16 v[100:103], a[20:23], v[80:83], v[100:103]
ds_read_b64_tr_b16 v[114:115], v8 offset:13312
v_mfma_f32_16x16x32_bf16 v[104:107], a[24:27], v[80:83], v[104:107]
ds_read_b64_tr_b16 v[116:117], v9 offset:12288
v_mfma_f32_16x16x32_bf16 v[108:111], a[28:31], v[80:83], v[108:111]
ds_read_b64_tr_b16 v[118:119], v9 offset:13312
s_waitcnt vmcnt(12)
v_cmp_ne_u32 vcc, 1, v6
s_cmp_gt_u32 s42, 1
s_cselect_b32 s50, 1, 0
s_cmp_eq_u64 vcc, 0
s_cselect_b32 s50, s50, 0
s_cmp_eq_u32 s50, 1
s_cselect_b32 s49, s49, 536870912
s_add_u32 s24, s49, s30
buffer_load_dwordx4 v[80:83], v1, s[8:11], s24 offen offset:0 sc1
s_waitcnt vmcnt(21)
v_mfma_f32_16x16x32_bf16 v[96:99], a[32:35], v[84:87], v[96:99]
ds_read_b64_tr_b16 v[120:121], v10 offset:12288
v_mfma_f32_16x16x32_bf16 v[100:103], a[36:39], v[84:87], v[100:103]
ds_read_b64_tr_b16 v[122:123], v10 offset:13312
v_mfma_f32_16x16x32_bf16 v[104:107], a[40:43], v[84:87], v[104:107]
ds_read_b64_tr_b16 v[124:125], v11 offset:12288
v_mfma_f32_16x16x32_bf16 v[108:111], a[44:47], v[84:87], v[108:111]
ds_read_b64_tr_b16 v[126:127], v11 offset:13312
buffer_load_dwordx4 v[84:87], v1, s[8:11], s24 offen offset:1024 sc1
s_waitcnt vmcnt(21)
v_mfma_f32_16x16x32_bf16 v[96:99], a[48:51], v[88:91], v[96:99]
v_mfma_f32_16x16x32_bf16 v[100:103], a[52:55], v[88:91], v[100:103]
v_mfma_f32_16x16x32_bf16 v[104:107], a[56:59], v[88:91], v[104:107]
v_mfma_f32_16x16x32_bf16 v[108:111], a[60:63], v[88:91], v[108:111]
buffer_load_dwordx4 v[88:91], v1, s[8:11], s24 offen offset:2048 sc1
s_waitcnt vmcnt(21) lgkmcnt(0)
v_mfma_f32_16x16x32_bf16 v[96:99], v[112:115], v[92:95], v[96:99]
v_mfma_f32_16x16x32_bf16 v[100:103], v[116:119], v[92:95], v[100:103]
v_mfma_f32_16x16x32_bf16 v[104:107], v[120:123], v[92:95], v[104:107]
v_mfma_f32_16x16x32_bf16 v[108:111], v[124:127], v[92:95], v[108:111]
buffer_load_dwordx4 v[92:95], v1, s[8:11], s24 offen offset:3072 sc1
s_waitcnt vmcnt(21)
v_mfma_f32_16x16x32_bf16 v[96:99], a[64:67], v[16:19], v[96:99]
ds_read_b64_tr_b16 v[112:113], v8 offset:16384
v_mfma_f32_16x16x32_bf16 v[100:103], a[68:71], v[16:19], v[100:103]
ds_read_b64_tr_b16 v[114:115], v8 offset:17408
v_mfma_f32_16x16x32_bf16 v[104:107], a[72:75], v[16:19], v[104:107]
ds_read_b64_tr_b16 v[116:117], v9 offset:16384
v_mfma_f32_16x16x32_bf16 v[108:111], a[76:79], v[16:19], v[108:111]
ds_read_b64_tr_b16 v[118:119], v9 offset:17408
s_add_u32 s24, s49, s31
buffer_load_dwordx4 v[16:19], v1, s[8:11], s24 offen offset:0 sc1
s_waitcnt vmcnt(21)
v_mfma_f32_16x16x32_bf16 v[96:99], a[80:83], v[20:23], v[96:99]
ds_read_b64_tr_b16 v[120:121], v10 offset:16384
v_mfma_f32_16x16x32_bf16 v[100:103], a[84:87], v[20:23], v[100:103]
ds_read_b64_tr_b16 v[122:123], v10 offset:17408
v_mfma_f32_16x16x32_bf16 v[104:107], a[88:91], v[20:23], v[104:107]
ds_read_b64_tr_b16 v[124:125], v11 offset:16384
v_mfma_f32_16x16x32_bf16 v[108:111], a[92:95], v[20:23], v[108:111]
ds_read_b64_tr_b16 v[126:127], v11 offset:17408
buffer_load_dwordx4 v[20:23], v1, s[8:11], s24 offen offset:1024 sc1
s_waitcnt vmcnt(21)
v_mfma_f32_16x16x32_bf16 v[96:99], a[96:99], v[24:27], v[96:99]
v_mfma_f32_16x16x32_bf16 v[100:103], a[100:103], v[24:27], v[100:103]
v_mfma_f32_16x16x32_bf16 v[104:107], a[104:107], v[24:27], v[104:107]
v_mfma_f32_16x16x32_bf16 v[108:111], a[108:111], v[24:27], v[108:111]
buffer_load_dwordx4 v[24:27], v1, s[8:11], s24 offen offset:2048 sc1
s_waitcnt vmcnt(21) lgkmcnt(0)
v_mfma_f32_16x16x32_bf16 v[96:99], v[112:115], v[28:31], v[96:99]
v_mfma_f32_16x16x32_bf16 v[100:103], v[116:119], v[28:31], v[100:103]
v_mfma_f32_16x16x32_bf16 v[104:107], v[120:123], v[28:31], v[104:107]
v_mfma_f32_16x16x32_bf16 v[108:111], v[124:127], v[28:31], v[108:111]
buffer_load_dwordx4 v[28:31], v1, s[8:11], s24 offen offset:3072 sc1
s_waitcnt vmcnt(19)
v_mfma_f32_16x16x32_bf16 v[96:99], a[112:115], v[32:35], v[96:99]
ds_read_b64_tr_b16 v[112:113], v8 offset:20480
v_mfma_f32_16x16x32_bf16 v[100:103], a[116:119], v[32:35], v[100:103]
ds_read_b64_tr_b16 v[114:115], v8 offset:21504
v_mfma_f32_16x16x32_bf16 v[104:107], a[120:123], v[32:35], v[104:107]
ds_read_b64_tr_b16 v[116:117], v9 offset:20480
v_mfma_f32_16x16x32_bf16 v[108:111], a[124:127], v[32:35], v[108:111]
ds_read_b64_tr_b16 v[118:119], v9 offset:21504
s_add_u32 s24, s49, s32
buffer_load_dwordx4 v[32:35], v1, s[8:11], s24 offen offset:0 sc1
s_waitcnt vmcnt(19)
v_mfma_f32_16x16x32_bf16 v[96:99], a[128:131], v[36:39], v[96:99]
ds_read_b64_tr_b16 v[120:121], v10 offset:20480
v_mfma_f32_16x16x32_bf16 v[100:103], a[132:135], v[36:39], v[100:103]
ds_read_b64_tr_b16 v[122:123], v10 offset:21504
v_mfma_f32_16x16x32_bf16 v[104:107], a[136:139], v[36:39], v[104:107]
ds_read_b64_tr_b16 v[124:125], v11 offset:20480
v_mfma_f32_16x16x32_bf16 v[108:111], a[140:143], v[36:39], v[108:111]
ds_read_b64_tr_b16 v[126:127], v11 offset:21504
buffer_load_dwordx4 v[36:39], v1, s[8:11], s24 offen offset:1024 sc1
s_waitcnt vmcnt(19)
v_mfma_f32_16x16x32_bf16 v[96:99], a[144:147], v[40:43], v[96:99]
v_mfma_f32_16x16x32_bf16 v[100:103], a[148:151], v[40:43], v[100:103]
v_mfma_f32_16x16x32_bf16 v[104:107], a[152:155], v[40:43], v[104:107]
v_mfma_f32_16x16x32_bf16 v[108:111], a[156:159], v[40:43], v[108:111]
buffer_load_dwordx4 v[40:43], v1, s[8:11], s24 offen offset:2048 sc1
s_waitcnt vmcnt(19) lgkmcnt(0)
v_mfma_f32_16x16x32_bf16 v[96:99], v[112:115], v[44:47], v[96:99]
v_mfma_f32_16x16x32_bf16 v[100:103], v[116:119], v[44:47], v[100:103]
v_mfma_f32_16x16x32_bf16 v[104:107], v[120:123], v[44:47], v[104:107]
v_mfma_f32_16x16x32_bf16 v[108:111], v[124:127], v[44:47], v[108:111]
buffer_load_dwordx4 v[44:47], v1, s[8:11], s24 offen offset:3072 sc1
s_waitcnt vmcnt(19)
v_mfma_f32_16x16x32_bf16 v[96:99], a[160:163], v[48:51], v[96:99]
ds_read_b64_tr_b16 v[112:113], v8 offset:24576
v_mfma_f32_16x16x32_bf16 v[100:103], a[164:167], v[48:51], v[100:103]
ds_read_b64_tr_b16 v[114:115], v8 offset:25600
v_mfma_f32_16x16x32_bf16 v[104:107], a[168:171], v[48:51], v[104:107]
ds_read_b64_tr_b16 v[116:117], v9 offset:24576
v_mfma_f32_16x16x32_bf16 v[108:111], a[172:175], v[48:51], v[108:111]
ds_read_b64_tr_b16 v[118:119], v9 offset:25600
s_add_u32 s24, s49, s33
buffer_load_dwordx4 v[48:51], v1, s[8:11], s24 offen offset:0 sc1
s_waitcnt vmcnt(19)
v_mfma_f32_16x16x32_bf16 v[96:99], a[176:179], v[52:55], v[96:99]
ds_read_b64_tr_b16 v[120:121], v10 offset:24576
v_mfma_f32_16x16x32_bf16 v[100:103], a[180:183], v[52:55], v[100:103]
ds_read_b64_tr_b16 v[122:123], v10 offset:25600
v_mfma_f32_16x16x32_bf16 v[104:107], a[184:187], v[52:55], v[104:107]
ds_read_b64_tr_b16 v[124:125], v11 offset:24576
v_mfma_f32_16x16x32_bf16 v[108:111], a[188:191], v[52:55], v[108:111]
ds_read_b64_tr_b16 v[126:127], v11 offset:25600
buffer_load_dwordx4 v[52:55], v1, s[8:11], s24 offen offset:1024 sc1
s_waitcnt vmcnt(19)
v_mfma_f32_16x16x32_bf16 v[96:99], a[192:195], v[56:59], v[96:99]
v_mfma_f32_16x16x32_bf16 v[100:103], a[196:199], v[56:59], v[100:103]
v_mfma_f32_16x16x32_bf16 v[104:107], a[200:203], v[56:59], v[104:107]
v_mfma_f32_16x16x32_bf16 v[108:111], a[204:207], v[56:59], v[108:111]
buffer_load_dwordx4 v[56:59], v1, s[8:11], s24 offen offset:2048 sc1
s_waitcnt vmcnt(19) lgkmcnt(0)
v_mfma_f32_16x16x32_bf16 v[96:99], v[112:115], v[60:63], v[96:99]
v_mfma_f32_16x16x32_bf16 v[100:103], v[116:119], v[60:63], v[100:103]
v_mfma_f32_16x16x32_bf16 v[104:107], v[120:123], v[60:63], v[104:107]
v_mfma_f32_16x16x32_bf16 v[108:111], v[124:127], v[60:63], v[108:111]
buffer_load_dwordx4 v[60:63], v1, s[8:11], s24 offen offset:3072 sc1
s_waitcnt vmcnt(19)
v_mfma_f32_16x16x32_bf16 v[96:99], a[208:211], v[64:67], v[96:99]
ds_read_b64_tr_b16 v[112:113], v8 offset:28672
v_mfma_f32_16x16x32_bf16 v[100:103], a[212:215], v[64:67], v[100:103]
ds_read_b64_tr_b16 v[114:115], v8 offset:29696
v_mfma_f32_16x16x32_bf16 v[104:107], a[216:219], v[64:67], v[104:107]
ds_read_b64_tr_b16 v[116:117], v9 offset:28672
v_mfma_f32_16x16x32_bf16 v[108:111], a[220:223], v[64:67], v[108:111]
ds_read_b64_tr_b16 v[118:119], v9 offset:29696
s_add_u32 s24, s49, s34
buffer_load_dwordx4 v[64:67], v1, s[8:11], s24 offen offset:0 sc1
s_waitcnt vmcnt(19)
v_mfma_f32_16x16x32_bf16 v[96:99], a[224:227], v[68:71], v[96:99]
ds_read_b64_tr_b16 v[120:121], v10 offset:28672
v_mfma_f32_16x16x32_bf16 v[100:103], a[228:231], v[68:71], v[100:103]
ds_read_b64_tr_b16 v[122:123], v10 offset:29696
v_mfma_f32_16x16x32_bf16 v[104:107], a[232:235], v[68:71], v[104:107]
ds_read_b64_tr_b16 v[124:125], v11 offset:28672
v_mfma_f32_16x16x32_bf16 v[108:111], a[236:239], v[68:71], v[108:111]
ds_read_b64_tr_b16 v[126:127], v11 offset:29696
buffer_load_dwordx4 v[68:71], v1, s[8:11], s24 offen offset:1024 sc1
s_waitcnt vmcnt(19)
v_mfma_f32_16x16x32_bf16 v[96:99], a[240:243], v[72:75], v[96:99]
v_mfma_f32_16x16x32_bf16 v[100:103], a[244:247], v[72:75], v[100:103]
v_mfma_f32_16x16x32_bf16 v[104:107], a[248:251], v[72:75], v[104:107]
v_mfma_f32_16x16x32_bf16 v[108:111], a[252:255], v[72:75], v[108:111]
buffer_load_dwordx4 v[72:75], v1, s[8:11], s24 offen offset:2048 sc1
s_waitcnt vmcnt(19) lgkmcnt(0)
v_mfma_f32_16x16x32_bf16 v[96:99], v[112:115], v[76:79], v[96:99]
v_mfma_f32_16x16x32_bf16 v[100:103], v[116:119], v[76:79], v[100:103]
v_mfma_f32_16x16x32_bf16 v[104:107], v[120:123], v[76:79], v[104:107]
v_mfma_f32_16x16x32_bf16 v[108:111], v[124:127], v[76:79], v[108:111]
buffer_load_dwordx4 v[76:79], v1, s[8:11], s24 offen offset:3072 sc1
s_nop 3
ds_write_b128 v3, v[96:99] offset:0
ds_write_b128 v3, v[100:103] offset:4096
ds_write_b128 v3, v[104:107] offset:8192
ds_write_b128 v3, v[108:111] offset:12288
s_waitcnt lgkmcnt(0)
s_barrier
ds_read_b128 v[96:99], v7 offset:0
ds_read_b128 v[100:103], v7 offset:1024
ds_read_b128 v[104:107], v7 offset:2048
ds_read_b128 v[108:111], v7 offset:3072
ds_read_b64_tr_b16 v[112:113], v8 offset:0
ds_read_b64_tr_b16 v[114:115], v8 offset:1024
ds_read_b64_tr_b16 v[116:117], v9 offset:0
ds_read_b64_tr_b16 v[118:119], v9 offset:1024
ds_read_b64_tr_b16 v[120:121], v10 offset:0
ds_read_b64_tr_b16 v[122:123], v10 offset:1024
ds_read_b64_tr_b16 v[124:125], v11 offset:0
ds_read_b64_tr_b16 v[126:127], v11 offset:1024
s_mul_i32 s24, s41, 36864
s_waitcnt lgkmcnt(10)
v_pk_add_f32 v[96:97], v[96:97], v[100:101]
v_pk_add_f32 v[98:99], v[98:99], v[102:103]
s_waitcnt lgkmcnt(9)
v_pk_add_f32 v[96:97], v[96:97], v[104:105]
v_pk_add_f32 v[98:99], v[98:99], v[106:107]
s_waitcnt lgkmcnt(8)
v_pk_add_f32 v[96:97], v[96:97], v[108:109]
v_pk_add_f32 v[98:99], v[98:99], v[110:111]
v_cvt_pk_bf16_f32 v12, v96, v97
v_cvt_pk_bf16_f32 v13, v98, v99
buffer_store_dwordx2 v[12:13], v4, s[12:15], s24 offen
v_xor_b32 v3, 16384, v3
v_xor_b32 v7, 16384, v7
s_mov_b32 s41, s27
s_mov_b32 s48, s49
s_sub_u32 s42, s42, 1
s_cmp_eq_u32 s50, 0
s_cbranch_scc1 L_opl_c
L_opl_r3:
s_add_u32 s27, s41, s43
s_and_b32 s27, s27, 127
s_lshr_b32 s25, s27, s46
s_lshl_b32 s25, s25, 7
s_add_u32 s25, s25, s45
buffer_load_dword v6, v5, s[8:11], s25 offen sc1
s_lshl_b32 s49, s27, 17
s_add_u32 s49, s49, s44
s_waitcnt vmcnt(21)
v_mfma_f32_16x16x32_bf16 v[96:99], v[128:131], v[80:83], 0
v_mfma_f32_16x16x32_bf16 v[100:103], v[132:135], v[80:83], 0
v_mfma_f32_16x16x32_bf16 v[104:107], v[136:139], v[80:83], 0
v_mfma_f32_16x16x32_bf16 v[108:111], v[140:143], v[80:83], 0
s_add_u32 s24, s48, s35
buffer_load_dwordx4 v[80:83], v1, s[8:11], s24 offen offset:0 sc1
s_waitcnt vmcnt(21)
v_mfma_f32_16x16x32_bf16 v[96:99], v[144:147], v[84:87], v[96:99]
v_mfma_f32_16x16x32_bf16 v[100:103], v[148:151], v[84:87], v[100:103]
v_mfma_f32_16x16x32_bf16 v[104:107], v[152:155], v[84:87], v[104:107]
v_mfma_f32_16x16x32_bf16 v[108:111], v[156:159], v[84:87], v[108:111]
buffer_load_dwordx4 v[84:87], v1, s[8:11], s24 offen offset:1024 sc1
s_waitcnt vmcnt(21)
v_mfma_f32_16x16x32_bf16 v[96:99], v[160:163], v[88:91], v[96:99]
v_mfma_f32_16x16x32_bf16 v[100:103], v[164:167], v[88:91], v[100:103]
v_mfma_f32_16x16x32_bf16 v[104:107], v[168:171], v[88:91], v[104:107]
v_mfma_f32_16x16x32_bf16 v[108:111], v[172:175], v[88:91], v[108:111]
buffer_load_dwordx4 v[88:91], v1, s[8:11], s24 offen offset:2048 sc1
s_waitcnt vmcnt(21) lgkmcnt(0)
v_mfma_f32_16x16x32_bf16 v[96:99], v[112:115], v[92:95], v[96:99]
v_mfma_f32_16x16x32_bf16 v[100:103], v[116:119], v[92:95], v[100:103]
v_mfma_f32_16x16x32_bf16 v[104:107], v[120:123], v[92:95], v[104:107]
v_mfma_f32_16x16x32_bf16 v[108:111], v[124:127], v[92:95], v[108:111]
buffer_load_dwordx4 v[92:95], v1, s[8:11], s24 offen offset:3072 sc1
s_waitcnt vmcnt(21)
v_mfma_f32_16x16x32_bf16 v[96:99], v[176:179], v[16:19], v[96:99]
ds_read_b64_tr_b16 v[112:113], v8 offset:4096
v_mfma_f32_16x16x32_bf16 v[100:103], v[180:183], v[16:19], v[100:103]
ds_read_b64_tr_b16 v[114:115], v8 offset:5120
v_mfma_f32_16x16x32_bf16 v[104:107], v[184:187], v[16:19], v[104:107]
ds_read_b64_tr_b16 v[116:117], v9 offset:4096
v_mfma_f32_16x16x32_bf16 v[108:111], v[188:191], v[16:19], v[108:111]
ds_read_b64_tr_b16 v[118:119], v9 offset:5120
s_add_u32 s24, s48, s36
buffer_load_dwordx4 v[16:19], v1, s[8:11], s24 offen offset:0 sc1
s_waitcnt vmcnt(21)
v_mfma_f32_16x16x32_bf16 v[96:99], v[192:195], v[20:23], v[96:99]
ds_read_b64_tr_b16 v[120:121], v10 offset:4096
v_mfma_f32_16x16x32_bf16 v[100:103], v[196:199], v[20:23], v[100:103]
ds_read_b64_tr_b16 v[122:123], v10 offset:5120
v_mfma_f32_16x16x32_bf16 v[104:107], v[200:203], v[20:23], v[104:107]
ds_read_b64_tr_b16 v[124:125], v11 offset:4096
v_mfma_f32_16x16x32_bf16 v[108:111], v[204:207], v[20:23], v[108:111]
ds_read_b64_tr_b16 v[126:127], v11 offset:5120
buffer_load_dwordx4 v[20:23], v1, s[8:11], s24 offen offset:1024 sc1
s_waitcnt vmcnt(21)
v_mfma_f32_16x16x32_bf16 v[96:99], v[208:211], v[24:27], v[96:99]
v_mfma_f32_16x16x32_bf16 v[100:103], v[212:215], v[24:27], v[100:103]
v_mfma_f32_16x16x32_bf16 v[104:107], v[216:219], v[24:27], v[104:107]
v_mfma_f32_16x16x32_bf16 v[108:111], v[220:223], v[24:27], v[108:111]
buffer_load_dwordx4 v[24:27], v1, s[8:11], s24 offen offset:2048 sc1
s_waitcnt vmcnt(21) lgkmcnt(0)
v_mfma_f32_16x16x32_bf16 v[96:99], v[112:115], v[28:31], v[96:99]
v_mfma_f32_16x16x32_bf16 v[100:103], v[116:119], v[28:31], v[100:103]
v_mfma_f32_16x16x32_bf16 v[104:107], v[120:123], v[28:31], v[104:107]
v_mfma_f32_16x16x32_bf16 v[108:111], v[124:127], v[28:31], v[108:111]
buffer_load_dwordx4 v[28:31], v1, s[8:11], s24 offen offset:3072 sc1
s_waitcnt vmcnt(21)
v_mfma_f32_16x16x32_bf16 v[96:99], v[224:227], v[32:35], v[96:99]
ds_read_b64_tr_b16 v[112:113], v8 offset:8192
v_mfma_f32_16x16x32_bf16 v[100:103], v[228:231], v[32:35], v[100:103]
ds_read_b64_tr_b16 v[114:115], v8 offset:9216
v_mfma_f32_16x16x32_bf16 v[104:107], v[232:235], v[32:35], v[104:107]
ds_read_b64_tr_b16 v[116:117], v9 offset:8192
v_mfma_f32_16x16x32_bf16 v[108:111], v[236:239], v[32:35], v[108:111]
ds_read_b64_tr_b16 v[118:119], v9 offset:9216
s_add_u32 s24, s48, s37
buffer_load_dwordx4 v[32:35], v1, s[8:11], s24 offen offset:0 sc1
s_waitcnt vmcnt(21)
v_mfma_f32_16x16x32_bf16 v[96:99], v[240:243], v[36:39], v[96:99]
ds_read_b64_tr_b16 v[120:121], v10 offset:8192
v_mfma_f32_16x16x32_bf16 v[100:103], v[244:247], v[36:39], v[100:103]
ds_read_b64_tr_b16 v[122:123], v10 offset:9216
v_mfma_f32_16x16x32_bf16 v[104:107], v[248:251], v[36:39], v[104:107]
ds_read_b64_tr_b16 v[124:125], v11 offset:8192
v_mfma_f32_16x16x32_bf16 v[108:111], v[252:255], v[36:39], v[108:111]
ds_read_b64_tr_b16 v[126:127], v11 offset:9216
buffer_load_dwordx4 v[36:39], v1, s[8:11], s24 offen offset:1024 sc1
s_waitcnt vmcnt(21)
v_mfma_f32_16x16x32_bf16 v[96:99], a[0:3], v[40:43], v[96:99]
v_mfma_f32_16x16x32_bf16 v[100:103], a[4:7], v[40:43], v[100:103]
v_mfma_f32_16x16x32_bf16 v[104:107], a[8:11], v[40:43], v[104:107]
v_mfma_f32_16x16x32_bf16 v[108:111], a[12:15], v[40:43], v[108:111]
buffer_load_dwordx4 v[40:43], v1, s[8:11], s24 offen offset:2048 sc1
s_waitcnt vmcnt(21) lgkmcnt(0)
v_mfma_f32_16x16x32_bf16 v[96:99], v[112:115], v[44:47], v[96:99]
v_mfma_f32_16x16x32_bf16 v[100:103], v[116:119], v[44:47], v[100:103]
v_mfma_f32_16x16x32_bf16 v[104:107], v[120:123], v[44:47], v[104:107]
v_mfma_f32_16x16x32_bf16 v[108:111], v[124:127], v[44:47], v[108:111]
buffer_load_dwordx4 v[44:47], v1, s[8:11], s24 offen offset:3072 sc1
s_waitcnt vmcnt(21)
v_mfma_f32_16x16x32_bf16 v[96:99], a[16:19], v[48:51], v[96:99]
ds_read_b64_tr_b16 v[112:113], v8 offset:12288
v_mfma_f32_16x16x32_bf16 v[100:103], a[20:23], v[48:51], v[100:103]
ds_read_b64_tr_b16 v[114:115], v8 offset:13312
v_mfma_f32_16x16x32_bf16 v[104:107], a[24:27], v[48:51], v[104:107]
ds_read_b64_tr_b16 v[116:117], v9 offset:12288
v_mfma_f32_16x16x32_bf16 v[108:111], a[28:31], v[48:51], v[108:111]
ds_read_b64_tr_b16 v[118:119], v9 offset:13312
s_waitcnt vmcnt(12)
v_cmp_ne_u32 vcc, 1, v6
s_cmp_gt_u32 s42, 1
s_cselect_b32 s50, 1, 0
s_cmp_eq_u64 vcc, 0
s_cselect_b32 s50, s50, 0
s_cmp_eq_u32 s50, 1
s_cselect_b32 s49, s49, 536870912
s_add_u32 s24, s49, s30
buffer_load_dwordx4 v[48:51], v1, s[8:11], s24 offen offset:0 sc1
s_waitcnt vmcnt(21)
v_mfma_f32_16x16x32_bf16 v[96:99], a[32:35], v[52:55], v[96:99]
ds_read_b64_tr_b16 v[120:121], v10 offset:12288
v_mfma_f32_16x16x32_bf16 v[100:103], a[36:39], v[52:55], v[100:103]
ds_read_b64_tr_b16 v[122:123], v10 offset:13312
v_mfma_f32_16x16x32_bf16 v[104:107], a[40:43], v[52:55], v[104:107]
ds_read_b64_tr_b16 v[124:125], v11 offset:12288
v_mfma_f32_16x16x32_bf16 v[108:111], a[44:47], v[52:55], v[108:111]
ds_read_b64_tr_b16 v[126:127], v11 offset:13312
buffer_load_dwordx4 v[52:55], v1, s[8:11], s24 offen offset:1024 sc1
s_waitcnt vmcnt(21)
v_mfma_f32_16x16x32_bf16 v[96:99], a[48:51], v[56:59], v[96:99]
v_mfma_f32_16x16x32_bf16 v[100:103], a[52:55], v[56:59], v[100:103]
v_mfma_f32_16x16x32_bf16 v[104:107], a[56:59], v[56:59], v[104:107]
v_mfma_f32_16x16x32_bf16 v[108:111], a[60:63], v[56:59], v[108:111]
buffer_load_dwordx4 v[56:59], v1, s[8:11], s24 offen offset:2048 sc1
s_waitcnt vmcnt(21) lgkmcnt(0)
v_mfma_f32_16x16x32_bf16 v[96:99], v[112:115], v[60:63], v[96:99]
v_mfma_f32_16x16x32_bf16 v[100:103], v[116:119], v[60:63], v[100:103]
v_mfma_f32_16x16x32_bf16 v[104:107], v[120:123], v[60:63], v[104:107]
v_mfma_f32_16x16x32_bf16 v[108:111], v[124:127], v[60:63], v[108:111]
buffer_load_dwordx4 v[60:63], v1, s[8:11], s24 offen offset:3072 sc1
s_waitcnt vmcnt(21)
v_mfma_f32_16x16x32_bf16 v[96:99], a[64:67], v[64:67], v[96:99]
ds_read_b64_tr_b16 v[112:113], v8 offset:16384
v_mfma_f32_16x16x32_bf16 v[100:103], a[68:71], v[64:67], v[100:103]
ds_read_b64_tr_b16 v[114:115], v8 offset:17408
v_mfma_f32_16x16x32_bf16 v[104:107], a[72:75], v[64:67], v[104:107]
ds_read_b64_tr_b16 v[116:117], v9 offset:16384
v_mfma_f32_16x16x32_bf16 v[108:111], a[76:79], v[64:67], v[108:111]
ds_read_b64_tr_b16 v[118:119], v9 offset:17408
s_add_u32 s24, s49, s31
buffer_load_dwordx4 v[64:67], v1, s[8:11], s24 offen offset:0 sc1
s_waitcnt vmcnt(21)
v_mfma_f32_16x16x32_bf16 v[96:99], a[80:83], v[68:71], v[96:99]
ds_read_b64_tr_b16 v[120:121], v10 offset:16384
v_mfma_f32_16x16x32_bf16 v[100:103], a[84:87], v[68:71], v[100:103]
ds_read_b64_tr_b16 v[122:123], v10 offset:17408
v_mfma_f32_16x16x32_bf16 v[104:107], a[88:91], v[68:71], v[104:107]
ds_read_b64_tr_b16 v[124:125], v11 offset:16384
v_mfma_f32_16x16x32_bf16 v[108:111], a[92:95], v[68:71], v[108:111]
ds_read_b64_tr_b16 v[126:127], v11 offset:17408
buffer_load_dwordx4 v[68:71], v1, s[8:11], s24 offen offset:1024 sc1
s_waitcnt vmcnt(21)
v_mfma_f32_16x16x32_bf16 v[96:99], a[96:99], v[72:75], v[96:99]
v_mfma_f32_16x16x32_bf16 v[100:103], a[100:103], v[72:75], v[100:103]
v_mfma_f32_16x16x32_bf16 v[104:107], a[104:107], v[72:75], v[104:107]
v_mfma_f32_16x16x32_bf16 v[108:111], a[108:111], v[72:75], v[108:111]
buffer_load_dwordx4 v[72:75], v1, s[8:11], s24 offen offset:2048 sc1
s_waitcnt vmcnt(21) lgkmcnt(0)
v_mfma_f32_16x16x32_bf16 v[96:99], v[112:115], v[76:79], v[96:99]
v_mfma_f32_16x16x32_bf16 v[100:103], v[116:119], v[76:79], v[100:103]
v_mfma_f32_16x16x32_bf16 v[104:107], v[120:123], v[76:79], v[104:107]
v_mfma_f32_16x16x32_bf16 v[108:111], v[124:127], v[76:79], v[108:111]
buffer_load_dwordx4 v[76:79], v1, s[8:11], s24 offen offset:3072 sc1
s_waitcnt vmcnt(19)
v_mfma_f32_16x16x32_bf16 v[96:99], a[112:115], v[80:83], v[96:99]
ds_read_b64_tr_b16 v[112:113], v8 offset:20480
v_mfma_f32_16x16x32_bf16 v[100:103], a[116:119], v[80:83], v[100:103]
ds_read_b64_tr_b16 v[114:115], v8 offset:21504
v_mfma_f32_16x16x32_bf16 v[104:107], a[120:123], v[80:83], v[104:107]
ds_read_b64_tr_b16 v[116:117], v9 offset:20480
v_mfma_f32_16x16x32_bf16 v[108:111], a[124:127], v[80:83], v[108:111]
ds_read_b64_tr_b16 v[118:119], v9 offset:21504
s_add_u32 s24, s49, s32
buffer_load_dwordx4 v[80:83], v1, s[8:11], s24 offen offset:0 sc1
s_waitcnt vmcnt(19)
v_mfma_f32_16x16x32_bf16 v[96:99], a[128:131], v[84:87], v[96:99]
ds_read_b64_tr_b16 v[120:121], v10 offset:20480
v_mfma_f32_16x16x32_bf16 v[100:103], a[132:135], v[84:87], v[100:103]
ds_read_b64_tr_b16 v[122:123], v10 offset:21504
v_mfma_f32_16x16x32_bf16 v[104:107], a[136:139], v[84:87], v[104:107]
ds_read_b64_tr_b16 v[124:125], v11 offset:20480
v_mfma_f32_16x16x32_bf16 v[108:111], a[140:143], v[84:87], v[108:111]
ds_read_b64_tr_b16 v[126:127], v11 offset:21504
buffer_load_dwordx4 v[84:87], v1, s[8:11], s24 offen offset:1024 sc1
s_waitcnt vmcnt(19)
v_mfma_f32_16x16x32_bf16 v[96:99], a[144:147], v[88:91], v[96:99]
v_mfma_f32_16x16x32_bf16 v[100:103], a[148:151], v[88:91], v[100:103]
v_mfma_f32_16x16x32_bf16 v[104:107], a[152:155], v[88:91], v[104:107]
v_mfma_f32_16x16x32_bf16 v[108:111], a[156:159], v[88:91], v[108:111]
buffer_load_dwordx4 v[88:91], v1, s[8:11], s24 offen offset:2048 sc1
s_waitcnt vmcnt(19) lgkmcnt(0)
v_mfma_f32_16x16x32_bf16 v[96:99], v[112:115], v[92:95], v[96:99]
v_mfma_f32_16x16x32_bf16 v[100:103], v[116:119], v[92:95], v[100:103]
v_mfma_f32_16x16x32_bf16 v[104:107], v[120:123], v[92:95], v[104:107]
v_mfma_f32_16x16x32_bf16 v[108:111], v[124:127], v[92:95], v[108:111]
buffer_load_dwordx4 v[92:95], v1, s[8:11], s24 offen offset:3072 sc1
s_waitcnt vmcnt(19)
v_mfma_f32_16x16x32_bf16 v[96:99], a[160:163], v[16:19], v[96:99]
ds_read_b64_tr_b16 v[112:113], v8 offset:24576
v_mfma_f32_16x16x32_bf16 v[100:103], a[164:167], v[16:19], v[100:103]
ds_read_b64_tr_b16 v[114:115], v8 offset:25600
v_mfma_f32_16x16x32_bf16 v[104:107], a[168:171], v[16:19], v[104:107]
ds_read_b64_tr_b16 v[116:117], v9 offset:24576
v_mfma_f32_16x16x32_bf16 v[108:111], a[172:175], v[16:19], v[108:111]
ds_read_b64_tr_b16 v[118:119], v9 offset:25600
s_add_u32 s24, s49, s33
buffer_load_dwordx4 v[16:19], v1, s[8:11], s24 offen offset:0 sc1
s_waitcnt vmcnt(19)
v_mfma_f32_16x16x32_bf16 v[96:99], a[176:179], v[20:23], v[96:99]
ds_read_b64_tr_b16 v[120:121], v10 offset:24576
v_mfma_f32_16x16x32_bf16 v[100:103], a[180:183], v[20:23], v[100:103]
ds_read_b64_tr_b16 v[122:123], v10 offset:25600
v_mfma_f32_16x16x32_bf16 v[104:107], a[184:187], v[20:23], v[104:107]
ds_read_b64_tr_b16 v[124:125], v11 offset:24576
v_mfma_f32_16x16x32_bf16 v[108:111], a[188:191], v[20:23], v[108:111]
ds_read_b64_tr_b16 v[126:127], v11 offset:25600
buffer_load_dwordx4 v[20:23], v1, s[8:11], s24 offen offset:1024 sc1
s_waitcnt vmcnt(19)
v_mfma_f32_16x16x32_bf16 v[96:99], a[192:195], v[24:27], v[96:99]
v_mfma_f32_16x16x32_bf16 v[100:103], a[196:199], v[24:27], v[100:103]
v_mfma_f32_16x16x32_bf16 v[104:107], a[200:203], v[24:27], v[104:107]
v_mfma_f32_16x16x32_bf16 v[108:111], a[204:207], v[24:27], v[108:111]
buffer_load_dwordx4 v[24:27], v1, s[8:11], s24 offen offset:2048 sc1
s_waitcnt vmcnt(19) lgkmcnt(0)
v_mfma_f32_16x16x32_bf16 v[96:99], v[112:115], v[28:31], v[96:99]
v_mfma_f32_16x16x32_bf16 v[100:103], v[116:119], v[28:31], v[100:103]
v_mfma_f32_16x16x32_bf16 v[104:107], v[120:123], v[28:31], v[104:107]
v_mfma_f32_16x16x32_bf16 v[108:111], v[124:127], v[28:31], v[108:111]
buffer_load_dwordx4 v[28:31], v1, s[8:11], s24 offen offset:3072 sc1
s_waitcnt vmcnt(19)
v_mfma_f32_16x16x32_bf16 v[96:99], a[208:211], v[32:35], v[96:99]
ds_read_b64_tr_b16 v[112:113], v8 offset:28672
v_mfma_f32_16x16x32_bf16 v[100:103], a[212:215], v[32:35], v[100:103]
ds_read_b64_tr_b16 v[114:115], v8 offset:29696
v_mfma_f32_16x16x32_bf16 v[104:107], a[216:219], v[32:35], v[104:107]
ds_read_b64_tr_b16 v[116:117], v9 offset:28672
v_mfma_f32_16x16x32_bf16 v[108:111], a[220:223], v[32:35], v[108:111]
ds_read_b64_tr_b16 v[118:119], v9 offset:29696
s_add_u32 s24, s49, s34
buffer_load_dwordx4 v[32:35], v1, s[8:11], s24 offen offset:0 sc1
s_waitcnt vmcnt(19)
v_mfma_f32_16x16x32_bf16 v[96:99], a[224:227], v[36:39], v[96:99]
ds_read_b64_tr_b16 v[120:121], v10 offset:28672
v_mfma_f32_16x16x32_bf16 v[100:103], a[228:231], v[36:39], v[100:103]
ds_read_b64_tr_b16 v[122:123], v10 offset:29696
v_mfma_f32_16x16x32_bf16 v[104:107], a[232:235], v[36:39], v[104:107]
ds_read_b64_tr_b16 v[124:125], v11 offset:28672
v_mfma_f32_16x16x32_bf16 v[108:111], a[236:239], v[36:39], v[108:111]
ds_read_b64_tr_b16 v[126:127], v11 offset:29696
buffer_load_dwordx4 v[36:39], v1, s[8:11], s24 offen offset:1024 sc1
s_waitcnt vmcnt(19)
v_mfma_f32_16x16x32_bf16 v[96:99], a[240:243], v[40:43], v[96:99]
v_mfma_f32_16x16x32_bf16 v[100:103], a[244:247], v[40:43], v[100:103]
v_mfma_f32_16x16x32_bf16 v[104:107], a[248:251], v[40:43], v[104:107]
v_mfma_f32_16x16x32_bf16 v[108:111], a[252:255], v[40:43], v[108:111]
buffer_load_dwordx4 v[40:43], v1, s[8:11], s24 offen offset:2048 sc1
s_waitcnt vmcnt(19) lgkmcnt(0)
v_mfma_f32_16x16x32_bf16 v[96:99], v[112:115], v[44:47], v[96:99]
v_mfma_f32_16x16x32_bf16 v[100:103], v[116:119], v[44:47], v[100:103]
v_mfma_f32_16x16x32_bf16 v[104:107], v[120:123], v[44:47], v[104:107]
v_mfma_f32_16x16x32_bf16 v[108:111], v[124:127], v[44:47], v[108:111]
buffer_load_dwordx4 v[44:47], v1, s[8:11], s24 offen offset:3072 sc1
s_nop 3
ds_write_b128 v3, v[96:99] offset:0
ds_write_b128 v3, v[100:103] offset:4096
ds_write_b128 v3, v[104:107] offset:8192
ds_write_b128 v3, v[108:111] offset:12288
s_waitcnt lgkmcnt(0)
s_barrier
ds_read_b128 v[96:99], v7 offset:0
ds_read_b128 v[100:103], v7 offset:1024
ds_read_b128 v[104:107], v7 offset:2048
ds_read_b128 v[108:111], v7 offset:3072
ds_read_b64_tr_b16 v[112:113], v8 offset:0
ds_read_b64_tr_b16 v[114:115], v8 offset:1024
ds_read_b64_tr_b16 v[116:117], v9 offset:0
ds_read_b64_tr_b16 v[118:119], v9 offset:1024
ds_read_b64_tr_b16 v[120:121], v10 offset:0
ds_read_b64_tr_b16 v[122:123], v10 offset:1024
ds_read_b64_tr_b16 v[124:125], v11 offset:0
ds_read_b64_tr_b16 v[126:127], v11 offset:1024
s_mul_i32 s24, s41, 36864
s_waitcnt lgkmcnt(10)
v_pk_add_f32 v[96:97], v[96:97], v[100:101]
v_pk_add_f32 v[98:99], v[98:99], v[102:103]
s_waitcnt lgkmcnt(9)
v_pk_add_f32 v[96:97], v[96:97], v[104:105]
v_pk_add_f32 v[98:99], v[98:99], v[106:107]
s_waitcnt lgkmcnt(8)
v_pk_add_f32 v[96:97], v[96:97], v[108:109]
v_pk_add_f32 v[98:99], v[98:99], v[110:111]
v_cvt_pk_bf16_f32 v12, v96, v97
v_cvt_pk_bf16_f32 v13, v98, v99
buffer_store_dwordx2 v[12:13], v4, s[12:15], s24 offen
v_xor_b32 v3, 16384, v3
v_xor_b32 v7, 16384, v7
s_mov_b32 s41, s27
s_mov_b32 s48, s49
s_sub_u32 s42, s42, 1
s_cmp_eq_u32 s50, 0
s_cbranch_scc1 L_opl_c
L_opl_r4:
s_add_u32 s27, s41, s43
s_and_b32 s27, s27, 127
s_lshr_b32 s25, s27, s46
s_lshl_b32 s25, s25, 7
s_add_u32 s25, s25, s45
buffer_load_dword v6, v5, s[8:11], s25 offen sc1
s_lshl_b32 s49, s27, 17
s_add_u32 s49, s49, s44
s_waitcnt vmcnt(21)
v_mfma_f32_16x16x32_bf16 v[96:99], v[128:131], v[48:51], 0
v_mfma_f32_16x16x32_bf16 v[100:103], v[132:135], v[48:51], 0
v_mfma_f32_16x16x32_bf16 v[104:107], v[136:139], v[48:51], 0
v_mfma_f32_16x16x32_bf16 v[108:111], v[140:143], v[48:51], 0
s_add_u32 s24, s48, s35
buffer_load_dwordx4 v[48:51], v1, s[8:11], s24 offen offset:0 sc1
s_waitcnt vmcnt(21)
v_mfma_f32_16x16x32_bf16 v[96:99], v[144:147], v[52:55], v[96:99]
v_mfma_f32_16x16x32_bf16 v[100:103], v[148:151], v[52:55], v[100:103]
v_mfma_f32_16x16x32_bf16 v[104:107], v[152:155], v[52:55], v[104:107]
v_mfma_f32_16x16x32_bf16 v[108:111], v[156:159], v[52:55], v[108:111]
buffer_load_dwordx4 v[52:55], v1, s[8:11], s24 offen offset:1024 sc1
s_waitcnt vmcnt(21)
v_mfma_f32_16x16x32_bf16 v[96:99], v[160:163], v[56:59], v[96:99]
v_mfma_f32_16x16x32_bf16 v[100:103], v[164:167], v[56:59], v[100:103]
v_mfma_f32_16x16x32_bf16 v[104:107], v[168:171], v[56:59], v[104:107]
v_mfma_f32_16x16x32_bf16 v[108:111], v[172:175], v[56:59], v[108:111]
buffer_load_dwordx4 v[56:59], v1, s[8:11], s24 offen offset:2048 sc1
s_waitcnt vmcnt(21) lgkmcnt(0)
v_mfma_f32_16x16x32_bf16 v[96:99], v[112:115], v[60:63], v[96:99]
v_mfma_f32_16x16x32_bf16 v[100:103], v[116:119], v[60:63], v[100:103]
v_mfma_f32_16x16x32_bf16 v[104:107], v[120:123], v[60:63], v[104:107]
v_mfma_f32_16x16x32_bf16 v[108:111], v[124:127], v[60:63], v[108:111]
buffer_load_dwordx4 v[60:63], v1, s[8:11], s24 offen offset:3072 sc1
s_waitcnt vmcnt(21)
v_mfma_f32_16x16x32_bf16 v[96:99], v[176:179], v[64:67], v[96:99]
ds_read_b64_tr_b16 v[112:113], v8 offset:4096
v_mfma_f32_16x16x32_bf16 v[100:103], v[180:183], v[64:67], v[100:103]
ds_read_b64_tr_b16 v[114:115], v8 offset:5120
v_mfma_f32_16x16x32_bf16 v[104:107], v[184:187], v[64:67], v[104:107]
ds_read_b64_tr_b16 v[116:117], v9 offset:4096
v_mfma_f32_16x16x32_bf16 v[108:111], v[188:191], v[64:67], v[108:111]
ds_read_b64_tr_b16 v[118:119], v9 offset:5120
s_add_u32 s24, s48, s36
buffer_load_dwordx4 v[64:67], v1, s[8:11], s24 offen offset:0 sc1
s_waitcnt vmcnt(21)
v_mfma_f32_16x16x32_bf16 v[96:99], v[192:195], v[68:71], v[96:99]
ds_read_b64_tr_b16 v[120:121], v10 offset:4096
v_mfma_f32_16x16x32_bf16 v[100:103], v[196:199], v[68:71], v[100:103]
ds_read_b64_tr_b16 v[122:123], v10 offset:5120
v_mfma_f32_16x16x32_bf16 v[104:107], v[200:203], v[68:71], v[104:107]
ds_read_b64_tr_b16 v[124:125], v11 offset:4096
v_mfma_f32_16x16x32_bf16 v[108:111], v[204:207], v[68:71], v[108:111]
ds_read_b64_tr_b16 v[126:127], v11 offset:5120
buffer_load_dwordx4 v[68:71], v1, s[8:11], s24 offen offset:1024 sc1
s_waitcnt vmcnt(21)
v_mfma_f32_16x16x32_bf16 v[96:99], v[208:211], v[72:75], v[96:99]
v_mfma_f32_16x16x32_bf16 v[100:103], v[212:215], v[72:75], v[100:103]
v_mfma_f32_16x16x32_bf16 v[104:107], v[216:219], v[72:75], v[104:107]
v_mfma_f32_16x16x32_bf16 v[108:111], v[220:223], v[72:75], v[108:111]
buffer_load_dwordx4 v[72:75], v1, s[8:11], s24 offen offset:2048 sc1
s_waitcnt vmcnt(21) lgkmcnt(0)
v_mfma_f32_16x16x32_bf16 v[96:99], v[112:115], v[76:79], v[96:99]
v_mfma_f32_16x16x32_bf16 v[100:103], v[116:119], v[76:79], v[100:103]
v_mfma_f32_16x16x32_bf16 v[104:107], v[120:123], v[76:79], v[104:107]
v_mfma_f32_16x16x32_bf16 v[108:111], v[124:127], v[76:79], v[108:111]
buffer_load_dwordx4 v[76:79], v1, s[8:11], s24 offen offset:3072 sc1
s_waitcnt vmcnt(21)
v_mfma_f32_16x16x32_bf16 v[96:99], v[224:227], v[80:83], v[96:99]
ds_read_b64_tr_b16 v[112:113], v8 offset:8192
v_mfma_f32_16x16x32_bf16 v[100:103], v[228:231], v[80:83], v[100:103]
ds_read_b64_tr_b16 v[114:115], v8 offset:9216
v_mfma_f32_16x16x32_bf16 v[104:107], v[232:235], v[80:83], v[104:107]
ds_read_b64_tr_b16 v[116:117], v9 offset:8192
v_mfma_f32_16x16x32_bf16 v[108:111], v[236:239], v[80:83], v[108:111]
ds_read_b64_tr_b16 v[118:119], v9 offset:9216
s_add_u32 s24, s48, s37
buffer_load_dwordx4 v[80:83], v1, s[8:11], s24 offen offset:0 sc1
s_waitcnt vmcnt(21)
v_mfma_f32_16x16x32_bf16 v[96:99], v[240:243], v[84:87], v[96:99]
ds_read_b64_tr_b16 v[120:121], v10 offset:8192
v_mfma_f32_16x16x32_bf16 v[100:103], v[244:247], v[84:87], v[100:103]
ds_read_b64_tr_b16 v[122:123], v10 offset:9216
v_mfma_f32_16x16x32_bf16 v[104:107], v[248:251], v[84:87], v[104:107]
ds_read_b64_tr_b16 v[124:125], v11 offset:8192
v_mfma_f32_16x16x32_bf16 v[108:111], v[252:255], v[84:87], v[108:111]
ds_read_b64_tr_b16 v[126:127], v11 offset:9216
buffer_load_dwordx4 v[84:87], v1, s[8:11], s24 offen offset:1024 sc1
s_waitcnt vmcnt(21)
v_mfma_f32_16x16x32_bf16 v[96:99], a[0:3], v[88:91], v[96:99]
v_mfma_f32_16x16x32_bf16 v[100:103], a[4:7], v[88:91], v[100:103]
v_mfma_f32_16x16x32_bf16 v[104:107], a[8:11], v[88:91], v[104:107]
v_mfma_f32_16x16x32_bf16 v[108:111], a[12:15], v[88:91], v[108:111]
buffer_load_dwordx4 v[88:91], v1, s[8:11], s24 offen offset:2048 sc1
s_waitcnt vmcnt(21) lgkmcnt(0)
v_mfma_f32_16x16x32_bf16 v[96:99], v[112:115], v[92:95], v[96:99]
v_mfma_f32_16x16x32_bf16 v[100:103], v[116:119], v[92:95], v[100:103]
v_mfma_f32_16x16x32_bf16 v[104:107], v[120:123], v[92:95], v[104:107]
v_mfma_f32_16x16x32_bf16 v[108:111], v[124:127], v[92:95], v[108:111]
buffer_load_dwordx4 v[92:95], v1, s[8:11], s24 offen offset:3072 sc1
s_waitcnt vmcnt(21)
v_mfma_f32_16x16x32_bf16 v[96:99], a[16:19], v[16:19], v[96:99]
ds_read_b64_tr_b16 v[112:113], v8 offset:12288
v_mfma_f32_16x16x32_bf16 v[100:103], a[20:23], v[16:19], v[100:103]
ds_read_b64_tr_b16 v[114:115], v8 offset:13312
v_mfma_f32_16x16x32_bf16 v[104:107], a[24:27], v[16:19], v[104:107]
ds_read_b64_tr_b16 v[116:117], v9 offset:12288
v_mfma_f32_16x16x32_bf16 v[108:111], a[28:31], v[16:19], v[108:111]
ds_read_b64_tr_b16 v[118:119], v9 offset:13312
s_waitcnt vmcnt(12)
v_cmp_ne_u32 vcc, 1, v6
s_cmp_gt_u32 s42, 1
s_cselect_b32 s50, 1, 0
s_cmp_eq_u64 vcc, 0
s_cselect_b32 s50, s50, 0
s_cmp_eq_u32 s50, 1
s_cselect_b32 s49, s49, 536870912
s_add_u32 s24, s49, s30
buffer_load_dwordx4 v[16:19], v1, s[8:11], s24 offen offset:0 sc1
s_waitcnt vmcnt(21)
v_mfma_f32_16x16x32_bf16 v[96:99], a[32:35], v[20:23], v[96:99]
ds_read_b64_tr_b16 v[120:121], v10 offset:12288
v_mfma_f32_16x16x32_bf16 v[100:103], a[36:39], v[20:23], v[100:103]
ds_read_b64_tr_b16 v[122:123], v10 offset:13312
v_mfma_f32_16x16x32_bf16 v[104:107], a[40:43], v[20:23], v[104:107]
ds_read_b64_tr_b16 v[124:125], v11 offset:12288
v_mfma_f32_16x16x32_bf16 v[108:111], a[44:47], v[20:23], v[108:111]
ds_read_b64_tr_b16 v[126:127], v11 offset:13312
buffer_load_dwordx4 v[20:23], v1, s[8:11], s24 offen offset:1024 sc1
s_waitcnt vmcnt(21)
v_mfma_f32_16x16x32_bf16 v[96:99], a[48:51], v[24:27], v[96:99]
v_mfma_f32_16x16x32_bf16 v[100:103], a[52:55], v[24:27], v[100:103]
v_mfma_f32_16x16x32_bf16 v[104:107], a[56:59], v[24:27], v[104:107]
v_mfma_f32_16x16x32_bf16 v[108:111], a[60:63], v[24:27], v[108:111]
buffer_load_dwordx4 v[24:27], v1, s[8:11], s24 offen offset:2048 sc1
s_waitcnt vmcnt(21) lgkmcnt(0)
v_mfma_f32_16x16x32_bf16 v[96:99], v[112:115], v[28:31], v[96:99]
v_mfma_f32_16x16x32_bf16 v[100:103], v[116:119], v[28:31], v[100:103]
v_mfma_f32_16x16x32_bf16 v[104:107], v[120:123], v[28:31], v[104:107]
v_mfma_f32_16x16x32_bf16 v[108:111], v[124:127], v[28:31], v[108:111]
buffer_load_dwordx4 v[28:31], v1, s[8:11], s24 offen offset:3072 sc1
s_waitcnt vmcnt(21)
v_mfma_f32_16x16x32_bf16 v[96:99], a[64:67], v[32:35], v[96:99]
ds_read_b64_tr_b16 v[112:113], v8 offset:16384
v_mfma_f32_16x16x32_bf16 v[100:103], a[68:71], v[32:35], v[100:103]
ds_read_b64_tr_b16 v[114:115], v8 offset:17408
v_mfma_f32_16x16x32_bf16 v[104:107], a[72:75], v[32:35], v[104:107]
ds_read_b64_tr_b16 v[116:117], v9 offset:16384
v_mfma_f32_16x16x32_bf16 v[108:111], a[76:79], v[32:35], v[108:111]
ds_read_b64_tr_b16 v[118:119], v9 offset:17408
s_add_u32 s24, s49, s31
buffer_load_dwordx4 v[32:35], v1, s[8:11], s24 offen offset:0 sc1
s_waitcnt vmcnt(21)
v_mfma_f32_16x16x32_bf16 v[96:99], a[80:83], v[36:39], v[96:99]
ds_read_b64_tr_b16 v[120:121], v10 offset:16384
v_mfma_f32_16x16x32_bf16 v[100:103], a[84:87], v[36:39], v[100:103]
ds_read_b64_tr_b16 v[122:123], v10 offset:17408
v_mfma_f32_16x16x32_bf16 v[104:107], a[88:91], v[36:39], v[104:107]
ds_read_b64_tr_b16 v[124:125], v11 offset:16384
v_mfma_f32_16x16x32_bf16 v[108:111], a[92:95], v[36:39], v[108:111]
ds_read_b64_tr_b16 v[126:127], v11 offset:17408
buffer_load_dwordx4 v[36:39], v1, s[8:11], s24 offen offset:1024 sc1
s_waitcnt vmcnt(21)
v_mfma_f32_16x16x32_bf16 v[96:99], a[96:99], v[40:43], v[96:99]
v_mfma_f32_16x16x32_bf16 v[100:103], a[100:103], v[40:43], v[100:103]
v_mfma_f32_16x16x32_bf16 v[104:107], a[104:107], v[40:43], v[104:107]
v_mfma_f32_16x16x32_bf16 v[108:111], a[108:111], v[40:43], v[108:111]
buffer_load_dwordx4 v[40:43], v1, s[8:11], s24 offen offset:2048 sc1
s_waitcnt vmcnt(21) lgkmcnt(0)
v_mfma_f32_16x16x32_bf16 v[96:99], v[112:115], v[44:47], v[96:99]
v_mfma_f32_16x16x32_bf16 v[100:103], v[116:119], v[44:47], v[100:103]
v_mfma_f32_16x16x32_bf16 v[104:107], v[120:123], v[44:47], v[104:107]
v_mfma_f32_16x16x32_bf16 v[108:111], v[124:127], v[44:47], v[108:111]
buffer_load_dwordx4 v[44:47], v1, s[8:11], s24 offen offset:3072 sc1
s_waitcnt vmcnt(19)
v_mfma_f32_16x16x32_bf16 v[96:99], a[112:115], v[48:51], v[96:99]
ds_read_b64_tr_b16 v[112:113], v8 offset:20480
v_mfma_f32_16x16x32_bf16 v[100:103], a[116:119], v[48:51], v[100:103]
ds_read_b64_tr_b16 v[114:115], v8 offset:21504
v_mfma_f32_16x16x32_bf16 v[104:107], a[120:123], v[48:51], v[104:107]
ds_read_b64_tr_b16 v[116:117], v9 offset:20480
v_mfma_f32_16x16x32_bf16 v[108:111], a[124:127], v[48:51], v[108:111]
ds_read_b64_tr_b16 v[118:119], v9 offset:21504
s_add_u32 s24, s49, s32
buffer_load_dwordx4 v[48:51], v1, s[8:11], s24 offen offset:0 sc1
s_waitcnt vmcnt(19)
v_mfma_f32_16x16x32_bf16 v[96:99], a[128:131], v[52:55], v[96:99]
ds_read_b64_tr_b16 v[120:121], v10 offset:20480
v_mfma_f32_16x16x32_bf16 v[100:103], a[132:135], v[52:55], v[100:103]
ds_read_b64_tr_b16 v[122:123], v10 offset:21504
v_mfma_f32_16x16x32_bf16 v[104:107], a[136:139], v[52:55], v[104:107]
ds_read_b64_tr_b16 v[124:125], v11 offset:20480
v_mfma_f32_16x16x32_bf16 v[108:111], a[140:143], v[52:55], v[108:111]
ds_read_b64_tr_b16 v[126:127], v11 offset:21504
buffer_load_dwordx4 v[52:55], v1, s[8:11], s24 offen offset:1024 sc1
s_waitcnt vmcnt(19)
v_mfma_f32_16x16x32_bf16 v[96:99], a[144:147], v[56:59], v[96:99]
v_mfma_f32_16x16x32_bf16 v[100:103], a[148:151], v[56:59], v[100:103]
v_mfma_f32_16x16x32_bf16 v[104:107], a[152:155], v[56:59], v[104:107]
v_mfma_f32_16x16x32_bf16 v[108:111], a[156:159], v[56:59], v[108:111]
buffer_load_dwordx4 v[56:59], v1, s[8:11], s24 offen offset:2048 sc1
s_waitcnt vmcnt(19) lgkmcnt(0)
v_mfma_f32_16x16x32_bf16 v[96:99], v[112:115], v[60:63], v[96:99]
v_mfma_f32_16x16x32_bf16 v[100:103], v[116:119], v[60:63], v[100:103]
v_mfma_f32_16x16x32_bf16 v[104:107], v[120:123], v[60:63], v[104:107]
v_mfma_f32_16x16x32_bf16 v[108:111], v[124:127], v[60:63], v[108:111]
buffer_load_dwordx4 v[60:63], v1, s[8:11], s24 offen offset:3072 sc1
s_waitcnt vmcnt(19)
v_mfma_f32_16x16x32_bf16 v[96:99], a[160:163], v[64:67], v[96:99]
ds_read_b64_tr_b16 v[112:113], v8 offset:24576
v_mfma_f32_16x16x32_bf16 v[100:103], a[164:167], v[64:67], v[100:103]
ds_read_b64_tr_b16 v[114:115], v8 offset:25600
v_mfma_f32_16x16x32_bf16 v[104:107], a[168:171], v[64:67], v[104:107]
ds_read_b64_tr_b16 v[116:117], v9 offset:24576
v_mfma_f32_16x16x32_bf16 v[108:111], a[172:175], v[64:67], v[108:111]
ds_read_b64_tr_b16 v[118:119], v9 offset:25600
s_add_u32 s24, s49, s33
buffer_load_dwordx4 v[64:67], v1, s[8:11], s24 offen offset:0 sc1
s_waitcnt vmcnt(19)
v_mfma_f32_16x16x32_bf16 v[96:99], a[176:179], v[68:71], v[96:99]
ds_read_b64_tr_b16 v[120:121], v10 offset:24576
v_mfma_f32_16x16x32_bf16 v[100:103], a[180:183], v[68:71], v[100:103]
ds_read_b64_tr_b16 v[122:123], v10 offset:25600
v_mfma_f32_16x16x32_bf16 v[104:107], a[184:187], v[68:71], v[104:107]
ds_read_b64_tr_b16 v[124:125], v11 offset:24576
v_mfma_f32_16x16x32_bf16 v[108:111], a[188:191], v[68:71], v[108:111]
ds_read_b64_tr_b16 v[126:127], v11 offset:25600
buffer_load_dwordx4 v[68:71], v1, s[8:11], s24 offen offset:1024 sc1
s_waitcnt vmcnt(19)
v_mfma_f32_16x16x32_bf16 v[96:99], a[192:195], v[72:75], v[96:99]
v_mfma_f32_16x16x32_bf16 v[100:103], a[196:199], v[72:75], v[100:103]
v_mfma_f32_16x16x32_bf16 v[104:107], a[200:203], v[72:75], v[104:107]
v_mfma_f32_16x16x32_bf16 v[108:111], a[204:207], v[72:75], v[108:111]
buffer_load_dwordx4 v[72:75], v1, s[8:11], s24 offen offset:2048 sc1
s_waitcnt vmcnt(19) lgkmcnt(0)
v_mfma_f32_16x16x32_bf16 v[96:99], v[112:115], v[76:79], v[96:99]
v_mfma_f32_16x16x32_bf16 v[100:103], v[116:119], v[76:79], v[100:103]
v_mfma_f32_16x16x32_bf16 v[104:107], v[120:123], v[76:79], v[104:107]
v_mfma_f32_16x16x32_bf16 v[108:111], v[124:127], v[76:79], v[108:111]
buffer_load_dwordx4 v[76:79], v1, s[8:11], s24 offen offset:3072 sc1
s_waitcnt vmcnt(19)
v_mfma_f32_16x16x32_bf16 v[96:99], a[208:211], v[80:83], v[96:99]
ds_read_b64_tr_b16 v[112:113], v8 offset:28672
v_mfma_f32_16x16x32_bf16 v[100:103], a[212:215], v[80:83], v[100:103]
ds_read_b64_tr_b16 v[114:115], v8 offset:29696
v_mfma_f32_16x16x32_bf16 v[104:107], a[216:219], v[80:83], v[104:107]
ds_read_b64_tr_b16 v[116:117], v9 offset:28672
v_mfma_f32_16x16x32_bf16 v[108:111], a[220:223], v[80:83], v[108:111]
ds_read_b64_tr_b16 v[118:119], v9 offset:29696
s_add_u32 s24, s49, s34
buffer_load_dwordx4 v[80:83], v1, s[8:11], s24 offen offset:0 sc1
s_waitcnt vmcnt(19)
v_mfma_f32_16x16x32_bf16 v[96:99], a[224:227], v[84:87], v[96:99]
ds_read_b64_tr_b16 v[120:121], v10 offset:28672
v_mfma_f32_16x16x32_bf16 v[100:103], a[228:231], v[84:87], v[100:103]
ds_read_b64_tr_b16 v[122:123], v10 offset:29696
v_mfma_f32_16x16x32_bf16 v[104:107], a[232:235], v[84:87], v[104:107]
ds_read_b64_tr_b16 v[124:125], v11 offset:28672
v_mfma_f32_16x16x32_bf16 v[108:111], a[236:239], v[84:87], v[108:111]
ds_read_b64_tr_b16 v[126:127], v11 offset:29696
buffer_load_dwordx4 v[84:87], v1, s[8:11], s24 offen offset:1024 sc1
s_waitcnt vmcnt(19)
v_mfma_f32_16x16x32_bf16 v[96:99], a[240:243], v[88:91], v[96:99]
v_mfma_f32_16x16x32_bf16 v[100:103], a[244:247], v[88:91], v[100:103]
v_mfma_f32_16x16x32_bf16 v[104:107], a[248:251], v[88:91], v[104:107]
v_mfma_f32_16x16x32_bf16 v[108:111], a[252:255], v[88:91], v[108:111]
buffer_load_dwordx4 v[88:91], v1, s[8:11], s24 offen offset:2048 sc1
s_waitcnt vmcnt(19) lgkmcnt(0)
v_mfma_f32_16x16x32_bf16 v[96:99], v[112:115], v[92:95], v[96:99]
v_mfma_f32_16x16x32_bf16 v[100:103], v[116:119], v[92:95], v[100:103]
v_mfma_f32_16x16x32_bf16 v[104:107], v[120:123], v[92:95], v[104:107]
v_mfma_f32_16x16x32_bf16 v[108:111], v[124:127], v[92:95], v[108:111]
buffer_load_dwordx4 v[92:95], v1, s[8:11], s24 offen offset:3072 sc1
s_nop 3
ds_write_b128 v3, v[96:99] offset:0
ds_write_b128 v3, v[100:103] offset:4096
ds_write_b128 v3, v[104:107] offset:8192
ds_write_b128 v3, v[108:111] offset:12288
s_waitcnt lgkmcnt(0)
s_barrier
ds_read_b128 v[96:99], v7 offset:0
ds_read_b128 v[100:103], v7 offset:1024
ds_read_b128 v[104:107], v7 offset:2048
ds_read_b128 v[108:111], v7 offset:3072
ds_read_b64_tr_b16 v[112:113], v8 offset:0
ds_read_b64_tr_b16 v[114:115], v8 offset:1024
ds_read_b64_tr_b16 v[116:117], v9 offset:0
ds_read_b64_tr_b16 v[118:119], v9 offset:1024
ds_read_b64_tr_b16 v[120:121], v10 offset:0
ds_read_b64_tr_b16 v[122:123], v10 offset:1024
ds_read_b64_tr_b16 v[124:125], v11 offset:0
ds_read_b64_tr_b16 v[126:127], v11 offset:1024
s_mul_i32 s24, s41, 36864
s_waitcnt lgkmcnt(10)
v_pk_add_f32 v[96:97], v[96:97], v[100:101]
v_pk_add_f32 v[98:99], v[98:99], v[102:103]
s_waitcnt lgkmcnt(9)
v_pk_add_f32 v[96:97], v[96:97], v[104:105]
v_pk_add_f32 v[98:99], v[98:99], v[106:107]
s_waitcnt lgkmcnt(8)
v_pk_add_f32 v[96:97], v[96:97], v[108:109]
v_pk_add_f32 v[98:99], v[98:99], v[110:111]
v_cvt_pk_bf16_f32 v12, v96, v97
v_cvt_pk_bf16_f32 v13, v98, v99
buffer_store_dwordx2 v[12:13], v4, s[12:15], s24 offen
v_xor_b32 v3, 16384, v3
v_xor_b32 v7, 16384, v7
s_mov_b32 s41, s27
s_mov_b32 s48, s49
s_sub_u32 s42, s42, 1
s_cmp_eq_u32 s50, 0
s_cbranch_scc1 L_opl_c
s_branch L_opl_r0
L_opl_c:
s_cmp_lg_u32 s42, 0
s_cbranch_scc1 L_opl_w
s_waitcnt lgkmcnt(0)
s_branch L_done
L_team:
v_mov_b32 v12, v0
v_and_b32 v13, 15, v0
v_bfe_u32 v14, v0, 4, 2
v_lshlrev_b32 v1, 4, v12
v_and_b32 v2, 0x3f0, v1
s_mul_i32 s20, s17, 34816
s_add_u32 s20, s20, 24576
v_add_u32 v2, s20, v2
v_and_b32 v15, 1, v12
v_mul_u32_u24 v0, 0xaaaa, v15
v_add_u32 v0, 0xffff4444, v0
v_lshrrev_b32 v18, 2, v13
v_lshl_add_u32 v18, v18, 1, v15
v_bfe_u32 v19, v13, 1, 1
v_lshrrev_b32 v16, 5, v12
v_lshlrev_b32 v16, 8, v16
v_lshl_add_u32 v16, v18, 5, v16
v_and_b32 v17, 1, v14
v_lshl_add_u32 v16, v17, 4, v16
v_and_b32 v17, 0x7f, v16
v_xor_b32 v17, 16, v17
v_add_u32 v16, 4224, v16
v_add_u32 v17, 6272, v17
v_cmp_eq_u32 vcc, 1, v19
s_nop 1
v_cndmask_b32 v7, v17, v16, vcc
v_and_b32 v16, 1, v14
v_xor_b32 v16, v18, v16
v_and_b32 v17, 2, v14
v_lshlrev_b32 v17, 1, v17
v_xor_b32 v16, v16, v17
v_lshlrev_b32 v16, 4, v16
v_lshl_add_u32 v16, v14, 7, v16
v_mul_u32_u24 v17, 2176, v19
v_add_u32 v16, v16, v17
v_add_u32 v5, 0, v16
v_bfe_u32 v20, v13, 3, 1
v_bfe_u32 v21, v13, 1, 1
v_lshlrev_b32 v16, 1, v14
v_xor_b32 v16, v16, v21
v_lshlrev_b32 v17, 2, v20
v_xor_b32 v16, v16, v17
v_lshlrev_b32 v16, 4, v16
v_lshl_add_u32 v16, v20, 8, v16
v_lshl_add_u32 v16, v21, 7, v16
v_bfe_u32 v17, v13, 2, 1
v_lshl_add_u32 v16, v17, 3, v16
v_lshl_add_u32 v16, v15, 2, v16
s_lshl_b32 s20, s17, 9
s_add_u32 s20, s20, 0
v_add_u32 v4, s20, v16
v_xor_b32 v3, 16, v4
v_lshrrev_b32 v16, 4, v12
v_xor_b32 v17, s16, v16
v_lshlrev_b32 v16, 12, v16
v_lshl_add_u32 v16, v17, 7, v16
v_lshl_add_u32 v9, v13, 3, v16
s_lshr_b32 s20, s17, 1
s_lshl_b32 s20, s20, 2
v_add_u32 v16, s20, v14
v_xor_b32 v17, s16, v16
v_lshlrev_b32 v16, 12, v16
v_lshl_add_u32 v16, v17, 7, v16
v_lshl_add_u32 v16, v13, 2, v16
s_and_b32 s20, s17, 1
s_lshl_b32 s20, s20, 6
s_add_u32 s20, s20, 262144
v_add_u32 v10, s20, v16
v_bfe_u32 v16, v13, 2, 1
v_lshlrev_b32 v16, 5, v16
v_and_b32 v17, 1, v14
v_lshl_add_u32 v16, v17, 8, v16
v_lshrrev_b32 v17, 1, v14
v_lshl_add_u32 v16, v17, 4, v16
v_and_b32 v17, 3, v13
v_lshl_add_u32 v11, v17, 2, v16
v_lshlrev_b32 v6, 7, v12
v_lshlrev_b32 v8, 2, v12
s_mov_b32 s36, 0x11111111
s_mov_b32 s37, 0x11111111
s_mov_b32 s38, 0x22222222
s_mov_b32 s39, 0x22222222
s_mov_b32 s40, 0x44444444
s_mov_b32 s41, 0x44444444
s_mov_b32 s42, 0x88888888
s_mov_b32 s43, 0x88888888
s_mov_b32 s44, 0xf0f0f0f0
s_mov_b32 s45, 0xf0f0f0f0
s_mov_b32 s18, 0x3e0293ee
s_lshl_b32 s20, s17, 5
s_add_u32 s20, s20, s16
s_cmp_lt_u32 s20, 72
s_cselect_b32 s48, 1, 0
s_lshl_b32 s23, s20, 12
s_lshl_b32 s21, s17, 10
s_sub_u32 s23, s23, s21
s_lshr_b32 s24, s20, 2
s_lshl_b32 s24, s24, 9
s_and_b32 s21, s20, 3
s_lshl_b32 s21, s21, 6
s_add_u32 s24, s24, s21
s_add_u32 s24, s24, 110100480
s_cmp_lt_u32 s20, 72
s_cselect_b32 s24, s24, 536870912
s_lshl_b32 s25, s16, 12
s_add_u32 s26, s25, 131072
s_add_u32 s27, s25, 262144
s_cmp_lt_u32 s16, 8
s_cselect_b32 s27, s27, 536870912
s_mov_b32 s28, 109051904
s_mov_b32 s29, 109346816
s_lshl_b32 s30, s16, 20
s_add_u32 s30, s30, 33554432
s_lshl_b32 s31, s16, 12
s_add_u32 s31, s31, 100663296
s_add_u32 s35, s24, 32768
s_mov_b32 s53, 0x3f803f80
s_mov_b32 s86, 0x33333333
s_mov_b32 s87, 0x33333333
s_lshl_b32 s84, s17, 13
s_sub_u32 s84, s20, s84
s_add_u32 s84, s84, 110886912
s_cmp_lt_u32 s20, 72
s_cselect_b32 s84, s84, 536870912
s_and_b32 s21, s16, 3
s_lshl_b32 s21, s21, 7
s_add_u32 s21, s21, 110886144
s_cmp_eq_u32 s17, 3
s_cselect_b32 s84, s21, s84
s_lshl_b32 s82, s16, 7
s_add_u32 s83, s82, 111152384
s_add_u32 s82, s82, 111148288
s_mov_b32 s19, 0
v_mov_b32 v64, -1
v_mov_b32 v65, -1
v_mov_b32 v66, -1
v_mov_b32 v67, -1
s_add_u32 s20, s28, s25
buffer_store_dwordx4 v[64:67], v1, s[8:11], s20 offen
s_add_u32 s20, s28, s26
buffer_store_dwordx4 v[64:67], v1, s[8:11], s20 offen
s_add_u32 s20, s28, s27
buffer_store_dwordx4 v[64:67], v1, s[8:11], s20 offen
s_add_u32 s20, s29, s25
buffer_store_dwordx4 v[64:67], v1, s[8:11], s20 offen
s_add_u32 s20, s29, s26
buffer_store_dwordx4 v[64:67], v1, s[8:11], s20 offen
s_add_u32 s20, s29, s27
buffer_store_dwordx4 v[64:67], v1, s[8:11], s20 offen
s_add_u32 s20, s24, 16384
buffer_store_dword v64, v11, s[8:11], s20 offen
s_cmp_eq_u32 s17, 3
s_cselect_b32 s20, 536870912, s84
s_mov_b64 exec, 15
buffer_store_byte v64, v6, s[8:11], s20 offen
s_mov_b64 exec, -1
v_lshrrev_b32 v0, 4, v1
s_waitcnt vmcnt(0)
s_barrier
s_cmp_eq_u32 s17, 0
s_cbranch_scc0 L_tw
s_mov_b64 exec, 1
v_mov_b32 v1, 1
v_mov_b32 v2, 64
buffer_atomic_add v1, v2, s[56:59], 0 offen
s_mov_b64 exec, -1
L_tw:
s_mov_b32 s46, 0x05040100
s_mov_b32 s47, 0x07060302
v_and_b32 v3, 63, v0
v_lshlrev_b32 v3, 4, v3
s_mul_i32 s20, s17, 34816
s_add_u32 s20, s20, 24576
v_add_u32 v3, s20, v3
v_bfe_u32 v64, v0, 5, 1
v_bfe_u32 v65, v0, 4, 1
v_and_b32 v66, 15, v0
v_lshlrev_b32 v1, 17, v64
v_lshl_add_u32 v1, v65, 14, v1
v_lshl_add_u32 v1, v66, 2, v1
s_lshl_b32 s20, s16, 8
s_lshl_b32 s21, s17, 6
s_add_u32 s20, s20, s21
v_add_u32 v1, s20, v1
v_lshlrev_b32 v2, 4, v64
v_lshl_add_u32 v2, v65, 2, v2
v_mul_u32_u24 v2, 1152, v2
s_mul_i32 s20, s16, 147456
v_add_u32 v2, s20, v2
s_load_dwordx2 s[50:51], s[0:1], 64
s_waitcnt lgkmcnt(0)
s_mov_b32 s12, s50
s_and_b32 s13, s51, 0xffff
s_mov_b32 s14, 4718592
s_mov_b32 s15, 0x20000
s_mov_b32 s20, 0
buffer_load_dword v4, v1, s[12:15], s20 offen
s_mov_b32 s21, 32768
buffer_load_dword v5, v1, s[12:15], s21 offen
s_mov_b32 s20, 65536
buffer_load_dword v6, v1, s[12:15], s20 offen
s_mov_b32 s21, 98304
buffer_load_dword v7, v1, s[12:15], s21 offen
s_mov_b32 s20, 8192
buffer_load_dword v8, v1, s[12:15], s20 offen
s_mov_b32 s21, 40960
buffer_load_dword v9, v1, s[12:15], s21 offen
s_mov_b32 s20, 73728
buffer_load_dword v10, v1, s[12:15], s20 offen
s_mov_b32 s21, 106496
buffer_load_dword v11, v1, s[12:15], s21 offen
s_mov_b32 s20, 262144
buffer_load_dword v12, v1, s[12:15], s20 offen
s_mov_b32 s21, 294912
buffer_load_dword v13, v1, s[12:15], s21 offen
s_mov_b32 s20, 327680
buffer_load_dword v14, v1, s[12:15], s20 offen
s_mov_b32 s21, 360448
buffer_load_dword v15, v1, s[12:15], s21 offen
s_mov_b32 s20, 270336
buffer_load_dword v16, v1, s[12:15], s20 offen
s_mov_b32 s21, 303104
buffer_load_dword v17, v1, s[12:15], s21 offen
s_mov_b32 s20, 335872
buffer_load_dword v18, v1, s[12:15], s20 offen
s_mov_b32 s21, 368640
buffer_load_dword v19, v1, s[12:15], s21 offen
s_mov_b32 s20, 524288
buffer_load_dword v20, v1, s[12:15], s20 offen
s_mov_b32 s21, 557056
buffer_load_dword v21, v1, s[12:15], s21 offen
s_mov_b32 s20, 589824
buffer_load_dword v22, v1, s[12:15], s20 offen
s_mov_b32 s21, 622592
buffer_load_dword v23, v1, s[12:15], s21 offen
s_mov_b32 s20, 532480
buffer_load_dword v24, v1, s[12:15], s20 offen
s_mov_b32 s21, 565248
buffer_load_dword v25, v1, s[12:15], s21 offen
s_mov_b32 s20, 598016
buffer_load_dword v26, v1, s[12:15], s20 offen
s_mov_b32 s21, 630784
buffer_load_dword v27, v1, s[12:15], s21 offen
s_mov_b32 s20, 786432
buffer_load_dword v28, v1, s[12:15], s20 offen
s_mov_b32 s21, 819200
buffer_load_dword v29, v1, s[12:15], s21 offen
s_mov_b32 s20, 851968
buffer_load_dword v30, v1, s[12:15], s20 offen
s_mov_b32 s21, 884736
buffer_load_dword v31, v1, s[12:15], s21 offen
s_mov_b32 s20, 794624
buffer_load_dword v32, v1, s[12:15], s20 offen
s_mov_b32 s21, 827392
buffer_load_dword v33, v1, s[12:15], s21 offen
s_mov_b32 s20, 860160
buffer_load_dword v34, v1, s[12:15], s20 offen
s_mov_b32 s21, 892928
buffer_load_dword v35, v1, s[12:15], s21 offen
s_mov_b32 s20, 1048576
buffer_load_dword v36, v1, s[12:15], s20 offen
s_mov_b32 s21, 1081344
buffer_load_dword v37, v1, s[12:15], s21 offen
s_mov_b32 s20, 1114112
buffer_load_dword v38, v1, s[12:15], s20 offen
s_mov_b32 s21, 1146880
buffer_load_dword v39, v1, s[12:15], s21 offen
s_mov_b32 s20, 1056768
buffer_load_dword v40, v1, s[12:15], s20 offen
s_mov_b32 s21, 1089536
buffer_load_dword v41, v1, s[12:15], s21 offen
s_mov_b32 s20, 1122304
buffer_load_dword v42, v1, s[12:15], s20 offen
s_mov_b32 s21, 1155072
buffer_load_dword v43, v1, s[12:15], s21 offen
s_mov_b32 s20, 1310720
buffer_load_dword v44, v1, s[12:15], s20 offen
s_mov_b32 s21, 1343488
buffer_load_dword v45, v1, s[12:15], s21 offen
s_mov_b32 s20, 1376256
buffer_load_dword v46, v1, s[12:15], s20 offen
s_mov_b32 s21, 1409024
buffer_load_dword v47, v1, s[12:15], s21 offen
s_mov_b32 s20, 1318912
buffer_load_dword v48, v1, s[12:15], s20 offen
s_mov_b32 s21, 1351680
buffer_load_dword v49, v1, s[12:15], s21 offen
s_mov_b32 s20, 1384448
buffer_load_dword v50, v1, s[12:15], s20 offen
s_mov_b32 s21, 1417216
buffer_load_dword v51, v1, s[12:15], s21 offen
s_mov_b32 s20, 1572864
buffer_load_dword v52, v1, s[12:15], s20 offen
s_mov_b32 s21, 1605632
buffer_load_dword v53, v1, s[12:15], s21 offen
s_mov_b32 s20, 1638400
buffer_load_dword v54, v1, s[12:15], s20 offen
s_mov_b32 s21, 1671168
buffer_load_dword v55, v1, s[12:15], s21 offen
s_mov_b32 s20, 1581056
buffer_load_dword v56, v1, s[12:15], s20 offen
s_mov_b32 s21, 1613824
buffer_load_dword v57, v1, s[12:15], s21 offen
s_mov_b32 s20, 1646592
buffer_load_dword v58, v1, s[12:15], s20 offen
s_mov_b32 s21, 1679360
buffer_load_dword v59, v1, s[12:15], s21 offen
s_mov_b32 s20, 1835008
buffer_load_dword v60, v1, s[12:15], s20 offen
s_mov_b32 s21, 1867776
buffer_load_dword v61, v1, s[12:15], s21 offen
s_mov_b32 s20, 1900544
buffer_load_dword v62, v1, s[12:15], s20 offen
s_mov_b32 s21, 1933312
buffer_load_dword v63, v1, s[12:15], s21 offen
s_waitcnt vmcnt(58)
v_perm_b32 v72, v5, v4, s46
v_perm_b32 v80, v5, v4, s47
s_mov_b32 s20, 1843200
buffer_load_dword v4, v1, s[12:15], s20 offen
s_mov_b32 s21, 1875968
buffer_load_dword v5, v1, s[12:15], s21 offen
s_waitcnt vmcnt(58)
v_perm_b32 v73, v7, v6, s46
v_perm_b32 v81, v7, v6, s47
s_mov_b32 s20, 1908736
buffer_load_dword v6, v1, s[12:15], s20 offen
s_mov_b32 s21, 1941504
buffer_load_dword v7, v1, s[12:15], s21 offen
s_waitcnt vmcnt(58)
v_perm_b32 v74, v9, v8, s46
v_perm_b32 v82, v9, v8, s47
s_mov_b32 s20, 2097152
buffer_load_dword v8, v1, s[12:15], s20 offen
s_mov_b32 s21, 2129920
buffer_load_dword v9, v1, s[12:15], s21 offen
s_waitcnt vmcnt(58)
v_perm_b32 v75, v11, v10, s46
v_perm_b32 v83, v11, v10, s47
s_mov_b32 s20, 2162688
buffer_load_dword v10, v1, s[12:15], s20 offen
s_mov_b32 s21, 2195456
buffer_load_dword v11, v1, s[12:15], s21 offen
s_waitcnt vmcnt(58)
v_perm_b32 v76, v13, v12, s46
v_perm_b32 v84, v13, v12, s47
s_mov_b32 s20, 2105344
buffer_load_dword v12, v1, s[12:15], s20 offen
s_mov_b32 s21, 2138112
buffer_load_dword v13, v1, s[12:15], s21 offen
s_waitcnt vmcnt(58)
v_perm_b32 v77, v15, v14, s46
v_perm_b32 v85, v15, v14, s47
s_mov_b32 s20, 2170880
buffer_load_dword v14, v1, s[12:15], s20 offen
s_mov_b32 s21, 2203648
buffer_load_dword v15, v1, s[12:15], s21 offen
s_waitcnt vmcnt(58)
v_perm_b32 v78, v17, v16, s46
v_perm_b32 v86, v17, v16, s47
s_mov_b32 s20, 2359296
buffer_load_dword v16, v1, s[12:15], s20 offen
s_mov_b32 s21, 2392064
buffer_load_dword v17, v1, s[12:15], s21 offen
s_waitcnt vmcnt(58)
v_perm_b32 v79, v19, v18, s46
v_perm_b32 v87, v19, v18, s47
s_mov_b32 s20, 2424832
buffer_load_dword v18, v1, s[12:15], s20 offen
s_mov_b32 s21, 2457600
buffer_load_dword v19, v1, s[12:15], s21 offen
s_waitcnt vmcnt(58)
v_perm_b32 v96, v21, v20, s46
v_perm_b32 v104, v21, v20, s47
s_mov_b32 s20, 2367488
buffer_load_dword v20, v1, s[12:15], s20 offen
s_mov_b32 s21, 2400256
buffer_load_dword v21, v1, s[12:15], s21 offen
s_waitcnt vmcnt(58)
v_perm_b32 v97, v23, v22, s46
v_perm_b32 v105, v23, v22, s47
s_mov_b32 s20, 2433024
buffer_load_dword v22, v1, s[12:15], s20 offen
s_mov_b32 s21, 2465792
buffer_load_dword v23, v1, s[12:15], s21 offen
s_waitcnt vmcnt(58)
v_perm_b32 v98, v25, v24, s46
v_perm_b32 v106, v25, v24, s47
s_mov_b32 s20, 2621440
buffer_load_dword v24, v1, s[12:15], s20 offen
s_mov_b32 s21, 2654208
buffer_load_dword v25, v1, s[12:15], s21 offen
s_waitcnt vmcnt(58)
v_perm_b32 v99, v27, v26, s46
v_perm_b32 v107, v27, v26, s47
s_mov_b32 s20, 2686976
buffer_load_dword v26, v1, s[12:15], s20 offen
s_mov_b32 s21, 2719744
buffer_load_dword v27, v1, s[12:15], s21 offen
s_waitcnt vmcnt(58)
v_perm_b32 v100, v29, v28, s46
v_perm_b32 v108, v29, v28, s47
s_mov_b32 s20, 2629632
buffer_load_dword v28, v1, s[12:15], s20 offen
s_mov_b32 s21, 2662400
buffer_load_dword v29, v1, s[12:15], s21 offen
s_waitcnt vmcnt(58)
v_perm_b32 v101, v31, v30, s46
v_perm_b32 v109, v31, v30, s47
s_mov_b32 s20, 2695168
buffer_load_dword v30, v1, s[12:15], s20 offen
s_mov_b32 s21, 2727936
buffer_load_dword v31, v1, s[12:15], s21 offen
s_waitcnt vmcnt(58)
v_perm_b32 v102, v33, v32, s46
v_perm_b32 v110, v33, v32, s47
s_mov_b32 s20, 2883584
buffer_load_dword v32, v1, s[12:15], s20 offen
s_mov_b32 s21, 2916352
buffer_load_dword v33, v1, s[12:15], s21 offen
s_waitcnt vmcnt(58)
v_perm_b32 v103, v35, v34, s46
v_perm_b32 v111, v35, v34, s47
s_mov_b32 s20, 2949120
buffer_load_dword v34, v1, s[12:15], s20 offen
s_mov_b32 s21, 2981888
buffer_load_dword v35, v1, s[12:15], s21 offen
s_waitcnt vmcnt(58)
v_perm_b32 v120, v37, v36, s46
v_perm_b32 v128, v37, v36, s47
s_mov_b32 s20, 2891776
buffer_load_dword v36, v1, s[12:15], s20 offen
s_mov_b32 s21, 2924544
buffer_load_dword v37, v1, s[12:15], s21 offen
s_waitcnt vmcnt(58)
v_perm_b32 v121, v39, v38, s46
v_perm_b32 v129, v39, v38, s47
s_mov_b32 s20, 2957312
buffer_load_dword v38, v1, s[12:15], s20 offen
s_mov_b32 s21, 2990080
buffer_load_dword v39, v1, s[12:15], s21 offen
s_waitcnt vmcnt(58)
v_perm_b32 v122, v41, v40, s46
v_perm_b32 v130, v41, v40, s47
s_mov_b32 s20, 3145728
buffer_load_dword v40, v1, s[12:15], s20 offen
s_mov_b32 s21, 3178496
buffer_load_dword v41, v1, s[12:15], s21 offen
s_waitcnt vmcnt(58)
v_perm_b32 v123, v43, v42, s46
v_perm_b32 v131, v43, v42, s47
s_mov_b32 s20, 3211264
buffer_load_dword v42, v1, s[12:15], s20 offen
s_mov_b32 s21, 3244032
buffer_load_dword v43, v1, s[12:15], s21 offen
s_waitcnt vmcnt(58)
v_perm_b32 v124, v45, v44, s46
v_perm_b32 v132, v45, v44, s47
s_mov_b32 s20, 3153920
buffer_load_dword v44, v1, s[12:15], s20 offen
s_mov_b32 s21, 3186688
buffer_load_dword v45, v1, s[12:15], s21 offen
s_waitcnt vmcnt(58)
v_perm_b32 v125, v47, v46, s46
v_perm_b32 v133, v47, v46, s47
s_mov_b32 s20, 3219456
buffer_load_dword v46, v1, s[12:15], s20 offen
s_mov_b32 s21, 3252224
buffer_load_dword v47, v1, s[12:15], s21 offen
s_waitcnt vmcnt(58)
v_perm_b32 v126, v49, v48, s46
v_perm_b32 v134, v49, v48, s47
s_mov_b32 s20, 3407872
buffer_load_dword v48, v1, s[12:15], s20 offen
s_mov_b32 s21, 3440640
buffer_load_dword v49, v1, s[12:15], s21 offen
s_waitcnt vmcnt(58)
v_perm_b32 v127, v51, v50, s46
v_perm_b32 v135, v51, v50, s47
s_mov_b32 s20, 3473408
buffer_load_dword v50, v1, s[12:15], s20 offen
s_mov_b32 s21, 3506176
buffer_load_dword v51, v1, s[12:15], s21 offen
s_waitcnt vmcnt(58)
v_perm_b32 v144, v53, v52, s46
v_perm_b32 v152, v53, v52, s47
s_mov_b32 s20, 3416064
buffer_load_dword v52, v1, s[12:15], s20 offen
s_mov_b32 s21, 3448832
buffer_load_dword v53, v1, s[12:15], s21 offen
s_waitcnt vmcnt(58)
v_perm_b32 v145, v55, v54, s46
v_perm_b32 v153, v55, v54, s47
s_mov_b32 s20, 3481600
buffer_load_dword v54, v1, s[12:15], s20 offen
s_mov_b32 s21, 3514368
buffer_load_dword v55, v1, s[12:15], s21 offen
s_waitcnt vmcnt(58)
v_perm_b32 v146, v57, v56, s46
v_perm_b32 v154, v57, v56, s47
s_mov_b32 s20, 3670016
buffer_load_dword v56, v1, s[12:15], s20 offen
s_mov_b32 s21, 3702784
buffer_load_dword v57, v1, s[12:15], s21 offen
s_waitcnt vmcnt(58)
v_perm_b32 v147, v59, v58, s46
v_perm_b32 v155, v59, v58, s47
s_mov_b32 s20, 3735552
buffer_load_dword v58, v1, s[12:15], s20 offen
s_mov_b32 s21, 3768320
buffer_load_dword v59, v1, s[12:15], s21 offen
s_waitcnt vmcnt(58)
v_perm_b32 v148, v61, v60, s46
v_perm_b32 v156, v61, v60, s47
s_mov_b32 s20, 3678208
buffer_load_dword v60, v1, s[12:15], s20 offen
s_mov_b32 s21, 3710976
buffer_load_dword v61, v1, s[12:15], s21 offen
s_waitcnt vmcnt(58)
v_perm_b32 v149, v63, v62, s46
v_perm_b32 v157, v63, v62, s47
s_mov_b32 s20, 3743744
buffer_load_dword v62, v1, s[12:15], s20 offen
s_mov_b32 s21, 3776512
buffer_load_dword v63, v1, s[12:15], s21 offen
s_waitcnt vmcnt(58)
v_perm_b32 v150, v5, v4, s46
v_perm_b32 v158, v5, v4, s47
s_mov_b32 s20, 3932160
buffer_load_dword v4, v1, s[12:15], s20 offen
s_mov_b32 s21, 3964928
buffer_load_dword v5, v1, s[12:15], s21 offen
s_waitcnt vmcnt(58)
v_perm_b32 v151, v7, v6, s46
v_perm_b32 v159, v7, v6, s47
s_mov_b32 s20, 3997696
buffer_load_dword v6, v1, s[12:15], s20 offen
s_mov_b32 s21, 4030464
buffer_load_dword v7, v1, s[12:15], s21 offen
s_waitcnt vmcnt(58)
v_perm_b32 v168, v9, v8, s46
v_perm_b32 v176, v9, v8, s47
s_mov_b32 s20, 3940352
buffer_load_dword v8, v1, s[12:15], s20 offen
s_mov_b32 s21, 3973120
buffer_load_dword v9, v1, s[12:15], s21 offen
s_waitcnt vmcnt(58)
v_perm_b32 v169, v11, v10, s46
v_perm_b32 v177, v11, v10, s47
s_mov_b32 s20, 4005888
buffer_load_dword v10, v1, s[12:15], s20 offen
s_mov_b32 s21, 4038656
buffer_load_dword v11, v1, s[12:15], s21 offen
s_waitcnt vmcnt(58)
v_perm_b32 v170, v13, v12, s46
v_perm_b32 v178, v13, v12, s47
s_mov_b32 s20, 4194304
buffer_load_dword v12, v1, s[12:15], s20 offen
s_mov_b32 s21, 4227072
buffer_load_dword v13, v1, s[12:15], s21 offen
s_waitcnt vmcnt(58)
v_perm_b32 v171, v15, v14, s46
v_perm_b32 v179, v15, v14, s47
s_mov_b32 s20, 4259840
buffer_load_dword v14, v1, s[12:15], s20 offen
s_mov_b32 s21, 4292608
buffer_load_dword v15, v1, s[12:15], s21 offen
s_waitcnt vmcnt(58)
v_perm_b32 v172, v17, v16, s46
v_perm_b32 v180, v17, v16, s47
s_mov_b32 s20, 4202496
buffer_load_dword v16, v1, s[12:15], s20 offen
s_mov_b32 s21, 4235264
buffer_load_dword v17, v1, s[12:15], s21 offen
s_waitcnt vmcnt(58)
v_perm_b32 v173, v19, v18, s46
v_perm_b32 v181, v19, v18, s47
s_mov_b32 s20, 4268032
buffer_load_dword v18, v1, s[12:15], s20 offen
s_mov_b32 s21, 4300800
buffer_load_dword v19, v1, s[12:15], s21 offen
s_waitcnt vmcnt(58)
v_perm_b32 v174, v21, v20, s46
v_perm_b32 v182, v21, v20, s47
s_mov_b32 s20, 4456448
buffer_load_dword v20, v1, s[12:15], s20 offen
s_mov_b32 s21, 4489216
buffer_load_dword v21, v1, s[12:15], s21 offen
s_waitcnt vmcnt(58)
v_perm_b32 v175, v23, v22, s46
v_perm_b32 v183, v23, v22, s47
s_mov_b32 s20, 4521984
buffer_load_dword v22, v1, s[12:15], s20 offen
s_mov_b32 s21, 4554752
buffer_load_dword v23, v1, s[12:15], s21 offen
s_waitcnt vmcnt(58)
v_perm_b32 v192, v25, v24, s46
v_perm_b32 v200, v25, v24, s47
s_mov_b32 s20, 4464640
buffer_load_dword v24, v1, s[12:15], s20 offen
s_mov_b32 s21, 4497408
buffer_load_dword v25, v1, s[12:15], s21 offen
s_waitcnt vmcnt(58)
v_perm_b32 v193, v27, v26, s46
v_perm_b32 v201, v27, v26, s47
s_mov_b32 s20, 4530176
buffer_load_dword v26, v1, s[12:15], s20 offen
s_mov_b32 s21, 4562944
buffer_load_dword v27, v1, s[12:15], s21 offen
s_waitcnt vmcnt(58)
v_perm_b32 v194, v29, v28, s46
v_perm_b32 v202, v29, v28, s47
s_load_dwordx2 s[50:51], s[0:1], 72
s_waitcnt lgkmcnt(0)
s_mov_b32 s12, s50
s_and_b32 s13, s51, 0xffff
s_mov_b32 s14, 4718592
s_mov_b32 s15, 0x20000
s_mov_b32 s20, 0
buffer_load_dword v28, v1, s[12:15], s20 offen
s_mov_b32 s21, 32768
buffer_load_dword v29, v1, s[12:15], s21 offen
s_waitcnt vmcnt(58)
v_perm_b32 v195, v31, v30, s46
v_perm_b32 v203, v31, v30, s47
s_mov_b32 s20, 65536
buffer_load_dword v30, v1, s[12:15], s20 offen
s_mov_b32 s21, 98304
buffer_load_dword v31, v1, s[12:15], s21 offen
s_waitcnt vmcnt(58)
v_perm_b32 v196, v33, v32, s46
v_perm_b32 v204, v33, v32, s47
s_mov_b32 s20, 8192
buffer_load_dword v32, v1, s[12:15], s20 offen
s_mov_b32 s21, 40960
buffer_load_dword v33, v1, s[12:15], s21 offen
s_waitcnt vmcnt(58)
v_perm_b32 v197, v35, v34, s46
v_perm_b32 v205, v35, v34, s47
s_mov_b32 s20, 73728
buffer_load_dword v34, v1, s[12:15], s20 offen
s_mov_b32 s21, 106496
buffer_load_dword v35, v1, s[12:15], s21 offen
s_waitcnt vmcnt(58)
v_perm_b32 v198, v37, v36, s46
v_perm_b32 v206, v37, v36, s47
s_mov_b32 s20, 262144
buffer_load_dword v36, v1, s[12:15], s20 offen
s_mov_b32 s21, 294912
buffer_load_dword v37, v1, s[12:15], s21 offen
s_waitcnt vmcnt(58)
v_perm_b32 v199, v39, v38, s46
v_perm_b32 v207, v39, v38, s47
s_mov_b32 s20, 327680
buffer_load_dword v38, v1, s[12:15], s20 offen
s_mov_b32 s21, 360448
buffer_load_dword v39, v1, s[12:15], s21 offen
s_waitcnt vmcnt(58)
v_perm_b32 v216, v41, v40, s46
v_perm_b32 v224, v41, v40, s47
s_mov_b32 s20, 270336
buffer_load_dword v40, v1, s[12:15], s20 offen
s_mov_b32 s21, 303104
buffer_load_dword v41, v1, s[12:15], s21 offen
s_waitcnt vmcnt(58)
v_perm_b32 v217, v43, v42, s46
v_perm_b32 v225, v43, v42, s47
s_mov_b32 s20, 335872
buffer_load_dword v42, v1, s[12:15], s20 offen
s_mov_b32 s21, 368640
buffer_load_dword v43, v1, s[12:15], s21 offen
s_waitcnt vmcnt(58)
v_perm_b32 v218, v45, v44, s46
v_perm_b32 v226, v45, v44, s47
s_mov_b32 s20, 524288
buffer_load_dword v44, v1, s[12:15], s20 offen
s_mov_b32 s21, 557056
buffer_load_dword v45, v1, s[12:15], s21 offen
s_waitcnt vmcnt(58)
v_perm_b32 v219, v47, v46, s46
v_perm_b32 v227, v47, v46, s47
s_mov_b32 s20, 589824
buffer_load_dword v46, v1, s[12:15], s20 offen
s_mov_b32 s21, 622592
buffer_load_dword v47, v1, s[12:15], s21 offen
s_waitcnt vmcnt(58)
v_perm_b32 v220, v49, v48, s46
v_perm_b32 v228, v49, v48, s47
s_mov_b32 s20, 532480
buffer_load_dword v48, v1, s[12:15], s20 offen
s_mov_b32 s21, 565248
buffer_load_dword v49, v1, s[12:15], s21 offen
s_waitcnt vmcnt(58)
v_perm_b32 v221, v51, v50, s46
v_perm_b32 v229, v51, v50, s47
s_mov_b32 s20, 598016
buffer_load_dword v50, v1, s[12:15], s20 offen
s_mov_b32 s21, 630784
buffer_load_dword v51, v1, s[12:15], s21 offen
s_waitcnt vmcnt(58)
v_perm_b32 v222, v53, v52, s46
v_perm_b32 v230, v53, v52, s47
s_mov_b32 s20, 786432
buffer_load_dword v52, v1, s[12:15], s20 offen
s_mov_b32 s21, 819200
buffer_load_dword v53, v1, s[12:15], s21 offen
s_waitcnt vmcnt(58)
v_perm_b32 v223, v55, v54, s46
v_perm_b32 v231, v55, v54, s47
s_mov_b32 s20, 851968
buffer_load_dword v54, v1, s[12:15], s20 offen
s_mov_b32 s21, 884736
buffer_load_dword v55, v1, s[12:15], s21 offen
s_waitcnt vmcnt(58)
v_perm_b32 v240, v57, v56, s46
v_perm_b32 v248, v57, v56, s47
s_mov_b32 s20, 794624
buffer_load_dword v56, v1, s[12:15], s20 offen
s_mov_b32 s21, 827392
buffer_load_dword v57, v1, s[12:15], s21 offen
s_waitcnt vmcnt(58)
v_perm_b32 v241, v59, v58, s46
v_perm_b32 v249, v59, v58, s47
s_mov_b32 s20, 860160
buffer_load_dword v58, v1, s[12:15], s20 offen
s_mov_b32 s21, 892928
buffer_load_dword v59, v1, s[12:15], s21 offen
s_waitcnt vmcnt(58)
v_perm_b32 v242, v61, v60, s46
v_perm_b32 v250, v61, v60, s47
s_mov_b32 s20, 1048576
buffer_load_dword v60, v1, s[12:15], s20 offen
s_mov_b32 s21, 1081344
buffer_load_dword v61, v1, s[12:15], s21 offen
s_waitcnt vmcnt(58)
v_perm_b32 v243, v63, v62, s46
v_perm_b32 v251, v63, v62, s47
s_mov_b32 s20, 1114112
buffer_load_dword v62, v1, s[12:15], s20 offen
s_mov_b32 s21, 1146880
buffer_load_dword v63, v1, s[12:15], s21 offen
s_waitcnt vmcnt(58)
v_perm_b32 v244, v5, v4, s46
v_perm_b32 v252, v5, v4, s47
s_mov_b32 s20, 1056768
buffer_load_dword v4, v1, s[12:15], s20 offen
s_mov_b32 s21, 1089536
buffer_load_dword v5, v1, s[12:15], s21 offen
s_waitcnt vmcnt(58)
v_perm_b32 v245, v7, v6, s46
v_perm_b32 v253, v7, v6, s47
s_mov_b32 s20, 1122304
buffer_load_dword v6, v1, s[12:15], s20 offen
s_mov_b32 s21, 1155072
buffer_load_dword v7, v1, s[12:15], s21 offen
s_waitcnt vmcnt(58)
v_perm_b32 v246, v9, v8, s46
v_perm_b32 v254, v9, v8, s47
s_mov_b32 s20, 1310720
buffer_load_dword v8, v1, s[12:15], s20 offen
s_mov_b32 s21, 1343488
buffer_load_dword v9, v1, s[12:15], s21 offen
s_waitcnt vmcnt(58)
v_perm_b32 v247, v11, v10, s46
v_perm_b32 v255, v11, v10, s47
s_mov_b32 s20, 1376256
buffer_load_dword v10, v1, s[12:15], s20 offen
s_mov_b32 s21, 1409024
buffer_load_dword v11, v1, s[12:15], s21 offen
s_waitcnt vmcnt(58)
v_perm_b32 v64, v13, v12, s46
v_accvgpr_write_b32 a8, v64
v_perm_b32 v68, v13, v12, s47
v_accvgpr_write_b32 a16, v68
s_mov_b32 s20, 1318912
buffer_load_dword v12, v1, s[12:15], s20 offen
s_mov_b32 s21, 1351680
buffer_load_dword v13, v1, s[12:15], s21 offen
s_waitcnt vmcnt(58)
v_perm_b32 v65, v15, v14, s46
v_accvgpr_write_b32 a9, v65
v_perm_b32 v69, v15, v14, s47
v_accvgpr_write_b32 a17, v69
s_mov_b32 s20, 1384448
buffer_load_dword v14, v1, s[12:15], s20 offen
s_mov_b32 s21, 1417216
buffer_load_dword v15, v1, s[12:15], s21 offen
s_waitcnt vmcnt(58)
v_perm_b32 v66, v17, v16, s46
v_accvgpr_write_b32 a10, v66
v_perm_b32 v70, v17, v16, s47
v_accvgpr_write_b32 a18, v70
s_mov_b32 s20, 1572864
buffer_load_dword v16, v1, s[12:15], s20 offen
s_mov_b32 s21, 1605632
buffer_load_dword v17, v1, s[12:15], s21 offen
s_waitcnt vmcnt(58)
v_perm_b32 v67, v19, v18, s46
v_accvgpr_write_b32 a11, v67
v_perm_b32 v71, v19, v18, s47
v_accvgpr_write_b32 a19, v71
s_mov_b32 s20, 1638400
buffer_load_dword v18, v1, s[12:15], s20 offen
s_mov_b32 s21, 1671168
buffer_load_dword v19, v1, s[12:15], s21 offen
s_waitcnt vmcnt(58)
v_perm_b32 v64, v21, v20, s46
v_accvgpr_write_b32 a12, v64
v_perm_b32 v68, v21, v20, s47
v_accvgpr_write_b32 a20, v68
s_mov_b32 s20, 1581056
buffer_load_dword v20, v1, s[12:15], s20 offen
s_mov_b32 s21, 1613824
buffer_load_dword v21, v1, s[12:15], s21 offen
s_waitcnt vmcnt(58)
v_perm_b32 v65, v23, v22, s46
v_accvgpr_write_b32 a13, v65
v_perm_b32 v69, v23, v22, s47
v_accvgpr_write_b32 a21, v69
s_mov_b32 s20, 1646592
buffer_load_dword v22, v1, s[12:15], s20 offen
s_mov_b32 s21, 1679360
buffer_load_dword v23, v1, s[12:15], s21 offen
s_waitcnt vmcnt(58)
v_perm_b32 v66, v25, v24, s46
v_accvgpr_write_b32 a14, v66
v_perm_b32 v70, v25, v24, s47
v_accvgpr_write_b32 a22, v70
s_mov_b32 s20, 1835008
buffer_load_dword v24, v1, s[12:15], s20 offen
s_mov_b32 s21, 1867776
buffer_load_dword v25, v1, s[12:15], s21 offen
s_waitcnt vmcnt(58)
v_perm_b32 v67, v27, v26, s46
v_accvgpr_write_b32 a15, v67
v_perm_b32 v71, v27, v26, s47
v_accvgpr_write_b32 a23, v71
s_mov_b32 s20, 1900544
buffer_load_dword v26, v1, s[12:15], s20 offen
s_mov_b32 s21, 1933312
buffer_load_dword v27, v1, s[12:15], s21 offen
s_waitcnt vmcnt(58)
v_perm_b32 v88, v29, v28, s46
v_perm_b32 v68, v29, v28, s47
s_mov_b32 s20, 1843200
buffer_load_dword v28, v1, s[12:15], s20 offen
s_mov_b32 s21, 1875968
buffer_load_dword v29, v1, s[12:15], s21 offen
s_waitcnt vmcnt(58)
v_perm_b32 v89, v31, v30, s46
v_perm_b32 v69, v31, v30, s47
s_mov_b32 s20, 1908736
buffer_load_dword v30, v1, s[12:15], s20 offen
s_mov_b32 s21, 1941504
buffer_load_dword v31, v1, s[12:15], s21 offen
s_waitcnt vmcnt(58)
v_perm_b32 v90, v33, v32, s46
v_perm_b32 v70, v33, v32, s47
s_mov_b32 s20, 2097152
buffer_load_dword v32, v1, s[12:15], s20 offen
s_mov_b32 s21, 2129920
buffer_load_dword v33, v1, s[12:15], s21 offen
s_waitcnt vmcnt(58)
v_perm_b32 v91, v35, v34, s46
v_perm_b32 v71, v35, v34, s47
ds_write_b128 v3, v[68:71] offset:0
s_waitcnt lgkmcnt(0)
s_mov_b32 s20, 2162688
buffer_load_dword v34, v1, s[12:15], s20 offen
s_mov_b32 s21, 2195456
buffer_load_dword v35, v1, s[12:15], s21 offen
s_waitcnt vmcnt(58)
v_perm_b32 v92, v37, v36, s46
v_perm_b32 v68, v37, v36, s47
s_mov_b32 s20, 2105344
buffer_load_dword v36, v1, s[12:15], s20 offen
s_mov_b32 s21, 2138112
buffer_load_dword v37, v1, s[12:15], s21 offen
s_waitcnt vmcnt(58)
v_perm_b32 v93, v39, v38, s46
v_perm_b32 v69, v39, v38, s47
s_mov_b32 s20, 2170880
buffer_load_dword v38, v1, s[12:15], s20 offen
s_mov_b32 s21, 2203648
buffer_load_dword v39, v1, s[12:15], s21 offen
s_waitcnt vmcnt(58)
v_perm_b32 v94, v41, v40, s46
v_perm_b32 v70, v41, v40, s47
s_mov_b32 s20, 2359296
buffer_load_dword v40, v1, s[12:15], s20 offen
s_mov_b32 s21, 2392064
buffer_load_dword v41, v1, s[12:15], s21 offen
s_waitcnt vmcnt(58)
v_perm_b32 v95, v43, v42, s46
v_perm_b32 v71, v43, v42, s47
ds_write_b128 v3, v[68:71] offset:1024
s_waitcnt lgkmcnt(0)
s_mov_b32 s20, 2424832
buffer_load_dword v42, v1, s[12:15], s20 offen
s_mov_b32 s21, 2457600
buffer_load_dword v43, v1, s[12:15], s21 offen
s_waitcnt vmcnt(58)
v_perm_b32 v112, v45, v44, s46
v_perm_b32 v68, v45, v44, s47
s_mov_b32 s20, 2367488
buffer_load_dword v44, v1, s[12:15], s20 offen
s_mov_b32 s21, 2400256
buffer_load_dword v45, v1, s[12:15], s21 offen
s_waitcnt vmcnt(58)
v_perm_b32 v113, v47, v46, s46
v_perm_b32 v69, v47, v46, s47
s_mov_b32 s20, 2433024
buffer_load_dword v46, v1, s[12:15], s20 offen
s_mov_b32 s21, 2465792
buffer_load_dword v47, v1, s[12:15], s21 offen
s_waitcnt vmcnt(58)
v_perm_b32 v114, v49, v48, s46
v_perm_b32 v70, v49, v48, s47
s_mov_b32 s20, 2621440
buffer_load_dword v48, v1, s[12:15], s20 offen
s_mov_b32 s21, 2654208
buffer_load_dword v49, v1, s[12:15], s21 offen
s_waitcnt vmcnt(58)
v_perm_b32 v115, v51, v50, s46
v_perm_b32 v71, v51, v50, s47
ds_write_b128 v3, v[68:71] offset:2048
s_waitcnt lgkmcnt(0)
s_mov_b32 s20, 2686976
buffer_load_dword v50, v1, s[12:15], s20 offen
s_mov_b32 s21, 2719744
buffer_load_dword v51, v1, s[12:15], s21 offen
s_waitcnt vmcnt(58)
v_perm_b32 v116, v53, v52, s46
v_perm_b32 v68, v53, v52, s47
s_mov_b32 s20, 2629632
buffer_load_dword v52, v1, s[12:15], s20 offen
s_mov_b32 s21, 2662400
buffer_load_dword v53, v1, s[12:15], s21 offen
s_waitcnt vmcnt(58)
v_perm_b32 v117, v55, v54, s46
v_perm_b32 v69, v55, v54, s47
s_mov_b32 s20, 2695168
buffer_load_dword v54, v1, s[12:15], s20 offen
s_mov_b32 s21, 2727936
buffer_load_dword v55, v1, s[12:15], s21 offen
s_waitcnt vmcnt(58)
v_perm_b32 v118, v57, v56, s46
v_perm_b32 v70, v57, v56, s47
s_mov_b32 s20, 2883584
buffer_load_dword v56, v1, s[12:15], s20 offen
s_mov_b32 s21, 2916352
buffer_load_dword v57, v1, s[12:15], s21 offen
s_waitcnt vmcnt(58)
v_perm_b32 v119, v59, v58, s46
v_perm_b32 v71, v59, v58, s47
ds_write_b128 v3, v[68:71] offset:3072
s_waitcnt lgkmcnt(0)
s_mov_b32 s20, 2949120
buffer_load_dword v58, v1, s[12:15], s20 offen
s_mov_b32 s21, 2981888
buffer_load_dword v59, v1, s[12:15], s21 offen
s_waitcnt vmcnt(58)
v_perm_b32 v136, v61, v60, s46
v_perm_b32 v68, v61, v60, s47
s_mov_b32 s20, 2891776
buffer_load_dword v60, v1, s[12:15], s20 offen
s_mov_b32 s21, 2924544
buffer_load_dword v61, v1, s[12:15], s21 offen
s_waitcnt vmcnt(58)
v_perm_b32 v137, v63, v62, s46
v_perm_b32 v69, v63, v62, s47
s_mov_b32 s20, 2957312
buffer_load_dword v62, v1, s[12:15], s20 offen
s_mov_b32 s21, 2990080
buffer_load_dword v63, v1, s[12:15], s21 offen
s_waitcnt vmcnt(58)
v_perm_b32 v138, v5, v4, s46
v_perm_b32 v70, v5, v4, s47
s_mov_b32 s20, 3145728
buffer_load_dword v4, v1, s[12:15], s20 offen
s_mov_b32 s21, 3178496
buffer_load_dword v5, v1, s[12:15], s21 offen
s_waitcnt vmcnt(58)
v_perm_b32 v139, v7, v6, s46
v_perm_b32 v71, v7, v6, s47
ds_write_b128 v3, v[68:71] offset:4096
s_waitcnt lgkmcnt(0)
s_mov_b32 s20, 3211264
buffer_load_dword v6, v1, s[12:15], s20 offen
s_mov_b32 s21, 3244032
buffer_load_dword v7, v1, s[12:15], s21 offen
s_waitcnt vmcnt(58)
v_perm_b32 v140, v9, v8, s46
v_perm_b32 v68, v9, v8, s47
s_mov_b32 s20, 3153920
buffer_load_dword v8, v1, s[12:15], s20 offen
s_mov_b32 s21, 3186688
buffer_load_dword v9, v1, s[12:15], s21 offen
s_waitcnt vmcnt(58)
v_perm_b32 v141, v11, v10, s46
v_perm_b32 v69, v11, v10, s47
s_mov_b32 s20, 3219456
buffer_load_dword v10, v1, s[12:15], s20 offen
s_mov_b32 s21, 3252224
buffer_load_dword v11, v1, s[12:15], s21 offen
s_waitcnt vmcnt(58)
v_perm_b32 v142, v13, v12, s46
v_perm_b32 v70, v13, v12, s47
s_mov_b32 s20, 3407872
buffer_load_dword v12, v1, s[12:15], s20 offen
s_mov_b32 s21, 3440640
buffer_load_dword v13, v1, s[12:15], s21 offen
s_waitcnt vmcnt(58)
v_perm_b32 v143, v15, v14, s46
v_perm_b32 v71, v15, v14, s47
ds_write_b128 v3, v[68:71] offset:5120
s_waitcnt lgkmcnt(0)
s_mov_b32 s20, 3473408
buffer_load_dword v14, v1, s[12:15], s20 offen
s_mov_b32 s21, 3506176
buffer_load_dword v15, v1, s[12:15], s21 offen
s_waitcnt vmcnt(58)
v_perm_b32 v160, v17, v16, s46
v_perm_b32 v68, v17, v16, s47
s_mov_b32 s20, 3416064
buffer_load_dword v16, v1, s[12:15], s20 offen
s_mov_b32 s21, 3448832
buffer_load_dword v17, v1, s[12:15], s21 offen
s_waitcnt vmcnt(58)
v_perm_b32 v161, v19, v18, s46
v_perm_b32 v69, v19, v18, s47
s_mov_b32 s20, 3481600
buffer_load_dword v18, v1, s[12:15], s20 offen
s_mov_b32 s21, 3514368
buffer_load_dword v19, v1, s[12:15], s21 offen
s_waitcnt vmcnt(58)
v_perm_b32 v162, v21, v20, s46
v_perm_b32 v70, v21, v20, s47
s_mov_b32 s20, 3670016
buffer_load_dword v20, v1, s[12:15], s20 offen
s_mov_b32 s21, 3702784
buffer_load_dword v21, v1, s[12:15], s21 offen
s_waitcnt vmcnt(58)
v_perm_b32 v163, v23, v22, s46
v_perm_b32 v71, v23, v22, s47
ds_write_b128 v3, v[68:71] offset:6144
s_waitcnt lgkmcnt(0)
s_mov_b32 s20, 3735552
buffer_load_dword v22, v1, s[12:15], s20 offen
s_mov_b32 s21, 3768320
buffer_load_dword v23, v1, s[12:15], s21 offen
s_waitcnt vmcnt(58)
v_perm_b32 v164, v25, v24, s46
v_perm_b32 v68, v25, v24, s47
s_mov_b32 s20, 3678208
buffer_load_dword v24, v1, s[12:15], s20 offen
s_mov_b32 s21, 3710976
buffer_load_dword v25, v1, s[12:15], s21 offen
s_waitcnt vmcnt(58)
v_perm_b32 v165, v27, v26, s46
v_perm_b32 v69, v27, v26, s47
s_mov_b32 s20, 3743744
buffer_load_dword v26, v1, s[12:15], s20 offen
s_mov_b32 s21, 3776512
buffer_load_dword v27, v1, s[12:15], s21 offen
s_waitcnt vmcnt(58)
v_perm_b32 v166, v29, v28, s46
v_perm_b32 v70, v29, v28, s47
s_mov_b32 s20, 3932160
buffer_load_dword v28, v1, s[12:15], s20 offen
s_mov_b32 s21, 3964928
buffer_load_dword v29, v1, s[12:15], s21 offen
s_waitcnt vmcnt(58)
v_perm_b32 v167, v31, v30, s46
v_perm_b32 v71, v31, v30, s47
ds_write_b128 v3, v[68:71] offset:7168
s_waitcnt lgkmcnt(0)
s_mov_b32 s20, 3997696
buffer_load_dword v30, v1, s[12:15], s20 offen
s_mov_b32 s21, 4030464
buffer_load_dword v31, v1, s[12:15], s21 offen
s_waitcnt vmcnt(58)
v_perm_b32 v184, v33, v32, s46
v_perm_b32 v68, v33, v32, s47
s_mov_b32 s20, 3940352
buffer_load_dword v32, v1, s[12:15], s20 offen
s_mov_b32 s21, 3973120
buffer_load_dword v33, v1, s[12:15], s21 offen
s_waitcnt vmcnt(58)
v_perm_b32 v185, v35, v34, s46
v_perm_b32 v69, v35, v34, s47
s_mov_b32 s20, 4005888
buffer_load_dword v34, v1, s[12:15], s20 offen
s_mov_b32 s21, 4038656
buffer_load_dword v35, v1, s[12:15], s21 offen
s_waitcnt vmcnt(58)
v_perm_b32 v186, v37, v36, s46
v_perm_b32 v70, v37, v36, s47
s_mov_b32 s20, 4194304
buffer_load_dword v36, v1, s[12:15], s20 offen
s_mov_b32 s21, 4227072
buffer_load_dword v37, v1, s[12:15], s21 offen
s_waitcnt vmcnt(58)
v_perm_b32 v187, v39, v38, s46
v_perm_b32 v71, v39, v38, s47
ds_write_b128 v3, v[68:71] offset:8192
s_waitcnt lgkmcnt(0)
s_mov_b32 s20, 4259840
buffer_load_dword v38, v1, s[12:15], s20 offen
s_mov_b32 s21, 4292608
buffer_load_dword v39, v1, s[12:15], s21 offen
s_waitcnt vmcnt(58)
v_perm_b32 v188, v41, v40, s46
v_perm_b32 v68, v41, v40, s47
s_mov_b32 s20, 4202496
buffer_load_dword v40, v1, s[12:15], s20 offen
s_mov_b32 s21, 4235264
buffer_load_dword v41, v1, s[12:15], s21 offen
s_waitcnt vmcnt(58)
v_perm_b32 v189, v43, v42, s46
v_perm_b32 v69, v43, v42, s47
s_mov_b32 s20, 4268032
buffer_load_dword v42, v1, s[12:15], s20 offen
s_mov_b32 s21, 4300800
buffer_load_dword v43, v1, s[12:15], s21 offen
s_waitcnt vmcnt(58)
v_perm_b32 v190, v45, v44, s46
v_perm_b32 v70, v45, v44, s47
s_mov_b32 s20, 4456448
buffer_load_dword v44, v1, s[12:15], s20 offen
s_mov_b32 s21, 4489216
buffer_load_dword v45, v1, s[12:15], s21 offen
s_waitcnt vmcnt(58)
v_perm_b32 v191, v47, v46, s46
v_perm_b32 v71, v47, v46, s47
ds_write_b128 v3, v[68:71] offset:9216
s_waitcnt lgkmcnt(0)
s_mov_b32 s20, 4521984
buffer_load_dword v46, v1, s[12:15], s20 offen
s_mov_b32 s21, 4554752
buffer_load_dword v47, v1, s[12:15], s21 offen
s_waitcnt vmcnt(58)
v_perm_b32 v208, v49, v48, s46
v_perm_b32 v68, v49, v48, s47
s_mov_b32 s20, 4464640
buffer_load_dword v48, v1, s[12:15], s20 offen
s_mov_b32 s21, 4497408
buffer_load_dword v49, v1, s[12:15], s21 offen
s_waitcnt vmcnt(58)
v_perm_b32 v209, v51, v50, s46
v_perm_b32 v69, v51, v50, s47
s_mov_b32 s20, 4530176
buffer_load_dword v50, v1, s[12:15], s20 offen
s_mov_b32 s21, 4562944
buffer_load_dword v51, v1, s[12:15], s21 offen
s_waitcnt vmcnt(58)
v_perm_b32 v210, v53, v52, s46
v_perm_b32 v70, v53, v52, s47
s_load_dwordx2 s[50:51], s[0:1], 80
s_waitcnt lgkmcnt(0)
s_mov_b32 s12, s50
s_and_b32 s13, s51, 0xffff
s_mov_b32 s14, 4718592
s_mov_b32 s15, 0x20000
s_mov_b32 s20, 0
buffer_load_dword v52, v1, s[12:15], s20 offen
s_mov_b32 s21, 32768
buffer_load_dword v53, v1, s[12:15], s21 offen
s_waitcnt vmcnt(58)
v_perm_b32 v211, v55, v54, s46
v_perm_b32 v71, v55, v54, s47
ds_write_b128 v3, v[68:71] offset:10240
s_waitcnt lgkmcnt(0)
s_mov_b32 s20, 65536
buffer_load_dword v54, v1, s[12:15], s20 offen
s_mov_b32 s21, 98304
buffer_load_dword v55, v1, s[12:15], s21 offen
s_waitcnt vmcnt(58)
v_perm_b32 v212, v57, v56, s46
v_perm_b32 v68, v57, v56, s47
s_mov_b32 s20, 8192
buffer_load_dword v56, v1, s[12:15], s20 offen
s_mov_b32 s21, 40960
buffer_load_dword v57, v1, s[12:15], s21 offen
s_waitcnt vmcnt(58)
v_perm_b32 v213, v59, v58, s46
v_perm_b32 v69, v59, v58, s47
s_mov_b32 s20, 73728
buffer_load_dword v58, v1, s[12:15], s20 offen
s_mov_b32 s21, 106496
buffer_load_dword v59, v1, s[12:15], s21 offen
s_waitcnt vmcnt(58)
v_perm_b32 v214, v61, v60, s46
v_perm_b32 v70, v61, v60, s47
s_mov_b32 s20, 262144
buffer_load_dword v60, v1, s[12:15], s20 offen
s_mov_b32 s21, 294912
buffer_load_dword v61, v1, s[12:15], s21 offen
s_waitcnt vmcnt(58)
v_perm_b32 v215, v63, v62, s46
v_perm_b32 v71, v63, v62, s47
ds_write_b128 v3, v[68:71] offset:11264
s_waitcnt lgkmcnt(0)
s_mov_b32 s20, 327680
buffer_load_dword v62, v1, s[12:15], s20 offen
s_mov_b32 s21, 360448
buffer_load_dword v63, v1, s[12:15], s21 offen
s_waitcnt vmcnt(58)
v_perm_b32 v232, v5, v4, s46
v_perm_b32 v68, v5, v4, s47
s_mov_b32 s20, 270336
buffer_load_dword v4, v1, s[12:15], s20 offen
s_mov_b32 s21, 303104
buffer_load_dword v5, v1, s[12:15], s21 offen
s_waitcnt vmcnt(58)
v_perm_b32 v233, v7, v6, s46
v_perm_b32 v69, v7, v6, s47
s_mov_b32 s20, 335872
buffer_load_dword v6, v1, s[12:15], s20 offen
s_mov_b32 s21, 368640
buffer_load_dword v7, v1, s[12:15], s21 offen
s_waitcnt vmcnt(58)
v_perm_b32 v234, v9, v8, s46
v_perm_b32 v70, v9, v8, s47
s_mov_b32 s20, 524288
buffer_load_dword v8, v1, s[12:15], s20 offen
s_mov_b32 s21, 557056
buffer_load_dword v9, v1, s[12:15], s21 offen
s_waitcnt vmcnt(58)
v_perm_b32 v235, v11, v10, s46
v_perm_b32 v71, v11, v10, s47
ds_write_b128 v3, v[68:71] offset:12288
s_waitcnt lgkmcnt(0)
s_mov_b32 s20, 589824
buffer_load_dword v10, v1, s[12:15], s20 offen
s_mov_b32 s21, 622592
buffer_load_dword v11, v1, s[12:15], s21 offen
s_waitcnt vmcnt(58)
v_perm_b32 v236, v13, v12, s46
v_perm_b32 v68, v13, v12, s47
s_mov_b32 s20, 532480
buffer_load_dword v12, v1, s[12:15], s20 offen
s_mov_b32 s21, 565248
buffer_load_dword v13, v1, s[12:15], s21 offen
s_waitcnt vmcnt(58)
v_perm_b32 v237, v15, v14, s46
v_perm_b32 v69, v15, v14, s47
s_mov_b32 s20, 598016
buffer_load_dword v14, v1, s[12:15], s20 offen
s_mov_b32 s21, 630784
buffer_load_dword v15, v1, s[12:15], s21 offen
s_waitcnt vmcnt(58)
v_perm_b32 v238, v17, v16, s46
v_perm_b32 v70, v17, v16, s47
s_mov_b32 s20, 786432
buffer_load_dword v16, v1, s[12:15], s20 offen
s_mov_b32 s21, 819200
buffer_load_dword v17, v1, s[12:15], s21 offen
s_waitcnt vmcnt(58)
v_perm_b32 v239, v19, v18, s46
v_perm_b32 v71, v19, v18, s47
ds_write_b128 v3, v[68:71] offset:13312
s_waitcnt lgkmcnt(0)
s_mov_b32 s20, 851968
buffer_load_dword v18, v1, s[12:15], s20 offen
s_mov_b32 s21, 884736
buffer_load_dword v19, v1, s[12:15], s21 offen
s_waitcnt vmcnt(58)
v_perm_b32 v64, v21, v20, s46
v_accvgpr_write_b32 a0, v64
v_perm_b32 v68, v21, v20, s47
s_mov_b32 s20, 794624
buffer_load_dword v20, v1, s[12:15], s20 offen
s_mov_b32 s21, 827392
buffer_load_dword v21, v1, s[12:15], s21 offen
s_waitcnt vmcnt(58)
v_perm_b32 v65, v23, v22, s46
v_accvgpr_write_b32 a1, v65
v_perm_b32 v69, v23, v22, s47
s_mov_b32 s20, 860160
buffer_load_dword v22, v1, s[12:15], s20 offen
s_mov_b32 s21, 892928
buffer_load_dword v23, v1, s[12:15], s21 offen
s_waitcnt vmcnt(58)
v_perm_b32 v66, v25, v24, s46
v_accvgpr_write_b32 a2, v66
v_perm_b32 v70, v25, v24, s47
s_mov_b32 s20, 1048576
buffer_load_dword v24, v1, s[12:15], s20 offen
s_mov_b32 s21, 1081344
buffer_load_dword v25, v1, s[12:15], s21 offen
s_waitcnt vmcnt(58)
v_perm_b32 v67, v27, v26, s46
v_accvgpr_write_b32 a3, v67
v_perm_b32 v71, v27, v26, s47
ds_write_b128 v3, v[68:71] offset:14336
s_waitcnt lgkmcnt(0)
s_mov_b32 s20, 1114112
buffer_load_dword v26, v1, s[12:15], s20 offen
s_mov_b32 s21, 1146880
buffer_load_dword v27, v1, s[12:15], s21 offen
s_waitcnt vmcnt(58)
v_perm_b32 v64, v29, v28, s46
v_accvgpr_write_b32 a4, v64
v_perm_b32 v68, v29, v28, s47
s_mov_b32 s20, 1056768
buffer_load_dword v28, v1, s[12:15], s20 offen
s_mov_b32 s21, 1089536
buffer_load_dword v29, v1, s[12:15], s21 offen
s_waitcnt vmcnt(58)
v_perm_b32 v65, v31, v30, s46
v_accvgpr_write_b32 a5, v65
v_perm_b32 v69, v31, v30, s47
s_mov_b32 s20, 1122304
buffer_load_dword v30, v1, s[12:15], s20 offen
s_mov_b32 s21, 1155072
buffer_load_dword v31, v1, s[12:15], s21 offen
s_waitcnt vmcnt(58)
v_perm_b32 v66, v33, v32, s46
v_accvgpr_write_b32 a6, v66
v_perm_b32 v70, v33, v32, s47
s_mov_b32 s20, 1310720
buffer_load_dword v32, v1, s[12:15], s20 offen
s_mov_b32 s21, 1343488
buffer_load_dword v33, v1, s[12:15], s21 offen
s_waitcnt vmcnt(58)
v_perm_b32 v67, v35, v34, s46
v_accvgpr_write_b32 a7, v67
v_perm_b32 v71, v35, v34, s47
ds_write_b128 v3, v[68:71] offset:15360
s_waitcnt lgkmcnt(0)
s_mov_b32 s20, 1376256
buffer_load_dword v34, v1, s[12:15], s20 offen
s_mov_b32 s21, 1409024
buffer_load_dword v35, v1, s[12:15], s21 offen
s_waitcnt vmcnt(58)
v_perm_b32 v64, v37, v36, s46
v_accvgpr_write_b32 a24, v64
v_perm_b32 v68, v37, v36, s47
s_mov_b32 s20, 1318912
buffer_load_dword v36, v1, s[12:15], s20 offen
s_mov_b32 s21, 1351680
buffer_load_dword v37, v1, s[12:15], s21 offen
s_waitcnt vmcnt(58)
v_perm_b32 v65, v39, v38, s46
v_accvgpr_write_b32 a25, v65
v_perm_b32 v69, v39, v38, s47
s_mov_b32 s20, 1384448
buffer_load_dword v38, v1, s[12:15], s20 offen
s_mov_b32 s21, 1417216
buffer_load_dword v39, v1, s[12:15], s21 offen
s_waitcnt vmcnt(58)
v_perm_b32 v66, v41, v40, s46
v_accvgpr_write_b32 a26, v66
v_perm_b32 v70, v41, v40, s47
s_mov_b32 s20, 1572864
buffer_load_dword v40, v1, s[12:15], s20 offen
s_mov_b32 s21, 1605632
buffer_load_dword v41, v1, s[12:15], s21 offen
s_waitcnt vmcnt(58)
v_perm_b32 v67, v43, v42, s46
v_accvgpr_write_b32 a27, v67
v_perm_b32 v71, v43, v42, s47
ds_write_b128 v3, v[68:71] offset:16384
s_waitcnt lgkmcnt(0)
s_mov_b32 s20, 1638400
buffer_load_dword v42, v1, s[12:15], s20 offen
s_mov_b32 s21, 1671168
buffer_load_dword v43, v1, s[12:15], s21 offen
s_waitcnt vmcnt(58)
v_perm_b32 v64, v45, v44, s46
v_accvgpr_write_b32 a28, v64
v_perm_b32 v68, v45, v44, s47
s_mov_b32 s20, 1581056
buffer_load_dword v44, v1, s[12:15], s20 offen
s_mov_b32 s21, 1613824
buffer_load_dword v45, v1, s[12:15], s21 offen
s_waitcnt vmcnt(58)
v_perm_b32 v65, v47, v46, s46
v_accvgpr_write_b32 a29, v65
v_perm_b32 v69, v47, v46, s47
s_mov_b32 s20, 1646592
buffer_load_dword v46, v1, s[12:15], s20 offen
s_mov_b32 s21, 1679360
buffer_load_dword v47, v1, s[12:15], s21 offen
s_waitcnt vmcnt(58)
v_perm_b32 v66, v49, v48, s46
v_accvgpr_write_b32 a30, v66
v_perm_b32 v70, v49, v48, s47
s_mov_b32 s20, 1835008
buffer_load_dword v48, v1, s[12:15], s20 offen
s_mov_b32 s21, 1867776
buffer_load_dword v49, v1, s[12:15], s21 offen
s_waitcnt vmcnt(58)
v_perm_b32 v67, v51, v50, s46
v_accvgpr_write_b32 a31, v67
v_perm_b32 v71, v51, v50, s47
ds_write_b128 v3, v[68:71] offset:17408
s_waitcnt lgkmcnt(0)
s_mov_b32 s20, 1900544
buffer_load_dword v50, v1, s[12:15], s20 offen
s_mov_b32 s21, 1933312
buffer_load_dword v51, v1, s[12:15], s21 offen
s_waitcnt vmcnt(58)
v_perm_b32 v64, v53, v52, s46
v_accvgpr_write_b32 a32, v64
v_perm_b32 v68, v53, v52, s47
v_accvgpr_write_b32 a40, v68
s_mov_b32 s20, 1843200
buffer_load_dword v52, v1, s[12:15], s20 offen
s_mov_b32 s21, 1875968
buffer_load_dword v53, v1, s[12:15], s21 offen
s_waitcnt vmcnt(58)
v_perm_b32 v65, v55, v54, s46
v_accvgpr_write_b32 a33, v65
v_perm_b32 v69, v55, v54, s47
v_accvgpr_write_b32 a41, v69
s_mov_b32 s20, 1908736
buffer_load_dword v54, v1, s[12:15], s20 offen
s_mov_b32 s21, 1941504
buffer_load_dword v55, v1, s[12:15], s21 offen
s_waitcnt vmcnt(58)
v_perm_b32 v66, v57, v56, s46
v_accvgpr_write_b32 a34, v66
v_perm_b32 v70, v57, v56, s47
v_accvgpr_write_b32 a42, v70
s_mov_b32 s20, 2097152
buffer_load_dword v56, v1, s[12:15], s20 offen
s_mov_b32 s21, 2129920
buffer_load_dword v57, v1, s[12:15], s21 offen
s_waitcnt vmcnt(58)
v_perm_b32 v67, v59, v58, s46
v_accvgpr_write_b32 a35, v67
v_perm_b32 v71, v59, v58, s47
v_accvgpr_write_b32 a43, v71
s_mov_b32 s20, 2162688
buffer_load_dword v58, v1, s[12:15], s20 offen
s_mov_b32 s21, 2195456
buffer_load_dword v59, v1, s[12:15], s21 offen
s_waitcnt vmcnt(58)
v_perm_b32 v64, v61, v60, s46
v_accvgpr_write_b32 a36, v64
v_perm_b32 v68, v61, v60, s47
v_accvgpr_write_b32 a44, v68
s_mov_b32 s20, 2105344
buffer_load_dword v60, v1, s[12:15], s20 offen
s_mov_b32 s21, 2138112
buffer_load_dword v61, v1, s[12:15], s21 offen
s_waitcnt vmcnt(58)
v_perm_b32 v65, v63, v62, s46
v_accvgpr_write_b32 a37, v65
v_perm_b32 v69, v63, v62, s47
v_accvgpr_write_b32 a45, v69
s_mov_b32 s20, 2170880
buffer_load_dword v62, v1, s[12:15], s20 offen
s_mov_b32 s21, 2203648
buffer_load_dword v63, v1, s[12:15], s21 offen
s_waitcnt vmcnt(58)
v_perm_b32 v66, v5, v4, s46
v_accvgpr_write_b32 a38, v66
v_perm_b32 v70, v5, v4, s47
v_accvgpr_write_b32 a46, v70
s_mov_b32 s20, 2359296
buffer_load_dword v4, v1, s[12:15], s20 offen
s_mov_b32 s21, 2392064
buffer_load_dword v5, v1, s[12:15], s21 offen
s_waitcnt vmcnt(58)
v_perm_b32 v67, v7, v6, s46
v_accvgpr_write_b32 a39, v67
v_perm_b32 v71, v7, v6, s47
v_accvgpr_write_b32 a47, v71
s_mov_b32 s20, 2424832
buffer_load_dword v6, v1, s[12:15], s20 offen
s_mov_b32 s21, 2457600
buffer_load_dword v7, v1, s[12:15], s21 offen
s_waitcnt vmcnt(58)
v_perm_b32 v64, v9, v8, s46
v_accvgpr_write_b32 a48, v64
v_perm_b32 v68, v9, v8, s47
v_accvgpr_write_b32 a56, v68
s_mov_b32 s20, 2367488
buffer_load_dword v8, v1, s[12:15], s20 offen
s_mov_b32 s21, 2400256
buffer_load_dword v9, v1, s[12:15], s21 offen
s_waitcnt vmcnt(58)
v_perm_b32 v65, v11, v10, s46
v_accvgpr_write_b32 a49, v65
v_perm_b32 v69, v11, v10, s47
v_accvgpr_write_b32 a57, v69
s_mov_b32 s20, 2433024
buffer_load_dword v10, v1, s[12:15], s20 offen
s_mov_b32 s21, 2465792
buffer_load_dword v11, v1, s[12:15], s21 offen
s_waitcnt vmcnt(58)
v_perm_b32 v66, v13, v12, s46
v_accvgpr_write_b32 a50, v66
v_perm_b32 v70, v13, v12, s47
v_accvgpr_write_b32 a58, v70
s_mov_b32 s20, 2621440
buffer_load_dword v12, v1, s[12:15], s20 offen
s_mov_b32 s21, 2654208
buffer_load_dword v13, v1, s[12:15], s21 offen
s_waitcnt vmcnt(58)
v_perm_b32 v67, v15, v14, s46
v_accvgpr_write_b32 a51, v67
v_perm_b32 v71, v15, v14, s47
v_accvgpr_write_b32 a59, v71
s_mov_b32 s20, 2686976
buffer_load_dword v14, v1, s[12:15], s20 offen
s_mov_b32 s21, 2719744
buffer_load_dword v15, v1, s[12:15], s21 offen
s_waitcnt vmcnt(58)
v_perm_b32 v64, v17, v16, s46
v_accvgpr_write_b32 a52, v64
v_perm_b32 v68, v17, v16, s47
v_accvgpr_write_b32 a60, v68
s_mov_b32 s20, 2629632
buffer_load_dword v16, v1, s[12:15], s20 offen
s_mov_b32 s21, 2662400
buffer_load_dword v17, v1, s[12:15], s21 offen
s_waitcnt vmcnt(58)
v_perm_b32 v65, v19, v18, s46
v_accvgpr_write_b32 a53, v65
v_perm_b32 v69, v19, v18, s47
v_accvgpr_write_b32 a61, v69
s_mov_b32 s20, 2695168
buffer_load_dword v18, v1, s[12:15], s20 offen
s_mov_b32 s21, 2727936
buffer_load_dword v19, v1, s[12:15], s21 offen
s_waitcnt vmcnt(58)
v_perm_b32 v66, v21, v20, s46
v_accvgpr_write_b32 a54, v66
v_perm_b32 v70, v21, v20, s47
v_accvgpr_write_b32 a62, v70
s_mov_b32 s20, 2883584
buffer_load_dword v20, v1, s[12:15], s20 offen
s_mov_b32 s21, 2916352
buffer_load_dword v21, v1, s[12:15], s21 offen
s_waitcnt vmcnt(58)
v_perm_b32 v67, v23, v22, s46
v_accvgpr_write_b32 a55, v67
v_perm_b32 v71, v23, v22, s47
v_accvgpr_write_b32 a63, v71
s_mov_b32 s20, 2949120
buffer_load_dword v22, v1, s[12:15], s20 offen
s_mov_b32 s21, 2981888
buffer_load_dword v23, v1, s[12:15], s21 offen
s_waitcnt vmcnt(58)
v_perm_b32 v64, v25, v24, s46
v_accvgpr_write_b32 a64, v64
v_perm_b32 v68, v25, v24, s47
v_accvgpr_write_b32 a72, v68
s_mov_b32 s20, 2891776
buffer_load_dword v24, v1, s[12:15], s20 offen
s_mov_b32 s21, 2924544
buffer_load_dword v25, v1, s[12:15], s21 offen
s_waitcnt vmcnt(58)
v_perm_b32 v65, v27, v26, s46
v_accvgpr_write_b32 a65, v65
v_perm_b32 v69, v27, v26, s47
v_accvgpr_write_b32 a73, v69
s_mov_b32 s20, 2957312
buffer_load_dword v26, v1, s[12:15], s20 offen
s_mov_b32 s21, 2990080
buffer_load_dword v27, v1, s[12:15], s21 offen
s_waitcnt vmcnt(58)
v_perm_b32 v66, v29, v28, s46
v_accvgpr_write_b32 a66, v66
v_perm_b32 v70, v29, v28, s47
v_accvgpr_write_b32 a74, v70
s_mov_b32 s20, 3145728
buffer_load_dword v28, v1, s[12:15], s20 offen
s_mov_b32 s21, 3178496
buffer_load_dword v29, v1, s[12:15], s21 offen
s_waitcnt vmcnt(58)
v_perm_b32 v67, v31, v30, s46
v_accvgpr_write_b32 a67, v67
v_perm_b32 v71, v31, v30, s47
v_accvgpr_write_b32 a75, v71
s_mov_b32 s20, 3211264
buffer_load_dword v30, v1, s[12:15], s20 offen
s_mov_b32 s21, 3244032
buffer_load_dword v31, v1, s[12:15], s21 offen
s_waitcnt vmcnt(58)
v_perm_b32 v64, v33, v32, s46
v_accvgpr_write_b32 a68, v64
v_perm_b32 v68, v33, v32, s47
v_accvgpr_write_b32 a76, v68
s_mov_b32 s20, 3153920
buffer_load_dword v32, v1, s[12:15], s20 offen
s_mov_b32 s21, 3186688
buffer_load_dword v33, v1, s[12:15], s21 offen
s_waitcnt vmcnt(58)
v_perm_b32 v65, v35, v34, s46
v_accvgpr_write_b32 a69, v65
v_perm_b32 v69, v35, v34, s47
v_accvgpr_write_b32 a77, v69
s_mov_b32 s20, 3219456
buffer_load_dword v34, v1, s[12:15], s20 offen
s_mov_b32 s21, 3252224
buffer_load_dword v35, v1, s[12:15], s21 offen
s_waitcnt vmcnt(58)
v_perm_b32 v66, v37, v36, s46
v_accvgpr_write_b32 a70, v66
v_perm_b32 v70, v37, v36, s47
v_accvgpr_write_b32 a78, v70
s_mov_b32 s20, 3407872
buffer_load_dword v36, v1, s[12:15], s20 offen
s_mov_b32 s21, 3440640
buffer_load_dword v37, v1, s[12:15], s21 offen
s_waitcnt vmcnt(58)
v_perm_b32 v67, v39, v38, s46
v_accvgpr_write_b32 a71, v67
v_perm_b32 v71, v39, v38, s47
v_accvgpr_write_b32 a79, v71
s_mov_b32 s20, 3473408
buffer_load_dword v38, v1, s[12:15], s20 offen
s_mov_b32 s21, 3506176
buffer_load_dword v39, v1, s[12:15], s21 offen
s_waitcnt vmcnt(58)
v_perm_b32 v64, v41, v40, s46
v_accvgpr_write_b32 a80, v64
v_perm_b32 v68, v41, v40, s47
v_accvgpr_write_b32 a88, v68
s_mov_b32 s20, 3416064
buffer_load_dword v40, v1, s[12:15], s20 offen
s_mov_b32 s21, 3448832
buffer_load_dword v41, v1, s[12:15], s21 offen
s_waitcnt vmcnt(58)
v_perm_b32 v65, v43, v42, s46
v_accvgpr_write_b32 a81, v65
v_perm_b32 v69, v43, v42, s47
v_accvgpr_write_b32 a89, v69
s_mov_b32 s20, 3481600
buffer_load_dword v42, v1, s[12:15], s20 offen
s_mov_b32 s21, 3514368
buffer_load_dword v43, v1, s[12:15], s21 offen
s_waitcnt vmcnt(58)
v_perm_b32 v66, v45, v44, s46
v_accvgpr_write_b32 a82, v66
v_perm_b32 v70, v45, v44, s47
v_accvgpr_write_b32 a90, v70
s_mov_b32 s20, 3670016
buffer_load_dword v44, v1, s[12:15], s20 offen
s_mov_b32 s21, 3702784
buffer_load_dword v45, v1, s[12:15], s21 offen
s_waitcnt vmcnt(58)
v_perm_b32 v67, v47, v46, s46
v_accvgpr_write_b32 a83, v67
v_perm_b32 v71, v47, v46, s47
v_accvgpr_write_b32 a91, v71
s_mov_b32 s20, 3735552
buffer_load_dword v46, v1, s[12:15], s20 offen
s_mov_b32 s21, 3768320
buffer_load_dword v47, v1, s[12:15], s21 offen
s_waitcnt vmcnt(58)
v_perm_b32 v64, v49, v48, s46
v_accvgpr_write_b32 a84, v64
v_perm_b32 v68, v49, v48, s47
v_accvgpr_write_b32 a92, v68
s_mov_b32 s20, 3678208
buffer_load_dword v48, v1, s[12:15], s20 offen
s_mov_b32 s21, 3710976
buffer_load_dword v49, v1, s[12:15], s21 offen
s_waitcnt vmcnt(58)
v_perm_b32 v65, v51, v50, s46
v_accvgpr_write_b32 a85, v65
v_perm_b32 v69, v51, v50, s47
v_accvgpr_write_b32 a93, v69
s_mov_b32 s20, 3743744
buffer_load_dword v50, v1, s[12:15], s20 offen
s_mov_b32 s21, 3776512
buffer_load_dword v51, v1, s[12:15], s21 offen
s_waitcnt vmcnt(58)
v_perm_b32 v66, v53, v52, s46
v_accvgpr_write_b32 a86, v66
v_perm_b32 v70, v53, v52, s47
v_accvgpr_write_b32 a94, v70
s_mov_b32 s20, 3932160
buffer_load_dword v52, v1, s[12:15], s20 offen
s_mov_b32 s21, 3964928
buffer_load_dword v53, v1, s[12:15], s21 offen
s_waitcnt vmcnt(58)
v_perm_b32 v67, v55, v54, s46
v_accvgpr_write_b32 a87, v67
v_perm_b32 v71, v55, v54, s47
v_accvgpr_write_b32 a95, v71
s_mov_b32 s20, 3997696
buffer_load_dword v54, v1, s[12:15], s20 offen
s_mov_b32 s21, 4030464
buffer_load_dword v55, v1, s[12:15], s21 offen
s_waitcnt vmcnt(58)
v_perm_b32 v64, v57, v56, s46
v_accvgpr_write_b32 a96, v64
v_perm_b32 v68, v57, v56, s47
v_accvgpr_write_b32 a104, v68
s_mov_b32 s20, 3940352
buffer_load_dword v56, v1, s[12:15], s20 offen
s_mov_b32 s21, 3973120
buffer_load_dword v57, v1, s[12:15], s21 offen
s_waitcnt vmcnt(58)
v_perm_b32 v65, v59, v58, s46
v_accvgpr_write_b32 a97, v65
v_perm_b32 v69, v59, v58, s47
v_accvgpr_write_b32 a105, v69
s_mov_b32 s20, 4005888
buffer_load_dword v58, v1, s[12:15], s20 offen
s_mov_b32 s21, 4038656
buffer_load_dword v59, v1, s[12:15], s21 offen
s_waitcnt vmcnt(58)
v_perm_b32 v66, v61, v60, s46
v_accvgpr_write_b32 a98, v66
v_perm_b32 v70, v61, v60, s47
v_accvgpr_write_b32 a106, v70
s_mov_b32 s20, 4194304
buffer_load_dword v60, v1, s[12:15], s20 offen
s_mov_b32 s21, 4227072
buffer_load_dword v61, v1, s[12:15], s21 offen
s_waitcnt vmcnt(58)
v_perm_b32 v67, v63, v62, s46
v_accvgpr_write_b32 a99, v67
v_perm_b32 v71, v63, v62, s47
v_accvgpr_write_b32 a107, v71
s_mov_b32 s20, 4259840
buffer_load_dword v62, v1, s[12:15], s20 offen
s_mov_b32 s21, 4292608
buffer_load_dword v63, v1, s[12:15], s21 offen
s_waitcnt vmcnt(58)
v_perm_b32 v64, v5, v4, s46
v_accvgpr_write_b32 a100, v64
v_perm_b32 v68, v5, v4, s47
v_accvgpr_write_b32 a108, v68
s_mov_b32 s20, 4202496
buffer_load_dword v4, v1, s[12:15], s20 offen
s_mov_b32 s21, 4235264
buffer_load_dword v5, v1, s[12:15], s21 offen
s_waitcnt vmcnt(58)
v_perm_b32 v65, v7, v6, s46
v_accvgpr_write_b32 a101, v65
v_perm_b32 v69, v7, v6, s47
v_accvgpr_write_b32 a109, v69
s_mov_b32 s20, 4268032
buffer_load_dword v6, v1, s[12:15], s20 offen
s_mov_b32 s21, 4300800
buffer_load_dword v7, v1, s[12:15], s21 offen
s_waitcnt vmcnt(58)
v_perm_b32 v66, v9, v8, s46
v_accvgpr_write_b32 a102, v66
v_perm_b32 v70, v9, v8, s47
v_accvgpr_write_b32 a110, v70
s_mov_b32 s20, 4456448
buffer_load_dword v8, v1, s[12:15], s20 offen
s_mov_b32 s21, 4489216
buffer_load_dword v9, v1, s[12:15], s21 offen
s_waitcnt vmcnt(58)
v_perm_b32 v67, v11, v10, s46
v_accvgpr_write_b32 a103, v67
v_perm_b32 v71, v11, v10, s47
v_accvgpr_write_b32 a111, v71
s_mov_b32 s20, 4521984
buffer_load_dword v10, v1, s[12:15], s20 offen
s_mov_b32 s21, 4554752
buffer_load_dword v11, v1, s[12:15], s21 offen
s_waitcnt vmcnt(58)
v_perm_b32 v64, v13, v12, s46
v_accvgpr_write_b32 a112, v64
v_perm_b32 v68, v13, v12, s47
v_accvgpr_write_b32 a120, v68
s_mov_b32 s20, 4464640
buffer_load_dword v12, v1, s[12:15], s20 offen
s_mov_b32 s21, 4497408
buffer_load_dword v13, v1, s[12:15], s21 offen
s_waitcnt vmcnt(58)
v_perm_b32 v65, v15, v14, s46
v_accvgpr_write_b32 a113, v65
v_perm_b32 v69, v15, v14, s47
v_accvgpr_write_b32 a121, v69
s_mov_b32 s20, 4530176
buffer_load_dword v14, v1, s[12:15], s20 offen
s_mov_b32 s21, 4562944
buffer_load_dword v15, v1, s[12:15], s21 offen
s_waitcnt vmcnt(58)
v_perm_b32 v66, v17, v16, s46
v_accvgpr_write_b32 a114, v66
v_perm_b32 v70, v17, v16, s47
v_accvgpr_write_b32 a122, v70
s_load_dwordx2 s[50:51], s[0:1], 88
s_waitcnt lgkmcnt(0)
s_mov_b32 s12, s50
s_and_b32 s13, s51, 0xffff
s_mov_b32 s14, 4718592
s_mov_b32 s15, 0x20000
v_and_b32 v1, 15, v0
s_lshl_b32 s20, s17, 4
v_add_u32 v1, s20, v1
v_lshlrev_b32 v1, 1, v1
v_add_u32 v2, v2, v1
v_add_u32 v1, v2, v1
s_mov_b32 s20, 0
buffer_load_dword v16, v1, s[12:15], s20 offen
s_mov_b32 s21, 1152
buffer_load_dword v17, v1, s[12:15], s21 offen
s_waitcnt vmcnt(58)
v_perm_b32 v67, v19, v18, s46
v_accvgpr_write_b32 a115, v67
v_perm_b32 v71, v19, v18, s47
v_accvgpr_write_b32 a123, v71
s_mov_b32 s20, 9216
buffer_load_dword v18, v1, s[12:15], s20 offen
s_mov_b32 s21, 10368
buffer_load_dword v19, v1, s[12:15], s21 offen
s_waitcnt vmcnt(58)
v_perm_b32 v64, v21, v20, s46
v_accvgpr_write_b32 a116, v64
v_perm_b32 v68, v21, v20, s47
v_accvgpr_write_b32 a124, v68
s_mov_b32 s20, 2304
buffer_load_dword v20, v1, s[12:15], s20 offen
s_mov_b32 s21, 3456
buffer_load_dword v21, v1, s[12:15], s21 offen
s_waitcnt vmcnt(58)
v_perm_b32 v65, v23, v22, s46
v_accvgpr_write_b32 a117, v65
v_perm_b32 v69, v23, v22, s47
v_accvgpr_write_b32 a125, v69
s_mov_b32 s20, 11520
buffer_load_dword v22, v1, s[12:15], s20 offen
s_mov_b32 s21, 12672
buffer_load_dword v23, v1, s[12:15], s21 offen
s_waitcnt vmcnt(58)
v_perm_b32 v66, v25, v24, s46
v_accvgpr_write_b32 a118, v66
v_perm_b32 v70, v25, v24, s47
v_accvgpr_write_b32 a126, v70
s_mov_b32 s20, 36864
buffer_load_dword v24, v1, s[12:15], s20 offen
s_mov_b32 s21, 38016
buffer_load_dword v25, v1, s[12:15], s21 offen
s_waitcnt vmcnt(58)
v_perm_b32 v67, v27, v26, s46
v_accvgpr_write_b32 a119, v67
v_perm_b32 v71, v27, v26, s47
v_accvgpr_write_b32 a127, v71
s_mov_b32 s20, 46080
buffer_load_dword v26, v1, s[12:15], s20 offen
s_mov_b32 s21, 47232
buffer_load_dword v27, v1, s[12:15], s21 offen
s_waitcnt vmcnt(58)
v_perm_b32 v64, v29, v28, s46
v_accvgpr_write_b32 a128, v64
v_perm_b32 v68, v29, v28, s47
v_accvgpr_write_b32 a136, v68
s_mov_b32 s20, 39168
buffer_load_dword v28, v1, s[12:15], s20 offen
s_mov_b32 s21, 40320
buffer_load_dword v29, v1, s[12:15], s21 offen
s_waitcnt vmcnt(58)
v_perm_b32 v65, v31, v30, s46
v_accvgpr_write_b32 a129, v65
v_perm_b32 v69, v31, v30, s47
v_accvgpr_write_b32 a137, v69
s_mov_b32 s20, 48384
buffer_load_dword v30, v1, s[12:15], s20 offen
s_mov_b32 s21, 49536
buffer_load_dword v31, v1, s[12:15], s21 offen
s_waitcnt vmcnt(58)
v_perm_b32 v66, v33, v32, s46
v_accvgpr_write_b32 a130, v66
v_perm_b32 v70, v33, v32, s47
v_accvgpr_write_b32 a138, v70
s_mov_b32 s20, 73728
buffer_load_dword v32, v1, s[12:15], s20 offen
s_mov_b32 s21, 74880
buffer_load_dword v33, v1, s[12:15], s21 offen
s_waitcnt vmcnt(58)
v_perm_b32 v67, v35, v34, s46
v_accvgpr_write_b32 a131, v67
v_perm_b32 v71, v35, v34, s47
v_accvgpr_write_b32 a139, v71
s_mov_b32 s20, 82944
buffer_load_dword v34, v1, s[12:15], s20 offen
s_mov_b32 s21, 84096
buffer_load_dword v35, v1, s[12:15], s21 offen
s_waitcnt vmcnt(58)
v_perm_b32 v64, v37, v36, s46
v_accvgpr_write_b32 a132, v64
v_perm_b32 v68, v37, v36, s47
v_accvgpr_write_b32 a140, v68
s_mov_b32 s20, 76032
buffer_load_dword v36, v1, s[12:15], s20 offen
s_mov_b32 s21, 77184
buffer_load_dword v37, v1, s[12:15], s21 offen
s_waitcnt vmcnt(58)
v_perm_b32 v65, v39, v38, s46
v_accvgpr_write_b32 a133, v65
v_perm_b32 v69, v39, v38, s47
v_accvgpr_write_b32 a141, v69
s_mov_b32 s20, 85248
buffer_load_dword v38, v1, s[12:15], s20 offen
s_mov_b32 s21, 86400
buffer_load_dword v39, v1, s[12:15], s21 offen
s_waitcnt vmcnt(58)
v_perm_b32 v66, v41, v40, s46
v_accvgpr_write_b32 a134, v66
v_perm_b32 v70, v41, v40, s47
v_accvgpr_write_b32 a142, v70
s_mov_b32 s20, 110592
buffer_load_dword v40, v1, s[12:15], s20 offen
s_mov_b32 s21, 111744
buffer_load_dword v41, v1, s[12:15], s21 offen
s_waitcnt vmcnt(58)
v_perm_b32 v67, v43, v42, s46
v_accvgpr_write_b32 a135, v67
v_perm_b32 v71, v43, v42, s47
v_accvgpr_write_b32 a143, v71
s_mov_b32 s20, 119808
buffer_load_dword v42, v1, s[12:15], s20 offen
s_mov_b32 s21, 120960
buffer_load_dword v43, v1, s[12:15], s21 offen
s_waitcnt vmcnt(58)
v_perm_b32 v64, v45, v44, s46
v_accvgpr_write_b32 a144, v64
v_perm_b32 v68, v45, v44, s47
v_accvgpr_write_b32 a152, v68
s_mov_b32 s20, 112896
buffer_load_dword v44, v1, s[12:15], s20 offen
s_mov_b32 s21, 114048
buffer_load_dword v45, v1, s[12:15], s21 offen
s_waitcnt vmcnt(58)
v_perm_b32 v65, v47, v46, s46
v_accvgpr_write_b32 a145, v65
v_perm_b32 v69, v47, v46, s47
v_accvgpr_write_b32 a153, v69
s_mov_b32 s20, 122112
buffer_load_dword v46, v1, s[12:15], s20 offen
s_mov_b32 s21, 123264
buffer_load_dword v47, v1, s[12:15], s21 offen
s_waitcnt vmcnt(58)
v_perm_b32 v66, v49, v48, s46
v_accvgpr_write_b32 a146, v66
v_perm_b32 v70, v49, v48, s47
v_accvgpr_write_b32 a154, v70
s_mov_b32 s20, 256
buffer_load_dword v48, v1, s[12:15], s20 offen
s_mov_b32 s21, 1408
buffer_load_dword v49, v1, s[12:15], s21 offen
s_waitcnt vmcnt(58)
v_perm_b32 v67, v51, v50, s46
v_accvgpr_write_b32 a147, v67
v_perm_b32 v71, v51, v50, s47
v_accvgpr_write_b32 a155, v71
s_mov_b32 s20, 9472
buffer_load_dword v50, v1, s[12:15], s20 offen
s_mov_b32 s21, 10624
buffer_load_dword v51, v1, s[12:15], s21 offen
s_waitcnt vmcnt(58)
v_perm_b32 v64, v53, v52, s46
v_accvgpr_write_b32 a148, v64
v_perm_b32 v68, v53, v52, s47
v_accvgpr_write_b32 a156, v68
s_mov_b32 s20, 2560
buffer_load_dword v52, v1, s[12:15], s20 offen
s_mov_b32 s21, 3712
buffer_load_dword v53, v1, s[12:15], s21 offen
s_waitcnt vmcnt(58)
v_perm_b32 v65, v55, v54, s46
v_accvgpr_write_b32 a149, v65
v_perm_b32 v69, v55, v54, s47
v_accvgpr_write_b32 a157, v69
s_mov_b32 s20, 11776
buffer_load_dword v54, v1, s[12:15], s20 offen
s_mov_b32 s21, 12928
buffer_load_dword v55, v1, s[12:15], s21 offen
s_waitcnt vmcnt(58)
v_perm_b32 v66, v57, v56, s46
v_accvgpr_write_b32 a150, v66
v_perm_b32 v70, v57, v56, s47
v_accvgpr_write_b32 a158, v70
s_mov_b32 s20, 37120
buffer_load_dword v56, v1, s[12:15], s20 offen
s_mov_b32 s21, 38272
buffer_load_dword v57, v1, s[12:15], s21 offen
s_waitcnt vmcnt(58)
v_perm_b32 v67, v59, v58, s46
v_accvgpr_write_b32 a151, v67
v_perm_b32 v71, v59, v58, s47
v_accvgpr_write_b32 a159, v71
s_mov_b32 s20, 46336
buffer_load_dword v58, v1, s[12:15], s20 offen
s_mov_b32 s21, 47488
buffer_load_dword v59, v1, s[12:15], s21 offen
s_waitcnt vmcnt(58)
v_perm_b32 v64, v61, v60, s46
v_accvgpr_write_b32 a160, v64
v_perm_b32 v68, v61, v60, s47
v_accvgpr_write_b32 a168, v68
s_mov_b32 s20, 39424
buffer_load_dword v60, v1, s[12:15], s20 offen
s_mov_b32 s21, 40576
buffer_load_dword v61, v1, s[12:15], s21 offen
s_waitcnt vmcnt(58)
v_perm_b32 v65, v63, v62, s46
v_accvgpr_write_b32 a161, v65
v_perm_b32 v69, v63, v62, s47
v_accvgpr_write_b32 a169, v69
s_mov_b32 s20, 48640
buffer_load_dword v62, v1, s[12:15], s20 offen
s_mov_b32 s21, 49792
buffer_load_dword v63, v1, s[12:15], s21 offen
s_waitcnt vmcnt(58)
v_perm_b32 v66, v5, v4, s46
v_accvgpr_write_b32 a162, v66
v_perm_b32 v70, v5, v4, s47
v_accvgpr_write_b32 a170, v70
s_mov_b32 s20, 73984
buffer_load_dword v4, v1, s[12:15], s20 offen
s_mov_b32 s21, 75136
buffer_load_dword v5, v1, s[12:15], s21 offen
s_waitcnt vmcnt(58)
v_perm_b32 v67, v7, v6, s46
v_accvgpr_write_b32 a163, v67
v_perm_b32 v71, v7, v6, s47
v_accvgpr_write_b32 a171, v71
s_mov_b32 s20, 83200
buffer_load_dword v6, v1, s[12:15], s20 offen
s_mov_b32 s21, 84352
buffer_load_dword v7, v1, s[12:15], s21 offen
s_waitcnt vmcnt(58)
v_perm_b32 v64, v9, v8, s46
v_accvgpr_write_b32 a164, v64
v_perm_b32 v68, v9, v8, s47
v_accvgpr_write_b32 a172, v68
s_mov_b32 s20, 76288
buffer_load_dword v8, v1, s[12:15], s20 offen
s_mov_b32 s21, 77440
buffer_load_dword v9, v1, s[12:15], s21 offen
s_waitcnt vmcnt(58)
v_perm_b32 v65, v11, v10, s46
v_accvgpr_write_b32 a165, v65
v_perm_b32 v69, v11, v10, s47
v_accvgpr_write_b32 a173, v69
s_mov_b32 s20, 85504
buffer_load_dword v10, v1, s[12:15], s20 offen
s_mov_b32 s21, 86656
buffer_load_dword v11, v1, s[12:15], s21 offen
s_waitcnt vmcnt(58)
v_perm_b32 v66, v13, v12, s46
v_accvgpr_write_b32 a166, v66
v_perm_b32 v70, v13, v12, s47
v_accvgpr_write_b32 a174, v70
s_mov_b32 s20, 110848
buffer_load_dword v12, v1, s[12:15], s20 offen
s_mov_b32 s21, 112000
buffer_load_dword v13, v1, s[12:15], s21 offen
s_waitcnt vmcnt(58)
v_perm_b32 v67, v15, v14, s46
v_accvgpr_write_b32 a167, v67
v_perm_b32 v71, v15, v14, s47
v_accvgpr_write_b32 a175, v71
s_mov_b32 s20, 120064
buffer_load_dword v14, v1, s[12:15], s20 offen
s_mov_b32 s21, 121216
buffer_load_dword v15, v1, s[12:15], s21 offen
s_waitcnt vmcnt(58)
v_perm_b32 v64, v17, v16, s46
v_accvgpr_write_b32 a176, v64
v_perm_b32 v68, v17, v16, s47
v_accvgpr_write_b32 a184, v68
s_mov_b32 s20, 113152
buffer_load_dword v16, v1, s[12:15], s20 offen
s_mov_b32 s21, 114304
buffer_load_dword v17, v1, s[12:15], s21 offen
s_waitcnt vmcnt(58)
v_perm_b32 v65, v19, v18, s46
v_accvgpr_write_b32 a177, v65
v_perm_b32 v69, v19, v18, s47
v_accvgpr_write_b32 a185, v69
s_mov_b32 s20, 122368
buffer_load_dword v18, v1, s[12:15], s20 offen
s_mov_b32 s21, 123520
buffer_load_dword v19, v1, s[12:15], s21 offen
s_waitcnt vmcnt(58)
v_perm_b32 v66, v21, v20, s46
v_accvgpr_write_b32 a178, v66
v_perm_b32 v70, v21, v20, s47
v_accvgpr_write_b32 a186, v70
s_mov_b32 s20, 512
buffer_load_dword v20, v1, s[12:15], s20 offen
s_mov_b32 s21, 1664
buffer_load_dword v21, v1, s[12:15], s21 offen
s_waitcnt vmcnt(58)
v_perm_b32 v67, v23, v22, s46
v_accvgpr_write_b32 a179, v67
v_perm_b32 v71, v23, v22, s47
v_accvgpr_write_b32 a187, v71
s_mov_b32 s20, 9728
buffer_load_dword v22, v1, s[12:15], s20 offen
s_mov_b32 s21, 10880
buffer_load_dword v23, v1, s[12:15], s21 offen
s_waitcnt vmcnt(58)
v_perm_b32 v64, v25, v24, s46
v_accvgpr_write_b32 a180, v64
v_perm_b32 v68, v25, v24, s47
v_accvgpr_write_b32 a188, v68
s_mov_b32 s20, 2816
buffer_load_dword v24, v1, s[12:15], s20 offen
s_mov_b32 s21, 3968
buffer_load_dword v25, v1, s[12:15], s21 offen
s_waitcnt vmcnt(58)
v_perm_b32 v65, v27, v26, s46
v_accvgpr_write_b32 a181, v65
v_perm_b32 v69, v27, v26, s47
v_accvgpr_write_b32 a189, v69
s_mov_b32 s20, 12032
buffer_load_dword v26, v1, s[12:15], s20 offen
s_mov_b32 s21, 13184
buffer_load_dword v27, v1, s[12:15], s21 offen
s_waitcnt vmcnt(58)
v_perm_b32 v66, v29, v28, s46
v_accvgpr_write_b32 a182, v66
v_perm_b32 v70, v29, v28, s47
v_accvgpr_write_b32 a190, v70
s_mov_b32 s20, 37376
buffer_load_dword v28, v1, s[12:15], s20 offen
s_mov_b32 s21, 38528
buffer_load_dword v29, v1, s[12:15], s21 offen
s_waitcnt vmcnt(58)
v_perm_b32 v67, v31, v30, s46
v_accvgpr_write_b32 a183, v67
v_perm_b32 v71, v31, v30, s47
v_accvgpr_write_b32 a191, v71
s_mov_b32 s20, 46592
buffer_load_dword v30, v1, s[12:15], s20 offen
s_mov_b32 s21, 47744
buffer_load_dword v31, v1, s[12:15], s21 offen
s_waitcnt vmcnt(58)
v_perm_b32 v64, v33, v32, s46
v_perm_b32 v68, v33, v32, s47
s_mov_b32 s20, 39680
buffer_load_dword v32, v1, s[12:15], s20 offen
s_mov_b32 s21, 40832
buffer_load_dword v33, v1, s[12:15], s21 offen
s_waitcnt vmcnt(58)
v_perm_b32 v65, v35, v34, s46
v_perm_b32 v69, v35, v34, s47
s_mov_b32 s20, 48896
buffer_load_dword v34, v1, s[12:15], s20 offen
s_mov_b32 s21, 50048
buffer_load_dword v35, v1, s[12:15], s21 offen
s_waitcnt vmcnt(58)
v_perm_b32 v66, v37, v36, s46
v_perm_b32 v70, v37, v36, s47
s_mov_b32 s20, 74240
buffer_load_dword v36, v1, s[12:15], s20 offen
s_mov_b32 s21, 75392
buffer_load_dword v37, v1, s[12:15], s21 offen
s_waitcnt vmcnt(58)
v_perm_b32 v67, v39, v38, s46
ds_write_b128 v3, v[64:67] offset:20480
s_waitcnt lgkmcnt(0)
v_perm_b32 v71, v39, v38, s47
ds_write_b128 v3, v[68:71] offset:22528
s_waitcnt lgkmcnt(0)
s_mov_b32 s20, 83456
buffer_load_dword v38, v1, s[12:15], s20 offen
s_mov_b32 s21, 84608
buffer_load_dword v39, v1, s[12:15], s21 offen
s_waitcnt vmcnt(58)
v_perm_b32 v64, v41, v40, s46
v_perm_b32 v68, v41, v40, s47
s_mov_b32 s20, 76544
buffer_load_dword v40, v1, s[12:15], s20 offen
s_mov_b32 s21, 77696
buffer_load_dword v41, v1, s[12:15], s21 offen
s_waitcnt vmcnt(58)
v_perm_b32 v65, v43, v42, s46
v_perm_b32 v69, v43, v42, s47
s_mov_b32 s20, 85760
buffer_load_dword v42, v1, s[12:15], s20 offen
s_mov_b32 s21, 86912
buffer_load_dword v43, v1, s[12:15], s21 offen
s_waitcnt vmcnt(58)
v_perm_b32 v66, v45, v44, s46
v_perm_b32 v70, v45, v44, s47
s_mov_b32 s20, 111104
buffer_load_dword v44, v1, s[12:15], s20 offen
s_mov_b32 s21, 112256
buffer_load_dword v45, v1, s[12:15], s21 offen
s_waitcnt vmcnt(58)
v_perm_b32 v67, v47, v46, s46
ds_write_b128 v3, v[64:67] offset:21504
s_waitcnt lgkmcnt(0)
v_perm_b32 v71, v47, v46, s47
ds_write_b128 v3, v[68:71] offset:23552
s_waitcnt lgkmcnt(0)
s_mov_b32 s20, 120320
buffer_load_dword v46, v1, s[12:15], s20 offen
s_mov_b32 s21, 121472
buffer_load_dword v47, v1, s[12:15], s21 offen
s_waitcnt vmcnt(58)
v_perm_b32 v64, v49, v48, s46
v_accvgpr_write_b32 a192, v64
v_perm_b32 v68, v49, v48, s47
v_accvgpr_write_b32 a200, v68
s_mov_b32 s20, 113408
buffer_load_dword v48, v1, s[12:15], s20 offen
s_mov_b32 s21, 114560
buffer_load_dword v49, v1, s[12:15], s21 offen
s_waitcnt vmcnt(58)
v_perm_b32 v65, v51, v50, s46
v_accvgpr_write_b32 a193, v65
v_perm_b32 v69, v51, v50, s47
v_accvgpr_write_b32 a201, v69
s_mov_b32 s20, 122624
buffer_load_dword v50, v1, s[12:15], s20 offen
s_mov_b32 s21, 123776
buffer_load_dword v51, v1, s[12:15], s21 offen
s_waitcnt vmcnt(58)
v_perm_b32 v66, v53, v52, s46
v_accvgpr_write_b32 a194, v66
v_perm_b32 v70, v53, v52, s47
v_accvgpr_write_b32 a202, v70
s_mov_b32 s20, 768
buffer_load_dword v52, v1, s[12:15], s20 offen
s_mov_b32 s21, 1920
buffer_load_dword v53, v1, s[12:15], s21 offen
s_waitcnt vmcnt(58)
v_perm_b32 v67, v55, v54, s46
v_accvgpr_write_b32 a195, v67
v_perm_b32 v71, v55, v54, s47
v_accvgpr_write_b32 a203, v71
s_mov_b32 s20, 9984
buffer_load_dword v54, v1, s[12:15], s20 offen
s_mov_b32 s21, 11136
buffer_load_dword v55, v1, s[12:15], s21 offen
s_waitcnt vmcnt(58)
v_perm_b32 v64, v57, v56, s46
v_accvgpr_write_b32 a196, v64
v_perm_b32 v68, v57, v56, s47
v_accvgpr_write_b32 a204, v68
s_mov_b32 s20, 3072
buffer_load_dword v56, v1, s[12:15], s20 offen
s_mov_b32 s21, 4224
buffer_load_dword v57, v1, s[12:15], s21 offen
s_waitcnt vmcnt(58)
v_perm_b32 v65, v59, v58, s46
v_accvgpr_write_b32 a197, v65
v_perm_b32 v69, v59, v58, s47
v_accvgpr_write_b32 a205, v69
s_mov_b32 s20, 12288
buffer_load_dword v58, v1, s[12:15], s20 offen
s_mov_b32 s21, 13440
buffer_load_dword v59, v1, s[12:15], s21 offen
s_waitcnt vmcnt(58)
v_perm_b32 v66, v61, v60, s46
v_accvgpr_write_b32 a198, v66
v_perm_b32 v70, v61, v60, s47
v_accvgpr_write_b32 a206, v70
s_mov_b32 s20, 37632
buffer_load_dword v60, v1, s[12:15], s20 offen
s_mov_b32 s21, 38784
buffer_load_dword v61, v1, s[12:15], s21 offen
s_waitcnt vmcnt(58)
v_perm_b32 v67, v63, v62, s46
v_accvgpr_write_b32 a199, v67
v_perm_b32 v71, v63, v62, s47
v_accvgpr_write_b32 a207, v71
s_mov_b32 s20, 46848
buffer_load_dword v62, v1, s[12:15], s20 offen
s_mov_b32 s21, 48000
buffer_load_dword v63, v1, s[12:15], s21 offen
s_waitcnt vmcnt(58)
v_perm_b32 v64, v5, v4, s46
v_perm_b32 v68, v5, v4, s47
s_mov_b32 s20, 39936
buffer_load_dword v4, v1, s[12:15], s20 offen
s_mov_b32 s21, 41088
buffer_load_dword v5, v1, s[12:15], s21 offen
s_waitcnt vmcnt(58)
v_perm_b32 v65, v7, v6, s46
v_perm_b32 v69, v7, v6, s47
s_mov_b32 s20, 49152
buffer_load_dword v6, v1, s[12:15], s20 offen
s_mov_b32 s21, 50304
buffer_load_dword v7, v1, s[12:15], s21 offen
s_waitcnt vmcnt(58)
v_perm_b32 v66, v9, v8, s46
v_perm_b32 v70, v9, v8, s47
s_mov_b32 s20, 74496
buffer_load_dword v8, v1, s[12:15], s20 offen
s_mov_b32 s21, 75648
buffer_load_dword v9, v1, s[12:15], s21 offen
s_waitcnt vmcnt(58)
v_perm_b32 v67, v11, v10, s46
ds_write_b128 v3, v[64:67] offset:24576
s_waitcnt lgkmcnt(0)
v_perm_b32 v71, v11, v10, s47
ds_write_b128 v3, v[68:71] offset:26624
s_waitcnt lgkmcnt(0)
s_mov_b32 s20, 83712
buffer_load_dword v10, v1, s[12:15], s20 offen
s_mov_b32 s21, 84864
buffer_load_dword v11, v1, s[12:15], s21 offen
s_waitcnt vmcnt(58)
v_perm_b32 v64, v13, v12, s46
v_perm_b32 v68, v13, v12, s47
s_mov_b32 s20, 76800
buffer_load_dword v12, v1, s[12:15], s20 offen
s_mov_b32 s21, 77952
buffer_load_dword v13, v1, s[12:15], s21 offen
s_waitcnt vmcnt(58)
v_perm_b32 v65, v15, v14, s46
v_perm_b32 v69, v15, v14, s47
s_mov_b32 s20, 86016
buffer_load_dword v14, v1, s[12:15], s20 offen
s_mov_b32 s21, 87168
buffer_load_dword v15, v1, s[12:15], s21 offen
s_waitcnt vmcnt(58)
v_perm_b32 v66, v17, v16, s46
v_perm_b32 v70, v17, v16, s47
s_mov_b32 s20, 111360
buffer_load_dword v16, v1, s[12:15], s20 offen
s_mov_b32 s21, 112512
buffer_load_dword v17, v1, s[12:15], s21 offen
s_waitcnt vmcnt(58)
v_perm_b32 v67, v19, v18, s46
ds_write_b128 v3, v[64:67] offset:25600
s_waitcnt lgkmcnt(0)
v_perm_b32 v71, v19, v18, s47
ds_write_b128 v3, v[68:71] offset:27648
s_waitcnt lgkmcnt(0)
s_mov_b32 s20, 120576
buffer_load_dword v18, v1, s[12:15], s20 offen
s_mov_b32 s21, 121728
buffer_load_dword v19, v1, s[12:15], s21 offen
s_waitcnt vmcnt(58)
v_perm_b32 v64, v21, v20, s46
v_accvgpr_write_b32 a208, v64
v_perm_b32 v68, v21, v20, s47
v_accvgpr_write_b32 a216, v68
s_mov_b32 s20, 113664
buffer_load_dword v20, v1, s[12:15], s20 offen
s_mov_b32 s21, 114816
buffer_load_dword v21, v1, s[12:15], s21 offen
s_waitcnt vmcnt(58)
v_perm_b32 v65, v23, v22, s46
v_accvgpr_write_b32 a209, v65
v_perm_b32 v69, v23, v22, s47
v_accvgpr_write_b32 a217, v69
s_mov_b32 s20, 122880
buffer_load_dword v22, v1, s[12:15], s20 offen
s_mov_b32 s21, 124032
buffer_load_dword v23, v1, s[12:15], s21 offen
s_waitcnt vmcnt(58)
v_perm_b32 v66, v25, v24, s46
v_accvgpr_write_b32 a210, v66
v_perm_b32 v70, v25, v24, s47
v_accvgpr_write_b32 a218, v70
s_mov_b32 s20, 1024
buffer_load_ushort v24, v2, s[12:15], s20 offen
s_mov_b32 s21, 2176
buffer_load_ushort v25, v2, s[12:15], s21 offen
s_waitcnt vmcnt(58)
v_perm_b32 v67, v27, v26, s46
v_accvgpr_write_b32 a211, v67
v_perm_b32 v71, v27, v26, s47
v_accvgpr_write_b32 a219, v71
s_mov_b32 s20, 10240
buffer_load_ushort v26, v2, s[12:15], s20 offen
s_mov_b32 s21, 11392
buffer_load_ushort v27, v2, s[12:15], s21 offen
s_waitcnt vmcnt(58)
v_perm_b32 v64, v29, v28, s46
v_accvgpr_write_b32 a212, v64
v_perm_b32 v68, v29, v28, s47
v_accvgpr_write_b32 a220, v68
s_mov_b32 s20, 3328
buffer_load_ushort v28, v2, s[12:15], s20 offen
s_mov_b32 s21, 4480
buffer_load_ushort v29, v2, s[12:15], s21 offen
s_waitcnt vmcnt(58)
v_perm_b32 v65, v31, v30, s46
v_accvgpr_write_b32 a213, v65
v_perm_b32 v69, v31, v30, s47
v_accvgpr_write_b32 a221, v69
s_mov_b32 s20, 12544
buffer_load_ushort v30, v2, s[12:15], s20 offen
s_mov_b32 s21, 13696
buffer_load_ushort v31, v2, s[12:15], s21 offen
s_waitcnt vmcnt(58)
v_perm_b32 v66, v33, v32, s46
v_accvgpr_write_b32 a214, v66
v_perm_b32 v70, v33, v32, s47
v_accvgpr_write_b32 a222, v70
s_mov_b32 s20, 37888
buffer_load_ushort v32, v2, s[12:15], s20 offen
s_mov_b32 s21, 39040
buffer_load_ushort v33, v2, s[12:15], s21 offen
s_waitcnt vmcnt(58)
v_perm_b32 v67, v35, v34, s46
v_accvgpr_write_b32 a215, v67
v_perm_b32 v71, v35, v34, s47
v_accvgpr_write_b32 a223, v71
s_mov_b32 s20, 47104
buffer_load_ushort v34, v2, s[12:15], s20 offen
s_mov_b32 s21, 48256
buffer_load_ushort v35, v2, s[12:15], s21 offen
s_waitcnt vmcnt(58)
v_perm_b32 v64, v37, v36, s46
v_perm_b32 v68, v37, v36, s47
s_mov_b32 s20, 40192
buffer_load_ushort v36, v2, s[12:15], s20 offen
s_mov_b32 s21, 41344
buffer_load_ushort v37, v2, s[12:15], s21 offen
s_waitcnt vmcnt(58)
v_perm_b32 v65, v39, v38, s46
v_perm_b32 v69, v39, v38, s47
s_mov_b32 s20, 49408
buffer_load_ushort v38, v2, s[12:15], s20 offen
s_mov_b32 s21, 50560
buffer_load_ushort v39, v2, s[12:15], s21 offen
s_waitcnt vmcnt(58)
v_perm_b32 v66, v41, v40, s46
v_perm_b32 v70, v41, v40, s47
s_mov_b32 s20, 74752
buffer_load_ushort v40, v2, s[12:15], s20 offen
s_mov_b32 s21, 75904
buffer_load_ushort v41, v2, s[12:15], s21 offen
s_waitcnt vmcnt(58)
v_perm_b32 v67, v43, v42, s46
ds_write_b128 v3, v[64:67] offset:28672
s_waitcnt lgkmcnt(0)
v_perm_b32 v71, v43, v42, s47
ds_write_b128 v3, v[68:71] offset:30720
s_waitcnt lgkmcnt(0)
s_mov_b32 s20, 83968
buffer_load_ushort v42, v2, s[12:15], s20 offen
s_mov_b32 s21, 85120
buffer_load_ushort v43, v2, s[12:15], s21 offen
s_waitcnt vmcnt(58)
v_perm_b32 v64, v45, v44, s46
v_perm_b32 v68, v45, v44, s47
s_mov_b32 s20, 77056
buffer_load_ushort v44, v2, s[12:15], s20 offen
s_mov_b32 s21, 78208
buffer_load_ushort v45, v2, s[12:15], s21 offen
s_waitcnt vmcnt(58)
v_perm_b32 v65, v47, v46, s46
v_perm_b32 v69, v47, v46, s47
s_mov_b32 s20, 86272
buffer_load_ushort v46, v2, s[12:15], s20 offen
s_mov_b32 s21, 87424
buffer_load_ushort v47, v2, s[12:15], s21 offen
s_waitcnt vmcnt(58)
v_perm_b32 v66, v49, v48, s46
v_perm_b32 v70, v49, v48, s47
s_mov_b32 s20, 111616
buffer_load_ushort v48, v2, s[12:15], s20 offen
s_mov_b32 s21, 112768
buffer_load_ushort v49, v2, s[12:15], s21 offen
s_waitcnt vmcnt(58)
v_perm_b32 v67, v51, v50, s46
ds_write_b128 v3, v[64:67] offset:29696
s_waitcnt lgkmcnt(0)
v_perm_b32 v71, v51, v50, s47
ds_write_b128 v3, v[68:71] offset:31744
s_waitcnt lgkmcnt(0)
s_mov_b32 s20, 120832
buffer_load_ushort v50, v2, s[12:15], s20 offen
s_mov_b32 s21, 121984
buffer_load_ushort v51, v2, s[12:15], s21 offen
s_waitcnt vmcnt(58)
v_perm_b32 v64, v53, v52, s46
v_accvgpr_write_b32 a224, v64
v_perm_b32 v68, v53, v52, s47
v_accvgpr_write_b32 a232, v68
s_mov_b32 s20, 113920
buffer_load_ushort v52, v2, s[12:15], s20 offen
s_mov_b32 s21, 115072
buffer_load_ushort v53, v2, s[12:15], s21 offen
s_waitcnt vmcnt(58)
v_perm_b32 v65, v55, v54, s46
v_accvgpr_write_b32 a225, v65
v_perm_b32 v69, v55, v54, s47
v_accvgpr_write_b32 a233, v69
s_mov_b32 s20, 123136
buffer_load_ushort v54, v2, s[12:15], s20 offen
s_mov_b32 s21, 124288
buffer_load_ushort v55, v2, s[12:15], s21 offen
s_waitcnt vmcnt(58)
v_perm_b32 v66, v57, v56, s46
v_accvgpr_write_b32 a226, v66
v_perm_b32 v70, v57, v56, s47
v_accvgpr_write_b32 a234, v70
s_waitcnt vmcnt(56)
v_perm_b32 v67, v59, v58, s46
v_accvgpr_write_b32 a227, v67
v_perm_b32 v71, v59, v58, s47
v_accvgpr_write_b32 a235, v71
s_waitcnt vmcnt(54)
v_perm_b32 v64, v61, v60, s46
v_accvgpr_write_b32 a228, v64
v_perm_b32 v68, v61, v60, s47
v_accvgpr_write_b32 a236, v68
s_waitcnt vmcnt(52)
v_perm_b32 v65, v63, v62, s46
v_accvgpr_write_b32 a229, v65
v_perm_b32 v69, v63, v62, s47
v_accvgpr_write_b32 a237, v69
s_waitcnt vmcnt(50)
v_perm_b32 v66, v5, v4, s46
v_accvgpr_write_b32 a230, v66
v_perm_b32 v70, v5, v4, s47
v_accvgpr_write_b32 a238, v70
s_waitcnt vmcnt(48)
v_perm_b32 v67, v7, v6, s46
v_accvgpr_write_b32 a231, v67
v_perm_b32 v71, v7, v6, s47
v_accvgpr_write_b32 a239, v71
s_waitcnt vmcnt(46)
v_perm_b32 v64, v9, v8, s46
v_perm_b32 v68, v9, v8, s47
v_accvgpr_write_b32 a240, v68
s_waitcnt vmcnt(44)
v_perm_b32 v65, v11, v10, s46
v_perm_b32 v69, v11, v10, s47
v_accvgpr_write_b32 a241, v69
s_waitcnt vmcnt(42)
v_perm_b32 v66, v13, v12, s46
v_perm_b32 v70, v13, v12, s47
v_accvgpr_write_b32 a242, v70
s_waitcnt vmcnt(40)
v_perm_b32 v67, v15, v14, s46
ds_write_b128 v3, v[64:67] offset:32768
s_waitcnt lgkmcnt(0)
v_perm_b32 v71, v15, v14, s47
v_accvgpr_write_b32 a243, v71
s_waitcnt vmcnt(38)
v_perm_b32 v64, v17, v16, s46
v_perm_b32 v68, v17, v16, s47
v_accvgpr_write_b32 a244, v68
s_waitcnt vmcnt(36)
v_perm_b32 v65, v19, v18, s46
v_perm_b32 v69, v19, v18, s47
v_accvgpr_write_b32 a245, v69
s_waitcnt vmcnt(34)
v_perm_b32 v66, v21, v20, s46
v_perm_b32 v70, v21, v20, s47
v_accvgpr_write_b32 a246, v70
s_waitcnt vmcnt(32)
v_perm_b32 v67, v23, v22, s46
ds_write_b128 v3, v[64:67] offset:33792
s_waitcnt lgkmcnt(0)
v_perm_b32 v71, v23, v22, s47
v_accvgpr_write_b32 a247, v71
s_waitcnt vmcnt(30)
v_perm_b32 v64, v25, v24, s46
v_accvgpr_write_b32 a248, v64
s_waitcnt vmcnt(28)
v_perm_b32 v65, v27, v26, s46
v_accvgpr_write_b32 a249, v65
s_waitcnt vmcnt(26)
v_perm_b32 v66, v29, v28, s46
v_accvgpr_write_b32 a250, v66
s_waitcnt vmcnt(24)
v_perm_b32 v67, v31, v30, s46
v_accvgpr_write_b32 a251, v67
s_waitcnt vmcnt(22)
v_perm_b32 v64, v33, v32, s46
v_accvgpr_write_b32 a252, v64
s_waitcnt vmcnt(20)
v_perm_b32 v65, v35, v34, s46
v_accvgpr_write_b32 a253, v65
s_waitcnt vmcnt(18)
v_perm_b32 v66, v37, v36, s46
v_accvgpr_write_b32 a254, v66
s_waitcnt vmcnt(16)
v_perm_b32 v67, v39, v38, s46
v_accvgpr_write_b32 a255, v67
s_waitcnt vmcnt(14)
v_perm_b32 v64, v41, v40, s46
s_waitcnt vmcnt(12)
v_perm_b32 v65, v43, v42, s46
s_waitcnt vmcnt(10)
v_perm_b32 v66, v45, v44, s46
s_waitcnt vmcnt(8)
v_perm_b32 v67, v47, v46, s46
ds_write_b128 v3, v[64:67] offset:18432
s_waitcnt lgkmcnt(0)
s_waitcnt vmcnt(6)
v_perm_b32 v64, v49, v48, s46
s_waitcnt vmcnt(4)
v_perm_b32 v65, v51, v50, s46
s_waitcnt vmcnt(2)
v_perm_b32 v66, v53, v52, s46
s_waitcnt vmcnt(0)
v_perm_b32 v67, v55, v54, s46
ds_write_b128 v3, v[64:67] offset:19456
s_waitcnt lgkmcnt(0)
v_mov_b32 v20, 64
s_mov_b32 s28, 0
L_poll_43:
buffer_load_dword v21, v20, s[56:59], 0 offen sc1
s_add_u32 s28, s28, 1
s_cmp_gt_u32 s28, 40000
s_cbranch_scc1 L_end
s_waitcnt vmcnt(0)
v_cmp_ne_u32 vcc, 32, v21
s_cbranch_vccz L_pd_44
s_sleep 1
s_branch L_poll_43
L_pd_44:
v_mov_b32 v20, 128
s_mov_b32 s28, 0
L_poll_45:
buffer_load_dword v21, v20, s[56:59], 0 offen sc1
s_add_u32 s28, s28, 1
s_cmp_gt_u32 s28, 40000
s_cbranch_scc1 L_end
s_waitcnt vmcnt(0)
v_cmp_ne_u32 vcc, 8, v21
s_cbranch_vccz L_pd_46
s_sleep 1
s_branch L_poll_45
L_pd_46:
v_mov_b32 v20, 0
s_lshl_b32 s25, s16, 7
s_add_u32 s25, s25, 111149056
s_mov_b32 s28, 0
L_poll_47:
buffer_load_dword v21, v20, s[8:11], s25 offen sc1
s_add_u32 s28, s28, 1
s_cmp_gt_u32 s28, 40000
s_cbranch_scc1 L_end
s_waitcnt vmcnt(0)
v_cmp_ne_u32 vcc, 1, v21
s_cbranch_vccz L_pd_48
s_sleep 1
s_branch L_poll_47
L_pd_48:
v_mov_b32 v12, v0
v_and_b32 v13, 15, v0
v_bfe_u32 v14, v0, 4, 2
v_lshlrev_b32 v1, 4, v12
v_and_b32 v2, 0x3f0, v1
s_mul_i32 s20, s17, 34816
s_add_u32 s20, s20, 24576
v_add_u32 v2, s20, v2
v_and_b32 v15, 1, v12
v_mul_u32_u24 v0, 0xaaaa, v15
v_add_u32 v0, 0xffff4444, v0
v_lshrrev_b32 v18, 2, v13
v_lshl_add_u32 v18, v18, 1, v15
v_bfe_u32 v19, v13, 1, 1
v_lshrrev_b32 v16, 5, v12
v_lshlrev_b32 v16, 8, v16
v_lshl_add_u32 v16, v18, 5, v16
v_and_b32 v17, 1, v14
v_lshl_add_u32 v16, v17, 4, v16
v_and_b32 v17, 0x7f, v16
v_xor_b32 v17, 16, v17
v_add_u32 v16, 4224, v16
v_add_u32 v17, 6272, v17
v_cmp_eq_u32 vcc, 1, v19
s_nop 1
v_cndmask_b32 v7, v17, v16, vcc
v_and_b32 v16, 1, v14
v_xor_b32 v16, v18, v16
v_and_b32 v17, 2, v14
v_lshlrev_b32 v17, 1, v17
v_xor_b32 v16, v16, v17
v_lshlrev_b32 v16, 4, v16
v_lshl_add_u32 v16, v14, 7, v16
v_mul_u32_u24 v17, 2176, v19
v_add_u32 v16, v16, v17
v_add_u32 v5, 0, v16
v_bfe_u32 v20, v13, 3, 1
v_bfe_u32 v21, v13, 1, 1
v_lshlrev_b32 v16, 1, v14
v_xor_b32 v16, v16, v21
v_lshlrev_b32 v17, 2, v20
v_xor_b32 v16, v16, v17
v_lshlrev_b32 v16, 4, v16
v_lshl_add_u32 v16, v20, 8, v16
v_lshl_add_u32 v16, v21, 7, v16
v_bfe_u32 v17, v13, 2, 1
v_lshl_add_u32 v16, v17, 3, v16
v_lshl_add_u32 v16, v15, 2, v16
s_lshl_b32 s20, s17, 9
s_add_u32 s20, s20, 0
v_add_u32 v4, s20, v16
v_xor_b32 v3, 16, v4
v_lshrrev_b32 v16, 4, v12
v_xor_b32 v17, s16, v16
v_lshlrev_b32 v16, 12, v16
v_lshl_add_u32 v16, v17, 7, v16
v_lshl_add_u32 v9, v13, 3, v16
s_lshr_b32 s20, s17, 1
s_lshl_b32 s20, s20, 2
v_add_u32 v16, s20, v14
v_xor_b32 v17, s16, v16
v_lshlrev_b32 v16, 12, v16
v_lshl_add_u32 v16, v17, 7, v16
v_lshl_add_u32 v16, v13, 2, v16
s_and_b32 s20, s17, 1
s_lshl_b32 s20, s20, 6
s_add_u32 s20, s20, 262144
v_add_u32 v10, s20, v16
v_bfe_u32 v16, v13, 2, 1
v_lshlrev_b32 v16, 5, v16
v_and_b32 v17, 1, v14
v_lshl_add_u32 v16, v17, 8, v16
v_lshrrev_b32 v17, 1, v14
v_lshl_add_u32 v16, v17, 4, v16
v_and_b32 v17, 3, v13
v_lshl_add_u32 v11, v17, 2, v16
v_lshlrev_b32 v6, 7, v12
v_lshlrev_b32 v8, 2, v12
s_mov_b32 s36, 0x11111111
s_mov_b32 s37, 0x11111111
s_mov_b32 s38, 0x22222222
s_mov_b32 s39, 0x22222222
s_mov_b32 s40, 0x44444444
s_mov_b32 s41, 0x44444444
s_mov_b32 s42, 0x88888888
s_mov_b32 s43, 0x88888888
s_mov_b32 s44, 0xf0f0f0f0
s_mov_b32 s45, 0xf0f0f0f0
s_mov_b32 s18, 0x3e0293ee
s_lshl_b32 s20, s17, 5
s_add_u32 s20, s20, s16
s_cmp_lt_u32 s20, 72
s_cselect_b32 s48, 1, 0
s_lshl_b32 s23, s20, 12
s_lshl_b32 s21, s17, 10
s_sub_u32 s23, s23, s21
s_lshr_b32 s24, s20, 2
s_lshl_b32 s24, s24, 9
s_and_b32 s21, s20, 3
s_lshl_b32 s21, s21, 6
s_add_u32 s24, s24, s21
s_add_u32 s24, s24, 110100480
s_cmp_lt_u32 s20, 72
s_cselect_b32 s24, s24, 536870912
s_lshl_b32 s25, s16, 12
s_add_u32 s26, s25, 131072
s_add_u32 s27, s25, 262144
s_cmp_lt_u32 s16, 8
s_cselect_b32 s27, s27, 536870912
s_mov_b32 s28, 109051904
s_mov_b32 s29, 109346816
s_lshl_b32 s30, s16, 20
s_add_u32 s30, s30, 33554432
s_lshl_b32 s31, s16, 12
s_add_u32 s31, s31, 100663296
s_add_u32 s35, s24, 32768
s_mov_b32 s53, 0x3f803f80
s_mov_b32 s86, 0x33333333
s_mov_b32 s87, 0x33333333
s_lshl_b32 s84, s17, 13
s_sub_u32 s84, s20, s84
s_add_u32 s84, s84, 110886912
s_cmp_lt_u32 s20, 72
s_cselect_b32 s84, s84, 536870912
s_and_b32 s21, s16, 3
s_lshl_b32 s21, s21, 7
s_add_u32 s21, s21, 110886144
s_cmp_eq_u32 s17, 3
s_cselect_b32 s84, s21, s84
s_lshl_b32 s82, s16, 7
s_add_u32 s83, s82, 111152384
s_add_u32 s82, s82, 111148288
s_mov_b32 s19, 0
s_load_dwordx2 s[50:51], s[0:1], 56
s_waitcnt lgkmcnt(0)
s_mov_b32 s12, s50
s_and_b32 s13, s51, 0xffff
s_mov_b32 s14, 9216
s_mov_b32 s15, 0x20000
v_bfe_u32 v64, v1, 5, 3
v_mul_u32_u24 v64, 1152, v64
v_lshrrev_b32 v65, 8, v1
v_lshl_add_u32 v64, v65, 5, v64
v_and_b32 v65, 16, v1
v_add_u32 v64, v64, v65
buffer_load_dwordx4 v[24:27], v64, s[12:15], 0 offen offset:0
buffer_load_dwordx4 v[28:31], v64, s[12:15], 0 offen offset:512
buffer_load_dwordx4 v[32:35], v64, s[12:15], 0 offen offset:1024
s_waitcnt vmcnt(0)
v_perm_b32 v12, v26, v24, s46
v_perm_b32 v13, v26, v24, s47
v_perm_b32 v14, v27, v25, s46
v_perm_b32 v15, v27, v25, s47
v_min_u32 v12, 0xfffeffff, v12
v_min_u32 v13, 0xfffeffff, v13
v_min_u32 v14, 0xfffeffff, v14
v_min_u32 v15, 0xfffeffff, v15
v_perm_b32 v16, v30, v28, s46
v_perm_b32 v17, v30, v28, s47
v_perm_b32 v18, v31, v29, s46
v_perm_b32 v19, v31, v29, s47
v_min_u32 v16, 0xfffeffff, v16
v_min_u32 v17, 0xfffeffff, v17
v_min_u32 v18, 0xfffeffff, v18
v_min_u32 v19, 0xfffeffff, v19
v_perm_b32 v20, v34, v32, s46
v_perm_b32 v21, v34, v32, s47
v_perm_b32 v22, v35, v33, s46
v_perm_b32 v23, v35, v33, s47
v_min_u32 v20, 0xfffeffff, v20
v_min_u32 v21, 0xfffeffff, v21
v_min_u32 v22, 0xfffeffff, v22
v_min_u32 v23, 0xfffeffff, v23
s_cmp_lg_u32 s17, 0
s_cbranch_scc1 L_m0_49
ds_write_b128 v1, v[20:23] offset:14848
v_mov_b32 v64, 6528
v_mov_b32 v56, 0
v_mov_b32 v57, 0
v_mov_b32 v58, 0
v_mov_b32 v59, 0
ds_write_b128 v64, v[56:59]
L_m0_49:
s_waitcnt lgkmcnt(0)
s_barrier
ds_read_b32 v20, v8 offset:14848
s_waitcnt lgkmcnt(0)
s_mov_b32 s33, 110100480
s_mov_b32 s6, 110100480
s_mov_b32 s7, 110100480
s_mov_b32 s22, 0
s_cmp_eq_u32 s17, 0
s_cbranch_scc1 L_ent0
s_cmp_eq_u32 s17, 1
s_cbranch_scc1 L_ent1
s_cmp_eq_u32 s17, 2
s_cbranch_scc1 L_ent2
s_cmp_eq_u32 s17, 3
s_cbranch_scc1 L_ent3
s_branch L_end
L_ent0:
v_mov_b64 v[24:25], 0
v_mov_b64 v[26:27], 0
v_mov_b64 v[28:29], 0
v_mov_b64 v[30:31], 0
v_and_b32 v69, 0x380, v1
v_add_u32 v69, v69, v1
v_and_b32 v70, 0xf00, v1
v_add_u32 v70, v70, v1
v_mov_b64 v[64:65], -1
v_mov_b64 v[66:67], -1
v_xor_b32 v3, 16, v4
ds_read_b128 v[48:51], v2 offset:8192
ds_read_b128 v[52:55], v2 offset:9216
ds_read_b128 v[40:43], v2 offset:0
ds_read_b128 v[44:47], v2 offset:1024
v_mov_b64 v[32:33], 0
v_mov_b64 v[34:35], 0
v_mov_b64 v[36:37], 0
v_mov_b64 v[38:39], 0
v_mov_b64 v[56:57], 0
v_mov_b64 v[58:59], 0
v_mov_b64 v[60:61], 0
v_mov_b64 v[62:63], 0
s_add_u32 s20, s30, 0
s_add_u32 s21, s30, 8192
s_add_u32 s49, s29, s25
s_add_u32 s50, s29, s26
s_add_u32 s51, s29, s27
s_add_u32 s52, s30, 16384
s_mov_b32 m0, 15872
s_waitcnt vmcnt(0) lgkmcnt(0)
s_branch L_step0
L_gr0:
buffer_load_dwordx4 v[12:15], v1, s[8:11], s33 offen sc1
buffer_load_dword v20, v8, s[8:11], s7 offen sc1
buffer_load_dwordx4 v[16:19], v1, s[8:11], s6 offen sc1
s_add_u32 s22, s22, 1
s_cmp_gt_u32 s22, 40000
s_cbranch_scc1 L_end
s_nop 0
v_mov_b64 v[24:25], 0
v_mov_b64 v[26:27], 0
v_mov_b64 v[28:29], 0
v_mov_b64 v[30:31], 0
v_mov_b64 v[32:33], 0
v_mov_b64 v[34:35], 0
v_mov_b64 v[36:37], 0
v_mov_b64 v[38:39], 0
v_mov_b64 v[56:57], 0
v_mov_b64 v[58:59], 0
v_mov_b64 v[60:61], 0
v_mov_b64 v[62:63], 0
s_waitcnt lgkmcnt(0)
s_branch L_step0
.p2align 3
L_gat0:
buffer_load_dwordx4 v[12:15], v1, s[8:11], s33 offen sc1
buffer_load_dword v20, v8, s[8:11], s7 offen sc1
buffer_load_dwordx4 v[16:19], v1, s[8:11], s6 offen sc1
s_add_u32 s20, s30, 0
s_add_u32 s21, s30, 8192
s_add_u32 s49, s29, s25
s_add_u32 s50, s29, s26
s_add_u32 s51, s29, s27
s_add_u32 s52, s30, 16384
s_mov_b32 m0, 15872
s_waitcnt lgkmcnt(0)
L_step0:
s_waitcnt vmcnt(2)
v_smfmac_f32_16x16x64_bf16 v[24:27], v[12:15], v[72:79], v0
ds_write_b128 v1, v[12:15] offset:6656
v_smfmac_f32_16x16x64_bf16 v[28:31], v[12:15], v[80:87], v0
s_waitcnt vmcnt(1)
ds_write_b32 v8, v20 offset:14848
v_smfmac_f32_16x16x64_bf16 v[32:35], v[12:15], v[88:95], v0
s_waitcnt vmcnt(0)
ds_write_b128 v1, v[16:19] offset:10752
v_smfmac_f32_16x16x64_bf16 v[56:59], v[12:15], a[32:39], v0
v_max3_u32 v21, v12, v13, v14
v_max3_u32 v21, v21, v15, v20
v_smfmac_f32_16x16x64_bf16 v[60:63], v[12:15], a[40:47], v0
v_max3_u32 v21, v21, v16, v17
v_max3_u32 v21, v21, v18, v19
v_smfmac_f32_16x16x64_bf16 v[36:39], v[12:15], v[40:47], v0
v_cmp_le_u32 vcc, 0xffff0000, v21
v_smfmac_f32_16x16x64_bf16 v[24:27], v[16:19], v[168:175], v0
s_cbranch_vccnz L_gr0
v_smfmac_f32_16x16x64_bf16 v[28:31], v[16:19], v[176:183], v0
s_waitcnt lgkmcnt(0)
s_barrier
ds_read_b128 v[20:23], v1 offset:7680
v_smfmac_f32_16x16x64_bf16 v[32:35], v[16:19], v[184:191], v0
ds_read_b128 v[12:15], v1 offset:8704
buffer_load_dwordx4 v69, s[8:11], s20 offen sc1 lds
v_smfmac_f32_16x16x64_bf16 v[56:59], v[16:19], a[96:103], v0
ds_read_b128 v[40:43], v2 offset:2048
s_mov_b32 m0, 16768
v_smfmac_f32_16x16x64_bf16 v[60:63], v[16:19], a[104:111], v0
ds_read_b128 v[44:47], v2 offset:3072
v_smfmac_f32_16x16x64_bf16 v[36:39], v[16:19], v[48:55], v0
ds_read_b128 v[16:19], v1 offset:9728
s_waitcnt lgkmcnt(4)
v_smfmac_f32_16x16x64_bf16 v[24:27], v[20:23], v[96:103], v0
ds_read_b128 v[48:51], v2 offset:4096
buffer_load_dwordx4 v69, s[8:11], s20 offen offset:128 sc1 lds
v_smfmac_f32_16x16x64_bf16 v[28:31], v[20:23], v[104:111], v0
ds_read_b128 v[52:55], v2 offset:5120
s_mov_b32 m0, 6272
v_smfmac_f32_16x16x64_bf16 v[32:35], v[20:23], v[112:119], v0
buffer_store_dword v0, v11, s[8:11], s35 offen
s_waitcnt lgkmcnt(3)
v_smfmac_f32_16x16x64_bf16 v[36:39], v[20:23], v[40:47], v0
ds_read_b128 v[20:23], v1 offset:11776
v_smfmac_f32_16x16x64_bf16 v[24:27], v[12:15], v[120:127], v0
ds_read_b128 v[40:43], v2 offset:6144
buffer_store_dwordx4 v[64:67], v1, s[8:11], s49 offen
v_smfmac_f32_16x16x64_bf16 v[28:31], v[12:15], v[128:135], v0
ds_read_b128 v[44:47], v2 offset:7168
v_smfmac_f32_16x16x64_bf16 v[32:35], v[12:15], v[136:143], v0
s_waitcnt lgkmcnt(3)
v_smfmac_f32_16x16x64_bf16 v[36:39], v[12:15], v[48:55], v0
ds_read_b128 v[12:15], v1 offset:12800
v_smfmac_f32_16x16x64_bf16 v[24:27], v[16:19], v[144:151], v0
ds_read_b128 v[48:51], v2 offset:10240
buffer_store_dwordx4 v[64:67], v1, s[8:11], s50 offen
v_smfmac_f32_16x16x64_bf16 v[28:31], v[16:19], v[152:159], v0
ds_read_b128 v[52:55], v2 offset:11264
v_smfmac_f32_16x16x64_bf16 v[32:35], v[16:19], v[160:167], v0
s_waitcnt lgkmcnt(3)
v_smfmac_f32_16x16x64_bf16 v[36:39], v[16:19], v[40:47], v0
ds_read_b128 v[16:19], v1 offset:13824
v_smfmac_f32_16x16x64_bf16 v[24:27], v[20:23], v[192:199], v0
ds_read_b128 v[40:43], v2 offset:12288
buffer_store_dwordx4 v[64:67], v1, s[8:11], s51 offen
v_smfmac_f32_16x16x64_bf16 v[28:31], v[20:23], v[200:207], v0
ds_read_b128 v[44:47], v2 offset:13312
v_smfmac_f32_16x16x64_bf16 v[32:35], v[20:23], v[208:215], v0
s_waitcnt lgkmcnt(3)
v_smfmac_f32_16x16x64_bf16 v[36:39], v[20:23], v[48:55], v0
ds_read_b128 v[20:23], v1 offset:14848
v_smfmac_f32_16x16x64_bf16 v[24:27], v[12:15], v[216:223], v0
ds_read_b128 v[48:51], v2 offset:14336
buffer_load_dwordx4 v[64:67], v70, s[8:11], s21 offen sc1
v_smfmac_f32_16x16x64_bf16 v[28:31], v[12:15], v[224:231], v0
ds_read_b128 v[52:55], v2 offset:15360
v_smfmac_f32_16x16x64_bf16 v[32:35], v[12:15], v[232:239], v0
s_waitcnt lgkmcnt(3)
v_smfmac_f32_16x16x64_bf16 v[36:39], v[12:15], v[40:47], v0
ds_read_b128 v[12:15], v1 offset:7680
v_smfmac_f32_16x16x64_bf16 v[24:27], v[16:19], v[240:247], v0
ds_read_b128 v[40:43], v2 offset:16384
buffer_load_dwordx4 v[68:71], v70, s[8:11], s21 offen offset:256 sc1
v_smfmac_f32_16x16x64_bf16 v[28:31], v[16:19], v[248:255], v0
ds_read_b128 v[44:47], v2 offset:17408
v_smfmac_f32_16x16x64_bf16 v[32:35], v[16:19], a[0:7], v0
s_waitcnt lgkmcnt(3)
v_smfmac_f32_16x16x64_bf16 v[36:39], v[16:19], v[48:55], v0
ds_read_b128 v[16:19], v1 offset:8704
v_smfmac_f32_16x16x64_bf16 v[24:27], v[20:23], a[8:15], v0
v_smfmac_f32_16x16x64_bf16 v[28:31], v[20:23], a[16:23], v0
buffer_load_dword v6, s[8:11], s52 offen sc1 lds
v_smfmac_f32_16x16x64_bf16 v[32:35], v[20:23], a[24:31], v0
s_waitcnt lgkmcnt(1)
v_smfmac_f32_16x16x64_bf16 v[36:39], v[20:23], v[40:47], v0
ds_read_b128 v[20:23], v1 offset:9728
v_smfmac_f32_16x16x64_bf16 v[56:59], v[12:15], a[48:55], v0
s_nop 0
v_add_f32 v24, v24, v25
v_add_f32 v26, v26, v27
v_add_f32 v28, v28, v29
v_add_f32 v30, v30, v31
v_cvt_pk_bf16_f32 v24, v24, v28
v_cvt_pk_bf16_f32 v26, v26, v30
ds_write_b32 v4, v24 offset:2176
v_add_f32 v32, v32, v33
v_add_f32 v34, v34, v35
v_add_f32 v36, v36, v37
v_add_f32 v38, v38, v39
ds_write_b32 v3, v26 offset:2176
v_cvt_pk_bf16_f32 v32, v32, v36
v_cvt_pk_bf16_f32 v34, v34, v38
ds_write_b32 v4, v32
v_smfmac_f32_16x16x64_bf16 v[60:63], v[12:15], a[56:63], v0
ds_write_b32 v3, v34
s_waitcnt lgkmcnt(5)
v_smfmac_f32_16x16x64_bf16 v[56:59], v[16:19], a[64:71], v0
ds_read_b128 v[12:15], v1 offset:11776
v_smfmac_f32_16x16x64_bf16 v[60:63], v[16:19], a[72:79], v0
ds_read_b128 v[16:19], v1 offset:12800
s_waitcnt lgkmcnt(6)
v_smfmac_f32_16x16x64_bf16 v[56:59], v[20:23], a[80:87], v0
s_waitcnt lgkmcnt(2) vmcnt(7)
s_barrier
ds_read_b128 v[24:27], v5 offset:0
v_smfmac_f32_16x16x64_bf16 v[60:63], v[20:23], a[88:95], v0
ds_read_b128 v[20:23], v1 offset:13824
s_waitcnt lgkmcnt(3)
v_smfmac_f32_16x16x64_bf16 v[56:59], v[12:15], a[112:119], v0
ds_read_b128 v[40:43], v1 offset:15872
v_smfmac_f32_16x16x64_bf16 v[60:63], v[12:15], a[120:127], v0
ds_read_b128 v[12:15], v1 offset:14848
s_waitcnt lgkmcnt(4)
v_smfmac_f32_16x16x64_bf16 v[56:59], v[16:19], a[128:135], v0
ds_read_b128 v[28:31], v5 offset:512
v_smfmac_f32_16x16x64_bf16 v[60:63], v[16:19], a[136:143], v0
ds_read_b128 v[44:47], v1 offset:17920
s_waitcnt lgkmcnt(4)
v_smfmac_f32_16x16x64_bf16 v[56:59], v[20:23], a[144:151], v0
ds_read_b128 v[32:35], v5 offset:1024
s_mov_b64 exec, s[86:87]
buffer_store_dwordx4 v[24:27], v5, s[8:11], s31 offen offset:0 sc1
s_mov_b64 exec, -1
v_smfmac_f32_16x16x64_bf16 v[60:63], v[20:23], a[152:159], v0
ds_read_b128 v[48:51], v1 offset:19968
s_waitcnt lgkmcnt(4)
v_smfmac_f32_16x16x64_bf16 v[56:59], v[12:15], a[160:167], v0
ds_read_b128 v[36:39], v5 offset:1536
v_smfmac_f32_16x16x64_bf16 v[60:63], v[12:15], a[168:175], v0
ds_read_b128 v[52:55], v1 offset:22016
v_mfma_f32_16x16x32_bf16 v[16:19], v[40:43], v[24:27], 0
ds_read_b128 v[40:43], v1 offset:16896
s_waitcnt lgkmcnt(5)
v_mfma_f32_16x16x32_bf16 v[16:19], v[44:47], v[28:31], v[16:19]
ds_read_b128 v[44:47], v1 offset:18944
s_waitcnt lgkmcnt(4)
v_mfma_f32_16x16x32_bf16 v[16:19], v[48:51], v[32:35], v[16:19]
ds_read_b128 v[48:51], v1 offset:20992
s_waitcnt lgkmcnt(3)
v_mfma_f32_16x16x32_bf16 v[16:19], v[52:55], v[36:39], v[16:19]
ds_read_b128 v[52:55], v1 offset:23040
v_mfma_f32_16x16x32_bf16 v[20:23], v[24:27], v[24:27], 0
v_add_f32 v56, v56, v57
v_add_f32 v58, v58, v59
v_mfma_f32_16x16x32_bf16 v[20:23], v[28:31], v[28:31], v[20:23]
v_add_f32 v60, v60, v61
v_add_f32 v62, v62, v63
v_mfma_f32_16x16x32_bf16 v[20:23], v[32:35], v[32:35], v[20:23]
v_cvt_pk_bf16_f32 v56, v56, v58
v_cvt_pk_bf16_f32 v57, v60, v62
v_mfma_f32_16x16x32_bf16 v[20:23], v[36:39], v[36:39], v[20:23]
v_lshrrev_b32 v58, 1, v1
v_max3_f32 v59, v16, v17, v18
s_waitcnt lgkmcnt(3)
v_mfma_f32_16x16x32_bf16 v[12:15], v[40:43], v[24:27], 0
ds_read_b128 v[40:43], v2 offset:18432
buffer_store_dwordx2 v[56:57], v58, s[8:11], s31 offen offset:2048 sc1
s_waitcnt lgkmcnt(3)
v_mfma_f32_16x16x32_bf16 v[12:15], v[44:47], v[28:31], v[12:15]
ds_read_b128 v[44:47], v2 offset:19456
s_waitcnt lgkmcnt(3)
v_mfma_f32_16x16x32_bf16 v[12:15], v[48:51], v[32:35], v[12:15]
ds_read_b128 v[48:51], v2 offset:20480
v_max3_f32 v59, v59, v19, v20
v_max_f32 v59, v59, v21
s_waitcnt lgkmcnt(3)
v_mfma_f32_16x16x32_bf16 v[12:15], v[52:55], v[36:39], v[12:15]
ds_read_b128 v[52:55], v2 offset:21504
v_mov_b32 v60, s53
s_add_u32 s49, s28, s23
v_mov_b32 v61, s53
s_add_u32 s50, s28, 65536
v_mov_b32 v62, s53
ds_read_b128 v[32:35], v2 offset:22528
v_mov_b32 v63, s53
v_max3_f32 v59, v59, v12, v13
v_max3_f32 v22, v59, v14, v15
v_max3_f32 v59, v59, v14, v15
s_add_u32 s51, s28, 131072
s_add_u32 s52, s28, 196608
v_permlane32_swap_b32 v22, v59
v_max_f32 v23, v59, v22
v_max_f32 v59, v59, v22
v_mov_b32 v22, 0
ds_read_b128 v[36:39], v2 offset:23552
v_permlane16_swap_b32 v23, v59
v_max_f32 v59, v59, v23
v_mul_f32 v58, s18, v59
v_pk_fma_f32 v[20:21], v[20:21], s[18:19], v[58:59] op_sel_hi:[1,0,0] neg_lo:[0,0,1] neg_hi:[0,0,1]
v_pk_fma_f32 v[16:17], v[16:17], s[18:19], v[58:59] op_sel_hi:[1,0,0] neg_lo:[0,0,1] neg_hi:[0,0,1]
v_pk_fma_f32 v[18:19], v[18:19], s[18:19], v[58:59] op_sel_hi:[1,0,0] neg_lo:[0,0,1] neg_hi:[0,0,1]
v_pk_fma_f32 v[12:13], v[12:13], s[18:19], v[58:59] op_sel_hi:[1,0,0] neg_lo:[0,0,1] neg_hi:[0,0,1]
v_pk_fma_f32 v[14:15], v[14:15], s[18:19], v[58:59] op_sel_hi:[1,0,0] neg_lo:[0,0,1] neg_hi:[0,0,1]
v_exp_f32 v20, v20
v_exp_f32 v21, v21
v_exp_f32 v16, v16
v_cvt_pk_bf16_f32 v23, v20, v21
v_cvt_pk_bf16_f32 v20, v20, v21
v_mov_b32 v21, 0
v_exp_f32 v17, v17
v_exp_f32 v18, v18
v_mfma_f32_16x16x16_bf16 v[24:27], v[56:57], v[20:21], 0
v_exp_f32 v19, v19
v_mfma_f32_16x16x16_bf16 v[28:31], v[56:57], v[22:23], 0
v_exp_f32 v12, v12
v_exp_f32 v13, v13
v_cvt_pk_bf16_f32 v16, v16, v17
v_cvt_pk_bf16_f32 v17, v18, v19
v_exp_f32 v14, v14
v_exp_f32 v15, v15
v_cvt_pk_bf16_f32 v18, v12, v13
v_cvt_pk_bf16_f32 v19, v14, v15
v_mfma_f32_16x16x16_bf16 v[12:15], v[60:61], v[20:21], 0
s_waitcnt vmcnt(3)
v_mfma_f32_16x16x32_bf16 v[12:15], v[60:63], v[16:19], v[12:15]
v_mov_b32 v20, 0
v_mov_b32 v23, 0
v_mfma_f32_16x16x32_bf16 v[24:27], v[64:67], v[16:19], v[24:27]
s_nop 1
v_mfma_f32_16x16x32_bf16 v[28:31], v[68:71], v[16:19], v[28:31]
v_mov_b32 v16, 0
v_mov_b32 v17, 0
v_rcp_f32 v12, v12
v_mov_b32 v18, 0
v_mov_b32 v19, 0
v_pk_mul_f32 v[24:25], v[24:25], v[12:13] op_sel_hi:[1,0]
v_pk_mul_f32 v[26:27], v[26:27], v[12:13] op_sel_hi:[1,0]
v_mov_b32 v15, 0
v_pk_mul_f32 v[28:29], v[28:29], v[12:13] op_sel_hi:[1,0]
v_pk_mul_f32 v[30:31], v[30:31], v[12:13] op_sel_hi:[1,0]
v_cvt_pk_bf16_f32 v24, v24, v28
v_cvt_pk_bf16_f32 v25, v25, v29
v_cvt_pk_bf16_f32 v26, v26, v30
v_cvt_pk_bf16_f32 v27, v27, v31
v_mfma_f32_16x16x32_bf16 v[56:59], v[20:23], v[20:23], 0
ds_write_b128 v7, v[24:27]
v_mfma_f32_16x16x32_bf16 v[60:63], v[20:23], v[20:23], 0
v_mov_b32 v12, 0
v_mov_b32 v13, 0
v_mov_b32 v14, 0
v_mov_b32 v3, 6528
s_nop 1
v_mfma_f32_16x16x32_bf16 v[64:67], v[20:23], v[20:23], 0
s_cmp_eq_u32 s19, 63
s_cbranch_scc1 L_texit
s_waitcnt lgkmcnt(0)
s_barrier
ds_read_b128 v[24:27], v1 offset:4224
v_mfma_f32_16x16x32_bf16 v[68:71], v[20:23], v[20:23], 0
ds_read_b128 v[28:31], v1 offset:5248
s_nop 2
v_mfma_f32_16x16x32_bf16 v[68:71], v[20:23], v[20:23], 0
s_waitcnt lgkmcnt(1)
v_smfmac_f32_16x16x64_bf16 v[12:15], v[24:27], a[248:255], v0
v_smfmac_f32_16x16x64_bf16 v[16:19], v[24:27], a[176:183], v0
s_waitcnt lgkmcnt(0)
v_smfmac_f32_16x16x64_bf16 v[12:15], v[28:31], v[40:47], v0
ds_read_b128 v[40:43], v2 offset:24576
v_smfmac_f32_16x16x64_bf16 v[16:19], v[28:31], v[48:55], v0
ds_read_b128 v[44:47], v2 offset:25600
v_smfmac_f32_16x16x64_bf16 v[20:23], v[24:27], a[184:191], v0
ds_read_b128 v[48:51], v2 offset:26624
v_smfmac_f32_16x16x64_bf16 v[20:23], v[28:31], v[32:39], v0
ds_read_b128 v[52:55], v2 offset:27648
s_nop 0
v_add_f32 v12, v12, v13
v_add_f32 v14, v14, v15
v_smfmac_f32_16x16x64_bf16 v[56:59], v[24:27], a[192:199], v0
ds_read_b128 v[32:35], v2 offset:28672
s_waitcnt lgkmcnt(3)
v_cvt_pk_bf16_f32 v12, v12, v14
buffer_store_dword v12, v10, s[8:11], s28 offen
v_smfmac_f32_16x16x64_bf16 v[56:59], v[28:31], v[40:47], v0
ds_read_b128 v[36:39], v2 offset:29696
v_add_f32 v16, v16, v17
v_add_f32 v18, v18, v19
v_smfmac_f32_16x16x64_bf16 v[60:63], v[24:27], a[200:207], v0
ds_read_b128 v[12:15], v3
s_waitcnt lgkmcnt(3)
v_cvt_pk_bf16_f32 v16, v16, v18
v_add_f32 v20, v20, v21
v_smfmac_f32_16x16x64_bf16 v[60:63], v[28:31], v[48:55], v0
ds_read_b128 v[40:43], v2 offset:30720
v_add_f32 v22, v22, v23
v_cvt_pk_bf16_f32 v17, v20, v22
v_smfmac_f32_16x16x64_bf16 v[64:67], v[24:27], a[208:215], v0
ds_read_b128 v[44:47], v2 offset:31744
s_waitcnt lgkmcnt(3)
buffer_store_dwordx2 v[16:17], v9, s[8:11], s28 offen
v_add_f32 v56, v56, v57
v_smfmac_f32_16x16x64_bf16 v[64:67], v[28:31], v[32:39], v0
ds_read_b128 v[48:51], v2 offset:32768
v_add_f32 v58, v58, v59
v_cvt_pk_bf16_f32 v56, v56, v58
v_smfmac_f32_16x16x64_bf16 v[68:71], v[24:27], a[216:223], v0
ds_read_b128 v[52:55], v2 offset:33792
s_waitcnt lgkmcnt(2)
v_add_f32 v60, v60, v61
v_add_f32 v62, v62, v63
v_smfmac_f32_16x16x64_bf16 v[68:71], v[28:31], v[40:47], v0
ds_read_b128 v[20:23], v3
v_cvt_pk_bf16_f32 v57, v60, v62
buffer_store_dwordx2 v[56:57], v9, s[8:11], s50 offen
v_smfmac_f32_16x16x64_bf16 v[12:15], v[24:27], a[224:231], v0
s_waitcnt lgkmcnt(1)
v_add_f32 v64, v64, v65
v_add_f32 v66, v66, v67
v_smfmac_f32_16x16x64_bf16 v[12:15], v[28:31], v[48:55], v0
s_waitcnt lgkmcnt(0)
v_cvt_pk_bf16_f32 v64, v64, v66
v_smfmac_f32_16x16x64_bf16 v[20:23], v[24:27], a[232:239], v0
v_add_f32 v68, v68, v69
v_add_f32 v70, v70, v71
v_smfmac_f32_16x16x64_bf16 v[20:23], v[28:31], a[240:247], v0
v_cvt_pk_bf16_f32 v65, v68, v70
buffer_store_dwordx2 v[64:65], v9, s[8:11], s51 offen
v_add_f32 v12, v12, v13
v_add_f32 v14, v14, v15
v_cvt_pk_bf16_f32 v12, v12, v14
s_nop 2
v_add_f32 v20, v20, v21
v_add_f32 v22, v22, v23
v_cvt_pk_bf16_f32 v13, v20, v22
buffer_store_dwordx2 v[12:13], v9, s[8:11], s52 offen
s_add_u32 s19, s19, 1
s_mov_b32 s20, s28
s_mov_b32 s28, s29
s_mov_b32 s29, s20
s_and_b32 s20, s19, 3
s_lshl_b32 s20, s20, 14
s_add_u32 s33, s20, 110100480
s_add_u32 s34, s20, s24
s_xor_b32 s20, s20, 32768
s_add_u32 s35, s20, s24
s_add_u32 s30, s30, 16384
s_add_u32 s31, s31, 131072
s_add_u32 s6, s33, 4096
s_add_u32 s7, s33, 8192
s_mov_b32 s22, 0
v_mov_b64 v[24:25], 0
v_mov_b64 v[26:27], 0
v_mov_b64 v[28:29], 0
v_mov_b64 v[30:31], 0
v_and_b32 v69, 0x380, v1
v_add_u32 v69, v69, v1
v_and_b32 v70, 0xf00, v1
v_add_u32 v70, v70, v1
v_mov_b64 v[64:65], -1
v_mov_b64 v[66:67], -1
v_xor_b32 v3, 16, v4
ds_read_b128 v[48:51], v2 offset:8192
ds_read_b128 v[52:55], v2 offset:9216
v_mov_b32 v56, 0x3f80
v_cndmask_b32 v56, v56, 1.0, s[44:45]
v_cndmask_b32 v60, 0, v56, s[36:37]
v_cndmask_b32 v61, 0, v56, s[38:39]
v_cndmask_b32 v62, 0, v56, s[40:41]
v_cndmask_b32 v63, 0, v56, s[42:43]
s_nop 5
buffer_load_dwordx4 v[32:35], v1, s[8:11], s49 offen offset:0 sc1
buffer_load_dwordx4 v[36:39], v1, s[8:11], s49 offen offset:1024 sc1
buffer_load_dwordx4 v[40:43], v1, s[8:11], s49 offen offset:2048 sc1
buffer_load_dwordx4 v[44:47], v1, s[8:11], s49 offen offset:3072 sc1
s_waitcnt vmcnt(3)
v_mfma_f32_16x16x32_bf16 v[56:59], v[32:35], v[60:63], 0
v_max3_u32 v16, v32, v33, v34
v_max_u32 v16, v16, v35
s_waitcnt vmcnt(2)
v_mfma_f32_16x16x32_bf16 v[56:59], v[36:39], v[60:63], v[56:59]
v_max3_u32 v16, v16, v36, v37
v_max3_u32 v16, v16, v38, v39
s_waitcnt vmcnt(1)
v_mfma_f32_16x16x32_bf16 v[56:59], v[40:43], v[60:63], v[56:59]
v_max3_u32 v16, v16, v40, v41
v_max3_u32 v16, v16, v42, v43
s_waitcnt vmcnt(0)
v_mfma_f32_16x16x32_bf16 v[56:59], v[44:47], v[60:63], v[56:59]
v_max3_u32 v16, v16, v44, v45
v_max3_u32 v16, v16, v46, v47
v_cmp_le_u32 vcc, 0xffff0000, v16
s_cbranch_vccnz L_red0
L_redb0:
s_nop 3
v_permlane32_swap_b32 v56, v58
v_permlane32_swap_b32 v57, v59
v_pk_add_f32 v[56:57], v[56:57], v[58:59]
v_cvt_pk_bf16_f32 v56, v56, v57
buffer_store_dword v56, v11, s[8:11], s34 offen
s_barrier
ds_read_b128 v[40:43], v2 offset:0
ds_read_b128 v[44:47], v2 offset:1024
v_mov_b64 v[32:33], 0
v_mov_b64 v[34:35], 0
v_mov_b64 v[36:37], 0
v_mov_b64 v[38:39], 0
v_mov_b64 v[56:57], 0
v_mov_b64 v[58:59], 0
v_mov_b64 v[60:61], 0
v_mov_b64 v[62:63], 0
s_nop 15
s_nop 13
s_branch L_gat0
L_red0:
L_red0b:
buffer_load_dwordx4 v[32:35], v1, s[8:11], s49 offen offset:0 sc1
buffer_load_dwordx4 v[36:39], v1, s[8:11], s49 offen offset:1024 sc1
buffer_load_dwordx4 v[40:43], v1, s[8:11], s49 offen offset:2048 sc1
buffer_load_dwordx4 v[44:47], v1, s[8:11], s49 offen offset:3072 sc1
s_add_u32 s22, s22, 1
s_cmp_gt_u32 s22, 40000
s_cbranch_scc1 L_end
s_waitcnt vmcnt(3)
v_mfma_f32_16x16x32_bf16 v[56:59], v[32:35], v[60:63], 0
v_max3_u32 v16, v32, v33, v34
v_max_u32 v16, v16, v35
s_waitcnt vmcnt(2)
v_mfma_f32_16x16x32_bf16 v[56:59], v[36:39], v[60:63], v[56:59]
v_max3_u32 v16, v16, v36, v37
v_max3_u32 v16, v16, v38, v39
s_waitcnt vmcnt(1)
v_mfma_f32_16x16x32_bf16 v[56:59], v[40:43], v[60:63], v[56:59]
v_max3_u32 v16, v16, v40, v41
v_max3_u32 v16, v16, v42, v43
s_waitcnt vmcnt(0)
v_mfma_f32_16x16x32_bf16 v[56:59], v[44:47], v[60:63], v[56:59]
v_max3_u32 v16, v16, v44, v45
v_max3_u32 v16, v16, v46, v47
v_cmp_le_u32 vcc, 0xffff0000, v16
s_cbranch_vccz L_redb0
s_branch L_red0b
L_ent1:
v_mov_b64 v[24:25], 0
v_mov_b64 v[26:27], 0
v_mov_b64 v[28:29], 0
v_mov_b64 v[30:31], 0
v_and_b32 v69, 0x380, v1
v_add_u32 v69, v69, v1
v_and_b32 v70, 0xf00, v1
v_add_u32 v70, v70, v1
v_mov_b64 v[64:65], -1
v_mov_b64 v[66:67], -1
v_xor_b32 v3, 16, v4
ds_read_b128 v[48:51], v2 offset:10240
ds_read_b128 v[52:55], v2 offset:11264
ds_read_b128 v[40:43], v2 offset:2048
ds_read_b128 v[44:47], v2 offset:3072
v_mov_b64 v[32:33], 0
v_mov_b64 v[34:35], 0
v_mov_b64 v[36:37], 0
v_mov_b64 v[38:39], 0
v_mov_b64 v[56:57], 0
v_mov_b64 v[58:59], 0
v_mov_b64 v[60:61], 0
v_mov_b64 v[62:63], 0
s_add_u32 s20, s30, 1024
s_add_u32 s21, s30, 8192
s_add_u32 s49, s29, s25
s_add_u32 s50, s29, s26
s_add_u32 s51, s29, s27
s_add_u32 s52, s30, 16384
s_mov_b32 m0, 17920
s_waitcnt vmcnt(0) lgkmcnt(0)
s_branch L_step1
L_gr1:
buffer_load_dwordx4 v[12:15], v1, s[8:11], s33 offen sc1
buffer_load_dword v20, v8, s[8:11], s7 offen sc1
buffer_load_dwordx4 v[16:19], v1, s[8:11], s6 offen sc1
s_add_u32 s22, s22, 1
s_cmp_gt_u32 s22, 40000
s_cbranch_scc1 L_end
s_nop 0
v_mov_b64 v[24:25], 0
v_mov_b64 v[26:27], 0
v_mov_b64 v[28:29], 0
v_mov_b64 v[30:31], 0
v_mov_b64 v[32:33], 0
v_mov_b64 v[34:35], 0
v_mov_b64 v[36:37], 0
v_mov_b64 v[38:39], 0
v_mov_b64 v[56:57], 0
v_mov_b64 v[58:59], 0
v_mov_b64 v[60:61], 0
v_mov_b64 v[62:63], 0
s_waitcnt lgkmcnt(0)
s_branch L_step1
.p2align 3
L_gat1:
buffer_load_dwordx4 v[12:15], v1, s[8:11], s33 offen sc1
buffer_load_dword v20, v8, s[8:11], s7 offen sc1
buffer_load_dwordx4 v[16:19], v1, s[8:11], s6 offen sc1
s_add_u32 s20, s30, 1024
s_add_u32 s21, s30, 8192
s_add_u32 s49, s29, s25
s_add_u32 s50, s29, s26
s_add_u32 s51, s29, s27
s_add_u32 s52, s30, 16384
s_mov_b32 m0, 17920
s_waitcnt lgkmcnt(0)
L_step1:
s_waitcnt vmcnt(2)
v_smfmac_f32_16x16x64_bf16 v[24:27], v[12:15], v[96:103], v0
ds_write_b128 v1, v[12:15] offset:6656
v_smfmac_f32_16x16x64_bf16 v[28:31], v[12:15], v[104:111], v0
s_waitcnt vmcnt(1)
ds_write_b32 v8, v20 offset:14848
v_smfmac_f32_16x16x64_bf16 v[32:35], v[12:15], v[112:119], v0
s_waitcnt vmcnt(0)
ds_write_b128 v1, v[16:19] offset:10752
v_smfmac_f32_16x16x64_bf16 v[56:59], v[12:15], a[48:55], v0
v_max3_u32 v21, v12, v13, v14
v_max3_u32 v21, v21, v15, v20
v_smfmac_f32_16x16x64_bf16 v[60:63], v[12:15], a[56:63], v0
v_max3_u32 v21, v21, v16, v17
v_max3_u32 v21, v21, v18, v19
v_smfmac_f32_16x16x64_bf16 v[36:39], v[12:15], v[40:47], v0
v_cmp_le_u32 vcc, 0xffff0000, v21
v_smfmac_f32_16x16x64_bf16 v[24:27], v[16:19], v[192:199], v0
s_cbranch_vccnz L_gr1
v_smfmac_f32_16x16x64_bf16 v[28:31], v[16:19], v[200:207], v0
s_waitcnt lgkmcnt(0)
s_barrier
ds_read_b128 v[20:23], v1 offset:5632
v_smfmac_f32_16x16x64_bf16 v[32:35], v[16:19], v[208:215], v0
ds_read_b128 v[12:15], v1 offset:7680
buffer_load_dwordx4 v69, s[8:11], s20 offen sc1 lds
v_smfmac_f32_16x16x64_bf16 v[56:59], v[16:19], a[112:119], v0
ds_read_b128 v[40:43], v2 offset:0
s_mov_b32 m0, 18816
v_smfmac_f32_16x16x64_bf16 v[60:63], v[16:19], a[120:127], v0
ds_read_b128 v[44:47], v2 offset:1024
v_smfmac_f32_16x16x64_bf16 v[36:39], v[16:19], v[48:55], v0
ds_read_b128 v[16:19], v1 offset:8704
s_waitcnt lgkmcnt(4)
v_smfmac_f32_16x16x64_bf16 v[24:27], v[20:23], v[72:79], v0
ds_read_b128 v[48:51], v2 offset:4096
buffer_load_dwordx4 v69, s[8:11], s20 offen offset:128 sc1 lds
v_smfmac_f32_16x16x64_bf16 v[28:31], v[20:23], v[80:87], v0
ds_read_b128 v[52:55], v2 offset:5120
s_mov_b32 m0, 6272
v_smfmac_f32_16x16x64_bf16 v[32:35], v[20:23], v[88:95], v0
buffer_store_dword v0, v11, s[8:11], s35 offen
s_waitcnt lgkmcnt(3)
v_smfmac_f32_16x16x64_bf16 v[36:39], v[20:23], v[40:47], v0
ds_read_b128 v[20:23], v1 offset:9728
v_smfmac_f32_16x16x64_bf16 v[24:27], v[12:15], v[120:127], v0
ds_read_b128 v[40:43], v2 offset:6144
v_smfmac_f32_16x16x64_bf16 v[28:31], v[12:15], v[128:135], v0
ds_read_b128 v[44:47], v2 offset:7168
buffer_store_dwordx4 v[64:67], v1, s[8:11], s49 offen
v_smfmac_f32_16x16x64_bf16 v[32:35], v[12:15], v[136:143], v0
s_waitcnt lgkmcnt(3)
v_smfmac_f32_16x16x64_bf16 v[36:39], v[12:15], v[48:55], v0
ds_read_b128 v[12:15], v1 offset:11776
v_smfmac_f32_16x16x64_bf16 v[24:27], v[16:19], v[144:151], v0
ds_read_b128 v[48:51], v2 offset:8192
v_smfmac_f32_16x16x64_bf16 v[28:31], v[16:19], v[152:159], v0
ds_read_b128 v[52:55], v2 offset:9216
buffer_store_dwordx4 v[64:67], v1, s[8:11], s50 offen
v_smfmac_f32_16x16x64_bf16 v[32:35], v[16:19], v[160:167], v0
s_waitcnt lgkmcnt(3)
v_smfmac_f32_16x16x64_bf16 v[36:39], v[16:19], v[40:47], v0
ds_read_b128 v[16:19], v1 offset:12800
v_smfmac_f32_16x16x64_bf16 v[24:27], v[20:23], v[168:175], v0
ds_read_b128 v[40:43], v2 offset:12288
v_smfmac_f32_16x16x64_bf16 v[28:31], v[20:23], v[176:183], v0
ds_read_b128 v[44:47], v2 offset:13312
buffer_store_dwordx4 v[64:67], v1, s[8:11], s51 offen
v_smfmac_f32_16x16x64_bf16 v[32:35], v[20:23], v[184:191], v0
s_waitcnt lgkmcnt(3)
v_smfmac_f32_16x16x64_bf16 v[36:39], v[20:23], v[48:55], v0
ds_read_b128 v[20:23], v1 offset:13824
v_smfmac_f32_16x16x64_bf16 v[24:27], v[12:15], v[216:223], v0
ds_read_b128 v[48:51], v2 offset:14336
buffer_load_dwordx4 v[64:67], v70, s[8:11], s21 offen sc1
v_smfmac_f32_16x16x64_bf16 v[28:31], v[12:15], v[224:231], v0
ds_read_b128 v[52:55], v2 offset:15360
v_smfmac_f32_16x16x64_bf16 v[32:35], v[12:15], v[232:239], v0
s_waitcnt lgkmcnt(3)
v_smfmac_f32_16x16x64_bf16 v[36:39], v[12:15], v[40:47], v0
ds_read_b128 v[12:15], v1 offset:5632
v_smfmac_f32_16x16x64_bf16 v[24:27], v[16:19], v[240:247], v0
ds_read_b128 v[40:43], v2 offset:16384
buffer_load_dwordx4 v[68:71], v70, s[8:11], s21 offen offset:256 sc1
v_smfmac_f32_16x16x64_bf16 v[28:31], v[16:19], v[248:255], v0
ds_read_b128 v[44:47], v2 offset:17408
v_smfmac_f32_16x16x64_bf16 v[32:35], v[16:19], a[0:7], v0
s_waitcnt lgkmcnt(3)
v_smfmac_f32_16x16x64_bf16 v[36:39], v[16:19], v[48:55], v0
ds_read_b128 v[16:19], v1 offset:7680
v_smfmac_f32_16x16x64_bf16 v[24:27], v[20:23], a[8:15], v0
v_smfmac_f32_16x16x64_bf16 v[28:31], v[20:23], a[16:23], v0
buffer_load_dword v6, s[8:11], s52 offen sc1 lds
v_smfmac_f32_16x16x64_bf16 v[32:35], v[20:23], a[24:31], v0
s_waitcnt lgkmcnt(1)
v_smfmac_f32_16x16x64_bf16 v[36:39], v[20:23], v[40:47], v0
ds_read_b128 v[20:23], v1 offset:8704
v_smfmac_f32_16x16x64_bf16 v[56:59], v[12:15], a[32:39], v0
s_nop 0
v_add_f32 v24, v24, v25
v_add_f32 v26, v26, v27
v_add_f32 v28, v28, v29
v_add_f32 v30, v30, v31
v_cvt_pk_bf16_f32 v24, v24, v28
v_cvt_pk_bf16_f32 v26, v26, v30
ds_write_b32 v4, v24 offset:2176
v_add_f32 v32, v32, v33
v_add_f32 v34, v34, v35
v_add_f32 v36, v36, v37
v_add_f32 v38, v38, v39
ds_write_b32 v3, v26 offset:2176
v_cvt_pk_bf16_f32 v32, v32, v36
v_cvt_pk_bf16_f32 v34, v34, v38
ds_write_b32 v4, v32
v_smfmac_f32_16x16x64_bf16 v[60:63], v[12:15], a[40:47], v0
ds_write_b32 v3, v34
s_waitcnt lgkmcnt(5)
v_smfmac_f32_16x16x64_bf16 v[56:59], v[16:19], a[64:71], v0
ds_read_b128 v[12:15], v1 offset:9728
v_smfmac_f32_16x16x64_bf16 v[60:63], v[16:19], a[72:79], v0
ds_read_b128 v[16:19], v1 offset:11776
s_waitcnt lgkmcnt(6)
v_smfmac_f32_16x16x64_bf16 v[56:59], v[20:23], a[80:87], v0
s_waitcnt lgkmcnt(2) vmcnt(7)
s_barrier
ds_read_b128 v[28:31], v5 offset:512
v_smfmac_f32_16x16x64_bf16 v[60:63], v[20:23], a[88:95], v0
ds_read_b128 v[20:23], v1 offset:12800
s_waitcnt lgkmcnt(3)
v_smfmac_f32_16x16x64_bf16 v[56:59], v[12:15], a[96:103], v0
ds_read_b128 v[44:47], v1 offset:16896
v_smfmac_f32_16x16x64_bf16 v[60:63], v[12:15], a[104:111], v0
ds_read_b128 v[12:15], v1 offset:13824
s_waitcnt lgkmcnt(4)
v_smfmac_f32_16x16x64_bf16 v[56:59], v[16:19], a[128:135], v0
ds_read_b128 v[32:35], v5 offset:1024
v_smfmac_f32_16x16x64_bf16 v[60:63], v[16:19], a[136:143], v0
ds_read_b128 v[48:51], v1 offset:18944
s_waitcnt lgkmcnt(4)
v_smfmac_f32_16x16x64_bf16 v[56:59], v[20:23], a[144:151], v0
ds_read_b128 v[36:39], v5 offset:1536
v_smfmac_f32_16x16x64_bf16 v[60:63], v[20:23], a[152:159], v0
ds_read_b128 v[52:55], v1 offset:20992
s_mov_b64 exec, s[86:87]
buffer_store_dwordx4 v[28:31], v5, s[8:11], s31 offen offset:512 sc1
s_mov_b64 exec, -1
s_waitcnt lgkmcnt(4)
v_smfmac_f32_16x16x64_bf16 v[56:59], v[12:15], a[160:167], v0
ds_read_b128 v[24:27], v5 offset:0
v_smfmac_f32_16x16x64_bf16 v[60:63], v[12:15], a[168:175], v0
ds_read_b128 v[40:43], v1 offset:14848
v_mfma_f32_16x16x32_bf16 v[16:19], v[44:47], v[28:31], 0
ds_read_b128 v[44:47], v1 offset:17920
s_waitcnt lgkmcnt(5)
v_mfma_f32_16x16x32_bf16 v[16:19], v[48:51], v[32:35], v[16:19]
ds_read_b128 v[48:51], v1 offset:19968
s_waitcnt lgkmcnt(4)
v_mfma_f32_16x16x32_bf16 v[16:19], v[52:55], v[36:39], v[16:19]
ds_read_b128 v[52:55], v1 offset:22016
s_waitcnt lgkmcnt(3)
v_mfma_f32_16x16x32_bf16 v[16:19], v[40:43], v[24:27], v[16:19]
ds_read_b128 v[40:43], v1 offset:15872
v_mfma_f32_16x16x32_bf16 v[20:23], v[28:31], v[28:31], 0
v_add_f32 v56, v56, v57
v_add_f32 v58, v58, v59
v_mfma_f32_16x16x32_bf16 v[20:23], v[32:35], v[32:35], v[20:23]
v_add_f32 v60, v60, v61
v_add_f32 v62, v62, v63
v_mfma_f32_16x16x32_bf16 v[20:23], v[36:39], v[36:39], v[20:23]
v_cvt_pk_bf16_f32 v56, v56, v58
v_cvt_pk_bf16_f32 v57, v60, v62
v_mfma_f32_16x16x32_bf16 v[20:23], v[24:27], v[24:27], v[20:23]
v_lshrrev_b32 v58, 1, v1
v_max3_f32 v59, v16, v17, v18
s_waitcnt lgkmcnt(3)
v_mfma_f32_16x16x32_bf16 v[12:15], v[44:47], v[28:31], 0
ds_read_b128 v[44:47], v2 offset:19456
s_waitcnt lgkmcnt(3)
v_mfma_f32_16x16x32_bf16 v[12:15], v[48:51], v[32:35], v[12:15]
ds_read_b128 v[48:51], v2 offset:20480
buffer_store_dwordx2 v[56:57], v58, s[8:11], s31 offen offset:2048 sc1
s_waitcnt lgkmcnt(3)
v_mfma_f32_16x16x32_bf16 v[12:15], v[52:55], v[36:39], v[12:15]
ds_read_b128 v[52:55], v2 offset:21504
v_max3_f32 v59, v59, v19, v20
v_max_f32 v59, v59, v21
s_waitcnt lgkmcnt(3)
v_mfma_f32_16x16x32_bf16 v[12:15], v[40:43], v[24:27], v[12:15]
ds_read_b128 v[40:43], v2 offset:18432
v_mov_b32 v60, s53
s_add_u32 s49, s28, s23
v_mov_b32 v61, s53
s_add_u32 s50, s28, 65536
v_mov_b32 v62, s53
ds_read_b128 v[32:35], v2 offset:22528
v_mov_b32 v63, s53
v_max3_f32 v59, v59, v12, v13
v_max3_f32 v22, v59, v14, v15
v_max3_f32 v59, v59, v14, v15
s_add_u32 s51, s28, 131072
s_add_u32 s52, s28, 196608
v_permlane32_swap_b32 v22, v59
v_max_f32 v23, v59, v22
v_max_f32 v59, v59, v22
v_mov_b32 v22, 0
ds_read_b128 v[36:39], v2 offset:23552
v_permlane16_swap_b32 v23, v59
v_max_f32 v59, v59, v23
v_mul_f32 v58, s18, v59
v_pk_fma_f32 v[20:21], v[20:21], s[18:19], v[58:59] op_sel_hi:[1,0,0] neg_lo:[0,0,1] neg_hi:[0,0,1]
v_pk_fma_f32 v[16:17], v[16:17], s[18:19], v[58:59] op_sel_hi:[1,0,0] neg_lo:[0,0,1] neg_hi:[0,0,1]
v_pk_fma_f32 v[18:19], v[18:19], s[18:19], v[58:59] op_sel_hi:[1,0,0] neg_lo:[0,0,1] neg_hi:[0,0,1]
v_pk_fma_f32 v[12:13], v[12:13], s[18:19], v[58:59] op_sel_hi:[1,0,0] neg_lo:[0,0,1] neg_hi:[0,0,1]
v_pk_fma_f32 v[14:15], v[14:15], s[18:19], v[58:59] op_sel_hi:[1,0,0] neg_lo:[0,0,1] neg_hi:[0,0,1]
v_exp_f32 v20, v20
v_exp_f32 v21, v21
v_exp_f32 v16, v16
v_cvt_pk_bf16_f32 v23, v20, v21
v_cvt_pk_bf16_f32 v20, v20, v21
v_mov_b32 v21, 0
v_exp_f32 v17, v17
v_exp_f32 v18, v18
v_mfma_f32_16x16x16_bf16 v[24:27], v[56:57], v[20:21], 0
v_exp_f32 v19, v19
v_mfma_f32_16x16x16_bf16 v[28:31], v[56:57], v[22:23], 0
v_exp_f32 v12, v12
v_exp_f32 v13, v13
v_cvt_pk_bf16_f32 v16, v16, v17
v_cvt_pk_bf16_f32 v17, v18, v19
v_exp_f32 v14, v14
v_exp_f32 v15, v15
v_cvt_pk_bf16_f32 v18, v12, v13
v_cvt_pk_bf16_f32 v19, v14, v15
v_mfma_f32_16x16x16_bf16 v[12:15], v[60:61], v[20:21], 0
s_waitcnt vmcnt(3)
v_mfma_f32_16x16x32_bf16 v[12:15], v[60:63], v[16:19], v[12:15]
v_mov_b32 v20, 0
v_mov_b32 v23, 0
v_mfma_f32_16x16x32_bf16 v[24:27], v[64:67], v[16:19], v[24:27]
s_nop 1
v_mfma_f32_16x16x32_bf16 v[28:31], v[68:71], v[16:19], v[28:31]
v_mov_b32 v16, 0
v_mov_b32 v17, 0
v_rcp_f32 v12, v12
v_mov_b32 v18, 0
v_mov_b32 v19, 0
v_pk_mul_f32 v[24:25], v[24:25], v[12:13] op_sel_hi:[1,0]
v_pk_mul_f32 v[26:27], v[26:27], v[12:13] op_sel_hi:[1,0]
v_mov_b32 v15, 0
v_pk_mul_f32 v[28:29], v[28:29], v[12:13] op_sel_hi:[1,0]
v_pk_mul_f32 v[30:31], v[30:31], v[12:13] op_sel_hi:[1,0]
v_cvt_pk_bf16_f32 v24, v24, v28
v_cvt_pk_bf16_f32 v25, v25, v29
v_cvt_pk_bf16_f32 v26, v26, v30
v_cvt_pk_bf16_f32 v27, v27, v31
v_mfma_f32_16x16x32_bf16 v[56:59], v[20:23], v[20:23], 0
ds_write_b128 v7, v[24:27]
v_mfma_f32_16x16x32_bf16 v[60:63], v[20:23], v[20:23], 0
v_mov_b32 v12, 0
v_mov_b32 v13, 0
v_mov_b32 v14, 0
v_mov_b32 v3, 6528
s_nop 1
v_mfma_f32_16x16x32_bf16 v[64:67], v[20:23], v[20:23], 0
s_cmp_eq_u32 s19, 63
s_cbranch_scc1 L_texit
s_waitcnt lgkmcnt(0)
s_barrier
ds_read_b128 v[24:27], v1 offset:3200
v_mfma_f32_16x16x32_bf16 v[68:71], v[20:23], v[20:23], 0
ds_read_b128 v[28:31], v1 offset:4224
s_nop 2
v_mfma_f32_16x16x32_bf16 v[68:71], v[20:23], v[20:23], 0
s_waitcnt lgkmcnt(1)
v_smfmac_f32_16x16x64_bf16 v[12:15], v[24:27], a[248:255], v0
v_smfmac_f32_16x16x64_bf16 v[16:19], v[24:27], a[176:183], v0
s_waitcnt lgkmcnt(0)
v_smfmac_f32_16x16x64_bf16 v[12:15], v[28:31], v[40:47], v0
ds_read_b128 v[40:43], v2 offset:24576
v_smfmac_f32_16x16x64_bf16 v[16:19], v[28:31], v[48:55], v0
ds_read_b128 v[44:47], v2 offset:25600
v_smfmac_f32_16x16x64_bf16 v[20:23], v[24:27], a[184:191], v0
ds_read_b128 v[48:51], v2 offset:26624
v_smfmac_f32_16x16x64_bf16 v[20:23], v[28:31], v[32:39], v0
ds_read_b128 v[52:55], v2 offset:27648
s_nop 0
v_add_f32 v12, v12, v13
v_add_f32 v14, v14, v15
v_smfmac_f32_16x16x64_bf16 v[56:59], v[24:27], a[192:199], v0
ds_read_b128 v[32:35], v2 offset:28672
s_waitcnt lgkmcnt(3)
v_cvt_pk_bf16_f32 v12, v12, v14
buffer_store_dword v12, v10, s[8:11], s28 offen
v_smfmac_f32_16x16x64_bf16 v[56:59], v[28:31], v[40:47], v0
ds_read_b128 v[36:39], v2 offset:29696
v_add_f32 v16, v16, v17
v_add_f32 v18, v18, v19
v_smfmac_f32_16x16x64_bf16 v[60:63], v[24:27], a[200:207], v0
ds_read_b128 v[12:15], v3
s_waitcnt lgkmcnt(3)
v_cvt_pk_bf16_f32 v16, v16, v18
v_add_f32 v20, v20, v21
v_smfmac_f32_16x16x64_bf16 v[60:63], v[28:31], v[48:55], v0
ds_read_b128 v[40:43], v2 offset:30720
v_add_f32 v22, v22, v23
v_cvt_pk_bf16_f32 v17, v20, v22
v_smfmac_f32_16x16x64_bf16 v[64:67], v[24:27], a[208:215], v0
ds_read_b128 v[44:47], v2 offset:31744
s_waitcnt lgkmcnt(3)
buffer_store_dwordx2 v[16:17], v9, s[8:11], s28 offen
v_add_f32 v56, v56, v57
v_smfmac_f32_16x16x64_bf16 v[64:67], v[28:31], v[32:39], v0
ds_read_b128 v[48:51], v2 offset:32768
v_add_f32 v58, v58, v59
v_cvt_pk_bf16_f32 v56, v56, v58
v_smfmac_f32_16x16x64_bf16 v[68:71], v[24:27], a[216:223], v0
ds_read_b128 v[52:55], v2 offset:33792
s_waitcnt lgkmcnt(2)
v_add_f32 v60, v60, v61
v_add_f32 v62, v62, v63
v_smfmac_f32_16x16x64_bf16 v[68:71], v[28:31], v[40:47], v0
ds_read_b128 v[20:23], v3
v_cvt_pk_bf16_f32 v57, v60, v62
buffer_store_dwordx2 v[56:57], v9, s[8:11], s50 offen
v_smfmac_f32_16x16x64_bf16 v[12:15], v[24:27], a[224:231], v0
s_waitcnt lgkmcnt(1)
v_add_f32 v64, v64, v65
v_add_f32 v66, v66, v67
v_smfmac_f32_16x16x64_bf16 v[12:15], v[28:31], v[48:55], v0
s_waitcnt lgkmcnt(0)
v_cvt_pk_bf16_f32 v64, v64, v66
v_smfmac_f32_16x16x64_bf16 v[20:23], v[24:27], a[232:239], v0
v_add_f32 v68, v68, v69
v_add_f32 v70, v70, v71
v_smfmac_f32_16x16x64_bf16 v[20:23], v[28:31], a[240:247], v0
v_cvt_pk_bf16_f32 v65, v68, v70
buffer_store_dwordx2 v[64:65], v9, s[8:11], s51 offen
v_add_f32 v12, v12, v13
v_add_f32 v14, v14, v15
v_cvt_pk_bf16_f32 v12, v12, v14
s_nop 2
v_add_f32 v20, v20, v21
v_add_f32 v22, v22, v23
v_cvt_pk_bf16_f32 v13, v20, v22
buffer_store_dwordx2 v[12:13], v9, s[8:11], s52 offen
s_add_u32 s19, s19, 1
s_mov_b32 s20, s28
s_mov_b32 s28, s29
s_mov_b32 s29, s20
s_and_b32 s20, s19, 3
s_lshl_b32 s20, s20, 14
s_add_u32 s33, s20, 110100480
s_add_u32 s34, s20, s24
s_xor_b32 s20, s20, 32768
s_add_u32 s35, s20, s24
s_add_u32 s30, s30, 16384
s_add_u32 s31, s31, 131072
s_add_u32 s6, s33, 4096
s_add_u32 s7, s33, 8192
s_mov_b32 s22, 0
v_mov_b64 v[24:25], 0
v_mov_b64 v[26:27], 0
v_mov_b64 v[28:29], 0
v_mov_b64 v[30:31], 0
v_and_b32 v69, 0x380, v1
v_add_u32 v69, v69, v1
v_and_b32 v70, 0xf00, v1
v_add_u32 v70, v70, v1
v_mov_b64 v[64:65], -1
v_mov_b64 v[66:67], -1
v_xor_b32 v3, 16, v4
ds_read_b128 v[48:51], v2 offset:10240
ds_read_b128 v[52:55], v2 offset:11264
v_mov_b32 v56, 0x3f80
v_cndmask_b32 v56, v56, 1.0, s[44:45]
v_cndmask_b32 v60, 0, v56, s[36:37]
v_cndmask_b32 v61, 0, v56, s[38:39]
v_cndmask_b32 v62, 0, v56, s[40:41]
v_cndmask_b32 v63, 0, v56, s[42:43]
s_nop 5
buffer_load_dwordx4 v[32:35], v1, s[8:11], s49 offen offset:0 sc1
buffer_load_dwordx4 v[36:39], v1, s[8:11], s49 offen offset:1024 sc1
buffer_load_dwordx4 v[40:43], v1, s[8:11], s49 offen offset:2048 sc1
buffer_load_dwordx4 v[44:47], v1, s[8:11], s49 offen offset:3072 sc1
s_waitcnt vmcnt(3)
v_mfma_f32_16x16x32_bf16 v[56:59], v[32:35], v[60:63], 0
v_max3_u32 v16, v32, v33, v34
v_max_u32 v16, v16, v35
s_waitcnt vmcnt(2)
v_mfma_f32_16x16x32_bf16 v[56:59], v[36:39], v[60:63], v[56:59]
v_max3_u32 v16, v16, v36, v37
v_max3_u32 v16, v16, v38, v39
s_waitcnt vmcnt(1)
v_mfma_f32_16x16x32_bf16 v[56:59], v[40:43], v[60:63], v[56:59]
v_max3_u32 v16, v16, v40, v41
v_max3_u32 v16, v16, v42, v43
s_waitcnt vmcnt(0)
v_mfma_f32_16x16x32_bf16 v[56:59], v[44:47], v[60:63], v[56:59]
v_max3_u32 v16, v16, v44, v45
v_max3_u32 v16, v16, v46, v47
v_cmp_le_u32 vcc, 0xffff0000, v16
s_cbranch_vccnz L_red1
L_redb1:
s_nop 3
v_permlane32_swap_b32 v56, v58
v_permlane32_swap_b32 v57, v59
v_pk_add_f32 v[56:57], v[56:57], v[58:59]
v_cvt_pk_bf16_f32 v56, v56, v57
buffer_store_dword v56, v11, s[8:11], s34 offen
s_barrier
ds_read_b128 v[40:43], v2 offset:2048
ds_read_b128 v[44:47], v2 offset:3072
v_mov_b64 v[32:33], 0
v_mov_b64 v[34:35], 0
v_mov_b64 v[36:37], 0
v_mov_b64 v[38:39], 0
v_mov_b64 v[56:57], 0
v_mov_b64 v[58:59], 0
v_mov_b64 v[60:61], 0
v_mov_b64 v[62:63], 0
s_nop 15
s_nop 13
s_branch L_gat1
L_red1:
L_red1b:
buffer_load_dwordx4 v[32:35], v1, s[8:11], s49 offen offset:0 sc1
buffer_load_dwordx4 v[36:39], v1, s[8:11], s49 offen offset:1024 sc1
buffer_load_dwordx4 v[40:43], v1, s[8:11], s49 offen offset:2048 sc1
buffer_load_dwordx4 v[44:47], v1, s[8:11], s49 offen offset:3072 sc1
s_add_u32 s22, s22, 1
s_cmp_gt_u32 s22, 40000
s_cbranch_scc1 L_end
s_waitcnt vmcnt(3)
v_mfma_f32_16x16x32_bf16 v[56:59], v[32:35], v[60:63], 0
v_max3_u32 v16, v32, v33, v34
v_max_u32 v16, v16, v35
s_waitcnt vmcnt(2)
v_mfma_f32_16x16x32_bf16 v[56:59], v[36:39], v[60:63], v[56:59]
v_max3_u32 v16, v16, v36, v37
v_max3_u32 v16, v16, v38, v39
s_waitcnt vmcnt(1)
v_mfma_f32_16x16x32_bf16 v[56:59], v[40:43], v[60:63], v[56:59]
v_max3_u32 v16, v16, v40, v41
v_max3_u32 v16, v16, v42, v43
s_waitcnt vmcnt(0)
v_mfma_f32_16x16x32_bf16 v[56:59], v[44:47], v[60:63], v[56:59]
v_max3_u32 v16, v16, v44, v45
v_max3_u32 v16, v16, v46, v47
v_cmp_le_u32 vcc, 0xffff0000, v16
s_cbranch_vccz L_redb1
s_branch L_red1b
L_ent2:
v_mov_b64 v[24:25], 0
v_mov_b64 v[26:27], 0
v_mov_b64 v[28:29], 0
v_mov_b64 v[30:31], 0
v_and_b32 v69, 0x380, v1
v_add_u32 v69, v69, v1
v_and_b32 v70, 0xf00, v1
v_add_u32 v70, v70, v1
v_mov_b64 v[64:65], -1
v_mov_b64 v[66:67], -1
v_xor_b32 v3, 16, v4
ds_read_b128 v[48:51], v2 offset:12288
ds_read_b128 v[52:55], v2 offset:13312
ds_read_b128 v[40:43], v2 offset:4096
ds_read_b128 v[44:47], v2 offset:5120
v_mov_b64 v[32:33], 0
v_mov_b64 v[34:35], 0
v_mov_b64 v[36:37], 0
v_mov_b64 v[38:39], 0
v_mov_b64 v[56:57], 0
v_mov_b64 v[58:59], 0
v_mov_b64 v[60:61], 0
v_mov_b64 v[62:63], 0
s_add_u32 s20, s30, 2048
s_add_u32 s21, s30, 8192
s_add_u32 s49, s29, s25
s_add_u32 s50, s29, s26
s_add_u32 s51, s29, s27
s_add_u32 s52, s30, 16384
s_mov_b32 m0, 19968
s_waitcnt vmcnt(0) lgkmcnt(0)
s_branch L_step2
L_gr2:
buffer_load_dwordx4 v[12:15], v1, s[8:11], s33 offen sc1
buffer_load_dword v20, v8, s[8:11], s7 offen sc1
buffer_load_dwordx4 v[16:19], v1, s[8:11], s6 offen sc1
s_add_u32 s22, s22, 1
s_cmp_gt_u32 s22, 40000
s_cbranch_scc1 L_end
s_nop 0
v_mov_b64 v[24:25], 0
v_mov_b64 v[26:27], 0
v_mov_b64 v[28:29], 0
v_mov_b64 v[30:31], 0
v_mov_b64 v[32:33], 0
v_mov_b64 v[34:35], 0
v_mov_b64 v[36:37], 0
v_mov_b64 v[38:39], 0
v_mov_b64 v[56:57], 0
v_mov_b64 v[58:59], 0
v_mov_b64 v[60:61], 0
v_mov_b64 v[62:63], 0
s_waitcnt lgkmcnt(0)
s_branch L_step2
.p2align 3
L_gat2:
buffer_load_dwordx4 v[12:15], v1, s[8:11], s33 offen sc1
buffer_load_dword v20, v8, s[8:11], s7 offen sc1
buffer_load_dwordx4 v[16:19], v1, s[8:11], s6 offen sc1
s_add_u32 s20, s30, 2048
s_add_u32 s21, s30, 8192
s_add_u32 s49, s29, s25
s_add_u32 s50, s29, s26
s_add_u32 s51, s29, s27
s_add_u32 s52, s30, 16384
s_mov_b32 m0, 19968
s_waitcnt lgkmcnt(0)
L_step2:
s_waitcnt vmcnt(2)
v_smfmac_f32_16x16x64_bf16 v[24:27], v[12:15], v[120:127], v0
ds_write_b128 v1, v[12:15] offset:6656
v_smfmac_f32_16x16x64_bf16 v[28:31], v[12:15], v[128:135], v0
s_waitcnt vmcnt(1)
ds_write_b32 v8, v20 offset:14848
v_smfmac_f32_16x16x64_bf16 v[32:35], v[12:15], v[136:143], v0
s_waitcnt vmcnt(0)
ds_write_b128 v1, v[16:19] offset:10752
v_smfmac_f32_16x16x64_bf16 v[56:59], v[12:15], a[64:71], v0
v_max3_u32 v21, v12, v13, v14
v_max3_u32 v21, v21, v15, v20
v_smfmac_f32_16x16x64_bf16 v[60:63], v[12:15], a[72:79], v0
v_max3_u32 v21, v21, v16, v17
v_max3_u32 v21, v21, v18, v19
v_smfmac_f32_16x16x64_bf16 v[36:39], v[12:15], v[40:47], v0
v_cmp_le_u32 vcc, 0xffff0000, v21
v_smfmac_f32_16x16x64_bf16 v[24:27], v[16:19], v[216:223], v0
s_cbranch_vccnz L_gr2
v_smfmac_f32_16x16x64_bf16 v[28:31], v[16:19], v[224:231], v0
s_waitcnt lgkmcnt(0)
s_barrier
ds_read_b128 v[20:23], v1 offset:4608
v_smfmac_f32_16x16x64_bf16 v[32:35], v[16:19], v[232:239], v0
ds_read_b128 v[12:15], v1 offset:5632
buffer_load_dwordx4 v69, s[8:11], s20 offen sc1 lds
v_smfmac_f32_16x16x64_bf16 v[56:59], v[16:19], a[128:135], v0
ds_read_b128 v[40:43], v2 offset:0
s_mov_b32 m0, 20864
v_smfmac_f32_16x16x64_bf16 v[60:63], v[16:19], a[136:143], v0
ds_read_b128 v[44:47], v2 offset:1024
v_smfmac_f32_16x16x64_bf16 v[36:39], v[16:19], v[48:55], v0
ds_read_b128 v[16:19], v1 offset:7680
s_waitcnt lgkmcnt(4)
v_smfmac_f32_16x16x64_bf16 v[24:27], v[20:23], v[72:79], v0
ds_read_b128 v[48:51], v2 offset:2048
buffer_load_dwordx4 v69, s[8:11], s20 offen offset:128 sc1 lds
v_smfmac_f32_16x16x64_bf16 v[28:31], v[20:23], v[80:87], v0
ds_read_b128 v[52:55], v2 offset:3072
s_mov_b32 m0, 6272
v_smfmac_f32_16x16x64_bf16 v[32:35], v[20:23], v[88:95], v0
buffer_store_dword v0, v11, s[8:11], s35 offen
s_waitcnt lgkmcnt(3)
v_smfmac_f32_16x16x64_bf16 v[36:39], v[20:23], v[40:47], v0
ds_read_b128 v[20:23], v1 offset:8704
v_smfmac_f32_16x16x64_bf16 v[24:27], v[12:15], v[96:103], v0
ds_read_b128 v[40:43], v2 offset:6144
v_smfmac_f32_16x16x64_bf16 v[28:31], v[12:15], v[104:111], v0
ds_read_b128 v[44:47], v2 offset:7168
v_smfmac_f32_16x16x64_bf16 v[32:35], v[12:15], v[112:119], v0
buffer_store_dwordx4 v[64:67], v1, s[8:11], s49 offen
s_waitcnt lgkmcnt(3)
v_smfmac_f32_16x16x64_bf16 v[36:39], v[12:15], v[48:55], v0
ds_read_b128 v[12:15], v1 offset:9728
v_smfmac_f32_16x16x64_bf16 v[24:27], v[16:19], v[144:151], v0
ds_read_b128 v[48:51], v2 offset:8192
v_smfmac_f32_16x16x64_bf16 v[28:31], v[16:19], v[152:159], v0
ds_read_b128 v[52:55], v2 offset:9216
v_smfmac_f32_16x16x64_bf16 v[32:35], v[16:19], v[160:167], v0
buffer_store_dwordx4 v[64:67], v1, s[8:11], s50 offen
s_waitcnt lgkmcnt(3)
v_smfmac_f32_16x16x64_bf16 v[36:39], v[16:19], v[40:47], v0
ds_read_b128 v[16:19], v1 offset:11776
v_smfmac_f32_16x16x64_bf16 v[24:27], v[20:23], v[168:175], v0
ds_read_b128 v[40:43], v2 offset:10240
v_smfmac_f32_16x16x64_bf16 v[28:31], v[20:23], v[176:183], v0
ds_read_b128 v[44:47], v2 offset:11264
v_smfmac_f32_16x16x64_bf16 v[32:35], v[20:23], v[184:191], v0
buffer_store_dwordx4 v[64:67], v1, s[8:11], s51 offen
s_waitcnt lgkmcnt(3)
v_smfmac_f32_16x16x64_bf16 v[36:39], v[20:23], v[48:55], v0
ds_read_b128 v[20:23], v1 offset:12800
v_smfmac_f32_16x16x64_bf16 v[24:27], v[12:15], v[192:199], v0
ds_read_b128 v[48:51], v2 offset:14336
buffer_load_dwordx4 v[64:67], v70, s[8:11], s21 offen sc1
v_smfmac_f32_16x16x64_bf16 v[28:31], v[12:15], v[200:207], v0
ds_read_b128 v[52:55], v2 offset:15360
v_smfmac_f32_16x16x64_bf16 v[32:35], v[12:15], v[208:215], v0
s_waitcnt lgkmcnt(3)
v_smfmac_f32_16x16x64_bf16 v[36:39], v[12:15], v[40:47], v0
ds_read_b128 v[12:15], v1 offset:4608
v_smfmac_f32_16x16x64_bf16 v[24:27], v[16:19], v[240:247], v0
ds_read_b128 v[40:43], v2 offset:16384
buffer_load_dwordx4 v[68:71], v70, s[8:11], s21 offen offset:256 sc1
v_smfmac_f32_16x16x64_bf16 v[28:31], v[16:19], v[248:255], v0
ds_read_b128 v[44:47], v2 offset:17408
v_smfmac_f32_16x16x64_bf16 v[32:35], v[16:19], a[0:7], v0
s_waitcnt lgkmcnt(3)
v_smfmac_f32_16x16x64_bf16 v[36:39], v[16:19], v[48:55], v0
ds_read_b128 v[16:19], v1 offset:5632
v_smfmac_f32_16x16x64_bf16 v[24:27], v[20:23], a[8:15], v0
v_smfmac_f32_16x16x64_bf16 v[28:31], v[20:23], a[16:23], v0
v_smfmac_f32_16x16x64_bf16 v[32:35], v[20:23], a[24:31], v0
s_waitcnt lgkmcnt(1)
v_smfmac_f32_16x16x64_bf16 v[36:39], v[20:23], v[40:47], v0
ds_read_b128 v[20:23], v1 offset:7680
v_smfmac_f32_16x16x64_bf16 v[56:59], v[12:15], a[32:39], v0
s_nop 1
v_add_f32 v24, v24, v25
v_add_f32 v26, v26, v27
v_add_f32 v28, v28, v29
v_add_f32 v30, v30, v31
v_cvt_pk_bf16_f32 v24, v24, v28
v_cvt_pk_bf16_f32 v26, v26, v30
ds_write_b32 v4, v24 offset:2176
v_add_f32 v32, v32, v33
v_add_f32 v34, v34, v35
v_add_f32 v36, v36, v37
v_add_f32 v38, v38, v39
ds_write_b32 v3, v26 offset:2176
v_cvt_pk_bf16_f32 v32, v32, v36
v_cvt_pk_bf16_f32 v34, v34, v38
ds_write_b32 v4, v32
v_smfmac_f32_16x16x64_bf16 v[60:63], v[12:15], a[40:47], v0
ds_write_b32 v3, v34
s_waitcnt lgkmcnt(5)
v_smfmac_f32_16x16x64_bf16 v[56:59], v[16:19], a[48:55], v0
ds_read_b128 v[12:15], v1 offset:8704
v_smfmac_f32_16x16x64_bf16 v[60:63], v[16:19], a[56:63], v0
ds_read_b128 v[16:19], v1 offset:9728
s_waitcnt lgkmcnt(6)
v_smfmac_f32_16x16x64_bf16 v[56:59], v[20:23], a[80:87], v0
s_waitcnt lgkmcnt(2) vmcnt(6)
s_barrier
ds_read_b128 v[32:35], v5 offset:1024
v_smfmac_f32_16x16x64_bf16 v[60:63], v[20:23], a[88:95], v0
ds_read_b128 v[20:23], v1 offset:11776
s_waitcnt lgkmcnt(3)
v_smfmac_f32_16x16x64_bf16 v[56:59], v[12:15], a[96:103], v0
ds_read_b128 v[48:51], v1 offset:17920
v_smfmac_f32_16x16x64_bf16 v[60:63], v[12:15], a[104:111], v0
ds_read_b128 v[12:15], v1 offset:12800
s_waitcnt lgkmcnt(4)
v_smfmac_f32_16x16x64_bf16 v[56:59], v[16:19], a[112:119], v0
ds_read_b128 v[36:39], v5 offset:1536
v_smfmac_f32_16x16x64_bf16 v[60:63], v[16:19], a[120:127], v0
ds_read_b128 v[52:55], v1 offset:19968
s_waitcnt lgkmcnt(4)
v_smfmac_f32_16x16x64_bf16 v[56:59], v[20:23], a[144:151], v0
ds_read_b128 v[24:27], v5 offset:0
v_smfmac_f32_16x16x64_bf16 v[60:63], v[20:23], a[152:159], v0
ds_read_b128 v[40:43], v1 offset:13824
s_waitcnt lgkmcnt(4)
v_smfmac_f32_16x16x64_bf16 v[56:59], v[12:15], a[160:167], v0
ds_read_b128 v[28:31], v5 offset:512
s_mov_b64 exec, s[86:87]
buffer_store_dwordx4 v[32:35], v5, s[8:11], s31 offen offset:1024 sc1
s_mov_b64 exec, -1
v_smfmac_f32_16x16x64_bf16 v[60:63], v[12:15], a[168:175], v0
ds_read_b128 v[44:47], v1 offset:15872
v_mfma_f32_16x16x32_bf16 v[16:19], v[48:51], v[32:35], 0
ds_read_b128 v[48:51], v1 offset:18944
s_waitcnt lgkmcnt(5)
v_mfma_f32_16x16x32_bf16 v[16:19], v[52:55], v[36:39], v[16:19]
ds_read_b128 v[52:55], v1 offset:20992
s_waitcnt lgkmcnt(4)
v_mfma_f32_16x16x32_bf16 v[16:19], v[40:43], v[24:27], v[16:19]
ds_read_b128 v[40:43], v1 offset:14848
s_waitcnt lgkmcnt(3)
v_mfma_f32_16x16x32_bf16 v[16:19], v[44:47], v[28:31], v[16:19]
ds_read_b128 v[44:47], v1 offset:16896
v_mfma_f32_16x16x32_bf16 v[20:23], v[32:35], v[32:35], 0
v_add_f32 v56, v56, v57
v_add_f32 v58, v58, v59
v_mfma_f32_16x16x32_bf16 v[20:23], v[36:39], v[36:39], v[20:23]
v_add_f32 v60, v60, v61
v_add_f32 v62, v62, v63
v_mfma_f32_16x16x32_bf16 v[20:23], v[24:27], v[24:27], v[20:23]
v_cvt_pk_bf16_f32 v56, v56, v58
v_cvt_pk_bf16_f32 v57, v60, v62
v_mfma_f32_16x16x32_bf16 v[20:23], v[28:31], v[28:31], v[20:23]
v_lshrrev_b32 v58, 1, v1
v_max3_f32 v59, v16, v17, v18
s_waitcnt lgkmcnt(3)
v_mfma_f32_16x16x32_bf16 v[12:15], v[48:51], v[32:35], 0
ds_read_b128 v[48:51], v2 offset:20480
s_waitcnt lgkmcnt(3)
v_mfma_f32_16x16x32_bf16 v[12:15], v[52:55], v[36:39], v[12:15]
ds_read_b128 v[52:55], v2 offset:21504
s_waitcnt lgkmcnt(3)
v_mfma_f32_16x16x32_bf16 v[12:15], v[40:43], v[24:27], v[12:15]
ds_read_b128 v[40:43], v2 offset:18432
buffer_store_dwordx2 v[56:57], v58, s[8:11], s31 offen offset:2048 sc1
s_waitcnt lgkmcnt(3)
v_mfma_f32_16x16x32_bf16 v[12:15], v[44:47], v[28:31], v[12:15]
ds_read_b128 v[44:47], v2 offset:19456
v_max3_f32 v59, v59, v19, v20
v_max_f32 v59, v59, v21
v_mov_b32 v60, s53
s_add_u32 s49, s28, s23
v_mov_b32 v61, s53
s_add_u32 s50, s28, 65536
v_mov_b32 v62, s53
ds_read_b128 v[32:35], v2 offset:22528
v_mov_b32 v63, s53
v_max3_f32 v59, v59, v12, v13
v_max3_f32 v22, v59, v14, v15
v_max3_f32 v59, v59, v14, v15
s_add_u32 s51, s28, 131072
s_add_u32 s52, s28, 196608
v_permlane32_swap_b32 v22, v59
v_max_f32 v23, v59, v22
v_max_f32 v59, v59, v22
v_mov_b32 v22, 0
ds_read_b128 v[36:39], v2 offset:23552
v_permlane16_swap_b32 v23, v59
v_max_f32 v59, v59, v23
v_mul_f32 v58, s18, v59
v_pk_fma_f32 v[20:21], v[20:21], s[18:19], v[58:59] op_sel_hi:[1,0,0] neg_lo:[0,0,1] neg_hi:[0,0,1]
v_pk_fma_f32 v[16:17], v[16:17], s[18:19], v[58:59] op_sel_hi:[1,0,0] neg_lo:[0,0,1] neg_hi:[0,0,1]
v_pk_fma_f32 v[18:19], v[18:19], s[18:19], v[58:59] op_sel_hi:[1,0,0] neg_lo:[0,0,1] neg_hi:[0,0,1]
v_pk_fma_f32 v[12:13], v[12:13], s[18:19], v[58:59] op_sel_hi:[1,0,0] neg_lo:[0,0,1] neg_hi:[0,0,1]
v_pk_fma_f32 v[14:15], v[14:15], s[18:19], v[58:59] op_sel_hi:[1,0,0] neg_lo:[0,0,1] neg_hi:[0,0,1]
v_exp_f32 v20, v20
v_exp_f32 v21, v21
v_exp_f32 v16, v16
v_cvt_pk_bf16_f32 v23, v20, v21
v_cvt_pk_bf16_f32 v20, v20, v21
v_mov_b32 v21, 0
v_exp_f32 v17, v17
v_exp_f32 v18, v18
v_mfma_f32_16x16x16_bf16 v[24:27], v[56:57], v[20:21], 0
v_exp_f32 v19, v19
v_mfma_f32_16x16x16_bf16 v[28:31], v[56:57], v[22:23], 0
v_exp_f32 v12, v12
v_exp_f32 v13, v13
v_cvt_pk_bf16_f32 v16, v16, v17
v_cvt_pk_bf16_f32 v17, v18, v19
v_exp_f32 v14, v14
v_exp_f32 v15, v15
v_cvt_pk_bf16_f32 v18, v12, v13
v_cvt_pk_bf16_f32 v19, v14, v15
v_mfma_f32_16x16x16_bf16 v[12:15], v[60:61], v[20:21], 0
s_waitcnt vmcnt(2)
v_mfma_f32_16x16x32_bf16 v[12:15], v[60:63], v[16:19], v[12:15]
v_mov_b32 v20, 0
v_mov_b32 v23, 0
v_mfma_f32_16x16x32_bf16 v[24:27], v[64:67], v[16:19], v[24:27]
s_nop 1
v_mfma_f32_16x16x32_bf16 v[28:31], v[68:71], v[16:19], v[28:31]
v_mov_b32 v16, 0
v_mov_b32 v17, 0
v_rcp_f32 v12, v12
v_mov_b32 v18, 0
v_mov_b32 v19, 0
v_pk_mul_f32 v[24:25], v[24:25], v[12:13] op_sel_hi:[1,0]
v_pk_mul_f32 v[26:27], v[26:27], v[12:13] op_sel_hi:[1,0]
v_mov_b32 v15, 0
v_pk_mul_f32 v[28:29], v[28:29], v[12:13] op_sel_hi:[1,0]
v_pk_mul_f32 v[30:31], v[30:31], v[12:13] op_sel_hi:[1,0]
v_cvt_pk_bf16_f32 v24, v24, v28
v_cvt_pk_bf16_f32 v25, v25, v29
v_cvt_pk_bf16_f32 v26, v26, v30
v_cvt_pk_bf16_f32 v27, v27, v31
v_mfma_f32_16x16x32_bf16 v[56:59], v[20:23], v[20:23], 0
ds_write_b128 v7, v[24:27]
v_mfma_f32_16x16x32_bf16 v[60:63], v[20:23], v[20:23], 0
v_mov_b32 v12, 0
v_mov_b32 v13, 0
v_mov_b32 v14, 0
v_mov_b32 v3, 6528
s_nop 1
v_mfma_f32_16x16x32_bf16 v[64:67], v[20:23], v[20:23], 0
s_cmp_eq_u32 s19, 63
s_cbranch_scc1 L_texit
s_waitcnt lgkmcnt(0)
s_barrier
ds_read_b128 v[24:27], v1 offset:2176
v_mfma_f32_16x16x32_bf16 v[68:71], v[20:23], v[20:23], 0
ds_read_b128 v[28:31], v1 offset:3200
s_nop 2
v_mfma_f32_16x16x32_bf16 v[68:71], v[20:23], v[20:23], 0
s_waitcnt lgkmcnt(1)
v_smfmac_f32_16x16x64_bf16 v[12:15], v[24:27], a[248:255], v0
v_smfmac_f32_16x16x64_bf16 v[16:19], v[24:27], a[176:183], v0
s_waitcnt lgkmcnt(0)
v_smfmac_f32_16x16x64_bf16 v[12:15], v[28:31], v[40:47], v0
ds_read_b128 v[40:43], v2 offset:24576
v_smfmac_f32_16x16x64_bf16 v[16:19], v[28:31], v[48:55], v0
ds_read_b128 v[44:47], v2 offset:25600
v_smfmac_f32_16x16x64_bf16 v[20:23], v[24:27], a[184:191], v0
ds_read_b128 v[48:51], v2 offset:26624
v_smfmac_f32_16x16x64_bf16 v[20:23], v[28:31], v[32:39], v0
ds_read_b128 v[52:55], v2 offset:27648
s_nop 0
v_add_f32 v12, v12, v13
v_add_f32 v14, v14, v15
v_smfmac_f32_16x16x64_bf16 v[56:59], v[24:27], a[192:199], v0
ds_read_b128 v[32:35], v2 offset:28672
s_waitcnt lgkmcnt(3)
v_cvt_pk_bf16_f32 v12, v12, v14
buffer_store_dword v12, v10, s[8:11], s28 offen
v_smfmac_f32_16x16x64_bf16 v[56:59], v[28:31], v[40:47], v0
ds_read_b128 v[36:39], v2 offset:29696
v_add_f32 v16, v16, v17
v_add_f32 v18, v18, v19
v_smfmac_f32_16x16x64_bf16 v[60:63], v[24:27], a[200:207], v0
ds_read_b128 v[12:15], v3
s_waitcnt lgkmcnt(3)
v_cvt_pk_bf16_f32 v16, v16, v18
v_add_f32 v20, v20, v21
v_smfmac_f32_16x16x64_bf16 v[60:63], v[28:31], v[48:55], v0
ds_read_b128 v[40:43], v2 offset:30720
v_add_f32 v22, v22, v23
v_cvt_pk_bf16_f32 v17, v20, v22
v_smfmac_f32_16x16x64_bf16 v[64:67], v[24:27], a[208:215], v0
ds_read_b128 v[44:47], v2 offset:31744
s_waitcnt lgkmcnt(3)
buffer_store_dwordx2 v[16:17], v9, s[8:11], s28 offen
v_add_f32 v56, v56, v57
v_smfmac_f32_16x16x64_bf16 v[64:67], v[28:31], v[32:39], v0
ds_read_b128 v[48:51], v2 offset:32768
v_add_f32 v58, v58, v59
v_cvt_pk_bf16_f32 v56, v56, v58
v_smfmac_f32_16x16x64_bf16 v[68:71], v[24:27], a[216:223], v0
ds_read_b128 v[52:55], v2 offset:33792
s_waitcnt lgkmcnt(2)
v_add_f32 v60, v60, v61
v_add_f32 v62, v62, v63
v_smfmac_f32_16x16x64_bf16 v[68:71], v[28:31], v[40:47], v0
ds_read_b128 v[20:23], v3
v_cvt_pk_bf16_f32 v57, v60, v62
buffer_store_dwordx2 v[56:57], v9, s[8:11], s50 offen
v_smfmac_f32_16x16x64_bf16 v[12:15], v[24:27], a[224:231], v0
s_waitcnt lgkmcnt(1)
v_add_f32 v64, v64, v65
v_add_f32 v66, v66, v67
v_smfmac_f32_16x16x64_bf16 v[12:15], v[28:31], v[48:55], v0
s_waitcnt lgkmcnt(0)
v_cvt_pk_bf16_f32 v64, v64, v66
v_smfmac_f32_16x16x64_bf16 v[20:23], v[24:27], a[232:239], v0
v_add_f32 v68, v68, v69
v_add_f32 v70, v70, v71
v_smfmac_f32_16x16x64_bf16 v[20:23], v[28:31], a[240:247], v0
v_cvt_pk_bf16_f32 v65, v68, v70
buffer_store_dwordx2 v[64:65], v9, s[8:11], s51 offen
v_add_f32 v12, v12, v13
v_add_f32 v14, v14, v15
v_cvt_pk_bf16_f32 v12, v12, v14
s_nop 2
v_add_f32 v20, v20, v21
v_add_f32 v22, v22, v23
v_cvt_pk_bf16_f32 v13, v20, v22
buffer_store_dwordx2 v[12:13], v9, s[8:11], s52 offen
s_cmp_eq_u32 s48, 0
s_cbranch_scc1 L_nojob2
s_add_u32 s19, s19, 1
s_mov_b32 s20, s28
s_mov_b32 s28, s29
s_mov_b32 s29, s20
s_and_b32 s20, s19, 3
s_lshl_b32 s20, s20, 14
s_add_u32 s33, s20, 110100480
s_add_u32 s34, s20, s24
s_xor_b32 s20, s20, 32768
s_add_u32 s35, s20, s24
s_add_u32 s30, s30, 16384
s_add_u32 s31, s31, 131072
s_add_u32 s6, s33, 4096
s_add_u32 s7, s33, 8192
s_mov_b32 s22, 0
v_mov_b64 v[24:25], 0
v_mov_b64 v[26:27], 0
v_mov_b64 v[28:29], 0
v_mov_b64 v[30:31], 0
v_and_b32 v69, 0x380, v1
v_add_u32 v69, v69, v1
v_and_b32 v70, 0xf00, v1
v_add_u32 v70, v70, v1
v_mov_b64 v[64:65], -1
v_mov_b64 v[66:67], -1
v_xor_b32 v3, 16, v4
ds_read_b128 v[48:51], v2 offset:12288
ds_read_b128 v[52:55], v2 offset:13312
v_mov_b32 v56, 0x3f80
v_cndmask_b32 v56, v56, 1.0, s[44:45]
v_cndmask_b32 v60, 0, v56, s[36:37]
v_cndmask_b32 v61, 0, v56, s[38:39]
v_cndmask_b32 v62, 0, v56, s[40:41]
v_cndmask_b32 v63, 0, v56, s[42:43]
s_nop 5
buffer_load_dwordx4 v[32:35], v1, s[8:11], s49 offen offset:0 sc1
buffer_load_dwordx4 v[36:39], v1, s[8:11], s49 offen offset:1024 sc1
buffer_load_dwordx4 v[40:43], v1, s[8:11], s49 offen offset:2048 sc1
buffer_load_dwordx4 v[44:47], v1, s[8:11], s49 offen offset:3072 sc1
s_waitcnt vmcnt(3)
v_mfma_f32_16x16x32_bf16 v[56:59], v[32:35], v[60:63], 0
v_max3_u32 v16, v32, v33, v34
v_max_u32 v16, v16, v35
s_waitcnt vmcnt(2)
v_mfma_f32_16x16x32_bf16 v[56:59], v[36:39], v[60:63], v[56:59]
v_max3_u32 v16, v16, v36, v37
v_max3_u32 v16, v16, v38, v39
s_waitcnt vmcnt(1)
v_mfma_f32_16x16x32_bf16 v[56:59], v[40:43], v[60:63], v[56:59]
v_max3_u32 v16, v16, v40, v41
v_max3_u32 v16, v16, v42, v43
s_waitcnt vmcnt(0)
v_mfma_f32_16x16x32_bf16 v[56:59], v[44:47], v[60:63], v[56:59]
v_max3_u32 v16, v16, v44, v45
v_max3_u32 v16, v16, v46, v47
v_cmp_le_u32 vcc, 0xffff0000, v16
s_cbranch_vccnz L_red2
L_redb2:
s_nop 3
v_permlane32_swap_b32 v56, v58
v_permlane32_swap_b32 v57, v59
v_pk_add_f32 v[56:57], v[56:57], v[58:59]
v_cvt_pk_bf16_f32 v56, v56, v57
buffer_store_dword v56, v11, s[8:11], s34 offen
s_barrier
ds_read_b128 v[40:43], v2 offset:4096
ds_read_b128 v[44:47], v2 offset:5120
v_mov_b64 v[32:33], 0
v_mov_b64 v[34:35], 0
v_mov_b64 v[36:37], 0
v_mov_b64 v[38:39], 0
v_mov_b64 v[56:57], 0
v_mov_b64 v[58:59], 0
v_mov_b64 v[60:61], 0
v_mov_b64 v[62:63], 0
s_nop 15
s_nop 13
s_branch L_gat2
L_red2:
L_red2b:
buffer_load_dwordx4 v[32:35], v1, s[8:11], s49 offen offset:0 sc1
buffer_load_dwordx4 v[36:39], v1, s[8:11], s49 offen offset:1024 sc1
buffer_load_dwordx4 v[40:43], v1, s[8:11], s49 offen offset:2048 sc1
buffer_load_dwordx4 v[44:47], v1, s[8:11], s49 offen offset:3072 sc1
s_add_u32 s22, s22, 1
s_cmp_gt_u32 s22, 40000
s_cbranch_scc1 L_end
s_waitcnt vmcnt(3)
v_mfma_f32_16x16x32_bf16 v[56:59], v[32:35], v[60:63], 0
v_max3_u32 v16, v32, v33, v34
v_max_u32 v16, v16, v35
s_waitcnt vmcnt(2)
v_mfma_f32_16x16x32_bf16 v[56:59], v[36:39], v[60:63], v[56:59]
v_max3_u32 v16, v16, v36, v37
v_max3_u32 v16, v16, v38, v39
s_waitcnt vmcnt(1)
v_mfma_f32_16x16x32_bf16 v[56:59], v[40:43], v[60:63], v[56:59]
v_max3_u32 v16, v16, v40, v41
v_max3_u32 v16, v16, v42, v43
s_waitcnt vmcnt(0)
v_mfma_f32_16x16x32_bf16 v[56:59], v[44:47], v[60:63], v[56:59]
v_max3_u32 v16, v16, v44, v45
v_max3_u32 v16, v16, v46, v47
v_cmp_le_u32 vcc, 0xffff0000, v16
s_cbranch_vccz L_redb2
s_branch L_red2b
L_nojob2:
s_add_u32 s19, s19, 1
s_mov_b32 s20, s28
s_mov_b32 s28, s29
s_mov_b32 s29, s20
s_and_b32 s20, s19, 3
s_lshl_b32 s20, s20, 14
s_add_u32 s33, s20, 110100480
s_add_u32 s34, s20, s24
s_xor_b32 s20, s20, 32768
s_add_u32 s35, s20, s24
s_add_u32 s30, s30, 16384
s_add_u32 s31, s31, 131072
s_add_u32 s6, s33, 4096
s_add_u32 s7, s33, 8192
s_mov_b32 s22, 0
v_mov_b64 v[24:25], 0
v_mov_b64 v[26:27], 0
v_mov_b64 v[28:29], 0
v_mov_b64 v[30:31], 0
v_and_b32 v69, 0x380, v1
v_add_u32 v69, v69, v1
v_and_b32 v70, 0xf00, v1
v_add_u32 v70, v70, v1
v_mov_b64 v[64:65], -1
v_mov_b64 v[66:67], -1
v_xor_b32 v3, 16, v4
ds_read_b128 v[48:51], v2 offset:12288
ds_read_b128 v[52:55], v2 offset:13312
ds_read_b128 v[40:43], v2 offset:4096
ds_read_b128 v[44:47], v2 offset:5120
v_mov_b64 v[32:33], 0
v_mov_b64 v[34:35], 0
v_mov_b64 v[36:37], 0
v_mov_b64 v[38:39], 0
v_mov_b64 v[56:57], 0
v_mov_b64 v[58:59], 0
v_mov_b64 v[60:61], 0
v_mov_b64 v[62:63], 0
s_barrier
s_nop 15
s_nop 15
s_nop 7
s_branch L_gat2
L_ent3:
v_mov_b64 v[24:25], 0
v_mov_b64 v[26:27], 0
v_mov_b64 v[28:29], 0
v_mov_b64 v[30:31], 0
v_and_b32 v69, 0x380, v1
v_add_u32 v69, v69, v1
v_and_b32 v70, 0xf00, v1
v_add_u32 v70, v70, v1
v_mov_b64 v[64:65], -1
v_mov_b64 v[66:67], -1
v_xor_b32 v3, 16, v4
ds_read_b128 v[48:51], v2 offset:14336
ds_read_b128 v[52:55], v2 offset:15360
ds_read_b128 v[40:43], v2 offset:6144
ds_read_b128 v[44:47], v2 offset:7168
v_mov_b64 v[32:33], 0
v_mov_b64 v[34:35], 0
v_mov_b64 v[36:37], 0
v_mov_b64 v[38:39], 0
v_mov_b64 v[56:57], 0
v_mov_b64 v[58:59], 0
v_mov_b64 v[60:61], 0
v_mov_b64 v[62:63], 0
s_add_u32 s20, s30, 3072
s_add_u32 s21, s30, 8192
s_add_u32 s49, s29, s25
s_add_u32 s50, s29, s26
s_add_u32 s51, s29, s27
s_add_u32 s52, s30, 16384
s_mov_b32 m0, 22016
s_waitcnt vmcnt(0) lgkmcnt(0)
s_branch L_step3
L_gr3:
buffer_load_dwordx4 v[12:15], v1, s[8:11], s33 offen sc1
buffer_load_dword v20, v8, s[8:11], s7 offen sc1
buffer_load_dwordx4 v[16:19], v1, s[8:11], s6 offen sc1
s_add_u32 s22, s22, 1
s_cmp_gt_u32 s22, 40000
s_cbranch_scc1 L_end
s_nop 0
v_mov_b64 v[24:25], 0
v_mov_b64 v[26:27], 0
v_mov_b64 v[28:29], 0
v_mov_b64 v[30:31], 0
v_mov_b64 v[32:33], 0
v_mov_b64 v[34:35], 0
v_mov_b64 v[36:37], 0
v_mov_b64 v[38:39], 0
v_mov_b64 v[56:57], 0
v_mov_b64 v[58:59], 0
v_mov_b64 v[60:61], 0
v_mov_b64 v[62:63], 0
s_waitcnt lgkmcnt(0)
s_branch L_step3
.p2align 3
L_gat3:
buffer_load_dwordx4 v[12:15], v1, s[8:11], s33 offen sc1
buffer_load_dword v20, v8, s[8:11], s7 offen sc1
buffer_load_dwordx4 v[16:19], v1, s[8:11], s6 offen sc1
s_add_u32 s20, s30, 3072
s_add_u32 s21, s30, 8192
s_add_u32 s49, s29, s25
s_add_u32 s50, s29, s26
s_add_u32 s51, s29, s27
s_add_u32 s52, s30, 16384
s_mov_b32 m0, 22016
s_waitcnt lgkmcnt(0)
L_step3:
s_waitcnt vmcnt(2)
v_smfmac_f32_16x16x64_bf16 v[24:27], v[12:15], v[144:151], v0
ds_write_b128 v1, v[12:15] offset:6656
v_smfmac_f32_16x16x64_bf16 v[28:31], v[12:15], v[152:159], v0
s_waitcnt vmcnt(1)
ds_write_b32 v8, v20 offset:14848
v_smfmac_f32_16x16x64_bf16 v[32:35], v[12:15], v[160:167], v0
s_waitcnt vmcnt(0)
ds_write_b128 v1, v[16:19] offset:10752
v_smfmac_f32_16x16x64_bf16 v[56:59], v[12:15], a[80:87], v0
v_max3_u32 v21, v12, v13, v14
v_max3_u32 v21, v21, v15, v20
v_smfmac_f32_16x16x64_bf16 v[60:63], v[12:15], a[88:95], v0
v_max3_u32 v21, v21, v16, v17
v_max3_u32 v21, v21, v18, v19
v_smfmac_f32_16x16x64_bf16 v[36:39], v[12:15], v[40:47], v0
v_cmp_le_u32 vcc, 0xffff0000, v21
v_smfmac_f32_16x16x64_bf16 v[24:27], v[16:19], v[240:247], v0
s_cbranch_vccnz L_gr3
v_smfmac_f32_16x16x64_bf16 v[28:31], v[16:19], v[248:255], v0
s_waitcnt lgkmcnt(0)
s_barrier
ds_read_b128 v[20:23], v1 offset:3584
v_smfmac_f32_16x16x64_bf16 v[32:35], v[16:19], a[0:7], v0
ds_read_b128 v[12:15], v1 offset:4608
buffer_load_dwordx4 v69, s[8:11], s20 offen sc1 lds
v_smfmac_f32_16x16x64_bf16 v[56:59], v[16:19], a[144:151], v0
ds_read_b128 v[40:43], v2 offset:0
s_mov_b32 m0, 22912
v_smfmac_f32_16x16x64_bf16 v[60:63], v[16:19], a[152:159], v0
ds_read_b128 v[44:47], v2 offset:1024
v_smfmac_f32_16x16x64_bf16 v[36:39], v[16:19], v[48:55], v0
ds_read_b128 v[16:19], v1 offset:5632
s_waitcnt lgkmcnt(4)
v_smfmac_f32_16x16x64_bf16 v[24:27], v[20:23], v[72:79], v0
ds_read_b128 v[48:51], v2 offset:2048
buffer_load_dwordx4 v69, s[8:11], s20 offen offset:128 sc1 lds
v_smfmac_f32_16x16x64_bf16 v[28:31], v[20:23], v[80:87], v0
ds_read_b128 v[52:55], v2 offset:3072
s_mov_b32 m0, 6272
v_smfmac_f32_16x16x64_bf16 v[32:35], v[20:23], v[88:95], v0
s_waitcnt lgkmcnt(3)
v_smfmac_f32_16x16x64_bf16 v[36:39], v[20:23], v[40:47], v0
ds_read_b128 v[20:23], v1 offset:7680
v_smfmac_f32_16x16x64_bf16 v[24:27], v[12:15], v[96:103], v0
ds_read_b128 v[40:43], v2 offset:4096
v_smfmac_f32_16x16x64_bf16 v[28:31], v[12:15], v[104:111], v0
ds_read_b128 v[44:47], v2 offset:5120
v_smfmac_f32_16x16x64_bf16 v[32:35], v[12:15], v[112:119], v0
s_waitcnt lgkmcnt(3)
v_smfmac_f32_16x16x64_bf16 v[36:39], v[12:15], v[48:55], v0
ds_read_b128 v[12:15], v1 offset:8704
buffer_store_dwordx4 v[64:67], v1, s[8:11], s49 offen
v_smfmac_f32_16x16x64_bf16 v[24:27], v[16:19], v[120:127], v0
ds_read_b128 v[48:51], v2 offset:8192
v_smfmac_f32_16x16x64_bf16 v[28:31], v[16:19], v[128:135], v0
ds_read_b128 v[52:55], v2 offset:9216
v_smfmac_f32_16x16x64_bf16 v[32:35], v[16:19], v[136:143], v0
s_waitcnt lgkmcnt(3)
v_smfmac_f32_16x16x64_bf16 v[36:39], v[16:19], v[40:47], v0
ds_read_b128 v[16:19], v1 offset:9728
buffer_store_dwordx4 v[64:67], v1, s[8:11], s50 offen
v_smfmac_f32_16x16x64_bf16 v[24:27], v[20:23], v[168:175], v0
ds_read_b128 v[40:43], v2 offset:10240
v_smfmac_f32_16x16x64_bf16 v[28:31], v[20:23], v[176:183], v0
ds_read_b128 v[44:47], v2 offset:11264
v_smfmac_f32_16x16x64_bf16 v[32:35], v[20:23], v[184:191], v0
s_waitcnt lgkmcnt(3)
v_smfmac_f32_16x16x64_bf16 v[36:39], v[20:23], v[48:55], v0
ds_read_b128 v[20:23], v1 offset:11776
buffer_store_dwordx4 v[64:67], v1, s[8:11], s51 offen
v_smfmac_f32_16x16x64_bf16 v[24:27], v[12:15], v[192:199], v0
ds_read_b128 v[48:51], v2 offset:12288
buffer_load_dwordx4 v[64:67], v70, s[8:11], s21 offen sc1
v_smfmac_f32_16x16x64_bf16 v[28:31], v[12:15], v[200:207], v0
ds_read_b128 v[52:55], v2 offset:13312
v_smfmac_f32_16x16x64_bf16 v[32:35], v[12:15], v[208:215], v0
s_waitcnt lgkmcnt(3)
v_smfmac_f32_16x16x64_bf16 v[36:39], v[12:15], v[40:47], v0
ds_read_b128 v[12:15], v1 offset:3584
v_smfmac_f32_16x16x64_bf16 v[24:27], v[16:19], v[216:223], v0
ds_read_b128 v[40:43], v2 offset:16384
buffer_load_dwordx4 v[68:71], v70, s[8:11], s21 offen offset:256 sc1
v_smfmac_f32_16x16x64_bf16 v[28:31], v[16:19], v[224:231], v0
ds_read_b128 v[44:47], v2 offset:17408
v_smfmac_f32_16x16x64_bf16 v[32:35], v[16:19], v[232:239], v0
s_waitcnt lgkmcnt(3)
v_smfmac_f32_16x16x64_bf16 v[36:39], v[16:19], v[48:55], v0
ds_read_b128 v[16:19], v1 offset:4608
v_mov_b32 v11, s19
v_smfmac_f32_16x16x64_bf16 v[24:27], v[20:23], a[8:15], v0
v_smfmac_f32_16x16x64_bf16 v[28:31], v[20:23], a[16:23], v0
s_mov_b64 exec, 1
buffer_store_dword v11, v8, s[8:11], s83 offen sc1
s_mov_b64 exec, 0xff
buffer_load_dword v11, v8, s[8:11], s82 offen sc1
s_mov_b64 exec, -1
v_smfmac_f32_16x16x64_bf16 v[32:35], v[20:23], a[24:31], v0
s_waitcnt lgkmcnt(1)
v_smfmac_f32_16x16x64_bf16 v[36:39], v[20:23], v[40:47], v0
ds_read_b128 v[20:23], v1 offset:5632
v_smfmac_f32_16x16x64_bf16 v[56:59], v[12:15], a[32:39], v0
v_add_f32 v24, v24, v25
v_add_f32 v26, v26, v27
v_add_f32 v28, v28, v29
v_add_f32 v30, v30, v31
v_cvt_pk_bf16_f32 v24, v24, v28
v_cvt_pk_bf16_f32 v26, v26, v30
ds_write_b32 v4, v24 offset:2176
v_add_f32 v32, v32, v33
v_add_f32 v34, v34, v35
v_add_f32 v36, v36, v37
v_add_f32 v38, v38, v39
ds_write_b32 v3, v26 offset:2176
v_cvt_pk_bf16_f32 v32, v32, v36
v_cvt_pk_bf16_f32 v34, v34, v38
ds_write_b32 v4, v32
v_smfmac_f32_16x16x64_bf16 v[60:63], v[12:15], a[40:47], v0
ds_write_b32 v3, v34
s_waitcnt lgkmcnt(5)
v_smfmac_f32_16x16x64_bf16 v[56:59], v[16:19], a[48:55], v0
ds_read_b128 v[12:15], v1 offset:7680
v_smfmac_f32_16x16x64_bf16 v[60:63], v[16:19], a[56:63], v0
ds_read_b128 v[16:19], v1 offset:8704
s_waitcnt lgkmcnt(6)
v_smfmac_f32_16x16x64_bf16 v[56:59], v[20:23], a[64:71], v0
s_waitcnt lgkmcnt(2) vmcnt(7)
s_barrier
ds_read_b128 v[36:39], v5 offset:1536
v_smfmac_f32_16x16x64_bf16 v[60:63], v[20:23], a[72:79], v0
ds_read_b128 v[20:23], v1 offset:9728
s_waitcnt lgkmcnt(3)
v_smfmac_f32_16x16x64_bf16 v[56:59], v[12:15], a[96:103], v0
ds_read_b128 v[52:55], v1 offset:18944
v_smfmac_f32_16x16x64_bf16 v[60:63], v[12:15], a[104:111], v0
ds_read_b128 v[12:15], v1 offset:11776
s_waitcnt lgkmcnt(4)
v_smfmac_f32_16x16x64_bf16 v[56:59], v[16:19], a[112:119], v0
ds_read_b128 v[24:27], v5 offset:0
v_smfmac_f32_16x16x64_bf16 v[60:63], v[16:19], a[120:127], v0
ds_read_b128 v[40:43], v1 offset:12800
s_waitcnt lgkmcnt(4)
v_smfmac_f32_16x16x64_bf16 v[56:59], v[20:23], a[128:135], v0
ds_read_b128 v[28:31], v5 offset:512
v_smfmac_f32_16x16x64_bf16 v[60:63], v[20:23], a[136:143], v0
ds_read_b128 v[44:47], v1 offset:14848
s_waitcnt lgkmcnt(4)
v_smfmac_f32_16x16x64_bf16 v[56:59], v[12:15], a[160:167], v0
ds_read_b128 v[32:35], v5 offset:1024
v_smfmac_f32_16x16x64_bf16 v[60:63], v[12:15], a[168:175], v0
ds_read_b128 v[48:51], v1 offset:16896
s_mov_b64 exec, s[86:87]
buffer_store_dwordx4 v[36:39], v5, s[8:11], s31 offen offset:1536 sc1
s_mov_b64 exec, -1
v_mfma_f32_16x16x32_bf16 v[16:19], v[52:55], v[36:39], 0
ds_read_b128 v[52:55], v1 offset:19968
s_waitcnt lgkmcnt(5)
v_mfma_f32_16x16x32_bf16 v[16:19], v[40:43], v[24:27], v[16:19]
ds_read_b128 v[40:43], v1 offset:13824
s_waitcnt lgkmcnt(4)
v_mfma_f32_16x16x32_bf16 v[16:19], v[44:47], v[28:31], v[16:19]
ds_read_b128 v[44:47], v1 offset:15872
s_waitcnt lgkmcnt(3)
v_mfma_f32_16x16x32_bf16 v[16:19], v[48:51], v[32:35], v[16:19]
ds_read_b128 v[48:51], v1 offset:17920
v_mfma_f32_16x16x32_bf16 v[20:23], v[36:39], v[36:39], 0
v_add_f32 v56, v56, v57
v_add_f32 v58, v58, v59
v_mfma_f32_16x16x32_bf16 v[20:23], v[24:27], v[24:27], v[20:23]
v_add_f32 v60, v60, v61
v_add_f32 v62, v62, v63
v_mfma_f32_16x16x32_bf16 v[20:23], v[28:31], v[28:31], v[20:23]
v_cvt_pk_bf16_f32 v56, v56, v58
v_cvt_pk_bf16_f32 v57, v60, v62
v_mfma_f32_16x16x32_bf16 v[20:23], v[32:35], v[32:35], v[20:23]
v_lshrrev_b32 v58, 1, v1
v_max3_f32 v59, v16, v17, v18
s_waitcnt lgkmcnt(3)
v_mfma_f32_16x16x32_bf16 v[12:15], v[52:55], v[36:39], 0
ds_read_b128 v[52:55], v2 offset:21504
s_waitcnt lgkmcnt(3)
v_mfma_f32_16x16x32_bf16 v[12:15], v[40:43], v[24:27], v[12:15]
ds_read_b128 v[40:43], v2 offset:18432
s_waitcnt lgkmcnt(3)
v_mfma_f32_16x16x32_bf16 v[12:15], v[44:47], v[28:31], v[12:15]
ds_read_b128 v[44:47], v2 offset:19456
v_max3_f32 v59, v59, v19, v20
v_max_f32 v59, v59, v21
s_waitcnt lgkmcnt(3)
v_mfma_f32_16x16x32_bf16 v[12:15], v[48:51], v[32:35], v[12:15]
ds_read_b128 v[48:51], v2 offset:20480
buffer_store_dwordx2 v[56:57], v58, s[8:11], s31 offen offset:2048 sc1
v_mov_b32 v60, s53
s_add_u32 s49, s28, s23
v_mov_b32 v61, s53
s_add_u32 s50, s28, 65536
v_mov_b32 v62, s53
ds_read_b128 v[32:35], v2 offset:22528
v_mov_b32 v63, s53
v_max3_f32 v59, v59, v12, v13
v_max3_f32 v22, v59, v14, v15
v_max3_f32 v59, v59, v14, v15
s_add_u32 s51, s28, 131072
s_add_u32 s52, s28, 196608
v_permlane32_swap_b32 v22, v59
v_max_f32 v23, v59, v22
v_max_f32 v59, v59, v22
v_mov_b32 v22, 0
ds_read_b128 v[36:39], v2 offset:23552
v_permlane16_swap_b32 v23, v59
v_max_f32 v59, v59, v23
v_mul_f32 v58, s18, v59
v_pk_fma_f32 v[20:21], v[20:21], s[18:19], v[58:59] op_sel_hi:[1,0,0] neg_lo:[0,0,1] neg_hi:[0,0,1]
v_pk_fma_f32 v[16:17], v[16:17], s[18:19], v[58:59] op_sel_hi:[1,0,0] neg_lo:[0,0,1] neg_hi:[0,0,1]
v_pk_fma_f32 v[18:19], v[18:19], s[18:19], v[58:59] op_sel_hi:[1,0,0] neg_lo:[0,0,1] neg_hi:[0,0,1]
v_pk_fma_f32 v[12:13], v[12:13], s[18:19], v[58:59] op_sel_hi:[1,0,0] neg_lo:[0,0,1] neg_hi:[0,0,1]
v_pk_fma_f32 v[14:15], v[14:15], s[18:19], v[58:59] op_sel_hi:[1,0,0] neg_lo:[0,0,1] neg_hi:[0,0,1]
v_exp_f32 v20, v20
v_exp_f32 v21, v21
v_exp_f32 v16, v16
v_cvt_pk_bf16_f32 v23, v20, v21
v_cvt_pk_bf16_f32 v20, v20, v21
v_mov_b32 v21, 0
v_exp_f32 v17, v17
v_exp_f32 v18, v18
v_mfma_f32_16x16x16_bf16 v[24:27], v[56:57], v[20:21], 0
v_exp_f32 v19, v19
v_mfma_f32_16x16x16_bf16 v[28:31], v[56:57], v[22:23], 0
v_exp_f32 v12, v12
v_exp_f32 v13, v13
v_cvt_pk_bf16_f32 v16, v16, v17
v_cvt_pk_bf16_f32 v17, v18, v19
v_exp_f32 v14, v14
v_exp_f32 v15, v15
v_cvt_pk_bf16_f32 v18, v12, v13
v_cvt_pk_bf16_f32 v19, v14, v15
v_mfma_f32_16x16x16_bf16 v[12:15], v[60:61], v[20:21], 0
s_waitcnt vmcnt(4)
v_mfma_f32_16x16x32_bf16 v[12:15], v[60:63], v[16:19], v[12:15]
v_mov_b32 v20, 0
v_mov_b32 v23, 0
v_mfma_f32_16x16x32_bf16 v[24:27], v[64:67], v[16:19], v[24:27]
s_nop 1
v_mfma_f32_16x16x32_bf16 v[28:31], v[68:71], v[16:19], v[28:31]
v_mov_b32 v16, 0
v_mov_b32 v17, 0
v_rcp_f32 v12, v12
v_mov_b32 v18, 0
v_mov_b32 v19, 0
v_pk_mul_f32 v[24:25], v[24:25], v[12:13] op_sel_hi:[1,0]
v_pk_mul_f32 v[26:27], v[26:27], v[12:13] op_sel_hi:[1,0]
v_mov_b32 v15, 0
v_pk_mul_f32 v[28:29], v[28:29], v[12:13] op_sel_hi:[1,0]
v_pk_mul_f32 v[30:31], v[30:31], v[12:13] op_sel_hi:[1,0]
v_cvt_pk_bf16_f32 v24, v24, v28
v_cvt_pk_bf16_f32 v25, v25, v29
v_cvt_pk_bf16_f32 v26, v26, v30
v_cvt_pk_bf16_f32 v27, v27, v31
v_mfma_f32_16x16x32_bf16 v[56:59], v[20:23], v[20:23], 0
ds_write_b128 v7, v[24:27]
v_mfma_f32_16x16x32_bf16 v[60:63], v[20:23], v[20:23], 0
v_mov_b32 v12, 0
v_mov_b32 v13, 0
v_mov_b32 v14, 0
v_mov_b32 v3, 6528
s_nop 1
v_mfma_f32_16x16x32_bf16 v[64:67], v[20:23], v[20:23], 0
s_cmp_eq_u32 s19, 63
s_cbranch_scc1 L_texit
s_waitcnt lgkmcnt(0)
s_barrier
ds_read_b128 v[24:27], v1 offset:1152
v_mfma_f32_16x16x32_bf16 v[68:71], v[20:23], v[20:23], 0
ds_read_b128 v[28:31], v1 offset:2176
s_nop 2
v_mfma_f32_16x16x32_bf16 v[68:71], v[20:23], v[20:23], 0
s_waitcnt lgkmcnt(1)
v_smfmac_f32_16x16x64_bf16 v[12:15], v[24:27], a[248:255], v0
v_smfmac_f32_16x16x64_bf16 v[16:19], v[24:27], a[176:183], v0
s_waitcnt lgkmcnt(0)
v_smfmac_f32_16x16x64_bf16 v[12:15], v[28:31], v[40:47], v0
ds_read_b128 v[40:43], v2 offset:24576
v_smfmac_f32_16x16x64_bf16 v[16:19], v[28:31], v[48:55], v0
ds_read_b128 v[44:47], v2 offset:25600
v_smfmac_f32_16x16x64_bf16 v[20:23], v[24:27], a[184:191], v0
ds_read_b128 v[48:51], v2 offset:26624
v_smfmac_f32_16x16x64_bf16 v[20:23], v[28:31], v[32:39], v0
ds_read_b128 v[52:55], v2 offset:27648
s_nop 0
v_add_f32 v12, v12, v13
v_add_f32 v14, v14, v15
v_smfmac_f32_16x16x64_bf16 v[56:59], v[24:27], a[192:199], v0
ds_read_b128 v[32:35], v2 offset:28672
s_waitcnt lgkmcnt(3)
v_cvt_pk_bf16_f32 v12, v12, v14
buffer_store_dword v12, v10, s[8:11], s28 offen
v_smfmac_f32_16x16x64_bf16 v[56:59], v[28:31], v[40:47], v0
ds_read_b128 v[36:39], v2 offset:29696
v_add_f32 v16, v16, v17
v_add_f32 v18, v18, v19
v_smfmac_f32_16x16x64_bf16 v[60:63], v[24:27], a[200:207], v0
ds_read_b128 v[12:15], v3
s_waitcnt lgkmcnt(3)
v_cvt_pk_bf16_f32 v16, v16, v18
v_add_f32 v20, v20, v21
v_smfmac_f32_16x16x64_bf16 v[60:63], v[28:31], v[48:55], v0
ds_read_b128 v[40:43], v2 offset:30720
v_add_f32 v22, v22, v23
v_cvt_pk_bf16_f32 v17, v20, v22
v_smfmac_f32_16x16x64_bf16 v[64:67], v[24:27], a[208:215], v0
ds_read_b128 v[44:47], v2 offset:31744
s_waitcnt lgkmcnt(3)
buffer_store_dwordx2 v[16:17], v9, s[8:11], s28 offen
v_add_f32 v56, v56, v57
v_smfmac_f32_16x16x64_bf16 v[64:67], v[28:31], v[32:39], v0
ds_read_b128 v[48:51], v2 offset:32768
v_add_f32 v58, v58, v59
v_cvt_pk_bf16_f32 v56, v56, v58
v_smfmac_f32_16x16x64_bf16 v[68:71], v[24:27], a[216:223], v0
ds_read_b128 v[52:55], v2 offset:33792
s_waitcnt lgkmcnt(2)
v_add_f32 v60, v60, v61
v_add_f32 v62, v62, v63
v_smfmac_f32_16x16x64_bf16 v[68:71], v[28:31], v[40:47], v0
ds_read_b128 v[20:23], v3
v_cvt_pk_bf16_f32 v57, v60, v62
buffer_store_dwordx2 v[56:57], v9, s[8:11], s50 offen
v_smfmac_f32_16x16x64_bf16 v[12:15], v[24:27], a[224:231], v0
s_waitcnt lgkmcnt(1)
v_add_f32 v64, v64, v65
v_add_f32 v66, v66, v67
v_smfmac_f32_16x16x64_bf16 v[12:15], v[28:31], v[48:55], v0
s_waitcnt lgkmcnt(0)
v_cvt_pk_bf16_f32 v64, v64, v66
v_smfmac_f32_16x16x64_bf16 v[20:23], v[24:27], a[232:239], v0
v_add_f32 v68, v68, v69
v_add_f32 v70, v70, v71
v_smfmac_f32_16x16x64_bf16 v[20:23], v[28:31], a[240:247], v0
v_cvt_pk_bf16_f32 v65, v68, v70
buffer_store_dwordx2 v[64:65], v9, s[8:11], s51 offen
v_add_f32 v12, v12, v13
v_add_f32 v14, v14, v15
v_cvt_pk_bf16_f32 v12, v12, v14
s_nop 2
v_add_f32 v20, v20, v21
v_add_f32 v22, v22, v23
v_cvt_pk_bf16_f32 v13, v20, v22
buffer_store_dwordx2 v[12:13], v9, s[8:11], s52 offen
s_add_u32 s19, s19, 1
s_mov_b32 s20, s28
s_mov_b32 s28, s29
s_mov_b32 s29, s20
s_and_b32 s20, s19, 3
s_lshl_b32 s20, s20, 14
s_add_u32 s33, s20, 110100480
s_add_u32 s34, s20, s24
s_xor_b32 s20, s20, 32768
s_add_u32 s35, s20, s24
s_add_u32 s30, s30, 16384
s_add_u32 s31, s31, 131072
s_add_u32 s6, s33, 4096
s_add_u32 s7, s33, 8192
s_mov_b32 s22, 0
v_mov_b64 v[24:25], 0
v_mov_b64 v[26:27], 0
v_mov_b64 v[28:29], 0
v_mov_b64 v[30:31], 0
v_and_b32 v69, 0x380, v1
v_add_u32 v69, v69, v1
v_and_b32 v70, 0xf00, v1
v_add_u32 v70, v70, v1
v_mov_b64 v[64:65], -1
v_mov_b64 v[66:67], -1
v_xor_b32 v3, 16, v4
ds_read_b128 v[48:51], v2 offset:14336
ds_read_b128 v[52:55], v2 offset:15360
ds_read_b128 v[40:43], v2 offset:6144
ds_read_b128 v[44:47], v2 offset:7168
v_mov_b64 v[32:33], 0
v_mov_b64 v[34:35], 0
v_mov_b64 v[36:37], 0
v_mov_b64 v[38:39], 0
v_mov_b64 v[56:57], 0
v_mov_b64 v[58:59], 0
v_mov_b64 v[60:61], 0
v_mov_b64 v[62:63], 0
s_add_u32 s20, s19, 1
s_lshr_b32 s20, s20, 3
s_min_u32 s20, s20, 7
s_waitcnt vmcnt(7)
L_kvw:
v_readlane_b32 s21, v11, s20
s_nop 0
s_cmp_eq_u32 s21, 1
s_cbranch_scc0 L_kvp
s_barrier
s_nop 15
s_nop 15
s_nop 7
s_branch L_gat3
L_kvp:
s_mov_b64 exec, 0xff
buffer_load_dword v11, v8, s[8:11], s82 offen sc1
s_mov_b64 exec, -1
s_add_u32 s22, s22, 1
s_cmp_gt_u32 s22, 40000
s_cbranch_scc1 L_end
s_waitcnt vmcnt(0)
s_branch L_kvw
L_texit:
s_lshl_b32 s61, s16, 7
s_add_u32 s61, s61, 111153152
s_waitcnt vmcnt(0)
s_barrier
s_cmp_lg_u32 s17, 0
s_cbranch_scc1 L_sf_50
v_mov_b32 v20, 0
v_mov_b32 v21, 64
s_mov_b64 exec, 1
buffer_store_dword v21, v20, s[8:11], s61 offen sc1
s_mov_b64 exec, -1
L_sf_50:
L_done:
L_end:
s_endpgm
.section .rodata,"a"
.p2align 6
.amdhsa_kernel concat_heads__compressed_kv_cla__memory_aug_recurrent_mem_tr__prompt_kernel
  .amdhsa_next_free_vgpr 512
  .amdhsa_next_free_sgpr 102
  .amdhsa_accum_offset 256
  .amdhsa_group_segment_fixed_size 0
  .amdhsa_kernarg_size 128
  .amdhsa_user_sgpr_count 2
  .amdhsa_user_sgpr_kernarg_segment_ptr 1
  .amdhsa_system_sgpr_workgroup_id_x 1
.end_amdhsa_kernel
```

```asm
; @launch grid=(256,1,1) block=(256,1,1) lds=163840
.amdgcn_target "amdgcn-amd-amdhsa--gfx950"
.text
.globl concat_heads__compressed_kv_cla__memory_aug_recurrent_mem_tr__prompt_kernel
.p2align 8
.type concat_heads__compressed_kv_cla__memory_aug_recurrent_mem_tr__prompt_kernel,@function
concat_heads__compressed_kv_cla__memory_aug_recurrent_mem_tr__prompt_kernel:
s_cmp_ge_u32 s2, 256
s_cbranch_scc1 L_end
s_getreg_b32 s3, hwreg(HW_REG_XCC_ID)
s_and_b32 s3, s3, 7
s_load_dwordx2 s[4:5], s[0:1], 120
s_load_dwordx2 s[6:7], s[0:1], 112
v_lshrrev_b32 v1, 6, v0
s_nop 0
v_readfirstlane_b32 s17, v1
s_waitcnt lgkmcnt(0)
s_mov_b32 s8, s4
s_and_b32 s9, s5, 0xffff
s_mov_b32 s10, 268435456
s_mov_b32 s11, 0x20000
s_mov_b32 s56, s6
s_and_b32 s57, s7, 0xffff
s_mov_b32 s58, 256
s_mov_b32 s59, 0x20000
s_getpc_b64 s[4:5]
L_pc:
s_mov_b32 s12, s4
s_and_b32 s13, s5, 0xffff
s_mov_b32 s14, L_end-L_pc
s_mov_b32 s15, 0x20000
s_lshr_b32 s25, s2, 3
s_lshl_b32 s25, s25, 7
v_lshlrev_b32 v3, 12, v0
buffer_load_dword v3, v3, s[12:15], s25 offen
s_lshl_b32 s24, s3, 2
s_cmp_eq_u32 s17, 0
s_cbranch_scc0 L_tk
s_mov_b64 exec, 1
v_mov_b32 v1, 1
v_mov_b32 v2, 0
buffer_atomic_add v1, v2, s[56:59], s24 offen sc0
s_waitcnt vmcnt(0)
ds_write_b32 v2, v1
s_waitcnt lgkmcnt(0)
s_mov_b64 exec, -1
L_tk:
s_waitcnt vmcnt(0)
s_barrier
v_mov_b32 v2, 0
ds_read_b32 v1, v2
s_lshr_b32 s3, 0x76530142, s24
s_and_b32 s3, s3, 7
s_waitcnt lgkmcnt(0)
v_readfirstlane_b32 s16, v1
s_barrier
s_cmp_ge_u32 s16, 32
s_cbranch_scc1 L_end
s_cmp_eq_u32 s3, 0
s_cbranch_scc1 L_team
s_cmp_eq_u32 s3, 1
s_cbranch_scc0 L_np
s_cmp_lt_u32 s16, 24
s_cbranch_scc1 L_np
v_lshlrev_b32 v1, 4, v0
v_mov_b64 v[4:5], 0
v_mov_b64 v[6:7], 0
s_sub_u32 s24, s16, 24
s_lshl_b32 s24, s24, 12
s_add_u32 s24, s24, 111149056
buffer_store_dwordx4 v[4:7], v1, s[8:11], s24 offen sc1
s_waitcnt vmcnt(0)
s_barrier
s_cmp_lg_u32 s17, 0
s_cbranch_scc1 L_np
v_mov_b32 v1, 1
v_mov_b32 v2, 128
s_mov_b64 exec, 1
buffer_atomic_add v1, v2, s[56:59], 0 offen
s_mov_b64 exec, -1
L_np:
s_cmp_lt_u32 s3, 4
s_cselect_b32 s61, 1, 0
s_cbranch_scc1 L_pb
s_load_dwordx2 s[52:53], s[0:1], 8
s_load_dwordx2 s[54:55], s[0:1], 0
s_load_dwordx2 s[6:7], s[0:1], 24
s_load_dwordx2 s[4:5], s[0:1], 32
s_load_dwordx2 s[18:19], s[0:1], 16
s_mov_b32 s45, 3
s_sub_u32 s24, s3, 4
s_lshl_b32 s24, s24, 5
s_add_u32 s24, s24, s16
s_lshr_b32 s89, s24, 2
s_lshr_b32 s90, s24, 3
s_and_b32 s24, s16, 3
s_mul_i32 s88, s24, 0x11
s_and_b32 s24, s16, 7
s_lshl_b32 s24, s24, 8
s_add_u32 s88, s88, s24
s_add_u32 s88, s88, 0x840
s_branch L_pg
L_pb:
s_load_dwordx2 s[52:53], s[0:1], 48
s_load_dwordx2 s[54:55], s[0:1], 48
s_load_dwordx2 s[6:7], s[0:1], 72
s_load_dwordx2 s[4:5], s[0:1], 80
s_load_dwordx2 s[18:19], s[0:1], 64
s_mov_b32 s45, 6
s_sub_u32 s24, s3, 2
s_lshl_b32 s24, s24, 5
s_add_u32 s24, s24, s16
s_lshr_b32 s89, s24, 1
s_lshr_b32 s90, s24, 2
s_mov_b32 s88, 0xe6a421
s_mov_b32 s25, 0xe6c421
s_bitcmp1_b32 s16, 0
s_cselect_b32 s88, 0xf7b538, s88
s_cselect_b32 s25, 0xf7d539, s25
s_bitcmp1_b32 s16, 1
s_cselect_b32 s88, s25, s88
s_cselect_b32 s45, 5, 6
s_cmp_eq_u32 s3, 1
s_cselect_b32 s45, 1, s45
s_cselect_b32 s88, 0, s88
s_cselect_b32 s89, s16, s89
L_pg:
s_waitcnt lgkmcnt(0)
s_cmp_ge_u32 s17, 2
s_cselect_b64 s[6:7], s[4:5], s[6:7]
s_cmp_eq_u32 s61, 0
s_cselect_b32 s24, 4, 1
s_mov_b32 s14, 589824
s_cselect_b32 s14, 1048576, s14
s_sub_u32 s24, s3, s24
s_lshl_b32 s24, s24, 5
s_add_u32 s24, s24, s16
s_lshl_b32 s24, s24, 13
s_mov_b32 s12, s52
s_and_b32 s13, s53, 0xffff
s_mov_b32 s15, 0x20000
v_lshlrev_b32 v15, 5, v0
buffer_load_dword v15, v15, s[12:15], s24 offen
s_sub_u32 s24, s3, 2
s_lshl_b32 s24, s24, 5
s_add_u32 s24, s24, s16
s_cmp_ge_u32 s24, 13
s_cbranch_scc1 L_pf_1
s_load_dwordx2 s[4:5], s[0:1], 8
s_sub_u32 s100, s24, 0
s_mul_i32 s100, s100, 81920
s_add_u32 s100, s100, 1048576
s_mov_b32 s98, 2097152
s_branch L_pfd
L_pf_1:
s_cmp_ge_u32 s24, 35
s_cbranch_scc1 L_pf_2
s_load_dwordx2 s[4:5], s[0:1], 48
s_sub_u32 s100, s24, 13
s_mul_i32 s100, s100, 81920
s_add_u32 s100, s100, 589824
s_mov_b32 s98, 2359296
s_branch L_pfd
L_pf_2:
s_cmp_ge_u32 s24, 64
s_cbranch_scc1 L_pf_3
s_load_dwordx2 s[4:5], s[0:1], 0
s_sub_u32 s100, s24, 35
s_mul_i32 s100, s100, 81920
s_add_u32 s100, s100, 0
s_mov_b32 s98, 2359296
s_branch L_pfd
L_pf_3:
s_cmp_ge_u32 s24, 122
s_cbranch_scc1 L_pf_4
s_load_dwordx2 s[4:5], s[0:1], 16
s_sub_u32 s100, s24, 64
s_mul_i32 s100, s100, 81920
s_add_u32 s100, s100, 0
s_mov_b32 s98, 4718592
s_branch L_pfd
L_pf_4:
s_load_dwordx2 s[4:5], s[0:1], 40
s_sub_u32 s100, s24, 122
s_mul_i32 s100, s100, 81920
s_add_u32 s100, s100, 0
s_mov_b32 s98, 4718592
s_branch L_pfd
L_pf_5:
L_pfd:
s_waitcnt lgkmcnt(0)
s_mov_b32 s96, s4
s_and_b32 s97, s5, 0xffff
s_mov_b32 s99, 0x20000
s_cmp_eq_u32 s3, 1
s_cselect_b32 s100, 536870912, s100
v_lshlrev_b32 v14, 5, v0
s_cmp_eq_u32 s61, 0
s_cselect_b32 s94, 0x3e0293ee, 1.0
v_bfe_u32 v16, v0, 4, 3
v_bfe_u32 v17, v0, 7, 1
v_lshlrev_b32 v17, 2, v17
v_xor_b32 v16, v16, v17
v_and_b32 v17, 7, v0
v_xor_b32 v16, v16, v17
v_lshlrev_b32 v1, 4, v16
v_bfe_u32 v17, v0, 4, 2
v_lshlrev_b32 v16, 2, v17
v_and_b32 v18, 15, v0
v_xor_b32 v16, v16, v18
v_bfe_u32 v18, v0, 6, 1
v_xor_b32 v16, v16, v18
v_lshlrev_b32 v16, 4, v16
v_lshl_add_u32 v16, v17, 13, v16
v_lshl_add_u32 v2, v18, 16, v16
s_and_b32 s24, s17, 1
s_lshr_b32 s25, s17, 1
s_lshl_b32 s25, s25, 13
s_lshl_b32 s33, s24, 11
s_add_u32 s33, s33, s25
s_lshl_b32 s32, s17, 10
s_add_u32 s32, s32, 65536
v_bfe_u32 v16, v0, 3, 1
v_lshlrev_b32 v16, 11, v16
v_and_b32 v18, 7, v0
v_lshl_add_u32 v16, v18, 7, v16
v_bfe_u32 v18, v0, 1, 3
v_xor_b32 v18, v18, v17
v_lshl_add_u32 v16, v18, 4, v16
s_lshl_b32 s24, s24, 14
s_add_u32 s24, s24, 65536
v_add_u32 v3, s24, v16
v_xor_b32 v4, 64, v3
v_bfe_u32 v18, v0, 2, 2
v_mul_u32_u24 v16, 320, v18
v_lshl_add_u32 v16, v17, 11, v16
v_bfe_u32 v18, v0, 1, 1
v_lshl_add_u32 v16, v18, 5, v16
v_bfe_u32 v18, v0, 4, 1
v_lshl_add_u32 v16, v18, 4, v16
v_and_b32 v18, 1, v0
v_lshl_add_u32 v16, v18, 3, v16
v_add_u32 v5, s25, v16
v_xor_b32 v6, 16, v5
v_xor_b32 v7, 64, v5
v_xor_b32 v8, 80, v5
v_xor_b32 v9, 128, v5
v_xor_b32 v10, 144, v5
v_xor_b32 v11, 192, v5
v_xor_b32 v12, 208, v5
s_mov_b32 s35, 0
s_lshl_b32 s24, s35, 2
s_lshr_b32 s26, s88, s24
s_bfe_u32 s2, s26, 0x10003
s_and_b32 s26, s26, 7
s_or_b32 s40, s2, s61
s_lshr_b32 s24, s17, 1
s_cmp_eq_u32 s2, 0
s_cselect_b32 s41, s24, 0
s_cselect_b32 s27, s89, s90
s_sub_u32 s25, s24, s41
s_and_b32 s51, s41, s61
s_lshl_b32 s51, s51, 1
s_or_b32 s51, s51, s41
s_lshl_b32 s46, s27, s2
s_add_u32 s46, s46, s25
s_lshl_b32 s46, s46, 8
s_lshl_b32 s47, s40, 7
s_add_u32 s47, s47, 1024
s_mul_i32 s101, s26, s47
s_lshl_b32 s101, s101, 8
s_lshl_b32 s42, s27, 3
s_add_u32 s42, s42, s26
s_lshl_b32 s42, s42, 1
s_and_b32 s25, s17, 1
s_add_u32 s42, s42, s25
s_lshl_b32 s42, s42, 3
s_add_u32 s42, s42, s24
s_lshl_b32 s42, s42, 13
s_lshl_b32 s43, s27, 5
s_add_u32 s43, s43, s26
s_lshl_b32 s43, s43, 2
s_lshl_b32 s24, s2, 1
s_add_u32 s24, s24, s61
s_lshl_b32 s24, s24, 2
s_lshr_b32 s25, 0x8720, s24
s_and_b32 s25, s25, 15
s_lshl_b32 s25, s25, 24
s_add_u32 s42, s42, s25
s_lshr_b32 s25, 0x7604, s24
s_and_b32 s25, s25, 15
s_lshl_b32 s25, s25, 12
s_add_u32 s43, s43, s25
s_add_u32 s43, s43, 111149056
s_cmp_lt_u32 s35, s45
s_cselect_b32 s101, s101, 536870912
s_cselect_b32 s46, s46, 536870912
s_cmp_eq_u32 s2, 0
s_cselect_b64 s[4:5], s[52:53], s[54:55]
s_mov_b32 s12, s4
s_and_b32 s13, s5, 0xffff
s_lshl_b32 s14, s47, 11
s_mov_b32 s15, 0x20000
s_mov_b32 s30, s101
v_lshrrev_b32 v16, 3, v0
v_mul_lo_u32 v16, v16, s47
v_and_b32 v1, 0x70, v1
v_add_u32 v1, v1, v16
s_lshl_b32 s34, s47, 5
s_cmp_eq_u32 s2, 0
s_cselect_b64 s[4:5], s[6:7], s[18:19]
s_mov_b32 s20, s4
s_and_b32 s21, s5, 0xffff
s_lshl_b32 s22, s47, 12
s_mov_b32 s23, 0x20000
s_mov_b32 s31, s46
s_mov_b32 s48, s30
s_add_u32 m0, s32, 0
s_nop 0
buffer_load_dwordx4 v1, s[12:15], s48 offen lds
s_add_u32 s48, s48, s34
s_add_u32 m0, s32, 4096
s_nop 0
buffer_load_dwordx4 v1, s[12:15], s48 offen lds
s_add_u32 s48, s48, s34
s_add_u32 m0, s32, 8192
s_nop 0
buffer_load_dwordx4 v1, s[12:15], s48 offen lds
s_add_u32 s48, s48, s34
s_add_u32 m0, s32, 12288
s_nop 0
buffer_load_dwordx4 v1, s[12:15], s48 offen lds
s_add_u32 s48, s48, s34
s_add_u32 m0, s32, 16384
s_nop 0
buffer_load_dwordx4 v1, s[12:15], s48 offen lds
s_add_u32 s48, s48, s34
s_add_u32 m0, s32, 20480
s_nop 0
buffer_load_dwordx4 v1, s[12:15], s48 offen lds
s_add_u32 s48, s48, s34
s_add_u32 m0, s32, 24576
s_nop 0
buffer_load_dwordx4 v1, s[12:15], s48 offen lds
s_add_u32 s48, s48, s34
s_add_u32 m0, s32, 28672
s_nop 0
buffer_load_dwordx4 v1, s[12:15], s48 offen lds
s_add_u32 s30, s30, 128
s_add_u32 s32, s32, 32768
s_sub_u32 s48, s32, 98304
s_cmp_ge_u32 s32, 163840
s_cselect_b32 s32, s48, s32
s_add_u32 s37, s31, 0
s_add_u32 m0, s33, 0
s_nop 0
buffer_load_dwordx4 v2, s[20:23], s37 offen  lds
s_add_u32 s37, s31, 32768
s_add_u32 m0, s33, 1024
s_nop 0
buffer_load_dwordx4 v2, s[20:23], s37 offen  lds
s_add_u32 s37, s31, 131072
s_add_u32 m0, s33, 4096
s_nop 0
buffer_load_dwordx4 v2, s[20:23], s37 offen  lds
s_add_u32 s37, s31, 163840
s_add_u32 m0, s33, 5120
s_nop 0
buffer_load_dwordx4 v2, s[20:23], s37 offen  lds
s_add_u32 s31, s31, 262144
s_add_u32 s33, s33, 16384
s_and_b32 s33, s33, 65535
s_add_u32 s37, s31, 0
s_add_u32 m0, s33, 0
s_nop 0
buffer_load_dwordx4 v2, s[20:23], s37 offen  lds
s_add_u32 s37, s31, 32768
s_add_u32 m0, s33, 1024
s_nop 0
buffer_load_dwordx4 v2, s[20:23], s37 offen  lds
s_add_u32 s37, s31, 131072
s_add_u32 m0, s33, 4096
s_nop 0
buffer_load_dwordx4 v2, s[20:23], s37 offen  lds
s_add_u32 s37, s31, 163840
s_add_u32 m0, s33, 5120
s_nop 0
buffer_load_dwordx4 v2, s[20:23], s37 offen  lds
s_add_u32 s31, s31, 262144
s_add_u32 s33, s33, 16384
s_and_b32 s33, s33, 65535
s_mov_b32 s48, s30
s_add_u32 m0, s32, 0
s_nop 0
buffer_load_dwordx4 v1, s[12:15], s48 offen lds
s_add_u32 s48, s48, s34
s_add_u32 m0, s32, 4096
s_nop 0
buffer_load_dwordx4 v1, s[12:15], s48 offen lds
s_add_u32 s48, s48, s34
s_add_u32 m0, s32, 8192
s_nop 0
buffer_load_dwordx4 v1, s[12:15], s48 offen lds
s_add_u32 s48, s48, s34
s_add_u32 m0, s32, 12288
s_nop 0
buffer_load_dwordx4 v1, s[12:15], s48 offen lds
s_add_u32 s37, s31, 0
s_add_u32 m0, s33, 0
s_nop 0
buffer_load_dwordx4 v2, s[20:23], s37 offen  lds
s_add_u32 s37, s31, 32768
s_add_u32 m0, s33, 1024
s_nop 0
buffer_load_dwordx4 v2, s[20:23], s37 offen  lds
s_add_u32 s37, s31, 131072
s_add_u32 m0, s33, 4096
s_nop 0
buffer_load_dwordx4 v2, s[20:23], s37 offen  lds
s_add_u32 s37, s31, 163840
s_add_u32 m0, s33, 5120
s_nop 0
buffer_load_dwordx4 v2, s[20:23], s37 offen  lds
s_add_u32 s31, s31, 262144
s_add_u32 s33, s33, 16384
s_and_b32 s33, s33, 65535
s_add_u32 s48, s48, s34
s_add_u32 m0, s32, 16384
s_nop 0
buffer_load_dwordx4 v1, s[12:15], s48 offen lds
s_add_u32 s48, s48, s34
s_add_u32 m0, s32, 20480
s_nop 0
buffer_load_dwordx4 v1, s[12:15], s48 offen lds
s_add_u32 s48, s48, s34
s_add_u32 m0, s32, 24576
s_nop 0
buffer_load_dwordx4 v1, s[12:15], s48 offen lds
s_add_u32 s48, s48, s34
s_add_u32 m0, s32, 28672
s_nop 0
buffer_load_dwordx4 v1, s[12:15], s48 offen lds
s_add_u32 s30, s30, 128
s_add_u32 s32, s32, 32768
s_sub_u32 s48, s32, 98304
s_cmp_ge_u32 s32, 163840
s_cselect_b32 s32, s48, s32
s_add_u32 s37, s31, 0
s_add_u32 m0, s33, 0
s_nop 0
buffer_load_dwordx4 v2, s[20:23], s37 offen  lds
s_add_u32 s37, s31, 32768
s_add_u32 m0, s33, 1024
s_nop 0
buffer_load_dwordx4 v2, s[20:23], s37 offen  lds
s_add_u32 s37, s31, 131072
s_add_u32 m0, s33, 4096
s_nop 0
buffer_load_dwordx4 v2, s[20:23], s37 offen  lds
s_add_u32 s37, s31, 163840
s_add_u32 m0, s33, 5120
s_nop 0
buffer_load_dwordx4 v2, s[20:23], s37 offen  lds
s_add_u32 s31, s31, 262144
s_add_u32 s33, s33, 16384
s_and_b32 s33, s33, 65535
s_mov_b32 s48, s30
s_add_u32 m0, s32, 0
s_nop 0
buffer_load_dwordx4 v1, s[12:15], s48 offen lds
s_add_u32 s48, s48, s34
s_add_u32 m0, s32, 4096
s_nop 0
buffer_load_dwordx4 v1, s[12:15], s48 offen lds
s_add_u32 s48, s48, s34
s_add_u32 m0, s32, 8192
s_nop 0
buffer_load_dwordx4 v1, s[12:15], s48 offen lds
s_add_u32 s48, s48, s34
s_add_u32 m0, s32, 12288
s_nop 0
buffer_load_dwordx4 v1, s[12:15], s48 offen lds
s_mov_b32 s62, 536870912
s_mov_b32 s63, 536870912
s_mov_b32 s50, 0
s_waitcnt vmcnt(24)
s_barrier
s_cmp_eq_u32 s41, 0
s_cbranch_scc0 L_g_p1
ds_read_b64_tr_b16 a[160:161], v5 offset:0
ds_read_b64_tr_b16 a[162:163], v5 offset:1024
ds_read_b64_tr_b16 a[164:165], v6 offset:0
ds_read_b64_tr_b16 a[166:167], v6 offset:1024
ds_read_b64_tr_b16 a[168:169], v7 offset:0
ds_read_b64_tr_b16 a[170:171], v7 offset:1024
ds_read_b64_tr_b16 a[172:173], v8 offset:0
ds_read_b64_tr_b16 a[174:175], v8 offset:1024
ds_read_b64_tr_b16 a[176:177], v9 offset:0
ds_read_b64_tr_b16 a[178:179], v9 offset:1024
ds_read_b64_tr_b16 a[180:181], v10 offset:0
ds_read_b64_tr_b16 a[182:183], v10 offset:1024
ds_read_b64_tr_b16 a[184:185], v11 offset:0
ds_read_b64_tr_b16 a[186:187], v11 offset:1024
ds_read_b64_tr_b16 a[188:189], v12 offset:0
ds_read_b64_tr_b16 a[190:191], v12 offset:1024
ds_read_b128 a[192:195], v3 offset:0
ds_read_b128 a[196:199], v4 offset:1024
ds_read_b128 a[200:203], v3 offset:4096
ds_read_b128 a[204:207], v4 offset:5120
ds_read_b128 a[208:211], v3 offset:8192
ds_read_b128 a[212:215], v4 offset:9216
ds_read_b128 a[216:219], v3 offset:12288
ds_read_b128 a[220:223], v4 offset:13312
s_branch L_g_p2
L_g_p1:
ds_read_b128 a[160:163], v3 offset:0
ds_read_b128 a[164:167], v4 offset:1024
ds_read_b128 a[168:171], v3 offset:4096
ds_read_b128 a[172:175], v4 offset:5120
ds_read_b128 a[176:179], v3 offset:8192
ds_read_b128 a[180:183], v4 offset:9216
ds_read_b128 a[184:187], v3 offset:12288
ds_read_b128 a[188:191], v4 offset:13312
ds_read_b64_tr_b16 a[192:193], v5 offset:0
ds_read_b64_tr_b16 a[194:195], v5 offset:1024
ds_read_b64_tr_b16 a[196:197], v6 offset:0
ds_read_b64_tr_b16 a[198:199], v6 offset:1024
ds_read_b64_tr_b16 a[200:201], v7 offset:0
ds_read_b64_tr_b16 a[202:203], v7 offset:1024
ds_read_b64_tr_b16 a[204:205], v8 offset:0
ds_read_b64_tr_b16 a[206:207], v8 offset:1024
ds_read_b64_tr_b16 a[208:209], v9 offset:0
ds_read_b64_tr_b16 a[210:211], v9 offset:1024
ds_read_b64_tr_b16 a[212:213], v10 offset:0
ds_read_b64_tr_b16 a[214:215], v10 offset:1024
ds_read_b64_tr_b16 a[216:217], v11 offset:0
ds_read_b64_tr_b16 a[218:219], v11 offset:1024
ds_read_b64_tr_b16 a[220:221], v12 offset:0
ds_read_b64_tr_b16 a[222:223], v12 offset:1024
L_g_p2:
v_add_u32 v5, 16384, v5
v_and_b32 v5, 65535, v5
v_xor_b32 v6, 16, v5
v_xor_b32 v7, 64, v5
v_xor_b32 v8, 80, v5
v_xor_b32 v9, 128, v5
v_xor_b32 v10, 144, v5
v_xor_b32 v11, 192, v5
v_xor_b32 v12, 208, v5
L_g_tile:
s_cmp_eq_u32 s35, 1
s_cbranch_scc1 L_g_first
L_g_go:
s_cmp_eq_u32 s41, 0
s_cbranch_scc0 L_g_v
.p2align 3
L_g_k:
s_waitcnt vmcnt(16) lgkmcnt(0)
s_barrier
v_mfma_f32_16x16x32_bf16 v[160:163], a[160:163], a[192:195], 0
ds_read_b128 a[224:227], v4 offset:0
v_accvgpr_read_b32 v20, a64
v_accvgpr_read_b32 v21, a65
v_accvgpr_read_b32 v22, a66
v_mfma_f32_16x16x32_bf16 v[164:167], a[160:163], a[196:199], 0
s_add_u32 s37, s31, 0
v_accvgpr_read_b32 v23, a67
v_cvt_pk_bf16_f32 v98, v20, v21
v_cvt_pk_bf16_f32 v99, v22, v23
v_mfma_f32_16x16x32_bf16 v[168:171], a[160:163], a[200:203], 0
s_add_u32 m0, s33, 0
ds_read_b128 a[228:231], v3 offset:1024
v_accvgpr_read_b32 v24, a68
v_accvgpr_read_b32 v25, a69
v_mfma_f32_16x16x32_bf16 v[172:175], a[160:163], a[204:207], 0
buffer_load_dwordx4 v2, s[20:23], s37 offen  lds
v_accvgpr_read_b32 v26, a70
v_accvgpr_read_b32 v27, a71
v_cvt_pk_bf16_f32 v102, v24, v25
v_mfma_f32_16x16x32_bf16 v[176:179], a[160:163], a[208:211], 0
ds_read_b128 a[232:235], v4 offset:4096
v_cvt_pk_bf16_f32 v103, v26, v27
v_accvgpr_read_b32 v20, a72
v_accvgpr_read_b32 v21, a73
v_mfma_f32_16x16x32_bf16 v[180:183], a[160:163], a[212:215], 0
v_accvgpr_read_b32 v22, a74
v_accvgpr_read_b32 v23, a75
v_cvt_pk_bf16_f32 v106, v20, v21
v_cvt_pk_bf16_f32 v107, v22, v23
v_mfma_f32_16x16x32_bf16 v[184:187], a[160:163], a[216:219], 0
ds_read_b128 a[236:239], v3 offset:5120
v_accvgpr_read_b32 v24, a76
v_accvgpr_read_b32 v25, a77
v_accvgpr_read_b32 v26, a78
v_mfma_f32_16x16x32_bf16 v[188:191], a[160:163], a[220:223], 0
ds_read_b64_tr_b16 a[160:161], v5 offset:0
v_accvgpr_read_b32 v27, a79
v_cvt_pk_bf16_f32 v110, v24, v25
v_cvt_pk_bf16_f32 v111, v26, v27
v_mfma_f32_16x16x32_bf16 v[192:195], a[164:167], a[192:195], 0
ds_read_b64_tr_b16 a[162:163], v5 offset:1024
ds_read_b128 a[240:243], v4 offset:8192
v_accvgpr_read_b32 v20, a80
v_accvgpr_read_b32 v21, a81
v_mfma_f32_16x16x32_bf16 v[196:199], a[164:167], a[196:199], 0
s_add_u32 s37, s31, 32768
v_accvgpr_read_b32 v22, a82
v_accvgpr_read_b32 v23, a83
v_cvt_pk_bf16_f32 v114, v20, v21
v_mfma_f32_16x16x32_bf16 v[200:203], a[164:167], a[200:203], 0
s_add_u32 m0, s33, 1024
ds_read_b128 a[244:247], v3 offset:9216
v_cvt_pk_bf16_f32 v115, v22, v23
v_accvgpr_read_b32 v24, a84
v_mfma_f32_16x16x32_bf16 v[204:207], a[164:167], a[204:207], 0
buffer_load_dwordx4 v2, s[20:23], s37 offen  lds
v_accvgpr_read_b32 v25, a85
v_accvgpr_read_b32 v26, a86
v_accvgpr_read_b32 v27, a87
v_mfma_f32_16x16x32_bf16 v[208:211], a[164:167], a[208:211], 0
ds_read_b128 a[248:251], v4 offset:12288
v_cvt_pk_bf16_f32 v118, v24, v25
v_cvt_pk_bf16_f32 v119, v26, v27
v_accvgpr_read_b32 v20, a88
v_mfma_f32_16x16x32_bf16 v[212:215], a[164:167], a[212:215], 0
v_accvgpr_read_b32 v21, a89
v_accvgpr_read_b32 v22, a90
v_accvgpr_read_b32 v23, a91
v_cvt_pk_bf16_f32 v122, v20, v21
v_mfma_f32_16x16x32_bf16 v[216:219], a[164:167], a[216:219], 0
ds_read_b128 a[252:255], v3 offset:13312
v_cvt_pk_bf16_f32 v123, v22, v23
v_accvgpr_read_b32 v24, a92
v_accvgpr_read_b32 v25, a93
v_mfma_f32_16x16x32_bf16 v[220:223], a[164:167], a[220:223], 0
ds_read_b64_tr_b16 a[164:165], v6 offset:0
v_accvgpr_read_b32 v26, a94
v_accvgpr_read_b32 v27, a95
v_cvt_pk_bf16_f32 v126, v24, v25
v_mfma_f32_16x16x32_bf16 v[224:227], a[168:171], a[192:195], 0
ds_read_b64_tr_b16 a[166:167], v6 offset:1024
ds_read_b64_tr_b16 v[28:29], v12 offset:0
v_cvt_pk_bf16_f32 v127, v26, v27
v_accvgpr_read_b32 v20, a96
v_mfma_f32_16x16x32_bf16 v[228:231], a[168:171], a[196:199], 0
s_add_u32 s37, s31, 131072
v_accvgpr_read_b32 v21, a97
v_accvgpr_read_b32 v22, a98
v_accvgpr_read_b32 v23, a99
v_mfma_f32_16x16x32_bf16 v[232:235], a[168:171], a[200:203], 0
s_add_u32 m0, s33, 4096
ds_read_b64_tr_b16 v[30:31], v12 offset:1024
v_cvt_pk_bf16_f32 v128, v20, v21
v_cvt_pk_bf16_f32 v129, v22, v23
v_mfma_f32_16x16x32_bf16 v[236:239], a[168:171], a[204:207], 0
buffer_load_dwordx4 v2, s[20:23], s37 offen  lds
v_accvgpr_read_b32 v24, a100
v_accvgpr_read_b32 v25, a101
v_accvgpr_read_b32 v26, a102
v_mfma_f32_16x16x32_bf16 v[240:243], a[168:171], a[208:211], 0
v_accvgpr_read_b32 v27, a103
v_cvt_pk_bf16_f32 v132, v24, v25
v_cvt_pk_bf16_f32 v133, v26, v27
v_accvgpr_read_b32 v20, a104
v_mfma_f32_16x16x32_bf16 v[244:247], a[168:171], a[212:215], 0
v_accvgpr_read_b32 v21, a105
v_accvgpr_read_b32 v22, a106
v_accvgpr_read_b32 v23, a107
v_cvt_pk_bf16_f32 v136, v20, v21
v_mfma_f32_16x16x32_bf16 v[248:251], a[168:171], a[216:219], 0
v_cvt_pk_bf16_f32 v137, v22, v23
v_accvgpr_read_b32 v24, a108
v_accvgpr_read_b32 v25, a109
v_accvgpr_read_b32 v26, a110
v_mfma_f32_16x16x32_bf16 v[252:255], a[168:171], a[220:223], 0
ds_read_b64_tr_b16 a[168:169], v7 offset:0
v_accvgpr_read_b32 v27, a111
v_cvt_pk_bf16_f32 v140, v24, v25
v_cvt_pk_bf16_f32 v141, v26, v27
v_mfma_f32_16x16x32_bf16 a[0:3], a[172:175], a[192:195], 0
ds_read_b64_tr_b16 a[170:171], v7 offset:1024
v_accvgpr_read_b32 v20, a112
v_accvgpr_read_b32 v21, a113
v_accvgpr_read_b32 v22, a114
v_mfma_f32_16x16x32_bf16 a[4:7], a[172:175], a[196:199], 0
s_add_u32 s37, s31, 163840
v_accvgpr_read_b32 v23, a115
v_cvt_pk_bf16_f32 v144, v20, v21
v_cvt_pk_bf16_f32 v145, v22, v23
v_mfma_f32_16x16x32_bf16 a[8:11], a[172:175], a[200:203], 0
s_add_u32 m0, s33, 5120
v_accvgpr_read_b32 v24, a116
v_accvgpr_read_b32 v25, a117
v_accvgpr_read_b32 v26, a118
v_mfma_f32_16x16x32_bf16 a[12:15], a[172:175], a[204:207], 0
buffer_load_dwordx4 v2, s[20:23], s37 offen  lds
v_accvgpr_read_b32 v27, a119
v_cvt_pk_bf16_f32 v148, v24, v25
v_cvt_pk_bf16_f32 v149, v26, v27
v_mfma_f32_16x16x32_bf16 a[16:19], a[172:175], a[208:211], 0
v_accvgpr_read_b32 v20, a120
v_accvgpr_read_b32 v21, a121
v_accvgpr_read_b32 v22, a122
v_accvgpr_read_b32 v23, a123
v_mfma_f32_16x16x32_bf16 a[20:23], a[172:175], a[212:215], 0
v_cvt_pk_bf16_f32 v152, v20, v21
v_cvt_pk_bf16_f32 v153, v22, v23
v_accvgpr_read_b32 v24, a124
v_accvgpr_read_b32 v25, a125
v_mfma_f32_16x16x32_bf16 a[24:27], a[172:175], a[216:219], 0
v_accvgpr_read_b32 v26, a126
v_accvgpr_read_b32 v27, a127
v_cvt_pk_bf16_f32 v156, v24, v25
v_cvt_pk_bf16_f32 v157, v26, v27
s_mov_b32 s38, s62
v_mfma_f32_16x16x32_bf16 a[28:31], a[172:175], a[220:223], 0
ds_read_b64_tr_b16 a[172:173], v8 offset:0
v_accvgpr_read_b32 v20, a128
v_accvgpr_read_b32 v21, a129
v_accvgpr_read_b32 v22, a130
s_mov_b32 s39, s63
v_mfma_f32_16x16x32_bf16 a[32:35], a[176:179], a[192:195], 0
ds_read_b64_tr_b16 a[174:175], v8 offset:1024
s_add_u32 s31, s31, 262144
v_accvgpr_read_b32 v23, a131
v_cvt_pk_bf16_f32 v130, v20, v21
s_mov_b32 s49, s50
v_mfma_f32_16x16x32_bf16 a[36:39], a[176:179], a[196:199], 0
s_add_u32 s48, s48, s34
s_add_u32 s33, s33, 16384
v_cvt_pk_bf16_f32 v131, v22, v23
v_accvgpr_read_b32 v24, a132
s_mov_b32 s62, s42
v_mfma_f32_16x16x32_bf16 a[40:43], a[176:179], a[200:203], 0
s_add_u32 m0, s32, 16384
s_and_b32 s33, s33, 65535
v_accvgpr_read_b32 v25, a133
v_accvgpr_read_b32 v26, a134
s_mov_b32 s63, s43
v_mfma_f32_16x16x32_bf16 a[44:47], a[176:179], a[204:207], 0
buffer_load_dwordx4 v1, s[12:15], s48 offen lds
v_accvgpr_read_b32 v27, a135
v_cvt_pk_bf16_f32 v134, v24, v25
v_cvt_pk_bf16_f32 v135, v26, v27
s_mov_b32 s50, s51
v_mfma_f32_16x16x32_bf16 a[48:51], a[176:179], a[208:211], 0
v_accvgpr_read_b32 v20, a136
v_accvgpr_read_b32 v21, a137
v_accvgpr_read_b32 v22, a138
v_accvgpr_read_b32 v23, a139
s_mov_b32 s36, s40
v_mfma_f32_16x16x32_bf16 a[52:55], a[176:179], a[212:215], 0
v_cvt_pk_bf16_f32 v138, v20, v21
v_cvt_pk_bf16_f32 v139, v22, v23
v_accvgpr_read_b32 v24, a140
v_accvgpr_read_b32 v25, a141
s_add_u32 s35, s35, 1
v_mfma_f32_16x16x32_bf16 a[56:59], a[176:179], a[216:219], 0
v_accvgpr_read_b32 v26, a142
v_accvgpr_read_b32 v27, a143
v_cvt_pk_bf16_f32 v142, v24, v25
v_cvt_pk_bf16_f32 v143, v26, v27
v_bfe_u32 v16, v0, 3, 3
v_mfma_f32_16x16x32_bf16 a[60:63], a[176:179], a[220:223], 0
ds_read_b64_tr_b16 a[176:177], v9 offset:0
v_accvgpr_read_b32 v20, a144
v_accvgpr_read_b32 v21, a145
v_accvgpr_read_b32 v22, a146
v_lshlrev_b32 v16, 4, v16
v_mfma_f32_16x16x32_bf16 a[64:67], a[180:183], a[192:195], 0
ds_read_b64_tr_b16 a[178:179], v9 offset:1024
v_accvgpr_read_b32 v23, a147
v_cvt_pk_bf16_f32 v146, v20, v21
v_cvt_pk_bf16_f32 v147, v22, v23
v_and_or_b32 v16, v0, 7, v16
v_mfma_f32_16x16x32_bf16 a[68:71], a[180:183], a[196:199], 0
s_add_u32 s48, s48, s34
v_accvgpr_read_b32 v24, a148
v_accvgpr_read_b32 v25, a149
v_accvgpr_read_b32 v26, a150
v_bfe_u32 v17, v0, 4, 2
v_mfma_f32_16x16x32_bf16 a[72:75], a[180:183], a[200:203], 0
s_add_u32 m0, s32, 20480
v_accvgpr_read_b32 v27, a151
v_cvt_pk_bf16_f32 v150, v24, v25
v_cvt_pk_bf16_f32 v151, v26, v27
v_lshlrev_b32 v17, 5, v17
v_mfma_f32_16x16x32_bf16 a[76:79], a[180:183], a[204:207], 0
buffer_load_dwordx4 v1, s[12:15], s48 offen lds
v_accvgpr_read_b32 v20, a152
v_accvgpr_read_b32 v21, a153
v_accvgpr_read_b32 v22, a154
v_and_or_b32 v17, v0, 8, v17
v_mfma_f32_16x16x32_bf16 a[80:83], a[180:183], a[208:211], 0
v_accvgpr_read_b32 v23, a155
v_cvt_pk_bf16_f32 v154, v20, v21
v_cvt_pk_bf16_f32 v155, v22, v23
v_accvgpr_read_b32 v24, a156
v_bfe_u32 v18, v0, 1, 2
v_mfma_f32_16x16x32_bf16 a[84:87], a[180:183], a[212:215], 0
v_accvgpr_read_b32 v25, a157
v_accvgpr_read_b32 v26, a158
v_accvgpr_read_b32 v27, a159
v_cvt_pk_bf16_f32 v158, v24, v25
v_or_b32 v17, v17, v18
v_mfma_f32_16x16x32_bf16 a[88:91], a[180:183], a[216:219], 0
v_cvt_pk_bf16_f32 v159, v26, v27
v_and_b32 v18, 1, v0
v_lshl_or_b32 v17, v18, 4, v17
v_mfma_f32_16x16x32_bf16 a[92:95], a[180:183], a[220:223], 0
ds_read_b64_tr_b16 a[180:181], v10 offset:0
s_bitcmp1_b32 s49, 1
s_cselect_b64 vcc, -1, 0
s_cselect_b32 s44, 64, 0x80
v_cndmask_b32 v16, v16, v17, vcc
v_mfma_f32_16x16x32_bf16 a[96:99], a[184:187], a[192:195], 0
ds_read_b64_tr_b16 a[182:183], v10 offset:1024
v_lshlrev_b32 v13, 4, v16
s_movk_i32 s92, 0x800
s_bitcmp1_b32 s49, 0
s_cselect_b32 s92, 0x4000, s92
v_mfma_f32_16x16x32_bf16 a[100:103], a[184:187], a[196:199], 0
s_add_u32 s48, s48, s34
s_xor_b32 s93, s92, 0x4800
s_sub_u32 s93, s93, s44
v_mfma_f32_16x16x32_bf16 a[104:107], a[184:187], a[200:203], 0
s_add_u32 m0, s32, 24576
v_mfma_f32_16x16x32_bf16 a[108:111], a[184:187], a[204:207], 0
buffer_load_dwordx4 v1, s[12:15], s48 offen lds
v_mfma_f32_16x16x32_bf16 a[112:115], a[184:187], a[208:211], 0
v_mfma_f32_16x16x32_bf16 a[116:119], a[184:187], a[212:215], 0
v_mfma_f32_16x16x32_bf16 a[120:123], a[184:187], a[216:219], 0
v_mfma_f32_16x16x32_bf16 a[124:127], a[184:187], a[220:223], 0
ds_read_b64_tr_b16 a[184:185], v11 offset:0
v_mfma_f32_16x16x32_bf16 a[128:131], a[188:191], a[192:195], 0
ds_read_b64_tr_b16 a[186:187], v11 offset:1024
v_mfma_f32_16x16x32_bf16 a[132:135], a[188:191], a[196:199], 0
s_add_u32 s48, s48, s34
v_add_u32 v3, 32768, v3
v_subrev_u32 v19, 98304, v3
v_mfma_f32_16x16x32_bf16 a[136:139], a[188:191], a[200:203], 0
s_add_u32 m0, s32, 28672
v_cmp_le_u32 vcc, 163840, v3
v_add_u32 v5, 16384, v5
v_mfma_f32_16x16x32_bf16 a[140:143], a[188:191], a[204:207], 0
buffer_load_dwordx4 v1, s[12:15], s48 offen lds
v_and_b32 v5, 65535, v5
v_xor_b32 v6, 16, v5
v_mfma_f32_16x16x32_bf16 a[144:147], a[188:191], a[208:211], 0
s_add_u32 s30, s30, 128
s_add_u32 s32, s32, 32768
s_sub_u32 s48, s32, 98304
v_mfma_f32_16x16x32_bf16 a[148:151], a[188:191], a[212:215], 0
s_cmp_ge_u32 s32, 163840
s_cselect_b32 s32, s48, s32
v_xor_b32 v7, 64, v5
v_mfma_f32_16x16x32_bf16 a[152:155], a[188:191], a[216:219], 0
v_xor_b32 v8, 80, v5
v_xor_b32 v9, 128, v5
v_xor_b32 v10, 144, v5
v_mfma_f32_16x16x32_bf16 a[156:159], a[188:191], a[220:223], 0
v_xor_b32 v11, 192, v5
v_xor_b32 v12, 208, v5
v_cndmask_b32 v3, v3, v19, vcc
v_xor_b32 v4, 64, v3
s_waitcnt vmcnt(16) lgkmcnt(0)
s_barrier
v_mfma_f32_16x16x32_bf16 v[160:163], a[160:163], a[224:227], v[160:163]
ds_read_b128 a[192:195], v3 offset:0
v_mfma_f32_16x16x32_bf16 v[164:167], a[160:163], a[228:231], v[164:167]
s_add_u32 s37, s31, 0
v_mfma_f32_16x16x32_bf16 v[168:171], a[160:163], a[232:235], v[168:171]
s_add_u32 m0, s33, 0
ds_read_b128 a[196:199], v4 offset:1024
v_mfma_f32_16x16x32_bf16 v[172:175], a[160:163], a[236:239], v[172:175]
buffer_load_dwordx4 v2, s[20:23], s37 offen  lds
s_mov_b32 s60, s38
v_mfma_f32_16x16x32_bf16 v[176:179], a[160:163], a[240:243], v[176:179]
s_mov_b32 s29, s38
ds_read_b128 a[200:203], v3 offset:4096
v_mfma_f32_16x16x32_bf16 v[180:183], a[160:163], a[244:247], v[180:183]
buffer_store_dwordx4 v[32:35], v13, s[8:11], s29 offen sc1
v_mfma_f32_16x16x32_bf16 v[184:187], a[160:163], a[248:251], v[184:187]
ds_read_b128 a[204:207], v4 offset:5120
v_mfma_f32_16x16x32_bf16 v[188:191], a[160:163], a[252:255], v[188:191]
ds_read_b64_tr_b16 a[160:161], v5 offset:0
v_mfma_f32_16x16x32_bf16 v[192:195], a[164:167], a[224:227], v[192:195]
ds_read_b64_tr_b16 a[162:163], v5 offset:1024
ds_read_b128 a[208:211], v3 offset:8192
v_mfma_f32_16x16x32_bf16 v[196:199], a[164:167], a[228:231], v[196:199]
s_add_u32 s37, s31, 32768
v_mfma_f32_16x16x32_bf16 v[200:203], a[164:167], a[232:235], v[200:203]
s_add_u32 m0, s33, 1024
ds_read_b128 a[212:215], v4 offset:9216
v_mfma_f32_16x16x32_bf16 v[204:207], a[164:167], a[236:239], v[204:207]
buffer_load_dwordx4 v2, s[20:23], s37 offen  lds
v_mfma_f32_16x16x32_bf16 v[208:211], a[164:167], a[240:243], v[208:211]
ds_read_b128 a[216:219], v3 offset:12288
v_mfma_f32_16x16x32_bf16 v[212:215], a[164:167], a[244:247], v[212:215]
v_mfma_f32_16x16x32_bf16 v[216:219], a[164:167], a[248:251], v[216:219]
ds_read_b128 a[220:223], v4 offset:13312
v_mfma_f32_16x16x32_bf16 v[220:223], a[164:167], a[252:255], v[220:223]
ds_read_b64_tr_b16 a[164:165], v6 offset:0
v_mfma_f32_16x16x32_bf16 v[224:227], a[168:171], a[224:227], v[224:227]
ds_read_b64_tr_b16 a[166:167], v6 offset:1024
ds_read_b64_tr_b16 a[188:189], v12 offset:0
v_mfma_f32_16x16x32_bf16 v[228:231], a[168:171], a[228:231], v[228:231]
s_add_u32 s37, s31, 131072
v_mfma_f32_16x16x32_bf16 v[232:235], a[168:171], a[232:235], v[232:235]
s_add_u32 m0, s33, 4096
ds_read_b64_tr_b16 a[190:191], v12 offset:1024
v_mfma_f32_16x16x32_bf16 v[236:239], a[168:171], a[236:239], v[236:239]
buffer_load_dwordx4 v2, s[20:23], s37 offen  lds
v_mfma_f32_16x16x32_bf16 v[240:243], a[168:171], a[240:243], v[240:243]
v_mfma_f32_16x16x32_bf16 v[244:247], a[168:171], a[244:247], v[244:247]
v_mfma_f32_16x16x32_bf16 v[248:251], a[168:171], a[248:251], v[248:251]
v_mfma_f32_16x16x32_bf16 v[252:255], a[168:171], a[252:255], v[252:255]
ds_read_b64_tr_b16 a[168:169], v7 offset:0
v_mfma_f32_16x16x32_bf16 a[0:3], a[172:175], a[224:227], a[0:3]
ds_read_b64_tr_b16 a[170:171], v7 offset:1024
v_mfma_f32_16x16x32_bf16 a[4:7], a[172:175], a[228:231], a[4:7]
s_add_u32 s37, s31, 163840
v_mfma_f32_16x16x32_bf16 a[8:11], a[172:175], a[232:235], a[8:11]
s_add_u32 m0, s33, 5120
v_mfma_f32_16x16x32_bf16 a[12:15], a[172:175], a[236:239], a[12:15]
buffer_load_dwordx4 v2, s[20:23], s37 offen  lds
s_add_u32 s29, s29, s44
v_mfma_f32_16x16x32_bf16 a[16:19], a[172:175], a[240:243], a[16:19]
v_mfma_f32_16x16x32_bf16 a[20:23], a[172:175], a[244:247], a[20:23]
buffer_store_dwordx4 v[36:39], v13, s[8:11], s29 offen sc1
v_mfma_f32_16x16x32_bf16 a[24:27], a[172:175], a[248:251], a[24:27]
v_mfma_f32_16x16x32_bf16 a[28:31], a[172:175], a[252:255], a[28:31]
ds_read_b64_tr_b16 a[172:173], v8 offset:0
v_mfma_f32_16x16x32_bf16 a[32:35], a[176:179], a[224:227], a[32:35]
ds_read_b64_tr_b16 a[174:175], v8 offset:1024
s_add_u32 s31, s31, 262144
v_mfma_f32_16x16x32_bf16 a[36:39], a[176:179], a[228:231], a[36:39]
s_mov_b32 s48, s30
s_add_u32 s33, s33, 16384
v_mfma_f32_16x16x32_bf16 a[40:43], a[176:179], a[232:235], a[40:43]
s_add_u32 m0, s32, 0
s_and_b32 s33, s33, 65535
v_mfma_f32_16x16x32_bf16 a[44:47], a[176:179], a[236:239], a[44:47]
buffer_load_dwordx4 v1, s[12:15], s48 offen lds
v_mfma_f32_16x16x32_bf16 a[48:51], a[176:179], a[240:243], a[48:51]
v_mfma_f32_16x16x32_bf16 a[52:55], a[176:179], a[244:247], a[52:55]
v_mfma_f32_16x16x32_bf16 a[56:59], a[176:179], a[248:251], a[56:59]
v_mfma_f32_16x16x32_bf16 a[60:63], a[176:179], a[252:255], a[60:63]
ds_read_b64_tr_b16 a[176:177], v9 offset:0
v_mfma_f32_16x16x32_bf16 a[64:67], a[180:183], a[224:227], a[64:67]
ds_read_b64_tr_b16 a[178:179], v9 offset:1024
v_mfma_f32_16x16x32_bf16 a[68:71], a[180:183], a[228:231], a[68:71]
s_add_u32 s48, s48, s34
v_mfma_f32_16x16x32_bf16 a[72:75], a[180:183], a[232:235], a[72:75]
s_add_u32 m0, s32, 4096
v_mfma_f32_16x16x32_bf16 a[76:79], a[180:183], a[236:239], a[76:79]
buffer_load_dwordx4 v1, s[12:15], s48 offen lds
v_mfma_f32_16x16x32_bf16 a[80:83], a[180:183], a[240:243], a[80:83]
v_mfma_f32_16x16x32_bf16 a[84:87], a[180:183], a[244:247], a[84:87]
v_mfma_f32_16x16x32_bf16 a[88:91], a[180:183], a[248:251], a[88:91]
v_mfma_f32_16x16x32_bf16 a[92:95], a[180:183], a[252:255], a[92:95]
ds_read_b64_tr_b16 a[180:181], v10 offset:0
v_mfma_f32_16x16x32_bf16 a[96:99], a[184:187], a[224:227], a[96:99]
ds_read_b64_tr_b16 a[182:183], v10 offset:1024
v_mfma_f32_16x16x32_bf16 a[100:103], a[184:187], a[228:231], a[100:103]
s_add_u32 s48, s48, s34
v_mfma_f32_16x16x32_bf16 a[104:107], a[184:187], a[232:235], a[104:107]
s_add_u32 m0, s32, 8192
v_mfma_f32_16x16x32_bf16 a[108:111], a[184:187], a[236:239], a[108:111]
buffer_load_dwordx4 v1, s[12:15], s48 offen lds
s_add_u32 s29, s29, s93
v_mfma_f32_16x16x32_bf16 a[112:115], a[184:187], a[240:243], a[112:115]
v_mfma_f32_16x16x32_bf16 a[116:119], a[184:187], a[244:247], a[116:119]
buffer_store_dwordx4 v[40:43], v13, s[8:11], s29 offen sc1
v_mfma_f32_16x16x32_bf16 a[120:123], a[184:187], a[248:251], a[120:123]
v_mfma_f32_16x16x32_bf16 a[124:127], a[184:187], a[252:255], a[124:127]
ds_read_b64_tr_b16 a[184:185], v11 offset:0
v_mfma_f32_16x16x32_bf16 a[128:131], v[28:31], a[224:227], a[128:131]
ds_read_b64_tr_b16 a[186:187], v11 offset:1024
v_mfma_f32_16x16x32_bf16 a[132:135], v[28:31], a[228:231], a[132:135]
s_add_u32 s48, s48, s34
v_add_u32 v5, 16384, v5
v_and_b32 v5, 65535, v5
v_mfma_f32_16x16x32_bf16 a[136:139], v[28:31], a[232:235], a[136:139]
s_add_u32 m0, s32, 12288
v_xor_b32 v6, 16, v5
v_xor_b32 v7, 64, v5
v_mfma_f32_16x16x32_bf16 a[140:143], v[28:31], a[236:239], a[140:143]
buffer_load_dwordx4 v1, s[12:15], s48 offen lds
v_xor_b32 v8, 80, v5
v_xor_b32 v9, 128, v5
v_mfma_f32_16x16x32_bf16 a[144:147], v[28:31], a[240:243], a[144:147]
v_xor_b32 v10, 144, v5
v_xor_b32 v11, 192, v5
v_xor_b32 v12, 208, v5
v_mfma_f32_16x16x32_bf16 a[148:151], v[28:31], a[244:247], a[148:151]
v_mfma_f32_16x16x32_bf16 a[152:155], v[28:31], a[248:251], a[152:155]
v_mfma_f32_16x16x32_bf16 a[156:159], v[28:31], a[252:255], a[156:159]
s_waitcnt vmcnt(19) lgkmcnt(0)
s_barrier
v_mfma_f32_16x16x32_bf16 v[160:163], a[160:163], a[192:195], v[160:163]
ds_read_b128 a[224:227], v4 offset:0
v_mfma_f32_16x16x32_bf16 v[164:167], a[160:163], a[196:199], v[164:167]
s_add_u32 s37, s31, 0
v_mfma_f32_16x16x32_bf16 v[168:171], a[160:163], a[200:203], v[168:171]
s_add_u32 m0, s33, 0
ds_read_b128 a[228:231], v3 offset:1024
v_mfma_f32_16x16x32_bf16 v[172:175], a[160:163], a[204:207], v[172:175]
buffer_load_dwordx4 v2, s[20:23], s37 offen  lds
s_add_u32 s29, s29, s44
v_mfma_f32_16x16x32_bf16 v[176:179], a[160:163], a[208:211], v[176:179]
ds_read_b128 a[232:235], v4 offset:4096
v_mfma_f32_16x16x32_bf16 v[180:183], a[160:163], a[212:215], v[180:183]
buffer_store_dwordx4 v[44:47], v13, s[8:11], s29 offen sc1
v_mfma_f32_16x16x32_bf16 v[184:187], a[160:163], a[216:219], v[184:187]
ds_read_b128 a[236:239], v3 offset:5120
v_mfma_f32_16x16x32_bf16 v[188:191], a[160:163], a[220:223], v[188:191]
ds_read_b64_tr_b16 a[160:161], v5 offset:0
v_mfma_f32_16x16x32_bf16 v[192:195], a[164:167], a[192:195], v[192:195]
ds_read_b64_tr_b16 a[162:163], v5 offset:1024
ds_read_b128 a[240:243], v4 offset:8192
v_mfma_f32_16x16x32_bf16 v[196:199], a[164:167], a[196:199], v[196:199]
s_add_u32 s37, s31, 32768
v_mfma_f32_16x16x32_bf16 v[200:203], a[164:167], a[200:203], v[200:203]
s_add_u32 m0, s33, 1024
ds_read_b128 a[244:247], v3 offset:9216
v_mfma_f32_16x16x32_bf16 v[204:207], a[164:167], a[204:207], v[204:207]
buffer_load_dwordx4 v2, s[20:23], s37 offen  lds
v_mfma_f32_16x16x32_bf16 v[208:211], a[164:167], a[208:211], v[208:211]
ds_read_b128 a[248:251], v4 offset:12288
v_mfma_f32_16x16x32_bf16 v[212:215], a[164:167], a[212:215], v[212:215]
v_mfma_f32_16x16x32_bf16 v[216:219], a[164:167], a[216:219], v[216:219]
ds_read_b128 a[252:255], v3 offset:13312
v_mfma_f32_16x16x32_bf16 v[220:223], a[164:167], a[220:223], v[220:223]
ds_read_b64_tr_b16 a[164:165], v6 offset:0
v_mfma_f32_16x16x32_bf16 v[224:227], a[168:171], a[192:195], v[224:227]
ds_read_b64_tr_b16 a[166:167], v6 offset:1024
ds_read_b64_tr_b16 v[28:29], v12 offset:0
v_mfma_f32_16x16x32_bf16 v[228:231], a[168:171], a[196:199], v[228:231]
s_add_u32 s37, s31, 131072
v_mfma_f32_16x16x32_bf16 v[232:235], a[168:171], a[200:203], v[232:235]
s_add_u32 m0, s33, 4096
ds_read_b64_tr_b16 v[30:31], v12 offset:1024
v_mfma_f32_16x16x32_bf16 v[236:239], a[168:171], a[204:207], v[236:239]
buffer_load_dwordx4 v2, s[20:23], s37 offen  lds
v_mfma_f32_16x16x32_bf16 v[240:243], a[168:171], a[208:211], v[240:243]
v_mfma_f32_16x16x32_bf16 v[244:247], a[168:171], a[212:215], v[244:247]
v_mfma_f32_16x16x32_bf16 v[248:251], a[168:171], a[216:219], v[248:251]
v_mfma_f32_16x16x32_bf16 v[252:255], a[168:171], a[220:223], v[252:255]
ds_read_b64_tr_b16 a[168:169], v7 offset:0
v_mfma_f32_16x16x32_bf16 a[0:3], a[172:175], a[192:195], a[0:3]
ds_read_b64_tr_b16 a[170:171], v7 offset:1024
v_mfma_f32_16x16x32_bf16 a[4:7], a[172:175], a[196:199], a[4:7]
s_add_u32 s37, s31, 163840
v_mfma_f32_16x16x32_bf16 a[8:11], a[172:175], a[200:203], a[8:11]
s_add_u32 m0, s33, 5120
v_mfma_f32_16x16x32_bf16 a[12:15], a[172:175], a[204:207], a[12:15]
buffer_load_dwordx4 v2, s[20:23], s37 offen  lds
s_add_u32 s29, s29, s93
v_mfma_f32_16x16x32_bf16 a[16:19], a[172:175], a[208:211], a[16:19]
v_mfma_f32_16x16x32_bf16 a[20:23], a[172:175], a[212:215], a[20:23]
buffer_store_dwordx4 v[48:51], v13, s[8:11], s29 offen sc1
v_mfma_f32_16x16x32_bf16 a[24:27], a[172:175], a[216:219], a[24:27]
v_mfma_f32_16x16x32_bf16 a[28:31], a[172:175], a[220:223], a[28:31]
ds_read_b64_tr_b16 a[172:173], v8 offset:0
v_mfma_f32_16x16x32_bf16 a[32:35], a[176:179], a[192:195], a[32:35]
ds_read_b64_tr_b16 a[174:175], v8 offset:1024
s_add_u32 s31, s31, 262144
v_mfma_f32_16x16x32_bf16 a[36:39], a[176:179], a[196:199], a[36:39]
s_add_u32 s48, s48, s34
s_add_u32 s33, s33, 16384
v_mfma_f32_16x16x32_bf16 a[40:43], a[176:179], a[200:203], a[40:43]
s_add_u32 m0, s32, 16384
s_and_b32 s33, s33, 65535
v_mfma_f32_16x16x32_bf16 a[44:47], a[176:179], a[204:207], a[44:47]
buffer_load_dwordx4 v1, s[12:15], s48 offen lds
v_mfma_f32_16x16x32_bf16 a[48:51], a[176:179], a[208:211], a[48:51]
v_mfma_f32_16x16x32_bf16 a[52:55], a[176:179], a[212:215], a[52:55]
v_mfma_f32_16x16x32_bf16 a[56:59], a[176:179], a[216:219], a[56:59]
v_mfma_f32_16x16x32_bf16 a[60:63], a[176:179], a[220:223], a[60:63]
ds_read_b64_tr_b16 a[176:177], v9 offset:0
v_mfma_f32_16x16x32_bf16 a[64:67], a[180:183], a[192:195], a[64:67]
ds_read_b64_tr_b16 a[178:179], v9 offset:1024
v_mfma_f32_16x16x32_bf16 a[68:71], a[180:183], a[196:199], a[68:71]
s_add_u32 s48, s48, s34
v_mfma_f32_16x16x32_bf16 a[72:75], a[180:183], a[200:203], a[72:75]
s_add_u32 m0, s32, 20480
v_mfma_f32_16x16x32_bf16 a[76:79], a[180:183], a[204:207], a[76:79]
buffer_load_dwordx4 v1, s[12:15], s48 offen lds
v_mfma_f32_16x16x32_bf16 a[80:83], a[180:183], a[208:211], a[80:83]
v_mfma_f32_16x16x32_bf16 a[84:87], a[180:183], a[212:215], a[84:87]
v_mfma_f32_16x16x32_bf16 a[88:91], a[180:183], a[216:219], a[88:91]
v_mfma_f32_16x16x32_bf16 a[92:95], a[180:183], a[220:223], a[92:95]
ds_read_b64_tr_b16 a[180:181], v10 offset:0
v_mfma_f32_16x16x32_bf16 a[96:99], a[184:187], a[192:195], a[96:99]
ds_read_b64_tr_b16 a[182:183], v10 offset:1024
v_mfma_f32_16x16x32_bf16 a[100:103], a[184:187], a[196:199], a[100:103]
s_add_u32 s48, s48, s34
v_mfma_f32_16x16x32_bf16 a[104:107], a[184:187], a[200:203], a[104:107]
s_add_u32 m0, s32, 24576
v_mfma_f32_16x16x32_bf16 a[108:111], a[184:187], a[204:207], a[108:111]
buffer_load_dwordx4 v1, s[12:15], s48 offen lds
s_add_u32 s29, s29, s44
v_mfma_f32_16x16x32_bf16 a[112:115], a[184:187], a[208:211], a[112:115]
v_mfma_f32_16x16x32_bf16 a[116:119], a[184:187], a[212:215], a[116:119]
buffer_store_dwordx4 v[52:55], v13, s[8:11], s29 offen sc1
v_mfma_f32_16x16x32_bf16 a[120:123], a[184:187], a[216:219], a[120:123]
v_mfma_f32_16x16x32_bf16 a[124:127], a[184:187], a[220:223], a[124:127]
ds_read_b64_tr_b16 a[184:185], v11 offset:0
v_mfma_f32_16x16x32_bf16 a[128:131], a[188:191], a[192:195], a[128:131]
ds_read_b64_tr_b16 a[186:187], v11 offset:1024
v_mfma_f32_16x16x32_bf16 a[132:135], a[188:191], a[196:199], a[132:135]
s_add_u32 s48, s48, s34
v_add_u32 v3, 32768, v3
v_subrev_u32 v19, 98304, v3
v_mfma_f32_16x16x32_bf16 a[136:139], a[188:191], a[200:203], a[136:139]
s_add_u32 m0, s32, 28672
v_cmp_le_u32 vcc, 163840, v3
v_add_u32 v5, 16384, v5
v_mfma_f32_16x16x32_bf16 a[140:143], a[188:191], a[204:207], a[140:143]
buffer_load_dwordx4 v1, s[12:15], s48 offen lds
v_and_b32 v5, 65535, v5
v_xor_b32 v6, 16, v5
v_mfma_f32_16x16x32_bf16 a[144:147], a[188:191], a[208:211], a[144:147]
s_add_u32 s30, s30, 128
s_add_u32 s32, s32, 32768
s_sub_u32 s48, s32, 98304
v_mfma_f32_16x16x32_bf16 a[148:151], a[188:191], a[212:215], a[148:151]
s_cmp_ge_u32 s32, 163840
s_cselect_b32 s32, s48, s32
v_xor_b32 v7, 64, v5
v_mfma_f32_16x16x32_bf16 a[152:155], a[188:191], a[216:219], a[152:155]
v_xor_b32 v8, 80, v5
v_xor_b32 v9, 128, v5
v_xor_b32 v10, 144, v5
v_mfma_f32_16x16x32_bf16 a[156:159], a[188:191], a[220:223], a[156:159]
v_xor_b32 v11, 192, v5
v_xor_b32 v12, 208, v5
v_cndmask_b32 v3, v3, v19, vcc
v_xor_b32 v4, 64, v3
s_waitcnt vmcnt(22) lgkmcnt(0)
s_barrier
v_mfma_f32_16x16x32_bf16 v[160:163], a[160:163], a[224:227], v[160:163]
ds_read_b128 a[192:195], v3 offset:0
v_mfma_f32_16x16x32_bf16 v[164:167], a[160:163], a[228:231], v[164:167]
s_add_u32 s37, s31, 0
v_mfma_f32_16x16x32_bf16 v[168:171], a[160:163], a[232:235], v[168:171]
s_add_u32 m0, s33, 0
ds_read_b128 a[196:199], v4 offset:1024
v_mfma_f32_16x16x32_bf16 v[172:175], a[160:163], a[236:239], v[172:175]
buffer_load_dwordx4 v2, s[20:23], s37 offen  lds
s_add_u32 s29, s29, s93
v_mfma_f32_16x16x32_bf16 v[176:179], a[160:163], a[240:243], v[176:179]
ds_read_b128 a[200:203], v3 offset:4096
v_mfma_f32_16x16x32_bf16 v[180:183], a[160:163], a[244:247], v[180:183]
buffer_store_dwordx4 v[56:59], v13, s[8:11], s29 offen sc1
v_mfma_f32_16x16x32_bf16 v[184:187], a[160:163], a[248:251], v[184:187]
ds_read_b128 a[204:207], v4 offset:5120
v_mfma_f32_16x16x32_bf16 v[188:191], a[160:163], a[252:255], v[188:191]
ds_read_b64_tr_b16 a[160:161], v5 offset:0
v_mfma_f32_16x16x32_bf16 v[192:195], a[164:167], a[224:227], v[192:195]
ds_read_b64_tr_b16 a[162:163], v5 offset:1024
ds_read_b128 a[208:211], v3 offset:8192
v_mfma_f32_16x16x32_bf16 v[196:199], a[164:167], a[228:231], v[196:199]
s_add_u32 s37, s31, 32768
v_mfma_f32_16x16x32_bf16 v[200:203], a[164:167], a[232:235], v[200:203]
s_add_u32 m0, s33, 1024
ds_read_b128 a[212:215], v4 offset:9216
v_mfma_f32_16x16x32_bf16 v[204:207], a[164:167], a[236:239], v[204:207]
buffer_load_dwordx4 v2, s[20:23], s37 offen  lds
v_mfma_f32_16x16x32_bf16 v[208:211], a[164:167], a[240:243], v[208:211]
ds_read_b128 a[216:219], v3 offset:12288
v_mfma_f32_16x16x32_bf16 v[212:215], a[164:167], a[244:247], v[212:215]
v_mfma_f32_16x16x32_bf16 v[216:219], a[164:167], a[248:251], v[216:219]
ds_read_b128 a[220:223], v4 offset:13312
v_mfma_f32_16x16x32_bf16 v[220:223], a[164:167], a[252:255], v[220:223]
ds_read_b64_tr_b16 a[164:165], v6 offset:0
v_mfma_f32_16x16x32_bf16 v[224:227], a[168:171], a[224:227], v[224:227]
ds_read_b64_tr_b16 a[166:167], v6 offset:1024
ds_read_b64_tr_b16 a[188:189], v12 offset:0
v_mfma_f32_16x16x32_bf16 v[228:231], a[168:171], a[228:231], v[228:231]
s_add_u32 s37, s31, 131072
v_mfma_f32_16x16x32_bf16 v[232:235], a[168:171], a[232:235], v[232:235]
s_add_u32 m0, s33, 4096
ds_read_b64_tr_b16 a[190:191], v12 offset:1024
v_mfma_f32_16x16x32_bf16 v[236:239], a[168:171], a[236:239], v[236:239]
buffer_load_dwordx4 v2, s[20:23], s37 offen  lds
v_mfma_f32_16x16x32_bf16 v[240:243], a[168:171], a[240:243], v[240:243]
v_mfma_f32_16x16x32_bf16 v[244:247], a[168:171], a[244:247], v[244:247]
v_mfma_f32_16x16x32_bf16 v[248:251], a[168:171], a[248:251], v[248:251]
v_mfma_f32_16x16x32_bf16 v[252:255], a[168:171], a[252:255], v[252:255]
ds_read_b64_tr_b16 a[168:169], v7 offset:0
v_mfma_f32_16x16x32_bf16 a[0:3], a[172:175], a[224:227], a[0:3]
ds_read_b64_tr_b16 a[170:171], v7 offset:1024
v_mfma_f32_16x16x32_bf16 a[4:7], a[172:175], a[228:231], a[4:7]
s_add_u32 s37, s31, 163840
v_mfma_f32_16x16x32_bf16 a[8:11], a[172:175], a[232:235], a[8:11]
s_add_u32 m0, s33, 5120
v_mfma_f32_16x16x32_bf16 a[12:15], a[172:175], a[236:239], a[12:15]
buffer_load_dwordx4 v2, s[20:23], s37 offen  lds
s_add_u32 s29, s29, s44
v_mfma_f32_16x16x32_bf16 a[16:19], a[172:175], a[240:243], a[16:19]
v_mfma_f32_16x16x32_bf16 a[20:23], a[172:175], a[244:247], a[20:23]
buffer_store_dwordx4 v[60:63], v13, s[8:11], s29 offen sc1
v_mfma_f32_16x16x32_bf16 a[24:27], a[172:175], a[248:251], a[24:27]
v_mfma_f32_16x16x32_bf16 a[28:31], a[172:175], a[252:255], a[28:31]
ds_read_b64_tr_b16 a[172:173], v8 offset:0
v_mfma_f32_16x16x32_bf16 a[32:35], a[176:179], a[224:227], a[32:35]
ds_read_b64_tr_b16 a[174:175], v8 offset:1024
s_add_u32 s31, s31, 262144
v_mfma_f32_16x16x32_bf16 a[36:39], a[176:179], a[228:231], a[36:39]
s_mov_b32 s48, s30
s_add_u32 s33, s33, 16384
v_mfma_f32_16x16x32_bf16 a[40:43], a[176:179], a[232:235], a[40:43]
s_add_u32 m0, s32, 0
s_and_b32 s33, s33, 65535
v_mfma_f32_16x16x32_bf16 a[44:47], a[176:179], a[236:239], a[44:47]
buffer_load_dwordx4 v1, s[12:15], s48 offen lds
v_mfma_f32_16x16x32_bf16 a[48:51], a[176:179], a[240:243], a[48:51]
v_mfma_f32_16x16x32_bf16 a[52:55], a[176:179], a[244:247], a[52:55]
v_mfma_f32_16x16x32_bf16 a[56:59], a[176:179], a[248:251], a[56:59]
v_mfma_f32_16x16x32_bf16 a[60:63], a[176:179], a[252:255], a[60:63]
ds_read_b64_tr_b16 a[176:177], v9 offset:0
v_mfma_f32_16x16x32_bf16 a[64:67], a[180:183], a[224:227], a[64:67]
ds_read_b64_tr_b16 a[178:179], v9 offset:1024
v_mfma_f32_16x16x32_bf16 a[68:71], a[180:183], a[228:231], a[68:71]
s_add_u32 s48, s48, s34
v_mfma_f32_16x16x32_bf16 a[72:75], a[180:183], a[232:235], a[72:75]
s_add_u32 m0, s32, 4096
v_mfma_f32_16x16x32_bf16 a[76:79], a[180:183], a[236:239], a[76:79]
buffer_load_dwordx4 v1, s[12:15], s48 offen lds
v_mfma_f32_16x16x32_bf16 a[80:83], a[180:183], a[240:243], a[80:83]
v_mfma_f32_16x16x32_bf16 a[84:87], a[180:183], a[244:247], a[84:87]
v_mfma_f32_16x16x32_bf16 a[88:91], a[180:183], a[248:251], a[88:91]
v_mfma_f32_16x16x32_bf16 a[92:95], a[180:183], a[252:255], a[92:95]
ds_read_b64_tr_b16 a[180:181], v10 offset:0
v_mfma_f32_16x16x32_bf16 a[96:99], a[184:187], a[224:227], a[96:99]
ds_read_b64_tr_b16 a[182:183], v10 offset:1024
v_mfma_f32_16x16x32_bf16 a[100:103], a[184:187], a[228:231], a[100:103]
s_add_u32 s48, s48, s34
v_mfma_f32_16x16x32_bf16 a[104:107], a[184:187], a[232:235], a[104:107]
s_add_u32 m0, s32, 8192
v_mfma_f32_16x16x32_bf16 a[108:111], a[184:187], a[236:239], a[108:111]
buffer_load_dwordx4 v1, s[12:15], s48 offen lds
v_mfma_f32_16x16x32_bf16 a[112:115], a[184:187], a[240:243], a[112:115]
v_mfma_f32_16x16x32_bf16 a[116:119], a[184:187], a[244:247], a[116:119]
v_mfma_f32_16x16x32_bf16 a[120:123], a[184:187], a[248:251], a[120:123]
v_mfma_f32_16x16x32_bf16 a[124:127], a[184:187], a[252:255], a[124:127]
ds_read_b64_tr_b16 a[184:185], v11 offset:0
v_mfma_f32_16x16x32_bf16 a[128:131], v[28:31], a[224:227], a[128:131]
ds_read_b64_tr_b16 a[186:187], v11 offset:1024
v_mfma_f32_16x16x32_bf16 a[132:135], v[28:31], a[228:231], a[132:135]
s_add_u32 s48, s48, s34
v_add_u32 v5, 16384, v5
v_and_b32 v5, 65535, v5
v_mfma_f32_16x16x32_bf16 a[136:139], v[28:31], a[232:235], a[136:139]
s_add_u32 m0, s32, 12288
v_xor_b32 v6, 16, v5
v_xor_b32 v7, 64, v5
v_mfma_f32_16x16x32_bf16 a[140:143], v[28:31], a[236:239], a[140:143]
buffer_load_dwordx4 v1, s[12:15], s48 offen lds
v_xor_b32 v8, 80, v5
v_xor_b32 v9, 128, v5
v_mfma_f32_16x16x32_bf16 a[144:147], v[28:31], a[240:243], a[144:147]
v_xor_b32 v10, 144, v5
v_xor_b32 v11, 192, v5
v_xor_b32 v12, 208, v5
v_mfma_f32_16x16x32_bf16 a[148:151], v[28:31], a[244:247], a[148:151]
v_mfma_f32_16x16x32_bf16 a[152:155], v[28:31], a[248:251], a[152:155]
v_mfma_f32_16x16x32_bf16 a[156:159], v[28:31], a[252:255], a[156:159]
s_waitcnt vmcnt(21) lgkmcnt(0)
s_barrier
v_mfma_f32_16x16x32_bf16 v[160:163], a[160:163], a[192:195], v[160:163]
ds_read_b128 a[224:227], v4 offset:0
v_mfma_f32_16x16x32_bf16 v[164:167], a[160:163], a[196:199], v[164:167]
s_add_u32 s37, s31, 0
v_mfma_f32_16x16x32_bf16 v[168:171], a[160:163], a[200:203], v[168:171]
s_add_u32 m0, s33, 0
ds_read_b128 a[228:231], v3 offset:1024
v_mfma_f32_16x16x32_bf16 v[172:175], a[160:163], a[204:207], v[172:175]
buffer_load_dwordx4 v2, s[20:23], s37 offen  lds
s_add_u32 s60, s60, s92
v_mfma_f32_16x16x32_bf16 v[176:179], a[160:163], a[208:211], v[176:179]
s_mov_b32 s29, s60
ds_read_b128 a[232:235], v4 offset:4096
v_mfma_f32_16x16x32_bf16 v[180:183], a[160:163], a[212:215], v[180:183]
buffer_store_dwordx4 v[64:67], v13, s[8:11], s29 offen sc1
v_mfma_f32_16x16x32_bf16 v[184:187], a[160:163], a[216:219], v[184:187]
ds_read_b128 a[236:239], v3 offset:5120
v_mfma_f32_16x16x32_bf16 v[188:191], a[160:163], a[220:223], v[188:191]
ds_read_b64_tr_b16 a[160:161], v5 offset:0
v_mfma_f32_16x16x32_bf16 v[192:195], a[164:167], a[192:195], v[192:195]
ds_read_b64_tr_b16 a[162:163], v5 offset:1024
ds_read_b128 a[240:243], v4 offset:8192
v_mfma_f32_16x16x32_bf16 v[196:199], a[164:167], a[196:199], v[196:199]
s_add_u32 s37, s31, 32768
v_mfma_f32_16x16x32_bf16 v[200:203], a[164:167], a[200:203], v[200:203]
s_add_u32 m0, s33, 1024
ds_read_b128 a[244:247], v3 offset:9216
v_mfma_f32_16x16x32_bf16 v[204:207], a[164:167], a[204:207], v[204:207]
buffer_load_dwordx4 v2, s[20:23], s37 offen  lds
v_mfma_f32_16x16x32_bf16 v[208:211], a[164:167], a[208:211], v[208:211]
ds_read_b128 a[248:251], v4 offset:12288
v_mfma_f32_16x16x32_bf16 v[212:215], a[164:167], a[212:215], v[212:215]
v_mfma_f32_16x16x32_bf16 v[216:219], a[164:167], a[216:219], v[216:219]
ds_read_b128 a[252:255], v3 offset:13312
v_mfma_f32_16x16x32_bf16 v[220:223], a[164:167], a[220:223], v[220:223]
ds_read_b64_tr_b16 a[164:165], v6 offset:0
v_mfma_f32_16x16x32_bf16 v[224:227], a[168:171], a[192:195], v[224:227]
ds_read_b64_tr_b16 a[166:167], v6 offset:1024
ds_read_b64_tr_b16 v[28:29], v12 offset:0
v_mfma_f32_16x16x32_bf16 v[228:231], a[168:171], a[196:199], v[228:231]
s_add_u32 s37, s31, 131072
v_mfma_f32_16x16x32_bf16 v[232:235], a[168:171], a[200:203], v[232:235]
s_add_u32 m0, s33, 4096
ds_read_b64_tr_b16 v[30:31], v12 offset:1024
v_mfma_f32_16x16x32_bf16 v[236:239], a[168:171], a[204:207], v[236:239]
buffer_load_dwordx4 v2, s[20:23], s37 offen  lds
v_mfma_f32_16x16x32_bf16 v[240:243], a[168:171], a[208:211], v[240:243]
v_mfma_f32_16x16x32_bf16 v[244:247], a[168:171], a[212:215], v[244:247]
v_mfma_f32_16x16x32_bf16 v[248:251], a[168:171], a[216:219], v[248:251]
v_mfma_f32_16x16x32_bf16 v[252:255], a[168:171], a[220:223], v[252:255]
ds_read_b64_tr_b16 a[168:169], v7 offset:0
v_mfma_f32_16x16x32_bf16 a[0:3], a[172:175], a[192:195], a[0:3]
ds_read_b64_tr_b16 a[170:171], v7 offset:1024
v_mfma_f32_16x16x32_bf16 a[4:7], a[172:175], a[196:199], a[4:7]
s_add_u32 s37, s31, 163840
v_mfma_f32_16x16x32_bf16 a[8:11], a[172:175], a[200:203], a[8:11]
s_add_u32 m0, s33, 5120
v_mfma_f32_16x16x32_bf16 a[12:15], a[172:175], a[204:207], a[12:15]
buffer_load_dwordx4 v2, s[20:23], s37 offen  lds
s_add_u32 s29, s29, s44
v_mfma_f32_16x16x32_bf16 a[16:19], a[172:175], a[208:211], a[16:19]
v_mfma_f32_16x16x32_bf16 a[20:23], a[172:175], a[212:215], a[20:23]
buffer_store_dwordx4 v[68:71], v13, s[8:11], s29 offen sc1
v_mfma_f32_16x16x32_bf16 a[24:27], a[172:175], a[216:219], a[24:27]
v_mfma_f32_16x16x32_bf16 a[28:31], a[172:175], a[220:223], a[28:31]
ds_read_b64_tr_b16 a[172:173], v8 offset:0
v_mfma_f32_16x16x32_bf16 a[32:35], a[176:179], a[192:195], a[32:35]
ds_read_b64_tr_b16 a[174:175], v8 offset:1024
s_add_u32 s31, s31, 262144
v_mfma_f32_16x16x32_bf16 a[36:39], a[176:179], a[196:199], a[36:39]
s_add_u32 s48, s48, s34
s_add_u32 s33, s33, 16384
v_mfma_f32_16x16x32_bf16 a[40:43], a[176:179], a[200:203], a[40:43]
s_add_u32 m0, s32, 16384
s_and_b32 s33, s33, 65535
v_mfma_f32_16x16x32_bf16 a[44:47], a[176:179], a[204:207], a[44:47]
buffer_load_dwordx4 v1, s[12:15], s48 offen lds
v_mfma_f32_16x16x32_bf16 a[48:51], a[176:179], a[208:211], a[48:51]
v_mfma_f32_16x16x32_bf16 a[52:55], a[176:179], a[212:215], a[52:55]
v_mfma_f32_16x16x32_bf16 a[56:59], a[176:179], a[216:219], a[56:59]
v_mfma_f32_16x16x32_bf16 a[60:63], a[176:179], a[220:223], a[60:63]
ds_read_b64_tr_b16 a[176:177], v9 offset:0
v_mfma_f32_16x16x32_bf16 a[64:67], a[180:183], a[192:195], a[64:67]
ds_read_b64_tr_b16 a[178:179], v9 offset:1024
v_mfma_f32_16x16x32_bf16 a[68:71], a[180:183], a[196:199], a[68:71]
s_add_u32 s48, s48, s34
v_mfma_f32_16x16x32_bf16 a[72:75], a[180:183], a[200:203], a[72:75]
s_add_u32 m0, s32, 20480
v_mfma_f32_16x16x32_bf16 a[76:79], a[180:183], a[204:207], a[76:79]
buffer_load_dwordx4 v1, s[12:15], s48 offen lds
v_mfma_f32_16x16x32_bf16 a[80:83], a[180:183], a[208:211], a[80:83]
v_mfma_f32_16x16x32_bf16 a[84:87], a[180:183], a[212:215], a[84:87]
v_mfma_f32_16x16x32_bf16 a[88:91], a[180:183], a[216:219], a[88:91]
v_mfma_f32_16x16x32_bf16 a[92:95], a[180:183], a[220:223], a[92:95]
ds_read_b64_tr_b16 a[180:181], v10 offset:0
v_mfma_f32_16x16x32_bf16 a[96:99], a[184:187], a[192:195], a[96:99]
ds_read_b64_tr_b16 a[182:183], v10 offset:1024
v_mfma_f32_16x16x32_bf16 a[100:103], a[184:187], a[196:199], a[100:103]
s_add_u32 s48, s48, s34
v_mfma_f32_16x16x32_bf16 a[104:107], a[184:187], a[200:203], a[104:107]
s_add_u32 m0, s32, 24576
v_mfma_f32_16x16x32_bf16 a[108:111], a[184:187], a[204:207], a[108:111]
buffer_load_dwordx4 v1, s[12:15], s48 offen lds
s_add_u32 s29, s29, s93
v_mfma_f32_16x16x32_bf16 a[112:115], a[184:187], a[208:211], a[112:115]
v_mfma_f32_16x16x32_bf16 a[116:119], a[184:187], a[212:215], a[116:119]
buffer_store_dwordx4 v[72:75], v13, s[8:11], s29 offen sc1
v_mfma_f32_16x16x32_bf16 a[120:123], a[184:187], a[216:219], a[120:123]
v_mfma_f32_16x16x32_bf16 a[124:127], a[184:187], a[220:223], a[124:127]
ds_read_b64_tr_b16 a[184:185], v11 offset:0
v_mfma_f32_16x16x32_bf16 a[128:131], a[188:191], a[192:195], a[128:131]
ds_read_b64_tr_b16 a[186:187], v11 offset:1024
v_mfma_f32_16x16x32_bf16 a[132:135], a[188:191], a[196:199], a[132:135]
s_add_u32 s48, s48, s34
v_add_u32 v3, 32768, v3
v_subrev_u32 v19, 98304, v3
v_mfma_f32_16x16x32_bf16 a[136:139], a[188:191], a[200:203], a[136:139]
s_add_u32 m0, s32, 28672
v_cmp_le_u32 vcc, 163840, v3
v_add_u32 v5, 16384, v5
v_mfma_f32_16x16x32_bf16 a[140:143], a[188:191], a[204:207], a[140:143]
buffer_load_dwordx4 v1, s[12:15], s48 offen lds
v_and_b32 v5, 65535, v5
v_xor_b32 v6, 16, v5
v_mfma_f32_16x16x32_bf16 a[144:147], a[188:191], a[208:211], a[144:147]
s_add_u32 s30, s30, 128
s_add_u32 s32, s32, 32768
s_sub_u32 s48, s32, 98304
v_mfma_f32_16x16x32_bf16 a[148:151], a[188:191], a[212:215], a[148:151]
s_cmp_ge_u32 s32, 163840
s_cselect_b32 s32, s48, s32
v_xor_b32 v7, 64, v5
v_mfma_f32_16x16x32_bf16 a[152:155], a[188:191], a[216:219], a[152:155]
v_xor_b32 v8, 80, v5
v_xor_b32 v9, 128, v5
v_xor_b32 v10, 144, v5
v_mfma_f32_16x16x32_bf16 a[156:159], a[188:191], a[220:223], a[156:159]
v_xor_b32 v11, 192, v5
v_xor_b32 v12, 208, v5
v_cndmask_b32 v3, v3, v19, vcc
v_xor_b32 v4, 64, v3
s_waitcnt vmcnt(21) lgkmcnt(0)
s_barrier
v_mfma_f32_16x16x32_bf16 v[160:163], a[160:163], a[224:227], v[160:163]
ds_read_b128 a[192:195], v3 offset:0
v_mfma_f32_16x16x32_bf16 v[164:167], a[160:163], a[228:231], v[164:167]
s_add_u32 s37, s31, 0
v_mfma_f32_16x16x32_bf16 v[168:171], a[160:163], a[232:235], v[168:171]
s_add_u32 m0, s33, 0
ds_read_b128 a[196:199], v4 offset:1024
v_mfma_f32_16x16x32_bf16 v[172:175], a[160:163], a[236:239], v[172:175]
buffer_load_dwordx4 v2, s[20:23], s37 offen  lds
s_add_u32 s29, s29, s44
v_mfma_f32_16x16x32_bf16 v[176:179], a[160:163], a[240:243], v[176:179]
ds_read_b128 a[200:203], v3 offset:4096
v_mfma_f32_16x16x32_bf16 v[180:183], a[160:163], a[244:247], v[180:183]
buffer_store_dwordx4 v[76:79], v13, s[8:11], s29 offen sc1
v_mfma_f32_16x16x32_bf16 v[184:187], a[160:163], a[248:251], v[184:187]
ds_read_b128 a[204:207], v4 offset:5120
v_mfma_f32_16x16x32_bf16 v[188:191], a[160:163], a[252:255], v[188:191]
ds_read_b64_tr_b16 a[160:161], v5 offset:0
v_mfma_f32_16x16x32_bf16 v[192:195], a[164:167], a[224:227], v[192:195]
ds_read_b64_tr_b16 a[162:163], v5 offset:1024
ds_read_b128 a[208:211], v3 offset:8192
v_mfma_f32_16x16x32_bf16 v[196:199], a[164:167], a[228:231], v[196:199]
s_add_u32 s37, s31, 32768
v_mfma_f32_16x16x32_bf16 v[200:203], a[164:167], a[232:235], v[200:203]
s_add_u32 m0, s33, 1024
ds_read_b128 a[212:215], v4 offset:9216
v_mfma_f32_16x16x32_bf16 v[204:207], a[164:167], a[236:239], v[204:207]
buffer_load_dwordx4 v2, s[20:23], s37 offen  lds
v_mfma_f32_16x16x32_bf16 v[208:211], a[164:167], a[240:243], v[208:211]
ds_read_b128 a[216:219], v3 offset:12288
v_mfma_f32_16x16x32_bf16 v[212:215], a[164:167], a[244:247], v[212:215]
v_mfma_f32_16x16x32_bf16 v[216:219], a[164:167], a[248:251], v[216:219]
ds_read_b128 a[220:223], v4 offset:13312
v_mfma_f32_16x16x32_bf16 v[220:223], a[164:167], a[252:255], v[220:223]
ds_read_b64_tr_b16 a[164:165], v6 offset:0
v_mfma_f32_16x16x32_bf16 v[224:227], a[168:171], a[224:227], v[224:227]
ds_read_b64_tr_b16 a[166:167], v6 offset:1024
ds_read_b64_tr_b16 a[188:189], v12 offset:0
v_mfma_f32_16x16x32_bf16 v[228:231], a[168:171], a[228:231], v[228:231]
s_add_u32 s37, s31, 131072
v_mfma_f32_16x16x32_bf16 v[232:235], a[168:171], a[232:235], v[232:235]
s_add_u32 m0, s33, 4096
ds_read_b64_tr_b16 a[190:191], v12 offset:1024
v_mfma_f32_16x16x32_bf16 v[236:239], a[168:171], a[236:239], v[236:239]
buffer_load_dwordx4 v2, s[20:23], s37 offen  lds
v_mfma_f32_16x16x32_bf16 v[240:243], a[168:171], a[240:243], v[240:243]
v_mfma_f32_16x16x32_bf16 v[244:247], a[168:171], a[244:247], v[244:247]
v_mfma_f32_16x16x32_bf16 v[248:251], a[168:171], a[248:251], v[248:251]
v_mfma_f32_16x16x32_bf16 v[252:255], a[168:171], a[252:255], v[252:255]
ds_read_b64_tr_b16 a[168:169], v7 offset:0
v_mfma_f32_16x16x32_bf16 a[0:3], a[172:175], a[224:227], a[0:3]
ds_read_b64_tr_b16 a[170:171], v7 offset:1024
v_mfma_f32_16x16x32_bf16 a[4:7], a[172:175], a[228:231], a[4:7]
s_add_u32 s37, s31, 163840
v_mfma_f32_16x16x32_bf16 a[8:11], a[172:175], a[232:235], a[8:11]
s_add_u32 m0, s33, 5120
v_mfma_f32_16x16x32_bf16 a[12:15], a[172:175], a[236:239], a[12:15]
buffer_load_dwordx4 v2, s[20:23], s37 offen  lds
s_add_u32 s29, s29, s93
v_mfma_f32_16x16x32_bf16 a[16:19], a[172:175], a[240:243], a[16:19]
v_mfma_f32_16x16x32_bf16 a[20:23], a[172:175], a[244:247], a[20:23]
buffer_store_dwordx4 v[80:83], v13, s[8:11], s29 offen sc1
v_mfma_f32_16x16x32_bf16 a[24:27], a[172:175], a[248:251], a[24:27]
v_mfma_f32_16x16x32_bf16 a[28:31], a[172:175], a[252:255], a[28:31]
ds_read_b64_tr_b16 a[172:173], v8 offset:0
v_mfma_f32_16x16x32_bf16 a[32:35], a[176:179], a[224:227], a[32:35]
ds_read_b64_tr_b16 a[174:175], v8 offset:1024
s_add_u32 s31, s31, 262144
v_mfma_f32_16x16x32_bf16 a[36:39], a[176:179], a[228:231], a[36:39]
s_mov_b32 s48, s30
s_add_u32 s33, s33, 16384
v_mfma_f32_16x16x32_bf16 a[40:43], a[176:179], a[232:235], a[40:43]
s_add_u32 m0, s32, 0
s_and_b32 s33, s33, 65535
v_mfma_f32_16x16x32_bf16 a[44:47], a[176:179], a[236:239], a[44:47]
buffer_load_dwordx4 v1, s[12:15], s48 offen lds
v_mfma_f32_16x16x32_bf16 a[48:51], a[176:179], a[240:243], a[48:51]
v_mfma_f32_16x16x32_bf16 a[52:55], a[176:179], a[244:247], a[52:55]
v_mfma_f32_16x16x32_bf16 a[56:59], a[176:179], a[248:251], a[56:59]
v_mfma_f32_16x16x32_bf16 a[60:63], a[176:179], a[252:255], a[60:63]
ds_read_b64_tr_b16 a[176:177], v9 offset:0
v_mfma_f32_16x16x32_bf16 a[64:67], a[180:183], a[224:227], a[64:67]
ds_read_b64_tr_b16 a[178:179], v9 offset:1024
v_mfma_f32_16x16x32_bf16 a[68:71], a[180:183], a[228:231], a[68:71]
s_add_u32 s48, s48, s34
v_mfma_f32_16x16x32_bf16 a[72:75], a[180:183], a[232:235], a[72:75]
s_add_u32 m0, s32, 4096
v_mfma_f32_16x16x32_bf16 a[76:79], a[180:183], a[236:239], a[76:79]
buffer_load_dwordx4 v1, s[12:15], s48 offen lds
v_mfma_f32_16x16x32_bf16 a[80:83], a[180:183], a[240:243], a[80:83]
v_mfma_f32_16x16x32_bf16 a[84:87], a[180:183], a[244:247], a[84:87]
v_mfma_f32_16x16x32_bf16 a[88:91], a[180:183], a[248:251], a[88:91]
v_mfma_f32_16x16x32_bf16 a[92:95], a[180:183], a[252:255], a[92:95]
ds_read_b64_tr_b16 a[180:181], v10 offset:0
v_mfma_f32_16x16x32_bf16 a[96:99], a[184:187], a[224:227], a[96:99]
ds_read_b64_tr_b16 a[182:183], v10 offset:1024
v_mfma_f32_16x16x32_bf16 a[100:103], a[184:187], a[228:231], a[100:103]
s_add_u32 s48, s48, s34
v_mfma_f32_16x16x32_bf16 a[104:107], a[184:187], a[232:235], a[104:107]
s_add_u32 m0, s32, 8192
v_mfma_f32_16x16x32_bf16 a[108:111], a[184:187], a[236:239], a[108:111]
buffer_load_dwordx4 v1, s[12:15], s48 offen lds
s_add_u32 s29, s29, s44
v_mfma_f32_16x16x32_bf16 a[112:115], a[184:187], a[240:243], a[112:115]
v_mfma_f32_16x16x32_bf16 a[116:119], a[184:187], a[244:247], a[116:119]
buffer_store_dwordx4 v[84:87], v13, s[8:11], s29 offen sc1
v_mfma_f32_16x16x32_bf16 a[120:123], a[184:187], a[248:251], a[120:123]
v_mfma_f32_16x16x32_bf16 a[124:127], a[184:187], a[252:255], a[124:127]
ds_read_b64_tr_b16 a[184:185], v11 offset:0
v_mfma_f32_16x16x32_bf16 a[128:131], v[28:31], a[224:227], a[128:131]
ds_read_b64_tr_b16 a[186:187], v11 offset:1024
v_mfma_f32_16x16x32_bf16 a[132:135], v[28:31], a[228:231], a[132:135]
s_add_u32 s48, s48, s34
v_add_u32 v5, 16384, v5
v_and_b32 v5, 65535, v5
v_mfma_f32_16x16x32_bf16 a[136:139], v[28:31], a[232:235], a[136:139]
s_add_u32 m0, s32, 12288
v_xor_b32 v6, 16, v5
v_xor_b32 v7, 64, v5
v_mfma_f32_16x16x32_bf16 a[140:143], v[28:31], a[236:239], a[140:143]
buffer_load_dwordx4 v1, s[12:15], s48 offen lds
v_xor_b32 v8, 80, v5
v_xor_b32 v9, 128, v5
v_mfma_f32_16x16x32_bf16 a[144:147], v[28:31], a[240:243], a[144:147]
v_xor_b32 v10, 144, v5
v_xor_b32 v11, 192, v5
v_xor_b32 v12, 208, v5
v_mfma_f32_16x16x32_bf16 a[148:151], v[28:31], a[244:247], a[148:151]
v_mfma_f32_16x16x32_bf16 a[152:155], v[28:31], a[248:251], a[152:155]
v_mfma_f32_16x16x32_bf16 a[156:159], v[28:31], a[252:255], a[156:159]
s_waitcnt vmcnt(22) lgkmcnt(0)
s_barrier
v_mfma_f32_16x16x32_bf16 v[160:163], a[160:163], a[192:195], v[160:163]
ds_read_b128 a[224:227], v4 offset:0
v_mfma_f32_16x16x32_bf16 v[164:167], a[160:163], a[196:199], v[164:167]
s_add_u32 s37, s31, 0
v_mfma_f32_16x16x32_bf16 v[168:171], a[160:163], a[200:203], v[168:171]
s_add_u32 m0, s33, 0
ds_read_b128 a[228:231], v3 offset:1024
v_mfma_f32_16x16x32_bf16 v[172:175], a[160:163], a[204:207], v[172:175]
buffer_load_dwordx4 v2, s[20:23], s37 offen  lds
s_add_u32 s29, s29, s93
v_mfma_f32_16x16x32_bf16 v[176:179], a[160:163], a[208:211], v[176:179]
ds_read_b128 a[232:235], v4 offset:4096
v_mfma_f32_16x16x32_bf16 v[180:183], a[160:163], a[212:215], v[180:183]
buffer_store_dwordx4 v[88:91], v13, s[8:11], s29 offen sc1
v_mfma_f32_16x16x32_bf16 v[184:187], a[160:163], a[216:219], v[184:187]
ds_read_b128 a[236:239], v3 offset:5120
v_mfma_f32_16x16x32_bf16 v[188:191], a[160:163], a[220:223], v[188:191]
ds_read_b64_tr_b16 a[160:161], v5 offset:0
v_mfma_f32_16x16x32_bf16 v[192:195], a[164:167], a[192:195], v[192:195]
ds_read_b64_tr_b16 a[162:163], v5 offset:1024
ds_read_b128 a[240:243], v4 offset:8192
v_mfma_f32_16x16x32_bf16 v[196:199], a[164:167], a[196:199], v[196:199]
s_add_u32 s37, s31, 32768
v_mfma_f32_16x16x32_bf16 v[200:203], a[164:167], a[200:203], v[200:203]
s_add_u32 m0, s33, 1024
ds_read_b128 a[244:247], v3 offset:9216
v_mfma_f32_16x16x32_bf16 v[204:207], a[164:167], a[204:207], v[204:207]
buffer_load_dwordx4 v2, s[20:23], s37 offen  lds
v_mfma_f32_16x16x32_bf16 v[208:211], a[164:167], a[208:211], v[208:211]
ds_read_b128 a[248:251], v4 offset:12288
v_mfma_f32_16x16x32_bf16 v[212:215], a[164:167], a[212:215], v[212:215]
v_mfma_f32_16x16x32_bf16 v[216:219], a[164:167], a[216:219], v[216:219]
ds_read_b128 a[252:255], v3 offset:13312
v_mfma_f32_16x16x32_bf16 v[220:223], a[164:167], a[220:223], v[220:223]
ds_read_b64_tr_b16 a[164:165], v6 offset:0
v_mfma_f32_16x16x32_bf16 v[224:227], a[168:171], a[192:195], v[224:227]
ds_read_b64_tr_b16 a[166:167], v6 offset:1024
ds_read_b64_tr_b16 v[28:29], v12 offset:0
v_mfma_f32_16x16x32_bf16 v[228:231], a[168:171], a[196:199], v[228:231]
s_add_u32 s37, s31, 131072
v_mfma_f32_16x16x32_bf16 v[232:235], a[168:171], a[200:203], v[232:235]
s_add_u32 m0, s33, 4096
ds_read_b64_tr_b16 v[30:31], v12 offset:1024
v_mfma_f32_16x16x32_bf16 v[236:239], a[168:171], a[204:207], v[236:239]
buffer_load_dwordx4 v2, s[20:23], s37 offen  lds
v_mfma_f32_16x16x32_bf16 v[240:243], a[168:171], a[208:211], v[240:243]
v_mfma_f32_16x16x32_bf16 v[244:247], a[168:171], a[212:215], v[244:247]
v_mfma_f32_16x16x32_bf16 v[248:251], a[168:171], a[216:219], v[248:251]
v_mfma_f32_16x16x32_bf16 v[252:255], a[168:171], a[220:223], v[252:255]
ds_read_b64_tr_b16 a[168:169], v7 offset:0
v_mfma_f32_16x16x32_bf16 a[0:3], a[172:175], a[192:195], a[0:3]
ds_read_b64_tr_b16 a[170:171], v7 offset:1024
v_mfma_f32_16x16x32_bf16 a[4:7], a[172:175], a[196:199], a[4:7]
s_add_u32 s37, s31, 163840
v_mfma_f32_16x16x32_bf16 a[8:11], a[172:175], a[200:203], a[8:11]
s_add_u32 m0, s33, 5120
v_mfma_f32_16x16x32_bf16 a[12:15], a[172:175], a[204:207], a[12:15]
buffer_load_dwordx4 v2, s[20:23], s37 offen  lds
s_add_u32 s29, s29, s44
v_mfma_f32_16x16x32_bf16 a[16:19], a[172:175], a[208:211], a[16:19]
v_mfma_f32_16x16x32_bf16 a[20:23], a[172:175], a[212:215], a[20:23]
buffer_store_dwordx4 v[92:95], v13, s[8:11], s29 offen sc1
v_mfma_f32_16x16x32_bf16 a[24:27], a[172:175], a[216:219], a[24:27]
v_mfma_f32_16x16x32_bf16 a[28:31], a[172:175], a[220:223], a[28:31]
ds_read_b64_tr_b16 a[172:173], v8 offset:0
v_mfma_f32_16x16x32_bf16 a[32:35], a[176:179], a[192:195], a[32:35]
ds_read_b64_tr_b16 a[174:175], v8 offset:1024
s_add_u32 s31, s31, 262144
v_mfma_f32_16x16x32_bf16 a[36:39], a[176:179], a[196:199], a[36:39]
s_add_u32 s48, s48, s34
s_add_u32 s33, s33, 16384
v_mfma_f32_16x16x32_bf16 a[40:43], a[176:179], a[200:203], a[40:43]
s_add_u32 m0, s32, 16384
s_and_b32 s33, s33, 65535
v_mfma_f32_16x16x32_bf16 a[44:47], a[176:179], a[204:207], a[44:47]
buffer_load_dwordx4 v1, s[12:15], s48 offen lds
v_mfma_f32_16x16x32_bf16 a[48:51], a[176:179], a[208:211], a[48:51]
v_mfma_f32_16x16x32_bf16 a[52:55], a[176:179], a[212:215], a[52:55]
v_mfma_f32_16x16x32_bf16 a[56:59], a[176:179], a[216:219], a[56:59]
v_mfma_f32_16x16x32_bf16 a[60:63], a[176:179], a[220:223], a[60:63]
ds_read_b64_tr_b16 a[176:177], v9 offset:0
v_mfma_f32_16x16x32_bf16 a[64:67], a[180:183], a[192:195], a[64:67]
ds_read_b64_tr_b16 a[178:179], v9 offset:1024
v_mfma_f32_16x16x32_bf16 a[68:71], a[180:183], a[196:199], a[68:71]
s_add_u32 s48, s48, s34
v_mfma_f32_16x16x32_bf16 a[72:75], a[180:183], a[200:203], a[72:75]
s_add_u32 m0, s32, 20480
v_mfma_f32_16x16x32_bf16 a[76:79], a[180:183], a[204:207], a[76:79]
buffer_load_dwordx4 v1, s[12:15], s48 offen lds
v_mfma_f32_16x16x32_bf16 a[80:83], a[180:183], a[208:211], a[80:83]
v_mfma_f32_16x16x32_bf16 a[84:87], a[180:183], a[212:215], a[84:87]
v_mfma_f32_16x16x32_bf16 a[88:91], a[180:183], a[216:219], a[88:91]
buffer_load_dword v15, v14, s[96:99], s100 offen
s_add_u32 s100, s100, 8192
v_mfma_f32_16x16x32_bf16 a[92:95], a[180:183], a[220:223], a[92:95]
ds_read_b64_tr_b16 a[180:181], v10 offset:0
v_mfma_f32_16x16x32_bf16 a[96:99], a[184:187], a[192:195], a[96:99]
ds_read_b64_tr_b16 a[182:183], v10 offset:1024
v_mfma_f32_16x16x32_bf16 a[100:103], a[184:187], a[196:199], a[100:103]
s_add_u32 s48, s48, s34
v_mfma_f32_16x16x32_bf16 a[104:107], a[184:187], a[200:203], a[104:107]
s_add_u32 m0, s32, 24576
v_mfma_f32_16x16x32_bf16 a[108:111], a[184:187], a[204:207], a[108:111]
buffer_load_dwordx4 v1, s[12:15], s48 offen lds
v_mfma_f32_16x16x32_bf16 a[112:115], a[184:187], a[208:211], a[112:115]
v_mfma_f32_16x16x32_bf16 a[116:119], a[184:187], a[212:215], a[116:119]
v_mfma_f32_16x16x32_bf16 a[120:123], a[184:187], a[216:219], a[120:123]
v_mfma_f32_16x16x32_bf16 a[124:127], a[184:187], a[220:223], a[124:127]
ds_read_b64_tr_b16 a[184:185], v11 offset:0
v_mfma_f32_16x16x32_bf16 a[128:131], a[188:191], a[192:195], a[128:131]
ds_read_b64_tr_b16 a[186:187], v11 offset:1024
v_mfma_f32_16x16x32_bf16 a[132:135], a[188:191], a[196:199], a[132:135]
s_add_u32 s48, s48, s34
v_add_u32 v3, 32768, v3
v_subrev_u32 v19, 98304, v3
v_mfma_f32_16x16x32_bf16 a[136:139], a[188:191], a[200:203], a[136:139]
s_add_u32 m0, s32, 28672
v_cmp_le_u32 vcc, 163840, v3
v_add_u32 v5, 16384, v5
v_mfma_f32_16x16x32_bf16 a[140:143], a[188:191], a[204:207], a[140:143]
buffer_load_dwordx4 v1, s[12:15], s48 offen lds
v_and_b32 v5, 65535, v5
v_xor_b32 v6, 16, v5
v_mfma_f32_16x16x32_bf16 a[144:147], a[188:191], a[208:211], a[144:147]
s_add_u32 s30, s30, 128
s_add_u32 s32, s32, 32768
s_sub_u32 s48, s32, 98304
v_mfma_f32_16x16x32_bf16 a[148:151], a[188:191], a[212:215], a[148:151]
s_cmp_ge_u32 s32, 163840
s_cselect_b32 s32, s48, s32
v_xor_b32 v7, 64, v5
v_mfma_f32_16x16x32_bf16 a[152:155], a[188:191], a[216:219], a[152:155]
v_xor_b32 v8, 80, v5
v_xor_b32 v9, 128, v5
v_xor_b32 v10, 144, v5
v_mfma_f32_16x16x32_bf16 a[156:159], a[188:191], a[220:223], a[156:159]
v_xor_b32 v11, 192, v5
v_xor_b32 v12, 208, v5
v_cndmask_b32 v3, v3, v19, vcc
v_xor_b32 v4, 64, v3
s_waitcnt vmcnt(22) lgkmcnt(0)
s_barrier
v_mfma_f32_16x16x32_bf16 v[160:163], a[160:163], a[224:227], v[160:163]
ds_read_b128 a[192:195], v3 offset:0
v_mfma_f32_16x16x32_bf16 v[164:167], a[160:163], a[228:231], v[164:167]
s_add_u32 s37, s31, 0
v_mfma_f32_16x16x32_bf16 v[168:171], a[160:163], a[232:235], v[168:171]
s_add_u32 m0, s33, 0
ds_read_b128 a[196:199], v4 offset:1024
v_mfma_f32_16x16x32_bf16 v[172:175], a[160:163], a[236:239], v[172:175]
buffer_load_dwordx4 v2, s[20:23], s37 offen  lds
s_add_u32 s60, s60, s92
v_mfma_f32_16x16x32_bf16 v[176:179], a[160:163], a[240:243], v[176:179]
s_mov_b32 s29, s60
ds_read_b128 a[200:203], v3 offset:4096
v_mfma_f32_16x16x32_bf16 v[180:183], a[160:163], a[244:247], v[180:183]
buffer_store_dwordx4 v[96:99], v13, s[8:11], s29 offen sc1
v_mfma_f32_16x16x32_bf16 v[184:187], a[160:163], a[248:251], v[184:187]
ds_read_b128 a[204:207], v4 offset:5120
v_mfma_f32_16x16x32_bf16 v[188:191], a[160:163], a[252:255], v[188:191]
ds_read_b64_tr_b16 a[160:161], v5 offset:0
v_mfma_f32_16x16x32_bf16 v[192:195], a[164:167], a[224:227], v[192:195]
ds_read_b64_tr_b16 a[162:163], v5 offset:1024
ds_read_b128 a[208:211], v3 offset:8192
v_mfma_f32_16x16x32_bf16 v[196:199], a[164:167], a[228:231], v[196:199]
s_add_u32 s37, s31, 32768
v_mfma_f32_16x16x32_bf16 v[200:203], a[164:167], a[232:235], v[200:203]
s_add_u32 m0, s33, 1024
ds_read_b128 a[212:215], v4 offset:9216
v_mfma_f32_16x16x32_bf16 v[204:207], a[164:167], a[236:239], v[204:207]
buffer_load_dwordx4 v2, s[20:23], s37 offen  lds
v_mfma_f32_16x16x32_bf16 v[208:211], a[164:167], a[240:243], v[208:211]
ds_read_b128 a[216:219], v3 offset:12288
v_mfma_f32_16x16x32_bf16 v[212:215], a[164:167], a[244:247], v[212:215]
v_mfma_f32_16x16x32_bf16 v[216:219], a[164:167], a[248:251], v[216:219]
ds_read_b128 a[220:223], v4 offset:13312
v_mfma_f32_16x16x32_bf16 v[220:223], a[164:167], a[252:255], v[220:223]
ds_read_b64_tr_b16 a[164:165], v6 offset:0
v_mfma_f32_16x16x32_bf16 v[224:227], a[168:171], a[224:227], v[224:227]
ds_read_b64_tr_b16 a[166:167], v6 offset:1024
ds_read_b64_tr_b16 a[188:189], v12 offset:0
v_mfma_f32_16x16x32_bf16 v[228:231], a[168:171], a[228:231], v[228:231]
s_add_u32 s37, s31, 131072
v_mfma_f32_16x16x32_bf16 v[232:235], a[168:171], a[232:235], v[232:235]
s_add_u32 m0, s33, 4096
ds_read_b64_tr_b16 a[190:191], v12 offset:1024
v_mfma_f32_16x16x32_bf16 v[236:239], a[168:171], a[236:239], v[236:239]
buffer_load_dwordx4 v2, s[20:23], s37 offen  lds
v_mfma_f32_16x16x32_bf16 v[240:243], a[168:171], a[240:243], v[240:243]
v_mfma_f32_16x16x32_bf16 v[244:247], a[168:171], a[244:247], v[244:247]
v_mfma_f32_16x16x32_bf16 v[248:251], a[168:171], a[248:251], v[248:251]
v_mfma_f32_16x16x32_bf16 v[252:255], a[168:171], a[252:255], v[252:255]
ds_read_b64_tr_b16 a[168:169], v7 offset:0
v_mfma_f32_16x16x32_bf16 a[0:3], a[172:175], a[224:227], a[0:3]
ds_read_b64_tr_b16 a[170:171], v7 offset:1024
v_mfma_f32_16x16x32_bf16 a[4:7], a[172:175], a[228:231], a[4:7]
s_add_u32 s37, s31, 163840
v_mfma_f32_16x16x32_bf16 a[8:11], a[172:175], a[232:235], a[8:11]
s_add_u32 m0, s33, 5120
v_mfma_f32_16x16x32_bf16 a[12:15], a[172:175], a[236:239], a[12:15]
buffer_load_dwordx4 v2, s[20:23], s37 offen  lds
s_add_u32 s29, s29, s44
v_mfma_f32_16x16x32_bf16 a[16:19], a[172:175], a[240:243], a[16:19]
v_mfma_f32_16x16x32_bf16 a[20:23], a[172:175], a[244:247], a[20:23]
buffer_store_dwordx4 v[100:103], v13, s[8:11], s29 offen sc1
v_mfma_f32_16x16x32_bf16 a[24:27], a[172:175], a[248:251], a[24:27]
v_mfma_f32_16x16x32_bf16 a[28:31], a[172:175], a[252:255], a[28:31]
ds_read_b64_tr_b16 a[172:173], v8 offset:0
v_mfma_f32_16x16x32_bf16 a[32:35], a[176:179], a[224:227], a[32:35]
ds_read_b64_tr_b16 a[174:175], v8 offset:1024
s_add_u32 s31, s31, 262144
v_mfma_f32_16x16x32_bf16 a[36:39], a[176:179], a[228:231], a[36:39]
s_mov_b32 s48, s30
s_add_u32 s33, s33, 16384
v_mfma_f32_16x16x32_bf16 a[40:43], a[176:179], a[232:235], a[40:43]
s_add_u32 m0, s32, 0
s_and_b32 s33, s33, 65535
v_mfma_f32_16x16x32_bf16 a[44:47], a[176:179], a[236:239], a[44:47]
buffer_load_dwordx4 v1, s[12:15], s48 offen lds
v_mfma_f32_16x16x32_bf16 a[48:51], a[176:179], a[240:243], a[48:51]
v_mfma_f32_16x16x32_bf16 a[52:55], a[176:179], a[244:247], a[52:55]
v_mfma_f32_16x16x32_bf16 a[56:59], a[176:179], a[248:251], a[56:59]
v_mfma_f32_16x16x32_bf16 a[60:63], a[176:179], a[252:255], a[60:63]
ds_read_b64_tr_b16 a[176:177], v9 offset:0
v_mfma_f32_16x16x32_bf16 a[64:67], a[180:183], a[224:227], a[64:67]
ds_read_b64_tr_b16 a[178:179], v9 offset:1024
v_mfma_f32_16x16x32_bf16 a[68:71], a[180:183], a[228:231], a[68:71]
s_add_u32 s48, s48, s34
v_mfma_f32_16x16x32_bf16 a[72:75], a[180:183], a[232:235], a[72:75]
s_add_u32 m0, s32, 4096
v_mfma_f32_16x16x32_bf16 a[76:79], a[180:183], a[236:239], a[76:79]
buffer_load_dwordx4 v1, s[12:15], s48 offen lds
v_mfma_f32_16x16x32_bf16 a[80:83], a[180:183], a[240:243], a[80:83]
v_mfma_f32_16x16x32_bf16 a[84:87], a[180:183], a[244:247], a[84:87]
v_mfma_f32_16x16x32_bf16 a[88:91], a[180:183], a[248:251], a[88:91]
buffer_load_dword v15, v14, s[96:99], s100 offen
s_add_u32 s100, s100, 8192
v_mfma_f32_16x16x32_bf16 a[92:95], a[180:183], a[252:255], a[92:95]
ds_read_b64_tr_b16 a[180:181], v10 offset:0
v_mfma_f32_16x16x32_bf16 a[96:99], a[184:187], a[224:227], a[96:99]
ds_read_b64_tr_b16 a[182:183], v10 offset:1024
v_mfma_f32_16x16x32_bf16 a[100:103], a[184:187], a[228:231], a[100:103]
s_add_u32 s48, s48, s34
v_mfma_f32_16x16x32_bf16 a[104:107], a[184:187], a[232:235], a[104:107]
s_add_u32 m0, s32, 8192
v_mfma_f32_16x16x32_bf16 a[108:111], a[184:187], a[236:239], a[108:111]
buffer_load_dwordx4 v1, s[12:15], s48 offen lds
s_add_u32 s29, s29, s93
v_mfma_f32_16x16x32_bf16 a[112:115], a[184:187], a[240:243], a[112:115]
v_mfma_f32_16x16x32_bf16 a[116:119], a[184:187], a[244:247], a[116:119]
buffer_store_dwordx4 v[104:107], v13, s[8:11], s29 offen sc1
v_mfma_f32_16x16x32_bf16 a[120:123], a[184:187], a[248:251], a[120:123]
v_mfma_f32_16x16x32_bf16 a[124:127], a[184:187], a[252:255], a[124:127]
ds_read_b64_tr_b16 a[184:185], v11 offset:0
v_mfma_f32_16x16x32_bf16 a[128:131], v[28:31], a[224:227], a[128:131]
ds_read_b64_tr_b16 a[186:187], v11 offset:1024
v_mfma_f32_16x16x32_bf16 a[132:135], v[28:31], a[228:231], a[132:135]
s_add_u32 s48, s48, s34
v_add_u32 v5, 16384, v5
v_and_b32 v5, 65535, v5
v_mfma_f32_16x16x32_bf16 a[136:139], v[28:31], a[232:235], a[136:139]
s_add_u32 m0, s32, 12288
v_xor_b32 v6, 16, v5
v_xor_b32 v7, 64, v5
v_mfma_f32_16x16x32_bf16 a[140:143], v[28:31], a[236:239], a[140:143]
buffer_load_dwordx4 v1, s[12:15], s48 offen lds
v_xor_b32 v8, 80, v5
v_xor_b32 v9, 128, v5
v_mfma_f32_16x16x32_bf16 a[144:147], v[28:31], a[240:243], a[144:147]
v_xor_b32 v10, 144, v5
v_xor_b32 v11, 192, v5
v_xor_b32 v12, 208, v5
v_mfma_f32_16x16x32_bf16 a[148:151], v[28:31], a[244:247], a[148:151]
v_mfma_f32_16x16x32_bf16 a[152:155], v[28:31], a[248:251], a[152:155]
v_mfma_f32_16x16x32_bf16 a[156:159], v[28:31], a[252:255], a[156:159]
s_waitcnt vmcnt(23) lgkmcnt(0)
s_barrier
v_mfma_f32_16x16x32_bf16 v[160:163], a[160:163], a[192:195], v[160:163]
ds_read_b128 a[224:227], v4 offset:0
v_mfma_f32_16x16x32_bf16 v[164:167], a[160:163], a[196:199], v[164:167]
s_add_u32 s37, s31, 0
v_mfma_f32_16x16x32_bf16 v[168:171], a[160:163], a[200:203], v[168:171]
s_add_u32 m0, s33, 0
ds_read_b128 a[228:231], v3 offset:1024
v_mfma_f32_16x16x32_bf16 v[172:175], a[160:163], a[204:207], v[172:175]
buffer_load_dwordx4 v2, s[20:23], s37 offen  lds
s_add_u32 s29, s29, s44
v_mfma_f32_16x16x32_bf16 v[176:179], a[160:163], a[208:211], v[176:179]
ds_read_b128 a[232:235], v4 offset:4096
v_mfma_f32_16x16x32_bf16 v[180:183], a[160:163], a[212:215], v[180:183]
buffer_store_dwordx4 v[108:111], v13, s[8:11], s29 offen sc1
v_mfma_f32_16x16x32_bf16 v[184:187], a[160:163], a[216:219], v[184:187]
ds_read_b128 a[236:239], v3 offset:5120
v_mfma_f32_16x16x32_bf16 v[188:191], a[160:163], a[220:223], v[188:191]
ds_read_b64_tr_b16 a[160:161], v5 offset:0
v_mfma_f32_16x16x32_bf16 v[192:195], a[164:167], a[192:195], v[192:195]
ds_read_b64_tr_b16 a[162:163], v5 offset:1024
ds_read_b128 a[240:243], v4 offset:8192
v_mfma_f32_16x16x32_bf16 v[196:199], a[164:167], a[196:199], v[196:199]
s_add_u32 s37, s31, 32768
v_mfma_f32_16x16x32_bf16 v[200:203], a[164:167], a[200:203], v[200:203]
s_add_u32 m0, s33, 1024
ds_read_b128 a[244:247], v3 offset:9216
v_mfma_f32_16x16x32_bf16 v[204:207], a[164:167], a[204:207], v[204:207]
buffer_load_dwordx4 v2, s[20:23], s37 offen  lds
v_mfma_f32_16x16x32_bf16 v[208:211], a[164:167], a[208:211], v[208:211]
ds_read_b128 a[248:251], v4 offset:12288
v_mfma_f32_16x16x32_bf16 v[212:215], a[164:167], a[212:215], v[212:215]
v_mfma_f32_16x16x32_bf16 v[216:219], a[164:167], a[216:219], v[216:219]
ds_read_b128 a[252:255], v3 offset:13312
v_mfma_f32_16x16x32_bf16 v[220:223], a[164:167], a[220:223], v[220:223]
ds_read_b64_tr_b16 a[164:165], v6 offset:0
v_mfma_f32_16x16x32_bf16 v[224:227], a[168:171], a[192:195], v[224:227]
ds_read_b64_tr_b16 a[166:167], v6 offset:1024
ds_read_b64_tr_b16 v[28:29], v12 offset:0
v_mfma_f32_16x16x32_bf16 v[228:231], a[168:171], a[196:199], v[228:231]
s_add_u32 s37, s31, 131072
v_mfma_f32_16x16x32_bf16 v[232:235], a[168:171], a[200:203], v[232:235]
s_add_u32 m0, s33, 4096
ds_read_b64_tr_b16 v[30:31], v12 offset:1024
v_mfma_f32_16x16x32_bf16 v[236:239], a[168:171], a[204:207], v[236:239]
buffer_load_dwordx4 v2, s[20:23], s37 offen  lds
v_mfma_f32_16x16x32_bf16 v[240:243], a[168:171], a[208:211], v[240:243]
v_mfma_f32_16x16x32_bf16 v[244:247], a[168:171], a[212:215], v[244:247]
v_mfma_f32_16x16x32_bf16 v[248:251], a[168:171], a[216:219], v[248:251]
v_mfma_f32_16x16x32_bf16 v[252:255], a[168:171], a[220:223], v[252:255]
ds_read_b64_tr_b16 a[168:169], v7 offset:0
v_mfma_f32_16x16x32_bf16 a[0:3], a[172:175], a[192:195], a[0:3]
ds_read_b64_tr_b16 a[170:171], v7 offset:1024
v_mfma_f32_16x16x32_bf16 a[4:7], a[172:175], a[196:199], a[4:7]
s_add_u32 s37, s31, 163840
v_mfma_f32_16x16x32_bf16 a[8:11], a[172:175], a[200:203], a[8:11]
s_add_u32 m0, s33, 5120
v_mfma_f32_16x16x32_bf16 a[12:15], a[172:175], a[204:207], a[12:15]
buffer_load_dwordx4 v2, s[20:23], s37 offen  lds
s_add_u32 s29, s29, s93
v_mfma_f32_16x16x32_bf16 a[16:19], a[172:175], a[208:211], a[16:19]
v_mfma_f32_16x16x32_bf16 a[20:23], a[172:175], a[212:215], a[20:23]
buffer_store_dwordx4 v[112:115], v13, s[8:11], s29 offen sc1
v_mfma_f32_16x16x32_bf16 a[24:27], a[172:175], a[216:219], a[24:27]
v_mfma_f32_16x16x32_bf16 a[28:31], a[172:175], a[220:223], a[28:31]
ds_read_b64_tr_b16 a[172:173], v8 offset:0
v_mfma_f32_16x16x32_bf16 a[32:35], a[176:179], a[192:195], a[32:35]
ds_read_b64_tr_b16 a[174:175], v8 offset:1024
s_add_u32 s31, s31, 262144
v_mfma_f32_16x16x32_bf16 a[36:39], a[176:179], a[196:199], a[36:39]
s_add_u32 s48, s48, s34
s_add_u32 s33, s33, 16384
v_mfma_f32_16x16x32_bf16 a[40:43], a[176:179], a[200:203], a[40:43]
s_add_u32 m0, s32, 16384
s_and_b32 s33, s33, 65535
v_mfma_f32_16x16x32_bf16 a[44:47], a[176:179], a[204:207], a[44:47]
buffer_load_dwordx4 v1, s[12:15], s48 offen lds
v_mfma_f32_16x16x32_bf16 a[48:51], a[176:179], a[208:211], a[48:51]
v_mfma_f32_16x16x32_bf16 a[52:55], a[176:179], a[212:215], a[52:55]
v_mfma_f32_16x16x32_bf16 a[56:59], a[176:179], a[216:219], a[56:59]
v_mfma_f32_16x16x32_bf16 a[60:63], a[176:179], a[220:223], a[60:63]
ds_read_b64_tr_b16 a[176:177], v9 offset:0
v_mfma_f32_16x16x32_bf16 a[64:67], a[180:183], a[192:195], a[64:67]
ds_read_b64_tr_b16 a[178:179], v9 offset:1024
v_mfma_f32_16x16x32_bf16 a[68:71], a[180:183], a[196:199], a[68:71]
s_add_u32 s48, s48, s34
v_mfma_f32_16x16x32_bf16 a[72:75], a[180:183], a[200:203], a[72:75]
s_add_u32 m0, s32, 20480
v_mfma_f32_16x16x32_bf16 a[76:79], a[180:183], a[204:207], a[76:79]
buffer_load_dwordx4 v1, s[12:15], s48 offen lds
v_mfma_f32_16x16x32_bf16 a[80:83], a[180:183], a[208:211], a[80:83]
v_mfma_f32_16x16x32_bf16 a[84:87], a[180:183], a[212:215], a[84:87]
v_mfma_f32_16x16x32_bf16 a[88:91], a[180:183], a[216:219], a[88:91]
buffer_load_dword v15, v14, s[96:99], s100 offen
s_add_u32 s100, s100, 8192
v_mfma_f32_16x16x32_bf16 a[92:95], a[180:183], a[220:223], a[92:95]
ds_read_b64_tr_b16 a[180:181], v10 offset:0
v_mfma_f32_16x16x32_bf16 a[96:99], a[184:187], a[192:195], a[96:99]
ds_read_b64_tr_b16 a[182:183], v10 offset:1024
v_mfma_f32_16x16x32_bf16 a[100:103], a[184:187], a[196:199], a[100:103]
s_add_u32 s48, s48, s34
v_mfma_f32_16x16x32_bf16 a[104:107], a[184:187], a[200:203], a[104:107]
s_add_u32 m0, s32, 24576
v_mfma_f32_16x16x32_bf16 a[108:111], a[184:187], a[204:207], a[108:111]
buffer_load_dwordx4 v1, s[12:15], s48 offen lds
s_add_u32 s29, s29, s44
v_mfma_f32_16x16x32_bf16 a[112:115], a[184:187], a[208:211], a[112:115]
v_mfma_f32_16x16x32_bf16 a[116:119], a[184:187], a[212:215], a[116:119]
buffer_store_dwordx4 v[116:119], v13, s[8:11], s29 offen sc1
v_mfma_f32_16x16x32_bf16 a[120:123], a[184:187], a[216:219], a[120:123]
v_mfma_f32_16x16x32_bf16 a[124:127], a[184:187], a[220:223], a[124:127]
ds_read_b64_tr_b16 a[184:185], v11 offset:0
v_mfma_f32_16x16x32_bf16 a[128:131], a[188:191], a[192:195], a[128:131]
ds_read_b64_tr_b16 a[186:187], v11 offset:1024
v_mfma_f32_16x16x32_bf16 a[132:135], a[188:191], a[196:199], a[132:135]
s_add_u32 s48, s48, s34
v_add_u32 v3, 32768, v3
v_subrev_u32 v19, 98304, v3
v_mfma_f32_16x16x32_bf16 a[136:139], a[188:191], a[200:203], a[136:139]
s_add_u32 m0, s32, 28672
v_cmp_le_u32 vcc, 163840, v3
v_add_u32 v5, 16384, v5
v_mfma_f32_16x16x32_bf16 a[140:143], a[188:191], a[204:207], a[140:143]
buffer_load_dwordx4 v1, s[12:15], s48 offen lds
v_and_b32 v5, 65535, v5
v_xor_b32 v6, 16, v5
v_mfma_f32_16x16x32_bf16 a[144:147], a[188:191], a[208:211], a[144:147]
s_add_u32 s30, s30, 128
s_add_u32 s32, s32, 32768
s_sub_u32 s48, s32, 98304
v_mfma_f32_16x16x32_bf16 a[148:151], a[188:191], a[212:215], a[148:151]
s_cmp_ge_u32 s32, 163840
s_cselect_b32 s32, s48, s32
v_xor_b32 v7, 64, v5
v_mfma_f32_16x16x32_bf16 a[152:155], a[188:191], a[216:219], a[152:155]
v_xor_b32 v8, 80, v5
v_xor_b32 v9, 128, v5
v_xor_b32 v10, 144, v5
v_mfma_f32_16x16x32_bf16 a[156:159], a[188:191], a[220:223], a[156:159]
v_xor_b32 v11, 192, v5
v_xor_b32 v12, 208, v5
v_cndmask_b32 v3, v3, v19, vcc
v_xor_b32 v4, 64, v3
s_waitcnt vmcnt(24) lgkmcnt(0)
s_barrier
v_mfma_f32_16x16x32_bf16 v[160:163], a[160:163], a[224:227], v[160:163]
ds_read_b128 a[192:195], v3 offset:0
v_mfma_f32_16x16x32_bf16 v[164:167], a[160:163], a[228:231], v[164:167]
s_add_u32 s37, s31, 0
v_mfma_f32_16x16x32_bf16 v[168:171], a[160:163], a[232:235], v[168:171]
s_add_u32 m0, s33, 0
ds_read_b128 a[196:199], v4 offset:1024
v_mfma_f32_16x16x32_bf16 v[172:175], a[160:163], a[236:239], v[172:175]
buffer_load_dwordx4 v2, s[20:23], s37 offen  lds
s_add_u32 s29, s29, s93
v_mfma_f32_16x16x32_bf16 v[176:179], a[160:163], a[240:243], v[176:179]
ds_read_b128 a[200:203], v3 offset:4096
v_mfma_f32_16x16x32_bf16 v[180:183], a[160:163], a[244:247], v[180:183]
buffer_store_dwordx4 v[120:123], v13, s[8:11], s29 offen sc1
v_mfma_f32_16x16x32_bf16 v[184:187], a[160:163], a[248:251], v[184:187]
ds_read_b128 a[204:207], v4 offset:5120
v_mfma_f32_16x16x32_bf16 v[188:191], a[160:163], a[252:255], v[188:191]
ds_read_b64_tr_b16 a[160:161], v5 offset:0
v_mfma_f32_16x16x32_bf16 v[192:195], a[164:167], a[224:227], v[192:195]
ds_read_b64_tr_b16 a[162:163], v5 offset:1024
ds_read_b128 a[208:211], v3 offset:8192
v_mfma_f32_16x16x32_bf16 v[196:199], a[164:167], a[228:231], v[196:199]
s_add_u32 s37, s31, 32768
v_mfma_f32_16x16x32_bf16 v[200:203], a[164:167], a[232:235], v[200:203]
s_add_u32 m0, s33, 1024
ds_read_b128 a[212:215], v4 offset:9216
v_mfma_f32_16x16x32_bf16 v[204:207], a[164:167], a[236:239], v[204:207]
buffer_load_dwordx4 v2, s[20:23], s37 offen  lds
v_mfma_f32_16x16x32_bf16 v[208:211], a[164:167], a[240:243], v[208:211]
ds_read_b128 a[216:219], v3 offset:12288
v_mfma_f32_16x16x32_bf16 v[212:215], a[164:167], a[244:247], v[212:215]
v_mfma_f32_16x16x32_bf16 v[216:219], a[164:167], a[248:251], v[216:219]
ds_read_b128 a[220:223], v4 offset:13312
v_mfma_f32_16x16x32_bf16 v[220:223], a[164:167], a[252:255], v[220:223]
ds_read_b64_tr_b16 a[164:165], v6 offset:0
v_mfma_f32_16x16x32_bf16 v[224:227], a[168:171], a[224:227], v[224:227]
ds_read_b64_tr_b16 a[166:167], v6 offset:1024
ds_read_b64_tr_b16 a[188:189], v12 offset:0
v_mfma_f32_16x16x32_bf16 v[228:231], a[168:171], a[228:231], v[228:231]
s_add_u32 s37, s31, 131072
v_mfma_f32_16x16x32_bf16 v[232:235], a[168:171], a[232:235], v[232:235]
s_add_u32 m0, s33, 4096
ds_read_b64_tr_b16 a[190:191], v12 offset:1024
v_mfma_f32_16x16x32_bf16 v[236:239], a[168:171], a[236:239], v[236:239]
buffer_load_dwordx4 v2, s[20:23], s37 offen  lds
v_mfma_f32_16x16x32_bf16 v[240:243], a[168:171], a[240:243], v[240:243]
v_mfma_f32_16x16x32_bf16 v[244:247], a[168:171], a[244:247], v[244:247]
v_mfma_f32_16x16x32_bf16 v[248:251], a[168:171], a[248:251], v[248:251]
v_mfma_f32_16x16x32_bf16 v[252:255], a[168:171], a[252:255], v[252:255]
ds_read_b64_tr_b16 a[168:169], v7 offset:0
v_mfma_f32_16x16x32_bf16 a[0:3], a[172:175], a[224:227], a[0:3]
ds_read_b64_tr_b16 a[170:171], v7 offset:1024
v_mfma_f32_16x16x32_bf16 a[4:7], a[172:175], a[228:231], a[4:7]
s_add_u32 s37, s31, 163840
v_mfma_f32_16x16x32_bf16 a[8:11], a[172:175], a[232:235], a[8:11]
s_add_u32 m0, s33, 5120
v_mfma_f32_16x16x32_bf16 a[12:15], a[172:175], a[236:239], a[12:15]
buffer_load_dwordx4 v2, s[20:23], s37 offen  lds
s_add_u32 s29, s29, s44
v_mfma_f32_16x16x32_bf16 a[16:19], a[172:175], a[240:243], a[16:19]
v_mfma_f32_16x16x32_bf16 a[20:23], a[172:175], a[244:247], a[20:23]
buffer_store_dwordx4 v[124:127], v13, s[8:11], s29 offen sc1
v_mfma_f32_16x16x32_bf16 a[24:27], a[172:175], a[248:251], a[24:27]
v_mfma_f32_16x16x32_bf16 a[28:31], a[172:175], a[252:255], a[28:31]
ds_read_b64_tr_b16 a[172:173], v8 offset:0
v_mfma_f32_16x16x32_bf16 a[32:35], a[176:179], a[224:227], a[32:35]
ds_read_b64_tr_b16 a[174:175], v8 offset:1024
s_add_u32 s31, s31, 262144
v_mfma_f32_16x16x32_bf16 a[36:39], a[176:179], a[228:231], a[36:39]
s_mov_b32 s48, s30
s_add_u32 s33, s33, 16384
v_mfma_f32_16x16x32_bf16 a[40:43], a[176:179], a[232:235], a[40:43]
s_add_u32 m0, s32, 0
s_and_b32 s33, s33, 65535
v_mfma_f32_16x16x32_bf16 a[44:47], a[176:179], a[236:239], a[44:47]
buffer_load_dwordx4 v1, s[12:15], s48 offen lds
v_mfma_f32_16x16x32_bf16 a[48:51], a[176:179], a[240:243], a[48:51]
v_mfma_f32_16x16x32_bf16 a[52:55], a[176:179], a[244:247], a[52:55]
v_mfma_f32_16x16x32_bf16 a[56:59], a[176:179], a[248:251], a[56:59]
v_mfma_f32_16x16x32_bf16 a[60:63], a[176:179], a[252:255], a[60:63]
ds_read_b64_tr_b16 a[176:177], v9 offset:0
v_mfma_f32_16x16x32_bf16 a[64:67], a[180:183], a[224:227], a[64:67]
ds_read_b64_tr_b16 a[178:179], v9 offset:1024
v_mfma_f32_16x16x32_bf16 a[68:71], a[180:183], a[228:231], a[68:71]
s_add_u32 s48, s48, s34
v_mfma_f32_16x16x32_bf16 a[72:75], a[180:183], a[232:235], a[72:75]
s_add_u32 m0, s32, 4096
v_mfma_f32_16x16x32_bf16 a[76:79], a[180:183], a[236:239], a[76:79]
buffer_load_dwordx4 v1, s[12:15], s48 offen lds
v_mfma_f32_16x16x32_bf16 a[80:83], a[180:183], a[240:243], a[80:83]
v_mfma_f32_16x16x32_bf16 a[84:87], a[180:183], a[244:247], a[84:87]
v_mfma_f32_16x16x32_bf16 a[88:91], a[180:183], a[248:251], a[88:91]
buffer_load_dword v15, v14, s[96:99], s100 offen
s_add_u32 s100, s100, 8192
v_mfma_f32_16x16x32_bf16 a[92:95], a[180:183], a[252:255], a[92:95]
ds_read_b64_tr_b16 a[180:181], v10 offset:0
v_mfma_f32_16x16x32_bf16 a[96:99], a[184:187], a[224:227], a[96:99]
ds_read_b64_tr_b16 a[182:183], v10 offset:1024
v_mfma_f32_16x16x32_bf16 a[100:103], a[184:187], a[228:231], a[100:103]
s_add_u32 s48, s48, s34
v_mfma_f32_16x16x32_bf16 a[104:107], a[184:187], a[232:235], a[104:107]
s_add_u32 m0, s32, 8192
v_mfma_f32_16x16x32_bf16 a[108:111], a[184:187], a[236:239], a[108:111]
buffer_load_dwordx4 v1, s[12:15], s48 offen lds
v_mfma_f32_16x16x32_bf16 a[112:115], a[184:187], a[240:243], a[112:115]
v_mfma_f32_16x16x32_bf16 a[116:119], a[184:187], a[244:247], a[116:119]
v_mfma_f32_16x16x32_bf16 a[120:123], a[184:187], a[248:251], a[120:123]
v_mfma_f32_16x16x32_bf16 a[124:127], a[184:187], a[252:255], a[124:127]
ds_read_b64_tr_b16 a[184:185], v11 offset:0
v_mfma_f32_16x16x32_bf16 a[128:131], v[28:31], a[224:227], a[128:131]
ds_read_b64_tr_b16 a[186:187], v11 offset:1024
v_mfma_f32_16x16x32_bf16 a[132:135], v[28:31], a[228:231], a[132:135]
s_add_u32 s48, s48, s34
v_add_u32 v5, 16384, v5
v_and_b32 v5, 65535, v5
v_mfma_f32_16x16x32_bf16 a[136:139], v[28:31], a[232:235], a[136:139]
s_add_u32 m0, s32, 12288
v_xor_b32 v6, 16, v5
v_xor_b32 v7, 64, v5
v_mfma_f32_16x16x32_bf16 a[140:143], v[28:31], a[236:239], a[140:143]
buffer_load_dwordx4 v1, s[12:15], s48 offen lds
v_xor_b32 v8, 80, v5
v_xor_b32 v9, 128, v5
v_mfma_f32_16x16x32_bf16 a[144:147], v[28:31], a[240:243], a[144:147]
v_xor_b32 v10, 144, v5
v_xor_b32 v11, 192, v5
v_xor_b32 v12, 208, v5
v_mfma_f32_16x16x32_bf16 a[148:151], v[28:31], a[244:247], a[148:151]
v_mfma_f32_16x16x32_bf16 a[152:155], v[28:31], a[248:251], a[152:155]
v_mfma_f32_16x16x32_bf16 a[156:159], v[28:31], a[252:255], a[156:159]
s_cmp_eq_u32 s36, 0
s_cbranch_scc1 L_g_k12
s_waitcnt vmcnt(23) lgkmcnt(0)
s_barrier
v_mfma_f32_16x16x32_bf16 v[160:163], a[160:163], a[192:195], v[160:163]
ds_read_b128 a[224:227], v4 offset:0
v_mfma_f32_16x16x32_bf16 v[164:167], a[160:163], a[196:199], v[164:167]
s_add_u32 s37, s31, 0
v_mfma_f32_16x16x32_bf16 v[168:171], a[160:163], a[200:203], v[168:171]
s_add_u32 m0, s33, 0
ds_read_b128 a[228:231], v3 offset:1024
v_mfma_f32_16x16x32_bf16 v[172:175], a[160:163], a[204:207], v[172:175]
buffer_load_dwordx4 v2, s[20:23], s37 offen  lds
v_mfma_f32_16x16x32_bf16 v[176:179], a[160:163], a[208:211], v[176:179]
ds_read_b128 a[232:235], v4 offset:4096
v_mfma_f32_16x16x32_bf16 v[180:183], a[160:163], a[212:215], v[180:183]
v_mfma_f32_16x16x32_bf16 v[184:187], a[160:163], a[216:219], v[184:187]
ds_read_b128 a[236:239], v3 offset:5120
v_mfma_f32_16x16x32_bf16 v[188:191], a[160:163], a[220:223], v[188:191]
ds_read_b64_tr_b16 a[160:161], v5 offset:0
v_mfma_f32_16x16x32_bf16 v[192:195], a[164:167], a[192:195], v[192:195]
ds_read_b64_tr_b16 a[162:163], v5 offset:1024
ds_read_b128 a[240:243], v4 offset:8192
v_mfma_f32_16x16x32_bf16 v[196:199], a[164:167], a[196:199], v[196:199]
s_add_u32 s37, s31, 32768
v_mfma_f32_16x16x32_bf16 v[200:203], a[164:167], a[200:203], v[200:203]
s_add_u32 m0, s33, 1024
ds_read_b128 a[244:247], v3 offset:9216
v_mfma_f32_16x16x32_bf16 v[204:207], a[164:167], a[204:207], v[204:207]
buffer_load_dwordx4 v2, s[20:23], s37 offen  lds
v_mfma_f32_16x16x32_bf16 v[208:211], a[164:167], a[208:211], v[208:211]
ds_read_b128 a[248:251], v4 offset:12288
v_mfma_f32_16x16x32_bf16 v[212:215], a[164:167], a[212:215], v[212:215]
v_mfma_f32_16x16x32_bf16 v[216:219], a[164:167], a[216:219], v[216:219]
ds_read_b128 a[252:255], v3 offset:13312
v_mfma_f32_16x16x32_bf16 v[220:223], a[164:167], a[220:223], v[220:223]
ds_read_b64_tr_b16 a[164:165], v6 offset:0
v_mfma_f32_16x16x32_bf16 v[224:227], a[168:171], a[192:195], v[224:227]
ds_read_b64_tr_b16 a[166:167], v6 offset:1024
ds_read_b64_tr_b16 v[28:29], v12 offset:0
v_mfma_f32_16x16x32_bf16 v[228:231], a[168:171], a[196:199], v[228:231]
s_add_u32 s37, s31, 131072
v_mfma_f32_16x16x32_bf16 v[232:235], a[168:171], a[200:203], v[232:235]
s_add_u32 m0, s33, 4096
ds_read_b64_tr_b16 v[30:31], v12 offset:1024
v_mfma_f32_16x16x32_bf16 v[236:239], a[168:171], a[204:207], v[236:239]
buffer_load_dwordx4 v2, s[20:23], s37 offen  lds
v_mfma_f32_16x16x32_bf16 v[240:243], a[168:171], a[208:211], v[240:243]
v_mfma_f32_16x16x32_bf16 v[244:247], a[168:171], a[212:215], v[244:247]
v_mfma_f32_16x16x32_bf16 v[248:251], a[168:171], a[216:219], v[248:251]
v_mfma_f32_16x16x32_bf16 v[252:255], a[168:171], a[220:223], v[252:255]
ds_read_b64_tr_b16 a[168:169], v7 offset:0
v_mfma_f32_16x16x32_bf16 a[0:3], a[172:175], a[192:195], a[0:3]
ds_read_b64_tr_b16 a[170:171], v7 offset:1024
v_mfma_f32_16x16x32_bf16 a[4:7], a[172:175], a[196:199], a[4:7]
s_add_u32 s37, s31, 163840
v_mfma_f32_16x16x32_bf16 a[8:11], a[172:175], a[200:203], a[8:11]
s_add_u32 m0, s33, 5120
v_mfma_f32_16x16x32_bf16 a[12:15], a[172:175], a[204:207], a[12:15]
buffer_load_dwordx4 v2, s[20:23], s37 offen  lds
v_mfma_f32_16x16x32_bf16 a[16:19], a[172:175], a[208:211], a[16:19]
v_mfma_f32_16x16x32_bf16 a[20:23], a[172:175], a[212:215], a[20:23]
v_mfma_f32_16x16x32_bf16 a[24:27], a[172:175], a[216:219], a[24:27]
v_mfma_f32_16x16x32_bf16 a[28:31], a[172:175], a[220:223], a[28:31]
ds_read_b64_tr_b16 a[172:173], v8 offset:0
v_mfma_f32_16x16x32_bf16 a[32:35], a[176:179], a[192:195], a[32:35]
ds_read_b64_tr_b16 a[174:175], v8 offset:1024
s_add_u32 s31, s31, 262144
v_mfma_f32_16x16x32_bf16 a[36:39], a[176:179], a[196:199], a[36:39]
s_add_u32 s48, s48, s34
s_add_u32 s33, s33, 16384
v_mfma_f32_16x16x32_bf16 a[40:43], a[176:179], a[200:203], a[40:43]
s_add_u32 m0, s32, 16384
s_and_b32 s33, s33, 65535
v_mfma_f32_16x16x32_bf16 a[44:47], a[176:179], a[204:207], a[44:47]
buffer_load_dwordx4 v1, s[12:15], s48 offen lds
v_mfma_f32_16x16x32_bf16 a[48:51], a[176:179], a[208:211], a[48:51]
v_mfma_f32_16x16x32_bf16 a[52:55], a[176:179], a[212:215], a[52:55]
v_mfma_f32_16x16x32_bf16 a[56:59], a[176:179], a[216:219], a[56:59]
v_mfma_f32_16x16x32_bf16 a[60:63], a[176:179], a[220:223], a[60:63]
ds_read_b64_tr_b16 a[176:177], v9 offset:0
v_mfma_f32_16x16x32_bf16 a[64:67], a[180:183], a[192:195], a[64:67]
ds_read_b64_tr_b16 a[178:179], v9 offset:1024
v_mfma_f32_16x16x32_bf16 a[68:71], a[180:183], a[196:199], a[68:71]
s_add_u32 s48, s48, s34
v_mfma_f32_16x16x32_bf16 a[72:75], a[180:183], a[200:203], a[72:75]
s_add_u32 m0, s32, 20480
v_mfma_f32_16x16x32_bf16 a[76:79], a[180:183], a[204:207], a[76:79]
buffer_load_dwordx4 v1, s[12:15], s48 offen lds
v_mfma_f32_16x16x32_bf16 a[80:83], a[180:183], a[208:211], a[80:83]
v_mfma_f32_16x16x32_bf16 a[84:87], a[180:183], a[212:215], a[84:87]
v_mfma_f32_16x16x32_bf16 a[88:91], a[180:183], a[216:219], a[88:91]
v_mfma_f32_16x16x32_bf16 a[92:95], a[180:183], a[220:223], a[92:95]
ds_read_b64_tr_b16 a[180:181], v10 offset:0
v_mfma_f32_16x16x32_bf16 a[96:99], a[184:187], a[192:195], a[96:99]
ds_read_b64_tr_b16 a[182:183], v10 offset:1024
v_mfma_f32_16x16x32_bf16 a[100:103], a[184:187], a[196:199], a[100:103]
s_add_u32 s48, s48, s34
v_mfma_f32_16x16x32_bf16 a[104:107], a[184:187], a[200:203], a[104:107]
s_add_u32 m0, s32, 24576
v_mfma_f32_16x16x32_bf16 a[108:111], a[184:187], a[204:207], a[108:111]
buffer_load_dwordx4 v1, s[12:15], s48 offen lds
v_mfma_f32_16x16x32_bf16 a[112:115], a[184:187], a[208:211], a[112:115]
v_mfma_f32_16x16x32_bf16 a[116:119], a[184:187], a[212:215], a[116:119]
v_mfma_f32_16x16x32_bf16 a[120:123], a[184:187], a[216:219], a[120:123]
v_mfma_f32_16x16x32_bf16 a[124:127], a[184:187], a[220:223], a[124:127]
ds_read_b64_tr_b16 a[184:185], v11 offset:0
v_mfma_f32_16x16x32_bf16 a[128:131], a[188:191], a[192:195], a[128:131]
ds_read_b64_tr_b16 a[186:187], v11 offset:1024
v_mfma_f32_16x16x32_bf16 a[132:135], a[188:191], a[196:199], a[132:135]
s_add_u32 s48, s48, s34
v_add_u32 v3, 32768, v3
v_subrev_u32 v19, 98304, v3
v_mfma_f32_16x16x32_bf16 a[136:139], a[188:191], a[200:203], a[136:139]
s_add_u32 m0, s32, 28672
v_cmp_le_u32 vcc, 163840, v3
v_add_u32 v5, 16384, v5
v_mfma_f32_16x16x32_bf16 a[140:143], a[188:191], a[204:207], a[140:143]
buffer_load_dwordx4 v1, s[12:15], s48 offen lds
v_and_b32 v5, 65535, v5
v_xor_b32 v6, 16, v5
v_mfma_f32_16x16x32_bf16 a[144:147], a[188:191], a[208:211], a[144:147]
s_add_u32 s30, s30, 128
s_add_u32 s32, s32, 32768
s_sub_u32 s48, s32, 98304
v_mfma_f32_16x16x32_bf16 a[148:151], a[188:191], a[212:215], a[148:151]
s_cmp_ge_u32 s32, 163840
s_cselect_b32 s32, s48, s32
v_xor_b32 v7, 64, v5
v_mfma_f32_16x16x32_bf16 a[152:155], a[188:191], a[216:219], a[152:155]
v_xor_b32 v8, 80, v5
v_xor_b32 v9, 128, v5
v_xor_b32 v10, 144, v5
v_mfma_f32_16x16x32_bf16 a[156:159], a[188:191], a[220:223], a[156:159]
v_xor_b32 v11, 192, v5
v_xor_b32 v12, 208, v5
v_cndmask_b32 v3, v3, v19, vcc
v_xor_b32 v4, 64, v3
s_waitcnt vmcnt(19) lgkmcnt(0)
s_barrier
v_mfma_f32_16x16x32_bf16 v[160:163], a[160:163], a[224:227], v[160:163]
ds_read_b128 a[192:195], v3 offset:0
v_mfma_f32_16x16x32_bf16 v[164:167], a[160:163], a[228:231], v[164:167]
s_add_u32 s37, s31, 0
v_mfma_f32_16x16x32_bf16 v[168:171], a[160:163], a[232:235], v[168:171]
s_add_u32 m0, s33, 0
ds_read_b128 a[196:199], v4 offset:1024
v_mfma_f32_16x16x32_bf16 v[172:175], a[160:163], a[236:239], v[172:175]
buffer_load_dwordx4 v2, s[20:23], s37 offen  lds
v_mfma_f32_16x16x32_bf16 v[176:179], a[160:163], a[240:243], v[176:179]
ds_read_b128 a[200:203], v3 offset:4096
v_mfma_f32_16x16x32_bf16 v[180:183], a[160:163], a[244:247], v[180:183]
v_mfma_f32_16x16x32_bf16 v[184:187], a[160:163], a[248:251], v[184:187]
ds_read_b128 a[204:207], v4 offset:5120
v_mfma_f32_16x16x32_bf16 v[188:191], a[160:163], a[252:255], v[188:191]
ds_read_b64_tr_b16 a[160:161], v5 offset:0
v_mfma_f32_16x16x32_bf16 v[192:195], a[164:167], a[224:227], v[192:195]
ds_read_b64_tr_b16 a[162:163], v5 offset:1024
ds_read_b128 a[208:211], v3 offset:8192
v_mfma_f32_16x16x32_bf16 v[196:199], a[164:167], a[228:231], v[196:199]
s_add_u32 s37, s31, 32768
v_mfma_f32_16x16x32_bf16 v[200:203], a[164:167], a[232:235], v[200:203]
s_add_u32 m0, s33, 1024
ds_read_b128 a[212:215], v4 offset:9216
v_mfma_f32_16x16x32_bf16 v[204:207], a[164:167], a[236:239], v[204:207]
buffer_load_dwordx4 v2, s[20:23], s37 offen  lds
v_mfma_f32_16x16x32_bf16 v[208:211], a[164:167], a[240:243], v[208:211]
ds_read_b128 a[216:219], v3 offset:12288
v_mfma_f32_16x16x32_bf16 v[212:215], a[164:167], a[244:247], v[212:215]
v_mfma_f32_16x16x32_bf16 v[216:219], a[164:167], a[248:251], v[216:219]
ds_read_b128 a[220:223], v4 offset:13312
v_mfma_f32_16x16x32_bf16 v[220:223], a[164:167], a[252:255], v[220:223]
ds_read_b64_tr_b16 a[164:165], v6 offset:0
v_mfma_f32_16x16x32_bf16 v[224:227], a[168:171], a[224:227], v[224:227]
ds_read_b64_tr_b16 a[166:167], v6 offset:1024
ds_read_b64_tr_b16 a[188:189], v12 offset:0
v_mfma_f32_16x16x32_bf16 v[228:231], a[168:171], a[228:231], v[228:231]
s_add_u32 s37, s31, 131072
v_mfma_f32_16x16x32_bf16 v[232:235], a[168:171], a[232:235], v[232:235]
s_add_u32 m0, s33, 4096
ds_read_b64_tr_b16 a[190:191], v12 offset:1024
v_mfma_f32_16x16x32_bf16 v[236:239], a[168:171], a[236:239], v[236:239]
buffer_load_dwordx4 v2, s[20:23], s37 offen  lds
v_mfma_f32_16x16x32_bf16 v[240:243], a[168:171], a[240:243], v[240:243]
v_mfma_f32_16x16x32_bf16 v[244:247], a[168:171], a[244:247], v[244:247]
v_mfma_f32_16x16x32_bf16 v[248:251], a[168:171], a[248:251], v[248:251]
v_mfma_f32_16x16x32_bf16 v[252:255], a[168:171], a[252:255], v[252:255]
ds_read_b64_tr_b16 a[168:169], v7 offset:0
v_mfma_f32_16x16x32_bf16 a[0:3], a[172:175], a[224:227], a[0:3]
ds_read_b64_tr_b16 a[170:171], v7 offset:1024
v_mfma_f32_16x16x32_bf16 a[4:7], a[172:175], a[228:231], a[4:7]
s_add_u32 s37, s31, 163840
v_mfma_f32_16x16x32_bf16 a[8:11], a[172:175], a[232:235], a[8:11]
s_add_u32 m0, s33, 5120
v_mfma_f32_16x16x32_bf16 a[12:15], a[172:175], a[236:239], a[12:15]
buffer_load_dwordx4 v2, s[20:23], s37 offen  lds
v_mfma_f32_16x16x32_bf16 a[16:19], a[172:175], a[240:243], a[16:19]
v_mfma_f32_16x16x32_bf16 a[20:23], a[172:175], a[244:247], a[20:23]
v_mfma_f32_16x16x32_bf16 a[24:27], a[172:175], a[248:251], a[24:27]
v_mfma_f32_16x16x32_bf16 a[28:31], a[172:175], a[252:255], a[28:31]
ds_read_b64_tr_b16 a[172:173], v8 offset:0
v_mfma_f32_16x16x32_bf16 a[32:35], a[176:179], a[224:227], a[32:35]
ds_read_b64_tr_b16 a[174:175], v8 offset:1024
s_add_u32 s31, s31, 262144
v_mfma_f32_16x16x32_bf16 a[36:39], a[176:179], a[228:231], a[36:39]
s_mov_b32 s48, s30
s_add_u32 s33, s33, 16384
v_mfma_f32_16x16x32_bf16 a[40:43], a[176:179], a[232:235], a[40:43]
s_add_u32 m0, s32, 0
s_and_b32 s33, s33, 65535
v_mfma_f32_16x16x32_bf16 a[44:47], a[176:179], a[236:239], a[44:47]
buffer_load_dwordx4 v1, s[12:15], s48 offen lds
v_mfma_f32_16x16x32_bf16 a[48:51], a[176:179], a[240:243], a[48:51]
v_mfma_f32_16x16x32_bf16 a[52:55], a[176:179], a[244:247], a[52:55]
v_mfma_f32_16x16x32_bf16 a[56:59], a[176:179], a[248:251], a[56:59]
v_mfma_f32_16x16x32_bf16 a[60:63], a[176:179], a[252:255], a[60:63]
ds_read_b64_tr_b16 a[176:177], v9 offset:0
v_mfma_f32_16x16x32_bf16 a[64:67], a[180:183], a[224:227], a[64:67]
ds_read_b64_tr_b16 a[178:179], v9 offset:1024
v_mfma_f32_16x16x32_bf16 a[68:71], a[180:183], a[228:231], a[68:71]
s_add_u32 s48, s48, s34
v_mfma_f32_16x16x32_bf16 a[72:75], a[180:183], a[232:235], a[72:75]
s_add_u32 m0, s32, 4096
v_mfma_f32_16x16x32_bf16 a[76:79], a[180:183], a[236:239], a[76:79]
buffer_load_dwordx4 v1, s[12:15], s48 offen lds
v_mfma_f32_16x16x32_bf16 a[80:83], a[180:183], a[240:243], a[80:83]
v_mfma_f32_16x16x32_bf16 a[84:87], a[180:183], a[244:247], a[84:87]
v_mfma_f32_16x16x32_bf16 a[88:91], a[180:183], a[248:251], a[88:91]
v_mfma_f32_16x16x32_bf16 a[92:95], a[180:183], a[252:255], a[92:95]
ds_read_b64_tr_b16 a[180:181], v10 offset:0
v_mfma_f32_16x16x32_bf16 a[96:99], a[184:187], a[224:227], a[96:99]
ds_read_b64_tr_b16 a[182:183], v10 offset:1024
v_mfma_f32_16x16x32_bf16 a[100:103], a[184:187], a[228:231], a[100:103]
s_add_u32 s48, s48, s34
v_mfma_f32_16x16x32_bf16 a[104:107], a[184:187], a[232:235], a[104:107]
s_add_u32 m0, s32, 8192
v_mfma_f32_16x16x32_bf16 a[108:111], a[184:187], a[236:239], a[108:111]
buffer_load_dwordx4 v1, s[12:15], s48 offen lds
v_mfma_f32_16x16x32_bf16 a[112:115], a[184:187], a[240:243], a[112:115]
v_mfma_f32_16x16x32_bf16 a[116:119], a[184:187], a[244:247], a[116:119]
v_mfma_f32_16x16x32_bf16 a[120:123], a[184:187], a[248:251], a[120:123]
v_mfma_f32_16x16x32_bf16 a[124:127], a[184:187], a[252:255], a[124:127]
ds_read_b64_tr_b16 a[184:185], v11 offset:0
v_mfma_f32_16x16x32_bf16 a[128:131], v[28:31], a[224:227], a[128:131]
ds_read_b64_tr_b16 a[186:187], v11 offset:1024
v_mfma_f32_16x16x32_bf16 a[132:135], v[28:31], a[228:231], a[132:135]
s_add_u32 s48, s48, s34
v_add_u32 v5, 16384, v5
v_and_b32 v5, 65535, v5
v_mfma_f32_16x16x32_bf16 a[136:139], v[28:31], a[232:235], a[136:139]
s_add_u32 m0, s32, 12288
v_xor_b32 v6, 16, v5
v_xor_b32 v7, 64, v5
v_mfma_f32_16x16x32_bf16 a[140:143], v[28:31], a[236:239], a[140:143]
buffer_load_dwordx4 v1, s[12:15], s48 offen lds
v_xor_b32 v8, 80, v5
v_xor_b32 v9, 128, v5
v_mfma_f32_16x16x32_bf16 a[144:147], v[28:31], a[240:243], a[144:147]
v_xor_b32 v10, 144, v5
v_xor_b32 v11, 192, v5
v_xor_b32 v12, 208, v5
v_mfma_f32_16x16x32_bf16 a[148:151], v[28:31], a[244:247], a[148:151]
v_mfma_f32_16x16x32_bf16 a[152:155], v[28:31], a[248:251], a[152:155]
v_mfma_f32_16x16x32_bf16 a[156:159], v[28:31], a[252:255], a[156:159]
L_g_k12:
s_waitcnt vmcnt(16) lgkmcnt(0)
s_barrier
v_mfma_f32_16x16x32_bf16 v[160:163], a[160:163], a[192:195], v[160:163]
ds_read_b128 a[224:227], v4 offset:0
s_lshl_b32 s24, s35, 2
s_lshr_b32 s26, s88, s24
v_mfma_f32_16x16x32_bf16 v[164:167], a[160:163], a[196:199], v[164:167]
s_add_u32 s37, s31, 0
s_bfe_u32 s2, s26, 0x10003
s_and_b32 s26, s26, 7
v_mfma_f32_16x16x32_bf16 v[168:171], a[160:163], a[200:203], v[168:171]
s_add_u32 m0, s33, 0
ds_read_b128 a[228:231], v3 offset:1024
s_or_b32 s40, s2, s61
v_mfma_f32_16x16x32_bf16 v[172:175], a[160:163], a[204:207], v[172:175]
buffer_load_dwordx4 v2, s[20:23], s37 offen  lds
s_add_u32 s60, s60, s92
s_lshr_b32 s24, s17, 1
v_mfma_f32_16x16x32_bf16 v[176:179], a[160:163], a[208:211], v[176:179]
s_mov_b32 s29, s60
ds_read_b128 a[232:235], v4 offset:4096
v_mfma_f32_16x16x32_bf16 v[180:183], a[160:163], a[212:215], v[180:183]
buffer_store_dwordx4 v[128:131], v13, s[8:11], s29 offen sc1
v_mfma_f32_16x16x32_bf16 v[184:187], a[160:163], a[216:219], v[184:187]
ds_read_b128 a[236:239], v3 offset:5120
v_mfma_f32_16x16x32_bf16 v[188:191], a[160:163], a[220:223], v[188:191]
ds_read_b64_tr_b16 a[160:161], v5 offset:0
v_mfma_f32_16x16x32_bf16 v[192:195], a[164:167], a[192:195], v[192:195]
ds_read_b64_tr_b16 a[162:163], v5 offset:1024
ds_read_b128 a[240:243], v4 offset:8192
v_mfma_f32_16x16x32_bf16 v[196:199], a[164:167], a[196:199], v[196:199]
s_add_u32 s37, s31, 32768
v_mfma_f32_16x16x32_bf16 v[200:203], a[164:167], a[200:203], v[200:203]
s_add_u32 m0, s33, 1024
ds_read_b128 a[244:247], v3 offset:9216
v_mfma_f32_16x16x32_bf16 v[204:207], a[164:167], a[204:207], v[204:207]
buffer_load_dwordx4 v2, s[20:23], s37 offen  lds
v_mfma_f32_16x16x32_bf16 v[208:211], a[164:167], a[208:211], v[208:211]
ds_read_b128 a[248:251], v4 offset:12288
v_mfma_f32_16x16x32_bf16 v[212:215], a[164:167], a[212:215], v[212:215]
s_cmp_eq_u32 s2, 0
s_cselect_b32 s41, s24, 0
s_cselect_b32 s27, s89, s90
v_mfma_f32_16x16x32_bf16 v[216:219], a[164:167], a[216:219], v[216:219]
ds_read_b128 a[252:255], v3 offset:13312
s_sub_u32 s25, s24, s41
s_and_b32 s51, s41, s61
v_mfma_f32_16x16x32_bf16 v[220:223], a[164:167], a[220:223], v[220:223]
ds_read_b64_tr_b16 a[164:165], v6 offset:0
s_lshl_b32 s51, s51, 1
s_or_b32 s51, s51, s41
v_mfma_f32_16x16x32_bf16 v[224:227], a[168:171], a[192:195], v[224:227]
ds_read_b64_tr_b16 a[166:167], v6 offset:1024
ds_read_b64_tr_b16 v[28:29], v12 offset:0
s_lshl_b32 s46, s27, s2
v_mfma_f32_16x16x32_bf16 v[228:231], a[168:171], a[196:199], v[228:231]
s_add_u32 s37, s31, 131072
s_add_u32 s46, s46, s25
s_lshl_b32 s46, s46, 8
v_mfma_f32_16x16x32_bf16 v[232:235], a[168:171], a[200:203], v[232:235]
s_add_u32 m0, s33, 4096
ds_read_b64_tr_b16 v[30:31], v12 offset:1024
s_lshl_b32 s47, s40, 7
v_mfma_f32_16x16x32_bf16 v[236:239], a[168:171], a[204:207], v[236:239]
buffer_load_dwordx4 v2, s[20:23], s37 offen  lds
s_add_u32 s47, s47, 1024
s_mul_i32 s101, s26, s47
v_mfma_f32_16x16x32_bf16 v[240:243], a[168:171], a[208:211], v[240:243]
s_lshl_b32 s101, s101, 8
s_lshl_b32 s42, s27, 3
s_add_u32 s42, s42, s26
v_mfma_f32_16x16x32_bf16 v[244:247], a[168:171], a[212:215], v[244:247]
s_lshl_b32 s42, s42, 1
s_and_b32 s25, s17, 1
s_add_u32 s42, s42, s25
v_mfma_f32_16x16x32_bf16 v[248:251], a[168:171], a[216:219], v[248:251]
s_lshl_b32 s42, s42, 3
s_add_u32 s42, s42, s24
s_lshl_b32 s42, s42, 13
v_mfma_f32_16x16x32_bf16 v[252:255], a[168:171], a[220:223], v[252:255]
ds_read_b64_tr_b16 a[168:169], v7 offset:0
s_lshl_b32 s43, s27, 5
s_add_u32 s43, s43, s26
v_mfma_f32_16x16x32_bf16 a[0:3], a[172:175], a[192:195], a[0:3]
ds_read_b64_tr_b16 a[170:171], v7 offset:1024
s_lshl_b32 s43, s43, 2
s_lshl_b32 s24, s2, 1
v_mfma_f32_16x16x32_bf16 a[4:7], a[172:175], a[196:199], a[4:7]
s_add_u32 s37, s31, 163840
s_add_u32 s24, s24, s61
s_lshl_b32 s24, s24, 2
v_mfma_f32_16x16x32_bf16 a[8:11], a[172:175], a[200:203], a[8:11]
s_add_u32 m0, s33, 5120
s_lshr_b32 s25, 0x8720, s24
s_and_b32 s25, s25, 15
v_mfma_f32_16x16x32_bf16 a[12:15], a[172:175], a[204:207], a[12:15]
buffer_load_dwordx4 v2, s[20:23], s37 offen  lds
s_add_u32 s29, s29, s44
s_lshl_b32 s25, s25, 24
v_mfma_f32_16x16x32_bf16 a[16:19], a[172:175], a[208:211], a[16:19]
s_add_u32 s42, s42, s25
s_lshr_b32 s25, 0x7604, s24
s_and_b32 s25, s25, 15
v_mfma_f32_16x16x32_bf16 a[20:23], a[172:175], a[212:215], a[20:23]
buffer_store_dwordx4 v[132:135], v13, s[8:11], s29 offen sc1
s_lshl_b32 s25, s25, 12
s_add_u32 s43, s43, s25
v_mfma_f32_16x16x32_bf16 a[24:27], a[172:175], a[216:219], a[24:27]
s_add_u32 s43, s43, 111149056
v_mfma_f32_16x16x32_bf16 a[28:31], a[172:175], a[220:223], a[28:31]
ds_read_b64_tr_b16 a[172:173], v8 offset:0
v_mfma_f32_16x16x32_bf16 a[32:35], a[176:179], a[192:195], a[32:35]
ds_read_b64_tr_b16 a[174:175], v8 offset:1024
s_add_u32 s31, s31, 262144
v_mfma_f32_16x16x32_bf16 a[36:39], a[176:179], a[196:199], a[36:39]
s_add_u32 s48, s48, s34
s_add_u32 s33, s33, 16384
v_mfma_f32_16x16x32_bf16 a[40:43], a[176:179], a[200:203], a[40:43]
s_add_u32 m0, s32, 16384
s_and_b32 s33, s33, 65535
v_mfma_f32_16x16x32_bf16 a[44:47], a[176:179], a[204:207], a[44:47]
buffer_load_dwordx4 v1, s[12:15], s48 offen lds
v_mfma_f32_16x16x32_bf16 a[48:51], a[176:179], a[208:211], a[48:51]
s_cmp_lt_u32 s35, s45
s_cselect_b32 s101, s101, 536870912
s_cselect_b32 s46, s46, 536870912
v_mfma_f32_16x16x32_bf16 a[52:55], a[176:179], a[212:215], a[52:55]
v_mfma_f32_16x16x32_bf16 a[56:59], a[176:179], a[216:219], a[56:59]
v_mfma_f32_16x16x32_bf16 a[60:63], a[176:179], a[220:223], a[60:63]
ds_read_b64_tr_b16 a[176:177], v9 offset:0
v_mfma_f32_16x16x32_bf16 a[64:67], a[180:183], a[192:195], a[64:67]
ds_read_b64_tr_b16 a[178:179], v9 offset:1024
v_mfma_f32_16x16x32_bf16 a[68:71], a[180:183], a[196:199], a[68:71]
s_add_u32 s48, s48, s34
v_mfma_f32_16x16x32_bf16 a[72:75], a[180:183], a[200:203], a[72:75]
s_add_u32 m0, s32, 20480
v_mfma_f32_16x16x32_bf16 a[76:79], a[180:183], a[204:207], a[76:79]
buffer_load_dwordx4 v1, s[12:15], s48 offen lds
v_mfma_f32_16x16x32_bf16 a[80:83], a[180:183], a[208:211], a[80:83]
v_mfma_f32_16x16x32_bf16 a[84:87], a[180:183], a[212:215], a[84:87]
v_mfma_f32_16x16x32_bf16 a[88:91], a[180:183], a[216:219], a[88:91]
buffer_load_dword v15, v14, s[96:99], s100 offen
s_add_u32 s100, s100, 8192
v_mfma_f32_16x16x32_bf16 a[92:95], a[180:183], a[220:223], a[92:95]
ds_read_b64_tr_b16 a[180:181], v10 offset:0
v_mfma_f32_16x16x32_bf16 a[96:99], a[184:187], a[192:195], a[96:99]
ds_read_b64_tr_b16 a[182:183], v10 offset:1024
v_mfma_f32_16x16x32_bf16 a[100:103], a[184:187], a[196:199], a[100:103]
s_add_u32 s48, s48, s34
v_mfma_f32_16x16x32_bf16 a[104:107], a[184:187], a[200:203], a[104:107]
s_add_u32 m0, s32, 24576
v_mfma_f32_16x16x32_bf16 a[108:111], a[184:187], a[204:207], a[108:111]
buffer_load_dwordx4 v1, s[12:15], s48 offen lds
s_add_u32 s29, s29, s93
v_mfma_f32_16x16x32_bf16 a[112:115], a[184:187], a[208:211], a[112:115]
v_mfma_f32_16x16x32_bf16 a[116:119], a[184:187], a[212:215], a[116:119]
buffer_store_dwordx4 v[136:139], v13, s[8:11], s29 offen sc1
v_mfma_f32_16x16x32_bf16 a[120:123], a[184:187], a[216:219], a[120:123]
v_mfma_f32_16x16x32_bf16 a[124:127], a[184:187], a[220:223], a[124:127]
ds_read_b64_tr_b16 a[184:185], v11 offset:0
v_mfma_f32_16x16x32_bf16 a[128:131], a[188:191], a[192:195], a[128:131]
ds_read_b64_tr_b16 a[186:187], v11 offset:1024
v_mfma_f32_16x16x32_bf16 a[132:135], a[188:191], a[196:199], a[132:135]
s_add_u32 s48, s48, s34
v_add_u32 v3, 32768, v3
v_subrev_u32 v19, 98304, v3
v_mfma_f32_16x16x32_bf16 a[136:139], a[188:191], a[200:203], a[136:139]
s_add_u32 m0, s32, 28672
v_cmp_le_u32 vcc, 163840, v3
v_add_u32 v5, 16384, v5
v_mfma_f32_16x16x32_bf16 a[140:143], a[188:191], a[204:207], a[140:143]
buffer_load_dwordx4 v1, s[12:15], s48 offen lds
v_and_b32 v5, 65535, v5
v_xor_b32 v6, 16, v5
v_mfma_f32_16x16x32_bf16 a[144:147], a[188:191], a[208:211], a[144:147]
s_add_u32 s30, s30, 128
s_add_u32 s32, s32, 32768
s_sub_u32 s48, s32, 98304
v_mfma_f32_16x16x32_bf16 a[148:151], a[188:191], a[212:215], a[148:151]
s_cmp_ge_u32 s32, 163840
s_cselect_b32 s32, s48, s32
v_xor_b32 v7, 64, v5
v_mfma_f32_16x16x32_bf16 a[152:155], a[188:191], a[216:219], a[152:155]
v_xor_b32 v8, 80, v5
v_xor_b32 v9, 128, v5
v_xor_b32 v10, 144, v5
v_mfma_f32_16x16x32_bf16 a[156:159], a[188:191], a[220:223], a[156:159]
v_xor_b32 v11, 192, v5
v_xor_b32 v12, 208, v5
v_cndmask_b32 v3, v3, v19, vcc
v_xor_b32 v4, 64, v3
s_waitcnt vmcnt(20) lgkmcnt(0)
s_barrier
v_mfma_f32_16x16x32_bf16 v[160:163], a[160:163], a[224:227], v[160:163]
ds_read_b128 a[192:195], v3 offset:0
v_mfma_f32_16x16x32_bf16 v[164:167], a[160:163], a[228:231], v[164:167]
s_add_u32 s37, s31, 0
v_mfma_f32_16x16x32_bf16 v[168:171], a[160:163], a[232:235], v[168:171]
s_add_u32 m0, s33, 0
ds_read_b128 a[196:199], v4 offset:1024
v_mfma_f32_16x16x32_bf16 v[172:175], a[160:163], a[236:239], v[172:175]
buffer_load_dwordx4 v2, s[20:23], s37 offen  lds
s_add_u32 s29, s29, s44
v_mfma_f32_16x16x32_bf16 v[176:179], a[160:163], a[240:243], v[176:179]
ds_read_b128 a[200:203], v3 offset:4096
v_mfma_f32_16x16x32_bf16 v[180:183], a[160:163], a[244:247], v[180:183]
buffer_store_dwordx4 v[140:143], v13, s[8:11], s29 offen sc1
v_mfma_f32_16x16x32_bf16 v[184:187], a[160:163], a[248:251], v[184:187]
ds_read_b128 a[204:207], v4 offset:5120
v_mfma_f32_16x16x32_bf16 v[188:191], a[160:163], a[252:255], v[188:191]
ds_read_b64_tr_b16 a[160:161], v5 offset:0
v_mfma_f32_16x16x32_bf16 v[192:195], a[164:167], a[224:227], v[192:195]
ds_read_b64_tr_b16 a[162:163], v5 offset:1024
ds_read_b128 a[208:211], v3 offset:8192
v_mfma_f32_16x16x32_bf16 v[196:199], a[164:167], a[228:231], v[196:199]
s_add_u32 s37, s31, 32768
v_mfma_f32_16x16x32_bf16 v[200:203], a[164:167], a[232:235], v[200:203]
s_add_u32 m0, s33, 1024
ds_read_b128 a[212:215], v4 offset:9216
v_mfma_f32_16x16x32_bf16 v[204:207], a[164:167], a[236:239], v[204:207]
buffer_load_dwordx4 v2, s[20:23], s37 offen  lds
v_mfma_f32_16x16x32_bf16 v[208:211], a[164:167], a[240:243], v[208:211]
ds_read_b128 a[216:219], v3 offset:12288
v_mfma_f32_16x16x32_bf16 v[212:215], a[164:167], a[244:247], v[212:215]
s_cmp_eq_u32 s2, 0
s_cselect_b64 s[4:5], s[52:53], s[54:55]
v_mfma_f32_16x16x32_bf16 v[216:219], a[164:167], a[248:251], v[216:219]
ds_read_b128 a[220:223], v4 offset:13312
s_mov_b32 s12, s4
v_mfma_f32_16x16x32_bf16 v[220:223], a[164:167], a[252:255], v[220:223]
ds_read_b64_tr_b16 a[164:165], v6 offset:0
s_and_b32 s13, s5, 0xffff
v_mfma_f32_16x16x32_bf16 v[224:227], a[168:171], a[224:227], v[224:227]
ds_read_b64_tr_b16 a[166:167], v6 offset:1024
ds_read_b64_tr_b16 a[188:189], v12 offset:0
v_mfma_f32_16x16x32_bf16 v[228:231], a[168:171], a[228:231], v[228:231]
s_add_u32 s37, s31, 131072
s_lshl_b32 s14, s47, 11
v_mfma_f32_16x16x32_bf16 v[232:235], a[168:171], a[232:235], v[232:235]
s_add_u32 m0, s33, 4096
ds_read_b64_tr_b16 a[190:191], v12 offset:1024
v_mfma_f32_16x16x32_bf16 v[236:239], a[168:171], a[236:239], v[236:239]
buffer_load_dwordx4 v2, s[20:23], s37 offen  lds
s_mov_b32 s15, 0x20000
v_mfma_f32_16x16x32_bf16 v[240:243], a[168:171], a[240:243], v[240:243]
s_mov_b32 s30, s101
v_lshrrev_b32 v16, 3, v0
v_mfma_f32_16x16x32_bf16 v[244:247], a[168:171], a[244:247], v[244:247]
v_mul_lo_u32 v16, v16, s47
v_and_b32 v1, 0x70, v1
v_mfma_f32_16x16x32_bf16 v[248:251], a[168:171], a[248:251], v[248:251]
v_add_u32 v1, v1, v16
s_lshl_b32 s34, s47, 5
v_mfma_f32_16x16x32_bf16 v[252:255], a[168:171], a[252:255], v[252:255]
ds_read_b64_tr_b16 a[168:169], v7 offset:0
v_mfma_f32_16x16x32_bf16 a[0:3], a[172:175], a[224:227], a[0:3]
ds_read_b64_tr_b16 a[170:171], v7 offset:1024
v_mfma_f32_16x16x32_bf16 a[4:7], a[172:175], a[228:231], a[4:7]
s_add_u32 s37, s31, 163840
v_mfma_f32_16x16x32_bf16 a[8:11], a[172:175], a[232:235], a[8:11]
s_add_u32 m0, s33, 5120
v_mfma_f32_16x16x32_bf16 a[12:15], a[172:175], a[236:239], a[12:15]
buffer_load_dwordx4 v2, s[20:23], s37 offen  lds
s_add_u32 s29, s29, s93
v_mfma_f32_16x16x32_bf16 a[16:19], a[172:175], a[240:243], a[16:19]
v_mfma_f32_16x16x32_bf16 a[20:23], a[172:175], a[244:247], a[20:23]
buffer_store_dwordx4 v[144:147], v13, s[8:11], s29 offen sc1
v_mfma_f32_16x16x32_bf16 a[24:27], a[172:175], a[248:251], a[24:27]
v_mfma_f32_16x16x32_bf16 a[28:31], a[172:175], a[252:255], a[28:31]
ds_read_b64_tr_b16 a[172:173], v8 offset:0
v_mfma_f32_16x16x32_bf16 a[32:35], a[176:179], a[224:227], a[32:35]
ds_read_b64_tr_b16 a[174:175], v8 offset:1024
s_add_u32 s31, s31, 262144
v_mfma_f32_16x16x32_bf16 a[36:39], a[176:179], a[228:231], a[36:39]
s_mov_b32 s48, s30
s_add_u32 s33, s33, 16384
v_mfma_f32_16x16x32_bf16 a[40:43], a[176:179], a[232:235], a[40:43]
s_add_u32 m0, s32, 0
s_and_b32 s33, s33, 65535
v_mfma_f32_16x16x32_bf16 a[44:47], a[176:179], a[236:239], a[44:47]
buffer_load_dwordx4 v1, s[12:15], s48 offen lds
v_mfma_f32_16x16x32_bf16 a[48:51], a[176:179], a[240:243], a[48:51]
v_mfma_f32_16x16x32_bf16 a[52:55], a[176:179], a[244:247], a[52:55]
v_mfma_f32_16x16x32_bf16 a[56:59], a[176:179], a[248:251], a[56:59]
v_mfma_f32_16x16x32_bf16 a[60:63], a[176:179], a[252:255], a[60:63]
ds_read_b64_tr_b16 a[176:177], v9 offset:0
v_mfma_f32_16x16x32_bf16 a[64:67], a[180:183], a[224:227], a[64:67]
ds_read_b64_tr_b16 a[178:179], v9 offset:1024
v_mfma_f32_16x16x32_bf16 a[68:71], a[180:183], a[228:231], a[68:71]
s_add_u32 s48, s48, s34
v_mfma_f32_16x16x32_bf16 a[72:75], a[180:183], a[232:235], a[72:75]
s_add_u32 m0, s32, 4096
v_mfma_f32_16x16x32_bf16 a[76:79], a[180:183], a[236:239], a[76:79]
buffer_load_dwordx4 v1, s[12:15], s48 offen lds
v_mfma_f32_16x16x32_bf16 a[80:83], a[180:183], a[240:243], a[80:83]
s_cmp_eq_u32 s2, 0
s_cselect_b64 s[4:5], s[6:7], s[18:19]
s_mov_b32 s20, s4
v_mfma_f32_16x16x32_bf16 a[84:87], a[180:183], a[244:247], a[84:87]
s_and_b32 s21, s5, 0xffff
s_lshl_b32 s22, s47, 12
s_mov_b32 s23, 0x20000
v_mfma_f32_16x16x32_bf16 a[88:91], a[180:183], a[248:251], a[88:91]
buffer_load_dword v15, v14, s[96:99], s100 offen
s_add_u32 s100, s100, 8192
s_mov_b32 s31, s46
v_mfma_f32_16x16x32_bf16 a[92:95], a[180:183], a[252:255], a[92:95]
ds_read_b64_tr_b16 a[180:181], v10 offset:0
v_mfma_f32_16x16x32_bf16 a[96:99], a[184:187], a[224:227], a[96:99]
ds_read_b64_tr_b16 a[182:183], v10 offset:1024
v_mfma_f32_16x16x32_bf16 a[100:103], a[184:187], a[228:231], a[100:103]
s_add_u32 s48, s48, s34
v_mfma_f32_16x16x32_bf16 a[104:107], a[184:187], a[232:235], a[104:107]
s_add_u32 m0, s32, 8192
v_mfma_f32_16x16x32_bf16 a[108:111], a[184:187], a[236:239], a[108:111]
buffer_load_dwordx4 v1, s[12:15], s48 offen lds
s_add_u32 s29, s29, s44
v_mfma_f32_16x16x32_bf16 a[112:115], a[184:187], a[240:243], a[112:115]
v_mfma_f32_16x16x32_bf16 a[116:119], a[184:187], a[244:247], a[116:119]
buffer_store_dwordx4 v[148:151], v13, s[8:11], s29 offen sc1
v_mfma_f32_16x16x32_bf16 a[120:123], a[184:187], a[248:251], a[120:123]
v_mfma_f32_16x16x32_bf16 a[124:127], a[184:187], a[252:255], a[124:127]
ds_read_b64_tr_b16 a[184:185], v11 offset:0
v_mfma_f32_16x16x32_bf16 a[128:131], v[28:31], a[224:227], a[128:131]
ds_read_b64_tr_b16 a[186:187], v11 offset:1024
v_mfma_f32_16x16x32_bf16 a[132:135], v[28:31], a[228:231], a[132:135]
s_add_u32 s48, s48, s34
v_add_u32 v5, 16384, v5
v_and_b32 v5, 65535, v5
v_mfma_f32_16x16x32_bf16 a[136:139], v[28:31], a[232:235], a[136:139]
s_add_u32 m0, s32, 12288
v_xor_b32 v6, 16, v5
v_xor_b32 v7, 64, v5
v_mfma_f32_16x16x32_bf16 a[140:143], v[28:31], a[236:239], a[140:143]
buffer_load_dwordx4 v1, s[12:15], s48 offen lds
v_xor_b32 v8, 80, v5
v_xor_b32 v9, 128, v5
v_mfma_f32_16x16x32_bf16 a[144:147], v[28:31], a[240:243], a[144:147]
v_xor_b32 v10, 144, v5
v_xor_b32 v11, 192, v5
v_xor_b32 v12, 208, v5
v_mfma_f32_16x16x32_bf16 a[148:151], v[28:31], a[244:247], a[148:151]
v_mfma_f32_16x16x32_bf16 a[152:155], v[28:31], a[248:251], a[152:155]
v_mfma_f32_16x16x32_bf16 a[156:159], v[28:31], a[252:255], a[156:159]
s_waitcnt vmcnt(24) lgkmcnt(0)
s_barrier
v_mfma_f32_16x16x32_bf16 v[160:163], a[160:163], a[192:195], v[160:163]
ds_read_b128 a[224:227], v4 offset:0
v_mfma_f32_16x16x32_bf16 v[164:167], a[160:163], a[196:199], v[164:167]
s_add_u32 s37, s31, 0
v_mfma_f32_16x16x32_bf16 v[168:171], a[160:163], a[200:203], v[168:171]
s_add_u32 m0, s33, 0
ds_read_b128 a[228:231], v3 offset:1024
v_mfma_f32_16x16x32_bf16 v[172:175], a[160:163], a[204:207], v[172:175]
buffer_load_dwordx4 v2, s[20:23], s37 offen  lds
s_add_u32 s29, s29, s93
v_mfma_f32_16x16x32_bf16 v[176:179], a[160:163], a[208:211], v[176:179]
ds_read_b128 a[232:235], v4 offset:4096
v_mfma_f32_16x16x32_bf16 v[180:183], a[160:163], a[212:215], v[180:183]
buffer_store_dwordx4 v[152:155], v13, s[8:11], s29 offen sc1
v_mfma_f32_16x16x32_bf16 v[184:187], a[160:163], a[216:219], v[184:187]
ds_read_b128 a[236:239], v3 offset:5120
v_mfma_f32_16x16x32_bf16 v[188:191], a[160:163], a[220:223], v[188:191]
ds_read_b64_tr_b16 a[160:161], v5 offset:0
v_mfma_f32_16x16x32_bf16 v[192:195], a[164:167], a[192:195], v[192:195]
ds_read_b64_tr_b16 a[162:163], v5 offset:1024
ds_read_b128 a[240:243], v4 offset:8192
v_mfma_f32_16x16x32_bf16 v[196:199], a[164:167], a[196:199], v[196:199]
s_add_u32 s37, s31, 32768
v_mfma_f32_16x16x32_bf16 v[200:203], a[164:167], a[200:203], v[200:203]
s_add_u32 m0, s33, 1024
ds_read_b128 a[244:247], v3 offset:9216
v_mfma_f32_16x16x32_bf16 v[204:207], a[164:167], a[204:207], v[204:207]
buffer_load_dwordx4 v2, s[20:23], s37 offen  lds
v_mfma_f32_16x16x32_bf16 v[208:211], a[164:167], a[208:211], v[208:211]
ds_read_b128 a[248:251], v4 offset:12288
v_mfma_f32_16x16x32_bf16 v[212:215], a[164:167], a[212:215], v[212:215]
v_mfma_f32_16x16x32_bf16 v[216:219], a[164:167], a[216:219], v[216:219]
ds_read_b128 a[252:255], v3 offset:13312
v_mfma_f32_16x16x32_bf16 v[220:223], a[164:167], a[220:223], v[220:223]
ds_read_b64_tr_b16 a[164:165], v6 offset:0
v_mfma_f32_16x16x32_bf16 v[224:227], a[168:171], a[192:195], v[224:227]
ds_read_b64_tr_b16 a[166:167], v6 offset:1024
ds_read_b64_tr_b16 v[28:29], v12 offset:0
v_mfma_f32_16x16x32_bf16 v[228:231], a[168:171], a[196:199], v[228:231]
s_add_u32 s37, s31, 131072
v_mfma_f32_16x16x32_bf16 v[232:235], a[168:171], a[200:203], v[232:235]
s_add_u32 m0, s33, 4096
ds_read_b64_tr_b16 v[30:31], v12 offset:1024
v_mfma_f32_16x16x32_bf16 v[236:239], a[168:171], a[204:207], v[236:239]
buffer_load_dwordx4 v2, s[20:23], s37 offen  lds
v_mfma_f32_16x16x32_bf16 v[240:243], a[168:171], a[208:211], v[240:243]
v_mfma_f32_16x16x32_bf16 v[244:247], a[168:171], a[212:215], v[244:247]
v_mfma_f32_16x16x32_bf16 v[248:251], a[168:171], a[216:219], v[248:251]
v_mfma_f32_16x16x32_bf16 v[252:255], a[168:171], a[220:223], v[252:255]
ds_read_b64_tr_b16 a[168:169], v7 offset:0
v_mfma_f32_16x16x32_bf16 a[0:3], a[172:175], a[192:195], a[0:3]
ds_read_b64_tr_b16 a[170:171], v7 offset:1024
v_mfma_f32_16x16x32_bf16 a[4:7], a[172:175], a[196:199], a[4:7]
s_add_u32 s37, s31, 163840
v_mfma_f32_16x16x32_bf16 a[8:11], a[172:175], a[200:203], a[8:11]
s_add_u32 m0, s33, 5120
v_mfma_f32_16x16x32_bf16 a[12:15], a[172:175], a[204:207], a[12:15]
buffer_load_dwordx4 v2, s[20:23], s37 offen  lds
s_add_u32 s29, s29, s44
v_mfma_f32_16x16x32_bf16 a[16:19], a[172:175], a[208:211], a[16:19]
v_mfma_f32_16x16x32_bf16 a[20:23], a[172:175], a[212:215], a[20:23]
buffer_store_dwordx4 v[156:159], v13, s[8:11], s29 offen sc1
v_mfma_f32_16x16x32_bf16 a[24:27], a[172:175], a[216:219], a[24:27]
v_mfma_f32_16x16x32_bf16 a[28:31], a[172:175], a[220:223], a[28:31]
ds_read_b64_tr_b16 a[172:173], v8 offset:0
v_mfma_f32_16x16x32_bf16 a[32:35], a[176:179], a[192:195], a[32:35]
ds_read_b64_tr_b16 a[174:175], v8 offset:1024
s_add_u32 s31, s31, 262144
v_mfma_f32_16x16x32_bf16 a[36:39], a[176:179], a[196:199], a[36:39]
s_add_u32 s48, s48, s34
s_add_u32 s33, s33, 16384
v_mfma_f32_16x16x32_bf16 a[40:43], a[176:179], a[200:203], a[40:43]
s_add_u32 m0, s32, 16384
s_and_b32 s33, s33, 65535
v_mfma_f32_16x16x32_bf16 a[44:47], a[176:179], a[204:207], a[44:47]
buffer_load_dwordx4 v1, s[12:15], s48 offen lds
v_mfma_f32_16x16x32_bf16 a[48:51], a[176:179], a[208:211], a[48:51]
v_mfma_f32_16x16x32_bf16 a[52:55], a[176:179], a[212:215], a[52:55]
v_mfma_f32_16x16x32_bf16 a[56:59], a[176:179], a[216:219], a[56:59]
v_mfma_f32_16x16x32_bf16 a[60:63], a[176:179], a[220:223], a[60:63]
ds_read_b64_tr_b16 a[176:177], v9 offset:0
v_mfma_f32_16x16x32_bf16 a[64:67], a[180:183], a[192:195], a[64:67]
ds_read_b64_tr_b16 a[178:179], v9 offset:1024
v_mfma_f32_16x16x32_bf16 a[68:71], a[180:183], a[196:199], a[68:71]
s_add_u32 s48, s48, s34
v_mfma_f32_16x16x32_bf16 a[72:75], a[180:183], a[200:203], a[72:75]
s_add_u32 m0, s32, 20480
v_mfma_f32_16x16x32_bf16 a[76:79], a[180:183], a[204:207], a[76:79]
buffer_load_dwordx4 v1, s[12:15], s48 offen lds
v_mfma_f32_16x16x32_bf16 a[80:83], a[180:183], a[208:211], a[80:83]
v_mfma_f32_16x16x32_bf16 a[84:87], a[180:183], a[212:215], a[84:87]
v_mfma_f32_16x16x32_bf16 a[88:91], a[180:183], a[216:219], a[88:91]
buffer_load_dword v15, v14, s[96:99], s100 offen
s_add_u32 s100, s100, 8192
v_mfma_f32_16x16x32_bf16 a[92:95], a[180:183], a[220:223], a[92:95]
ds_read_b64_tr_b16 a[180:181], v10 offset:0
v_mfma_f32_16x16x32_bf16 a[96:99], a[184:187], a[192:195], a[96:99]
ds_read_b64_tr_b16 a[182:183], v10 offset:1024
v_mfma_f32_16x16x32_bf16 a[100:103], a[184:187], a[196:199], a[100:103]
s_add_u32 s48, s48, s34
v_mfma_f32_16x16x32_bf16 a[104:107], a[184:187], a[200:203], a[104:107]
s_add_u32 m0, s32, 24576
v_mfma_f32_16x16x32_bf16 a[108:111], a[184:187], a[204:207], a[108:111]
buffer_load_dwordx4 v1, s[12:15], s48 offen lds
v_mfma_f32_16x16x32_bf16 a[112:115], a[184:187], a[208:211], a[112:115]
v_mfma_f32_16x16x32_bf16 a[116:119], a[184:187], a[212:215], a[116:119]
v_mfma_f32_16x16x32_bf16 a[120:123], a[184:187], a[216:219], a[120:123]
v_mfma_f32_16x16x32_bf16 a[124:127], a[184:187], a[220:223], a[124:127]
ds_read_b64_tr_b16 a[184:185], v11 offset:0
v_mfma_f32_16x16x32_bf16 a[128:131], a[188:191], a[192:195], a[128:131]
ds_read_b64_tr_b16 a[186:187], v11 offset:1024
v_mfma_f32_16x16x32_bf16 a[132:135], a[188:191], a[196:199], a[132:135]
s_add_u32 s48, s48, s34
v_add_u32 v3, 32768, v3
v_subrev_u32 v19, 98304, v3
v_mfma_f32_16x16x32_bf16 a[136:139], a[188:191], a[200:203], a[136:139]
s_add_u32 m0, s32, 28672
v_cmp_le_u32 vcc, 163840, v3
v_add_u32 v5, 16384, v5
v_mfma_f32_16x16x32_bf16 a[140:143], a[188:191], a[204:207], a[140:143]
buffer_load_dwordx4 v1, s[12:15], s48 offen lds
v_and_b32 v5, 65535, v5
v_xor_b32 v6, 16, v5
v_mfma_f32_16x16x32_bf16 a[144:147], a[188:191], a[208:211], a[144:147]
s_add_u32 s30, s30, 128
s_add_u32 s32, s32, 32768
s_sub_u32 s48, s32, 98304
v_mfma_f32_16x16x32_bf16 a[148:151], a[188:191], a[212:215], a[148:151]
s_cmp_ge_u32 s32, 163840
s_cselect_b32 s32, s48, s32
v_xor_b32 v7, 64, v5
v_mfma_f32_16x16x32_bf16 a[152:155], a[188:191], a[216:219], a[152:155]
v_xor_b32 v8, 80, v5
v_xor_b32 v9, 128, v5
v_xor_b32 v10, 144, v5
v_mfma_f32_16x16x32_bf16 a[156:159], a[188:191], a[220:223], a[156:159]
v_xor_b32 v11, 192, v5
v_xor_b32 v12, 208, v5
v_cndmask_b32 v3, v3, v19, vcc
v_xor_b32 v4, 64, v3
s_waitcnt vmcnt(23) lgkmcnt(0)
s_barrier
v_mfma_f32_16x16x32_bf16 v[160:163], a[160:163], a[224:227], v[160:163]
ds_read_b128 a[192:195], v3 offset:0
v_mfma_f32_16x16x32_bf16 v[164:167], a[160:163], a[228:231], v[164:167]
s_add_u32 s37, s31, 0
v_mfma_f32_16x16x32_bf16 v[168:171], a[160:163], a[232:235], v[168:171]
s_add_u32 m0, s33, 0
ds_read_b128 a[196:199], v4 offset:1024
v_mfma_f32_16x16x32_bf16 v[172:175], a[160:163], a[236:239], v[172:175]
buffer_load_dwordx4 v2, s[20:23], s37 offen  lds
v_mfma_f32_16x16x32_bf16 v[176:179], a[160:163], a[240:243], v[176:179]
ds_read_b128 a[200:203], v3 offset:4096
v_mfma_f32_16x16x32_bf16 v[180:183], a[160:163], a[244:247], v[180:183]
v_mfma_f32_16x16x32_bf16 v[184:187], a[160:163], a[248:251], v[184:187]
ds_read_b128 a[204:207], v4 offset:5120
v_mfma_f32_16x16x32_bf16 v[188:191], a[160:163], a[252:255], v[188:191]
ds_read_b64_tr_b16 a[160:161], v5 offset:0
v_mfma_f32_16x16x32_bf16 v[192:195], a[164:167], a[224:227], v[192:195]
ds_read_b64_tr_b16 a[162:163], v5 offset:1024
ds_read_b128 a[208:211], v3 offset:8192
v_mfma_f32_16x16x32_bf16 v[196:199], a[164:167], a[228:231], v[196:199]
s_add_u32 s37, s31, 32768
v_mfma_f32_16x16x32_bf16 v[200:203], a[164:167], a[232:235], v[200:203]
s_add_u32 m0, s33, 1024
ds_read_b128 a[212:215], v4 offset:9216
v_mfma_f32_16x16x32_bf16 v[204:207], a[164:167], a[236:239], v[204:207]
buffer_load_dwordx4 v2, s[20:23], s37 offen  lds
v_mfma_f32_16x16x32_bf16 v[208:211], a[164:167], a[240:243], v[208:211]
ds_read_b128 a[216:219], v3 offset:12288
v_mfma_f32_16x16x32_bf16 v[212:215], a[164:167], a[244:247], v[212:215]
v_mfma_f32_16x16x32_bf16 v[216:219], a[164:167], a[248:251], v[216:219]
ds_read_b128 a[220:223], v4 offset:13312
v_mfma_f32_16x16x32_bf16 v[220:223], a[164:167], a[252:255], v[220:223]
ds_read_b64_tr_b16 a[164:165], v6 offset:0
v_mfma_f32_16x16x32_bf16 v[224:227], a[168:171], a[224:227], v[224:227]
ds_read_b64_tr_b16 a[166:167], v6 offset:1024
ds_read_b64_tr_b16 a[188:189], v12 offset:0
v_mfma_f32_16x16x32_bf16 v[228:231], a[168:171], a[228:231], v[228:231]
s_add_u32 s37, s31, 131072
v_mfma_f32_16x16x32_bf16 v[232:235], a[168:171], a[232:235], v[232:235]
s_add_u32 m0, s33, 4096
ds_read_b64_tr_b16 a[190:191], v12 offset:1024
v_mfma_f32_16x16x32_bf16 v[236:239], a[168:171], a[236:239], v[236:239]
buffer_load_dwordx4 v2, s[20:23], s37 offen  lds
v_mfma_f32_16x16x32_bf16 v[240:243], a[168:171], a[240:243], v[240:243]
v_mfma_f32_16x16x32_bf16 v[244:247], a[168:171], a[244:247], v[244:247]
v_mfma_f32_16x16x32_bf16 v[248:251], a[168:171], a[248:251], v[248:251]
v_mfma_f32_16x16x32_bf16 v[252:255], a[168:171], a[252:255], v[252:255]
ds_read_b64_tr_b16 a[168:169], v7 offset:0
v_mfma_f32_16x16x32_bf16 a[0:3], a[172:175], a[224:227], a[0:3]
ds_read_b64_tr_b16 a[170:171], v7 offset:1024
v_mfma_f32_16x16x32_bf16 a[4:7], a[172:175], a[228:231], a[4:7]
s_add_u32 s37, s31, 163840
v_mfma_f32_16x16x32_bf16 a[8:11], a[172:175], a[232:235], a[8:11]
s_add_u32 m0, s33, 5120
v_mfma_f32_16x16x32_bf16 a[12:15], a[172:175], a[236:239], a[12:15]
buffer_load_dwordx4 v2, s[20:23], s37 offen  lds
v_mfma_f32_16x16x32_bf16 a[16:19], a[172:175], a[240:243], a[16:19]
v_mfma_f32_16x16x32_bf16 a[20:23], a[172:175], a[244:247], a[20:23]
v_mfma_f32_16x16x32_bf16 a[24:27], a[172:175], a[248:251], a[24:27]
v_mfma_f32_16x16x32_bf16 a[28:31], a[172:175], a[252:255], a[28:31]
ds_read_b64_tr_b16 a[172:173], v8 offset:0
v_mfma_f32_16x16x32_bf16 a[32:35], a[176:179], a[224:227], a[32:35]
ds_read_b64_tr_b16 a[174:175], v8 offset:1024
s_add_u32 s31, s31, 262144
v_mfma_f32_16x16x32_bf16 a[36:39], a[176:179], a[228:231], a[36:39]
s_mov_b32 s48, s30
s_add_u32 s33, s33, 16384
v_mfma_f32_16x16x32_bf16 a[40:43], a[176:179], a[232:235], a[40:43]
s_add_u32 m0, s32, 0
s_and_b32 s33, s33, 65535
v_mfma_f32_16x16x32_bf16 a[44:47], a[176:179], a[236:239], a[44:47]
buffer_load_dwordx4 v1, s[12:15], s48 offen lds
v_mfma_f32_16x16x32_bf16 a[48:51], a[176:179], a[240:243], a[48:51]
v_mfma_f32_16x16x32_bf16 a[52:55], a[176:179], a[244:247], a[52:55]
v_mfma_f32_16x16x32_bf16 a[56:59], a[176:179], a[248:251], a[56:59]
v_mfma_f32_16x16x32_bf16 a[60:63], a[176:179], a[252:255], a[60:63]
ds_read_b64_tr_b16 a[176:177], v9 offset:0
v_mfma_f32_16x16x32_bf16 a[64:67], a[180:183], a[224:227], a[64:67]
ds_read_b64_tr_b16 a[178:179], v9 offset:1024
v_mfma_f32_16x16x32_bf16 a[68:71], a[180:183], a[228:231], a[68:71]
s_add_u32 s48, s48, s34
v_mfma_f32_16x16x32_bf16 a[72:75], a[180:183], a[232:235], a[72:75]
s_add_u32 m0, s32, 4096
v_mfma_f32_16x16x32_bf16 a[76:79], a[180:183], a[236:239], a[76:79]
buffer_load_dwordx4 v1, s[12:15], s48 offen lds
v_mfma_f32_16x16x32_bf16 a[80:83], a[180:183], a[240:243], a[80:83]
v_mfma_f32_16x16x32_bf16 a[84:87], a[180:183], a[244:247], a[84:87]
v_mfma_f32_16x16x32_bf16 a[88:91], a[180:183], a[248:251], a[88:91]
buffer_load_dword v15, v14, s[96:99], s100 offen
s_add_u32 s100, s100, 8192
v_mfma_f32_16x16x32_bf16 a[92:95], a[180:183], a[252:255], a[92:95]
ds_read_b64_tr_b16 a[180:181], v10 offset:0
v_mfma_f32_16x16x32_bf16 a[96:99], a[184:187], a[224:227], a[96:99]
ds_read_b64_tr_b16 a[182:183], v10 offset:1024
v_mfma_f32_16x16x32_bf16 a[100:103], a[184:187], a[228:231], a[100:103]
s_add_u32 s48, s48, s34
v_mfma_f32_16x16x32_bf16 a[104:107], a[184:187], a[232:235], a[104:107]
s_add_u32 m0, s32, 8192
v_mfma_f32_16x16x32_bf16 a[108:111], a[184:187], a[236:239], a[108:111]
buffer_load_dwordx4 v1, s[12:15], s48 offen lds
v_mfma_f32_16x16x32_bf16 a[112:115], a[184:187], a[240:243], a[112:115]
v_mfma_f32_16x16x32_bf16 a[116:119], a[184:187], a[244:247], a[116:119]
v_mfma_f32_16x16x32_bf16 a[120:123], a[184:187], a[248:251], a[120:123]
v_mfma_f32_16x16x32_bf16 a[124:127], a[184:187], a[252:255], a[124:127]
ds_read_b64_tr_b16 a[184:185], v11 offset:0
v_mfma_f32_16x16x32_bf16 a[128:131], v[28:31], a[224:227], a[128:131]
ds_read_b64_tr_b16 a[186:187], v11 offset:1024
v_mfma_f32_16x16x32_bf16 a[132:135], v[28:31], a[228:231], a[132:135]
s_add_u32 s48, s48, s34
v_add_u32 v5, 16384, v5
v_and_b32 v5, 65535, v5
v_mfma_f32_16x16x32_bf16 a[136:139], v[28:31], a[232:235], a[136:139]
s_add_u32 m0, s32, 12288
v_xor_b32 v6, 16, v5
v_xor_b32 v7, 64, v5
v_mfma_f32_16x16x32_bf16 a[140:143], v[28:31], a[236:239], a[140:143]
buffer_load_dwordx4 v1, s[12:15], s48 offen lds
v_xor_b32 v8, 80, v5
v_xor_b32 v9, 128, v5
v_mfma_f32_16x16x32_bf16 a[144:147], v[28:31], a[240:243], a[144:147]
v_xor_b32 v10, 144, v5
v_xor_b32 v11, 192, v5
v_xor_b32 v12, 208, v5
v_mfma_f32_16x16x32_bf16 a[148:151], v[28:31], a[244:247], a[148:151]
v_mfma_f32_16x16x32_bf16 a[152:155], v[28:31], a[248:251], a[152:155]
v_mfma_f32_16x16x32_bf16 a[156:159], v[28:31], a[252:255], a[156:159]
s_waitcnt vmcnt(20) lgkmcnt(0)
s_barrier
v_mfma_f32_16x16x32_bf16 v[160:163], a[160:163], a[192:195], v[160:163]
ds_read_b128 a[224:227], v4 offset:0
v_mfma_f32_16x16x32_bf16 v[164:167], a[160:163], a[196:199], v[164:167]
s_add_u32 s37, s31, 0
v_mfma_f32_16x16x32_bf16 v[168:171], a[160:163], a[200:203], v[168:171]
s_add_u32 m0, s33, 0
ds_read_b128 a[228:231], v3 offset:1024
v_mfma_f32_16x16x32_bf16 v[172:175], a[160:163], a[204:207], v[172:175]
buffer_load_dwordx4 v2, s[20:23], s37 offen  lds
v_mfma_f32_16x16x32_bf16 v[176:179], a[160:163], a[208:211], v[176:179]
ds_read_b128 a[232:235], v4 offset:4096
v_mfma_f32_16x16x32_bf16 v[180:183], a[160:163], a[212:215], v[180:183]
v_mfma_f32_16x16x32_bf16 v[184:187], a[160:163], a[216:219], v[184:187]
ds_read_b128 a[236:239], v3 offset:5120
v_mfma_f32_16x16x32_bf16 v[188:191], a[160:163], a[220:223], v[188:191]
ds_read_b64_tr_b16 a[160:161], v5 offset:0
v_mfma_f32_16x16x32_bf16 v[192:195], a[164:167], a[192:195], v[192:195]
ds_read_b64_tr_b16 a[162:163], v5 offset:1024
ds_read_b128 a[240:243], v4 offset:8192
v_mfma_f32_16x16x32_bf16 v[196:199], a[164:167], a[196:199], v[196:199]
s_add_u32 s37, s31, 32768
v_mfma_f32_16x16x32_bf16 v[200:203], a[164:167], a[200:203], v[200:203]
s_add_u32 m0, s33, 1024
ds_read_b128 a[244:247], v3 offset:9216
v_mfma_f32_16x16x32_bf16 v[204:207], a[164:167], a[204:207], v[204:207]
buffer_load_dwordx4 v2, s[20:23], s37 offen  lds
v_mfma_f32_16x16x32_bf16 v[208:211], a[164:167], a[208:211], v[208:211]
ds_read_b128 a[248:251], v4 offset:12288
v_mfma_f32_16x16x32_bf16 v[212:215], a[164:167], a[212:215], v[212:215]
v_mfma_f32_16x16x32_bf16 v[216:219], a[164:167], a[216:219], v[216:219]
ds_read_b128 a[252:255], v3 offset:13312
v_mfma_f32_16x16x32_bf16 v[220:223], a[164:167], a[220:223], v[220:223]
ds_read_b64_tr_b16 a[164:165], v6 offset:0
v_mfma_f32_16x16x32_bf16 v[224:227], a[168:171], a[192:195], v[224:227]
ds_read_b64_tr_b16 a[166:167], v6 offset:1024
ds_read_b64_tr_b16 v[28:29], v12 offset:0
v_mfma_f32_16x16x32_bf16 v[228:231], a[168:171], a[196:199], v[228:231]
s_add_u32 s37, s31, 131072
v_mfma_f32_16x16x32_bf16 v[232:235], a[168:171], a[200:203], v[232:235]
s_add_u32 m0, s33, 4096
ds_read_b64_tr_b16 v[30:31], v12 offset:1024
v_mfma_f32_16x16x32_bf16 v[236:239], a[168:171], a[204:207], v[236:239]
buffer_load_dwordx4 v2, s[20:23], s37 offen  lds
v_mfma_f32_16x16x32_bf16 v[240:243], a[168:171], a[208:211], v[240:243]
v_mfma_f32_16x16x32_bf16 v[244:247], a[168:171], a[212:215], v[244:247]
v_mfma_f32_16x16x32_bf16 v[248:251], a[168:171], a[216:219], v[248:251]
v_mfma_f32_16x16x32_bf16 v[252:255], a[168:171], a[220:223], v[252:255]
ds_read_b64_tr_b16 a[168:169], v7 offset:0
v_mfma_f32_16x16x32_bf16 a[0:3], a[172:175], a[192:195], a[0:3]
ds_read_b64_tr_b16 a[170:171], v7 offset:1024
v_mfma_f32_16x16x32_bf16 a[4:7], a[172:175], a[196:199], a[4:7]
s_add_u32 s37, s31, 163840
v_mfma_f32_16x16x32_bf16 a[8:11], a[172:175], a[200:203], a[8:11]
s_add_u32 m0, s33, 5120
v_mfma_f32_16x16x32_bf16 a[12:15], a[172:175], a[204:207], a[12:15]
buffer_load_dwordx4 v2, s[20:23], s37 offen  lds
v_mfma_f32_16x16x32_bf16 a[16:19], a[172:175], a[208:211], a[16:19]
v_mfma_f32_16x16x32_bf16 a[20:23], a[172:175], a[212:215], a[20:23]
v_mfma_f32_16x16x32_bf16 a[24:27], a[172:175], a[216:219], a[24:27]
v_mfma_f32_16x16x32_bf16 a[28:31], a[172:175], a[220:223], a[28:31]
ds_read_b64_tr_b16 a[172:173], v8 offset:0
v_mfma_f32_16x16x32_bf16 a[32:35], a[176:179], a[192:195], a[32:35]
ds_read_b64_tr_b16 a[174:175], v8 offset:1024
s_add_u32 s31, s31, 262144
v_mfma_f32_16x16x32_bf16 a[36:39], a[176:179], a[196:199], a[36:39]
s_add_u32 s48, s48, s34
s_add_u32 s33, s33, 16384
v_mfma_f32_16x16x32_bf16 a[40:43], a[176:179], a[200:203], a[40:43]
s_add_u32 m0, s32, 16384
s_and_b32 s33, s33, 65535
v_mfma_f32_16x16x32_bf16 a[44:47], a[176:179], a[204:207], a[44:47]
buffer_load_dwordx4 v1, s[12:15], s48 offen lds
v_mfma_f32_16x16x32_bf16 a[48:51], a[176:179], a[208:211], a[48:51]
v_mfma_f32_16x16x32_bf16 a[52:55], a[176:179], a[212:215], a[52:55]
v_mfma_f32_16x16x32_bf16 a[56:59], a[176:179], a[216:219], a[56:59]
v_mfma_f32_16x16x32_bf16 a[60:63], a[176:179], a[220:223], a[60:63]
ds_read_b64_tr_b16 a[176:177], v9 offset:0
v_mfma_f32_16x16x32_bf16 a[64:67], a[180:183], a[192:195], a[64:67]
ds_read_b64_tr_b16 a[178:179], v9 offset:1024
v_mfma_f32_16x16x32_bf16 a[68:71], a[180:183], a[196:199], a[68:71]
s_add_u32 s48, s48, s34
v_mfma_f32_16x16x32_bf16 a[72:75], a[180:183], a[200:203], a[72:75]
s_add_u32 m0, s32, 20480
v_mfma_f32_16x16x32_bf16 a[76:79], a[180:183], a[204:207], a[76:79]
buffer_load_dwordx4 v1, s[12:15], s48 offen lds
v_mfma_f32_16x16x32_bf16 a[80:83], a[180:183], a[208:211], a[80:83]
v_mfma_f32_16x16x32_bf16 a[84:87], a[180:183], a[212:215], a[84:87]
v_mfma_f32_16x16x32_bf16 a[88:91], a[180:183], a[216:219], a[88:91]
buffer_load_dword v15, v14, s[96:99], s100 offen
s_add_u32 s100, s100, 8192
v_mfma_f32_16x16x32_bf16 a[92:95], a[180:183], a[220:223], a[92:95]
ds_read_b64_tr_b16 a[180:181], v10 offset:0
v_mfma_f32_16x16x32_bf16 a[96:99], a[184:187], a[192:195], a[96:99]
ds_read_b64_tr_b16 a[182:183], v10 offset:1024
v_mfma_f32_16x16x32_bf16 a[100:103], a[184:187], a[196:199], a[100:103]
s_add_u32 s48, s48, s34
v_mfma_f32_16x16x32_bf16 a[104:107], a[184:187], a[200:203], a[104:107]
s_add_u32 m0, s32, 24576
v_mfma_f32_16x16x32_bf16 a[108:111], a[184:187], a[204:207], a[108:111]
buffer_load_dwordx4 v1, s[12:15], s48 offen lds
v_mfma_f32_16x16x32_bf16 a[112:115], a[184:187], a[208:211], a[112:115]
v_mfma_f32_16x16x32_bf16 a[116:119], a[184:187], a[212:215], a[116:119]
v_mfma_f32_16x16x32_bf16 a[120:123], a[184:187], a[216:219], a[120:123]
v_mfma_f32_16x16x32_bf16 a[124:127], a[184:187], a[220:223], a[124:127]
ds_read_b64_tr_b16 a[184:185], v11 offset:0
v_mfma_f32_16x16x32_bf16 a[128:131], a[188:191], a[192:195], a[128:131]
ds_read_b64_tr_b16 a[186:187], v11 offset:1024
v_mfma_f32_16x16x32_bf16 a[132:135], a[188:191], a[196:199], a[132:135]
s_add_u32 s48, s48, s34
v_add_u32 v3, 32768, v3
v_subrev_u32 v19, 98304, v3
v_mfma_f32_16x16x32_bf16 a[136:139], a[188:191], a[200:203], a[136:139]
s_add_u32 m0, s32, 28672
v_cmp_le_u32 vcc, 163840, v3
v_add_u32 v5, 16384, v5
v_mfma_f32_16x16x32_bf16 a[140:143], a[188:191], a[204:207], a[140:143]
buffer_load_dwordx4 v1, s[12:15], s48 offen lds
v_and_b32 v5, 65535, v5
v_xor_b32 v6, 16, v5
v_mfma_f32_16x16x32_bf16 a[144:147], a[188:191], a[208:211], a[144:147]
s_add_u32 s30, s30, 128
s_add_u32 s32, s32, 32768
s_sub_u32 s48, s32, 98304
v_mfma_f32_16x16x32_bf16 a[148:151], a[188:191], a[212:215], a[148:151]
s_cmp_ge_u32 s32, 163840
s_cselect_b32 s32, s48, s32
v_xor_b32 v7, 64, v5
v_mfma_f32_16x16x32_bf16 a[152:155], a[188:191], a[216:219], a[152:155]
v_xor_b32 v8, 80, v5
v_xor_b32 v9, 128, v5
v_xor_b32 v10, 144, v5
v_mfma_f32_16x16x32_bf16 a[156:159], a[188:191], a[220:223], a[156:159]
v_xor_b32 v11, 192, v5
v_xor_b32 v12, 208, v5
v_cndmask_b32 v3, v3, v19, vcc
v_xor_b32 v4, 64, v3
s_cmp_eq_u32 s41, 0
s_cbranch_scc0 L_g_k17v
s_waitcnt vmcnt(18) lgkmcnt(0)
s_barrier
v_mfma_f32_16x16x32_bf16 v[160:163], a[160:163], a[224:227], v[160:163]
ds_read_b128 a[192:195], v3 offset:0
v_mfma_f32_16x16x32_bf16 v[164:167], a[160:163], a[228:231], v[164:167]
s_add_u32 s37, s31, 0
v_mfma_f32_16x16x32_bf16 v[168:171], a[160:163], a[232:235], v[168:171]
s_add_u32 m0, s33, 0
ds_read_b128 a[196:199], v4 offset:1024
v_mfma_f32_16x16x32_bf16 v[172:175], a[160:163], a[236:239], v[172:175]
buffer_load_dwordx4 v2, s[20:23], s37 offen  lds
v_mfma_f32_16x16x32_bf16 v[176:179], a[160:163], a[240:243], v[176:179]
ds_read_b128 a[200:203], v3 offset:4096
v_cvt_pk_bf16_f32 v32, v160, v161
v_cvt_pk_bf16_f32 v33, v162, v163
v_mfma_f32_16x16x32_bf16 v[180:183], a[160:163], a[244:247], v[180:183]
v_cvt_pk_bf16_f32 v36, v164, v165
v_cvt_pk_bf16_f32 v37, v166, v167
v_mfma_f32_16x16x32_bf16 v[184:187], a[160:163], a[248:251], v[184:187]
ds_read_b128 a[204:207], v4 offset:5120
v_cvt_pk_bf16_f32 v40, v168, v169
v_cvt_pk_bf16_f32 v41, v170, v171
v_mfma_f32_16x16x32_bf16 v[188:191], a[160:163], a[252:255], v[188:191]
ds_read_b64_tr_b16 a[160:161], v5 offset:0
v_cvt_pk_bf16_f32 v44, v172, v173
v_cvt_pk_bf16_f32 v45, v174, v175
v_mfma_f32_16x16x32_bf16 v[192:195], a[164:167], a[224:227], v[192:195]
ds_read_b64_tr_b16 a[162:163], v5 offset:1024
ds_read_b128 a[208:211], v3 offset:8192
v_cvt_pk_bf16_f32 v48, v176, v177
v_cvt_pk_bf16_f32 v49, v178, v179
v_mfma_f32_16x16x32_bf16 v[196:199], a[164:167], a[228:231], v[196:199]
s_add_u32 s37, s31, 32768
v_cvt_pk_bf16_f32 v52, v180, v181
v_cvt_pk_bf16_f32 v53, v182, v183
v_mfma_f32_16x16x32_bf16 v[200:203], a[164:167], a[232:235], v[200:203]
s_add_u32 m0, s33, 1024
ds_read_b128 a[212:215], v4 offset:9216
v_cvt_pk_bf16_f32 v56, v184, v185
v_cvt_pk_bf16_f32 v57, v186, v187
v_mfma_f32_16x16x32_bf16 v[204:207], a[164:167], a[236:239], v[204:207]
buffer_load_dwordx4 v2, s[20:23], s37 offen  lds
v_cvt_pk_bf16_f32 v60, v188, v189
v_cvt_pk_bf16_f32 v61, v190, v191
v_mfma_f32_16x16x32_bf16 v[208:211], a[164:167], a[240:243], v[208:211]
ds_read_b128 a[216:219], v3 offset:12288
v_cvt_pk_bf16_f32 v34, v192, v193
v_cvt_pk_bf16_f32 v35, v194, v195
v_mfma_f32_16x16x32_bf16 v[212:215], a[164:167], a[244:247], v[212:215]
v_cvt_pk_bf16_f32 v38, v196, v197
v_cvt_pk_bf16_f32 v39, v198, v199
v_mfma_f32_16x16x32_bf16 v[216:219], a[164:167], a[248:251], v[216:219]
ds_read_b128 a[220:223], v4 offset:13312
v_cvt_pk_bf16_f32 v42, v200, v201
v_cvt_pk_bf16_f32 v43, v202, v203
v_mfma_f32_16x16x32_bf16 v[220:223], a[164:167], a[252:255], v[220:223]
ds_read_b64_tr_b16 a[164:165], v6 offset:0
v_cvt_pk_bf16_f32 v46, v204, v205
v_cvt_pk_bf16_f32 v47, v206, v207
v_mfma_f32_16x16x32_bf16 v[224:227], a[168:171], a[224:227], v[224:227]
ds_read_b64_tr_b16 a[166:167], v6 offset:1024
ds_read_b64_tr_b16 a[188:189], v12 offset:0
v_cvt_pk_bf16_f32 v50, v208, v209
v_cvt_pk_bf16_f32 v51, v210, v211
v_mfma_f32_16x16x32_bf16 v[228:231], a[168:171], a[228:231], v[228:231]
s_add_u32 s37, s31, 131072
v_cvt_pk_bf16_f32 v54, v212, v213
v_cvt_pk_bf16_f32 v55, v214, v215
v_mfma_f32_16x16x32_bf16 v[232:235], a[168:171], a[232:235], v[232:235]
s_add_u32 m0, s33, 4096
ds_read_b64_tr_b16 a[190:191], v12 offset:1024
v_cvt_pk_bf16_f32 v58, v216, v217
v_cvt_pk_bf16_f32 v59, v218, v219
v_mfma_f32_16x16x32_bf16 v[236:239], a[168:171], a[236:239], v[236:239]
buffer_load_dwordx4 v2, s[20:23], s37 offen  lds
v_cvt_pk_bf16_f32 v62, v220, v221
v_cvt_pk_bf16_f32 v63, v222, v223
v_mfma_f32_16x16x32_bf16 v[240:243], a[168:171], a[240:243], v[240:243]
v_cvt_pk_bf16_f32 v64, v224, v225
v_cvt_pk_bf16_f32 v65, v226, v227
v_mfma_f32_16x16x32_bf16 v[244:247], a[168:171], a[244:247], v[244:247]
v_cvt_pk_bf16_f32 v68, v228, v229
v_cvt_pk_bf16_f32 v69, v230, v231
v_mfma_f32_16x16x32_bf16 v[248:251], a[168:171], a[248:251], v[248:251]
v_cvt_pk_bf16_f32 v72, v232, v233
v_cvt_pk_bf16_f32 v73, v234, v235
v_mfma_f32_16x16x32_bf16 v[252:255], a[168:171], a[252:255], v[252:255]
ds_read_b64_tr_b16 a[168:169], v7 offset:0
v_cvt_pk_bf16_f32 v76, v236, v237
v_cvt_pk_bf16_f32 v77, v238, v239
v_mfma_f32_16x16x32_bf16 a[0:3], a[172:175], a[224:227], a[0:3]
ds_read_b64_tr_b16 a[170:171], v7 offset:1024
v_cvt_pk_bf16_f32 v80, v240, v241
v_cvt_pk_bf16_f32 v81, v242, v243
v_mfma_f32_16x16x32_bf16 a[4:7], a[172:175], a[228:231], a[4:7]
s_add_u32 s37, s31, 163840
v_cvt_pk_bf16_f32 v84, v244, v245
v_cvt_pk_bf16_f32 v85, v246, v247
v_mfma_f32_16x16x32_bf16 a[8:11], a[172:175], a[232:235], a[8:11]
s_add_u32 m0, s33, 5120
v_cvt_pk_bf16_f32 v88, v248, v249
v_cvt_pk_bf16_f32 v89, v250, v251
v_mfma_f32_16x16x32_bf16 a[12:15], a[172:175], a[236:239], a[12:15]
buffer_load_dwordx4 v2, s[20:23], s37 offen  lds
v_cvt_pk_bf16_f32 v92, v252, v253
v_cvt_pk_bf16_f32 v93, v254, v255
v_mfma_f32_16x16x32_bf16 a[16:19], a[172:175], a[240:243], a[16:19]
v_accvgpr_read_b32 v20, a0
v_accvgpr_read_b32 v21, a1
v_accvgpr_read_b32 v22, a2
v_accvgpr_read_b32 v23, a3
v_mfma_f32_16x16x32_bf16 a[20:23], a[172:175], a[244:247], a[20:23]
v_cvt_pk_bf16_f32 v66, v20, v21
v_cvt_pk_bf16_f32 v67, v22, v23
v_accvgpr_read_b32 v24, a4
v_accvgpr_read_b32 v25, a5
v_mfma_f32_16x16x32_bf16 a[24:27], a[172:175], a[248:251], a[24:27]
v_accvgpr_read_b32 v26, a6
v_accvgpr_read_b32 v27, a7
v_cvt_pk_bf16_f32 v70, v24, v25
v_cvt_pk_bf16_f32 v71, v26, v27
v_mfma_f32_16x16x32_bf16 a[28:31], a[172:175], a[252:255], a[28:31]
ds_read_b64_tr_b16 a[172:173], v8 offset:0
v_accvgpr_read_b32 v20, a8
v_accvgpr_read_b32 v21, a9
v_accvgpr_read_b32 v22, a10
v_mfma_f32_16x16x32_bf16 a[32:35], a[176:179], a[224:227], a[32:35]
ds_read_b64_tr_b16 a[174:175], v8 offset:1024
s_add_u32 s31, s31, 262144
v_accvgpr_read_b32 v23, a11
v_cvt_pk_bf16_f32 v74, v20, v21
v_mfma_f32_16x16x32_bf16 a[36:39], a[176:179], a[228:231], a[36:39]
s_mov_b32 s48, s30
s_add_u32 s33, s33, 16384
v_cvt_pk_bf16_f32 v75, v22, v23
v_accvgpr_read_b32 v24, a12
v_mfma_f32_16x16x32_bf16 a[40:43], a[176:179], a[232:235], a[40:43]
s_add_u32 m0, s32, 0
s_and_b32 s33, s33, 65535
v_accvgpr_read_b32 v25, a13
v_accvgpr_read_b32 v26, a14
v_mfma_f32_16x16x32_bf16 a[44:47], a[176:179], a[236:239], a[44:47]
buffer_load_dwordx4 v1, s[12:15], s48 offen lds
v_mov_b32 v16, 0
v_accvgpr_read_b32 v27, a15
v_cvt_pk_bf16_f32 v78, v24, v25
v_mfma_f32_16x16x32_bf16 a[48:51], a[176:179], a[240:243], a[48:51]
v_mov_b32 v17, 1
v_cvt_pk_bf16_f32 v79, v26, v27
v_accvgpr_read_b32 v20, a16
v_accvgpr_read_b32 v21, a17
v_mfma_f32_16x16x32_bf16 a[52:55], a[176:179], a[244:247], a[52:55]
s_cmp_eq_u32 s17, 0
s_cselect_b32 s29, s39, 536870912
v_accvgpr_read_b32 v22, a18
v_accvgpr_read_b32 v23, a19
v_mfma_f32_16x16x32_bf16 a[56:59], a[176:179], a[248:251], a[56:59]
s_mov_b64 exec, 1
buffer_store_dword v17, v16, s[8:11], s29 offen sc1
s_mov_b64 exec, -1
v_cvt_pk_bf16_f32 v82, v20, v21
v_mfma_f32_16x16x32_bf16 a[60:63], a[176:179], a[252:255], a[60:63]
ds_read_b64_tr_b16 a[176:177], v9 offset:0
v_cvt_pk_bf16_f32 v83, v22, v23
v_accvgpr_read_b32 v24, a20
v_accvgpr_read_b32 v25, a21
v_mfma_f32_16x16x32_bf16 a[64:67], a[180:183], a[224:227], a[64:67]
ds_read_b64_tr_b16 a[178:179], v9 offset:1024
v_accvgpr_read_b32 v26, a22
v_accvgpr_read_b32 v27, a23
v_cvt_pk_bf16_f32 v86, v24, v25
v_mfma_f32_16x16x32_bf16 a[68:71], a[180:183], a[228:231], a[68:71]
s_add_u32 s48, s48, s34
v_cvt_pk_bf16_f32 v87, v26, v27
v_accvgpr_read_b32 v20, a24
v_accvgpr_read_b32 v21, a25
v_mfma_f32_16x16x32_bf16 a[72:75], a[180:183], a[232:235], a[72:75]
s_add_u32 m0, s32, 4096
v_accvgpr_read_b32 v22, a26
v_accvgpr_read_b32 v23, a27
v_cvt_pk_bf16_f32 v90, v20, v21
v_mfma_f32_16x16x32_bf16 a[76:79], a[180:183], a[236:239], a[76:79]
buffer_load_dwordx4 v1, s[12:15], s48 offen lds
v_cvt_pk_bf16_f32 v91, v22, v23
v_accvgpr_read_b32 v24, a28
v_accvgpr_read_b32 v25, a29
v_mfma_f32_16x16x32_bf16 a[80:83], a[180:183], a[240:243], a[80:83]
v_accvgpr_read_b32 v26, a30
v_accvgpr_read_b32 v27, a31
v_cvt_pk_bf16_f32 v94, v24, v25
v_cvt_pk_bf16_f32 v95, v26, v27
v_mfma_f32_16x16x32_bf16 a[84:87], a[180:183], a[244:247], a[84:87]
v_accvgpr_read_b32 v20, a32
v_accvgpr_read_b32 v21, a33
v_accvgpr_read_b32 v22, a34
v_accvgpr_read_b32 v23, a35
v_mfma_f32_16x16x32_bf16 a[88:91], a[180:183], a[248:251], a[88:91]
buffer_load_dword v15, v14, s[96:99], s100 offen
s_add_u32 s100, s100, 8192
v_cvt_pk_bf16_f32 v96, v20, v21
v_cvt_pk_bf16_f32 v97, v22, v23
v_mfma_f32_16x16x32_bf16 a[92:95], a[180:183], a[252:255], a[92:95]
ds_read_b64_tr_b16 a[180:181], v10 offset:0
v_accvgpr_read_b32 v24, a36
v_accvgpr_read_b32 v25, a37
v_accvgpr_read_b32 v26, a38
v_mfma_f32_16x16x32_bf16 a[96:99], a[184:187], a[224:227], a[96:99]
ds_read_b64_tr_b16 a[182:183], v10 offset:1024
v_accvgpr_read_b32 v27, a39
v_cvt_pk_bf16_f32 v100, v24, v25
v_cvt_pk_bf16_f32 v101, v26, v27
v_mfma_f32_16x16x32_bf16 a[100:103], a[184:187], a[228:231], a[100:103]
s_add_u32 s48, s48, s34
v_accvgpr_read_b32 v20, a40
v_accvgpr_read_b32 v21, a41
v_accvgpr_read_b32 v22, a42
v_mfma_f32_16x16x32_bf16 a[104:107], a[184:187], a[232:235], a[104:107]
s_add_u32 m0, s32, 8192
v_accvgpr_read_b32 v23, a43
v_cvt_pk_bf16_f32 v104, v20, v21
v_cvt_pk_bf16_f32 v105, v22, v23
v_mfma_f32_16x16x32_bf16 a[108:111], a[184:187], a[236:239], a[108:111]
buffer_load_dwordx4 v1, s[12:15], s48 offen lds
v_accvgpr_read_b32 v24, a44
v_accvgpr_read_b32 v25, a45
v_accvgpr_read_b32 v26, a46
v_mfma_f32_16x16x32_bf16 a[112:115], a[184:187], a[240:243], a[112:115]
v_accvgpr_read_b32 v27, a47
v_cvt_pk_bf16_f32 v108, v24, v25
v_cvt_pk_bf16_f32 v109, v26, v27
v_accvgpr_read_b32 v20, a48
v_mfma_f32_16x16x32_bf16 a[116:119], a[184:187], a[244:247], a[116:119]
v_accvgpr_read_b32 v21, a49
v_accvgpr_read_b32 v22, a50
v_accvgpr_read_b32 v23, a51
v_cvt_pk_bf16_f32 v112, v20, v21
v_mfma_f32_16x16x32_bf16 a[120:123], a[184:187], a[248:251], a[120:123]
v_cvt_pk_bf16_f32 v113, v22, v23
v_accvgpr_read_b32 v24, a52
v_accvgpr_read_b32 v25, a53
v_accvgpr_read_b32 v26, a54
v_mfma_f32_16x16x32_bf16 a[124:127], a[184:187], a[252:255], a[124:127]
ds_read_b64_tr_b16 a[184:185], v11 offset:0
v_accvgpr_read_b32 v27, a55
v_cvt_pk_bf16_f32 v116, v24, v25
v_cvt_pk_bf16_f32 v117, v26, v27
v_mfma_f32_16x16x32_bf16 a[128:131], v[28:31], a[224:227], a[128:131]
ds_read_b64_tr_b16 a[186:187], v11 offset:1024
v_accvgpr_read_b32 v20, a56
v_accvgpr_read_b32 v21, a57
v_accvgpr_read_b32 v22, a58
v_mfma_f32_16x16x32_bf16 a[132:135], v[28:31], a[228:231], a[132:135]
s_add_u32 s48, s48, s34
v_add_u32 v5, 16384, v5
v_and_b32 v5, 65535, v5
v_accvgpr_read_b32 v23, a59
v_mfma_f32_16x16x32_bf16 a[136:139], v[28:31], a[232:235], a[136:139]
s_add_u32 m0, s32, 12288
v_xor_b32 v6, 16, v5
v_xor_b32 v7, 64, v5
v_cvt_pk_bf16_f32 v120, v20, v21
v_mfma_f32_16x16x32_bf16 a[140:143], v[28:31], a[236:239], a[140:143]
buffer_load_dwordx4 v1, s[12:15], s48 offen lds
v_xor_b32 v8, 80, v5
v_xor_b32 v9, 128, v5
v_cvt_pk_bf16_f32 v121, v22, v23
v_mfma_f32_16x16x32_bf16 a[144:147], v[28:31], a[240:243], a[144:147]
v_xor_b32 v10, 144, v5
v_xor_b32 v11, 192, v5
v_xor_b32 v12, 208, v5
v_accvgpr_read_b32 v24, a60
v_mfma_f32_16x16x32_bf16 a[148:151], v[28:31], a[244:247], a[148:151]
v_accvgpr_read_b32 v25, a61
v_accvgpr_read_b32 v26, a62
v_accvgpr_read_b32 v27, a63
v_cvt_pk_bf16_f32 v124, v24, v25
v_mfma_f32_16x16x32_bf16 a[152:155], v[28:31], a[248:251], a[152:155]
v_cvt_pk_bf16_f32 v125, v26, v27
v_mfma_f32_16x16x32_bf16 a[156:159], v[28:31], a[252:255], a[156:159]
s_cmp_lt_u32 s35, s45
s_cbranch_scc1 L_g_tile
s_branch L_g_end
L_g_k17v:
s_waitcnt vmcnt(18) lgkmcnt(0)
s_barrier
v_mfma_f32_16x16x32_bf16 v[160:163], a[160:163], a[224:227], v[160:163]
ds_read_b64_tr_b16 a[192:193], v5 offset:0
v_mfma_f32_16x16x32_bf16 v[164:167], a[160:163], a[228:231], v[164:167]
s_add_u32 s37, s31, 0
v_mfma_f32_16x16x32_bf16 v[168:171], a[160:163], a[232:235], v[168:171]
s_add_u32 m0, s33, 0
ds_read_b64_tr_b16 a[194:195], v5 offset:1024
v_mfma_f32_16x16x32_bf16 v[172:175], a[160:163], a[236:239], v[172:175]
buffer_load_dwordx4 v2, s[20:23], s37 offen  lds
v_mfma_f32_16x16x32_bf16 v[176:179], a[160:163], a[240:243], v[176:179]
ds_read_b64_tr_b16 a[196:197], v6 offset:0
v_cvt_pk_bf16_f32 v32, v160, v161
v_cvt_pk_bf16_f32 v33, v162, v163
v_mfma_f32_16x16x32_bf16 v[180:183], a[160:163], a[244:247], v[180:183]
v_cvt_pk_bf16_f32 v36, v164, v165
v_cvt_pk_bf16_f32 v37, v166, v167
v_mfma_f32_16x16x32_bf16 v[184:187], a[160:163], a[248:251], v[184:187]
ds_read_b64_tr_b16 a[198:199], v6 offset:1024
v_cvt_pk_bf16_f32 v40, v168, v169
v_cvt_pk_bf16_f32 v41, v170, v171
v_mfma_f32_16x16x32_bf16 v[188:191], a[160:163], a[252:255], v[188:191]
ds_read_b128 a[160:163], v3 offset:0
v_cvt_pk_bf16_f32 v44, v172, v173
v_cvt_pk_bf16_f32 v45, v174, v175
v_mfma_f32_16x16x32_bf16 v[192:195], a[164:167], a[224:227], v[192:195]
ds_read_b64_tr_b16 a[200:201], v7 offset:0
v_cvt_pk_bf16_f32 v48, v176, v177
v_cvt_pk_bf16_f32 v49, v178, v179
v_mfma_f32_16x16x32_bf16 v[196:199], a[164:167], a[228:231], v[196:199]
s_add_u32 s37, s31, 32768
v_cvt_pk_bf16_f32 v52, v180, v181
v_cvt_pk_bf16_f32 v53, v182, v183
v_mfma_f32_16x16x32_bf16 v[200:203], a[164:167], a[232:235], v[200:203]
s_add_u32 m0, s33, 1024
ds_read_b64_tr_b16 a[202:203], v7 offset:1024
v_cvt_pk_bf16_f32 v56, v184, v185
v_cvt_pk_bf16_f32 v57, v186, v187
v_mfma_f32_16x16x32_bf16 v[204:207], a[164:167], a[236:239], v[204:207]
buffer_load_dwordx4 v2, s[20:23], s37 offen  lds
v_cvt_pk_bf16_f32 v60, v188, v189
v_cvt_pk_bf16_f32 v61, v190, v191
v_mfma_f32_16x16x32_bf16 v[208:211], a[164:167], a[240:243], v[208:211]
ds_read_b64_tr_b16 a[204:205], v8 offset:0
v_cvt_pk_bf16_f32 v34, v192, v193
v_cvt_pk_bf16_f32 v35, v194, v195
v_mfma_f32_16x16x32_bf16 v[212:215], a[164:167], a[244:247], v[212:215]
v_cvt_pk_bf16_f32 v38, v196, v197
v_cvt_pk_bf16_f32 v39, v198, v199
v_mfma_f32_16x16x32_bf16 v[216:219], a[164:167], a[248:251], v[216:219]
ds_read_b64_tr_b16 a[206:207], v8 offset:1024
v_cvt_pk_bf16_f32 v42, v200, v201
v_cvt_pk_bf16_f32 v43, v202, v203
v_mfma_f32_16x16x32_bf16 v[220:223], a[164:167], a[252:255], v[220:223]
ds_read_b128 a[164:167], v4 offset:1024
v_cvt_pk_bf16_f32 v46, v204, v205
v_cvt_pk_bf16_f32 v47, v206, v207
v_mfma_f32_16x16x32_bf16 v[224:227], a[168:171], a[224:227], v[224:227]
ds_read_b64_tr_b16 a[208:209], v9 offset:0
v_cvt_pk_bf16_f32 v50, v208, v209
v_cvt_pk_bf16_f32 v51, v210, v211
v_mfma_f32_16x16x32_bf16 v[228:231], a[168:171], a[228:231], v[228:231]
s_add_u32 s37, s31, 131072
v_cvt_pk_bf16_f32 v54, v212, v213
v_cvt_pk_bf16_f32 v55, v214, v215
v_mfma_f32_16x16x32_bf16 v[232:235], a[168:171], a[232:235], v[232:235]
s_add_u32 m0, s33, 4096
ds_read_b64_tr_b16 a[210:211], v9 offset:1024
v_cvt_pk_bf16_f32 v58, v216, v217
v_cvt_pk_bf16_f32 v59, v218, v219
v_mfma_f32_16x16x32_bf16 v[236:239], a[168:171], a[236:239], v[236:239]
buffer_load_dwordx4 v2, s[20:23], s37 offen  lds
v_cvt_pk_bf16_f32 v62, v220, v221
v_cvt_pk_bf16_f32 v63, v222, v223
v_mfma_f32_16x16x32_bf16 v[240:243], a[168:171], a[240:243], v[240:243]
ds_read_b64_tr_b16 a[212:213], v10 offset:0
v_cvt_pk_bf16_f32 v64, v224, v225
v_cvt_pk_bf16_f32 v65, v226, v227
v_mfma_f32_16x16x32_bf16 v[244:247], a[168:171], a[244:247], v[244:247]
v_cvt_pk_bf16_f32 v68, v228, v229
v_cvt_pk_bf16_f32 v69, v230, v231
v_mfma_f32_16x16x32_bf16 v[248:251], a[168:171], a[248:251], v[248:251]
ds_read_b64_tr_b16 a[214:215], v10 offset:1024
v_cvt_pk_bf16_f32 v72, v232, v233
v_cvt_pk_bf16_f32 v73, v234, v235
v_mfma_f32_16x16x32_bf16 v[252:255], a[168:171], a[252:255], v[252:255]
ds_read_b128 a[168:171], v3 offset:4096
v_cvt_pk_bf16_f32 v76, v236, v237
v_cvt_pk_bf16_f32 v77, v238, v239
v_mfma_f32_16x16x32_bf16 a[0:3], a[172:175], a[224:227], a[0:3]
ds_read_b64_tr_b16 a[216:217], v11 offset:0
v_cvt_pk_bf16_f32 v80, v240, v241
v_cvt_pk_bf16_f32 v81, v242, v243
v_mfma_f32_16x16x32_bf16 a[4:7], a[172:175], a[228:231], a[4:7]
s_add_u32 s37, s31, 163840
v_cvt_pk_bf16_f32 v84, v244, v245
v_cvt_pk_bf16_f32 v85, v246, v247
v_mfma_f32_16x16x32_bf16 a[8:11], a[172:175], a[232:235], a[8:11]
s_add_u32 m0, s33, 5120
ds_read_b64_tr_b16 a[218:219], v11 offset:1024
v_cvt_pk_bf16_f32 v88, v248, v249
v_cvt_pk_bf16_f32 v89, v250, v251
v_mfma_f32_16x16x32_bf16 a[12:15], a[172:175], a[236:239], a[12:15]
buffer_load_dwordx4 v2, s[20:23], s37 offen  lds
v_cvt_pk_bf16_f32 v92, v252, v253
v_cvt_pk_bf16_f32 v93, v254, v255
v_mfma_f32_16x16x32_bf16 a[16:19], a[172:175], a[240:243], a[16:19]
ds_read_b64_tr_b16 a[220:221], v12 offset:0
v_accvgpr_read_b32 v20, a0
v_accvgpr_read_b32 v21, a1
v_accvgpr_read_b32 v22, a2
v_mfma_f32_16x16x32_bf16 a[20:23], a[172:175], a[244:247], a[20:23]
v_accvgpr_read_b32 v23, a3
v_cvt_pk_bf16_f32 v66, v20, v21
v_cvt_pk_bf16_f32 v67, v22, v23
v_accvgpr_read_b32 v24, a4
v_mfma_f32_16x16x32_bf16 a[24:27], a[172:175], a[248:251], a[24:27]
ds_read_b64_tr_b16 a[222:223], v12 offset:1024
v_accvgpr_read_b32 v25, a5
v_accvgpr_read_b32 v26, a6
v_accvgpr_read_b32 v27, a7
v_mfma_f32_16x16x32_bf16 a[28:31], a[172:175], a[252:255], a[28:31]
ds_read_b128 a[172:175], v4 offset:5120
v_cvt_pk_bf16_f32 v70, v24, v25
v_cvt_pk_bf16_f32 v71, v26, v27
v_accvgpr_read_b32 v20, a8
v_mfma_f32_16x16x32_bf16 a[32:35], a[176:179], a[224:227], a[32:35]
s_add_u32 s31, s31, 262144
s_add_u32 s33, s33, 16384
v_accvgpr_read_b32 v21, a9
v_accvgpr_read_b32 v22, a10
v_mfma_f32_16x16x32_bf16 a[36:39], a[176:179], a[228:231], a[36:39]
s_mov_b32 s48, s30
s_and_b32 s33, s33, 65535
v_accvgpr_read_b32 v23, a11
v_cvt_pk_bf16_f32 v74, v20, v21
v_mfma_f32_16x16x32_bf16 a[40:43], a[176:179], a[232:235], a[40:43]
s_add_u32 m0, s32, 0
ds_read_b128 a[188:191], v4 offset:13312
v_cvt_pk_bf16_f32 v75, v22, v23
v_accvgpr_read_b32 v24, a12
v_mfma_f32_16x16x32_bf16 a[44:47], a[176:179], a[236:239], a[44:47]
buffer_load_dwordx4 v1, s[12:15], s48 offen lds
v_mov_b32 v16, 0
v_accvgpr_read_b32 v25, a13
v_accvgpr_read_b32 v26, a14
v_mfma_f32_16x16x32_bf16 a[48:51], a[176:179], a[240:243], a[48:51]
v_mov_b32 v17, 1
v_accvgpr_read_b32 v27, a15
v_cvt_pk_bf16_f32 v78, v24, v25
v_cvt_pk_bf16_f32 v79, v26, v27
v_mfma_f32_16x16x32_bf16 a[52:55], a[176:179], a[244:247], a[52:55]
s_cmp_eq_u32 s17, 0
s_cselect_b32 s29, s39, 536870912
v_accvgpr_read_b32 v20, a16
v_accvgpr_read_b32 v21, a17
v_mfma_f32_16x16x32_bf16 a[56:59], a[176:179], a[248:251], a[56:59]
s_mov_b64 exec, 1
buffer_store_dword v17, v16, s[8:11], s29 offen sc1
s_mov_b64 exec, -1
v_accvgpr_read_b32 v22, a18
v_mfma_f32_16x16x32_bf16 a[60:63], a[176:179], a[252:255], a[60:63]
ds_read_b128 a[176:179], v3 offset:8192
v_accvgpr_read_b32 v23, a19
v_cvt_pk_bf16_f32 v82, v20, v21
v_cvt_pk_bf16_f32 v83, v22, v23
v_mfma_f32_16x16x32_bf16 a[64:67], a[180:183], a[224:227], a[64:67]
v_accvgpr_read_b32 v24, a20
v_accvgpr_read_b32 v25, a21
v_accvgpr_read_b32 v26, a22
v_accvgpr_read_b32 v27, a23
v_mfma_f32_16x16x32_bf16 a[68:71], a[180:183], a[228:231], a[68:71]
s_add_u32 s48, s48, s34
v_cvt_pk_bf16_f32 v86, v24, v25
v_cvt_pk_bf16_f32 v87, v26, v27
v_accvgpr_read_b32 v20, a24
v_mfma_f32_16x16x32_bf16 a[72:75], a[180:183], a[232:235], a[72:75]
s_add_u32 m0, s32, 4096
v_accvgpr_read_b32 v21, a25
v_accvgpr_read_b32 v22, a26
v_accvgpr_read_b32 v23, a27
v_mfma_f32_16x16x32_bf16 a[76:79], a[180:183], a[236:239], a[76:79]
buffer_load_dwordx4 v1, s[12:15], s48 offen lds
v_cvt_pk_bf16_f32 v90, v20, v21
v_cvt_pk_bf16_f32 v91, v22, v23
v_accvgpr_read_b32 v24, a28
v_mfma_f32_16x16x32_bf16 a[80:83], a[180:183], a[240:243], a[80:83]
v_accvgpr_read_b32 v25, a29
v_accvgpr_read_b32 v26, a30
v_accvgpr_read_b32 v27, a31
v_cvt_pk_bf16_f32 v94, v24, v25
v_mfma_f32_16x16x32_bf16 a[84:87], a[180:183], a[244:247], a[84:87]
v_cvt_pk_bf16_f32 v95, v26, v27
v_accvgpr_read_b32 v20, a32
v_accvgpr_read_b32 v21, a33
v_accvgpr_read_b32 v22, a34
v_mfma_f32_16x16x32_bf16 a[88:91], a[180:183], a[248:251], a[88:91]
buffer_load_dword v15, v14, s[96:99], s100 offen
s_add_u32 s100, s100, 8192
v_accvgpr_read_b32 v23, a35
v_cvt_pk_bf16_f32 v96, v20, v21
v_mfma_f32_16x16x32_bf16 a[92:95], a[180:183], a[252:255], a[92:95]
ds_read_b128 a[180:183], v4 offset:9216
v_cvt_pk_bf16_f32 v97, v22, v23
v_accvgpr_read_b32 v24, a36
v_accvgpr_read_b32 v25, a37
v_mfma_f32_16x16x32_bf16 a[96:99], a[184:187], a[224:227], a[96:99]
v_accvgpr_read_b32 v26, a38
v_accvgpr_read_b32 v27, a39
v_cvt_pk_bf16_f32 v100, v24, v25
v_cvt_pk_bf16_f32 v101, v26, v27
v_mfma_f32_16x16x32_bf16 a[100:103], a[184:187], a[228:231], a[100:103]
s_add_u32 s48, s48, s34
v_accvgpr_read_b32 v20, a40
v_accvgpr_read_b32 v21, a41
v_accvgpr_read_b32 v22, a42
v_mfma_f32_16x16x32_bf16 a[104:107], a[184:187], a[232:235], a[104:107]
s_add_u32 m0, s32, 8192
v_accvgpr_read_b32 v23, a43
v_cvt_pk_bf16_f32 v104, v20, v21
v_cvt_pk_bf16_f32 v105, v22, v23
v_mfma_f32_16x16x32_bf16 a[108:111], a[184:187], a[236:239], a[108:111]
buffer_load_dwordx4 v1, s[12:15], s48 offen lds
v_accvgpr_read_b32 v24, a44
v_accvgpr_read_b32 v25, a45
v_accvgpr_read_b32 v26, a46
v_mfma_f32_16x16x32_bf16 a[112:115], a[184:187], a[240:243], a[112:115]
v_accvgpr_read_b32 v27, a47
v_cvt_pk_bf16_f32 v108, v24, v25
v_cvt_pk_bf16_f32 v109, v26, v27
v_accvgpr_read_b32 v20, a48
v_mfma_f32_16x16x32_bf16 a[116:119], a[184:187], a[244:247], a[116:119]
v_accvgpr_read_b32 v21, a49
v_accvgpr_read_b32 v22, a50
v_accvgpr_read_b32 v23, a51
v_cvt_pk_bf16_f32 v112, v20, v21
v_mfma_f32_16x16x32_bf16 a[120:123], a[184:187], a[248:251], a[120:123]
v_cvt_pk_bf16_f32 v113, v22, v23
v_accvgpr_read_b32 v24, a52
v_accvgpr_read_b32 v25, a53
v_accvgpr_read_b32 v26, a54
v_mfma_f32_16x16x32_bf16 a[124:127], a[184:187], a[252:255], a[124:127]
ds_read_b128 a[184:187], v3 offset:12288
v_accvgpr_read_b32 v27, a55
v_cvt_pk_bf16_f32 v116, v24, v25
v_cvt_pk_bf16_f32 v117, v26, v27
v_mfma_f32_16x16x32_bf16 a[128:131], v[28:31], a[224:227], a[128:131]
v_accvgpr_read_b32 v20, a56
v_accvgpr_read_b32 v21, a57
v_accvgpr_read_b32 v22, a58
v_accvgpr_read_b32 v23, a59
v_mfma_f32_16x16x32_bf16 a[132:135], v[28:31], a[228:231], a[132:135]
s_add_u32 s48, s48, s34
v_add_u32 v5, 16384, v5
v_and_b32 v5, 65535, v5
v_cvt_pk_bf16_f32 v120, v20, v21
v_mfma_f32_16x16x32_bf16 a[136:139], v[28:31], a[232:235], a[136:139]
s_add_u32 m0, s32, 12288
v_xor_b32 v6, 16, v5
v_xor_b32 v7, 64, v5
v_cvt_pk_bf16_f32 v121, v22, v23
v_mfma_f32_16x16x32_bf16 a[140:143], v[28:31], a[236:239], a[140:143]
buffer_load_dwordx4 v1, s[12:15], s48 offen lds
v_xor_b32 v8, 80, v5
v_xor_b32 v9, 128, v5
v_accvgpr_read_b32 v24, a60
v_mfma_f32_16x16x32_bf16 a[144:147], v[28:31], a[240:243], a[144:147]
v_xor_b32 v10, 144, v5
v_xor_b32 v11, 192, v5
v_xor_b32 v12, 208, v5
v_accvgpr_read_b32 v25, a61
v_mfma_f32_16x16x32_bf16 a[148:151], v[28:31], a[244:247], a[148:151]
v_accvgpr_read_b32 v26, a62
v_accvgpr_read_b32 v27, a63
v_cvt_pk_bf16_f32 v124, v24, v25
v_cvt_pk_bf16_f32 v125, v26, v27
v_mfma_f32_16x16x32_bf16 a[152:155], v[28:31], a[248:251], a[152:155]
v_mfma_f32_16x16x32_bf16 a[156:159], v[28:31], a[252:255], a[156:159]
s_cmp_lt_u32 s35, s45
s_cbranch_scc1 L_g_tile
s_branch L_g_end
.p2align 3
L_g_v:
s_waitcnt vmcnt(16) lgkmcnt(0)
s_barrier
v_mfma_f32_16x16x32_bf16 v[160:163], a[160:163], a[192:195], 0
ds_read_b64_tr_b16 a[224:225], v5 offset:0
v_accvgpr_read_b32 v20, a64
v_accvgpr_read_b32 v21, a65
v_accvgpr_read_b32 v22, a66
v_mfma_f32_16x16x32_bf16 v[164:167], a[160:163], a[196:199], 0
v_accvgpr_read_b32 v23, a67
v_cvt_pk_bf16_f32 v98, v20, v21
v_cvt_pk_bf16_f32 v99, v22, v23
v_accvgpr_read_b32 v24, a68
v_mfma_f32_16x16x32_bf16 v[168:171], a[160:163], a[200:203], 0
ds_read_b64_tr_b16 a[226:227], v5 offset:1024
v_accvgpr_read_b32 v25, a69
v_accvgpr_read_b32 v26, a70
v_accvgpr_read_b32 v27, a71
v_mfma_f32_16x16x32_bf16 v[172:175], a[160:163], a[204:207], 0
s_add_u32 s37, s31, 0
v_cvt_pk_bf16_f32 v102, v24, v25
v_cvt_pk_bf16_f32 v103, v26, v27
v_accvgpr_read_b32 v20, a72
v_mfma_f32_16x16x32_bf16 v[176:179], a[160:163], a[208:211], 0
s_add_u32 m0, s33, 0
ds_read_b64_tr_b16 a[228:229], v6 offset:0
v_accvgpr_read_b32 v21, a73
v_accvgpr_read_b32 v22, a74
v_mfma_f32_16x16x32_bf16 v[180:183], a[160:163], a[212:215], 0
buffer_load_dwordx4 v2, s[20:23], s37 offen  lds
v_accvgpr_read_b32 v23, a75
v_cvt_pk_bf16_f32 v106, v20, v21
v_cvt_pk_bf16_f32 v107, v22, v23
v_mfma_f32_16x16x32_bf16 v[184:187], a[160:163], a[216:219], 0
ds_read_b64_tr_b16 a[230:231], v6 offset:1024
v_accvgpr_read_b32 v24, a76
v_accvgpr_read_b32 v25, a77
v_accvgpr_read_b32 v26, a78
v_mfma_f32_16x16x32_bf16 v[188:191], a[160:163], a[220:223], 0
ds_read_b128 a[160:163], v4 offset:0
v_accvgpr_read_b32 v27, a79
v_cvt_pk_bf16_f32 v110, v24, v25
v_cvt_pk_bf16_f32 v111, v26, v27
v_mfma_f32_16x16x32_bf16 v[192:195], a[164:167], a[192:195], 0
ds_read_b64_tr_b16 a[232:233], v7 offset:0
v_accvgpr_read_b32 v20, a80
v_accvgpr_read_b32 v21, a81
v_accvgpr_read_b32 v22, a82
v_mfma_f32_16x16x32_bf16 v[196:199], a[164:167], a[196:199], 0
v_accvgpr_read_b32 v23, a83
v_cvt_pk_bf16_f32 v114, v20, v21
v_cvt_pk_bf16_f32 v115, v22, v23
v_accvgpr_read_b32 v24, a84
v_mfma_f32_16x16x32_bf16 v[200:203], a[164:167], a[200:203], 0
ds_read_b64_tr_b16 a[234:235], v7 offset:1024
v_accvgpr_read_b32 v25, a85
v_accvgpr_read_b32 v26, a86
v_accvgpr_read_b32 v27, a87
v_mfma_f32_16x16x32_bf16 v[204:207], a[164:167], a[204:207], 0
s_add_u32 s37, s31, 32768
v_cvt_pk_bf16_f32 v118, v24, v25
v_cvt_pk_bf16_f32 v119, v26, v27
v_accvgpr_read_b32 v20, a88
v_mfma_f32_16x16x32_bf16 v[208:211], a[164:167], a[208:211], 0
s_add_u32 m0, s33, 1024
ds_read_b64_tr_b16 a[236:237], v8 offset:0
v_accvgpr_read_b32 v21, a89
v_accvgpr_read_b32 v22, a90
v_mfma_f32_16x16x32_bf16 v[212:215], a[164:167], a[212:215], 0
buffer_load_dwordx4 v2, s[20:23], s37 offen  lds
v_accvgpr_read_b32 v23, a91
v_cvt_pk_bf16_f32 v122, v20, v21
v_cvt_pk_bf16_f32 v123, v22, v23
v_mfma_f32_16x16x32_bf16 v[216:219], a[164:167], a[216:219], 0
ds_read_b64_tr_b16 a[238:239], v8 offset:1024
v_accvgpr_read_b32 v24, a92
v_accvgpr_read_b32 v25, a93
v_accvgpr_read_b32 v26, a94
v_mfma_f32_16x16x32_bf16 v[220:223], a[164:167], a[220:223], 0
ds_read_b128 a[164:167], v3 offset:1024
v_accvgpr_read_b32 v27, a95
v_cvt_pk_bf16_f32 v126, v24, v25
v_cvt_pk_bf16_f32 v127, v26, v27
v_mfma_f32_16x16x32_bf16 v[224:227], a[168:171], a[192:195], 0
ds_read_b64_tr_b16 a[240:241], v9 offset:0
v_accvgpr_read_b32 v20, a96
v_accvgpr_read_b32 v21, a97
v_accvgpr_read_b32 v22, a98
v_mfma_f32_16x16x32_bf16 v[228:231], a[168:171], a[196:199], 0
v_accvgpr_read_b32 v23, a99
v_cvt_pk_bf16_f32 v128, v20, v21
v_cvt_pk_bf16_f32 v129, v22, v23
v_accvgpr_read_b32 v24, a100
v_mfma_f32_16x16x32_bf16 v[232:235], a[168:171], a[200:203], 0
ds_read_b64_tr_b16 a[242:243], v9 offset:1024
v_accvgpr_read_b32 v25, a101
v_accvgpr_read_b32 v26, a102
v_accvgpr_read_b32 v27, a103
v_mfma_f32_16x16x32_bf16 v[236:239], a[168:171], a[204:207], 0
s_add_u32 s37, s31, 131072
v_cvt_pk_bf16_f32 v132, v24, v25
v_cvt_pk_bf16_f32 v133, v26, v27
v_accvgpr_read_b32 v20, a104
v_mfma_f32_16x16x32_bf16 v[240:243], a[168:171], a[208:211], 0
s_add_u32 m0, s33, 4096
ds_read_b64_tr_b16 a[244:245], v10 offset:0
v_accvgpr_read_b32 v21, a105
v_accvgpr_read_b32 v22, a106
v_mfma_f32_16x16x32_bf16 v[244:247], a[168:171], a[212:215], 0
buffer_load_dwordx4 v2, s[20:23], s37 offen  lds
v_accvgpr_read_b32 v23, a107
v_cvt_pk_bf16_f32 v136, v20, v21
v_cvt_pk_bf16_f32 v137, v22, v23
v_mfma_f32_16x16x32_bf16 v[248:251], a[168:171], a[216:219], 0
ds_read_b64_tr_b16 a[246:247], v10 offset:1024
v_accvgpr_read_b32 v24, a108
v_accvgpr_read_b32 v25, a109
v_accvgpr_read_b32 v26, a110
v_mfma_f32_16x16x32_bf16 v[252:255], a[168:171], a[220:223], 0
ds_read_b128 a[168:171], v4 offset:4096
v_accvgpr_read_b32 v27, a111
v_cvt_pk_bf16_f32 v140, v24, v25
v_cvt_pk_bf16_f32 v141, v26, v27
v_mfma_f32_16x16x32_bf16 a[0:3], a[172:175], a[192:195], 0
ds_read_b64_tr_b16 a[248:249], v11 offset:0
v_accvgpr_read_b32 v20, a112
v_accvgpr_read_b32 v21, a113
v_accvgpr_read_b32 v22, a114
v_mfma_f32_16x16x32_bf16 a[4:7], a[172:175], a[196:199], 0
v_accvgpr_read_b32 v23, a115
v_cvt_pk_bf16_f32 v144, v20, v21
v_cvt_pk_bf16_f32 v145, v22, v23
v_accvgpr_read_b32 v24, a116
v_mfma_f32_16x16x32_bf16 a[8:11], a[172:175], a[200:203], 0
ds_read_b64_tr_b16 a[250:251], v11 offset:1024
v_accvgpr_read_b32 v25, a117
v_accvgpr_read_b32 v26, a118
v_accvgpr_read_b32 v27, a119
v_mfma_f32_16x16x32_bf16 a[12:15], a[172:175], a[204:207], 0
s_add_u32 s37, s31, 163840
v_cvt_pk_bf16_f32 v148, v24, v25
v_cvt_pk_bf16_f32 v149, v26, v27
v_accvgpr_read_b32 v20, a120
v_mfma_f32_16x16x32_bf16 a[16:19], a[172:175], a[208:211], 0
s_add_u32 m0, s33, 5120
ds_read_b64_tr_b16 a[252:253], v12 offset:0
v_accvgpr_read_b32 v21, a121
v_accvgpr_read_b32 v22, a122
v_mfma_f32_16x16x32_bf16 a[20:23], a[172:175], a[212:215], 0
buffer_load_dwordx4 v2, s[20:23], s37 offen  lds
v_accvgpr_read_b32 v23, a123
v_cvt_pk_bf16_f32 v152, v20, v21
v_cvt_pk_bf16_f32 v153, v22, v23
v_mfma_f32_16x16x32_bf16 a[24:27], a[172:175], a[216:219], 0
ds_read_b64_tr_b16 a[254:255], v12 offset:1024
v_accvgpr_read_b32 v24, a124
v_accvgpr_read_b32 v25, a125
v_accvgpr_read_b32 v26, a126
s_mov_b32 s38, s62
v_mfma_f32_16x16x32_bf16 a[28:31], a[172:175], a[220:223], 0
ds_read_b128 a[172:175], v3 offset:5120
v_accvgpr_read_b32 v27, a127
v_cvt_pk_bf16_f32 v156, v24, v25
v_cvt_pk_bf16_f32 v157, v26, v27
s_mov_b32 s39, s63
v_mfma_f32_16x16x32_bf16 a[32:35], a[176:179], a[192:195], 0
s_add_u32 s31, s31, 262144
s_add_u32 s33, s33, 16384
v_accvgpr_read_b32 v20, a128
v_accvgpr_read_b32 v21, a129
s_mov_b32 s49, s50
v_mfma_f32_16x16x32_bf16 a[36:39], a[176:179], a[196:199], 0
s_and_b32 s33, s33, 65535
ds_read_b128 v[28:31], v3 offset:13312
v_accvgpr_read_b32 v22, a130
v_accvgpr_read_b32 v23, a131
s_mov_b32 s62, s42
v_mfma_f32_16x16x32_bf16 a[40:43], a[176:179], a[200:203], 0
v_cvt_pk_bf16_f32 v130, v20, v21
v_cvt_pk_bf16_f32 v131, v22, v23
v_accvgpr_read_b32 v24, a132
v_accvgpr_read_b32 v25, a133
s_mov_b32 s63, s43
v_mfma_f32_16x16x32_bf16 a[44:47], a[176:179], a[204:207], 0
s_add_u32 s48, s48, s34
v_accvgpr_read_b32 v26, a134
v_accvgpr_read_b32 v27, a135
v_cvt_pk_bf16_f32 v134, v24, v25
s_mov_b32 s50, s51
v_mfma_f32_16x16x32_bf16 a[48:51], a[176:179], a[208:211], 0
s_add_u32 m0, s32, 16384
v_cvt_pk_bf16_f32 v135, v26, v27
v_accvgpr_read_b32 v20, a136
v_accvgpr_read_b32 v21, a137
s_mov_b32 s36, s40
v_mfma_f32_16x16x32_bf16 a[52:55], a[176:179], a[212:215], 0
buffer_load_dwordx4 v1, s[12:15], s48 offen lds
v_accvgpr_read_b32 v22, a138
v_accvgpr_read_b32 v23, a139
v_cvt_pk_bf16_f32 v138, v20, v21
s_add_u32 s35, s35, 1
v_mfma_f32_16x16x32_bf16 a[56:59], a[176:179], a[216:219], 0
v_cvt_pk_bf16_f32 v139, v22, v23
v_accvgpr_read_b32 v24, a140
v_accvgpr_read_b32 v25, a141
v_accvgpr_read_b32 v26, a142
v_bfe_u32 v16, v0, 3, 3
v_mfma_f32_16x16x32_bf16 a[60:63], a[176:179], a[220:223], 0
ds_read_b128 a[176:179], v4 offset:8192
v_accvgpr_read_b32 v27, a143
v_cvt_pk_bf16_f32 v142, v24, v25
v_cvt_pk_bf16_f32 v143, v26, v27
v_lshlrev_b32 v16, 4, v16
v_mfma_f32_16x16x32_bf16 a[64:67], a[180:183], a[192:195], 0
v_accvgpr_read_b32 v20, a144
v_accvgpr_read_b32 v21, a145
v_accvgpr_read_b32 v22, a146
v_accvgpr_read_b32 v23, a147
v_and_or_b32 v16, v0, 7, v16
v_mfma_f32_16x16x32_bf16 a[68:71], a[180:183], a[196:199], 0
v_cvt_pk_bf16_f32 v146, v20, v21
v_cvt_pk_bf16_f32 v147, v22, v23
v_accvgpr_read_b32 v24, a148
v_accvgpr_read_b32 v25, a149
v_bfe_u32 v17, v0, 4, 2
v_mfma_f32_16x16x32_bf16 a[72:75], a[180:183], a[200:203], 0
v_accvgpr_read_b32 v26, a150
v_accvgpr_read_b32 v27, a151
v_cvt_pk_bf16_f32 v150, v24, v25
v_cvt_pk_bf16_f32 v151, v26, v27
v_lshlrev_b32 v17, 5, v17
v_mfma_f32_16x16x32_bf16 a[76:79], a[180:183], a[204:207], 0
s_add_u32 s48, s48, s34
v_accvgpr_read_b32 v20, a152
v_accvgpr_read_b32 v21, a153
v_accvgpr_read_b32 v22, a154
v_and_or_b32 v17, v0, 8, v17
v_mfma_f32_16x16x32_bf16 a[80:83], a[180:183], a[208:211], 0
s_add_u32 m0, s32, 20480
v_accvgpr_read_b32 v23, a155
v_cvt_pk_bf16_f32 v154, v20, v21
v_cvt_pk_bf16_f32 v155, v22, v23
v_bfe_u32 v18, v0, 1, 2
v_mfma_f32_16x16x32_bf16 a[84:87], a[180:183], a[212:215], 0
buffer_load_dwordx4 v1, s[12:15], s48 offen lds
v_accvgpr_read_b32 v24, a156
v_accvgpr_read_b32 v25, a157
v_accvgpr_read_b32 v26, a158
v_or_b32 v17, v17, v18
v_mfma_f32_16x16x32_bf16 a[88:91], a[180:183], a[216:219], 0
v_accvgpr_read_b32 v27, a159
v_cvt_pk_bf16_f32 v158, v24, v25
v_cvt_pk_bf16_f32 v159, v26, v27
v_and_b32 v18, 1, v0
v_lshl_or_b32 v17, v18, 4, v17
v_mfma_f32_16x16x32_bf16 a[92:95], a[180:183], a[220:223], 0
ds_read_b128 a[180:183], v3 offset:9216
s_bitcmp1_b32 s49, 1
s_cselect_b64 vcc, -1, 0
s_cselect_b32 s44, 64, 0x80
v_cndmask_b32 v16, v16, v17, vcc
v_mfma_f32_16x16x32_bf16 a[96:99], a[184:187], a[192:195], 0
v_lshlrev_b32 v13, 4, v16
s_movk_i32 s92, 0x800
s_bitcmp1_b32 s49, 0
s_cselect_b32 s92, 0x4000, s92
s_xor_b32 s93, s92, 0x4800
v_mfma_f32_16x16x32_bf16 a[100:103], a[184:187], a[196:199], 0
s_sub_u32 s93, s93, s44
v_mfma_f32_16x16x32_bf16 a[104:107], a[184:187], a[200:203], 0
v_mfma_f32_16x16x32_bf16 a[108:111], a[184:187], a[204:207], 0
s_add_u32 s48, s48, s34
v_mfma_f32_16x16x32_bf16 a[112:115], a[184:187], a[208:211], 0
s_add_u32 m0, s32, 24576
v_mfma_f32_16x16x32_bf16 a[116:119], a[184:187], a[212:215], 0
buffer_load_dwordx4 v1, s[12:15], s48 offen lds
v_mfma_f32_16x16x32_bf16 a[120:123], a[184:187], a[216:219], 0
v_mfma_f32_16x16x32_bf16 a[124:127], a[184:187], a[220:223], 0
ds_read_b128 a[184:187], v4 offset:12288
v_mfma_f32_16x16x32_bf16 a[128:131], a[188:191], a[192:195], 0
v_mfma_f32_16x16x32_bf16 a[132:135], a[188:191], a[196:199], 0
v_add_u32 v3, 32768, v3
v_subrev_u32 v19, 98304, v3
v_cmp_le_u32 vcc, 163840, v3
v_mfma_f32_16x16x32_bf16 a[136:139], a[188:191], a[200:203], 0
v_add_u32 v5, 16384, v5
v_and_b32 v5, 65535, v5
v_xor_b32 v6, 16, v5
v_mfma_f32_16x16x32_bf16 a[140:143], a[188:191], a[204:207], 0
s_add_u32 s48, s48, s34
v_xor_b32 v7, 64, v5
v_xor_b32 v8, 80, v5
v_mfma_f32_16x16x32_bf16 a[144:147], a[188:191], a[208:211], 0
s_add_u32 m0, s32, 28672
v_xor_b32 v9, 128, v5
v_xor_b32 v10, 144, v5
v_mfma_f32_16x16x32_bf16 a[148:151], a[188:191], a[212:215], 0
buffer_load_dwordx4 v1, s[12:15], s48 offen lds
v_xor_b32 v11, 192, v5
v_xor_b32 v12, 208, v5
v_mfma_f32_16x16x32_bf16 a[152:155], a[188:191], a[216:219], 0
s_add_u32 s30, s30, 128
s_add_u32 s32, s32, 32768
s_sub_u32 s48, s32, 98304
v_mfma_f32_16x16x32_bf16 a[156:159], a[188:191], a[220:223], 0
s_cmp_ge_u32 s32, 163840
s_cselect_b32 s32, s48, s32
v_cndmask_b32 v3, v3, v19, vcc
v_xor_b32 v4, 64, v3
s_waitcnt vmcnt(16) lgkmcnt(0)
s_barrier
v_mfma_f32_16x16x32_bf16 v[160:163], a[160:163], a[224:227], v[160:163]
ds_read_b64_tr_b16 a[192:193], v5 offset:0
v_mfma_f32_16x16x32_bf16 v[164:167], a[160:163], a[228:231], v[164:167]
v_mfma_f32_16x16x32_bf16 v[168:171], a[160:163], a[232:235], v[168:171]
ds_read_b64_tr_b16 a[194:195], v5 offset:1024
v_mfma_f32_16x16x32_bf16 v[172:175], a[160:163], a[236:239], v[172:175]
s_add_u32 s37, s31, 0
v_mfma_f32_16x16x32_bf16 v[176:179], a[160:163], a[240:243], v[176:179]
s_add_u32 m0, s33, 0
ds_read_b64_tr_b16 a[196:197], v6 offset:0
v_mfma_f32_16x16x32_bf16 v[180:183], a[160:163], a[244:247], v[180:183]
buffer_load_dwordx4 v2, s[20:23], s37 offen  lds
v_mfma_f32_16x16x32_bf16 v[184:187], a[160:163], a[248:251], v[184:187]
ds_read_b64_tr_b16 a[198:199], v6 offset:1024
v_mfma_f32_16x16x32_bf16 v[188:191], a[160:163], a[252:255], v[188:191]
ds_read_b128 a[160:163], v3 offset:0
s_mov_b32 s60, s38
v_mfma_f32_16x16x32_bf16 v[192:195], a[164:167], a[224:227], v[192:195]
s_mov_b32 s29, s38
ds_read_b64_tr_b16 a[200:201], v7 offset:0
v_mfma_f32_16x16x32_bf16 v[196:199], a[164:167], a[228:231], v[196:199]
buffer_store_dwordx4 v[32:35], v13, s[8:11], s29 offen sc1
v_mfma_f32_16x16x32_bf16 v[200:203], a[164:167], a[232:235], v[200:203]
ds_read_b64_tr_b16 a[202:203], v7 offset:1024
v_mfma_f32_16x16x32_bf16 v[204:207], a[164:167], a[236:239], v[204:207]
s_add_u32 s37, s31, 32768
v_mfma_f32_16x16x32_bf16 v[208:211], a[164:167], a[240:243], v[208:211]
s_add_u32 m0, s33, 1024
ds_read_b64_tr_b16 a[204:205], v8 offset:0
v_mfma_f32_16x16x32_bf16 v[212:215], a[164:167], a[244:247], v[212:215]
buffer_load_dwordx4 v2, s[20:23], s37 offen  lds
v_mfma_f32_16x16x32_bf16 v[216:219], a[164:167], a[248:251], v[216:219]
ds_read_b64_tr_b16 a[206:207], v8 offset:1024
v_mfma_f32_16x16x32_bf16 v[220:223], a[164:167], a[252:255], v[220:223]
ds_read_b128 a[164:167], v4 offset:1024
v_mfma_f32_16x16x32_bf16 v[224:227], a[168:171], a[224:227], v[224:227]
ds_read_b64_tr_b16 a[208:209], v9 offset:0
v_mfma_f32_16x16x32_bf16 v[228:231], a[168:171], a[228:231], v[228:231]
v_mfma_f32_16x16x32_bf16 v[232:235], a[168:171], a[232:235], v[232:235]
ds_read_b64_tr_b16 a[210:211], v9 offset:1024
v_mfma_f32_16x16x32_bf16 v[236:239], a[168:171], a[236:239], v[236:239]
s_add_u32 s37, s31, 131072
v_mfma_f32_16x16x32_bf16 v[240:243], a[168:171], a[240:243], v[240:243]
s_add_u32 m0, s33, 4096
ds_read_b64_tr_b16 a[212:213], v10 offset:0
v_mfma_f32_16x16x32_bf16 v[244:247], a[168:171], a[244:247], v[244:247]
buffer_load_dwordx4 v2, s[20:23], s37 offen  lds
v_mfma_f32_16x16x32_bf16 v[248:251], a[168:171], a[248:251], v[248:251]
ds_read_b64_tr_b16 a[214:215], v10 offset:1024
v_mfma_f32_16x16x32_bf16 v[252:255], a[168:171], a[252:255], v[252:255]
ds_read_b128 a[168:171], v3 offset:4096
v_mfma_f32_16x16x32_bf16 a[0:3], a[172:175], a[224:227], a[0:3]
ds_read_b64_tr_b16 a[216:217], v11 offset:0
v_mfma_f32_16x16x32_bf16 a[4:7], a[172:175], a[228:231], a[4:7]
v_mfma_f32_16x16x32_bf16 a[8:11], a[172:175], a[232:235], a[8:11]
ds_read_b64_tr_b16 a[218:219], v11 offset:1024
v_mfma_f32_16x16x32_bf16 a[12:15], a[172:175], a[236:239], a[12:15]
s_add_u32 s37, s31, 163840
v_mfma_f32_16x16x32_bf16 a[16:19], a[172:175], a[240:243], a[16:19]
s_add_u32 m0, s33, 5120
ds_read_b64_tr_b16 a[220:221], v12 offset:0
v_mfma_f32_16x16x32_bf16 a[20:23], a[172:175], a[244:247], a[20:23]
buffer_load_dwordx4 v2, s[20:23], s37 offen  lds
v_mfma_f32_16x16x32_bf16 a[24:27], a[172:175], a[248:251], a[24:27]
ds_read_b64_tr_b16 a[222:223], v12 offset:1024
v_mfma_f32_16x16x32_bf16 a[28:31], a[172:175], a[252:255], a[28:31]
ds_read_b128 a[172:175], v4 offset:5120
s_add_u32 s29, s29, s44
v_mfma_f32_16x16x32_bf16 a[32:35], a[176:179], a[224:227], a[32:35]
s_add_u32 s31, s31, 262144
s_add_u32 s33, s33, 16384
v_mfma_f32_16x16x32_bf16 a[36:39], a[176:179], a[228:231], a[36:39]
s_and_b32 s33, s33, 65535
buffer_store_dwordx4 v[36:39], v13, s[8:11], s29 offen sc1
v_mfma_f32_16x16x32_bf16 a[40:43], a[176:179], a[232:235], a[40:43]
ds_read_b128 a[188:191], v4 offset:13312
v_mfma_f32_16x16x32_bf16 a[44:47], a[176:179], a[236:239], a[44:47]
s_mov_b32 s48, s30
v_mfma_f32_16x16x32_bf16 a[48:51], a[176:179], a[240:243], a[48:51]
s_add_u32 m0, s32, 0
v_mfma_f32_16x16x32_bf16 a[52:55], a[176:179], a[244:247], a[52:55]
buffer_load_dwordx4 v1, s[12:15], s48 offen lds
v_mfma_f32_16x16x32_bf16 a[56:59], a[176:179], a[248:251], a[56:59]
v_mfma_f32_16x16x32_bf16 a[60:63], a[176:179], a[252:255], a[60:63]
ds_read_b128 a[176:179], v3 offset:8192
v_mfma_f32_16x16x32_bf16 a[64:67], a[180:183], a[224:227], a[64:67]
v_mfma_f32_16x16x32_bf16 a[68:71], a[180:183], a[228:231], a[68:71]
v_mfma_f32_16x16x32_bf16 a[72:75], a[180:183], a[232:235], a[72:75]
v_mfma_f32_16x16x32_bf16 a[76:79], a[180:183], a[236:239], a[76:79]
s_add_u32 s48, s48, s34
v_mfma_f32_16x16x32_bf16 a[80:83], a[180:183], a[240:243], a[80:83]
s_add_u32 m0, s32, 4096
v_mfma_f32_16x16x32_bf16 a[84:87], a[180:183], a[244:247], a[84:87]
buffer_load_dwordx4 v1, s[12:15], s48 offen lds
v_mfma_f32_16x16x32_bf16 a[88:91], a[180:183], a[248:251], a[88:91]
v_mfma_f32_16x16x32_bf16 a[92:95], a[180:183], a[252:255], a[92:95]
ds_read_b128 a[180:183], v4 offset:9216
v_mfma_f32_16x16x32_bf16 a[96:99], a[184:187], a[224:227], a[96:99]
v_mfma_f32_16x16x32_bf16 a[100:103], a[184:187], a[228:231], a[100:103]
v_mfma_f32_16x16x32_bf16 a[104:107], a[184:187], a[232:235], a[104:107]
v_mfma_f32_16x16x32_bf16 a[108:111], a[184:187], a[236:239], a[108:111]
s_add_u32 s48, s48, s34
v_mfma_f32_16x16x32_bf16 a[112:115], a[184:187], a[240:243], a[112:115]
s_add_u32 m0, s32, 8192
v_mfma_f32_16x16x32_bf16 a[116:119], a[184:187], a[244:247], a[116:119]
buffer_load_dwordx4 v1, s[12:15], s48 offen lds
v_mfma_f32_16x16x32_bf16 a[120:123], a[184:187], a[248:251], a[120:123]
v_mfma_f32_16x16x32_bf16 a[124:127], a[184:187], a[252:255], a[124:127]
ds_read_b128 a[184:187], v3 offset:12288
s_add_u32 s29, s29, s93
v_mfma_f32_16x16x32_bf16 a[128:131], v[28:31], a[224:227], a[128:131]
v_mfma_f32_16x16x32_bf16 a[132:135], v[28:31], a[228:231], a[132:135]
buffer_store_dwordx4 v[40:43], v13, s[8:11], s29 offen sc1
v_add_u32 v5, 16384, v5
v_and_b32 v5, 65535, v5
v_mfma_f32_16x16x32_bf16 a[136:139], v[28:31], a[232:235], a[136:139]
v_xor_b32 v6, 16, v5
v_xor_b32 v7, 64, v5
v_xor_b32 v8, 80, v5
v_mfma_f32_16x16x32_bf16 a[140:143], v[28:31], a[236:239], a[140:143]
s_add_u32 s48, s48, s34
v_xor_b32 v9, 128, v5
v_xor_b32 v10, 144, v5
v_mfma_f32_16x16x32_bf16 a[144:147], v[28:31], a[240:243], a[144:147]
s_add_u32 m0, s32, 12288
v_xor_b32 v11, 192, v5
v_xor_b32 v12, 208, v5
v_mfma_f32_16x16x32_bf16 a[148:151], v[28:31], a[244:247], a[148:151]
buffer_load_dwordx4 v1, s[12:15], s48 offen lds
v_mfma_f32_16x16x32_bf16 a[152:155], v[28:31], a[248:251], a[152:155]
v_mfma_f32_16x16x32_bf16 a[156:159], v[28:31], a[252:255], a[156:159]
s_waitcnt vmcnt(19) lgkmcnt(0)
s_barrier
v_mfma_f32_16x16x32_bf16 v[160:163], a[160:163], a[192:195], v[160:163]
ds_read_b64_tr_b16 a[224:225], v5 offset:0
v_mfma_f32_16x16x32_bf16 v[164:167], a[160:163], a[196:199], v[164:167]
v_mfma_f32_16x16x32_bf16 v[168:171], a[160:163], a[200:203], v[168:171]
ds_read_b64_tr_b16 a[226:227], v5 offset:1024
v_mfma_f32_16x16x32_bf16 v[172:175], a[160:163], a[204:207], v[172:175]
s_add_u32 s37, s31, 0
v_mfma_f32_16x16x32_bf16 v[176:179], a[160:163], a[208:211], v[176:179]
s_add_u32 m0, s33, 0
ds_read_b64_tr_b16 a[228:229], v6 offset:0
v_mfma_f32_16x16x32_bf16 v[180:183], a[160:163], a[212:215], v[180:183]
buffer_load_dwordx4 v2, s[20:23], s37 offen  lds
v_mfma_f32_16x16x32_bf16 v[184:187], a[160:163], a[216:219], v[184:187]
ds_read_b64_tr_b16 a[230:231], v6 offset:1024
v_mfma_f32_16x16x32_bf16 v[188:191], a[160:163], a[220:223], v[188:191]
ds_read_b128 a[160:163], v4 offset:0
s_add_u32 s29, s29, s44
v_mfma_f32_16x16x32_bf16 v[192:195], a[164:167], a[192:195], v[192:195]
ds_read_b64_tr_b16 a[232:233], v7 offset:0
v_mfma_f32_16x16x32_bf16 v[196:199], a[164:167], a[196:199], v[196:199]
buffer_store_dwordx4 v[44:47], v13, s[8:11], s29 offen sc1
v_mfma_f32_16x16x32_bf16 v[200:203], a[164:167], a[200:203], v[200:203]
ds_read_b64_tr_b16 a[234:235], v7 offset:1024
v_mfma_f32_16x16x32_bf16 v[204:207], a[164:167], a[204:207], v[204:207]
s_add_u32 s37, s31, 32768
v_mfma_f32_16x16x32_bf16 v[208:211], a[164:167], a[208:211], v[208:211]
s_add_u32 m0, s33, 1024
ds_read_b64_tr_b16 a[236:237], v8 offset:0
v_mfma_f32_16x16x32_bf16 v[212:215], a[164:167], a[212:215], v[212:215]
buffer_load_dwordx4 v2, s[20:23], s37 offen  lds
v_mfma_f32_16x16x32_bf16 v[216:219], a[164:167], a[216:219], v[216:219]
ds_read_b64_tr_b16 a[238:239], v8 offset:1024
v_mfma_f32_16x16x32_bf16 v[220:223], a[164:167], a[220:223], v[220:223]
ds_read_b128 a[164:167], v3 offset:1024
v_mfma_f32_16x16x32_bf16 v[224:227], a[168:171], a[192:195], v[224:227]
ds_read_b64_tr_b16 a[240:241], v9 offset:0
v_mfma_f32_16x16x32_bf16 v[228:231], a[168:171], a[196:199], v[228:231]
v_mfma_f32_16x16x32_bf16 v[232:235], a[168:171], a[200:203], v[232:235]
ds_read_b64_tr_b16 a[242:243], v9 offset:1024
v_mfma_f32_16x16x32_bf16 v[236:239], a[168:171], a[204:207], v[236:239]
s_add_u32 s37, s31, 131072
v_mfma_f32_16x16x32_bf16 v[240:243], a[168:171], a[208:211], v[240:243]
s_add_u32 m0, s33, 4096
ds_read_b64_tr_b16 a[244:245], v10 offset:0
v_mfma_f32_16x16x32_bf16 v[244:247], a[168:171], a[212:215], v[244:247]
buffer_load_dwordx4 v2, s[20:23], s37 offen  lds
v_mfma_f32_16x16x32_bf16 v[248:251], a[168:171], a[216:219], v[248:251]
ds_read_b64_tr_b16 a[246:247], v10 offset:1024
v_mfma_f32_16x16x32_bf16 v[252:255], a[168:171], a[220:223], v[252:255]
ds_read_b128 a[168:171], v4 offset:4096
v_mfma_f32_16x16x32_bf16 a[0:3], a[172:175], a[192:195], a[0:3]
ds_read_b64_tr_b16 a[248:249], v11 offset:0
v_mfma_f32_16x16x32_bf16 a[4:7], a[172:175], a[196:199], a[4:7]
v_mfma_f32_16x16x32_bf16 a[8:11], a[172:175], a[200:203], a[8:11]
ds_read_b64_tr_b16 a[250:251], v11 offset:1024
v_mfma_f32_16x16x32_bf16 a[12:15], a[172:175], a[204:207], a[12:15]
s_add_u32 s37, s31, 163840
v_mfma_f32_16x16x32_bf16 a[16:19], a[172:175], a[208:211], a[16:19]
s_add_u32 m0, s33, 5120
ds_read_b64_tr_b16 a[252:253], v12 offset:0
v_mfma_f32_16x16x32_bf16 a[20:23], a[172:175], a[212:215], a[20:23]
buffer_load_dwordx4 v2, s[20:23], s37 offen  lds
v_mfma_f32_16x16x32_bf16 a[24:27], a[172:175], a[216:219], a[24:27]
ds_read_b64_tr_b16 a[254:255], v12 offset:1024
v_mfma_f32_16x16x32_bf16 a[28:31], a[172:175], a[220:223], a[28:31]
ds_read_b128 a[172:175], v3 offset:5120
s_add_u32 s29, s29, s93
v_mfma_f32_16x16x32_bf16 a[32:35], a[176:179], a[192:195], a[32:35]
s_add_u32 s31, s31, 262144
s_add_u32 s33, s33, 16384
v_mfma_f32_16x16x32_bf16 a[36:39], a[176:179], a[196:199], a[36:39]
s_and_b32 s33, s33, 65535
buffer_store_dwordx4 v[48:51], v13, s[8:11], s29 offen sc1
v_mfma_f32_16x16x32_bf16 a[40:43], a[176:179], a[200:203], a[40:43]
ds_read_b128 v[28:31], v3 offset:13312
v_mfma_f32_16x16x32_bf16 a[44:47], a[176:179], a[204:207], a[44:47]
s_add_u32 s48, s48, s34
v_mfma_f32_16x16x32_bf16 a[48:51], a[176:179], a[208:211], a[48:51]
s_add_u32 m0, s32, 16384
v_mfma_f32_16x16x32_bf16 a[52:55], a[176:179], a[212:215], a[52:55]
buffer_load_dwordx4 v1, s[12:15], s48 offen lds
v_mfma_f32_16x16x32_bf16 a[56:59], a[176:179], a[216:219], a[56:59]
v_mfma_f32_16x16x32_bf16 a[60:63], a[176:179], a[220:223], a[60:63]
ds_read_b128 a[176:179], v4 offset:8192
v_mfma_f32_16x16x32_bf16 a[64:67], a[180:183], a[192:195], a[64:67]
v_mfma_f32_16x16x32_bf16 a[68:71], a[180:183], a[196:199], a[68:71]
v_mfma_f32_16x16x32_bf16 a[72:75], a[180:183], a[200:203], a[72:75]
v_mfma_f32_16x16x32_bf16 a[76:79], a[180:183], a[204:207], a[76:79]
s_add_u32 s48, s48, s34
v_mfma_f32_16x16x32_bf16 a[80:83], a[180:183], a[208:211], a[80:83]
s_add_u32 m0, s32, 20480
v_mfma_f32_16x16x32_bf16 a[84:87], a[180:183], a[212:215], a[84:87]
buffer_load_dwordx4 v1, s[12:15], s48 offen lds
v_mfma_f32_16x16x32_bf16 a[88:91], a[180:183], a[216:219], a[88:91]
v_mfma_f32_16x16x32_bf16 a[92:95], a[180:183], a[220:223], a[92:95]
ds_read_b128 a[180:183], v3 offset:9216
v_mfma_f32_16x16x32_bf16 a[96:99], a[184:187], a[192:195], a[96:99]
v_mfma_f32_16x16x32_bf16 a[100:103], a[184:187], a[196:199], a[100:103]
v_mfma_f32_16x16x32_bf16 a[104:107], a[184:187], a[200:203], a[104:107]
v_mfma_f32_16x16x32_bf16 a[108:111], a[184:187], a[204:207], a[108:111]
s_add_u32 s48, s48, s34
v_mfma_f32_16x16x32_bf16 a[112:115], a[184:187], a[208:211], a[112:115]
s_add_u32 m0, s32, 24576
v_mfma_f32_16x16x32_bf16 a[116:119], a[184:187], a[212:215], a[116:119]
buffer_load_dwordx4 v1, s[12:15], s48 offen lds
v_mfma_f32_16x16x32_bf16 a[120:123], a[184:187], a[216:219], a[120:123]
v_mfma_f32_16x16x32_bf16 a[124:127], a[184:187], a[220:223], a[124:127]
ds_read_b128 a[184:187], v4 offset:12288
s_add_u32 s29, s29, s44
v_mfma_f32_16x16x32_bf16 a[128:131], a[188:191], a[192:195], a[128:131]
v_mfma_f32_16x16x32_bf16 a[132:135], a[188:191], a[196:199], a[132:135]
buffer_store_dwordx4 v[52:55], v13, s[8:11], s29 offen sc1
v_add_u32 v3, 32768, v3
v_subrev_u32 v19, 98304, v3
v_mfma_f32_16x16x32_bf16 a[136:139], a[188:191], a[200:203], a[136:139]
v_cmp_le_u32 vcc, 163840, v3
v_add_u32 v5, 16384, v5
v_and_b32 v5, 65535, v5
v_mfma_f32_16x16x32_bf16 a[140:143], a[188:191], a[204:207], a[140:143]
s_add_u32 s48, s48, s34
v_xor_b32 v6, 16, v5
v_xor_b32 v7, 64, v5
v_mfma_f32_16x16x32_bf16 a[144:147], a[188:191], a[208:211], a[144:147]
s_add_u32 m0, s32, 28672
v_xor_b32 v8, 80, v5
v_xor_b32 v9, 128, v5
v_mfma_f32_16x16x32_bf16 a[148:151], a[188:191], a[212:215], a[148:151]
buffer_load_dwordx4 v1, s[12:15], s48 offen lds
v_xor_b32 v10, 144, v5
v_xor_b32 v11, 192, v5
v_mfma_f32_16x16x32_bf16 a[152:155], a[188:191], a[216:219], a[152:155]
s_add_u32 s30, s30, 128
s_add_u32 s32, s32, 32768
s_sub_u32 s48, s32, 98304
v_mfma_f32_16x16x32_bf16 a[156:159], a[188:191], a[220:223], a[156:159]
s_cmp_ge_u32 s32, 163840
s_cselect_b32 s32, s48, s32
v_xor_b32 v12, 208, v5
v_cndmask_b32 v3, v3, v19, vcc
v_xor_b32 v4, 64, v3
s_waitcnt vmcnt(22) lgkmcnt(0)
s_barrier
v_mfma_f32_16x16x32_bf16 v[160:163], a[160:163], a[224:227], v[160:163]
ds_read_b64_tr_b16 a[192:193], v5 offset:0
v_mfma_f32_16x16x32_bf16 v[164:167], a[160:163], a[228:231], v[164:167]
v_mfma_f32_16x16x32_bf16 v[168:171], a[160:163], a[232:235], v[168:171]
ds_read_b64_tr_b16 a[194:195], v5 offset:1024
v_mfma_f32_16x16x32_bf16 v[172:175], a[160:163], a[236:239], v[172:175]
s_add_u32 s37, s31, 0
v_mfma_f32_16x16x32_bf16 v[176:179], a[160:163], a[240:243], v[176:179]
s_add_u32 m0, s33, 0
ds_read_b64_tr_b16 a[196:197], v6 offset:0
v_mfma_f32_16x16x32_bf16 v[180:183], a[160:163], a[244:247], v[180:183]
buffer_load_dwordx4 v2, s[20:23], s37 offen  lds
v_mfma_f32_16x16x32_bf16 v[184:187], a[160:163], a[248:251], v[184:187]
ds_read_b64_tr_b16 a[198:199], v6 offset:1024
v_mfma_f32_16x16x32_bf16 v[188:191], a[160:163], a[252:255], v[188:191]
ds_read_b128 a[160:163], v3 offset:0
s_add_u32 s29, s29, s93
v_mfma_f32_16x16x32_bf16 v[192:195], a[164:167], a[224:227], v[192:195]
ds_read_b64_tr_b16 a[200:201], v7 offset:0
v_mfma_f32_16x16x32_bf16 v[196:199], a[164:167], a[228:231], v[196:199]
buffer_store_dwordx4 v[56:59], v13, s[8:11], s29 offen sc1
v_mfma_f32_16x16x32_bf16 v[200:203], a[164:167], a[232:235], v[200:203]
ds_read_b64_tr_b16 a[202:203], v7 offset:1024
v_mfma_f32_16x16x32_bf16 v[204:207], a[164:167], a[236:239], v[204:207]
s_add_u32 s37, s31, 32768
v_mfma_f32_16x16x32_bf16 v[208:211], a[164:167], a[240:243], v[208:211]
s_add_u32 m0, s33, 1024
ds_read_b64_tr_b16 a[204:205], v8 offset:0
v_mfma_f32_16x16x32_bf16 v[212:215], a[164:167], a[244:247], v[212:215]
buffer_load_dwordx4 v2, s[20:23], s37 offen  lds
v_mfma_f32_16x16x32_bf16 v[216:219], a[164:167], a[248:251], v[216:219]
ds_read_b64_tr_b16 a[206:207], v8 offset:1024
v_mfma_f32_16x16x32_bf16 v[220:223], a[164:167], a[252:255], v[220:223]
ds_read_b128 a[164:167], v4 offset:1024
v_mfma_f32_16x16x32_bf16 v[224:227], a[168:171], a[224:227], v[224:227]
ds_read_b64_tr_b16 a[208:209], v9 offset:0
v_mfma_f32_16x16x32_bf16 v[228:231], a[168:171], a[228:231], v[228:231]
v_mfma_f32_16x16x32_bf16 v[232:235], a[168:171], a[232:235], v[232:235]
ds_read_b64_tr_b16 a[210:211], v9 offset:1024
v_mfma_f32_16x16x32_bf16 v[236:239], a[168:171], a[236:239], v[236:239]
s_add_u32 s37, s31, 131072
v_mfma_f32_16x16x32_bf16 v[240:243], a[168:171], a[240:243], v[240:243]
s_add_u32 m0, s33, 4096
ds_read_b64_tr_b16 a[212:213], v10 offset:0
v_mfma_f32_16x16x32_bf16 v[244:247], a[168:171], a[244:247], v[244:247]
buffer_load_dwordx4 v2, s[20:23], s37 offen  lds
v_mfma_f32_16x16x32_bf16 v[248:251], a[168:171], a[248:251], v[248:251]
ds_read_b64_tr_b16 a[214:215], v10 offset:1024
v_mfma_f32_16x16x32_bf16 v[252:255], a[168:171], a[252:255], v[252:255]
ds_read_b128 a[168:171], v3 offset:4096
v_mfma_f32_16x16x32_bf16 a[0:3], a[172:175], a[224:227], a[0:3]
ds_read_b64_tr_b16 a[216:217], v11 offset:0
v_mfma_f32_16x16x32_bf16 a[4:7], a[172:175], a[228:231], a[4:7]
v_mfma_f32_16x16x32_bf16 a[8:11], a[172:175], a[232:235], a[8:11]
ds_read_b64_tr_b16 a[218:219], v11 offset:1024
v_mfma_f32_16x16x32_bf16 a[12:15], a[172:175], a[236:239], a[12:15]
s_add_u32 s37, s31, 163840
v_mfma_f32_16x16x32_bf16 a[16:19], a[172:175], a[240:243], a[16:19]
s_add_u32 m0, s33, 5120
ds_read_b64_tr_b16 a[220:221], v12 offset:0
v_mfma_f32_16x16x32_bf16 a[20:23], a[172:175], a[244:247], a[20:23]
buffer_load_dwordx4 v2, s[20:23], s37 offen  lds
v_mfma_f32_16x16x32_bf16 a[24:27], a[172:175], a[248:251], a[24:27]
ds_read_b64_tr_b16 a[222:223], v12 offset:1024
v_mfma_f32_16x16x32_bf16 a[28:31], a[172:175], a[252:255], a[28:31]
ds_read_b128 a[172:175], v4 offset:5120
s_add_u32 s29, s29, s44
v_mfma_f32_16x16x32_bf16 a[32:35], a[176:179], a[224:227], a[32:35]
s_add_u32 s31, s31, 262144
s_add_u32 s33, s33, 16384
v_mfma_f32_16x16x32_bf16 a[36:39], a[176:179], a[228:231], a[36:39]
s_and_b32 s33, s33, 65535
buffer_store_dwordx4 v[60:63], v13, s[8:11], s29 offen sc1
v_mfma_f32_16x16x32_bf16 a[40:43], a[176:179], a[232:235], a[40:43]
ds_read_b128 a[188:191], v4 offset:13312
v_mfma_f32_16x16x32_bf16 a[44:47], a[176:179], a[236:239], a[44:47]
s_mov_b32 s48, s30
v_mfma_f32_16x16x32_bf16 a[48:51], a[176:179], a[240:243], a[48:51]
s_add_u32 m0, s32, 0
v_mfma_f32_16x16x32_bf16 a[52:55], a[176:179], a[244:247], a[52:55]
buffer_load_dwordx4 v1, s[12:15], s48 offen lds
v_mfma_f32_16x16x32_bf16 a[56:59], a[176:179], a[248:251], a[56:59]
v_mfma_f32_16x16x32_bf16 a[60:63], a[176:179], a[252:255], a[60:63]
ds_read_b128 a[176:179], v3 offset:8192
v_mfma_f32_16x16x32_bf16 a[64:67], a[180:183], a[224:227], a[64:67]
v_mfma_f32_16x16x32_bf16 a[68:71], a[180:183], a[228:231], a[68:71]
v_mfma_f32_16x16x32_bf16 a[72:75], a[180:183], a[232:235], a[72:75]
v_mfma_f32_16x16x32_bf16 a[76:79], a[180:183], a[236:239], a[76:79]
s_add_u32 s48, s48, s34
v_mfma_f32_16x16x32_bf16 a[80:83], a[180:183], a[240:243], a[80:83]
s_add_u32 m0, s32, 4096
v_mfma_f32_16x16x32_bf16 a[84:87], a[180:183], a[244:247], a[84:87]
buffer_load_dwordx4 v1, s[12:15], s48 offen lds
v_mfma_f32_16x16x32_bf16 a[88:91], a[180:183], a[248:251], a[88:91]
v_mfma_f32_16x16x32_bf16 a[92:95], a[180:183], a[252:255], a[92:95]
ds_read_b128 a[180:183], v4 offset:9216
v_mfma_f32_16x16x32_bf16 a[96:99], a[184:187], a[224:227], a[96:99]
v_mfma_f32_16x16x32_bf16 a[100:103], a[184:187], a[228:231], a[100:103]
v_mfma_f32_16x16x32_bf16 a[104:107], a[184:187], a[232:235], a[104:107]
v_mfma_f32_16x16x32_bf16 a[108:111], a[184:187], a[236:239], a[108:111]
s_add_u32 s48, s48, s34
v_mfma_f32_16x16x32_bf16 a[112:115], a[184:187], a[240:243], a[112:115]
s_add_u32 m0, s32, 8192
v_mfma_f32_16x16x32_bf16 a[116:119], a[184:187], a[244:247], a[116:119]
buffer_load_dwordx4 v1, s[12:15], s48 offen lds
v_mfma_f32_16x16x32_bf16 a[120:123], a[184:187], a[248:251], a[120:123]
v_mfma_f32_16x16x32_bf16 a[124:127], a[184:187], a[252:255], a[124:127]
ds_read_b128 a[184:187], v3 offset:12288
v_mfma_f32_16x16x32_bf16 a[128:131], v[28:31], a[224:227], a[128:131]
v_mfma_f32_16x16x32_bf16 a[132:135], v[28:31], a[228:231], a[132:135]
v_add_u32 v5, 16384, v5
v_and_b32 v5, 65535, v5
v_xor_b32 v6, 16, v5
v_mfma_f32_16x16x32_bf16 a[136:139], v[28:31], a[232:235], a[136:139]
v_xor_b32 v7, 64, v5
v_xor_b32 v8, 80, v5
v_xor_b32 v9, 128, v5
v_mfma_f32_16x16x32_bf16 a[140:143], v[28:31], a[236:239], a[140:143]
s_add_u32 s48, s48, s34
v_xor_b32 v10, 144, v5
v_xor_b32 v11, 192, v5
v_mfma_f32_16x16x32_bf16 a[144:147], v[28:31], a[240:243], a[144:147]
s_add_u32 m0, s32, 12288
v_xor_b32 v12, 208, v5
v_mfma_f32_16x16x32_bf16 a[148:151], v[28:31], a[244:247], a[148:151]
buffer_load_dwordx4 v1, s[12:15], s48 offen lds
v_mfma_f32_16x16x32_bf16 a[152:155], v[28:31], a[248:251], a[152:155]
v_mfma_f32_16x16x32_bf16 a[156:159], v[28:31], a[252:255], a[156:159]
s_waitcnt vmcnt(21) lgkmcnt(0)
s_barrier
v_mfma_f32_16x16x32_bf16 v[160:163], a[160:163], a[192:195], v[160:163]
ds_read_b64_tr_b16 a[224:225], v5 offset:0
v_mfma_f32_16x16x32_bf16 v[164:167], a[160:163], a[196:199], v[164:167]
v_mfma_f32_16x16x32_bf16 v[168:171], a[160:163], a[200:203], v[168:171]
ds_read_b64_tr_b16 a[226:227], v5 offset:1024
v_mfma_f32_16x16x32_bf16 v[172:175], a[160:163], a[204:207], v[172:175]
s_add_u32 s37, s31, 0
v_mfma_f32_16x16x32_bf16 v[176:179], a[160:163], a[208:211], v[176:179]
s_add_u32 m0, s33, 0
ds_read_b64_tr_b16 a[228:229], v6 offset:0
v_mfma_f32_16x16x32_bf16 v[180:183], a[160:163], a[212:215], v[180:183]
buffer_load_dwordx4 v2, s[20:23], s37 offen  lds
v_mfma_f32_16x16x32_bf16 v[184:187], a[160:163], a[216:219], v[184:187]
ds_read_b64_tr_b16 a[230:231], v6 offset:1024
v_mfma_f32_16x16x32_bf16 v[188:191], a[160:163], a[220:223], v[188:191]
ds_read_b128 a[160:163], v4 offset:0
s_add_u32 s60, s60, s92
v_mfma_f32_16x16x32_bf16 v[192:195], a[164:167], a[192:195], v[192:195]
s_mov_b32 s29, s60
ds_read_b64_tr_b16 a[232:233], v7 offset:0
v_mfma_f32_16x16x32_bf16 v[196:199], a[164:167], a[196:199], v[196:199]
buffer_store_dwordx4 v[64:67], v13, s[8:11], s29 offen sc1
v_mfma_f32_16x16x32_bf16 v[200:203], a[164:167], a[200:203], v[200:203]
ds_read_b64_tr_b16 a[234:235], v7 offset:1024
v_mfma_f32_16x16x32_bf16 v[204:207], a[164:167], a[204:207], v[204:207]
s_add_u32 s37, s31, 32768
v_mfma_f32_16x16x32_bf16 v[208:211], a[164:167], a[208:211], v[208:211]
s_add_u32 m0, s33, 1024
ds_read_b64_tr_b16 a[236:237], v8 offset:0
v_mfma_f32_16x16x32_bf16 v[212:215], a[164:167], a[212:215], v[212:215]
buffer_load_dwordx4 v2, s[20:23], s37 offen  lds
v_mfma_f32_16x16x32_bf16 v[216:219], a[164:167], a[216:219], v[216:219]
ds_read_b64_tr_b16 a[238:239], v8 offset:1024
v_mfma_f32_16x16x32_bf16 v[220:223], a[164:167], a[220:223], v[220:223]
ds_read_b128 a[164:167], v3 offset:1024
v_mfma_f32_16x16x32_bf16 v[224:227], a[168:171], a[192:195], v[224:227]
ds_read_b64_tr_b16 a[240:241], v9 offset:0
v_mfma_f32_16x16x32_bf16 v[228:231], a[168:171], a[196:199], v[228:231]
v_mfma_f32_16x16x32_bf16 v[232:235], a[168:171], a[200:203], v[232:235]
ds_read_b64_tr_b16 a[242:243], v9 offset:1024
v_mfma_f32_16x16x32_bf16 v[236:239], a[168:171], a[204:207], v[236:239]
s_add_u32 s37, s31, 131072
v_mfma_f32_16x16x32_bf16 v[240:243], a[168:171], a[208:211], v[240:243]
s_add_u32 m0, s33, 4096
ds_read_b64_tr_b16 a[244:245], v10 offset:0
v_mfma_f32_16x16x32_bf16 v[244:247], a[168:171], a[212:215], v[244:247]
buffer_load_dwordx4 v2, s[20:23], s37 offen  lds
v_mfma_f32_16x16x32_bf16 v[248:251], a[168:171], a[216:219], v[248:251]
ds_read_b64_tr_b16 a[246:247], v10 offset:1024
v_mfma_f32_16x16x32_bf16 v[252:255], a[168:171], a[220:223], v[252:255]
ds_read_b128 a[168:171], v4 offset:4096
v_mfma_f32_16x16x32_bf16 a[0:3], a[172:175], a[192:195], a[0:3]
ds_read_b64_tr_b16 a[248:249], v11 offset:0
v_mfma_f32_16x16x32_bf16 a[4:7], a[172:175], a[196:199], a[4:7]
v_mfma_f32_16x16x32_bf16 a[8:11], a[172:175], a[200:203], a[8:11]
ds_read_b64_tr_b16 a[250:251], v11 offset:1024
v_mfma_f32_16x16x32_bf16 a[12:15], a[172:175], a[204:207], a[12:15]
s_add_u32 s37, s31, 163840
v_mfma_f32_16x16x32_bf16 a[16:19], a[172:175], a[208:211], a[16:19]
s_add_u32 m0, s33, 5120
ds_read_b64_tr_b16 a[252:253], v12 offset:0
v_mfma_f32_16x16x32_bf16 a[20:23], a[172:175], a[212:215], a[20:23]
buffer_load_dwordx4 v2, s[20:23], s37 offen  lds
v_mfma_f32_16x16x32_bf16 a[24:27], a[172:175], a[216:219], a[24:27]
ds_read_b64_tr_b16 a[254:255], v12 offset:1024
v_mfma_f32_16x16x32_bf16 a[28:31], a[172:175], a[220:223], a[28:31]
ds_read_b128 a[172:175], v3 offset:5120
s_add_u32 s29, s29, s44
v_mfma_f32_16x16x32_bf16 a[32:35], a[176:179], a[192:195], a[32:35]
s_add_u32 s31, s31, 262144
s_add_u32 s33, s33, 16384
v_mfma_f32_16x16x32_bf16 a[36:39], a[176:179], a[196:199], a[36:39]
s_and_b32 s33, s33, 65535
buffer_store_dwordx4 v[68:71], v13, s[8:11], s29 offen sc1
v_mfma_f32_16x16x32_bf16 a[40:43], a[176:179], a[200:203], a[40:43]
ds_read_b128 v[28:31], v3 offset:13312
v_mfma_f32_16x16x32_bf16 a[44:47], a[176:179], a[204:207], a[44:47]
s_add_u32 s48, s48, s34
v_mfma_f32_16x16x32_bf16 a[48:51], a[176:179], a[208:211], a[48:51]
s_add_u32 m0, s32, 16384
v_mfma_f32_16x16x32_bf16 a[52:55], a[176:179], a[212:215], a[52:55]
buffer_load_dwordx4 v1, s[12:15], s48 offen lds
v_mfma_f32_16x16x32_bf16 a[56:59], a[176:179], a[216:219], a[56:59]
v_mfma_f32_16x16x32_bf16 a[60:63], a[176:179], a[220:223], a[60:63]
ds_read_b128 a[176:179], v4 offset:8192
v_mfma_f32_16x16x32_bf16 a[64:67], a[180:183], a[192:195], a[64:67]
v_mfma_f32_16x16x32_bf16 a[68:71], a[180:183], a[196:199], a[68:71]
v_mfma_f32_16x16x32_bf16 a[72:75], a[180:183], a[200:203], a[72:75]
v_mfma_f32_16x16x32_bf16 a[76:79], a[180:183], a[204:207], a[76:79]
s_add_u32 s48, s48, s34
v_mfma_f32_16x16x32_bf16 a[80:83], a[180:183], a[208:211], a[80:83]
s_add_u32 m0, s32, 20480
v_mfma_f32_16x16x32_bf16 a[84:87], a[180:183], a[212:215], a[84:87]
buffer_load_dwordx4 v1, s[12:15], s48 offen lds
v_mfma_f32_16x16x32_bf16 a[88:91], a[180:183], a[216:219], a[88:91]
v_mfma_f32_16x16x32_bf16 a[92:95], a[180:183], a[220:223], a[92:95]
ds_read_b128 a[180:183], v3 offset:9216
v_mfma_f32_16x16x32_bf16 a[96:99], a[184:187], a[192:195], a[96:99]
v_mfma_f32_16x16x32_bf16 a[100:103], a[184:187], a[196:199], a[100:103]
v_mfma_f32_16x16x32_bf16 a[104:107], a[184:187], a[200:203], a[104:107]
v_mfma_f32_16x16x32_bf16 a[108:111], a[184:187], a[204:207], a[108:111]
s_add_u32 s48, s48, s34
v_mfma_f32_16x16x32_bf16 a[112:115], a[184:187], a[208:211], a[112:115]
s_add_u32 m0, s32, 24576
v_mfma_f32_16x16x32_bf16 a[116:119], a[184:187], a[212:215], a[116:119]
buffer_load_dwordx4 v1, s[12:15], s48 offen lds
v_mfma_f32_16x16x32_bf16 a[120:123], a[184:187], a[216:219], a[120:123]
v_mfma_f32_16x16x32_bf16 a[124:127], a[184:187], a[220:223], a[124:127]
ds_read_b128 a[184:187], v4 offset:12288
s_add_u32 s29, s29, s93
v_mfma_f32_16x16x32_bf16 a[128:131], a[188:191], a[192:195], a[128:131]
v_mfma_f32_16x16x32_bf16 a[132:135], a[188:191], a[196:199], a[132:135]
buffer_store_dwordx4 v[72:75], v13, s[8:11], s29 offen sc1
v_add_u32 v3, 32768, v3
v_subrev_u32 v19, 98304, v3
v_mfma_f32_16x16x32_bf16 a[136:139], a[188:191], a[200:203], a[136:139]
v_cmp_le_u32 vcc, 163840, v3
v_add_u32 v5, 16384, v5
v_and_b32 v5, 65535, v5
v_mfma_f32_16x16x32_bf16 a[140:143], a[188:191], a[204:207], a[140:143]
s_add_u32 s48, s48, s34
v_xor_b32 v6, 16, v5
v_xor_b32 v7, 64, v5
v_mfma_f32_16x16x32_bf16 a[144:147], a[188:191], a[208:211], a[144:147]
s_add_u32 m0, s32, 28672
v_xor_b32 v8, 80, v5
v_xor_b32 v9, 128, v5
v_mfma_f32_16x16x32_bf16 a[148:151], a[188:191], a[212:215], a[148:151]
buffer_load_dwordx4 v1, s[12:15], s48 offen lds
v_xor_b32 v10, 144, v5
v_xor_b32 v11, 192, v5
v_mfma_f32_16x16x32_bf16 a[152:155], a[188:191], a[216:219], a[152:155]
s_add_u32 s30, s30, 128
s_add_u32 s32, s32, 32768
s_sub_u32 s48, s32, 98304
v_mfma_f32_16x16x32_bf16 a[156:159], a[188:191], a[220:223], a[156:159]
s_cmp_ge_u32 s32, 163840
s_cselect_b32 s32, s48, s32
v_xor_b32 v12, 208, v5
v_cndmask_b32 v3, v3, v19, vcc
v_xor_b32 v4, 64, v3
s_waitcnt vmcnt(21) lgkmcnt(0)
s_barrier
v_mfma_f32_16x16x32_bf16 v[160:163], a[160:163], a[224:227], v[160:163]
ds_read_b64_tr_b16 a[192:193], v5 offset:0
v_mfma_f32_16x16x32_bf16 v[164:167], a[160:163], a[228:231], v[164:167]
v_mfma_f32_16x16x32_bf16 v[168:171], a[160:163], a[232:235], v[168:171]
ds_read_b64_tr_b16 a[194:195], v5 offset:1024
v_mfma_f32_16x16x32_bf16 v[172:175], a[160:163], a[236:239], v[172:175]
s_add_u32 s37, s31, 0
v_mfma_f32_16x16x32_bf16 v[176:179], a[160:163], a[240:243], v[176:179]
s_add_u32 m0, s33, 0
ds_read_b64_tr_b16 a[196:197], v6 offset:0
v_mfma_f32_16x16x32_bf16 v[180:183], a[160:163], a[244:247], v[180:183]
buffer_load_dwordx4 v2, s[20:23], s37 offen  lds
v_mfma_f32_16x16x32_bf16 v[184:187], a[160:163], a[248:251], v[184:187]
ds_read_b64_tr_b16 a[198:199], v6 offset:1024
v_mfma_f32_16x16x32_bf16 v[188:191], a[160:163], a[252:255], v[188:191]
ds_read_b128 a[160:163], v3 offset:0
s_add_u32 s29, s29, s44
v_mfma_f32_16x16x32_bf16 v[192:195], a[164:167], a[224:227], v[192:195]
ds_read_b64_tr_b16 a[200:201], v7 offset:0
v_mfma_f32_16x16x32_bf16 v[196:199], a[164:167], a[228:231], v[196:199]
buffer_store_dwordx4 v[76:79], v13, s[8:11], s29 offen sc1
v_mfma_f32_16x16x32_bf16 v[200:203], a[164:167], a[232:235], v[200:203]
ds_read_b64_tr_b16 a[202:203], v7 offset:1024
v_mfma_f32_16x16x32_bf16 v[204:207], a[164:167], a[236:239], v[204:207]
s_add_u32 s37, s31, 32768
v_mfma_f32_16x16x32_bf16 v[208:211], a[164:167], a[240:243], v[208:211]
s_add_u32 m0, s33, 1024
ds_read_b64_tr_b16 a[204:205], v8 offset:0
v_mfma_f32_16x16x32_bf16 v[212:215], a[164:167], a[244:247], v[212:215]
buffer_load_dwordx4 v2, s[20:23], s37 offen  lds
v_mfma_f32_16x16x32_bf16 v[216:219], a[164:167], a[248:251], v[216:219]
ds_read_b64_tr_b16 a[206:207], v8 offset:1024
v_mfma_f32_16x16x32_bf16 v[220:223], a[164:167], a[252:255], v[220:223]
ds_read_b128 a[164:167], v4 offset:1024
v_mfma_f32_16x16x32_bf16 v[224:227], a[168:171], a[224:227], v[224:227]
ds_read_b64_tr_b16 a[208:209], v9 offset:0
v_mfma_f32_16x16x32_bf16 v[228:231], a[168:171], a[228:231], v[228:231]
v_mfma_f32_16x16x32_bf16 v[232:235], a[168:171], a[232:235], v[232:235]
ds_read_b64_tr_b16 a[210:211], v9 offset:1024
v_mfma_f32_16x16x32_bf16 v[236:239], a[168:171], a[236:239], v[236:239]
s_add_u32 s37, s31, 131072
v_mfma_f32_16x16x32_bf16 v[240:243], a[168:171], a[240:243], v[240:243]
s_add_u32 m0, s33, 4096
ds_read_b64_tr_b16 a[212:213], v10 offset:0
v_mfma_f32_16x16x32_bf16 v[244:247], a[168:171], a[244:247], v[244:247]
buffer_load_dwordx4 v2, s[20:23], s37 offen  lds
v_mfma_f32_16x16x32_bf16 v[248:251], a[168:171], a[248:251], v[248:251]
ds_read_b64_tr_b16 a[214:215], v10 offset:1024
v_mfma_f32_16x16x32_bf16 v[252:255], a[168:171], a[252:255], v[252:255]
ds_read_b128 a[168:171], v3 offset:4096
v_mfma_f32_16x16x32_bf16 a[0:3], a[172:175], a[224:227], a[0:3]
ds_read_b64_tr_b16 a[216:217], v11 offset:0
v_mfma_f32_16x16x32_bf16 a[4:7], a[172:175], a[228:231], a[4:7]
v_mfma_f32_16x16x32_bf16 a[8:11], a[172:175], a[232:235], a[8:11]
ds_read_b64_tr_b16 a[218:219], v11 offset:1024
v_mfma_f32_16x16x32_bf16 a[12:15], a[172:175], a[236:239], a[12:15]
s_add_u32 s37, s31, 163840
v_mfma_f32_16x16x32_bf16 a[16:19], a[172:175], a[240:243], a[16:19]
s_add_u32 m0, s33, 5120
ds_read_b64_tr_b16 a[220:221], v12 offset:0
v_mfma_f32_16x16x32_bf16 a[20:23], a[172:175], a[244:247], a[20:23]
buffer_load_dwordx4 v2, s[20:23], s37 offen  lds
v_mfma_f32_16x16x32_bf16 a[24:27], a[172:175], a[248:251], a[24:27]
ds_read_b64_tr_b16 a[222:223], v12 offset:1024
v_mfma_f32_16x16x32_bf16 a[28:31], a[172:175], a[252:255], a[28:31]
ds_read_b128 a[172:175], v4 offset:5120
s_add_u32 s29, s29, s93
v_mfma_f32_16x16x32_bf16 a[32:35], a[176:179], a[224:227], a[32:35]
s_add_u32 s31, s31, 262144
s_add_u32 s33, s33, 16384
v_mfma_f32_16x16x32_bf16 a[36:39], a[176:179], a[228:231], a[36:39]
s_and_b32 s33, s33, 65535
buffer_store_dwordx4 v[80:83], v13, s[8:11], s29 offen sc1
v_mfma_f32_16x16x32_bf16 a[40:43], a[176:179], a[232:235], a[40:43]
ds_read_b128 a[188:191], v4 offset:13312
v_mfma_f32_16x16x32_bf16 a[44:47], a[176:179], a[236:239], a[44:47]
s_mov_b32 s48, s30
v_mfma_f32_16x16x32_bf16 a[48:51], a[176:179], a[240:243], a[48:51]
s_add_u32 m0, s32, 0
v_mfma_f32_16x16x32_bf16 a[52:55], a[176:179], a[244:247], a[52:55]
buffer_load_dwordx4 v1, s[12:15], s48 offen lds
v_mfma_f32_16x16x32_bf16 a[56:59], a[176:179], a[248:251], a[56:59]
v_mfma_f32_16x16x32_bf16 a[60:63], a[176:179], a[252:255], a[60:63]
ds_read_b128 a[176:179], v3 offset:8192
v_mfma_f32_16x16x32_bf16 a[64:67], a[180:183], a[224:227], a[64:67]
v_mfma_f32_16x16x32_bf16 a[68:71], a[180:183], a[228:231], a[68:71]
v_mfma_f32_16x16x32_bf16 a[72:75], a[180:183], a[232:235], a[72:75]
v_mfma_f32_16x16x32_bf16 a[76:79], a[180:183], a[236:239], a[76:79]
s_add_u32 s48, s48, s34
v_mfma_f32_16x16x32_bf16 a[80:83], a[180:183], a[240:243], a[80:83]
s_add_u32 m0, s32, 4096
v_mfma_f32_16x16x32_bf16 a[84:87], a[180:183], a[244:247], a[84:87]
buffer_load_dwordx4 v1, s[12:15], s48 offen lds
v_mfma_f32_16x16x32_bf16 a[88:91], a[180:183], a[248:251], a[88:91]
v_mfma_f32_16x16x32_bf16 a[92:95], a[180:183], a[252:255], a[92:95]
ds_read_b128 a[180:183], v4 offset:9216
v_mfma_f32_16x16x32_bf16 a[96:99], a[184:187], a[224:227], a[96:99]
v_mfma_f32_16x16x32_bf16 a[100:103], a[184:187], a[228:231], a[100:103]
v_mfma_f32_16x16x32_bf16 a[104:107], a[184:187], a[232:235], a[104:107]
v_mfma_f32_16x16x32_bf16 a[108:111], a[184:187], a[236:239], a[108:111]
s_add_u32 s48, s48, s34
v_mfma_f32_16x16x32_bf16 a[112:115], a[184:187], a[240:243], a[112:115]
s_add_u32 m0, s32, 8192
v_mfma_f32_16x16x32_bf16 a[116:119], a[184:187], a[244:247], a[116:119]
buffer_load_dwordx4 v1, s[12:15], s48 offen lds
v_mfma_f32_16x16x32_bf16 a[120:123], a[184:187], a[248:251], a[120:123]
v_mfma_f32_16x16x32_bf16 a[124:127], a[184:187], a[252:255], a[124:127]
ds_read_b128 a[184:187], v3 offset:12288
s_add_u32 s29, s29, s44
v_mfma_f32_16x16x32_bf16 a[128:131], v[28:31], a[224:227], a[128:131]
v_mfma_f32_16x16x32_bf16 a[132:135], v[28:31], a[228:231], a[132:135]
buffer_store_dwordx4 v[84:87], v13, s[8:11], s29 offen sc1
v_add_u32 v5, 16384, v5
v_and_b32 v5, 65535, v5
v_mfma_f32_16x16x32_bf16 a[136:139], v[28:31], a[232:235], a[136:139]
v_xor_b32 v6, 16, v5
v_xor_b32 v7, 64, v5
v_xor_b32 v8, 80, v5
v_mfma_f32_16x16x32_bf16 a[140:143], v[28:31], a[236:239], a[140:143]
s_add_u32 s48, s48, s34
v_xor_b32 v9, 128, v5
v_xor_b32 v10, 144, v5
v_mfma_f32_16x16x32_bf16 a[144:147], v[28:31], a[240:243], a[144:147]
s_add_u32 m0, s32, 12288
v_xor_b32 v11, 192, v5
v_xor_b32 v12, 208, v5
v_mfma_f32_16x16x32_bf16 a[148:151], v[28:31], a[244:247], a[148:151]
buffer_load_dwordx4 v1, s[12:15], s48 offen lds
v_mfma_f32_16x16x32_bf16 a[152:155], v[28:31], a[248:251], a[152:155]
v_mfma_f32_16x16x32_bf16 a[156:159], v[28:31], a[252:255], a[156:159]
s_waitcnt vmcnt(22) lgkmcnt(0)
s_barrier
v_mfma_f32_16x16x32_bf16 v[160:163], a[160:163], a[192:195], v[160:163]
ds_read_b64_tr_b16 a[224:225], v5 offset:0
v_mfma_f32_16x16x32_bf16 v[164:167], a[160:163], a[196:199], v[164:167]
v_mfma_f32_16x16x32_bf16 v[168:171], a[160:163], a[200:203], v[168:171]
ds_read_b64_tr_b16 a[226:227], v5 offset:1024
v_mfma_f32_16x16x32_bf16 v[172:175], a[160:163], a[204:207], v[172:175]
s_add_u32 s37, s31, 0
v_mfma_f32_16x16x32_bf16 v[176:179], a[160:163], a[208:211], v[176:179]
s_add_u32 m0, s33, 0
ds_read_b64_tr_b16 a[228:229], v6 offset:0
v_mfma_f32_16x16x32_bf16 v[180:183], a[160:163], a[212:215], v[180:183]
buffer_load_dwordx4 v2, s[20:23], s37 offen  lds
v_mfma_f32_16x16x32_bf16 v[184:187], a[160:163], a[216:219], v[184:187]
ds_read_b64_tr_b16 a[230:231], v6 offset:1024
v_mfma_f32_16x16x32_bf16 v[188:191], a[160:163], a[220:223], v[188:191]
ds_read_b128 a[160:163], v4 offset:0
s_add_u32 s29, s29, s93
v_mfma_f32_16x16x32_bf16 v[192:195], a[164:167], a[192:195], v[192:195]
ds_read_b64_tr_b16 a[232:233], v7 offset:0
v_mfma_f32_16x16x32_bf16 v[196:199], a[164:167], a[196:199], v[196:199]
buffer_store_dwordx4 v[88:91], v13, s[8:11], s29 offen sc1
v_mfma_f32_16x16x32_bf16 v[200:203], a[164:167], a[200:203], v[200:203]
ds_read_b64_tr_b16 a[234:235], v7 offset:1024
v_mfma_f32_16x16x32_bf16 v[204:207], a[164:167], a[204:207], v[204:207]
s_add_u32 s37, s31, 32768
v_mfma_f32_16x16x32_bf16 v[208:211], a[164:167], a[208:211], v[208:211]
s_add_u32 m0, s33, 1024
ds_read_b64_tr_b16 a[236:237], v8 offset:0
v_mfma_f32_16x16x32_bf16 v[212:215], a[164:167], a[212:215], v[212:215]
buffer_load_dwordx4 v2, s[20:23], s37 offen  lds
v_mfma_f32_16x16x32_bf16 v[216:219], a[164:167], a[216:219], v[216:219]
ds_read_b64_tr_b16 a[238:239], v8 offset:1024
v_mfma_f32_16x16x32_bf16 v[220:223], a[164:167], a[220:223], v[220:223]
ds_read_b128 a[164:167], v3 offset:1024
v_mfma_f32_16x16x32_bf16 v[224:227], a[168:171], a[192:195], v[224:227]
ds_read_b64_tr_b16 a[240:241], v9 offset:0
v_mfma_f32_16x16x32_bf16 v[228:231], a[168:171], a[196:199], v[228:231]
v_mfma_f32_16x16x32_bf16 v[232:235], a[168:171], a[200:203], v[232:235]
ds_read_b64_tr_b16 a[242:243], v9 offset:1024
v_mfma_f32_16x16x32_bf16 v[236:239], a[168:171], a[204:207], v[236:239]
s_add_u32 s37, s31, 131072
v_mfma_f32_16x16x32_bf16 v[240:243], a[168:171], a[208:211], v[240:243]
s_add_u32 m0, s33, 4096
ds_read_b64_tr_b16 a[244:245], v10 offset:0
v_mfma_f32_16x16x32_bf16 v[244:247], a[168:171], a[212:215], v[244:247]
buffer_load_dwordx4 v2, s[20:23], s37 offen  lds
v_mfma_f32_16x16x32_bf16 v[248:251], a[168:171], a[216:219], v[248:251]
ds_read_b64_tr_b16 a[246:247], v10 offset:1024
v_mfma_f32_16x16x32_bf16 v[252:255], a[168:171], a[220:223], v[252:255]
ds_read_b128 a[168:171], v4 offset:4096
v_mfma_f32_16x16x32_bf16 a[0:3], a[172:175], a[192:195], a[0:3]
ds_read_b64_tr_b16 a[248:249], v11 offset:0
v_mfma_f32_16x16x32_bf16 a[4:7], a[172:175], a[196:199], a[4:7]
v_mfma_f32_16x16x32_bf16 a[8:11], a[172:175], a[200:203], a[8:11]
ds_read_b64_tr_b16 a[250:251], v11 offset:1024
v_mfma_f32_16x16x32_bf16 a[12:15], a[172:175], a[204:207], a[12:15]
s_add_u32 s37, s31, 163840
v_mfma_f32_16x16x32_bf16 a[16:19], a[172:175], a[208:211], a[16:19]
s_add_u32 m0, s33, 5120
ds_read_b64_tr_b16 a[252:253], v12 offset:0
v_mfma_f32_16x16x32_bf16 a[20:23], a[172:175], a[212:215], a[20:23]
buffer_load_dwordx4 v2, s[20:23], s37 offen  lds
v_mfma_f32_16x16x32_bf16 a[24:27], a[172:175], a[216:219], a[24:27]
ds_read_b64_tr_b16 a[254:255], v12 offset:1024
v_mfma_f32_16x16x32_bf16 a[28:31], a[172:175], a[220:223], a[28:31]
ds_read_b128 a[172:175], v3 offset:5120
s_add_u32 s29, s29, s44
v_mfma_f32_16x16x32_bf16 a[32:35], a[176:179], a[192:195], a[32:35]
s_add_u32 s31, s31, 262144
s_add_u32 s33, s33, 16384
v_mfma_f32_16x16x32_bf16 a[36:39], a[176:179], a[196:199], a[36:39]
s_and_b32 s33, s33, 65535
buffer_store_dwordx4 v[92:95], v13, s[8:11], s29 offen sc1
v_mfma_f32_16x16x32_bf16 a[40:43], a[176:179], a[200:203], a[40:43]
ds_read_b128 v[28:31], v3 offset:13312
v_mfma_f32_16x16x32_bf16 a[44:47], a[176:179], a[204:207], a[44:47]
s_add_u32 s48, s48, s34
v_mfma_f32_16x16x32_bf16 a[48:51], a[176:179], a[208:211], a[48:51]
s_add_u32 m0, s32, 16384
v_mfma_f32_16x16x32_bf16 a[52:55], a[176:179], a[212:215], a[52:55]
buffer_load_dwordx4 v1, s[12:15], s48 offen lds
v_mfma_f32_16x16x32_bf16 a[56:59], a[176:179], a[216:219], a[56:59]
v_mfma_f32_16x16x32_bf16 a[60:63], a[176:179], a[220:223], a[60:63]
ds_read_b128 a[176:179], v4 offset:8192
v_mfma_f32_16x16x32_bf16 a[64:67], a[180:183], a[192:195], a[64:67]
v_mfma_f32_16x16x32_bf16 a[68:71], a[180:183], a[196:199], a[68:71]
v_mfma_f32_16x16x32_bf16 a[72:75], a[180:183], a[200:203], a[72:75]
v_mfma_f32_16x16x32_bf16 a[76:79], a[180:183], a[204:207], a[76:79]
s_add_u32 s48, s48, s34
v_mfma_f32_16x16x32_bf16 a[80:83], a[180:183], a[208:211], a[80:83]
s_add_u32 m0, s32, 20480
v_mfma_f32_16x16x32_bf16 a[84:87], a[180:183], a[212:215], a[84:87]
buffer_load_dwordx4 v1, s[12:15], s48 offen lds
v_mfma_f32_16x16x32_bf16 a[88:91], a[180:183], a[216:219], a[88:91]
buffer_load_dword v15, v14, s[96:99], s100 offen
s_add_u32 s100, s100, 8192
v_mfma_f32_16x16x32_bf16 a[92:95], a[180:183], a[220:223], a[92:95]
ds_read_b128 a[180:183], v3 offset:9216
v_mfma_f32_16x16x32_bf16 a[96:99], a[184:187], a[192:195], a[96:99]
v_mfma_f32_16x16x32_bf16 a[100:103], a[184:187], a[196:199], a[100:103]
v_mfma_f32_16x16x32_bf16 a[104:107], a[184:187], a[200:203], a[104:107]
v_mfma_f32_16x16x32_bf16 a[108:111], a[184:187], a[204:207], a[108:111]
s_add_u32 s48, s48, s34
v_mfma_f32_16x16x32_bf16 a[112:115], a[184:187], a[208:211], a[112:115]
s_add_u32 m0, s32, 24576
v_mfma_f32_16x16x32_bf16 a[116:119], a[184:187], a[212:215], a[116:119]
buffer_load_dwordx4 v1, s[12:15], s48 offen lds
v_mfma_f32_16x16x32_bf16 a[120:123], a[184:187], a[216:219], a[120:123]
v_mfma_f32_16x16x32_bf16 a[124:127], a[184:187], a[220:223], a[124:127]
ds_read_b128 a[184:187], v4 offset:12288
v_mfma_f32_16x16x32_bf16 a[128:131], a[188:191], a[192:195], a[128:131]
v_mfma_f32_16x16x32_bf16 a[132:135], a[188:191], a[196:199], a[132:135]
v_add_u32 v3, 32768, v3
v_subrev_u32 v19, 98304, v3
v_cmp_le_u32 vcc, 163840, v3
v_mfma_f32_16x16x32_bf16 a[136:139], a[188:191], a[200:203], a[136:139]
v_add_u32 v5, 16384, v5
v_and_b32 v5, 65535, v5
v_xor_b32 v6, 16, v5
v_mfma_f32_16x16x32_bf16 a[140:143], a[188:191], a[204:207], a[140:143]
s_add_u32 s48, s48, s34
v_xor_b32 v7, 64, v5
v_xor_b32 v8, 80, v5
v_mfma_f32_16x16x32_bf16 a[144:147], a[188:191], a[208:211], a[144:147]
s_add_u32 m0, s32, 28672
v_xor_b32 v9, 128, v5
v_xor_b32 v10, 144, v5
v_mfma_f32_16x16x32_bf16 a[148:151], a[188:191], a[212:215], a[148:151]
buffer_load_dwordx4 v1, s[12:15], s48 offen lds
v_xor_b32 v11, 192, v5
v_xor_b32 v12, 208, v5
v_mfma_f32_16x16x32_bf16 a[152:155], a[188:191], a[216:219], a[152:155]
s_add_u32 s30, s30, 128
s_add_u32 s32, s32, 32768
s_sub_u32 s48, s32, 98304
v_mfma_f32_16x16x32_bf16 a[156:159], a[188:191], a[220:223], a[156:159]
s_cmp_ge_u32 s32, 163840
s_cselect_b32 s32, s48, s32
v_cndmask_b32 v3, v3, v19, vcc
v_xor_b32 v4, 64, v3
s_waitcnt vmcnt(22) lgkmcnt(0)
s_barrier
v_mfma_f32_16x16x32_bf16 v[160:163], a[160:163], a[224:227], v[160:163]
ds_read_b64_tr_b16 a[192:193], v5 offset:0
v_mfma_f32_16x16x32_bf16 v[164:167], a[160:163], a[228:231], v[164:167]
v_mfma_f32_16x16x32_bf16 v[168:171], a[160:163], a[232:235], v[168:171]
ds_read_b64_tr_b16 a[194:195], v5 offset:1024
v_mfma_f32_16x16x32_bf16 v[172:175], a[160:163], a[236:239], v[172:175]
s_add_u32 s37, s31, 0
v_mfma_f32_16x16x32_bf16 v[176:179], a[160:163], a[240:243], v[176:179]
s_add_u32 m0, s33, 0
ds_read_b64_tr_b16 a[196:197], v6 offset:0
v_mfma_f32_16x16x32_bf16 v[180:183], a[160:163], a[244:247], v[180:183]
buffer_load_dwordx4 v2, s[20:23], s37 offen  lds
v_mfma_f32_16x16x32_bf16 v[184:187], a[160:163], a[248:251], v[184:187]
ds_read_b64_tr_b16 a[198:199], v6 offset:1024
v_mfma_f32_16x16x32_bf16 v[188:191], a[160:163], a[252:255], v[188:191]
ds_read_b128 a[160:163], v3 offset:0
s_add_u32 s60, s60, s92
v_mfma_f32_16x16x32_bf16 v[192:195], a[164:167], a[224:227], v[192:195]
s_mov_b32 s29, s60
ds_read_b64_tr_b16 a[200:201], v7 offset:0
v_mfma_f32_16x16x32_bf16 v[196:199], a[164:167], a[228:231], v[196:199]
buffer_store_dwordx4 v[96:99], v13, s[8:11], s29 offen sc1
v_mfma_f32_16x16x32_bf16 v[200:203], a[164:167], a[232:235], v[200:203]
ds_read_b64_tr_b16 a[202:203], v7 offset:1024
v_mfma_f32_16x16x32_bf16 v[204:207], a[164:167], a[236:239], v[204:207]
s_add_u32 s37, s31, 32768
v_mfma_f32_16x16x32_bf16 v[208:211], a[164:167], a[240:243], v[208:211]
s_add_u32 m0, s33, 1024
ds_read_b64_tr_b16 a[204:205], v8 offset:0
v_mfma_f32_16x16x32_bf16 v[212:215], a[164:167], a[244:247], v[212:215]
buffer_load_dwordx4 v2, s[20:23], s37 offen  lds
v_mfma_f32_16x16x32_bf16 v[216:219], a[164:167], a[248:251], v[216:219]
ds_read_b64_tr_b16 a[206:207], v8 offset:1024
v_mfma_f32_16x16x32_bf16 v[220:223], a[164:167], a[252:255], v[220:223]
ds_read_b128 a[164:167], v4 offset:1024
v_mfma_f32_16x16x32_bf16 v[224:227], a[168:171], a[224:227], v[224:227]
ds_read_b64_tr_b16 a[208:209], v9 offset:0
v_mfma_f32_16x16x32_bf16 v[228:231], a[168:171], a[228:231], v[228:231]
v_mfma_f32_16x16x32_bf16 v[232:235], a[168:171], a[232:235], v[232:235]
ds_read_b64_tr_b16 a[210:211], v9 offset:1024
v_mfma_f32_16x16x32_bf16 v[236:239], a[168:171], a[236:239], v[236:239]
s_add_u32 s37, s31, 131072
v_mfma_f32_16x16x32_bf16 v[240:243], a[168:171], a[240:243], v[240:243]
s_add_u32 m0, s33, 4096
ds_read_b64_tr_b16 a[212:213], v10 offset:0
v_mfma_f32_16x16x32_bf16 v[244:247], a[168:171], a[244:247], v[244:247]
buffer_load_dwordx4 v2, s[20:23], s37 offen  lds
v_mfma_f32_16x16x32_bf16 v[248:251], a[168:171], a[248:251], v[248:251]
ds_read_b64_tr_b16 a[214:215], v10 offset:1024
v_mfma_f32_16x16x32_bf16 v[252:255], a[168:171], a[252:255], v[252:255]
ds_read_b128 a[168:171], v3 offset:4096
v_mfma_f32_16x16x32_bf16 a[0:3], a[172:175], a[224:227], a[0:3]
ds_read_b64_tr_b16 a[216:217], v11 offset:0
v_mfma_f32_16x16x32_bf16 a[4:7], a[172:175], a[228:231], a[4:7]
v_mfma_f32_16x16x32_bf16 a[8:11], a[172:175], a[232:235], a[8:11]
ds_read_b64_tr_b16 a[218:219], v11 offset:1024
v_mfma_f32_16x16x32_bf16 a[12:15], a[172:175], a[236:239], a[12:15]
s_add_u32 s37, s31, 163840
v_mfma_f32_16x16x32_bf16 a[16:19], a[172:175], a[240:243], a[16:19]
s_add_u32 m0, s33, 5120
ds_read_b64_tr_b16 a[220:221], v12 offset:0
v_mfma_f32_16x16x32_bf16 a[20:23], a[172:175], a[244:247], a[20:23]
buffer_load_dwordx4 v2, s[20:23], s37 offen  lds
v_mfma_f32_16x16x32_bf16 a[24:27], a[172:175], a[248:251], a[24:27]
ds_read_b64_tr_b16 a[222:223], v12 offset:1024
v_mfma_f32_16x16x32_bf16 a[28:31], a[172:175], a[252:255], a[28:31]
ds_read_b128 a[172:175], v4 offset:5120
s_add_u32 s29, s29, s44
v_mfma_f32_16x16x32_bf16 a[32:35], a[176:179], a[224:227], a[32:35]
s_add_u32 s31, s31, 262144
s_add_u32 s33, s33, 16384
v_mfma_f32_16x16x32_bf16 a[36:39], a[176:179], a[228:231], a[36:39]
s_and_b32 s33, s33, 65535
buffer_store_dwordx4 v[100:103], v13, s[8:11], s29 offen sc1
v_mfma_f32_16x16x32_bf16 a[40:43], a[176:179], a[232:235], a[40:43]
ds_read_b128 a[188:191], v4 offset:13312
v_mfma_f32_16x16x32_bf16 a[44:47], a[176:179], a[236:239], a[44:47]
s_mov_b32 s48, s30
v_mfma_f32_16x16x32_bf16 a[48:51], a[176:179], a[240:243], a[48:51]
s_add_u32 m0, s32, 0
v_mfma_f32_16x16x32_bf16 a[52:55], a[176:179], a[244:247], a[52:55]
buffer_load_dwordx4 v1, s[12:15], s48 offen lds
v_mfma_f32_16x16x32_bf16 a[56:59], a[176:179], a[248:251], a[56:59]
v_mfma_f32_16x16x32_bf16 a[60:63], a[176:179], a[252:255], a[60:63]
ds_read_b128 a[176:179], v3 offset:8192
v_mfma_f32_16x16x32_bf16 a[64:67], a[180:183], a[224:227], a[64:67]
v_mfma_f32_16x16x32_bf16 a[68:71], a[180:183], a[228:231], a[68:71]
v_mfma_f32_16x16x32_bf16 a[72:75], a[180:183], a[232:235], a[72:75]
v_mfma_f32_16x16x32_bf16 a[76:79], a[180:183], a[236:239], a[76:79]
s_add_u32 s48, s48, s34
v_mfma_f32_16x16x32_bf16 a[80:83], a[180:183], a[240:243], a[80:83]
s_add_u32 m0, s32, 4096
v_mfma_f32_16x16x32_bf16 a[84:87], a[180:183], a[244:247], a[84:87]
buffer_load_dwordx4 v1, s[12:15], s48 offen lds
v_mfma_f32_16x16x32_bf16 a[88:91], a[180:183], a[248:251], a[88:91]
buffer_load_dword v15, v14, s[96:99], s100 offen
s_add_u32 s100, s100, 8192
v_mfma_f32_16x16x32_bf16 a[92:95], a[180:183], a[252:255], a[92:95]
ds_read_b128 a[180:183], v4 offset:9216
v_mfma_f32_16x16x32_bf16 a[96:99], a[184:187], a[224:227], a[96:99]
v_mfma_f32_16x16x32_bf16 a[100:103], a[184:187], a[228:231], a[100:103]
v_mfma_f32_16x16x32_bf16 a[104:107], a[184:187], a[232:235], a[104:107]
v_mfma_f32_16x16x32_bf16 a[108:111], a[184:187], a[236:239], a[108:111]
s_add_u32 s48, s48, s34
v_mfma_f32_16x16x32_bf16 a[112:115], a[184:187], a[240:243], a[112:115]
s_add_u32 m0, s32, 8192
v_mfma_f32_16x16x32_bf16 a[116:119], a[184:187], a[244:247], a[116:119]
buffer_load_dwordx4 v1, s[12:15], s48 offen lds
v_mfma_f32_16x16x32_bf16 a[120:123], a[184:187], a[248:251], a[120:123]
v_mfma_f32_16x16x32_bf16 a[124:127], a[184:187], a[252:255], a[124:127]
ds_read_b128 a[184:187], v3 offset:12288
s_add_u32 s29, s29, s93
v_mfma_f32_16x16x32_bf16 a[128:131], v[28:31], a[224:227], a[128:131]
v_mfma_f32_16x16x32_bf16 a[132:135], v[28:31], a[228:231], a[132:135]
buffer_store_dwordx4 v[104:107], v13, s[8:11], s29 offen sc1
v_add_u32 v5, 16384, v5
v_and_b32 v5, 65535, v5
v_mfma_f32_16x16x32_bf16 a[136:139], v[28:31], a[232:235], a[136:139]
v_xor_b32 v6, 16, v5
v_xor_b32 v7, 64, v5
v_xor_b32 v8, 80, v5
v_mfma_f32_16x16x32_bf16 a[140:143], v[28:31], a[236:239], a[140:143]
s_add_u32 s48, s48, s34
v_xor_b32 v9, 128, v5
v_xor_b32 v10, 144, v5
v_mfma_f32_16x16x32_bf16 a[144:147], v[28:31], a[240:243], a[144:147]
s_add_u32 m0, s32, 12288
v_xor_b32 v11, 192, v5
v_xor_b32 v12, 208, v5
v_mfma_f32_16x16x32_bf16 a[148:151], v[28:31], a[244:247], a[148:151]
buffer_load_dwordx4 v1, s[12:15], s48 offen lds
v_mfma_f32_16x16x32_bf16 a[152:155], v[28:31], a[248:251], a[152:155]
v_mfma_f32_16x16x32_bf16 a[156:159], v[28:31], a[252:255], a[156:159]
s_waitcnt vmcnt(23) lgkmcnt(0)
s_barrier
v_mfma_f32_16x16x32_bf16 v[160:163], a[160:163], a[192:195], v[160:163]
ds_read_b64_tr_b16 a[224:225], v5 offset:0
v_mfma_f32_16x16x32_bf16 v[164:167], a[160:163], a[196:199], v[164:167]
v_mfma_f32_16x16x32_bf16 v[168:171], a[160:163], a[200:203], v[168:171]
ds_read_b64_tr_b16 a[226:227], v5 offset:1024
v_mfma_f32_16x16x32_bf16 v[172:175], a[160:163], a[204:207], v[172:175]
s_add_u32 s37, s31, 0
v_mfma_f32_16x16x32_bf16 v[176:179], a[160:163], a[208:211], v[176:179]
s_add_u32 m0, s33, 0
ds_read_b64_tr_b16 a[228:229], v6 offset:0
v_mfma_f32_16x16x32_bf16 v[180:183], a[160:163], a[212:215], v[180:183]
buffer_load_dwordx4 v2, s[20:23], s37 offen  lds
v_mfma_f32_16x16x32_bf16 v[184:187], a[160:163], a[216:219], v[184:187]
ds_read_b64_tr_b16 a[230:231], v6 offset:1024
v_mfma_f32_16x16x32_bf16 v[188:191], a[160:163], a[220:223], v[188:191]
ds_read_b128 a[160:163], v4 offset:0
s_add_u32 s29, s29, s44
v_mfma_f32_16x16x32_bf16 v[192:195], a[164:167], a[192:195], v[192:195]
ds_read_b64_tr_b16 a[232:233], v7 offset:0
v_mfma_f32_16x16x32_bf16 v[196:199], a[164:167], a[196:199], v[196:199]
buffer_store_dwordx4 v[108:111], v13, s[8:11], s29 offen sc1
v_mfma_f32_16x16x32_bf16 v[200:203], a[164:167], a[200:203], v[200:203]
ds_read_b64_tr_b16 a[234:235], v7 offset:1024
v_mfma_f32_16x16x32_bf16 v[204:207], a[164:167], a[204:207], v[204:207]
s_add_u32 s37, s31, 32768
v_mfma_f32_16x16x32_bf16 v[208:211], a[164:167], a[208:211], v[208:211]
s_add_u32 m0, s33, 1024
ds_read_b64_tr_b16 a[236:237], v8 offset:0
v_mfma_f32_16x16x32_bf16 v[212:215], a[164:167], a[212:215], v[212:215]
buffer_load_dwordx4 v2, s[20:23], s37 offen  lds
v_mfma_f32_16x16x32_bf16 v[216:219], a[164:167], a[216:219], v[216:219]
ds_read_b64_tr_b16 a[238:239], v8 offset:1024
v_mfma_f32_16x16x32_bf16 v[220:223], a[164:167], a[220:223], v[220:223]
ds_read_b128 a[164:167], v3 offset:1024
v_mfma_f32_16x16x32_bf16 v[224:227], a[168:171], a[192:195], v[224:227]
ds_read_b64_tr_b16 a[240:241], v9 offset:0
v_mfma_f32_16x16x32_bf16 v[228:231], a[168:171], a[196:199], v[228:231]
v_mfma_f32_16x16x32_bf16 v[232:235], a[168:171], a[200:203], v[232:235]
ds_read_b64_tr_b16 a[242:243], v9 offset:1024
v_mfma_f32_16x16x32_bf16 v[236:239], a[168:171], a[204:207], v[236:239]
s_add_u32 s37, s31, 131072
v_mfma_f32_16x16x32_bf16 v[240:243], a[168:171], a[208:211], v[240:243]
s_add_u32 m0, s33, 4096
ds_read_b64_tr_b16 a[244:245], v10 offset:0
v_mfma_f32_16x16x32_bf16 v[244:247], a[168:171], a[212:215], v[244:247]
buffer_load_dwordx4 v2, s[20:23], s37 offen  lds
v_mfma_f32_16x16x32_bf16 v[248:251], a[168:171], a[216:219], v[248:251]
ds_read_b64_tr_b16 a[246:247], v10 offset:1024
v_mfma_f32_16x16x32_bf16 v[252:255], a[168:171], a[220:223], v[252:255]
ds_read_b128 a[168:171], v4 offset:4096
v_mfma_f32_16x16x32_bf16 a[0:3], a[172:175], a[192:195], a[0:3]
ds_read_b64_tr_b16 a[248:249], v11 offset:0
v_mfma_f32_16x16x32_bf16 a[4:7], a[172:175], a[196:199], a[4:7]
v_mfma_f32_16x16x32_bf16 a[8:11], a[172:175], a[200:203], a[8:11]
ds_read_b64_tr_b16 a[250:251], v11 offset:1024
v_mfma_f32_16x16x32_bf16 a[12:15], a[172:175], a[204:207], a[12:15]
s_add_u32 s37, s31, 163840
v_mfma_f32_16x16x32_bf16 a[16:19], a[172:175], a[208:211], a[16:19]
s_add_u32 m0, s33, 5120
ds_read_b64_tr_b16 a[252:253], v12 offset:0
v_mfma_f32_16x16x32_bf16 a[20:23], a[172:175], a[212:215], a[20:23]
buffer_load_dwordx4 v2, s[20:23], s37 offen  lds
v_mfma_f32_16x16x32_bf16 a[24:27], a[172:175], a[216:219], a[24:27]
ds_read_b64_tr_b16 a[254:255], v12 offset:1024
v_mfma_f32_16x16x32_bf16 a[28:31], a[172:175], a[220:223], a[28:31]
ds_read_b128 a[172:175], v3 offset:5120
s_add_u32 s29, s29, s93
v_mfma_f32_16x16x32_bf16 a[32:35], a[176:179], a[192:195], a[32:35]
s_add_u32 s31, s31, 262144
s_add_u32 s33, s33, 16384
v_mfma_f32_16x16x32_bf16 a[36:39], a[176:179], a[196:199], a[36:39]
s_and_b32 s33, s33, 65535
buffer_store_dwordx4 v[112:115], v13, s[8:11], s29 offen sc1
v_mfma_f32_16x16x32_bf16 a[40:43], a[176:179], a[200:203], a[40:43]
ds_read_b128 v[28:31], v3 offset:13312
v_mfma_f32_16x16x32_bf16 a[44:47], a[176:179], a[204:207], a[44:47]
s_add_u32 s48, s48, s34
v_mfma_f32_16x16x32_bf16 a[48:51], a[176:179], a[208:211], a[48:51]
s_add_u32 m0, s32, 16384
v_mfma_f32_16x16x32_bf16 a[52:55], a[176:179], a[212:215], a[52:55]
buffer_load_dwordx4 v1, s[12:15], s48 offen lds
v_mfma_f32_16x16x32_bf16 a[56:59], a[176:179], a[216:219], a[56:59]
v_mfma_f32_16x16x32_bf16 a[60:63], a[176:179], a[220:223], a[60:63]
ds_read_b128 a[176:179], v4 offset:8192
v_mfma_f32_16x16x32_bf16 a[64:67], a[180:183], a[192:195], a[64:67]
v_mfma_f32_16x16x32_bf16 a[68:71], a[180:183], a[196:199], a[68:71]
v_mfma_f32_16x16x32_bf16 a[72:75], a[180:183], a[200:203], a[72:75]
v_mfma_f32_16x16x32_bf16 a[76:79], a[180:183], a[204:207], a[76:79]
s_add_u32 s48, s48, s34
v_mfma_f32_16x16x32_bf16 a[80:83], a[180:183], a[208:211], a[80:83]
s_add_u32 m0, s32, 20480
v_mfma_f32_16x16x32_bf16 a[84:87], a[180:183], a[212:215], a[84:87]
buffer_load_dwordx4 v1, s[12:15], s48 offen lds
v_mfma_f32_16x16x32_bf16 a[88:91], a[180:183], a[216:219], a[88:91]
buffer_load_dword v15, v14, s[96:99], s100 offen
s_add_u32 s100, s100, 8192
v_mfma_f32_16x16x32_bf16 a[92:95], a[180:183], a[220:223], a[92:95]
ds_read_b128 a[180:183], v3 offset:9216
v_mfma_f32_16x16x32_bf16 a[96:99], a[184:187], a[192:195], a[96:99]
v_mfma_f32_16x16x32_bf16 a[100:103], a[184:187], a[196:199], a[100:103]
v_mfma_f32_16x16x32_bf16 a[104:107], a[184:187], a[200:203], a[104:107]
v_mfma_f32_16x16x32_bf16 a[108:111], a[184:187], a[204:207], a[108:111]
s_add_u32 s48, s48, s34
v_mfma_f32_16x16x32_bf16 a[112:115], a[184:187], a[208:211], a[112:115]
s_add_u32 m0, s32, 24576
v_mfma_f32_16x16x32_bf16 a[116:119], a[184:187], a[212:215], a[116:119]
buffer_load_dwordx4 v1, s[12:15], s48 offen lds
v_mfma_f32_16x16x32_bf16 a[120:123], a[184:187], a[216:219], a[120:123]
v_mfma_f32_16x16x32_bf16 a[124:127], a[184:187], a[220:223], a[124:127]
ds_read_b128 a[184:187], v4 offset:12288
s_add_u32 s29, s29, s44
v_mfma_f32_16x16x32_bf16 a[128:131], a[188:191], a[192:195], a[128:131]
v_mfma_f32_16x16x32_bf16 a[132:135], a[188:191], a[196:199], a[132:135]
buffer_store_dwordx4 v[116:119], v13, s[8:11], s29 offen sc1
v_add_u32 v3, 32768, v3
v_subrev_u32 v19, 98304, v3
v_mfma_f32_16x16x32_bf16 a[136:139], a[188:191], a[200:203], a[136:139]
v_cmp_le_u32 vcc, 163840, v3
v_add_u32 v5, 16384, v5
v_and_b32 v5, 65535, v5
v_mfma_f32_16x16x32_bf16 a[140:143], a[188:191], a[204:207], a[140:143]
s_add_u32 s48, s48, s34
v_xor_b32 v6, 16, v5
v_xor_b32 v7, 64, v5
v_mfma_f32_16x16x32_bf16 a[144:147], a[188:191], a[208:211], a[144:147]
s_add_u32 m0, s32, 28672
v_xor_b32 v8, 80, v5
v_xor_b32 v9, 128, v5
v_mfma_f32_16x16x32_bf16 a[148:151], a[188:191], a[212:215], a[148:151]
buffer_load_dwordx4 v1, s[12:15], s48 offen lds
v_xor_b32 v10, 144, v5
v_xor_b32 v11, 192, v5
v_mfma_f32_16x16x32_bf16 a[152:155], a[188:191], a[216:219], a[152:155]
s_add_u32 s30, s30, 128
s_add_u32 s32, s32, 32768
s_sub_u32 s48, s32, 98304
v_mfma_f32_16x16x32_bf16 a[156:159], a[188:191], a[220:223], a[156:159]
s_cmp_ge_u32 s32, 163840
s_cselect_b32 s32, s48, s32
v_xor_b32 v12, 208, v5
v_cndmask_b32 v3, v3, v19, vcc
v_xor_b32 v4, 64, v3
s_waitcnt vmcnt(24) lgkmcnt(0)
s_barrier
v_mfma_f32_16x16x32_bf16 v[160:163], a[160:163], a[224:227], v[160:163]
ds_read_b64_tr_b16 a[192:193], v5 offset:0
v_mfma_f32_16x16x32_bf16 v[164:167], a[160:163], a[228:231], v[164:167]
v_mfma_f32_16x16x32_bf16 v[168:171], a[160:163], a[232:235], v[168:171]
ds_read_b64_tr_b16 a[194:195], v5 offset:1024
v_mfma_f32_16x16x32_bf16 v[172:175], a[160:163], a[236:239], v[172:175]
s_add_u32 s37, s31, 0
v_mfma_f32_16x16x32_bf16 v[176:179], a[160:163], a[240:243], v[176:179]
s_add_u32 m0, s33, 0
ds_read_b64_tr_b16 a[196:197], v6 offset:0
v_mfma_f32_16x16x32_bf16 v[180:183], a[160:163], a[244:247], v[180:183]
buffer_load_dwordx4 v2, s[20:23], s37 offen  lds
v_mfma_f32_16x16x32_bf16 v[184:187], a[160:163], a[248:251], v[184:187]
ds_read_b64_tr_b16 a[198:199], v6 offset:1024
v_mfma_f32_16x16x32_bf16 v[188:191], a[160:163], a[252:255], v[188:191]
ds_read_b128 a[160:163], v3 offset:0
s_add_u32 s29, s29, s93
v_mfma_f32_16x16x32_bf16 v[192:195], a[164:167], a[224:227], v[192:195]
ds_read_b64_tr_b16 a[200:201], v7 offset:0
v_mfma_f32_16x16x32_bf16 v[196:199], a[164:167], a[228:231], v[196:199]
buffer_store_dwordx4 v[120:123], v13, s[8:11], s29 offen sc1
v_mfma_f32_16x16x32_bf16 v[200:203], a[164:167], a[232:235], v[200:203]
ds_read_b64_tr_b16 a[202:203], v7 offset:1024
v_mfma_f32_16x16x32_bf16 v[204:207], a[164:167], a[236:239], v[204:207]
s_add_u32 s37, s31, 32768
v_mfma_f32_16x16x32_bf16 v[208:211], a[164:167], a[240:243], v[208:211]
s_add_u32 m0, s33, 1024
ds_read_b64_tr_b16 a[204:205], v8 offset:0
v_mfma_f32_16x16x32_bf16 v[212:215], a[164:167], a[244:247], v[212:215]
buffer_load_dwordx4 v2, s[20:23], s37 offen  lds
v_mfma_f32_16x16x32_bf16 v[216:219], a[164:167], a[248:251], v[216:219]
ds_read_b64_tr_b16 a[206:207], v8 offset:1024
v_mfma_f32_16x16x32_bf16 v[220:223], a[164:167], a[252:255], v[220:223]
ds_read_b128 a[164:167], v4 offset:1024
v_mfma_f32_16x16x32_bf16 v[224:227], a[168:171], a[224:227], v[224:227]
ds_read_b64_tr_b16 a[208:209], v9 offset:0
v_mfma_f32_16x16x32_bf16 v[228:231], a[168:171], a[228:231], v[228:231]
v_mfma_f32_16x16x32_bf16 v[232:235], a[168:171], a[232:235], v[232:235]
ds_read_b64_tr_b16 a[210:211], v9 offset:1024
v_mfma_f32_16x16x32_bf16 v[236:239], a[168:171], a[236:239], v[236:239]
s_add_u32 s37, s31, 131072
v_mfma_f32_16x16x32_bf16 v[240:243], a[168:171], a[240:243], v[240:243]
s_add_u32 m0, s33, 4096
ds_read_b64_tr_b16 a[212:213], v10 offset:0
v_mfma_f32_16x16x32_bf16 v[244:247], a[168:171], a[244:247], v[244:247]
buffer_load_dwordx4 v2, s[20:23], s37 offen  lds
v_mfma_f32_16x16x32_bf16 v[248:251], a[168:171], a[248:251], v[248:251]
ds_read_b64_tr_b16 a[214:215], v10 offset:1024
v_mfma_f32_16x16x32_bf16 v[252:255], a[168:171], a[252:255], v[252:255]
ds_read_b128 a[168:171], v3 offset:4096
v_mfma_f32_16x16x32_bf16 a[0:3], a[172:175], a[224:227], a[0:3]
ds_read_b64_tr_b16 a[216:217], v11 offset:0
v_mfma_f32_16x16x32_bf16 a[4:7], a[172:175], a[228:231], a[4:7]
v_mfma_f32_16x16x32_bf16 a[8:11], a[172:175], a[232:235], a[8:11]
ds_read_b64_tr_b16 a[218:219], v11 offset:1024
v_mfma_f32_16x16x32_bf16 a[12:15], a[172:175], a[236:239], a[12:15]
s_add_u32 s37, s31, 163840
v_mfma_f32_16x16x32_bf16 a[16:19], a[172:175], a[240:243], a[16:19]
s_add_u32 m0, s33, 5120
ds_read_b64_tr_b16 a[220:221], v12 offset:0
v_mfma_f32_16x16x32_bf16 a[20:23], a[172:175], a[244:247], a[20:23]
buffer_load_dwordx4 v2, s[20:23], s37 offen  lds
v_mfma_f32_16x16x32_bf16 a[24:27], a[172:175], a[248:251], a[24:27]
ds_read_b64_tr_b16 a[222:223], v12 offset:1024
v_mfma_f32_16x16x32_bf16 a[28:31], a[172:175], a[252:255], a[28:31]
ds_read_b128 a[172:175], v4 offset:5120
s_add_u32 s29, s29, s44
v_mfma_f32_16x16x32_bf16 a[32:35], a[176:179], a[224:227], a[32:35]
s_add_u32 s31, s31, 262144
s_add_u32 s33, s33, 16384
v_mfma_f32_16x16x32_bf16 a[36:39], a[176:179], a[228:231], a[36:39]
s_and_b32 s33, s33, 65535
buffer_store_dwordx4 v[124:127], v13, s[8:11], s29 offen sc1
v_mfma_f32_16x16x32_bf16 a[40:43], a[176:179], a[232:235], a[40:43]
ds_read_b128 a[188:191], v4 offset:13312
v_mfma_f32_16x16x32_bf16 a[44:47], a[176:179], a[236:239], a[44:47]
s_mov_b32 s48, s30
v_mfma_f32_16x16x32_bf16 a[48:51], a[176:179], a[240:243], a[48:51]
s_add_u32 m0, s32, 0
v_mfma_f32_16x16x32_bf16 a[52:55], a[176:179], a[244:247], a[52:55]
buffer_load_dwordx4 v1, s[12:15], s48 offen lds
v_mfma_f32_16x16x32_bf16 a[56:59], a[176:179], a[248:251], a[56:59]
v_mfma_f32_16x16x32_bf16 a[60:63], a[176:179], a[252:255], a[60:63]
ds_read_b128 a[176:179], v3 offset:8192
v_mfma_f32_16x16x32_bf16 a[64:67], a[180:183], a[224:227], a[64:67]
v_mfma_f32_16x16x32_bf16 a[68:71], a[180:183], a[228:231], a[68:71]
v_mfma_f32_16x16x32_bf16 a[72:75], a[180:183], a[232:235], a[72:75]
v_mfma_f32_16x16x32_bf16 a[76:79], a[180:183], a[236:239], a[76:79]
s_add_u32 s48, s48, s34
v_mfma_f32_16x16x32_bf16 a[80:83], a[180:183], a[240:243], a[80:83]
s_add_u32 m0, s32, 4096
v_mfma_f32_16x16x32_bf16 a[84:87], a[180:183], a[244:247], a[84:87]
buffer_load_dwordx4 v1, s[12:15], s48 offen lds
v_mfma_f32_16x16x32_bf16 a[88:91], a[180:183], a[248:251], a[88:91]
buffer_load_dword v15, v14, s[96:99], s100 offen
s_add_u32 s100, s100, 8192
v_mfma_f32_16x16x32_bf16 a[92:95], a[180:183], a[252:255], a[92:95]
ds_read_b128 a[180:183], v4 offset:9216
v_mfma_f32_16x16x32_bf16 a[96:99], a[184:187], a[224:227], a[96:99]
v_mfma_f32_16x16x32_bf16 a[100:103], a[184:187], a[228:231], a[100:103]
v_mfma_f32_16x16x32_bf16 a[104:107], a[184:187], a[232:235], a[104:107]
v_mfma_f32_16x16x32_bf16 a[108:111], a[184:187], a[236:239], a[108:111]
s_add_u32 s48, s48, s34
v_mfma_f32_16x16x32_bf16 a[112:115], a[184:187], a[240:243], a[112:115]
s_add_u32 m0, s32, 8192
v_mfma_f32_16x16x32_bf16 a[116:119], a[184:187], a[244:247], a[116:119]
buffer_load_dwordx4 v1, s[12:15], s48 offen lds
v_mfma_f32_16x16x32_bf16 a[120:123], a[184:187], a[248:251], a[120:123]
v_mfma_f32_16x16x32_bf16 a[124:127], a[184:187], a[252:255], a[124:127]
ds_read_b128 a[184:187], v3 offset:12288
v_mfma_f32_16x16x32_bf16 a[128:131], v[28:31], a[224:227], a[128:131]
v_mfma_f32_16x16x32_bf16 a[132:135], v[28:31], a[228:231], a[132:135]
v_add_u32 v5, 16384, v5
v_and_b32 v5, 65535, v5
v_xor_b32 v6, 16, v5
v_mfma_f32_16x16x32_bf16 a[136:139], v[28:31], a[232:235], a[136:139]
v_xor_b32 v7, 64, v5
v_xor_b32 v8, 80, v5
v_xor_b32 v9, 128, v5
v_mfma_f32_16x16x32_bf16 a[140:143], v[28:31], a[236:239], a[140:143]
s_add_u32 s48, s48, s34
v_xor_b32 v10, 144, v5
v_xor_b32 v11, 192, v5
v_mfma_f32_16x16x32_bf16 a[144:147], v[28:31], a[240:243], a[144:147]
s_add_u32 m0, s32, 12288
v_xor_b32 v12, 208, v5
v_mfma_f32_16x16x32_bf16 a[148:151], v[28:31], a[244:247], a[148:151]
buffer_load_dwordx4 v1, s[12:15], s48 offen lds
v_mfma_f32_16x16x32_bf16 a[152:155], v[28:31], a[248:251], a[152:155]
v_mfma_f32_16x16x32_bf16 a[156:159], v[28:31], a[252:255], a[156:159]
s_cmp_eq_u32 s36, 0
s_cbranch_scc1 L_g_v12
s_waitcnt vmcnt(23) lgkmcnt(0)
s_barrier
v_mfma_f32_16x16x32_bf16 v[160:163], a[160:163], a[192:195], v[160:163]
ds_read_b64_tr_b16 a[224:225], v5 offset:0
v_mfma_f32_16x16x32_bf16 v[164:167], a[160:163], a[196:199], v[164:167]
v_mfma_f32_16x16x32_bf16 v[168:171], a[160:163], a[200:203], v[168:171]
ds_read_b64_tr_b16 a[226:227], v5 offset:1024
v_mfma_f32_16x16x32_bf16 v[172:175], a[160:163], a[204:207], v[172:175]
s_add_u32 s37, s31, 0
v_mfma_f32_16x16x32_bf16 v[176:179], a[160:163], a[208:211], v[176:179]
s_add_u32 m0, s33, 0
ds_read_b64_tr_b16 a[228:229], v6 offset:0
v_mfma_f32_16x16x32_bf16 v[180:183], a[160:163], a[212:215], v[180:183]
buffer_load_dwordx4 v2, s[20:23], s37 offen  lds
v_mfma_f32_16x16x32_bf16 v[184:187], a[160:163], a[216:219], v[184:187]
ds_read_b64_tr_b16 a[230:231], v6 offset:1024
v_mfma_f32_16x16x32_bf16 v[188:191], a[160:163], a[220:223], v[188:191]
ds_read_b128 a[160:163], v4 offset:0
v_mfma_f32_16x16x32_bf16 v[192:195], a[164:167], a[192:195], v[192:195]
ds_read_b64_tr_b16 a[232:233], v7 offset:0
v_mfma_f32_16x16x32_bf16 v[196:199], a[164:167], a[196:199], v[196:199]
v_mfma_f32_16x16x32_bf16 v[200:203], a[164:167], a[200:203], v[200:203]
ds_read_b64_tr_b16 a[234:235], v7 offset:1024
v_mfma_f32_16x16x32_bf16 v[204:207], a[164:167], a[204:207], v[204:207]
s_add_u32 s37, s31, 32768
v_mfma_f32_16x16x32_bf16 v[208:211], a[164:167], a[208:211], v[208:211]
s_add_u32 m0, s33, 1024
ds_read_b64_tr_b16 a[236:237], v8 offset:0
v_mfma_f32_16x16x32_bf16 v[212:215], a[164:167], a[212:215], v[212:215]
buffer_load_dwordx4 v2, s[20:23], s37 offen  lds
v_mfma_f32_16x16x32_bf16 v[216:219], a[164:167], a[216:219], v[216:219]
ds_read_b64_tr_b16 a[238:239], v8 offset:1024
v_mfma_f32_16x16x32_bf16 v[220:223], a[164:167], a[220:223], v[220:223]
ds_read_b128 a[164:167], v3 offset:1024
v_mfma_f32_16x16x32_bf16 v[224:227], a[168:171], a[192:195], v[224:227]
ds_read_b64_tr_b16 a[240:241], v9 offset:0
v_mfma_f32_16x16x32_bf16 v[228:231], a[168:171], a[196:199], v[228:231]
v_mfma_f32_16x16x32_bf16 v[232:235], a[168:171], a[200:203], v[232:235]
ds_read_b64_tr_b16 a[242:243], v9 offset:1024
v_mfma_f32_16x16x32_bf16 v[236:239], a[168:171], a[204:207], v[236:239]
s_add_u32 s37, s31, 131072
v_mfma_f32_16x16x32_bf16 v[240:243], a[168:171], a[208:211], v[240:243]
s_add_u32 m0, s33, 4096
ds_read_b64_tr_b16 a[244:245], v10 offset:0
v_mfma_f32_16x16x32_bf16 v[244:247], a[168:171], a[212:215], v[244:247]
buffer_load_dwordx4 v2, s[20:23], s37 offen  lds
v_mfma_f32_16x16x32_bf16 v[248:251], a[168:171], a[216:219], v[248:251]
ds_read_b64_tr_b16 a[246:247], v10 offset:1024
v_mfma_f32_16x16x32_bf16 v[252:255], a[168:171], a[220:223], v[252:255]
ds_read_b128 a[168:171], v4 offset:4096
v_mfma_f32_16x16x32_bf16 a[0:3], a[172:175], a[192:195], a[0:3]
ds_read_b64_tr_b16 a[248:249], v11 offset:0
v_mfma_f32_16x16x32_bf16 a[4:7], a[172:175], a[196:199], a[4:7]
v_mfma_f32_16x16x32_bf16 a[8:11], a[172:175], a[200:203], a[8:11]
ds_read_b64_tr_b16 a[250:251], v11 offset:1024
v_mfma_f32_16x16x32_bf16 a[12:15], a[172:175], a[204:207], a[12:15]
s_add_u32 s37, s31, 163840
v_mfma_f32_16x16x32_bf16 a[16:19], a[172:175], a[208:211], a[16:19]
s_add_u32 m0, s33, 5120
ds_read_b64_tr_b16 a[252:253], v12 offset:0
v_mfma_f32_16x16x32_bf16 a[20:23], a[172:175], a[212:215], a[20:23]
buffer_load_dwordx4 v2, s[20:23], s37 offen  lds
v_mfma_f32_16x16x32_bf16 a[24:27], a[172:175], a[216:219], a[24:27]
ds_read_b64_tr_b16 a[254:255], v12 offset:1024
v_mfma_f32_16x16x32_bf16 a[28:31], a[172:175], a[220:223], a[28:31]
ds_read_b128 a[172:175], v3 offset:5120
v_mfma_f32_16x16x32_bf16 a[32:35], a[176:179], a[192:195], a[32:35]
s_add_u32 s31, s31, 262144
s_add_u32 s33, s33, 16384
v_mfma_f32_16x16x32_bf16 a[36:39], a[176:179], a[196:199], a[36:39]
s_and_b32 s33, s33, 65535
ds_read_b128 v[28:31], v3 offset:13312
v_mfma_f32_16x16x32_bf16 a[40:43], a[176:179], a[200:203], a[40:43]
v_mfma_f32_16x16x32_bf16 a[44:47], a[176:179], a[204:207], a[44:47]
s_add_u32 s48, s48, s34
v_mfma_f32_16x16x32_bf16 a[48:51], a[176:179], a[208:211], a[48:51]
s_add_u32 m0, s32, 16384
v_mfma_f32_16x16x32_bf16 a[52:55], a[176:179], a[212:215], a[52:55]
buffer_load_dwordx4 v1, s[12:15], s48 offen lds
v_mfma_f32_16x16x32_bf16 a[56:59], a[176:179], a[216:219], a[56:59]
v_mfma_f32_16x16x32_bf16 a[60:63], a[176:179], a[220:223], a[60:63]
ds_read_b128 a[176:179], v4 offset:8192
v_mfma_f32_16x16x32_bf16 a[64:67], a[180:183], a[192:195], a[64:67]
v_mfma_f32_16x16x32_bf16 a[68:71], a[180:183], a[196:199], a[68:71]
v_mfma_f32_16x16x32_bf16 a[72:75], a[180:183], a[200:203], a[72:75]
v_mfma_f32_16x16x32_bf16 a[76:79], a[180:183], a[204:207], a[76:79]
s_add_u32 s48, s48, s34
v_mfma_f32_16x16x32_bf16 a[80:83], a[180:183], a[208:211], a[80:83]
s_add_u32 m0, s32, 20480
v_mfma_f32_16x16x32_bf16 a[84:87], a[180:183], a[212:215], a[84:87]
buffer_load_dwordx4 v1, s[12:15], s48 offen lds
v_mfma_f32_16x16x32_bf16 a[88:91], a[180:183], a[216:219], a[88:91]
v_mfma_f32_16x16x32_bf16 a[92:95], a[180:183], a[220:223], a[92:95]
ds_read_b128 a[180:183], v3 offset:9216
v_mfma_f32_16x16x32_bf16 a[96:99], a[184:187], a[192:195], a[96:99]
v_mfma_f32_16x16x32_bf16 a[100:103], a[184:187], a[196:199], a[100:103]
v_mfma_f32_16x16x32_bf16 a[104:107], a[184:187], a[200:203], a[104:107]
v_mfma_f32_16x16x32_bf16 a[108:111], a[184:187], a[204:207], a[108:111]
s_add_u32 s48, s48, s34
v_mfma_f32_16x16x32_bf16 a[112:115], a[184:187], a[208:211], a[112:115]
s_add_u32 m0, s32, 24576
v_mfma_f32_16x16x32_bf16 a[116:119], a[184:187], a[212:215], a[116:119]
buffer_load_dwordx4 v1, s[12:15], s48 offen lds
v_mfma_f32_16x16x32_bf16 a[120:123], a[184:187], a[216:219], a[120:123]
v_mfma_f32_16x16x32_bf16 a[124:127], a[184:187], a[220:223], a[124:127]
ds_read_b128 a[184:187], v4 offset:12288
v_mfma_f32_16x16x32_bf16 a[128:131], a[188:191], a[192:195], a[128:131]
v_mfma_f32_16x16x32_bf16 a[132:135], a[188:191], a[196:199], a[132:135]
v_add_u32 v3, 32768, v3
v_subrev_u32 v19, 98304, v3
v_cmp_le_u32 vcc, 163840, v3
v_mfma_f32_16x16x32_bf16 a[136:139], a[188:191], a[200:203], a[136:139]
v_add_u32 v5, 16384, v5
v_and_b32 v5, 65535, v5
v_xor_b32 v6, 16, v5
v_mfma_f32_16x16x32_bf16 a[140:143], a[188:191], a[204:207], a[140:143]
s_add_u32 s48, s48, s34
v_xor_b32 v7, 64, v5
v_xor_b32 v8, 80, v5
v_mfma_f32_16x16x32_bf16 a[144:147], a[188:191], a[208:211], a[144:147]
s_add_u32 m0, s32, 28672
v_xor_b32 v9, 128, v5
v_xor_b32 v10, 144, v5
v_mfma_f32_16x16x32_bf16 a[148:151], a[188:191], a[212:215], a[148:151]
buffer_load_dwordx4 v1, s[12:15], s48 offen lds
v_xor_b32 v11, 192, v5
v_xor_b32 v12, 208, v5
v_mfma_f32_16x16x32_bf16 a[152:155], a[188:191], a[216:219], a[152:155]
s_add_u32 s30, s30, 128
s_add_u32 s32, s32, 32768
s_sub_u32 s48, s32, 98304
v_mfma_f32_16x16x32_bf16 a[156:159], a[188:191], a[220:223], a[156:159]
s_cmp_ge_u32 s32, 163840
s_cselect_b32 s32, s48, s32
v_cndmask_b32 v3, v3, v19, vcc
v_xor_b32 v4, 64, v3
s_waitcnt vmcnt(19) lgkmcnt(0)
s_barrier
v_mfma_f32_16x16x32_bf16 v[160:163], a[160:163], a[224:227], v[160:163]
ds_read_b64_tr_b16 a[192:193], v5 offset:0
v_mfma_f32_16x16x32_bf16 v[164:167], a[160:163], a[228:231], v[164:167]
v_mfma_f32_16x16x32_bf16 v[168:171], a[160:163], a[232:235], v[168:171]
ds_read_b64_tr_b16 a[194:195], v5 offset:1024
v_mfma_f32_16x16x32_bf16 v[172:175], a[160:163], a[236:239], v[172:175]
s_add_u32 s37, s31, 0
v_mfma_f32_16x16x32_bf16 v[176:179], a[160:163], a[240:243], v[176:179]
s_add_u32 m0, s33, 0
ds_read_b64_tr_b16 a[196:197], v6 offset:0
v_mfma_f32_16x16x32_bf16 v[180:183], a[160:163], a[244:247], v[180:183]
buffer_load_dwordx4 v2, s[20:23], s37 offen  lds
v_mfma_f32_16x16x32_bf16 v[184:187], a[160:163], a[248:251], v[184:187]
ds_read_b64_tr_b16 a[198:199], v6 offset:1024
v_mfma_f32_16x16x32_bf16 v[188:191], a[160:163], a[252:255], v[188:191]
ds_read_b128 a[160:163], v3 offset:0
v_mfma_f32_16x16x32_bf16 v[192:195], a[164:167], a[224:227], v[192:195]
ds_read_b64_tr_b16 a[200:201], v7 offset:0
v_mfma_f32_16x16x32_bf16 v[196:199], a[164:167], a[228:231], v[196:199]
v_mfma_f32_16x16x32_bf16 v[200:203], a[164:167], a[232:235], v[200:203]
ds_read_b64_tr_b16 a[202:203], v7 offset:1024
v_mfma_f32_16x16x32_bf16 v[204:207], a[164:167], a[236:239], v[204:207]
s_add_u32 s37, s31, 32768
v_mfma_f32_16x16x32_bf16 v[208:211], a[164:167], a[240:243], v[208:211]
s_add_u32 m0, s33, 1024
ds_read_b64_tr_b16 a[204:205], v8 offset:0
v_mfma_f32_16x16x32_bf16 v[212:215], a[164:167], a[244:247], v[212:215]
buffer_load_dwordx4 v2, s[20:23], s37 offen  lds
v_mfma_f32_16x16x32_bf16 v[216:219], a[164:167], a[248:251], v[216:219]
ds_read_b64_tr_b16 a[206:207], v8 offset:1024
v_mfma_f32_16x16x32_bf16 v[220:223], a[164:167], a[252:255], v[220:223]
ds_read_b128 a[164:167], v4 offset:1024
v_mfma_f32_16x16x32_bf16 v[224:227], a[168:171], a[224:227], v[224:227]
ds_read_b64_tr_b16 a[208:209], v9 offset:0
v_mfma_f32_16x16x32_bf16 v[228:231], a[168:171], a[228:231], v[228:231]
v_mfma_f32_16x16x32_bf16 v[232:235], a[168:171], a[232:235], v[232:235]
ds_read_b64_tr_b16 a[210:211], v9 offset:1024
v_mfma_f32_16x16x32_bf16 v[236:239], a[168:171], a[236:239], v[236:239]
s_add_u32 s37, s31, 131072
v_mfma_f32_16x16x32_bf16 v[240:243], a[168:171], a[240:243], v[240:243]
s_add_u32 m0, s33, 4096
ds_read_b64_tr_b16 a[212:213], v10 offset:0
v_mfma_f32_16x16x32_bf16 v[244:247], a[168:171], a[244:247], v[244:247]
buffer_load_dwordx4 v2, s[20:23], s37 offen  lds
v_mfma_f32_16x16x32_bf16 v[248:251], a[168:171], a[248:251], v[248:251]
ds_read_b64_tr_b16 a[214:215], v10 offset:1024
v_mfma_f32_16x16x32_bf16 v[252:255], a[168:171], a[252:255], v[252:255]
ds_read_b128 a[168:171], v3 offset:4096
v_mfma_f32_16x16x32_bf16 a[0:3], a[172:175], a[224:227], a[0:3]
ds_read_b64_tr_b16 a[216:217], v11 offset:0
v_mfma_f32_16x16x32_bf16 a[4:7], a[172:175], a[228:231], a[4:7]
v_mfma_f32_16x16x32_bf16 a[8:11], a[172:175], a[232:235], a[8:11]
ds_read_b64_tr_b16 a[218:219], v11 offset:1024
v_mfma_f32_16x16x32_bf16 a[12:15], a[172:175], a[236:239], a[12:15]
s_add_u32 s37, s31, 163840
v_mfma_f32_16x16x32_bf16 a[16:19], a[172:175], a[240:243], a[16:19]
s_add_u32 m0, s33, 5120
ds_read_b64_tr_b16 a[220:221], v12 offset:0
v_mfma_f32_16x16x32_bf16 a[20:23], a[172:175], a[244:247], a[20:23]
buffer_load_dwordx4 v2, s[20:23], s37 offen  lds
v_mfma_f32_16x16x32_bf16 a[24:27], a[172:175], a[248:251], a[24:27]
ds_read_b64_tr_b16 a[222:223], v12 offset:1024
v_mfma_f32_16x16x32_bf16 a[28:31], a[172:175], a[252:255], a[28:31]
ds_read_b128 a[172:175], v4 offset:5120
v_mfma_f32_16x16x32_bf16 a[32:35], a[176:179], a[224:227], a[32:35]
s_add_u32 s31, s31, 262144
s_add_u32 s33, s33, 16384
v_mfma_f32_16x16x32_bf16 a[36:39], a[176:179], a[228:231], a[36:39]
s_and_b32 s33, s33, 65535
ds_read_b128 a[188:191], v4 offset:13312
v_mfma_f32_16x16x32_bf16 a[40:43], a[176:179], a[232:235], a[40:43]
v_mfma_f32_16x16x32_bf16 a[44:47], a[176:179], a[236:239], a[44:47]
s_mov_b32 s48, s30
v_mfma_f32_16x16x32_bf16 a[48:51], a[176:179], a[240:243], a[48:51]
s_add_u32 m0, s32, 0
v_mfma_f32_16x16x32_bf16 a[52:55], a[176:179], a[244:247], a[52:55]
buffer_load_dwordx4 v1, s[12:15], s48 offen lds
v_mfma_f32_16x16x32_bf16 a[56:59], a[176:179], a[248:251], a[56:59]
v_mfma_f32_16x16x32_bf16 a[60:63], a[176:179], a[252:255], a[60:63]
ds_read_b128 a[176:179], v3 offset:8192
v_mfma_f32_16x16x32_bf16 a[64:67], a[180:183], a[224:227], a[64:67]
v_mfma_f32_16x16x32_bf16 a[68:71], a[180:183], a[228:231], a[68:71]
v_mfma_f32_16x16x32_bf16 a[72:75], a[180:183], a[232:235], a[72:75]
v_mfma_f32_16x16x32_bf16 a[76:79], a[180:183], a[236:239], a[76:79]
s_add_u32 s48, s48, s34
v_mfma_f32_16x16x32_bf16 a[80:83], a[180:183], a[240:243], a[80:83]
s_add_u32 m0, s32, 4096
v_mfma_f32_16x16x32_bf16 a[84:87], a[180:183], a[244:247], a[84:87]
buffer_load_dwordx4 v1, s[12:15], s48 offen lds
v_mfma_f32_16x16x32_bf16 a[88:91], a[180:183], a[248:251], a[88:91]
v_mfma_f32_16x16x32_bf16 a[92:95], a[180:183], a[252:255], a[92:95]
ds_read_b128 a[180:183], v4 offset:9216
v_mfma_f32_16x16x32_bf16 a[96:99], a[184:187], a[224:227], a[96:99]
v_mfma_f32_16x16x32_bf16 a[100:103], a[184:187], a[228:231], a[100:103]
v_mfma_f32_16x16x32_bf16 a[104:107], a[184:187], a[232:235], a[104:107]
v_mfma_f32_16x16x32_bf16 a[108:111], a[184:187], a[236:239], a[108:111]
s_add_u32 s48, s48, s34
v_mfma_f32_16x16x32_bf16 a[112:115], a[184:187], a[240:243], a[112:115]
s_add_u32 m0, s32, 8192
v_mfma_f32_16x16x32_bf16 a[116:119], a[184:187], a[244:247], a[116:119]
buffer_load_dwordx4 v1, s[12:15], s48 offen lds
v_mfma_f32_16x16x32_bf16 a[120:123], a[184:187], a[248:251], a[120:123]
v_mfma_f32_16x16x32_bf16 a[124:127], a[184:187], a[252:255], a[124:127]
ds_read_b128 a[184:187], v3 offset:12288
v_mfma_f32_16x16x32_bf16 a[128:131], v[28:31], a[224:227], a[128:131]
v_mfma_f32_16x16x32_bf16 a[132:135], v[28:31], a[228:231], a[132:135]
v_add_u32 v5, 16384, v5
v_and_b32 v5, 65535, v5
v_xor_b32 v6, 16, v5
v_mfma_f32_16x16x32_bf16 a[136:139], v[28:31], a[232:235], a[136:139]
v_xor_b32 v7, 64, v5
v_xor_b32 v8, 80, v5
v_xor_b32 v9, 128, v5
v_mfma_f32_16x16x32_bf16 a[140:143], v[28:31], a[236:239], a[140:143]
s_add_u32 s48, s48, s34
v_xor_b32 v10, 144, v5
v_xor_b32 v11, 192, v5
v_mfma_f32_16x16x32_bf16 a[144:147], v[28:31], a[240:243], a[144:147]
s_add_u32 m0, s32, 12288
v_xor_b32 v12, 208, v5
v_mfma_f32_16x16x32_bf16 a[148:151], v[28:31], a[244:247], a[148:151]
buffer_load_dwordx4 v1, s[12:15], s48 offen lds
v_mfma_f32_16x16x32_bf16 a[152:155], v[28:31], a[248:251], a[152:155]
v_mfma_f32_16x16x32_bf16 a[156:159], v[28:31], a[252:255], a[156:159]
L_g_v12:
s_waitcnt vmcnt(16) lgkmcnt(0)
s_barrier
v_mfma_f32_16x16x32_bf16 v[160:163], a[160:163], a[192:195], v[160:163]
ds_read_b64_tr_b16 a[224:225], v5 offset:0
s_lshl_b32 s24, s35, 2
s_lshr_b32 s26, s88, s24
v_mfma_f32_16x16x32_bf16 v[164:167], a[160:163], a[196:199], v[164:167]
s_bfe_u32 s2, s26, 0x10003
s_and_b32 s26, s26, 7
s_or_b32 s40, s2, s61
v_mfma_f32_16x16x32_bf16 v[168:171], a[160:163], a[200:203], v[168:171]
ds_read_b64_tr_b16 a[226:227], v5 offset:1024
s_lshr_b32 s24, s17, 1
v_mfma_f32_16x16x32_bf16 v[172:175], a[160:163], a[204:207], v[172:175]
s_add_u32 s37, s31, 0
v_mfma_f32_16x16x32_bf16 v[176:179], a[160:163], a[208:211], v[176:179]
s_add_u32 m0, s33, 0
ds_read_b64_tr_b16 a[228:229], v6 offset:0
v_mfma_f32_16x16x32_bf16 v[180:183], a[160:163], a[212:215], v[180:183]
buffer_load_dwordx4 v2, s[20:23], s37 offen  lds
v_mfma_f32_16x16x32_bf16 v[184:187], a[160:163], a[216:219], v[184:187]
ds_read_b64_tr_b16 a[230:231], v6 offset:1024
v_mfma_f32_16x16x32_bf16 v[188:191], a[160:163], a[220:223], v[188:191]
ds_read_b128 a[160:163], v4 offset:0
s_add_u32 s60, s60, s92
v_mfma_f32_16x16x32_bf16 v[192:195], a[164:167], a[192:195], v[192:195]
s_mov_b32 s29, s60
ds_read_b64_tr_b16 a[232:233], v7 offset:0
v_mfma_f32_16x16x32_bf16 v[196:199], a[164:167], a[196:199], v[196:199]
buffer_store_dwordx4 v[128:131], v13, s[8:11], s29 offen sc1
v_mfma_f32_16x16x32_bf16 v[200:203], a[164:167], a[200:203], v[200:203]
ds_read_b64_tr_b16 a[234:235], v7 offset:1024
v_mfma_f32_16x16x32_bf16 v[204:207], a[164:167], a[204:207], v[204:207]
s_add_u32 s37, s31, 32768
v_mfma_f32_16x16x32_bf16 v[208:211], a[164:167], a[208:211], v[208:211]
s_add_u32 m0, s33, 1024
ds_read_b64_tr_b16 a[236:237], v8 offset:0
v_mfma_f32_16x16x32_bf16 v[212:215], a[164:167], a[212:215], v[212:215]
buffer_load_dwordx4 v2, s[20:23], s37 offen  lds
v_mfma_f32_16x16x32_bf16 v[216:219], a[164:167], a[216:219], v[216:219]
ds_read_b64_tr_b16 a[238:239], v8 offset:1024
v_mfma_f32_16x16x32_bf16 v[220:223], a[164:167], a[220:223], v[220:223]
ds_read_b128 a[164:167], v3 offset:1024
v_mfma_f32_16x16x32_bf16 v[224:227], a[168:171], a[192:195], v[224:227]
ds_read_b64_tr_b16 a[240:241], v9 offset:0
v_mfma_f32_16x16x32_bf16 v[228:231], a[168:171], a[196:199], v[228:231]
s_cmp_eq_u32 s2, 0
s_cselect_b32 s41, s24, 0
s_cselect_b32 s27, s89, s90
v_mfma_f32_16x16x32_bf16 v[232:235], a[168:171], a[200:203], v[232:235]
ds_read_b64_tr_b16 a[242:243], v9 offset:1024
s_sub_u32 s25, s24, s41
s_and_b32 s51, s41, s61
v_mfma_f32_16x16x32_bf16 v[236:239], a[168:171], a[204:207], v[236:239]
s_add_u32 s37, s31, 131072
s_lshl_b32 s51, s51, 1
s_or_b32 s51, s51, s41
v_mfma_f32_16x16x32_bf16 v[240:243], a[168:171], a[208:211], v[240:243]
s_add_u32 m0, s33, 4096
ds_read_b64_tr_b16 a[244:245], v10 offset:0
s_lshl_b32 s46, s27, s2
v_mfma_f32_16x16x32_bf16 v[244:247], a[168:171], a[212:215], v[244:247]
buffer_load_dwordx4 v2, s[20:23], s37 offen  lds
s_add_u32 s46, s46, s25
s_lshl_b32 s46, s46, 8
v_mfma_f32_16x16x32_bf16 v[248:251], a[168:171], a[216:219], v[248:251]
ds_read_b64_tr_b16 a[246:247], v10 offset:1024
s_lshl_b32 s47, s40, 7
s_add_u32 s47, s47, 1024
v_mfma_f32_16x16x32_bf16 v[252:255], a[168:171], a[220:223], v[252:255]
ds_read_b128 a[168:171], v4 offset:4096
s_mul_i32 s101, s26, s47
s_lshl_b32 s101, s101, 8
v_mfma_f32_16x16x32_bf16 a[0:3], a[172:175], a[192:195], a[0:3]
ds_read_b64_tr_b16 a[248:249], v11 offset:0
s_lshl_b32 s42, s27, 3
s_add_u32 s42, s42, s26
v_mfma_f32_16x16x32_bf16 a[4:7], a[172:175], a[196:199], a[4:7]
s_lshl_b32 s42, s42, 1
s_and_b32 s25, s17, 1
s_add_u32 s42, s42, s25
v_mfma_f32_16x16x32_bf16 a[8:11], a[172:175], a[200:203], a[8:11]
ds_read_b64_tr_b16 a[250:251], v11 offset:1024
s_lshl_b32 s42, s42, 3
s_add_u32 s42, s42, s24
v_mfma_f32_16x16x32_bf16 a[12:15], a[172:175], a[204:207], a[12:15]
s_add_u32 s37, s31, 163840
s_lshl_b32 s42, s42, 13
s_lshl_b32 s43, s27, 5
v_mfma_f32_16x16x32_bf16 a[16:19], a[172:175], a[208:211], a[16:19]
s_add_u32 m0, s33, 5120
ds_read_b64_tr_b16 a[252:253], v12 offset:0
s_add_u32 s43, s43, s26
v_mfma_f32_16x16x32_bf16 a[20:23], a[172:175], a[212:215], a[20:23]
buffer_load_dwordx4 v2, s[20:23], s37 offen  lds
s_lshl_b32 s43, s43, 2
s_lshl_b32 s24, s2, 1
v_mfma_f32_16x16x32_bf16 a[24:27], a[172:175], a[216:219], a[24:27]
ds_read_b64_tr_b16 a[254:255], v12 offset:1024
s_add_u32 s24, s24, s61
s_lshl_b32 s24, s24, 2
v_mfma_f32_16x16x32_bf16 a[28:31], a[172:175], a[220:223], a[28:31]
ds_read_b128 a[172:175], v3 offset:5120
s_add_u32 s29, s29, s44
s_lshr_b32 s25, 0x8720, s24
v_mfma_f32_16x16x32_bf16 a[32:35], a[176:179], a[192:195], a[32:35]
s_add_u32 s31, s31, 262144
s_add_u32 s33, s33, 16384
s_and_b32 s25, s25, 15
v_mfma_f32_16x16x32_bf16 a[36:39], a[176:179], a[196:199], a[36:39]
s_and_b32 s33, s33, 65535
buffer_store_dwordx4 v[132:135], v13, s[8:11], s29 offen sc1
s_lshl_b32 s25, s25, 24
v_mfma_f32_16x16x32_bf16 a[40:43], a[176:179], a[200:203], a[40:43]
ds_read_b128 v[28:31], v3 offset:13312
s_add_u32 s42, s42, s25
s_lshr_b32 s25, 0x7604, s24
v_mfma_f32_16x16x32_bf16 a[44:47], a[176:179], a[204:207], a[44:47]
s_add_u32 s48, s48, s34
s_and_b32 s25, s25, 15
s_lshl_b32 s25, s25, 12
v_mfma_f32_16x16x32_bf16 a[48:51], a[176:179], a[208:211], a[48:51]
s_add_u32 m0, s32, 16384
s_add_u32 s43, s43, s25
s_add_u32 s43, s43, 111149056
v_mfma_f32_16x16x32_bf16 a[52:55], a[176:179], a[212:215], a[52:55]
buffer_load_dwordx4 v1, s[12:15], s48 offen lds
v_mfma_f32_16x16x32_bf16 a[56:59], a[176:179], a[216:219], a[56:59]
s_cmp_lt_u32 s35, s45
s_cselect_b32 s101, s101, 536870912
s_cselect_b32 s46, s46, 536870912
v_mfma_f32_16x16x32_bf16 a[60:63], a[176:179], a[220:223], a[60:63]
ds_read_b128 a[176:179], v4 offset:8192
v_mfma_f32_16x16x32_bf16 a[64:67], a[180:183], a[192:195], a[64:67]
v_mfma_f32_16x16x32_bf16 a[68:71], a[180:183], a[196:199], a[68:71]
v_mfma_f32_16x16x32_bf16 a[72:75], a[180:183], a[200:203], a[72:75]
v_mfma_f32_16x16x32_bf16 a[76:79], a[180:183], a[204:207], a[76:79]
s_add_u32 s48, s48, s34
v_mfma_f32_16x16x32_bf16 a[80:83], a[180:183], a[208:211], a[80:83]
s_add_u32 m0, s32, 20480
v_mfma_f32_16x16x32_bf16 a[84:87], a[180:183], a[212:215], a[84:87]
buffer_load_dwordx4 v1, s[12:15], s48 offen lds
v_mfma_f32_16x16x32_bf16 a[88:91], a[180:183], a[216:219], a[88:91]
buffer_load_dword v15, v14, s[96:99], s100 offen
s_add_u32 s100, s100, 8192
v_mfma_f32_16x16x32_bf16 a[92:95], a[180:183], a[220:223], a[92:95]
ds_read_b128 a[180:183], v3 offset:9216
v_mfma_f32_16x16x32_bf16 a[96:99], a[184:187], a[192:195], a[96:99]
v_mfma_f32_16x16x32_bf16 a[100:103], a[184:187], a[196:199], a[100:103]
v_mfma_f32_16x16x32_bf16 a[104:107], a[184:187], a[200:203], a[104:107]
v_mfma_f32_16x16x32_bf16 a[108:111], a[184:187], a[204:207], a[108:111]
s_add_u32 s48, s48, s34
v_mfma_f32_16x16x32_bf16 a[112:115], a[184:187], a[208:211], a[112:115]
s_add_u32 m0, s32, 24576
v_mfma_f32_16x16x32_bf16 a[116:119], a[184:187], a[212:215], a[116:119]
buffer_load_dwordx4 v1, s[12:15], s48 offen lds
v_mfma_f32_16x16x32_bf16 a[120:123], a[184:187], a[216:219], a[120:123]
v_mfma_f32_16x16x32_bf16 a[124:127], a[184:187], a[220:223], a[124:127]
ds_read_b128 a[184:187], v4 offset:12288
s_add_u32 s29, s29, s93
v_mfma_f32_16x16x32_bf16 a[128:131], a[188:191], a[192:195], a[128:131]
v_mfma_f32_16x16x32_bf16 a[132:135], a[188:191], a[196:199], a[132:135]
buffer_store_dwordx4 v[136:139], v13, s[8:11], s29 offen sc1
v_add_u32 v3, 32768, v3
v_subrev_u32 v19, 98304, v3
v_mfma_f32_16x16x32_bf16 a[136:139], a[188:191], a[200:203], a[136:139]
v_cmp_le_u32 vcc, 163840, v3
v_add_u32 v5, 16384, v5
v_and_b32 v5, 65535, v5
v_mfma_f32_16x16x32_bf16 a[140:143], a[188:191], a[204:207], a[140:143]
s_add_u32 s48, s48, s34
v_xor_b32 v6, 16, v5
v_xor_b32 v7, 64, v5
v_mfma_f32_16x16x32_bf16 a[144:147], a[188:191], a[208:211], a[144:147]
s_add_u32 m0, s32, 28672
v_xor_b32 v8, 80, v5
v_xor_b32 v9, 128, v5
v_mfma_f32_16x16x32_bf16 a[148:151], a[188:191], a[212:215], a[148:151]
buffer_load_dwordx4 v1, s[12:15], s48 offen lds
v_xor_b32 v10, 144, v5
v_xor_b32 v11, 192, v5
v_mfma_f32_16x16x32_bf16 a[152:155], a[188:191], a[216:219], a[152:155]
s_add_u32 s30, s30, 128
s_add_u32 s32, s32, 32768
s_sub_u32 s48, s32, 98304
v_mfma_f32_16x16x32_bf16 a[156:159], a[188:191], a[220:223], a[156:159]
s_cmp_ge_u32 s32, 163840
s_cselect_b32 s32, s48, s32
v_xor_b32 v12, 208, v5
v_cndmask_b32 v3, v3, v19, vcc
v_xor_b32 v4, 64, v3
s_waitcnt vmcnt(20) lgkmcnt(0)
s_barrier
v_mfma_f32_16x16x32_bf16 v[160:163], a[160:163], a[224:227], v[160:163]
ds_read_b64_tr_b16 a[192:193], v5 offset:0
v_mfma_f32_16x16x32_bf16 v[164:167], a[160:163], a[228:231], v[164:167]
s_cmp_eq_u32 s2, 0
s_cselect_b64 s[4:5], s[52:53], s[54:55]
v_mfma_f32_16x16x32_bf16 v[168:171], a[160:163], a[232:235], v[168:171]
ds_read_b64_tr_b16 a[194:195], v5 offset:1024
s_mov_b32 s12, s4
v_mfma_f32_16x16x32_bf16 v[172:175], a[160:163], a[236:239], v[172:175]
s_add_u32 s37, s31, 0
s_and_b32 s13, s5, 0xffff
v_mfma_f32_16x16x32_bf16 v[176:179], a[160:163], a[240:243], v[176:179]
s_add_u32 m0, s33, 0
ds_read_b64_tr_b16 a[196:197], v6 offset:0
v_mfma_f32_16x16x32_bf16 v[180:183], a[160:163], a[244:247], v[180:183]
buffer_load_dwordx4 v2, s[20:23], s37 offen  lds
s_lshl_b32 s14, s47, 11
v_mfma_f32_16x16x32_bf16 v[184:187], a[160:163], a[248:251], v[184:187]
ds_read_b64_tr_b16 a[198:199], v6 offset:1024
s_mov_b32 s15, 0x20000
v_mfma_f32_16x16x32_bf16 v[188:191], a[160:163], a[252:255], v[188:191]
ds_read_b128 a[160:163], v3 offset:0
s_add_u32 s29, s29, s44
v_mfma_f32_16x16x32_bf16 v[192:195], a[164:167], a[224:227], v[192:195]
ds_read_b64_tr_b16 a[200:201], v7 offset:0
s_mov_b32 s30, s101
v_mfma_f32_16x16x32_bf16 v[196:199], a[164:167], a[228:231], v[196:199]
buffer_store_dwordx4 v[140:143], v13, s[8:11], s29 offen sc1
v_lshrrev_b32 v16, 3, v0
v_mfma_f32_16x16x32_bf16 v[200:203], a[164:167], a[232:235], v[200:203]
ds_read_b64_tr_b16 a[202:203], v7 offset:1024
v_mul_lo_u32 v16, v16, s47
v_mfma_f32_16x16x32_bf16 v[204:207], a[164:167], a[236:239], v[204:207]
s_add_u32 s37, s31, 32768
v_and_b32 v1, 0x70, v1
v_mfma_f32_16x16x32_bf16 v[208:211], a[164:167], a[240:243], v[208:211]
s_add_u32 m0, s33, 1024
ds_read_b64_tr_b16 a[204:205], v8 offset:0
v_mfma_f32_16x16x32_bf16 v[212:215], a[164:167], a[244:247], v[212:215]
buffer_load_dwordx4 v2, s[20:23], s37 offen  lds
v_add_u32 v1, v1, v16
v_mfma_f32_16x16x32_bf16 v[216:219], a[164:167], a[248:251], v[216:219]
ds_read_b64_tr_b16 a[206:207], v8 offset:1024
s_lshl_b32 s34, s47, 5
v_mfma_f32_16x16x32_bf16 v[220:223], a[164:167], a[252:255], v[220:223]
ds_read_b128 a[164:167], v4 offset:1024
v_mfma_f32_16x16x32_bf16 v[224:227], a[168:171], a[224:227], v[224:227]
ds_read_b64_tr_b16 a[208:209], v9 offset:0
v_mfma_f32_16x16x32_bf16 v[228:231], a[168:171], a[228:231], v[228:231]
v_mfma_f32_16x16x32_bf16 v[232:235], a[168:171], a[232:235], v[232:235]
ds_read_b64_tr_b16 a[210:211], v9 offset:1024
v_mfma_f32_16x16x32_bf16 v[236:239], a[168:171], a[236:239], v[236:239]
s_add_u32 s37, s31, 131072
v_mfma_f32_16x16x32_bf16 v[240:243], a[168:171], a[240:243], v[240:243]
s_add_u32 m0, s33, 4096
ds_read_b64_tr_b16 a[212:213], v10 offset:0
v_mfma_f32_16x16x32_bf16 v[244:247], a[168:171], a[244:247], v[244:247]
buffer_load_dwordx4 v2, s[20:23], s37 offen  lds
v_mfma_f32_16x16x32_bf16 v[248:251], a[168:171], a[248:251], v[248:251]
ds_read_b64_tr_b16 a[214:215], v10 offset:1024
v_mfma_f32_16x16x32_bf16 v[252:255], a[168:171], a[252:255], v[252:255]
ds_read_b128 a[168:171], v3 offset:4096
v_mfma_f32_16x16x32_bf16 a[0:3], a[172:175], a[224:227], a[0:3]
ds_read_b64_tr_b16 a[216:217], v11 offset:0
v_mfma_f32_16x16x32_bf16 a[4:7], a[172:175], a[228:231], a[4:7]
v_mfma_f32_16x16x32_bf16 a[8:11], a[172:175], a[232:235], a[8:11]
ds_read_b64_tr_b16 a[218:219], v11 offset:1024
v_mfma_f32_16x16x32_bf16 a[12:15], a[172:175], a[236:239], a[12:15]
s_add_u32 s37, s31, 163840
v_mfma_f32_16x16x32_bf16 a[16:19], a[172:175], a[240:243], a[16:19]
s_add_u32 m0, s33, 5120
ds_read_b64_tr_b16 a[220:221], v12 offset:0
v_mfma_f32_16x16x32_bf16 a[20:23], a[172:175], a[244:247], a[20:23]
buffer_load_dwordx4 v2, s[20:23], s37 offen  lds
v_mfma_f32_16x16x32_bf16 a[24:27], a[172:175], a[248:251], a[24:27]
ds_read_b64_tr_b16 a[222:223], v12 offset:1024
v_mfma_f32_16x16x32_bf16 a[28:31], a[172:175], a[252:255], a[28:31]
ds_read_b128 a[172:175], v4 offset:5120
s_add_u32 s29, s29, s93
v_mfma_f32_16x16x32_bf16 a[32:35], a[176:179], a[224:227], a[32:35]
s_add_u32 s31, s31, 262144
s_add_u32 s33, s33, 16384
v_mfma_f32_16x16x32_bf16 a[36:39], a[176:179], a[228:231], a[36:39]
s_and_b32 s33, s33, 65535
buffer_store_dwordx4 v[144:147], v13, s[8:11], s29 offen sc1
v_mfma_f32_16x16x32_bf16 a[40:43], a[176:179], a[232:235], a[40:43]
ds_read_b128 a[188:191], v4 offset:13312
v_mfma_f32_16x16x32_bf16 a[44:47], a[176:179], a[236:239], a[44:47]
s_mov_b32 s48, s30
v_mfma_f32_16x16x32_bf16 a[48:51], a[176:179], a[240:243], a[48:51]
s_add_u32 m0, s32, 0
v_mfma_f32_16x16x32_bf16 a[52:55], a[176:179], a[244:247], a[52:55]
buffer_load_dwordx4 v1, s[12:15], s48 offen lds
v_mfma_f32_16x16x32_bf16 a[56:59], a[176:179], a[248:251], a[56:59]
v_mfma_f32_16x16x32_bf16 a[60:63], a[176:179], a[252:255], a[60:63]
ds_read_b128 a[176:179], v3 offset:8192
v_mfma_f32_16x16x32_bf16 a[64:67], a[180:183], a[224:227], a[64:67]
v_mfma_f32_16x16x32_bf16 a[68:71], a[180:183], a[228:231], a[68:71]
v_mfma_f32_16x16x32_bf16 a[72:75], a[180:183], a[232:235], a[72:75]
v_mfma_f32_16x16x32_bf16 a[76:79], a[180:183], a[236:239], a[76:79]
s_add_u32 s48, s48, s34
v_mfma_f32_16x16x32_bf16 a[80:83], a[180:183], a[240:243], a[80:83]
s_add_u32 m0, s32, 4096
s_cmp_eq_u32 s2, 0
s_cselect_b64 s[4:5], s[6:7], s[18:19]
v_mfma_f32_16x16x32_bf16 a[84:87], a[180:183], a[244:247], a[84:87]
buffer_load_dwordx4 v1, s[12:15], s48 offen lds
s_mov_b32 s20, s4
s_and_b32 s21, s5, 0xffff
v_mfma_f32_16x16x32_bf16 a[88:91], a[180:183], a[248:251], a[88:91]
buffer_load_dword v15, v14, s[96:99], s100 offen
s_add_u32 s100, s100, 8192
s_lshl_b32 s22, s47, 12
v_mfma_f32_16x16x32_bf16 a[92:95], a[180:183], a[252:255], a[92:95]
ds_read_b128 a[180:183], v4 offset:9216
s_mov_b32 s23, 0x20000
s_mov_b32 s31, s46
v_mfma_f32_16x16x32_bf16 a[96:99], a[184:187], a[224:227], a[96:99]
v_mfma_f32_16x16x32_bf16 a[100:103], a[184:187], a[228:231], a[100:103]
v_mfma_f32_16x16x32_bf16 a[104:107], a[184:187], a[232:235], a[104:107]
v_mfma_f32_16x16x32_bf16 a[108:111], a[184:187], a[236:239], a[108:111]
s_add_u32 s48, s48, s34
v_mfma_f32_16x16x32_bf16 a[112:115], a[184:187], a[240:243], a[112:115]
s_add_u32 m0, s32, 8192
v_mfma_f32_16x16x32_bf16 a[116:119], a[184:187], a[244:247], a[116:119]
buffer_load_dwordx4 v1, s[12:15], s48 offen lds
v_mfma_f32_16x16x32_bf16 a[120:123], a[184:187], a[248:251], a[120:123]
v_mfma_f32_16x16x32_bf16 a[124:127], a[184:187], a[252:255], a[124:127]
ds_read_b128 a[184:187], v3 offset:12288
s_add_u32 s29, s29, s44
v_mfma_f32_16x16x32_bf16 a[128:131], v[28:31], a[224:227], a[128:131]
v_mfma_f32_16x16x32_bf16 a[132:135], v[28:31], a[228:231], a[132:135]
buffer_store_dwordx4 v[148:151], v13, s[8:11], s29 offen sc1
v_add_u32 v5, 16384, v5
v_and_b32 v5, 65535, v5
v_mfma_f32_16x16x32_bf16 a[136:139], v[28:31], a[232:235], a[136:139]
v_xor_b32 v6, 16, v5
v_xor_b32 v7, 64, v5
v_xor_b32 v8, 80, v5
v_mfma_f32_16x16x32_bf16 a[140:143], v[28:31], a[236:239], a[140:143]
s_add_u32 s48, s48, s34
v_xor_b32 v9, 128, v5
v_xor_b32 v10, 144, v5
v_mfma_f32_16x16x32_bf16 a[144:147], v[28:31], a[240:243], a[144:147]
s_add_u32 m0, s32, 12288
v_xor_b32 v11, 192, v5
v_xor_b32 v12, 208, v5
v_mfma_f32_16x16x32_bf16 a[148:151], v[28:31], a[244:247], a[148:151]
buffer_load_dwordx4 v1, s[12:15], s48 offen lds
v_mfma_f32_16x16x32_bf16 a[152:155], v[28:31], a[248:251], a[152:155]
v_mfma_f32_16x16x32_bf16 a[156:159], v[28:31], a[252:255], a[156:159]
s_waitcnt vmcnt(24) lgkmcnt(0)
s_barrier
v_mfma_f32_16x16x32_bf16 v[160:163], a[160:163], a[192:195], v[160:163]
ds_read_b64_tr_b16 a[224:225], v5 offset:0
v_mfma_f32_16x16x32_bf16 v[164:167], a[160:163], a[196:199], v[164:167]
v_mfma_f32_16x16x32_bf16 v[168:171], a[160:163], a[200:203], v[168:171]
ds_read_b64_tr_b16 a[226:227], v5 offset:1024
v_mfma_f32_16x16x32_bf16 v[172:175], a[160:163], a[204:207], v[172:175]
s_add_u32 s37, s31, 0
v_mfma_f32_16x16x32_bf16 v[176:179], a[160:163], a[208:211], v[176:179]
s_add_u32 m0, s33, 0
ds_read_b64_tr_b16 a[228:229], v6 offset:0
v_mfma_f32_16x16x32_bf16 v[180:183], a[160:163], a[212:215], v[180:183]
buffer_load_dwordx4 v2, s[20:23], s37 offen  lds
v_mfma_f32_16x16x32_bf16 v[184:187], a[160:163], a[216:219], v[184:187]
ds_read_b64_tr_b16 a[230:231], v6 offset:1024
v_mfma_f32_16x16x32_bf16 v[188:191], a[160:163], a[220:223], v[188:191]
ds_read_b128 a[160:163], v4 offset:0
s_add_u32 s29, s29, s93
v_mfma_f32_16x16x32_bf16 v[192:195], a[164:167], a[192:195], v[192:195]
ds_read_b64_tr_b16 a[232:233], v7 offset:0
v_mfma_f32_16x16x32_bf16 v[196:199], a[164:167], a[196:199], v[196:199]
buffer_store_dwordx4 v[152:155], v13, s[8:11], s29 offen sc1
v_mfma_f32_16x16x32_bf16 v[200:203], a[164:167], a[200:203], v[200:203]
ds_read_b64_tr_b16 a[234:235], v7 offset:1024
v_mfma_f32_16x16x32_bf16 v[204:207], a[164:167], a[204:207], v[204:207]
s_add_u32 s37, s31, 32768
v_mfma_f32_16x16x32_bf16 v[208:211], a[164:167], a[208:211], v[208:211]
s_add_u32 m0, s33, 1024
ds_read_b64_tr_b16 a[236:237], v8 offset:0
v_mfma_f32_16x16x32_bf16 v[212:215], a[164:167], a[212:215], v[212:215]
buffer_load_dwordx4 v2, s[20:23], s37 offen  lds
v_mfma_f32_16x16x32_bf16 v[216:219], a[164:167], a[216:219], v[216:219]
ds_read_b64_tr_b16 a[238:239], v8 offset:1024
v_mfma_f32_16x16x32_bf16 v[220:223], a[164:167], a[220:223], v[220:223]
ds_read_b128 a[164:167], v3 offset:1024
v_mfma_f32_16x16x32_bf16 v[224:227], a[168:171], a[192:195], v[224:227]
ds_read_b64_tr_b16 a[240:241], v9 offset:0
v_mfma_f32_16x16x32_bf16 v[228:231], a[168:171], a[196:199], v[228:231]
v_mfma_f32_16x16x32_bf16 v[232:235], a[168:171], a[200:203], v[232:235]
ds_read_b64_tr_b16 a[242:243], v9 offset:1024
v_mfma_f32_16x16x32_bf16 v[236:239], a[168:171], a[204:207], v[236:239]
s_add_u32 s37, s31, 131072
v_mfma_f32_16x16x32_bf16 v[240:243], a[168:171], a[208:211], v[240:243]
s_add_u32 m0, s33, 4096
ds_read_b64_tr_b16 a[244:245], v10 offset:0
v_mfma_f32_16x16x32_bf16 v[244:247], a[168:171], a[212:215], v[244:247]
buffer_load_dwordx4 v2, s[20:23], s37 offen  lds
v_mfma_f32_16x16x32_bf16 v[248:251], a[168:171], a[216:219], v[248:251]
ds_read_b64_tr_b16 a[246:247], v10 offset:1024
v_mfma_f32_16x16x32_bf16 v[252:255], a[168:171], a[220:223], v[252:255]
ds_read_b128 a[168:171], v4 offset:4096
v_mfma_f32_16x16x32_bf16 a[0:3], a[172:175], a[192:195], a[0:3]
ds_read_b64_tr_b16 a[248:249], v11 offset:0
v_mfma_f32_16x16x32_bf16 a[4:7], a[172:175], a[196:199], a[4:7]
v_mfma_f32_16x16x32_bf16 a[8:11], a[172:175], a[200:203], a[8:11]
ds_read_b64_tr_b16 a[250:251], v11 offset:1024
v_mfma_f32_16x16x32_bf16 a[12:15], a[172:175], a[204:207], a[12:15]
s_add_u32 s37, s31, 163840
v_mfma_f32_16x16x32_bf16 a[16:19], a[172:175], a[208:211], a[16:19]
s_add_u32 m0, s33, 5120
ds_read_b64_tr_b16 a[252:253], v12 offset:0
v_mfma_f32_16x16x32_bf16 a[20:23], a[172:175], a[212:215], a[20:23]
buffer_load_dwordx4 v2, s[20:23], s37 offen  lds
v_mfma_f32_16x16x32_bf16 a[24:27], a[172:175], a[216:219], a[24:27]
ds_read_b64_tr_b16 a[254:255], v12 offset:1024
v_mfma_f32_16x16x32_bf16 a[28:31], a[172:175], a[220:223], a[28:31]
ds_read_b128 a[172:175], v3 offset:5120
s_add_u32 s29, s29, s44
v_mfma_f32_16x16x32_bf16 a[32:35], a[176:179], a[192:195], a[32:35]
s_add_u32 s31, s31, 262144
s_add_u32 s33, s33, 16384
v_mfma_f32_16x16x32_bf16 a[36:39], a[176:179], a[196:199], a[36:39]
s_and_b32 s33, s33, 65535
buffer_store_dwordx4 v[156:159], v13, s[8:11], s29 offen sc1
v_mfma_f32_16x16x32_bf16 a[40:43], a[176:179], a[200:203], a[40:43]
ds_read_b128 v[28:31], v3 offset:13312
v_mfma_f32_16x16x32_bf16 a[44:47], a[176:179], a[204:207], a[44:47]
s_add_u32 s48, s48, s34
v_mfma_f32_16x16x32_bf16 a[48:51], a[176:179], a[208:211], a[48:51]
s_add_u32 m0, s32, 16384
v_mfma_f32_16x16x32_bf16 a[52:55], a[176:179], a[212:215], a[52:55]
buffer_load_dwordx4 v1, s[12:15], s48 offen lds
v_mfma_f32_16x16x32_bf16 a[56:59], a[176:179], a[216:219], a[56:59]
v_mfma_f32_16x16x32_bf16 a[60:63], a[176:179], a[220:223], a[60:63]
ds_read_b128 a[176:179], v4 offset:8192
v_mfma_f32_16x16x32_bf16 a[64:67], a[180:183], a[192:195], a[64:67]
v_mfma_f32_16x16x32_bf16 a[68:71], a[180:183], a[196:199], a[68:71]
v_mfma_f32_16x16x32_bf16 a[72:75], a[180:183], a[200:203], a[72:75]
v_mfma_f32_16x16x32_bf16 a[76:79], a[180:183], a[204:207], a[76:79]
s_add_u32 s48, s48, s34
v_mfma_f32_16x16x32_bf16 a[80:83], a[180:183], a[208:211], a[80:83]
s_add_u32 m0, s32, 20480
v_mfma_f32_16x16x32_bf16 a[84:87], a[180:183], a[212:215], a[84:87]
buffer_load_dwordx4 v1, s[12:15], s48 offen lds
v_mfma_f32_16x16x32_bf16 a[88:91], a[180:183], a[216:219], a[88:91]
buffer_load_dword v15, v14, s[96:99], s100 offen
s_add_u32 s100, s100, 8192
v_mfma_f32_16x16x32_bf16 a[92:95], a[180:183], a[220:223], a[92:95]
ds_read_b128 a[180:183], v3 offset:9216
v_mfma_f32_16x16x32_bf16 a[96:99], a[184:187], a[192:195], a[96:99]
v_mfma_f32_16x16x32_bf16 a[100:103], a[184:187], a[196:199], a[100:103]
v_mfma_f32_16x16x32_bf16 a[104:107], a[184:187], a[200:203], a[104:107]
v_mfma_f32_16x16x32_bf16 a[108:111], a[184:187], a[204:207], a[108:111]
s_add_u32 s48, s48, s34
v_mfma_f32_16x16x32_bf16 a[112:115], a[184:187], a[208:211], a[112:115]
s_add_u32 m0, s32, 24576
v_mfma_f32_16x16x32_bf16 a[116:119], a[184:187], a[212:215], a[116:119]
buffer_load_dwordx4 v1, s[12:15], s48 offen lds
v_mfma_f32_16x16x32_bf16 a[120:123], a[184:187], a[216:219], a[120:123]
v_mfma_f32_16x16x32_bf16 a[124:127], a[184:187], a[220:223], a[124:127]
ds_read_b128 a[184:187], v4 offset:12288
v_mfma_f32_16x16x32_bf16 a[128:131], a[188:191], a[192:195], a[128:131]
v_mfma_f32_16x16x32_bf16 a[132:135], a[188:191], a[196:199], a[132:135]
v_add_u32 v3, 32768, v3
v_subrev_u32 v19, 98304, v3
v_cmp_le_u32 vcc, 163840, v3
v_mfma_f32_16x16x32_bf16 a[136:139], a[188:191], a[200:203], a[136:139]
v_add_u32 v5, 16384, v5
v_and_b32 v5, 65535, v5
v_xor_b32 v6, 16, v5
v_mfma_f32_16x16x32_bf16 a[140:143], a[188:191], a[204:207], a[140:143]
s_add_u32 s48, s48, s34
v_xor_b32 v7, 64, v5
v_xor_b32 v8, 80, v5
v_mfma_f32_16x16x32_bf16 a[144:147], a[188:191], a[208:211], a[144:147]
s_add_u32 m0, s32, 28672
v_xor_b32 v9, 128, v5
v_xor_b32 v10, 144, v5
v_mfma_f32_16x16x32_bf16 a[148:151], a[188:191], a[212:215], a[148:151]
buffer_load_dwordx4 v1, s[12:15], s48 offen lds
v_xor_b32 v11, 192, v5
v_xor_b32 v12, 208, v5
v_mfma_f32_16x16x32_bf16 a[152:155], a[188:191], a[216:219], a[152:155]
s_add_u32 s30, s30, 128
s_add_u32 s32, s32, 32768
s_sub_u32 s48, s32, 98304
v_mfma_f32_16x16x32_bf16 a[156:159], a[188:191], a[220:223], a[156:159]
s_cmp_ge_u32 s32, 163840
s_cselect_b32 s32, s48, s32
v_cndmask_b32 v3, v3, v19, vcc
v_xor_b32 v4, 64, v3
s_waitcnt vmcnt(23) lgkmcnt(0)
s_barrier
v_mfma_f32_16x16x32_bf16 v[160:163], a[160:163], a[224:227], v[160:163]
ds_read_b64_tr_b16 a[192:193], v5 offset:0
v_mfma_f32_16x16x32_bf16 v[164:167], a[160:163], a[228:231], v[164:167]
v_mfma_f32_16x16x32_bf16 v[168:171], a[160:163], a[232:235], v[168:171]
ds_read_b64_tr_b16 a[194:195], v5 offset:1024
v_mfma_f32_16x16x32_bf16 v[172:175], a[160:163], a[236:239], v[172:175]
s_add_u32 s37, s31, 0
v_mfma_f32_16x16x32_bf16 v[176:179], a[160:163], a[240:243], v[176:179]
s_add_u32 m0, s33, 0
ds_read_b64_tr_b16 a[196:197], v6 offset:0
v_mfma_f32_16x16x32_bf16 v[180:183], a[160:163], a[244:247], v[180:183]
buffer_load_dwordx4 v2, s[20:23], s37 offen  lds
v_mfma_f32_16x16x32_bf16 v[184:187], a[160:163], a[248:251], v[184:187]
ds_read_b64_tr_b16 a[198:199], v6 offset:1024
v_mfma_f32_16x16x32_bf16 v[188:191], a[160:163], a[252:255], v[188:191]
ds_read_b128 a[160:163], v3 offset:0
v_mfma_f32_16x16x32_bf16 v[192:195], a[164:167], a[224:227], v[192:195]
ds_read_b64_tr_b16 a[200:201], v7 offset:0
v_mfma_f32_16x16x32_bf16 v[196:199], a[164:167], a[228:231], v[196:199]
v_mfma_f32_16x16x32_bf16 v[200:203], a[164:167], a[232:235], v[200:203]
ds_read_b64_tr_b16 a[202:203], v7 offset:1024
v_mfma_f32_16x16x32_bf16 v[204:207], a[164:167], a[236:239], v[204:207]
s_add_u32 s37, s31, 32768
v_mfma_f32_16x16x32_bf16 v[208:211], a[164:167], a[240:243], v[208:211]
s_add_u32 m0, s33, 1024
ds_read_b64_tr_b16 a[204:205], v8 offset:0
v_mfma_f32_16x16x32_bf16 v[212:215], a[164:167], a[244:247], v[212:215]
buffer_load_dwordx4 v2, s[20:23], s37 offen  lds
v_mfma_f32_16x16x32_bf16 v[216:219], a[164:167], a[248:251], v[216:219]
ds_read_b64_tr_b16 a[206:207], v8 offset:1024
v_mfma_f32_16x16x32_bf16 v[220:223], a[164:167], a[252:255], v[220:223]
ds_read_b128 a[164:167], v4 offset:1024
v_mfma_f32_16x16x32_bf16 v[224:227], a[168:171], a[224:227], v[224:227]
ds_read_b64_tr_b16 a[208:209], v9 offset:0
v_mfma_f32_16x16x32_bf16 v[228:231], a[168:171], a[228:231], v[228:231]
v_mfma_f32_16x16x32_bf16 v[232:235], a[168:171], a[232:235], v[232:235]
ds_read_b64_tr_b16 a[210:211], v9 offset:1024
v_mfma_f32_16x16x32_bf16 v[236:239], a[168:171], a[236:239], v[236:239]
s_add_u32 s37, s31, 131072
v_mfma_f32_16x16x32_bf16 v[240:243], a[168:171], a[240:243], v[240:243]
s_add_u32 m0, s33, 4096
ds_read_b64_tr_b16 a[212:213], v10 offset:0
v_mfma_f32_16x16x32_bf16 v[244:247], a[168:171], a[244:247], v[244:247]
buffer_load_dwordx4 v2, s[20:23], s37 offen  lds
v_mfma_f32_16x16x32_bf16 v[248:251], a[168:171], a[248:251], v[248:251]
ds_read_b64_tr_b16 a[214:215], v10 offset:1024
v_mfma_f32_16x16x32_bf16 v[252:255], a[168:171], a[252:255], v[252:255]
ds_read_b128 a[168:171], v3 offset:4096
v_mfma_f32_16x16x32_bf16 a[0:3], a[172:175], a[224:227], a[0:3]
ds_read_b64_tr_b16 a[216:217], v11 offset:0
v_mfma_f32_16x16x32_bf16 a[4:7], a[172:175], a[228:231], a[4:7]
v_mfma_f32_16x16x32_bf16 a[8:11], a[172:175], a[232:235], a[8:11]
ds_read_b64_tr_b16 a[218:219], v11 offset:1024
v_mfma_f32_16x16x32_bf16 a[12:15], a[172:175], a[236:239], a[12:15]
s_add_u32 s37, s31, 163840
v_mfma_f32_16x16x32_bf16 a[16:19], a[172:175], a[240:243], a[16:19]
s_add_u32 m0, s33, 5120
ds_read_b64_tr_b16 a[220:221], v12 offset:0
v_mfma_f32_16x16x32_bf16 a[20:23], a[172:175], a[244:247], a[20:23]
buffer_load_dwordx4 v2, s[20:23], s37 offen  lds
v_mfma_f32_16x16x32_bf16 a[24:27], a[172:175], a[248:251], a[24:27]
ds_read_b64_tr_b16 a[222:223], v12 offset:1024
v_mfma_f32_16x16x32_bf16 a[28:31], a[172:175], a[252:255], a[28:31]
ds_read_b128 a[172:175], v4 offset:5120
v_mfma_f32_16x16x32_bf16 a[32:35], a[176:179], a[224:227], a[32:35]
s_add_u32 s31, s31, 262144
s_add_u32 s33, s33, 16384
v_mfma_f32_16x16x32_bf16 a[36:39], a[176:179], a[228:231], a[36:39]
s_and_b32 s33, s33, 65535
ds_read_b128 a[188:191], v4 offset:13312
v_mfma_f32_16x16x32_bf16 a[40:43], a[176:179], a[232:235], a[40:43]
v_mfma_f32_16x16x32_bf16 a[44:47], a[176:179], a[236:239], a[44:47]
s_mov_b32 s48, s30
v_mfma_f32_16x16x32_bf16 a[48:51], a[176:179], a[240:243], a[48:51]
s_add_u32 m0, s32, 0
v_mfma_f32_16x16x32_bf16 a[52:55], a[176:179], a[244:247], a[52:55]
buffer_load_dwordx4 v1, s[12:15], s48 offen lds
v_mfma_f32_16x16x32_bf16 a[56:59], a[176:179], a[248:251], a[56:59]
v_mfma_f32_16x16x32_bf16 a[60:63], a[176:179], a[252:255], a[60:63]
ds_read_b128 a[176:179], v3 offset:8192
v_mfma_f32_16x16x32_bf16 a[64:67], a[180:183], a[224:227], a[64:67]
v_mfma_f32_16x16x32_bf16 a[68:71], a[180:183], a[228:231], a[68:71]
v_mfma_f32_16x16x32_bf16 a[72:75], a[180:183], a[232:235], a[72:75]
v_mfma_f32_16x16x32_bf16 a[76:79], a[180:183], a[236:239], a[76:79]
s_add_u32 s48, s48, s34
v_mfma_f32_16x16x32_bf16 a[80:83], a[180:183], a[240:243], a[80:83]
s_add_u32 m0, s32, 4096
v_mfma_f32_16x16x32_bf16 a[84:87], a[180:183], a[244:247], a[84:87]
buffer_load_dwordx4 v1, s[12:15], s48 offen lds
v_mfma_f32_16x16x32_bf16 a[88:91], a[180:183], a[248:251], a[88:91]
buffer_load_dword v15, v14, s[96:99], s100 offen
s_add_u32 s100, s100, 8192
v_mfma_f32_16x16x32_bf16 a[92:95], a[180:183], a[252:255], a[92:95]
ds_read_b128 a[180:183], v4 offset:9216
v_mfma_f32_16x16x32_bf16 a[96:99], a[184:187], a[224:227], a[96:99]
v_mfma_f32_16x16x32_bf16 a[100:103], a[184:187], a[228:231], a[100:103]
v_mfma_f32_16x16x32_bf16 a[104:107], a[184:187], a[232:235], a[104:107]
v_mfma_f32_16x16x32_bf16 a[108:111], a[184:187], a[236:239], a[108:111]
s_add_u32 s48, s48, s34
v_mfma_f32_16x16x32_bf16 a[112:115], a[184:187], a[240:243], a[112:115]
s_add_u32 m0, s32, 8192
v_mfma_f32_16x16x32_bf16 a[116:119], a[184:187], a[244:247], a[116:119]
buffer_load_dwordx4 v1, s[12:15], s48 offen lds
v_mfma_f32_16x16x32_bf16 a[120:123], a[184:187], a[248:251], a[120:123]
v_mfma_f32_16x16x32_bf16 a[124:127], a[184:187], a[252:255], a[124:127]
ds_read_b128 a[184:187], v3 offset:12288
v_mfma_f32_16x16x32_bf16 a[128:131], v[28:31], a[224:227], a[128:131]
v_mfma_f32_16x16x32_bf16 a[132:135], v[28:31], a[228:231], a[132:135]
v_add_u32 v5, 16384, v5
v_and_b32 v5, 65535, v5
v_xor_b32 v6, 16, v5
v_mfma_f32_16x16x32_bf16 a[136:139], v[28:31], a[232:235], a[136:139]
v_xor_b32 v7, 64, v5
v_xor_b32 v8, 80, v5
v_xor_b32 v9, 128, v5
v_mfma_f32_16x16x32_bf16 a[140:143], v[28:31], a[236:239], a[140:143]
s_add_u32 s48, s48, s34
v_xor_b32 v10, 144, v5
v_xor_b32 v11, 192, v5
v_mfma_f32_16x16x32_bf16 a[144:147], v[28:31], a[240:243], a[144:147]
s_add_u32 m0, s32, 12288
v_xor_b32 v12, 208, v5
v_mfma_f32_16x16x32_bf16 a[148:151], v[28:31], a[244:247], a[148:151]
buffer_load_dwordx4 v1, s[12:15], s48 offen lds
v_mfma_f32_16x16x32_bf16 a[152:155], v[28:31], a[248:251], a[152:155]
v_mfma_f32_16x16x32_bf16 a[156:159], v[28:31], a[252:255], a[156:159]
s_waitcnt vmcnt(20) lgkmcnt(0)
s_barrier
v_mfma_f32_16x16x32_bf16 v[160:163], a[160:163], a[192:195], v[160:163]
ds_read_b64_tr_b16 a[224:225], v5 offset:0
v_mfma_f32_16x16x32_bf16 v[164:167], a[160:163], a[196:199], v[164:167]
v_mfma_f32_16x16x32_bf16 v[168:171], a[160:163], a[200:203], v[168:171]
ds_read_b64_tr_b16 a[226:227], v5 offset:1024
v_mfma_f32_16x16x32_bf16 v[172:175], a[160:163], a[204:207], v[172:175]
s_add_u32 s37, s31, 0
v_mfma_f32_16x16x32_bf16 v[176:179], a[160:163], a[208:211], v[176:179]
s_add_u32 m0, s33, 0
ds_read_b64_tr_b16 a[228:229], v6 offset:0
v_mfma_f32_16x16x32_bf16 v[180:183], a[160:163], a[212:215], v[180:183]
buffer_load_dwordx4 v2, s[20:23], s37 offen  lds
v_mfma_f32_16x16x32_bf16 v[184:187], a[160:163], a[216:219], v[184:187]
ds_read_b64_tr_b16 a[230:231], v6 offset:1024
v_mfma_f32_16x16x32_bf16 v[188:191], a[160:163], a[220:223], v[188:191]
ds_read_b128 a[160:163], v4 offset:0
v_mfma_f32_16x16x32_bf16 v[192:195], a[164:167], a[192:195], v[192:195]
ds_read_b64_tr_b16 a[232:233], v7 offset:0
v_mfma_f32_16x16x32_bf16 v[196:199], a[164:167], a[196:199], v[196:199]
v_mfma_f32_16x16x32_bf16 v[200:203], a[164:167], a[200:203], v[200:203]
ds_read_b64_tr_b16 a[234:235], v7 offset:1024
v_mfma_f32_16x16x32_bf16 v[204:207], a[164:167], a[204:207], v[204:207]
s_add_u32 s37, s31, 32768
v_mfma_f32_16x16x32_bf16 v[208:211], a[164:167], a[208:211], v[208:211]
s_add_u32 m0, s33, 1024
ds_read_b64_tr_b16 a[236:237], v8 offset:0
v_mfma_f32_16x16x32_bf16 v[212:215], a[164:167], a[212:215], v[212:215]
buffer_load_dwordx4 v2, s[20:23], s37 offen  lds
v_mfma_f32_16x16x32_bf16 v[216:219], a[164:167], a[216:219], v[216:219]
ds_read_b64_tr_b16 a[238:239], v8 offset:1024
v_mfma_f32_16x16x32_bf16 v[220:223], a[164:167], a[220:223], v[220:223]
ds_read_b128 a[164:167], v3 offset:1024
v_mfma_f32_16x16x32_bf16 v[224:227], a[168:171], a[192:195], v[224:227]
ds_read_b64_tr_b16 a[240:241], v9 offset:0
v_mfma_f32_16x16x32_bf16 v[228:231], a[168:171], a[196:199], v[228:231]
v_mfma_f32_16x16x32_bf16 v[232:235], a[168:171], a[200:203], v[232:235]
ds_read_b64_tr_b16 a[242:243], v9 offset:1024
v_mfma_f32_16x16x32_bf16 v[236:239], a[168:171], a[204:207], v[236:239]
s_add_u32 s37, s31, 131072
v_mfma_f32_16x16x32_bf16 v[240:243], a[168:171], a[208:211], v[240:243]
s_add_u32 m0, s33, 4096
ds_read_b64_tr_b16 a[244:245], v10 offset:0
v_mfma_f32_16x16x32_bf16 v[244:247], a[168:171], a[212:215], v[244:247]
buffer_load_dwordx4 v2, s[20:23], s37 offen  lds
v_mfma_f32_16x16x32_bf16 v[248:251], a[168:171], a[216:219], v[248:251]
ds_read_b64_tr_b16 a[246:247], v10 offset:1024
v_mfma_f32_16x16x32_bf16 v[252:255], a[168:171], a[220:223], v[252:255]
ds_read_b128 a[168:171], v4 offset:4096
v_mfma_f32_16x16x32_bf16 a[0:3], a[172:175], a[192:195], a[0:3]
ds_read_b64_tr_b16 a[248:249], v11 offset:0
v_mfma_f32_16x16x32_bf16 a[4:7], a[172:175], a[196:199], a[4:7]
v_mfma_f32_16x16x32_bf16 a[8:11], a[172:175], a[200:203], a[8:11]
ds_read_b64_tr_b16 a[250:251], v11 offset:1024
v_mfma_f32_16x16x32_bf16 a[12:15], a[172:175], a[204:207], a[12:15]
s_add_u32 s37, s31, 163840
v_mfma_f32_16x16x32_bf16 a[16:19], a[172:175], a[208:211], a[16:19]
s_add_u32 m0, s33, 5120
ds_read_b64_tr_b16 a[252:253], v12 offset:0
v_mfma_f32_16x16x32_bf16 a[20:23], a[172:175], a[212:215], a[20:23]
buffer_load_dwordx4 v2, s[20:23], s37 offen  lds
v_mfma_f32_16x16x32_bf16 a[24:27], a[172:175], a[216:219], a[24:27]
ds_read_b64_tr_b16 a[254:255], v12 offset:1024
v_mfma_f32_16x16x32_bf16 a[28:31], a[172:175], a[220:223], a[28:31]
ds_read_b128 a[172:175], v3 offset:5120
v_mfma_f32_16x16x32_bf16 a[32:35], a[176:179], a[192:195], a[32:35]
s_add_u32 s31, s31, 262144
s_add_u32 s33, s33, 16384
v_mfma_f32_16x16x32_bf16 a[36:39], a[176:179], a[196:199], a[36:39]
s_and_b32 s33, s33, 65535
ds_read_b128 v[28:31], v3 offset:13312
v_mfma_f32_16x16x32_bf16 a[40:43], a[176:179], a[200:203], a[40:43]
v_mfma_f32_16x16x32_bf16 a[44:47], a[176:179], a[204:207], a[44:47]
s_add_u32 s48, s48, s34
v_mfma_f32_16x16x32_bf16 a[48:51], a[176:179], a[208:211], a[48:51]
s_add_u32 m0, s32, 16384
v_mfma_f32_16x16x32_bf16 a[52:55], a[176:179], a[212:215], a[52:55]
buffer_load_dwordx4 v1, s[12:15], s48 offen lds
v_mfma_f32_16x16x32_bf16 a[56:59], a[176:179], a[216:219], a[56:59]
v_mfma_f32_16x16x32_bf16 a[60:63], a[176:179], a[220:223], a[60:63]
ds_read_b128 a[176:179], v4 offset:8192
v_mfma_f32_16x16x32_bf16 a[64:67], a[180:183], a[192:195], a[64:67]
v_mfma_f32_16x16x32_bf16 a[68:71], a[180:183], a[196:199], a[68:71]
v_mfma_f32_16x16x32_bf16 a[72:75], a[180:183], a[200:203], a[72:75]
v_mfma_f32_16x16x32_bf16 a[76:79], a[180:183], a[204:207], a[76:79]
s_add_u32 s48, s48, s34
v_mfma_f32_16x16x32_bf16 a[80:83], a[180:183], a[208:211], a[80:83]
s_add_u32 m0, s32, 20480
v_mfma_f32_16x16x32_bf16 a[84:87], a[180:183], a[212:215], a[84:87]
buffer_load_dwordx4 v1, s[12:15], s48 offen lds
v_mfma_f32_16x16x32_bf16 a[88:91], a[180:183], a[216:219], a[88:91]
buffer_load_dword v15, v14, s[96:99], s100 offen
s_add_u32 s100, s100, 8192
v_mfma_f32_16x16x32_bf16 a[92:95], a[180:183], a[220:223], a[92:95]
ds_read_b128 a[180:183], v3 offset:9216
v_mfma_f32_16x16x32_bf16 a[96:99], a[184:187], a[192:195], a[96:99]
v_mfma_f32_16x16x32_bf16 a[100:103], a[184:187], a[196:199], a[100:103]
v_mfma_f32_16x16x32_bf16 a[104:107], a[184:187], a[200:203], a[104:107]
v_mfma_f32_16x16x32_bf16 a[108:111], a[184:187], a[204:207], a[108:111]
s_add_u32 s48, s48, s34
v_mfma_f32_16x16x32_bf16 a[112:115], a[184:187], a[208:211], a[112:115]
s_add_u32 m0, s32, 24576
v_mfma_f32_16x16x32_bf16 a[116:119], a[184:187], a[212:215], a[116:119]
buffer_load_dwordx4 v1, s[12:15], s48 offen lds
v_mfma_f32_16x16x32_bf16 a[120:123], a[184:187], a[216:219], a[120:123]
v_mfma_f32_16x16x32_bf16 a[124:127], a[184:187], a[220:223], a[124:127]
ds_read_b128 a[184:187], v4 offset:12288
v_mfma_f32_16x16x32_bf16 a[128:131], a[188:191], a[192:195], a[128:131]
v_mfma_f32_16x16x32_bf16 a[132:135], a[188:191], a[196:199], a[132:135]
v_add_u32 v3, 32768, v3
v_subrev_u32 v19, 98304, v3
v_cmp_le_u32 vcc, 163840, v3
v_mfma_f32_16x16x32_bf16 a[136:139], a[188:191], a[200:203], a[136:139]
v_add_u32 v5, 16384, v5
v_and_b32 v5, 65535, v5
v_xor_b32 v6, 16, v5
v_mfma_f32_16x16x32_bf16 a[140:143], a[188:191], a[204:207], a[140:143]
s_add_u32 s48, s48, s34
v_xor_b32 v7, 64, v5
v_xor_b32 v8, 80, v5
v_mfma_f32_16x16x32_bf16 a[144:147], a[188:191], a[208:211], a[144:147]
s_add_u32 m0, s32, 28672
v_xor_b32 v9, 128, v5
v_xor_b32 v10, 144, v5
v_mfma_f32_16x16x32_bf16 a[148:151], a[188:191], a[212:215], a[148:151]
buffer_load_dwordx4 v1, s[12:15], s48 offen lds
v_xor_b32 v11, 192, v5
v_xor_b32 v12, 208, v5
v_mfma_f32_16x16x32_bf16 a[152:155], a[188:191], a[216:219], a[152:155]
s_add_u32 s30, s30, 128
s_add_u32 s32, s32, 32768
s_sub_u32 s48, s32, 98304
v_mfma_f32_16x16x32_bf16 a[156:159], a[188:191], a[220:223], a[156:159]
s_cmp_ge_u32 s32, 163840
s_cselect_b32 s32, s48, s32
v_cndmask_b32 v3, v3, v19, vcc
v_xor_b32 v4, 64, v3
s_cmp_eq_u32 s41, 0
s_cbranch_scc0 L_g_v17v
s_waitcnt vmcnt(18) lgkmcnt(0)
s_barrier
v_mfma_f32_16x16x32_bf16 v[160:163], a[160:163], a[224:227], v[160:163]
ds_read_b128 a[192:195], v3 offset:0
v_mfma_f32_16x16x32_bf16 v[164:167], a[160:163], a[228:231], v[164:167]
v_mfma_f32_16x16x32_bf16 v[168:171], a[160:163], a[232:235], v[168:171]
ds_read_b128 a[196:199], v4 offset:1024
v_mfma_f32_16x16x32_bf16 v[172:175], a[160:163], a[236:239], v[172:175]
s_add_u32 s37, s31, 0
v_mfma_f32_16x16x32_bf16 v[176:179], a[160:163], a[240:243], v[176:179]
s_add_u32 m0, s33, 0
ds_read_b128 a[200:203], v3 offset:4096
v_cvt_pk_bf16_f32 v32, v160, v161
v_cvt_pk_bf16_f32 v33, v162, v163
v_mfma_f32_16x16x32_bf16 v[180:183], a[160:163], a[244:247], v[180:183]
buffer_load_dwordx4 v2, s[20:23], s37 offen  lds
v_cvt_pk_bf16_f32 v36, v164, v165
v_cvt_pk_bf16_f32 v37, v166, v167
v_mfma_f32_16x16x32_bf16 v[184:187], a[160:163], a[248:251], v[184:187]
ds_read_b128 a[204:207], v4 offset:5120
v_cvt_pk_bf16_f32 v40, v168, v169
v_cvt_pk_bf16_f32 v41, v170, v171
v_mfma_f32_16x16x32_bf16 v[188:191], a[160:163], a[252:255], v[188:191]
ds_read_b64_tr_b16 a[160:161], v5 offset:0
v_cvt_pk_bf16_f32 v44, v172, v173
v_cvt_pk_bf16_f32 v45, v174, v175
v_mfma_f32_16x16x32_bf16 v[192:195], a[164:167], a[224:227], v[192:195]
ds_read_b64_tr_b16 a[162:163], v5 offset:1024
ds_read_b128 a[208:211], v3 offset:8192
v_cvt_pk_bf16_f32 v48, v176, v177
v_cvt_pk_bf16_f32 v49, v178, v179
v_mfma_f32_16x16x32_bf16 v[196:199], a[164:167], a[228:231], v[196:199]
v_cvt_pk_bf16_f32 v52, v180, v181
v_cvt_pk_bf16_f32 v53, v182, v183
v_mfma_f32_16x16x32_bf16 v[200:203], a[164:167], a[232:235], v[200:203]
ds_read_b128 a[212:215], v4 offset:9216
v_cvt_pk_bf16_f32 v56, v184, v185
v_cvt_pk_bf16_f32 v57, v186, v187
v_mfma_f32_16x16x32_bf16 v[204:207], a[164:167], a[236:239], v[204:207]
s_add_u32 s37, s31, 32768
v_cvt_pk_bf16_f32 v60, v188, v189
v_cvt_pk_bf16_f32 v61, v190, v191
v_mfma_f32_16x16x32_bf16 v[208:211], a[164:167], a[240:243], v[208:211]
s_add_u32 m0, s33, 1024
ds_read_b128 a[216:219], v3 offset:12288
v_cvt_pk_bf16_f32 v34, v192, v193
v_cvt_pk_bf16_f32 v35, v194, v195
v_mfma_f32_16x16x32_bf16 v[212:215], a[164:167], a[244:247], v[212:215]
buffer_load_dwordx4 v2, s[20:23], s37 offen  lds
v_cvt_pk_bf16_f32 v38, v196, v197
v_cvt_pk_bf16_f32 v39, v198, v199
v_mfma_f32_16x16x32_bf16 v[216:219], a[164:167], a[248:251], v[216:219]
ds_read_b128 a[220:223], v4 offset:13312
v_cvt_pk_bf16_f32 v42, v200, v201
v_cvt_pk_bf16_f32 v43, v202, v203
v_mfma_f32_16x16x32_bf16 v[220:223], a[164:167], a[252:255], v[220:223]
ds_read_b64_tr_b16 a[164:165], v6 offset:0
v_cvt_pk_bf16_f32 v46, v204, v205
v_cvt_pk_bf16_f32 v47, v206, v207
v_mfma_f32_16x16x32_bf16 v[224:227], a[168:171], a[224:227], v[224:227]
ds_read_b64_tr_b16 a[166:167], v6 offset:1024
ds_read_b64_tr_b16 a[188:189], v12 offset:0
v_cvt_pk_bf16_f32 v50, v208, v209
v_cvt_pk_bf16_f32 v51, v210, v211
v_mfma_f32_16x16x32_bf16 v[228:231], a[168:171], a[228:231], v[228:231]
v_cvt_pk_bf16_f32 v54, v212, v213
v_cvt_pk_bf16_f32 v55, v214, v215
v_mfma_f32_16x16x32_bf16 v[232:235], a[168:171], a[232:235], v[232:235]
ds_read_b64_tr_b16 a[190:191], v12 offset:1024
v_cvt_pk_bf16_f32 v58, v216, v217
v_cvt_pk_bf16_f32 v59, v218, v219
v_mfma_f32_16x16x32_bf16 v[236:239], a[168:171], a[236:239], v[236:239]
s_add_u32 s37, s31, 131072
v_cvt_pk_bf16_f32 v62, v220, v221
v_cvt_pk_bf16_f32 v63, v222, v223
v_mfma_f32_16x16x32_bf16 v[240:243], a[168:171], a[240:243], v[240:243]
s_add_u32 m0, s33, 4096
v_cvt_pk_bf16_f32 v64, v224, v225
v_cvt_pk_bf16_f32 v65, v226, v227
v_mfma_f32_16x16x32_bf16 v[244:247], a[168:171], a[244:247], v[244:247]
buffer_load_dwordx4 v2, s[20:23], s37 offen  lds
v_cvt_pk_bf16_f32 v68, v228, v229
v_cvt_pk_bf16_f32 v69, v230, v231
v_mfma_f32_16x16x32_bf16 v[248:251], a[168:171], a[248:251], v[248:251]
v_cvt_pk_bf16_f32 v72, v232, v233
v_cvt_pk_bf16_f32 v73, v234, v235
v_mfma_f32_16x16x32_bf16 v[252:255], a[168:171], a[252:255], v[252:255]
ds_read_b64_tr_b16 a[168:169], v7 offset:0
v_cvt_pk_bf16_f32 v76, v236, v237
v_cvt_pk_bf16_f32 v77, v238, v239
v_mfma_f32_16x16x32_bf16 a[0:3], a[172:175], a[224:227], a[0:3]
ds_read_b64_tr_b16 a[170:171], v7 offset:1024
v_cvt_pk_bf16_f32 v80, v240, v241
v_cvt_pk_bf16_f32 v81, v242, v243
v_mfma_f32_16x16x32_bf16 a[4:7], a[172:175], a[228:231], a[4:7]
v_cvt_pk_bf16_f32 v84, v244, v245
v_cvt_pk_bf16_f32 v85, v246, v247
v_mfma_f32_16x16x32_bf16 a[8:11], a[172:175], a[232:235], a[8:11]
v_cvt_pk_bf16_f32 v88, v248, v249
v_cvt_pk_bf16_f32 v89, v250, v251
v_mfma_f32_16x16x32_bf16 a[12:15], a[172:175], a[236:239], a[12:15]
s_add_u32 s37, s31, 163840
v_cvt_pk_bf16_f32 v92, v252, v253
v_cvt_pk_bf16_f32 v93, v254, v255
v_mfma_f32_16x16x32_bf16 a[16:19], a[172:175], a[240:243], a[16:19]
s_add_u32 m0, s33, 5120
v_accvgpr_read_b32 v20, a0
v_accvgpr_read_b32 v21, a1
v_accvgpr_read_b32 v22, a2
v_mfma_f32_16x16x32_bf16 a[20:23], a[172:175], a[244:247], a[20:23]
buffer_load_dwordx4 v2, s[20:23], s37 offen  lds
v_accvgpr_read_b32 v23, a3
v_cvt_pk_bf16_f32 v66, v20, v21
v_cvt_pk_bf16_f32 v67, v22, v23
v_mfma_f32_16x16x32_bf16 a[24:27], a[172:175], a[248:251], a[24:27]
v_accvgpr_read_b32 v24, a4
v_accvgpr_read_b32 v25, a5
v_accvgpr_read_b32 v26, a6
v_accvgpr_read_b32 v27, a7
v_mfma_f32_16x16x32_bf16 a[28:31], a[172:175], a[252:255], a[28:31]
ds_read_b64_tr_b16 a[172:173], v8 offset:0
v_cvt_pk_bf16_f32 v70, v24, v25
v_cvt_pk_bf16_f32 v71, v26, v27
v_accvgpr_read_b32 v20, a8
v_mfma_f32_16x16x32_bf16 a[32:35], a[176:179], a[224:227], a[32:35]
ds_read_b64_tr_b16 a[174:175], v8 offset:1024
s_add_u32 s31, s31, 262144
v_accvgpr_read_b32 v21, a9
v_accvgpr_read_b32 v22, a10
v_mfma_f32_16x16x32_bf16 a[36:39], a[176:179], a[228:231], a[36:39]
s_add_u32 s33, s33, 16384
s_and_b32 s33, s33, 65535
v_accvgpr_read_b32 v23, a11
v_cvt_pk_bf16_f32 v74, v20, v21
v_mfma_f32_16x16x32_bf16 a[40:43], a[176:179], a[232:235], a[40:43]
v_mov_b32 v16, 0
v_mov_b32 v17, 1
v_cvt_pk_bf16_f32 v75, v22, v23
v_accvgpr_read_b32 v24, a12
v_mfma_f32_16x16x32_bf16 a[44:47], a[176:179], a[236:239], a[44:47]
s_mov_b32 s48, s30
v_accvgpr_read_b32 v25, a13
v_accvgpr_read_b32 v26, a14
v_accvgpr_read_b32 v27, a15
v_mfma_f32_16x16x32_bf16 a[48:51], a[176:179], a[240:243], a[48:51]
s_add_u32 m0, s32, 0
v_cvt_pk_bf16_f32 v78, v24, v25
v_cvt_pk_bf16_f32 v79, v26, v27
v_accvgpr_read_b32 v20, a16
v_mfma_f32_16x16x32_bf16 a[52:55], a[176:179], a[244:247], a[52:55]
buffer_load_dwordx4 v1, s[12:15], s48 offen lds
v_accvgpr_read_b32 v21, a17
v_accvgpr_read_b32 v22, a18
v_accvgpr_read_b32 v23, a19
v_mfma_f32_16x16x32_bf16 a[56:59], a[176:179], a[248:251], a[56:59]
s_cmp_eq_u32 s17, 0
s_cselect_b32 s29, s39, 536870912
v_cvt_pk_bf16_f32 v82, v20, v21
v_cvt_pk_bf16_f32 v83, v22, v23
v_mfma_f32_16x16x32_bf16 a[60:63], a[176:179], a[252:255], a[60:63]
ds_read_b64_tr_b16 a[176:177], v9 offset:0
v_accvgpr_read_b32 v24, a20
v_accvgpr_read_b32 v25, a21
v_accvgpr_read_b32 v26, a22
v_mfma_f32_16x16x32_bf16 a[64:67], a[180:183], a[224:227], a[64:67]
ds_read_b64_tr_b16 a[178:179], v9 offset:1024
v_accvgpr_read_b32 v27, a23
v_cvt_pk_bf16_f32 v86, v24, v25
v_cvt_pk_bf16_f32 v87, v26, v27
v_mfma_f32_16x16x32_bf16 a[68:71], a[180:183], a[228:231], a[68:71]
s_mov_b64 exec, 1
buffer_store_dword v17, v16, s[8:11], s29 offen sc1
s_mov_b64 exec, -1
v_accvgpr_read_b32 v20, a24
v_mfma_f32_16x16x32_bf16 a[72:75], a[180:183], a[232:235], a[72:75]
v_accvgpr_read_b32 v21, a25
v_accvgpr_read_b32 v22, a26
v_accvgpr_read_b32 v23, a27
v_cvt_pk_bf16_f32 v90, v20, v21
v_mfma_f32_16x16x32_bf16 a[76:79], a[180:183], a[236:239], a[76:79]
s_add_u32 s48, s48, s34
v_cvt_pk_bf16_f32 v91, v22, v23
v_accvgpr_read_b32 v24, a28
v_accvgpr_read_b32 v25, a29
v_mfma_f32_16x16x32_bf16 a[80:83], a[180:183], a[240:243], a[80:83]
s_add_u32 m0, s32, 4096
v_accvgpr_read_b32 v26, a30
v_accvgpr_read_b32 v27, a31
v_cvt_pk_bf16_f32 v94, v24, v25
v_mfma_f32_16x16x32_bf16 a[84:87], a[180:183], a[244:247], a[84:87]
buffer_load_dwordx4 v1, s[12:15], s48 offen lds
v_cvt_pk_bf16_f32 v95, v26, v27
v_accvgpr_read_b32 v20, a32
v_accvgpr_read_b32 v21, a33
v_mfma_f32_16x16x32_bf16 a[88:91], a[180:183], a[248:251], a[88:91]
buffer_load_dword v15, v14, s[96:99], s100 offen
s_add_u32 s100, s100, 8192
v_accvgpr_read_b32 v22, a34
v_accvgpr_read_b32 v23, a35
v_mfma_f32_16x16x32_bf16 a[92:95], a[180:183], a[252:255], a[92:95]
ds_read_b64_tr_b16 a[180:181], v10 offset:0
v_cvt_pk_bf16_f32 v96, v20, v21
v_cvt_pk_bf16_f32 v97, v22, v23
v_accvgpr_read_b32 v24, a36
v_mfma_f32_16x16x32_bf16 a[96:99], a[184:187], a[224:227], a[96:99]
ds_read_b64_tr_b16 a[182:183], v10 offset:1024
v_accvgpr_read_b32 v25, a37
v_accvgpr_read_b32 v26, a38
v_accvgpr_read_b32 v27, a39
v_mfma_f32_16x16x32_bf16 a[100:103], a[184:187], a[228:231], a[100:103]
v_cvt_pk_bf16_f32 v100, v24, v25
v_cvt_pk_bf16_f32 v101, v26, v27
v_accvgpr_read_b32 v20, a40
v_accvgpr_read_b32 v21, a41
v_mfma_f32_16x16x32_bf16 a[104:107], a[184:187], a[232:235], a[104:107]
v_accvgpr_read_b32 v22, a42
v_accvgpr_read_b32 v23, a43
v_cvt_pk_bf16_f32 v104, v20, v21
v_cvt_pk_bf16_f32 v105, v22, v23
v_mfma_f32_16x16x32_bf16 a[108:111], a[184:187], a[236:239], a[108:111]
s_add_u32 s48, s48, s34
v_accvgpr_read_b32 v24, a44
v_accvgpr_read_b32 v25, a45
v_accvgpr_read_b32 v26, a46
v_mfma_f32_16x16x32_bf16 a[112:115], a[184:187], a[240:243], a[112:115]
s_add_u32 m0, s32, 8192
v_accvgpr_read_b32 v27, a47
v_cvt_pk_bf16_f32 v108, v24, v25
v_cvt_pk_bf16_f32 v109, v26, v27
v_mfma_f32_16x16x32_bf16 a[116:119], a[184:187], a[244:247], a[116:119]
buffer_load_dwordx4 v1, s[12:15], s48 offen lds
v_accvgpr_read_b32 v20, a48
v_accvgpr_read_b32 v21, a49
v_accvgpr_read_b32 v22, a50
v_mfma_f32_16x16x32_bf16 a[120:123], a[184:187], a[248:251], a[120:123]
v_accvgpr_read_b32 v23, a51
v_cvt_pk_bf16_f32 v112, v20, v21
v_cvt_pk_bf16_f32 v113, v22, v23
v_accvgpr_read_b32 v24, a52
v_mfma_f32_16x16x32_bf16 a[124:127], a[184:187], a[252:255], a[124:127]
ds_read_b64_tr_b16 a[184:185], v11 offset:0
v_accvgpr_read_b32 v25, a53
v_accvgpr_read_b32 v26, a54
v_accvgpr_read_b32 v27, a55
v_mfma_f32_16x16x32_bf16 a[128:131], v[28:31], a[224:227], a[128:131]
ds_read_b64_tr_b16 a[186:187], v11 offset:1024
v_cvt_pk_bf16_f32 v116, v24, v25
v_cvt_pk_bf16_f32 v117, v26, v27
v_accvgpr_read_b32 v20, a56
v_mfma_f32_16x16x32_bf16 a[132:135], v[28:31], a[228:231], a[132:135]
v_add_u32 v5, 16384, v5
v_and_b32 v5, 65535, v5
v_xor_b32 v6, 16, v5
v_accvgpr_read_b32 v21, a57
v_mfma_f32_16x16x32_bf16 a[136:139], v[28:31], a[232:235], a[136:139]
v_xor_b32 v7, 64, v5
v_xor_b32 v8, 80, v5
v_xor_b32 v9, 128, v5
v_accvgpr_read_b32 v22, a58
v_mfma_f32_16x16x32_bf16 a[140:143], v[28:31], a[236:239], a[140:143]
s_add_u32 s48, s48, s34
v_xor_b32 v10, 144, v5
v_xor_b32 v11, 192, v5
v_accvgpr_read_b32 v23, a59
v_mfma_f32_16x16x32_bf16 a[144:147], v[28:31], a[240:243], a[144:147]
s_add_u32 m0, s32, 12288
v_xor_b32 v12, 208, v5
v_cvt_pk_bf16_f32 v120, v20, v21
v_cvt_pk_bf16_f32 v121, v22, v23
v_mfma_f32_16x16x32_bf16 a[148:151], v[28:31], a[244:247], a[148:151]
buffer_load_dwordx4 v1, s[12:15], s48 offen lds
v_accvgpr_read_b32 v24, a60
v_accvgpr_read_b32 v25, a61
v_accvgpr_read_b32 v26, a62
v_mfma_f32_16x16x32_bf16 a[152:155], v[28:31], a[248:251], a[152:155]
v_accvgpr_read_b32 v27, a63
v_cvt_pk_bf16_f32 v124, v24, v25
v_cvt_pk_bf16_f32 v125, v26, v27
v_mfma_f32_16x16x32_bf16 a[156:159], v[28:31], a[252:255], a[156:159]
s_cmp_lt_u32 s35, s45
s_cbranch_scc1 L_g_tile
s_branch L_g_end
L_g_v17v:
s_waitcnt vmcnt(18) lgkmcnt(0)
s_barrier
v_mfma_f32_16x16x32_bf16 v[160:163], a[160:163], a[224:227], v[160:163]
ds_read_b64_tr_b16 a[192:193], v5 offset:0
v_mfma_f32_16x16x32_bf16 v[164:167], a[160:163], a[228:231], v[164:167]
v_mfma_f32_16x16x32_bf16 v[168:171], a[160:163], a[232:235], v[168:171]
ds_read_b64_tr_b16 a[194:195], v5 offset:1024
v_mfma_f32_16x16x32_bf16 v[172:175], a[160:163], a[236:239], v[172:175]
s_add_u32 s37, s31, 0
v_mfma_f32_16x16x32_bf16 v[176:179], a[160:163], a[240:243], v[176:179]
s_add_u32 m0, s33, 0
ds_read_b64_tr_b16 a[196:197], v6 offset:0
v_cvt_pk_bf16_f32 v32, v160, v161
v_cvt_pk_bf16_f32 v33, v162, v163
v_mfma_f32_16x16x32_bf16 v[180:183], a[160:163], a[244:247], v[180:183]
buffer_load_dwordx4 v2, s[20:23], s37 offen  lds
v_cvt_pk_bf16_f32 v36, v164, v165
v_cvt_pk_bf16_f32 v37, v166, v167
v_mfma_f32_16x16x32_bf16 v[184:187], a[160:163], a[248:251], v[184:187]
ds_read_b64_tr_b16 a[198:199], v6 offset:1024
v_cvt_pk_bf16_f32 v40, v168, v169
v_cvt_pk_bf16_f32 v41, v170, v171
v_mfma_f32_16x16x32_bf16 v[188:191], a[160:163], a[252:255], v[188:191]
ds_read_b128 a[160:163], v3 offset:0
v_cvt_pk_bf16_f32 v44, v172, v173
v_cvt_pk_bf16_f32 v45, v174, v175
v_mfma_f32_16x16x32_bf16 v[192:195], a[164:167], a[224:227], v[192:195]
ds_read_b64_tr_b16 a[200:201], v7 offset:0
v_cvt_pk_bf16_f32 v48, v176, v177
v_cvt_pk_bf16_f32 v49, v178, v179
v_mfma_f32_16x16x32_bf16 v[196:199], a[164:167], a[228:231], v[196:199]
v_cvt_pk_bf16_f32 v52, v180, v181
v_cvt_pk_bf16_f32 v53, v182, v183
v_mfma_f32_16x16x32_bf16 v[200:203], a[164:167], a[232:235], v[200:203]
ds_read_b64_tr_b16 a[202:203], v7 offset:1024
v_cvt_pk_bf16_f32 v56, v184, v185
v_cvt_pk_bf16_f32 v57, v186, v187
v_mfma_f32_16x16x32_bf16 v[204:207], a[164:167], a[236:239], v[204:207]
s_add_u32 s37, s31, 32768
v_cvt_pk_bf16_f32 v60, v188, v189
v_cvt_pk_bf16_f32 v61, v190, v191
v_mfma_f32_16x16x32_bf16 v[208:211], a[164:167], a[240:243], v[208:211]
s_add_u32 m0, s33, 1024
ds_read_b64_tr_b16 a[204:205], v8 offset:0
v_cvt_pk_bf16_f32 v34, v192, v193
v_cvt_pk_bf16_f32 v35, v194, v195
v_mfma_f32_16x16x32_bf16 v[212:215], a[164:167], a[244:247], v[212:215]
buffer_load_dwordx4 v2, s[20:23], s37 offen  lds
v_cvt_pk_bf16_f32 v38, v196, v197
v_cvt_pk_bf16_f32 v39, v198, v199
v_mfma_f32_16x16x32_bf16 v[216:219], a[164:167], a[248:251], v[216:219]
ds_read_b64_tr_b16 a[206:207], v8 offset:1024
v_cvt_pk_bf16_f32 v42, v200, v201
v_cvt_pk_bf16_f32 v43, v202, v203
v_mfma_f32_16x16x32_bf16 v[220:223], a[164:167], a[252:255], v[220:223]
ds_read_b128 a[164:167], v4 offset:1024
v_cvt_pk_bf16_f32 v46, v204, v205
v_cvt_pk_bf16_f32 v47, v206, v207
v_mfma_f32_16x16x32_bf16 v[224:227], a[168:171], a[224:227], v[224:227]
ds_read_b64_tr_b16 a[208:209], v9 offset:0
v_cvt_pk_bf16_f32 v50, v208, v209
v_cvt_pk_bf16_f32 v51, v210, v211
v_mfma_f32_16x16x32_bf16 v[228:231], a[168:171], a[228:231], v[228:231]
v_cvt_pk_bf16_f32 v54, v212, v213
v_cvt_pk_bf16_f32 v55, v214, v215
v_mfma_f32_16x16x32_bf16 v[232:235], a[168:171], a[232:235], v[232:235]
ds_read_b64_tr_b16 a[210:211], v9 offset:1024
v_cvt_pk_bf16_f32 v58, v216, v217
v_cvt_pk_bf16_f32 v59, v218, v219
v_mfma_f32_16x16x32_bf16 v[236:239], a[168:171], a[236:239], v[236:239]
s_add_u32 s37, s31, 131072
v_cvt_pk_bf16_f32 v62, v220, v221
v_cvt_pk_bf16_f32 v63, v222, v223
v_mfma_f32_16x16x32_bf16 v[240:243], a[168:171], a[240:243], v[240:243]
s_add_u32 m0, s33, 4096
ds_read_b64_tr_b16 a[212:213], v10 offset:0
v_cvt_pk_bf16_f32 v64, v224, v225
v_cvt_pk_bf16_f32 v65, v226, v227
v_mfma_f32_16x16x32_bf16 v[244:247], a[168:171], a[244:247], v[244:247]
buffer_load_dwordx4 v2, s[20:23], s37 offen  lds
v_cvt_pk_bf16_f32 v68, v228, v229
v_cvt_pk_bf16_f32 v69, v230, v231
v_mfma_f32_16x16x32_bf16 v[248:251], a[168:171], a[248:251], v[248:251]
ds_read_b64_tr_b16 a[214:215], v10 offset:1024
v_cvt_pk_bf16_f32 v72, v232, v233
v_cvt_pk_bf16_f32 v73, v234, v235
v_mfma_f32_16x16x32_bf16 v[252:255], a[168:171], a[252:255], v[252:255]
ds_read_b128 a[168:171], v3 offset:4096
v_cvt_pk_bf16_f32 v76, v236, v237
v_cvt_pk_bf16_f32 v77, v238, v239
v_mfma_f32_16x16x32_bf16 a[0:3], a[172:175], a[224:227], a[0:3]
ds_read_b64_tr_b16 a[216:217], v11 offset:0
v_cvt_pk_bf16_f32 v80, v240, v241
v_cvt_pk_bf16_f32 v81, v242, v243
v_mfma_f32_16x16x32_bf16 a[4:7], a[172:175], a[228:231], a[4:7]
v_cvt_pk_bf16_f32 v84, v244, v245
v_cvt_pk_bf16_f32 v85, v246, v247
v_mfma_f32_16x16x32_bf16 a[8:11], a[172:175], a[232:235], a[8:11]
ds_read_b64_tr_b16 a[218:219], v11 offset:1024
v_cvt_pk_bf16_f32 v88, v248, v249
v_cvt_pk_bf16_f32 v89, v250, v251
v_mfma_f32_16x16x32_bf16 a[12:15], a[172:175], a[236:239], a[12:15]
s_add_u32 s37, s31, 163840
v_cvt_pk_bf16_f32 v92, v252, v253
v_cvt_pk_bf16_f32 v93, v254, v255
v_mfma_f32_16x16x32_bf16 a[16:19], a[172:175], a[240:243], a[16:19]
s_add_u32 m0, s33, 5120
ds_read_b64_tr_b16 a[220:221], v12 offset:0
v_accvgpr_read_b32 v20, a0
v_accvgpr_read_b32 v21, a1
v_mfma_f32_16x16x32_bf16 a[20:23], a[172:175], a[244:247], a[20:23]
buffer_load_dwordx4 v2, s[20:23], s37 offen  lds
v_accvgpr_read_b32 v22, a2
v_accvgpr_read_b32 v23, a3
v_cvt_pk_bf16_f32 v66, v20, v21
v_mfma_f32_16x16x32_bf16 a[24:27], a[172:175], a[248:251], a[24:27]
ds_read_b64_tr_b16 a[222:223], v12 offset:1024
v_cvt_pk_bf16_f32 v67, v22, v23
v_accvgpr_read_b32 v24, a4
v_accvgpr_read_b32 v25, a5
v_mfma_f32_16x16x32_bf16 a[28:31], a[172:175], a[252:255], a[28:31]
ds_read_b128 a[172:175], v4 offset:5120
v_accvgpr_read_b32 v26, a6
v_accvgpr_read_b32 v27, a7
v_cvt_pk_bf16_f32 v70, v24, v25
v_mfma_f32_16x16x32_bf16 a[32:35], a[176:179], a[224:227], a[32:35]
s_add_u32 s31, s31, 262144
s_add_u32 s33, s33, 16384
v_cvt_pk_bf16_f32 v71, v26, v27
v_accvgpr_read_b32 v20, a8
v_mfma_f32_16x16x32_bf16 a[36:39], a[176:179], a[228:231], a[36:39]
s_and_b32 s33, s33, 65535
ds_read_b128 a[188:191], v4 offset:13312
v_accvgpr_read_b32 v21, a9
v_accvgpr_read_b32 v22, a10
v_mfma_f32_16x16x32_bf16 a[40:43], a[176:179], a[232:235], a[40:43]
v_mov_b32 v16, 0
v_mov_b32 v17, 1
v_accvgpr_read_b32 v23, a11
v_cvt_pk_bf16_f32 v74, v20, v21
v_mfma_f32_16x16x32_bf16 a[44:47], a[176:179], a[236:239], a[44:47]
s_mov_b32 s48, s30
v_cvt_pk_bf16_f32 v75, v22, v23
v_accvgpr_read_b32 v24, a12
v_accvgpr_read_b32 v25, a13
v_mfma_f32_16x16x32_bf16 a[48:51], a[176:179], a[240:243], a[48:51]
s_add_u32 m0, s32, 0
v_accvgpr_read_b32 v26, a14
v_accvgpr_read_b32 v27, a15
v_cvt_pk_bf16_f32 v78, v24, v25
v_mfma_f32_16x16x32_bf16 a[52:55], a[176:179], a[244:247], a[52:55]
buffer_load_dwordx4 v1, s[12:15], s48 offen lds
v_cvt_pk_bf16_f32 v79, v26, v27
v_accvgpr_read_b32 v20, a16
v_accvgpr_read_b32 v21, a17
v_mfma_f32_16x16x32_bf16 a[56:59], a[176:179], a[248:251], a[56:59]
s_cmp_eq_u32 s17, 0
s_cselect_b32 s29, s39, 536870912
v_accvgpr_read_b32 v22, a18
v_accvgpr_read_b32 v23, a19
v_mfma_f32_16x16x32_bf16 a[60:63], a[176:179], a[252:255], a[60:63]
ds_read_b128 a[176:179], v3 offset:8192
v_cvt_pk_bf16_f32 v82, v20, v21
v_cvt_pk_bf16_f32 v83, v22, v23
v_accvgpr_read_b32 v24, a20
v_mfma_f32_16x16x32_bf16 a[64:67], a[180:183], a[224:227], a[64:67]
s_mov_b64 exec, 1
buffer_store_dword v17, v16, s[8:11], s29 offen sc1
s_mov_b64 exec, -1
v_accvgpr_read_b32 v25, a21
v_mfma_f32_16x16x32_bf16 a[68:71], a[180:183], a[228:231], a[68:71]
v_accvgpr_read_b32 v26, a22
v_accvgpr_read_b32 v27, a23
v_cvt_pk_bf16_f32 v86, v24, v25
v_cvt_pk_bf16_f32 v87, v26, v27
v_mfma_f32_16x16x32_bf16 a[72:75], a[180:183], a[232:235], a[72:75]
v_accvgpr_read_b32 v20, a24
v_accvgpr_read_b32 v21, a25
v_accvgpr_read_b32 v22, a26
v_accvgpr_read_b32 v23, a27
v_mfma_f32_16x16x32_bf16 a[76:79], a[180:183], a[236:239], a[76:79]
s_add_u32 s48, s48, s34
v_cvt_pk_bf16_f32 v90, v20, v21
v_cvt_pk_bf16_f32 v91, v22, v23
v_accvgpr_read_b32 v24, a28
v_mfma_f32_16x16x32_bf16 a[80:83], a[180:183], a[240:243], a[80:83]
s_add_u32 m0, s32, 4096
v_accvgpr_read_b32 v25, a29
v_accvgpr_read_b32 v26, a30
v_accvgpr_read_b32 v27, a31
v_mfma_f32_16x16x32_bf16 a[84:87], a[180:183], a[244:247], a[84:87]
buffer_load_dwordx4 v1, s[12:15], s48 offen lds
v_cvt_pk_bf16_f32 v94, v24, v25
v_cvt_pk_bf16_f32 v95, v26, v27
v_accvgpr_read_b32 v20, a32
v_mfma_f32_16x16x32_bf16 a[88:91], a[180:183], a[248:251], a[88:91]
buffer_load_dword v15, v14, s[96:99], s100 offen
s_add_u32 s100, s100, 8192
v_accvgpr_read_b32 v21, a33
v_accvgpr_read_b32 v22, a34
v_mfma_f32_16x16x32_bf16 a[92:95], a[180:183], a[252:255], a[92:95]
ds_read_b128 a[180:183], v4 offset:9216
v_accvgpr_read_b32 v23, a35
v_cvt_pk_bf16_f32 v96, v20, v21
v_cvt_pk_bf16_f32 v97, v22, v23
v_mfma_f32_16x16x32_bf16 a[96:99], a[184:187], a[224:227], a[96:99]
v_accvgpr_read_b32 v24, a36
v_accvgpr_read_b32 v25, a37
v_accvgpr_read_b32 v26, a38
v_accvgpr_read_b32 v27, a39
v_mfma_f32_16x16x32_bf16 a[100:103], a[184:187], a[228:231], a[100:103]
v_cvt_pk_bf16_f32 v100, v24, v25
v_cvt_pk_bf16_f32 v101, v26, v27
v_accvgpr_read_b32 v20, a40
v_accvgpr_read_b32 v21, a41
v_mfma_f32_16x16x32_bf16 a[104:107], a[184:187], a[232:235], a[104:107]
v_accvgpr_read_b32 v22, a42
v_accvgpr_read_b32 v23, a43
v_cvt_pk_bf16_f32 v104, v20, v21
v_cvt_pk_bf16_f32 v105, v22, v23
v_mfma_f32_16x16x32_bf16 a[108:111], a[184:187], a[236:239], a[108:111]
s_add_u32 s48, s48, s34
v_accvgpr_read_b32 v24, a44
v_accvgpr_read_b32 v25, a45
v_accvgpr_read_b32 v26, a46
v_mfma_f32_16x16x32_bf16 a[112:115], a[184:187], a[240:243], a[112:115]
s_add_u32 m0, s32, 8192
v_accvgpr_read_b32 v27, a47
v_cvt_pk_bf16_f32 v108, v24, v25
v_cvt_pk_bf16_f32 v109, v26, v27
v_mfma_f32_16x16x32_bf16 a[116:119], a[184:187], a[244:247], a[116:119]
buffer_load_dwordx4 v1, s[12:15], s48 offen lds
v_accvgpr_read_b32 v20, a48
v_accvgpr_read_b32 v21, a49
v_accvgpr_read_b32 v22, a50
v_mfma_f32_16x16x32_bf16 a[120:123], a[184:187], a[248:251], a[120:123]
v_accvgpr_read_b32 v23, a51
v_cvt_pk_bf16_f32 v112, v20, v21
v_cvt_pk_bf16_f32 v113, v22, v23
v_accvgpr_read_b32 v24, a52
v_mfma_f32_16x16x32_bf16 a[124:127], a[184:187], a[252:255], a[124:127]
ds_read_b128 a[184:187], v3 offset:12288
v_accvgpr_read_b32 v25, a53
v_accvgpr_read_b32 v26, a54
v_accvgpr_read_b32 v27, a55
v_mfma_f32_16x16x32_bf16 a[128:131], v[28:31], a[224:227], a[128:131]
v_cvt_pk_bf16_f32 v116, v24, v25
v_cvt_pk_bf16_f32 v117, v26, v27
v_accvgpr_read_b32 v20, a56
v_accvgpr_read_b32 v21, a57
v_mfma_f32_16x16x32_bf16 a[132:135], v[28:31], a[228:231], a[132:135]
v_add_u32 v5, 16384, v5
v_and_b32 v5, 65535, v5
v_xor_b32 v6, 16, v5
v_accvgpr_read_b32 v22, a58
v_mfma_f32_16x16x32_bf16 a[136:139], v[28:31], a[232:235], a[136:139]
v_xor_b32 v7, 64, v5
v_xor_b32 v8, 80, v5
v_xor_b32 v9, 128, v5
v_accvgpr_read_b32 v23, a59
v_mfma_f32_16x16x32_bf16 a[140:143], v[28:31], a[236:239], a[140:143]
s_add_u32 s48, s48, s34
v_xor_b32 v10, 144, v5
v_xor_b32 v11, 192, v5
v_cvt_pk_bf16_f32 v120, v20, v21
v_mfma_f32_16x16x32_bf16 a[144:147], v[28:31], a[240:243], a[144:147]
s_add_u32 m0, s32, 12288
v_xor_b32 v12, 208, v5
v_cvt_pk_bf16_f32 v121, v22, v23
v_accvgpr_read_b32 v24, a60
v_mfma_f32_16x16x32_bf16 a[148:151], v[28:31], a[244:247], a[148:151]
buffer_load_dwordx4 v1, s[12:15], s48 offen lds
v_accvgpr_read_b32 v25, a61
v_accvgpr_read_b32 v26, a62
v_accvgpr_read_b32 v27, a63
v_mfma_f32_16x16x32_bf16 a[152:155], v[28:31], a[248:251], a[152:155]
v_cvt_pk_bf16_f32 v124, v24, v25
v_cvt_pk_bf16_f32 v125, v26, v27
v_mfma_f32_16x16x32_bf16 a[156:159], v[28:31], a[252:255], a[156:159]
s_cmp_lt_u32 s35, s45
s_cbranch_scc1 L_g_tile
s_branch L_g_end
L_g_first:
s_mov_b32 s100, 536870912
s_cmp_eq_u32 s61, 0
s_cbranch_scc0 L_g_end
v_mov_b32 v20, 128
s_mov_b32 s28, 0
L_poll_6:
buffer_load_dword v21, v20, s[56:59], 0 offen sc1
s_add_u32 s28, s28, 1
s_cmp_gt_u32 s28, 40000
s_cbranch_scc1 L_end
s_waitcnt vmcnt(0)
v_cmp_ne_u32 vcc, 8, v21
s_cbranch_vccz L_pd_7
s_sleep 1
s_branch L_poll_6
L_pd_7:
s_branch L_g_go
L_g_end:
v_bfe_u32 v16, v0, 3, 3
v_lshlrev_b32 v16, 4, v16
v_and_or_b32 v16, v0, 7, v16
v_bfe_u32 v17, v0, 4, 2
v_lshlrev_b32 v17, 5, v17
v_and_or_b32 v17, v0, 8, v17
v_bfe_u32 v18, v0, 1, 2
v_or_b32 v17, v17, v18
v_and_b32 v18, 1, v0
v_lshl_or_b32 v17, v18, 4, v17
s_bitcmp1_b32 s50, 1
s_cselect_b64 vcc, -1, 0
s_cselect_b32 s44, 64, 0x80
v_cndmask_b32 v16, v16, v17, vcc
v_lshlrev_b32 v13, 4, v16
s_movk_i32 s92, 0x800
s_bitcmp1_b32 s50, 0
s_cselect_b32 s92, 0x4000, s92
s_xor_b32 s93, s92, 0x4800
s_sub_u32 s93, s93, s44
v_pk_mul_f32 v[20:21], v[160:161], s[94:95] op_sel_hi:[1,0]
v_pk_mul_f32 v[22:23], v[162:163], s[94:95] op_sel_hi:[1,0]
v_cvt_pk_bf16_f32 v32, v20, v21
v_cvt_pk_bf16_f32 v33, v22, v23
v_pk_mul_f32 v[20:21], v[192:193], s[94:95] op_sel_hi:[1,0]
v_pk_mul_f32 v[22:23], v[194:195], s[94:95] op_sel_hi:[1,0]
v_cvt_pk_bf16_f32 v34, v20, v21
v_cvt_pk_bf16_f32 v35, v22, v23
s_mov_b32 s60, s62
s_mov_b32 s29, s62
buffer_store_dwordx4 v[32:35], v13, s[8:11], s29 offen sc1
v_pk_mul_f32 v[24:25], v[164:165], s[94:95] op_sel_hi:[1,0]
v_pk_mul_f32 v[26:27], v[166:167], s[94:95] op_sel_hi:[1,0]
v_cvt_pk_bf16_f32 v36, v24, v25
v_cvt_pk_bf16_f32 v37, v26, v27
v_pk_mul_f32 v[24:25], v[196:197], s[94:95] op_sel_hi:[1,0]
v_pk_mul_f32 v[26:27], v[198:199], s[94:95] op_sel_hi:[1,0]
v_cvt_pk_bf16_f32 v38, v24, v25
v_cvt_pk_bf16_f32 v39, v26, v27
s_add_u32 s29, s29, s44
buffer_store_dwordx4 v[36:39], v13, s[8:11], s29 offen sc1
v_pk_mul_f32 v[20:21], v[168:169], s[94:95] op_sel_hi:[1,0]
v_pk_mul_f32 v[22:23], v[170:171], s[94:95] op_sel_hi:[1,0]
v_cvt_pk_bf16_f32 v40, v20, v21
v_cvt_pk_bf16_f32 v41, v22, v23
v_pk_mul_f32 v[20:21], v[200:201], s[94:95] op_sel_hi:[1,0]
v_pk_mul_f32 v[22:23], v[202:203], s[94:95] op_sel_hi:[1,0]
v_cvt_pk_bf16_f32 v42, v20, v21
v_cvt_pk_bf16_f32 v43, v22, v23
s_add_u32 s29, s29, s93
buffer_store_dwordx4 v[40:43], v13, s[8:11], s29 offen sc1
v_pk_mul_f32 v[24:25], v[172:173], s[94:95] op_sel_hi:[1,0]
v_pk_mul_f32 v[26:27], v[174:175], s[94:95] op_sel_hi:[1,0]
v_cvt_pk_bf16_f32 v44, v24, v25
v_cvt_pk_bf16_f32 v45, v26, v27
v_pk_mul_f32 v[24:25], v[204:205], s[94:95] op_sel_hi:[1,0]
v_pk_mul_f32 v[26:27], v[206:207], s[94:95] op_sel_hi:[1,0]
v_cvt_pk_bf16_f32 v46, v24, v25
v_cvt_pk_bf16_f32 v47, v26, v27
s_add_u32 s29, s29, s44
buffer_store_dwordx4 v[44:47], v13, s[8:11], s29 offen sc1
v_pk_mul_f32 v[20:21], v[176:177], s[94:95] op_sel_hi:[1,0]
v_pk_mul_f32 v[22:23], v[178:179], s[94:95] op_sel_hi:[1,0]
v_cvt_pk_bf16_f32 v48, v20, v21
v_cvt_pk_bf16_f32 v49, v22, v23
v_pk_mul_f32 v[20:21], v[208:209], s[94:95] op_sel_hi:[1,0]
v_pk_mul_f32 v[22:23], v[210:211], s[94:95] op_sel_hi:[1,0]
v_cvt_pk_bf16_f32 v50, v20, v21
v_cvt_pk_bf16_f32 v51, v22, v23
s_add_u32 s29, s29, s93
buffer_store_dwordx4 v[48:51], v13, s[8:11], s29 offen sc1
v_pk_mul_f32 v[24:25], v[180:181], s[94:95] op_sel_hi:[1,0]
v_pk_mul_f32 v[26:27], v[182:183], s[94:95] op_sel_hi:[1,0]
v_cvt_pk_bf16_f32 v52, v24, v25
v_cvt_pk_bf16_f32 v53, v26, v27
v_pk_mul_f32 v[24:25], v[212:213], s[94:95] op_sel_hi:[1,0]
v_pk_mul_f32 v[26:27], v[214:215], s[94:95] op_sel_hi:[1,0]
v_cvt_pk_bf16_f32 v54, v24, v25
v_cvt_pk_bf16_f32 v55, v26, v27
s_add_u32 s29, s29, s44
buffer_store_dwordx4 v[52:55], v13, s[8:11], s29 offen sc1
v_pk_mul_f32 v[20:21], v[184:185], s[94:95] op_sel_hi:[1,0]
v_pk_mul_f32 v[22:23], v[186:187], s[94:95] op_sel_hi:[1,0]
v_cvt_pk_bf16_f32 v56, v20, v21
v_cvt_pk_bf16_f32 v57, v22, v23
v_pk_mul_f32 v[20:21], v[216:217], s[94:95] op_sel_hi:[1,0]
v_pk_mul_f32 v[22:23], v[218:219], s[94:95] op_sel_hi:[1,0]
v_cvt_pk_bf16_f32 v58, v20, v21
v_cvt_pk_bf16_f32 v59, v22, v23
s_add_u32 s29, s29, s93
buffer_store_dwordx4 v[56:59], v13, s[8:11], s29 offen sc1
v_pk_mul_f32 v[24:25], v[188:189], s[94:95] op_sel_hi:[1,0]
v_pk_mul_f32 v[26:27], v[190:191], s[94:95] op_sel_hi:[1,0]
v_cvt_pk_bf16_f32 v60, v24, v25
v_cvt_pk_bf16_f32 v61, v26, v27
v_pk_mul_f32 v[24:25], v[220:221], s[94:95] op_sel_hi:[1,0]
v_pk_mul_f32 v[26:27], v[222:223], s[94:95] op_sel_hi:[1,0]
v_cvt_pk_bf16_f32 v62, v24, v25
v_cvt_pk_bf16_f32 v63, v26, v27
s_add_u32 s29, s29, s44
buffer_store_dwordx4 v[60:63], v13, s[8:11], s29 offen sc1
v_pk_mul_f32 v[20:21], v[224:225], s[94:95] op_sel_hi:[1,0]
v_pk_mul_f32 v[22:23], v[226:227], s[94:95] op_sel_hi:[1,0]
v_cvt_pk_bf16_f32 v64, v20, v21
v_cvt_pk_bf16_f32 v65, v22, v23
v_accvgpr_read_b32 v20, a0
v_accvgpr_read_b32 v21, a1
v_accvgpr_read_b32 v22, a2
v_accvgpr_read_b32 v23, a3
v_pk_mul_f32 v[20:21], v[20:21], s[94:95] op_sel_hi:[1,0]
v_pk_mul_f32 v[22:23], v[22:23], s[94:95] op_sel_hi:[1,0]
v_cvt_pk_bf16_f32 v66, v20, v21
v_cvt_pk_bf16_f32 v67, v22, v23
s_add_u32 s60, s60, s92
s_mov_b32 s29, s60
buffer_store_dwordx4 v[64:67], v13, s[8:11], s29 offen sc1
v_pk_mul_f32 v[24:25], v[228:229], s[94:95] op_sel_hi:[1,0]
v_pk_mul_f32 v[26:27], v[230:231], s[94:95] op_sel_hi:[1,0]
v_cvt_pk_bf16_f32 v68, v24, v25
v_cvt_pk_bf16_f32 v69, v26, v27
v_accvgpr_read_b32 v24, a4
v_accvgpr_read_b32 v25, a5
v_accvgpr_read_b32 v26, a6
v_accvgpr_read_b32 v27, a7
v_pk_mul_f32 v[24:25], v[24:25], s[94:95] op_sel_hi:[1,0]
v_pk_mul_f32 v[26:27], v[26:27], s[94:95] op_sel_hi:[1,0]
v_cvt_pk_bf16_f32 v70, v24, v25
v_cvt_pk_bf16_f32 v71, v26, v27
s_add_u32 s29, s29, s44
buffer_store_dwordx4 v[68:71], v13, s[8:11], s29 offen sc1
v_pk_mul_f32 v[20:21], v[232:233], s[94:95] op_sel_hi:[1,0]
v_pk_mul_f32 v[22:23], v[234:235], s[94:95] op_sel_hi:[1,0]
v_cvt_pk_bf16_f32 v72, v20, v21
v_cvt_pk_bf16_f32 v73, v22, v23
v_accvgpr_read_b32 v20, a8
v_accvgpr_read_b32 v21, a9
v_accvgpr_read_b32 v22, a10
v_accvgpr_read_b32 v23, a11
v_pk_mul_f32 v[20:21], v[20:21], s[94:95] op_sel_hi:[1,0]
v_pk_mul_f32 v[22:23], v[22:23], s[94:95] op_sel_hi:[1,0]
v_cvt_pk_bf16_f32 v74, v20, v21
v_cvt_pk_bf16_f32 v75, v22, v23
s_add_u32 s29, s29, s93
buffer_store_dwordx4 v[72:75], v13, s[8:11], s29 offen sc1
v_pk_mul_f32 v[24:25], v[236:237], s[94:95] op_sel_hi:[1,0]
v_pk_mul_f32 v[26:27], v[238:239], s[94:95] op_sel_hi:[1,0]
v_cvt_pk_bf16_f32 v76, v24, v25
v_cvt_pk_bf16_f32 v77, v26, v27
v_accvgpr_read_b32 v24, a12
v_accvgpr_read_b32 v25, a13
v_accvgpr_read_b32 v26, a14
v_accvgpr_read_b32 v27, a15
v_pk_mul_f32 v[24:25], v[24:25], s[94:95] op_sel_hi:[1,0]
v_pk_mul_f32 v[26:27], v[26:27], s[94:95] op_sel_hi:[1,0]
v_cvt_pk_bf16_f32 v78, v24, v25
v_cvt_pk_bf16_f32 v79, v26, v27
s_add_u32 s29, s29, s44
buffer_store_dwordx4 v[76:79], v13, s[8:11], s29 offen sc1
v_pk_mul_f32 v[20:21], v[240:241], s[94:95] op_sel_hi:[1,0]
v_pk_mul_f32 v[22:23], v[242:243], s[94:95] op_sel_hi:[1,0]
v_cvt_pk_bf16_f32 v80, v20, v21
v_cvt_pk_bf16_f32 v81, v22, v23
v_accvgpr_read_b32 v20, a16
v_accvgpr_read_b32 v21, a17
v_accvgpr_read_b32 v22, a18
v_accvgpr_read_b32 v23, a19
v_pk_mul_f32 v[20:21], v[20:21], s[94:95] op_sel_hi:[1,0]
v_pk_mul_f32 v[22:23], v[22:23], s[94:95] op_sel_hi:[1,0]
v_cvt_pk_bf16_f32 v82, v20, v21
v_cvt_pk_bf16_f32 v83, v22, v23
s_add_u32 s29, s29, s93
buffer_store_dwordx4 v[80:83], v13, s[8:11], s29 offen sc1
v_pk_mul_f32 v[24:25], v[244:245], s[94:95] op_sel_hi:[1,0]
v_pk_mul_f32 v[26:27], v[246:247], s[94:95] op_sel_hi:[1,0]
v_cvt_pk_bf16_f32 v84, v24, v25
v_cvt_pk_bf16_f32 v85, v26, v27
v_accvgpr_read_b32 v24, a20
v_accvgpr_read_b32 v25, a21
v_accvgpr_read_b32 v26, a22
v_accvgpr_read_b32 v27, a23
v_pk_mul_f32 v[24:25], v[24:25], s[94:95] op_sel_hi:[1,0]
v_pk_mul_f32 v[26:27], v[26:27], s[94:95] op_sel_hi:[1,0]
v_cvt_pk_bf16_f32 v86, v24, v25
v_cvt_pk_bf16_f32 v87, v26, v27
s_add_u32 s29, s29, s44
buffer_store_dwordx4 v[84:87], v13, s[8:11], s29 offen sc1
v_pk_mul_f32 v[20:21], v[248:249], s[94:95] op_sel_hi:[1,0]
v_pk_mul_f32 v[22:23], v[250:251], s[94:95] op_sel_hi:[1,0]
v_cvt_pk_bf16_f32 v88, v20, v21
v_cvt_pk_bf16_f32 v89, v22, v23
v_accvgpr_read_b32 v20, a24
v_accvgpr_read_b32 v21, a25
v_accvgpr_read_b32 v22, a26
v_accvgpr_read_b32 v23, a27
v_pk_mul_f32 v[20:21], v[20:21], s[94:95] op_sel_hi:[1,0]
v_pk_mul_f32 v[22:23], v[22:23], s[94:95] op_sel_hi:[1,0]
v_cvt_pk_bf16_f32 v90, v20, v21
v_cvt_pk_bf16_f32 v91, v22, v23
s_add_u32 s29, s29, s93
buffer_store_dwordx4 v[88:91], v13, s[8:11], s29 offen sc1
v_pk_mul_f32 v[24:25], v[252:253], s[94:95] op_sel_hi:[1,0]
v_pk_mul_f32 v[26:27], v[254:255], s[94:95] op_sel_hi:[1,0]
v_cvt_pk_bf16_f32 v92, v24, v25
v_cvt_pk_bf16_f32 v93, v26, v27
v_accvgpr_read_b32 v24, a28
v_accvgpr_read_b32 v25, a29
v_accvgpr_read_b32 v26, a30
v_accvgpr_read_b32 v27, a31
v_pk_mul_f32 v[24:25], v[24:25], s[94:95] op_sel_hi:[1,0]
v_pk_mul_f32 v[26:27], v[26:27], s[94:95] op_sel_hi:[1,0]
v_cvt_pk_bf16_f32 v94, v24, v25
v_cvt_pk_bf16_f32 v95, v26, v27
s_add_u32 s29, s29, s44
buffer_store_dwordx4 v[92:95], v13, s[8:11], s29 offen sc1
v_accvgpr_read_b32 v20, a32
v_accvgpr_read_b32 v21, a33
v_accvgpr_read_b32 v22, a34
v_accvgpr_read_b32 v23, a35
v_pk_mul_f32 v[20:21], v[20:21], s[94:95] op_sel_hi:[1,0]
v_pk_mul_f32 v[22:23], v[22:23], s[94:95] op_sel_hi:[1,0]
v_cvt_pk_bf16_f32 v96, v20, v21
v_cvt_pk_bf16_f32 v97, v22, v23
v_accvgpr_read_b32 v20, a64
v_accvgpr_read_b32 v21, a65
v_accvgpr_read_b32 v22, a66
v_accvgpr_read_b32 v23, a67
v_pk_mul_f32 v[20:21], v[20:21], s[94:95] op_sel_hi:[1,0]
v_pk_mul_f32 v[22:23], v[22:23], s[94:95] op_sel_hi:[1,0]
v_cvt_pk_bf16_f32 v98, v20, v21
v_cvt_pk_bf16_f32 v99, v22, v23
s_add_u32 s60, s60, s92
s_mov_b32 s29, s60
buffer_store_dwordx4 v[96:99], v13, s[8:11], s29 offen sc1
v_accvgpr_read_b32 v24, a36
v_accvgpr_read_b32 v25, a37
v_accvgpr_read_b32 v26, a38
v_accvgpr_read_b32 v27, a39
v_pk_mul_f32 v[24:25], v[24:25], s[94:95] op_sel_hi:[1,0]
v_pk_mul_f32 v[26:27], v[26:27], s[94:95] op_sel_hi:[1,0]
v_cvt_pk_bf16_f32 v100, v24, v25
v_cvt_pk_bf16_f32 v101, v26, v27
v_accvgpr_read_b32 v24, a68
v_accvgpr_read_b32 v25, a69
v_accvgpr_read_b32 v26, a70
v_accvgpr_read_b32 v27, a71
v_pk_mul_f32 v[24:25], v[24:25], s[94:95] op_sel_hi:[1,0]
v_pk_mul_f32 v[26:27], v[26:27], s[94:95] op_sel_hi:[1,0]
v_cvt_pk_bf16_f32 v102, v24, v25
v_cvt_pk_bf16_f32 v103, v26, v27
s_add_u32 s29, s29, s44
buffer_store_dwordx4 v[100:103], v13, s[8:11], s29 offen sc1
v_accvgpr_read_b32 v20, a40
v_accvgpr_read_b32 v21, a41
v_accvgpr_read_b32 v22, a42
v_accvgpr_read_b32 v23, a43
v_pk_mul_f32 v[20:21], v[20:21], s[94:95] op_sel_hi:[1,0]
v_pk_mul_f32 v[22:23], v[22:23], s[94:95] op_sel_hi:[1,0]
v_cvt_pk_bf16_f32 v104, v20, v21
v_cvt_pk_bf16_f32 v105, v22, v23
v_accvgpr_read_b32 v20, a72
v_accvgpr_read_b32 v21, a73
v_accvgpr_read_b32 v22, a74
v_accvgpr_read_b32 v23, a75
v_pk_mul_f32 v[20:21], v[20:21], s[94:95] op_sel_hi:[1,0]
v_pk_mul_f32 v[22:23], v[22:23], s[94:95] op_sel_hi:[1,0]
v_cvt_pk_bf16_f32 v106, v20, v21
v_cvt_pk_bf16_f32 v107, v22, v23
s_add_u32 s29, s29, s93
buffer_store_dwordx4 v[104:107], v13, s[8:11], s29 offen sc1
v_accvgpr_read_b32 v24, a44
v_accvgpr_read_b32 v25, a45
v_accvgpr_read_b32 v26, a46
v_accvgpr_read_b32 v27, a47
v_pk_mul_f32 v[24:25], v[24:25], s[94:95] op_sel_hi:[1,0]
v_pk_mul_f32 v[26:27], v[26:27], s[94:95] op_sel_hi:[1,0]
v_cvt_pk_bf16_f32 v108, v24, v25
v_cvt_pk_bf16_f32 v109, v26, v27
v_accvgpr_read_b32 v24, a76
v_accvgpr_read_b32 v25, a77
v_accvgpr_read_b32 v26, a78
v_accvgpr_read_b32 v27, a79
v_pk_mul_f32 v[24:25], v[24:25], s[94:95] op_sel_hi:[1,0]
v_pk_mul_f32 v[26:27], v[26:27], s[94:95] op_sel_hi:[1,0]
v_cvt_pk_bf16_f32 v110, v24, v25
v_cvt_pk_bf16_f32 v111, v26, v27
s_add_u32 s29, s29, s44
buffer_store_dwordx4 v[108:111], v13, s[8:11], s29 offen sc1
v_accvgpr_read_b32 v20, a48
v_accvgpr_read_b32 v21, a49
v_accvgpr_read_b32 v22, a50
v_accvgpr_read_b32 v23, a51
v_pk_mul_f32 v[20:21], v[20:21], s[94:95] op_sel_hi:[1,0]
v_pk_mul_f32 v[22:23], v[22:23], s[94:95] op_sel_hi:[1,0]
v_cvt_pk_bf16_f32 v112, v20, v21
v_cvt_pk_bf16_f32 v113, v22, v23
v_accvgpr_read_b32 v20, a80
v_accvgpr_read_b32 v21, a81
v_accvgpr_read_b32 v22, a82
v_accvgpr_read_b32 v23, a83
v_pk_mul_f32 v[20:21], v[20:21], s[94:95] op_sel_hi:[1,0]
v_pk_mul_f32 v[22:23], v[22:23], s[94:95] op_sel_hi:[1,0]
v_cvt_pk_bf16_f32 v114, v20, v21
v_cvt_pk_bf16_f32 v115, v22, v23
s_add_u32 s29, s29, s93
buffer_store_dwordx4 v[112:115], v13, s[8:11], s29 offen sc1
v_accvgpr_read_b32 v24, a52
v_accvgpr_read_b32 v25, a53
v_accvgpr_read_b32 v26, a54
v_accvgpr_read_b32 v27, a55
v_pk_mul_f32 v[24:25], v[24:25], s[94:95] op_sel_hi:[1,0]
v_pk_mul_f32 v[26:27], v[26:27], s[94:95] op_sel_hi:[1,0]
v_cvt_pk_bf16_f32 v116, v24, v25
v_cvt_pk_bf16_f32 v117, v26, v27
v_accvgpr_read_b32 v24, a84
v_accvgpr_read_b32 v25, a85
v_accvgpr_read_b32 v26, a86
v_accvgpr_read_b32 v27, a87
v_pk_mul_f32 v[24:25], v[24:25], s[94:95] op_sel_hi:[1,0]
v_pk_mul_f32 v[26:27], v[26:27], s[94:95] op_sel_hi:[1,0]
v_cvt_pk_bf16_f32 v118, v24, v25
v_cvt_pk_bf16_f32 v119, v26, v27
s_add_u32 s29, s29, s44
buffer_store_dwordx4 v[116:119], v13, s[8:11], s29 offen sc1
v_accvgpr_read_b32 v20, a56
v_accvgpr_read_b32 v21, a57
v_accvgpr_read_b32 v22, a58
v_accvgpr_read_b32 v23, a59
v_pk_mul_f32 v[20:21], v[20:21], s[94:95] op_sel_hi:[1,0]
v_pk_mul_f32 v[22:23], v[22:23], s[94:95] op_sel_hi:[1,0]
v_cvt_pk_bf16_f32 v120, v20, v21
v_cvt_pk_bf16_f32 v121, v22, v23
v_accvgpr_read_b32 v20, a88
v_accvgpr_read_b32 v21, a89
v_accvgpr_read_b32 v22, a90
v_accvgpr_read_b32 v23, a91
v_pk_mul_f32 v[20:21], v[20:21], s[94:95] op_sel_hi:[1,0]
v_pk_mul_f32 v[22:23], v[22:23], s[94:95] op_sel_hi:[1,0]
v_cvt_pk_bf16_f32 v122, v20, v21
v_cvt_pk_bf16_f32 v123, v22, v23
s_add_u32 s29, s29, s93
buffer_store_dwordx4 v[120:123], v13, s[8:11], s29 offen sc1
v_accvgpr_read_b32 v24, a60
v_accvgpr_read_b32 v25, a61
v_accvgpr_read_b32 v26, a62
v_accvgpr_read_b32 v27, a63
v_pk_mul_f32 v[24:25], v[24:25], s[94:95] op_sel_hi:[1,0]
v_pk_mul_f32 v[26:27], v[26:27], s[94:95] op_sel_hi:[1,0]
v_cvt_pk_bf16_f32 v124, v24, v25
v_cvt_pk_bf16_f32 v125, v26, v27
v_accvgpr_read_b32 v24, a92
v_accvgpr_read_b32 v25, a93
v_accvgpr_read_b32 v26, a94
v_accvgpr_read_b32 v27, a95
v_pk_mul_f32 v[24:25], v[24:25], s[94:95] op_sel_hi:[1,0]
v_pk_mul_f32 v[26:27], v[26:27], s[94:95] op_sel_hi:[1,0]
v_cvt_pk_bf16_f32 v126, v24, v25
v_cvt_pk_bf16_f32 v127, v26, v27
s_add_u32 s29, s29, s44
buffer_store_dwordx4 v[124:127], v13, s[8:11], s29 offen sc1
v_accvgpr_read_b32 v20, a96
v_accvgpr_read_b32 v21, a97
v_accvgpr_read_b32 v22, a98
v_accvgpr_read_b32 v23, a99
v_pk_mul_f32 v[20:21], v[20:21], s[94:95] op_sel_hi:[1,0]
v_pk_mul_f32 v[22:23], v[22:23], s[94:95] op_sel_hi:[1,0]
v_cvt_pk_bf16_f32 v128, v20, v21
v_cvt_pk_bf16_f32 v129, v22, v23
v_accvgpr_read_b32 v20, a128
v_accvgpr_read_b32 v21, a129
v_accvgpr_read_b32 v22, a130
v_accvgpr_read_b32 v23, a131
v_pk_mul_f32 v[20:21], v[20:21], s[94:95] op_sel_hi:[1,0]
v_pk_mul_f32 v[22:23], v[22:23], s[94:95] op_sel_hi:[1,0]
v_cvt_pk_bf16_f32 v130, v20, v21
v_cvt_pk_bf16_f32 v131, v22, v23
s_add_u32 s60, s60, s92
s_mov_b32 s29, s60
buffer_store_dwordx4 v[128:131], v13, s[8:11], s29 offen sc1
v_accvgpr_read_b32 v24, a100
v_accvgpr_read_b32 v25, a101
v_accvgpr_read_b32 v26, a102
v_accvgpr_read_b32 v27, a103
v_pk_mul_f32 v[24:25], v[24:25], s[94:95] op_sel_hi:[1,0]
v_pk_mul_f32 v[26:27], v[26:27], s[94:95] op_sel_hi:[1,0]
v_cvt_pk_bf16_f32 v132, v24, v25
v_cvt_pk_bf16_f32 v133, v26, v27
v_accvgpr_read_b32 v24, a132
v_accvgpr_read_b32 v25, a133
v_accvgpr_read_b32 v26, a134
v_accvgpr_read_b32 v27, a135
v_pk_mul_f32 v[24:25], v[24:25], s[94:95] op_sel_hi:[1,0]
v_pk_mul_f32 v[26:27], v[26:27], s[94:95] op_sel_hi:[1,0]
v_cvt_pk_bf16_f32 v134, v24, v25
v_cvt_pk_bf16_f32 v135, v26, v27
s_add_u32 s29, s29, s44
buffer_store_dwordx4 v[132:135], v13, s[8:11], s29 offen sc1
v_accvgpr_read_b32 v20, a104
v_accvgpr_read_b32 v21, a105
v_accvgpr_read_b32 v22, a106
v_accvgpr_read_b32 v23, a107
v_pk_mul_f32 v[20:21], v[20:21], s[94:95] op_sel_hi:[1,0]
v_pk_mul_f32 v[22:23], v[22:23], s[94:95] op_sel_hi:[1,0]
v_cvt_pk_bf16_f32 v136, v20, v21
v_cvt_pk_bf16_f32 v137, v22, v23
v_accvgpr_read_b32 v20, a136
v_accvgpr_read_b32 v21, a137
v_accvgpr_read_b32 v22, a138
v_accvgpr_read_b32 v23, a139
v_pk_mul_f32 v[20:21], v[20:21], s[94:95] op_sel_hi:[1,0]
v_pk_mul_f32 v[22:23], v[22:23], s[94:95] op_sel_hi:[1,0]
v_cvt_pk_bf16_f32 v138, v20, v21
v_cvt_pk_bf16_f32 v139, v22, v23
s_add_u32 s29, s29, s93
buffer_store_dwordx4 v[136:139], v13, s[8:11], s29 offen sc1
v_accvgpr_read_b32 v24, a108
v_accvgpr_read_b32 v25, a109
v_accvgpr_read_b32 v26, a110
v_accvgpr_read_b32 v27, a111
v_pk_mul_f32 v[24:25], v[24:25], s[94:95] op_sel_hi:[1,0]
v_pk_mul_f32 v[26:27], v[26:27], s[94:95] op_sel_hi:[1,0]
v_cvt_pk_bf16_f32 v140, v24, v25
v_cvt_pk_bf16_f32 v141, v26, v27
v_accvgpr_read_b32 v24, a140
v_accvgpr_read_b32 v25, a141
v_accvgpr_read_b32 v26, a142
v_accvgpr_read_b32 v27, a143
v_pk_mul_f32 v[24:25], v[24:25], s[94:95] op_sel_hi:[1,0]
v_pk_mul_f32 v[26:27], v[26:27], s[94:95] op_sel_hi:[1,0]
v_cvt_pk_bf16_f32 v142, v24, v25
v_cvt_pk_bf16_f32 v143, v26, v27
s_add_u32 s29, s29, s44
buffer_store_dwordx4 v[140:143], v13, s[8:11], s29 offen sc1
v_accvgpr_read_b32 v20, a112
v_accvgpr_read_b32 v21, a113
v_accvgpr_read_b32 v22, a114
v_accvgpr_read_b32 v23, a115
v_pk_mul_f32 v[20:21], v[20:21], s[94:95] op_sel_hi:[1,0]
v_pk_mul_f32 v[22:23], v[22:23], s[94:95] op_sel_hi:[1,0]
v_cvt_pk_bf16_f32 v144, v20, v21
v_cvt_pk_bf16_f32 v145, v22, v23
v_accvgpr_read_b32 v20, a144
v_accvgpr_read_b32 v21, a145
v_accvgpr_read_b32 v22, a146
v_accvgpr_read_b32 v23, a147
v_pk_mul_f32 v[20:21], v[20:21], s[94:95] op_sel_hi:[1,0]
v_pk_mul_f32 v[22:23], v[22:23], s[94:95] op_sel_hi:[1,0]
v_cvt_pk_bf16_f32 v146, v20, v21
v_cvt_pk_bf16_f32 v147, v22, v23
s_add_u32 s29, s29, s93
buffer_store_dwordx4 v[144:147], v13, s[8:11], s29 offen sc1
v_accvgpr_read_b32 v24, a116
v_accvgpr_read_b32 v25, a117
v_accvgpr_read_b32 v26, a118
v_accvgpr_read_b32 v27, a119
v_pk_mul_f32 v[24:25], v[24:25], s[94:95] op_sel_hi:[1,0]
v_pk_mul_f32 v[26:27], v[26:27], s[94:95] op_sel_hi:[1,0]
v_cvt_pk_bf16_f32 v148, v24, v25
v_cvt_pk_bf16_f32 v149, v26, v27
v_accvgpr_read_b32 v24, a148
v_accvgpr_read_b32 v25, a149
v_accvgpr_read_b32 v26, a150
v_accvgpr_read_b32 v27, a151
v_pk_mul_f32 v[24:25], v[24:25], s[94:95] op_sel_hi:[1,0]
v_pk_mul_f32 v[26:27], v[26:27], s[94:95] op_sel_hi:[1,0]
v_cvt_pk_bf16_f32 v150, v24, v25
v_cvt_pk_bf16_f32 v151, v26, v27
s_add_u32 s29, s29, s44
buffer_store_dwordx4 v[148:151], v13, s[8:11], s29 offen sc1
v_accvgpr_read_b32 v20, a120
v_accvgpr_read_b32 v21, a121
v_accvgpr_read_b32 v22, a122
v_accvgpr_read_b32 v23, a123
v_pk_mul_f32 v[20:21], v[20:21], s[94:95] op_sel_hi:[1,0]
v_pk_mul_f32 v[22:23], v[22:23], s[94:95] op_sel_hi:[1,0]
v_cvt_pk_bf16_f32 v152, v20, v21
v_cvt_pk_bf16_f32 v153, v22, v23
v_accvgpr_read_b32 v20, a152
v_accvgpr_read_b32 v21, a153
v_accvgpr_read_b32 v22, a154
v_accvgpr_read_b32 v23, a155
v_pk_mul_f32 v[20:21], v[20:21], s[94:95] op_sel_hi:[1,0]
v_pk_mul_f32 v[22:23], v[22:23], s[94:95] op_sel_hi:[1,0]
v_cvt_pk_bf16_f32 v154, v20, v21
v_cvt_pk_bf16_f32 v155, v22, v23
s_add_u32 s29, s29, s93
buffer_store_dwordx4 v[152:155], v13, s[8:11], s29 offen sc1
v_accvgpr_read_b32 v24, a124
v_accvgpr_read_b32 v25, a125
v_accvgpr_read_b32 v26, a126
v_accvgpr_read_b32 v27, a127
v_pk_mul_f32 v[24:25], v[24:25], s[94:95] op_sel_hi:[1,0]
v_pk_mul_f32 v[26:27], v[26:27], s[94:95] op_sel_hi:[1,0]
v_cvt_pk_bf16_f32 v156, v24, v25
v_cvt_pk_bf16_f32 v157, v26, v27
v_accvgpr_read_b32 v24, a156
v_accvgpr_read_b32 v25, a157
v_accvgpr_read_b32 v26, a158
v_accvgpr_read_b32 v27, a159
v_pk_mul_f32 v[24:25], v[24:25], s[94:95] op_sel_hi:[1,0]
v_pk_mul_f32 v[26:27], v[26:27], s[94:95] op_sel_hi:[1,0]
v_cvt_pk_bf16_f32 v158, v24, v25
v_cvt_pk_bf16_f32 v159, v26, v27
s_add_u32 s29, s29, s44
buffer_store_dwordx4 v[156:159], v13, s[8:11], s29 offen sc1
v_mov_b32 v20, 128
s_mov_b32 s28, 0
L_poll_8:
buffer_load_dword v21, v20, s[56:59], 0 offen sc1
s_add_u32 s28, s28, 1
s_cmp_gt_u32 s28, 40000
s_cbranch_scc1 L_end
s_waitcnt vmcnt(0)
v_cmp_ne_u32 vcc, 8, v21
s_cbranch_vccz L_pd_9
s_sleep 1
s_branch L_poll_8
L_pd_9:
s_waitcnt vmcnt(0) lgkmcnt(0)
s_barrier
v_mov_b32 v16, 0
v_mov_b32 v17, 1
s_cmp_eq_u32 s17, 0
s_cselect_b32 s29, s63, 536870912
s_mov_b64 exec, 1
buffer_store_dword v17, v16, s[8:11], s29 offen sc1
s_mov_b64 exec, -1
s_mov_b32 s62, 536870912
s_mov_b32 s63, 536870912
s_cmp_lt_u32 s35, s45
s_cbranch_scc1 L_g_go
s_cmp_eq_u32 s3, 1
s_cbranch_scc1 L_part
s_cmp_eq_u32 s61, 1
s_cbranch_scc1 L_bdie
s_sub_u32 s24, s3, 4
s_lshl_b32 s24, s24, 3
s_lshr_b32 s42, s16, 2
s_add_u32 s42, s42, s24
s_and_b32 s62, s16, 3
s_mov_b32 s40, 0x3e0293ee
s_mov_b32 s50, 0xf149f2ca
s_mov_b32 s51, 0x41a00000
v_and_b32 v20, 7, v0
v_lshlrev_b32 v20, 2, v20
v_bfe_u32 v21, v0, 3, 1
s_lshl_b32 s25, s42, 7
s_add_u32 s25, s25, 111165440
s_lshr_b32 s24, s42, 1
s_lshl_b32 s24, s24, 7
s_add_u32 s24, s24, 111173632
s_sub_u32 s24, s24, s25
v_mad_u32_u24 v20, v21, s24, v20
s_mov_b32 s28, 0
L_poll_10:
buffer_load_dword v21, v20, s[8:11], s25 offen sc1
s_add_u32 s28, s28, 1
s_cmp_gt_u32 s28, 40000
s_cbranch_scc1 L_end
s_waitcnt vmcnt(0)
v_cmp_ne_u32 vcc, 1, v21
s_cbranch_vccz L_pd_11
s_sleep 1
s_branch L_poll_10
L_pd_11:
s_sub_u32 s41, 7, s62
s_mov_b32 s60, 0
L_aat:
v_and_b32 v5, 31, v0
v_bfe_u32 v26, v0, 5, 1
v_lshlrev_b32 v27, 2, v26
v_sub_u32 v5, v5, v27
v_bfe_u32 v27, v0, 4, 1
v_lshlrev_b32 v6, 17, v27
v_lshl_add_u32 v6, v26, 8, v6
v_and_b32 v27, 15, v0
v_lshl_add_u32 v6, v27, 4, v6
v_and_b32 v2, 63, v0
v_lshlrev_b32 v2, 4, v2
s_lshl_b32 s24, s17, 13
v_add_u32 v1, s24, v2
v_add_u32 v3, 32768, v2
v_mov_b32 v4, v2
s_lshl_b32 s46, s42, 20
s_add_u32 s46, s46, 0
s_mov_b32 s47, s24
s_lshl_b32 s44, s41, 2
s_add_u32 s45, s44, 4
s_add_u32 s44, s44, s17
s_mov_b32 s43, 0
s_mov_b32 s48, 0
s_mov_b32 s54, s50
s_mov_b32 s55, s50
s_barrier
s_lshr_b32 s26, s42, 1
s_lshl_b32 s26, s26, 6
s_lshl_b32 s27, s44, 1
s_add_u32 s26, s26, s27
s_lshl_b32 s26, s26, 1
s_and_b32 s27, s42, 1
s_add_u32 s26, s26, s27
s_lshl_b32 s26, s26, 13
s_add_u32 s26, s26, 117440512
s_add_u32 s27, s26, 0
buffer_load_dwordx4 a[0:3], v2, s[8:11], s27 offen offset:0 sc1
buffer_load_dwordx4 a[4:7], v2, s[8:11], s27 offen offset:1024 sc1
buffer_load_dwordx4 a[8:11], v2, s[8:11], s27 offen offset:2048 sc1
buffer_load_dwordx4 a[12:15], v2, s[8:11], s27 offen offset:3072 sc1
s_add_u32 s27, s26, 4096
buffer_load_dwordx4 a[16:19], v2, s[8:11], s27 offen offset:0 sc1
buffer_load_dwordx4 a[20:23], v2, s[8:11], s27 offen offset:1024 sc1
buffer_load_dwordx4 a[24:27], v2, s[8:11], s27 offen offset:2048 sc1
buffer_load_dwordx4 a[28:31], v2, s[8:11], s27 offen offset:3072 sc1
s_add_u32 s27, s26, 16384
buffer_load_dwordx4 a[32:35], v2, s[8:11], s27 offen offset:0 sc1
buffer_load_dwordx4 a[36:39], v2, s[8:11], s27 offen offset:1024 sc1
buffer_load_dwordx4 a[40:43], v2, s[8:11], s27 offen offset:2048 sc1
buffer_load_dwordx4 a[44:47], v2, s[8:11], s27 offen offset:3072 sc1
s_add_u32 s27, s26, 20480
buffer_load_dwordx4 a[48:51], v2, s[8:11], s27 offen offset:0 sc1
buffer_load_dwordx4 a[52:55], v2, s[8:11], s27 offen offset:1024 sc1
buffer_load_dwordx4 a[56:59], v2, s[8:11], s27 offen offset:2048 sc1
buffer_load_dwordx4 a[60:63], v2, s[8:11], s27 offen offset:3072 sc1
s_mov_b32 m0, s47
s_add_u32 s24, s46, 4096
buffer_load_dwordx4 v1, s[8:11], s46 offen offset:0 sc1 lds
buffer_load_dwordx4 v1, s[8:11], s46 offen offset:1024 sc1 lds
buffer_load_dwordx4 v1, s[8:11], s46 offen offset:2048 sc1 lds
buffer_load_dwordx4 v1, s[8:11], s46 offen offset:3072 sc1 lds
s_add_u32 m0, s47, 4096
s_nop 0
buffer_load_dwordx4 v1, s[8:11], s24 offen offset:0 sc1 lds
buffer_load_dwordx4 v1, s[8:11], s24 offen offset:1024 sc1 lds
buffer_load_dwordx4 v1, s[8:11], s24 offen offset:2048 sc1 lds
buffer_load_dwordx4 v1, s[8:11], s24 offen offset:3072 sc1 lds
s_add_u32 s46, s46, 32768
s_add_u32 s47, s47, 32768
s_and_b32 s47, s47, 131071
s_mov_b32 m0, s47
s_add_u32 s24, s46, 4096
buffer_load_dwordx4 v1, s[8:11], s46 offen offset:0 sc1 lds
buffer_load_dwordx4 v1, s[8:11], s46 offen offset:1024 sc1 lds
buffer_load_dwordx4 v1, s[8:11], s46 offen offset:2048 sc1 lds
buffer_load_dwordx4 v1, s[8:11], s46 offen offset:3072 sc1 lds
s_add_u32 m0, s47, 4096
s_nop 0
buffer_load_dwordx4 v1, s[8:11], s24 offen offset:0 sc1 lds
buffer_load_dwordx4 v1, s[8:11], s24 offen offset:1024 sc1 lds
buffer_load_dwordx4 v1, s[8:11], s24 offen offset:2048 sc1 lds
buffer_load_dwordx4 v1, s[8:11], s24 offen offset:3072 sc1 lds
s_add_u32 s46, s46, 32768
s_add_u32 s47, s47, 32768
s_and_b32 s47, s47, 131071
s_mov_b32 m0, s47
s_add_u32 s24, s46, 4096
buffer_load_dwordx4 v1, s[8:11], s46 offen offset:0 sc1 lds
buffer_load_dwordx4 v1, s[8:11], s46 offen offset:1024 sc1 lds
buffer_load_dwordx4 v1, s[8:11], s46 offen offset:2048 sc1 lds
buffer_load_dwordx4 v1, s[8:11], s46 offen offset:3072 sc1 lds
s_add_u32 m0, s47, 4096
s_nop 0
buffer_load_dwordx4 v1, s[8:11], s24 offen offset:0 sc1 lds
buffer_load_dwordx4 v1, s[8:11], s24 offen offset:1024 sc1 lds
buffer_load_dwordx4 v1, s[8:11], s24 offen offset:2048 sc1 lds
buffer_load_dwordx4 v1, s[8:11], s24 offen offset:3072 sc1 lds
s_add_u32 s46, s46, 32768
s_add_u32 s47, s47, 32768
s_and_b32 s47, s47, 131071
v_accvgpr_write_b32 a96, 0
v_accvgpr_write_b32 a97, 0
v_accvgpr_write_b32 a98, 0
v_accvgpr_write_b32 a99, 0
v_accvgpr_write_b32 a100, 0
v_accvgpr_write_b32 a101, 0
v_accvgpr_write_b32 a102, 0
v_accvgpr_write_b32 a103, 0
v_accvgpr_write_b32 a104, 0
v_accvgpr_write_b32 a105, 0
v_accvgpr_write_b32 a106, 0
v_accvgpr_write_b32 a107, 0
v_accvgpr_write_b32 a108, 0
v_accvgpr_write_b32 a109, 0
v_accvgpr_write_b32 a110, 0
v_accvgpr_write_b32 a111, 0
v_accvgpr_write_b32 a112, 0
v_accvgpr_write_b32 a113, 0
v_accvgpr_write_b32 a114, 0
v_accvgpr_write_b32 a115, 0
v_accvgpr_write_b32 a116, 0
v_accvgpr_write_b32 a117, 0
v_accvgpr_write_b32 a118, 0
v_accvgpr_write_b32 a119, 0
v_accvgpr_write_b32 a120, 0
v_accvgpr_write_b32 a121, 0
v_accvgpr_write_b32 a122, 0
v_accvgpr_write_b32 a123, 0
v_accvgpr_write_b32 a124, 0
v_accvgpr_write_b32 a125, 0
v_accvgpr_write_b32 a126, 0
v_accvgpr_write_b32 a127, 0
v_accvgpr_write_b32 a128, 0
v_accvgpr_write_b32 a129, 0
v_accvgpr_write_b32 a130, 0
v_accvgpr_write_b32 a131, 0
v_accvgpr_write_b32 a132, 0
v_accvgpr_write_b32 a133, 0
v_accvgpr_write_b32 a134, 0
v_accvgpr_write_b32 a135, 0
v_accvgpr_write_b32 a136, 0
v_accvgpr_write_b32 a137, 0
v_accvgpr_write_b32 a138, 0
v_accvgpr_write_b32 a139, 0
v_accvgpr_write_b32 a140, 0
v_accvgpr_write_b32 a141, 0
v_accvgpr_write_b32 a142, 0
v_accvgpr_write_b32 a143, 0
v_accvgpr_write_b32 a144, 0
v_accvgpr_write_b32 a145, 0
v_accvgpr_write_b32 a146, 0
v_accvgpr_write_b32 a147, 0
v_accvgpr_write_b32 a148, 0
v_accvgpr_write_b32 a149, 0
v_accvgpr_write_b32 a150, 0
v_accvgpr_write_b32 a151, 0
v_accvgpr_write_b32 a152, 0
v_accvgpr_write_b32 a153, 0
v_accvgpr_write_b32 a154, 0
v_accvgpr_write_b32 a155, 0
v_accvgpr_write_b32 a156, 0
v_accvgpr_write_b32 a157, 0
v_accvgpr_write_b32 a158, 0
v_accvgpr_write_b32 a159, 0
v_accvgpr_write_b32 a160, 0
v_accvgpr_write_b32 a161, 0
v_accvgpr_write_b32 a162, 0
v_accvgpr_write_b32 a163, 0
v_accvgpr_write_b32 a164, 0
v_accvgpr_write_b32 a165, 0
v_accvgpr_write_b32 a166, 0
v_accvgpr_write_b32 a167, 0
v_accvgpr_write_b32 a168, 0
v_accvgpr_write_b32 a169, 0
v_accvgpr_write_b32 a170, 0
v_accvgpr_write_b32 a171, 0
v_accvgpr_write_b32 a172, 0
v_accvgpr_write_b32 a173, 0
v_accvgpr_write_b32 a174, 0
v_accvgpr_write_b32 a175, 0
v_accvgpr_write_b32 a176, 0
v_accvgpr_write_b32 a177, 0
v_accvgpr_write_b32 a178, 0
v_accvgpr_write_b32 a179, 0
v_accvgpr_write_b32 a180, 0
v_accvgpr_write_b32 a181, 0
v_accvgpr_write_b32 a182, 0
v_accvgpr_write_b32 a183, 0
v_accvgpr_write_b32 a184, 0
v_accvgpr_write_b32 a185, 0
v_accvgpr_write_b32 a186, 0
v_accvgpr_write_b32 a187, 0
v_accvgpr_write_b32 a188, 0
v_accvgpr_write_b32 a189, 0
v_accvgpr_write_b32 a190, 0
v_accvgpr_write_b32 a191, 0
v_accvgpr_write_b32 a192, 0
v_accvgpr_write_b32 a193, 0
v_accvgpr_write_b32 a194, 0
v_accvgpr_write_b32 a195, 0
v_accvgpr_write_b32 a196, 0
v_accvgpr_write_b32 a197, 0
v_accvgpr_write_b32 a198, 0
v_accvgpr_write_b32 a199, 0
v_accvgpr_write_b32 a200, 0
v_accvgpr_write_b32 a201, 0
v_accvgpr_write_b32 a202, 0
v_accvgpr_write_b32 a203, 0
v_accvgpr_write_b32 a204, 0
v_accvgpr_write_b32 a205, 0
v_accvgpr_write_b32 a206, 0
v_accvgpr_write_b32 a207, 0
v_accvgpr_write_b32 a208, 0
v_accvgpr_write_b32 a209, 0
v_accvgpr_write_b32 a210, 0
v_accvgpr_write_b32 a211, 0
v_accvgpr_write_b32 a212, 0
v_accvgpr_write_b32 a213, 0
v_accvgpr_write_b32 a214, 0
v_accvgpr_write_b32 a215, 0
v_accvgpr_write_b32 a216, 0
v_accvgpr_write_b32 a217, 0
v_accvgpr_write_b32 a218, 0
v_accvgpr_write_b32 a219, 0
v_accvgpr_write_b32 a220, 0
v_accvgpr_write_b32 a221, 0
v_accvgpr_write_b32 a222, 0
v_accvgpr_write_b32 a223, 0
v_mov_b64 v[112:113], 0
v_mov_b64 v[114:115], 0
v_mov_b64 v[116:117], 0
v_mov_b64 v[118:119], 0
v_mov_b64 v[120:121], 0
v_mov_b64 v[122:123], 0
v_mov_b64 v[124:125], 0
v_mov_b64 v[126:127], 0
v_mov_b64 v[128:129], 0
v_mov_b64 v[130:131], 0
v_mov_b64 v[132:133], 0
v_mov_b64 v[134:135], 0
v_mov_b64 v[136:137], 0
v_mov_b64 v[138:139], 0
v_mov_b64 v[140:141], 0
v_mov_b64 v[142:143], 0
v_mov_b64 v[144:145], 0
v_mov_b64 v[146:147], 0
v_mov_b64 v[148:149], 0
v_mov_b64 v[150:151], 0
v_mov_b64 v[152:153], 0
v_mov_b64 v[154:155], 0
v_mov_b64 v[156:157], 0
v_mov_b64 v[158:159], 0
v_mov_b64 v[22:23], 0
s_waitcnt vmcnt(16)
s_barrier
ds_read_b128 a[64:67], v2 offset:0
ds_read_b128 a[68:71], v2 offset:1024
ds_read_b128 a[72:75], v2 offset:2048
ds_read_b128 a[76:79], v2 offset:3072
s_waitcnt lgkmcnt(3)
v_mfma_f32_32x32x16_bf16 v[32:47], a[64:67], a[0:3], v[128:143]
ds_read_b128 a[80:83], v2 offset:4096
v_mfma_f32_32x32x16_bf16 v[48:63], a[64:67], a[32:35], v[144:159]
s_waitcnt lgkmcnt(3)
v_mfma_f32_32x32x16_bf16 v[32:47], a[68:71], a[4:7], v[32:47]
ds_read_b128 a[84:87], v2 offset:5120
v_mfma_f32_32x32x16_bf16 v[48:63], a[68:71], a[36:39], v[48:63]
s_waitcnt lgkmcnt(3)
v_mfma_f32_32x32x16_bf16 v[32:47], a[72:75], a[8:11], v[32:47]
ds_read_b128 a[88:91], v2 offset:6144
v_mfma_f32_32x32x16_bf16 v[48:63], a[72:75], a[40:43], v[48:63]
s_waitcnt lgkmcnt(3)
v_mfma_f32_32x32x16_bf16 v[32:47], a[76:79], a[12:15], v[32:47]
ds_read_b128 a[92:95], v2 offset:7168
v_mfma_f32_32x32x16_bf16 v[48:63], a[76:79], a[44:47], v[48:63]
s_waitcnt lgkmcnt(3)
v_mfma_f32_32x32x16_bf16 v[32:47], a[80:83], a[16:19], v[32:47]
ds_read_b128 a[64:67], v4 offset:24576
v_mfma_f32_32x32x16_bf16 v[48:63], a[80:83], a[48:51], v[48:63]
s_waitcnt lgkmcnt(3)
v_mfma_f32_32x32x16_bf16 v[32:47], a[84:87], a[20:23], v[32:47]
ds_read_b128 a[68:71], v4 offset:25600
v_mfma_f32_32x32x16_bf16 v[48:63], a[84:87], a[52:55], v[48:63]
s_waitcnt lgkmcnt(3)
v_mfma_f32_32x32x16_bf16 v[32:47], a[88:91], a[24:27], v[32:47]
ds_read_b128 a[72:75], v4 offset:26624
v_mfma_f32_32x32x16_bf16 v[48:63], a[88:91], a[56:59], v[48:63]
s_waitcnt lgkmcnt(3)
v_mfma_f32_32x32x16_bf16 v[32:47], a[92:95], a[28:31], v[32:47]
ds_read_b128 a[76:79], v4 offset:27648
v_mfma_f32_32x32x16_bf16 v[48:63], a[92:95], a[60:63], v[48:63]
s_waitcnt lgkmcnt(3)
s_cmp_eq_u32 s44, 0
s_cbranch_scc1 L_at_last
.p2align 3
L_at_loop:
v_mfma_f32_32x32x16_bf16 a[96:111], a[64:67], v[112:115], a[96:111]
ds_read_b128 a[80:83], v4 offset:28672
v_mfma_f32_32x32x16_bf16 a[112:127], a[64:67], v[120:123], a[112:127]
s_waitcnt lgkmcnt(3)
s_add_u32 s24, s43, 3
v_mfma_f32_32x32x16_bf16 a[96:111], a[68:71], v[116:119], a[96:111]
ds_read_b128 a[84:87], v4 offset:29696
v_max3_f32 v26, v32, v33, v34
v_max3_f32 v26, v26, v35, v36
v_max3_f32 v26, v26, v37, v38
v_max3_f32 v26, v26, v39, v40
v_mfma_f32_32x32x16_bf16 a[112:127], a[68:71], v[124:127], a[112:127]
s_waitcnt lgkmcnt(3)
s_cmp_lt_u32 s24, s45
s_cselect_b32 s46, s46, 536870912
v_max3_f32 v26, v26, v41, v42
v_max3_f32 v26, v26, v43, v44
v_max3_f32 v26, v26, v45, v46
v_max3_f32 v26, v26, v47, v48
v_max3_f32 v26, v26, v49, v50
v_mfma_f32_32x32x16_bf16 a[128:143], a[72:75], v[112:115], a[128:143]
ds_read_b128 a[88:91], v4 offset:30720
v_max3_f32 v26, v26, v51, v52
v_max3_f32 v26, v26, v53, v54
v_max3_f32 v26, v26, v55, v56
v_max3_f32 v26, v26, v57, v58
v_mfma_f32_32x32x16_bf16 a[144:159], a[72:75], v[120:123], a[144:159]
s_waitcnt lgkmcnt(3)
v_max3_f32 v26, v26, v59, v60
v_max3_f32 v26, v26, v61, v62
v_max_f32 v26, v26, v63
v_cmp_lt_f32 vcc, s54, v26
v_mfma_f32_32x32x16_bf16 a[128:143], a[76:79], v[116:119], a[128:143]
ds_read_b128 a[92:95], v4 offset:31744
s_cbranch_vccnz L_at_upa
L_at_upra:
v_exp_f32 v32, v32
v_exp_f32 v33, v33
v_mfma_f32_32x32x16_bf16 a[144:159], a[76:79], v[124:127], a[144:159]
s_waitcnt lgkmcnt(3)
v_exp_f32 v34, v34
v_add_f32 v22, v22, v32
v_add_f32 v22, v22, v33
v_mfma_f32_32x32x16_bf16 a[160:175], a[80:83], v[112:115], a[160:175]
ds_read_b128 a[64:67], v2 offset:16384
v_exp_f32 v35, v35
v_cvt_pk_bf16_f32 v96, v32, v33
v_exp_f32 v36, v36
v_mfma_f32_32x32x16_bf16 a[176:191], a[80:83], v[120:123], a[176:191]
s_waitcnt lgkmcnt(3)
v_add_f32 v22, v22, v34
v_add_f32 v22, v22, v35
v_exp_f32 v37, v37
v_mfma_f32_32x32x16_bf16 a[160:175], a[84:87], v[116:119], a[160:175]
ds_read_b128 a[68:71], v2 offset:17408
v_cvt_pk_bf16_f32 v97, v34, v35
v_exp_f32 v38, v38
v_add_f32 v22, v22, v36
v_add_f32 v22, v22, v37
v_mfma_f32_32x32x16_bf16 a[176:191], a[84:87], v[124:127], a[176:191]
s_waitcnt lgkmcnt(3)
v_exp_f32 v39, v39
v_cvt_pk_bf16_f32 v98, v36, v37
v_mfma_f32_32x32x16_bf16 a[192:207], a[88:91], v[112:115], a[192:207]
ds_read_b128 a[72:75], v2 offset:18432
v_exp_f32 v40, v40
v_add_f32 v22, v22, v38
v_add_f32 v22, v22, v39
v_exp_f32 v41, v41
v_mfma_f32_32x32x16_bf16 a[208:223], a[88:91], v[120:123], a[208:223]
s_waitcnt lgkmcnt(3)
v_cvt_pk_bf16_f32 v99, v38, v39
v_exp_f32 v42, v42
v_mfma_f32_32x32x16_bf16 a[192:207], a[92:95], v[116:119], a[192:207]
ds_read_b128 a[76:79], v2 offset:19456
v_add_f32 v22, v22, v40
v_add_f32 v22, v22, v41
v_exp_f32 v43, v43
v_cvt_pk_bf16_f32 v100, v40, v41
v_mfma_f32_32x32x16_bf16 a[208:223], a[92:95], v[124:127], a[208:223]
s_waitcnt lgkmcnt(3)
s_cmp_eq_u32 s48, 0
s_cbranch_scc0 L_at_rsa
L_at_rsra:
v_exp_f32 v44, v44
v_add_f32 v22, v22, v42
v_add_f32 v22, v22, v43
v_mfma_f32_32x32x16_bf16 v[64:79], a[64:67], a[0:3], v[128:143]
ds_read_b128 a[80:83], v2 offset:20480
v_exp_f32 v45, v45
v_cvt_pk_bf16_f32 v101, v42, v43
v_exp_f32 v46, v46
v_mfma_f32_32x32x16_bf16 v[80:95], a[64:67], a[32:35], v[144:159]
s_waitcnt lgkmcnt(3)
v_add_f32 v22, v22, v44
v_add_f32 v22, v22, v45
v_exp_f32 v47, v47
v_mfma_f32_32x32x16_bf16 v[64:79], a[68:71], a[4:7], v[64:79]
ds_read_b128 a[84:87], v2 offset:21504
v_cvt_pk_bf16_f32 v102, v44, v45
v_exp_f32 v48, v48
v_add_f32 v22, v22, v46
v_mfma_f32_32x32x16_bf16 v[80:95], a[68:71], a[36:39], v[80:95]
s_waitcnt lgkmcnt(3)
v_add_f32 v22, v22, v47
v_exp_f32 v49, v49
v_cvt_pk_bf16_f32 v103, v46, v47
v_mfma_f32_32x32x16_bf16 v[64:79], a[72:75], a[8:11], v[64:79]
ds_read_b128 a[88:91], v2 offset:22528
v_exp_f32 v50, v50
v_add_f32 v23, v23, v48
v_add_f32 v23, v23, v49
v_mfma_f32_32x32x16_bf16 v[80:95], a[72:75], a[40:43], v[80:95]
s_waitcnt lgkmcnt(3)
v_exp_f32 v51, v51
v_cvt_pk_bf16_f32 v104, v48, v49
v_exp_f32 v52, v52
v_mfma_f32_32x32x16_bf16 v[64:79], a[76:79], a[12:15], v[64:79]
ds_read_b128 a[92:95], v2 offset:23552
v_add_f32 v23, v23, v50
v_add_f32 v23, v23, v51
v_exp_f32 v53, v53
v_mfma_f32_32x32x16_bf16 v[80:95], a[76:79], a[44:47], v[80:95]
s_waitcnt lgkmcnt(3)
v_cvt_pk_bf16_f32 v105, v50, v51
v_exp_f32 v54, v54
v_add_f32 v23, v23, v52
v_add_f32 v23, v23, v53
v_mfma_f32_32x32x16_bf16 v[64:79], a[80:83], a[16:19], v[64:79]
ds_read_b128 a[64:67], v2 offset:8192
v_exp_f32 v55, v55
v_cvt_pk_bf16_f32 v106, v52, v53
v_mfma_f32_32x32x16_bf16 v[80:95], a[80:83], a[48:51], v[80:95]
s_waitcnt lgkmcnt(3)
v_exp_f32 v56, v56
v_add_f32 v23, v23, v54
v_add_f32 v23, v23, v55
v_exp_f32 v57, v57
v_mfma_f32_32x32x16_bf16 v[64:79], a[84:87], a[20:23], v[64:79]
ds_read_b128 a[68:71], v2 offset:9216
v_cvt_pk_bf16_f32 v107, v54, v55
v_exp_f32 v58, v58
v_mfma_f32_32x32x16_bf16 v[80:95], a[84:87], a[52:55], v[80:95]
s_waitcnt lgkmcnt(3)
v_add_f32 v23, v23, v56
v_add_f32 v23, v23, v57
v_exp_f32 v59, v59
v_cvt_pk_bf16_f32 v108, v56, v57
v_mfma_f32_32x32x16_bf16 v[64:79], a[88:91], a[24:27], v[64:79]
ds_read_b128 a[72:75], v2 offset:10240
v_exp_f32 v60, v60
v_add_f32 v23, v23, v58
v_add_f32 v23, v23, v59
v_mfma_f32_32x32x16_bf16 v[80:95], a[88:91], a[56:59], v[80:95]
s_waitcnt lgkmcnt(3)
v_exp_f32 v61, v61
v_cvt_pk_bf16_f32 v109, v58, v59
v_exp_f32 v62, v62
v_mfma_f32_32x32x16_bf16 v[64:79], a[92:95], a[28:31], v[64:79]
ds_read_b128 a[76:79], v2 offset:11264
v_add_f32 v23, v23, v60
v_add_f32 v23, v23, v61
v_exp_f32 v63, v63
v_mfma_f32_32x32x16_bf16 v[80:95], a[92:95], a[60:63], v[80:95]
s_waitcnt lgkmcnt(3)
v_cvt_pk_bf16_f32 v110, v60, v61
v_add_f32 v23, v23, v62
v_add_f32 v23, v23, v63
v_cvt_pk_bf16_f32 v111, v62, v63
s_waitcnt vmcnt(8)
s_barrier
v_mfma_f32_32x32x16_bf16 a[96:111], a[64:67], v[96:99], a[96:111]
ds_read_b128 a[80:83], v2 offset:12288
v_mfma_f32_32x32x16_bf16 a[112:127], a[64:67], v[104:107], a[112:127]
s_waitcnt lgkmcnt(3)
s_mov_b32 m0, s47
v_mfma_f32_32x32x16_bf16 a[96:111], a[68:71], v[100:103], a[96:111]
ds_read_b128 a[84:87], v2 offset:13312
v_max3_f32 v26, v64, v65, v66
v_max3_f32 v26, v26, v67, v68
v_max3_f32 v26, v26, v69, v70
v_max3_f32 v26, v26, v71, v72
v_mfma_f32_32x32x16_bf16 a[112:127], a[68:71], v[108:111], a[112:127]
s_waitcnt lgkmcnt(3)
s_add_u32 s24, s46, 4096
v_max3_f32 v26, v26, v73, v74
v_max3_f32 v26, v26, v75, v76
v_max3_f32 v26, v26, v77, v78
v_max3_f32 v26, v26, v79, v80
v_max3_f32 v26, v26, v81, v82
v_mfma_f32_32x32x16_bf16 a[128:143], a[72:75], v[96:99], a[128:143]
ds_read_b128 a[88:91], v2 offset:14336
v_max3_f32 v26, v26, v83, v84
v_max3_f32 v26, v26, v85, v86
v_max3_f32 v26, v26, v87, v88
v_max3_f32 v26, v26, v89, v90
v_mfma_f32_32x32x16_bf16 a[144:159], a[72:75], v[104:107], a[144:159]
s_waitcnt lgkmcnt(3)
buffer_load_dwordx4 v1, s[8:11], s46 offen offset:0 sc1 lds
v_max3_f32 v26, v26, v91, v92
v_max3_f32 v26, v26, v93, v94
v_max_f32 v26, v26, v95
v_cmp_lt_f32 vcc, s54, v26
v_mfma_f32_32x32x16_bf16 a[128:143], a[76:79], v[100:103], a[128:143]
ds_read_b128 a[92:95], v2 offset:15360
s_cbranch_vccnz L_at_upb
L_at_uprb:
v_exp_f32 v64, v64
v_exp_f32 v65, v65
v_mfma_f32_32x32x16_bf16 a[144:159], a[76:79], v[108:111], a[144:159]
s_waitcnt lgkmcnt(3)
buffer_load_dwordx4 v1, s[8:11], s46 offen offset:1024 sc1 lds
v_exp_f32 v66, v66
v_add_f32 v22, v22, v64
v_add_f32 v22, v22, v65
v_mfma_f32_32x32x16_bf16 a[160:175], a[80:83], v[96:99], a[160:175]
ds_read_b128 a[64:67], v3 offset:0
v_exp_f32 v67, v67
v_cvt_pk_bf16_f32 v112, v64, v65
v_exp_f32 v68, v68
v_mfma_f32_32x32x16_bf16 a[176:191], a[80:83], v[104:107], a[176:191]
s_waitcnt lgkmcnt(3)
buffer_load_dwordx4 v1, s[8:11], s46 offen offset:2048 sc1 lds
v_add_f32 v22, v22, v66
v_add_f32 v22, v22, v67
v_exp_f32 v69, v69
v_cvt_pk_bf16_f32 v113, v66, v67
v_mfma_f32_32x32x16_bf16 a[160:175], a[84:87], v[100:103], a[160:175]
ds_read_b128 a[68:71], v3 offset:1024
v_exp_f32 v70, v70
v_add_f32 v22, v22, v68
v_add_f32 v22, v22, v69
v_mfma_f32_32x32x16_bf16 a[176:191], a[84:87], v[108:111], a[176:191]
s_waitcnt lgkmcnt(3)
buffer_load_dwordx4 v1, s[8:11], s46 offen offset:3072 sc1 lds
v_exp_f32 v71, v71
v_cvt_pk_bf16_f32 v114, v68, v69
v_exp_f32 v72, v72
v_mfma_f32_32x32x16_bf16 a[192:207], a[88:91], v[96:99], a[192:207]
ds_read_b128 a[72:75], v3 offset:2048
v_add_f32 v22, v22, v70
v_add_f32 v22, v22, v71
v_exp_f32 v73, v73
v_mfma_f32_32x32x16_bf16 a[208:223], a[88:91], v[104:107], a[208:223]
s_waitcnt lgkmcnt(3)
s_add_u32 m0, s47, 4096
v_cvt_pk_bf16_f32 v115, v70, v71
v_exp_f32 v74, v74
v_add_f32 v22, v22, v72
v_add_f32 v22, v22, v73
v_mfma_f32_32x32x16_bf16 a[192:207], a[92:95], v[100:103], a[192:207]
ds_read_b128 a[76:79], v3 offset:3072
v_exp_f32 v75, v75
v_cvt_pk_bf16_f32 v116, v72, v73
v_exp_f32 v76, v76
v_mfma_f32_32x32x16_bf16 a[208:223], a[92:95], v[108:111], a[208:223]
s_waitcnt lgkmcnt(3)
buffer_load_dwordx4 v1, s[8:11], s24 offen offset:0 sc1 lds
s_cmp_eq_u32 s48, 0
s_cbranch_scc0 L_at_rsb
L_at_rsrb:
v_add_f32 v22, v22, v74
v_add_f32 v22, v22, v75
v_exp_f32 v77, v77
v_mfma_f32_32x32x16_bf16 v[32:47], a[64:67], a[0:3], v[128:143]
ds_read_b128 a[80:83], v3 offset:4096
v_cvt_pk_bf16_f32 v117, v74, v75
v_exp_f32 v78, v78
v_add_f32 v22, v22, v76
v_mfma_f32_32x32x16_bf16 v[48:63], a[64:67], a[32:35], v[144:159]
s_waitcnt lgkmcnt(3)
buffer_load_dwordx4 v1, s[8:11], s24 offen offset:1024 sc1 lds
v_add_f32 v22, v22, v77
v_exp_f32 v79, v79
v_cvt_pk_bf16_f32 v118, v76, v77
v_mfma_f32_32x32x16_bf16 v[32:47], a[68:71], a[4:7], v[32:47]
ds_read_b128 a[84:87], v3 offset:5120
v_exp_f32 v80, v80
v_add_f32 v22, v22, v78
v_add_f32 v22, v22, v79
v_exp_f32 v81, v81
v_mfma_f32_32x32x16_bf16 v[48:63], a[68:71], a[36:39], v[48:63]
s_waitcnt lgkmcnt(3)
buffer_load_dwordx4 v1, s[8:11], s24 offen offset:2048 sc1 lds
v_cvt_pk_bf16_f32 v119, v78, v79
v_exp_f32 v82, v82
v_mfma_f32_32x32x16_bf16 v[32:47], a[72:75], a[8:11], v[32:47]
ds_read_b128 a[88:91], v3 offset:6144
v_add_f32 v23, v23, v80
v_add_f32 v23, v23, v81
v_exp_f32 v83, v83
v_cvt_pk_bf16_f32 v120, v80, v81
v_mfma_f32_32x32x16_bf16 v[48:63], a[72:75], a[40:43], v[48:63]
s_waitcnt lgkmcnt(3)
buffer_load_dwordx4 v1, s[8:11], s24 offen offset:3072 sc1 lds
v_exp_f32 v84, v84
v_add_f32 v23, v23, v82
v_add_f32 v23, v23, v83
v_mfma_f32_32x32x16_bf16 v[32:47], a[76:79], a[12:15], v[32:47]
ds_read_b128 a[92:95], v3 offset:7168
v_exp_f32 v85, v85
v_cvt_pk_bf16_f32 v121, v82, v83
v_exp_f32 v86, v86
v_mfma_f32_32x32x16_bf16 v[48:63], a[76:79], a[44:47], v[48:63]
s_waitcnt lgkmcnt(3)
s_add_u32 s46, s46, 32768
v_add_f32 v23, v23, v84
v_add_f32 v23, v23, v85
v_exp_f32 v87, v87
v_mfma_f32_32x32x16_bf16 v[32:47], a[80:83], a[16:19], v[32:47]
ds_read_b128 a[64:67], v2 offset:24576
v_cvt_pk_bf16_f32 v122, v84, v85
v_exp_f32 v88, v88
v_add_f32 v23, v23, v86
v_add_f32 v23, v23, v87
v_mfma_f32_32x32x16_bf16 v[48:63], a[80:83], a[48:51], v[48:63]
s_waitcnt lgkmcnt(3)
s_add_u32 s47, s47, 32768
v_exp_f32 v89, v89
v_cvt_pk_bf16_f32 v123, v86, v87
v_exp_f32 v90, v90
v_mfma_f32_32x32x16_bf16 v[32:47], a[84:87], a[20:23], v[32:47]
ds_read_b128 a[68:71], v2 offset:25600
v_add_f32 v23, v23, v88
v_add_f32 v23, v23, v89
v_exp_f32 v91, v91
v_mfma_f32_32x32x16_bf16 v[48:63], a[84:87], a[52:55], v[48:63]
s_waitcnt lgkmcnt(3)
s_and_b32 s47, s47, 131071
v_cvt_pk_bf16_f32 v124, v88, v89
v_exp_f32 v92, v92
v_add_f32 v23, v23, v90
v_mfma_f32_32x32x16_bf16 v[32:47], a[88:91], a[24:27], v[32:47]
ds_read_b128 a[72:75], v2 offset:26624
v_add_f32 v23, v23, v91
v_exp_f32 v93, v93
v_cvt_pk_bf16_f32 v125, v90, v91
v_mfma_f32_32x32x16_bf16 v[48:63], a[88:91], a[56:59], v[48:63]
s_waitcnt lgkmcnt(3)
s_add_u32 s43, s43, 1
v_exp_f32 v94, v94
v_add_f32 v23, v23, v92
v_add_f32 v23, v23, v93
v_exp_f32 v95, v95
v_mfma_f32_32x32x16_bf16 v[32:47], a[92:95], a[28:31], v[32:47]
ds_read_b128 a[76:79], v2 offset:27648
v_cvt_pk_bf16_f32 v126, v92, v93
v_add_f32 v23, v23, v94
v_add_f32 v23, v23, v95
v_cvt_pk_bf16_f32 v127, v94, v95
v_mfma_f32_32x32x16_bf16 v[48:63], a[92:95], a[60:63], v[48:63]
s_waitcnt lgkmcnt(3)
s_cmp_lt_u32 s43, s44
v_mov_b32 v4, v2
v_mov_b32 v2, v3
v_add_u32 v3, 32768, v3
v_and_b32 v3, 131071, v3
s_cbranch_scc1 L_at_loop
L_at_last:
v_mfma_f32_32x32x16_bf16 a[96:111], a[64:67], v[112:115], a[96:111]
ds_read_b128 a[80:83], v4 offset:28672
v_mfma_f32_32x32x16_bf16 a[112:127], a[64:67], v[120:123], a[112:127]
s_waitcnt lgkmcnt(3)
s_add_u32 s24, s43, 3
v_mfma_f32_32x32x16_bf16 a[96:111], a[68:71], v[116:119], a[96:111]
ds_read_b128 a[84:87], v4 offset:29696
v_mov_b32 v31, s50
v_cmp_le_i32 vcc, 0, v5
s_nop 1
v_cndmask_b32 v32, v31, v32, vcc
v_cmp_le_i32 vcc, 1, v5
v_mfma_f32_32x32x16_bf16 a[112:127], a[68:71], v[124:127], a[112:127]
s_waitcnt lgkmcnt(3)
s_cmp_lt_u32 s24, s45
s_cselect_b32 s46, s46, 536870912
v_cndmask_b32 v33, v31, v33, vcc
v_cmp_le_i32 vcc, 2, v5
s_nop 1
v_cndmask_b32 v34, v31, v34, vcc
v_cmp_le_i32 vcc, 3, v5
v_mfma_f32_32x32x16_bf16 a[128:143], a[72:75], v[112:115], a[128:143]
ds_read_b128 a[88:91], v4 offset:30720
v_cndmask_b32 v35, v31, v35, vcc
v_cmp_le_i32 vcc, 8, v5
s_nop 1
v_cndmask_b32 v36, v31, v36, vcc
v_cmp_le_i32 vcc, 9, v5
s_nop 1
v_cndmask_b32 v37, v31, v37, vcc
v_mfma_f32_32x32x16_bf16 a[144:159], a[72:75], v[120:123], a[144:159]
s_waitcnt lgkmcnt(3)
v_cmp_le_i32 vcc, 10, v5
s_nop 1
v_cndmask_b32 v38, v31, v38, vcc
v_cmp_le_i32 vcc, 11, v5
s_nop 1
v_cndmask_b32 v39, v31, v39, vcc
v_mfma_f32_32x32x16_bf16 a[128:143], a[76:79], v[116:119], a[128:143]
ds_read_b128 a[92:95], v4 offset:31744
v_cmp_le_i32 vcc, 16, v5
s_nop 1
v_cndmask_b32 v40, v31, v40, vcc
v_cmp_le_i32 vcc, 17, v5
s_nop 1
v_cndmask_b32 v41, v31, v41, vcc
v_mfma_f32_32x32x16_bf16 a[144:159], a[76:79], v[124:127], a[144:159]
s_waitcnt lgkmcnt(3)
v_cmp_le_i32 vcc, 18, v5
s_nop 1
v_cndmask_b32 v42, v31, v42, vcc
v_cmp_le_i32 vcc, 19, v5
s_nop 1
v_cndmask_b32 v43, v31, v43, vcc
v_mfma_f32_32x32x16_bf16 a[160:175], a[80:83], v[112:115], a[160:175]
ds_read_b128 a[64:67], v2 offset:16384
v_cmp_le_i32 vcc, 24, v5
s_nop 1
v_cndmask_b32 v44, v31, v44, vcc
v_cmp_le_i32 vcc, 25, v5
s_nop 1
v_cndmask_b32 v45, v31, v45, vcc
v_mfma_f32_32x32x16_bf16 a[176:191], a[80:83], v[120:123], a[176:191]
s_waitcnt lgkmcnt(3)
v_cmp_le_i32 vcc, 26, v5
s_nop 1
v_cndmask_b32 v46, v31, v46, vcc
v_cmp_le_i32 vcc, 27, v5
s_nop 1
v_cndmask_b32 v47, v31, v47, vcc
v_mfma_f32_32x32x16_bf16 a[160:175], a[84:87], v[116:119], a[160:175]
ds_read_b128 a[68:71], v2 offset:17408
v_max3_f32 v26, v32, v33, v34
v_max3_f32 v26, v26, v35, v36
v_max3_f32 v26, v26, v37, v38
v_max3_f32 v26, v26, v39, v40
v_max3_f32 v26, v26, v41, v42
v_mfma_f32_32x32x16_bf16 a[176:191], a[84:87], v[124:127], a[176:191]
s_waitcnt lgkmcnt(3)
v_max3_f32 v26, v26, v43, v44
v_max3_f32 v26, v26, v45, v46
v_max3_f32 v26, v26, v47, v48
v_max3_f32 v26, v26, v49, v50
v_mfma_f32_32x32x16_bf16 a[192:207], a[88:91], v[112:115], a[192:207]
ds_read_b128 a[72:75], v2 offset:18432
v_max3_f32 v26, v26, v51, v52
v_max3_f32 v26, v26, v53, v54
v_max3_f32 v26, v26, v55, v56
v_max3_f32 v26, v26, v57, v58
v_mfma_f32_32x32x16_bf16 a[208:223], a[88:91], v[120:123], a[208:223]
s_waitcnt lgkmcnt(3)
v_max3_f32 v26, v26, v59, v60
v_max3_f32 v26, v26, v61, v62
v_max_f32 v26, v26, v63
v_cmp_lt_f32 vcc, s54, v26
v_mfma_f32_32x32x16_bf16 a[192:207], a[92:95], v[116:119], a[192:207]
ds_read_b128 a[76:79], v2 offset:19456
s_cbranch_vccnz L_at_upc
L_at_uprc:
v_exp_f32 v32, v32
v_exp_f32 v33, v33
v_exp_f32 v34, v34
v_mfma_f32_32x32x16_bf16 a[208:223], a[92:95], v[124:127], a[208:223]
s_waitcnt lgkmcnt(3)
s_cmp_eq_u32 s48, 0
s_cbranch_scc0 L_at_rsc
L_at_rsrc:
v_add_f32 v22, v22, v32
v_add_f32 v22, v22, v33
v_exp_f32 v35, v35
v_cvt_pk_bf16_f32 v96, v32, v33
v_exp_f32 v36, v36
v_mfma_f32_32x32x16_bf16 v[64:79], a[64:67], a[0:3], v[128:143]
ds_read_b128 a[80:83], v2 offset:20480
v_add_f32 v22, v22, v34
v_add_f32 v22, v22, v35
v_exp_f32 v37, v37
v_cvt_pk_bf16_f32 v97, v34, v35
v_mfma_f32_32x32x16_bf16 v[80:95], a[64:67], a[32:35], v[144:159]
s_waitcnt lgkmcnt(3)
v_exp_f32 v38, v38
v_add_f32 v22, v22, v36
v_add_f32 v22, v22, v37
v_exp_f32 v39, v39
v_cvt_pk_bf16_f32 v98, v36, v37
v_mfma_f32_32x32x16_bf16 v[64:79], a[68:71], a[4:7], v[64:79]
ds_read_b128 a[84:87], v2 offset:21504
v_exp_f32 v40, v40
v_add_f32 v22, v22, v38
v_add_f32 v22, v22, v39
v_exp_f32 v41, v41
v_mfma_f32_32x32x16_bf16 v[80:95], a[68:71], a[36:39], v[80:95]
s_waitcnt lgkmcnt(3)
v_cvt_pk_bf16_f32 v99, v38, v39
v_exp_f32 v42, v42
v_add_f32 v22, v22, v40
v_add_f32 v22, v22, v41
v_exp_f32 v43, v43
v_mfma_f32_32x32x16_bf16 v[64:79], a[72:75], a[8:11], v[64:79]
ds_read_b128 a[88:91], v2 offset:22528
v_cvt_pk_bf16_f32 v100, v40, v41
v_exp_f32 v44, v44
v_add_f32 v22, v22, v42
v_add_f32 v22, v22, v43
v_mfma_f32_32x32x16_bf16 v[80:95], a[72:75], a[40:43], v[80:95]
s_waitcnt lgkmcnt(3)
v_exp_f32 v45, v45
v_cvt_pk_bf16_f32 v101, v42, v43
v_exp_f32 v46, v46
v_add_f32 v22, v22, v44
v_add_f32 v22, v22, v45
v_mfma_f32_32x32x16_bf16 v[64:79], a[76:79], a[12:15], v[64:79]
ds_read_b128 a[92:95], v2 offset:23552
v_exp_f32 v47, v47
v_cvt_pk_bf16_f32 v102, v44, v45
v_exp_f32 v48, v48
v_add_f32 v22, v22, v46
v_mfma_f32_32x32x16_bf16 v[80:95], a[76:79], a[44:47], v[80:95]
s_waitcnt lgkmcnt(3)
v_add_f32 v22, v22, v47
v_exp_f32 v49, v49
v_cvt_pk_bf16_f32 v103, v46, v47
v_exp_f32 v50, v50
v_mfma_f32_32x32x16_bf16 v[64:79], a[80:83], a[16:19], v[64:79]
ds_read_b128 a[64:67], v2 offset:8192
v_add_f32 v23, v23, v48
v_add_f32 v23, v23, v49
v_exp_f32 v51, v51
v_cvt_pk_bf16_f32 v104, v48, v49
v_exp_f32 v52, v52
v_mfma_f32_32x32x16_bf16 v[80:95], a[80:83], a[48:51], v[80:95]
s_waitcnt lgkmcnt(3)
v_add_f32 v23, v23, v50
v_add_f32 v23, v23, v51
v_exp_f32 v53, v53
v_cvt_pk_bf16_f32 v105, v50, v51
v_mfma_f32_32x32x16_bf16 v[64:79], a[84:87], a[20:23], v[64:79]
ds_read_b128 a[68:71], v2 offset:9216
v_exp_f32 v54, v54
v_add_f32 v23, v23, v52
v_add_f32 v23, v23, v53
v_exp_f32 v55, v55
v_cvt_pk_bf16_f32 v106, v52, v53
v_mfma_f32_32x32x16_bf16 v[80:95], a[84:87], a[52:55], v[80:95]
s_waitcnt lgkmcnt(3)
v_exp_f32 v56, v56
v_add_f32 v23, v23, v54
v_add_f32 v23, v23, v55
v_exp_f32 v57, v57
v_mfma_f32_32x32x16_bf16 v[64:79], a[88:91], a[24:27], v[64:79]
ds_read_b128 a[72:75], v2 offset:10240
v_cvt_pk_bf16_f32 v107, v54, v55
v_exp_f32 v58, v58
v_add_f32 v23, v23, v56
v_add_f32 v23, v23, v57
v_exp_f32 v59, v59
v_mfma_f32_32x32x16_bf16 v[80:95], a[88:91], a[56:59], v[80:95]
s_waitcnt lgkmcnt(3)
v_cvt_pk_bf16_f32 v108, v56, v57
v_exp_f32 v60, v60
v_add_f32 v23, v23, v58
v_add_f32 v23, v23, v59
v_mfma_f32_32x32x16_bf16 v[64:79], a[92:95], a[28:31], v[64:79]
ds_read_b128 a[76:79], v2 offset:11264
v_exp_f32 v61, v61
v_cvt_pk_bf16_f32 v109, v58, v59
v_exp_f32 v62, v62
v_add_f32 v23, v23, v60
v_add_f32 v23, v23, v61
v_mfma_f32_32x32x16_bf16 v[80:95], a[92:95], a[60:63], v[80:95]
s_waitcnt lgkmcnt(3)
v_exp_f32 v63, v63
v_cvt_pk_bf16_f32 v110, v60, v61
v_add_f32 v23, v23, v62
v_add_f32 v23, v23, v63
v_cvt_pk_bf16_f32 v111, v62, v63
s_waitcnt vmcnt(8)
s_barrier
v_mfma_f32_32x32x16_bf16 a[96:111], a[64:67], v[96:99], a[96:111]
ds_read_b128 a[80:83], v2 offset:12288
s_mov_b32 m0, s47
v_mfma_f32_32x32x16_bf16 a[112:127], a[64:67], v[104:107], a[112:127]
s_waitcnt lgkmcnt(3)
s_add_u32 s24, s46, 4096
v_mfma_f32_32x32x16_bf16 a[96:111], a[68:71], v[100:103], a[96:111]
ds_read_b128 a[84:87], v2 offset:13312
buffer_load_dwordx4 v1, s[8:11], s46 offen offset:0 sc1 lds
v_mov_b32 v31, s50
v_cmp_le_i32 vcc, 0, v5
s_nop 1
v_cndmask_b32 v80, v31, v80, vcc
v_cmp_le_i32 vcc, 1, v5
s_nop 1
v_cndmask_b32 v81, v31, v81, vcc
v_cmp_le_i32 vcc, 2, v5
v_mfma_f32_32x32x16_bf16 a[112:127], a[68:71], v[108:111], a[112:127]
s_waitcnt lgkmcnt(3)
buffer_load_dwordx4 v1, s[8:11], s46 offen offset:1024 sc1 lds
v_cndmask_b32 v82, v31, v82, vcc
v_cmp_le_i32 vcc, 3, v5
s_nop 1
v_cndmask_b32 v83, v31, v83, vcc
v_cmp_le_i32 vcc, 8, v5
s_nop 1
v_cndmask_b32 v84, v31, v84, vcc
v_mfma_f32_32x32x16_bf16 a[128:143], a[72:75], v[96:99], a[128:143]
ds_read_b128 a[88:91], v2 offset:14336
buffer_load_dwordx4 v1, s[8:11], s46 offen offset:2048 sc1 lds
v_cmp_le_i32 vcc, 9, v5
s_nop 1
v_cndmask_b32 v85, v31, v85, vcc
v_cmp_le_i32 vcc, 10, v5
s_nop 1
v_cndmask_b32 v86, v31, v86, vcc
v_cmp_le_i32 vcc, 11, v5
s_nop 1
v_cndmask_b32 v87, v31, v87, vcc
v_mfma_f32_32x32x16_bf16 a[144:159], a[72:75], v[104:107], a[144:159]
s_waitcnt lgkmcnt(3)
buffer_load_dwordx4 v1, s[8:11], s46 offen offset:3072 sc1 lds
v_cmp_le_i32 vcc, 16, v5
s_nop 1
v_cndmask_b32 v88, v31, v88, vcc
v_cmp_le_i32 vcc, 17, v5
s_nop 1
v_cndmask_b32 v89, v31, v89, vcc
v_cmp_le_i32 vcc, 18, v5
v_mfma_f32_32x32x16_bf16 a[128:143], a[76:79], v[100:103], a[128:143]
ds_read_b128 a[92:95], v2 offset:15360
s_add_u32 m0, s47, 4096
v_cndmask_b32 v90, v31, v90, vcc
v_cmp_le_i32 vcc, 19, v5
s_nop 1
v_cndmask_b32 v91, v31, v91, vcc
v_cmp_le_i32 vcc, 24, v5
s_nop 1
v_cndmask_b32 v92, v31, v92, vcc
v_cmp_le_i32 vcc, 25, v5
v_mfma_f32_32x32x16_bf16 a[144:159], a[76:79], v[108:111], a[144:159]
s_waitcnt lgkmcnt(3)
buffer_load_dwordx4 v1, s[8:11], s24 offen offset:0 sc1 lds
v_cndmask_b32 v93, v31, v93, vcc
v_cmp_le_i32 vcc, 26, v5
s_nop 1
v_cndmask_b32 v94, v31, v94, vcc
v_cmp_le_i32 vcc, 27, v5
s_nop 1
v_cndmask_b32 v95, v31, v95, vcc
v_mfma_f32_32x32x16_bf16 a[160:175], a[80:83], v[96:99], a[160:175]
ds_read_b128 a[64:67], v2 offset:24576
buffer_load_dwordx4 v1, s[8:11], s24 offen offset:1024 sc1 lds
v_mov_b32 v64, v31
v_mov_b32 v65, v31
v_mov_b32 v66, v31
v_mov_b32 v67, v31
v_mov_b32 v68, v31
v_mov_b32 v69, v31
v_mfma_f32_32x32x16_bf16 a[176:191], a[80:83], v[104:107], a[176:191]
s_waitcnt lgkmcnt(3)
buffer_load_dwordx4 v1, s[8:11], s24 offen offset:2048 sc1 lds
v_mov_b32 v70, v31
v_mov_b32 v71, v31
v_mov_b32 v72, v31
v_mov_b32 v73, v31
v_mov_b32 v74, v31
v_mfma_f32_32x32x16_bf16 a[160:175], a[84:87], v[100:103], a[160:175]
ds_read_b128 a[68:71], v2 offset:25600
buffer_load_dwordx4 v1, s[8:11], s24 offen offset:3072 sc1 lds
v_mov_b32 v75, v31
v_mov_b32 v76, v31
v_mov_b32 v77, v31
v_mov_b32 v78, v31
v_mov_b32 v79, v31
v_max3_f32 v26, v64, v65, v66
v_mfma_f32_32x32x16_bf16 a[176:191], a[84:87], v[108:111], a[176:191]
s_waitcnt lgkmcnt(3)
s_add_u32 s46, s46, 32768
v_max3_f32 v26, v26, v67, v68
v_max3_f32 v26, v26, v69, v70
v_max3_f32 v26, v26, v71, v72
v_max3_f32 v26, v26, v73, v74
v_max3_f32 v26, v26, v75, v76
v_mfma_f32_32x32x16_bf16 a[192:207], a[88:91], v[96:99], a[192:207]
ds_read_b128 a[72:75], v2 offset:26624
s_add_u32 s47, s47, 32768
v_max3_f32 v26, v26, v77, v78
v_max3_f32 v26, v26, v79, v80
v_max3_f32 v26, v26, v81, v82
v_max3_f32 v26, v26, v83, v84
v_max3_f32 v26, v26, v85, v86
v_max3_f32 v26, v26, v87, v88
v_mfma_f32_32x32x16_bf16 a[208:223], a[88:91], v[104:107], a[208:223]
s_waitcnt lgkmcnt(3)
s_and_b32 s47, s47, 131071
v_max3_f32 v26, v26, v89, v90
v_max3_f32 v26, v26, v91, v92
v_max3_f32 v26, v26, v93, v94
v_max_f32 v26, v26, v95
v_cmp_lt_f32 vcc, s54, v26
v_mfma_f32_32x32x16_bf16 a[192:207], a[92:95], v[100:103], a[192:207]
ds_read_b128 a[76:79], v2 offset:27648
s_cbranch_vccnz L_at_upd
L_at_uprd:
v_exp_f32 v64, v64
v_exp_f32 v65, v65
v_exp_f32 v66, v66
v_add_f32 v22, v22, v64
v_add_f32 v22, v22, v65
v_exp_f32 v67, v67
v_cvt_pk_bf16_f32 v112, v64, v65
v_exp_f32 v68, v68
v_add_f32 v22, v22, v66
v_add_f32 v22, v22, v67
v_exp_f32 v69, v69
v_cvt_pk_bf16_f32 v113, v66, v67
v_exp_f32 v70, v70
v_add_f32 v22, v22, v68
v_add_f32 v22, v22, v69
v_exp_f32 v71, v71
v_cvt_pk_bf16_f32 v114, v68, v69
v_exp_f32 v72, v72
v_add_f32 v22, v22, v70
v_add_f32 v22, v22, v71
v_exp_f32 v73, v73
v_cvt_pk_bf16_f32 v115, v70, v71
v_exp_f32 v74, v74
v_add_f32 v22, v22, v72
v_add_f32 v22, v22, v73
v_exp_f32 v75, v75
v_cvt_pk_bf16_f32 v116, v72, v73
v_exp_f32 v76, v76
v_add_f32 v22, v22, v74
v_add_f32 v22, v22, v75
v_exp_f32 v77, v77
v_cvt_pk_bf16_f32 v117, v74, v75
v_exp_f32 v78, v78
v_add_f32 v22, v22, v76
v_add_f32 v22, v22, v77
v_exp_f32 v79, v79
v_cvt_pk_bf16_f32 v118, v76, v77
v_exp_f32 v80, v80
v_add_f32 v22, v22, v78
v_mfma_f32_32x32x16_bf16 a[208:223], a[92:95], v[108:111], a[208:223]
s_waitcnt lgkmcnt(3)
s_cmp_eq_u32 s48, 0
s_cbranch_scc0 L_at_rsd
L_at_rsrd:
v_add_f32 v22, v22, v79
v_exp_f32 v81, v81
v_cvt_pk_bf16_f32 v119, v78, v79
v_exp_f32 v82, v82
v_add_f32 v23, v23, v80
v_add_f32 v23, v23, v81
v_exp_f32 v83, v83
v_cvt_pk_bf16_f32 v120, v80, v81
v_exp_f32 v84, v84
v_add_f32 v23, v23, v82
v_add_f32 v23, v23, v83
v_exp_f32 v85, v85
v_cvt_pk_bf16_f32 v121, v82, v83
v_exp_f32 v86, v86
v_add_f32 v23, v23, v84
v_add_f32 v23, v23, v85
v_exp_f32 v87, v87
v_cvt_pk_bf16_f32 v122, v84, v85
v_exp_f32 v88, v88
v_add_f32 v23, v23, v86
v_add_f32 v23, v23, v87
v_exp_f32 v89, v89
v_cvt_pk_bf16_f32 v123, v86, v87
v_exp_f32 v90, v90
v_add_f32 v23, v23, v88
v_add_f32 v23, v23, v89
v_exp_f32 v91, v91
v_cvt_pk_bf16_f32 v124, v88, v89
v_exp_f32 v92, v92
v_add_f32 v23, v23, v90
v_add_f32 v23, v23, v91
v_exp_f32 v93, v93
v_cvt_pk_bf16_f32 v125, v90, v91
v_exp_f32 v94, v94
v_add_f32 v23, v23, v92
v_add_f32 v23, v23, v93
v_exp_f32 v95, v95
v_cvt_pk_bf16_f32 v126, v92, v93
v_add_f32 v23, v23, v94
v_add_f32 v23, v23, v95
v_cvt_pk_bf16_f32 v127, v94, v95
v_mfma_f32_32x32x16_bf16 a[96:111], a[64:67], v[112:115], a[96:111]
ds_read_b128 a[80:83], v2 offset:28672
v_mfma_f32_32x32x16_bf16 a[112:127], a[64:67], v[120:123], a[112:127]
s_waitcnt lgkmcnt(3)
v_mfma_f32_32x32x16_bf16 a[96:111], a[68:71], v[116:119], a[96:111]
ds_read_b128 a[84:87], v2 offset:29696
v_mfma_f32_32x32x16_bf16 a[112:127], a[68:71], v[124:127], a[112:127]
s_waitcnt lgkmcnt(3)
v_mfma_f32_32x32x16_bf16 a[128:143], a[72:75], v[112:115], a[128:143]
ds_read_b128 a[88:91], v2 offset:30720
v_mfma_f32_32x32x16_bf16 a[144:159], a[72:75], v[120:123], a[144:159]
s_waitcnt lgkmcnt(3)
v_mfma_f32_32x32x16_bf16 a[128:143], a[76:79], v[116:119], a[128:143]
ds_read_b128 a[92:95], v2 offset:31744
v_mfma_f32_32x32x16_bf16 a[144:159], a[76:79], v[124:127], a[144:159]
s_waitcnt lgkmcnt(3)
v_mfma_f32_32x32x16_bf16 a[160:175], a[80:83], v[112:115], a[160:175]
v_mfma_f32_32x32x16_bf16 a[176:191], a[80:83], v[120:123], a[176:191]
s_waitcnt lgkmcnt(2)
v_mfma_f32_32x32x16_bf16 a[160:175], a[84:87], v[116:119], a[160:175]
v_mfma_f32_32x32x16_bf16 a[176:191], a[84:87], v[124:127], a[176:191]
s_waitcnt lgkmcnt(1)
v_mfma_f32_32x32x16_bf16 a[192:207], a[88:91], v[112:115], a[192:207]
v_mfma_f32_32x32x16_bf16 a[208:223], a[88:91], v[120:123], a[208:223]
s_waitcnt lgkmcnt(0)
v_mfma_f32_32x32x16_bf16 a[192:207], a[92:95], v[116:119], a[192:207]
v_mfma_f32_32x32x16_bf16 a[208:223], a[92:95], v[124:127], a[208:223]
s_lshl_b32 s26, s44, 19
s_lshl_b32 s27, s42, 12
s_add_u32 s26, s26, s27
s_add_u32 s26, s26, 67108864
s_add_u32 s27, s26, 262144
L_at_idle:
s_add_u32 s43, s43, 1
s_cmp_ge_u32 s43, s45
s_cbranch_scc1 L_at_fin
s_waitcnt vmcnt(0)
s_barrier
s_branch L_at_idle
L_at_upa:
v_max3_f32 v26, v32, v33, v34
v_max3_f32 v26, v26, v35, v36
v_max3_f32 v26, v26, v37, v38
v_max3_f32 v26, v26, v39, v40
v_max3_f32 v26, v26, v41, v42
v_max3_f32 v26, v26, v43, v44
v_max3_f32 v26, v26, v45, v46
v_max_f32 v26, v26, v47
v_mov_b32 v27, v26
s_nop 1
v_permlane32_swap_b32 v27, v26
v_max3_f32 v26, v26, v27, s55
v_exp_f32 v24, -v26
v_sub_f32 v32, v32, v26
v_sub_f32 v128, v128, v26
v_sub_f32 v33, v33, v26
v_sub_f32 v129, v129, v26
v_sub_f32 v34, v34, v26
v_sub_f32 v130, v130, v26
v_sub_f32 v35, v35, v26
v_sub_f32 v131, v131, v26
v_sub_f32 v36, v36, v26
v_sub_f32 v132, v132, v26
v_sub_f32 v37, v37, v26
v_sub_f32 v133, v133, v26
v_sub_f32 v38, v38, v26
v_sub_f32 v134, v134, v26
v_sub_f32 v39, v39, v26
v_sub_f32 v135, v135, v26
v_sub_f32 v40, v40, v26
v_sub_f32 v136, v136, v26
v_sub_f32 v41, v41, v26
v_sub_f32 v137, v137, v26
v_sub_f32 v42, v42, v26
v_sub_f32 v138, v138, v26
v_sub_f32 v43, v43, v26
v_sub_f32 v139, v139, v26
v_sub_f32 v44, v44, v26
v_sub_f32 v140, v140, v26
v_sub_f32 v45, v45, v26
v_sub_f32 v141, v141, v26
v_sub_f32 v46, v46, v26
v_sub_f32 v142, v142, v26
v_sub_f32 v47, v47, v26
v_sub_f32 v143, v143, v26
v_min_f32 v24, 1.0, v24
v_mul_f32 v22, v22, v24
v_max3_f32 v26, v48, v49, v50
v_max3_f32 v26, v26, v51, v52
v_max3_f32 v26, v26, v53, v54
v_max3_f32 v26, v26, v55, v56
v_max3_f32 v26, v26, v57, v58
v_max3_f32 v26, v26, v59, v60
v_max3_f32 v26, v26, v61, v62
v_max_f32 v26, v26, v63
v_mov_b32 v27, v26
s_nop 1
v_permlane32_swap_b32 v27, v26
v_max3_f32 v26, v26, v27, s55
v_exp_f32 v25, -v26
v_sub_f32 v48, v48, v26
v_sub_f32 v144, v144, v26
v_sub_f32 v49, v49, v26
v_sub_f32 v145, v145, v26
v_sub_f32 v50, v50, v26
v_sub_f32 v146, v146, v26
v_sub_f32 v51, v51, v26
v_sub_f32 v147, v147, v26
v_sub_f32 v52, v52, v26
v_sub_f32 v148, v148, v26
v_sub_f32 v53, v53, v26
v_sub_f32 v149, v149, v26
v_sub_f32 v54, v54, v26
v_sub_f32 v150, v150, v26
v_sub_f32 v55, v55, v26
v_sub_f32 v151, v151, v26
v_sub_f32 v56, v56, v26
v_sub_f32 v152, v152, v26
v_sub_f32 v57, v57, v26
v_sub_f32 v153, v153, v26
v_sub_f32 v58, v58, v26
v_sub_f32 v154, v154, v26
v_sub_f32 v59, v59, v26
v_sub_f32 v155, v155, v26
v_sub_f32 v60, v60, v26
v_sub_f32 v156, v156, v26
v_sub_f32 v61, v61, v26
v_sub_f32 v157, v157, v26
v_sub_f32 v62, v62, v26
v_sub_f32 v158, v158, v26
v_sub_f32 v63, v63, v26
v_sub_f32 v159, v159, v26
v_min_f32 v25, 1.0, v25
v_mul_f32 v23, v23, v25
s_cmp_eq_u32 s55, 0
s_cselect_b32 s48, 1, 0
s_mov_b32 s55, 0
s_mov_b32 s54, s51
s_branch L_at_upra
L_at_rsa:
s_getpc_b64 s[52:53]
s_add_u32 s52, s52, 12
s_addc_u32 s53, s53, 0
s_branch L_at_rescale
s_branch L_at_rsra
L_at_upb:
v_max3_f32 v26, v64, v65, v66
v_max3_f32 v26, v26, v67, v68
v_max3_f32 v26, v26, v69, v70
v_max3_f32 v26, v26, v71, v72
v_max3_f32 v26, v26, v73, v74
v_max3_f32 v26, v26, v75, v76
v_max3_f32 v26, v26, v77, v78
v_max_f32 v26, v26, v79
v_mov_b32 v27, v26
s_nop 1
v_permlane32_swap_b32 v27, v26
v_max3_f32 v26, v26, v27, s55
v_exp_f32 v24, -v26
v_sub_f32 v64, v64, v26
v_sub_f32 v128, v128, v26
v_sub_f32 v65, v65, v26
v_sub_f32 v129, v129, v26
v_sub_f32 v66, v66, v26
v_sub_f32 v130, v130, v26
v_sub_f32 v67, v67, v26
v_sub_f32 v131, v131, v26
v_sub_f32 v68, v68, v26
v_sub_f32 v132, v132, v26
v_sub_f32 v69, v69, v26
v_sub_f32 v133, v133, v26
v_sub_f32 v70, v70, v26
v_sub_f32 v134, v134, v26
v_sub_f32 v71, v71, v26
v_sub_f32 v135, v135, v26
v_sub_f32 v72, v72, v26
v_sub_f32 v136, v136, v26
v_sub_f32 v73, v73, v26
v_sub_f32 v137, v137, v26
v_sub_f32 v74, v74, v26
v_sub_f32 v138, v138, v26
v_sub_f32 v75, v75, v26
v_sub_f32 v139, v139, v26
v_sub_f32 v76, v76, v26
v_sub_f32 v140, v140, v26
v_sub_f32 v77, v77, v26
v_sub_f32 v141, v141, v26
v_sub_f32 v78, v78, v26
v_sub_f32 v142, v142, v26
v_sub_f32 v79, v79, v26
v_sub_f32 v143, v143, v26
v_min_f32 v24, 1.0, v24
v_mul_f32 v22, v22, v24
v_max3_f32 v26, v80, v81, v82
v_max3_f32 v26, v26, v83, v84
v_max3_f32 v26, v26, v85, v86
v_max3_f32 v26, v26, v87, v88
v_max3_f32 v26, v26, v89, v90
v_max3_f32 v26, v26, v91, v92
v_max3_f32 v26, v26, v93, v94
v_max_f32 v26, v26, v95
v_mov_b32 v27, v26
s_nop 1
v_permlane32_swap_b32 v27, v26
v_max3_f32 v26, v26, v27, s55
v_exp_f32 v25, -v26
v_sub_f32 v80, v80, v26
v_sub_f32 v144, v144, v26
v_sub_f32 v81, v81, v26
v_sub_f32 v145, v145, v26
v_sub_f32 v82, v82, v26
v_sub_f32 v146, v146, v26
v_sub_f32 v83, v83, v26
v_sub_f32 v147, v147, v26
v_sub_f32 v84, v84, v26
v_sub_f32 v148, v148, v26
v_sub_f32 v85, v85, v26
v_sub_f32 v149, v149, v26
v_sub_f32 v86, v86, v26
v_sub_f32 v150, v150, v26
v_sub_f32 v87, v87, v26
v_sub_f32 v151, v151, v26
v_sub_f32 v88, v88, v26
v_sub_f32 v152, v152, v26
v_sub_f32 v89, v89, v26
v_sub_f32 v153, v153, v26
v_sub_f32 v90, v90, v26
v_sub_f32 v154, v154, v26
v_sub_f32 v91, v91, v26
v_sub_f32 v155, v155, v26
v_sub_f32 v92, v92, v26
v_sub_f32 v156, v156, v26
v_sub_f32 v93, v93, v26
v_sub_f32 v157, v157, v26
v_sub_f32 v94, v94, v26
v_sub_f32 v158, v158, v26
v_sub_f32 v95, v95, v26
v_sub_f32 v159, v159, v26
v_min_f32 v25, 1.0, v25
v_mul_f32 v23, v23, v25
s_cmp_eq_u32 s55, 0
s_cselect_b32 s48, 1, 0
s_mov_b32 s55, 0
s_mov_b32 s54, s51
s_branch L_at_uprb
L_at_rsb:
s_getpc_b64 s[52:53]
s_add_u32 s52, s52, 12
s_addc_u32 s53, s53, 0
s_branch L_at_rescale
s_branch L_at_rsrb
L_at_upc:
v_max3_f32 v26, v32, v33, v34
v_max3_f32 v26, v26, v35, v36
v_max3_f32 v26, v26, v37, v38
v_max3_f32 v26, v26, v39, v40
v_max3_f32 v26, v26, v41, v42
v_max3_f32 v26, v26, v43, v44
v_max3_f32 v26, v26, v45, v46
v_max_f32 v26, v26, v47
v_mov_b32 v27, v26
s_nop 1
v_permlane32_swap_b32 v27, v26
v_max3_f32 v26, v26, v27, s55
v_exp_f32 v24, -v26
v_sub_f32 v32, v32, v26
v_sub_f32 v128, v128, v26
v_sub_f32 v33, v33, v26
v_sub_f32 v129, v129, v26
v_sub_f32 v34, v34, v26
v_sub_f32 v130, v130, v26
v_sub_f32 v35, v35, v26
v_sub_f32 v131, v131, v26
v_sub_f32 v36, v36, v26
v_sub_f32 v132, v132, v26
v_sub_f32 v37, v37, v26
v_sub_f32 v133, v133, v26
v_sub_f32 v38, v38, v26
v_sub_f32 v134, v134, v26
v_sub_f32 v39, v39, v26
v_sub_f32 v135, v135, v26
v_sub_f32 v40, v40, v26
v_sub_f32 v136, v136, v26
v_sub_f32 v41, v41, v26
v_sub_f32 v137, v137, v26
v_sub_f32 v42, v42, v26
v_sub_f32 v138, v138, v26
v_sub_f32 v43, v43, v26
v_sub_f32 v139, v139, v26
v_sub_f32 v44, v44, v26
v_sub_f32 v140, v140, v26
v_sub_f32 v45, v45, v26
v_sub_f32 v141, v141, v26
v_sub_f32 v46, v46, v26
v_sub_f32 v142, v142, v26
v_sub_f32 v47, v47, v26
v_sub_f32 v143, v143, v26
v_min_f32 v24, 1.0, v24
v_mul_f32 v22, v22, v24
v_max3_f32 v26, v48, v49, v50
v_max3_f32 v26, v26, v51, v52
v_max3_f32 v26, v26, v53, v54
v_max3_f32 v26, v26, v55, v56
v_max3_f32 v26, v26, v57, v58
v_max3_f32 v26, v26, v59, v60
v_max3_f32 v26, v26, v61, v62
v_max_f32 v26, v26, v63
v_mov_b32 v27, v26
s_nop 1
v_permlane32_swap_b32 v27, v26
v_max3_f32 v26, v26, v27, s55
v_exp_f32 v25, -v26
v_sub_f32 v48, v48, v26
v_sub_f32 v144, v144, v26
v_sub_f32 v49, v49, v26
v_sub_f32 v145, v145, v26
v_sub_f32 v50, v50, v26
v_sub_f32 v146, v146, v26
v_sub_f32 v51, v51, v26
v_sub_f32 v147, v147, v26
v_sub_f32 v52, v52, v26
v_sub_f32 v148, v148, v26
v_sub_f32 v53, v53, v26
v_sub_f32 v149, v149, v26
v_sub_f32 v54, v54, v26
v_sub_f32 v150, v150, v26
v_sub_f32 v55, v55, v26
v_sub_f32 v151, v151, v26
v_sub_f32 v56, v56, v26
v_sub_f32 v152, v152, v26
v_sub_f32 v57, v57, v26
v_sub_f32 v153, v153, v26
v_sub_f32 v58, v58, v26
v_sub_f32 v154, v154, v26
v_sub_f32 v59, v59, v26
v_sub_f32 v155, v155, v26
v_sub_f32 v60, v60, v26
v_sub_f32 v156, v156, v26
v_sub_f32 v61, v61, v26
v_sub_f32 v157, v157, v26
v_sub_f32 v62, v62, v26
v_sub_f32 v158, v158, v26
v_sub_f32 v63, v63, v26
v_sub_f32 v159, v159, v26
v_min_f32 v25, 1.0, v25
v_mul_f32 v23, v23, v25
s_cmp_eq_u32 s55, 0
s_cselect_b32 s48, 1, 0
s_mov_b32 s55, 0
s_mov_b32 s54, s51
s_branch L_at_uprc
L_at_rsc:
s_getpc_b64 s[52:53]
s_add_u32 s52, s52, 12
s_addc_u32 s53, s53, 0
s_branch L_at_rescale
s_branch L_at_rsrc
L_at_upd:
v_max3_f32 v26, v64, v65, v66
v_max3_f32 v26, v26, v67, v68
v_max3_f32 v26, v26, v69, v70
v_max3_f32 v26, v26, v71, v72
v_max3_f32 v26, v26, v73, v74
v_max3_f32 v26, v26, v75, v76
v_max3_f32 v26, v26, v77, v78
v_max_f32 v26, v26, v79
v_mov_b32 v27, v26
s_nop 1
v_permlane32_swap_b32 v27, v26
v_max3_f32 v26, v26, v27, s55
v_exp_f32 v24, -v26
v_sub_f32 v64, v64, v26
v_sub_f32 v128, v128, v26
v_sub_f32 v65, v65, v26
v_sub_f32 v129, v129, v26
v_sub_f32 v66, v66, v26
v_sub_f32 v130, v130, v26
v_sub_f32 v67, v67, v26
v_sub_f32 v131, v131, v26
v_sub_f32 v68, v68, v26
v_sub_f32 v132, v132, v26
v_sub_f32 v69, v69, v26
v_sub_f32 v133, v133, v26
v_sub_f32 v70, v70, v26
v_sub_f32 v134, v134, v26
v_sub_f32 v71, v71, v26
v_sub_f32 v135, v135, v26
v_sub_f32 v72, v72, v26
v_sub_f32 v136, v136, v26
v_sub_f32 v73, v73, v26
v_sub_f32 v137, v137, v26
v_sub_f32 v74, v74, v26
v_sub_f32 v138, v138, v26
v_sub_f32 v75, v75, v26
v_sub_f32 v139, v139, v26
v_sub_f32 v76, v76, v26
v_sub_f32 v140, v140, v26
v_sub_f32 v77, v77, v26
v_sub_f32 v141, v141, v26
v_sub_f32 v78, v78, v26
v_sub_f32 v142, v142, v26
v_sub_f32 v79, v79, v26
v_sub_f32 v143, v143, v26
v_min_f32 v24, 1.0, v24
v_mul_f32 v22, v22, v24
v_max3_f32 v26, v80, v81, v82
v_max3_f32 v26, v26, v83, v84
v_max3_f32 v26, v26, v85, v86
v_max3_f32 v26, v26, v87, v88
v_max3_f32 v26, v26, v89, v90
v_max3_f32 v26, v26, v91, v92
v_max3_f32 v26, v26, v93, v94
v_max_f32 v26, v26, v95
v_mov_b32 v27, v26
s_nop 1
v_permlane32_swap_b32 v27, v26
v_max3_f32 v26, v26, v27, s55
v_exp_f32 v25, -v26
v_sub_f32 v80, v80, v26
v_sub_f32 v144, v144, v26
v_sub_f32 v81, v81, v26
v_sub_f32 v145, v145, v26
v_sub_f32 v82, v82, v26
v_sub_f32 v146, v146, v26
v_sub_f32 v83, v83, v26
v_sub_f32 v147, v147, v26
v_sub_f32 v84, v84, v26
v_sub_f32 v148, v148, v26
v_sub_f32 v85, v85, v26
v_sub_f32 v149, v149, v26
v_sub_f32 v86, v86, v26
v_sub_f32 v150, v150, v26
v_sub_f32 v87, v87, v26
v_sub_f32 v151, v151, v26
v_sub_f32 v88, v88, v26
v_sub_f32 v152, v152, v26
v_sub_f32 v89, v89, v26
v_sub_f32 v153, v153, v26
v_sub_f32 v90, v90, v26
v_sub_f32 v154, v154, v26
v_sub_f32 v91, v91, v26
v_sub_f32 v155, v155, v26
v_sub_f32 v92, v92, v26
v_sub_f32 v156, v156, v26
v_sub_f32 v93, v93, v26
v_sub_f32 v157, v157, v26
v_sub_f32 v94, v94, v26
v_sub_f32 v158, v158, v26
v_sub_f32 v95, v95, v26
v_sub_f32 v159, v159, v26
v_min_f32 v25, 1.0, v25
v_mul_f32 v23, v23, v25
s_cmp_eq_u32 s55, 0
s_cselect_b32 s48, 1, 0
s_mov_b32 s55, 0
s_mov_b32 s54, s51
s_branch L_at_uprd
L_at_rsd:
s_getpc_b64 s[52:53]
s_add_u32 s52, s52, 12
s_addc_u32 s53, s53, 0
s_branch L_at_rescale
s_branch L_at_rsrd
L_at_rescale:
s_nop 7
s_nop 3
v_accvgpr_read_b32 v160, a96
v_accvgpr_read_b32 v161, a97
v_accvgpr_read_b32 v162, a98
v_accvgpr_read_b32 v163, a99
v_accvgpr_read_b32 v164, a100
v_accvgpr_read_b32 v165, a101
v_accvgpr_read_b32 v166, a102
v_accvgpr_read_b32 v167, a103
v_mul_f32 v160, v160, v24
v_mul_f32 v161, v161, v24
v_mul_f32 v162, v162, v24
v_mul_f32 v163, v163, v24
v_mul_f32 v164, v164, v24
v_mul_f32 v165, v165, v24
v_mul_f32 v166, v166, v24
v_mul_f32 v167, v167, v24
v_accvgpr_write_b32 a96, v160
v_accvgpr_write_b32 a97, v161
v_accvgpr_write_b32 a98, v162
v_accvgpr_write_b32 a99, v163
v_accvgpr_write_b32 a100, v164
v_accvgpr_write_b32 a101, v165
v_accvgpr_write_b32 a102, v166
v_accvgpr_write_b32 a103, v167
v_accvgpr_read_b32 v160, a104
v_accvgpr_read_b32 v161, a105
v_accvgpr_read_b32 v162, a106
v_accvgpr_read_b32 v163, a107
v_accvgpr_read_b32 v164, a108
v_accvgpr_read_b32 v165, a109
v_accvgpr_read_b32 v166, a110
v_accvgpr_read_b32 v167, a111
v_mul_f32 v160, v160, v24
v_mul_f32 v161, v161, v24
v_mul_f32 v162, v162, v24
v_mul_f32 v163, v163, v24
v_mul_f32 v164, v164, v24
v_mul_f32 v165, v165, v24
v_mul_f32 v166, v166, v24
v_mul_f32 v167, v167, v24
v_accvgpr_write_b32 a104, v160
v_accvgpr_write_b32 a105, v161
v_accvgpr_write_b32 a106, v162
v_accvgpr_write_b32 a107, v163
v_accvgpr_write_b32 a108, v164
v_accvgpr_write_b32 a109, v165
v_accvgpr_write_b32 a110, v166
v_accvgpr_write_b32 a111, v167
v_accvgpr_read_b32 v160, a112
v_accvgpr_read_b32 v161, a113
v_accvgpr_read_b32 v162, a114
v_accvgpr_read_b32 v163, a115
v_accvgpr_read_b32 v164, a116
v_accvgpr_read_b32 v165, a117
v_accvgpr_read_b32 v166, a118
v_accvgpr_read_b32 v167, a119
v_mul_f32 v160, v160, v25
v_mul_f32 v161, v161, v25
v_mul_f32 v162, v162, v25
v_mul_f32 v163, v163, v25
v_mul_f32 v164, v164, v25
v_mul_f32 v165, v165, v25
v_mul_f32 v166, v166, v25
v_mul_f32 v167, v167, v25
v_accvgpr_write_b32 a112, v160
v_accvgpr_write_b32 a113, v161
v_accvgpr_write_b32 a114, v162
v_accvgpr_write_b32 a115, v163
v_accvgpr_write_b32 a116, v164
v_accvgpr_write_b32 a117, v165
v_accvgpr_write_b32 a118, v166
v_accvgpr_write_b32 a119, v167
v_accvgpr_read_b32 v160, a120
v_accvgpr_read_b32 v161, a121
v_accvgpr_read_b32 v162, a122
v_accvgpr_read_b32 v163, a123
v_accvgpr_read_b32 v164, a124
v_accvgpr_read_b32 v165, a125
v_accvgpr_read_b32 v166, a126
v_accvgpr_read_b32 v167, a127
v_mul_f32 v160, v160, v25
v_mul_f32 v161, v161, v25
v_mul_f32 v162, v162, v25
v_mul_f32 v163, v163, v25
v_mul_f32 v164, v164, v25
v_mul_f32 v165, v165, v25
v_mul_f32 v166, v166, v25
v_mul_f32 v167, v167, v25
v_accvgpr_write_b32 a120, v160
v_accvgpr_write_b32 a121, v161
v_accvgpr_write_b32 a122, v162
v_accvgpr_write_b32 a123, v163
v_accvgpr_write_b32 a124, v164
v_accvgpr_write_b32 a125, v165
v_accvgpr_write_b32 a126, v166
v_accvgpr_write_b32 a127, v167
v_accvgpr_read_b32 v160, a128
v_accvgpr_read_b32 v161, a129
v_accvgpr_read_b32 v162, a130
v_accvgpr_read_b32 v163, a131
v_accvgpr_read_b32 v164, a132
v_accvgpr_read_b32 v165, a133
v_accvgpr_read_b32 v166, a134
v_accvgpr_read_b32 v167, a135
v_mul_f32 v160, v160, v24
v_mul_f32 v161, v161, v24
v_mul_f32 v162, v162, v24
v_mul_f32 v163, v163, v24
v_mul_f32 v164, v164, v24
v_mul_f32 v165, v165, v24
v_mul_f32 v166, v166, v24
v_mul_f32 v167, v167, v24
v_accvgpr_write_b32 a128, v160
v_accvgpr_write_b32 a129, v161
v_accvgpr_write_b32 a130, v162
v_accvgpr_write_b32 a131, v163
v_accvgpr_write_b32 a132, v164
v_accvgpr_write_b32 a133, v165
v_accvgpr_write_b32 a134, v166
v_accvgpr_write_b32 a135, v167
v_accvgpr_read_b32 v160, a136
v_accvgpr_read_b32 v161, a137
v_accvgpr_read_b32 v162, a138
v_accvgpr_read_b32 v163, a139
v_accvgpr_read_b32 v164, a140
v_accvgpr_read_b32 v165, a141
v_accvgpr_read_b32 v166, a142
v_accvgpr_read_b32 v167, a143
v_mul_f32 v160, v160, v24
v_mul_f32 v161, v161, v24
v_mul_f32 v162, v162, v24
v_mul_f32 v163, v163, v24
v_mul_f32 v164, v164, v24
v_mul_f32 v165, v165, v24
v_mul_f32 v166, v166, v24
v_mul_f32 v167, v167, v24
v_accvgpr_write_b32 a136, v160
v_accvgpr_write_b32 a137, v161
v_accvgpr_write_b32 a138, v162
v_accvgpr_write_b32 a139, v163
v_accvgpr_write_b32 a140, v164
v_accvgpr_write_b32 a141, v165
v_accvgpr_write_b32 a142, v166
v_accvgpr_write_b32 a143, v167
v_accvgpr_read_b32 v160, a144
v_accvgpr_read_b32 v161, a145
v_accvgpr_read_b32 v162, a146
v_accvgpr_read_b32 v163, a147
v_accvgpr_read_b32 v164, a148
v_accvgpr_read_b32 v165, a149
v_accvgpr_read_b32 v166, a150
v_accvgpr_read_b32 v167, a151
v_mul_f32 v160, v160, v25
v_mul_f32 v161, v161, v25
v_mul_f32 v162, v162, v25
v_mul_f32 v163, v163, v25
v_mul_f32 v164, v164, v25
v_mul_f32 v165, v165, v25
v_mul_f32 v166, v166, v25
v_mul_f32 v167, v167, v25
v_accvgpr_write_b32 a144, v160
v_accvgpr_write_b32 a145, v161
v_accvgpr_write_b32 a146, v162
v_accvgpr_write_b32 a147, v163
v_accvgpr_write_b32 a148, v164
v_accvgpr_write_b32 a149, v165
v_accvgpr_write_b32 a150, v166
v_accvgpr_write_b32 a151, v167
v_accvgpr_read_b32 v160, a152
v_accvgpr_read_b32 v161, a153
v_accvgpr_read_b32 v162, a154
v_accvgpr_read_b32 v163, a155
v_accvgpr_read_b32 v164, a156
v_accvgpr_read_b32 v165, a157
v_accvgpr_read_b32 v166, a158
v_accvgpr_read_b32 v167, a159
v_mul_f32 v160, v160, v25
v_mul_f32 v161, v161, v25
v_mul_f32 v162, v162, v25
v_mul_f32 v163, v163, v25
v_mul_f32 v164, v164, v25
v_mul_f32 v165, v165, v25
v_mul_f32 v166, v166, v25
v_mul_f32 v167, v167, v25
v_accvgpr_write_b32 a152, v160
v_accvgpr_write_b32 a153, v161
v_accvgpr_write_b32 a154, v162
v_accvgpr_write_b32 a155, v163
v_accvgpr_write_b32 a156, v164
v_accvgpr_write_b32 a157, v165
v_accvgpr_write_b32 a158, v166
v_accvgpr_write_b32 a159, v167
v_accvgpr_read_b32 v160, a160
v_accvgpr_read_b32 v161, a161
v_accvgpr_read_b32 v162, a162
v_accvgpr_read_b32 v163, a163
v_accvgpr_read_b32 v164, a164
v_accvgpr_read_b32 v165, a165
v_accvgpr_read_b32 v166, a166
v_accvgpr_read_b32 v167, a167
v_mul_f32 v160, v160, v24
v_mul_f32 v161, v161, v24
v_mul_f32 v162, v162, v24
v_mul_f32 v163, v163, v24
v_mul_f32 v164, v164, v24
v_mul_f32 v165, v165, v24
v_mul_f32 v166, v166, v24
v_mul_f32 v167, v167, v24
v_accvgpr_write_b32 a160, v160
v_accvgpr_write_b32 a161, v161
v_accvgpr_write_b32 a162, v162
v_accvgpr_write_b32 a163, v163
v_accvgpr_write_b32 a164, v164
v_accvgpr_write_b32 a165, v165
v_accvgpr_write_b32 a166, v166
v_accvgpr_write_b32 a167, v167
v_accvgpr_read_b32 v160, a168
v_accvgpr_read_b32 v161, a169
v_accvgpr_read_b32 v162, a170
v_accvgpr_read_b32 v163, a171
v_accvgpr_read_b32 v164, a172
v_accvgpr_read_b32 v165, a173
v_accvgpr_read_b32 v166, a174
v_accvgpr_read_b32 v167, a175
v_mul_f32 v160, v160, v24
v_mul_f32 v161, v161, v24
v_mul_f32 v162, v162, v24
v_mul_f32 v163, v163, v24
v_mul_f32 v164, v164, v24
v_mul_f32 v165, v165, v24
v_mul_f32 v166, v166, v24
v_mul_f32 v167, v167, v24
v_accvgpr_write_b32 a168, v160
v_accvgpr_write_b32 a169, v161
v_accvgpr_write_b32 a170, v162
v_accvgpr_write_b32 a171, v163
v_accvgpr_write_b32 a172, v164
v_accvgpr_write_b32 a173, v165
v_accvgpr_write_b32 a174, v166
v_accvgpr_write_b32 a175, v167
v_accvgpr_read_b32 v160, a176
v_accvgpr_read_b32 v161, a177
v_accvgpr_read_b32 v162, a178
v_accvgpr_read_b32 v163, a179
v_accvgpr_read_b32 v164, a180
v_accvgpr_read_b32 v165, a181
v_accvgpr_read_b32 v166, a182
v_accvgpr_read_b32 v167, a183
v_mul_f32 v160, v160, v25
v_mul_f32 v161, v161, v25
v_mul_f32 v162, v162, v25
v_mul_f32 v163, v163, v25
v_mul_f32 v164, v164, v25
v_mul_f32 v165, v165, v25
v_mul_f32 v166, v166, v25
v_mul_f32 v167, v167, v25
v_accvgpr_write_b32 a176, v160
v_accvgpr_write_b32 a177, v161
v_accvgpr_write_b32 a178, v162
v_accvgpr_write_b32 a179, v163
v_accvgpr_write_b32 a180, v164
v_accvgpr_write_b32 a181, v165
v_accvgpr_write_b32 a182, v166
v_accvgpr_write_b32 a183, v167
v_accvgpr_read_b32 v160, a184
v_accvgpr_read_b32 v161, a185
v_accvgpr_read_b32 v162, a186
v_accvgpr_read_b32 v163, a187
v_accvgpr_read_b32 v164, a188
v_accvgpr_read_b32 v165, a189
v_accvgpr_read_b32 v166, a190
v_accvgpr_read_b32 v167, a191
v_mul_f32 v160, v160, v25
v_mul_f32 v161, v161, v25
v_mul_f32 v162, v162, v25
v_mul_f32 v163, v163, v25
v_mul_f32 v164, v164, v25
v_mul_f32 v165, v165, v25
v_mul_f32 v166, v166, v25
v_mul_f32 v167, v167, v25
v_accvgpr_write_b32 a184, v160
v_accvgpr_write_b32 a185, v161
v_accvgpr_write_b32 a186, v162
v_accvgpr_write_b32 a187, v163
v_accvgpr_write_b32 a188, v164
v_accvgpr_write_b32 a189, v165
v_accvgpr_write_b32 a190, v166
v_accvgpr_write_b32 a191, v167
v_accvgpr_read_b32 v160, a192
v_accvgpr_read_b32 v161, a193
v_accvgpr_read_b32 v162, a194
v_accvgpr_read_b32 v163, a195
v_accvgpr_read_b32 v164, a196
v_accvgpr_read_b32 v165, a197
v_accvgpr_read_b32 v166, a198
v_accvgpr_read_b32 v167, a199
v_mul_f32 v160, v160, v24
v_mul_f32 v161, v161, v24
v_mul_f32 v162, v162, v24
v_mul_f32 v163, v163, v24
v_mul_f32 v164, v164, v24
v_mul_f32 v165, v165, v24
v_mul_f32 v166, v166, v24
v_mul_f32 v167, v167, v24
v_accvgpr_write_b32 a192, v160
v_accvgpr_write_b32 a193, v161
v_accvgpr_write_b32 a194, v162
v_accvgpr_write_b32 a195, v163
v_accvgpr_write_b32 a196, v164
v_accvgpr_write_b32 a197, v165
v_accvgpr_write_b32 a198, v166
v_accvgpr_write_b32 a199, v167
v_accvgpr_read_b32 v160, a200
v_accvgpr_read_b32 v161, a201
v_accvgpr_read_b32 v162, a202
v_accvgpr_read_b32 v163, a203
v_accvgpr_read_b32 v164, a204
v_accvgpr_read_b32 v165, a205
v_accvgpr_read_b32 v166, a206
v_accvgpr_read_b32 v167, a207
v_mul_f32 v160, v160, v24
v_mul_f32 v161, v161, v24
v_mul_f32 v162, v162, v24
v_mul_f32 v163, v163, v24
v_mul_f32 v164, v164, v24
v_mul_f32 v165, v165, v24
v_mul_f32 v166, v166, v24
v_mul_f32 v167, v167, v24
v_accvgpr_write_b32 a200, v160
v_accvgpr_write_b32 a201, v161
v_accvgpr_write_b32 a202, v162
v_accvgpr_write_b32 a203, v163
v_accvgpr_write_b32 a204, v164
v_accvgpr_write_b32 a205, v165
v_accvgpr_write_b32 a206, v166
v_accvgpr_write_b32 a207, v167
v_accvgpr_read_b32 v160, a208
v_accvgpr_read_b32 v161, a209
v_accvgpr_read_b32 v162, a210
v_accvgpr_read_b32 v163, a211
v_accvgpr_read_b32 v164, a212
v_accvgpr_read_b32 v165, a213
v_accvgpr_read_b32 v166, a214
v_accvgpr_read_b32 v167, a215
v_mul_f32 v160, v160, v25
v_mul_f32 v161, v161, v25
v_mul_f32 v162, v162, v25
v_mul_f32 v163, v163, v25
v_mul_f32 v164, v164, v25
v_mul_f32 v165, v165, v25
v_mul_f32 v166, v166, v25
v_mul_f32 v167, v167, v25
v_accvgpr_write_b32 a208, v160
v_accvgpr_write_b32 a209, v161
v_accvgpr_write_b32 a210, v162
v_accvgpr_write_b32 a211, v163
v_accvgpr_write_b32 a212, v164
v_accvgpr_write_b32 a213, v165
v_accvgpr_write_b32 a214, v166
v_accvgpr_write_b32 a215, v167
v_accvgpr_read_b32 v160, a216
v_accvgpr_read_b32 v161, a217
v_accvgpr_read_b32 v162, a218
v_accvgpr_read_b32 v163, a219
v_accvgpr_read_b32 v164, a220
v_accvgpr_read_b32 v165, a221
v_accvgpr_read_b32 v166, a222
v_accvgpr_read_b32 v167, a223
v_mul_f32 v160, v160, v25
v_mul_f32 v161, v161, v25
v_mul_f32 v162, v162, v25
v_mul_f32 v163, v163, v25
v_mul_f32 v164, v164, v25
v_mul_f32 v165, v165, v25
v_mul_f32 v166, v166, v25
v_mul_f32 v167, v167, v25
v_accvgpr_write_b32 a216, v160
v_accvgpr_write_b32 a217, v161
v_accvgpr_write_b32 a218, v162
v_accvgpr_write_b32 a219, v163
v_accvgpr_write_b32 a220, v164
v_accvgpr_write_b32 a221, v165
v_accvgpr_write_b32 a222, v166
v_accvgpr_write_b32 a223, v167
s_mov_b32 s48, 0
s_nop 1
s_setpc_b64 s[52:53]
L_at_fin:
v_accvgpr_read_b32 v128, a96
v_accvgpr_read_b32 v129, a97
v_accvgpr_read_b32 v130, a98
v_accvgpr_read_b32 v131, a99
v_accvgpr_read_b32 v132, a100
v_accvgpr_read_b32 v133, a101
v_accvgpr_read_b32 v134, a102
v_accvgpr_read_b32 v135, a103
v_accvgpr_read_b32 v136, a104
v_accvgpr_read_b32 v137, a105
v_accvgpr_read_b32 v138, a106
v_accvgpr_read_b32 v139, a107
v_accvgpr_read_b32 v140, a108
v_accvgpr_read_b32 v141, a109
v_accvgpr_read_b32 v142, a110
v_accvgpr_read_b32 v143, a111
v_accvgpr_read_b32 v144, a112
v_accvgpr_read_b32 v145, a113
v_accvgpr_read_b32 v146, a114
v_accvgpr_read_b32 v147, a115
v_accvgpr_read_b32 v148, a116
v_accvgpr_read_b32 v149, a117
v_accvgpr_read_b32 v150, a118
v_accvgpr_read_b32 v151, a119
v_accvgpr_read_b32 v152, a120
v_accvgpr_read_b32 v153, a121
v_accvgpr_read_b32 v154, a122
v_accvgpr_read_b32 v155, a123
v_accvgpr_read_b32 v156, a124
v_accvgpr_read_b32 v157, a125
v_accvgpr_read_b32 v158, a126
v_accvgpr_read_b32 v159, a127
v_accvgpr_read_b32 v160, a128
v_accvgpr_read_b32 v161, a129
v_accvgpr_read_b32 v162, a130
v_accvgpr_read_b32 v163, a131
v_accvgpr_read_b32 v164, a132
v_accvgpr_read_b32 v165, a133
v_accvgpr_read_b32 v166, a134
v_accvgpr_read_b32 v167, a135
v_accvgpr_read_b32 v168, a136
v_accvgpr_read_b32 v169, a137
v_accvgpr_read_b32 v170, a138
v_accvgpr_read_b32 v171, a139
v_accvgpr_read_b32 v172, a140
v_accvgpr_read_b32 v173, a141
v_accvgpr_read_b32 v174, a142
v_accvgpr_read_b32 v175, a143
v_accvgpr_read_b32 v176, a144
v_accvgpr_read_b32 v177, a145
v_accvgpr_read_b32 v178, a146
v_accvgpr_read_b32 v179, a147
v_accvgpr_read_b32 v180, a148
v_accvgpr_read_b32 v181, a149
v_accvgpr_read_b32 v182, a150
v_accvgpr_read_b32 v183, a151
v_accvgpr_read_b32 v184, a152
v_accvgpr_read_b32 v185, a153
v_accvgpr_read_b32 v186, a154
v_accvgpr_read_b32 v187, a155
v_accvgpr_read_b32 v188, a156
v_accvgpr_read_b32 v189, a157
v_accvgpr_read_b32 v190, a158
v_accvgpr_read_b32 v191, a159
v_accvgpr_read_b32 v192, a160
v_accvgpr_read_b32 v193, a161
v_accvgpr_read_b32 v194, a162
v_accvgpr_read_b32 v195, a163
v_accvgpr_read_b32 v196, a164
v_accvgpr_read_b32 v197, a165
v_accvgpr_read_b32 v198, a166
v_accvgpr_read_b32 v199, a167
v_accvgpr_read_b32 v200, a168
v_accvgpr_read_b32 v201, a169
v_accvgpr_read_b32 v202, a170
v_accvgpr_read_b32 v203, a171
v_accvgpr_read_b32 v204, a172
v_accvgpr_read_b32 v205, a173
v_accvgpr_read_b32 v206, a174
v_accvgpr_read_b32 v207, a175
v_accvgpr_read_b32 v208, a176
v_accvgpr_read_b32 v209, a177
v_accvgpr_read_b32 v210, a178
v_accvgpr_read_b32 v211, a179
v_accvgpr_read_b32 v212, a180
v_accvgpr_read_b32 v213, a181
v_accvgpr_read_b32 v214, a182
v_accvgpr_read_b32 v215, a183
v_accvgpr_read_b32 v216, a184
v_accvgpr_read_b32 v217, a185
v_accvgpr_read_b32 v218, a186
v_accvgpr_read_b32 v219, a187
v_accvgpr_read_b32 v220, a188
v_accvgpr_read_b32 v221, a189
v_accvgpr_read_b32 v222, a190
v_accvgpr_read_b32 v223, a191
v_accvgpr_read_b32 v224, a192
v_accvgpr_read_b32 v225, a193
v_accvgpr_read_b32 v226, a194
v_accvgpr_read_b32 v227, a195
v_accvgpr_read_b32 v228, a196
v_accvgpr_read_b32 v229, a197
v_accvgpr_read_b32 v230, a198
v_accvgpr_read_b32 v231, a199
v_accvgpr_read_b32 v232, a200
v_accvgpr_read_b32 v233, a201
v_accvgpr_read_b32 v234, a202
v_accvgpr_read_b32 v235, a203
v_accvgpr_read_b32 v236, a204
v_accvgpr_read_b32 v237, a205
v_accvgpr_read_b32 v238, a206
v_accvgpr_read_b32 v239, a207
v_accvgpr_read_b32 v240, a208
v_accvgpr_read_b32 v241, a209
v_accvgpr_read_b32 v242, a210
v_accvgpr_read_b32 v243, a211
v_accvgpr_read_b32 v244, a212
v_accvgpr_read_b32 v245, a213
v_accvgpr_read_b32 v246, a214
v_accvgpr_read_b32 v247, a215
v_accvgpr_read_b32 v248, a216
v_accvgpr_read_b32 v249, a217
v_accvgpr_read_b32 v250, a218
v_accvgpr_read_b32 v251, a219
v_accvgpr_read_b32 v252, a220
v_accvgpr_read_b32 v253, a221
v_accvgpr_read_b32 v254, a222
v_accvgpr_read_b32 v255, a223
v_mov_b32 v26, v22
s_nop 1
v_permlane32_swap_b32 v26, v22
v_add_f32 v26, v26, v22
v_rcp_f32 v26, v26
s_nop 0
v_pk_mul_f32 v[128:129], v[128:129], v[26:27] op_sel_hi:[1,0]
v_pk_mul_f32 v[130:131], v[130:131], v[26:27] op_sel_hi:[1,0]
v_pk_mul_f32 v[132:133], v[132:133], v[26:27] op_sel_hi:[1,0]
v_pk_mul_f32 v[134:135], v[134:135], v[26:27] op_sel_hi:[1,0]
v_pk_mul_f32 v[136:137], v[136:137], v[26:27] op_sel_hi:[1,0]
v_pk_mul_f32 v[138:139], v[138:139], v[26:27] op_sel_hi:[1,0]
v_pk_mul_f32 v[140:141], v[140:141], v[26:27] op_sel_hi:[1,0]
v_pk_mul_f32 v[142:143], v[142:143], v[26:27] op_sel_hi:[1,0]
v_cvt_pk_bf16_f32 v128, v128, v129
v_cvt_pk_bf16_f32 v129, v130, v131
v_cvt_pk_bf16_f32 v130, v132, v133
v_cvt_pk_bf16_f32 v131, v134, v135
buffer_store_dwordx4 v[128:131], v6, s[8:11], s26 offen offset:0 sc1
v_cvt_pk_bf16_f32 v136, v136, v137
v_cvt_pk_bf16_f32 v137, v138, v139
v_cvt_pk_bf16_f32 v138, v140, v141
v_cvt_pk_bf16_f32 v139, v142, v143
buffer_store_dwordx4 v[136:139], v6, s[8:11], s26 offen offset:512 sc1
v_pk_mul_f32 v[160:161], v[160:161], v[26:27] op_sel_hi:[1,0]
v_pk_mul_f32 v[162:163], v[162:163], v[26:27] op_sel_hi:[1,0]
v_pk_mul_f32 v[164:165], v[164:165], v[26:27] op_sel_hi:[1,0]
v_pk_mul_f32 v[166:167], v[166:167], v[26:27] op_sel_hi:[1,0]
v_pk_mul_f32 v[168:169], v[168:169], v[26:27] op_sel_hi:[1,0]
v_pk_mul_f32 v[170:171], v[170:171], v[26:27] op_sel_hi:[1,0]
v_pk_mul_f32 v[172:173], v[172:173], v[26:27] op_sel_hi:[1,0]
v_pk_mul_f32 v[174:175], v[174:175], v[26:27] op_sel_hi:[1,0]
v_cvt_pk_bf16_f32 v160, v160, v161
v_cvt_pk_bf16_f32 v161, v162, v163
v_cvt_pk_bf16_f32 v162, v164, v165
v_cvt_pk_bf16_f32 v163, v166, v167
buffer_store_dwordx4 v[160:163], v6, s[8:11], s26 offen offset:1024 sc1
v_cvt_pk_bf16_f32 v168, v168, v169
v_cvt_pk_bf16_f32 v169, v170, v171
v_cvt_pk_bf16_f32 v170, v172, v173
v_cvt_pk_bf16_f32 v171, v174, v175
buffer_store_dwordx4 v[168:171], v6, s[8:11], s26 offen offset:1536 sc1
v_pk_mul_f32 v[192:193], v[192:193], v[26:27] op_sel_hi:[1,0]
v_pk_mul_f32 v[194:195], v[194:195], v[26:27] op_sel_hi:[1,0]
v_pk_mul_f32 v[196:197], v[196:197], v[26:27] op_sel_hi:[1,0]
v_pk_mul_f32 v[198:199], v[198:199], v[26:27] op_sel_hi:[1,0]
v_pk_mul_f32 v[200:201], v[200:201], v[26:27] op_sel_hi:[1,0]
v_pk_mul_f32 v[202:203], v[202:203], v[26:27] op_sel_hi:[1,0]
v_pk_mul_f32 v[204:205], v[204:205], v[26:27] op_sel_hi:[1,0]
v_pk_mul_f32 v[206:207], v[206:207], v[26:27] op_sel_hi:[1,0]
v_cvt_pk_bf16_f32 v192, v192, v193
v_cvt_pk_bf16_f32 v193, v194, v195
v_cvt_pk_bf16_f32 v194, v196, v197
v_cvt_pk_bf16_f32 v195, v198, v199
buffer_store_dwordx4 v[192:195], v6, s[8:11], s26 offen offset:2048 sc1
v_cvt_pk_bf16_f32 v200, v200, v201
v_cvt_pk_bf16_f32 v201, v202, v203
v_cvt_pk_bf16_f32 v202, v204, v205
v_cvt_pk_bf16_f32 v203, v206, v207
buffer_store_dwordx4 v[200:203], v6, s[8:11], s26 offen offset:2560 sc1
v_pk_mul_f32 v[224:225], v[224:225], v[26:27] op_sel_hi:[1,0]
v_pk_mul_f32 v[226:227], v[226:227], v[26:27] op_sel_hi:[1,0]
v_pk_mul_f32 v[228:229], v[228:229], v[26:27] op_sel_hi:[1,0]
v_pk_mul_f32 v[230:231], v[230:231], v[26:27] op_sel_hi:[1,0]
v_pk_mul_f32 v[232:233], v[232:233], v[26:27] op_sel_hi:[1,0]
v_pk_mul_f32 v[234:235], v[234:235], v[26:27] op_sel_hi:[1,0]
v_pk_mul_f32 v[236:237], v[236:237], v[26:27] op_sel_hi:[1,0]
v_pk_mul_f32 v[238:239], v[238:239], v[26:27] op_sel_hi:[1,0]
v_cvt_pk_bf16_f32 v224, v224, v225
v_cvt_pk_bf16_f32 v225, v226, v227
v_cvt_pk_bf16_f32 v226, v228, v229
v_cvt_pk_bf16_f32 v227, v230, v231
buffer_store_dwordx4 v[224:227], v6, s[8:11], s26 offen offset:3072 sc1
v_cvt_pk_bf16_f32 v232, v232, v233
v_cvt_pk_bf16_f32 v233, v234, v235
v_cvt_pk_bf16_f32 v234, v236, v237
v_cvt_pk_bf16_f32 v235, v238, v239
buffer_store_dwordx4 v[232:235], v6, s[8:11], s26 offen offset:3584 sc1
v_mov_b32 v26, v23
s_nop 1
v_permlane32_swap_b32 v26, v23
v_add_f32 v26, v26, v23
v_rcp_f32 v26, v26
s_nop 0
v_pk_mul_f32 v[144:145], v[144:145], v[26:27] op_sel_hi:[1,0]
v_pk_mul_f32 v[146:147], v[146:147], v[26:27] op_sel_hi:[1,0]
v_pk_mul_f32 v[148:149], v[148:149], v[26:27] op_sel_hi:[1,0]
v_pk_mul_f32 v[150:151], v[150:151], v[26:27] op_sel_hi:[1,0]
v_pk_mul_f32 v[152:153], v[152:153], v[26:27] op_sel_hi:[1,0]
v_pk_mul_f32 v[154:155], v[154:155], v[26:27] op_sel_hi:[1,0]
v_pk_mul_f32 v[156:157], v[156:157], v[26:27] op_sel_hi:[1,0]
v_pk_mul_f32 v[158:159], v[158:159], v[26:27] op_sel_hi:[1,0]
v_cvt_pk_bf16_f32 v144, v144, v145
v_cvt_pk_bf16_f32 v145, v146, v147
v_cvt_pk_bf16_f32 v146, v148, v149
v_cvt_pk_bf16_f32 v147, v150, v151
buffer_store_dwordx4 v[144:147], v6, s[8:11], s27 offen offset:0 sc1
v_cvt_pk_bf16_f32 v152, v152, v153
v_cvt_pk_bf16_f32 v153, v154, v155
v_cvt_pk_bf16_f32 v154, v156, v157
v_cvt_pk_bf16_f32 v155, v158, v159
buffer_store_dwordx4 v[152:155], v6, s[8:11], s27 offen offset:512 sc1
v_pk_mul_f32 v[176:177], v[176:177], v[26:27] op_sel_hi:[1,0]
v_pk_mul_f32 v[178:179], v[178:179], v[26:27] op_sel_hi:[1,0]
v_pk_mul_f32 v[180:181], v[180:181], v[26:27] op_sel_hi:[1,0]
v_pk_mul_f32 v[182:183], v[182:183], v[26:27] op_sel_hi:[1,0]
v_pk_mul_f32 v[184:185], v[184:185], v[26:27] op_sel_hi:[1,0]
v_pk_mul_f32 v[186:187], v[186:187], v[26:27] op_sel_hi:[1,0]
v_pk_mul_f32 v[188:189], v[188:189], v[26:27] op_sel_hi:[1,0]
v_pk_mul_f32 v[190:191], v[190:191], v[26:27] op_sel_hi:[1,0]
v_cvt_pk_bf16_f32 v176, v176, v177
v_cvt_pk_bf16_f32 v177, v178, v179
v_cvt_pk_bf16_f32 v178, v180, v181
v_cvt_pk_bf16_f32 v179, v182, v183
buffer_store_dwordx4 v[176:179], v6, s[8:11], s27 offen offset:1024 sc1
v_cvt_pk_bf16_f32 v184, v184, v185
v_cvt_pk_bf16_f32 v185, v186, v187
v_cvt_pk_bf16_f32 v186, v188, v189
v_cvt_pk_bf16_f32 v187, v190, v191
buffer_store_dwordx4 v[184:187], v6, s[8:11], s27 offen offset:1536 sc1
v_pk_mul_f32 v[208:209], v[208:209], v[26:27] op_sel_hi:[1,0]
v_pk_mul_f32 v[210:211], v[210:211], v[26:27] op_sel_hi:[1,0]
v_pk_mul_f32 v[212:213], v[212:213], v[26:27] op_sel_hi:[1,0]
v_pk_mul_f32 v[214:215], v[214:215], v[26:27] op_sel_hi:[1,0]
v_pk_mul_f32 v[216:217], v[216:217], v[26:27] op_sel_hi:[1,0]
v_pk_mul_f32 v[218:219], v[218:219], v[26:27] op_sel_hi:[1,0]
v_pk_mul_f32 v[220:221], v[220:221], v[26:27] op_sel_hi:[1,0]
v_pk_mul_f32 v[222:223], v[222:223], v[26:27] op_sel_hi:[1,0]
v_cvt_pk_bf16_f32 v208, v208, v209
v_cvt_pk_bf16_f32 v209, v210, v211
v_cvt_pk_bf16_f32 v210, v212, v213
v_cvt_pk_bf16_f32 v211, v214, v215
buffer_store_dwordx4 v[208:211], v6, s[8:11], s27 offen offset:2048 sc1
v_cvt_pk_bf16_f32 v216, v216, v217
v_cvt_pk_bf16_f32 v217, v218, v219
v_cvt_pk_bf16_f32 v218, v220, v221
v_cvt_pk_bf16_f32 v219, v222, v223
buffer_store_dwordx4 v[216:219], v6, s[8:11], s27 offen offset:2560 sc1
v_pk_mul_f32 v[240:241], v[240:241], v[26:27] op_sel_hi:[1,0]
v_pk_mul_f32 v[242:243], v[242:243], v[26:27] op_sel_hi:[1,0]
v_pk_mul_f32 v[244:245], v[244:245], v[26:27] op_sel_hi:[1,0]
v_pk_mul_f32 v[246:247], v[246:247], v[26:27] op_sel_hi:[1,0]
v_pk_mul_f32 v[248:249], v[248:249], v[26:27] op_sel_hi:[1,0]
v_pk_mul_f32 v[250:251], v[250:251], v[26:27] op_sel_hi:[1,0]
v_pk_mul_f32 v[252:253], v[252:253], v[26:27] op_sel_hi:[1,0]
v_pk_mul_f32 v[254:255], v[254:255], v[26:27] op_sel_hi:[1,0]
v_cvt_pk_bf16_f32 v240, v240, v241
v_cvt_pk_bf16_f32 v241, v242, v243
v_cvt_pk_bf16_f32 v242, v244, v245
v_cvt_pk_bf16_f32 v243, v246, v247
buffer_store_dwordx4 v[240:243], v6, s[8:11], s27 offen offset:3072 sc1
v_cvt_pk_bf16_f32 v248, v248, v249
v_cvt_pk_bf16_f32 v249, v250, v251
v_cvt_pk_bf16_f32 v250, v252, v253
v_cvt_pk_bf16_f32 v251, v254, v255
buffer_store_dwordx4 v[248:251], v6, s[8:11], s27 offen offset:3584 sc1
s_lshl_b32 s61, s41, 5
s_add_u32 s61, s61, s42
s_lshl_b32 s61, s61, 2
s_add_u32 s61, s61, 111169536
s_waitcnt vmcnt(0)
s_barrier
s_cmp_lg_u32 s17, 0
s_cbranch_scc1 L_sf_12
v_mov_b32 v20, 0
v_mov_b32 v21, 1
s_mov_b64 exec, 1
buffer_store_dword v21, v20, s[8:11], s61 offen sc1
s_mov_b64 exec, -1
L_sf_12:
s_mov_b32 s41, s62
s_add_u32 s60, s60, 1
s_cmp_lt_u32 s60, 2
s_cbranch_scc1 L_aat
s_cmp_ge_u32 s16, 27
s_cbranch_scc1 L_done
s_load_dwordx2 s[4:5], s[0:1], 40
s_waitcnt lgkmcnt(0)
s_mov_b32 s20, s4
s_and_b32 s21, s5, 0xffff
s_mov_b32 s22, 4718592
s_mov_b32 s23, 0x20000
s_mul_i32 s24, s16, 57
s_lshr_b32 s24, s24, 9
s_mul_i32 s25, s24, 9
s_sub_u32 s40, s16, s25
s_sub_u32 s25, s3, 4
s_mul_i32 s25, s25, 3
s_add_u32 s25, s25, s24
s_and_b32 s51, s25, 1
s_add_u32 s51, s51, 64
s_lshr_b32 s25, s25, 1
s_cmp_eq_u32 s25, 0
s_cselect_b32 s42, 0x10411249, s42
s_cselect_b32 s43, 0x4104104, s43
s_cmp_eq_u32 s25, 1
s_cselect_b32 s42, 0x20822492, s42
s_cselect_b32 s43, 0x8208208, s43
s_cmp_eq_u32 s25, 2
s_cselect_b32 s42, 0x41044924, s42
s_cselect_b32 s43, 0x10410410, s43
s_cmp_eq_u32 s25, 3
s_cselect_b32 s42, 0x82088000, s42
s_cselect_b32 s43, 0x20820820, s43
s_cmp_eq_u32 s25, 4
s_cselect_b32 s42, 0x4100000, s42
s_cselect_b32 s43, 0x41041041, s43
s_cmp_eq_u32 s25, 5
s_cselect_b32 s42, 0x8200000, s42
s_cselect_b32 s43, 0x82082082, s43
s_mov_b32 s44, 67108864
s_mov_b32 s45, 111169536
s_mov_b32 s46, 4
s_mov_b32 s47, 0
s_branch L_op
L_bdie:
s_and_b32 s27, s3, 1
s_lshr_b32 s26, s16, 2
s_lshl_b32 s26, s26, 1
s_and_b32 s24, s16, 1
s_add_u32 s26, s26, s24
s_mov_b32 s4, 0x55ff0000
s_mov_b32 s5, 0x55555555
s_bitcmp1_b32 s16, 1
s_cbranch_scc1 L_crew
s_mov_b32 s4, 0xaa000000
s_mov_b32 s5, 0xaaaaaaaa
s_branch L_crew
L_part:
s_and_b32 s27, s16, 1
s_lshr_b32 s26, s16, 1
s_mov_b32 s4, 0xffff
s_mov_b32 s5, 0x0
L_crew:
s_cmp_eq_u64 s[4:5], 0
s_cbranch_scc1 L_done
s_cmp_lt_u32 s26, 9
s_cbranch_scc1 L_bo
s_mov_b64 s[52:53], s[4:5]
s_sub_u32 s41, s26, 9
s_lshl_b32 s41, s41, 1
s_add_u32 s41, s41, s27
s_mul_i32 s24, s17, 14
s_add_u32 s41, s41, s24
s_mov_b32 s40, 0x3e0293ee
s_mov_b32 s50, 0xf149f2ca
s_mov_b32 s51, 0x41a00000
v_and_b32 v5, 31, v0
v_bfe_u32 v26, v0, 5, 1
v_lshlrev_b32 v27, 2, v26
v_sub_u32 v5, v5, v27
v_bfe_u32 v27, v0, 4, 1
v_lshlrev_b32 v6, 17, v27
v_lshl_add_u32 v6, v26, 8, v6
v_and_b32 v27, 15, v0
v_lshl_add_u32 v6, v27, 4, v6
v_and_b32 v1, 63, v0
v_min_u32 v17, 47, v1
v_lshlrev_b32 v1, 4, v1
v_bfe_u32 v26, v0, 5, 1
v_and_b32 v27, 7, v0
v_xor_b32 v27, v27, v26
v_lshlrev_b32 v27, 4, v27
v_lshl_add_u32 v2, v26, 7, v27
v_xor_b32 v7, 64, v2
v_and_b32 v27, 31, v0
v_lshlrev_b32 v27, 2, v27
v_lshl_add_u32 v3, v26, 8, v27
v_mov_b32 v4, 0
v_lshlrev_b32 v17, 7, v17
v_mul_u32_u24 v26, 24576, v26
v_add_u32 v17, v17, v26
v_add_u32 v17, 111149056, v17
v_bfe_u32 v26, v0, 1, 4
v_and_b32 v27, 1, v0
v_lshl_add_u32 v26, v27, 4, v26
v_and_or_b32 v26, v0, 32, v26
v_lshlrev_b32 v16, 4, v26
v_mov_b32 v31, s50
s_mov_b32 s49, 0
s_mov_b32 s45, -1
v_cmp_le_i32 s[64:65], 0, v5
v_cmp_le_i32 s[66:67], 1, v5
v_cmp_le_i32 s[68:69], 2, v5
v_cmp_le_i32 s[70:71], 3, v5
v_cmp_le_i32 s[72:73], 8, v5
v_cmp_le_i32 s[74:75], 9, v5
v_cmp_le_i32 s[76:77], 10, v5
v_cmp_le_i32 s[78:79], 11, v5
v_cmp_le_i32 s[80:81], 16, v5
v_cmp_le_i32 s[82:83], 17, v5
v_cmp_le_i32 s[84:85], 18, v5
v_cmp_le_i32 s[86:87], 19, v5
v_cmp_le_i32 s[88:89], 24, v5
v_cmp_le_i32 s[90:91], 25, v5
v_cmp_le_i32 s[92:93], 26, v5
v_cmp_le_i32 s[94:95], 27, v5
L_nb_14:
s_ff1_i32_b64 s47, s[52:53]
s_cmp_lt_u32 s41, 32
s_cbranch_scc1 L_nb_15
s_bitset0_b64 s[52:53], s47
s_sub_u32 s41, s41, 32
s_branch L_nb_14
L_nb_15:
s_lshl_b32 s47, s47, 5
s_add_u32 s47, s47, s41
s_add_u32 s41, s41, 56
s_and_b32 s24, s47, 31
s_lshr_b32 s25, s47, 5
s_lshl_b32 s46, s24, 6
s_add_u32 s46, s46, s25
s_lshl_b32 s46, s46, 14
s_add_u32 s46, s46, 33554432
s_lshr_b32 s44, s24, 1
s_lshl_b32 s44, s44, 6
s_add_u32 s44, s44, s25
s_lshl_b32 s44, s44, 1
s_and_b32 s24, s24, 1
s_add_u32 s44, s44, s24
s_lshl_b32 s44, s44, 13
s_add_u32 s44, s44, 134217728
s_cmp_ge_u32 s47, 2048
s_cselect_b32 s44, 536870912, s44
s_cselect_b32 s46, 536870912, s46
s_cbranch_scc1 L_nb_13
s_lshr_b32 s25, s47, 8
s_lshl_b32 s25, s25, 2
s_cmp_eq_u32 s25, s45
s_cbranch_scc1 L_nb_13
s_mov_b32 s45, s25
s_mov_b32 s28, 0
L_poll_16:
buffer_load_dword v26, v17, s[8:11], s45 offen sc1
s_add_u32 s28, s28, 1
s_cmp_gt_u32 s28, 40000
s_cbranch_scc1 L_end
s_waitcnt vmcnt(0)
v_cmp_ne_u32 vcc, 1, v26
s_cbranch_vccz L_pd_17
s_sleep 8
s_branch L_poll_16
L_pd_17:
L_nb_13:
s_cmp_ge_u32 s47, 2048
s_cbranch_scc1 L_bt_x
s_add_u32 s25, s44, 0
buffer_load_dwordx4 a[0:3], v1, s[8:11], s25 offen offset:0 sc1
buffer_load_dwordx4 a[4:7], v1, s[8:11], s25 offen offset:1024 sc1
buffer_load_dwordx4 a[8:11], v1, s[8:11], s25 offen offset:2048 sc1
buffer_load_dwordx4 a[12:15], v1, s[8:11], s25 offen offset:3072 sc1
s_add_u32 s25, s44, 4096
buffer_load_dwordx4 a[16:19], v1, s[8:11], s25 offen offset:0 sc1
buffer_load_dwordx4 a[20:23], v1, s[8:11], s25 offen offset:1024 sc1
buffer_load_dwordx4 a[24:27], v1, s[8:11], s25 offen offset:2048 sc1
buffer_load_dwordx4 a[28:31], v1, s[8:11], s25 offen offset:3072 sc1
s_add_u32 s25, s46, 0
buffer_load_dwordx4 a[32:35], v1, s[8:11], s25 offen offset:0 sc1
buffer_load_dwordx4 a[36:39], v1, s[8:11], s25 offen offset:1024 sc1
buffer_load_dwordx4 a[40:43], v1, s[8:11], s25 offen offset:2048 sc1
buffer_load_dwordx4 a[44:47], v1, s[8:11], s25 offen offset:3072 sc1
s_add_u32 s25, s46, 4096
buffer_load_dwordx4 a[48:51], v1, s[8:11], s25 offen offset:0 sc1
buffer_load_dwordx4 a[52:55], v1, s[8:11], s25 offen offset:1024 sc1
buffer_load_dwordx4 a[56:59], v1, s[8:11], s25 offen offset:2048 sc1
buffer_load_dwordx4 a[60:63], v1, s[8:11], s25 offen offset:3072 sc1
s_add_u32 s25, s46, 8192
buffer_load_dwordx4 a[64:67], v16, s[8:11], s25 offen offset:0 sc1
buffer_load_dwordx4 a[68:71], v16, s[8:11], s25 offen offset:1024 sc1
buffer_load_dwordx4 a[72:75], v16, s[8:11], s25 offen offset:2048 sc1
buffer_load_dwordx4 a[76:79], v16, s[8:11], s25 offen offset:3072 sc1
s_add_u32 s25, s46, 12288
buffer_load_dwordx4 a[80:83], v16, s[8:11], s25 offen offset:0 sc1
buffer_load_dwordx4 a[84:87], v16, s[8:11], s25 offen offset:1024 sc1
buffer_load_dwordx4 a[88:91], v16, s[8:11], s25 offen offset:2048 sc1
buffer_load_dwordx4 a[92:95], v16, s[8:11], s25 offen offset:3072 sc1
s_waitcnt vmcnt(0)
L_bt:
v_mfma_f32_32x32x16_bf16 v[32:47], a[32:35], a[0:3], 0
v_mfma_f32_32x32x16_bf16 v[32:47], a[36:39], a[4:7], v[32:47]
v_mfma_f32_32x32x16_bf16 v[32:47], a[40:43], a[8:11], v[32:47]
v_mfma_f32_32x32x16_bf16 v[32:47], a[44:47], a[12:15], v[32:47]
v_mfma_f32_32x32x16_bf16 v[32:47], a[48:51], a[16:19], v[32:47]
v_mfma_f32_32x32x16_bf16 v[32:47], a[52:55], a[20:23], v[32:47]
v_mfma_f32_32x32x16_bf16 v[32:47], a[56:59], a[24:27], v[32:47]
v_mfma_f32_32x32x16_bf16 v[32:47], a[60:63], a[28:31], v[32:47]
s_and_b32 s42, s47, 31
s_lshr_b32 s43, s47, 5
L_nb_19:
s_ff1_i32_b64 s48, s[52:53]
s_cmp_lt_u32 s41, 32
s_cbranch_scc1 L_nb_20
s_bitset0_b64 s[52:53], s48
s_sub_u32 s41, s41, 32
s_branch L_nb_19
L_nb_20:
s_lshl_b32 s48, s48, 5
s_add_u32 s48, s48, s41
s_add_u32 s41, s41, 56
s_and_b32 s24, s48, 31
s_lshr_b32 s25, s48, 5
s_lshl_b32 s46, s24, 6
s_add_u32 s46, s46, s25
s_lshl_b32 s46, s46, 14
s_add_u32 s46, s46, 33554432
s_lshr_b32 s44, s24, 1
s_lshl_b32 s44, s44, 6
s_add_u32 s44, s44, s25
s_lshl_b32 s44, s44, 1
s_and_b32 s24, s24, 1
s_add_u32 s44, s44, s24
s_lshl_b32 s44, s44, 13
s_add_u32 s44, s44, 134217728
s_cmp_ge_u32 s48, 2048
s_cselect_b32 s44, 536870912, s44
s_cselect_b32 s46, 536870912, s46
s_cbranch_scc1 L_nb_18
s_lshr_b32 s25, s48, 8
s_lshl_b32 s25, s25, 2
s_cmp_eq_u32 s25, s45
s_cbranch_scc1 L_nb_18
s_mov_b32 s45, s25
s_mov_b32 s28, 0
L_poll_21:
buffer_load_dword v26, v17, s[8:11], s45 offen sc1
s_add_u32 s28, s28, 1
s_cmp_gt_u32 s28, 40000
s_cbranch_scc1 L_end
s_waitcnt vmcnt(0)
v_cmp_ne_u32 vcc, 1, v26
s_cbranch_vccz L_pd_22
s_sleep 8
s_branch L_poll_21
L_pd_22:
L_nb_18:
s_add_u32 s25, s44, 0
buffer_load_dwordx4 a[96:99], v1, s[8:11], s25 offen offset:0 sc1
buffer_load_dwordx4 a[100:103], v1, s[8:11], s25 offen offset:1024 sc1
buffer_load_dwordx4 a[104:107], v1, s[8:11], s25 offen offset:2048 sc1
buffer_load_dwordx4 a[108:111], v1, s[8:11], s25 offen offset:3072 sc1
s_add_u32 s25, s44, 4096
buffer_load_dwordx4 a[112:115], v1, s[8:11], s25 offen offset:0 sc1
buffer_load_dwordx4 a[116:119], v1, s[8:11], s25 offen offset:1024 sc1
buffer_load_dwordx4 a[120:123], v1, s[8:11], s25 offen offset:2048 sc1
buffer_load_dwordx4 a[124:127], v1, s[8:11], s25 offen offset:3072 sc1
s_add_u32 s25, s46, 0
buffer_load_dwordx4 a[128:131], v1, s[8:11], s25 offen offset:0 sc1
buffer_load_dwordx4 a[132:135], v1, s[8:11], s25 offen offset:1024 sc1
buffer_load_dwordx4 a[136:139], v1, s[8:11], s25 offen offset:2048 sc1
buffer_load_dwordx4 a[140:143], v1, s[8:11], s25 offen offset:3072 sc1
s_add_u32 s25, s46, 4096
buffer_load_dwordx4 a[144:147], v1, s[8:11], s25 offen offset:0 sc1
buffer_load_dwordx4 a[148:151], v1, s[8:11], s25 offen offset:1024 sc1
buffer_load_dwordx4 a[152:155], v1, s[8:11], s25 offen offset:2048 sc1
buffer_load_dwordx4 a[156:159], v1, s[8:11], s25 offen offset:3072 sc1
s_add_u32 s25, s46, 8192
buffer_load_dwordx4 a[160:163], v16, s[8:11], s25 offen offset:0 sc1
buffer_load_dwordx4 a[164:167], v16, s[8:11], s25 offen offset:1024 sc1
buffer_load_dwordx4 a[168:171], v16, s[8:11], s25 offen offset:2048 sc1
buffer_load_dwordx4 a[172:175], v16, s[8:11], s25 offen offset:3072 sc1
s_add_u32 s25, s46, 12288
buffer_load_dwordx4 a[176:179], v16, s[8:11], s25 offen offset:0 sc1
buffer_load_dwordx4 a[180:183], v16, s[8:11], s25 offen offset:1024 sc1
buffer_load_dwordx4 a[184:187], v16, s[8:11], s25 offen offset:2048 sc1
buffer_load_dwordx4 a[188:191], v16, s[8:11], s25 offen offset:3072 sc1
v_cndmask_b32 v32, v31, v32, s[64:65]
v_cndmask_b32 v33, v31, v33, s[66:67]
v_cndmask_b32 v34, v31, v34, s[68:69]
v_cndmask_b32 v35, v31, v35, s[70:71]
v_cndmask_b32 v36, v31, v36, s[72:73]
v_cndmask_b32 v37, v31, v37, s[74:75]
v_cndmask_b32 v38, v31, v38, s[76:77]
v_cndmask_b32 v39, v31, v39, s[78:79]
v_cndmask_b32 v40, v31, v40, s[80:81]
v_cndmask_b32 v41, v31, v41, s[82:83]
v_cndmask_b32 v42, v31, v42, s[84:85]
v_cndmask_b32 v43, v31, v43, s[86:87]
v_cndmask_b32 v44, v31, v44, s[88:89]
v_cndmask_b32 v45, v31, v45, s[90:91]
v_cndmask_b32 v46, v31, v46, s[92:93]
v_cndmask_b32 v47, v31, v47, s[94:95]
v_max3_f32 v20, v32, v33, v34
v_max3_f32 v20, v20, v35, v36
v_max3_f32 v20, v20, v37, v38
v_max3_f32 v20, v20, v39, v40
v_max3_f32 v20, v20, v41, v42
v_max3_f32 v20, v20, v43, v44
v_max3_f32 v20, v20, v45, v46
v_max_f32 v20, v20, v47
s_lshl_b32 s25, s42, 7
s_add_u32 s25, s25, 111153152
s_lshl_b32 s24, s47, 12
s_add_u32 s24, s24, 100663296
s_cmp_lt_u32 s43, s49
s_cbranch_scc1 L_kn_23
s_mov_b32 s28, 0
L_poll_24:
buffer_load_dword v26, v4, s[8:11], s25 offen sc1
s_add_u32 s28, s28, 1
s_cmp_gt_u32 s28, 40000
s_cbranch_scc1 L_end
s_waitcnt vmcnt(0)
v_cmp_ge_u32 vcc, s43, v26
s_cbranch_vccz L_pd_25
s_sleep 1
s_branch L_poll_24
L_pd_25:
v_readfirstlane_b32 s49, v26
s_nop 0
s_min_u32 s49, s49, 63
s_sub_u32 s49, s49, 1
L_kn_23:
buffer_load_dwordx4 v[96:99], v2, s[8:11], s24 offen offset:0 sc1
buffer_load_dwordx4 v[100:103], v7, s[8:11], s24 offen offset:256 sc1
buffer_load_dwordx4 v[104:107], v2, s[8:11], s24 offen offset:512 sc1
buffer_load_dwordx4 v[108:111], v7, s[8:11], s24 offen offset:768 sc1
buffer_load_dwordx4 v[112:115], v2, s[8:11], s24 offen offset:1024 sc1
buffer_load_dwordx4 v[116:119], v7, s[8:11], s24 offen offset:1280 sc1
buffer_load_dwordx4 v[120:123], v2, s[8:11], s24 offen offset:1536 sc1
buffer_load_dwordx4 v[124:127], v7, s[8:11], s24 offen offset:1792 sc1
buffer_load_dword v8, v3, s[8:11], s24 offen offset:2048 sc1
buffer_load_dword v9, v3, s[8:11], s24 offen offset:2176 sc1
buffer_load_dword v10, v3, s[8:11], s24 offen offset:2560 sc1
buffer_load_dword v11, v3, s[8:11], s24 offen offset:2688 sc1
buffer_load_dword v12, v3, s[8:11], s24 offen offset:3072 sc1
buffer_load_dword v13, v3, s[8:11], s24 offen offset:3200 sc1
buffer_load_dword v14, v3, s[8:11], s24 offen offset:3584 sc1
buffer_load_dword v15, v3, s[8:11], s24 offen offset:3712 sc1
s_waitcnt vmcnt(15)
v_mfma_f32_32x32x16_bf16 v[64:79], v[96:99], a[0:3], 0
s_waitcnt vmcnt(14)
v_mfma_f32_32x32x16_bf16 v[64:79], v[100:103], a[4:7], v[64:79]
s_waitcnt vmcnt(13)
v_mfma_f32_32x32x16_bf16 v[64:79], v[104:107], a[8:11], v[64:79]
s_waitcnt vmcnt(12)
v_mfma_f32_32x32x16_bf16 v[64:79], v[108:111], a[12:15], v[64:79]
s_waitcnt vmcnt(11)
v_mfma_f32_32x32x16_bf16 v[64:79], v[112:115], a[16:19], v[64:79]
s_waitcnt vmcnt(10)
v_mfma_f32_32x32x16_bf16 v[64:79], v[116:119], a[20:23], v[64:79]
s_waitcnt vmcnt(9)
v_mfma_f32_32x32x16_bf16 v[64:79], v[120:123], a[24:27], v[64:79]
s_waitcnt vmcnt(8)
v_mfma_f32_32x32x16_bf16 v[64:79], v[124:127], a[28:31], v[64:79]
s_nop 11
v_max3_f32 v20, v20, v64, v65
v_max3_f32 v20, v20, v66, v67
v_mov_b32 v26, v20
s_nop 1
v_permlane32_swap_b32 v26, v20
v_max_f32 v20, v20, v26
v_mul_f32 v20, s40, v20
v_fma_f32 v64, v64, s40, -v20
v_fma_f32 v65, v65, s40, -v20
v_fma_f32 v66, v66, s40, -v20
v_fma_f32 v67, v67, s40, -v20
v_fma_f32 v32, v32, s40, -v20
v_fma_f32 v33, v33, s40, -v20
v_fma_f32 v34, v34, s40, -v20
v_fma_f32 v35, v35, s40, -v20
v_fma_f32 v36, v36, s40, -v20
v_fma_f32 v37, v37, s40, -v20
v_fma_f32 v38, v38, s40, -v20
v_fma_f32 v39, v39, s40, -v20
v_fma_f32 v40, v40, s40, -v20
v_fma_f32 v41, v41, s40, -v20
v_fma_f32 v42, v42, s40, -v20
v_fma_f32 v43, v43, s40, -v20
v_fma_f32 v44, v44, s40, -v20
v_fma_f32 v45, v45, s40, -v20
v_fma_f32 v46, v46, s40, -v20
v_fma_f32 v47, v47, s40, -v20
v_exp_f32 v64, v64
v_exp_f32 v65, v65
v_exp_f32 v66, v66
v_exp_f32 v67, v67
v_exp_f32 v32, v32
v_exp_f32 v33, v33
v_exp_f32 v34, v34
v_exp_f32 v35, v35
v_exp_f32 v36, v36
v_exp_f32 v37, v37
v_exp_f32 v38, v38
v_exp_f32 v39, v39
v_exp_f32 v40, v40
v_exp_f32 v41, v41
v_exp_f32 v42, v42
v_exp_f32 v43, v43
v_exp_f32 v44, v44
v_exp_f32 v45, v45
v_exp_f32 v46, v46
v_exp_f32 v47, v47
v_cvt_pk_bf16_f32 v88, v64, v65
v_cvt_pk_bf16_f32 v89, v66, v67
v_cvt_pk_bf16_f32 v80, v32, v33
v_cvt_pk_bf16_f32 v81, v34, v35
v_cvt_pk_bf16_f32 v82, v36, v37
v_cvt_pk_bf16_f32 v83, v38, v39
v_cvt_pk_bf16_f32 v84, v40, v41
v_cvt_pk_bf16_f32 v85, v42, v43
v_cvt_pk_bf16_f32 v86, v44, v45
v_cvt_pk_bf16_f32 v87, v46, v47
s_waitcnt vmcnt(0)
v_mfma_f32_32x32x8_bf16 v[128:143], v[8:9], v[88:89], 0
v_add_f32 v22, v64, v65
v_add_f32 v22, v22, v66
v_mfma_f32_32x32x16_bf16 v[128:143], a[64:67], v[80:83], v[128:143]
v_add_f32 v22, v22, v67
v_add_f32 v22, v22, v32
v_add_f32 v22, v22, v33
v_mfma_f32_32x32x16_bf16 v[128:143], a[68:71], v[84:87], v[128:143]
v_add_f32 v22, v22, v34
v_add_f32 v22, v22, v35
v_mfma_f32_32x32x8_bf16 v[160:175], v[10:11], v[88:89], 0
v_add_f32 v22, v22, v36
v_add_f32 v22, v22, v37
v_add_f32 v22, v22, v38
v_mfma_f32_32x32x16_bf16 v[160:175], a[72:75], v[80:83], v[160:175]
v_add_f32 v22, v22, v39
v_add_f32 v22, v22, v40
v_mfma_f32_32x32x16_bf16 v[160:175], a[76:79], v[84:87], v[160:175]
v_add_f32 v22, v22, v41
v_add_f32 v22, v22, v42
v_mfma_f32_32x32x8_bf16 v[192:207], v[12:13], v[88:89], 0
v_add_f32 v22, v22, v43
v_add_f32 v22, v22, v44
v_add_f32 v22, v22, v45
v_mfma_f32_32x32x16_bf16 v[192:207], a[80:83], v[80:83], v[192:207]
v_add_f32 v22, v22, v46
v_add_f32 v22, v22, v47
v_mfma_f32_32x32x16_bf16 v[192:207], a[84:87], v[84:87], v[192:207]
v_mfma_f32_32x32x8_bf16 v[224:239], v[14:15], v[88:89], 0
v_mfma_f32_32x32x16_bf16 v[224:239], a[88:91], v[80:83], v[224:239]
v_mfma_f32_32x32x16_bf16 v[224:239], a[92:95], v[84:87], v[224:239]
s_lshl_b32 s26, s43, 18
s_lshl_b32 s27, s42, 12
s_add_u32 s26, s26, s27
s_add_u32 s26, s26, 83886080
v_mov_b32 v26, v22
s_nop 1
v_permlane32_swap_b32 v26, v22
v_add_f32 v26, v26, v22
v_rcp_f32 v26, v26
s_nop 0
v_pk_mul_f32 v[128:129], v[128:129], v[26:27] op_sel_hi:[1,0]
v_pk_mul_f32 v[130:131], v[130:131], v[26:27] op_sel_hi:[1,0]
v_pk_mul_f32 v[132:133], v[132:133], v[26:27] op_sel_hi:[1,0]
v_pk_mul_f32 v[134:135], v[134:135], v[26:27] op_sel_hi:[1,0]
v_pk_mul_f32 v[136:137], v[136:137], v[26:27] op_sel_hi:[1,0]
v_pk_mul_f32 v[138:139], v[138:139], v[26:27] op_sel_hi:[1,0]
v_pk_mul_f32 v[140:141], v[140:141], v[26:27] op_sel_hi:[1,0]
v_pk_mul_f32 v[142:143], v[142:143], v[26:27] op_sel_hi:[1,0]
v_cvt_pk_bf16_f32 v128, v128, v129
v_cvt_pk_bf16_f32 v129, v130, v131
v_cvt_pk_bf16_f32 v130, v132, v133
v_cvt_pk_bf16_f32 v131, v134, v135
buffer_store_dwordx4 v[128:131], v6, s[8:11], s26 offen offset:0 sc1
v_cvt_pk_bf16_f32 v136, v136, v137
v_cvt_pk_bf16_f32 v137, v138, v139
v_cvt_pk_bf16_f32 v138, v140, v141
v_cvt_pk_bf16_f32 v139, v142, v143
buffer_store_dwordx4 v[136:139], v6, s[8:11], s26 offen offset:512 sc1
v_pk_mul_f32 v[160:161], v[160:161], v[26:27] op_sel_hi:[1,0]
v_pk_mul_f32 v[162:163], v[162:163], v[26:27] op_sel_hi:[1,0]
v_pk_mul_f32 v[164:165], v[164:165], v[26:27] op_sel_hi:[1,0]
v_pk_mul_f32 v[166:167], v[166:167], v[26:27] op_sel_hi:[1,0]
v_pk_mul_f32 v[168:169], v[168:169], v[26:27] op_sel_hi:[1,0]
v_pk_mul_f32 v[170:171], v[170:171], v[26:27] op_sel_hi:[1,0]
v_pk_mul_f32 v[172:173], v[172:173], v[26:27] op_sel_hi:[1,0]
v_pk_mul_f32 v[174:175], v[174:175], v[26:27] op_sel_hi:[1,0]
v_cvt_pk_bf16_f32 v160, v160, v161
v_cvt_pk_bf16_f32 v161, v162, v163
v_cvt_pk_bf16_f32 v162, v164, v165
v_cvt_pk_bf16_f32 v163, v166, v167
buffer_store_dwordx4 v[160:163], v6, s[8:11], s26 offen offset:1024 sc1
v_cvt_pk_bf16_f32 v168, v168, v169
v_cvt_pk_bf16_f32 v169, v170, v171
v_cvt_pk_bf16_f32 v170, v172, v173
v_cvt_pk_bf16_f32 v171, v174, v175
buffer_store_dwordx4 v[168:171], v6, s[8:11], s26 offen offset:1536 sc1
v_pk_mul_f32 v[192:193], v[192:193], v[26:27] op_sel_hi:[1,0]
v_pk_mul_f32 v[194:195], v[194:195], v[26:27] op_sel_hi:[1,0]
v_pk_mul_f32 v[196:197], v[196:197], v[26:27] op_sel_hi:[1,0]
v_pk_mul_f32 v[198:199], v[198:199], v[26:27] op_sel_hi:[1,0]
v_pk_mul_f32 v[200:201], v[200:201], v[26:27] op_sel_hi:[1,0]
v_pk_mul_f32 v[202:203], v[202:203], v[26:27] op_sel_hi:[1,0]
v_pk_mul_f32 v[204:205], v[204:205], v[26:27] op_sel_hi:[1,0]
v_pk_mul_f32 v[206:207], v[206:207], v[26:27] op_sel_hi:[1,0]
v_cvt_pk_bf16_f32 v192, v192, v193
v_cvt_pk_bf16_f32 v193, v194, v195
v_cvt_pk_bf16_f32 v194, v196, v197
v_cvt_pk_bf16_f32 v195, v198, v199
buffer_store_dwordx4 v[192:195], v6, s[8:11], s26 offen offset:2048 sc1
v_cvt_pk_bf16_f32 v200, v200, v201
v_cvt_pk_bf16_f32 v201, v202, v203
v_cvt_pk_bf16_f32 v202, v204, v205
v_cvt_pk_bf16_f32 v203, v206, v207
buffer_store_dwordx4 v[200:203], v6, s[8:11], s26 offen offset:2560 sc1
v_pk_mul_f32 v[224:225], v[224:225], v[26:27] op_sel_hi:[1,0]
v_pk_mul_f32 v[226:227], v[226:227], v[26:27] op_sel_hi:[1,0]
v_pk_mul_f32 v[228:229], v[228:229], v[26:27] op_sel_hi:[1,0]
v_pk_mul_f32 v[230:231], v[230:231], v[26:27] op_sel_hi:[1,0]
v_pk_mul_f32 v[232:233], v[232:233], v[26:27] op_sel_hi:[1,0]
v_pk_mul_f32 v[234:235], v[234:235], v[26:27] op_sel_hi:[1,0]
v_pk_mul_f32 v[236:237], v[236:237], v[26:27] op_sel_hi:[1,0]
v_pk_mul_f32 v[238:239], v[238:239], v[26:27] op_sel_hi:[1,0]
v_cvt_pk_bf16_f32 v224, v224, v225
v_cvt_pk_bf16_f32 v225, v226, v227
v_cvt_pk_bf16_f32 v226, v228, v229
v_cvt_pk_bf16_f32 v227, v230, v231
buffer_store_dwordx4 v[224:227], v6, s[8:11], s26 offen offset:3072 sc1
v_cvt_pk_bf16_f32 v232, v232, v233
v_cvt_pk_bf16_f32 v233, v234, v235
v_cvt_pk_bf16_f32 v234, v236, v237
v_cvt_pk_bf16_f32 v235, v238, v239
buffer_store_dwordx4 v[232:235], v6, s[8:11], s26 offen offset:3584 sc1
s_lshl_b32 s26, s47, 2
s_add_u32 s26, s26, 111157248
v_mov_b32 v26, 1
s_waitcnt vmcnt(0)
s_mov_b64 exec, 1
buffer_store_dword v26, v4, s[8:11], s26 offen sc1
s_mov_b64 exec, -1
s_mov_b32 s47, s48
s_cmp_lt_u32 s47, 2048
s_cbranch_scc0 L_bt_x
v_mfma_f32_32x32x16_bf16 v[32:47], a[128:131], a[96:99], 0
v_mfma_f32_32x32x16_bf16 v[32:47], a[132:135], a[100:103], v[32:47]
v_mfma_f32_32x32x16_bf16 v[32:47], a[136:139], a[104:107], v[32:47]
v_mfma_f32_32x32x16_bf16 v[32:47], a[140:143], a[108:111], v[32:47]
v_mfma_f32_32x32x16_bf16 v[32:47], a[144:147], a[112:115], v[32:47]
v_mfma_f32_32x32x16_bf16 v[32:47], a[148:151], a[116:119], v[32:47]
v_mfma_f32_32x32x16_bf16 v[32:47], a[152:155], a[120:123], v[32:47]
v_mfma_f32_32x32x16_bf16 v[32:47], a[156:159], a[124:127], v[32:47]
s_and_b32 s42, s47, 31
s_lshr_b32 s43, s47, 5
L_nb_27:
s_ff1_i32_b64 s48, s[52:53]
s_cmp_lt_u32 s41, 32
s_cbranch_scc1 L_nb_28
s_bitset0_b64 s[52:53], s48
s_sub_u32 s41, s41, 32
s_branch L_nb_27
L_nb_28:
s_lshl_b32 s48, s48, 5
s_add_u32 s48, s48, s41
s_add_u32 s41, s41, 56
s_and_b32 s24, s48, 31
s_lshr_b32 s25, s48, 5
s_lshl_b32 s46, s24, 6
s_add_u32 s46, s46, s25
s_lshl_b32 s46, s46, 14
s_add_u32 s46, s46, 33554432
s_lshr_b32 s44, s24, 1
s_lshl_b32 s44, s44, 6
s_add_u32 s44, s44, s25
s_lshl_b32 s44, s44, 1
s_and_b32 s24, s24, 1
s_add_u32 s44, s44, s24
s_lshl_b32 s44, s44, 13
s_add_u32 s44, s44, 134217728
s_cmp_ge_u32 s48, 2048
s_cselect_b32 s44, 536870912, s44
s_cselect_b32 s46, 536870912, s46
s_cbranch_scc1 L_nb_26
s_lshr_b32 s25, s48, 8
s_lshl_b32 s25, s25, 2
s_cmp_eq_u32 s25, s45
s_cbranch_scc1 L_nb_26
s_mov_b32 s45, s25
s_mov_b32 s28, 0
L_poll_29:
buffer_load_dword v26, v17, s[8:11], s45 offen sc1
s_add_u32 s28, s28, 1
s_cmp_gt_u32 s28, 40000
s_cbranch_scc1 L_end
s_waitcnt vmcnt(0)
v_cmp_ne_u32 vcc, 1, v26
s_cbranch_vccz L_pd_30
s_sleep 8
s_branch L_poll_29
L_pd_30:
L_nb_26:
s_add_u32 s25, s44, 0
buffer_load_dwordx4 a[0:3], v1, s[8:11], s25 offen offset:0 sc1
buffer_load_dwordx4 a[4:7], v1, s[8:11], s25 offen offset:1024 sc1
buffer_load_dwordx4 a[8:11], v1, s[8:11], s25 offen offset:2048 sc1
buffer_load_dwordx4 a[12:15], v1, s[8:11], s25 offen offset:3072 sc1
s_add_u32 s25, s44, 4096
buffer_load_dwordx4 a[16:19], v1, s[8:11], s25 offen offset:0 sc1
buffer_load_dwordx4 a[20:23], v1, s[8:11], s25 offen offset:1024 sc1
buffer_load_dwordx4 a[24:27], v1, s[8:11], s25 offen offset:2048 sc1
buffer_load_dwordx4 a[28:31], v1, s[8:11], s25 offen offset:3072 sc1
s_add_u32 s25, s46, 0
buffer_load_dwordx4 a[32:35], v1, s[8:11], s25 offen offset:0 sc1
buffer_load_dwordx4 a[36:39], v1, s[8:11], s25 offen offset:1024 sc1
buffer_load_dwordx4 a[40:43], v1, s[8:11], s25 offen offset:2048 sc1
buffer_load_dwordx4 a[44:47], v1, s[8:11], s25 offen offset:3072 sc1
s_add_u32 s25, s46, 4096
buffer_load_dwordx4 a[48:51], v1, s[8:11], s25 offen offset:0 sc1
buffer_load_dwordx4 a[52:55], v1, s[8:11], s25 offen offset:1024 sc1
buffer_load_dwordx4 a[56:59], v1, s[8:11], s25 offen offset:2048 sc1
buffer_load_dwordx4 a[60:63], v1, s[8:11], s25 offen offset:3072 sc1
s_add_u32 s25, s46, 8192
buffer_load_dwordx4 a[64:67], v16, s[8:11], s25 offen offset:0 sc1
buffer_load_dwordx4 a[68:71], v16, s[8:11], s25 offen offset:1024 sc1
buffer_load_dwordx4 a[72:75], v16, s[8:11], s25 offen offset:2048 sc1
buffer_load_dwordx4 a[76:79], v16, s[8:11], s25 offen offset:3072 sc1
s_add_u32 s25, s46, 12288
buffer_load_dwordx4 a[80:83], v16, s[8:11], s25 offen offset:0 sc1
buffer_load_dwordx4 a[84:87], v16, s[8:11], s25 offen offset:1024 sc1
buffer_load_dwordx4 a[88:91], v16, s[8:11], s25 offen offset:2048 sc1
buffer_load_dwordx4 a[92:95], v16, s[8:11], s25 offen offset:3072 sc1
v_cndmask_b32 v32, v31, v32, s[64:65]
v_cndmask_b32 v33, v31, v33, s[66:67]
v_cndmask_b32 v34, v31, v34, s[68:69]
v_cndmask_b32 v35, v31, v35, s[70:71]
v_cndmask_b32 v36, v31, v36, s[72:73]
v_cndmask_b32 v37, v31, v37, s[74:75]
v_cndmask_b32 v38, v31, v38, s[76:77]
v_cndmask_b32 v39, v31, v39, s[78:79]
v_cndmask_b32 v40, v31, v40, s[80:81]
v_cndmask_b32 v41, v31, v41, s[82:83]
v_cndmask_b32 v42, v31, v42, s[84:85]
v_cndmask_b32 v43, v31, v43, s[86:87]
v_cndmask_b32 v44, v31, v44, s[88:89]
v_cndmask_b32 v45, v31, v45, s[90:91]
v_cndmask_b32 v46, v31, v46, s[92:93]
v_cndmask_b32 v47, v31, v47, s[94:95]
v_max3_f32 v20, v32, v33, v34
v_max3_f32 v20, v20, v35, v36
v_max3_f32 v20, v20, v37, v38
v_max3_f32 v20, v20, v39, v40
v_max3_f32 v20, v20, v41, v42
v_max3_f32 v20, v20, v43, v44
v_max3_f32 v20, v20, v45, v46
v_max_f32 v20, v20, v47
s_lshl_b32 s25, s42, 7
s_add_u32 s25, s25, 111153152
s_lshl_b32 s24, s47, 12
s_add_u32 s24, s24, 100663296
s_cmp_lt_u32 s43, s49
s_cbranch_scc1 L_kn_31
s_mov_b32 s28, 0
L_poll_32:
buffer_load_dword v26, v4, s[8:11], s25 offen sc1
s_add_u32 s28, s28, 1
s_cmp_gt_u32 s28, 40000
s_cbranch_scc1 L_end
s_waitcnt vmcnt(0)
v_cmp_ge_u32 vcc, s43, v26
s_cbranch_vccz L_pd_33
s_sleep 1
s_branch L_poll_32
L_pd_33:
v_readfirstlane_b32 s49, v26
s_nop 0
s_min_u32 s49, s49, 63
s_sub_u32 s49, s49, 1
L_kn_31:
buffer_load_dwordx4 v[96:99], v2, s[8:11], s24 offen offset:0 sc1
buffer_load_dwordx4 v[100:103], v7, s[8:11], s24 offen offset:256 sc1
buffer_load_dwordx4 v[104:107], v2, s[8:11], s24 offen offset:512 sc1
buffer_load_dwordx4 v[108:111], v7, s[8:11], s24 offen offset:768 sc1
buffer_load_dwordx4 v[112:115], v2, s[8:11], s24 offen offset:1024 sc1
buffer_load_dwordx4 v[116:119], v7, s[8:11], s24 offen offset:1280 sc1
buffer_load_dwordx4 v[120:123], v2, s[8:11], s24 offen offset:1536 sc1
buffer_load_dwordx4 v[124:127], v7, s[8:11], s24 offen offset:1792 sc1
buffer_load_dword v8, v3, s[8:11], s24 offen offset:2048 sc1
buffer_load_dword v9, v3, s[8:11], s24 offen offset:2176 sc1
buffer_load_dword v10, v3, s[8:11], s24 offen offset:2560 sc1
buffer_load_dword v11, v3, s[8:11], s24 offen offset:2688 sc1
buffer_load_dword v12, v3, s[8:11], s24 offen offset:3072 sc1
buffer_load_dword v13, v3, s[8:11], s24 offen offset:3200 sc1
buffer_load_dword v14, v3, s[8:11], s24 offen offset:3584 sc1
buffer_load_dword v15, v3, s[8:11], s24 offen offset:3712 sc1
s_waitcnt vmcnt(15)
v_mfma_f32_32x32x16_bf16 v[64:79], v[96:99], a[96:99], 0
s_waitcnt vmcnt(14)
v_mfma_f32_32x32x16_bf16 v[64:79], v[100:103], a[100:103], v[64:79]
s_waitcnt vmcnt(13)
v_mfma_f32_32x32x16_bf16 v[64:79], v[104:107], a[104:107], v[64:79]
s_waitcnt vmcnt(12)
v_mfma_f32_32x32x16_bf16 v[64:79], v[108:111], a[108:111], v[64:79]
s_waitcnt vmcnt(11)
v_mfma_f32_32x32x16_bf16 v[64:79], v[112:115], a[112:115], v[64:79]
s_waitcnt vmcnt(10)
v_mfma_f32_32x32x16_bf16 v[64:79], v[116:119], a[116:119], v[64:79]
s_waitcnt vmcnt(9)
v_mfma_f32_32x32x16_bf16 v[64:79], v[120:123], a[120:123], v[64:79]
s_waitcnt vmcnt(8)
v_mfma_f32_32x32x16_bf16 v[64:79], v[124:127], a[124:127], v[64:79]
s_nop 11
v_max3_f32 v20, v20, v64, v65
v_max3_f32 v20, v20, v66, v67
v_mov_b32 v26, v20
s_nop 1
v_permlane32_swap_b32 v26, v20
v_max_f32 v20, v20, v26
v_mul_f32 v20, s40, v20
v_fma_f32 v64, v64, s40, -v20
v_fma_f32 v65, v65, s40, -v20
v_fma_f32 v66, v66, s40, -v20
v_fma_f32 v67, v67, s40, -v20
v_fma_f32 v32, v32, s40, -v20
v_fma_f32 v33, v33, s40, -v20
v_fma_f32 v34, v34, s40, -v20
v_fma_f32 v35, v35, s40, -v20
v_fma_f32 v36, v36, s40, -v20
v_fma_f32 v37, v37, s40, -v20
v_fma_f32 v38, v38, s40, -v20
v_fma_f32 v39, v39, s40, -v20
v_fma_f32 v40, v40, s40, -v20
v_fma_f32 v41, v41, s40, -v20
v_fma_f32 v42, v42, s40, -v20
v_fma_f32 v43, v43, s40, -v20
v_fma_f32 v44, v44, s40, -v20
v_fma_f32 v45, v45, s40, -v20
v_fma_f32 v46, v46, s40, -v20
v_fma_f32 v47, v47, s40, -v20
v_exp_f32 v64, v64
v_exp_f32 v65, v65
v_exp_f32 v66, v66
v_exp_f32 v67, v67
v_exp_f32 v32, v32
v_exp_f32 v33, v33
v_exp_f32 v34, v34
v_exp_f32 v35, v35
v_exp_f32 v36, v36
v_exp_f32 v37, v37
v_exp_f32 v38, v38
v_exp_f32 v39, v39
v_exp_f32 v40, v40
v_exp_f32 v41, v41
v_exp_f32 v42, v42
v_exp_f32 v43, v43
v_exp_f32 v44, v44
v_exp_f32 v45, v45
v_exp_f32 v46, v46
v_exp_f32 v47, v47
v_cvt_pk_bf16_f32 v88, v64, v65
v_cvt_pk_bf16_f32 v89, v66, v67
v_cvt_pk_bf16_f32 v80, v32, v33
v_cvt_pk_bf16_f32 v81, v34, v35
v_cvt_pk_bf16_f32 v82, v36, v37
v_cvt_pk_bf16_f32 v83, v38, v39
v_cvt_pk_bf16_f32 v84, v40, v41
v_cvt_pk_bf16_f32 v85, v42, v43
v_cvt_pk_bf16_f32 v86, v44, v45
v_cvt_pk_bf16_f32 v87, v46, v47
s_waitcnt vmcnt(0)
v_mfma_f32_32x32x8_bf16 v[128:143], v[8:9], v[88:89], 0
v_add_f32 v22, v64, v65
v_add_f32 v22, v22, v66
v_mfma_f32_32x32x16_bf16 v[128:143], a[160:163], v[80:83], v[128:143]
v_add_f32 v22, v22, v67
v_add_f32 v22, v22, v32
v_add_f32 v22, v22, v33
v_mfma_f32_32x32x16_bf16 v[128:143], a[164:167], v[84:87], v[128:143]
v_add_f32 v22, v22, v34
v_add_f32 v22, v22, v35
v_mfma_f32_32x32x8_bf16 v[160:175], v[10:11], v[88:89], 0
v_add_f32 v22, v22, v36
v_add_f32 v22, v22, v37
v_add_f32 v22, v22, v38
v_mfma_f32_32x32x16_bf16 v[160:175], a[168:171], v[80:83], v[160:175]
v_add_f32 v22, v22, v39
v_add_f32 v22, v22, v40
v_mfma_f32_32x32x16_bf16 v[160:175], a[172:175], v[84:87], v[160:175]
v_add_f32 v22, v22, v41
v_add_f32 v22, v22, v42
v_mfma_f32_32x32x8_bf16 v[192:207], v[12:13], v[88:89], 0
v_add_f32 v22, v22, v43
v_add_f32 v22, v22, v44
v_add_f32 v22, v22, v45
v_mfma_f32_32x32x16_bf16 v[192:207], a[176:179], v[80:83], v[192:207]
v_add_f32 v22, v22, v46
v_add_f32 v22, v22, v47
v_mfma_f32_32x32x16_bf16 v[192:207], a[180:183], v[84:87], v[192:207]
v_mfma_f32_32x32x8_bf16 v[224:239], v[14:15], v[88:89], 0
v_mfma_f32_32x32x16_bf16 v[224:239], a[184:187], v[80:83], v[224:239]
v_mfma_f32_32x32x16_bf16 v[224:239], a[188:191], v[84:87], v[224:239]
s_lshl_b32 s26, s43, 18
s_lshl_b32 s27, s42, 12
s_add_u32 s26, s26, s27
s_add_u32 s26, s26, 83886080
v_mov_b32 v26, v22
s_nop 1
v_permlane32_swap_b32 v26, v22
v_add_f32 v26, v26, v22
v_rcp_f32 v26, v26
s_nop 0
v_pk_mul_f32 v[128:129], v[128:129], v[26:27] op_sel_hi:[1,0]
v_pk_mul_f32 v[130:131], v[130:131], v[26:27] op_sel_hi:[1,0]
v_pk_mul_f32 v[132:133], v[132:133], v[26:27] op_sel_hi:[1,0]
v_pk_mul_f32 v[134:135], v[134:135], v[26:27] op_sel_hi:[1,0]
v_pk_mul_f32 v[136:137], v[136:137], v[26:27] op_sel_hi:[1,0]
v_pk_mul_f32 v[138:139], v[138:139], v[26:27] op_sel_hi:[1,0]
v_pk_mul_f32 v[140:141], v[140:141], v[26:27] op_sel_hi:[1,0]
v_pk_mul_f32 v[142:143], v[142:143], v[26:27] op_sel_hi:[1,0]
v_cvt_pk_bf16_f32 v128, v128, v129
v_cvt_pk_bf16_f32 v129, v130, v131
v_cvt_pk_bf16_f32 v130, v132, v133
v_cvt_pk_bf16_f32 v131, v134, v135
buffer_store_dwordx4 v[128:131], v6, s[8:11], s26 offen offset:0 sc1
v_cvt_pk_bf16_f32 v136, v136, v137
v_cvt_pk_bf16_f32 v137, v138, v139
v_cvt_pk_bf16_f32 v138, v140, v141
v_cvt_pk_bf16_f32 v139, v142, v143
buffer_store_dwordx4 v[136:139], v6, s[8:11], s26 offen offset:512 sc1
v_pk_mul_f32 v[160:161], v[160:161], v[26:27] op_sel_hi:[1,0]
v_pk_mul_f32 v[162:163], v[162:163], v[26:27] op_sel_hi:[1,0]
v_pk_mul_f32 v[164:165], v[164:165], v[26:27] op_sel_hi:[1,0]
v_pk_mul_f32 v[166:167], v[166:167], v[26:27] op_sel_hi:[1,0]
v_pk_mul_f32 v[168:169], v[168:169], v[26:27] op_sel_hi:[1,0]
v_pk_mul_f32 v[170:171], v[170:171], v[26:27] op_sel_hi:[1,0]
v_pk_mul_f32 v[172:173], v[172:173], v[26:27] op_sel_hi:[1,0]
v_pk_mul_f32 v[174:175], v[174:175], v[26:27] op_sel_hi:[1,0]
v_cvt_pk_bf16_f32 v160, v160, v161
v_cvt_pk_bf16_f32 v161, v162, v163
v_cvt_pk_bf16_f32 v162, v164, v165
v_cvt_pk_bf16_f32 v163, v166, v167
buffer_store_dwordx4 v[160:163], v6, s[8:11], s26 offen offset:1024 sc1
v_cvt_pk_bf16_f32 v168, v168, v169
v_cvt_pk_bf16_f32 v169, v170, v171
v_cvt_pk_bf16_f32 v170, v172, v173
v_cvt_pk_bf16_f32 v171, v174, v175
buffer_store_dwordx4 v[168:171], v6, s[8:11], s26 offen offset:1536 sc1
v_pk_mul_f32 v[192:193], v[192:193], v[26:27] op_sel_hi:[1,0]
v_pk_mul_f32 v[194:195], v[194:195], v[26:27] op_sel_hi:[1,0]
v_pk_mul_f32 v[196:197], v[196:197], v[26:27] op_sel_hi:[1,0]
v_pk_mul_f32 v[198:199], v[198:199], v[26:27] op_sel_hi:[1,0]
v_pk_mul_f32 v[200:201], v[200:201], v[26:27] op_sel_hi:[1,0]
v_pk_mul_f32 v[202:203], v[202:203], v[26:27] op_sel_hi:[1,0]
v_pk_mul_f32 v[204:205], v[204:205], v[26:27] op_sel_hi:[1,0]
v_pk_mul_f32 v[206:207], v[206:207], v[26:27] op_sel_hi:[1,0]
v_cvt_pk_bf16_f32 v192, v192, v193
v_cvt_pk_bf16_f32 v193, v194, v195
v_cvt_pk_bf16_f32 v194, v196, v197
v_cvt_pk_bf16_f32 v195, v198, v199
buffer_store_dwordx4 v[192:195], v6, s[8:11], s26 offen offset:2048 sc1
v_cvt_pk_bf16_f32 v200, v200, v201
v_cvt_pk_bf16_f32 v201, v202, v203
v_cvt_pk_bf16_f32 v202, v204, v205
v_cvt_pk_bf16_f32 v203, v206, v207
buffer_store_dwordx4 v[200:203], v6, s[8:11], s26 offen offset:2560 sc1
v_pk_mul_f32 v[224:225], v[224:225], v[26:27] op_sel_hi:[1,0]
v_pk_mul_f32 v[226:227], v[226:227], v[26:27] op_sel_hi:[1,0]
v_pk_mul_f32 v[228:229], v[228:229], v[26:27] op_sel_hi:[1,0]
v_pk_mul_f32 v[230:231], v[230:231], v[26:27] op_sel_hi:[1,0]
v_pk_mul_f32 v[232:233], v[232:233], v[26:27] op_sel_hi:[1,0]
v_pk_mul_f32 v[234:235], v[234:235], v[26:27] op_sel_hi:[1,0]
v_pk_mul_f32 v[236:237], v[236:237], v[26:27] op_sel_hi:[1,0]
v_pk_mul_f32 v[238:239], v[238:239], v[26:27] op_sel_hi:[1,0]
v_cvt_pk_bf16_f32 v224, v224, v225
v_cvt_pk_bf16_f32 v225, v226, v227
v_cvt_pk_bf16_f32 v226, v228, v229
v_cvt_pk_bf16_f32 v227, v230, v231
buffer_store_dwordx4 v[224:227], v6, s[8:11], s26 offen offset:3072 sc1
v_cvt_pk_bf16_f32 v232, v232, v233
v_cvt_pk_bf16_f32 v233, v234, v235
v_cvt_pk_bf16_f32 v234, v236, v237
v_cvt_pk_bf16_f32 v235, v238, v239
buffer_store_dwordx4 v[232:235], v6, s[8:11], s26 offen offset:3584 sc1
s_lshl_b32 s26, s47, 2
s_add_u32 s26, s26, 111157248
v_mov_b32 v26, 1
s_waitcnt vmcnt(0)
s_mov_b64 exec, 1
buffer_store_dword v26, v4, s[8:11], s26 offen sc1
s_mov_b64 exec, -1
s_mov_b32 s47, s48
s_cmp_lt_u32 s47, 2048
s_cbranch_scc1 L_bt
L_bt_x:
s_branch L_done
L_bo:
s_mov_b64 s[42:43], s[4:5]
s_mov_b32 s51, s27
s_mov_b32 s40, s26
s_mov_b32 s44, 83886080
s_mov_b32 s45, 111157248
s_mov_b32 s46, 1
s_mov_b32 s47, 1152
s_load_dwordx2 s[4:5], s[0:1], 88
s_waitcnt lgkmcnt(0)
s_mov_b32 s20, s4
s_and_b32 s21, s5, 0xffff
s_mov_b32 s22, 4718592
s_mov_b32 s23, 0x20000
L_op:
s_load_dwordx2 s[4:5], s[0:1], 104
s_waitcnt lgkmcnt(0)
s_mov_b32 s12, s4
s_and_b32 s13, s5, 0xffff
s_mov_b32 s14, 4718592
s_mov_b32 s15, 0x20000
v_and_b32 v1, 63, v0
v_lshlrev_b32 v1, 4, v1
v_bfe_u32 v12, v0, 3, 3
v_mul_u32_u24 v12, 1152, v12
v_bfe_u32 v13, v0, 4, 2
v_lshlrev_b32 v13, 1, v13
v_and_b32 v14, 7, v0
v_xor_b32 v13, v13, v14
v_lshl_add_u32 v12, v13, 4, v12
s_mul_i32 s24, s17, 1179648
s_lshl_b32 s25, s40, 7
s_add_u32 s24, s24, s25
v_add_u32 v2, s24, v12
s_lshl_b32 s26, s17, 15
v_bfe_u32 v12, v0, 2, 3
v_lshlrev_b32 v12, 7, v12
v_bfe_u32 v13, v0, 5, 1
v_lshl_add_u32 v12, v13, 11, v12
v_bfe_u32 v13, v0, 3, 2
v_lshl_add_u32 v12, v13, 5, v12
v_and_b32 v13, 3, v0
v_lshl_add_u32 v12, v13, 3, v12
v_add_u32 v8, s26, v12
v_xor_b32 v9, 32, v8
v_xor_b32 v10, 64, v8
v_xor_b32 v11, 96, v8
s_add_u32 s24, s40, 0
s_and_b32 s24, s24, 7
s_lshl_b32 s30, s24, 12
s_add_u32 s24, s40, 1
s_and_b32 s24, s24, 7
s_lshl_b32 s31, s24, 12
s_add_u32 s24, s40, 2
s_and_b32 s24, s24, 7
s_lshl_b32 s32, s24, 12
s_add_u32 s24, s40, 3
s_and_b32 s24, s24, 7
s_lshl_b32 s33, s24, 12
s_add_u32 s24, s40, 4
s_and_b32 s24, s24, 7
s_lshl_b32 s34, s24, 12
s_add_u32 s24, s40, 5
s_and_b32 s24, s24, 7
s_lshl_b32 s35, s24, 12
s_add_u32 s24, s40, 6
s_and_b32 s24, s24, 7
s_lshl_b32 s36, s24, 12
s_add_u32 s24, s40, 7
s_and_b32 s24, s24, 7
s_lshl_b32 s37, s24, 12
s_mul_i32 s25, s30, 36
s_add_u32 m0, s26, 0
s_add_u32 s24, s25, 0
buffer_load_dwordx4 v2, s[20:23], s24 offen lds
s_add_u32 m0, s26, 1024
s_add_u32 s24, s25, 9216
buffer_load_dwordx4 v2, s[20:23], s24 offen lds
s_add_u32 m0, s26, 2048
s_add_u32 s24, s25, 18432
buffer_load_dwordx4 v2, s[20:23], s24 offen lds
s_add_u32 m0, s26, 3072
s_add_u32 s24, s25, 27648
buffer_load_dwordx4 v2, s[20:23], s24 offen lds
s_mul_i32 s25, s30, 36
s_add_u32 m0, s26, 4096
s_add_u32 s24, s25, 36864
buffer_load_dwordx4 v2, s[20:23], s24 offen lds
s_add_u32 m0, s26, 5120
s_add_u32 s24, s25, 46080
buffer_load_dwordx4 v2, s[20:23], s24 offen lds
s_add_u32 m0, s26, 6144
s_add_u32 s24, s25, 55296
buffer_load_dwordx4 v2, s[20:23], s24 offen lds
s_add_u32 m0, s26, 7168
s_add_u32 s24, s25, 64512
buffer_load_dwordx4 v2, s[20:23], s24 offen lds
s_mul_i32 s25, s30, 36
s_add_u32 m0, s26, 8192
s_add_u32 s24, s25, 73728
buffer_load_dwordx4 v2, s[20:23], s24 offen lds
s_add_u32 m0, s26, 9216
s_add_u32 s24, s25, 82944
buffer_load_dwordx4 v2, s[20:23], s24 offen lds
s_add_u32 m0, s26, 10240
s_add_u32 s24, s25, 92160
buffer_load_dwordx4 v2, s[20:23], s24 offen lds
s_add_u32 m0, s26, 11264
s_add_u32 s24, s25, 101376
buffer_load_dwordx4 v2, s[20:23], s24 offen lds
s_mul_i32 s25, s31, 36
s_add_u32 m0, s26, 12288
s_add_u32 s24, s25, 0
buffer_load_dwordx4 v2, s[20:23], s24 offen lds
s_add_u32 m0, s26, 13312
s_add_u32 s24, s25, 9216
buffer_load_dwordx4 v2, s[20:23], s24 offen lds
s_add_u32 m0, s26, 14336
s_add_u32 s24, s25, 18432
buffer_load_dwordx4 v2, s[20:23], s24 offen lds
s_add_u32 m0, s26, 15360
s_add_u32 s24, s25, 27648
buffer_load_dwordx4 v2, s[20:23], s24 offen lds
s_mul_i32 s25, s31, 36
s_add_u32 m0, s26, 16384
s_add_u32 s24, s25, 36864
buffer_load_dwordx4 v2, s[20:23], s24 offen lds
s_add_u32 m0, s26, 17408
s_add_u32 s24, s25, 46080
buffer_load_dwordx4 v2, s[20:23], s24 offen lds
s_add_u32 m0, s26, 18432
s_add_u32 s24, s25, 55296
buffer_load_dwordx4 v2, s[20:23], s24 offen lds
s_add_u32 m0, s26, 19456
s_add_u32 s24, s25, 64512
buffer_load_dwordx4 v2, s[20:23], s24 offen lds
s_mul_i32 s25, s31, 36
s_add_u32 m0, s26, 20480
s_add_u32 s24, s25, 73728
buffer_load_dwordx4 v2, s[20:23], s24 offen lds
s_add_u32 m0, s26, 21504
s_add_u32 s24, s25, 82944
buffer_load_dwordx4 v2, s[20:23], s24 offen lds
s_add_u32 m0, s26, 22528
s_add_u32 s24, s25, 92160
buffer_load_dwordx4 v2, s[20:23], s24 offen lds
s_add_u32 m0, s26, 23552
s_add_u32 s24, s25, 101376
buffer_load_dwordx4 v2, s[20:23], s24 offen lds
s_mul_i32 s25, s32, 36
s_add_u32 m0, s26, 24576
s_add_u32 s24, s25, 0
buffer_load_dwordx4 v2, s[20:23], s24 offen lds
s_add_u32 m0, s26, 25600
s_add_u32 s24, s25, 9216
buffer_load_dwordx4 v2, s[20:23], s24 offen lds
s_add_u32 m0, s26, 26624
s_add_u32 s24, s25, 18432
buffer_load_dwordx4 v2, s[20:23], s24 offen lds
s_add_u32 m0, s26, 27648
s_add_u32 s24, s25, 27648
buffer_load_dwordx4 v2, s[20:23], s24 offen lds
s_mul_i32 s25, s32, 36
s_add_u32 m0, s26, 28672
s_add_u32 s24, s25, 36864
buffer_load_dwordx4 v2, s[20:23], s24 offen lds
s_add_u32 m0, s26, 29696
s_add_u32 s24, s25, 46080
buffer_load_dwordx4 v2, s[20:23], s24 offen lds
s_add_u32 m0, s26, 30720
s_add_u32 s24, s25, 55296
buffer_load_dwordx4 v2, s[20:23], s24 offen lds
s_add_u32 m0, s26, 31744
s_add_u32 s24, s25, 64512
buffer_load_dwordx4 v2, s[20:23], s24 offen lds
s_waitcnt vmcnt(28)
ds_read_b64_tr_b16 v[128:129], v8 offset:0
ds_read_b64_tr_b16 v[130:131], v8 offset:1024
ds_read_b64_tr_b16 v[132:133], v9 offset:0
ds_read_b64_tr_b16 v[134:135], v9 offset:1024
ds_read_b64_tr_b16 v[136:137], v10 offset:0
ds_read_b64_tr_b16 v[138:139], v10 offset:1024
ds_read_b64_tr_b16 v[140:141], v11 offset:0
ds_read_b64_tr_b16 v[142:143], v11 offset:1024
s_waitcnt lgkmcnt(0)
s_mul_i32 s25, s32, 36
s_add_u32 m0, s26, 0
s_add_u32 s24, s25, 73728
buffer_load_dwordx4 v2, s[20:23], s24 offen lds
s_add_u32 m0, s26, 1024
s_add_u32 s24, s25, 82944
buffer_load_dwordx4 v2, s[20:23], s24 offen lds
s_add_u32 m0, s26, 2048
s_add_u32 s24, s25, 92160
buffer_load_dwordx4 v2, s[20:23], s24 offen lds
s_add_u32 m0, s26, 3072
s_add_u32 s24, s25, 101376
buffer_load_dwordx4 v2, s[20:23], s24 offen lds
s_waitcnt vmcnt(28)
ds_read_b64_tr_b16 v[144:145], v8 offset:4096
ds_read_b64_tr_b16 v[146:147], v8 offset:5120
ds_read_b64_tr_b16 v[148:149], v9 offset:4096
ds_read_b64_tr_b16 v[150:151], v9 offset:5120
ds_read_b64_tr_b16 v[152:153], v10 offset:4096
ds_read_b64_tr_b16 v[154:155], v10 offset:5120
ds_read_b64_tr_b16 v[156:157], v11 offset:4096
ds_read_b64_tr_b16 v[158:159], v11 offset:5120
s_waitcnt lgkmcnt(0)
s_mul_i32 s25, s33, 36
s_add_u32 m0, s26, 4096
s_add_u32 s24, s25, 0
buffer_load_dwordx4 v2, s[20:23], s24 offen lds
s_add_u32 m0, s26, 5120
s_add_u32 s24, s25, 9216
buffer_load_dwordx4 v2, s[20:23], s24 offen lds
s_add_u32 m0, s26, 6144
s_add_u32 s24, s25, 18432
buffer_load_dwordx4 v2, s[20:23], s24 offen lds
s_add_u32 m0, s26, 7168
s_add_u32 s24, s25, 27648
buffer_load_dwordx4 v2, s[20:23], s24 offen lds
s_waitcnt vmcnt(28)
ds_read_b64_tr_b16 v[160:161], v8 offset:8192
ds_read_b64_tr_b16 v[162:163], v8 offset:9216
ds_read_b64_tr_b16 v[164:165], v9 offset:8192
ds_read_b64_tr_b16 v[166:167], v9 offset:9216
ds_read_b64_tr_b16 v[168:169], v10 offset:8192
ds_read_b64_tr_b16 v[170:171], v10 offset:9216
ds_read_b64_tr_b16 v[172:173], v11 offset:8192
ds_read_b64_tr_b16 v[174:175], v11 offset:9216
s_waitcnt lgkmcnt(0)
s_mul_i32 s25, s33, 36
s_add_u32 m0, s26, 8192
s_add_u32 s24, s25, 36864
buffer_load_dwordx4 v2, s[20:23], s24 offen lds
s_add_u32 m0, s26, 9216
s_add_u32 s24, s25, 46080
buffer_load_dwordx4 v2, s[20:23], s24 offen lds
s_add_u32 m0, s26, 10240
s_add_u32 s24, s25, 55296
buffer_load_dwordx4 v2, s[20:23], s24 offen lds
s_add_u32 m0, s26, 11264
s_add_u32 s24, s25, 64512
buffer_load_dwordx4 v2, s[20:23], s24 offen lds
s_waitcnt vmcnt(28)
ds_read_b64_tr_b16 v[176:177], v8 offset:12288
ds_read_b64_tr_b16 v[178:179], v8 offset:13312
ds_read_b64_tr_b16 v[180:181], v9 offset:12288
ds_read_b64_tr_b16 v[182:183], v9 offset:13312
ds_read_b64_tr_b16 v[184:185], v10 offset:12288
ds_read_b64_tr_b16 v[186:187], v10 offset:13312
ds_read_b64_tr_b16 v[188:189], v11 offset:12288
ds_read_b64_tr_b16 v[190:191], v11 offset:13312
s_waitcnt lgkmcnt(0)
s_mul_i32 s25, s33, 36
s_add_u32 m0, s26, 12288
s_add_u32 s24, s25, 73728
buffer_load_dwordx4 v2, s[20:23], s24 offen lds
s_add_u32 m0, s26, 13312
s_add_u32 s24, s25, 82944
buffer_load_dwordx4 v2, s[20:23], s24 offen lds
s_add_u32 m0, s26, 14336
s_add_u32 s24, s25, 92160
buffer_load_dwordx4 v2, s[20:23], s24 offen lds
s_add_u32 m0, s26, 15360
s_add_u32 s24, s25, 101376
buffer_load_dwordx4 v2, s[20:23], s24 offen lds
s_waitcnt vmcnt(28)
ds_read_b64_tr_b16 v[192:193], v8 offset:16384
ds_read_b64_tr_b16 v[194:195], v8 offset:17408
ds_read_b64_tr_b16 v[196:197], v9 offset:16384
ds_read_b64_tr_b16 v[198:199], v9 offset:17408
ds_read_b64_tr_b16 v[200:201], v10 offset:16384
ds_read_b64_tr_b16 v[202:203], v10 offset:17408
ds_read_b64_tr_b16 v[204:205], v11 offset:16384
ds_read_b64_tr_b16 v[206:207], v11 offset:17408
s_waitcnt lgkmcnt(0)
s_mul_i32 s25, s34, 36
s_add_u32 m0, s26, 16384
s_add_u32 s24, s25, 0
buffer_load_dwordx4 v2, s[20:23], s24 offen lds
s_add_u32 m0, s26, 17408
s_add_u32 s24, s25, 9216
buffer_load_dwordx4 v2, s[20:23], s24 offen lds
s_add_u32 m0, s26, 18432
s_add_u32 s24, s25, 18432
buffer_load_dwordx4 v2, s[20:23], s24 offen lds
s_add_u32 m0, s26, 19456
s_add_u32 s24, s25, 27648
buffer_load_dwordx4 v2, s[20:23], s24 offen lds
s_waitcnt vmcnt(28)
ds_read_b64_tr_b16 v[208:209], v8 offset:20480
ds_read_b64_tr_b16 v[210:211], v8 offset:21504
ds_read_b64_tr_b16 v[212:213], v9 offset:20480
ds_read_b64_tr_b16 v[214:215], v9 offset:21504
ds_read_b64_tr_b16 v[216:217], v10 offset:20480
ds_read_b64_tr_b16 v[218:219], v10 offset:21504
ds_read_b64_tr_b16 v[220:221], v11 offset:20480
ds_read_b64_tr_b16 v[222:223], v11 offset:21504
s_waitcnt lgkmcnt(0)
s_mul_i32 s25, s34, 36
s_add_u32 m0, s26, 20480
s_add_u32 s24, s25, 36864
buffer_load_dwordx4 v2, s[20:23], s24 offen lds
s_add_u32 m0, s26, 21504
s_add_u32 s24, s25, 46080
buffer_load_dwordx4 v2, s[20:23], s24 offen lds
s_add_u32 m0, s26, 22528
s_add_u32 s24, s25, 55296
buffer_load_dwordx4 v2, s[20:23], s24 offen lds
s_add_u32 m0, s26, 23552
s_add_u32 s24, s25, 64512
buffer_load_dwordx4 v2, s[20:23], s24 offen lds
s_waitcnt vmcnt(28)
ds_read_b64_tr_b16 v[224:225], v8 offset:24576
ds_read_b64_tr_b16 v[226:227], v8 offset:25600
ds_read_b64_tr_b16 v[228:229], v9 offset:24576
ds_read_b64_tr_b16 v[230:231], v9 offset:25600
ds_read_b64_tr_b16 v[232:233], v10 offset:24576
ds_read_b64_tr_b16 v[234:235], v10 offset:25600
ds_read_b64_tr_b16 v[236:237], v11 offset:24576
ds_read_b64_tr_b16 v[238:239], v11 offset:25600
s_waitcnt lgkmcnt(0)
s_mul_i32 s25, s34, 36
s_add_u32 m0, s26, 24576
s_add_u32 s24, s25, 73728
buffer_load_dwordx4 v2, s[20:23], s24 offen lds
s_add_u32 m0, s26, 25600
s_add_u32 s24, s25, 82944
buffer_load_dwordx4 v2, s[20:23], s24 offen lds
s_add_u32 m0, s26, 26624
s_add_u32 s24, s25, 92160
buffer_load_dwordx4 v2, s[20:23], s24 offen lds
s_add_u32 m0, s26, 27648
s_add_u32 s24, s25, 101376
buffer_load_dwordx4 v2, s[20:23], s24 offen lds
s_waitcnt vmcnt(28)
ds_read_b64_tr_b16 v[240:241], v8 offset:28672
ds_read_b64_tr_b16 v[242:243], v8 offset:29696
ds_read_b64_tr_b16 v[244:245], v9 offset:28672
ds_read_b64_tr_b16 v[246:247], v9 offset:29696
ds_read_b64_tr_b16 v[248:249], v10 offset:28672
ds_read_b64_tr_b16 v[250:251], v10 offset:29696
ds_read_b64_tr_b16 v[252:253], v11 offset:28672
ds_read_b64_tr_b16 v[254:255], v11 offset:29696
s_waitcnt lgkmcnt(0)
s_mul_i32 s25, s35, 36
s_add_u32 m0, s26, 28672
s_add_u32 s24, s25, 0
buffer_load_dwordx4 v2, s[20:23], s24 offen lds
s_add_u32 m0, s26, 29696
s_add_u32 s24, s25, 9216
buffer_load_dwordx4 v2, s[20:23], s24 offen lds
s_add_u32 m0, s26, 30720
s_add_u32 s24, s25, 18432
buffer_load_dwordx4 v2, s[20:23], s24 offen lds
s_add_u32 m0, s26, 31744
s_add_u32 s24, s25, 27648
buffer_load_dwordx4 v2, s[20:23], s24 offen lds
s_waitcnt vmcnt(28)
ds_read_b64_tr_b16 a[0:1], v8 offset:0
ds_read_b64_tr_b16 a[2:3], v8 offset:1024
ds_read_b64_tr_b16 a[4:5], v9 offset:0
ds_read_b64_tr_b16 a[6:7], v9 offset:1024
ds_read_b64_tr_b16 a[8:9], v10 offset:0
ds_read_b64_tr_b16 a[10:11], v10 offset:1024
ds_read_b64_tr_b16 a[12:13], v11 offset:0
ds_read_b64_tr_b16 a[14:15], v11 offset:1024
s_waitcnt lgkmcnt(0)
s_mul_i32 s25, s35, 36
s_add_u32 m0, s26, 0
s_add_u32 s24, s25, 36864
buffer_load_dwordx4 v2, s[20:23], s24 offen lds
s_add_u32 m0, s26, 1024
s_add_u32 s24, s25, 46080
buffer_load_dwordx4 v2, s[20:23], s24 offen lds
s_add_u32 m0, s26, 2048
s_add_u32 s24, s25, 55296
buffer_load_dwordx4 v2, s[20:23], s24 offen lds
s_add_u32 m0, s26, 3072
s_add_u32 s24, s25, 64512
buffer_load_dwordx4 v2, s[20:23], s24 offen lds
s_waitcnt vmcnt(28)
ds_read_b64_tr_b16 a[16:17], v8 offset:4096
ds_read_b64_tr_b16 a[18:19], v8 offset:5120
ds_read_b64_tr_b16 a[20:21], v9 offset:4096
ds_read_b64_tr_b16 a[22:23], v9 offset:5120
ds_read_b64_tr_b16 a[24:25], v10 offset:4096
ds_read_b64_tr_b16 a[26:27], v10 offset:5120
ds_read_b64_tr_b16 a[28:29], v11 offset:4096
ds_read_b64_tr_b16 a[30:31], v11 offset:5120
s_waitcnt lgkmcnt(0)
s_mul_i32 s25, s35, 36
s_add_u32 m0, s26, 4096
s_add_u32 s24, s25, 73728
buffer_load_dwordx4 v2, s[20:23], s24 offen lds
s_add_u32 m0, s26, 5120
s_add_u32 s24, s25, 82944
buffer_load_dwordx4 v2, s[20:23], s24 offen lds
s_add_u32 m0, s26, 6144
s_add_u32 s24, s25, 92160
buffer_load_dwordx4 v2, s[20:23], s24 offen lds
s_add_u32 m0, s26, 7168
s_add_u32 s24, s25, 101376
buffer_load_dwordx4 v2, s[20:23], s24 offen lds
s_waitcnt vmcnt(28)
ds_read_b64_tr_b16 a[32:33], v8 offset:8192
ds_read_b64_tr_b16 a[34:35], v8 offset:9216
ds_read_b64_tr_b16 a[36:37], v9 offset:8192
ds_read_b64_tr_b16 a[38:39], v9 offset:9216
ds_read_b64_tr_b16 a[40:41], v10 offset:8192
ds_read_b64_tr_b16 a[42:43], v10 offset:9216
ds_read_b64_tr_b16 a[44:45], v11 offset:8192
ds_read_b64_tr_b16 a[46:47], v11 offset:9216
s_waitcnt lgkmcnt(0)
s_mul_i32 s25, s36, 36
s_add_u32 m0, s26, 8192
s_add_u32 s24, s25, 0
buffer_load_dwordx4 v2, s[20:23], s24 offen lds
s_add_u32 m0, s26, 9216
s_add_u32 s24, s25, 9216
buffer_load_dwordx4 v2, s[20:23], s24 offen lds
s_add_u32 m0, s26, 10240
s_add_u32 s24, s25, 18432
buffer_load_dwordx4 v2, s[20:23], s24 offen lds
s_add_u32 m0, s26, 11264
s_add_u32 s24, s25, 27648
buffer_load_dwordx4 v2, s[20:23], s24 offen lds
s_waitcnt vmcnt(28)
ds_read_b64_tr_b16 a[48:49], v8 offset:12288
ds_read_b64_tr_b16 a[50:51], v8 offset:13312
ds_read_b64_tr_b16 a[52:53], v9 offset:12288
ds_read_b64_tr_b16 a[54:55], v9 offset:13312
ds_read_b64_tr_b16 a[56:57], v10 offset:12288
ds_read_b64_tr_b16 a[58:59], v10 offset:13312
ds_read_b64_tr_b16 a[60:61], v11 offset:12288
ds_read_b64_tr_b16 a[62:63], v11 offset:13312
s_waitcnt lgkmcnt(0)
s_mul_i32 s25, s36, 36
s_add_u32 m0, s26, 12288
s_add_u32 s24, s25, 36864
buffer_load_dwordx4 v2, s[20:23], s24 offen lds
s_add_u32 m0, s26, 13312
s_add_u32 s24, s25, 46080
buffer_load_dwordx4 v2, s[20:23], s24 offen lds
s_add_u32 m0, s26, 14336
s_add_u32 s24, s25, 55296
buffer_load_dwordx4 v2, s[20:23], s24 offen lds
s_add_u32 m0, s26, 15360
s_add_u32 s24, s25, 64512
buffer_load_dwordx4 v2, s[20:23], s24 offen lds
s_waitcnt vmcnt(28)
ds_read_b64_tr_b16 a[64:65], v8 offset:16384
ds_read_b64_tr_b16 a[66:67], v8 offset:17408
ds_read_b64_tr_b16 a[68:69], v9 offset:16384
ds_read_b64_tr_b16 a[70:71], v9 offset:17408
ds_read_b64_tr_b16 a[72:73], v10 offset:16384
ds_read_b64_tr_b16 a[74:75], v10 offset:17408
ds_read_b64_tr_b16 a[76:77], v11 offset:16384
ds_read_b64_tr_b16 a[78:79], v11 offset:17408
s_waitcnt lgkmcnt(0)
s_mul_i32 s25, s36, 36
s_add_u32 m0, s26, 16384
s_add_u32 s24, s25, 73728
buffer_load_dwordx4 v2, s[20:23], s24 offen lds
s_add_u32 m0, s26, 17408
s_add_u32 s24, s25, 82944
buffer_load_dwordx4 v2, s[20:23], s24 offen lds
s_add_u32 m0, s26, 18432
s_add_u32 s24, s25, 92160
buffer_load_dwordx4 v2, s[20:23], s24 offen lds
s_add_u32 m0, s26, 19456
s_add_u32 s24, s25, 101376
buffer_load_dwordx4 v2, s[20:23], s24 offen lds
s_waitcnt vmcnt(28)
ds_read_b64_tr_b16 a[80:81], v8 offset:20480
ds_read_b64_tr_b16 a[82:83], v8 offset:21504
ds_read_b64_tr_b16 a[84:85], v9 offset:20480
ds_read_b64_tr_b16 a[86:87], v9 offset:21504
ds_read_b64_tr_b16 a[88:89], v10 offset:20480
ds_read_b64_tr_b16 a[90:91], v10 offset:21504
ds_read_b64_tr_b16 a[92:93], v11 offset:20480
ds_read_b64_tr_b16 a[94:95], v11 offset:21504
s_waitcnt lgkmcnt(0)
s_mul_i32 s25, s37, 36
s_add_u32 m0, s26, 20480
s_add_u32 s24, s25, 0
buffer_load_dwordx4 v2, s[20:23], s24 offen lds
s_add_u32 m0, s26, 21504
s_add_u32 s24, s25, 9216
buffer_load_dwordx4 v2, s[20:23], s24 offen lds
s_add_u32 m0, s26, 22528
s_add_u32 s24, s25, 18432
buffer_load_dwordx4 v2, s[20:23], s24 offen lds
s_add_u32 m0, s26, 23552
s_add_u32 s24, s25, 27648
buffer_load_dwordx4 v2, s[20:23], s24 offen lds
s_waitcnt vmcnt(28)
ds_read_b64_tr_b16 a[96:97], v8 offset:24576
ds_read_b64_tr_b16 a[98:99], v8 offset:25600
ds_read_b64_tr_b16 a[100:101], v9 offset:24576
ds_read_b64_tr_b16 a[102:103], v9 offset:25600
ds_read_b64_tr_b16 a[104:105], v10 offset:24576
ds_read_b64_tr_b16 a[106:107], v10 offset:25600
ds_read_b64_tr_b16 a[108:109], v11 offset:24576
ds_read_b64_tr_b16 a[110:111], v11 offset:25600
s_waitcnt lgkmcnt(0)
s_mul_i32 s25, s37, 36
s_add_u32 m0, s26, 24576
s_add_u32 s24, s25, 36864
buffer_load_dwordx4 v2, s[20:23], s24 offen lds
s_add_u32 m0, s26, 25600
s_add_u32 s24, s25, 46080
buffer_load_dwordx4 v2, s[20:23], s24 offen lds
s_add_u32 m0, s26, 26624
s_add_u32 s24, s25, 55296
buffer_load_dwordx4 v2, s[20:23], s24 offen lds
s_add_u32 m0, s26, 27648
s_add_u32 s24, s25, 64512
buffer_load_dwordx4 v2, s[20:23], s24 offen lds
s_waitcnt vmcnt(28)
ds_read_b64_tr_b16 a[112:113], v8 offset:28672
ds_read_b64_tr_b16 a[114:115], v8 offset:29696
ds_read_b64_tr_b16 a[116:117], v9 offset:28672
ds_read_b64_tr_b16 a[118:119], v9 offset:29696
ds_read_b64_tr_b16 a[120:121], v10 offset:28672
ds_read_b64_tr_b16 a[122:123], v10 offset:29696
ds_read_b64_tr_b16 a[124:125], v11 offset:28672
ds_read_b64_tr_b16 a[126:127], v11 offset:29696
s_waitcnt lgkmcnt(0)
s_mul_i32 s25, s37, 36
s_add_u32 m0, s26, 28672
s_add_u32 s24, s25, 73728
buffer_load_dwordx4 v2, s[20:23], s24 offen lds
s_add_u32 m0, s26, 29696
s_add_u32 s24, s25, 82944
buffer_load_dwordx4 v2, s[20:23], s24 offen lds
s_add_u32 m0, s26, 30720
s_add_u32 s24, s25, 92160
buffer_load_dwordx4 v2, s[20:23], s24 offen lds
s_add_u32 m0, s26, 31744
s_add_u32 s24, s25, 101376
buffer_load_dwordx4 v2, s[20:23], s24 offen lds
s_waitcnt vmcnt(28)
ds_read_b64_tr_b16 a[128:129], v8 offset:0
ds_read_b64_tr_b16 a[130:131], v8 offset:1024
ds_read_b64_tr_b16 a[132:133], v9 offset:0
ds_read_b64_tr_b16 a[134:135], v9 offset:1024
ds_read_b64_tr_b16 a[136:137], v10 offset:0
ds_read_b64_tr_b16 a[138:139], v10 offset:1024
ds_read_b64_tr_b16 a[140:141], v11 offset:0
ds_read_b64_tr_b16 a[142:143], v11 offset:1024
s_waitcnt lgkmcnt(0)
s_mul_i32 s25, s30, 36
s_add_u32 m0, s26, 0
s_add_u32 s24, s25, 110592
buffer_load_dwordx4 v2, s[20:23], s24 offen lds
s_add_u32 m0, s26, 1024
s_add_u32 s24, s25, 119808
buffer_load_dwordx4 v2, s[20:23], s24 offen lds
s_add_u32 m0, s26, 2048
s_add_u32 s24, s25, 129024
buffer_load_dwordx4 v2, s[20:23], s24 offen lds
s_add_u32 m0, s26, 3072
s_add_u32 s24, s25, 138240
buffer_load_dwordx4 v2, s[20:23], s24 offen lds
s_waitcnt vmcnt(28)
ds_read_b64_tr_b16 a[144:145], v8 offset:4096
ds_read_b64_tr_b16 a[146:147], v8 offset:5120
ds_read_b64_tr_b16 a[148:149], v9 offset:4096
ds_read_b64_tr_b16 a[150:151], v9 offset:5120
ds_read_b64_tr_b16 a[152:153], v10 offset:4096
ds_read_b64_tr_b16 a[154:155], v10 offset:5120
ds_read_b64_tr_b16 a[156:157], v11 offset:4096
ds_read_b64_tr_b16 a[158:159], v11 offset:5120
s_waitcnt lgkmcnt(0)
s_mul_i32 s25, s31, 36
s_add_u32 m0, s26, 4096
s_add_u32 s24, s25, 110592
buffer_load_dwordx4 v2, s[20:23], s24 offen lds
s_add_u32 m0, s26, 5120
s_add_u32 s24, s25, 119808
buffer_load_dwordx4 v2, s[20:23], s24 offen lds
s_add_u32 m0, s26, 6144
s_add_u32 s24, s25, 129024
buffer_load_dwordx4 v2, s[20:23], s24 offen lds
s_add_u32 m0, s26, 7168
s_add_u32 s24, s25, 138240
buffer_load_dwordx4 v2, s[20:23], s24 offen lds
s_waitcnt vmcnt(28)
ds_read_b64_tr_b16 a[160:161], v8 offset:8192
ds_read_b64_tr_b16 a[162:163], v8 offset:9216
ds_read_b64_tr_b16 a[164:165], v9 offset:8192
ds_read_b64_tr_b16 a[166:167], v9 offset:9216
ds_read_b64_tr_b16 a[168:169], v10 offset:8192
ds_read_b64_tr_b16 a[170:171], v10 offset:9216
ds_read_b64_tr_b16 a[172:173], v11 offset:8192
ds_read_b64_tr_b16 a[174:175], v11 offset:9216
s_waitcnt lgkmcnt(0)
s_mul_i32 s25, s32, 36
s_add_u32 m0, s26, 8192
s_add_u32 s24, s25, 110592
buffer_load_dwordx4 v2, s[20:23], s24 offen lds
s_add_u32 m0, s26, 9216
s_add_u32 s24, s25, 119808
buffer_load_dwordx4 v2, s[20:23], s24 offen lds
s_add_u32 m0, s26, 10240
s_add_u32 s24, s25, 129024
buffer_load_dwordx4 v2, s[20:23], s24 offen lds
s_add_u32 m0, s26, 11264
s_add_u32 s24, s25, 138240
buffer_load_dwordx4 v2, s[20:23], s24 offen lds
s_waitcnt vmcnt(28)
ds_read_b64_tr_b16 a[176:177], v8 offset:12288
ds_read_b64_tr_b16 a[178:179], v8 offset:13312
ds_read_b64_tr_b16 a[180:181], v9 offset:12288
ds_read_b64_tr_b16 a[182:183], v9 offset:13312
ds_read_b64_tr_b16 a[184:185], v10 offset:12288
ds_read_b64_tr_b16 a[186:187], v10 offset:13312
ds_read_b64_tr_b16 a[188:189], v11 offset:12288
ds_read_b64_tr_b16 a[190:191], v11 offset:13312
s_waitcnt lgkmcnt(0)
s_mul_i32 s25, s33, 36
s_add_u32 m0, s26, 12288
s_add_u32 s24, s25, 110592
buffer_load_dwordx4 v2, s[20:23], s24 offen lds
s_add_u32 m0, s26, 13312
s_add_u32 s24, s25, 119808
buffer_load_dwordx4 v2, s[20:23], s24 offen lds
s_add_u32 m0, s26, 14336
s_add_u32 s24, s25, 129024
buffer_load_dwordx4 v2, s[20:23], s24 offen lds
s_add_u32 m0, s26, 15360
s_add_u32 s24, s25, 138240
buffer_load_dwordx4 v2, s[20:23], s24 offen lds
s_waitcnt vmcnt(28)
ds_read_b64_tr_b16 a[192:193], v8 offset:16384
ds_read_b64_tr_b16 a[194:195], v8 offset:17408
ds_read_b64_tr_b16 a[196:197], v9 offset:16384
ds_read_b64_tr_b16 a[198:199], v9 offset:17408
ds_read_b64_tr_b16 a[200:201], v10 offset:16384
ds_read_b64_tr_b16 a[202:203], v10 offset:17408
ds_read_b64_tr_b16 a[204:205], v11 offset:16384
ds_read_b64_tr_b16 a[206:207], v11 offset:17408
s_waitcnt lgkmcnt(0)
s_mul_i32 s25, s34, 36
s_add_u32 m0, s26, 16384
s_add_u32 s24, s25, 110592
buffer_load_dwordx4 v2, s[20:23], s24 offen lds
s_add_u32 m0, s26, 17408
s_add_u32 s24, s25, 119808
buffer_load_dwordx4 v2, s[20:23], s24 offen lds
s_add_u32 m0, s26, 18432
s_add_u32 s24, s25, 129024
buffer_load_dwordx4 v2, s[20:23], s24 offen lds
s_add_u32 m0, s26, 19456
s_add_u32 s24, s25, 138240
buffer_load_dwordx4 v2, s[20:23], s24 offen lds
s_waitcnt vmcnt(28)
ds_read_b64_tr_b16 a[208:209], v8 offset:20480
ds_read_b64_tr_b16 a[210:211], v8 offset:21504
ds_read_b64_tr_b16 a[212:213], v9 offset:20480
ds_read_b64_tr_b16 a[214:215], v9 offset:21504
ds_read_b64_tr_b16 a[216:217], v10 offset:20480
ds_read_b64_tr_b16 a[218:219], v10 offset:21504
ds_read_b64_tr_b16 a[220:221], v11 offset:20480
ds_read_b64_tr_b16 a[222:223], v11 offset:21504
s_waitcnt lgkmcnt(0)
s_mul_i32 s25, s35, 36
s_add_u32 m0, s26, 20480
s_add_u32 s24, s25, 110592
buffer_load_dwordx4 v2, s[20:23], s24 offen lds
s_add_u32 m0, s26, 21504
s_add_u32 s24, s25, 119808
buffer_load_dwordx4 v2, s[20:23], s24 offen lds
s_add_u32 m0, s26, 22528
s_add_u32 s24, s25, 129024
buffer_load_dwordx4 v2, s[20:23], s24 offen lds
s_add_u32 m0, s26, 23552
s_add_u32 s24, s25, 138240
buffer_load_dwordx4 v2, s[20:23], s24 offen lds
s_waitcnt vmcnt(28)
ds_read_b64_tr_b16 a[224:225], v8 offset:24576
ds_read_b64_tr_b16 a[226:227], v8 offset:25600
ds_read_b64_tr_b16 a[228:229], v9 offset:24576
ds_read_b64_tr_b16 a[230:231], v9 offset:25600
ds_read_b64_tr_b16 a[232:233], v10 offset:24576
ds_read_b64_tr_b16 a[234:235], v10 offset:25600
ds_read_b64_tr_b16 a[236:237], v11 offset:24576
ds_read_b64_tr_b16 a[238:239], v11 offset:25600
s_waitcnt lgkmcnt(0)
s_mul_i32 s25, s36, 36
s_add_u32 m0, s26, 24576
s_add_u32 s24, s25, 110592
buffer_load_dwordx4 v2, s[20:23], s24 offen lds
s_add_u32 m0, s26, 25600
s_add_u32 s24, s25, 119808
buffer_load_dwordx4 v2, s[20:23], s24 offen lds
s_add_u32 m0, s26, 26624
s_add_u32 s24, s25, 129024
buffer_load_dwordx4 v2, s[20:23], s24 offen lds
s_add_u32 m0, s26, 27648
s_add_u32 s24, s25, 138240
buffer_load_dwordx4 v2, s[20:23], s24 offen lds
s_waitcnt vmcnt(28)
ds_read_b64_tr_b16 a[240:241], v8 offset:28672
ds_read_b64_tr_b16 a[242:243], v8 offset:29696
ds_read_b64_tr_b16 a[244:245], v9 offset:28672
ds_read_b64_tr_b16 a[246:247], v9 offset:29696
ds_read_b64_tr_b16 a[248:249], v10 offset:28672
ds_read_b64_tr_b16 a[250:251], v10 offset:29696
ds_read_b64_tr_b16 a[252:253], v11 offset:28672
ds_read_b64_tr_b16 a[254:255], v11 offset:29696
s_waitcnt lgkmcnt(0)
s_mul_i32 s25, s37, 36
s_add_u32 m0, s26, 28672
s_add_u32 s24, s25, 110592
buffer_load_dwordx4 v2, s[20:23], s24 offen lds
s_add_u32 m0, s26, 29696
s_add_u32 s24, s25, 119808
buffer_load_dwordx4 v2, s[20:23], s24 offen lds
s_add_u32 m0, s26, 30720
s_add_u32 s24, s25, 129024
buffer_load_dwordx4 v2, s[20:23], s24 offen lds
s_add_u32 m0, s26, 31744
s_add_u32 s24, s25, 138240
buffer_load_dwordx4 v2, s[20:23], s24 offen lds
s_waitcnt vmcnt(0)
v_and_b32 v12, 15, v0
v_mul_u32_u24 v12, 2304, v12
v_lshrrev_b32 v13, 4, v0
v_lshl_add_u32 v12, v13, 3, v12
s_lshl_b32 s24, s40, 7
s_add_u32 s24, s24, s47
v_add_u32 v4, s24, v12
v_and_b32 v5, 7, v0
v_lshlrev_b32 v5, 2, v5
s_lshl_b32 s24, s17, 5
v_add_u32 v5, s24, v5
v_lshlrev_b32 v3, 4, v0
v_add_u32 v3, 131072, v3
s_lshl_b32 s24, s17, 12
s_add_u32 s24, s24, 131072
v_add_u32 v7, s24, v1
s_lshl_b32 s24, s17, 15
s_add_u32 s44, s44, s24
ds_read_b64_tr_b16 v[112:113], v8 offset:0
ds_read_b64_tr_b16 v[114:115], v8 offset:1024
ds_read_b64_tr_b16 v[116:117], v9 offset:0
ds_read_b64_tr_b16 v[118:119], v9 offset:1024
ds_read_b64_tr_b16 v[120:121], v10 offset:0
ds_read_b64_tr_b16 v[122:123], v10 offset:1024
ds_read_b64_tr_b16 v[124:125], v11 offset:0
ds_read_b64_tr_b16 v[126:127], v11 offset:1024
s_ff1_i32_b64 s41, s[42:43]
s_bitset0_b64 s[42:43], s41
s_lshl_b32 s41, s41, 1
s_add_u32 s41, s41, s51
s_and_b32 s41, s41, 127
L_opl_w:
s_lshr_b32 s25, s41, s46
s_lshl_b32 s25, s25, 7
s_add_u32 s25, s25, s45
s_mov_b32 s28, 0
L_poll_34:
buffer_load_dword v6, v5, s[8:11], s25 offen sc1
s_add_u32 s28, s28, 1
s_cmp_gt_u32 s28, 40000
s_cbranch_scc1 L_end
s_waitcnt vmcnt(0)
v_cmp_ne_u32 vcc, 1, v6
s_cbranch_vccz L_pd_35
s_sleep 1
s_branch L_poll_34
L_pd_35:
s_lshl_b32 s48, s41, 17
s_add_u32 s48, s48, s44
s_add_u32 s24, s48, s30
buffer_load_dwordx4 v[16:19], v1, s[8:11], s24 offen offset:0 sc1
buffer_load_dwordx4 v[20:23], v1, s[8:11], s24 offen offset:1024 sc1
buffer_load_dwordx4 v[24:27], v1, s[8:11], s24 offen offset:2048 sc1
buffer_load_dwordx4 v[28:31], v1, s[8:11], s24 offen offset:3072 sc1
s_add_u32 s24, s48, s31
buffer_load_dwordx4 v[32:35], v1, s[8:11], s24 offen offset:0 sc1
buffer_load_dwordx4 v[36:39], v1, s[8:11], s24 offen offset:1024 sc1
buffer_load_dwordx4 v[40:43], v1, s[8:11], s24 offen offset:2048 sc1
buffer_load_dwordx4 v[44:47], v1, s[8:11], s24 offen offset:3072 sc1
s_add_u32 s24, s48, s32
buffer_load_dwordx4 v[48:51], v1, s[8:11], s24 offen offset:0 sc1
buffer_load_dwordx4 v[52:55], v1, s[8:11], s24 offen offset:1024 sc1
buffer_load_dwordx4 v[56:59], v1, s[8:11], s24 offen offset:2048 sc1
buffer_load_dwordx4 v[60:63], v1, s[8:11], s24 offen offset:3072 sc1
s_add_u32 s24, s48, s33
buffer_load_dwordx4 v[64:67], v1, s[8:11], s24 offen offset:0 sc1
buffer_load_dwordx4 v[68:71], v1, s[8:11], s24 offen offset:1024 sc1
buffer_load_dwordx4 v[72:75], v1, s[8:11], s24 offen offset:2048 sc1
buffer_load_dwordx4 v[76:79], v1, s[8:11], s24 offen offset:3072 sc1
s_add_u32 s24, s48, s34
buffer_load_dwordx4 v[80:83], v1, s[8:11], s24 offen offset:0 sc1
buffer_load_dwordx4 v[84:87], v1, s[8:11], s24 offen offset:1024 sc1
buffer_load_dwordx4 v[88:91], v1, s[8:11], s24 offen offset:2048 sc1
buffer_load_dwordx4 v[92:95], v1, s[8:11], s24 offen offset:3072 sc1
buffer_load_dword v6, v5, s[8:11], s25 offen sc1
L_opl_r0:
s_cmp_lg_u64 s[42:43], 0
s_cselect_b32 s52, 1, 0
s_ff1_i32_b64 s27, s[42:43]
s_bitset0_b64 s[42:43], s27
s_lshl_b32 s27, s27, 1
s_add_u32 s27, s27, s51
s_and_b32 s27, s27, 127
s_lshr_b32 s25, s27, s46
s_lshl_b32 s25, s25, 7
s_add_u32 s25, s25, s45
buffer_load_dword v6, v5, s[8:11], s25 offen sc1
s_lshl_b32 s49, s27, 17
s_add_u32 s49, s49, s44
s_waitcnt vmcnt(21)
v_mfma_f32_16x16x32_bf16 v[96:99], v[128:131], v[16:19], 0
v_mfma_f32_16x16x32_bf16 v[100:103], v[132:135], v[16:19], 0
v_mfma_f32_16x16x32_bf16 v[104:107], v[136:139], v[16:19], 0
v_mfma_f32_16x16x32_bf16 v[108:111], v[140:143], v[16:19], 0
s_add_u32 s24, s48, s35
buffer_load_dwordx4 v[16:19], v1, s[8:11], s24 offen offset:0 sc1
s_waitcnt vmcnt(21)
v_mfma_f32_16x16x32_bf16 v[96:99], v[144:147], v[20:23], v[96:99]
v_mfma_f32_16x16x32_bf16 v[100:103], v[148:151], v[20:23], v[100:103]
v_mfma_f32_16x16x32_bf16 v[104:107], v[152:155], v[20:23], v[104:107]
v_mfma_f32_16x16x32_bf16 v[108:111], v[156:159], v[20:23], v[108:111]
buffer_load_dwordx4 v[20:23], v1, s[8:11], s24 offen offset:1024 sc1
s_waitcnt vmcnt(21)
v_mfma_f32_16x16x32_bf16 v[96:99], v[160:163], v[24:27], v[96:99]
v_mfma_f32_16x16x32_bf16 v[100:103], v[164:167], v[24:27], v[100:103]
v_mfma_f32_16x16x32_bf16 v[104:107], v[168:171], v[24:27], v[104:107]
v_mfma_f32_16x16x32_bf16 v[108:111], v[172:175], v[24:27], v[108:111]
buffer_load_dwordx4 v[24:27], v1, s[8:11], s24 offen offset:2048 sc1
s_waitcnt vmcnt(21) lgkmcnt(0)
v_mfma_f32_16x16x32_bf16 v[96:99], v[112:115], v[28:31], v[96:99]
v_mfma_f32_16x16x32_bf16 v[100:103], v[116:119], v[28:31], v[100:103]
v_mfma_f32_16x16x32_bf16 v[104:107], v[120:123], v[28:31], v[104:107]
v_mfma_f32_16x16x32_bf16 v[108:111], v[124:127], v[28:31], v[108:111]
buffer_load_dwordx4 v[28:31], v1, s[8:11], s24 offen offset:3072 sc1
s_waitcnt vmcnt(21)
v_mfma_f32_16x16x32_bf16 v[96:99], v[176:179], v[32:35], v[96:99]
ds_read_b64_tr_b16 v[112:113], v8 offset:4096
v_mfma_f32_16x16x32_bf16 v[100:103], v[180:183], v[32:35], v[100:103]
ds_read_b64_tr_b16 v[114:115], v8 offset:5120
v_mfma_f32_16x16x32_bf16 v[104:107], v[184:187], v[32:35], v[104:107]
ds_read_b64_tr_b16 v[116:117], v9 offset:4096
v_mfma_f32_16x16x32_bf16 v[108:111], v[188:191], v[32:35], v[108:111]
ds_read_b64_tr_b16 v[118:119], v9 offset:5120
s_add_u32 s24, s48, s36
buffer_load_dwordx4 v[32:35], v1, s[8:11], s24 offen offset:0 sc1
s_waitcnt vmcnt(21)
v_mfma_f32_16x16x32_bf16 v[96:99], v[192:195], v[36:39], v[96:99]
ds_read_b64_tr_b16 v[120:121], v10 offset:4096
v_mfma_f32_16x16x32_bf16 v[100:103], v[196:199], v[36:39], v[100:103]
ds_read_b64_tr_b16 v[122:123], v10 offset:5120
v_mfma_f32_16x16x32_bf16 v[104:107], v[200:203], v[36:39], v[104:107]
ds_read_b64_tr_b16 v[124:125], v11 offset:4096
v_mfma_f32_16x16x32_bf16 v[108:111], v[204:207], v[36:39], v[108:111]
ds_read_b64_tr_b16 v[126:127], v11 offset:5120
buffer_load_dwordx4 v[36:39], v1, s[8:11], s24 offen offset:1024 sc1
s_waitcnt vmcnt(21)
v_mfma_f32_16x16x32_bf16 v[96:99], v[208:211], v[40:43], v[96:99]
v_mfma_f32_16x16x32_bf16 v[100:103], v[212:215], v[40:43], v[100:103]
v_mfma_f32_16x16x32_bf16 v[104:107], v[216:219], v[40:43], v[104:107]
v_mfma_f32_16x16x32_bf16 v[108:111], v[220:223], v[40:43], v[108:111]
buffer_load_dwordx4 v[40:43], v1, s[8:11], s24 offen offset:2048 sc1
s_waitcnt vmcnt(21) lgkmcnt(0)
v_mfma_f32_16x16x32_bf16 v[96:99], v[112:115], v[44:47], v[96:99]
v_mfma_f32_16x16x32_bf16 v[100:103], v[116:119], v[44:47], v[100:103]
v_mfma_f32_16x16x32_bf16 v[104:107], v[120:123], v[44:47], v[104:107]
v_mfma_f32_16x16x32_bf16 v[108:111], v[124:127], v[44:47], v[108:111]
buffer_load_dwordx4 v[44:47], v1, s[8:11], s24 offen offset:3072 sc1
s_waitcnt vmcnt(21)
v_mfma_f32_16x16x32_bf16 v[96:99], v[224:227], v[48:51], v[96:99]
ds_read_b64_tr_b16 v[112:113], v8 offset:8192
v_mfma_f32_16x16x32_bf16 v[100:103], v[228:231], v[48:51], v[100:103]
ds_read_b64_tr_b16 v[114:115], v8 offset:9216
v_mfma_f32_16x16x32_bf16 v[104:107], v[232:235], v[48:51], v[104:107]
ds_read_b64_tr_b16 v[116:117], v9 offset:8192
v_mfma_f32_16x16x32_bf16 v[108:111], v[236:239], v[48:51], v[108:111]
ds_read_b64_tr_b16 v[118:119], v9 offset:9216
s_add_u32 s24, s48, s37
buffer_load_dwordx4 v[48:51], v1, s[8:11], s24 offen offset:0 sc1
s_waitcnt vmcnt(21)
v_mfma_f32_16x16x32_bf16 v[96:99], v[240:243], v[52:55], v[96:99]
ds_read_b64_tr_b16 v[120:121], v10 offset:8192
v_mfma_f32_16x16x32_bf16 v[100:103], v[244:247], v[52:55], v[100:103]
ds_read_b64_tr_b16 v[122:123], v10 offset:9216
v_mfma_f32_16x16x32_bf16 v[104:107], v[248:251], v[52:55], v[104:107]
ds_read_b64_tr_b16 v[124:125], v11 offset:8192
v_mfma_f32_16x16x32_bf16 v[108:111], v[252:255], v[52:55], v[108:111]
ds_read_b64_tr_b16 v[126:127], v11 offset:9216
buffer_load_dwordx4 v[52:55], v1, s[8:11], s24 offen offset:1024 sc1
s_waitcnt vmcnt(21)
v_mfma_f32_16x16x32_bf16 v[96:99], a[0:3], v[56:59], v[96:99]
v_mfma_f32_16x16x32_bf16 v[100:103], a[4:7], v[56:59], v[100:103]
v_mfma_f32_16x16x32_bf16 v[104:107], a[8:11], v[56:59], v[104:107]
v_mfma_f32_16x16x32_bf16 v[108:111], a[12:15], v[56:59], v[108:111]
buffer_load_dwordx4 v[56:59], v1, s[8:11], s24 offen offset:2048 sc1
s_waitcnt vmcnt(21) lgkmcnt(0)
v_mfma_f32_16x16x32_bf16 v[96:99], v[112:115], v[60:63], v[96:99]
v_mfma_f32_16x16x32_bf16 v[100:103], v[116:119], v[60:63], v[100:103]
v_mfma_f32_16x16x32_bf16 v[104:107], v[120:123], v[60:63], v[104:107]
v_mfma_f32_16x16x32_bf16 v[108:111], v[124:127], v[60:63], v[108:111]
buffer_load_dwordx4 v[60:63], v1, s[8:11], s24 offen offset:3072 sc1
s_waitcnt vmcnt(21)
v_mfma_f32_16x16x32_bf16 v[96:99], a[16:19], v[64:67], v[96:99]
ds_read_b64_tr_b16 v[112:113], v8 offset:12288
v_mfma_f32_16x16x32_bf16 v[100:103], a[20:23], v[64:67], v[100:103]
ds_read_b64_tr_b16 v[114:115], v8 offset:13312
v_mfma_f32_16x16x32_bf16 v[104:107], a[24:27], v[64:67], v[104:107]
ds_read_b64_tr_b16 v[116:117], v9 offset:12288
v_mfma_f32_16x16x32_bf16 v[108:111], a[28:31], v[64:67], v[108:111]
ds_read_b64_tr_b16 v[118:119], v9 offset:13312
s_waitcnt vmcnt(12)
v_cmp_ne_u32 vcc, 1, v6
s_nop 0
s_cmp_eq_u64 vcc, 0
s_cselect_b32 s50, s52, 0
s_cmp_eq_u32 s50, 1
s_cselect_b32 s49, s49, 536870912
s_add_u32 s24, s49, s30
buffer_load_dwordx4 v[64:67], v1, s[8:11], s24 offen offset:0 sc1
s_waitcnt vmcnt(21)
v_mfma_f32_16x16x32_bf16 v[96:99], a[32:35], v[68:71], v[96:99]
ds_read_b64_tr_b16 v[120:121], v10 offset:12288
v_mfma_f32_16x16x32_bf16 v[100:103], a[36:39], v[68:71], v[100:103]
ds_read_b64_tr_b16 v[122:123], v10 offset:13312
v_mfma_f32_16x16x32_bf16 v[104:107], a[40:43], v[68:71], v[104:107]
ds_read_b64_tr_b16 v[124:125], v11 offset:12288
v_mfma_f32_16x16x32_bf16 v[108:111], a[44:47], v[68:71], v[108:111]
ds_read_b64_tr_b16 v[126:127], v11 offset:13312
buffer_load_dwordx4 v[68:71], v1, s[8:11], s24 offen offset:1024 sc1
s_waitcnt vmcnt(21)
v_mfma_f32_16x16x32_bf16 v[96:99], a[48:51], v[72:75], v[96:99]
v_mfma_f32_16x16x32_bf16 v[100:103], a[52:55], v[72:75], v[100:103]
v_mfma_f32_16x16x32_bf16 v[104:107], a[56:59], v[72:75], v[104:107]
v_mfma_f32_16x16x32_bf16 v[108:111], a[60:63], v[72:75], v[108:111]
buffer_load_dwordx4 v[72:75], v1, s[8:11], s24 offen offset:2048 sc1
s_waitcnt vmcnt(21) lgkmcnt(0)
v_mfma_f32_16x16x32_bf16 v[96:99], v[112:115], v[76:79], v[96:99]
v_mfma_f32_16x16x32_bf16 v[100:103], v[116:119], v[76:79], v[100:103]
v_mfma_f32_16x16x32_bf16 v[104:107], v[120:123], v[76:79], v[104:107]
v_mfma_f32_16x16x32_bf16 v[108:111], v[124:127], v[76:79], v[108:111]
buffer_load_dwordx4 v[76:79], v1, s[8:11], s24 offen offset:3072 sc1
s_waitcnt vmcnt(21)
v_mfma_f32_16x16x32_bf16 v[96:99], a[64:67], v[80:83], v[96:99]
ds_read_b64_tr_b16 v[112:113], v8 offset:16384
v_mfma_f32_16x16x32_bf16 v[100:103], a[68:71], v[80:83], v[100:103]
ds_read_b64_tr_b16 v[114:115], v8 offset:17408
v_mfma_f32_16x16x32_bf16 v[104:107], a[72:75], v[80:83], v[104:107]
ds_read_b64_tr_b16 v[116:117], v9 offset:16384
v_mfma_f32_16x16x32_bf16 v[108:111], a[76:79], v[80:83], v[108:111]
ds_read_b64_tr_b16 v[118:119], v9 offset:17408
s_add_u32 s24, s49, s31
buffer_load_dwordx4 v[80:83], v1, s[8:11], s24 offen offset:0 sc1
s_waitcnt vmcnt(21)
v_mfma_f32_16x16x32_bf16 v[96:99], a[80:83], v[84:87], v[96:99]
ds_read_b64_tr_b16 v[120:121], v10 offset:16384
v_mfma_f32_16x16x32_bf16 v[100:103], a[84:87], v[84:87], v[100:103]
ds_read_b64_tr_b16 v[122:123], v10 offset:17408
v_mfma_f32_16x16x32_bf16 v[104:107], a[88:91], v[84:87], v[104:107]
ds_read_b64_tr_b16 v[124:125], v11 offset:16384
v_mfma_f32_16x16x32_bf16 v[108:111], a[92:95], v[84:87], v[108:111]
ds_read_b64_tr_b16 v[126:127], v11 offset:17408
buffer_load_dwordx4 v[84:87], v1, s[8:11], s24 offen offset:1024 sc1
s_waitcnt vmcnt(21)
v_mfma_f32_16x16x32_bf16 v[96:99], a[96:99], v[88:91], v[96:99]
v_mfma_f32_16x16x32_bf16 v[100:103], a[100:103], v[88:91], v[100:103]
v_mfma_f32_16x16x32_bf16 v[104:107], a[104:107], v[88:91], v[104:107]
v_mfma_f32_16x16x32_bf16 v[108:111], a[108:111], v[88:91], v[108:111]
buffer_load_dwordx4 v[88:91], v1, s[8:11], s24 offen offset:2048 sc1
s_waitcnt vmcnt(21) lgkmcnt(0)
v_mfma_f32_16x16x32_bf16 v[96:99], v[112:115], v[92:95], v[96:99]
v_mfma_f32_16x16x32_bf16 v[100:103], v[116:119], v[92:95], v[100:103]
v_mfma_f32_16x16x32_bf16 v[104:107], v[120:123], v[92:95], v[104:107]
v_mfma_f32_16x16x32_bf16 v[108:111], v[124:127], v[92:95], v[108:111]
buffer_load_dwordx4 v[92:95], v1, s[8:11], s24 offen offset:3072 sc1
s_waitcnt vmcnt(19)
v_mfma_f32_16x16x32_bf16 v[96:99], a[112:115], v[16:19], v[96:99]
ds_read_b64_tr_b16 v[112:113], v8 offset:20480
v_mfma_f32_16x16x32_bf16 v[100:103], a[116:119], v[16:19], v[100:103]
ds_read_b64_tr_b16 v[114:115], v8 offset:21504
v_mfma_f32_16x16x32_bf16 v[104:107], a[120:123], v[16:19], v[104:107]
ds_read_b64_tr_b16 v[116:117], v9 offset:20480
v_mfma_f32_16x16x32_bf16 v[108:111], a[124:127], v[16:19], v[108:111]
ds_read_b64_tr_b16 v[118:119], v9 offset:21504
s_add_u32 s24, s49, s32
buffer_load_dwordx4 v[16:19], v1, s[8:11], s24 offen offset:0 sc1
s_waitcnt vmcnt(19)
v_mfma_f32_16x16x32_bf16 v[96:99], a[128:131], v[20:23], v[96:99]
ds_read_b64_tr_b16 v[120:121], v10 offset:20480
v_mfma_f32_16x16x32_bf16 v[100:103], a[132:135], v[20:23], v[100:103]
ds_read_b64_tr_b16 v[122:123], v10 offset:21504
v_mfma_f32_16x16x32_bf16 v[104:107], a[136:139], v[20:23], v[104:107]
ds_read_b64_tr_b16 v[124:125], v11 offset:20480
v_mfma_f32_16x16x32_bf16 v[108:111], a[140:143], v[20:23], v[108:111]
ds_read_b64_tr_b16 v[126:127], v11 offset:21504
buffer_load_dwordx4 v[20:23], v1, s[8:11], s24 offen offset:1024 sc1
s_waitcnt vmcnt(19)
v_mfma_f32_16x16x32_bf16 v[96:99], a[144:147], v[24:27], v[96:99]
v_mfma_f32_16x16x32_bf16 v[100:103], a[148:151], v[24:27], v[100:103]
v_mfma_f32_16x16x32_bf16 v[104:107], a[152:155], v[24:27], v[104:107]
v_mfma_f32_16x16x32_bf16 v[108:111], a[156:159], v[24:27], v[108:111]
buffer_load_dwordx4 v[24:27], v1, s[8:11], s24 offen offset:2048 sc1
s_waitcnt vmcnt(19) lgkmcnt(0)
v_mfma_f32_16x16x32_bf16 v[96:99], v[112:115], v[28:31], v[96:99]
v_mfma_f32_16x16x32_bf16 v[100:103], v[116:119], v[28:31], v[100:103]
v_mfma_f32_16x16x32_bf16 v[104:107], v[120:123], v[28:31], v[104:107]
v_mfma_f32_16x16x32_bf16 v[108:111], v[124:127], v[28:31], v[108:111]
buffer_load_dwordx4 v[28:31], v1, s[8:11], s24 offen offset:3072 sc1
s_waitcnt vmcnt(19)
v_mfma_f32_16x16x32_bf16 v[96:99], a[160:163], v[32:35], v[96:99]
ds_read_b64_tr_b16 v[112:113], v8 offset:24576
v_mfma_f32_16x16x32_bf16 v[100:103], a[164:167], v[32:35], v[100:103]
ds_read_b64_tr_b16 v[114:115], v8 offset:25600
v_mfma_f32_16x16x32_bf16 v[104:107], a[168:171], v[32:35], v[104:107]
ds_read_b64_tr_b16 v[116:117], v9 offset:24576
v_mfma_f32_16x16x32_bf16 v[108:111], a[172:175], v[32:35], v[108:111]
ds_read_b64_tr_b16 v[118:119], v9 offset:25600
s_add_u32 s24, s49, s33
buffer_load_dwordx4 v[32:35], v1, s[8:11], s24 offen offset:0 sc1
s_waitcnt vmcnt(19)
v_mfma_f32_16x16x32_bf16 v[96:99], a[176:179], v[36:39], v[96:99]
ds_read_b64_tr_b16 v[120:121], v10 offset:24576
v_mfma_f32_16x16x32_bf16 v[100:103], a[180:183], v[36:39], v[100:103]
ds_read_b64_tr_b16 v[122:123], v10 offset:25600
v_mfma_f32_16x16x32_bf16 v[104:107], a[184:187], v[36:39], v[104:107]
ds_read_b64_tr_b16 v[124:125], v11 offset:24576
v_mfma_f32_16x16x32_bf16 v[108:111], a[188:191], v[36:39], v[108:111]
ds_read_b64_tr_b16 v[126:127], v11 offset:25600
buffer_load_dwordx4 v[36:39], v1, s[8:11], s24 offen offset:1024 sc1
s_waitcnt vmcnt(19)
v_mfma_f32_16x16x32_bf16 v[96:99], a[192:195], v[40:43], v[96:99]
v_mfma_f32_16x16x32_bf16 v[100:103], a[196:199], v[40:43], v[100:103]
v_mfma_f32_16x16x32_bf16 v[104:107], a[200:203], v[40:43], v[104:107]
v_mfma_f32_16x16x32_bf16 v[108:111], a[204:207], v[40:43], v[108:111]
buffer_load_dwordx4 v[40:43], v1, s[8:11], s24 offen offset:2048 sc1
s_waitcnt vmcnt(19) lgkmcnt(0)
v_mfma_f32_16x16x32_bf16 v[96:99], v[112:115], v[44:47], v[96:99]
v_mfma_f32_16x16x32_bf16 v[100:103], v[116:119], v[44:47], v[100:103]
v_mfma_f32_16x16x32_bf16 v[104:107], v[120:123], v[44:47], v[104:107]
v_mfma_f32_16x16x32_bf16 v[108:111], v[124:127], v[44:47], v[108:111]
buffer_load_dwordx4 v[44:47], v1, s[8:11], s24 offen offset:3072 sc1
s_waitcnt vmcnt(19)
v_mfma_f32_16x16x32_bf16 v[96:99], a[208:211], v[48:51], v[96:99]
ds_read_b64_tr_b16 v[112:113], v8 offset:28672
v_mfma_f32_16x16x32_bf16 v[100:103], a[212:215], v[48:51], v[100:103]
ds_read_b64_tr_b16 v[114:115], v8 offset:29696
v_mfma_f32_16x16x32_bf16 v[104:107], a[216:219], v[48:51], v[104:107]
ds_read_b64_tr_b16 v[116:117], v9 offset:28672
v_mfma_f32_16x16x32_bf16 v[108:111], a[220:223], v[48:51], v[108:111]
ds_read_b64_tr_b16 v[118:119], v9 offset:29696
s_add_u32 s24, s49, s34
buffer_load_dwordx4 v[48:51], v1, s[8:11], s24 offen offset:0 sc1
s_waitcnt vmcnt(19)
v_mfma_f32_16x16x32_bf16 v[96:99], a[224:227], v[52:55], v[96:99]
ds_read_b64_tr_b16 v[120:121], v10 offset:28672
v_mfma_f32_16x16x32_bf16 v[100:103], a[228:231], v[52:55], v[100:103]
ds_read_b64_tr_b16 v[122:123], v10 offset:29696
v_mfma_f32_16x16x32_bf16 v[104:107], a[232:235], v[52:55], v[104:107]
ds_read_b64_tr_b16 v[124:125], v11 offset:28672
v_mfma_f32_16x16x32_bf16 v[108:111], a[236:239], v[52:55], v[108:111]
ds_read_b64_tr_b16 v[126:127], v11 offset:29696
buffer_load_dwordx4 v[52:55], v1, s[8:11], s24 offen offset:1024 sc1
s_waitcnt vmcnt(19)
v_mfma_f32_16x16x32_bf16 v[96:99], a[240:243], v[56:59], v[96:99]
v_mfma_f32_16x16x32_bf16 v[100:103], a[244:247], v[56:59], v[100:103]
v_mfma_f32_16x16x32_bf16 v[104:107], a[248:251], v[56:59], v[104:107]
v_mfma_f32_16x16x32_bf16 v[108:111], a[252:255], v[56:59], v[108:111]
buffer_load_dwordx4 v[56:59], v1, s[8:11], s24 offen offset:2048 sc1
s_waitcnt vmcnt(19) lgkmcnt(0)
v_mfma_f32_16x16x32_bf16 v[96:99], v[112:115], v[60:63], v[96:99]
v_mfma_f32_16x16x32_bf16 v[100:103], v[116:119], v[60:63], v[100:103]
v_mfma_f32_16x16x32_bf16 v[104:107], v[120:123], v[60:63], v[104:107]
v_mfma_f32_16x16x32_bf16 v[108:111], v[124:127], v[60:63], v[108:111]
buffer_load_dwordx4 v[60:63], v1, s[8:11], s24 offen offset:3072 sc1
s_nop 3
ds_write_b128 v3, v[96:99] offset:0
ds_write_b128 v3, v[100:103] offset:4096
ds_write_b128 v3, v[104:107] offset:8192
ds_write_b128 v3, v[108:111] offset:12288
s_waitcnt lgkmcnt(0)
s_barrier
ds_read_b128 v[96:99], v7 offset:0
ds_read_b128 v[100:103], v7 offset:1024
ds_read_b128 v[104:107], v7 offset:2048
ds_read_b128 v[108:111], v7 offset:3072
ds_read_b64_tr_b16 v[112:113], v8 offset:0
ds_read_b64_tr_b16 v[114:115], v8 offset:1024
ds_read_b64_tr_b16 v[116:117], v9 offset:0
ds_read_b64_tr_b16 v[118:119], v9 offset:1024
ds_read_b64_tr_b16 v[120:121], v10 offset:0
ds_read_b64_tr_b16 v[122:123], v10 offset:1024
ds_read_b64_tr_b16 v[124:125], v11 offset:0
ds_read_b64_tr_b16 v[126:127], v11 offset:1024
s_mul_i32 s24, s41, 36864
s_waitcnt lgkmcnt(10)
v_pk_add_f32 v[96:97], v[96:97], v[100:101]
v_pk_add_f32 v[98:99], v[98:99], v[102:103]
s_waitcnt lgkmcnt(9)
v_pk_add_f32 v[96:97], v[96:97], v[104:105]
v_pk_add_f32 v[98:99], v[98:99], v[106:107]
s_waitcnt lgkmcnt(8)
v_pk_add_f32 v[96:97], v[96:97], v[108:109]
v_pk_add_f32 v[98:99], v[98:99], v[110:111]
v_cvt_pk_bf16_f32 v12, v96, v97
v_cvt_pk_bf16_f32 v13, v98, v99
buffer_store_dwordx2 v[12:13], v4, s[12:15], s24 offen
v_xor_b32 v3, 16384, v3
v_xor_b32 v7, 16384, v7
s_mov_b32 s41, s27
s_mov_b32 s48, s49
s_cmp_eq_u32 s50, 0
s_cbranch_scc1 L_opl_c
L_opl_r1:
s_cmp_lg_u64 s[42:43], 0
s_cselect_b32 s52, 1, 0
s_ff1_i32_b64 s27, s[42:43]
s_bitset0_b64 s[42:43], s27
s_lshl_b32 s27, s27, 1
s_add_u32 s27, s27, s51
s_and_b32 s27, s27, 127
s_lshr_b32 s25, s27, s46
s_lshl_b32 s25, s25, 7
s_add_u32 s25, s25, s45
buffer_load_dword v6, v5, s[8:11], s25 offen sc1
s_lshl_b32 s49, s27, 17
s_add_u32 s49, s49, s44
s_waitcnt vmcnt(21)
v_mfma_f32_16x16x32_bf16 v[96:99], v[128:131], v[64:67], 0
v_mfma_f32_16x16x32_bf16 v[100:103], v[132:135], v[64:67], 0
v_mfma_f32_16x16x32_bf16 v[104:107], v[136:139], v[64:67], 0
v_mfma_f32_16x16x32_bf16 v[108:111], v[140:143], v[64:67], 0
s_add_u32 s24, s48, s35
buffer_load_dwordx4 v[64:67], v1, s[8:11], s24 offen offset:0 sc1
s_waitcnt vmcnt(21)
v_mfma_f32_16x16x32_bf16 v[96:99], v[144:147], v[68:71], v[96:99]
v_mfma_f32_16x16x32_bf16 v[100:103], v[148:151], v[68:71], v[100:103]
v_mfma_f32_16x16x32_bf16 v[104:107], v[152:155], v[68:71], v[104:107]
v_mfma_f32_16x16x32_bf16 v[108:111], v[156:159], v[68:71], v[108:111]
buffer_load_dwordx4 v[68:71], v1, s[8:11], s24 offen offset:1024 sc1
s_waitcnt vmcnt(21)
v_mfma_f32_16x16x32_bf16 v[96:99], v[160:163], v[72:75], v[96:99]
v_mfma_f32_16x16x32_bf16 v[100:103], v[164:167], v[72:75], v[100:103]
v_mfma_f32_16x16x32_bf16 v[104:107], v[168:171], v[72:75], v[104:107]
v_mfma_f32_16x16x32_bf16 v[108:111], v[172:175], v[72:75], v[108:111]
buffer_load_dwordx4 v[72:75], v1, s[8:11], s24 offen offset:2048 sc1
s_waitcnt vmcnt(21) lgkmcnt(0)
v_mfma_f32_16x16x32_bf16 v[96:99], v[112:115], v[76:79], v[96:99]
v_mfma_f32_16x16x32_bf16 v[100:103], v[116:119], v[76:79], v[100:103]
v_mfma_f32_16x16x32_bf16 v[104:107], v[120:123], v[76:79], v[104:107]
v_mfma_f32_16x16x32_bf16 v[108:111], v[124:127], v[76:79], v[108:111]
buffer_load_dwordx4 v[76:79], v1, s[8:11], s24 offen offset:3072 sc1
s_waitcnt vmcnt(21)
v_mfma_f32_16x16x32_bf16 v[96:99], v[176:179], v[80:83], v[96:99]
ds_read_b64_tr_b16 v[112:113], v8 offset:4096
v_mfma_f32_16x16x32_bf16 v[100:103], v[180:183], v[80:83], v[100:103]
ds_read_b64_tr_b16 v[114:115], v8 offset:5120
v_mfma_f32_16x16x32_bf16 v[104:107], v[184:187], v[80:83], v[104:107]
ds_read_b64_tr_b16 v[116:117], v9 offset:4096
v_mfma_f32_16x16x32_bf16 v[108:111], v[188:191], v[80:83], v[108:111]
ds_read_b64_tr_b16 v[118:119], v9 offset:5120
s_add_u32 s24, s48, s36
buffer_load_dwordx4 v[80:83], v1, s[8:11], s24 offen offset:0 sc1
s_waitcnt vmcnt(21)
v_mfma_f32_16x16x32_bf16 v[96:99], v[192:195], v[84:87], v[96:99]
ds_read_b64_tr_b16 v[120:121], v10 offset:4096
v_mfma_f32_16x16x32_bf16 v[100:103], v[196:199], v[84:87], v[100:103]
ds_read_b64_tr_b16 v[122:123], v10 offset:5120
v_mfma_f32_16x16x32_bf16 v[104:107], v[200:203], v[84:87], v[104:107]
ds_read_b64_tr_b16 v[124:125], v11 offset:4096
v_mfma_f32_16x16x32_bf16 v[108:111], v[204:207], v[84:87], v[108:111]
ds_read_b64_tr_b16 v[126:127], v11 offset:5120
buffer_load_dwordx4 v[84:87], v1, s[8:11], s24 offen offset:1024 sc1
s_waitcnt vmcnt(21)
v_mfma_f32_16x16x32_bf16 v[96:99], v[208:211], v[88:91], v[96:99]
v_mfma_f32_16x16x32_bf16 v[100:103], v[212:215], v[88:91], v[100:103]
v_mfma_f32_16x16x32_bf16 v[104:107], v[216:219], v[88:91], v[104:107]
v_mfma_f32_16x16x32_bf16 v[108:111], v[220:223], v[88:91], v[108:111]
buffer_load_dwordx4 v[88:91], v1, s[8:11], s24 offen offset:2048 sc1
s_waitcnt vmcnt(21) lgkmcnt(0)
v_mfma_f32_16x16x32_bf16 v[96:99], v[112:115], v[92:95], v[96:99]
v_mfma_f32_16x16x32_bf16 v[100:103], v[116:119], v[92:95], v[100:103]
v_mfma_f32_16x16x32_bf16 v[104:107], v[120:123], v[92:95], v[104:107]
v_mfma_f32_16x16x32_bf16 v[108:111], v[124:127], v[92:95], v[108:111]
buffer_load_dwordx4 v[92:95], v1, s[8:11], s24 offen offset:3072 sc1
s_waitcnt vmcnt(21)
v_mfma_f32_16x16x32_bf16 v[96:99], v[224:227], v[16:19], v[96:99]
ds_read_b64_tr_b16 v[112:113], v8 offset:8192
v_mfma_f32_16x16x32_bf16 v[100:103], v[228:231], v[16:19], v[100:103]
ds_read_b64_tr_b16 v[114:115], v8 offset:9216
v_mfma_f32_16x16x32_bf16 v[104:107], v[232:235], v[16:19], v[104:107]
ds_read_b64_tr_b16 v[116:117], v9 offset:8192
v_mfma_f32_16x16x32_bf16 v[108:111], v[236:239], v[16:19], v[108:111]
ds_read_b64_tr_b16 v[118:119], v9 offset:9216
s_add_u32 s24, s48, s37
buffer_load_dwordx4 v[16:19], v1, s[8:11], s24 offen offset:0 sc1
s_waitcnt vmcnt(21)
v_mfma_f32_16x16x32_bf16 v[96:99], v[240:243], v[20:23], v[96:99]
ds_read_b64_tr_b16 v[120:121], v10 offset:8192
v_mfma_f32_16x16x32_bf16 v[100:103], v[244:247], v[20:23], v[100:103]
ds_read_b64_tr_b16 v[122:123], v10 offset:9216
v_mfma_f32_16x16x32_bf16 v[104:107], v[248:251], v[20:23], v[104:107]
ds_read_b64_tr_b16 v[124:125], v11 offset:8192
v_mfma_f32_16x16x32_bf16 v[108:111], v[252:255], v[20:23], v[108:111]
ds_read_b64_tr_b16 v[126:127], v11 offset:9216
buffer_load_dwordx4 v[20:23], v1, s[8:11], s24 offen offset:1024 sc1
s_waitcnt vmcnt(21)
v_mfma_f32_16x16x32_bf16 v[96:99], a[0:3], v[24:27], v[96:99]
v_mfma_f32_16x16x32_bf16 v[100:103], a[4:7], v[24:27], v[100:103]
v_mfma_f32_16x16x32_bf16 v[104:107], a[8:11], v[24:27], v[104:107]
v_mfma_f32_16x16x32_bf16 v[108:111], a[12:15], v[24:27], v[108:111]
buffer_load_dwordx4 v[24:27], v1, s[8:11], s24 offen offset:2048 sc1
s_waitcnt vmcnt(21) lgkmcnt(0)
v_mfma_f32_16x16x32_bf16 v[96:99], v[112:115], v[28:31], v[96:99]
v_mfma_f32_16x16x32_bf16 v[100:103], v[116:119], v[28:31], v[100:103]
v_mfma_f32_16x16x32_bf16 v[104:107], v[120:123], v[28:31], v[104:107]
v_mfma_f32_16x16x32_bf16 v[108:111], v[124:127], v[28:31], v[108:111]
buffer_load_dwordx4 v[28:31], v1, s[8:11], s24 offen offset:3072 sc1
s_waitcnt vmcnt(21)
v_mfma_f32_16x16x32_bf16 v[96:99], a[16:19], v[32:35], v[96:99]
ds_read_b64_tr_b16 v[112:113], v8 offset:12288
v_mfma_f32_16x16x32_bf16 v[100:103], a[20:23], v[32:35], v[100:103]
ds_read_b64_tr_b16 v[114:115], v8 offset:13312
v_mfma_f32_16x16x32_bf16 v[104:107], a[24:27], v[32:35], v[104:107]
ds_read_b64_tr_b16 v[116:117], v9 offset:12288
v_mfma_f32_16x16x32_bf16 v[108:111], a[28:31], v[32:35], v[108:111]
ds_read_b64_tr_b16 v[118:119], v9 offset:13312
s_waitcnt vmcnt(12)
v_cmp_ne_u32 vcc, 1, v6
s_nop 0
s_cmp_eq_u64 vcc, 0
s_cselect_b32 s50, s52, 0
s_cmp_eq_u32 s50, 1
s_cselect_b32 s49, s49, 536870912
s_add_u32 s24, s49, s30
buffer_load_dwordx4 v[32:35], v1, s[8:11], s24 offen offset:0 sc1
s_waitcnt vmcnt(21)
v_mfma_f32_16x16x32_bf16 v[96:99], a[32:35], v[36:39], v[96:99]
ds_read_b64_tr_b16 v[120:121], v10 offset:12288
v_mfma_f32_16x16x32_bf16 v[100:103], a[36:39], v[36:39], v[100:103]
ds_read_b64_tr_b16 v[122:123], v10 offset:13312
v_mfma_f32_16x16x32_bf16 v[104:107], a[40:43], v[36:39], v[104:107]
ds_read_b64_tr_b16 v[124:125], v11 offset:12288
v_mfma_f32_16x16x32_bf16 v[108:111], a[44:47], v[36:39], v[108:111]
ds_read_b64_tr_b16 v[126:127], v11 offset:13312
buffer_load_dwordx4 v[36:39], v1, s[8:11], s24 offen offset:1024 sc1
s_waitcnt vmcnt(21)
v_mfma_f32_16x16x32_bf16 v[96:99], a[48:51], v[40:43], v[96:99]
v_mfma_f32_16x16x32_bf16 v[100:103], a[52:55], v[40:43], v[100:103]
v_mfma_f32_16x16x32_bf16 v[104:107], a[56:59], v[40:43], v[104:107]
v_mfma_f32_16x16x32_bf16 v[108:111], a[60:63], v[40:43], v[108:111]
buffer_load_dwordx4 v[40:43], v1, s[8:11], s24 offen offset:2048 sc1
s_waitcnt vmcnt(21) lgkmcnt(0)
v_mfma_f32_16x16x32_bf16 v[96:99], v[112:115], v[44:47], v[96:99]
v_mfma_f32_16x16x32_bf16 v[100:103], v[116:119], v[44:47], v[100:103]
v_mfma_f32_16x16x32_bf16 v[104:107], v[120:123], v[44:47], v[104:107]
v_mfma_f32_16x16x32_bf16 v[108:111], v[124:127], v[44:47], v[108:111]
buffer_load_dwordx4 v[44:47], v1, s[8:11], s24 offen offset:3072 sc1
s_waitcnt vmcnt(21)
v_mfma_f32_16x16x32_bf16 v[96:99], a[64:67], v[48:51], v[96:99]
ds_read_b64_tr_b16 v[112:113], v8 offset:16384
v_mfma_f32_16x16x32_bf16 v[100:103], a[68:71], v[48:51], v[100:103]
ds_read_b64_tr_b16 v[114:115], v8 offset:17408
v_mfma_f32_16x16x32_bf16 v[104:107], a[72:75], v[48:51], v[104:107]
ds_read_b64_tr_b16 v[116:117], v9 offset:16384
v_mfma_f32_16x16x32_bf16 v[108:111], a[76:79], v[48:51], v[108:111]
ds_read_b64_tr_b16 v[118:119], v9 offset:17408
s_add_u32 s24, s49, s31
buffer_load_dwordx4 v[48:51], v1, s[8:11], s24 offen offset:0 sc1
s_waitcnt vmcnt(21)
v_mfma_f32_16x16x32_bf16 v[96:99], a[80:83], v[52:55], v[96:99]
ds_read_b64_tr_b16 v[120:121], v10 offset:16384
v_mfma_f32_16x16x32_bf16 v[100:103], a[84:87], v[52:55], v[100:103]
ds_read_b64_tr_b16 v[122:123], v10 offset:17408
v_mfma_f32_16x16x32_bf16 v[104:107], a[88:91], v[52:55], v[104:107]
ds_read_b64_tr_b16 v[124:125], v11 offset:16384
v_mfma_f32_16x16x32_bf16 v[108:111], a[92:95], v[52:55], v[108:111]
ds_read_b64_tr_b16 v[126:127], v11 offset:17408
buffer_load_dwordx4 v[52:55], v1, s[8:11], s24 offen offset:1024 sc1
s_waitcnt vmcnt(21)
v_mfma_f32_16x16x32_bf16 v[96:99], a[96:99], v[56:59], v[96:99]
v_mfma_f32_16x16x32_bf16 v[100:103], a[100:103], v[56:59], v[100:103]
v_mfma_f32_16x16x32_bf16 v[104:107], a[104:107], v[56:59], v[104:107]
v_mfma_f32_16x16x32_bf16 v[108:111], a[108:111], v[56:59], v[108:111]
buffer_load_dwordx4 v[56:59], v1, s[8:11], s24 offen offset:2048 sc1
s_waitcnt vmcnt(21) lgkmcnt(0)
v_mfma_f32_16x16x32_bf16 v[96:99], v[112:115], v[60:63], v[96:99]
v_mfma_f32_16x16x32_bf16 v[100:103], v[116:119], v[60:63], v[100:103]
v_mfma_f32_16x16x32_bf16 v[104:107], v[120:123], v[60:63], v[104:107]
v_mfma_f32_16x16x32_bf16 v[108:111], v[124:127], v[60:63], v[108:111]
buffer_load_dwordx4 v[60:63], v1, s[8:11], s24 offen offset:3072 sc1
s_waitcnt vmcnt(19)
v_mfma_f32_16x16x32_bf16 v[96:99], a[112:115], v[64:67], v[96:99]
ds_read_b64_tr_b16 v[112:113], v8 offset:20480
v_mfma_f32_16x16x32_bf16 v[100:103], a[116:119], v[64:67], v[100:103]
ds_read_b64_tr_b16 v[114:115], v8 offset:21504
v_mfma_f32_16x16x32_bf16 v[104:107], a[120:123], v[64:67], v[104:107]
ds_read_b64_tr_b16 v[116:117], v9 offset:20480
v_mfma_f32_16x16x32_bf16 v[108:111], a[124:127], v[64:67], v[108:111]
ds_read_b64_tr_b16 v[118:119], v9 offset:21504
s_add_u32 s24, s49, s32
buffer_load_dwordx4 v[64:67], v1, s[8:11], s24 offen offset:0 sc1
s_waitcnt vmcnt(19)
v_mfma_f32_16x16x32_bf16 v[96:99], a[128:131], v[68:71], v[96:99]
ds_read_b64_tr_b16 v[120:121], v10 offset:20480
v_mfma_f32_16x16x32_bf16 v[100:103], a[132:135], v[68:71], v[100:103]
ds_read_b64_tr_b16 v[122:123], v10 offset:21504
v_mfma_f32_16x16x32_bf16 v[104:107], a[136:139], v[68:71], v[104:107]
ds_read_b64_tr_b16 v[124:125], v11 offset:20480
v_mfma_f32_16x16x32_bf16 v[108:111], a[140:143], v[68:71], v[108:111]
ds_read_b64_tr_b16 v[126:127], v11 offset:21504
buffer_load_dwordx4 v[68:71], v1, s[8:11], s24 offen offset:1024 sc1
s_waitcnt vmcnt(19)
v_mfma_f32_16x16x32_bf16 v[96:99], a[144:147], v[72:75], v[96:99]
v_mfma_f32_16x16x32_bf16 v[100:103], a[148:151], v[72:75], v[100:103]
v_mfma_f32_16x16x32_bf16 v[104:107], a[152:155], v[72:75], v[104:107]
v_mfma_f32_16x16x32_bf16 v[108:111], a[156:159], v[72:75], v[108:111]
buffer_load_dwordx4 v[72:75], v1, s[8:11], s24 offen offset:2048 sc1
s_waitcnt vmcnt(19) lgkmcnt(0)
v_mfma_f32_16x16x32_bf16 v[96:99], v[112:115], v[76:79], v[96:99]
v_mfma_f32_16x16x32_bf16 v[100:103], v[116:119], v[76:79], v[100:103]
v_mfma_f32_16x16x32_bf16 v[104:107], v[120:123], v[76:79], v[104:107]
v_mfma_f32_16x16x32_bf16 v[108:111], v[124:127], v[76:79], v[108:111]
buffer_load_dwordx4 v[76:79], v1, s[8:11], s24 offen offset:3072 sc1
s_waitcnt vmcnt(19)
v_mfma_f32_16x16x32_bf16 v[96:99], a[160:163], v[80:83], v[96:99]
ds_read_b64_tr_b16 v[112:113], v8 offset:24576
v_mfma_f32_16x16x32_bf16 v[100:103], a[164:167], v[80:83], v[100:103]
ds_read_b64_tr_b16 v[114:115], v8 offset:25600
v_mfma_f32_16x16x32_bf16 v[104:107], a[168:171], v[80:83], v[104:107]
ds_read_b64_tr_b16 v[116:117], v9 offset:24576
v_mfma_f32_16x16x32_bf16 v[108:111], a[172:175], v[80:83], v[108:111]
ds_read_b64_tr_b16 v[118:119], v9 offset:25600
s_add_u32 s24, s49, s33
buffer_load_dwordx4 v[80:83], v1, s[8:11], s24 offen offset:0 sc1
s_waitcnt vmcnt(19)
v_mfma_f32_16x16x32_bf16 v[96:99], a[176:179], v[84:87], v[96:99]
ds_read_b64_tr_b16 v[120:121], v10 offset:24576
v_mfma_f32_16x16x32_bf16 v[100:103], a[180:183], v[84:87], v[100:103]
ds_read_b64_tr_b16 v[122:123], v10 offset:25600
v_mfma_f32_16x16x32_bf16 v[104:107], a[184:187], v[84:87], v[104:107]
ds_read_b64_tr_b16 v[124:125], v11 offset:24576
v_mfma_f32_16x16x32_bf16 v[108:111], a[188:191], v[84:87], v[108:111]
ds_read_b64_tr_b16 v[126:127], v11 offset:25600
buffer_load_dwordx4 v[84:87], v1, s[8:11], s24 offen offset:1024 sc1
s_waitcnt vmcnt(19)
v_mfma_f32_16x16x32_bf16 v[96:99], a[192:195], v[88:91], v[96:99]
v_mfma_f32_16x16x32_bf16 v[100:103], a[196:199], v[88:91], v[100:103]
v_mfma_f32_16x16x32_bf16 v[104:107], a[200:203], v[88:91], v[104:107]
v_mfma_f32_16x16x32_bf16 v[108:111], a[204:207], v[88:91], v[108:111]
buffer_load_dwordx4 v[88:91], v1, s[8:11], s24 offen offset:2048 sc1
s_waitcnt vmcnt(19) lgkmcnt(0)
v_mfma_f32_16x16x32_bf16 v[96:99], v[112:115], v[92:95], v[96:99]
v_mfma_f32_16x16x32_bf16 v[100:103], v[116:119], v[92:95], v[100:103]
v_mfma_f32_16x16x32_bf16 v[104:107], v[120:123], v[92:95], v[104:107]
v_mfma_f32_16x16x32_bf16 v[108:111], v[124:127], v[92:95], v[108:111]
buffer_load_dwordx4 v[92:95], v1, s[8:11], s24 offen offset:3072 sc1
s_waitcnt vmcnt(19)
v_mfma_f32_16x16x32_bf16 v[96:99], a[208:211], v[16:19], v[96:99]
ds_read_b64_tr_b16 v[112:113], v8 offset:28672
v_mfma_f32_16x16x32_bf16 v[100:103], a[212:215], v[16:19], v[100:103]
ds_read_b64_tr_b16 v[114:115], v8 offset:29696
v_mfma_f32_16x16x32_bf16 v[104:107], a[216:219], v[16:19], v[104:107]
ds_read_b64_tr_b16 v[116:117], v9 offset:28672
v_mfma_f32_16x16x32_bf16 v[108:111], a[220:223], v[16:19], v[108:111]
ds_read_b64_tr_b16 v[118:119], v9 offset:29696
s_add_u32 s24, s49, s34
buffer_load_dwordx4 v[16:19], v1, s[8:11], s24 offen offset:0 sc1
s_waitcnt vmcnt(19)
v_mfma_f32_16x16x32_bf16 v[96:99], a[224:227], v[20:23], v[96:99]
ds_read_b64_tr_b16 v[120:121], v10 offset:28672
v_mfma_f32_16x16x32_bf16 v[100:103], a[228:231], v[20:23], v[100:103]
ds_read_b64_tr_b16 v[122:123], v10 offset:29696
v_mfma_f32_16x16x32_bf16 v[104:107], a[232:235], v[20:23], v[104:107]
ds_read_b64_tr_b16 v[124:125], v11 offset:28672
v_mfma_f32_16x16x32_bf16 v[108:111], a[236:239], v[20:23], v[108:111]
ds_read_b64_tr_b16 v[126:127], v11 offset:29696
buffer_load_dwordx4 v[20:23], v1, s[8:11], s24 offen offset:1024 sc1
s_waitcnt vmcnt(19)
v_mfma_f32_16x16x32_bf16 v[96:99], a[240:243], v[24:27], v[96:99]
v_mfma_f32_16x16x32_bf16 v[100:103], a[244:247], v[24:27], v[100:103]
v_mfma_f32_16x16x32_bf16 v[104:107], a[248:251], v[24:27], v[104:107]
v_mfma_f32_16x16x32_bf16 v[108:111], a[252:255], v[24:27], v[108:111]
buffer_load_dwordx4 v[24:27], v1, s[8:11], s24 offen offset:2048 sc1
s_waitcnt vmcnt(19) lgkmcnt(0)
v_mfma_f32_16x16x32_bf16 v[96:99], v[112:115], v[28:31], v[96:99]
v_mfma_f32_16x16x32_bf16 v[100:103], v[116:119], v[28:31], v[100:103]
v_mfma_f32_16x16x32_bf16 v[104:107], v[120:123], v[28:31], v[104:107]
v_mfma_f32_16x16x32_bf16 v[108:111], v[124:127], v[28:31], v[108:111]
buffer_load_dwordx4 v[28:31], v1, s[8:11], s24 offen offset:3072 sc1
s_nop 3
ds_write_b128 v3, v[96:99] offset:0
ds_write_b128 v3, v[100:103] offset:4096
ds_write_b128 v3, v[104:107] offset:8192
ds_write_b128 v3, v[108:111] offset:12288
s_waitcnt lgkmcnt(0)
s_barrier
ds_read_b128 v[96:99], v7 offset:0
ds_read_b128 v[100:103], v7 offset:1024
ds_read_b128 v[104:107], v7 offset:2048
ds_read_b128 v[108:111], v7 offset:3072
ds_read_b64_tr_b16 v[112:113], v8 offset:0
ds_read_b64_tr_b16 v[114:115], v8 offset:1024
ds_read_b64_tr_b16 v[116:117], v9 offset:0
ds_read_b64_tr_b16 v[118:119], v9 offset:1024
ds_read_b64_tr_b16 v[120:121], v10 offset:0
ds_read_b64_tr_b16 v[122:123], v10 offset:1024
ds_read_b64_tr_b16 v[124:125], v11 offset:0
ds_read_b64_tr_b16 v[126:127], v11 offset:1024
s_mul_i32 s24, s41, 36864
s_waitcnt lgkmcnt(10)
v_pk_add_f32 v[96:97], v[96:97], v[100:101]
v_pk_add_f32 v[98:99], v[98:99], v[102:103]
s_waitcnt lgkmcnt(9)
v_pk_add_f32 v[96:97], v[96:97], v[104:105]
v_pk_add_f32 v[98:99], v[98:99], v[106:107]
s_waitcnt lgkmcnt(8)
v_pk_add_f32 v[96:97], v[96:97], v[108:109]
v_pk_add_f32 v[98:99], v[98:99], v[110:111]
v_cvt_pk_bf16_f32 v12, v96, v97
v_cvt_pk_bf16_f32 v13, v98, v99
buffer_store_dwordx2 v[12:13], v4, s[12:15], s24 offen
v_xor_b32 v3, 16384, v3
v_xor_b32 v7, 16384, v7
s_mov_b32 s41, s27
s_mov_b32 s48, s49
s_cmp_eq_u32 s50, 0
s_cbranch_scc1 L_opl_c
L_opl_r2:
s_cmp_lg_u64 s[42:43], 0
s_cselect_b32 s52, 1, 0
s_ff1_i32_b64 s27, s[42:43]
s_bitset0_b64 s[42:43], s27
s_lshl_b32 s27, s27, 1
s_add_u32 s27, s27, s51
s_and_b32 s27, s27, 127
s_lshr_b32 s25, s27, s46
s_lshl_b32 s25, s25, 7
s_add_u32 s25, s25, s45
buffer_load_dword v6, v5, s[8:11], s25 offen sc1
s_lshl_b32 s49, s27, 17
s_add_u32 s49, s49, s44
s_waitcnt vmcnt(21)
v_mfma_f32_16x16x32_bf16 v[96:99], v[128:131], v[32:35], 0
v_mfma_f32_16x16x32_bf16 v[100:103], v[132:135], v[32:35], 0
v_mfma_f32_16x16x32_bf16 v[104:107], v[136:139], v[32:35], 0
v_mfma_f32_16x16x32_bf16 v[108:111], v[140:143], v[32:35], 0
s_add_u32 s24, s48, s35
buffer_load_dwordx4 v[32:35], v1, s[8:11], s24 offen offset:0 sc1
s_waitcnt vmcnt(21)
v_mfma_f32_16x16x32_bf16 v[96:99], v[144:147], v[36:39], v[96:99]
v_mfma_f32_16x16x32_bf16 v[100:103], v[148:151], v[36:39], v[100:103]
v_mfma_f32_16x16x32_bf16 v[104:107], v[152:155], v[36:39], v[104:107]
v_mfma_f32_16x16x32_bf16 v[108:111], v[156:159], v[36:39], v[108:111]
buffer_load_dwordx4 v[36:39], v1, s[8:11], s24 offen offset:1024 sc1
s_waitcnt vmcnt(21)
v_mfma_f32_16x16x32_bf16 v[96:99], v[160:163], v[40:43], v[96:99]
v_mfma_f32_16x16x32_bf16 v[100:103], v[164:167], v[40:43], v[100:103]
v_mfma_f32_16x16x32_bf16 v[104:107], v[168:171], v[40:43], v[104:107]
v_mfma_f32_16x16x32_bf16 v[108:111], v[172:175], v[40:43], v[108:111]
buffer_load_dwordx4 v[40:43], v1, s[8:11], s24 offen offset:2048 sc1
s_waitcnt vmcnt(21) lgkmcnt(0)
v_mfma_f32_16x16x32_bf16 v[96:99], v[112:115], v[44:47], v[96:99]
v_mfma_f32_16x16x32_bf16 v[100:103], v[116:119], v[44:47], v[100:103]
v_mfma_f32_16x16x32_bf16 v[104:107], v[120:123], v[44:47], v[104:107]
v_mfma_f32_16x16x32_bf16 v[108:111], v[124:127], v[44:47], v[108:111]
buffer_load_dwordx4 v[44:47], v1, s[8:11], s24 offen offset:3072 sc1
s_waitcnt vmcnt(21)
v_mfma_f32_16x16x32_bf16 v[96:99], v[176:179], v[48:51], v[96:99]
ds_read_b64_tr_b16 v[112:113], v8 offset:4096
v_mfma_f32_16x16x32_bf16 v[100:103], v[180:183], v[48:51], v[100:103]
ds_read_b64_tr_b16 v[114:115], v8 offset:5120
v_mfma_f32_16x16x32_bf16 v[104:107], v[184:187], v[48:51], v[104:107]
ds_read_b64_tr_b16 v[116:117], v9 offset:4096
v_mfma_f32_16x16x32_bf16 v[108:111], v[188:191], v[48:51], v[108:111]
ds_read_b64_tr_b16 v[118:119], v9 offset:5120
s_add_u32 s24, s48, s36
buffer_load_dwordx4 v[48:51], v1, s[8:11], s24 offen offset:0 sc1
s_waitcnt vmcnt(21)
v_mfma_f32_16x16x32_bf16 v[96:99], v[192:195], v[52:55], v[96:99]
ds_read_b64_tr_b16 v[120:121], v10 offset:4096
v_mfma_f32_16x16x32_bf16 v[100:103], v[196:199], v[52:55], v[100:103]
ds_read_b64_tr_b16 v[122:123], v10 offset:5120
v_mfma_f32_16x16x32_bf16 v[104:107], v[200:203], v[52:55], v[104:107]
ds_read_b64_tr_b16 v[124:125], v11 offset:4096
v_mfma_f32_16x16x32_bf16 v[108:111], v[204:207], v[52:55], v[108:111]
ds_read_b64_tr_b16 v[126:127], v11 offset:5120
buffer_load_dwordx4 v[52:55], v1, s[8:11], s24 offen offset:1024 sc1
s_waitcnt vmcnt(21)
v_mfma_f32_16x16x32_bf16 v[96:99], v[208:211], v[56:59], v[96:99]
v_mfma_f32_16x16x32_bf16 v[100:103], v[212:215], v[56:59], v[100:103]
v_mfma_f32_16x16x32_bf16 v[104:107], v[216:219], v[56:59], v[104:107]
v_mfma_f32_16x16x32_bf16 v[108:111], v[220:223], v[56:59], v[108:111]
buffer_load_dwordx4 v[56:59], v1, s[8:11], s24 offen offset:2048 sc1
s_waitcnt vmcnt(21) lgkmcnt(0)
v_mfma_f32_16x16x32_bf16 v[96:99], v[112:115], v[60:63], v[96:99]
v_mfma_f32_16x16x32_bf16 v[100:103], v[116:119], v[60:63], v[100:103]
v_mfma_f32_16x16x32_bf16 v[104:107], v[120:123], v[60:63], v[104:107]
v_mfma_f32_16x16x32_bf16 v[108:111], v[124:127], v[60:63], v[108:111]
buffer_load_dwordx4 v[60:63], v1, s[8:11], s24 offen offset:3072 sc1
s_waitcnt vmcnt(21)
v_mfma_f32_16x16x32_bf16 v[96:99], v[224:227], v[64:67], v[96:99]
ds_read_b64_tr_b16 v[112:113], v8 offset:8192
v_mfma_f32_16x16x32_bf16 v[100:103], v[228:231], v[64:67], v[100:103]
ds_read_b64_tr_b16 v[114:115], v8 offset:9216
v_mfma_f32_16x16x32_bf16 v[104:107], v[232:235], v[64:67], v[104:107]
ds_read_b64_tr_b16 v[116:117], v9 offset:8192
v_mfma_f32_16x16x32_bf16 v[108:111], v[236:239], v[64:67], v[108:111]
ds_read_b64_tr_b16 v[118:119], v9 offset:9216
s_add_u32 s24, s48, s37
buffer_load_dwordx4 v[64:67], v1, s[8:11], s24 offen offset:0 sc1
s_waitcnt vmcnt(21)
v_mfma_f32_16x16x32_bf16 v[96:99], v[240:243], v[68:71], v[96:99]
ds_read_b64_tr_b16 v[120:121], v10 offset:8192
v_mfma_f32_16x16x32_bf16 v[100:103], v[244:247], v[68:71], v[100:103]
ds_read_b64_tr_b16 v[122:123], v10 offset:9216
v_mfma_f32_16x16x32_bf16 v[104:107], v[248:251], v[68:71], v[104:107]
ds_read_b64_tr_b16 v[124:125], v11 offset:8192
v_mfma_f32_16x16x32_bf16 v[108:111], v[252:255], v[68:71], v[108:111]
ds_read_b64_tr_b16 v[126:127], v11 offset:9216
buffer_load_dwordx4 v[68:71], v1, s[8:11], s24 offen offset:1024 sc1
s_waitcnt vmcnt(21)
v_mfma_f32_16x16x32_bf16 v[96:99], a[0:3], v[72:75], v[96:99]
v_mfma_f32_16x16x32_bf16 v[100:103], a[4:7], v[72:75], v[100:103]
v_mfma_f32_16x16x32_bf16 v[104:107], a[8:11], v[72:75], v[104:107]
v_mfma_f32_16x16x32_bf16 v[108:111], a[12:15], v[72:75], v[108:111]
buffer_load_dwordx4 v[72:75], v1, s[8:11], s24 offen offset:2048 sc1
s_waitcnt vmcnt(21) lgkmcnt(0)
v_mfma_f32_16x16x32_bf16 v[96:99], v[112:115], v[76:79], v[96:99]
v_mfma_f32_16x16x32_bf16 v[100:103], v[116:119], v[76:79], v[100:103]
v_mfma_f32_16x16x32_bf16 v[104:107], v[120:123], v[76:79], v[104:107]
v_mfma_f32_16x16x32_bf16 v[108:111], v[124:127], v[76:79], v[108:111]
buffer_load_dwordx4 v[76:79], v1, s[8:11], s24 offen offset:3072 sc1
s_waitcnt vmcnt(21)
v_mfma_f32_16x16x32_bf16 v[96:99], a[16:19], v[80:83], v[96:99]
ds_read_b64_tr_b16 v[112:113], v8 offset:12288
v_mfma_f32_16x16x32_bf16 v[100:103], a[20:23], v[80:83], v[100:103]
ds_read_b64_tr_b16 v[114:115], v8 offset:13312
v_mfma_f32_16x16x32_bf16 v[104:107], a[24:27], v[80:83], v[104:107]
ds_read_b64_tr_b16 v[116:117], v9 offset:12288
v_mfma_f32_16x16x32_bf16 v[108:111], a[28:31], v[80:83], v[108:111]
ds_read_b64_tr_b16 v[118:119], v9 offset:13312
s_waitcnt vmcnt(12)
v_cmp_ne_u32 vcc, 1, v6
s_nop 0
s_cmp_eq_u64 vcc, 0
s_cselect_b32 s50, s52, 0
s_cmp_eq_u32 s50, 1
s_cselect_b32 s49, s49, 536870912
s_add_u32 s24, s49, s30
buffer_load_dwordx4 v[80:83], v1, s[8:11], s24 offen offset:0 sc1
s_waitcnt vmcnt(21)
v_mfma_f32_16x16x32_bf16 v[96:99], a[32:35], v[84:87], v[96:99]
ds_read_b64_tr_b16 v[120:121], v10 offset:12288
v_mfma_f32_16x16x32_bf16 v[100:103], a[36:39], v[84:87], v[100:103]
ds_read_b64_tr_b16 v[122:123], v10 offset:13312
v_mfma_f32_16x16x32_bf16 v[104:107], a[40:43], v[84:87], v[104:107]
ds_read_b64_tr_b16 v[124:125], v11 offset:12288
v_mfma_f32_16x16x32_bf16 v[108:111], a[44:47], v[84:87], v[108:111]
ds_read_b64_tr_b16 v[126:127], v11 offset:13312
buffer_load_dwordx4 v[84:87], v1, s[8:11], s24 offen offset:1024 sc1
s_waitcnt vmcnt(21)
v_mfma_f32_16x16x32_bf16 v[96:99], a[48:51], v[88:91], v[96:99]
v_mfma_f32_16x16x32_bf16 v[100:103], a[52:55], v[88:91], v[100:103]
v_mfma_f32_16x16x32_bf16 v[104:107], a[56:59], v[88:91], v[104:107]
v_mfma_f32_16x16x32_bf16 v[108:111], a[60:63], v[88:91], v[108:111]
buffer_load_dwordx4 v[88:91], v1, s[8:11], s24 offen offset:2048 sc1
s_waitcnt vmcnt(21) lgkmcnt(0)
v_mfma_f32_16x16x32_bf16 v[96:99], v[112:115], v[92:95], v[96:99]
v_mfma_f32_16x16x32_bf16 v[100:103], v[116:119], v[92:95], v[100:103]
v_mfma_f32_16x16x32_bf16 v[104:107], v[120:123], v[92:95], v[104:107]
v_mfma_f32_16x16x32_bf16 v[108:111], v[124:127], v[92:95], v[108:111]
buffer_load_dwordx4 v[92:95], v1, s[8:11], s24 offen offset:3072 sc1
s_waitcnt vmcnt(21)
v_mfma_f32_16x16x32_bf16 v[96:99], a[64:67], v[16:19], v[96:99]
ds_read_b64_tr_b16 v[112:113], v8 offset:16384
v_mfma_f32_16x16x32_bf16 v[100:103], a[68:71], v[16:19], v[100:103]
ds_read_b64_tr_b16 v[114:115], v8 offset:17408
v_mfma_f32_16x16x32_bf16 v[104:107], a[72:75], v[16:19], v[104:107]
ds_read_b64_tr_b16 v[116:117], v9 offset:16384
v_mfma_f32_16x16x32_bf16 v[108:111], a[76:79], v[16:19], v[108:111]
ds_read_b64_tr_b16 v[118:119], v9 offset:17408
s_add_u32 s24, s49, s31
buffer_load_dwordx4 v[16:19], v1, s[8:11], s24 offen offset:0 sc1
s_waitcnt vmcnt(21)
v_mfma_f32_16x16x32_bf16 v[96:99], a[80:83], v[20:23], v[96:99]
ds_read_b64_tr_b16 v[120:121], v10 offset:16384
v_mfma_f32_16x16x32_bf16 v[100:103], a[84:87], v[20:23], v[100:103]
ds_read_b64_tr_b16 v[122:123], v10 offset:17408
v_mfma_f32_16x16x32_bf16 v[104:107], a[88:91], v[20:23], v[104:107]
ds_read_b64_tr_b16 v[124:125], v11 offset:16384
v_mfma_f32_16x16x32_bf16 v[108:111], a[92:95], v[20:23], v[108:111]
ds_read_b64_tr_b16 v[126:127], v11 offset:17408
buffer_load_dwordx4 v[20:23], v1, s[8:11], s24 offen offset:1024 sc1
s_waitcnt vmcnt(21)
v_mfma_f32_16x16x32_bf16 v[96:99], a[96:99], v[24:27], v[96:99]
v_mfma_f32_16x16x32_bf16 v[100:103], a[100:103], v[24:27], v[100:103]
v_mfma_f32_16x16x32_bf16 v[104:107], a[104:107], v[24:27], v[104:107]
v_mfma_f32_16x16x32_bf16 v[108:111], a[108:111], v[24:27], v[108:111]
buffer_load_dwordx4 v[24:27], v1, s[8:11], s24 offen offset:2048 sc1
s_waitcnt vmcnt(21) lgkmcnt(0)
v_mfma_f32_16x16x32_bf16 v[96:99], v[112:115], v[28:31], v[96:99]
v_mfma_f32_16x16x32_bf16 v[100:103], v[116:119], v[28:31], v[100:103]
v_mfma_f32_16x16x32_bf16 v[104:107], v[120:123], v[28:31], v[104:107]
v_mfma_f32_16x16x32_bf16 v[108:111], v[124:127], v[28:31], v[108:111]
buffer_load_dwordx4 v[28:31], v1, s[8:11], s24 offen offset:3072 sc1
s_waitcnt vmcnt(19)
v_mfma_f32_16x16x32_bf16 v[96:99], a[112:115], v[32:35], v[96:99]
ds_read_b64_tr_b16 v[112:113], v8 offset:20480
v_mfma_f32_16x16x32_bf16 v[100:103], a[116:119], v[32:35], v[100:103]
ds_read_b64_tr_b16 v[114:115], v8 offset:21504
v_mfma_f32_16x16x32_bf16 v[104:107], a[120:123], v[32:35], v[104:107]
ds_read_b64_tr_b16 v[116:117], v9 offset:20480
v_mfma_f32_16x16x32_bf16 v[108:111], a[124:127], v[32:35], v[108:111]
ds_read_b64_tr_b16 v[118:119], v9 offset:21504
s_add_u32 s24, s49, s32
buffer_load_dwordx4 v[32:35], v1, s[8:11], s24 offen offset:0 sc1
s_waitcnt vmcnt(19)
v_mfma_f32_16x16x32_bf16 v[96:99], a[128:131], v[36:39], v[96:99]
ds_read_b64_tr_b16 v[120:121], v10 offset:20480
v_mfma_f32_16x16x32_bf16 v[100:103], a[132:135], v[36:39], v[100:103]
ds_read_b64_tr_b16 v[122:123], v10 offset:21504
v_mfma_f32_16x16x32_bf16 v[104:107], a[136:139], v[36:39], v[104:107]
ds_read_b64_tr_b16 v[124:125], v11 offset:20480
v_mfma_f32_16x16x32_bf16 v[108:111], a[140:143], v[36:39], v[108:111]
ds_read_b64_tr_b16 v[126:127], v11 offset:21504
buffer_load_dwordx4 v[36:39], v1, s[8:11], s24 offen offset:1024 sc1
s_waitcnt vmcnt(19)
v_mfma_f32_16x16x32_bf16 v[96:99], a[144:147], v[40:43], v[96:99]
v_mfma_f32_16x16x32_bf16 v[100:103], a[148:151], v[40:43], v[100:103]
v_mfma_f32_16x16x32_bf16 v[104:107], a[152:155], v[40:43], v[104:107]
v_mfma_f32_16x16x32_bf16 v[108:111], a[156:159], v[40:43], v[108:111]
buffer_load_dwordx4 v[40:43], v1, s[8:11], s24 offen offset:2048 sc1
s_waitcnt vmcnt(19) lgkmcnt(0)
v_mfma_f32_16x16x32_bf16 v[96:99], v[112:115], v[44:47], v[96:99]
v_mfma_f32_16x16x32_bf16 v[100:103], v[116:119], v[44:47], v[100:103]
v_mfma_f32_16x16x32_bf16 v[104:107], v[120:123], v[44:47], v[104:107]
v_mfma_f32_16x16x32_bf16 v[108:111], v[124:127], v[44:47], v[108:111]
buffer_load_dwordx4 v[44:47], v1, s[8:11], s24 offen offset:3072 sc1
s_waitcnt vmcnt(19)
v_mfma_f32_16x16x32_bf16 v[96:99], a[160:163], v[48:51], v[96:99]
ds_read_b64_tr_b16 v[112:113], v8 offset:24576
v_mfma_f32_16x16x32_bf16 v[100:103], a[164:167], v[48:51], v[100:103]
ds_read_b64_tr_b16 v[114:115], v8 offset:25600
v_mfma_f32_16x16x32_bf16 v[104:107], a[168:171], v[48:51], v[104:107]
ds_read_b64_tr_b16 v[116:117], v9 offset:24576
v_mfma_f32_16x16x32_bf16 v[108:111], a[172:175], v[48:51], v[108:111]
ds_read_b64_tr_b16 v[118:119], v9 offset:25600
s_add_u32 s24, s49, s33
buffer_load_dwordx4 v[48:51], v1, s[8:11], s24 offen offset:0 sc1
s_waitcnt vmcnt(19)
v_mfma_f32_16x16x32_bf16 v[96:99], a[176:179], v[52:55], v[96:99]
ds_read_b64_tr_b16 v[120:121], v10 offset:24576
v_mfma_f32_16x16x32_bf16 v[100:103], a[180:183], v[52:55], v[100:103]
ds_read_b64_tr_b16 v[122:123], v10 offset:25600
v_mfma_f32_16x16x32_bf16 v[104:107], a[184:187], v[52:55], v[104:107]
ds_read_b64_tr_b16 v[124:125], v11 offset:24576
v_mfma_f32_16x16x32_bf16 v[108:111], a[188:191], v[52:55], v[108:111]
ds_read_b64_tr_b16 v[126:127], v11 offset:25600
buffer_load_dwordx4 v[52:55], v1, s[8:11], s24 offen offset:1024 sc1
s_waitcnt vmcnt(19)
v_mfma_f32_16x16x32_bf16 v[96:99], a[192:195], v[56:59], v[96:99]
v_mfma_f32_16x16x32_bf16 v[100:103], a[196:199], v[56:59], v[100:103]
v_mfma_f32_16x16x32_bf16 v[104:107], a[200:203], v[56:59], v[104:107]
v_mfma_f32_16x16x32_bf16 v[108:111], a[204:207], v[56:59], v[108:111]
buffer_load_dwordx4 v[56:59], v1, s[8:11], s24 offen offset:2048 sc1
s_waitcnt vmcnt(19) lgkmcnt(0)
v_mfma_f32_16x16x32_bf16 v[96:99], v[112:115], v[60:63], v[96:99]
v_mfma_f32_16x16x32_bf16 v[100:103], v[116:119], v[60:63], v[100:103]
v_mfma_f32_16x16x32_bf16 v[104:107], v[120:123], v[60:63], v[104:107]
v_mfma_f32_16x16x32_bf16 v[108:111], v[124:127], v[60:63], v[108:111]
buffer_load_dwordx4 v[60:63], v1, s[8:11], s24 offen offset:3072 sc1
s_waitcnt vmcnt(19)
v_mfma_f32_16x16x32_bf16 v[96:99], a[208:211], v[64:67], v[96:99]
ds_read_b64_tr_b16 v[112:113], v8 offset:28672
v_mfma_f32_16x16x32_bf16 v[100:103], a[212:215], v[64:67], v[100:103]
ds_read_b64_tr_b16 v[114:115], v8 offset:29696
v_mfma_f32_16x16x32_bf16 v[104:107], a[216:219], v[64:67], v[104:107]
ds_read_b64_tr_b16 v[116:117], v9 offset:28672
v_mfma_f32_16x16x32_bf16 v[108:111], a[220:223], v[64:67], v[108:111]
ds_read_b64_tr_b16 v[118:119], v9 offset:29696
s_add_u32 s24, s49, s34
buffer_load_dwordx4 v[64:67], v1, s[8:11], s24 offen offset:0 sc1
s_waitcnt vmcnt(19)
v_mfma_f32_16x16x32_bf16 v[96:99], a[224:227], v[68:71], v[96:99]
ds_read_b64_tr_b16 v[120:121], v10 offset:28672
v_mfma_f32_16x16x32_bf16 v[100:103], a[228:231], v[68:71], v[100:103]
ds_read_b64_tr_b16 v[122:123], v10 offset:29696
v_mfma_f32_16x16x32_bf16 v[104:107], a[232:235], v[68:71], v[104:107]
ds_read_b64_tr_b16 v[124:125], v11 offset:28672
v_mfma_f32_16x16x32_bf16 v[108:111], a[236:239], v[68:71], v[108:111]
ds_read_b64_tr_b16 v[126:127], v11 offset:29696
buffer_load_dwordx4 v[68:71], v1, s[8:11], s24 offen offset:1024 sc1
s_waitcnt vmcnt(19)
v_mfma_f32_16x16x32_bf16 v[96:99], a[240:243], v[72:75], v[96:99]
v_mfma_f32_16x16x32_bf16 v[100:103], a[244:247], v[72:75], v[100:103]
v_mfma_f32_16x16x32_bf16 v[104:107], a[248:251], v[72:75], v[104:107]
v_mfma_f32_16x16x32_bf16 v[108:111], a[252:255], v[72:75], v[108:111]
buffer_load_dwordx4 v[72:75], v1, s[8:11], s24 offen offset:2048 sc1
s_waitcnt vmcnt(19) lgkmcnt(0)
v_mfma_f32_16x16x32_bf16 v[96:99], v[112:115], v[76:79], v[96:99]
v_mfma_f32_16x16x32_bf16 v[100:103], v[116:119], v[76:79], v[100:103]
v_mfma_f32_16x16x32_bf16 v[104:107], v[120:123], v[76:79], v[104:107]
v_mfma_f32_16x16x32_bf16 v[108:111], v[124:127], v[76:79], v[108:111]
buffer_load_dwordx4 v[76:79], v1, s[8:11], s24 offen offset:3072 sc1
s_nop 3
ds_write_b128 v3, v[96:99] offset:0
ds_write_b128 v3, v[100:103] offset:4096
ds_write_b128 v3, v[104:107] offset:8192
ds_write_b128 v3, v[108:111] offset:12288
s_waitcnt lgkmcnt(0)
s_barrier
ds_read_b128 v[96:99], v7 offset:0
ds_read_b128 v[100:103], v7 offset:1024
ds_read_b128 v[104:107], v7 offset:2048
ds_read_b128 v[108:111], v7 offset:3072
ds_read_b64_tr_b16 v[112:113], v8 offset:0
ds_read_b64_tr_b16 v[114:115], v8 offset:1024
ds_read_b64_tr_b16 v[116:117], v9 offset:0
ds_read_b64_tr_b16 v[118:119], v9 offset:1024
ds_read_b64_tr_b16 v[120:121], v10 offset:0
ds_read_b64_tr_b16 v[122:123], v10 offset:1024
ds_read_b64_tr_b16 v[124:125], v11 offset:0
ds_read_b64_tr_b16 v[126:127], v11 offset:1024
s_mul_i32 s24, s41, 36864
s_waitcnt lgkmcnt(10)
v_pk_add_f32 v[96:97], v[96:97], v[100:101]
v_pk_add_f32 v[98:99], v[98:99], v[102:103]
s_waitcnt lgkmcnt(9)
v_pk_add_f32 v[96:97], v[96:97], v[104:105]
v_pk_add_f32 v[98:99], v[98:99], v[106:107]
s_waitcnt lgkmcnt(8)
v_pk_add_f32 v[96:97], v[96:97], v[108:109]
v_pk_add_f32 v[98:99], v[98:99], v[110:111]
v_cvt_pk_bf16_f32 v12, v96, v97
v_cvt_pk_bf16_f32 v13, v98, v99
buffer_store_dwordx2 v[12:13], v4, s[12:15], s24 offen
v_xor_b32 v3, 16384, v3
v_xor_b32 v7, 16384, v7
s_mov_b32 s41, s27
s_mov_b32 s48, s49
s_cmp_eq_u32 s50, 0
s_cbranch_scc1 L_opl_c
L_opl_r3:
s_cmp_lg_u64 s[42:43], 0
s_cselect_b32 s52, 1, 0
s_ff1_i32_b64 s27, s[42:43]
s_bitset0_b64 s[42:43], s27
s_lshl_b32 s27, s27, 1
s_add_u32 s27, s27, s51
s_and_b32 s27, s27, 127
s_lshr_b32 s25, s27, s46
s_lshl_b32 s25, s25, 7
s_add_u32 s25, s25, s45
buffer_load_dword v6, v5, s[8:11], s25 offen sc1
s_lshl_b32 s49, s27, 17
s_add_u32 s49, s49, s44
s_waitcnt vmcnt(21)
v_mfma_f32_16x16x32_bf16 v[96:99], v[128:131], v[80:83], 0
v_mfma_f32_16x16x32_bf16 v[100:103], v[132:135], v[80:83], 0
v_mfma_f32_16x16x32_bf16 v[104:107], v[136:139], v[80:83], 0
v_mfma_f32_16x16x32_bf16 v[108:111], v[140:143], v[80:83], 0
s_add_u32 s24, s48, s35
buffer_load_dwordx4 v[80:83], v1, s[8:11], s24 offen offset:0 sc1
s_waitcnt vmcnt(21)
v_mfma_f32_16x16x32_bf16 v[96:99], v[144:147], v[84:87], v[96:99]
v_mfma_f32_16x16x32_bf16 v[100:103], v[148:151], v[84:87], v[100:103]
v_mfma_f32_16x16x32_bf16 v[104:107], v[152:155], v[84:87], v[104:107]
v_mfma_f32_16x16x32_bf16 v[108:111], v[156:159], v[84:87], v[108:111]
buffer_load_dwordx4 v[84:87], v1, s[8:11], s24 offen offset:1024 sc1
s_waitcnt vmcnt(21)
v_mfma_f32_16x16x32_bf16 v[96:99], v[160:163], v[88:91], v[96:99]
v_mfma_f32_16x16x32_bf16 v[100:103], v[164:167], v[88:91], v[100:103]
v_mfma_f32_16x16x32_bf16 v[104:107], v[168:171], v[88:91], v[104:107]
v_mfma_f32_16x16x32_bf16 v[108:111], v[172:175], v[88:91], v[108:111]
buffer_load_dwordx4 v[88:91], v1, s[8:11], s24 offen offset:2048 sc1
s_waitcnt vmcnt(21) lgkmcnt(0)
v_mfma_f32_16x16x32_bf16 v[96:99], v[112:115], v[92:95], v[96:99]
v_mfma_f32_16x16x32_bf16 v[100:103], v[116:119], v[92:95], v[100:103]
v_mfma_f32_16x16x32_bf16 v[104:107], v[120:123], v[92:95], v[104:107]
v_mfma_f32_16x16x32_bf16 v[108:111], v[124:127], v[92:95], v[108:111]
buffer_load_dwordx4 v[92:95], v1, s[8:11], s24 offen offset:3072 sc1
s_waitcnt vmcnt(21)
v_mfma_f32_16x16x32_bf16 v[96:99], v[176:179], v[16:19], v[96:99]
ds_read_b64_tr_b16 v[112:113], v8 offset:4096
v_mfma_f32_16x16x32_bf16 v[100:103], v[180:183], v[16:19], v[100:103]
ds_read_b64_tr_b16 v[114:115], v8 offset:5120
v_mfma_f32_16x16x32_bf16 v[104:107], v[184:187], v[16:19], v[104:107]
ds_read_b64_tr_b16 v[116:117], v9 offset:4096
v_mfma_f32_16x16x32_bf16 v[108:111], v[188:191], v[16:19], v[108:111]
ds_read_b64_tr_b16 v[118:119], v9 offset:5120
s_add_u32 s24, s48, s36
buffer_load_dwordx4 v[16:19], v1, s[8:11], s24 offen offset:0 sc1
s_waitcnt vmcnt(21)
v_mfma_f32_16x16x32_bf16 v[96:99], v[192:195], v[20:23], v[96:99]
ds_read_b64_tr_b16 v[120:121], v10 offset:4096
v_mfma_f32_16x16x32_bf16 v[100:103], v[196:199], v[20:23], v[100:103]
ds_read_b64_tr_b16 v[122:123], v10 offset:5120
v_mfma_f32_16x16x32_bf16 v[104:107], v[200:203], v[20:23], v[104:107]
ds_read_b64_tr_b16 v[124:125], v11 offset:4096
v_mfma_f32_16x16x32_bf16 v[108:111], v[204:207], v[20:23], v[108:111]
ds_read_b64_tr_b16 v[126:127], v11 offset:5120
buffer_load_dwordx4 v[20:23], v1, s[8:11], s24 offen offset:1024 sc1
s_waitcnt vmcnt(21)
v_mfma_f32_16x16x32_bf16 v[96:99], v[208:211], v[24:27], v[96:99]
v_mfma_f32_16x16x32_bf16 v[100:103], v[212:215], v[24:27], v[100:103]
v_mfma_f32_16x16x32_bf16 v[104:107], v[216:219], v[24:27], v[104:107]
v_mfma_f32_16x16x32_bf16 v[108:111], v[220:223], v[24:27], v[108:111]
buffer_load_dwordx4 v[24:27], v1, s[8:11], s24 offen offset:2048 sc1
s_waitcnt vmcnt(21) lgkmcnt(0)
v_mfma_f32_16x16x32_bf16 v[96:99], v[112:115], v[28:31], v[96:99]
v_mfma_f32_16x16x32_bf16 v[100:103], v[116:119], v[28:31], v[100:103]
v_mfma_f32_16x16x32_bf16 v[104:107], v[120:123], v[28:31], v[104:107]
v_mfma_f32_16x16x32_bf16 v[108:111], v[124:127], v[28:31], v[108:111]
buffer_load_dwordx4 v[28:31], v1, s[8:11], s24 offen offset:3072 sc1
s_waitcnt vmcnt(21)
v_mfma_f32_16x16x32_bf16 v[96:99], v[224:227], v[32:35], v[96:99]
ds_read_b64_tr_b16 v[112:113], v8 offset:8192
v_mfma_f32_16x16x32_bf16 v[100:103], v[228:231], v[32:35], v[100:103]
ds_read_b64_tr_b16 v[114:115], v8 offset:9216
v_mfma_f32_16x16x32_bf16 v[104:107], v[232:235], v[32:35], v[104:107]
ds_read_b64_tr_b16 v[116:117], v9 offset:8192
v_mfma_f32_16x16x32_bf16 v[108:111], v[236:239], v[32:35], v[108:111]
ds_read_b64_tr_b16 v[118:119], v9 offset:9216
s_add_u32 s24, s48, s37
buffer_load_dwordx4 v[32:35], v1, s[8:11], s24 offen offset:0 sc1
s_waitcnt vmcnt(21)
v_mfma_f32_16x16x32_bf16 v[96:99], v[240:243], v[36:39], v[96:99]
ds_read_b64_tr_b16 v[120:121], v10 offset:8192
v_mfma_f32_16x16x32_bf16 v[100:103], v[244:247], v[36:39], v[100:103]
ds_read_b64_tr_b16 v[122:123], v10 offset:9216
v_mfma_f32_16x16x32_bf16 v[104:107], v[248:251], v[36:39], v[104:107]
ds_read_b64_tr_b16 v[124:125], v11 offset:8192
v_mfma_f32_16x16x32_bf16 v[108:111], v[252:255], v[36:39], v[108:111]
ds_read_b64_tr_b16 v[126:127], v11 offset:9216
buffer_load_dwordx4 v[36:39], v1, s[8:11], s24 offen offset:1024 sc1
s_waitcnt vmcnt(21)
v_mfma_f32_16x16x32_bf16 v[96:99], a[0:3], v[40:43], v[96:99]
v_mfma_f32_16x16x32_bf16 v[100:103], a[4:7], v[40:43], v[100:103]
v_mfma_f32_16x16x32_bf16 v[104:107], a[8:11], v[40:43], v[104:107]
v_mfma_f32_16x16x32_bf16 v[108:111], a[12:15], v[40:43], v[108:111]
buffer_load_dwordx4 v[40:43], v1, s[8:11], s24 offen offset:2048 sc1
s_waitcnt vmcnt(21) lgkmcnt(0)
v_mfma_f32_16x16x32_bf16 v[96:99], v[112:115], v[44:47], v[96:99]
v_mfma_f32_16x16x32_bf16 v[100:103], v[116:119], v[44:47], v[100:103]
v_mfma_f32_16x16x32_bf16 v[104:107], v[120:123], v[44:47], v[104:107]
v_mfma_f32_16x16x32_bf16 v[108:111], v[124:127], v[44:47], v[108:111]
buffer_load_dwordx4 v[44:47], v1, s[8:11], s24 offen offset:3072 sc1
s_waitcnt vmcnt(21)
v_mfma_f32_16x16x32_bf16 v[96:99], a[16:19], v[48:51], v[96:99]
ds_read_b64_tr_b16 v[112:113], v8 offset:12288
v_mfma_f32_16x16x32_bf16 v[100:103], a[20:23], v[48:51], v[100:103]
ds_read_b64_tr_b16 v[114:115], v8 offset:13312
v_mfma_f32_16x16x32_bf16 v[104:107], a[24:27], v[48:51], v[104:107]
ds_read_b64_tr_b16 v[116:117], v9 offset:12288
v_mfma_f32_16x16x32_bf16 v[108:111], a[28:31], v[48:51], v[108:111]
ds_read_b64_tr_b16 v[118:119], v9 offset:13312
s_waitcnt vmcnt(12)
v_cmp_ne_u32 vcc, 1, v6
s_nop 0
s_cmp_eq_u64 vcc, 0
s_cselect_b32 s50, s52, 0
s_cmp_eq_u32 s50, 1
s_cselect_b32 s49, s49, 536870912
s_add_u32 s24, s49, s30
buffer_load_dwordx4 v[48:51], v1, s[8:11], s24 offen offset:0 sc1
s_waitcnt vmcnt(21)
v_mfma_f32_16x16x32_bf16 v[96:99], a[32:35], v[52:55], v[96:99]
ds_read_b64_tr_b16 v[120:121], v10 offset:12288
v_mfma_f32_16x16x32_bf16 v[100:103], a[36:39], v[52:55], v[100:103]
ds_read_b64_tr_b16 v[122:123], v10 offset:13312
v_mfma_f32_16x16x32_bf16 v[104:107], a[40:43], v[52:55], v[104:107]
ds_read_b64_tr_b16 v[124:125], v11 offset:12288
v_mfma_f32_16x16x32_bf16 v[108:111], a[44:47], v[52:55], v[108:111]
ds_read_b64_tr_b16 v[126:127], v11 offset:13312
buffer_load_dwordx4 v[52:55], v1, s[8:11], s24 offen offset:1024 sc1
s_waitcnt vmcnt(21)
v_mfma_f32_16x16x32_bf16 v[96:99], a[48:51], v[56:59], v[96:99]
v_mfma_f32_16x16x32_bf16 v[100:103], a[52:55], v[56:59], v[100:103]
v_mfma_f32_16x16x32_bf16 v[104:107], a[56:59], v[56:59], v[104:107]
v_mfma_f32_16x16x32_bf16 v[108:111], a[60:63], v[56:59], v[108:111]
buffer_load_dwordx4 v[56:59], v1, s[8:11], s24 offen offset:2048 sc1
s_waitcnt vmcnt(21) lgkmcnt(0)
v_mfma_f32_16x16x32_bf16 v[96:99], v[112:115], v[60:63], v[96:99]
v_mfma_f32_16x16x32_bf16 v[100:103], v[116:119], v[60:63], v[100:103]
v_mfma_f32_16x16x32_bf16 v[104:107], v[120:123], v[60:63], v[104:107]
v_mfma_f32_16x16x32_bf16 v[108:111], v[124:127], v[60:63], v[108:111]
buffer_load_dwordx4 v[60:63], v1, s[8:11], s24 offen offset:3072 sc1
s_waitcnt vmcnt(21)
v_mfma_f32_16x16x32_bf16 v[96:99], a[64:67], v[64:67], v[96:99]
ds_read_b64_tr_b16 v[112:113], v8 offset:16384
v_mfma_f32_16x16x32_bf16 v[100:103], a[68:71], v[64:67], v[100:103]
ds_read_b64_tr_b16 v[114:115], v8 offset:17408
v_mfma_f32_16x16x32_bf16 v[104:107], a[72:75], v[64:67], v[104:107]
ds_read_b64_tr_b16 v[116:117], v9 offset:16384
v_mfma_f32_16x16x32_bf16 v[108:111], a[76:79], v[64:67], v[108:111]
ds_read_b64_tr_b16 v[118:119], v9 offset:17408
s_add_u32 s24, s49, s31
buffer_load_dwordx4 v[64:67], v1, s[8:11], s24 offen offset:0 sc1
s_waitcnt vmcnt(21)
v_mfma_f32_16x16x32_bf16 v[96:99], a[80:83], v[68:71], v[96:99]
ds_read_b64_tr_b16 v[120:121], v10 offset:16384
v_mfma_f32_16x16x32_bf16 v[100:103], a[84:87], v[68:71], v[100:103]
ds_read_b64_tr_b16 v[122:123], v10 offset:17408
v_mfma_f32_16x16x32_bf16 v[104:107], a[88:91], v[68:71], v[104:107]
ds_read_b64_tr_b16 v[124:125], v11 offset:16384
v_mfma_f32_16x16x32_bf16 v[108:111], a[92:95], v[68:71], v[108:111]
ds_read_b64_tr_b16 v[126:127], v11 offset:17408
buffer_load_dwordx4 v[68:71], v1, s[8:11], s24 offen offset:1024 sc1
s_waitcnt vmcnt(21)
v_mfma_f32_16x16x32_bf16 v[96:99], a[96:99], v[72:75], v[96:99]
v_mfma_f32_16x16x32_bf16 v[100:103], a[100:103], v[72:75], v[100:103]
v_mfma_f32_16x16x32_bf16 v[104:107], a[104:107], v[72:75], v[104:107]
v_mfma_f32_16x16x32_bf16 v[108:111], a[108:111], v[72:75], v[108:111]
buffer_load_dwordx4 v[72:75], v1, s[8:11], s24 offen offset:2048 sc1
s_waitcnt vmcnt(21) lgkmcnt(0)
v_mfma_f32_16x16x32_bf16 v[96:99], v[112:115], v[76:79], v[96:99]
v_mfma_f32_16x16x32_bf16 v[100:103], v[116:119], v[76:79], v[100:103]
v_mfma_f32_16x16x32_bf16 v[104:107], v[120:123], v[76:79], v[104:107]
v_mfma_f32_16x16x32_bf16 v[108:111], v[124:127], v[76:79], v[108:111]
buffer_load_dwordx4 v[76:79], v1, s[8:11], s24 offen offset:3072 sc1
s_waitcnt vmcnt(19)
v_mfma_f32_16x16x32_bf16 v[96:99], a[112:115], v[80:83], v[96:99]
ds_read_b64_tr_b16 v[112:113], v8 offset:20480
v_mfma_f32_16x16x32_bf16 v[100:103], a[116:119], v[80:83], v[100:103]
ds_read_b64_tr_b16 v[114:115], v8 offset:21504
v_mfma_f32_16x16x32_bf16 v[104:107], a[120:123], v[80:83], v[104:107]
ds_read_b64_tr_b16 v[116:117], v9 offset:20480
v_mfma_f32_16x16x32_bf16 v[108:111], a[124:127], v[80:83], v[108:111]
ds_read_b64_tr_b16 v[118:119], v9 offset:21504
s_add_u32 s24, s49, s32
buffer_load_dwordx4 v[80:83], v1, s[8:11], s24 offen offset:0 sc1
s_waitcnt vmcnt(19)
v_mfma_f32_16x16x32_bf16 v[96:99], a[128:131], v[84:87], v[96:99]
ds_read_b64_tr_b16 v[120:121], v10 offset:20480
v_mfma_f32_16x16x32_bf16 v[100:103], a[132:135], v[84:87], v[100:103]
ds_read_b64_tr_b16 v[122:123], v10 offset:21504
v_mfma_f32_16x16x32_bf16 v[104:107], a[136:139], v[84:87], v[104:107]
ds_read_b64_tr_b16 v[124:125], v11 offset:20480
v_mfma_f32_16x16x32_bf16 v[108:111], a[140:143], v[84:87], v[108:111]
ds_read_b64_tr_b16 v[126:127], v11 offset:21504
buffer_load_dwordx4 v[84:87], v1, s[8:11], s24 offen offset:1024 sc1
s_waitcnt vmcnt(19)
v_mfma_f32_16x16x32_bf16 v[96:99], a[144:147], v[88:91], v[96:99]
v_mfma_f32_16x16x32_bf16 v[100:103], a[148:151], v[88:91], v[100:103]
v_mfma_f32_16x16x32_bf16 v[104:107], a[152:155], v[88:91], v[104:107]
v_mfma_f32_16x16x32_bf16 v[108:111], a[156:159], v[88:91], v[108:111]
buffer_load_dwordx4 v[88:91], v1, s[8:11], s24 offen offset:2048 sc1
s_waitcnt vmcnt(19) lgkmcnt(0)
v_mfma_f32_16x16x32_bf16 v[96:99], v[112:115], v[92:95], v[96:99]
v_mfma_f32_16x16x32_bf16 v[100:103], v[116:119], v[92:95], v[100:103]
v_mfma_f32_16x16x32_bf16 v[104:107], v[120:123], v[92:95], v[104:107]
v_mfma_f32_16x16x32_bf16 v[108:111], v[124:127], v[92:95], v[108:111]
buffer_load_dwordx4 v[92:95], v1, s[8:11], s24 offen offset:3072 sc1
s_waitcnt vmcnt(19)
v_mfma_f32_16x16x32_bf16 v[96:99], a[160:163], v[16:19], v[96:99]
ds_read_b64_tr_b16 v[112:113], v8 offset:24576
v_mfma_f32_16x16x32_bf16 v[100:103], a[164:167], v[16:19], v[100:103]
ds_read_b64_tr_b16 v[114:115], v8 offset:25600
v_mfma_f32_16x16x32_bf16 v[104:107], a[168:171], v[16:19], v[104:107]
ds_read_b64_tr_b16 v[116:117], v9 offset:24576
v_mfma_f32_16x16x32_bf16 v[108:111], a[172:175], v[16:19], v[108:111]
ds_read_b64_tr_b16 v[118:119], v9 offset:25600
s_add_u32 s24, s49, s33
buffer_load_dwordx4 v[16:19], v1, s[8:11], s24 offen offset:0 sc1
s_waitcnt vmcnt(19)
v_mfma_f32_16x16x32_bf16 v[96:99], a[176:179], v[20:23], v[96:99]
ds_read_b64_tr_b16 v[120:121], v10 offset:24576
v_mfma_f32_16x16x32_bf16 v[100:103], a[180:183], v[20:23], v[100:103]
ds_read_b64_tr_b16 v[122:123], v10 offset:25600
v_mfma_f32_16x16x32_bf16 v[104:107], a[184:187], v[20:23], v[104:107]
ds_read_b64_tr_b16 v[124:125], v11 offset:24576
v_mfma_f32_16x16x32_bf16 v[108:111], a[188:191], v[20:23], v[108:111]
ds_read_b64_tr_b16 v[126:127], v11 offset:25600
buffer_load_dwordx4 v[20:23], v1, s[8:11], s24 offen offset:1024 sc1
s_waitcnt vmcnt(19)
v_mfma_f32_16x16x32_bf16 v[96:99], a[192:195], v[24:27], v[96:99]
v_mfma_f32_16x16x32_bf16 v[100:103], a[196:199], v[24:27], v[100:103]
v_mfma_f32_16x16x32_bf16 v[104:107], a[200:203], v[24:27], v[104:107]
v_mfma_f32_16x16x32_bf16 v[108:111], a[204:207], v[24:27], v[108:111]
buffer_load_dwordx4 v[24:27], v1, s[8:11], s24 offen offset:2048 sc1
s_waitcnt vmcnt(19) lgkmcnt(0)
v_mfma_f32_16x16x32_bf16 v[96:99], v[112:115], v[28:31], v[96:99]
v_mfma_f32_16x16x32_bf16 v[100:103], v[116:119], v[28:31], v[100:103]
v_mfma_f32_16x16x32_bf16 v[104:107], v[120:123], v[28:31], v[104:107]
v_mfma_f32_16x16x32_bf16 v[108:111], v[124:127], v[28:31], v[108:111]
buffer_load_dwordx4 v[28:31], v1, s[8:11], s24 offen offset:3072 sc1
s_waitcnt vmcnt(19)
v_mfma_f32_16x16x32_bf16 v[96:99], a[208:211], v[32:35], v[96:99]
ds_read_b64_tr_b16 v[112:113], v8 offset:28672
v_mfma_f32_16x16x32_bf16 v[100:103], a[212:215], v[32:35], v[100:103]
ds_read_b64_tr_b16 v[114:115], v8 offset:29696
v_mfma_f32_16x16x32_bf16 v[104:107], a[216:219], v[32:35], v[104:107]
ds_read_b64_tr_b16 v[116:117], v9 offset:28672
v_mfma_f32_16x16x32_bf16 v[108:111], a[220:223], v[32:35], v[108:111]
ds_read_b64_tr_b16 v[118:119], v9 offset:29696
s_add_u32 s24, s49, s34
buffer_load_dwordx4 v[32:35], v1, s[8:11], s24 offen offset:0 sc1
s_waitcnt vmcnt(19)
v_mfma_f32_16x16x32_bf16 v[96:99], a[224:227], v[36:39], v[96:99]
ds_read_b64_tr_b16 v[120:121], v10 offset:28672
v_mfma_f32_16x16x32_bf16 v[100:103], a[228:231], v[36:39], v[100:103]
ds_read_b64_tr_b16 v[122:123], v10 offset:29696
v_mfma_f32_16x16x32_bf16 v[104:107], a[232:235], v[36:39], v[104:107]
ds_read_b64_tr_b16 v[124:125], v11 offset:28672
v_mfma_f32_16x16x32_bf16 v[108:111], a[236:239], v[36:39], v[108:111]
ds_read_b64_tr_b16 v[126:127], v11 offset:29696
buffer_load_dwordx4 v[36:39], v1, s[8:11], s24 offen offset:1024 sc1
s_waitcnt vmcnt(19)
v_mfma_f32_16x16x32_bf16 v[96:99], a[240:243], v[40:43], v[96:99]
v_mfma_f32_16x16x32_bf16 v[100:103], a[244:247], v[40:43], v[100:103]
v_mfma_f32_16x16x32_bf16 v[104:107], a[248:251], v[40:43], v[104:107]
v_mfma_f32_16x16x32_bf16 v[108:111], a[252:255], v[40:43], v[108:111]
buffer_load_dwordx4 v[40:43], v1, s[8:11], s24 offen offset:2048 sc1
s_waitcnt vmcnt(19) lgkmcnt(0)
v_mfma_f32_16x16x32_bf16 v[96:99], v[112:115], v[44:47], v[96:99]
v_mfma_f32_16x16x32_bf16 v[100:103], v[116:119], v[44:47], v[100:103]
v_mfma_f32_16x16x32_bf16 v[104:107], v[120:123], v[44:47], v[104:107]
v_mfma_f32_16x16x32_bf16 v[108:111], v[124:127], v[44:47], v[108:111]
buffer_load_dwordx4 v[44:47], v1, s[8:11], s24 offen offset:3072 sc1
s_nop 3
ds_write_b128 v3, v[96:99] offset:0
ds_write_b128 v3, v[100:103] offset:4096
ds_write_b128 v3, v[104:107] offset:8192
ds_write_b128 v3, v[108:111] offset:12288
s_waitcnt lgkmcnt(0)
s_barrier
ds_read_b128 v[96:99], v7 offset:0
ds_read_b128 v[100:103], v7 offset:1024
ds_read_b128 v[104:107], v7 offset:2048
ds_read_b128 v[108:111], v7 offset:3072
ds_read_b64_tr_b16 v[112:113], v8 offset:0
ds_read_b64_tr_b16 v[114:115], v8 offset:1024
ds_read_b64_tr_b16 v[116:117], v9 offset:0
ds_read_b64_tr_b16 v[118:119], v9 offset:1024
ds_read_b64_tr_b16 v[120:121], v10 offset:0
ds_read_b64_tr_b16 v[122:123], v10 offset:1024
ds_read_b64_tr_b16 v[124:125], v11 offset:0
ds_read_b64_tr_b16 v[126:127], v11 offset:1024
s_mul_i32 s24, s41, 36864
s_waitcnt lgkmcnt(10)
v_pk_add_f32 v[96:97], v[96:97], v[100:101]
v_pk_add_f32 v[98:99], v[98:99], v[102:103]
s_waitcnt lgkmcnt(9)
v_pk_add_f32 v[96:97], v[96:97], v[104:105]
v_pk_add_f32 v[98:99], v[98:99], v[106:107]
s_waitcnt lgkmcnt(8)
v_pk_add_f32 v[96:97], v[96:97], v[108:109]
v_pk_add_f32 v[98:99], v[98:99], v[110:111]
v_cvt_pk_bf16_f32 v12, v96, v97
v_cvt_pk_bf16_f32 v13, v98, v99
buffer_store_dwordx2 v[12:13], v4, s[12:15], s24 offen
v_xor_b32 v3, 16384, v3
v_xor_b32 v7, 16384, v7
s_mov_b32 s41, s27
s_mov_b32 s48, s49
s_cmp_eq_u32 s50, 0
s_cbranch_scc1 L_opl_c
L_opl_r4:
s_cmp_lg_u64 s[42:43], 0
s_cselect_b32 s52, 1, 0
s_ff1_i32_b64 s27, s[42:43]
s_bitset0_b64 s[42:43], s27
s_lshl_b32 s27, s27, 1
s_add_u32 s27, s27, s51
s_and_b32 s27, s27, 127
s_lshr_b32 s25, s27, s46
s_lshl_b32 s25, s25, 7
s_add_u32 s25, s25, s45
buffer_load_dword v6, v5, s[8:11], s25 offen sc1
s_lshl_b32 s49, s27, 17
s_add_u32 s49, s49, s44
s_waitcnt vmcnt(21)
v_mfma_f32_16x16x32_bf16 v[96:99], v[128:131], v[48:51], 0
v_mfma_f32_16x16x32_bf16 v[100:103], v[132:135], v[48:51], 0
v_mfma_f32_16x16x32_bf16 v[104:107], v[136:139], v[48:51], 0
v_mfma_f32_16x16x32_bf16 v[108:111], v[140:143], v[48:51], 0
s_add_u32 s24, s48, s35
buffer_load_dwordx4 v[48:51], v1, s[8:11], s24 offen offset:0 sc1
s_waitcnt vmcnt(21)
v_mfma_f32_16x16x32_bf16 v[96:99], v[144:147], v[52:55], v[96:99]
v_mfma_f32_16x16x32_bf16 v[100:103], v[148:151], v[52:55], v[100:103]
v_mfma_f32_16x16x32_bf16 v[104:107], v[152:155], v[52:55], v[104:107]
v_mfma_f32_16x16x32_bf16 v[108:111], v[156:159], v[52:55], v[108:111]
buffer_load_dwordx4 v[52:55], v1, s[8:11], s24 offen offset:1024 sc1
s_waitcnt vmcnt(21)
v_mfma_f32_16x16x32_bf16 v[96:99], v[160:163], v[56:59], v[96:99]
v_mfma_f32_16x16x32_bf16 v[100:103], v[164:167], v[56:59], v[100:103]
v_mfma_f32_16x16x32_bf16 v[104:107], v[168:171], v[56:59], v[104:107]
v_mfma_f32_16x16x32_bf16 v[108:111], v[172:175], v[56:59], v[108:111]
buffer_load_dwordx4 v[56:59], v1, s[8:11], s24 offen offset:2048 sc1
s_waitcnt vmcnt(21) lgkmcnt(0)
v_mfma_f32_16x16x32_bf16 v[96:99], v[112:115], v[60:63], v[96:99]
v_mfma_f32_16x16x32_bf16 v[100:103], v[116:119], v[60:63], v[100:103]
v_mfma_f32_16x16x32_bf16 v[104:107], v[120:123], v[60:63], v[104:107]
v_mfma_f32_16x16x32_bf16 v[108:111], v[124:127], v[60:63], v[108:111]
buffer_load_dwordx4 v[60:63], v1, s[8:11], s24 offen offset:3072 sc1
s_waitcnt vmcnt(21)
v_mfma_f32_16x16x32_bf16 v[96:99], v[176:179], v[64:67], v[96:99]
ds_read_b64_tr_b16 v[112:113], v8 offset:4096
v_mfma_f32_16x16x32_bf16 v[100:103], v[180:183], v[64:67], v[100:103]
ds_read_b64_tr_b16 v[114:115], v8 offset:5120
v_mfma_f32_16x16x32_bf16 v[104:107], v[184:187], v[64:67], v[104:107]
ds_read_b64_tr_b16 v[116:117], v9 offset:4096
v_mfma_f32_16x16x32_bf16 v[108:111], v[188:191], v[64:67], v[108:111]
ds_read_b64_tr_b16 v[118:119], v9 offset:5120
s_add_u32 s24, s48, s36
buffer_load_dwordx4 v[64:67], v1, s[8:11], s24 offen offset:0 sc1
s_waitcnt vmcnt(21)
v_mfma_f32_16x16x32_bf16 v[96:99], v[192:195], v[68:71], v[96:99]
ds_read_b64_tr_b16 v[120:121], v10 offset:4096
v_mfma_f32_16x16x32_bf16 v[100:103], v[196:199], v[68:71], v[100:103]
ds_read_b64_tr_b16 v[122:123], v10 offset:5120
v_mfma_f32_16x16x32_bf16 v[104:107], v[200:203], v[68:71], v[104:107]
ds_read_b64_tr_b16 v[124:125], v11 offset:4096
v_mfma_f32_16x16x32_bf16 v[108:111], v[204:207], v[68:71], v[108:111]
ds_read_b64_tr_b16 v[126:127], v11 offset:5120
buffer_load_dwordx4 v[68:71], v1, s[8:11], s24 offen offset:1024 sc1
s_waitcnt vmcnt(21)
v_mfma_f32_16x16x32_bf16 v[96:99], v[208:211], v[72:75], v[96:99]
v_mfma_f32_16x16x32_bf16 v[100:103], v[212:215], v[72:75], v[100:103]
v_mfma_f32_16x16x32_bf16 v[104:107], v[216:219], v[72:75], v[104:107]
v_mfma_f32_16x16x32_bf16 v[108:111], v[220:223], v[72:75], v[108:111]
buffer_load_dwordx4 v[72:75], v1, s[8:11], s24 offen offset:2048 sc1
s_waitcnt vmcnt(21) lgkmcnt(0)
v_mfma_f32_16x16x32_bf16 v[96:99], v[112:115], v[76:79], v[96:99]
v_mfma_f32_16x16x32_bf16 v[100:103], v[116:119], v[76:79], v[100:103]
v_mfma_f32_16x16x32_bf16 v[104:107], v[120:123], v[76:79], v[104:107]
v_mfma_f32_16x16x32_bf16 v[108:111], v[124:127], v[76:79], v[108:111]
buffer_load_dwordx4 v[76:79], v1, s[8:11], s24 offen offset:3072 sc1
s_waitcnt vmcnt(21)
v_mfma_f32_16x16x32_bf16 v[96:99], v[224:227], v[80:83], v[96:99]
ds_read_b64_tr_b16 v[112:113], v8 offset:8192
v_mfma_f32_16x16x32_bf16 v[100:103], v[228:231], v[80:83], v[100:103]
ds_read_b64_tr_b16 v[114:115], v8 offset:9216
v_mfma_f32_16x16x32_bf16 v[104:107], v[232:235], v[80:83], v[104:107]
ds_read_b64_tr_b16 v[116:117], v9 offset:8192
v_mfma_f32_16x16x32_bf16 v[108:111], v[236:239], v[80:83], v[108:111]
ds_read_b64_tr_b16 v[118:119], v9 offset:9216
s_add_u32 s24, s48, s37
buffer_load_dwordx4 v[80:83], v1, s[8:11], s24 offen offset:0 sc1
s_waitcnt vmcnt(21)
v_mfma_f32_16x16x32_bf16 v[96:99], v[240:243], v[84:87], v[96:99]
ds_read_b64_tr_b16 v[120:121], v10 offset:8192
v_mfma_f32_16x16x32_bf16 v[100:103], v[244:247], v[84:87], v[100:103]
ds_read_b64_tr_b16 v[122:123], v10 offset:9216
v_mfma_f32_16x16x32_bf16 v[104:107], v[248:251], v[84:87], v[104:107]
ds_read_b64_tr_b16 v[124:125], v11 offset:8192
v_mfma_f32_16x16x32_bf16 v[108:111], v[252:255], v[84:87], v[108:111]
ds_read_b64_tr_b16 v[126:127], v11 offset:9216
buffer_load_dwordx4 v[84:87], v1, s[8:11], s24 offen offset:1024 sc1
s_waitcnt vmcnt(21)
v_mfma_f32_16x16x32_bf16 v[96:99], a[0:3], v[88:91], v[96:99]
v_mfma_f32_16x16x32_bf16 v[100:103], a[4:7], v[88:91], v[100:103]
v_mfma_f32_16x16x32_bf16 v[104:107], a[8:11], v[88:91], v[104:107]
v_mfma_f32_16x16x32_bf16 v[108:111], a[12:15], v[88:91], v[108:111]
buffer_load_dwordx4 v[88:91], v1, s[8:11], s24 offen offset:2048 sc1
s_waitcnt vmcnt(21) lgkmcnt(0)
v_mfma_f32_16x16x32_bf16 v[96:99], v[112:115], v[92:95], v[96:99]
v_mfma_f32_16x16x32_bf16 v[100:103], v[116:119], v[92:95], v[100:103]
v_mfma_f32_16x16x32_bf16 v[104:107], v[120:123], v[92:95], v[104:107]
v_mfma_f32_16x16x32_bf16 v[108:111], v[124:127], v[92:95], v[108:111]
buffer_load_dwordx4 v[92:95], v1, s[8:11], s24 offen offset:3072 sc1
s_waitcnt vmcnt(21)
v_mfma_f32_16x16x32_bf16 v[96:99], a[16:19], v[16:19], v[96:99]
ds_read_b64_tr_b16 v[112:113], v8 offset:12288
v_mfma_f32_16x16x32_bf16 v[100:103], a[20:23], v[16:19], v[100:103]
ds_read_b64_tr_b16 v[114:115], v8 offset:13312
v_mfma_f32_16x16x32_bf16 v[104:107], a[24:27], v[16:19], v[104:107]
ds_read_b64_tr_b16 v[116:117], v9 offset:12288
v_mfma_f32_16x16x32_bf16 v[108:111], a[28:31], v[16:19], v[108:111]
ds_read_b64_tr_b16 v[118:119], v9 offset:13312
s_waitcnt vmcnt(12)
v_cmp_ne_u32 vcc, 1, v6
s_nop 0
s_cmp_eq_u64 vcc, 0
s_cselect_b32 s50, s52, 0
s_cmp_eq_u32 s50, 1
s_cselect_b32 s49, s49, 536870912
s_add_u32 s24, s49, s30
buffer_load_dwordx4 v[16:19], v1, s[8:11], s24 offen offset:0 sc1
s_waitcnt vmcnt(21)
v_mfma_f32_16x16x32_bf16 v[96:99], a[32:35], v[20:23], v[96:99]
ds_read_b64_tr_b16 v[120:121], v10 offset:12288
v_mfma_f32_16x16x32_bf16 v[100:103], a[36:39], v[20:23], v[100:103]
ds_read_b64_tr_b16 v[122:123], v10 offset:13312
v_mfma_f32_16x16x32_bf16 v[104:107], a[40:43], v[20:23], v[104:107]
ds_read_b64_tr_b16 v[124:125], v11 offset:12288
v_mfma_f32_16x16x32_bf16 v[108:111], a[44:47], v[20:23], v[108:111]
ds_read_b64_tr_b16 v[126:127], v11 offset:13312
buffer_load_dwordx4 v[20:23], v1, s[8:11], s24 offen offset:1024 sc1
s_waitcnt vmcnt(21)
v_mfma_f32_16x16x32_bf16 v[96:99], a[48:51], v[24:27], v[96:99]
v_mfma_f32_16x16x32_bf16 v[100:103], a[52:55], v[24:27], v[100:103]
v_mfma_f32_16x16x32_bf16 v[104:107], a[56:59], v[24:27], v[104:107]
v_mfma_f32_16x16x32_bf16 v[108:111], a[60:63], v[24:27], v[108:111]
buffer_load_dwordx4 v[24:27], v1, s[8:11], s24 offen offset:2048 sc1
s_waitcnt vmcnt(21) lgkmcnt(0)
v_mfma_f32_16x16x32_bf16 v[96:99], v[112:115], v[28:31], v[96:99]
v_mfma_f32_16x16x32_bf16 v[100:103], v[116:119], v[28:31], v[100:103]
v_mfma_f32_16x16x32_bf16 v[104:107], v[120:123], v[28:31], v[104:107]
v_mfma_f32_16x16x32_bf16 v[108:111], v[124:127], v[28:31], v[108:111]
buffer_load_dwordx4 v[28:31], v1, s[8:11], s24 offen offset:3072 sc1
s_waitcnt vmcnt(21)
v_mfma_f32_16x16x32_bf16 v[96:99], a[64:67], v[32:35], v[96:99]
ds_read_b64_tr_b16 v[112:113], v8 offset:16384
v_mfma_f32_16x16x32_bf16 v[100:103], a[68:71], v[32:35], v[100:103]
ds_read_b64_tr_b16 v[114:115], v8 offset:17408
v_mfma_f32_16x16x32_bf16 v[104:107], a[72:75], v[32:35], v[104:107]
ds_read_b64_tr_b16 v[116:117], v9 offset:16384
v_mfma_f32_16x16x32_bf16 v[108:111], a[76:79], v[32:35], v[108:111]
ds_read_b64_tr_b16 v[118:119], v9 offset:17408
s_add_u32 s24, s49, s31
buffer_load_dwordx4 v[32:35], v1, s[8:11], s24 offen offset:0 sc1
s_waitcnt vmcnt(21)
v_mfma_f32_16x16x32_bf16 v[96:99], a[80:83], v[36:39], v[96:99]
ds_read_b64_tr_b16 v[120:121], v10 offset:16384
v_mfma_f32_16x16x32_bf16 v[100:103], a[84:87], v[36:39], v[100:103]
ds_read_b64_tr_b16 v[122:123], v10 offset:17408
v_mfma_f32_16x16x32_bf16 v[104:107], a[88:91], v[36:39], v[104:107]
ds_read_b64_tr_b16 v[124:125], v11 offset:16384
v_mfma_f32_16x16x32_bf16 v[108:111], a[92:95], v[36:39], v[108:111]
ds_read_b64_tr_b16 v[126:127], v11 offset:17408
buffer_load_dwordx4 v[36:39], v1, s[8:11], s24 offen offset:1024 sc1
s_waitcnt vmcnt(21)
v_mfma_f32_16x16x32_bf16 v[96:99], a[96:99], v[40:43], v[96:99]
v_mfma_f32_16x16x32_bf16 v[100:103], a[100:103], v[40:43], v[100:103]
v_mfma_f32_16x16x32_bf16 v[104:107], a[104:107], v[40:43], v[104:107]
v_mfma_f32_16x16x32_bf16 v[108:111], a[108:111], v[40:43], v[108:111]
buffer_load_dwordx4 v[40:43], v1, s[8:11], s24 offen offset:2048 sc1
s_waitcnt vmcnt(21) lgkmcnt(0)
v_mfma_f32_16x16x32_bf16 v[96:99], v[112:115], v[44:47], v[96:99]
v_mfma_f32_16x16x32_bf16 v[100:103], v[116:119], v[44:47], v[100:103]
v_mfma_f32_16x16x32_bf16 v[104:107], v[120:123], v[44:47], v[104:107]
v_mfma_f32_16x16x32_bf16 v[108:111], v[124:127], v[44:47], v[108:111]
buffer_load_dwordx4 v[44:47], v1, s[8:11], s24 offen offset:3072 sc1
s_waitcnt vmcnt(19)
v_mfma_f32_16x16x32_bf16 v[96:99], a[112:115], v[48:51], v[96:99]
ds_read_b64_tr_b16 v[112:113], v8 offset:20480
v_mfma_f32_16x16x32_bf16 v[100:103], a[116:119], v[48:51], v[100:103]
ds_read_b64_tr_b16 v[114:115], v8 offset:21504
v_mfma_f32_16x16x32_bf16 v[104:107], a[120:123], v[48:51], v[104:107]
ds_read_b64_tr_b16 v[116:117], v9 offset:20480
v_mfma_f32_16x16x32_bf16 v[108:111], a[124:127], v[48:51], v[108:111]
ds_read_b64_tr_b16 v[118:119], v9 offset:21504
s_add_u32 s24, s49, s32
buffer_load_dwordx4 v[48:51], v1, s[8:11], s24 offen offset:0 sc1
s_waitcnt vmcnt(19)
v_mfma_f32_16x16x32_bf16 v[96:99], a[128:131], v[52:55], v[96:99]
ds_read_b64_tr_b16 v[120:121], v10 offset:20480
v_mfma_f32_16x16x32_bf16 v[100:103], a[132:135], v[52:55], v[100:103]
ds_read_b64_tr_b16 v[122:123], v10 offset:21504
v_mfma_f32_16x16x32_bf16 v[104:107], a[136:139], v[52:55], v[104:107]
ds_read_b64_tr_b16 v[124:125], v11 offset:20480
v_mfma_f32_16x16x32_bf16 v[108:111], a[140:143], v[52:55], v[108:111]
ds_read_b64_tr_b16 v[126:127], v11 offset:21504
buffer_load_dwordx4 v[52:55], v1, s[8:11], s24 offen offset:1024 sc1
s_waitcnt vmcnt(19)
v_mfma_f32_16x16x32_bf16 v[96:99], a[144:147], v[56:59], v[96:99]
v_mfma_f32_16x16x32_bf16 v[100:103], a[148:151], v[56:59], v[100:103]
v_mfma_f32_16x16x32_bf16 v[104:107], a[152:155], v[56:59], v[104:107]
v_mfma_f32_16x16x32_bf16 v[108:111], a[156:159], v[56:59], v[108:111]
buffer_load_dwordx4 v[56:59], v1, s[8:11], s24 offen offset:2048 sc1
s_waitcnt vmcnt(19) lgkmcnt(0)
v_mfma_f32_16x16x32_bf16 v[96:99], v[112:115], v[60:63], v[96:99]
v_mfma_f32_16x16x32_bf16 v[100:103], v[116:119], v[60:63], v[100:103]
v_mfma_f32_16x16x32_bf16 v[104:107], v[120:123], v[60:63], v[104:107]
v_mfma_f32_16x16x32_bf16 v[108:111], v[124:127], v[60:63], v[108:111]
buffer_load_dwordx4 v[60:63], v1, s[8:11], s24 offen offset:3072 sc1
s_waitcnt vmcnt(19)
v_mfma_f32_16x16x32_bf16 v[96:99], a[160:163], v[64:67], v[96:99]
ds_read_b64_tr_b16 v[112:113], v8 offset:24576
v_mfma_f32_16x16x32_bf16 v[100:103], a[164:167], v[64:67], v[100:103]
ds_read_b64_tr_b16 v[114:115], v8 offset:25600
v_mfma_f32_16x16x32_bf16 v[104:107], a[168:171], v[64:67], v[104:107]
ds_read_b64_tr_b16 v[116:117], v9 offset:24576
v_mfma_f32_16x16x32_bf16 v[108:111], a[172:175], v[64:67], v[108:111]
ds_read_b64_tr_b16 v[118:119], v9 offset:25600
s_add_u32 s24, s49, s33
buffer_load_dwordx4 v[64:67], v1, s[8:11], s24 offen offset:0 sc1
s_waitcnt vmcnt(19)
v_mfma_f32_16x16x32_bf16 v[96:99], a[176:179], v[68:71], v[96:99]
ds_read_b64_tr_b16 v[120:121], v10 offset:24576
v_mfma_f32_16x16x32_bf16 v[100:103], a[180:183], v[68:71], v[100:103]
ds_read_b64_tr_b16 v[122:123], v10 offset:25600
v_mfma_f32_16x16x32_bf16 v[104:107], a[184:187], v[68:71], v[104:107]
ds_read_b64_tr_b16 v[124:125], v11 offset:24576
v_mfma_f32_16x16x32_bf16 v[108:111], a[188:191], v[68:71], v[108:111]
ds_read_b64_tr_b16 v[126:127], v11 offset:25600
buffer_load_dwordx4 v[68:71], v1, s[8:11], s24 offen offset:1024 sc1
s_waitcnt vmcnt(19)
v_mfma_f32_16x16x32_bf16 v[96:99], a[192:195], v[72:75], v[96:99]
v_mfma_f32_16x16x32_bf16 v[100:103], a[196:199], v[72:75], v[100:103]
v_mfma_f32_16x16x32_bf16 v[104:107], a[200:203], v[72:75], v[104:107]
v_mfma_f32_16x16x32_bf16 v[108:111], a[204:207], v[72:75], v[108:111]
buffer_load_dwordx4 v[72:75], v1, s[8:11], s24 offen offset:2048 sc1
s_waitcnt vmcnt(19) lgkmcnt(0)
v_mfma_f32_16x16x32_bf16 v[96:99], v[112:115], v[76:79], v[96:99]
v_mfma_f32_16x16x32_bf16 v[100:103], v[116:119], v[76:79], v[100:103]
v_mfma_f32_16x16x32_bf16 v[104:107], v[120:123], v[76:79], v[104:107]
v_mfma_f32_16x16x32_bf16 v[108:111], v[124:127], v[76:79], v[108:111]
buffer_load_dwordx4 v[76:79], v1, s[8:11], s24 offen offset:3072 sc1
s_waitcnt vmcnt(19)
v_mfma_f32_16x16x32_bf16 v[96:99], a[208:211], v[80:83], v[96:99]
ds_read_b64_tr_b16 v[112:113], v8 offset:28672
v_mfma_f32_16x16x32_bf16 v[100:103], a[212:215], v[80:83], v[100:103]
ds_read_b64_tr_b16 v[114:115], v8 offset:29696
v_mfma_f32_16x16x32_bf16 v[104:107], a[216:219], v[80:83], v[104:107]
ds_read_b64_tr_b16 v[116:117], v9 offset:28672
v_mfma_f32_16x16x32_bf16 v[108:111], a[220:223], v[80:83], v[108:111]
ds_read_b64_tr_b16 v[118:119], v9 offset:29696
s_add_u32 s24, s49, s34
buffer_load_dwordx4 v[80:83], v1, s[8:11], s24 offen offset:0 sc1
s_waitcnt vmcnt(19)
v_mfma_f32_16x16x32_bf16 v[96:99], a[224:227], v[84:87], v[96:99]
ds_read_b64_tr_b16 v[120:121], v10 offset:28672
v_mfma_f32_16x16x32_bf16 v[100:103], a[228:231], v[84:87], v[100:103]
ds_read_b64_tr_b16 v[122:123], v10 offset:29696
v_mfma_f32_16x16x32_bf16 v[104:107], a[232:235], v[84:87], v[104:107]
ds_read_b64_tr_b16 v[124:125], v11 offset:28672
v_mfma_f32_16x16x32_bf16 v[108:111], a[236:239], v[84:87], v[108:111]
ds_read_b64_tr_b16 v[126:127], v11 offset:29696
buffer_load_dwordx4 v[84:87], v1, s[8:11], s24 offen offset:1024 sc1
s_waitcnt vmcnt(19)
v_mfma_f32_16x16x32_bf16 v[96:99], a[240:243], v[88:91], v[96:99]
v_mfma_f32_16x16x32_bf16 v[100:103], a[244:247], v[88:91], v[100:103]
v_mfma_f32_16x16x32_bf16 v[104:107], a[248:251], v[88:91], v[104:107]
v_mfma_f32_16x16x32_bf16 v[108:111], a[252:255], v[88:91], v[108:111]
buffer_load_dwordx4 v[88:91], v1, s[8:11], s24 offen offset:2048 sc1
s_waitcnt vmcnt(19) lgkmcnt(0)
v_mfma_f32_16x16x32_bf16 v[96:99], v[112:115], v[92:95], v[96:99]
v_mfma_f32_16x16x32_bf16 v[100:103], v[116:119], v[92:95], v[100:103]
v_mfma_f32_16x16x32_bf16 v[104:107], v[120:123], v[92:95], v[104:107]
v_mfma_f32_16x16x32_bf16 v[108:111], v[124:127], v[92:95], v[108:111]
buffer_load_dwordx4 v[92:95], v1, s[8:11], s24 offen offset:3072 sc1
s_nop 3
ds_write_b128 v3, v[96:99] offset:0
ds_write_b128 v3, v[100:103] offset:4096
ds_write_b128 v3, v[104:107] offset:8192
ds_write_b128 v3, v[108:111] offset:12288
s_waitcnt lgkmcnt(0)
s_barrier
ds_read_b128 v[96:99], v7 offset:0
ds_read_b128 v[100:103], v7 offset:1024
ds_read_b128 v[104:107], v7 offset:2048
ds_read_b128 v[108:111], v7 offset:3072
ds_read_b64_tr_b16 v[112:113], v8 offset:0
ds_read_b64_tr_b16 v[114:115], v8 offset:1024
ds_read_b64_tr_b16 v[116:117], v9 offset:0
ds_read_b64_tr_b16 v[118:119], v9 offset:1024
ds_read_b64_tr_b16 v[120:121], v10 offset:0
ds_read_b64_tr_b16 v[122:123], v10 offset:1024
ds_read_b64_tr_b16 v[124:125], v11 offset:0
ds_read_b64_tr_b16 v[126:127], v11 offset:1024
s_mul_i32 s24, s41, 36864
s_waitcnt lgkmcnt(10)
v_pk_add_f32 v[96:97], v[96:97], v[100:101]
v_pk_add_f32 v[98:99], v[98:99], v[102:103]
s_waitcnt lgkmcnt(9)
v_pk_add_f32 v[96:97], v[96:97], v[104:105]
v_pk_add_f32 v[98:99], v[98:99], v[106:107]
s_waitcnt lgkmcnt(8)
v_pk_add_f32 v[96:97], v[96:97], v[108:109]
v_pk_add_f32 v[98:99], v[98:99], v[110:111]
v_cvt_pk_bf16_f32 v12, v96, v97
v_cvt_pk_bf16_f32 v13, v98, v99
buffer_store_dwordx2 v[12:13], v4, s[12:15], s24 offen
v_xor_b32 v3, 16384, v3
v_xor_b32 v7, 16384, v7
s_mov_b32 s41, s27
s_mov_b32 s48, s49
s_cmp_eq_u32 s50, 0
s_cbranch_scc1 L_opl_c
s_branch L_opl_r0
L_opl_c:
s_cmp_lg_u32 s52, 0
s_cbranch_scc1 L_opl_w
s_waitcnt lgkmcnt(0)
s_branch L_done
L_team:
v_mov_b32 v12, v0
v_and_b32 v13, 15, v0
v_bfe_u32 v14, v0, 4, 2
v_lshlrev_b32 v1, 4, v12
v_and_b32 v2, 0x3f0, v1
s_mul_i32 s20, s17, 34816
s_add_u32 s20, s20, 24576
v_add_u32 v2, s20, v2
v_and_b32 v15, 1, v12
v_mul_u32_u24 v0, 0xaaaa, v15
v_add_u32 v0, 0xffff4444, v0
v_lshrrev_b32 v18, 2, v13
v_lshl_add_u32 v18, v18, 1, v15
v_bfe_u32 v19, v13, 1, 1
v_lshrrev_b32 v16, 5, v12
v_lshlrev_b32 v16, 8, v16
v_lshl_add_u32 v16, v18, 5, v16
v_and_b32 v17, 1, v14
v_lshl_add_u32 v16, v17, 4, v16
v_and_b32 v17, 0x7f, v16
v_xor_b32 v17, 16, v17
v_add_u32 v16, 4224, v16
v_add_u32 v17, 6272, v17
v_cmp_eq_u32 vcc, 1, v19
s_nop 1
v_cndmask_b32 v7, v17, v16, vcc
v_and_b32 v16, 1, v14
v_xor_b32 v16, v18, v16
v_and_b32 v17, 2, v14
v_lshlrev_b32 v17, 1, v17
v_xor_b32 v16, v16, v17
v_lshlrev_b32 v16, 4, v16
v_lshl_add_u32 v16, v14, 7, v16
v_mul_u32_u24 v17, 2176, v19
v_add_u32 v16, v16, v17
v_add_u32 v5, 0, v16
v_bfe_u32 v20, v13, 3, 1
v_bfe_u32 v21, v13, 1, 1
v_lshlrev_b32 v16, 1, v14
v_xor_b32 v16, v16, v21
v_lshlrev_b32 v17, 2, v20
v_xor_b32 v16, v16, v17
v_lshlrev_b32 v16, 4, v16
v_lshl_add_u32 v16, v20, 8, v16
v_lshl_add_u32 v16, v21, 7, v16
v_bfe_u32 v17, v13, 2, 1
v_lshl_add_u32 v16, v17, 3, v16
v_lshl_add_u32 v16, v15, 2, v16
s_lshl_b32 s20, s17, 9
s_add_u32 s20, s20, 0
v_add_u32 v4, s20, v16
v_xor_b32 v3, 16, v4
v_lshrrev_b32 v16, 4, v12
v_xor_b32 v17, s16, v16
v_lshlrev_b32 v16, 12, v16
v_lshl_add_u32 v16, v17, 7, v16
v_lshl_add_u32 v9, v13, 3, v16
s_lshr_b32 s20, s17, 1
s_lshl_b32 s20, s20, 2
v_add_u32 v16, s20, v14
v_xor_b32 v17, s16, v16
v_lshlrev_b32 v16, 12, v16
v_lshl_add_u32 v16, v17, 7, v16
v_lshl_add_u32 v16, v13, 2, v16
s_and_b32 s20, s17, 1
s_lshl_b32 s20, s20, 6
s_add_u32 s20, s20, 262144
v_add_u32 v10, s20, v16
v_bfe_u32 v16, v13, 2, 1
v_lshlrev_b32 v16, 5, v16
v_and_b32 v17, 1, v14
v_lshl_add_u32 v16, v17, 8, v16
v_lshrrev_b32 v17, 1, v14
v_lshl_add_u32 v16, v17, 4, v16
v_and_b32 v17, 3, v13
v_lshl_add_u32 v11, v17, 2, v16
v_lshlrev_b32 v6, 7, v12
v_lshlrev_b32 v8, 2, v12
s_mov_b32 s36, 0x11111111
s_mov_b32 s37, 0x11111111
s_mov_b32 s38, 0x22222222
s_mov_b32 s39, 0x22222222
s_mov_b32 s40, 0x44444444
s_mov_b32 s41, 0x44444444
s_mov_b32 s42, 0x88888888
s_mov_b32 s43, 0x88888888
s_mov_b32 s44, 0xf0f0f0f0
s_mov_b32 s45, 0xf0f0f0f0
s_mov_b32 s18, 0x3e0293ee
s_lshl_b32 s20, s17, 5
s_add_u32 s20, s20, s16
s_cmp_lt_u32 s20, 72
s_cselect_b32 s48, 1, 0
s_lshl_b32 s23, s20, 12
s_lshl_b32 s21, s17, 10
s_sub_u32 s23, s23, s21
s_lshr_b32 s24, s20, 2
s_lshl_b32 s24, s24, 9
s_and_b32 s21, s20, 3
s_lshl_b32 s21, s21, 6
s_add_u32 s24, s24, s21
s_add_u32 s24, s24, 110100480
s_cmp_lt_u32 s20, 72
s_cselect_b32 s24, s24, 536870912
s_lshl_b32 s25, s16, 12
s_add_u32 s26, s25, 131072
s_add_u32 s27, s25, 262144
s_cmp_lt_u32 s16, 8
s_cselect_b32 s27, s27, 536870912
s_mov_b32 s28, 109051904
s_mov_b32 s29, 109346816
s_lshl_b32 s30, s16, 20
s_add_u32 s30, s30, 33554432
s_lshl_b32 s31, s16, 12
s_add_u32 s31, s31, 100663296
s_add_u32 s35, s24, 32768
s_mov_b32 s53, 0x3f803f80
s_mov_b32 s86, 0x33333333
s_mov_b32 s87, 0x33333333
s_lshl_b32 s84, s17, 13
s_sub_u32 s84, s20, s84
s_add_u32 s84, s84, 110886912
s_cmp_lt_u32 s20, 72
s_cselect_b32 s84, s84, 536870912
s_and_b32 s21, s16, 3
s_lshl_b32 s21, s21, 7
s_add_u32 s21, s21, 110886144
s_cmp_eq_u32 s17, 3
s_cselect_b32 s84, s21, s84
s_lshl_b32 s82, s16, 7
s_add_u32 s83, s82, 111152384
s_add_u32 s82, s82, 111148288
s_mov_b32 s19, 0
v_mov_b32 v64, -1
v_mov_b32 v65, -1
v_mov_b32 v66, -1
v_mov_b32 v67, -1
s_add_u32 s20, s28, s25
buffer_store_dwordx4 v[64:67], v1, s[8:11], s20 offen
s_add_u32 s20, s28, s26
buffer_store_dwordx4 v[64:67], v1, s[8:11], s20 offen
s_add_u32 s20, s28, s27
buffer_store_dwordx4 v[64:67], v1, s[8:11], s20 offen
s_add_u32 s20, s29, s25
buffer_store_dwordx4 v[64:67], v1, s[8:11], s20 offen
s_add_u32 s20, s29, s26
buffer_store_dwordx4 v[64:67], v1, s[8:11], s20 offen
s_add_u32 s20, s29, s27
buffer_store_dwordx4 v[64:67], v1, s[8:11], s20 offen
s_add_u32 s20, s24, 16384
buffer_store_dword v64, v11, s[8:11], s20 offen
s_cmp_eq_u32 s17, 3
s_cselect_b32 s20, 536870912, s84
s_mov_b64 exec, 15
buffer_store_byte v64, v6, s[8:11], s20 offen
s_mov_b64 exec, -1
v_lshrrev_b32 v0, 4, v1
s_waitcnt vmcnt(0)
s_barrier
s_cmp_eq_u32 s17, 0
s_cbranch_scc0 L_tw
s_mov_b64 exec, 1
v_mov_b32 v1, 1
v_mov_b32 v2, 64
buffer_atomic_add v1, v2, s[56:59], 0 offen
s_mov_b64 exec, -1
L_tw:
s_mov_b32 s46, 0x05040100
s_mov_b32 s47, 0x07060302
v_and_b32 v3, 63, v0
v_lshlrev_b32 v3, 4, v3
s_mul_i32 s20, s17, 34816
s_add_u32 s20, s20, 24576
v_add_u32 v3, s20, v3
v_bfe_u32 v64, v0, 5, 1
v_bfe_u32 v65, v0, 4, 1
v_and_b32 v66, 15, v0
v_lshlrev_b32 v1, 17, v64
v_lshl_add_u32 v1, v65, 14, v1
v_lshl_add_u32 v1, v66, 2, v1
s_lshl_b32 s20, s16, 8
s_lshl_b32 s21, s17, 6
s_add_u32 s20, s20, s21
v_add_u32 v1, s20, v1
v_lshlrev_b32 v2, 4, v64
v_lshl_add_u32 v2, v65, 2, v2
v_mul_u32_u24 v2, 1152, v2
s_mul_i32 s20, s16, 147456
v_add_u32 v2, s20, v2
v_and_b32 v4, 15, v0
s_lshl_b32 s20, s17, 4
v_add_u32 v4, s20, v4
v_lshlrev_b32 v4, 1, v4
v_add_u32 v2, v2, v4
v_add_u32 v4, v2, v4
s_load_dwordx2 s[50:51], s[0:1], 88
s_waitcnt lgkmcnt(0)
s_mov_b32 s12, s50
s_and_b32 s13, s51, 0xffff
s_mov_b32 s14, 4718592
s_mov_b32 s15, 0x20000
s_mov_b32 s20, 0
buffer_load_dword v6, v4, s[12:15], s20 offen
s_mov_b32 s21, 1152
buffer_load_dword v7, v4, s[12:15], s21 offen
s_mov_b32 s20, 9216
buffer_load_dword v8, v4, s[12:15], s20 offen
s_mov_b32 s21, 10368
buffer_load_dword v9, v4, s[12:15], s21 offen
s_mov_b32 s20, 2304
buffer_load_dword v10, v4, s[12:15], s20 offen
s_mov_b32 s21, 3456
buffer_load_dword v11, v4, s[12:15], s21 offen
s_mov_b32 s20, 11520
buffer_load_dword v12, v4, s[12:15], s20 offen
s_mov_b32 s21, 12672
buffer_load_dword v13, v4, s[12:15], s21 offen
s_mov_b32 s20, 36864
buffer_load_dword v14, v4, s[12:15], s20 offen
s_mov_b32 s21, 38016
buffer_load_dword v15, v4, s[12:15], s21 offen
s_mov_b32 s20, 46080
buffer_load_dword v16, v4, s[12:15], s20 offen
s_mov_b32 s21, 47232
buffer_load_dword v17, v4, s[12:15], s21 offen
s_mov_b32 s20, 39168
buffer_load_dword v18, v4, s[12:15], s20 offen
s_mov_b32 s21, 40320
buffer_load_dword v19, v4, s[12:15], s21 offen
s_mov_b32 s20, 48384
buffer_load_dword v20, v4, s[12:15], s20 offen
s_mov_b32 s21, 49536
buffer_load_dword v21, v4, s[12:15], s21 offen
s_mov_b32 s20, 73728
buffer_load_dword v22, v4, s[12:15], s20 offen
s_mov_b32 s21, 74880
buffer_load_dword v23, v4, s[12:15], s21 offen
s_mov_b32 s20, 82944
buffer_load_dword v24, v4, s[12:15], s20 offen
s_mov_b32 s21, 84096
buffer_load_dword v25, v4, s[12:15], s21 offen
s_mov_b32 s20, 76032
buffer_load_dword v26, v4, s[12:15], s20 offen
s_mov_b32 s21, 77184
buffer_load_dword v27, v4, s[12:15], s21 offen
s_mov_b32 s20, 85248
buffer_load_dword v28, v4, s[12:15], s20 offen
s_mov_b32 s21, 86400
buffer_load_dword v29, v4, s[12:15], s21 offen
s_mov_b32 s20, 110592
buffer_load_dword v30, v4, s[12:15], s20 offen
s_mov_b32 s21, 111744
buffer_load_dword v31, v4, s[12:15], s21 offen
s_mov_b32 s20, 119808
buffer_load_dword v32, v4, s[12:15], s20 offen
s_mov_b32 s21, 120960
buffer_load_dword v33, v4, s[12:15], s21 offen
s_mov_b32 s20, 112896
buffer_load_dword v34, v4, s[12:15], s20 offen
s_mov_b32 s21, 114048
buffer_load_dword v35, v4, s[12:15], s21 offen
s_mov_b32 s20, 122112
buffer_load_dword v36, v4, s[12:15], s20 offen
s_mov_b32 s21, 123264
buffer_load_dword v37, v4, s[12:15], s21 offen
s_mov_b32 s20, 256
buffer_load_dword v38, v4, s[12:15], s20 offen
s_mov_b32 s21, 1408
buffer_load_dword v39, v4, s[12:15], s21 offen
s_mov_b32 s20, 9472
buffer_load_dword v40, v4, s[12:15], s20 offen
s_mov_b32 s21, 10624
buffer_load_dword v41, v4, s[12:15], s21 offen
s_mov_b32 s20, 2560
buffer_load_dword v42, v4, s[12:15], s20 offen
s_mov_b32 s21, 3712
buffer_load_dword v43, v4, s[12:15], s21 offen
s_mov_b32 s20, 11776
buffer_load_dword v44, v4, s[12:15], s20 offen
s_mov_b32 s21, 12928
buffer_load_dword v45, v4, s[12:15], s21 offen
s_mov_b32 s20, 37120
buffer_load_dword v46, v4, s[12:15], s20 offen
s_mov_b32 s21, 38272
buffer_load_dword v47, v4, s[12:15], s21 offen
s_mov_b32 s20, 46336
buffer_load_dword v48, v4, s[12:15], s20 offen
s_mov_b32 s21, 47488
buffer_load_dword v49, v4, s[12:15], s21 offen
s_mov_b32 s20, 39424
buffer_load_dword v50, v4, s[12:15], s20 offen
s_mov_b32 s21, 40576
buffer_load_dword v51, v4, s[12:15], s21 offen
s_mov_b32 s20, 48640
buffer_load_dword v52, v4, s[12:15], s20 offen
s_mov_b32 s21, 49792
buffer_load_dword v53, v4, s[12:15], s21 offen
s_mov_b32 s20, 73984
buffer_load_dword v54, v4, s[12:15], s20 offen
s_mov_b32 s21, 75136
buffer_load_dword v55, v4, s[12:15], s21 offen
s_mov_b32 s20, 83200
buffer_load_dword v56, v4, s[12:15], s20 offen
s_mov_b32 s21, 84352
buffer_load_dword v57, v4, s[12:15], s21 offen
s_mov_b32 s20, 76288
buffer_load_dword v58, v4, s[12:15], s20 offen
s_mov_b32 s21, 77440
buffer_load_dword v59, v4, s[12:15], s21 offen
s_mov_b32 s20, 85504
buffer_load_dword v60, v4, s[12:15], s20 offen
s_mov_b32 s21, 86656
buffer_load_dword v61, v4, s[12:15], s21 offen
s_mov_b32 s20, 110848
buffer_load_dword v62, v4, s[12:15], s20 offen
s_mov_b32 s21, 112000
buffer_load_dword v63, v4, s[12:15], s21 offen
s_waitcnt vmcnt(56)
v_perm_b32 v64, v7, v6, s46
v_accvgpr_write_b32 a176, v64
v_perm_b32 v68, v7, v6, s47
v_accvgpr_write_b32 a184, v68
s_mov_b32 s20, 120064
buffer_load_dword v6, v4, s[12:15], s20 offen
s_mov_b32 s21, 121216
buffer_load_dword v7, v4, s[12:15], s21 offen
s_waitcnt vmcnt(56)
v_perm_b32 v65, v9, v8, s46
v_accvgpr_write_b32 a177, v65
v_perm_b32 v69, v9, v8, s47
v_accvgpr_write_b32 a185, v69
s_mov_b32 s20, 113152
buffer_load_dword v8, v4, s[12:15], s20 offen
s_mov_b32 s21, 114304
buffer_load_dword v9, v4, s[12:15], s21 offen
s_waitcnt vmcnt(56)
v_perm_b32 v66, v11, v10, s46
v_accvgpr_write_b32 a178, v66
v_perm_b32 v70, v11, v10, s47
v_accvgpr_write_b32 a186, v70
s_mov_b32 s20, 122368
buffer_load_dword v10, v4, s[12:15], s20 offen
s_mov_b32 s21, 123520
buffer_load_dword v11, v4, s[12:15], s21 offen
s_waitcnt vmcnt(56)
v_perm_b32 v67, v13, v12, s46
v_accvgpr_write_b32 a179, v67
v_perm_b32 v71, v13, v12, s47
v_accvgpr_write_b32 a187, v71
s_mov_b32 s20, 512
buffer_load_dword v12, v4, s[12:15], s20 offen
s_mov_b32 s21, 1664
buffer_load_dword v13, v4, s[12:15], s21 offen
s_waitcnt vmcnt(56)
v_perm_b32 v64, v15, v14, s46
v_accvgpr_write_b32 a180, v64
v_perm_b32 v68, v15, v14, s47
v_accvgpr_write_b32 a188, v68
s_mov_b32 s20, 9728
buffer_load_dword v14, v4, s[12:15], s20 offen
s_mov_b32 s21, 10880
buffer_load_dword v15, v4, s[12:15], s21 offen
s_waitcnt vmcnt(56)
v_perm_b32 v65, v17, v16, s46
v_accvgpr_write_b32 a181, v65
v_perm_b32 v69, v17, v16, s47
v_accvgpr_write_b32 a189, v69
s_mov_b32 s20, 2816
buffer_load_dword v16, v4, s[12:15], s20 offen
s_mov_b32 s21, 3968
buffer_load_dword v17, v4, s[12:15], s21 offen
s_waitcnt vmcnt(56)
v_perm_b32 v66, v19, v18, s46
v_accvgpr_write_b32 a182, v66
v_perm_b32 v70, v19, v18, s47
v_accvgpr_write_b32 a190, v70
s_mov_b32 s20, 12032
buffer_load_dword v18, v4, s[12:15], s20 offen
s_mov_b32 s21, 13184
buffer_load_dword v19, v4, s[12:15], s21 offen
s_waitcnt vmcnt(56)
v_perm_b32 v67, v21, v20, s46
v_accvgpr_write_b32 a183, v67
v_perm_b32 v71, v21, v20, s47
v_accvgpr_write_b32 a191, v71
s_mov_b32 s20, 37376
buffer_load_dword v20, v4, s[12:15], s20 offen
s_mov_b32 s21, 38528
buffer_load_dword v21, v4, s[12:15], s21 offen
s_waitcnt vmcnt(56)
v_perm_b32 v64, v23, v22, s46
v_perm_b32 v68, v23, v22, s47
s_mov_b32 s20, 46592
buffer_load_dword v22, v4, s[12:15], s20 offen
s_mov_b32 s21, 47744
buffer_load_dword v23, v4, s[12:15], s21 offen
s_waitcnt vmcnt(56)
v_perm_b32 v65, v25, v24, s46
v_perm_b32 v69, v25, v24, s47
s_mov_b32 s20, 39680
buffer_load_dword v24, v4, s[12:15], s20 offen
s_mov_b32 s21, 40832
buffer_load_dword v25, v4, s[12:15], s21 offen
s_waitcnt vmcnt(56)
v_perm_b32 v66, v27, v26, s46
v_perm_b32 v70, v27, v26, s47
s_mov_b32 s20, 48896
buffer_load_dword v26, v4, s[12:15], s20 offen
s_mov_b32 s21, 50048
buffer_load_dword v27, v4, s[12:15], s21 offen
s_waitcnt vmcnt(56)
v_perm_b32 v67, v29, v28, s46
ds_write_b128 v3, v[64:67] offset:20480
s_waitcnt lgkmcnt(0)
v_perm_b32 v71, v29, v28, s47
ds_write_b128 v3, v[68:71] offset:22528
s_waitcnt lgkmcnt(0)
s_mov_b32 s20, 74240
buffer_load_dword v28, v4, s[12:15], s20 offen
s_mov_b32 s21, 75392
buffer_load_dword v29, v4, s[12:15], s21 offen
s_waitcnt vmcnt(56)
v_perm_b32 v64, v31, v30, s46
v_perm_b32 v68, v31, v30, s47
s_mov_b32 s20, 83456
buffer_load_dword v30, v4, s[12:15], s20 offen
s_mov_b32 s21, 84608
buffer_load_dword v31, v4, s[12:15], s21 offen
s_waitcnt vmcnt(56)
v_perm_b32 v65, v33, v32, s46
v_perm_b32 v69, v33, v32, s47
s_mov_b32 s20, 76544
buffer_load_dword v32, v4, s[12:15], s20 offen
s_mov_b32 s21, 77696
buffer_load_dword v33, v4, s[12:15], s21 offen
s_waitcnt vmcnt(56)
v_perm_b32 v66, v35, v34, s46
v_perm_b32 v70, v35, v34, s47
s_mov_b32 s20, 85760
buffer_load_dword v34, v4, s[12:15], s20 offen
s_mov_b32 s21, 86912
buffer_load_dword v35, v4, s[12:15], s21 offen
s_waitcnt vmcnt(56)
v_perm_b32 v67, v37, v36, s46
ds_write_b128 v3, v[64:67] offset:21504
s_waitcnt lgkmcnt(0)
v_perm_b32 v71, v37, v36, s47
ds_write_b128 v3, v[68:71] offset:23552
s_waitcnt lgkmcnt(0)
s_mov_b32 s20, 111104
buffer_load_dword v36, v4, s[12:15], s20 offen
s_mov_b32 s21, 112256
buffer_load_dword v37, v4, s[12:15], s21 offen
s_waitcnt vmcnt(56)
v_perm_b32 v64, v39, v38, s46
v_accvgpr_write_b32 a192, v64
v_perm_b32 v68, v39, v38, s47
v_accvgpr_write_b32 a200, v68
s_mov_b32 s20, 120320
buffer_load_dword v38, v4, s[12:15], s20 offen
s_mov_b32 s21, 121472
buffer_load_dword v39, v4, s[12:15], s21 offen
s_waitcnt vmcnt(56)
v_perm_b32 v65, v41, v40, s46
v_accvgpr_write_b32 a193, v65
v_perm_b32 v69, v41, v40, s47
v_accvgpr_write_b32 a201, v69
s_mov_b32 s20, 113408
buffer_load_dword v40, v4, s[12:15], s20 offen
s_mov_b32 s21, 114560
buffer_load_dword v41, v4, s[12:15], s21 offen
s_waitcnt vmcnt(56)
v_perm_b32 v66, v43, v42, s46
v_accvgpr_write_b32 a194, v66
v_perm_b32 v70, v43, v42, s47
v_accvgpr_write_b32 a202, v70
s_mov_b32 s20, 122624
buffer_load_dword v42, v4, s[12:15], s20 offen
s_mov_b32 s21, 123776
buffer_load_dword v43, v4, s[12:15], s21 offen
s_waitcnt vmcnt(56)
v_perm_b32 v67, v45, v44, s46
v_accvgpr_write_b32 a195, v67
v_perm_b32 v71, v45, v44, s47
v_accvgpr_write_b32 a203, v71
s_mov_b32 s20, 768
buffer_load_dword v44, v4, s[12:15], s20 offen
s_mov_b32 s21, 1920
buffer_load_dword v45, v4, s[12:15], s21 offen
s_waitcnt vmcnt(56)
v_perm_b32 v64, v47, v46, s46
v_accvgpr_write_b32 a196, v64
v_perm_b32 v68, v47, v46, s47
v_accvgpr_write_b32 a204, v68
s_mov_b32 s20, 9984
buffer_load_dword v46, v4, s[12:15], s20 offen
s_mov_b32 s21, 11136
buffer_load_dword v47, v4, s[12:15], s21 offen
s_waitcnt vmcnt(56)
v_perm_b32 v65, v49, v48, s46
v_accvgpr_write_b32 a197, v65
v_perm_b32 v69, v49, v48, s47
v_accvgpr_write_b32 a205, v69
s_mov_b32 s20, 3072
buffer_load_dword v48, v4, s[12:15], s20 offen
s_mov_b32 s21, 4224
buffer_load_dword v49, v4, s[12:15], s21 offen
s_waitcnt vmcnt(56)
v_perm_b32 v66, v51, v50, s46
v_accvgpr_write_b32 a198, v66
v_perm_b32 v70, v51, v50, s47
v_accvgpr_write_b32 a206, v70
s_mov_b32 s20, 12288
buffer_load_dword v50, v4, s[12:15], s20 offen
s_mov_b32 s21, 13440
buffer_load_dword v51, v4, s[12:15], s21 offen
s_waitcnt vmcnt(56)
v_perm_b32 v67, v53, v52, s46
v_accvgpr_write_b32 a199, v67
v_perm_b32 v71, v53, v52, s47
v_accvgpr_write_b32 a207, v71
s_mov_b32 s20, 37632
buffer_load_dword v52, v4, s[12:15], s20 offen
s_mov_b32 s21, 38784
buffer_load_dword v53, v4, s[12:15], s21 offen
s_waitcnt vmcnt(56)
v_perm_b32 v64, v55, v54, s46
v_perm_b32 v68, v55, v54, s47
s_mov_b32 s20, 46848
buffer_load_dword v54, v4, s[12:15], s20 offen
s_mov_b32 s21, 48000
buffer_load_dword v55, v4, s[12:15], s21 offen
s_waitcnt vmcnt(56)
v_perm_b32 v65, v57, v56, s46
v_perm_b32 v69, v57, v56, s47
s_mov_b32 s20, 39936
buffer_load_dword v56, v4, s[12:15], s20 offen
s_mov_b32 s21, 41088
buffer_load_dword v57, v4, s[12:15], s21 offen
s_waitcnt vmcnt(56)
v_perm_b32 v66, v59, v58, s46
v_perm_b32 v70, v59, v58, s47
s_mov_b32 s20, 49152
buffer_load_dword v58, v4, s[12:15], s20 offen
s_mov_b32 s21, 50304
buffer_load_dword v59, v4, s[12:15], s21 offen
s_waitcnt vmcnt(56)
v_perm_b32 v67, v61, v60, s46
ds_write_b128 v3, v[64:67] offset:24576
s_waitcnt lgkmcnt(0)
v_perm_b32 v71, v61, v60, s47
ds_write_b128 v3, v[68:71] offset:26624
s_waitcnt lgkmcnt(0)
s_mov_b32 s20, 74496
buffer_load_dword v60, v4, s[12:15], s20 offen
s_mov_b32 s21, 75648
buffer_load_dword v61, v4, s[12:15], s21 offen
s_waitcnt vmcnt(56)
v_perm_b32 v64, v63, v62, s46
v_perm_b32 v68, v63, v62, s47
s_mov_b32 s20, 83712
buffer_load_dword v62, v4, s[12:15], s20 offen
s_mov_b32 s21, 84864
buffer_load_dword v63, v4, s[12:15], s21 offen
s_waitcnt vmcnt(56)
v_perm_b32 v65, v7, v6, s46
v_perm_b32 v69, v7, v6, s47
s_mov_b32 s20, 76800
buffer_load_dword v6, v4, s[12:15], s20 offen
s_mov_b32 s21, 77952
buffer_load_dword v7, v4, s[12:15], s21 offen
s_waitcnt vmcnt(56)
v_perm_b32 v66, v9, v8, s46
v_perm_b32 v70, v9, v8, s47
s_mov_b32 s20, 86016
buffer_load_dword v8, v4, s[12:15], s20 offen
s_mov_b32 s21, 87168
buffer_load_dword v9, v4, s[12:15], s21 offen
s_waitcnt vmcnt(56)
v_perm_b32 v67, v11, v10, s46
ds_write_b128 v3, v[64:67] offset:25600
s_waitcnt lgkmcnt(0)
v_perm_b32 v71, v11, v10, s47
ds_write_b128 v3, v[68:71] offset:27648
s_waitcnt lgkmcnt(0)
s_mov_b32 s20, 111360
buffer_load_dword v10, v4, s[12:15], s20 offen
s_mov_b32 s21, 112512
buffer_load_dword v11, v4, s[12:15], s21 offen
s_waitcnt vmcnt(56)
v_perm_b32 v64, v13, v12, s46
v_accvgpr_write_b32 a208, v64
v_perm_b32 v68, v13, v12, s47
v_accvgpr_write_b32 a216, v68
s_mov_b32 s20, 120576
buffer_load_dword v12, v4, s[12:15], s20 offen
s_mov_b32 s21, 121728
buffer_load_dword v13, v4, s[12:15], s21 offen
s_waitcnt vmcnt(56)
v_perm_b32 v65, v15, v14, s46
v_accvgpr_write_b32 a209, v65
v_perm_b32 v69, v15, v14, s47
v_accvgpr_write_b32 a217, v69
s_mov_b32 s20, 113664
buffer_load_dword v14, v4, s[12:15], s20 offen
s_mov_b32 s21, 114816
buffer_load_dword v15, v4, s[12:15], s21 offen
s_waitcnt vmcnt(56)
v_perm_b32 v66, v17, v16, s46
v_accvgpr_write_b32 a210, v66
v_perm_b32 v70, v17, v16, s47
v_accvgpr_write_b32 a218, v70
s_mov_b32 s20, 122880
buffer_load_dword v16, v4, s[12:15], s20 offen
s_mov_b32 s21, 124032
buffer_load_dword v17, v4, s[12:15], s21 offen
s_waitcnt vmcnt(56)
v_perm_b32 v67, v19, v18, s46
v_accvgpr_write_b32 a211, v67
v_perm_b32 v71, v19, v18, s47
v_accvgpr_write_b32 a219, v71
s_mov_b32 s20, 1024
buffer_load_ushort v18, v2, s[12:15], s20 offen
s_mov_b32 s21, 2176
buffer_load_ushort v19, v2, s[12:15], s21 offen
s_waitcnt vmcnt(56)
v_perm_b32 v64, v21, v20, s46
v_accvgpr_write_b32 a212, v64
v_perm_b32 v68, v21, v20, s47
v_accvgpr_write_b32 a220, v68
s_mov_b32 s20, 10240
buffer_load_ushort v20, v2, s[12:15], s20 offen
s_mov_b32 s21, 11392
buffer_load_ushort v21, v2, s[12:15], s21 offen
s_waitcnt vmcnt(56)
v_perm_b32 v65, v23, v22, s46
v_accvgpr_write_b32 a213, v65
v_perm_b32 v69, v23, v22, s47
v_accvgpr_write_b32 a221, v69
s_mov_b32 s20, 3328
buffer_load_ushort v22, v2, s[12:15], s20 offen
s_mov_b32 s21, 4480
buffer_load_ushort v23, v2, s[12:15], s21 offen
s_waitcnt vmcnt(56)
v_perm_b32 v66, v25, v24, s46
v_accvgpr_write_b32 a214, v66
v_perm_b32 v70, v25, v24, s47
v_accvgpr_write_b32 a222, v70
s_mov_b32 s20, 12544
buffer_load_ushort v24, v2, s[12:15], s20 offen
s_mov_b32 s21, 13696
buffer_load_ushort v25, v2, s[12:15], s21 offen
s_waitcnt vmcnt(56)
v_perm_b32 v67, v27, v26, s46
v_accvgpr_write_b32 a215, v67
v_perm_b32 v71, v27, v26, s47
v_accvgpr_write_b32 a223, v71
s_mov_b32 s20, 37888
buffer_load_ushort v26, v2, s[12:15], s20 offen
s_mov_b32 s21, 39040
buffer_load_ushort v27, v2, s[12:15], s21 offen
s_waitcnt vmcnt(56)
v_perm_b32 v64, v29, v28, s46
v_perm_b32 v68, v29, v28, s47
s_mov_b32 s20, 47104
buffer_load_ushort v28, v2, s[12:15], s20 offen
s_mov_b32 s21, 48256
buffer_load_ushort v29, v2, s[12:15], s21 offen
s_waitcnt vmcnt(56)
v_perm_b32 v65, v31, v30, s46
v_perm_b32 v69, v31, v30, s47
s_mov_b32 s20, 40192
buffer_load_ushort v30, v2, s[12:15], s20 offen
s_mov_b32 s21, 41344
buffer_load_ushort v31, v2, s[12:15], s21 offen
s_waitcnt vmcnt(56)
v_perm_b32 v66, v33, v32, s46
v_perm_b32 v70, v33, v32, s47
s_mov_b32 s20, 49408
buffer_load_ushort v32, v2, s[12:15], s20 offen
s_mov_b32 s21, 50560
buffer_load_ushort v33, v2, s[12:15], s21 offen
s_waitcnt vmcnt(56)
v_perm_b32 v67, v35, v34, s46
ds_write_b128 v3, v[64:67] offset:28672
s_waitcnt lgkmcnt(0)
v_perm_b32 v71, v35, v34, s47
ds_write_b128 v3, v[68:71] offset:30720
s_waitcnt lgkmcnt(0)
s_mov_b32 s20, 74752
buffer_load_ushort v34, v2, s[12:15], s20 offen
s_mov_b32 s21, 75904
buffer_load_ushort v35, v2, s[12:15], s21 offen
s_waitcnt vmcnt(56)
v_perm_b32 v64, v37, v36, s46
v_perm_b32 v68, v37, v36, s47
s_mov_b32 s20, 83968
buffer_load_ushort v36, v2, s[12:15], s20 offen
s_mov_b32 s21, 85120
buffer_load_ushort v37, v2, s[12:15], s21 offen
s_waitcnt vmcnt(56)
v_perm_b32 v65, v39, v38, s46
v_perm_b32 v69, v39, v38, s47
s_mov_b32 s20, 77056
buffer_load_ushort v38, v2, s[12:15], s20 offen
s_mov_b32 s21, 78208
buffer_load_ushort v39, v2, s[12:15], s21 offen
s_waitcnt vmcnt(56)
v_perm_b32 v66, v41, v40, s46
v_perm_b32 v70, v41, v40, s47
s_mov_b32 s20, 86272
buffer_load_ushort v40, v2, s[12:15], s20 offen
s_mov_b32 s21, 87424
buffer_load_ushort v41, v2, s[12:15], s21 offen
s_waitcnt vmcnt(56)
v_perm_b32 v67, v43, v42, s46
ds_write_b128 v3, v[64:67] offset:29696
s_waitcnt lgkmcnt(0)
v_perm_b32 v71, v43, v42, s47
ds_write_b128 v3, v[68:71] offset:31744
s_waitcnt lgkmcnt(0)
s_mov_b32 s20, 111616
buffer_load_ushort v42, v2, s[12:15], s20 offen
s_mov_b32 s21, 112768
buffer_load_ushort v43, v2, s[12:15], s21 offen
s_waitcnt vmcnt(56)
v_perm_b32 v64, v45, v44, s46
v_accvgpr_write_b32 a224, v64
v_perm_b32 v68, v45, v44, s47
v_accvgpr_write_b32 a232, v68
s_mov_b32 s20, 120832
buffer_load_ushort v44, v2, s[12:15], s20 offen
s_mov_b32 s21, 121984
buffer_load_ushort v45, v2, s[12:15], s21 offen
s_waitcnt vmcnt(56)
v_perm_b32 v65, v47, v46, s46
v_accvgpr_write_b32 a225, v65
v_perm_b32 v69, v47, v46, s47
v_accvgpr_write_b32 a233, v69
s_mov_b32 s20, 113920
buffer_load_ushort v46, v2, s[12:15], s20 offen
s_mov_b32 s21, 115072
buffer_load_ushort v47, v2, s[12:15], s21 offen
s_waitcnt vmcnt(56)
v_perm_b32 v66, v49, v48, s46
v_accvgpr_write_b32 a226, v66
v_perm_b32 v70, v49, v48, s47
v_accvgpr_write_b32 a234, v70
s_mov_b32 s20, 123136
buffer_load_ushort v48, v2, s[12:15], s20 offen
s_mov_b32 s21, 124288
buffer_load_ushort v49, v2, s[12:15], s21 offen
s_waitcnt vmcnt(56)
v_perm_b32 v67, v51, v50, s46
v_accvgpr_write_b32 a227, v67
v_perm_b32 v71, v51, v50, s47
v_accvgpr_write_b32 a235, v71
s_load_dwordx2 s[50:51], s[0:1], 64
s_waitcnt lgkmcnt(0)
s_mov_b32 s12, s50
s_and_b32 s13, s51, 0xffff
s_mov_b32 s14, 4718592
s_mov_b32 s15, 0x20000
s_mov_b32 s20, 0
buffer_load_dword v50, v1, s[12:15], s20 offen
s_mov_b32 s21, 32768
buffer_load_dword v51, v1, s[12:15], s21 offen
s_waitcnt vmcnt(56)
v_perm_b32 v64, v53, v52, s46
v_accvgpr_write_b32 a228, v64
v_perm_b32 v68, v53, v52, s47
v_accvgpr_write_b32 a236, v68
s_mov_b32 s20, 65536
buffer_load_dword v52, v1, s[12:15], s20 offen
s_mov_b32 s21, 98304
buffer_load_dword v53, v1, s[12:15], s21 offen
s_waitcnt vmcnt(56)
v_perm_b32 v65, v55, v54, s46
v_accvgpr_write_b32 a229, v65
v_perm_b32 v69, v55, v54, s47
v_accvgpr_write_b32 a237, v69
s_mov_b32 s20, 8192
buffer_load_dword v54, v1, s[12:15], s20 offen
s_mov_b32 s21, 40960
buffer_load_dword v55, v1, s[12:15], s21 offen
s_waitcnt vmcnt(56)
v_perm_b32 v66, v57, v56, s46
v_accvgpr_write_b32 a230, v66
v_perm_b32 v70, v57, v56, s47
v_accvgpr_write_b32 a238, v70
s_mov_b32 s20, 73728
buffer_load_dword v56, v1, s[12:15], s20 offen
s_mov_b32 s21, 106496
buffer_load_dword v57, v1, s[12:15], s21 offen
s_waitcnt vmcnt(56)
v_perm_b32 v67, v59, v58, s46
v_accvgpr_write_b32 a231, v67
v_perm_b32 v71, v59, v58, s47
v_accvgpr_write_b32 a239, v71
s_mov_b32 s20, 262144
buffer_load_dword v58, v1, s[12:15], s20 offen
s_mov_b32 s21, 294912
buffer_load_dword v59, v1, s[12:15], s21 offen
s_waitcnt vmcnt(56)
v_perm_b32 v64, v61, v60, s46
v_perm_b32 v68, v61, v60, s47
v_accvgpr_write_b32 a240, v68
s_mov_b32 s20, 327680
buffer_load_dword v60, v1, s[12:15], s20 offen
s_mov_b32 s21, 360448
buffer_load_dword v61, v1, s[12:15], s21 offen
s_waitcnt vmcnt(56)
v_perm_b32 v65, v63, v62, s46
v_perm_b32 v69, v63, v62, s47
v_accvgpr_write_b32 a241, v69
s_mov_b32 s20, 270336
buffer_load_dword v62, v1, s[12:15], s20 offen
s_mov_b32 s21, 303104
buffer_load_dword v63, v1, s[12:15], s21 offen
s_waitcnt vmcnt(56)
v_perm_b32 v66, v7, v6, s46
v_perm_b32 v70, v7, v6, s47
v_accvgpr_write_b32 a242, v70
s_mov_b32 s20, 335872
buffer_load_dword v6, v1, s[12:15], s20 offen
s_mov_b32 s21, 368640
buffer_load_dword v7, v1, s[12:15], s21 offen
s_waitcnt vmcnt(56)
v_perm_b32 v67, v9, v8, s46
ds_write_b128 v3, v[64:67] offset:32768
s_waitcnt lgkmcnt(0)
v_perm_b32 v71, v9, v8, s47
v_accvgpr_write_b32 a243, v71
s_mov_b32 s20, 524288
buffer_load_dword v8, v1, s[12:15], s20 offen
s_mov_b32 s21, 557056
buffer_load_dword v9, v1, s[12:15], s21 offen
s_waitcnt vmcnt(56)
v_perm_b32 v64, v11, v10, s46
v_perm_b32 v68, v11, v10, s47
v_accvgpr_write_b32 a244, v68
s_mov_b32 s20, 589824
buffer_load_dword v10, v1, s[12:15], s20 offen
s_mov_b32 s21, 622592
buffer_load_dword v11, v1, s[12:15], s21 offen
s_waitcnt vmcnt(56)
v_perm_b32 v65, v13, v12, s46
v_perm_b32 v69, v13, v12, s47
v_accvgpr_write_b32 a245, v69
s_mov_b32 s20, 532480
buffer_load_dword v12, v1, s[12:15], s20 offen
s_mov_b32 s21, 565248
buffer_load_dword v13, v1, s[12:15], s21 offen
s_waitcnt vmcnt(56)
v_perm_b32 v66, v15, v14, s46
v_perm_b32 v70, v15, v14, s47
v_accvgpr_write_b32 a246, v70
s_mov_b32 s20, 598016
buffer_load_dword v14, v1, s[12:15], s20 offen
s_mov_b32 s21, 630784
buffer_load_dword v15, v1, s[12:15], s21 offen
s_waitcnt vmcnt(56)
v_perm_b32 v67, v17, v16, s46
ds_write_b128 v3, v[64:67] offset:33792
s_waitcnt lgkmcnt(0)
v_perm_b32 v71, v17, v16, s47
v_accvgpr_write_b32 a247, v71
s_mov_b32 s20, 786432
buffer_load_dword v16, v1, s[12:15], s20 offen
s_mov_b32 s21, 819200
buffer_load_dword v17, v1, s[12:15], s21 offen
s_waitcnt vmcnt(56)
v_perm_b32 v64, v19, v18, s46
v_accvgpr_write_b32 a248, v64
s_mov_b32 s20, 851968
buffer_load_dword v18, v1, s[12:15], s20 offen
s_mov_b32 s21, 884736
buffer_load_dword v19, v1, s[12:15], s21 offen
s_waitcnt vmcnt(56)
v_perm_b32 v65, v21, v20, s46
v_accvgpr_write_b32 a249, v65
s_mov_b32 s20, 794624
buffer_load_dword v20, v1, s[12:15], s20 offen
s_mov_b32 s21, 827392
buffer_load_dword v21, v1, s[12:15], s21 offen
s_waitcnt vmcnt(56)
v_perm_b32 v66, v23, v22, s46
v_accvgpr_write_b32 a250, v66
s_mov_b32 s20, 860160
buffer_load_dword v22, v1, s[12:15], s20 offen
s_mov_b32 s21, 892928
buffer_load_dword v23, v1, s[12:15], s21 offen
s_waitcnt vmcnt(56)
v_perm_b32 v67, v25, v24, s46
v_accvgpr_write_b32 a251, v67
s_mov_b32 s20, 1048576
buffer_load_dword v24, v1, s[12:15], s20 offen
s_mov_b32 s21, 1081344
buffer_load_dword v25, v1, s[12:15], s21 offen
s_waitcnt vmcnt(56)
v_perm_b32 v64, v27, v26, s46
v_accvgpr_write_b32 a252, v64
s_mov_b32 s20, 1114112
buffer_load_dword v26, v1, s[12:15], s20 offen
s_mov_b32 s21, 1146880
buffer_load_dword v27, v1, s[12:15], s21 offen
s_waitcnt vmcnt(56)
v_perm_b32 v65, v29, v28, s46
v_accvgpr_write_b32 a253, v65
s_mov_b32 s20, 1056768
buffer_load_dword v28, v1, s[12:15], s20 offen
s_mov_b32 s21, 1089536
buffer_load_dword v29, v1, s[12:15], s21 offen
s_waitcnt vmcnt(56)
v_perm_b32 v66, v31, v30, s46
v_accvgpr_write_b32 a254, v66
s_mov_b32 s20, 1122304
buffer_load_dword v30, v1, s[12:15], s20 offen
s_mov_b32 s21, 1155072
buffer_load_dword v31, v1, s[12:15], s21 offen
s_waitcnt vmcnt(56)
v_perm_b32 v67, v33, v32, s46
v_accvgpr_write_b32 a255, v67
s_mov_b32 s20, 1310720
buffer_load_dword v32, v1, s[12:15], s20 offen
s_mov_b32 s21, 1343488
buffer_load_dword v33, v1, s[12:15], s21 offen
s_waitcnt vmcnt(56)
v_perm_b32 v64, v35, v34, s46
s_mov_b32 s20, 1376256
buffer_load_dword v34, v1, s[12:15], s20 offen
s_mov_b32 s21, 1409024
buffer_load_dword v35, v1, s[12:15], s21 offen
s_waitcnt vmcnt(56)
v_perm_b32 v65, v37, v36, s46
s_mov_b32 s20, 1318912
buffer_load_dword v36, v1, s[12:15], s20 offen
s_mov_b32 s21, 1351680
buffer_load_dword v37, v1, s[12:15], s21 offen
s_waitcnt vmcnt(56)
v_perm_b32 v66, v39, v38, s46
s_mov_b32 s20, 1384448
buffer_load_dword v38, v1, s[12:15], s20 offen
s_mov_b32 s21, 1417216
buffer_load_dword v39, v1, s[12:15], s21 offen
s_waitcnt vmcnt(56)
v_perm_b32 v67, v41, v40, s46
ds_write_b128 v3, v[64:67] offset:18432
s_waitcnt lgkmcnt(0)
s_mov_b32 s20, 1572864
buffer_load_dword v40, v1, s[12:15], s20 offen
s_mov_b32 s21, 1605632
buffer_load_dword v41, v1, s[12:15], s21 offen
s_waitcnt vmcnt(56)
v_perm_b32 v64, v43, v42, s46
s_mov_b32 s20, 1638400
buffer_load_dword v42, v1, s[12:15], s20 offen
s_mov_b32 s21, 1671168
buffer_load_dword v43, v1, s[12:15], s21 offen
s_waitcnt vmcnt(56)
v_perm_b32 v65, v45, v44, s46
s_mov_b32 s20, 1581056
buffer_load_dword v44, v1, s[12:15], s20 offen
s_mov_b32 s21, 1613824
buffer_load_dword v45, v1, s[12:15], s21 offen
s_waitcnt vmcnt(56)
v_perm_b32 v66, v47, v46, s46
s_mov_b32 s20, 1646592
buffer_load_dword v46, v1, s[12:15], s20 offen
s_mov_b32 s21, 1679360
buffer_load_dword v47, v1, s[12:15], s21 offen
s_waitcnt vmcnt(56)
v_perm_b32 v67, v49, v48, s46
ds_write_b128 v3, v[64:67] offset:19456
s_waitcnt lgkmcnt(0)
s_mov_b32 s20, 1835008
buffer_load_dword v48, v1, s[12:15], s20 offen
s_mov_b32 s21, 1867776
buffer_load_dword v49, v1, s[12:15], s21 offen
s_waitcnt vmcnt(56)
v_perm_b32 v72, v51, v50, s46
v_perm_b32 v80, v51, v50, s47
s_mov_b32 s20, 1900544
buffer_load_dword v50, v1, s[12:15], s20 offen
s_mov_b32 s21, 1933312
buffer_load_dword v51, v1, s[12:15], s21 offen
s_waitcnt vmcnt(56)
v_perm_b32 v73, v53, v52, s46
v_perm_b32 v81, v53, v52, s47
s_mov_b32 s20, 1843200
buffer_load_dword v52, v1, s[12:15], s20 offen
s_mov_b32 s21, 1875968
buffer_load_dword v53, v1, s[12:15], s21 offen
s_waitcnt vmcnt(56)
v_perm_b32 v74, v55, v54, s46
v_perm_b32 v82, v55, v54, s47
s_mov_b32 s20, 1908736
buffer_load_dword v54, v1, s[12:15], s20 offen
s_mov_b32 s21, 1941504
buffer_load_dword v55, v1, s[12:15], s21 offen
s_waitcnt vmcnt(56)
v_perm_b32 v75, v57, v56, s46
v_perm_b32 v83, v57, v56, s47
s_mov_b32 s20, 2097152
buffer_load_dword v56, v1, s[12:15], s20 offen
s_mov_b32 s21, 2129920
buffer_load_dword v57, v1, s[12:15], s21 offen
s_waitcnt vmcnt(56)
v_perm_b32 v76, v59, v58, s46
v_perm_b32 v84, v59, v58, s47
s_mov_b32 s20, 2162688
buffer_load_dword v58, v1, s[12:15], s20 offen
s_mov_b32 s21, 2195456
buffer_load_dword v59, v1, s[12:15], s21 offen
s_waitcnt vmcnt(56)
v_perm_b32 v77, v61, v60, s46
v_perm_b32 v85, v61, v60, s47
s_mov_b32 s20, 2105344
buffer_load_dword v60, v1, s[12:15], s20 offen
s_mov_b32 s21, 2138112
buffer_load_dword v61, v1, s[12:15], s21 offen
s_waitcnt vmcnt(56)
v_perm_b32 v78, v63, v62, s46
v_perm_b32 v86, v63, v62, s47
s_mov_b32 s20, 2170880
buffer_load_dword v62, v1, s[12:15], s20 offen
s_mov_b32 s21, 2203648
buffer_load_dword v63, v1, s[12:15], s21 offen
s_waitcnt vmcnt(56)
v_perm_b32 v79, v7, v6, s46
v_perm_b32 v87, v7, v6, s47
s_mov_b32 s20, 2359296
buffer_load_dword v6, v1, s[12:15], s20 offen
s_mov_b32 s21, 2392064
buffer_load_dword v7, v1, s[12:15], s21 offen
s_waitcnt vmcnt(56)
v_perm_b32 v96, v9, v8, s46
v_perm_b32 v104, v9, v8, s47
s_mov_b32 s20, 2424832
buffer_load_dword v8, v1, s[12:15], s20 offen
s_mov_b32 s21, 2457600
buffer_load_dword v9, v1, s[12:15], s21 offen
s_waitcnt vmcnt(56)
v_perm_b32 v97, v11, v10, s46
v_perm_b32 v105, v11, v10, s47
s_mov_b32 s20, 2367488
buffer_load_dword v10, v1, s[12:15], s20 offen
s_mov_b32 s21, 2400256
buffer_load_dword v11, v1, s[12:15], s21 offen
s_waitcnt vmcnt(56)
v_perm_b32 v98, v13, v12, s46
v_perm_b32 v106, v13, v12, s47
s_mov_b32 s20, 2433024
buffer_load_dword v12, v1, s[12:15], s20 offen
s_mov_b32 s21, 2465792
buffer_load_dword v13, v1, s[12:15], s21 offen
s_waitcnt vmcnt(56)
v_perm_b32 v99, v15, v14, s46
v_perm_b32 v107, v15, v14, s47
s_mov_b32 s20, 2621440
buffer_load_dword v14, v1, s[12:15], s20 offen
s_mov_b32 s21, 2654208
buffer_load_dword v15, v1, s[12:15], s21 offen
s_waitcnt vmcnt(56)
v_perm_b32 v100, v17, v16, s46
v_perm_b32 v108, v17, v16, s47
s_mov_b32 s20, 2686976
buffer_load_dword v16, v1, s[12:15], s20 offen
s_mov_b32 s21, 2719744
buffer_load_dword v17, v1, s[12:15], s21 offen
s_waitcnt vmcnt(56)
v_perm_b32 v101, v19, v18, s46
v_perm_b32 v109, v19, v18, s47
s_mov_b32 s20, 2629632
buffer_load_dword v18, v1, s[12:15], s20 offen
s_mov_b32 s21, 2662400
buffer_load_dword v19, v1, s[12:15], s21 offen
s_waitcnt vmcnt(56)
v_perm_b32 v102, v21, v20, s46
v_perm_b32 v110, v21, v20, s47
s_mov_b32 s20, 2695168
buffer_load_dword v20, v1, s[12:15], s20 offen
s_mov_b32 s21, 2727936
buffer_load_dword v21, v1, s[12:15], s21 offen
s_waitcnt vmcnt(56)
v_perm_b32 v103, v23, v22, s46
v_perm_b32 v111, v23, v22, s47
s_mov_b32 s20, 2883584
buffer_load_dword v22, v1, s[12:15], s20 offen
s_mov_b32 s21, 2916352
buffer_load_dword v23, v1, s[12:15], s21 offen
s_waitcnt vmcnt(56)
v_perm_b32 v120, v25, v24, s46
v_perm_b32 v128, v25, v24, s47
s_mov_b32 s20, 2949120
buffer_load_dword v24, v1, s[12:15], s20 offen
s_mov_b32 s21, 2981888
buffer_load_dword v25, v1, s[12:15], s21 offen
s_waitcnt vmcnt(56)
v_perm_b32 v121, v27, v26, s46
v_perm_b32 v129, v27, v26, s47
s_mov_b32 s20, 2891776
buffer_load_dword v26, v1, s[12:15], s20 offen
s_mov_b32 s21, 2924544
buffer_load_dword v27, v1, s[12:15], s21 offen
s_waitcnt vmcnt(56)
v_perm_b32 v122, v29, v28, s46
v_perm_b32 v130, v29, v28, s47
s_mov_b32 s20, 2957312
buffer_load_dword v28, v1, s[12:15], s20 offen
s_mov_b32 s21, 2990080
buffer_load_dword v29, v1, s[12:15], s21 offen
s_waitcnt vmcnt(56)
v_perm_b32 v123, v31, v30, s46
v_perm_b32 v131, v31, v30, s47
s_mov_b32 s20, 3145728
buffer_load_dword v30, v1, s[12:15], s20 offen
s_mov_b32 s21, 3178496
buffer_load_dword v31, v1, s[12:15], s21 offen
s_waitcnt vmcnt(56)
v_perm_b32 v124, v33, v32, s46
v_perm_b32 v132, v33, v32, s47
s_mov_b32 s20, 3211264
buffer_load_dword v32, v1, s[12:15], s20 offen
s_mov_b32 s21, 3244032
buffer_load_dword v33, v1, s[12:15], s21 offen
s_waitcnt vmcnt(56)
v_perm_b32 v125, v35, v34, s46
v_perm_b32 v133, v35, v34, s47
s_mov_b32 s20, 3153920
buffer_load_dword v34, v1, s[12:15], s20 offen
s_mov_b32 s21, 3186688
buffer_load_dword v35, v1, s[12:15], s21 offen
s_waitcnt vmcnt(56)
v_perm_b32 v126, v37, v36, s46
v_perm_b32 v134, v37, v36, s47
s_mov_b32 s20, 3219456
buffer_load_dword v36, v1, s[12:15], s20 offen
s_mov_b32 s21, 3252224
buffer_load_dword v37, v1, s[12:15], s21 offen
s_waitcnt vmcnt(56)
v_perm_b32 v127, v39, v38, s46
v_perm_b32 v135, v39, v38, s47
s_mov_b32 s20, 3407872
buffer_load_dword v38, v1, s[12:15], s20 offen
s_mov_b32 s21, 3440640
buffer_load_dword v39, v1, s[12:15], s21 offen
s_waitcnt vmcnt(56)
v_perm_b32 v144, v41, v40, s46
v_perm_b32 v152, v41, v40, s47
s_mov_b32 s20, 3473408
buffer_load_dword v40, v1, s[12:15], s20 offen
s_mov_b32 s21, 3506176
buffer_load_dword v41, v1, s[12:15], s21 offen
s_waitcnt vmcnt(56)
v_perm_b32 v145, v43, v42, s46
v_perm_b32 v153, v43, v42, s47
s_mov_b32 s20, 3416064
buffer_load_dword v42, v1, s[12:15], s20 offen
s_mov_b32 s21, 3448832
buffer_load_dword v43, v1, s[12:15], s21 offen
s_waitcnt vmcnt(56)
v_perm_b32 v146, v45, v44, s46
v_perm_b32 v154, v45, v44, s47
s_mov_b32 s20, 3481600
buffer_load_dword v44, v1, s[12:15], s20 offen
s_mov_b32 s21, 3514368
buffer_load_dword v45, v1, s[12:15], s21 offen
s_waitcnt vmcnt(56)
v_perm_b32 v147, v47, v46, s46
v_perm_b32 v155, v47, v46, s47
s_mov_b32 s20, 3670016
buffer_load_dword v46, v1, s[12:15], s20 offen
s_mov_b32 s21, 3702784
buffer_load_dword v47, v1, s[12:15], s21 offen
s_waitcnt vmcnt(56)
v_perm_b32 v148, v49, v48, s46
v_perm_b32 v156, v49, v48, s47
s_mov_b32 s20, 3735552
buffer_load_dword v48, v1, s[12:15], s20 offen
s_mov_b32 s21, 3768320
buffer_load_dword v49, v1, s[12:15], s21 offen
s_waitcnt vmcnt(56)
v_perm_b32 v149, v51, v50, s46
v_perm_b32 v157, v51, v50, s47
s_mov_b32 s20, 3678208
buffer_load_dword v50, v1, s[12:15], s20 offen
s_mov_b32 s21, 3710976
buffer_load_dword v51, v1, s[12:15], s21 offen
s_waitcnt vmcnt(56)
v_perm_b32 v150, v53, v52, s46
v_perm_b32 v158, v53, v52, s47
s_mov_b32 s20, 3743744
buffer_load_dword v52, v1, s[12:15], s20 offen
s_mov_b32 s21, 3776512
buffer_load_dword v53, v1, s[12:15], s21 offen
s_waitcnt vmcnt(56)
v_perm_b32 v151, v55, v54, s46
v_perm_b32 v159, v55, v54, s47
s_mov_b32 s20, 3932160
buffer_load_dword v54, v1, s[12:15], s20 offen
s_mov_b32 s21, 3964928
buffer_load_dword v55, v1, s[12:15], s21 offen
s_waitcnt vmcnt(56)
v_perm_b32 v168, v57, v56, s46
v_perm_b32 v176, v57, v56, s47
s_mov_b32 s20, 3997696
buffer_load_dword v56, v1, s[12:15], s20 offen
s_mov_b32 s21, 4030464
buffer_load_dword v57, v1, s[12:15], s21 offen
s_waitcnt vmcnt(56)
v_perm_b32 v169, v59, v58, s46
v_perm_b32 v177, v59, v58, s47
s_mov_b32 s20, 3940352
buffer_load_dword v58, v1, s[12:15], s20 offen
s_mov_b32 s21, 3973120
buffer_load_dword v59, v1, s[12:15], s21 offen
s_waitcnt vmcnt(56)
v_perm_b32 v170, v61, v60, s46
v_perm_b32 v178, v61, v60, s47
s_mov_b32 s20, 4005888
buffer_load_dword v60, v1, s[12:15], s20 offen
s_mov_b32 s21, 4038656
buffer_load_dword v61, v1, s[12:15], s21 offen
s_waitcnt vmcnt(56)
v_perm_b32 v171, v63, v62, s46
v_perm_b32 v179, v63, v62, s47
s_mov_b32 s20, 4194304
buffer_load_dword v62, v1, s[12:15], s20 offen
s_mov_b32 s21, 4227072
buffer_load_dword v63, v1, s[12:15], s21 offen
s_waitcnt vmcnt(56)
v_perm_b32 v172, v7, v6, s46
v_perm_b32 v180, v7, v6, s47
s_mov_b32 s20, 4259840
buffer_load_dword v6, v1, s[12:15], s20 offen
s_mov_b32 s21, 4292608
buffer_load_dword v7, v1, s[12:15], s21 offen
s_waitcnt vmcnt(56)
v_perm_b32 v173, v9, v8, s46
v_perm_b32 v181, v9, v8, s47
s_mov_b32 s20, 4202496
buffer_load_dword v8, v1, s[12:15], s20 offen
s_mov_b32 s21, 4235264
buffer_load_dword v9, v1, s[12:15], s21 offen
s_waitcnt vmcnt(56)
v_perm_b32 v174, v11, v10, s46
v_perm_b32 v182, v11, v10, s47
s_mov_b32 s20, 4268032
buffer_load_dword v10, v1, s[12:15], s20 offen
s_mov_b32 s21, 4300800
buffer_load_dword v11, v1, s[12:15], s21 offen
s_waitcnt vmcnt(56)
v_perm_b32 v175, v13, v12, s46
v_perm_b32 v183, v13, v12, s47
s_mov_b32 s20, 4456448
buffer_load_dword v12, v1, s[12:15], s20 offen
s_mov_b32 s21, 4489216
buffer_load_dword v13, v1, s[12:15], s21 offen
s_waitcnt vmcnt(56)
v_perm_b32 v192, v15, v14, s46
v_perm_b32 v200, v15, v14, s47
s_mov_b32 s20, 4521984
buffer_load_dword v14, v1, s[12:15], s20 offen
s_mov_b32 s21, 4554752
buffer_load_dword v15, v1, s[12:15], s21 offen
s_waitcnt vmcnt(56)
v_perm_b32 v193, v17, v16, s46
v_perm_b32 v201, v17, v16, s47
s_mov_b32 s20, 4464640
buffer_load_dword v16, v1, s[12:15], s20 offen
s_mov_b32 s21, 4497408
buffer_load_dword v17, v1, s[12:15], s21 offen
s_waitcnt vmcnt(56)
v_perm_b32 v194, v19, v18, s46
v_perm_b32 v202, v19, v18, s47
s_mov_b32 s20, 4530176
buffer_load_dword v18, v1, s[12:15], s20 offen
s_mov_b32 s21, 4562944
buffer_load_dword v19, v1, s[12:15], s21 offen
s_waitcnt vmcnt(56)
v_perm_b32 v195, v21, v20, s46
v_perm_b32 v203, v21, v20, s47
s_load_dwordx2 s[50:51], s[0:1], 72
s_waitcnt lgkmcnt(0)
s_mov_b32 s12, s50
s_and_b32 s13, s51, 0xffff
s_mov_b32 s14, 4718592
s_mov_b32 s15, 0x20000
s_mov_b32 s20, 0
buffer_load_dword v20, v1, s[12:15], s20 offen
s_mov_b32 s21, 32768
buffer_load_dword v21, v1, s[12:15], s21 offen
s_waitcnt vmcnt(56)
v_perm_b32 v196, v23, v22, s46
v_perm_b32 v204, v23, v22, s47
s_mov_b32 s20, 65536
buffer_load_dword v22, v1, s[12:15], s20 offen
s_mov_b32 s21, 98304
buffer_load_dword v23, v1, s[12:15], s21 offen
s_waitcnt vmcnt(56)
v_perm_b32 v197, v25, v24, s46
v_perm_b32 v205, v25, v24, s47
s_mov_b32 s20, 8192
buffer_load_dword v24, v1, s[12:15], s20 offen
s_mov_b32 s21, 40960
buffer_load_dword v25, v1, s[12:15], s21 offen
s_waitcnt vmcnt(56)
v_perm_b32 v198, v27, v26, s46
v_perm_b32 v206, v27, v26, s47
s_mov_b32 s20, 73728
buffer_load_dword v26, v1, s[12:15], s20 offen
s_mov_b32 s21, 106496
buffer_load_dword v27, v1, s[12:15], s21 offen
s_waitcnt vmcnt(56)
v_perm_b32 v199, v29, v28, s46
v_perm_b32 v207, v29, v28, s47
s_mov_b32 s20, 262144
buffer_load_dword v28, v1, s[12:15], s20 offen
s_mov_b32 s21, 294912
buffer_load_dword v29, v1, s[12:15], s21 offen
s_waitcnt vmcnt(56)
v_perm_b32 v216, v31, v30, s46
v_perm_b32 v224, v31, v30, s47
s_mov_b32 s20, 327680
buffer_load_dword v30, v1, s[12:15], s20 offen
s_mov_b32 s21, 360448
buffer_load_dword v31, v1, s[12:15], s21 offen
s_waitcnt vmcnt(56)
v_perm_b32 v217, v33, v32, s46
v_perm_b32 v225, v33, v32, s47
s_mov_b32 s20, 270336
buffer_load_dword v32, v1, s[12:15], s20 offen
s_mov_b32 s21, 303104
buffer_load_dword v33, v1, s[12:15], s21 offen
s_waitcnt vmcnt(56)
v_perm_b32 v218, v35, v34, s46
v_perm_b32 v226, v35, v34, s47
s_mov_b32 s20, 335872
buffer_load_dword v34, v1, s[12:15], s20 offen
s_mov_b32 s21, 368640
buffer_load_dword v35, v1, s[12:15], s21 offen
s_waitcnt vmcnt(56)
v_perm_b32 v219, v37, v36, s46
v_perm_b32 v227, v37, v36, s47
s_mov_b32 s20, 524288
buffer_load_dword v36, v1, s[12:15], s20 offen
s_mov_b32 s21, 557056
buffer_load_dword v37, v1, s[12:15], s21 offen
s_waitcnt vmcnt(56)
v_perm_b32 v220, v39, v38, s46
v_perm_b32 v228, v39, v38, s47
s_mov_b32 s20, 589824
buffer_load_dword v38, v1, s[12:15], s20 offen
s_mov_b32 s21, 622592
buffer_load_dword v39, v1, s[12:15], s21 offen
s_waitcnt vmcnt(56)
v_perm_b32 v221, v41, v40, s46
v_perm_b32 v229, v41, v40, s47
s_mov_b32 s20, 532480
buffer_load_dword v40, v1, s[12:15], s20 offen
s_mov_b32 s21, 565248
buffer_load_dword v41, v1, s[12:15], s21 offen
s_waitcnt vmcnt(56)
v_perm_b32 v222, v43, v42, s46
v_perm_b32 v230, v43, v42, s47
s_mov_b32 s20, 598016
buffer_load_dword v42, v1, s[12:15], s20 offen
s_mov_b32 s21, 630784
buffer_load_dword v43, v1, s[12:15], s21 offen
s_waitcnt vmcnt(56)
v_perm_b32 v223, v45, v44, s46
v_perm_b32 v231, v45, v44, s47
s_mov_b32 s20, 786432
buffer_load_dword v44, v1, s[12:15], s20 offen
s_mov_b32 s21, 819200
buffer_load_dword v45, v1, s[12:15], s21 offen
s_waitcnt vmcnt(56)
v_perm_b32 v240, v47, v46, s46
v_perm_b32 v248, v47, v46, s47
s_mov_b32 s20, 851968
buffer_load_dword v46, v1, s[12:15], s20 offen
s_mov_b32 s21, 884736
buffer_load_dword v47, v1, s[12:15], s21 offen
s_waitcnt vmcnt(56)
v_perm_b32 v241, v49, v48, s46
v_perm_b32 v249, v49, v48, s47
s_mov_b32 s20, 794624
buffer_load_dword v48, v1, s[12:15], s20 offen
s_mov_b32 s21, 827392
buffer_load_dword v49, v1, s[12:15], s21 offen
s_waitcnt vmcnt(56)
v_perm_b32 v242, v51, v50, s46
v_perm_b32 v250, v51, v50, s47
s_mov_b32 s20, 860160
buffer_load_dword v50, v1, s[12:15], s20 offen
s_mov_b32 s21, 892928
buffer_load_dword v51, v1, s[12:15], s21 offen
s_waitcnt vmcnt(56)
v_perm_b32 v243, v53, v52, s46
v_perm_b32 v251, v53, v52, s47
s_mov_b32 s20, 1048576
buffer_load_dword v52, v1, s[12:15], s20 offen
s_mov_b32 s21, 1081344
buffer_load_dword v53, v1, s[12:15], s21 offen
s_waitcnt vmcnt(56)
v_perm_b32 v244, v55, v54, s46
v_perm_b32 v252, v55, v54, s47
s_mov_b32 s20, 1114112
buffer_load_dword v54, v1, s[12:15], s20 offen
s_mov_b32 s21, 1146880
buffer_load_dword v55, v1, s[12:15], s21 offen
s_waitcnt vmcnt(56)
v_perm_b32 v245, v57, v56, s46
v_perm_b32 v253, v57, v56, s47
s_mov_b32 s20, 1056768
buffer_load_dword v56, v1, s[12:15], s20 offen
s_mov_b32 s21, 1089536
buffer_load_dword v57, v1, s[12:15], s21 offen
s_waitcnt vmcnt(56)
v_perm_b32 v246, v59, v58, s46
v_perm_b32 v254, v59, v58, s47
s_mov_b32 s20, 1122304
buffer_load_dword v58, v1, s[12:15], s20 offen
s_mov_b32 s21, 1155072
buffer_load_dword v59, v1, s[12:15], s21 offen
s_waitcnt vmcnt(56)
v_perm_b32 v247, v61, v60, s46
v_perm_b32 v255, v61, v60, s47
s_mov_b32 s20, 1310720
buffer_load_dword v60, v1, s[12:15], s20 offen
s_mov_b32 s21, 1343488
buffer_load_dword v61, v1, s[12:15], s21 offen
s_waitcnt vmcnt(56)
v_perm_b32 v64, v63, v62, s46
v_accvgpr_write_b32 a8, v64
v_perm_b32 v68, v63, v62, s47
v_accvgpr_write_b32 a16, v68
s_mov_b32 s20, 1376256
buffer_load_dword v62, v1, s[12:15], s20 offen
s_mov_b32 s21, 1409024
buffer_load_dword v63, v1, s[12:15], s21 offen
s_waitcnt vmcnt(56)
v_perm_b32 v65, v7, v6, s46
v_accvgpr_write_b32 a9, v65
v_perm_b32 v69, v7, v6, s47
v_accvgpr_write_b32 a17, v69
s_mov_b32 s20, 1318912
buffer_load_dword v6, v1, s[12:15], s20 offen
s_mov_b32 s21, 1351680
buffer_load_dword v7, v1, s[12:15], s21 offen
s_waitcnt vmcnt(56)
v_perm_b32 v66, v9, v8, s46
v_accvgpr_write_b32 a10, v66
v_perm_b32 v70, v9, v8, s47
v_accvgpr_write_b32 a18, v70
s_mov_b32 s20, 1384448
buffer_load_dword v8, v1, s[12:15], s20 offen
s_mov_b32 s21, 1417216
buffer_load_dword v9, v1, s[12:15], s21 offen
s_waitcnt vmcnt(56)
v_perm_b32 v67, v11, v10, s46
v_accvgpr_write_b32 a11, v67
v_perm_b32 v71, v11, v10, s47
v_accvgpr_write_b32 a19, v71
s_mov_b32 s20, 1572864
buffer_load_dword v10, v1, s[12:15], s20 offen
s_mov_b32 s21, 1605632
buffer_load_dword v11, v1, s[12:15], s21 offen
s_waitcnt vmcnt(56)
v_perm_b32 v64, v13, v12, s46
v_accvgpr_write_b32 a12, v64
v_perm_b32 v68, v13, v12, s47
v_accvgpr_write_b32 a20, v68
s_mov_b32 s20, 1638400
buffer_load_dword v12, v1, s[12:15], s20 offen
s_mov_b32 s21, 1671168
buffer_load_dword v13, v1, s[12:15], s21 offen
s_waitcnt vmcnt(56)
v_perm_b32 v65, v15, v14, s46
v_accvgpr_write_b32 a13, v65
v_perm_b32 v69, v15, v14, s47
v_accvgpr_write_b32 a21, v69
s_mov_b32 s20, 1581056
buffer_load_dword v14, v1, s[12:15], s20 offen
s_mov_b32 s21, 1613824
buffer_load_dword v15, v1, s[12:15], s21 offen
s_waitcnt vmcnt(56)
v_perm_b32 v66, v17, v16, s46
v_accvgpr_write_b32 a14, v66
v_perm_b32 v70, v17, v16, s47
v_accvgpr_write_b32 a22, v70
s_mov_b32 s20, 1646592
buffer_load_dword v16, v1, s[12:15], s20 offen
s_mov_b32 s21, 1679360
buffer_load_dword v17, v1, s[12:15], s21 offen
s_waitcnt vmcnt(56)
v_perm_b32 v67, v19, v18, s46
v_accvgpr_write_b32 a15, v67
v_perm_b32 v71, v19, v18, s47
v_accvgpr_write_b32 a23, v71
s_mov_b32 s20, 1835008
buffer_load_dword v18, v1, s[12:15], s20 offen
s_mov_b32 s21, 1867776
buffer_load_dword v19, v1, s[12:15], s21 offen
s_waitcnt vmcnt(56)
v_perm_b32 v88, v21, v20, s46
v_perm_b32 v68, v21, v20, s47
s_mov_b32 s20, 1900544
buffer_load_dword v20, v1, s[12:15], s20 offen
s_mov_b32 s21, 1933312
buffer_load_dword v21, v1, s[12:15], s21 offen
s_waitcnt vmcnt(56)
v_perm_b32 v89, v23, v22, s46
v_perm_b32 v69, v23, v22, s47
s_mov_b32 s20, 1843200
buffer_load_dword v22, v1, s[12:15], s20 offen
s_mov_b32 s21, 1875968
buffer_load_dword v23, v1, s[12:15], s21 offen
s_waitcnt vmcnt(56)
v_perm_b32 v90, v25, v24, s46
v_perm_b32 v70, v25, v24, s47
s_mov_b32 s20, 1908736
buffer_load_dword v24, v1, s[12:15], s20 offen
s_mov_b32 s21, 1941504
buffer_load_dword v25, v1, s[12:15], s21 offen
s_waitcnt vmcnt(56)
v_perm_b32 v91, v27, v26, s46
v_perm_b32 v71, v27, v26, s47
ds_write_b128 v3, v[68:71] offset:0
s_waitcnt lgkmcnt(0)
s_mov_b32 s20, 2097152
buffer_load_dword v26, v1, s[12:15], s20 offen
s_mov_b32 s21, 2129920
buffer_load_dword v27, v1, s[12:15], s21 offen
s_waitcnt vmcnt(56)
v_perm_b32 v92, v29, v28, s46
v_perm_b32 v68, v29, v28, s47
s_mov_b32 s20, 2162688
buffer_load_dword v28, v1, s[12:15], s20 offen
s_mov_b32 s21, 2195456
buffer_load_dword v29, v1, s[12:15], s21 offen
s_waitcnt vmcnt(56)
v_perm_b32 v93, v31, v30, s46
v_perm_b32 v69, v31, v30, s47
s_mov_b32 s20, 2105344
buffer_load_dword v30, v1, s[12:15], s20 offen
s_mov_b32 s21, 2138112
buffer_load_dword v31, v1, s[12:15], s21 offen
s_waitcnt vmcnt(56)
v_perm_b32 v94, v33, v32, s46
v_perm_b32 v70, v33, v32, s47
s_mov_b32 s20, 2170880
buffer_load_dword v32, v1, s[12:15], s20 offen
s_mov_b32 s21, 2203648
buffer_load_dword v33, v1, s[12:15], s21 offen
s_waitcnt vmcnt(56)
v_perm_b32 v95, v35, v34, s46
v_perm_b32 v71, v35, v34, s47
ds_write_b128 v3, v[68:71] offset:1024
s_waitcnt lgkmcnt(0)
s_mov_b32 s20, 2359296
buffer_load_dword v34, v1, s[12:15], s20 offen
s_mov_b32 s21, 2392064
buffer_load_dword v35, v1, s[12:15], s21 offen
s_waitcnt vmcnt(56)
v_perm_b32 v112, v37, v36, s46
v_perm_b32 v68, v37, v36, s47
s_mov_b32 s20, 2424832
buffer_load_dword v36, v1, s[12:15], s20 offen
s_mov_b32 s21, 2457600
buffer_load_dword v37, v1, s[12:15], s21 offen
s_waitcnt vmcnt(56)
v_perm_b32 v113, v39, v38, s46
v_perm_b32 v69, v39, v38, s47
s_mov_b32 s20, 2367488
buffer_load_dword v38, v1, s[12:15], s20 offen
s_mov_b32 s21, 2400256
buffer_load_dword v39, v1, s[12:15], s21 offen
s_waitcnt vmcnt(56)
v_perm_b32 v114, v41, v40, s46
v_perm_b32 v70, v41, v40, s47
s_mov_b32 s20, 2433024
buffer_load_dword v40, v1, s[12:15], s20 offen
s_mov_b32 s21, 2465792
buffer_load_dword v41, v1, s[12:15], s21 offen
s_waitcnt vmcnt(56)
v_perm_b32 v115, v43, v42, s46
v_perm_b32 v71, v43, v42, s47
ds_write_b128 v3, v[68:71] offset:2048
s_waitcnt lgkmcnt(0)
s_mov_b32 s20, 2621440
buffer_load_dword v42, v1, s[12:15], s20 offen
s_mov_b32 s21, 2654208
buffer_load_dword v43, v1, s[12:15], s21 offen
s_waitcnt vmcnt(56)
v_perm_b32 v116, v45, v44, s46
v_perm_b32 v68, v45, v44, s47
s_mov_b32 s20, 2686976
buffer_load_dword v44, v1, s[12:15], s20 offen
s_mov_b32 s21, 2719744
buffer_load_dword v45, v1, s[12:15], s21 offen
s_waitcnt vmcnt(56)
v_perm_b32 v117, v47, v46, s46
v_perm_b32 v69, v47, v46, s47
s_mov_b32 s20, 2629632
buffer_load_dword v46, v1, s[12:15], s20 offen
s_mov_b32 s21, 2662400
buffer_load_dword v47, v1, s[12:15], s21 offen
s_waitcnt vmcnt(56)
v_perm_b32 v118, v49, v48, s46
v_perm_b32 v70, v49, v48, s47
s_mov_b32 s20, 2695168
buffer_load_dword v48, v1, s[12:15], s20 offen
s_mov_b32 s21, 2727936
buffer_load_dword v49, v1, s[12:15], s21 offen
s_waitcnt vmcnt(56)
v_perm_b32 v119, v51, v50, s46
v_perm_b32 v71, v51, v50, s47
ds_write_b128 v3, v[68:71] offset:3072
s_waitcnt lgkmcnt(0)
s_mov_b32 s20, 2883584
buffer_load_dword v50, v1, s[12:15], s20 offen
s_mov_b32 s21, 2916352
buffer_load_dword v51, v1, s[12:15], s21 offen
s_waitcnt vmcnt(56)
v_perm_b32 v136, v53, v52, s46
v_perm_b32 v68, v53, v52, s47
s_mov_b32 s20, 2949120
buffer_load_dword v52, v1, s[12:15], s20 offen
s_mov_b32 s21, 2981888
buffer_load_dword v53, v1, s[12:15], s21 offen
s_waitcnt vmcnt(56)
v_perm_b32 v137, v55, v54, s46
v_perm_b32 v69, v55, v54, s47
s_mov_b32 s20, 2891776
buffer_load_dword v54, v1, s[12:15], s20 offen
s_mov_b32 s21, 2924544
buffer_load_dword v55, v1, s[12:15], s21 offen
s_waitcnt vmcnt(56)
v_perm_b32 v138, v57, v56, s46
v_perm_b32 v70, v57, v56, s47
s_mov_b32 s20, 2957312
buffer_load_dword v56, v1, s[12:15], s20 offen
s_mov_b32 s21, 2990080
buffer_load_dword v57, v1, s[12:15], s21 offen
s_waitcnt vmcnt(56)
v_perm_b32 v139, v59, v58, s46
v_perm_b32 v71, v59, v58, s47
ds_write_b128 v3, v[68:71] offset:4096
s_waitcnt lgkmcnt(0)
s_mov_b32 s20, 3145728
buffer_load_dword v58, v1, s[12:15], s20 offen
s_mov_b32 s21, 3178496
buffer_load_dword v59, v1, s[12:15], s21 offen
s_waitcnt vmcnt(56)
v_perm_b32 v140, v61, v60, s46
v_perm_b32 v68, v61, v60, s47
s_mov_b32 s20, 3211264
buffer_load_dword v60, v1, s[12:15], s20 offen
s_mov_b32 s21, 3244032
buffer_load_dword v61, v1, s[12:15], s21 offen
s_waitcnt vmcnt(56)
v_perm_b32 v141, v63, v62, s46
v_perm_b32 v69, v63, v62, s47
s_mov_b32 s20, 3153920
buffer_load_dword v62, v1, s[12:15], s20 offen
s_mov_b32 s21, 3186688
buffer_load_dword v63, v1, s[12:15], s21 offen
s_waitcnt vmcnt(56)
v_perm_b32 v142, v7, v6, s46
v_perm_b32 v70, v7, v6, s47
s_mov_b32 s20, 3219456
buffer_load_dword v6, v1, s[12:15], s20 offen
s_mov_b32 s21, 3252224
buffer_load_dword v7, v1, s[12:15], s21 offen
s_waitcnt vmcnt(56)
v_perm_b32 v143, v9, v8, s46
v_perm_b32 v71, v9, v8, s47
ds_write_b128 v3, v[68:71] offset:5120
s_waitcnt lgkmcnt(0)
s_mov_b32 s20, 3407872
buffer_load_dword v8, v1, s[12:15], s20 offen
s_mov_b32 s21, 3440640
buffer_load_dword v9, v1, s[12:15], s21 offen
s_waitcnt vmcnt(56)
v_perm_b32 v160, v11, v10, s46
v_perm_b32 v68, v11, v10, s47
s_mov_b32 s20, 3473408
buffer_load_dword v10, v1, s[12:15], s20 offen
s_mov_b32 s21, 3506176
buffer_load_dword v11, v1, s[12:15], s21 offen
s_waitcnt vmcnt(56)
v_perm_b32 v161, v13, v12, s46
v_perm_b32 v69, v13, v12, s47
s_mov_b32 s20, 3416064
buffer_load_dword v12, v1, s[12:15], s20 offen
s_mov_b32 s21, 3448832
buffer_load_dword v13, v1, s[12:15], s21 offen
s_waitcnt vmcnt(56)
v_perm_b32 v162, v15, v14, s46
v_perm_b32 v70, v15, v14, s47
s_mov_b32 s20, 3481600
buffer_load_dword v14, v1, s[12:15], s20 offen
s_mov_b32 s21, 3514368
buffer_load_dword v15, v1, s[12:15], s21 offen
s_waitcnt vmcnt(56)
v_perm_b32 v163, v17, v16, s46
v_perm_b32 v71, v17, v16, s47
ds_write_b128 v3, v[68:71] offset:6144
s_waitcnt lgkmcnt(0)
s_mov_b32 s20, 3670016
buffer_load_dword v16, v1, s[12:15], s20 offen
s_mov_b32 s21, 3702784
buffer_load_dword v17, v1, s[12:15], s21 offen
s_waitcnt vmcnt(56)
v_perm_b32 v164, v19, v18, s46
v_perm_b32 v68, v19, v18, s47
s_mov_b32 s20, 3735552
buffer_load_dword v18, v1, s[12:15], s20 offen
s_mov_b32 s21, 3768320
buffer_load_dword v19, v1, s[12:15], s21 offen
s_waitcnt vmcnt(56)
v_perm_b32 v165, v21, v20, s46
v_perm_b32 v69, v21, v20, s47
s_mov_b32 s20, 3678208
buffer_load_dword v20, v1, s[12:15], s20 offen
s_mov_b32 s21, 3710976
buffer_load_dword v21, v1, s[12:15], s21 offen
s_waitcnt vmcnt(56)
v_perm_b32 v166, v23, v22, s46
v_perm_b32 v70, v23, v22, s47
s_mov_b32 s20, 3743744
buffer_load_dword v22, v1, s[12:15], s20 offen
s_mov_b32 s21, 3776512
buffer_load_dword v23, v1, s[12:15], s21 offen
s_waitcnt vmcnt(56)
v_perm_b32 v167, v25, v24, s46
v_perm_b32 v71, v25, v24, s47
ds_write_b128 v3, v[68:71] offset:7168
s_waitcnt lgkmcnt(0)
s_mov_b32 s20, 3932160
buffer_load_dword v24, v1, s[12:15], s20 offen
s_mov_b32 s21, 3964928
buffer_load_dword v25, v1, s[12:15], s21 offen
s_waitcnt vmcnt(56)
v_perm_b32 v184, v27, v26, s46
v_perm_b32 v68, v27, v26, s47
s_mov_b32 s20, 3997696
buffer_load_dword v26, v1, s[12:15], s20 offen
s_mov_b32 s21, 4030464
buffer_load_dword v27, v1, s[12:15], s21 offen
s_waitcnt vmcnt(56)
v_perm_b32 v185, v29, v28, s46
v_perm_b32 v69, v29, v28, s47
s_mov_b32 s20, 3940352
buffer_load_dword v28, v1, s[12:15], s20 offen
s_mov_b32 s21, 3973120
buffer_load_dword v29, v1, s[12:15], s21 offen
s_waitcnt vmcnt(56)
v_perm_b32 v186, v31, v30, s46
v_perm_b32 v70, v31, v30, s47
s_mov_b32 s20, 4005888
buffer_load_dword v30, v1, s[12:15], s20 offen
s_mov_b32 s21, 4038656
buffer_load_dword v31, v1, s[12:15], s21 offen
s_waitcnt vmcnt(56)
v_perm_b32 v187, v33, v32, s46
v_perm_b32 v71, v33, v32, s47
ds_write_b128 v3, v[68:71] offset:8192
s_waitcnt lgkmcnt(0)
s_mov_b32 s20, 4194304
buffer_load_dword v32, v1, s[12:15], s20 offen
s_mov_b32 s21, 4227072
buffer_load_dword v33, v1, s[12:15], s21 offen
s_waitcnt vmcnt(56)
v_perm_b32 v188, v35, v34, s46
v_perm_b32 v68, v35, v34, s47
s_mov_b32 s20, 4259840
buffer_load_dword v34, v1, s[12:15], s20 offen
s_mov_b32 s21, 4292608
buffer_load_dword v35, v1, s[12:15], s21 offen
s_waitcnt vmcnt(56)
v_perm_b32 v189, v37, v36, s46
v_perm_b32 v69, v37, v36, s47
s_mov_b32 s20, 4202496
buffer_load_dword v36, v1, s[12:15], s20 offen
s_mov_b32 s21, 4235264
buffer_load_dword v37, v1, s[12:15], s21 offen
s_waitcnt vmcnt(56)
v_perm_b32 v190, v39, v38, s46
v_perm_b32 v70, v39, v38, s47
s_mov_b32 s20, 4268032
buffer_load_dword v38, v1, s[12:15], s20 offen
s_mov_b32 s21, 4300800
buffer_load_dword v39, v1, s[12:15], s21 offen
s_waitcnt vmcnt(56)
v_perm_b32 v191, v41, v40, s46
v_perm_b32 v71, v41, v40, s47
ds_write_b128 v3, v[68:71] offset:9216
s_waitcnt lgkmcnt(0)
s_mov_b32 s20, 4456448
buffer_load_dword v40, v1, s[12:15], s20 offen
s_mov_b32 s21, 4489216
buffer_load_dword v41, v1, s[12:15], s21 offen
s_waitcnt vmcnt(56)
v_perm_b32 v208, v43, v42, s46
v_perm_b32 v68, v43, v42, s47
s_mov_b32 s20, 4521984
buffer_load_dword v42, v1, s[12:15], s20 offen
s_mov_b32 s21, 4554752
buffer_load_dword v43, v1, s[12:15], s21 offen
s_waitcnt vmcnt(56)
v_perm_b32 v209, v45, v44, s46
v_perm_b32 v69, v45, v44, s47
s_mov_b32 s20, 4464640
buffer_load_dword v44, v1, s[12:15], s20 offen
s_mov_b32 s21, 4497408
buffer_load_dword v45, v1, s[12:15], s21 offen
s_waitcnt vmcnt(56)
v_perm_b32 v210, v47, v46, s46
v_perm_b32 v70, v47, v46, s47
s_mov_b32 s20, 4530176
buffer_load_dword v46, v1, s[12:15], s20 offen
s_mov_b32 s21, 4562944
buffer_load_dword v47, v1, s[12:15], s21 offen
s_waitcnt vmcnt(56)
v_perm_b32 v211, v49, v48, s46
v_perm_b32 v71, v49, v48, s47
ds_write_b128 v3, v[68:71] offset:10240
s_waitcnt lgkmcnt(0)
s_load_dwordx2 s[50:51], s[0:1], 80
s_waitcnt lgkmcnt(0)
s_mov_b32 s12, s50
s_and_b32 s13, s51, 0xffff
s_mov_b32 s14, 4718592
s_mov_b32 s15, 0x20000
s_mov_b32 s20, 0
buffer_load_dword v48, v1, s[12:15], s20 offen
s_mov_b32 s21, 32768
buffer_load_dword v49, v1, s[12:15], s21 offen
s_waitcnt vmcnt(56)
v_perm_b32 v212, v51, v50, s46
v_perm_b32 v68, v51, v50, s47
s_mov_b32 s20, 65536
buffer_load_dword v50, v1, s[12:15], s20 offen
s_mov_b32 s21, 98304
buffer_load_dword v51, v1, s[12:15], s21 offen
s_waitcnt vmcnt(56)
v_perm_b32 v213, v53, v52, s46
v_perm_b32 v69, v53, v52, s47
s_mov_b32 s20, 8192
buffer_load_dword v52, v1, s[12:15], s20 offen
s_mov_b32 s21, 40960
buffer_load_dword v53, v1, s[12:15], s21 offen
s_waitcnt vmcnt(56)
v_perm_b32 v214, v55, v54, s46
v_perm_b32 v70, v55, v54, s47
s_mov_b32 s20, 73728
buffer_load_dword v54, v1, s[12:15], s20 offen
s_mov_b32 s21, 106496
buffer_load_dword v55, v1, s[12:15], s21 offen
s_waitcnt vmcnt(56)
v_perm_b32 v215, v57, v56, s46
v_perm_b32 v71, v57, v56, s47
ds_write_b128 v3, v[68:71] offset:11264
s_waitcnt lgkmcnt(0)
s_mov_b32 s20, 262144
buffer_load_dword v56, v1, s[12:15], s20 offen
s_mov_b32 s21, 294912
buffer_load_dword v57, v1, s[12:15], s21 offen
s_waitcnt vmcnt(56)
v_perm_b32 v232, v59, v58, s46
v_perm_b32 v68, v59, v58, s47
s_mov_b32 s20, 327680
buffer_load_dword v58, v1, s[12:15], s20 offen
s_mov_b32 s21, 360448
buffer_load_dword v59, v1, s[12:15], s21 offen
s_waitcnt vmcnt(56)
v_perm_b32 v233, v61, v60, s46
v_perm_b32 v69, v61, v60, s47
s_mov_b32 s20, 270336
buffer_load_dword v60, v1, s[12:15], s20 offen
s_mov_b32 s21, 303104
buffer_load_dword v61, v1, s[12:15], s21 offen
s_waitcnt vmcnt(56)
v_perm_b32 v234, v63, v62, s46
v_perm_b32 v70, v63, v62, s47
s_mov_b32 s20, 335872
buffer_load_dword v62, v1, s[12:15], s20 offen
s_mov_b32 s21, 368640
buffer_load_dword v63, v1, s[12:15], s21 offen
s_waitcnt vmcnt(56)
v_perm_b32 v235, v7, v6, s46
v_perm_b32 v71, v7, v6, s47
ds_write_b128 v3, v[68:71] offset:12288
s_waitcnt lgkmcnt(0)
s_mov_b32 s20, 524288
buffer_load_dword v6, v1, s[12:15], s20 offen
s_mov_b32 s21, 557056
buffer_load_dword v7, v1, s[12:15], s21 offen
s_waitcnt vmcnt(56)
v_perm_b32 v236, v9, v8, s46
v_perm_b32 v68, v9, v8, s47
s_mov_b32 s20, 589824
buffer_load_dword v8, v1, s[12:15], s20 offen
s_mov_b32 s21, 622592
buffer_load_dword v9, v1, s[12:15], s21 offen
s_waitcnt vmcnt(56)
v_perm_b32 v237, v11, v10, s46
v_perm_b32 v69, v11, v10, s47
s_mov_b32 s20, 532480
buffer_load_dword v10, v1, s[12:15], s20 offen
s_mov_b32 s21, 565248
buffer_load_dword v11, v1, s[12:15], s21 offen
s_waitcnt vmcnt(56)
v_perm_b32 v238, v13, v12, s46
v_perm_b32 v70, v13, v12, s47
s_mov_b32 s20, 598016
buffer_load_dword v12, v1, s[12:15], s20 offen
s_mov_b32 s21, 630784
buffer_load_dword v13, v1, s[12:15], s21 offen
s_waitcnt vmcnt(56)
v_perm_b32 v239, v15, v14, s46
v_perm_b32 v71, v15, v14, s47
ds_write_b128 v3, v[68:71] offset:13312
s_waitcnt lgkmcnt(0)
s_mov_b32 s20, 786432
buffer_load_dword v14, v1, s[12:15], s20 offen
s_mov_b32 s21, 819200
buffer_load_dword v15, v1, s[12:15], s21 offen
s_waitcnt vmcnt(56)
v_perm_b32 v64, v17, v16, s46
v_accvgpr_write_b32 a0, v64
v_perm_b32 v68, v17, v16, s47
s_mov_b32 s20, 851968
buffer_load_dword v16, v1, s[12:15], s20 offen
s_mov_b32 s21, 884736
buffer_load_dword v17, v1, s[12:15], s21 offen
s_waitcnt vmcnt(56)
v_perm_b32 v65, v19, v18, s46
v_accvgpr_write_b32 a1, v65
v_perm_b32 v69, v19, v18, s47
s_mov_b32 s20, 794624
buffer_load_dword v18, v1, s[12:15], s20 offen
s_mov_b32 s21, 827392
buffer_load_dword v19, v1, s[12:15], s21 offen
s_waitcnt vmcnt(56)
v_perm_b32 v66, v21, v20, s46
v_accvgpr_write_b32 a2, v66
v_perm_b32 v70, v21, v20, s47
s_mov_b32 s20, 860160
buffer_load_dword v20, v1, s[12:15], s20 offen
s_mov_b32 s21, 892928
buffer_load_dword v21, v1, s[12:15], s21 offen
s_waitcnt vmcnt(56)
v_perm_b32 v67, v23, v22, s46
v_accvgpr_write_b32 a3, v67
v_perm_b32 v71, v23, v22, s47
ds_write_b128 v3, v[68:71] offset:14336
s_waitcnt lgkmcnt(0)
s_mov_b32 s20, 1048576
buffer_load_dword v22, v1, s[12:15], s20 offen
s_mov_b32 s21, 1081344
buffer_load_dword v23, v1, s[12:15], s21 offen
s_waitcnt vmcnt(56)
v_perm_b32 v64, v25, v24, s46
v_accvgpr_write_b32 a4, v64
v_perm_b32 v68, v25, v24, s47
s_mov_b32 s20, 1114112
buffer_load_dword v24, v1, s[12:15], s20 offen
s_mov_b32 s21, 1146880
buffer_load_dword v25, v1, s[12:15], s21 offen
s_waitcnt vmcnt(56)
v_perm_b32 v65, v27, v26, s46
v_accvgpr_write_b32 a5, v65
v_perm_b32 v69, v27, v26, s47
s_mov_b32 s20, 1056768
buffer_load_dword v26, v1, s[12:15], s20 offen
s_mov_b32 s21, 1089536
buffer_load_dword v27, v1, s[12:15], s21 offen
s_waitcnt vmcnt(56)
v_perm_b32 v66, v29, v28, s46
v_accvgpr_write_b32 a6, v66
v_perm_b32 v70, v29, v28, s47
s_mov_b32 s20, 1122304
buffer_load_dword v28, v1, s[12:15], s20 offen
s_mov_b32 s21, 1155072
buffer_load_dword v29, v1, s[12:15], s21 offen
s_waitcnt vmcnt(56)
v_perm_b32 v67, v31, v30, s46
v_accvgpr_write_b32 a7, v67
v_perm_b32 v71, v31, v30, s47
ds_write_b128 v3, v[68:71] offset:15360
s_waitcnt lgkmcnt(0)
s_mov_b32 s20, 1310720
buffer_load_dword v30, v1, s[12:15], s20 offen
s_mov_b32 s21, 1343488
buffer_load_dword v31, v1, s[12:15], s21 offen
s_waitcnt vmcnt(56)
v_perm_b32 v64, v33, v32, s46
v_accvgpr_write_b32 a24, v64
v_perm_b32 v68, v33, v32, s47
s_mov_b32 s20, 1376256
buffer_load_dword v32, v1, s[12:15], s20 offen
s_mov_b32 s21, 1409024
buffer_load_dword v33, v1, s[12:15], s21 offen
s_waitcnt vmcnt(56)
v_perm_b32 v65, v35, v34, s46
v_accvgpr_write_b32 a25, v65
v_perm_b32 v69, v35, v34, s47
s_mov_b32 s20, 1318912
buffer_load_dword v34, v1, s[12:15], s20 offen
s_mov_b32 s21, 1351680
buffer_load_dword v35, v1, s[12:15], s21 offen
s_waitcnt vmcnt(56)
v_perm_b32 v66, v37, v36, s46
v_accvgpr_write_b32 a26, v66
v_perm_b32 v70, v37, v36, s47
s_mov_b32 s20, 1384448
buffer_load_dword v36, v1, s[12:15], s20 offen
s_mov_b32 s21, 1417216
buffer_load_dword v37, v1, s[12:15], s21 offen
s_waitcnt vmcnt(56)
v_perm_b32 v67, v39, v38, s46
v_accvgpr_write_b32 a27, v67
v_perm_b32 v71, v39, v38, s47
ds_write_b128 v3, v[68:71] offset:16384
s_waitcnt lgkmcnt(0)
s_mov_b32 s20, 1572864
buffer_load_dword v38, v1, s[12:15], s20 offen
s_mov_b32 s21, 1605632
buffer_load_dword v39, v1, s[12:15], s21 offen
s_waitcnt vmcnt(56)
v_perm_b32 v64, v41, v40, s46
v_accvgpr_write_b32 a28, v64
v_perm_b32 v68, v41, v40, s47
s_mov_b32 s20, 1638400
buffer_load_dword v40, v1, s[12:15], s20 offen
s_mov_b32 s21, 1671168
buffer_load_dword v41, v1, s[12:15], s21 offen
s_waitcnt vmcnt(56)
v_perm_b32 v65, v43, v42, s46
v_accvgpr_write_b32 a29, v65
v_perm_b32 v69, v43, v42, s47
s_mov_b32 s20, 1581056
buffer_load_dword v42, v1, s[12:15], s20 offen
s_mov_b32 s21, 1613824
buffer_load_dword v43, v1, s[12:15], s21 offen
s_waitcnt vmcnt(56)
v_perm_b32 v66, v45, v44, s46
v_accvgpr_write_b32 a30, v66
v_perm_b32 v70, v45, v44, s47
s_mov_b32 s20, 1646592
buffer_load_dword v44, v1, s[12:15], s20 offen
s_mov_b32 s21, 1679360
buffer_load_dword v45, v1, s[12:15], s21 offen
s_waitcnt vmcnt(56)
v_perm_b32 v67, v47, v46, s46
v_accvgpr_write_b32 a31, v67
v_perm_b32 v71, v47, v46, s47
ds_write_b128 v3, v[68:71] offset:17408
s_waitcnt lgkmcnt(0)
s_mov_b32 s20, 1835008
buffer_load_dword v46, v1, s[12:15], s20 offen
s_mov_b32 s21, 1867776
buffer_load_dword v47, v1, s[12:15], s21 offen
s_waitcnt vmcnt(56)
v_perm_b32 v64, v49, v48, s46
v_accvgpr_write_b32 a32, v64
v_perm_b32 v68, v49, v48, s47
v_accvgpr_write_b32 a40, v68
s_mov_b32 s20, 1900544
buffer_load_dword v48, v1, s[12:15], s20 offen
s_mov_b32 s21, 1933312
buffer_load_dword v49, v1, s[12:15], s21 offen
s_waitcnt vmcnt(56)
v_perm_b32 v65, v51, v50, s46
v_accvgpr_write_b32 a33, v65
v_perm_b32 v69, v51, v50, s47
v_accvgpr_write_b32 a41, v69
s_mov_b32 s20, 1843200
buffer_load_dword v50, v1, s[12:15], s20 offen
s_mov_b32 s21, 1875968
buffer_load_dword v51, v1, s[12:15], s21 offen
s_waitcnt vmcnt(56)
v_perm_b32 v66, v53, v52, s46
v_accvgpr_write_b32 a34, v66
v_perm_b32 v70, v53, v52, s47
v_accvgpr_write_b32 a42, v70
s_mov_b32 s20, 1908736
buffer_load_dword v52, v1, s[12:15], s20 offen
s_mov_b32 s21, 1941504
buffer_load_dword v53, v1, s[12:15], s21 offen
s_waitcnt vmcnt(56)
v_perm_b32 v67, v55, v54, s46
v_accvgpr_write_b32 a35, v67
v_perm_b32 v71, v55, v54, s47
v_accvgpr_write_b32 a43, v71
s_mov_b32 s20, 2097152
buffer_load_dword v54, v1, s[12:15], s20 offen
s_mov_b32 s21, 2129920
buffer_load_dword v55, v1, s[12:15], s21 offen
s_waitcnt vmcnt(56)
v_perm_b32 v64, v57, v56, s46
v_accvgpr_write_b32 a36, v64
v_perm_b32 v68, v57, v56, s47
v_accvgpr_write_b32 a44, v68
s_mov_b32 s20, 2162688
buffer_load_dword v56, v1, s[12:15], s20 offen
s_mov_b32 s21, 2195456
buffer_load_dword v57, v1, s[12:15], s21 offen
s_waitcnt vmcnt(56)
v_perm_b32 v65, v59, v58, s46
v_accvgpr_write_b32 a37, v65
v_perm_b32 v69, v59, v58, s47
v_accvgpr_write_b32 a45, v69
s_mov_b32 s20, 2105344
buffer_load_dword v58, v1, s[12:15], s20 offen
s_mov_b32 s21, 2138112
buffer_load_dword v59, v1, s[12:15], s21 offen
s_waitcnt vmcnt(56)
v_perm_b32 v66, v61, v60, s46
v_accvgpr_write_b32 a38, v66
v_perm_b32 v70, v61, v60, s47
v_accvgpr_write_b32 a46, v70
s_mov_b32 s20, 2170880
buffer_load_dword v60, v1, s[12:15], s20 offen
s_mov_b32 s21, 2203648
buffer_load_dword v61, v1, s[12:15], s21 offen
s_waitcnt vmcnt(56)
v_perm_b32 v67, v63, v62, s46
v_accvgpr_write_b32 a39, v67
v_perm_b32 v71, v63, v62, s47
v_accvgpr_write_b32 a47, v71
s_mov_b32 s20, 2359296
buffer_load_dword v62, v1, s[12:15], s20 offen
s_mov_b32 s21, 2392064
buffer_load_dword v63, v1, s[12:15], s21 offen
s_waitcnt vmcnt(56)
v_perm_b32 v64, v7, v6, s46
v_accvgpr_write_b32 a48, v64
v_perm_b32 v68, v7, v6, s47
v_accvgpr_write_b32 a56, v68
s_mov_b32 s20, 2424832
buffer_load_dword v6, v1, s[12:15], s20 offen
s_mov_b32 s21, 2457600
buffer_load_dword v7, v1, s[12:15], s21 offen
s_waitcnt vmcnt(56)
v_perm_b32 v65, v9, v8, s46
v_accvgpr_write_b32 a49, v65
v_perm_b32 v69, v9, v8, s47
v_accvgpr_write_b32 a57, v69
s_mov_b32 s20, 2367488
buffer_load_dword v8, v1, s[12:15], s20 offen
s_mov_b32 s21, 2400256
buffer_load_dword v9, v1, s[12:15], s21 offen
s_waitcnt vmcnt(56)
v_perm_b32 v66, v11, v10, s46
v_accvgpr_write_b32 a50, v66
v_perm_b32 v70, v11, v10, s47
v_accvgpr_write_b32 a58, v70
s_mov_b32 s20, 2433024
buffer_load_dword v10, v1, s[12:15], s20 offen
s_mov_b32 s21, 2465792
buffer_load_dword v11, v1, s[12:15], s21 offen
s_waitcnt vmcnt(56)
v_perm_b32 v67, v13, v12, s46
v_accvgpr_write_b32 a51, v67
v_perm_b32 v71, v13, v12, s47
v_accvgpr_write_b32 a59, v71
s_mov_b32 s20, 2621440
buffer_load_dword v12, v1, s[12:15], s20 offen
s_mov_b32 s21, 2654208
buffer_load_dword v13, v1, s[12:15], s21 offen
s_waitcnt vmcnt(56)
v_perm_b32 v64, v15, v14, s46
v_accvgpr_write_b32 a52, v64
v_perm_b32 v68, v15, v14, s47
v_accvgpr_write_b32 a60, v68
s_mov_b32 s20, 2686976
buffer_load_dword v14, v1, s[12:15], s20 offen
s_mov_b32 s21, 2719744
buffer_load_dword v15, v1, s[12:15], s21 offen
s_waitcnt vmcnt(56)
v_perm_b32 v65, v17, v16, s46
v_accvgpr_write_b32 a53, v65
v_perm_b32 v69, v17, v16, s47
v_accvgpr_write_b32 a61, v69
s_mov_b32 s20, 2629632
buffer_load_dword v16, v1, s[12:15], s20 offen
s_mov_b32 s21, 2662400
buffer_load_dword v17, v1, s[12:15], s21 offen
s_waitcnt vmcnt(56)
v_perm_b32 v66, v19, v18, s46
v_accvgpr_write_b32 a54, v66
v_perm_b32 v70, v19, v18, s47
v_accvgpr_write_b32 a62, v70
s_mov_b32 s20, 2695168
buffer_load_dword v18, v1, s[12:15], s20 offen
s_mov_b32 s21, 2727936
buffer_load_dword v19, v1, s[12:15], s21 offen
s_waitcnt vmcnt(56)
v_perm_b32 v67, v21, v20, s46
v_accvgpr_write_b32 a55, v67
v_perm_b32 v71, v21, v20, s47
v_accvgpr_write_b32 a63, v71
s_mov_b32 s20, 2883584
buffer_load_dword v20, v1, s[12:15], s20 offen
s_mov_b32 s21, 2916352
buffer_load_dword v21, v1, s[12:15], s21 offen
s_waitcnt vmcnt(56)
v_perm_b32 v64, v23, v22, s46
v_accvgpr_write_b32 a64, v64
v_perm_b32 v68, v23, v22, s47
v_accvgpr_write_b32 a72, v68
s_mov_b32 s20, 2949120
buffer_load_dword v22, v1, s[12:15], s20 offen
s_mov_b32 s21, 2981888
buffer_load_dword v23, v1, s[12:15], s21 offen
s_waitcnt vmcnt(56)
v_perm_b32 v65, v25, v24, s46
v_accvgpr_write_b32 a65, v65
v_perm_b32 v69, v25, v24, s47
v_accvgpr_write_b32 a73, v69
s_mov_b32 s20, 2891776
buffer_load_dword v24, v1, s[12:15], s20 offen
s_mov_b32 s21, 2924544
buffer_load_dword v25, v1, s[12:15], s21 offen
s_waitcnt vmcnt(56)
v_perm_b32 v66, v27, v26, s46
v_accvgpr_write_b32 a66, v66
v_perm_b32 v70, v27, v26, s47
v_accvgpr_write_b32 a74, v70
s_mov_b32 s20, 2957312
buffer_load_dword v26, v1, s[12:15], s20 offen
s_mov_b32 s21, 2990080
buffer_load_dword v27, v1, s[12:15], s21 offen
s_waitcnt vmcnt(56)
v_perm_b32 v67, v29, v28, s46
v_accvgpr_write_b32 a67, v67
v_perm_b32 v71, v29, v28, s47
v_accvgpr_write_b32 a75, v71
s_mov_b32 s20, 3145728
buffer_load_dword v28, v1, s[12:15], s20 offen
s_mov_b32 s21, 3178496
buffer_load_dword v29, v1, s[12:15], s21 offen
s_waitcnt vmcnt(56)
v_perm_b32 v64, v31, v30, s46
v_accvgpr_write_b32 a68, v64
v_perm_b32 v68, v31, v30, s47
v_accvgpr_write_b32 a76, v68
s_mov_b32 s20, 3211264
buffer_load_dword v30, v1, s[12:15], s20 offen
s_mov_b32 s21, 3244032
buffer_load_dword v31, v1, s[12:15], s21 offen
s_waitcnt vmcnt(56)
v_perm_b32 v65, v33, v32, s46
v_accvgpr_write_b32 a69, v65
v_perm_b32 v69, v33, v32, s47
v_accvgpr_write_b32 a77, v69
s_mov_b32 s20, 3153920
buffer_load_dword v32, v1, s[12:15], s20 offen
s_mov_b32 s21, 3186688
buffer_load_dword v33, v1, s[12:15], s21 offen
s_waitcnt vmcnt(56)
v_perm_b32 v66, v35, v34, s46
v_accvgpr_write_b32 a70, v66
v_perm_b32 v70, v35, v34, s47
v_accvgpr_write_b32 a78, v70
s_mov_b32 s20, 3219456
buffer_load_dword v34, v1, s[12:15], s20 offen
s_mov_b32 s21, 3252224
buffer_load_dword v35, v1, s[12:15], s21 offen
s_waitcnt vmcnt(56)
v_perm_b32 v67, v37, v36, s46
v_accvgpr_write_b32 a71, v67
v_perm_b32 v71, v37, v36, s47
v_accvgpr_write_b32 a79, v71
s_mov_b32 s20, 3407872
buffer_load_dword v36, v1, s[12:15], s20 offen
s_mov_b32 s21, 3440640
buffer_load_dword v37, v1, s[12:15], s21 offen
s_waitcnt vmcnt(56)
v_perm_b32 v64, v39, v38, s46
v_accvgpr_write_b32 a80, v64
v_perm_b32 v68, v39, v38, s47
v_accvgpr_write_b32 a88, v68
s_mov_b32 s20, 3473408
buffer_load_dword v38, v1, s[12:15], s20 offen
s_mov_b32 s21, 3506176
buffer_load_dword v39, v1, s[12:15], s21 offen
s_waitcnt vmcnt(56)
v_perm_b32 v65, v41, v40, s46
v_accvgpr_write_b32 a81, v65
v_perm_b32 v69, v41, v40, s47
v_accvgpr_write_b32 a89, v69
s_mov_b32 s20, 3416064
buffer_load_dword v40, v1, s[12:15], s20 offen
s_mov_b32 s21, 3448832
buffer_load_dword v41, v1, s[12:15], s21 offen
s_waitcnt vmcnt(56)
v_perm_b32 v66, v43, v42, s46
v_accvgpr_write_b32 a82, v66
v_perm_b32 v70, v43, v42, s47
v_accvgpr_write_b32 a90, v70
s_mov_b32 s20, 3481600
buffer_load_dword v42, v1, s[12:15], s20 offen
s_mov_b32 s21, 3514368
buffer_load_dword v43, v1, s[12:15], s21 offen
s_waitcnt vmcnt(56)
v_perm_b32 v67, v45, v44, s46
v_accvgpr_write_b32 a83, v67
v_perm_b32 v71, v45, v44, s47
v_accvgpr_write_b32 a91, v71
s_mov_b32 s20, 3670016
buffer_load_dword v44, v1, s[12:15], s20 offen
s_mov_b32 s21, 3702784
buffer_load_dword v45, v1, s[12:15], s21 offen
s_waitcnt vmcnt(56)
v_perm_b32 v64, v47, v46, s46
v_accvgpr_write_b32 a84, v64
v_perm_b32 v68, v47, v46, s47
v_accvgpr_write_b32 a92, v68
s_mov_b32 s20, 3735552
buffer_load_dword v46, v1, s[12:15], s20 offen
s_mov_b32 s21, 3768320
buffer_load_dword v47, v1, s[12:15], s21 offen
s_waitcnt vmcnt(56)
v_perm_b32 v65, v49, v48, s46
v_accvgpr_write_b32 a85, v65
v_perm_b32 v69, v49, v48, s47
v_accvgpr_write_b32 a93, v69
s_mov_b32 s20, 3678208
buffer_load_dword v48, v1, s[12:15], s20 offen
s_mov_b32 s21, 3710976
buffer_load_dword v49, v1, s[12:15], s21 offen
s_waitcnt vmcnt(56)
v_perm_b32 v66, v51, v50, s46
v_accvgpr_write_b32 a86, v66
v_perm_b32 v70, v51, v50, s47
v_accvgpr_write_b32 a94, v70
s_mov_b32 s20, 3743744
buffer_load_dword v50, v1, s[12:15], s20 offen
s_mov_b32 s21, 3776512
buffer_load_dword v51, v1, s[12:15], s21 offen
s_waitcnt vmcnt(56)
v_perm_b32 v67, v53, v52, s46
v_accvgpr_write_b32 a87, v67
v_perm_b32 v71, v53, v52, s47
v_accvgpr_write_b32 a95, v71
s_mov_b32 s20, 3932160
buffer_load_dword v52, v1, s[12:15], s20 offen
s_mov_b32 s21, 3964928
buffer_load_dword v53, v1, s[12:15], s21 offen
s_waitcnt vmcnt(56)
v_perm_b32 v64, v55, v54, s46
v_accvgpr_write_b32 a96, v64
v_perm_b32 v68, v55, v54, s47
v_accvgpr_write_b32 a104, v68
s_mov_b32 s20, 3997696
buffer_load_dword v54, v1, s[12:15], s20 offen
s_mov_b32 s21, 4030464
buffer_load_dword v55, v1, s[12:15], s21 offen
s_waitcnt vmcnt(56)
v_perm_b32 v65, v57, v56, s46
v_accvgpr_write_b32 a97, v65
v_perm_b32 v69, v57, v56, s47
v_accvgpr_write_b32 a105, v69
s_mov_b32 s20, 3940352
buffer_load_dword v56, v1, s[12:15], s20 offen
s_mov_b32 s21, 3973120
buffer_load_dword v57, v1, s[12:15], s21 offen
s_waitcnt vmcnt(56)
v_perm_b32 v66, v59, v58, s46
v_accvgpr_write_b32 a98, v66
v_perm_b32 v70, v59, v58, s47
v_accvgpr_write_b32 a106, v70
s_mov_b32 s20, 4005888
buffer_load_dword v58, v1, s[12:15], s20 offen
s_mov_b32 s21, 4038656
buffer_load_dword v59, v1, s[12:15], s21 offen
s_waitcnt vmcnt(56)
v_perm_b32 v67, v61, v60, s46
v_accvgpr_write_b32 a99, v67
v_perm_b32 v71, v61, v60, s47
v_accvgpr_write_b32 a107, v71
s_mov_b32 s20, 4194304
buffer_load_dword v60, v1, s[12:15], s20 offen
s_mov_b32 s21, 4227072
buffer_load_dword v61, v1, s[12:15], s21 offen
s_waitcnt vmcnt(56)
v_perm_b32 v64, v63, v62, s46
v_accvgpr_write_b32 a100, v64
v_perm_b32 v68, v63, v62, s47
v_accvgpr_write_b32 a108, v68
s_mov_b32 s20, 4259840
buffer_load_dword v62, v1, s[12:15], s20 offen
s_mov_b32 s21, 4292608
buffer_load_dword v63, v1, s[12:15], s21 offen
s_waitcnt vmcnt(56)
v_perm_b32 v65, v7, v6, s46
v_accvgpr_write_b32 a101, v65
v_perm_b32 v69, v7, v6, s47
v_accvgpr_write_b32 a109, v69
s_mov_b32 s20, 4202496
buffer_load_dword v6, v1, s[12:15], s20 offen
s_mov_b32 s21, 4235264
buffer_load_dword v7, v1, s[12:15], s21 offen
s_waitcnt vmcnt(56)
v_perm_b32 v66, v9, v8, s46
v_accvgpr_write_b32 a102, v66
v_perm_b32 v70, v9, v8, s47
v_accvgpr_write_b32 a110, v70
s_mov_b32 s20, 4268032
buffer_load_dword v8, v1, s[12:15], s20 offen
s_mov_b32 s21, 4300800
buffer_load_dword v9, v1, s[12:15], s21 offen
s_waitcnt vmcnt(56)
v_perm_b32 v67, v11, v10, s46
v_accvgpr_write_b32 a103, v67
v_perm_b32 v71, v11, v10, s47
v_accvgpr_write_b32 a111, v71
s_mov_b32 s20, 4456448
buffer_load_dword v10, v1, s[12:15], s20 offen
s_mov_b32 s21, 4489216
buffer_load_dword v11, v1, s[12:15], s21 offen
s_waitcnt vmcnt(56)
v_perm_b32 v64, v13, v12, s46
v_accvgpr_write_b32 a112, v64
v_perm_b32 v68, v13, v12, s47
v_accvgpr_write_b32 a120, v68
s_mov_b32 s20, 4521984
buffer_load_dword v12, v1, s[12:15], s20 offen
s_mov_b32 s21, 4554752
buffer_load_dword v13, v1, s[12:15], s21 offen
s_waitcnt vmcnt(56)
v_perm_b32 v65, v15, v14, s46
v_accvgpr_write_b32 a113, v65
v_perm_b32 v69, v15, v14, s47
v_accvgpr_write_b32 a121, v69
s_mov_b32 s20, 4464640
buffer_load_dword v14, v1, s[12:15], s20 offen
s_mov_b32 s21, 4497408
buffer_load_dword v15, v1, s[12:15], s21 offen
s_waitcnt vmcnt(56)
v_perm_b32 v66, v17, v16, s46
v_accvgpr_write_b32 a114, v66
v_perm_b32 v70, v17, v16, s47
v_accvgpr_write_b32 a122, v70
s_mov_b32 s20, 4530176
buffer_load_dword v16, v1, s[12:15], s20 offen
s_mov_b32 s21, 4562944
buffer_load_dword v17, v1, s[12:15], s21 offen
s_waitcnt vmcnt(56)
v_perm_b32 v67, v19, v18, s46
v_accvgpr_write_b32 a115, v67
v_perm_b32 v71, v19, v18, s47
v_accvgpr_write_b32 a123, v71
s_waitcnt vmcnt(54)
v_perm_b32 v64, v21, v20, s46
v_accvgpr_write_b32 a116, v64
v_perm_b32 v68, v21, v20, s47
v_accvgpr_write_b32 a124, v68
s_waitcnt vmcnt(52)
v_perm_b32 v65, v23, v22, s46
v_accvgpr_write_b32 a117, v65
v_perm_b32 v69, v23, v22, s47
v_accvgpr_write_b32 a125, v69
s_waitcnt vmcnt(50)
v_perm_b32 v66, v25, v24, s46
v_accvgpr_write_b32 a118, v66
v_perm_b32 v70, v25, v24, s47
v_accvgpr_write_b32 a126, v70
s_waitcnt vmcnt(48)
v_perm_b32 v67, v27, v26, s46
v_accvgpr_write_b32 a119, v67
v_perm_b32 v71, v27, v26, s47
v_accvgpr_write_b32 a127, v71
s_waitcnt vmcnt(46)
v_perm_b32 v64, v29, v28, s46
v_accvgpr_write_b32 a128, v64
v_perm_b32 v68, v29, v28, s47
v_accvgpr_write_b32 a136, v68
s_waitcnt vmcnt(44)
v_perm_b32 v65, v31, v30, s46
v_accvgpr_write_b32 a129, v65
v_perm_b32 v69, v31, v30, s47
v_accvgpr_write_b32 a137, v69
s_waitcnt vmcnt(42)
v_perm_b32 v66, v33, v32, s46
v_accvgpr_write_b32 a130, v66
v_perm_b32 v70, v33, v32, s47
v_accvgpr_write_b32 a138, v70
s_waitcnt vmcnt(40)
v_perm_b32 v67, v35, v34, s46
v_accvgpr_write_b32 a131, v67
v_perm_b32 v71, v35, v34, s47
v_accvgpr_write_b32 a139, v71
s_waitcnt vmcnt(38)
v_perm_b32 v64, v37, v36, s46
v_accvgpr_write_b32 a132, v64
v_perm_b32 v68, v37, v36, s47
v_accvgpr_write_b32 a140, v68
s_waitcnt vmcnt(36)
v_perm_b32 v65, v39, v38, s46
v_accvgpr_write_b32 a133, v65
v_perm_b32 v69, v39, v38, s47
v_accvgpr_write_b32 a141, v69
s_waitcnt vmcnt(34)
v_perm_b32 v66, v41, v40, s46
v_accvgpr_write_b32 a134, v66
v_perm_b32 v70, v41, v40, s47
v_accvgpr_write_b32 a142, v70
s_waitcnt vmcnt(32)
v_perm_b32 v67, v43, v42, s46
v_accvgpr_write_b32 a135, v67
v_perm_b32 v71, v43, v42, s47
v_accvgpr_write_b32 a143, v71
s_waitcnt vmcnt(30)
v_perm_b32 v64, v45, v44, s46
v_accvgpr_write_b32 a144, v64
v_perm_b32 v68, v45, v44, s47
v_accvgpr_write_b32 a152, v68
s_waitcnt vmcnt(28)
v_perm_b32 v65, v47, v46, s46
v_accvgpr_write_b32 a145, v65
v_perm_b32 v69, v47, v46, s47
v_accvgpr_write_b32 a153, v69
s_waitcnt vmcnt(26)
v_perm_b32 v66, v49, v48, s46
v_accvgpr_write_b32 a146, v66
v_perm_b32 v70, v49, v48, s47
v_accvgpr_write_b32 a154, v70
s_waitcnt vmcnt(24)
v_perm_b32 v67, v51, v50, s46
v_accvgpr_write_b32 a147, v67
v_perm_b32 v71, v51, v50, s47
v_accvgpr_write_b32 a155, v71
s_waitcnt vmcnt(22)
v_perm_b32 v64, v53, v52, s46
v_accvgpr_write_b32 a148, v64
v_perm_b32 v68, v53, v52, s47
v_accvgpr_write_b32 a156, v68
s_waitcnt vmcnt(20)
v_perm_b32 v65, v55, v54, s46
v_accvgpr_write_b32 a149, v65
v_perm_b32 v69, v55, v54, s47
v_accvgpr_write_b32 a157, v69
s_waitcnt vmcnt(18)
v_perm_b32 v66, v57, v56, s46
v_accvgpr_write_b32 a150, v66
v_perm_b32 v70, v57, v56, s47
v_accvgpr_write_b32 a158, v70
s_waitcnt vmcnt(16)
v_perm_b32 v67, v59, v58, s46
v_accvgpr_write_b32 a151, v67
v_perm_b32 v71, v59, v58, s47
v_accvgpr_write_b32 a159, v71
s_waitcnt vmcnt(14)
v_perm_b32 v64, v61, v60, s46
v_accvgpr_write_b32 a160, v64
v_perm_b32 v68, v61, v60, s47
v_accvgpr_write_b32 a168, v68
s_waitcnt vmcnt(12)
v_perm_b32 v65, v63, v62, s46
v_accvgpr_write_b32 a161, v65
v_perm_b32 v69, v63, v62, s47
v_accvgpr_write_b32 a169, v69
s_waitcnt vmcnt(10)
v_perm_b32 v66, v7, v6, s46
v_accvgpr_write_b32 a162, v66
v_perm_b32 v70, v7, v6, s47
v_accvgpr_write_b32 a170, v70
s_waitcnt vmcnt(8)
v_perm_b32 v67, v9, v8, s46
v_accvgpr_write_b32 a163, v67
v_perm_b32 v71, v9, v8, s47
v_accvgpr_write_b32 a171, v71
s_waitcnt vmcnt(6)
v_perm_b32 v64, v11, v10, s46
v_accvgpr_write_b32 a164, v64
v_perm_b32 v68, v11, v10, s47
v_accvgpr_write_b32 a172, v68
s_waitcnt vmcnt(4)
v_perm_b32 v65, v13, v12, s46
v_accvgpr_write_b32 a165, v65
v_perm_b32 v69, v13, v12, s47
v_accvgpr_write_b32 a173, v69
s_waitcnt vmcnt(2)
v_perm_b32 v66, v15, v14, s46
v_accvgpr_write_b32 a166, v66
v_perm_b32 v70, v15, v14, s47
v_accvgpr_write_b32 a174, v70
s_waitcnt vmcnt(0)
v_perm_b32 v67, v17, v16, s46
v_accvgpr_write_b32 a167, v67
v_perm_b32 v71, v17, v16, s47
v_accvgpr_write_b32 a175, v71
v_mov_b32 v12, v0
v_and_b32 v13, 15, v0
v_bfe_u32 v14, v0, 4, 2
v_lshlrev_b32 v1, 4, v12
v_and_b32 v2, 0x3f0, v1
s_mul_i32 s20, s17, 34816
s_add_u32 s20, s20, 24576
v_add_u32 v2, s20, v2
v_and_b32 v15, 1, v12
v_mul_u32_u24 v0, 0xaaaa, v15
v_add_u32 v0, 0xffff4444, v0
v_lshrrev_b32 v18, 2, v13
v_lshl_add_u32 v18, v18, 1, v15
v_bfe_u32 v19, v13, 1, 1
v_lshrrev_b32 v16, 5, v12
v_lshlrev_b32 v16, 8, v16
v_lshl_add_u32 v16, v18, 5, v16
v_and_b32 v17, 1, v14
v_lshl_add_u32 v16, v17, 4, v16
v_and_b32 v17, 0x7f, v16
v_xor_b32 v17, 16, v17
v_add_u32 v16, 4224, v16
v_add_u32 v17, 6272, v17
v_cmp_eq_u32 vcc, 1, v19
s_nop 1
v_cndmask_b32 v7, v17, v16, vcc
v_and_b32 v16, 1, v14
v_xor_b32 v16, v18, v16
v_and_b32 v17, 2, v14
v_lshlrev_b32 v17, 1, v17
v_xor_b32 v16, v16, v17
v_lshlrev_b32 v16, 4, v16
v_lshl_add_u32 v16, v14, 7, v16
v_mul_u32_u24 v17, 2176, v19
v_add_u32 v16, v16, v17
v_add_u32 v5, 0, v16
v_bfe_u32 v20, v13, 3, 1
v_bfe_u32 v21, v13, 1, 1
v_lshlrev_b32 v16, 1, v14
v_xor_b32 v16, v16, v21
v_lshlrev_b32 v17, 2, v20
v_xor_b32 v16, v16, v17
v_lshlrev_b32 v16, 4, v16
v_lshl_add_u32 v16, v20, 8, v16
v_lshl_add_u32 v16, v21, 7, v16
v_bfe_u32 v17, v13, 2, 1
v_lshl_add_u32 v16, v17, 3, v16
v_lshl_add_u32 v16, v15, 2, v16
s_lshl_b32 s20, s17, 9
s_add_u32 s20, s20, 0
v_add_u32 v4, s20, v16
v_xor_b32 v3, 16, v4
v_lshrrev_b32 v16, 4, v12
v_xor_b32 v17, s16, v16
v_lshlrev_b32 v16, 12, v16
v_lshl_add_u32 v16, v17, 7, v16
v_lshl_add_u32 v9, v13, 3, v16
s_lshr_b32 s20, s17, 1
s_lshl_b32 s20, s20, 2
v_add_u32 v16, s20, v14
v_xor_b32 v17, s16, v16
v_lshlrev_b32 v16, 12, v16
v_lshl_add_u32 v16, v17, 7, v16
v_lshl_add_u32 v16, v13, 2, v16
s_and_b32 s20, s17, 1
s_lshl_b32 s20, s20, 6
s_add_u32 s20, s20, 262144
v_add_u32 v10, s20, v16
v_bfe_u32 v16, v13, 2, 1
v_lshlrev_b32 v16, 5, v16
v_and_b32 v17, 1, v14
v_lshl_add_u32 v16, v17, 8, v16
v_lshrrev_b32 v17, 1, v14
v_lshl_add_u32 v16, v17, 4, v16
v_and_b32 v17, 3, v13
v_lshl_add_u32 v11, v17, 2, v16
v_lshlrev_b32 v6, 7, v12
v_lshlrev_b32 v8, 2, v12
s_mov_b32 s36, 0x11111111
s_mov_b32 s37, 0x11111111
s_mov_b32 s38, 0x22222222
s_mov_b32 s39, 0x22222222
s_mov_b32 s40, 0x44444444
s_mov_b32 s41, 0x44444444
s_mov_b32 s42, 0x88888888
s_mov_b32 s43, 0x88888888
s_mov_b32 s44, 0xf0f0f0f0
s_mov_b32 s45, 0xf0f0f0f0
s_mov_b32 s18, 0x3e0293ee
s_lshl_b32 s20, s17, 5
s_add_u32 s20, s20, s16
s_cmp_lt_u32 s20, 72
s_cselect_b32 s48, 1, 0
s_lshl_b32 s23, s20, 12
s_lshl_b32 s21, s17, 10
s_sub_u32 s23, s23, s21
s_lshr_b32 s24, s20, 2
s_lshl_b32 s24, s24, 9
s_and_b32 s21, s20, 3
s_lshl_b32 s21, s21, 6
s_add_u32 s24, s24, s21
s_add_u32 s24, s24, 110100480
s_cmp_lt_u32 s20, 72
s_cselect_b32 s24, s24, 536870912
s_lshl_b32 s25, s16, 12
s_add_u32 s26, s25, 131072
s_add_u32 s27, s25, 262144
s_cmp_lt_u32 s16, 8
s_cselect_b32 s27, s27, 536870912
s_mov_b32 s28, 109051904
s_mov_b32 s29, 109346816
s_lshl_b32 s30, s16, 20
s_add_u32 s30, s30, 33554432
s_lshl_b32 s31, s16, 12
s_add_u32 s31, s31, 100663296
s_add_u32 s35, s24, 32768
s_mov_b32 s53, 0x3f803f80
s_mov_b32 s86, 0x33333333
s_mov_b32 s87, 0x33333333
s_lshl_b32 s84, s17, 13
s_sub_u32 s84, s20, s84
s_add_u32 s84, s84, 110886912
s_cmp_lt_u32 s20, 72
s_cselect_b32 s84, s84, 536870912
s_and_b32 s21, s16, 3
s_lshl_b32 s21, s21, 7
s_add_u32 s21, s21, 110886144
s_cmp_eq_u32 s17, 3
s_cselect_b32 s84, s21, s84
s_lshl_b32 s82, s16, 7
s_add_u32 s83, s82, 111152384
s_add_u32 s82, s82, 111148288
s_mov_b32 s19, 0
s_load_dwordx2 s[50:51], s[0:1], 56
s_waitcnt lgkmcnt(0)
s_mov_b32 s12, s50
s_and_b32 s13, s51, 0xffff
s_mov_b32 s14, 9216
s_mov_b32 s15, 0x20000
v_bfe_u32 v64, v1, 5, 3
v_mul_u32_u24 v64, 1152, v64
v_lshrrev_b32 v65, 8, v1
v_lshl_add_u32 v64, v65, 5, v64
v_and_b32 v65, 16, v1
v_add_u32 v64, v64, v65
buffer_load_dwordx4 v[24:27], v64, s[12:15], 0 offen offset:0
buffer_load_dwordx4 v[28:31], v64, s[12:15], 0 offen offset:512
buffer_load_dwordx4 v[32:35], v64, s[12:15], 0 offen offset:1024
s_waitcnt vmcnt(0)
v_perm_b32 v12, v26, v24, s46
v_perm_b32 v13, v26, v24, s47
v_perm_b32 v14, v27, v25, s46
v_perm_b32 v15, v27, v25, s47
v_min_u32 v12, 0xfffeffff, v12
v_min_u32 v13, 0xfffeffff, v13
v_min_u32 v14, 0xfffeffff, v14
v_min_u32 v15, 0xfffeffff, v15
v_perm_b32 v16, v30, v28, s46
v_perm_b32 v17, v30, v28, s47
v_perm_b32 v18, v31, v29, s46
v_perm_b32 v19, v31, v29, s47
v_min_u32 v16, 0xfffeffff, v16
v_min_u32 v17, 0xfffeffff, v17
v_min_u32 v18, 0xfffeffff, v18
v_min_u32 v19, 0xfffeffff, v19
v_perm_b32 v20, v34, v32, s46
v_perm_b32 v21, v34, v32, s47
v_perm_b32 v22, v35, v33, s46
v_perm_b32 v23, v35, v33, s47
v_min_u32 v20, 0xfffeffff, v20
v_min_u32 v21, 0xfffeffff, v21
v_min_u32 v22, 0xfffeffff, v22
v_min_u32 v23, 0xfffeffff, v23
s_cmp_lg_u32 s17, 0
s_cbranch_scc1 L_m0_36
ds_write_b128 v1, v[20:23] offset:14848
v_mov_b32 v64, 6528
v_mov_b32 v56, 0
v_mov_b32 v57, 0
v_mov_b32 v58, 0
v_mov_b32 v59, 0
ds_write_b128 v64, v[56:59]
L_m0_36:
s_waitcnt lgkmcnt(0)
s_barrier
ds_read_b32 v20, v8 offset:14848
s_waitcnt lgkmcnt(0)
s_mov_b32 s33, 110100480
s_mov_b32 s6, 110100480
s_mov_b32 s7, 110100480
v_and_b32 v66, 16, v1
v_lshlrev_b32 v64, 2, v66
v_add_u32 v64, 64, v64
v_mul_u32_u24 v66, 3, v66
v_lshrrev_b32 v66, 1, v66
v_sub_u32 v66, 32, v66
s_mov_b32 s22, 0
L_poll_37:
buffer_load_dword v65, v64, s[56:59], 0 offen sc1
s_add_u32 s22, s22, 1
s_cmp_gt_u32 s22, 40000
s_cbranch_scc1 L_end
s_waitcnt vmcnt(0)
v_cmp_ne_u32 vcc, v66, v65
s_cbranch_vccz L_pd_38
s_sleep 1
s_branch L_poll_37
L_pd_38:
v_mov_b32 v64, 0
s_lshl_b32 s21, s16, 7
s_add_u32 s21, s21, 111149056
s_mov_b32 s22, 0
L_poll_39:
buffer_load_dword v65, v64, s[8:11], s21 offen sc1
s_add_u32 s22, s22, 1
s_cmp_gt_u32 s22, 40000
s_cbranch_scc1 L_end
s_waitcnt vmcnt(0)
v_cmp_ne_u32 vcc, 1, v65
s_cbranch_vccz L_pd_40
s_sleep 1
s_branch L_poll_39
L_pd_40:
s_mov_b32 s22, 0
s_cmp_eq_u32 s17, 0
s_cbranch_scc1 L_ent0
s_cmp_eq_u32 s17, 1
s_cbranch_scc1 L_ent1
s_cmp_eq_u32 s17, 2
s_cbranch_scc1 L_ent2
s_cmp_eq_u32 s17, 3
s_cbranch_scc1 L_ent3
s_branch L_end
L_ent0:
v_mov_b64 v[24:25], 0
v_mov_b64 v[26:27], 0
v_mov_b64 v[28:29], 0
v_mov_b64 v[30:31], 0
v_and_b32 v69, 0x380, v1
v_add_u32 v69, v69, v1
v_and_b32 v70, 0xf00, v1
v_add_u32 v70, v70, v1
v_mov_b64 v[64:65], -1
v_mov_b64 v[66:67], -1
v_xor_b32 v3, 16, v4
ds_read_b128 v[48:51], v2 offset:8192
ds_read_b128 v[52:55], v2 offset:9216
ds_read_b128 v[40:43], v2 offset:0
ds_read_b128 v[44:47], v2 offset:1024
v_mov_b64 v[32:33], 0
v_mov_b64 v[34:35], 0
v_mov_b64 v[36:37], 0
v_mov_b64 v[38:39], 0
v_mov_b64 v[56:57], 0
v_mov_b64 v[58:59], 0
v_mov_b64 v[60:61], 0
v_mov_b64 v[62:63], 0
s_add_u32 s20, s30, 0
s_add_u32 s21, s30, 8192
s_add_u32 s49, s29, s25
s_add_u32 s50, s29, s26
s_add_u32 s51, s29, s27
s_add_u32 s52, s30, 16384
s_mov_b32 m0, 15872
s_waitcnt vmcnt(0) lgkmcnt(0)
s_branch L_step0
L_gr0:
buffer_load_dwordx4 v[12:15], v1, s[8:11], s33 offen sc1
buffer_load_dword v20, v8, s[8:11], s7 offen sc1
buffer_load_dwordx4 v[16:19], v1, s[8:11], s6 offen sc1
s_add_u32 s22, s22, 1
s_cmp_gt_u32 s22, 40000
s_cbranch_scc1 L_end
s_nop 0
v_mov_b64 v[24:25], 0
v_mov_b64 v[26:27], 0
v_mov_b64 v[28:29], 0
v_mov_b64 v[30:31], 0
v_mov_b64 v[32:33], 0
v_mov_b64 v[34:35], 0
v_mov_b64 v[36:37], 0
v_mov_b64 v[38:39], 0
v_mov_b64 v[56:57], 0
v_mov_b64 v[58:59], 0
v_mov_b64 v[60:61], 0
v_mov_b64 v[62:63], 0
s_waitcnt lgkmcnt(0)
s_branch L_step0
.p2align 3
L_gat0:
buffer_load_dwordx4 v[12:15], v1, s[8:11], s33 offen sc1
buffer_load_dword v20, v8, s[8:11], s7 offen sc1
buffer_load_dwordx4 v[16:19], v1, s[8:11], s6 offen sc1
s_add_u32 s20, s30, 0
s_add_u32 s21, s30, 8192
s_add_u32 s49, s29, s25
s_add_u32 s50, s29, s26
s_add_u32 s51, s29, s27
s_add_u32 s52, s30, 16384
s_mov_b32 m0, 15872
s_waitcnt lgkmcnt(0)
L_step0:
s_waitcnt vmcnt(2)
v_smfmac_f32_16x16x64_bf16 v[24:27], v[12:15], v[72:79], v0
ds_write_b128 v1, v[12:15] offset:6656
v_smfmac_f32_16x16x64_bf16 v[28:31], v[12:15], v[80:87], v0
s_waitcnt vmcnt(1)
ds_write_b32 v8, v20 offset:14848
v_smfmac_f32_16x16x64_bf16 v[32:35], v[12:15], v[88:95], v0
s_waitcnt vmcnt(0)
ds_write_b128 v1, v[16:19] offset:10752
v_smfmac_f32_16x16x64_bf16 v[56:59], v[12:15], a[32:39], v0
v_max3_u32 v21, v12, v13, v14
v_max3_u32 v21, v21, v15, v20
v_smfmac_f32_16x16x64_bf16 v[60:63], v[12:15], a[40:47], v0
v_max3_u32 v21, v21, v16, v17
v_max3_u32 v21, v21, v18, v19
v_smfmac_f32_16x16x64_bf16 v[36:39], v[12:15], v[40:47], v0
v_cmp_le_u32 vcc, 0xffff0000, v21
v_smfmac_f32_16x16x64_bf16 v[24:27], v[16:19], v[168:175], v0
s_cbranch_vccnz L_gr0
v_smfmac_f32_16x16x64_bf16 v[28:31], v[16:19], v[176:183], v0
s_waitcnt lgkmcnt(0)
s_barrier
ds_read_b128 v[20:23], v1 offset:7680
v_smfmac_f32_16x16x64_bf16 v[32:35], v[16:19], v[184:191], v0
ds_read_b128 v[12:15], v1 offset:8704
buffer_load_dwordx4 v69, s[8:11], s20 offen sc1 lds
v_smfmac_f32_16x16x64_bf16 v[56:59], v[16:19], a[96:103], v0
ds_read_b128 v[40:43], v2 offset:2048
s_mov_b32 m0, 16768
v_smfmac_f32_16x16x64_bf16 v[60:63], v[16:19], a[104:111], v0
ds_read_b128 v[44:47], v2 offset:3072
v_smfmac_f32_16x16x64_bf16 v[36:39], v[16:19], v[48:55], v0
ds_read_b128 v[16:19], v1 offset:9728
s_waitcnt lgkmcnt(4)
v_smfmac_f32_16x16x64_bf16 v[24:27], v[20:23], v[96:103], v0
ds_read_b128 v[48:51], v2 offset:4096
buffer_load_dwordx4 v69, s[8:11], s20 offen offset:128 sc1 lds
v_smfmac_f32_16x16x64_bf16 v[28:31], v[20:23], v[104:111], v0
ds_read_b128 v[52:55], v2 offset:5120
s_mov_b32 m0, 6272
v_smfmac_f32_16x16x64_bf16 v[32:35], v[20:23], v[112:119], v0
buffer_store_dword v0, v11, s[8:11], s35 offen
s_waitcnt lgkmcnt(3)
v_smfmac_f32_16x16x64_bf16 v[36:39], v[20:23], v[40:47], v0
ds_read_b128 v[20:23], v1 offset:11776
v_smfmac_f32_16x16x64_bf16 v[24:27], v[12:15], v[120:127], v0
ds_read_b128 v[40:43], v2 offset:6144
buffer_store_dwordx4 v[64:67], v1, s[8:11], s49 offen
v_smfmac_f32_16x16x64_bf16 v[28:31], v[12:15], v[128:135], v0
ds_read_b128 v[44:47], v2 offset:7168
v_smfmac_f32_16x16x64_bf16 v[32:35], v[12:15], v[136:143], v0
s_waitcnt lgkmcnt(3)
v_smfmac_f32_16x16x64_bf16 v[36:39], v[12:15], v[48:55], v0
ds_read_b128 v[12:15], v1 offset:12800
v_smfmac_f32_16x16x64_bf16 v[24:27], v[16:19], v[144:151], v0
ds_read_b128 v[48:51], v2 offset:10240
buffer_store_dwordx4 v[64:67], v1, s[8:11], s50 offen
v_smfmac_f32_16x16x64_bf16 v[28:31], v[16:19], v[152:159], v0
ds_read_b128 v[52:55], v2 offset:11264
v_smfmac_f32_16x16x64_bf16 v[32:35], v[16:19], v[160:167], v0
s_waitcnt lgkmcnt(3)
v_smfmac_f32_16x16x64_bf16 v[36:39], v[16:19], v[40:47], v0
ds_read_b128 v[16:19], v1 offset:13824
v_smfmac_f32_16x16x64_bf16 v[24:27], v[20:23], v[192:199], v0
ds_read_b128 v[40:43], v2 offset:12288
buffer_store_dwordx4 v[64:67], v1, s[8:11], s51 offen
v_smfmac_f32_16x16x64_bf16 v[28:31], v[20:23], v[200:207], v0
ds_read_b128 v[44:47], v2 offset:13312
v_smfmac_f32_16x16x64_bf16 v[32:35], v[20:23], v[208:215], v0
s_waitcnt lgkmcnt(3)
v_smfmac_f32_16x16x64_bf16 v[36:39], v[20:23], v[48:55], v0
ds_read_b128 v[20:23], v1 offset:14848
v_smfmac_f32_16x16x64_bf16 v[24:27], v[12:15], v[216:223], v0
ds_read_b128 v[48:51], v2 offset:14336
buffer_load_dwordx4 v[64:67], v70, s[8:11], s21 offen sc1
v_smfmac_f32_16x16x64_bf16 v[28:31], v[12:15], v[224:231], v0
ds_read_b128 v[52:55], v2 offset:15360
v_smfmac_f32_16x16x64_bf16 v[32:35], v[12:15], v[232:239], v0
s_waitcnt lgkmcnt(3)
v_smfmac_f32_16x16x64_bf16 v[36:39], v[12:15], v[40:47], v0
ds_read_b128 v[12:15], v1 offset:7680
v_smfmac_f32_16x16x64_bf16 v[24:27], v[16:19], v[240:247], v0
ds_read_b128 v[40:43], v2 offset:16384
buffer_load_dwordx4 v[68:71], v70, s[8:11], s21 offen offset:256 sc1
v_smfmac_f32_16x16x64_bf16 v[28:31], v[16:19], v[248:255], v0
ds_read_b128 v[44:47], v2 offset:17408
v_smfmac_f32_16x16x64_bf16 v[32:35], v[16:19], a[0:7], v0
s_waitcnt lgkmcnt(3)
v_smfmac_f32_16x16x64_bf16 v[36:39], v[16:19], v[48:55], v0
ds_read_b128 v[16:19], v1 offset:8704
v_smfmac_f32_16x16x64_bf16 v[24:27], v[20:23], a[8:15], v0
v_smfmac_f32_16x16x64_bf16 v[28:31], v[20:23], a[16:23], v0
buffer_load_dword v6, s[8:11], s52 offen sc1 lds
v_smfmac_f32_16x16x64_bf16 v[32:35], v[20:23], a[24:31], v0
s_waitcnt lgkmcnt(1)
v_smfmac_f32_16x16x64_bf16 v[36:39], v[20:23], v[40:47], v0
ds_read_b128 v[20:23], v1 offset:9728
v_smfmac_f32_16x16x64_bf16 v[56:59], v[12:15], a[48:55], v0
s_nop 0
v_add_f32 v24, v24, v25
v_add_f32 v26, v26, v27
v_add_f32 v28, v28, v29
v_add_f32 v30, v30, v31
v_cvt_pk_bf16_f32 v24, v24, v28
v_cvt_pk_bf16_f32 v26, v26, v30
ds_write_b32 v4, v24 offset:2176
v_add_f32 v32, v32, v33
v_add_f32 v34, v34, v35
v_add_f32 v36, v36, v37
v_add_f32 v38, v38, v39
ds_write_b32 v3, v26 offset:2176
v_cvt_pk_bf16_f32 v32, v32, v36
v_cvt_pk_bf16_f32 v34, v34, v38
ds_write_b32 v4, v32
v_smfmac_f32_16x16x64_bf16 v[60:63], v[12:15], a[56:63], v0
ds_write_b32 v3, v34
s_waitcnt lgkmcnt(5)
v_smfmac_f32_16x16x64_bf16 v[56:59], v[16:19], a[64:71], v0
ds_read_b128 v[12:15], v1 offset:11776
v_smfmac_f32_16x16x64_bf16 v[60:63], v[16:19], a[72:79], v0
ds_read_b128 v[16:19], v1 offset:12800
s_waitcnt lgkmcnt(6)
v_smfmac_f32_16x16x64_bf16 v[56:59], v[20:23], a[80:87], v0
s_waitcnt lgkmcnt(2) vmcnt(7)
s_barrier
ds_read_b128 v[24:27], v5 offset:0
v_smfmac_f32_16x16x64_bf16 v[60:63], v[20:23], a[88:95], v0
ds_read_b128 v[20:23], v1 offset:13824
s_waitcnt lgkmcnt(3)
v_smfmac_f32_16x16x64_bf16 v[56:59], v[12:15], a[112:119], v0
ds_read_b128 v[40:43], v1 offset:15872
v_smfmac_f32_16x16x64_bf16 v[60:63], v[12:15], a[120:127], v0
ds_read_b128 v[12:15], v1 offset:14848
s_waitcnt lgkmcnt(4)
v_smfmac_f32_16x16x64_bf16 v[56:59], v[16:19], a[128:135], v0
ds_read_b128 v[28:31], v5 offset:512
v_smfmac_f32_16x16x64_bf16 v[60:63], v[16:19], a[136:143], v0
ds_read_b128 v[44:47], v1 offset:17920
s_waitcnt lgkmcnt(4)
v_smfmac_f32_16x16x64_bf16 v[56:59], v[20:23], a[144:151], v0
ds_read_b128 v[32:35], v5 offset:1024
s_mov_b64 exec, s[86:87]
buffer_store_dwordx4 v[24:27], v5, s[8:11], s31 offen offset:0 sc1
s_mov_b64 exec, -1
v_smfmac_f32_16x16x64_bf16 v[60:63], v[20:23], a[152:159], v0
ds_read_b128 v[48:51], v1 offset:19968
s_waitcnt lgkmcnt(4)
v_smfmac_f32_16x16x64_bf16 v[56:59], v[12:15], a[160:167], v0
ds_read_b128 v[36:39], v5 offset:1536
v_smfmac_f32_16x16x64_bf16 v[60:63], v[12:15], a[168:175], v0
ds_read_b128 v[52:55], v1 offset:22016
v_mfma_f32_16x16x32_bf16 v[16:19], v[40:43], v[24:27], 0
ds_read_b128 v[40:43], v1 offset:16896
s_waitcnt lgkmcnt(5)
v_mfma_f32_16x16x32_bf16 v[16:19], v[44:47], v[28:31], v[16:19]
ds_read_b128 v[44:47], v1 offset:18944
s_waitcnt lgkmcnt(4)
v_mfma_f32_16x16x32_bf16 v[16:19], v[48:51], v[32:35], v[16:19]
ds_read_b128 v[48:51], v1 offset:20992
s_waitcnt lgkmcnt(3)
v_mfma_f32_16x16x32_bf16 v[16:19], v[52:55], v[36:39], v[16:19]
ds_read_b128 v[52:55], v1 offset:23040
v_mfma_f32_16x16x32_bf16 v[20:23], v[24:27], v[24:27], 0
v_add_f32 v56, v56, v57
v_add_f32 v58, v58, v59
v_mfma_f32_16x16x32_bf16 v[20:23], v[28:31], v[28:31], v[20:23]
v_add_f32 v60, v60, v61
v_add_f32 v62, v62, v63
v_mfma_f32_16x16x32_bf16 v[20:23], v[32:35], v[32:35], v[20:23]
v_cvt_pk_bf16_f32 v56, v56, v58
v_cvt_pk_bf16_f32 v57, v60, v62
v_mfma_f32_16x16x32_bf16 v[20:23], v[36:39], v[36:39], v[20:23]
v_lshrrev_b32 v58, 1, v1
v_max3_f32 v59, v16, v17, v18
s_waitcnt lgkmcnt(3)
v_mfma_f32_16x16x32_bf16 v[12:15], v[40:43], v[24:27], 0
ds_read_b128 v[40:43], v2 offset:18432
buffer_store_dwordx2 v[56:57], v58, s[8:11], s31 offen offset:2048 sc1
s_waitcnt lgkmcnt(3)
v_mfma_f32_16x16x32_bf16 v[12:15], v[44:47], v[28:31], v[12:15]
ds_read_b128 v[44:47], v2 offset:19456
s_waitcnt lgkmcnt(3)
v_mfma_f32_16x16x32_bf16 v[12:15], v[48:51], v[32:35], v[12:15]
ds_read_b128 v[48:51], v2 offset:20480
v_max3_f32 v59, v59, v19, v20
v_max_f32 v59, v59, v21
s_waitcnt lgkmcnt(3)
v_mfma_f32_16x16x32_bf16 v[12:15], v[52:55], v[36:39], v[12:15]
ds_read_b128 v[52:55], v2 offset:21504
v_mov_b32 v60, s53
s_add_u32 s49, s28, s23
v_mov_b32 v61, s53
s_add_u32 s50, s28, 65536
v_mov_b32 v62, s53
ds_read_b128 v[32:35], v2 offset:22528
v_mov_b32 v63, s53
v_max3_f32 v59, v59, v12, v13
v_max3_f32 v22, v59, v14, v15
v_max3_f32 v59, v59, v14, v15
s_add_u32 s51, s28, 131072
s_add_u32 s52, s28, 196608
v_permlane32_swap_b32 v22, v59
v_max_f32 v23, v59, v22
v_max_f32 v59, v59, v22
v_mov_b32 v22, 0
ds_read_b128 v[36:39], v2 offset:23552
v_permlane16_swap_b32 v23, v59
v_max_f32 v59, v59, v23
v_mul_f32 v58, s18, v59
v_pk_fma_f32 v[20:21], v[20:21], s[18:19], v[58:59] op_sel_hi:[1,0,0] neg_lo:[0,0,1] neg_hi:[0,0,1]
v_pk_fma_f32 v[16:17], v[16:17], s[18:19], v[58:59] op_sel_hi:[1,0,0] neg_lo:[0,0,1] neg_hi:[0,0,1]
v_pk_fma_f32 v[18:19], v[18:19], s[18:19], v[58:59] op_sel_hi:[1,0,0] neg_lo:[0,0,1] neg_hi:[0,0,1]
v_pk_fma_f32 v[12:13], v[12:13], s[18:19], v[58:59] op_sel_hi:[1,0,0] neg_lo:[0,0,1] neg_hi:[0,0,1]
v_pk_fma_f32 v[14:15], v[14:15], s[18:19], v[58:59] op_sel_hi:[1,0,0] neg_lo:[0,0,1] neg_hi:[0,0,1]
v_exp_f32 v20, v20
v_exp_f32 v21, v21
v_exp_f32 v16, v16
v_cvt_pk_bf16_f32 v23, v20, v21
v_cvt_pk_bf16_f32 v20, v20, v21
v_mov_b32 v21, 0
v_exp_f32 v17, v17
v_exp_f32 v18, v18
v_mfma_f32_16x16x16_bf16 v[24:27], v[56:57], v[20:21], 0
v_exp_f32 v19, v19
v_mfma_f32_16x16x16_bf16 v[28:31], v[56:57], v[22:23], 0
v_exp_f32 v12, v12
v_exp_f32 v13, v13
v_cvt_pk_bf16_f32 v16, v16, v17
v_cvt_pk_bf16_f32 v17, v18, v19
v_exp_f32 v14, v14
v_exp_f32 v15, v15
v_cvt_pk_bf16_f32 v18, v12, v13
v_cvt_pk_bf16_f32 v19, v14, v15
v_mfma_f32_16x16x16_bf16 v[12:15], v[60:61], v[20:21], 0
s_waitcnt vmcnt(3)
v_mfma_f32_16x16x32_bf16 v[12:15], v[60:63], v[16:19], v[12:15]
v_mov_b32 v20, 0
v_mov_b32 v23, 0
v_mfma_f32_16x16x32_bf16 v[24:27], v[64:67], v[16:19], v[24:27]
s_nop 1
v_mfma_f32_16x16x32_bf16 v[28:31], v[68:71], v[16:19], v[28:31]
v_mov_b32 v16, 0
v_mov_b32 v17, 0
v_rcp_f32 v12, v12
v_mov_b32 v18, 0
v_mov_b32 v19, 0
v_pk_mul_f32 v[24:25], v[24:25], v[12:13] op_sel_hi:[1,0]
v_pk_mul_f32 v[26:27], v[26:27], v[12:13] op_sel_hi:[1,0]
v_mov_b32 v15, 0
v_pk_mul_f32 v[28:29], v[28:29], v[12:13] op_sel_hi:[1,0]
v_pk_mul_f32 v[30:31], v[30:31], v[12:13] op_sel_hi:[1,0]
v_cvt_pk_bf16_f32 v24, v24, v28
v_cvt_pk_bf16_f32 v25, v25, v29
v_cvt_pk_bf16_f32 v26, v26, v30
v_cvt_pk_bf16_f32 v27, v27, v31
v_mfma_f32_16x16x32_bf16 v[56:59], v[20:23], v[20:23], 0
ds_write_b128 v7, v[24:27]
v_mfma_f32_16x16x32_bf16 v[60:63], v[20:23], v[20:23], 0
v_mov_b32 v12, 0
v_mov_b32 v13, 0
v_mov_b32 v14, 0
v_mov_b32 v3, 6528
s_nop 1
v_mfma_f32_16x16x32_bf16 v[64:67], v[20:23], v[20:23], 0
s_cmp_eq_u32 s19, 63
s_cbranch_scc1 L_texit
s_waitcnt lgkmcnt(0)
s_barrier
ds_read_b128 v[24:27], v1 offset:4224
v_mfma_f32_16x16x32_bf16 v[68:71], v[20:23], v[20:23], 0
ds_read_b128 v[28:31], v1 offset:5248
s_nop 2
v_mfma_f32_16x16x32_bf16 v[68:71], v[20:23], v[20:23], 0
s_waitcnt lgkmcnt(1)
v_smfmac_f32_16x16x64_bf16 v[12:15], v[24:27], a[248:255], v0
v_smfmac_f32_16x16x64_bf16 v[16:19], v[24:27], a[176:183], v0
s_waitcnt lgkmcnt(0)
v_smfmac_f32_16x16x64_bf16 v[12:15], v[28:31], v[40:47], v0
ds_read_b128 v[40:43], v2 offset:24576
v_smfmac_f32_16x16x64_bf16 v[16:19], v[28:31], v[48:55], v0
ds_read_b128 v[44:47], v2 offset:25600
v_smfmac_f32_16x16x64_bf16 v[20:23], v[24:27], a[184:191], v0
ds_read_b128 v[48:51], v2 offset:26624
v_smfmac_f32_16x16x64_bf16 v[20:23], v[28:31], v[32:39], v0
ds_read_b128 v[52:55], v2 offset:27648
s_nop 0
v_add_f32 v12, v12, v13
v_add_f32 v14, v14, v15
v_smfmac_f32_16x16x64_bf16 v[56:59], v[24:27], a[192:199], v0
ds_read_b128 v[32:35], v2 offset:28672
s_waitcnt lgkmcnt(3)
v_cvt_pk_bf16_f32 v12, v12, v14
buffer_store_dword v12, v10, s[8:11], s28 offen
v_smfmac_f32_16x16x64_bf16 v[56:59], v[28:31], v[40:47], v0
ds_read_b128 v[36:39], v2 offset:29696
v_add_f32 v16, v16, v17
v_add_f32 v18, v18, v19
v_smfmac_f32_16x16x64_bf16 v[60:63], v[24:27], a[200:207], v0
ds_read_b128 v[12:15], v3
s_waitcnt lgkmcnt(3)
v_cvt_pk_bf16_f32 v16, v16, v18
v_add_f32 v20, v20, v21
v_smfmac_f32_16x16x64_bf16 v[60:63], v[28:31], v[48:55], v0
ds_read_b128 v[40:43], v2 offset:30720
v_add_f32 v22, v22, v23
v_cvt_pk_bf16_f32 v17, v20, v22
v_smfmac_f32_16x16x64_bf16 v[64:67], v[24:27], a[208:215], v0
ds_read_b128 v[44:47], v2 offset:31744
s_waitcnt lgkmcnt(3)
buffer_store_dwordx2 v[16:17], v9, s[8:11], s28 offen
v_add_f32 v56, v56, v57
v_smfmac_f32_16x16x64_bf16 v[64:67], v[28:31], v[32:39], v0
ds_read_b128 v[48:51], v2 offset:32768
v_add_f32 v58, v58, v59
v_cvt_pk_bf16_f32 v56, v56, v58
v_smfmac_f32_16x16x64_bf16 v[68:71], v[24:27], a[216:223], v0
ds_read_b128 v[52:55], v2 offset:33792
s_waitcnt lgkmcnt(2)
v_add_f32 v60, v60, v61
v_add_f32 v62, v62, v63
v_smfmac_f32_16x16x64_bf16 v[68:71], v[28:31], v[40:47], v0
ds_read_b128 v[20:23], v3
v_cvt_pk_bf16_f32 v57, v60, v62
buffer_store_dwordx2 v[56:57], v9, s[8:11], s50 offen
v_smfmac_f32_16x16x64_bf16 v[12:15], v[24:27], a[224:231], v0
s_waitcnt lgkmcnt(1)
v_add_f32 v64, v64, v65
v_add_f32 v66, v66, v67
v_smfmac_f32_16x16x64_bf16 v[12:15], v[28:31], v[48:55], v0
s_waitcnt lgkmcnt(0)
v_cvt_pk_bf16_f32 v64, v64, v66
v_smfmac_f32_16x16x64_bf16 v[20:23], v[24:27], a[232:239], v0
v_add_f32 v68, v68, v69
v_add_f32 v70, v70, v71
v_smfmac_f32_16x16x64_bf16 v[20:23], v[28:31], a[240:247], v0
v_cvt_pk_bf16_f32 v65, v68, v70
buffer_store_dwordx2 v[64:65], v9, s[8:11], s51 offen
v_add_f32 v12, v12, v13
v_add_f32 v14, v14, v15
v_cvt_pk_bf16_f32 v12, v12, v14
s_nop 2
v_add_f32 v20, v20, v21
v_add_f32 v22, v22, v23
v_cvt_pk_bf16_f32 v13, v20, v22
buffer_store_dwordx2 v[12:13], v9, s[8:11], s52 offen
s_add_u32 s19, s19, 1
s_mov_b32 s20, s28
s_mov_b32 s28, s29
s_mov_b32 s29, s20
s_and_b32 s20, s19, 3
s_lshl_b32 s20, s20, 14
s_add_u32 s33, s20, 110100480
s_add_u32 s34, s20, s24
s_xor_b32 s20, s20, 32768
s_add_u32 s35, s20, s24
s_add_u32 s30, s30, 16384
s_add_u32 s31, s31, 131072
s_add_u32 s6, s33, 4096
s_add_u32 s7, s33, 8192
s_mov_b32 s22, 0
v_mov_b64 v[24:25], 0
v_mov_b64 v[26:27], 0
v_mov_b64 v[28:29], 0
v_mov_b64 v[30:31], 0
v_and_b32 v69, 0x380, v1
v_add_u32 v69, v69, v1
v_and_b32 v70, 0xf00, v1
v_add_u32 v70, v70, v1
v_mov_b64 v[64:65], -1
v_mov_b64 v[66:67], -1
v_xor_b32 v3, 16, v4
ds_read_b128 v[48:51], v2 offset:8192
ds_read_b128 v[52:55], v2 offset:9216
v_mov_b32 v56, 0x3f80
v_cndmask_b32 v56, v56, 1.0, s[44:45]
v_cndmask_b32 v60, 0, v56, s[36:37]
v_cndmask_b32 v61, 0, v56, s[38:39]
v_cndmask_b32 v62, 0, v56, s[40:41]
v_cndmask_b32 v63, 0, v56, s[42:43]
s_nop 5
buffer_load_dwordx4 v[32:35], v1, s[8:11], s49 offen offset:0 sc1
buffer_load_dwordx4 v[36:39], v1, s[8:11], s49 offen offset:1024 sc1
buffer_load_dwordx4 v[40:43], v1, s[8:11], s49 offen offset:2048 sc1
buffer_load_dwordx4 v[44:47], v1, s[8:11], s49 offen offset:3072 sc1
s_waitcnt vmcnt(3)
v_mfma_f32_16x16x32_bf16 v[56:59], v[32:35], v[60:63], 0
v_max3_u32 v16, v32, v33, v34
v_max_u32 v16, v16, v35
s_waitcnt vmcnt(2)
v_mfma_f32_16x16x32_bf16 v[56:59], v[36:39], v[60:63], v[56:59]
v_max3_u32 v16, v16, v36, v37
v_max3_u32 v16, v16, v38, v39
s_waitcnt vmcnt(1)
v_mfma_f32_16x16x32_bf16 v[56:59], v[40:43], v[60:63], v[56:59]
v_max3_u32 v16, v16, v40, v41
v_max3_u32 v16, v16, v42, v43
s_waitcnt vmcnt(0)
v_mfma_f32_16x16x32_bf16 v[56:59], v[44:47], v[60:63], v[56:59]
v_max3_u32 v16, v16, v44, v45
v_max3_u32 v16, v16, v46, v47
v_cmp_le_u32 vcc, 0xffff0000, v16
s_cbranch_vccnz L_red0
L_redb0:
s_nop 3
v_permlane32_swap_b32 v56, v58
v_permlane32_swap_b32 v57, v59
v_pk_add_f32 v[56:57], v[56:57], v[58:59]
v_cvt_pk_bf16_f32 v56, v56, v57
buffer_store_dword v56, v11, s[8:11], s34 offen
s_barrier
ds_read_b128 v[40:43], v2 offset:0
ds_read_b128 v[44:47], v2 offset:1024
v_mov_b64 v[32:33], 0
v_mov_b64 v[34:35], 0
v_mov_b64 v[36:37], 0
v_mov_b64 v[38:39], 0
v_mov_b64 v[56:57], 0
v_mov_b64 v[58:59], 0
v_mov_b64 v[60:61], 0
v_mov_b64 v[62:63], 0
s_nop 15
s_nop 13
s_branch L_gat0
L_red0:
L_red0b:
buffer_load_dwordx4 v[32:35], v1, s[8:11], s49 offen offset:0 sc1
buffer_load_dwordx4 v[36:39], v1, s[8:11], s49 offen offset:1024 sc1
buffer_load_dwordx4 v[40:43], v1, s[8:11], s49 offen offset:2048 sc1
buffer_load_dwordx4 v[44:47], v1, s[8:11], s49 offen offset:3072 sc1
s_add_u32 s22, s22, 1
s_cmp_gt_u32 s22, 40000
s_cbranch_scc1 L_end
s_waitcnt vmcnt(3)
v_mfma_f32_16x16x32_bf16 v[56:59], v[32:35], v[60:63], 0
v_max3_u32 v16, v32, v33, v34
v_max_u32 v16, v16, v35
s_waitcnt vmcnt(2)
v_mfma_f32_16x16x32_bf16 v[56:59], v[36:39], v[60:63], v[56:59]
v_max3_u32 v16, v16, v36, v37
v_max3_u32 v16, v16, v38, v39
s_waitcnt vmcnt(1)
v_mfma_f32_16x16x32_bf16 v[56:59], v[40:43], v[60:63], v[56:59]
v_max3_u32 v16, v16, v40, v41
v_max3_u32 v16, v16, v42, v43
s_waitcnt vmcnt(0)
v_mfma_f32_16x16x32_bf16 v[56:59], v[44:47], v[60:63], v[56:59]
v_max3_u32 v16, v16, v44, v45
v_max3_u32 v16, v16, v46, v47
v_cmp_le_u32 vcc, 0xffff0000, v16
s_cbranch_vccz L_redb0
s_branch L_red0b
L_ent1:
v_mov_b64 v[24:25], 0
v_mov_b64 v[26:27], 0
v_mov_b64 v[28:29], 0
v_mov_b64 v[30:31], 0
v_and_b32 v69, 0x380, v1
v_add_u32 v69, v69, v1
v_and_b32 v70, 0xf00, v1
v_add_u32 v70, v70, v1
v_mov_b64 v[64:65], -1
v_mov_b64 v[66:67], -1
v_xor_b32 v3, 16, v4
ds_read_b128 v[48:51], v2 offset:10240
ds_read_b128 v[52:55], v2 offset:11264
ds_read_b128 v[40:43], v2 offset:2048
ds_read_b128 v[44:47], v2 offset:3072
v_mov_b64 v[32:33], 0
v_mov_b64 v[34:35], 0
v_mov_b64 v[36:37], 0
v_mov_b64 v[38:39], 0
v_mov_b64 v[56:57], 0
v_mov_b64 v[58:59], 0
v_mov_b64 v[60:61], 0
v_mov_b64 v[62:63], 0
s_add_u32 s20, s30, 1024
s_add_u32 s21, s30, 8192
s_add_u32 s49, s29, s25
s_add_u32 s50, s29, s26
s_add_u32 s51, s29, s27
s_add_u32 s52, s30, 16384
s_mov_b32 m0, 17920
s_waitcnt vmcnt(0) lgkmcnt(0)
s_branch L_step1
L_gr1:
buffer_load_dwordx4 v[12:15], v1, s[8:11], s33 offen sc1
buffer_load_dword v20, v8, s[8:11], s7 offen sc1
buffer_load_dwordx4 v[16:19], v1, s[8:11], s6 offen sc1
s_add_u32 s22, s22, 1
s_cmp_gt_u32 s22, 40000
s_cbranch_scc1 L_end
s_nop 0
v_mov_b64 v[24:25], 0
v_mov_b64 v[26:27], 0
v_mov_b64 v[28:29], 0
v_mov_b64 v[30:31], 0
v_mov_b64 v[32:33], 0
v_mov_b64 v[34:35], 0
v_mov_b64 v[36:37], 0
v_mov_b64 v[38:39], 0
v_mov_b64 v[56:57], 0
v_mov_b64 v[58:59], 0
v_mov_b64 v[60:61], 0
v_mov_b64 v[62:63], 0
s_waitcnt lgkmcnt(0)
s_branch L_step1
.p2align 3
L_gat1:
buffer_load_dwordx4 v[12:15], v1, s[8:11], s33 offen sc1
buffer_load_dword v20, v8, s[8:11], s7 offen sc1
buffer_load_dwordx4 v[16:19], v1, s[8:11], s6 offen sc1
s_add_u32 s20, s30, 1024
s_add_u32 s21, s30, 8192
s_add_u32 s49, s29, s25
s_add_u32 s50, s29, s26
s_add_u32 s51, s29, s27
s_add_u32 s52, s30, 16384
s_mov_b32 m0, 17920
s_waitcnt lgkmcnt(0)
L_step1:
s_waitcnt vmcnt(2)
v_smfmac_f32_16x16x64_bf16 v[24:27], v[12:15], v[96:103], v0
ds_write_b128 v1, v[12:15] offset:6656
v_smfmac_f32_16x16x64_bf16 v[28:31], v[12:15], v[104:111], v0
s_waitcnt vmcnt(1)
ds_write_b32 v8, v20 offset:14848
v_smfmac_f32_16x16x64_bf16 v[32:35], v[12:15], v[112:119], v0
s_waitcnt vmcnt(0)
ds_write_b128 v1, v[16:19] offset:10752
v_smfmac_f32_16x16x64_bf16 v[56:59], v[12:15], a[48:55], v0
v_max3_u32 v21, v12, v13, v14
v_max3_u32 v21, v21, v15, v20
v_smfmac_f32_16x16x64_bf16 v[60:63], v[12:15], a[56:63], v0
v_max3_u32 v21, v21, v16, v17
v_max3_u32 v21, v21, v18, v19
v_smfmac_f32_16x16x64_bf16 v[36:39], v[12:15], v[40:47], v0
v_cmp_le_u32 vcc, 0xffff0000, v21
v_smfmac_f32_16x16x64_bf16 v[24:27], v[16:19], v[192:199], v0
s_cbranch_vccnz L_gr1
v_smfmac_f32_16x16x64_bf16 v[28:31], v[16:19], v[200:207], v0
s_waitcnt lgkmcnt(0)
s_barrier
ds_read_b128 v[20:23], v1 offset:5632
v_smfmac_f32_16x16x64_bf16 v[32:35], v[16:19], v[208:215], v0
ds_read_b128 v[12:15], v1 offset:7680
buffer_load_dwordx4 v69, s[8:11], s20 offen sc1 lds
v_smfmac_f32_16x16x64_bf16 v[56:59], v[16:19], a[112:119], v0
ds_read_b128 v[40:43], v2 offset:0
s_mov_b32 m0, 18816
v_smfmac_f32_16x16x64_bf16 v[60:63], v[16:19], a[120:127], v0
ds_read_b128 v[44:47], v2 offset:1024
v_smfmac_f32_16x16x64_bf16 v[36:39], v[16:19], v[48:55], v0
ds_read_b128 v[16:19], v1 offset:8704
s_waitcnt lgkmcnt(4)
v_smfmac_f32_16x16x64_bf16 v[24:27], v[20:23], v[72:79], v0
ds_read_b128 v[48:51], v2 offset:4096
buffer_load_dwordx4 v69, s[8:11], s20 offen offset:128 sc1 lds
v_smfmac_f32_16x16x64_bf16 v[28:31], v[20:23], v[80:87], v0
ds_read_b128 v[52:55], v2 offset:5120
s_mov_b32 m0, 6272
v_smfmac_f32_16x16x64_bf16 v[32:35], v[20:23], v[88:95], v0
buffer_store_dword v0, v11, s[8:11], s35 offen
s_waitcnt lgkmcnt(3)
v_smfmac_f32_16x16x64_bf16 v[36:39], v[20:23], v[40:47], v0
ds_read_b128 v[20:23], v1 offset:9728
v_smfmac_f32_16x16x64_bf16 v[24:27], v[12:15], v[120:127], v0
ds_read_b128 v[40:43], v2 offset:6144
v_smfmac_f32_16x16x64_bf16 v[28:31], v[12:15], v[128:135], v0
ds_read_b128 v[44:47], v2 offset:7168
buffer_store_dwordx4 v[64:67], v1, s[8:11], s49 offen
v_smfmac_f32_16x16x64_bf16 v[32:35], v[12:15], v[136:143], v0
s_waitcnt lgkmcnt(3)
v_smfmac_f32_16x16x64_bf16 v[36:39], v[12:15], v[48:55], v0
ds_read_b128 v[12:15], v1 offset:11776
v_smfmac_f32_16x16x64_bf16 v[24:27], v[16:19], v[144:151], v0
ds_read_b128 v[48:51], v2 offset:8192
v_smfmac_f32_16x16x64_bf16 v[28:31], v[16:19], v[152:159], v0
ds_read_b128 v[52:55], v2 offset:9216
buffer_store_dwordx4 v[64:67], v1, s[8:11], s50 offen
v_smfmac_f32_16x16x64_bf16 v[32:35], v[16:19], v[160:167], v0
s_waitcnt lgkmcnt(3)
v_smfmac_f32_16x16x64_bf16 v[36:39], v[16:19], v[40:47], v0
ds_read_b128 v[16:19], v1 offset:12800
v_smfmac_f32_16x16x64_bf16 v[24:27], v[20:23], v[168:175], v0
ds_read_b128 v[40:43], v2 offset:12288
v_smfmac_f32_16x16x64_bf16 v[28:31], v[20:23], v[176:183], v0
ds_read_b128 v[44:47], v2 offset:13312
buffer_store_dwordx4 v[64:67], v1, s[8:11], s51 offen
v_smfmac_f32_16x16x64_bf16 v[32:35], v[20:23], v[184:191], v0
s_waitcnt lgkmcnt(3)
v_smfmac_f32_16x16x64_bf16 v[36:39], v[20:23], v[48:55], v0
ds_read_b128 v[20:23], v1 offset:13824
v_smfmac_f32_16x16x64_bf16 v[24:27], v[12:15], v[216:223], v0
ds_read_b128 v[48:51], v2 offset:14336
buffer_load_dwordx4 v[64:67], v70, s[8:11], s21 offen sc1
v_smfmac_f32_16x16x64_bf16 v[28:31], v[12:15], v[224:231], v0
ds_read_b128 v[52:55], v2 offset:15360
v_smfmac_f32_16x16x64_bf16 v[32:35], v[12:15], v[232:239], v0
s_waitcnt lgkmcnt(3)
v_smfmac_f32_16x16x64_bf16 v[36:39], v[12:15], v[40:47], v0
ds_read_b128 v[12:15], v1 offset:5632
v_smfmac_f32_16x16x64_bf16 v[24:27], v[16:19], v[240:247], v0
ds_read_b128 v[40:43], v2 offset:16384
buffer_load_dwordx4 v[68:71], v70, s[8:11], s21 offen offset:256 sc1
v_smfmac_f32_16x16x64_bf16 v[28:31], v[16:19], v[248:255], v0
ds_read_b128 v[44:47], v2 offset:17408
v_smfmac_f32_16x16x64_bf16 v[32:35], v[16:19], a[0:7], v0
s_waitcnt lgkmcnt(3)
v_smfmac_f32_16x16x64_bf16 v[36:39], v[16:19], v[48:55], v0
ds_read_b128 v[16:19], v1 offset:7680
v_smfmac_f32_16x16x64_bf16 v[24:27], v[20:23], a[8:15], v0
v_smfmac_f32_16x16x64_bf16 v[28:31], v[20:23], a[16:23], v0
buffer_load_dword v6, s[8:11], s52 offen sc1 lds
v_smfmac_f32_16x16x64_bf16 v[32:35], v[20:23], a[24:31], v0
s_waitcnt lgkmcnt(1)
v_smfmac_f32_16x16x64_bf16 v[36:39], v[20:23], v[40:47], v0
ds_read_b128 v[20:23], v1 offset:8704
v_smfmac_f32_16x16x64_bf16 v[56:59], v[12:15], a[32:39], v0
s_nop 0
v_add_f32 v24, v24, v25
v_add_f32 v26, v26, v27
v_add_f32 v28, v28, v29
v_add_f32 v30, v30, v31
v_cvt_pk_bf16_f32 v24, v24, v28
v_cvt_pk_bf16_f32 v26, v26, v30
ds_write_b32 v4, v24 offset:2176
v_add_f32 v32, v32, v33
v_add_f32 v34, v34, v35
v_add_f32 v36, v36, v37
v_add_f32 v38, v38, v39
ds_write_b32 v3, v26 offset:2176
v_cvt_pk_bf16_f32 v32, v32, v36
v_cvt_pk_bf16_f32 v34, v34, v38
ds_write_b32 v4, v32
v_smfmac_f32_16x16x64_bf16 v[60:63], v[12:15], a[40:47], v0
ds_write_b32 v3, v34
s_waitcnt lgkmcnt(5)
v_smfmac_f32_16x16x64_bf16 v[56:59], v[16:19], a[64:71], v0
ds_read_b128 v[12:15], v1 offset:9728
v_smfmac_f32_16x16x64_bf16 v[60:63], v[16:19], a[72:79], v0
ds_read_b128 v[16:19], v1 offset:11776
s_waitcnt lgkmcnt(6)
v_smfmac_f32_16x16x64_bf16 v[56:59], v[20:23], a[80:87], v0
s_waitcnt lgkmcnt(2) vmcnt(7)
s_barrier
ds_read_b128 v[28:31], v5 offset:512
v_smfmac_f32_16x16x64_bf16 v[60:63], v[20:23], a[88:95], v0
ds_read_b128 v[20:23], v1 offset:12800
s_waitcnt lgkmcnt(3)
v_smfmac_f32_16x16x64_bf16 v[56:59], v[12:15], a[96:103], v0
ds_read_b128 v[44:47], v1 offset:16896
v_smfmac_f32_16x16x64_bf16 v[60:63], v[12:15], a[104:111], v0
ds_read_b128 v[12:15], v1 offset:13824
s_waitcnt lgkmcnt(4)
v_smfmac_f32_16x16x64_bf16 v[56:59], v[16:19], a[128:135], v0
ds_read_b128 v[32:35], v5 offset:1024
v_smfmac_f32_16x16x64_bf16 v[60:63], v[16:19], a[136:143], v0
ds_read_b128 v[48:51], v1 offset:18944
s_waitcnt lgkmcnt(4)
v_smfmac_f32_16x16x64_bf16 v[56:59], v[20:23], a[144:151], v0
ds_read_b128 v[36:39], v5 offset:1536
v_smfmac_f32_16x16x64_bf16 v[60:63], v[20:23], a[152:159], v0
ds_read_b128 v[52:55], v1 offset:20992
s_mov_b64 exec, s[86:87]
buffer_store_dwordx4 v[28:31], v5, s[8:11], s31 offen offset:512 sc1
s_mov_b64 exec, -1
s_waitcnt lgkmcnt(4)
v_smfmac_f32_16x16x64_bf16 v[56:59], v[12:15], a[160:167], v0
ds_read_b128 v[24:27], v5 offset:0
v_smfmac_f32_16x16x64_bf16 v[60:63], v[12:15], a[168:175], v0
ds_read_b128 v[40:43], v1 offset:14848
v_mfma_f32_16x16x32_bf16 v[16:19], v[44:47], v[28:31], 0
ds_read_b128 v[44:47], v1 offset:17920
s_waitcnt lgkmcnt(5)
v_mfma_f32_16x16x32_bf16 v[16:19], v[48:51], v[32:35], v[16:19]
ds_read_b128 v[48:51], v1 offset:19968
s_waitcnt lgkmcnt(4)
v_mfma_f32_16x16x32_bf16 v[16:19], v[52:55], v[36:39], v[16:19]
ds_read_b128 v[52:55], v1 offset:22016
s_waitcnt lgkmcnt(3)
v_mfma_f32_16x16x32_bf16 v[16:19], v[40:43], v[24:27], v[16:19]
ds_read_b128 v[40:43], v1 offset:15872
v_mfma_f32_16x16x32_bf16 v[20:23], v[28:31], v[28:31], 0
v_add_f32 v56, v56, v57
v_add_f32 v58, v58, v59
v_mfma_f32_16x16x32_bf16 v[20:23], v[32:35], v[32:35], v[20:23]
v_add_f32 v60, v60, v61
v_add_f32 v62, v62, v63
v_mfma_f32_16x16x32_bf16 v[20:23], v[36:39], v[36:39], v[20:23]
v_cvt_pk_bf16_f32 v56, v56, v58
v_cvt_pk_bf16_f32 v57, v60, v62
v_mfma_f32_16x16x32_bf16 v[20:23], v[24:27], v[24:27], v[20:23]
v_lshrrev_b32 v58, 1, v1
v_max3_f32 v59, v16, v17, v18
s_waitcnt lgkmcnt(3)
v_mfma_f32_16x16x32_bf16 v[12:15], v[44:47], v[28:31], 0
ds_read_b128 v[44:47], v2 offset:19456
s_waitcnt lgkmcnt(3)
v_mfma_f32_16x16x32_bf16 v[12:15], v[48:51], v[32:35], v[12:15]
ds_read_b128 v[48:51], v2 offset:20480
buffer_store_dwordx2 v[56:57], v58, s[8:11], s31 offen offset:2048 sc1
s_waitcnt lgkmcnt(3)
v_mfma_f32_16x16x32_bf16 v[12:15], v[52:55], v[36:39], v[12:15]
ds_read_b128 v[52:55], v2 offset:21504
v_max3_f32 v59, v59, v19, v20
v_max_f32 v59, v59, v21
s_waitcnt lgkmcnt(3)
v_mfma_f32_16x16x32_bf16 v[12:15], v[40:43], v[24:27], v[12:15]
ds_read_b128 v[40:43], v2 offset:18432
v_mov_b32 v60, s53
s_add_u32 s49, s28, s23
v_mov_b32 v61, s53
s_add_u32 s50, s28, 65536
v_mov_b32 v62, s53
ds_read_b128 v[32:35], v2 offset:22528
v_mov_b32 v63, s53
v_max3_f32 v59, v59, v12, v13
v_max3_f32 v22, v59, v14, v15
v_max3_f32 v59, v59, v14, v15
s_add_u32 s51, s28, 131072
s_add_u32 s52, s28, 196608
v_permlane32_swap_b32 v22, v59
v_max_f32 v23, v59, v22
v_max_f32 v59, v59, v22
v_mov_b32 v22, 0
ds_read_b128 v[36:39], v2 offset:23552
v_permlane16_swap_b32 v23, v59
v_max_f32 v59, v59, v23
v_mul_f32 v58, s18, v59
v_pk_fma_f32 v[20:21], v[20:21], s[18:19], v[58:59] op_sel_hi:[1,0,0] neg_lo:[0,0,1] neg_hi:[0,0,1]
v_pk_fma_f32 v[16:17], v[16:17], s[18:19], v[58:59] op_sel_hi:[1,0,0] neg_lo:[0,0,1] neg_hi:[0,0,1]
v_pk_fma_f32 v[18:19], v[18:19], s[18:19], v[58:59] op_sel_hi:[1,0,0] neg_lo:[0,0,1] neg_hi:[0,0,1]
v_pk_fma_f32 v[12:13], v[12:13], s[18:19], v[58:59] op_sel_hi:[1,0,0] neg_lo:[0,0,1] neg_hi:[0,0,1]
v_pk_fma_f32 v[14:15], v[14:15], s[18:19], v[58:59] op_sel_hi:[1,0,0] neg_lo:[0,0,1] neg_hi:[0,0,1]
v_exp_f32 v20, v20
v_exp_f32 v21, v21
v_exp_f32 v16, v16
v_cvt_pk_bf16_f32 v23, v20, v21
v_cvt_pk_bf16_f32 v20, v20, v21
v_mov_b32 v21, 0
v_exp_f32 v17, v17
v_exp_f32 v18, v18
v_mfma_f32_16x16x16_bf16 v[24:27], v[56:57], v[20:21], 0
v_exp_f32 v19, v19
v_mfma_f32_16x16x16_bf16 v[28:31], v[56:57], v[22:23], 0
v_exp_f32 v12, v12
v_exp_f32 v13, v13
v_cvt_pk_bf16_f32 v16, v16, v17
v_cvt_pk_bf16_f32 v17, v18, v19
v_exp_f32 v14, v14
v_exp_f32 v15, v15
v_cvt_pk_bf16_f32 v18, v12, v13
v_cvt_pk_bf16_f32 v19, v14, v15
v_mfma_f32_16x16x16_bf16 v[12:15], v[60:61], v[20:21], 0
s_waitcnt vmcnt(3)
v_mfma_f32_16x16x32_bf16 v[12:15], v[60:63], v[16:19], v[12:15]
v_mov_b32 v20, 0
v_mov_b32 v23, 0
v_mfma_f32_16x16x32_bf16 v[24:27], v[64:67], v[16:19], v[24:27]
s_nop 1
v_mfma_f32_16x16x32_bf16 v[28:31], v[68:71], v[16:19], v[28:31]
v_mov_b32 v16, 0
v_mov_b32 v17, 0
v_rcp_f32 v12, v12
v_mov_b32 v18, 0
v_mov_b32 v19, 0
v_pk_mul_f32 v[24:25], v[24:25], v[12:13] op_sel_hi:[1,0]
v_pk_mul_f32 v[26:27], v[26:27], v[12:13] op_sel_hi:[1,0]
v_mov_b32 v15, 0
v_pk_mul_f32 v[28:29], v[28:29], v[12:13] op_sel_hi:[1,0]
v_pk_mul_f32 v[30:31], v[30:31], v[12:13] op_sel_hi:[1,0]
v_cvt_pk_bf16_f32 v24, v24, v28
v_cvt_pk_bf16_f32 v25, v25, v29
v_cvt_pk_bf16_f32 v26, v26, v30
v_cvt_pk_bf16_f32 v27, v27, v31
v_mfma_f32_16x16x32_bf16 v[56:59], v[20:23], v[20:23], 0
ds_write_b128 v7, v[24:27]
v_mfma_f32_16x16x32_bf16 v[60:63], v[20:23], v[20:23], 0
v_mov_b32 v12, 0
v_mov_b32 v13, 0
v_mov_b32 v14, 0
v_mov_b32 v3, 6528
s_nop 1
v_mfma_f32_16x16x32_bf16 v[64:67], v[20:23], v[20:23], 0
s_cmp_eq_u32 s19, 63
s_cbranch_scc1 L_texit
s_waitcnt lgkmcnt(0)
s_barrier
ds_read_b128 v[24:27], v1 offset:3200
v_mfma_f32_16x16x32_bf16 v[68:71], v[20:23], v[20:23], 0
ds_read_b128 v[28:31], v1 offset:4224
s_nop 2
v_mfma_f32_16x16x32_bf16 v[68:71], v[20:23], v[20:23], 0
s_waitcnt lgkmcnt(1)
v_smfmac_f32_16x16x64_bf16 v[12:15], v[24:27], a[248:255], v0
v_smfmac_f32_16x16x64_bf16 v[16:19], v[24:27], a[176:183], v0
s_waitcnt lgkmcnt(0)
v_smfmac_f32_16x16x64_bf16 v[12:15], v[28:31], v[40:47], v0
ds_read_b128 v[40:43], v2 offset:24576
v_smfmac_f32_16x16x64_bf16 v[16:19], v[28:31], v[48:55], v0
ds_read_b128 v[44:47], v2 offset:25600
v_smfmac_f32_16x16x64_bf16 v[20:23], v[24:27], a[184:191], v0
ds_read_b128 v[48:51], v2 offset:26624
v_smfmac_f32_16x16x64_bf16 v[20:23], v[28:31], v[32:39], v0
ds_read_b128 v[52:55], v2 offset:27648
s_nop 0
v_add_f32 v12, v12, v13
v_add_f32 v14, v14, v15
v_smfmac_f32_16x16x64_bf16 v[56:59], v[24:27], a[192:199], v0
ds_read_b128 v[32:35], v2 offset:28672
s_waitcnt lgkmcnt(3)
v_cvt_pk_bf16_f32 v12, v12, v14
buffer_store_dword v12, v10, s[8:11], s28 offen
v_smfmac_f32_16x16x64_bf16 v[56:59], v[28:31], v[40:47], v0
ds_read_b128 v[36:39], v2 offset:29696
v_add_f32 v16, v16, v17
v_add_f32 v18, v18, v19
v_smfmac_f32_16x16x64_bf16 v[60:63], v[24:27], a[200:207], v0
ds_read_b128 v[12:15], v3
s_waitcnt lgkmcnt(3)
v_cvt_pk_bf16_f32 v16, v16, v18
v_add_f32 v20, v20, v21
v_smfmac_f32_16x16x64_bf16 v[60:63], v[28:31], v[48:55], v0
ds_read_b128 v[40:43], v2 offset:30720
v_add_f32 v22, v22, v23
v_cvt_pk_bf16_f32 v17, v20, v22
v_smfmac_f32_16x16x64_bf16 v[64:67], v[24:27], a[208:215], v0
ds_read_b128 v[44:47], v2 offset:31744
s_waitcnt lgkmcnt(3)
buffer_store_dwordx2 v[16:17], v9, s[8:11], s28 offen
v_add_f32 v56, v56, v57
v_smfmac_f32_16x16x64_bf16 v[64:67], v[28:31], v[32:39], v0
ds_read_b128 v[48:51], v2 offset:32768
v_add_f32 v58, v58, v59
v_cvt_pk_bf16_f32 v56, v56, v58
v_smfmac_f32_16x16x64_bf16 v[68:71], v[24:27], a[216:223], v0
ds_read_b128 v[52:55], v2 offset:33792
s_waitcnt lgkmcnt(2)
v_add_f32 v60, v60, v61
v_add_f32 v62, v62, v63
v_smfmac_f32_16x16x64_bf16 v[68:71], v[28:31], v[40:47], v0
ds_read_b128 v[20:23], v3
v_cvt_pk_bf16_f32 v57, v60, v62
buffer_store_dwordx2 v[56:57], v9, s[8:11], s50 offen
v_smfmac_f32_16x16x64_bf16 v[12:15], v[24:27], a[224:231], v0
s_waitcnt lgkmcnt(1)
v_add_f32 v64, v64, v65
v_add_f32 v66, v66, v67
v_smfmac_f32_16x16x64_bf16 v[12:15], v[28:31], v[48:55], v0
s_waitcnt lgkmcnt(0)
v_cvt_pk_bf16_f32 v64, v64, v66
v_smfmac_f32_16x16x64_bf16 v[20:23], v[24:27], a[232:239], v0
v_add_f32 v68, v68, v69
v_add_f32 v70, v70, v71
v_smfmac_f32_16x16x64_bf16 v[20:23], v[28:31], a[240:247], v0
v_cvt_pk_bf16_f32 v65, v68, v70
buffer_store_dwordx2 v[64:65], v9, s[8:11], s51 offen
v_add_f32 v12, v12, v13
v_add_f32 v14, v14, v15
v_cvt_pk_bf16_f32 v12, v12, v14
s_nop 2
v_add_f32 v20, v20, v21
v_add_f32 v22, v22, v23
v_cvt_pk_bf16_f32 v13, v20, v22
buffer_store_dwordx2 v[12:13], v9, s[8:11], s52 offen
s_add_u32 s19, s19, 1
s_mov_b32 s20, s28
s_mov_b32 s28, s29
s_mov_b32 s29, s20
s_and_b32 s20, s19, 3
s_lshl_b32 s20, s20, 14
s_add_u32 s33, s20, 110100480
s_add_u32 s34, s20, s24
s_xor_b32 s20, s20, 32768
s_add_u32 s35, s20, s24
s_add_u32 s30, s30, 16384
s_add_u32 s31, s31, 131072
s_add_u32 s6, s33, 4096
s_add_u32 s7, s33, 8192
s_mov_b32 s22, 0
v_mov_b64 v[24:25], 0
v_mov_b64 v[26:27], 0
v_mov_b64 v[28:29], 0
v_mov_b64 v[30:31], 0
v_and_b32 v69, 0x380, v1
v_add_u32 v69, v69, v1
v_and_b32 v70, 0xf00, v1
v_add_u32 v70, v70, v1
v_mov_b64 v[64:65], -1
v_mov_b64 v[66:67], -1
v_xor_b32 v3, 16, v4
ds_read_b128 v[48:51], v2 offset:10240
ds_read_b128 v[52:55], v2 offset:11264
v_mov_b32 v56, 0x3f80
v_cndmask_b32 v56, v56, 1.0, s[44:45]
v_cndmask_b32 v60, 0, v56, s[36:37]
v_cndmask_b32 v61, 0, v56, s[38:39]
v_cndmask_b32 v62, 0, v56, s[40:41]
v_cndmask_b32 v63, 0, v56, s[42:43]
s_nop 5
buffer_load_dwordx4 v[32:35], v1, s[8:11], s49 offen offset:0 sc1
buffer_load_dwordx4 v[36:39], v1, s[8:11], s49 offen offset:1024 sc1
buffer_load_dwordx4 v[40:43], v1, s[8:11], s49 offen offset:2048 sc1
buffer_load_dwordx4 v[44:47], v1, s[8:11], s49 offen offset:3072 sc1
s_waitcnt vmcnt(3)
v_mfma_f32_16x16x32_bf16 v[56:59], v[32:35], v[60:63], 0
v_max3_u32 v16, v32, v33, v34
v_max_u32 v16, v16, v35
s_waitcnt vmcnt(2)
v_mfma_f32_16x16x32_bf16 v[56:59], v[36:39], v[60:63], v[56:59]
v_max3_u32 v16, v16, v36, v37
v_max3_u32 v16, v16, v38, v39
s_waitcnt vmcnt(1)
v_mfma_f32_16x16x32_bf16 v[56:59], v[40:43], v[60:63], v[56:59]
v_max3_u32 v16, v16, v40, v41
v_max3_u32 v16, v16, v42, v43
s_waitcnt vmcnt(0)
v_mfma_f32_16x16x32_bf16 v[56:59], v[44:47], v[60:63], v[56:59]
v_max3_u32 v16, v16, v44, v45
v_max3_u32 v16, v16, v46, v47
v_cmp_le_u32 vcc, 0xffff0000, v16
s_cbranch_vccnz L_red1
L_redb1:
s_nop 3
v_permlane32_swap_b32 v56, v58
v_permlane32_swap_b32 v57, v59
v_pk_add_f32 v[56:57], v[56:57], v[58:59]
v_cvt_pk_bf16_f32 v56, v56, v57
buffer_store_dword v56, v11, s[8:11], s34 offen
s_barrier
ds_read_b128 v[40:43], v2 offset:2048
ds_read_b128 v[44:47], v2 offset:3072
v_mov_b64 v[32:33], 0
v_mov_b64 v[34:35], 0
v_mov_b64 v[36:37], 0
v_mov_b64 v[38:39], 0
v_mov_b64 v[56:57], 0
v_mov_b64 v[58:59], 0
v_mov_b64 v[60:61], 0
v_mov_b64 v[62:63], 0
s_nop 15
s_nop 13
s_branch L_gat1
L_red1:
L_red1b:
buffer_load_dwordx4 v[32:35], v1, s[8:11], s49 offen offset:0 sc1
buffer_load_dwordx4 v[36:39], v1, s[8:11], s49 offen offset:1024 sc1
buffer_load_dwordx4 v[40:43], v1, s[8:11], s49 offen offset:2048 sc1
buffer_load_dwordx4 v[44:47], v1, s[8:11], s49 offen offset:3072 sc1
s_add_u32 s22, s22, 1
s_cmp_gt_u32 s22, 40000
s_cbranch_scc1 L_end
s_waitcnt vmcnt(3)
v_mfma_f32_16x16x32_bf16 v[56:59], v[32:35], v[60:63], 0
v_max3_u32 v16, v32, v33, v34
v_max_u32 v16, v16, v35
s_waitcnt vmcnt(2)
v_mfma_f32_16x16x32_bf16 v[56:59], v[36:39], v[60:63], v[56:59]
v_max3_u32 v16, v16, v36, v37
v_max3_u32 v16, v16, v38, v39
s_waitcnt vmcnt(1)
v_mfma_f32_16x16x32_bf16 v[56:59], v[40:43], v[60:63], v[56:59]
v_max3_u32 v16, v16, v40, v41
v_max3_u32 v16, v16, v42, v43
s_waitcnt vmcnt(0)
v_mfma_f32_16x16x32_bf16 v[56:59], v[44:47], v[60:63], v[56:59]
v_max3_u32 v16, v16, v44, v45
v_max3_u32 v16, v16, v46, v47
v_cmp_le_u32 vcc, 0xffff0000, v16
s_cbranch_vccz L_redb1
s_branch L_red1b
L_ent2:
v_mov_b64 v[24:25], 0
v_mov_b64 v[26:27], 0
v_mov_b64 v[28:29], 0
v_mov_b64 v[30:31], 0
v_and_b32 v69, 0x380, v1
v_add_u32 v69, v69, v1
v_and_b32 v70, 0xf00, v1
v_add_u32 v70, v70, v1
v_mov_b64 v[64:65], -1
v_mov_b64 v[66:67], -1
v_xor_b32 v3, 16, v4
ds_read_b128 v[48:51], v2 offset:12288
ds_read_b128 v[52:55], v2 offset:13312
ds_read_b128 v[40:43], v2 offset:4096
ds_read_b128 v[44:47], v2 offset:5120
v_mov_b64 v[32:33], 0
v_mov_b64 v[34:35], 0
v_mov_b64 v[36:37], 0
v_mov_b64 v[38:39], 0
v_mov_b64 v[56:57], 0
v_mov_b64 v[58:59], 0
v_mov_b64 v[60:61], 0
v_mov_b64 v[62:63], 0
s_add_u32 s20, s30, 2048
s_add_u32 s21, s30, 8192
s_add_u32 s49, s29, s25
s_add_u32 s50, s29, s26
s_add_u32 s51, s29, s27
s_add_u32 s52, s30, 16384
s_mov_b32 m0, 19968
s_waitcnt vmcnt(0) lgkmcnt(0)
s_branch L_step2
L_gr2:
buffer_load_dwordx4 v[12:15], v1, s[8:11], s33 offen sc1
buffer_load_dword v20, v8, s[8:11], s7 offen sc1
buffer_load_dwordx4 v[16:19], v1, s[8:11], s6 offen sc1
s_add_u32 s22, s22, 1
s_cmp_gt_u32 s22, 40000
s_cbranch_scc1 L_end
s_nop 0
v_mov_b64 v[24:25], 0
v_mov_b64 v[26:27], 0
v_mov_b64 v[28:29], 0
v_mov_b64 v[30:31], 0
v_mov_b64 v[32:33], 0
v_mov_b64 v[34:35], 0
v_mov_b64 v[36:37], 0
v_mov_b64 v[38:39], 0
v_mov_b64 v[56:57], 0
v_mov_b64 v[58:59], 0
v_mov_b64 v[60:61], 0
v_mov_b64 v[62:63], 0
s_waitcnt lgkmcnt(0)
s_branch L_step2
.p2align 3
L_gat2:
buffer_load_dwordx4 v[12:15], v1, s[8:11], s33 offen sc1
buffer_load_dword v20, v8, s[8:11], s7 offen sc1
buffer_load_dwordx4 v[16:19], v1, s[8:11], s6 offen sc1
s_add_u32 s20, s30, 2048
s_add_u32 s21, s30, 8192
s_add_u32 s49, s29, s25
s_add_u32 s50, s29, s26
s_add_u32 s51, s29, s27
s_add_u32 s52, s30, 16384
s_mov_b32 m0, 19968
s_waitcnt lgkmcnt(0)
L_step2:
s_waitcnt vmcnt(2)
v_smfmac_f32_16x16x64_bf16 v[24:27], v[12:15], v[120:127], v0
ds_write_b128 v1, v[12:15] offset:6656
v_smfmac_f32_16x16x64_bf16 v[28:31], v[12:15], v[128:135], v0
s_waitcnt vmcnt(1)
ds_write_b32 v8, v20 offset:14848
v_smfmac_f32_16x16x64_bf16 v[32:35], v[12:15], v[136:143], v0
s_waitcnt vmcnt(0)
ds_write_b128 v1, v[16:19] offset:10752
v_smfmac_f32_16x16x64_bf16 v[56:59], v[12:15], a[64:71], v0
v_max3_u32 v21, v12, v13, v14
v_max3_u32 v21, v21, v15, v20
v_smfmac_f32_16x16x64_bf16 v[60:63], v[12:15], a[72:79], v0
v_max3_u32 v21, v21, v16, v17
v_max3_u32 v21, v21, v18, v19
v_smfmac_f32_16x16x64_bf16 v[36:39], v[12:15], v[40:47], v0
v_cmp_le_u32 vcc, 0xffff0000, v21
v_smfmac_f32_16x16x64_bf16 v[24:27], v[16:19], v[216:223], v0
s_cbranch_vccnz L_gr2
v_smfmac_f32_16x16x64_bf16 v[28:31], v[16:19], v[224:231], v0
s_waitcnt lgkmcnt(0)
s_barrier
ds_read_b128 v[20:23], v1 offset:4608
v_smfmac_f32_16x16x64_bf16 v[32:35], v[16:19], v[232:239], v0
ds_read_b128 v[12:15], v1 offset:5632
buffer_load_dwordx4 v69, s[8:11], s20 offen sc1 lds
v_smfmac_f32_16x16x64_bf16 v[56:59], v[16:19], a[128:135], v0
ds_read_b128 v[40:43], v2 offset:0
s_mov_b32 m0, 20864
v_smfmac_f32_16x16x64_bf16 v[60:63], v[16:19], a[136:143], v0
ds_read_b128 v[44:47], v2 offset:1024
v_smfmac_f32_16x16x64_bf16 v[36:39], v[16:19], v[48:55], v0
ds_read_b128 v[16:19], v1 offset:7680
s_waitcnt lgkmcnt(4)
v_smfmac_f32_16x16x64_bf16 v[24:27], v[20:23], v[72:79], v0
ds_read_b128 v[48:51], v2 offset:2048
buffer_load_dwordx4 v69, s[8:11], s20 offen offset:128 sc1 lds
v_smfmac_f32_16x16x64_bf16 v[28:31], v[20:23], v[80:87], v0
ds_read_b128 v[52:55], v2 offset:3072
s_mov_b32 m0, 6272
v_smfmac_f32_16x16x64_bf16 v[32:35], v[20:23], v[88:95], v0
buffer_store_dword v0, v11, s[8:11], s35 offen
s_waitcnt lgkmcnt(3)
v_smfmac_f32_16x16x64_bf16 v[36:39], v[20:23], v[40:47], v0
ds_read_b128 v[20:23], v1 offset:8704
v_smfmac_f32_16x16x64_bf16 v[24:27], v[12:15], v[96:103], v0
ds_read_b128 v[40:43], v2 offset:6144
v_smfmac_f32_16x16x64_bf16 v[28:31], v[12:15], v[104:111], v0
ds_read_b128 v[44:47], v2 offset:7168
v_smfmac_f32_16x16x64_bf16 v[32:35], v[12:15], v[112:119], v0
buffer_store_dwordx4 v[64:67], v1, s[8:11], s49 offen
s_waitcnt lgkmcnt(3)
v_smfmac_f32_16x16x64_bf16 v[36:39], v[12:15], v[48:55], v0
ds_read_b128 v[12:15], v1 offset:9728
v_smfmac_f32_16x16x64_bf16 v[24:27], v[16:19], v[144:151], v0
ds_read_b128 v[48:51], v2 offset:8192
v_smfmac_f32_16x16x64_bf16 v[28:31], v[16:19], v[152:159], v0
ds_read_b128 v[52:55], v2 offset:9216
v_smfmac_f32_16x16x64_bf16 v[32:35], v[16:19], v[160:167], v0
buffer_store_dwordx4 v[64:67], v1, s[8:11], s50 offen
s_waitcnt lgkmcnt(3)
v_smfmac_f32_16x16x64_bf16 v[36:39], v[16:19], v[40:47], v0
ds_read_b128 v[16:19], v1 offset:11776
v_smfmac_f32_16x16x64_bf16 v[24:27], v[20:23], v[168:175], v0
ds_read_b128 v[40:43], v2 offset:10240
v_smfmac_f32_16x16x64_bf16 v[28:31], v[20:23], v[176:183], v0
ds_read_b128 v[44:47], v2 offset:11264
v_smfmac_f32_16x16x64_bf16 v[32:35], v[20:23], v[184:191], v0
buffer_store_dwordx4 v[64:67], v1, s[8:11], s51 offen
s_waitcnt lgkmcnt(3)
v_smfmac_f32_16x16x64_bf16 v[36:39], v[20:23], v[48:55], v0
ds_read_b128 v[20:23], v1 offset:12800
v_smfmac_f32_16x16x64_bf16 v[24:27], v[12:15], v[192:199], v0
ds_read_b128 v[48:51], v2 offset:14336
buffer_load_dwordx4 v[64:67], v70, s[8:11], s21 offen sc1
v_smfmac_f32_16x16x64_bf16 v[28:31], v[12:15], v[200:207], v0
ds_read_b128 v[52:55], v2 offset:15360
v_smfmac_f32_16x16x64_bf16 v[32:35], v[12:15], v[208:215], v0
s_waitcnt lgkmcnt(3)
v_smfmac_f32_16x16x64_bf16 v[36:39], v[12:15], v[40:47], v0
ds_read_b128 v[12:15], v1 offset:4608
v_smfmac_f32_16x16x64_bf16 v[24:27], v[16:19], v[240:247], v0
ds_read_b128 v[40:43], v2 offset:16384
buffer_load_dwordx4 v[68:71], v70, s[8:11], s21 offen offset:256 sc1
v_smfmac_f32_16x16x64_bf16 v[28:31], v[16:19], v[248:255], v0
ds_read_b128 v[44:47], v2 offset:17408
v_smfmac_f32_16x16x64_bf16 v[32:35], v[16:19], a[0:7], v0
s_waitcnt lgkmcnt(3)
v_smfmac_f32_16x16x64_bf16 v[36:39], v[16:19], v[48:55], v0
ds_read_b128 v[16:19], v1 offset:5632
v_smfmac_f32_16x16x64_bf16 v[24:27], v[20:23], a[8:15], v0
v_smfmac_f32_16x16x64_bf16 v[28:31], v[20:23], a[16:23], v0
v_smfmac_f32_16x16x64_bf16 v[32:35], v[20:23], a[24:31], v0
s_waitcnt lgkmcnt(1)
v_smfmac_f32_16x16x64_bf16 v[36:39], v[20:23], v[40:47], v0
ds_read_b128 v[20:23], v1 offset:7680
v_smfmac_f32_16x16x64_bf16 v[56:59], v[12:15], a[32:39], v0
s_nop 1
v_add_f32 v24, v24, v25
v_add_f32 v26, v26, v27
v_add_f32 v28, v28, v29
v_add_f32 v30, v30, v31
v_cvt_pk_bf16_f32 v24, v24, v28
v_cvt_pk_bf16_f32 v26, v26, v30
ds_write_b32 v4, v24 offset:2176
v_add_f32 v32, v32, v33
v_add_f32 v34, v34, v35
v_add_f32 v36, v36, v37
v_add_f32 v38, v38, v39
ds_write_b32 v3, v26 offset:2176
v_cvt_pk_bf16_f32 v32, v32, v36
v_cvt_pk_bf16_f32 v34, v34, v38
ds_write_b32 v4, v32
v_smfmac_f32_16x16x64_bf16 v[60:63], v[12:15], a[40:47], v0
ds_write_b32 v3, v34
s_waitcnt lgkmcnt(5)
v_smfmac_f32_16x16x64_bf16 v[56:59], v[16:19], a[48:55], v0
ds_read_b128 v[12:15], v1 offset:8704
v_smfmac_f32_16x16x64_bf16 v[60:63], v[16:19], a[56:63], v0
ds_read_b128 v[16:19], v1 offset:9728
s_waitcnt lgkmcnt(6)
v_smfmac_f32_16x16x64_bf16 v[56:59], v[20:23], a[80:87], v0
s_waitcnt lgkmcnt(2) vmcnt(6)
s_barrier
ds_read_b128 v[32:35], v5 offset:1024
v_smfmac_f32_16x16x64_bf16 v[60:63], v[20:23], a[88:95], v0
ds_read_b128 v[20:23], v1 offset:11776
s_waitcnt lgkmcnt(3)
v_smfmac_f32_16x16x64_bf16 v[56:59], v[12:15], a[96:103], v0
ds_read_b128 v[48:51], v1 offset:17920
v_smfmac_f32_16x16x64_bf16 v[60:63], v[12:15], a[104:111], v0
ds_read_b128 v[12:15], v1 offset:12800
s_waitcnt lgkmcnt(4)
v_smfmac_f32_16x16x64_bf16 v[56:59], v[16:19], a[112:119], v0
ds_read_b128 v[36:39], v5 offset:1536
v_smfmac_f32_16x16x64_bf16 v[60:63], v[16:19], a[120:127], v0
ds_read_b128 v[52:55], v1 offset:19968
s_waitcnt lgkmcnt(4)
v_smfmac_f32_16x16x64_bf16 v[56:59], v[20:23], a[144:151], v0
ds_read_b128 v[24:27], v5 offset:0
v_smfmac_f32_16x16x64_bf16 v[60:63], v[20:23], a[152:159], v0
ds_read_b128 v[40:43], v1 offset:13824
s_waitcnt lgkmcnt(4)
v_smfmac_f32_16x16x64_bf16 v[56:59], v[12:15], a[160:167], v0
ds_read_b128 v[28:31], v5 offset:512
s_mov_b64 exec, s[86:87]
buffer_store_dwordx4 v[32:35], v5, s[8:11], s31 offen offset:1024 sc1
s_mov_b64 exec, -1
v_smfmac_f32_16x16x64_bf16 v[60:63], v[12:15], a[168:175], v0
ds_read_b128 v[44:47], v1 offset:15872
v_mfma_f32_16x16x32_bf16 v[16:19], v[48:51], v[32:35], 0
ds_read_b128 v[48:51], v1 offset:18944
s_waitcnt lgkmcnt(5)
v_mfma_f32_16x16x32_bf16 v[16:19], v[52:55], v[36:39], v[16:19]
ds_read_b128 v[52:55], v1 offset:20992
s_waitcnt lgkmcnt(4)
v_mfma_f32_16x16x32_bf16 v[16:19], v[40:43], v[24:27], v[16:19]
ds_read_b128 v[40:43], v1 offset:14848
s_waitcnt lgkmcnt(3)
v_mfma_f32_16x16x32_bf16 v[16:19], v[44:47], v[28:31], v[16:19]
ds_read_b128 v[44:47], v1 offset:16896
v_mfma_f32_16x16x32_bf16 v[20:23], v[32:35], v[32:35], 0
v_add_f32 v56, v56, v57
v_add_f32 v58, v58, v59
v_mfma_f32_16x16x32_bf16 v[20:23], v[36:39], v[36:39], v[20:23]
v_add_f32 v60, v60, v61
v_add_f32 v62, v62, v63
v_mfma_f32_16x16x32_bf16 v[20:23], v[24:27], v[24:27], v[20:23]
v_cvt_pk_bf16_f32 v56, v56, v58
v_cvt_pk_bf16_f32 v57, v60, v62
v_mfma_f32_16x16x32_bf16 v[20:23], v[28:31], v[28:31], v[20:23]
v_lshrrev_b32 v58, 1, v1
v_max3_f32 v59, v16, v17, v18
s_waitcnt lgkmcnt(3)
v_mfma_f32_16x16x32_bf16 v[12:15], v[48:51], v[32:35], 0
ds_read_b128 v[48:51], v2 offset:20480
s_waitcnt lgkmcnt(3)
v_mfma_f32_16x16x32_bf16 v[12:15], v[52:55], v[36:39], v[12:15]
ds_read_b128 v[52:55], v2 offset:21504
s_waitcnt lgkmcnt(3)
v_mfma_f32_16x16x32_bf16 v[12:15], v[40:43], v[24:27], v[12:15]
ds_read_b128 v[40:43], v2 offset:18432
buffer_store_dwordx2 v[56:57], v58, s[8:11], s31 offen offset:2048 sc1
s_waitcnt lgkmcnt(3)
v_mfma_f32_16x16x32_bf16 v[12:15], v[44:47], v[28:31], v[12:15]
ds_read_b128 v[44:47], v2 offset:19456
v_max3_f32 v59, v59, v19, v20
v_max_f32 v59, v59, v21
v_mov_b32 v60, s53
s_add_u32 s49, s28, s23
v_mov_b32 v61, s53
s_add_u32 s50, s28, 65536
v_mov_b32 v62, s53
ds_read_b128 v[32:35], v2 offset:22528
v_mov_b32 v63, s53
v_max3_f32 v59, v59, v12, v13
v_max3_f32 v22, v59, v14, v15
v_max3_f32 v59, v59, v14, v15
s_add_u32 s51, s28, 131072
s_add_u32 s52, s28, 196608
v_permlane32_swap_b32 v22, v59
v_max_f32 v23, v59, v22
v_max_f32 v59, v59, v22
v_mov_b32 v22, 0
ds_read_b128 v[36:39], v2 offset:23552
v_permlane16_swap_b32 v23, v59
v_max_f32 v59, v59, v23
v_mul_f32 v58, s18, v59
v_pk_fma_f32 v[20:21], v[20:21], s[18:19], v[58:59] op_sel_hi:[1,0,0] neg_lo:[0,0,1] neg_hi:[0,0,1]
v_pk_fma_f32 v[16:17], v[16:17], s[18:19], v[58:59] op_sel_hi:[1,0,0] neg_lo:[0,0,1] neg_hi:[0,0,1]
v_pk_fma_f32 v[18:19], v[18:19], s[18:19], v[58:59] op_sel_hi:[1,0,0] neg_lo:[0,0,1] neg_hi:[0,0,1]
v_pk_fma_f32 v[12:13], v[12:13], s[18:19], v[58:59] op_sel_hi:[1,0,0] neg_lo:[0,0,1] neg_hi:[0,0,1]
v_pk_fma_f32 v[14:15], v[14:15], s[18:19], v[58:59] op_sel_hi:[1,0,0] neg_lo:[0,0,1] neg_hi:[0,0,1]
v_exp_f32 v20, v20
v_exp_f32 v21, v21
v_exp_f32 v16, v16
v_cvt_pk_bf16_f32 v23, v20, v21
v_cvt_pk_bf16_f32 v20, v20, v21
v_mov_b32 v21, 0
v_exp_f32 v17, v17
v_exp_f32 v18, v18
v_mfma_f32_16x16x16_bf16 v[24:27], v[56:57], v[20:21], 0
v_exp_f32 v19, v19
v_mfma_f32_16x16x16_bf16 v[28:31], v[56:57], v[22:23], 0
v_exp_f32 v12, v12
v_exp_f32 v13, v13
v_cvt_pk_bf16_f32 v16, v16, v17
v_cvt_pk_bf16_f32 v17, v18, v19
v_exp_f32 v14, v14
v_exp_f32 v15, v15
v_cvt_pk_bf16_f32 v18, v12, v13
v_cvt_pk_bf16_f32 v19, v14, v15
v_mfma_f32_16x16x16_bf16 v[12:15], v[60:61], v[20:21], 0
s_waitcnt vmcnt(2)
v_mfma_f32_16x16x32_bf16 v[12:15], v[60:63], v[16:19], v[12:15]
v_mov_b32 v20, 0
v_mov_b32 v23, 0
v_mfma_f32_16x16x32_bf16 v[24:27], v[64:67], v[16:19], v[24:27]
s_nop 1
v_mfma_f32_16x16x32_bf16 v[28:31], v[68:71], v[16:19], v[28:31]
v_mov_b32 v16, 0
v_mov_b32 v17, 0
v_rcp_f32 v12, v12
v_mov_b32 v18, 0
v_mov_b32 v19, 0
v_pk_mul_f32 v[24:25], v[24:25], v[12:13] op_sel_hi:[1,0]
v_pk_mul_f32 v[26:27], v[26:27], v[12:13] op_sel_hi:[1,0]
v_mov_b32 v15, 0
v_pk_mul_f32 v[28:29], v[28:29], v[12:13] op_sel_hi:[1,0]
v_pk_mul_f32 v[30:31], v[30:31], v[12:13] op_sel_hi:[1,0]
v_cvt_pk_bf16_f32 v24, v24, v28
v_cvt_pk_bf16_f32 v25, v25, v29
v_cvt_pk_bf16_f32 v26, v26, v30
v_cvt_pk_bf16_f32 v27, v27, v31
v_mfma_f32_16x16x32_bf16 v[56:59], v[20:23], v[20:23], 0
ds_write_b128 v7, v[24:27]
v_mfma_f32_16x16x32_bf16 v[60:63], v[20:23], v[20:23], 0
v_mov_b32 v12, 0
v_mov_b32 v13, 0
v_mov_b32 v14, 0
v_mov_b32 v3, 6528
s_nop 1
v_mfma_f32_16x16x32_bf16 v[64:67], v[20:23], v[20:23], 0
s_cmp_eq_u32 s19, 63
s_cbranch_scc1 L_texit
s_waitcnt lgkmcnt(0)
s_barrier
ds_read_b128 v[24:27], v1 offset:2176
v_mfma_f32_16x16x32_bf16 v[68:71], v[20:23], v[20:23], 0
ds_read_b128 v[28:31], v1 offset:3200
s_nop 2
v_mfma_f32_16x16x32_bf16 v[68:71], v[20:23], v[20:23], 0
s_waitcnt lgkmcnt(1)
v_smfmac_f32_16x16x64_bf16 v[12:15], v[24:27], a[248:255], v0
v_smfmac_f32_16x16x64_bf16 v[16:19], v[24:27], a[176:183], v0
s_waitcnt lgkmcnt(0)
v_smfmac_f32_16x16x64_bf16 v[12:15], v[28:31], v[40:47], v0
ds_read_b128 v[40:43], v2 offset:24576
v_smfmac_f32_16x16x64_bf16 v[16:19], v[28:31], v[48:55], v0
ds_read_b128 v[44:47], v2 offset:25600
v_smfmac_f32_16x16x64_bf16 v[20:23], v[24:27], a[184:191], v0
ds_read_b128 v[48:51], v2 offset:26624
v_smfmac_f32_16x16x64_bf16 v[20:23], v[28:31], v[32:39], v0
ds_read_b128 v[52:55], v2 offset:27648
s_nop 0
v_add_f32 v12, v12, v13
v_add_f32 v14, v14, v15
v_smfmac_f32_16x16x64_bf16 v[56:59], v[24:27], a[192:199], v0
ds_read_b128 v[32:35], v2 offset:28672
s_waitcnt lgkmcnt(3)
v_cvt_pk_bf16_f32 v12, v12, v14
buffer_store_dword v12, v10, s[8:11], s28 offen
v_smfmac_f32_16x16x64_bf16 v[56:59], v[28:31], v[40:47], v0
ds_read_b128 v[36:39], v2 offset:29696
v_add_f32 v16, v16, v17
v_add_f32 v18, v18, v19
v_smfmac_f32_16x16x64_bf16 v[60:63], v[24:27], a[200:207], v0
ds_read_b128 v[12:15], v3
s_waitcnt lgkmcnt(3)
v_cvt_pk_bf16_f32 v16, v16, v18
v_add_f32 v20, v20, v21
v_smfmac_f32_16x16x64_bf16 v[60:63], v[28:31], v[48:55], v0
ds_read_b128 v[40:43], v2 offset:30720
v_add_f32 v22, v22, v23
v_cvt_pk_bf16_f32 v17, v20, v22
v_smfmac_f32_16x16x64_bf16 v[64:67], v[24:27], a[208:215], v0
ds_read_b128 v[44:47], v2 offset:31744
s_waitcnt lgkmcnt(3)
buffer_store_dwordx2 v[16:17], v9, s[8:11], s28 offen
v_add_f32 v56, v56, v57
v_smfmac_f32_16x16x64_bf16 v[64:67], v[28:31], v[32:39], v0
ds_read_b128 v[48:51], v2 offset:32768
v_add_f32 v58, v58, v59
v_cvt_pk_bf16_f32 v56, v56, v58
v_smfmac_f32_16x16x64_bf16 v[68:71], v[24:27], a[216:223], v0
ds_read_b128 v[52:55], v2 offset:33792
s_waitcnt lgkmcnt(2)
v_add_f32 v60, v60, v61
v_add_f32 v62, v62, v63
v_smfmac_f32_16x16x64_bf16 v[68:71], v[28:31], v[40:47], v0
ds_read_b128 v[20:23], v3
v_cvt_pk_bf16_f32 v57, v60, v62
buffer_store_dwordx2 v[56:57], v9, s[8:11], s50 offen
v_smfmac_f32_16x16x64_bf16 v[12:15], v[24:27], a[224:231], v0
s_waitcnt lgkmcnt(1)
v_add_f32 v64, v64, v65
v_add_f32 v66, v66, v67
v_smfmac_f32_16x16x64_bf16 v[12:15], v[28:31], v[48:55], v0
s_waitcnt lgkmcnt(0)
v_cvt_pk_bf16_f32 v64, v64, v66
v_smfmac_f32_16x16x64_bf16 v[20:23], v[24:27], a[232:239], v0
v_add_f32 v68, v68, v69
v_add_f32 v70, v70, v71
v_smfmac_f32_16x16x64_bf16 v[20:23], v[28:31], a[240:247], v0
v_cvt_pk_bf16_f32 v65, v68, v70
buffer_store_dwordx2 v[64:65], v9, s[8:11], s51 offen
v_add_f32 v12, v12, v13
v_add_f32 v14, v14, v15
v_cvt_pk_bf16_f32 v12, v12, v14
s_nop 2
v_add_f32 v20, v20, v21
v_add_f32 v22, v22, v23
v_cvt_pk_bf16_f32 v13, v20, v22
buffer_store_dwordx2 v[12:13], v9, s[8:11], s52 offen
s_cmp_eq_u32 s48, 0
s_cbranch_scc1 L_nojob2
s_add_u32 s19, s19, 1
s_mov_b32 s20, s28
s_mov_b32 s28, s29
s_mov_b32 s29, s20
s_and_b32 s20, s19, 3
s_lshl_b32 s20, s20, 14
s_add_u32 s33, s20, 110100480
s_add_u32 s34, s20, s24
s_xor_b32 s20, s20, 32768
s_add_u32 s35, s20, s24
s_add_u32 s30, s30, 16384
s_add_u32 s31, s31, 131072
s_add_u32 s6, s33, 4096
s_add_u32 s7, s33, 8192
s_mov_b32 s22, 0
v_mov_b64 v[24:25], 0
v_mov_b64 v[26:27], 0
v_mov_b64 v[28:29], 0
v_mov_b64 v[30:31], 0
v_and_b32 v69, 0x380, v1
v_add_u32 v69, v69, v1
v_and_b32 v70, 0xf00, v1
v_add_u32 v70, v70, v1
v_mov_b64 v[64:65], -1
v_mov_b64 v[66:67], -1
v_xor_b32 v3, 16, v4
ds_read_b128 v[48:51], v2 offset:12288
ds_read_b128 v[52:55], v2 offset:13312
v_mov_b32 v56, 0x3f80
v_cndmask_b32 v56, v56, 1.0, s[44:45]
v_cndmask_b32 v60, 0, v56, s[36:37]
v_cndmask_b32 v61, 0, v56, s[38:39]
v_cndmask_b32 v62, 0, v56, s[40:41]
v_cndmask_b32 v63, 0, v56, s[42:43]
s_nop 5
buffer_load_dwordx4 v[32:35], v1, s[8:11], s49 offen offset:0 sc1
buffer_load_dwordx4 v[36:39], v1, s[8:11], s49 offen offset:1024 sc1
buffer_load_dwordx4 v[40:43], v1, s[8:11], s49 offen offset:2048 sc1
buffer_load_dwordx4 v[44:47], v1, s[8:11], s49 offen offset:3072 sc1
s_waitcnt vmcnt(3)
v_mfma_f32_16x16x32_bf16 v[56:59], v[32:35], v[60:63], 0
v_max3_u32 v16, v32, v33, v34
v_max_u32 v16, v16, v35
s_waitcnt vmcnt(2)
v_mfma_f32_16x16x32_bf16 v[56:59], v[36:39], v[60:63], v[56:59]
v_max3_u32 v16, v16, v36, v37
v_max3_u32 v16, v16, v38, v39
s_waitcnt vmcnt(1)
v_mfma_f32_16x16x32_bf16 v[56:59], v[40:43], v[60:63], v[56:59]
v_max3_u32 v16, v16, v40, v41
v_max3_u32 v16, v16, v42, v43
s_waitcnt vmcnt(0)
v_mfma_f32_16x16x32_bf16 v[56:59], v[44:47], v[60:63], v[56:59]
v_max3_u32 v16, v16, v44, v45
v_max3_u32 v16, v16, v46, v47
v_cmp_le_u32 vcc, 0xffff0000, v16
s_cbranch_vccnz L_red2
L_redb2:
s_nop 3
v_permlane32_swap_b32 v56, v58
v_permlane32_swap_b32 v57, v59
v_pk_add_f32 v[56:57], v[56:57], v[58:59]
v_cvt_pk_bf16_f32 v56, v56, v57
buffer_store_dword v56, v11, s[8:11], s34 offen
s_barrier
ds_read_b128 v[40:43], v2 offset:4096
ds_read_b128 v[44:47], v2 offset:5120
v_mov_b64 v[32:33], 0
v_mov_b64 v[34:35], 0
v_mov_b64 v[36:37], 0
v_mov_b64 v[38:39], 0
v_mov_b64 v[56:57], 0
v_mov_b64 v[58:59], 0
v_mov_b64 v[60:61], 0
v_mov_b64 v[62:63], 0
s_nop 15
s_nop 13
s_branch L_gat2
L_red2:
L_red2b:
buffer_load_dwordx4 v[32:35], v1, s[8:11], s49 offen offset:0 sc1
buffer_load_dwordx4 v[36:39], v1, s[8:11], s49 offen offset:1024 sc1
buffer_load_dwordx4 v[40:43], v1, s[8:11], s49 offen offset:2048 sc1
buffer_load_dwordx4 v[44:47], v1, s[8:11], s49 offen offset:3072 sc1
s_add_u32 s22, s22, 1
s_cmp_gt_u32 s22, 40000
s_cbranch_scc1 L_end
s_waitcnt vmcnt(3)
v_mfma_f32_16x16x32_bf16 v[56:59], v[32:35], v[60:63], 0
v_max3_u32 v16, v32, v33, v34
v_max_u32 v16, v16, v35
s_waitcnt vmcnt(2)
v_mfma_f32_16x16x32_bf16 v[56:59], v[36:39], v[60:63], v[56:59]
v_max3_u32 v16, v16, v36, v37
v_max3_u32 v16, v16, v38, v39
s_waitcnt vmcnt(1)
v_mfma_f32_16x16x32_bf16 v[56:59], v[40:43], v[60:63], v[56:59]
v_max3_u32 v16, v16, v40, v41
v_max3_u32 v16, v16, v42, v43
s_waitcnt vmcnt(0)
v_mfma_f32_16x16x32_bf16 v[56:59], v[44:47], v[60:63], v[56:59]
v_max3_u32 v16, v16, v44, v45
v_max3_u32 v16, v16, v46, v47
v_cmp_le_u32 vcc, 0xffff0000, v16
s_cbranch_vccz L_redb2
s_branch L_red2b
L_nojob2:
s_add_u32 s19, s19, 1
s_mov_b32 s20, s28
s_mov_b32 s28, s29
s_mov_b32 s29, s20
s_and_b32 s20, s19, 3
s_lshl_b32 s20, s20, 14
s_add_u32 s33, s20, 110100480
s_add_u32 s34, s20, s24
s_xor_b32 s20, s20, 32768
s_add_u32 s35, s20, s24
s_add_u32 s30, s30, 16384
s_add_u32 s31, s31, 131072
s_add_u32 s6, s33, 4096
s_add_u32 s7, s33, 8192
s_mov_b32 s22, 0
v_mov_b64 v[24:25], 0
v_mov_b64 v[26:27], 0
v_mov_b64 v[28:29], 0
v_mov_b64 v[30:31], 0
v_and_b32 v69, 0x380, v1
v_add_u32 v69, v69, v1
v_and_b32 v70, 0xf00, v1
v_add_u32 v70, v70, v1
v_mov_b64 v[64:65], -1
v_mov_b64 v[66:67], -1
v_xor_b32 v3, 16, v4
ds_read_b128 v[48:51], v2 offset:12288
ds_read_b128 v[52:55], v2 offset:13312
ds_read_b128 v[40:43], v2 offset:4096
ds_read_b128 v[44:47], v2 offset:5120
v_mov_b64 v[32:33], 0
v_mov_b64 v[34:35], 0
v_mov_b64 v[36:37], 0
v_mov_b64 v[38:39], 0
v_mov_b64 v[56:57], 0
v_mov_b64 v[58:59], 0
v_mov_b64 v[60:61], 0
v_mov_b64 v[62:63], 0
s_barrier
s_nop 15
s_nop 15
s_nop 7
s_branch L_gat2
L_ent3:
v_mov_b64 v[24:25], 0
v_mov_b64 v[26:27], 0
v_mov_b64 v[28:29], 0
v_mov_b64 v[30:31], 0
v_and_b32 v69, 0x380, v1
v_add_u32 v69, v69, v1
v_and_b32 v70, 0xf00, v1
v_add_u32 v70, v70, v1
v_mov_b64 v[64:65], -1
v_mov_b64 v[66:67], -1
v_xor_b32 v3, 16, v4
ds_read_b128 v[48:51], v2 offset:14336
ds_read_b128 v[52:55], v2 offset:15360
ds_read_b128 v[40:43], v2 offset:6144
ds_read_b128 v[44:47], v2 offset:7168
v_mov_b64 v[32:33], 0
v_mov_b64 v[34:35], 0
v_mov_b64 v[36:37], 0
v_mov_b64 v[38:39], 0
v_mov_b64 v[56:57], 0
v_mov_b64 v[58:59], 0
v_mov_b64 v[60:61], 0
v_mov_b64 v[62:63], 0
s_add_u32 s20, s30, 3072
s_add_u32 s21, s30, 8192
s_add_u32 s49, s29, s25
s_add_u32 s50, s29, s26
s_add_u32 s51, s29, s27
s_add_u32 s52, s30, 16384
s_mov_b32 m0, 22016
s_waitcnt vmcnt(0) lgkmcnt(0)
s_branch L_step3
L_gr3:
buffer_load_dwordx4 v[12:15], v1, s[8:11], s33 offen sc1
buffer_load_dword v20, v8, s[8:11], s7 offen sc1
buffer_load_dwordx4 v[16:19], v1, s[8:11], s6 offen sc1
s_add_u32 s22, s22, 1
s_cmp_gt_u32 s22, 40000
s_cbranch_scc1 L_end
s_nop 0
v_mov_b64 v[24:25], 0
v_mov_b64 v[26:27], 0
v_mov_b64 v[28:29], 0
v_mov_b64 v[30:31], 0
v_mov_b64 v[32:33], 0
v_mov_b64 v[34:35], 0
v_mov_b64 v[36:37], 0
v_mov_b64 v[38:39], 0
v_mov_b64 v[56:57], 0
v_mov_b64 v[58:59], 0
v_mov_b64 v[60:61], 0
v_mov_b64 v[62:63], 0
s_waitcnt lgkmcnt(0)
s_branch L_step3
.p2align 3
L_gat3:
buffer_load_dwordx4 v[12:15], v1, s[8:11], s33 offen sc1
buffer_load_dword v20, v8, s[8:11], s7 offen sc1
buffer_load_dwordx4 v[16:19], v1, s[8:11], s6 offen sc1
s_add_u32 s20, s30, 3072
s_add_u32 s21, s30, 8192
s_add_u32 s49, s29, s25
s_add_u32 s50, s29, s26
s_add_u32 s51, s29, s27
s_add_u32 s52, s30, 16384
s_mov_b32 m0, 22016
s_waitcnt lgkmcnt(0)
L_step3:
s_waitcnt vmcnt(2)
v_smfmac_f32_16x16x64_bf16 v[24:27], v[12:15], v[144:151], v0
ds_write_b128 v1, v[12:15] offset:6656
v_smfmac_f32_16x16x64_bf16 v[28:31], v[12:15], v[152:159], v0
s_waitcnt vmcnt(1)
ds_write_b32 v8, v20 offset:14848
v_smfmac_f32_16x16x64_bf16 v[32:35], v[12:15], v[160:167], v0
s_waitcnt vmcnt(0)
ds_write_b128 v1, v[16:19] offset:10752
v_smfmac_f32_16x16x64_bf16 v[56:59], v[12:15], a[80:87], v0
v_max3_u32 v21, v12, v13, v14
v_max3_u32 v21, v21, v15, v20
v_smfmac_f32_16x16x64_bf16 v[60:63], v[12:15], a[88:95], v0
v_max3_u32 v21, v21, v16, v17
v_max3_u32 v21, v21, v18, v19
v_smfmac_f32_16x16x64_bf16 v[36:39], v[12:15], v[40:47], v0
v_cmp_le_u32 vcc, 0xffff0000, v21
v_smfmac_f32_16x16x64_bf16 v[24:27], v[16:19], v[240:247], v0
s_cbranch_vccnz L_gr3
v_smfmac_f32_16x16x64_bf16 v[28:31], v[16:19], v[248:255], v0
s_waitcnt lgkmcnt(0)
s_barrier
ds_read_b128 v[20:23], v1 offset:3584
v_smfmac_f32_16x16x64_bf16 v[32:35], v[16:19], a[0:7], v0
ds_read_b128 v[12:15], v1 offset:4608
buffer_load_dwordx4 v69, s[8:11], s20 offen sc1 lds
v_smfmac_f32_16x16x64_bf16 v[56:59], v[16:19], a[144:151], v0
ds_read_b128 v[40:43], v2 offset:0
s_mov_b32 m0, 22912
v_smfmac_f32_16x16x64_bf16 v[60:63], v[16:19], a[152:159], v0
ds_read_b128 v[44:47], v2 offset:1024
v_smfmac_f32_16x16x64_bf16 v[36:39], v[16:19], v[48:55], v0
ds_read_b128 v[16:19], v1 offset:5632
s_waitcnt lgkmcnt(4)
v_smfmac_f32_16x16x64_bf16 v[24:27], v[20:23], v[72:79], v0
ds_read_b128 v[48:51], v2 offset:2048
buffer_load_dwordx4 v69, s[8:11], s20 offen offset:128 sc1 lds
v_smfmac_f32_16x16x64_bf16 v[28:31], v[20:23], v[80:87], v0
ds_read_b128 v[52:55], v2 offset:3072
s_mov_b32 m0, 6272
v_smfmac_f32_16x16x64_bf16 v[32:35], v[20:23], v[88:95], v0
s_waitcnt lgkmcnt(3)
v_smfmac_f32_16x16x64_bf16 v[36:39], v[20:23], v[40:47], v0
ds_read_b128 v[20:23], v1 offset:7680
v_smfmac_f32_16x16x64_bf16 v[24:27], v[12:15], v[96:103], v0
ds_read_b128 v[40:43], v2 offset:4096
v_smfmac_f32_16x16x64_bf16 v[28:31], v[12:15], v[104:111], v0
ds_read_b128 v[44:47], v2 offset:5120
v_smfmac_f32_16x16x64_bf16 v[32:35], v[12:15], v[112:119], v0
s_waitcnt lgkmcnt(3)
v_smfmac_f32_16x16x64_bf16 v[36:39], v[12:15], v[48:55], v0
ds_read_b128 v[12:15], v1 offset:8704
buffer_store_dwordx4 v[64:67], v1, s[8:11], s49 offen
v_smfmac_f32_16x16x64_bf16 v[24:27], v[16:19], v[120:127], v0
ds_read_b128 v[48:51], v2 offset:8192
v_smfmac_f32_16x16x64_bf16 v[28:31], v[16:19], v[128:135], v0
ds_read_b128 v[52:55], v2 offset:9216
v_smfmac_f32_16x16x64_bf16 v[32:35], v[16:19], v[136:143], v0
s_waitcnt lgkmcnt(3)
v_smfmac_f32_16x16x64_bf16 v[36:39], v[16:19], v[40:47], v0
ds_read_b128 v[16:19], v1 offset:9728
buffer_store_dwordx4 v[64:67], v1, s[8:11], s50 offen
v_smfmac_f32_16x16x64_bf16 v[24:27], v[20:23], v[168:175], v0
ds_read_b128 v[40:43], v2 offset:10240
v_smfmac_f32_16x16x64_bf16 v[28:31], v[20:23], v[176:183], v0
ds_read_b128 v[44:47], v2 offset:11264
v_smfmac_f32_16x16x64_bf16 v[32:35], v[20:23], v[184:191], v0
s_waitcnt lgkmcnt(3)
v_smfmac_f32_16x16x64_bf16 v[36:39], v[20:23], v[48:55], v0
ds_read_b128 v[20:23], v1 offset:11776
buffer_store_dwordx4 v[64:67], v1, s[8:11], s51 offen
v_smfmac_f32_16x16x64_bf16 v[24:27], v[12:15], v[192:199], v0
ds_read_b128 v[48:51], v2 offset:12288
buffer_load_dwordx4 v[64:67], v70, s[8:11], s21 offen sc1
v_smfmac_f32_16x16x64_bf16 v[28:31], v[12:15], v[200:207], v0
ds_read_b128 v[52:55], v2 offset:13312
v_smfmac_f32_16x16x64_bf16 v[32:35], v[12:15], v[208:215], v0
s_waitcnt lgkmcnt(3)
v_smfmac_f32_16x16x64_bf16 v[36:39], v[12:15], v[40:47], v0
ds_read_b128 v[12:15], v1 offset:3584
v_smfmac_f32_16x16x64_bf16 v[24:27], v[16:19], v[216:223], v0
ds_read_b128 v[40:43], v2 offset:16384
buffer_load_dwordx4 v[68:71], v70, s[8:11], s21 offen offset:256 sc1
v_smfmac_f32_16x16x64_bf16 v[28:31], v[16:19], v[224:231], v0
ds_read_b128 v[44:47], v2 offset:17408
v_smfmac_f32_16x16x64_bf16 v[32:35], v[16:19], v[232:239], v0
s_waitcnt lgkmcnt(3)
v_smfmac_f32_16x16x64_bf16 v[36:39], v[16:19], v[48:55], v0
ds_read_b128 v[16:19], v1 offset:4608
v_mov_b32 v11, s19
v_smfmac_f32_16x16x64_bf16 v[24:27], v[20:23], a[8:15], v0
v_smfmac_f32_16x16x64_bf16 v[28:31], v[20:23], a[16:23], v0
s_mov_b64 exec, 1
buffer_store_dword v11, v8, s[8:11], s83 offen sc1
s_mov_b64 exec, 0xff
buffer_load_dword v11, v8, s[8:11], s82 offen sc1
s_mov_b64 exec, -1
v_smfmac_f32_16x16x64_bf16 v[32:35], v[20:23], a[24:31], v0
s_waitcnt lgkmcnt(1)
v_smfmac_f32_16x16x64_bf16 v[36:39], v[20:23], v[40:47], v0
ds_read_b128 v[20:23], v1 offset:5632
v_smfmac_f32_16x16x64_bf16 v[56:59], v[12:15], a[32:39], v0
v_add_f32 v24, v24, v25
v_add_f32 v26, v26, v27
v_add_f32 v28, v28, v29
v_add_f32 v30, v30, v31
v_cvt_pk_bf16_f32 v24, v24, v28
v_cvt_pk_bf16_f32 v26, v26, v30
ds_write_b32 v4, v24 offset:2176
v_add_f32 v32, v32, v33
v_add_f32 v34, v34, v35
v_add_f32 v36, v36, v37
v_add_f32 v38, v38, v39
ds_write_b32 v3, v26 offset:2176
v_cvt_pk_bf16_f32 v32, v32, v36
v_cvt_pk_bf16_f32 v34, v34, v38
ds_write_b32 v4, v32
v_smfmac_f32_16x16x64_bf16 v[60:63], v[12:15], a[40:47], v0
ds_write_b32 v3, v34
s_waitcnt lgkmcnt(5)
v_smfmac_f32_16x16x64_bf16 v[56:59], v[16:19], a[48:55], v0
ds_read_b128 v[12:15], v1 offset:7680
v_smfmac_f32_16x16x64_bf16 v[60:63], v[16:19], a[56:63], v0
ds_read_b128 v[16:19], v1 offset:8704
s_waitcnt lgkmcnt(6)
v_smfmac_f32_16x16x64_bf16 v[56:59], v[20:23], a[64:71], v0
s_waitcnt lgkmcnt(2) vmcnt(7)
s_barrier
ds_read_b128 v[36:39], v5 offset:1536
v_smfmac_f32_16x16x64_bf16 v[60:63], v[20:23], a[72:79], v0
ds_read_b128 v[20:23], v1 offset:9728
s_waitcnt lgkmcnt(3)
v_smfmac_f32_16x16x64_bf16 v[56:59], v[12:15], a[96:103], v0
ds_read_b128 v[52:55], v1 offset:18944
v_smfmac_f32_16x16x64_bf16 v[60:63], v[12:15], a[104:111], v0
ds_read_b128 v[12:15], v1 offset:11776
s_waitcnt lgkmcnt(4)
v_smfmac_f32_16x16x64_bf16 v[56:59], v[16:19], a[112:119], v0
ds_read_b128 v[24:27], v5 offset:0
v_smfmac_f32_16x16x64_bf16 v[60:63], v[16:19], a[120:127], v0
ds_read_b128 v[40:43], v1 offset:12800
s_waitcnt lgkmcnt(4)
v_smfmac_f32_16x16x64_bf16 v[56:59], v[20:23], a[128:135], v0
ds_read_b128 v[28:31], v5 offset:512
v_smfmac_f32_16x16x64_bf16 v[60:63], v[20:23], a[136:143], v0
ds_read_b128 v[44:47], v1 offset:14848
s_waitcnt lgkmcnt(4)
v_smfmac_f32_16x16x64_bf16 v[56:59], v[12:15], a[160:167], v0
ds_read_b128 v[32:35], v5 offset:1024
v_smfmac_f32_16x16x64_bf16 v[60:63], v[12:15], a[168:175], v0
ds_read_b128 v[48:51], v1 offset:16896
s_mov_b64 exec, s[86:87]
buffer_store_dwordx4 v[36:39], v5, s[8:11], s31 offen offset:1536 sc1
s_mov_b64 exec, -1
v_mfma_f32_16x16x32_bf16 v[16:19], v[52:55], v[36:39], 0
ds_read_b128 v[52:55], v1 offset:19968
s_waitcnt lgkmcnt(5)
v_mfma_f32_16x16x32_bf16 v[16:19], v[40:43], v[24:27], v[16:19]
ds_read_b128 v[40:43], v1 offset:13824
s_waitcnt lgkmcnt(4)
v_mfma_f32_16x16x32_bf16 v[16:19], v[44:47], v[28:31], v[16:19]
ds_read_b128 v[44:47], v1 offset:15872
s_waitcnt lgkmcnt(3)
v_mfma_f32_16x16x32_bf16 v[16:19], v[48:51], v[32:35], v[16:19]
ds_read_b128 v[48:51], v1 offset:17920
v_mfma_f32_16x16x32_bf16 v[20:23], v[36:39], v[36:39], 0
v_add_f32 v56, v56, v57
v_add_f32 v58, v58, v59
v_mfma_f32_16x16x32_bf16 v[20:23], v[24:27], v[24:27], v[20:23]
v_add_f32 v60, v60, v61
v_add_f32 v62, v62, v63
v_mfma_f32_16x16x32_bf16 v[20:23], v[28:31], v[28:31], v[20:23]
v_cvt_pk_bf16_f32 v56, v56, v58
v_cvt_pk_bf16_f32 v57, v60, v62
v_mfma_f32_16x16x32_bf16 v[20:23], v[32:35], v[32:35], v[20:23]
v_lshrrev_b32 v58, 1, v1
v_max3_f32 v59, v16, v17, v18
s_waitcnt lgkmcnt(3)
v_mfma_f32_16x16x32_bf16 v[12:15], v[52:55], v[36:39], 0
ds_read_b128 v[52:55], v2 offset:21504
s_waitcnt lgkmcnt(3)
v_mfma_f32_16x16x32_bf16 v[12:15], v[40:43], v[24:27], v[12:15]
ds_read_b128 v[40:43], v2 offset:18432
s_waitcnt lgkmcnt(3)
v_mfma_f32_16x16x32_bf16 v[12:15], v[44:47], v[28:31], v[12:15]
ds_read_b128 v[44:47], v2 offset:19456
v_max3_f32 v59, v59, v19, v20
v_max_f32 v59, v59, v21
s_waitcnt lgkmcnt(3)
v_mfma_f32_16x16x32_bf16 v[12:15], v[48:51], v[32:35], v[12:15]
ds_read_b128 v[48:51], v2 offset:20480
buffer_store_dwordx2 v[56:57], v58, s[8:11], s31 offen offset:2048 sc1
v_mov_b32 v60, s53
s_add_u32 s49, s28, s23
v_mov_b32 v61, s53
s_add_u32 s50, s28, 65536
v_mov_b32 v62, s53
ds_read_b128 v[32:35], v2 offset:22528
v_mov_b32 v63, s53
v_max3_f32 v59, v59, v12, v13
v_max3_f32 v22, v59, v14, v15
v_max3_f32 v59, v59, v14, v15
s_add_u32 s51, s28, 131072
s_add_u32 s52, s28, 196608
v_permlane32_swap_b32 v22, v59
v_max_f32 v23, v59, v22
v_max_f32 v59, v59, v22
v_mov_b32 v22, 0
ds_read_b128 v[36:39], v2 offset:23552
v_permlane16_swap_b32 v23, v59
v_max_f32 v59, v59, v23
v_mul_f32 v58, s18, v59
v_pk_fma_f32 v[20:21], v[20:21], s[18:19], v[58:59] op_sel_hi:[1,0,0] neg_lo:[0,0,1] neg_hi:[0,0,1]
v_pk_fma_f32 v[16:17], v[16:17], s[18:19], v[58:59] op_sel_hi:[1,0,0] neg_lo:[0,0,1] neg_hi:[0,0,1]
v_pk_fma_f32 v[18:19], v[18:19], s[18:19], v[58:59] op_sel_hi:[1,0,0] neg_lo:[0,0,1] neg_hi:[0,0,1]
v_pk_fma_f32 v[12:13], v[12:13], s[18:19], v[58:59] op_sel_hi:[1,0,0] neg_lo:[0,0,1] neg_hi:[0,0,1]
v_pk_fma_f32 v[14:15], v[14:15], s[18:19], v[58:59] op_sel_hi:[1,0,0] neg_lo:[0,0,1] neg_hi:[0,0,1]
v_exp_f32 v20, v20
v_exp_f32 v21, v21
v_exp_f32 v16, v16
v_cvt_pk_bf16_f32 v23, v20, v21
v_cvt_pk_bf16_f32 v20, v20, v21
v_mov_b32 v21, 0
v_exp_f32 v17, v17
v_exp_f32 v18, v18
v_mfma_f32_16x16x16_bf16 v[24:27], v[56:57], v[20:21], 0
v_exp_f32 v19, v19
v_mfma_f32_16x16x16_bf16 v[28:31], v[56:57], v[22:23], 0
v_exp_f32 v12, v12
v_exp_f32 v13, v13
v_cvt_pk_bf16_f32 v16, v16, v17
v_cvt_pk_bf16_f32 v17, v18, v19
v_exp_f32 v14, v14
v_exp_f32 v15, v15
v_cvt_pk_bf16_f32 v18, v12, v13
v_cvt_pk_bf16_f32 v19, v14, v15
v_mfma_f32_16x16x16_bf16 v[12:15], v[60:61], v[20:21], 0
s_waitcnt vmcnt(4)
v_mfma_f32_16x16x32_bf16 v[12:15], v[60:63], v[16:19], v[12:15]
v_mov_b32 v20, 0
v_mov_b32 v23, 0
v_mfma_f32_16x16x32_bf16 v[24:27], v[64:67], v[16:19], v[24:27]
s_nop 1
v_mfma_f32_16x16x32_bf16 v[28:31], v[68:71], v[16:19], v[28:31]
v_mov_b32 v16, 0
v_mov_b32 v17, 0
v_rcp_f32 v12, v12
v_mov_b32 v18, 0
v_mov_b32 v19, 0
v_pk_mul_f32 v[24:25], v[24:25], v[12:13] op_sel_hi:[1,0]
v_pk_mul_f32 v[26:27], v[26:27], v[12:13] op_sel_hi:[1,0]
v_mov_b32 v15, 0
v_pk_mul_f32 v[28:29], v[28:29], v[12:13] op_sel_hi:[1,0]
v_pk_mul_f32 v[30:31], v[30:31], v[12:13] op_sel_hi:[1,0]
v_cvt_pk_bf16_f32 v24, v24, v28
v_cvt_pk_bf16_f32 v25, v25, v29
v_cvt_pk_bf16_f32 v26, v26, v30
v_cvt_pk_bf16_f32 v27, v27, v31
v_mfma_f32_16x16x32_bf16 v[56:59], v[20:23], v[20:23], 0
ds_write_b128 v7, v[24:27]
v_mfma_f32_16x16x32_bf16 v[60:63], v[20:23], v[20:23], 0
v_mov_b32 v12, 0
v_mov_b32 v13, 0
v_mov_b32 v14, 0
v_mov_b32 v3, 6528
s_nop 1
v_mfma_f32_16x16x32_bf16 v[64:67], v[20:23], v[20:23], 0
s_cmp_eq_u32 s19, 63
s_cbranch_scc1 L_texit
s_waitcnt lgkmcnt(0)
s_barrier
ds_read_b128 v[24:27], v1 offset:1152
v_mfma_f32_16x16x32_bf16 v[68:71], v[20:23], v[20:23], 0
ds_read_b128 v[28:31], v1 offset:2176
s_nop 2
v_mfma_f32_16x16x32_bf16 v[68:71], v[20:23], v[20:23], 0
s_waitcnt lgkmcnt(1)
v_smfmac_f32_16x16x64_bf16 v[12:15], v[24:27], a[248:255], v0
v_smfmac_f32_16x16x64_bf16 v[16:19], v[24:27], a[176:183], v0
s_waitcnt lgkmcnt(0)
v_smfmac_f32_16x16x64_bf16 v[12:15], v[28:31], v[40:47], v0
ds_read_b128 v[40:43], v2 offset:24576
v_smfmac_f32_16x16x64_bf16 v[16:19], v[28:31], v[48:55], v0
ds_read_b128 v[44:47], v2 offset:25600
v_smfmac_f32_16x16x64_bf16 v[20:23], v[24:27], a[184:191], v0
ds_read_b128 v[48:51], v2 offset:26624
v_smfmac_f32_16x16x64_bf16 v[20:23], v[28:31], v[32:39], v0
ds_read_b128 v[52:55], v2 offset:27648
s_nop 0
v_add_f32 v12, v12, v13
v_add_f32 v14, v14, v15
v_smfmac_f32_16x16x64_bf16 v[56:59], v[24:27], a[192:199], v0
ds_read_b128 v[32:35], v2 offset:28672
s_waitcnt lgkmcnt(3)
v_cvt_pk_bf16_f32 v12, v12, v14
buffer_store_dword v12, v10, s[8:11], s28 offen
v_smfmac_f32_16x16x64_bf16 v[56:59], v[28:31], v[40:47], v0
ds_read_b128 v[36:39], v2 offset:29696
v_add_f32 v16, v16, v17
v_add_f32 v18, v18, v19
v_smfmac_f32_16x16x64_bf16 v[60:63], v[24:27], a[200:207], v0
ds_read_b128 v[12:15], v3
s_waitcnt lgkmcnt(3)
v_cvt_pk_bf16_f32 v16, v16, v18
v_add_f32 v20, v20, v21
v_smfmac_f32_16x16x64_bf16 v[60:63], v[28:31], v[48:55], v0
ds_read_b128 v[40:43], v2 offset:30720
v_add_f32 v22, v22, v23
v_cvt_pk_bf16_f32 v17, v20, v22
v_smfmac_f32_16x16x64_bf16 v[64:67], v[24:27], a[208:215], v0
ds_read_b128 v[44:47], v2 offset:31744
s_waitcnt lgkmcnt(3)
buffer_store_dwordx2 v[16:17], v9, s[8:11], s28 offen
v_add_f32 v56, v56, v57
v_smfmac_f32_16x16x64_bf16 v[64:67], v[28:31], v[32:39], v0
ds_read_b128 v[48:51], v2 offset:32768
v_add_f32 v58, v58, v59
v_cvt_pk_bf16_f32 v56, v56, v58
v_smfmac_f32_16x16x64_bf16 v[68:71], v[24:27], a[216:223], v0
ds_read_b128 v[52:55], v2 offset:33792
s_waitcnt lgkmcnt(2)
v_add_f32 v60, v60, v61
v_add_f32 v62, v62, v63
v_smfmac_f32_16x16x64_bf16 v[68:71], v[28:31], v[40:47], v0
ds_read_b128 v[20:23], v3
v_cvt_pk_bf16_f32 v57, v60, v62
buffer_store_dwordx2 v[56:57], v9, s[8:11], s50 offen
v_smfmac_f32_16x16x64_bf16 v[12:15], v[24:27], a[224:231], v0
s_waitcnt lgkmcnt(1)
v_add_f32 v64, v64, v65
v_add_f32 v66, v66, v67
v_smfmac_f32_16x16x64_bf16 v[12:15], v[28:31], v[48:55], v0
s_waitcnt lgkmcnt(0)
v_cvt_pk_bf16_f32 v64, v64, v66
v_smfmac_f32_16x16x64_bf16 v[20:23], v[24:27], a[232:239], v0
v_add_f32 v68, v68, v69
v_add_f32 v70, v70, v71
v_smfmac_f32_16x16x64_bf16 v[20:23], v[28:31], a[240:247], v0
v_cvt_pk_bf16_f32 v65, v68, v70
buffer_store_dwordx2 v[64:65], v9, s[8:11], s51 offen
v_add_f32 v12, v12, v13
v_add_f32 v14, v14, v15
v_cvt_pk_bf16_f32 v12, v12, v14
s_nop 2
v_add_f32 v20, v20, v21
v_add_f32 v22, v22, v23
v_cvt_pk_bf16_f32 v13, v20, v22
buffer_store_dwordx2 v[12:13], v9, s[8:11], s52 offen
s_add_u32 s19, s19, 1
s_mov_b32 s20, s28
s_mov_b32 s28, s29
s_mov_b32 s29, s20
s_and_b32 s20, s19, 3
s_lshl_b32 s20, s20, 14
s_add_u32 s33, s20, 110100480
s_add_u32 s34, s20, s24
s_xor_b32 s20, s20, 32768
s_add_u32 s35, s20, s24
s_add_u32 s30, s30, 16384
s_add_u32 s31, s31, 131072
s_add_u32 s6, s33, 4096
s_add_u32 s7, s33, 8192
s_mov_b32 s22, 0
v_mov_b64 v[24:25], 0
v_mov_b64 v[26:27], 0
v_mov_b64 v[28:29], 0
v_mov_b64 v[30:31], 0
v_and_b32 v69, 0x380, v1
v_add_u32 v69, v69, v1
v_and_b32 v70, 0xf00, v1
v_add_u32 v70, v70, v1
v_mov_b64 v[64:65], -1
v_mov_b64 v[66:67], -1
v_xor_b32 v3, 16, v4
ds_read_b128 v[48:51], v2 offset:14336
ds_read_b128 v[52:55], v2 offset:15360
ds_read_b128 v[40:43], v2 offset:6144
ds_read_b128 v[44:47], v2 offset:7168
v_mov_b64 v[32:33], 0
v_mov_b64 v[34:35], 0
v_mov_b64 v[36:37], 0
v_mov_b64 v[38:39], 0
v_mov_b64 v[56:57], 0
v_mov_b64 v[58:59], 0
v_mov_b64 v[60:61], 0
v_mov_b64 v[62:63], 0
s_add_u32 s20, s19, 1
s_lshr_b32 s20, s20, 3
s_min_u32 s20, s20, 7
s_waitcnt vmcnt(7)
L_kvw:
v_readlane_b32 s21, v11, s20
s_nop 0
s_cmp_eq_u32 s21, 1
s_cbranch_scc0 L_kvp
s_barrier
s_nop 15
s_nop 15
s_nop 7
s_branch L_gat3
L_kvp:
s_mov_b64 exec, 0xff
buffer_load_dword v11, v8, s[8:11], s82 offen sc1
s_mov_b64 exec, -1
s_add_u32 s22, s22, 1
s_cmp_gt_u32 s22, 40000
s_cbranch_scc1 L_end
s_waitcnt vmcnt(0)
s_branch L_kvw
L_texit:
s_lshl_b32 s61, s16, 7
s_add_u32 s61, s61, 111153152
s_waitcnt vmcnt(0)
s_barrier
s_cmp_lg_u32 s17, 0
s_cbranch_scc1 L_sf_41
v_mov_b32 v20, 0
v_mov_b32 v21, 64
s_mov_b64 exec, 1
buffer_store_dword v21, v20, s[8:11], s61 offen sc1
s_mov_b64 exec, -1
L_sf_41:
L_done:
L_end:
s_endpgm
.section .rodata,"a"
.p2align 6
.amdhsa_kernel concat_heads__compressed_kv_cla__memory_aug_recurrent_mem_tr__prompt_kernel
  .amdhsa_next_free_vgpr 512
  .amdhsa_next_free_sgpr 102
  .amdhsa_accum_offset 256
  .amdhsa_group_segment_fixed_size 0
  .amdhsa_kernarg_size 128
  .amdhsa_user_sgpr_count 2
  .amdhsa_user_sgpr_kernarg_segment_ptr 1
  .amdhsa_system_sgpr_workgroup_id_x 1
.end_amdhsa_kernel
```

```asm
; @launch grid=(256,1,1) block=(256,1,1) lds=163840
.amdgcn_target "amdgcn-amd-amdhsa--gfx950"
.text
.globl concat_heads__compressed_kv_cla__memory_aug_recurrent_mem_tr__prompt_kernel
.p2align 8
.type concat_heads__compressed_kv_cla__memory_aug_recurrent_mem_tr__prompt_kernel,@function
concat_heads__compressed_kv_cla__memory_aug_recurrent_mem_tr__prompt_kernel:
s_cmp_ge_u32 s2, 256
s_cbranch_scc1 L_end
s_getreg_b32 s3, hwreg(HW_REG_XCC_ID)
s_and_b32 s3, s3, 7
s_load_dwordx2 s[4:5], s[0:1], 120
s_load_dwordx2 s[6:7], s[0:1], 112
v_lshrrev_b32 v1, 6, v0
s_nop 0
v_readfirstlane_b32 s17, v1
s_waitcnt lgkmcnt(0)
s_mov_b32 s8, s4
s_and_b32 s9, s5, 0xffff
s_mov_b32 s10, 268435456
s_mov_b32 s11, 0x20000
s_mov_b32 s56, s6
s_and_b32 s57, s7, 0xffff
s_mov_b32 s58, 256
s_mov_b32 s59, 0x20000
s_getpc_b64 s[4:5]
L_pc:
s_mov_b32 s12, s4
s_and_b32 s13, s5, 0xffff
s_mov_b32 s14, L_end-L_pc
s_mov_b32 s15, 0x20000
s_lshr_b32 s25, s2, 3
s_lshl_b32 s25, s25, 7
v_lshlrev_b32 v3, 12, v0
buffer_load_dword v3, v3, s[12:15], s25 offen
s_lshl_b32 s24, s3, 2
s_cmp_eq_u32 s17, 0
s_cbranch_scc0 L_tk
s_mov_b64 exec, 1
v_mov_b32 v1, 1
v_mov_b32 v2, 0
buffer_atomic_add v1, v2, s[56:59], s24 offen sc0
s_waitcnt vmcnt(0)
ds_write_b32 v2, v1
s_waitcnt lgkmcnt(0)
s_mov_b64 exec, -1
L_tk:
s_waitcnt vmcnt(0)
s_barrier
v_mov_b32 v2, 0
ds_read_b32 v1, v2
s_lshr_b32 s3, 0x76350124, s24
s_and_b32 s3, s3, 7
s_waitcnt lgkmcnt(0)
v_readfirstlane_b32 s16, v1
s_barrier
s_cmp_ge_u32 s16, 32
s_cbranch_scc1 L_end
s_cmp_eq_u32 s3, 0
s_cbranch_scc1 L_team
s_cmp_eq_u32 s3, 1
s_cbranch_scc0 L_np
s_cmp_lt_u32 s16, 24
s_cbranch_scc1 L_np
v_lshlrev_b32 v1, 4, v0
v_mov_b64 v[4:5], 0
v_mov_b64 v[6:7], 0
s_sub_u32 s24, s16, 24
s_lshl_b32 s24, s24, 12
s_add_u32 s24, s24, 111149056
buffer_store_dwordx4 v[4:7], v1, s[8:11], s24 offen sc1
s_waitcnt vmcnt(0)
s_barrier
s_cmp_lg_u32 s17, 0
s_cbranch_scc1 L_np
v_mov_b32 v1, 1
v_mov_b32 v2, 128
s_mov_b64 exec, 1
buffer_atomic_add v1, v2, s[56:59], 0 offen
s_mov_b64 exec, -1
L_np:
s_cmp_lt_u32 s3, 4
s_cselect_b32 s61, 1, 0
s_cbranch_scc1 L_pb
s_load_dwordx2 s[52:53], s[0:1], 8
s_load_dwordx2 s[54:55], s[0:1], 0
s_load_dwordx2 s[6:7], s[0:1], 24
s_load_dwordx2 s[4:5], s[0:1], 32
s_load_dwordx2 s[18:19], s[0:1], 16
s_mov_b32 s45, 3
s_sub_u32 s24, s3, 4
s_lshl_b32 s24, s24, 5
s_add_u32 s24, s24, s16
s_lshr_b32 s89, s24, 2
s_lshr_b32 s90, s24, 3
s_and_b32 s24, s16, 3
s_mul_i32 s88, s24, 0x11
s_and_b32 s24, s16, 7
s_lshl_b32 s24, s24, 8
s_add_u32 s88, s88, s24
s_add_u32 s88, s88, 0x840
s_branch L_pg
L_pb:
s_load_dwordx2 s[52:53], s[0:1], 48
s_load_dwordx2 s[54:55], s[0:1], 48
s_load_dwordx2 s[6:7], s[0:1], 72
s_load_dwordx2 s[4:5], s[0:1], 80
s_load_dwordx2 s[18:19], s[0:1], 64
s_mov_b32 s45, 6
s_sub_u32 s24, s3, 2
s_lshl_b32 s24, s24, 5
s_add_u32 s24, s24, s16
s_lshr_b32 s89, s24, 1
s_lshr_b32 s90, s24, 2
s_mov_b32 s88, 0xe6a431
s_mov_b32 s25, 0xe6c431
s_bitcmp1_b32 s16, 0
s_cselect_b32 s88, 0xf7b582, s88
s_cselect_b32 s25, 0xf7d592, s25
s_bitcmp1_b32 s16, 1
s_cselect_b32 s88, s25, s88
s_cselect_b32 s45, 5, 6
s_cmp_eq_u32 s3, 1
s_cselect_b32 s45, 1, s45
s_cselect_b32 s88, 0, s88
s_cselect_b32 s89, s16, s89
L_pg:
s_waitcnt lgkmcnt(0)
s_cmp_ge_u32 s17, 2
s_cselect_b64 s[6:7], s[4:5], s[6:7]
s_cmp_eq_u32 s61, 0
s_cselect_b32 s24, 4, 1
s_mov_b32 s14, 884736
s_cselect_b32 s14, 1048576, s14
s_sub_u32 s24, s3, s24
s_lshl_b32 s24, s24, 5
s_add_u32 s24, s24, s16
s_lshl_b32 s24, s24, 13
s_mov_b32 s12, s52
s_and_b32 s13, s53, 0xffff
s_mov_b32 s15, 0x20000
v_lshlrev_b32 v15, 5, v0
buffer_load_dword v15, v15, s[12:15], s24 offen
s_sub_u32 s24, s3, 2
s_lshl_b32 s24, s24, 5
s_add_u32 s24, s24, s16
s_cmp_ge_u32 s24, 13
s_cbranch_scc1 L_pf_1
s_load_dwordx2 s[4:5], s[0:1], 8
s_sub_u32 s100, s24, 0
s_mul_i32 s100, s100, 81920
s_add_u32 s100, s100, 1048576
s_mov_b32 s98, 2097152
s_branch L_pfd
L_pf_1:
s_cmp_ge_u32 s24, 33
s_cbranch_scc1 L_pf_2
s_load_dwordx2 s[4:5], s[0:1], 48
s_sub_u32 s100, s24, 13
s_mul_i32 s100, s100, 81920
s_add_u32 s100, s100, 786432
s_mov_b32 s98, 2359296
s_branch L_pfd
L_pf_2:
s_cmp_ge_u32 s24, 62
s_cbranch_scc1 L_pf_3
s_load_dwordx2 s[4:5], s[0:1], 0
s_sub_u32 s100, s24, 33
s_mul_i32 s100, s100, 81920
s_add_u32 s100, s100, 0
s_mov_b32 s98, 2359296
s_branch L_pfd
L_pf_3:
s_cmp_ge_u32 s24, 120
s_cbranch_scc1 L_pf_4
s_load_dwordx2 s[4:5], s[0:1], 16
s_sub_u32 s100, s24, 62
s_mul_i32 s100, s100, 81920
s_add_u32 s100, s100, 0
s_mov_b32 s98, 4718592
s_branch L_pfd
L_pf_4:
s_load_dwordx2 s[4:5], s[0:1], 40
s_sub_u32 s100, s24, 120
s_mul_i32 s100, s100, 81920
s_add_u32 s100, s100, 0
s_mov_b32 s98, 4718592
s_branch L_pfd
L_pf_5:
L_pfd:
s_waitcnt lgkmcnt(0)
s_mov_b32 s96, s4
s_and_b32 s97, s5, 0xffff
s_mov_b32 s99, 0x20000
s_cmp_eq_u32 s3, 1
s_cselect_b32 s100, 536870912, s100
v_lshlrev_b32 v14, 5, v0
s_cmp_eq_u32 s61, 0
s_cselect_b32 s94, 0x3e0293ee, 1.0
v_bfe_u32 v16, v0, 4, 3
v_bfe_u32 v17, v0, 7, 1
v_lshlrev_b32 v17, 2, v17
v_xor_b32 v16, v16, v17
v_and_b32 v17, 7, v0
v_xor_b32 v16, v16, v17
v_lshlrev_b32 v1, 4, v16
v_bfe_u32 v17, v0, 4, 2
v_lshlrev_b32 v16, 2, v17
v_and_b32 v18, 15, v0
v_xor_b32 v16, v16, v18
v_bfe_u32 v18, v0, 6, 1
v_xor_b32 v16, v16, v18
v_lshlrev_b32 v16, 4, v16
v_lshl_add_u32 v16, v17, 13, v16
v_lshl_add_u32 v2, v18, 16, v16
s_and_b32 s24, s17, 1
s_lshr_b32 s25, s17, 1
s_lshl_b32 s25, s25, 13
s_lshl_b32 s33, s24, 11
s_add_u32 s33, s33, s25
s_lshl_b32 s32, s17, 10
s_add_u32 s32, s32, 65536
v_bfe_u32 v16, v0, 3, 1
v_lshlrev_b32 v16, 11, v16
v_and_b32 v18, 7, v0
v_lshl_add_u32 v16, v18, 7, v16
v_bfe_u32 v18, v0, 1, 3
v_xor_b32 v18, v18, v17
v_lshl_add_u32 v16, v18, 4, v16
s_lshl_b32 s24, s24, 14
s_add_u32 s24, s24, 65536
v_add_u32 v3, s24, v16
v_xor_b32 v4, 64, v3
v_bfe_u32 v18, v0, 2, 2
v_mul_u32_u24 v16, 320, v18
v_lshl_add_u32 v16, v17, 11, v16
v_bfe_u32 v18, v0, 1, 1
v_lshl_add_u32 v16, v18, 5, v16
v_bfe_u32 v18, v0, 4, 1
v_lshl_add_u32 v16, v18, 4, v16
v_and_b32 v18, 1, v0
v_lshl_add_u32 v16, v18, 3, v16
v_add_u32 v5, s25, v16
v_xor_b32 v6, 16, v5
v_xor_b32 v7, 64, v5
v_xor_b32 v8, 80, v5
v_xor_b32 v9, 128, v5
v_xor_b32 v10, 144, v5
v_xor_b32 v11, 192, v5
v_xor_b32 v12, 208, v5
s_mov_b32 s35, 0
s_lshl_b32 s24, s35, 2
s_lshr_b32 s26, s88, s24
s_bfe_u32 s2, s26, 0x10003
s_and_b32 s26, s26, 7
s_or_b32 s40, s2, s61
s_lshr_b32 s24, s17, 1
s_cmp_eq_u32 s2, 0
s_cselect_b32 s41, s24, 0
s_cselect_b32 s27, s89, s90
s_sub_u32 s25, s24, s41
s_and_b32 s51, s41, s61
s_lshl_b32 s51, s51, 1
s_or_b32 s51, s51, s41
s_lshl_b32 s46, s27, s2
s_add_u32 s46, s46, s25
s_lshl_b32 s46, s46, 8
s_lshl_b32 s47, s40, 7
s_add_u32 s47, s47, 1024
s_mul_i32 s101, s26, s47
s_lshl_b32 s101, s101, 8
s_lshl_b32 s42, s27, 3
s_add_u32 s42, s42, s26
s_lshl_b32 s42, s42, 1
s_and_b32 s25, s17, 1
s_add_u32 s42, s42, s25
s_lshl_b32 s42, s42, 3
s_add_u32 s42, s42, s24
s_lshl_b32 s42, s42, 13
s_lshl_b32 s43, s27, 5
s_add_u32 s43, s43, s26
s_lshl_b32 s43, s43, 2
s_lshl_b32 s24, s2, 1
s_add_u32 s24, s24, s61
s_lshl_b32 s24, s24, 2
s_lshr_b32 s25, 0x8720, s24
s_and_b32 s25, s25, 15
s_lshl_b32 s25, s25, 24
s_add_u32 s42, s42, s25
s_lshr_b32 s25, 0x7604, s24
s_and_b32 s25, s25, 15
s_lshl_b32 s25, s25, 12
s_add_u32 s43, s43, s25
s_add_u32 s43, s43, 111149056
s_cmp_lt_u32 s35, s45
s_cselect_b32 s101, s101, 536870912
s_cselect_b32 s46, s46, 536870912
s_cmp_eq_u32 s2, 0
s_cselect_b64 s[4:5], s[52:53], s[54:55]
s_mov_b32 s12, s4
s_and_b32 s13, s5, 0xffff
s_lshl_b32 s14, s47, 11
s_mov_b32 s15, 0x20000
s_mov_b32 s30, s101
v_lshrrev_b32 v16, 3, v0
v_mul_lo_u32 v16, v16, s47
v_and_b32 v1, 0x70, v1
v_add_u32 v1, v1, v16
s_lshl_b32 s34, s47, 5
s_cmp_eq_u32 s2, 0
s_cselect_b64 s[4:5], s[6:7], s[18:19]
s_mov_b32 s20, s4
s_and_b32 s21, s5, 0xffff
s_lshl_b32 s22, s47, 12
s_mov_b32 s23, 0x20000
s_mov_b32 s31, s46
s_mov_b32 s48, s30
s_add_u32 m0, s32, 0
s_nop 0
buffer_load_dwordx4 v1, s[12:15], s48 offen lds
s_add_u32 s48, s48, s34
s_add_u32 m0, s32, 4096
s_nop 0
buffer_load_dwordx4 v1, s[12:15], s48 offen lds
s_add_u32 s48, s48, s34
s_add_u32 m0, s32, 8192
s_nop 0
buffer_load_dwordx4 v1, s[12:15], s48 offen lds
s_add_u32 s48, s48, s34
s_add_u32 m0, s32, 12288
s_nop 0
buffer_load_dwordx4 v1, s[12:15], s48 offen lds
s_add_u32 s48, s48, s34
s_add_u32 m0, s32, 16384
s_nop 0
buffer_load_dwordx4 v1, s[12:15], s48 offen lds
s_add_u32 s48, s48, s34
s_add_u32 m0, s32, 20480
s_nop 0
buffer_load_dwordx4 v1, s[12:15], s48 offen lds
s_add_u32 s48, s48, s34
s_add_u32 m0, s32, 24576
s_nop 0
buffer_load_dwordx4 v1, s[12:15], s48 offen lds
s_add_u32 s48, s48, s34
s_add_u32 m0, s32, 28672
s_nop 0
buffer_load_dwordx4 v1, s[12:15], s48 offen lds
s_add_u32 s30, s30, 128
s_add_u32 s32, s32, 32768
s_sub_u32 s48, s32, 98304
s_cmp_ge_u32 s32, 163840
s_cselect_b32 s32, s48, s32
s_add_u32 s37, s31, 0
s_add_u32 m0, s33, 0
s_nop 0
buffer_load_dwordx4 v2, s[20:23], s37 offen  lds
s_add_u32 s37, s31, 32768
s_add_u32 m0, s33, 1024
s_nop 0
buffer_load_dwordx4 v2, s[20:23], s37 offen  lds
s_add_u32 s37, s31, 131072
s_add_u32 m0, s33, 4096
s_nop 0
buffer_load_dwordx4 v2, s[20:23], s37 offen  lds
s_add_u32 s37, s31, 163840
s_add_u32 m0, s33, 5120
s_nop 0
buffer_load_dwordx4 v2, s[20:23], s37 offen  lds
s_add_u32 s31, s31, 262144
s_add_u32 s33, s33, 16384
s_and_b32 s33, s33, 65535
s_add_u32 s37, s31, 0
s_add_u32 m0, s33, 0
s_nop 0
buffer_load_dwordx4 v2, s[20:23], s37 offen  lds
s_add_u32 s37, s31, 32768
s_add_u32 m0, s33, 1024
s_nop 0
buffer_load_dwordx4 v2, s[20:23], s37 offen  lds
s_add_u32 s37, s31, 131072
s_add_u32 m0, s33, 4096
s_nop 0
buffer_load_dwordx4 v2, s[20:23], s37 offen  lds
s_add_u32 s37, s31, 163840
s_add_u32 m0, s33, 5120
s_nop 0
buffer_load_dwordx4 v2, s[20:23], s37 offen  lds
s_add_u32 s31, s31, 262144
s_add_u32 s33, s33, 16384
s_and_b32 s33, s33, 65535
s_mov_b32 s48, s30
s_add_u32 m0, s32, 0
s_nop 0
buffer_load_dwordx4 v1, s[12:15], s48 offen lds
s_add_u32 s48, s48, s34
s_add_u32 m0, s32, 4096
s_nop 0
buffer_load_dwordx4 v1, s[12:15], s48 offen lds
s_add_u32 s48, s48, s34
s_add_u32 m0, s32, 8192
s_nop 0
buffer_load_dwordx4 v1, s[12:15], s48 offen lds
s_add_u32 s48, s48, s34
s_add_u32 m0, s32, 12288
s_nop 0
buffer_load_dwordx4 v1, s[12:15], s48 offen lds
s_add_u32 s37, s31, 0
s_add_u32 m0, s33, 0
s_nop 0
buffer_load_dwordx4 v2, s[20:23], s37 offen  lds
s_add_u32 s37, s31, 32768
s_add_u32 m0, s33, 1024
s_nop 0
buffer_load_dwordx4 v2, s[20:23], s37 offen  lds
s_add_u32 s37, s31, 131072
s_add_u32 m0, s33, 4096
s_nop 0
buffer_load_dwordx4 v2, s[20:23], s37 offen  lds
s_add_u32 s37, s31, 163840
s_add_u32 m0, s33, 5120
s_nop 0
buffer_load_dwordx4 v2, s[20:23], s37 offen  lds
s_add_u32 s31, s31, 262144
s_add_u32 s33, s33, 16384
s_and_b32 s33, s33, 65535
s_add_u32 s48, s48, s34
s_add_u32 m0, s32, 16384
s_nop 0
buffer_load_dwordx4 v1, s[12:15], s48 offen lds
s_add_u32 s48, s48, s34
s_add_u32 m0, s32, 20480
s_nop 0
buffer_load_dwordx4 v1, s[12:15], s48 offen lds
s_add_u32 s48, s48, s34
s_add_u32 m0, s32, 24576
s_nop 0
buffer_load_dwordx4 v1, s[12:15], s48 offen lds
s_add_u32 s48, s48, s34
s_add_u32 m0, s32, 28672
s_nop 0
buffer_load_dwordx4 v1, s[12:15], s48 offen lds
s_add_u32 s30, s30, 128
s_add_u32 s32, s32, 32768
s_sub_u32 s48, s32, 98304
s_cmp_ge_u32 s32, 163840
s_cselect_b32 s32, s48, s32
s_add_u32 s37, s31, 0
s_add_u32 m0, s33, 0
s_nop 0
buffer_load_dwordx4 v2, s[20:23], s37 offen  lds
s_add_u32 s37, s31, 32768
s_add_u32 m0, s33, 1024
s_nop 0
buffer_load_dwordx4 v2, s[20:23], s37 offen  lds
s_add_u32 s37, s31, 131072
s_add_u32 m0, s33, 4096
s_nop 0
buffer_load_dwordx4 v2, s[20:23], s37 offen  lds
s_add_u32 s37, s31, 163840
s_add_u32 m0, s33, 5120
s_nop 0
buffer_load_dwordx4 v2, s[20:23], s37 offen  lds
s_add_u32 s31, s31, 262144
s_add_u32 s33, s33, 16384
s_and_b32 s33, s33, 65535
s_mov_b32 s48, s30
s_add_u32 m0, s32, 0
s_nop 0
buffer_load_dwordx4 v1, s[12:15], s48 offen lds
s_add_u32 s48, s48, s34
s_add_u32 m0, s32, 4096
s_nop 0
buffer_load_dwordx4 v1, s[12:15], s48 offen lds
s_add_u32 s48, s48, s34
s_add_u32 m0, s32, 8192
s_nop 0
buffer_load_dwordx4 v1, s[12:15], s48 offen lds
s_add_u32 s48, s48, s34
s_add_u32 m0, s32, 12288
s_nop 0
buffer_load_dwordx4 v1, s[12:15], s48 offen lds
s_mov_b32 s62, 536870912
s_mov_b32 s63, 536870912
s_mov_b32 s50, 0
s_waitcnt vmcnt(24)
s_barrier
s_cmp_eq_u32 s41, 0
s_cbranch_scc0 L_g_p1
ds_read_b64_tr_b16 a[160:161], v5 offset:0
ds_read_b64_tr_b16 a[162:163], v5 offset:1024
ds_read_b64_tr_b16 a[164:165], v6 offset:0
ds_read_b64_tr_b16 a[166:167], v6 offset:1024
ds_read_b64_tr_b16 a[168:169], v7 offset:0
ds_read_b64_tr_b16 a[170:171], v7 offset:1024
ds_read_b64_tr_b16 a[172:173], v8 offset:0
ds_read_b64_tr_b16 a[174:175], v8 offset:1024
ds_read_b64_tr_b16 a[176:177], v9 offset:0
ds_read_b64_tr_b16 a[178:179], v9 offset:1024
ds_read_b64_tr_b16 a[180:181], v10 offset:0
ds_read_b64_tr_b16 a[182:183], v10 offset:1024
ds_read_b64_tr_b16 a[184:185], v11 offset:0
ds_read_b64_tr_b16 a[186:187], v11 offset:1024
ds_read_b64_tr_b16 a[188:189], v12 offset:0
ds_read_b64_tr_b16 a[190:191], v12 offset:1024
ds_read_b128 a[192:195], v3 offset:0
ds_read_b128 a[196:199], v4 offset:1024
ds_read_b128 a[200:203], v3 offset:4096
ds_read_b128 a[204:207], v4 offset:5120
ds_read_b128 a[208:211], v3 offset:8192
ds_read_b128 a[212:215], v4 offset:9216
ds_read_b128 a[216:219], v3 offset:12288
ds_read_b128 a[220:223], v4 offset:13312
s_branch L_g_p2
L_g_p1:
ds_read_b128 a[160:163], v3 offset:0
ds_read_b128 a[164:167], v4 offset:1024
ds_read_b128 a[168:171], v3 offset:4096
ds_read_b128 a[172:175], v4 offset:5120
ds_read_b128 a[176:179], v3 offset:8192
ds_read_b128 a[180:183], v4 offset:9216
ds_read_b128 a[184:187], v3 offset:12288
ds_read_b128 a[188:191], v4 offset:13312
ds_read_b64_tr_b16 a[192:193], v5 offset:0
ds_read_b64_tr_b16 a[194:195], v5 offset:1024
ds_read_b64_tr_b16 a[196:197], v6 offset:0
ds_read_b64_tr_b16 a[198:199], v6 offset:1024
ds_read_b64_tr_b16 a[200:201], v7 offset:0
ds_read_b64_tr_b16 a[202:203], v7 offset:1024
ds_read_b64_tr_b16 a[204:205], v8 offset:0
ds_read_b64_tr_b16 a[206:207], v8 offset:1024
ds_read_b64_tr_b16 a[208:209], v9 offset:0
ds_read_b64_tr_b16 a[210:211], v9 offset:1024
ds_read_b64_tr_b16 a[212:213], v10 offset:0
ds_read_b64_tr_b16 a[214:215], v10 offset:1024
ds_read_b64_tr_b16 a[216:217], v11 offset:0
ds_read_b64_tr_b16 a[218:219], v11 offset:1024
ds_read_b64_tr_b16 a[220:221], v12 offset:0
ds_read_b64_tr_b16 a[222:223], v12 offset:1024
L_g_p2:
v_add_u32 v5, 16384, v5
v_and_b32 v5, 65535, v5
v_xor_b32 v6, 16, v5
v_xor_b32 v7, 64, v5
v_xor_b32 v8, 80, v5
v_xor_b32 v9, 128, v5
v_xor_b32 v10, 144, v5
v_xor_b32 v11, 192, v5
v_xor_b32 v12, 208, v5
L_g_tile:
s_cmp_eq_u32 s35, 1
s_cbranch_scc1 L_g_first
L_g_go:
s_cmp_eq_u32 s41, 0
s_cbranch_scc0 L_g_v
.p2align 3
L_g_k:
s_waitcnt vmcnt(16) lgkmcnt(0)
s_barrier
v_mfma_f32_16x16x32_bf16 v[160:163], a[160:163], a[192:195], 0
ds_read_b128 a[224:227], v4 offset:0
v_accvgpr_read_b32 v20, a64
v_accvgpr_read_b32 v21, a65
v_accvgpr_read_b32 v22, a66
v_mfma_f32_16x16x32_bf16 v[164:167], a[160:163], a[196:199], 0
s_add_u32 s37, s31, 0
v_accvgpr_read_b32 v23, a67
v_cvt_pk_bf16_f32 v98, v20, v21
v_cvt_pk_bf16_f32 v99, v22, v23
v_mfma_f32_16x16x32_bf16 v[168:171], a[160:163], a[200:203], 0
s_add_u32 m0, s33, 0
ds_read_b128 a[228:231], v3 offset:1024
v_accvgpr_read_b32 v24, a68
v_accvgpr_read_b32 v25, a69
v_mfma_f32_16x16x32_bf16 v[172:175], a[160:163], a[204:207], 0
buffer_load_dwordx4 v2, s[20:23], s37 offen  lds
v_accvgpr_read_b32 v26, a70
v_accvgpr_read_b32 v27, a71
v_cvt_pk_bf16_f32 v102, v24, v25
v_mfma_f32_16x16x32_bf16 v[176:179], a[160:163], a[208:211], 0
ds_read_b128 a[232:235], v4 offset:4096
v_cvt_pk_bf16_f32 v103, v26, v27
v_accvgpr_read_b32 v20, a72
v_accvgpr_read_b32 v21, a73
v_mfma_f32_16x16x32_bf16 v[180:183], a[160:163], a[212:215], 0
v_accvgpr_read_b32 v22, a74
v_accvgpr_read_b32 v23, a75
v_cvt_pk_bf16_f32 v106, v20, v21
v_cvt_pk_bf16_f32 v107, v22, v23
v_mfma_f32_16x16x32_bf16 v[184:187], a[160:163], a[216:219], 0
ds_read_b128 a[236:239], v3 offset:5120
v_accvgpr_read_b32 v24, a76
v_accvgpr_read_b32 v25, a77
v_accvgpr_read_b32 v26, a78
v_mfma_f32_16x16x32_bf16 v[188:191], a[160:163], a[220:223], 0
ds_read_b64_tr_b16 a[160:161], v5 offset:0
v_accvgpr_read_b32 v27, a79
v_cvt_pk_bf16_f32 v110, v24, v25
v_cvt_pk_bf16_f32 v111, v26, v27
v_mfma_f32_16x16x32_bf16 v[192:195], a[164:167], a[192:195], 0
ds_read_b64_tr_b16 a[162:163], v5 offset:1024
ds_read_b128 a[240:243], v4 offset:8192
v_accvgpr_read_b32 v20, a80
v_accvgpr_read_b32 v21, a81
v_mfma_f32_16x16x32_bf16 v[196:199], a[164:167], a[196:199], 0
s_add_u32 s37, s31, 32768
v_accvgpr_read_b32 v22, a82
v_accvgpr_read_b32 v23, a83
v_cvt_pk_bf16_f32 v114, v20, v21
v_mfma_f32_16x16x32_bf16 v[200:203], a[164:167], a[200:203], 0
s_add_u32 m0, s33, 1024
ds_read_b128 a[244:247], v3 offset:9216
v_cvt_pk_bf16_f32 v115, v22, v23
v_accvgpr_read_b32 v24, a84
v_mfma_f32_16x16x32_bf16 v[204:207], a[164:167], a[204:207], 0
buffer_load_dwordx4 v2, s[20:23], s37 offen  lds
v_accvgpr_read_b32 v25, a85
v_accvgpr_read_b32 v26, a86
v_accvgpr_read_b32 v27, a87
v_mfma_f32_16x16x32_bf16 v[208:211], a[164:167], a[208:211], 0
ds_read_b128 a[248:251], v4 offset:12288
v_cvt_pk_bf16_f32 v118, v24, v25
v_cvt_pk_bf16_f32 v119, v26, v27
v_accvgpr_read_b32 v20, a88
v_mfma_f32_16x16x32_bf16 v[212:215], a[164:167], a[212:215], 0
v_accvgpr_read_b32 v21, a89
v_accvgpr_read_b32 v22, a90
v_accvgpr_read_b32 v23, a91
v_cvt_pk_bf16_f32 v122, v20, v21
v_mfma_f32_16x16x32_bf16 v[216:219], a[164:167], a[216:219], 0
ds_read_b128 a[252:255], v3 offset:13312
v_cvt_pk_bf16_f32 v123, v22, v23
v_accvgpr_read_b32 v24, a92
v_accvgpr_read_b32 v25, a93
v_mfma_f32_16x16x32_bf16 v[220:223], a[164:167], a[220:223], 0
ds_read_b64_tr_b16 a[164:165], v6 offset:0
v_accvgpr_read_b32 v26, a94
v_accvgpr_read_b32 v27, a95
v_cvt_pk_bf16_f32 v126, v24, v25
v_mfma_f32_16x16x32_bf16 v[224:227], a[168:171], a[192:195], 0
ds_read_b64_tr_b16 a[166:167], v6 offset:1024
ds_read_b64_tr_b16 v[28:29], v12 offset:0
v_cvt_pk_bf16_f32 v127, v26, v27
v_accvgpr_read_b32 v20, a96
v_mfma_f32_16x16x32_bf16 v[228:231], a[168:171], a[196:199], 0
s_add_u32 s37, s31, 131072
v_accvgpr_read_b32 v21, a97
v_accvgpr_read_b32 v22, a98
v_accvgpr_read_b32 v23, a99
v_mfma_f32_16x16x32_bf16 v[232:235], a[168:171], a[200:203], 0
s_add_u32 m0, s33, 4096
ds_read_b64_tr_b16 v[30:31], v12 offset:1024
v_cvt_pk_bf16_f32 v128, v20, v21
v_cvt_pk_bf16_f32 v129, v22, v23
v_mfma_f32_16x16x32_bf16 v[236:239], a[168:171], a[204:207], 0
buffer_load_dwordx4 v2, s[20:23], s37 offen  lds
v_accvgpr_read_b32 v24, a100
v_accvgpr_read_b32 v25, a101
v_accvgpr_read_b32 v26, a102
v_mfma_f32_16x16x32_bf16 v[240:243], a[168:171], a[208:211], 0
v_accvgpr_read_b32 v27, a103
v_cvt_pk_bf16_f32 v132, v24, v25
v_cvt_pk_bf16_f32 v133, v26, v27
v_accvgpr_read_b32 v20, a104
v_mfma_f32_16x16x32_bf16 v[244:247], a[168:171], a[212:215], 0
v_accvgpr_read_b32 v21, a105
v_accvgpr_read_b32 v22, a106
v_accvgpr_read_b32 v23, a107
v_cvt_pk_bf16_f32 v136, v20, v21
v_mfma_f32_16x16x32_bf16 v[248:251], a[168:171], a[216:219], 0
v_cvt_pk_bf16_f32 v137, v22, v23
v_accvgpr_read_b32 v24, a108
v_accvgpr_read_b32 v25, a109
v_accvgpr_read_b32 v26, a110
v_mfma_f32_16x16x32_bf16 v[252:255], a[168:171], a[220:223], 0
ds_read_b64_tr_b16 a[168:169], v7 offset:0
v_accvgpr_read_b32 v27, a111
v_cvt_pk_bf16_f32 v140, v24, v25
v_cvt_pk_bf16_f32 v141, v26, v27
v_mfma_f32_16x16x32_bf16 a[0:3], a[172:175], a[192:195], 0
ds_read_b64_tr_b16 a[170:171], v7 offset:1024
v_accvgpr_read_b32 v20, a112
v_accvgpr_read_b32 v21, a113
v_accvgpr_read_b32 v22, a114
v_mfma_f32_16x16x32_bf16 a[4:7], a[172:175], a[196:199], 0
s_add_u32 s37, s31, 163840
v_accvgpr_read_b32 v23, a115
v_cvt_pk_bf16_f32 v144, v20, v21
v_cvt_pk_bf16_f32 v145, v22, v23
v_mfma_f32_16x16x32_bf16 a[8:11], a[172:175], a[200:203], 0
s_add_u32 m0, s33, 5120
v_accvgpr_read_b32 v24, a116
v_accvgpr_read_b32 v25, a117
v_accvgpr_read_b32 v26, a118
v_mfma_f32_16x16x32_bf16 a[12:15], a[172:175], a[204:207], 0
buffer_load_dwordx4 v2, s[20:23], s37 offen  lds
v_accvgpr_read_b32 v27, a119
v_cvt_pk_bf16_f32 v148, v24, v25
v_cvt_pk_bf16_f32 v149, v26, v27
v_mfma_f32_16x16x32_bf16 a[16:19], a[172:175], a[208:211], 0
v_accvgpr_read_b32 v20, a120
v_accvgpr_read_b32 v21, a121
v_accvgpr_read_b32 v22, a122
v_accvgpr_read_b32 v23, a123
v_mfma_f32_16x16x32_bf16 a[20:23], a[172:175], a[212:215], 0
v_cvt_pk_bf16_f32 v152, v20, v21
v_cvt_pk_bf16_f32 v153, v22, v23
v_accvgpr_read_b32 v24, a124
v_accvgpr_read_b32 v25, a125
v_mfma_f32_16x16x32_bf16 a[24:27], a[172:175], a[216:219], 0
v_accvgpr_read_b32 v26, a126
v_accvgpr_read_b32 v27, a127
v_cvt_pk_bf16_f32 v156, v24, v25
v_cvt_pk_bf16_f32 v157, v26, v27
s_mov_b32 s38, s62
v_mfma_f32_16x16x32_bf16 a[28:31], a[172:175], a[220:223], 0
ds_read_b64_tr_b16 a[172:173], v8 offset:0
v_accvgpr_read_b32 v20, a128
v_accvgpr_read_b32 v21, a129
v_accvgpr_read_b32 v22, a130
s_mov_b32 s39, s63
v_mfma_f32_16x16x32_bf16 a[32:35], a[176:179], a[192:195], 0
ds_read_b64_tr_b16 a[174:175], v8 offset:1024
s_add_u32 s31, s31, 262144
v_accvgpr_read_b32 v23, a131
v_cvt_pk_bf16_f32 v130, v20, v21
s_mov_b32 s49, s50
v_mfma_f32_16x16x32_bf16 a[36:39], a[176:179], a[196:199], 0
s_add_u32 s48, s48, s34
s_add_u32 s33, s33, 16384
v_cvt_pk_bf16_f32 v131, v22, v23
v_accvgpr_read_b32 v24, a132
s_mov_b32 s62, s42
v_mfma_f32_16x16x32_bf16 a[40:43], a[176:179], a[200:203], 0
s_add_u32 m0, s32, 16384
s_and_b32 s33, s33, 65535
v_accvgpr_read_b32 v25, a133
v_accvgpr_read_b32 v26, a134
s_mov_b32 s63, s43
v_mfma_f32_16x16x32_bf16 a[44:47], a[176:179], a[204:207], 0
buffer_load_dwordx4 v1, s[12:15], s48 offen lds
v_accvgpr_read_b32 v27, a135
v_cvt_pk_bf16_f32 v134, v24, v25
v_cvt_pk_bf16_f32 v135, v26, v27
s_mov_b32 s50, s51
v_mfma_f32_16x16x32_bf16 a[48:51], a[176:179], a[208:211], 0
v_accvgpr_read_b32 v20, a136
v_accvgpr_read_b32 v21, a137
v_accvgpr_read_b32 v22, a138
v_accvgpr_read_b32 v23, a139
s_mov_b32 s36, s40
v_mfma_f32_16x16x32_bf16 a[52:55], a[176:179], a[212:215], 0
v_cvt_pk_bf16_f32 v138, v20, v21
v_cvt_pk_bf16_f32 v139, v22, v23
v_accvgpr_read_b32 v24, a140
v_accvgpr_read_b32 v25, a141
s_add_u32 s35, s35, 1
v_mfma_f32_16x16x32_bf16 a[56:59], a[176:179], a[216:219], 0
v_accvgpr_read_b32 v26, a142
v_accvgpr_read_b32 v27, a143
v_cvt_pk_bf16_f32 v142, v24, v25
v_cvt_pk_bf16_f32 v143, v26, v27
v_bfe_u32 v16, v0, 3, 3
v_mfma_f32_16x16x32_bf16 a[60:63], a[176:179], a[220:223], 0
ds_read_b64_tr_b16 a[176:177], v9 offset:0
v_accvgpr_read_b32 v20, a144
v_accvgpr_read_b32 v21, a145
v_accvgpr_read_b32 v22, a146
v_lshlrev_b32 v16, 4, v16
v_mfma_f32_16x16x32_bf16 a[64:67], a[180:183], a[192:195], 0
ds_read_b64_tr_b16 a[178:179], v9 offset:1024
v_accvgpr_read_b32 v23, a147
v_cvt_pk_bf16_f32 v146, v20, v21
v_cvt_pk_bf16_f32 v147, v22, v23
v_and_or_b32 v16, v0, 7, v16
v_mfma_f32_16x16x32_bf16 a[68:71], a[180:183], a[196:199], 0
s_add_u32 s48, s48, s34
v_accvgpr_read_b32 v24, a148
v_accvgpr_read_b32 v25, a149
v_accvgpr_read_b32 v26, a150
v_bfe_u32 v17, v0, 4, 2
v_mfma_f32_16x16x32_bf16 a[72:75], a[180:183], a[200:203], 0
s_add_u32 m0, s32, 20480
v_accvgpr_read_b32 v27, a151
v_cvt_pk_bf16_f32 v150, v24, v25
v_cvt_pk_bf16_f32 v151, v26, v27
v_lshlrev_b32 v17, 5, v17
v_mfma_f32_16x16x32_bf16 a[76:79], a[180:183], a[204:207], 0
buffer_load_dwordx4 v1, s[12:15], s48 offen lds
v_accvgpr_read_b32 v20, a152
v_accvgpr_read_b32 v21, a153
v_accvgpr_read_b32 v22, a154
v_and_or_b32 v17, v0, 8, v17
v_mfma_f32_16x16x32_bf16 a[80:83], a[180:183], a[208:211], 0
v_accvgpr_read_b32 v23, a155
v_cvt_pk_bf16_f32 v154, v20, v21
v_cvt_pk_bf16_f32 v155, v22, v23
v_accvgpr_read_b32 v24, a156
v_bfe_u32 v18, v0, 1, 2
v_mfma_f32_16x16x32_bf16 a[84:87], a[180:183], a[212:215], 0
v_accvgpr_read_b32 v25, a157
v_accvgpr_read_b32 v26, a158
v_accvgpr_read_b32 v27, a159
v_cvt_pk_bf16_f32 v158, v24, v25
v_or_b32 v17, v17, v18
v_mfma_f32_16x16x32_bf16 a[88:91], a[180:183], a[216:219], 0
v_cvt_pk_bf16_f32 v159, v26, v27
v_and_b32 v18, 1, v0
v_lshl_or_b32 v17, v18, 4, v17
v_mfma_f32_16x16x32_bf16 a[92:95], a[180:183], a[220:223], 0
ds_read_b64_tr_b16 a[180:181], v10 offset:0
s_bitcmp1_b32 s49, 1
s_cselect_b64 vcc, -1, 0
s_cselect_b32 s44, 64, 0x80
v_cndmask_b32 v16, v16, v17, vcc
v_mfma_f32_16x16x32_bf16 a[96:99], a[184:187], a[192:195], 0
ds_read_b64_tr_b16 a[182:183], v10 offset:1024
v_lshlrev_b32 v13, 4, v16
s_movk_i32 s92, 0x800
s_bitcmp1_b32 s49, 0
s_cselect_b32 s92, 0x4000, s92
v_mfma_f32_16x16x32_bf16 a[100:103], a[184:187], a[196:199], 0
s_add_u32 s48, s48, s34
s_xor_b32 s93, s92, 0x4800
s_sub_u32 s93, s93, s44
v_mfma_f32_16x16x32_bf16 a[104:107], a[184:187], a[200:203], 0
s_add_u32 m0, s32, 24576
v_mfma_f32_16x16x32_bf16 a[108:111], a[184:187], a[204:207], 0
buffer_load_dwordx4 v1, s[12:15], s48 offen lds
v_mfma_f32_16x16x32_bf16 a[112:115], a[184:187], a[208:211], 0
v_mfma_f32_16x16x32_bf16 a[116:119], a[184:187], a[212:215], 0
v_mfma_f32_16x16x32_bf16 a[120:123], a[184:187], a[216:219], 0
v_mfma_f32_16x16x32_bf16 a[124:127], a[184:187], a[220:223], 0
ds_read_b64_tr_b16 a[184:185], v11 offset:0
v_mfma_f32_16x16x32_bf16 a[128:131], a[188:191], a[192:195], 0
ds_read_b64_tr_b16 a[186:187], v11 offset:1024
v_mfma_f32_16x16x32_bf16 a[132:135], a[188:191], a[196:199], 0
s_add_u32 s48, s48, s34
v_add_u32 v3, 32768, v3
v_subrev_u32 v19, 98304, v3
v_mfma_f32_16x16x32_bf16 a[136:139], a[188:191], a[200:203], 0
s_add_u32 m0, s32, 28672
v_cmp_le_u32 vcc, 163840, v3
v_add_u32 v5, 16384, v5
v_mfma_f32_16x16x32_bf16 a[140:143], a[188:191], a[204:207], 0
buffer_load_dwordx4 v1, s[12:15], s48 offen lds
v_and_b32 v5, 65535, v5
v_xor_b32 v6, 16, v5
v_mfma_f32_16x16x32_bf16 a[144:147], a[188:191], a[208:211], 0
s_add_u32 s30, s30, 128
s_add_u32 s32, s32, 32768
s_sub_u32 s48, s32, 98304
v_mfma_f32_16x16x32_bf16 a[148:151], a[188:191], a[212:215], 0
s_cmp_ge_u32 s32, 163840
s_cselect_b32 s32, s48, s32
v_xor_b32 v7, 64, v5
v_mfma_f32_16x16x32_bf16 a[152:155], a[188:191], a[216:219], 0
v_xor_b32 v8, 80, v5
v_xor_b32 v9, 128, v5
v_xor_b32 v10, 144, v5
v_mfma_f32_16x16x32_bf16 a[156:159], a[188:191], a[220:223], 0
v_xor_b32 v11, 192, v5
v_xor_b32 v12, 208, v5
v_cndmask_b32 v3, v3, v19, vcc
v_xor_b32 v4, 64, v3
s_waitcnt vmcnt(16) lgkmcnt(0)
s_barrier
v_mfma_f32_16x16x32_bf16 v[160:163], a[160:163], a[224:227], v[160:163]
ds_read_b128 a[192:195], v3 offset:0
v_mfma_f32_16x16x32_bf16 v[164:167], a[160:163], a[228:231], v[164:167]
s_add_u32 s37, s31, 0
v_mfma_f32_16x16x32_bf16 v[168:171], a[160:163], a[232:235], v[168:171]
s_add_u32 m0, s33, 0
ds_read_b128 a[196:199], v4 offset:1024
v_mfma_f32_16x16x32_bf16 v[172:175], a[160:163], a[236:239], v[172:175]
buffer_load_dwordx4 v2, s[20:23], s37 offen  lds
s_mov_b32 s60, s38
v_mfma_f32_16x16x32_bf16 v[176:179], a[160:163], a[240:243], v[176:179]
s_mov_b32 s29, s38
ds_read_b128 a[200:203], v3 offset:4096
v_mfma_f32_16x16x32_bf16 v[180:183], a[160:163], a[244:247], v[180:183]
buffer_store_dwordx4 v[32:35], v13, s[8:11], s29 offen sc1
v_mfma_f32_16x16x32_bf16 v[184:187], a[160:163], a[248:251], v[184:187]
ds_read_b128 a[204:207], v4 offset:5120
v_mfma_f32_16x16x32_bf16 v[188:191], a[160:163], a[252:255], v[188:191]
ds_read_b64_tr_b16 a[160:161], v5 offset:0
v_mfma_f32_16x16x32_bf16 v[192:195], a[164:167], a[224:227], v[192:195]
ds_read_b64_tr_b16 a[162:163], v5 offset:1024
ds_read_b128 a[208:211], v3 offset:8192
v_mfma_f32_16x16x32_bf16 v[196:199], a[164:167], a[228:231], v[196:199]
s_add_u32 s37, s31, 32768
v_mfma_f32_16x16x32_bf16 v[200:203], a[164:167], a[232:235], v[200:203]
s_add_u32 m0, s33, 1024
ds_read_b128 a[212:215], v4 offset:9216
v_mfma_f32_16x16x32_bf16 v[204:207], a[164:167], a[236:239], v[204:207]
buffer_load_dwordx4 v2, s[20:23], s37 offen  lds
v_mfma_f32_16x16x32_bf16 v[208:211], a[164:167], a[240:243], v[208:211]
ds_read_b128 a[216:219], v3 offset:12288
v_mfma_f32_16x16x32_bf16 v[212:215], a[164:167], a[244:247], v[212:215]
v_mfma_f32_16x16x32_bf16 v[216:219], a[164:167], a[248:251], v[216:219]
ds_read_b128 a[220:223], v4 offset:13312
v_mfma_f32_16x16x32_bf16 v[220:223], a[164:167], a[252:255], v[220:223]
ds_read_b64_tr_b16 a[164:165], v6 offset:0
v_mfma_f32_16x16x32_bf16 v[224:227], a[168:171], a[224:227], v[224:227]
ds_read_b64_tr_b16 a[166:167], v6 offset:1024
ds_read_b64_tr_b16 a[188:189], v12 offset:0
v_mfma_f32_16x16x32_bf16 v[228:231], a[168:171], a[228:231], v[228:231]
s_add_u32 s37, s31, 131072
v_mfma_f32_16x16x32_bf16 v[232:235], a[168:171], a[232:235], v[232:235]
s_add_u32 m0, s33, 4096
ds_read_b64_tr_b16 a[190:191], v12 offset:1024
v_mfma_f32_16x16x32_bf16 v[236:239], a[168:171], a[236:239], v[236:239]
buffer_load_dwordx4 v2, s[20:23], s37 offen  lds
v_mfma_f32_16x16x32_bf16 v[240:243], a[168:171], a[240:243], v[240:243]
v_mfma_f32_16x16x32_bf16 v[244:247], a[168:171], a[244:247], v[244:247]
v_mfma_f32_16x16x32_bf16 v[248:251], a[168:171], a[248:251], v[248:251]
v_mfma_f32_16x16x32_bf16 v[252:255], a[168:171], a[252:255], v[252:255]
ds_read_b64_tr_b16 a[168:169], v7 offset:0
v_mfma_f32_16x16x32_bf16 a[0:3], a[172:175], a[224:227], a[0:3]
ds_read_b64_tr_b16 a[170:171], v7 offset:1024
v_mfma_f32_16x16x32_bf16 a[4:7], a[172:175], a[228:231], a[4:7]
s_add_u32 s37, s31, 163840
v_mfma_f32_16x16x32_bf16 a[8:11], a[172:175], a[232:235], a[8:11]
s_add_u32 m0, s33, 5120
v_mfma_f32_16x16x32_bf16 a[12:15], a[172:175], a[236:239], a[12:15]
buffer_load_dwordx4 v2, s[20:23], s37 offen  lds
s_add_u32 s29, s29, s44
v_mfma_f32_16x16x32_bf16 a[16:19], a[172:175], a[240:243], a[16:19]
v_mfma_f32_16x16x32_bf16 a[20:23], a[172:175], a[244:247], a[20:23]
buffer_store_dwordx4 v[36:39], v13, s[8:11], s29 offen sc1
v_mfma_f32_16x16x32_bf16 a[24:27], a[172:175], a[248:251], a[24:27]
v_mfma_f32_16x16x32_bf16 a[28:31], a[172:175], a[252:255], a[28:31]
ds_read_b64_tr_b16 a[172:173], v8 offset:0
v_mfma_f32_16x16x32_bf16 a[32:35], a[176:179], a[224:227], a[32:35]
ds_read_b64_tr_b16 a[174:175], v8 offset:1024
s_add_u32 s31, s31, 262144
v_mfma_f32_16x16x32_bf16 a[36:39], a[176:179], a[228:231], a[36:39]
s_mov_b32 s48, s30
s_add_u32 s33, s33, 16384
v_mfma_f32_16x16x32_bf16 a[40:43], a[176:179], a[232:235], a[40:43]
s_add_u32 m0, s32, 0
s_and_b32 s33, s33, 65535
v_mfma_f32_16x16x32_bf16 a[44:47], a[176:179], a[236:239], a[44:47]
buffer_load_dwordx4 v1, s[12:15], s48 offen lds
v_mfma_f32_16x16x32_bf16 a[48:51], a[176:179], a[240:243], a[48:51]
v_mfma_f32_16x16x32_bf16 a[52:55], a[176:179], a[244:247], a[52:55]
v_mfma_f32_16x16x32_bf16 a[56:59], a[176:179], a[248:251], a[56:59]
v_mfma_f32_16x16x32_bf16 a[60:63], a[176:179], a[252:255], a[60:63]
ds_read_b64_tr_b16 a[176:177], v9 offset:0
v_mfma_f32_16x16x32_bf16 a[64:67], a[180:183], a[224:227], a[64:67]
ds_read_b64_tr_b16 a[178:179], v9 offset:1024
v_mfma_f32_16x16x32_bf16 a[68:71], a[180:183], a[228:231], a[68:71]
s_add_u32 s48, s48, s34
v_mfma_f32_16x16x32_bf16 a[72:75], a[180:183], a[232:235], a[72:75]
s_add_u32 m0, s32, 4096
v_mfma_f32_16x16x32_bf16 a[76:79], a[180:183], a[236:239], a[76:79]
buffer_load_dwordx4 v1, s[12:15], s48 offen lds
v_mfma_f32_16x16x32_bf16 a[80:83], a[180:183], a[240:243], a[80:83]
v_mfma_f32_16x16x32_bf16 a[84:87], a[180:183], a[244:247], a[84:87]
v_mfma_f32_16x16x32_bf16 a[88:91], a[180:183], a[248:251], a[88:91]
v_mfma_f32_16x16x32_bf16 a[92:95], a[180:183], a[252:255], a[92:95]
ds_read_b64_tr_b16 a[180:181], v10 offset:0
v_mfma_f32_16x16x32_bf16 a[96:99], a[184:187], a[224:227], a[96:99]
ds_read_b64_tr_b16 a[182:183], v10 offset:1024
v_mfma_f32_16x16x32_bf16 a[100:103], a[184:187], a[228:231], a[100:103]
s_add_u32 s48, s48, s34
v_mfma_f32_16x16x32_bf16 a[104:107], a[184:187], a[232:235], a[104:107]
s_add_u32 m0, s32, 8192
v_mfma_f32_16x16x32_bf16 a[108:111], a[184:187], a[236:239], a[108:111]
buffer_load_dwordx4 v1, s[12:15], s48 offen lds
s_add_u32 s29, s29, s93
v_mfma_f32_16x16x32_bf16 a[112:115], a[184:187], a[240:243], a[112:115]
v_mfma_f32_16x16x32_bf16 a[116:119], a[184:187], a[244:247], a[116:119]
buffer_store_dwordx4 v[40:43], v13, s[8:11], s29 offen sc1
v_mfma_f32_16x16x32_bf16 a[120:123], a[184:187], a[248:251], a[120:123]
v_mfma_f32_16x16x32_bf16 a[124:127], a[184:187], a[252:255], a[124:127]
ds_read_b64_tr_b16 a[184:185], v11 offset:0
v_mfma_f32_16x16x32_bf16 a[128:131], v[28:31], a[224:227], a[128:131]
ds_read_b64_tr_b16 a[186:187], v11 offset:1024
v_mfma_f32_16x16x32_bf16 a[132:135], v[28:31], a[228:231], a[132:135]
s_add_u32 s48, s48, s34
v_add_u32 v5, 16384, v5
v_and_b32 v5, 65535, v5
v_mfma_f32_16x16x32_bf16 a[136:139], v[28:31], a[232:235], a[136:139]
s_add_u32 m0, s32, 12288
v_xor_b32 v6, 16, v5
v_xor_b32 v7, 64, v5
v_mfma_f32_16x16x32_bf16 a[140:143], v[28:31], a[236:239], a[140:143]
buffer_load_dwordx4 v1, s[12:15], s48 offen lds
v_xor_b32 v8, 80, v5
v_xor_b32 v9, 128, v5
v_mfma_f32_16x16x32_bf16 a[144:147], v[28:31], a[240:243], a[144:147]
v_xor_b32 v10, 144, v5
v_xor_b32 v11, 192, v5
v_xor_b32 v12, 208, v5
v_mfma_f32_16x16x32_bf16 a[148:151], v[28:31], a[244:247], a[148:151]
v_mfma_f32_16x16x32_bf16 a[152:155], v[28:31], a[248:251], a[152:155]
v_mfma_f32_16x16x32_bf16 a[156:159], v[28:31], a[252:255], a[156:159]
s_waitcnt vmcnt(19) lgkmcnt(0)
s_barrier
v_mfma_f32_16x16x32_bf16 v[160:163], a[160:163], a[192:195], v[160:163]
ds_read_b128 a[224:227], v4 offset:0
v_mfma_f32_16x16x32_bf16 v[164:167], a[160:163], a[196:199], v[164:167]
s_add_u32 s37, s31, 0
v_mfma_f32_16x16x32_bf16 v[168:171], a[160:163], a[200:203], v[168:171]
s_add_u32 m0, s33, 0
ds_read_b128 a[228:231], v3 offset:1024
v_mfma_f32_16x16x32_bf16 v[172:175], a[160:163], a[204:207], v[172:175]
buffer_load_dwordx4 v2, s[20:23], s37 offen  lds
s_add_u32 s29, s29, s44
v_mfma_f32_16x16x32_bf16 v[176:179], a[160:163], a[208:211], v[176:179]
ds_read_b128 a[232:235], v4 offset:4096
v_mfma_f32_16x16x32_bf16 v[180:183], a[160:163], a[212:215], v[180:183]
buffer_store_dwordx4 v[44:47], v13, s[8:11], s29 offen sc1
v_mfma_f32_16x16x32_bf16 v[184:187], a[160:163], a[216:219], v[184:187]
ds_read_b128 a[236:239], v3 offset:5120
v_mfma_f32_16x16x32_bf16 v[188:191], a[160:163], a[220:223], v[188:191]
ds_read_b64_tr_b16 a[160:161], v5 offset:0
v_mfma_f32_16x16x32_bf16 v[192:195], a[164:167], a[192:195], v[192:195]
ds_read_b64_tr_b16 a[162:163], v5 offset:1024
ds_read_b128 a[240:243], v4 offset:8192
v_mfma_f32_16x16x32_bf16 v[196:199], a[164:167], a[196:199], v[196:199]
s_add_u32 s37, s31, 32768
v_mfma_f32_16x16x32_bf16 v[200:203], a[164:167], a[200:203], v[200:203]
s_add_u32 m0, s33, 1024
ds_read_b128 a[244:247], v3 offset:9216
v_mfma_f32_16x16x32_bf16 v[204:207], a[164:167], a[204:207], v[204:207]
buffer_load_dwordx4 v2, s[20:23], s37 offen  lds
v_mfma_f32_16x16x32_bf16 v[208:211], a[164:167], a[208:211], v[208:211]
ds_read_b128 a[248:251], v4 offset:12288
v_mfma_f32_16x16x32_bf16 v[212:215], a[164:167], a[212:215], v[212:215]
v_mfma_f32_16x16x32_bf16 v[216:219], a[164:167], a[216:219], v[216:219]
ds_read_b128 a[252:255], v3 offset:13312
v_mfma_f32_16x16x32_bf16 v[220:223], a[164:167], a[220:223], v[220:223]
ds_read_b64_tr_b16 a[164:165], v6 offset:0
v_mfma_f32_16x16x32_bf16 v[224:227], a[168:171], a[192:195], v[224:227]
ds_read_b64_tr_b16 a[166:167], v6 offset:1024
ds_read_b64_tr_b16 v[28:29], v12 offset:0
v_mfma_f32_16x16x32_bf16 v[228:231], a[168:171], a[196:199], v[228:231]
s_add_u32 s37, s31, 131072
v_mfma_f32_16x16x32_bf16 v[232:235], a[168:171], a[200:203], v[232:235]
s_add_u32 m0, s33, 4096
ds_read_b64_tr_b16 v[30:31], v12 offset:1024
v_mfma_f32_16x16x32_bf16 v[236:239], a[168:171], a[204:207], v[236:239]
buffer_load_dwordx4 v2, s[20:23], s37 offen  lds
v_mfma_f32_16x16x32_bf16 v[240:243], a[168:171], a[208:211], v[240:243]
v_mfma_f32_16x16x32_bf16 v[244:247], a[168:171], a[212:215], v[244:247]
v_mfma_f32_16x16x32_bf16 v[248:251], a[168:171], a[216:219], v[248:251]
v_mfma_f32_16x16x32_bf16 v[252:255], a[168:171], a[220:223], v[252:255]
ds_read_b64_tr_b16 a[168:169], v7 offset:0
v_mfma_f32_16x16x32_bf16 a[0:3], a[172:175], a[192:195], a[0:3]
ds_read_b64_tr_b16 a[170:171], v7 offset:1024
v_mfma_f32_16x16x32_bf16 a[4:7], a[172:175], a[196:199], a[4:7]
s_add_u32 s37, s31, 163840
v_mfma_f32_16x16x32_bf16 a[8:11], a[172:175], a[200:203], a[8:11]
s_add_u32 m0, s33, 5120
v_mfma_f32_16x16x32_bf16 a[12:15], a[172:175], a[204:207], a[12:15]
buffer_load_dwordx4 v2, s[20:23], s37 offen  lds
s_add_u32 s29, s29, s93
v_mfma_f32_16x16x32_bf16 a[16:19], a[172:175], a[208:211], a[16:19]
v_mfma_f32_16x16x32_bf16 a[20:23], a[172:175], a[212:215], a[20:23]
buffer_store_dwordx4 v[48:51], v13, s[8:11], s29 offen sc1
v_mfma_f32_16x16x32_bf16 a[24:27], a[172:175], a[216:219], a[24:27]
v_mfma_f32_16x16x32_bf16 a[28:31], a[172:175], a[220:223], a[28:31]
ds_read_b64_tr_b16 a[172:173], v8 offset:0
v_mfma_f32_16x16x32_bf16 a[32:35], a[176:179], a[192:195], a[32:35]
ds_read_b64_tr_b16 a[174:175], v8 offset:1024
s_add_u32 s31, s31, 262144
v_mfma_f32_16x16x32_bf16 a[36:39], a[176:179], a[196:199], a[36:39]
s_add_u32 s48, s48, s34
s_add_u32 s33, s33, 16384
v_mfma_f32_16x16x32_bf16 a[40:43], a[176:179], a[200:203], a[40:43]
s_add_u32 m0, s32, 16384
s_and_b32 s33, s33, 65535
v_mfma_f32_16x16x32_bf16 a[44:47], a[176:179], a[204:207], a[44:47]
buffer_load_dwordx4 v1, s[12:15], s48 offen lds
v_mfma_f32_16x16x32_bf16 a[48:51], a[176:179], a[208:211], a[48:51]
v_mfma_f32_16x16x32_bf16 a[52:55], a[176:179], a[212:215], a[52:55]
v_mfma_f32_16x16x32_bf16 a[56:59], a[176:179], a[216:219], a[56:59]
v_mfma_f32_16x16x32_bf16 a[60:63], a[176:179], a[220:223], a[60:63]
ds_read_b64_tr_b16 a[176:177], v9 offset:0
v_mfma_f32_16x16x32_bf16 a[64:67], a[180:183], a[192:195], a[64:67]
ds_read_b64_tr_b16 a[178:179], v9 offset:1024
v_mfma_f32_16x16x32_bf16 a[68:71], a[180:183], a[196:199], a[68:71]
s_add_u32 s48, s48, s34
v_mfma_f32_16x16x32_bf16 a[72:75], a[180:183], a[200:203], a[72:75]
s_add_u32 m0, s32, 20480
v_mfma_f32_16x16x32_bf16 a[76:79], a[180:183], a[204:207], a[76:79]
buffer_load_dwordx4 v1, s[12:15], s48 offen lds
v_mfma_f32_16x16x32_bf16 a[80:83], a[180:183], a[208:211], a[80:83]
v_mfma_f32_16x16x32_bf16 a[84:87], a[180:183], a[212:215], a[84:87]
v_mfma_f32_16x16x32_bf16 a[88:91], a[180:183], a[216:219], a[88:91]
v_mfma_f32_16x16x32_bf16 a[92:95], a[180:183], a[220:223], a[92:95]
ds_read_b64_tr_b16 a[180:181], v10 offset:0
v_mfma_f32_16x16x32_bf16 a[96:99], a[184:187], a[192:195], a[96:99]
ds_read_b64_tr_b16 a[182:183], v10 offset:1024
v_mfma_f32_16x16x32_bf16 a[100:103], a[184:187], a[196:199], a[100:103]
s_add_u32 s48, s48, s34
v_mfma_f32_16x16x32_bf16 a[104:107], a[184:187], a[200:203], a[104:107]
s_add_u32 m0, s32, 24576
v_mfma_f32_16x16x32_bf16 a[108:111], a[184:187], a[204:207], a[108:111]
buffer_load_dwordx4 v1, s[12:15], s48 offen lds
s_add_u32 s29, s29, s44
v_mfma_f32_16x16x32_bf16 a[112:115], a[184:187], a[208:211], a[112:115]
v_mfma_f32_16x16x32_bf16 a[116:119], a[184:187], a[212:215], a[116:119]
buffer_store_dwordx4 v[52:55], v13, s[8:11], s29 offen sc1
v_mfma_f32_16x16x32_bf16 a[120:123], a[184:187], a[216:219], a[120:123]
v_mfma_f32_16x16x32_bf16 a[124:127], a[184:187], a[220:223], a[124:127]
ds_read_b64_tr_b16 a[184:185], v11 offset:0
v_mfma_f32_16x16x32_bf16 a[128:131], a[188:191], a[192:195], a[128:131]
ds_read_b64_tr_b16 a[186:187], v11 offset:1024
v_mfma_f32_16x16x32_bf16 a[132:135], a[188:191], a[196:199], a[132:135]
s_add_u32 s48, s48, s34
v_add_u32 v3, 32768, v3
v_subrev_u32 v19, 98304, v3
v_mfma_f32_16x16x32_bf16 a[136:139], a[188:191], a[200:203], a[136:139]
s_add_u32 m0, s32, 28672
v_cmp_le_u32 vcc, 163840, v3
v_add_u32 v5, 16384, v5
v_mfma_f32_16x16x32_bf16 a[140:143], a[188:191], a[204:207], a[140:143]
buffer_load_dwordx4 v1, s[12:15], s48 offen lds
v_and_b32 v5, 65535, v5
v_xor_b32 v6, 16, v5
v_mfma_f32_16x16x32_bf16 a[144:147], a[188:191], a[208:211], a[144:147]
s_add_u32 s30, s30, 128
s_add_u32 s32, s32, 32768
s_sub_u32 s48, s32, 98304
v_mfma_f32_16x16x32_bf16 a[148:151], a[188:191], a[212:215], a[148:151]
s_cmp_ge_u32 s32, 163840
s_cselect_b32 s32, s48, s32
v_xor_b32 v7, 64, v5
v_mfma_f32_16x16x32_bf16 a[152:155], a[188:191], a[216:219], a[152:155]
v_xor_b32 v8, 80, v5
v_xor_b32 v9, 128, v5
v_xor_b32 v10, 144, v5
v_mfma_f32_16x16x32_bf16 a[156:159], a[188:191], a[220:223], a[156:159]
v_xor_b32 v11, 192, v5
v_xor_b32 v12, 208, v5
v_cndmask_b32 v3, v3, v19, vcc
v_xor_b32 v4, 64, v3
s_waitcnt vmcnt(22) lgkmcnt(0)
s_barrier
v_mfma_f32_16x16x32_bf16 v[160:163], a[160:163], a[224:227], v[160:163]
ds_read_b128 a[192:195], v3 offset:0
v_mfma_f32_16x16x32_bf16 v[164:167], a[160:163], a[228:231], v[164:167]
s_add_u32 s37, s31, 0
v_mfma_f32_16x16x32_bf16 v[168:171], a[160:163], a[232:235], v[168:171]
s_add_u32 m0, s33, 0
ds_read_b128 a[196:199], v4 offset:1024
v_mfma_f32_16x16x32_bf16 v[172:175], a[160:163], a[236:239], v[172:175]
buffer_load_dwordx4 v2, s[20:23], s37 offen  lds
s_add_u32 s29, s29, s93
v_mfma_f32_16x16x32_bf16 v[176:179], a[160:163], a[240:243], v[176:179]
ds_read_b128 a[200:203], v3 offset:4096
v_mfma_f32_16x16x32_bf16 v[180:183], a[160:163], a[244:247], v[180:183]
buffer_store_dwordx4 v[56:59], v13, s[8:11], s29 offen sc1
v_mfma_f32_16x16x32_bf16 v[184:187], a[160:163], a[248:251], v[184:187]
ds_read_b128 a[204:207], v4 offset:5120
v_mfma_f32_16x16x32_bf16 v[188:191], a[160:163], a[252:255], v[188:191]
ds_read_b64_tr_b16 a[160:161], v5 offset:0
v_mfma_f32_16x16x32_bf16 v[192:195], a[164:167], a[224:227], v[192:195]
ds_read_b64_tr_b16 a[162:163], v5 offset:1024
ds_read_b128 a[208:211], v3 offset:8192
v_mfma_f32_16x16x32_bf16 v[196:199], a[164:167], a[228:231], v[196:199]
s_add_u32 s37, s31, 32768
v_mfma_f32_16x16x32_bf16 v[200:203], a[164:167], a[232:235], v[200:203]
s_add_u32 m0, s33, 1024
ds_read_b128 a[212:215], v4 offset:9216
v_mfma_f32_16x16x32_bf16 v[204:207], a[164:167], a[236:239], v[204:207]
buffer_load_dwordx4 v2, s[20:23], s37 offen  lds
v_mfma_f32_16x16x32_bf16 v[208:211], a[164:167], a[240:243], v[208:211]
ds_read_b128 a[216:219], v3 offset:12288
v_mfma_f32_16x16x32_bf16 v[212:215], a[164:167], a[244:247], v[212:215]
v_mfma_f32_16x16x32_bf16 v[216:219], a[164:167], a[248:251], v[216:219]
ds_read_b128 a[220:223], v4 offset:13312
v_mfma_f32_16x16x32_bf16 v[220:223], a[164:167], a[252:255], v[220:223]
ds_read_b64_tr_b16 a[164:165], v6 offset:0
v_mfma_f32_16x16x32_bf16 v[224:227], a[168:171], a[224:227], v[224:227]
ds_read_b64_tr_b16 a[166:167], v6 offset:1024
ds_read_b64_tr_b16 a[188:189], v12 offset:0
v_mfma_f32_16x16x32_bf16 v[228:231], a[168:171], a[228:231], v[228:231]
s_add_u32 s37, s31, 131072
v_mfma_f32_16x16x32_bf16 v[232:235], a[168:171], a[232:235], v[232:235]
s_add_u32 m0, s33, 4096
ds_read_b64_tr_b16 a[190:191], v12 offset:1024
v_mfma_f32_16x16x32_bf16 v[236:239], a[168:171], a[236:239], v[236:239]
buffer_load_dwordx4 v2, s[20:23], s37 offen  lds
v_mfma_f32_16x16x32_bf16 v[240:243], a[168:171], a[240:243], v[240:243]
v_mfma_f32_16x16x32_bf16 v[244:247], a[168:171], a[244:247], v[244:247]
v_mfma_f32_16x16x32_bf16 v[248:251], a[168:171], a[248:251], v[248:251]
v_mfma_f32_16x16x32_bf16 v[252:255], a[168:171], a[252:255], v[252:255]
ds_read_b64_tr_b16 a[168:169], v7 offset:0
v_mfma_f32_16x16x32_bf16 a[0:3], a[172:175], a[224:227], a[0:3]
ds_read_b64_tr_b16 a[170:171], v7 offset:1024
v_mfma_f32_16x16x32_bf16 a[4:7], a[172:175], a[228:231], a[4:7]
s_add_u32 s37, s31, 163840
v_mfma_f32_16x16x32_bf16 a[8:11], a[172:175], a[232:235], a[8:11]
s_add_u32 m0, s33, 5120
v_mfma_f32_16x16x32_bf16 a[12:15], a[172:175], a[236:239], a[12:15]
buffer_load_dwordx4 v2, s[20:23], s37 offen  lds
s_add_u32 s29, s29, s44
v_mfma_f32_16x16x32_bf16 a[16:19], a[172:175], a[240:243], a[16:19]
v_mfma_f32_16x16x32_bf16 a[20:23], a[172:175], a[244:247], a[20:23]
buffer_store_dwordx4 v[60:63], v13, s[8:11], s29 offen sc1
v_mfma_f32_16x16x32_bf16 a[24:27], a[172:175], a[248:251], a[24:27]
v_mfma_f32_16x16x32_bf16 a[28:31], a[172:175], a[252:255], a[28:31]
ds_read_b64_tr_b16 a[172:173], v8 offset:0
v_mfma_f32_16x16x32_bf16 a[32:35], a[176:179], a[224:227], a[32:35]
ds_read_b64_tr_b16 a[174:175], v8 offset:1024
s_add_u32 s31, s31, 262144
v_mfma_f32_16x16x32_bf16 a[36:39], a[176:179], a[228:231], a[36:39]
s_mov_b32 s48, s30
s_add_u32 s33, s33, 16384
v_mfma_f32_16x16x32_bf16 a[40:43], a[176:179], a[232:235], a[40:43]
s_add_u32 m0, s32, 0
s_and_b32 s33, s33, 65535
v_mfma_f32_16x16x32_bf16 a[44:47], a[176:179], a[236:239], a[44:47]
buffer_load_dwordx4 v1, s[12:15], s48 offen lds
v_mfma_f32_16x16x32_bf16 a[48:51], a[176:179], a[240:243], a[48:51]
v_mfma_f32_16x16x32_bf16 a[52:55], a[176:179], a[244:247], a[52:55]
v_mfma_f32_16x16x32_bf16 a[56:59], a[176:179], a[248:251], a[56:59]
v_mfma_f32_16x16x32_bf16 a[60:63], a[176:179], a[252:255], a[60:63]
ds_read_b64_tr_b16 a[176:177], v9 offset:0
v_mfma_f32_16x16x32_bf16 a[64:67], a[180:183], a[224:227], a[64:67]
ds_read_b64_tr_b16 a[178:179], v9 offset:1024
v_mfma_f32_16x16x32_bf16 a[68:71], a[180:183], a[228:231], a[68:71]
s_add_u32 s48, s48, s34
v_mfma_f32_16x16x32_bf16 a[72:75], a[180:183], a[232:235], a[72:75]
s_add_u32 m0, s32, 4096
v_mfma_f32_16x16x32_bf16 a[76:79], a[180:183], a[236:239], a[76:79]
buffer_load_dwordx4 v1, s[12:15], s48 offen lds
v_mfma_f32_16x16x32_bf16 a[80:83], a[180:183], a[240:243], a[80:83]
v_mfma_f32_16x16x32_bf16 a[84:87], a[180:183], a[244:247], a[84:87]
v_mfma_f32_16x16x32_bf16 a[88:91], a[180:183], a[248:251], a[88:91]
v_mfma_f32_16x16x32_bf16 a[92:95], a[180:183], a[252:255], a[92:95]
ds_read_b64_tr_b16 a[180:181], v10 offset:0
v_mfma_f32_16x16x32_bf16 a[96:99], a[184:187], a[224:227], a[96:99]
ds_read_b64_tr_b16 a[182:183], v10 offset:1024
v_mfma_f32_16x16x32_bf16 a[100:103], a[184:187], a[228:231], a[100:103]
s_add_u32 s48, s48, s34
v_mfma_f32_16x16x32_bf16 a[104:107], a[184:187], a[232:235], a[104:107]
s_add_u32 m0, s32, 8192
v_mfma_f32_16x16x32_bf16 a[108:111], a[184:187], a[236:239], a[108:111]
buffer_load_dwordx4 v1, s[12:15], s48 offen lds
v_mfma_f32_16x16x32_bf16 a[112:115], a[184:187], a[240:243], a[112:115]
v_mfma_f32_16x16x32_bf16 a[116:119], a[184:187], a[244:247], a[116:119]
v_mfma_f32_16x16x32_bf16 a[120:123], a[184:187], a[248:251], a[120:123]
v_mfma_f32_16x16x32_bf16 a[124:127], a[184:187], a[252:255], a[124:127]
ds_read_b64_tr_b16 a[184:185], v11 offset:0
v_mfma_f32_16x16x32_bf16 a[128:131], v[28:31], a[224:227], a[128:131]
ds_read_b64_tr_b16 a[186:187], v11 offset:1024
v_mfma_f32_16x16x32_bf16 a[132:135], v[28:31], a[228:231], a[132:135]
s_add_u32 s48, s48, s34
v_add_u32 v5, 16384, v5
v_and_b32 v5, 65535, v5
v_mfma_f32_16x16x32_bf16 a[136:139], v[28:31], a[232:235], a[136:139]
s_add_u32 m0, s32, 12288
v_xor_b32 v6, 16, v5
v_xor_b32 v7, 64, v5
v_mfma_f32_16x16x32_bf16 a[140:143], v[28:31], a[236:239], a[140:143]
buffer_load_dwordx4 v1, s[12:15], s48 offen lds
v_xor_b32 v8, 80, v5
v_xor_b32 v9, 128, v5
v_mfma_f32_16x16x32_bf16 a[144:147], v[28:31], a[240:243], a[144:147]
v_xor_b32 v10, 144, v5
v_xor_b32 v11, 192, v5
v_xor_b32 v12, 208, v5
v_mfma_f32_16x16x32_bf16 a[148:151], v[28:31], a[244:247], a[148:151]
v_mfma_f32_16x16x32_bf16 a[152:155], v[28:31], a[248:251], a[152:155]
v_mfma_f32_16x16x32_bf16 a[156:159], v[28:31], a[252:255], a[156:159]
s_waitcnt vmcnt(21) lgkmcnt(0)
s_barrier
v_mfma_f32_16x16x32_bf16 v[160:163], a[160:163], a[192:195], v[160:163]
ds_read_b128 a[224:227], v4 offset:0
v_mfma_f32_16x16x32_bf16 v[164:167], a[160:163], a[196:199], v[164:167]
s_add_u32 s37, s31, 0
v_mfma_f32_16x16x32_bf16 v[168:171], a[160:163], a[200:203], v[168:171]
s_add_u32 m0, s33, 0
ds_read_b128 a[228:231], v3 offset:1024
v_mfma_f32_16x16x32_bf16 v[172:175], a[160:163], a[204:207], v[172:175]
buffer_load_dwordx4 v2, s[20:23], s37 offen  lds
s_add_u32 s60, s60, s92
v_mfma_f32_16x16x32_bf16 v[176:179], a[160:163], a[208:211], v[176:179]
s_mov_b32 s29, s60
ds_read_b128 a[232:235], v4 offset:4096
v_mfma_f32_16x16x32_bf16 v[180:183], a[160:163], a[212:215], v[180:183]
buffer_store_dwordx4 v[64:67], v13, s[8:11], s29 offen sc1
v_mfma_f32_16x16x32_bf16 v[184:187], a[160:163], a[216:219], v[184:187]
ds_read_b128 a[236:239], v3 offset:5120
v_mfma_f32_16x16x32_bf16 v[188:191], a[160:163], a[220:223], v[188:191]
ds_read_b64_tr_b16 a[160:161], v5 offset:0
v_mfma_f32_16x16x32_bf16 v[192:195], a[164:167], a[192:195], v[192:195]
ds_read_b64_tr_b16 a[162:163], v5 offset:1024
ds_read_b128 a[240:243], v4 offset:8192
v_mfma_f32_16x16x32_bf16 v[196:199], a[164:167], a[196:199], v[196:199]
s_add_u32 s37, s31, 32768
v_mfma_f32_16x16x32_bf16 v[200:203], a[164:167], a[200:203], v[200:203]
s_add_u32 m0, s33, 1024
ds_read_b128 a[244:247], v3 offset:9216
v_mfma_f32_16x16x32_bf16 v[204:207], a[164:167], a[204:207], v[204:207]
buffer_load_dwordx4 v2, s[20:23], s37 offen  lds
v_mfma_f32_16x16x32_bf16 v[208:211], a[164:167], a[208:211], v[208:211]
ds_read_b128 a[248:251], v4 offset:12288
v_mfma_f32_16x16x32_bf16 v[212:215], a[164:167], a[212:215], v[212:215]
v_mfma_f32_16x16x32_bf16 v[216:219], a[164:167], a[216:219], v[216:219]
ds_read_b128 a[252:255], v3 offset:13312
v_mfma_f32_16x16x32_bf16 v[220:223], a[164:167], a[220:223], v[220:223]
ds_read_b64_tr_b16 a[164:165], v6 offset:0
v_mfma_f32_16x16x32_bf16 v[224:227], a[168:171], a[192:195], v[224:227]
ds_read_b64_tr_b16 a[166:167], v6 offset:1024
ds_read_b64_tr_b16 v[28:29], v12 offset:0
v_mfma_f32_16x16x32_bf16 v[228:231], a[168:171], a[196:199], v[228:231]
s_add_u32 s37, s31, 131072
v_mfma_f32_16x16x32_bf16 v[232:235], a[168:171], a[200:203], v[232:235]
s_add_u32 m0, s33, 4096
ds_read_b64_tr_b16 v[30:31], v12 offset:1024
v_mfma_f32_16x16x32_bf16 v[236:239], a[168:171], a[204:207], v[236:239]
buffer_load_dwordx4 v2, s[20:23], s37 offen  lds
v_mfma_f32_16x16x32_bf16 v[240:243], a[168:171], a[208:211], v[240:243]
v_mfma_f32_16x16x32_bf16 v[244:247], a[168:171], a[212:215], v[244:247]
v_mfma_f32_16x16x32_bf16 v[248:251], a[168:171], a[216:219], v[248:251]
v_mfma_f32_16x16x32_bf16 v[252:255], a[168:171], a[220:223], v[252:255]
ds_read_b64_tr_b16 a[168:169], v7 offset:0
v_mfma_f32_16x16x32_bf16 a[0:3], a[172:175], a[192:195], a[0:3]
ds_read_b64_tr_b16 a[170:171], v7 offset:1024
v_mfma_f32_16x16x32_bf16 a[4:7], a[172:175], a[196:199], a[4:7]
s_add_u32 s37, s31, 163840
v_mfma_f32_16x16x32_bf16 a[8:11], a[172:175], a[200:203], a[8:11]
s_add_u32 m0, s33, 5120
v_mfma_f32_16x16x32_bf16 a[12:15], a[172:175], a[204:207], a[12:15]
buffer_load_dwordx4 v2, s[20:23], s37 offen  lds
s_add_u32 s29, s29, s44
v_mfma_f32_16x16x32_bf16 a[16:19], a[172:175], a[208:211], a[16:19]
v_mfma_f32_16x16x32_bf16 a[20:23], a[172:175], a[212:215], a[20:23]
buffer_store_dwordx4 v[68:71], v13, s[8:11], s29 offen sc1
v_mfma_f32_16x16x32_bf16 a[24:27], a[172:175], a[216:219], a[24:27]
v_mfma_f32_16x16x32_bf16 a[28:31], a[172:175], a[220:223], a[28:31]
ds_read_b64_tr_b16 a[172:173], v8 offset:0
v_mfma_f32_16x16x32_bf16 a[32:35], a[176:179], a[192:195], a[32:35]
ds_read_b64_tr_b16 a[174:175], v8 offset:1024
s_add_u32 s31, s31, 262144
v_mfma_f32_16x16x32_bf16 a[36:39], a[176:179], a[196:199], a[36:39]
s_add_u32 s48, s48, s34
s_add_u32 s33, s33, 16384
v_mfma_f32_16x16x32_bf16 a[40:43], a[176:179], a[200:203], a[40:43]
s_add_u32 m0, s32, 16384
s_and_b32 s33, s33, 65535
v_mfma_f32_16x16x32_bf16 a[44:47], a[176:179], a[204:207], a[44:47]
buffer_load_dwordx4 v1, s[12:15], s48 offen lds
v_mfma_f32_16x16x32_bf16 a[48:51], a[176:179], a[208:211], a[48:51]
v_mfma_f32_16x16x32_bf16 a[52:55], a[176:179], a[212:215], a[52:55]
v_mfma_f32_16x16x32_bf16 a[56:59], a[176:179], a[216:219], a[56:59]
v_mfma_f32_16x16x32_bf16 a[60:63], a[176:179], a[220:223], a[60:63]
ds_read_b64_tr_b16 a[176:177], v9 offset:0
v_mfma_f32_16x16x32_bf16 a[64:67], a[180:183], a[192:195], a[64:67]
ds_read_b64_tr_b16 a[178:179], v9 offset:1024
v_mfma_f32_16x16x32_bf16 a[68:71], a[180:183], a[196:199], a[68:71]
s_add_u32 s48, s48, s34
v_mfma_f32_16x16x32_bf16 a[72:75], a[180:183], a[200:203], a[72:75]
s_add_u32 m0, s32, 20480
v_mfma_f32_16x16x32_bf16 a[76:79], a[180:183], a[204:207], a[76:79]
buffer_load_dwordx4 v1, s[12:15], s48 offen lds
v_mfma_f32_16x16x32_bf16 a[80:83], a[180:183], a[208:211], a[80:83]
v_mfma_f32_16x16x32_bf16 a[84:87], a[180:183], a[212:215], a[84:87]
v_mfma_f32_16x16x32_bf16 a[88:91], a[180:183], a[216:219], a[88:91]
v_mfma_f32_16x16x32_bf16 a[92:95], a[180:183], a[220:223], a[92:95]
ds_read_b64_tr_b16 a[180:181], v10 offset:0
v_mfma_f32_16x16x32_bf16 a[96:99], a[184:187], a[192:195], a[96:99]
ds_read_b64_tr_b16 a[182:183], v10 offset:1024
v_mfma_f32_16x16x32_bf16 a[100:103], a[184:187], a[196:199], a[100:103]
s_add_u32 s48, s48, s34
v_mfma_f32_16x16x32_bf16 a[104:107], a[184:187], a[200:203], a[104:107]
s_add_u32 m0, s32, 24576
v_mfma_f32_16x16x32_bf16 a[108:111], a[184:187], a[204:207], a[108:111]
buffer_load_dwordx4 v1, s[12:15], s48 offen lds
s_add_u32 s29, s29, s93
v_mfma_f32_16x16x32_bf16 a[112:115], a[184:187], a[208:211], a[112:115]
v_mfma_f32_16x16x32_bf16 a[116:119], a[184:187], a[212:215], a[116:119]
buffer_store_dwordx4 v[72:75], v13, s[8:11], s29 offen sc1
v_mfma_f32_16x16x32_bf16 a[120:123], a[184:187], a[216:219], a[120:123]
v_mfma_f32_16x16x32_bf16 a[124:127], a[184:187], a[220:223], a[124:127]
ds_read_b64_tr_b16 a[184:185], v11 offset:0
v_mfma_f32_16x16x32_bf16 a[128:131], a[188:191], a[192:195], a[128:131]
ds_read_b64_tr_b16 a[186:187], v11 offset:1024
v_mfma_f32_16x16x32_bf16 a[132:135], a[188:191], a[196:199], a[132:135]
s_add_u32 s48, s48, s34
v_add_u32 v3, 32768, v3
v_subrev_u32 v19, 98304, v3
v_mfma_f32_16x16x32_bf16 a[136:139], a[188:191], a[200:203], a[136:139]
s_add_u32 m0, s32, 28672
v_cmp_le_u32 vcc, 163840, v3
v_add_u32 v5, 16384, v5
v_mfma_f32_16x16x32_bf16 a[140:143], a[188:191], a[204:207], a[140:143]
buffer_load_dwordx4 v1, s[12:15], s48 offen lds
v_and_b32 v5, 65535, v5
v_xor_b32 v6, 16, v5
v_mfma_f32_16x16x32_bf16 a[144:147], a[188:191], a[208:211], a[144:147]
s_add_u32 s30, s30, 128
s_add_u32 s32, s32, 32768
s_sub_u32 s48, s32, 98304
v_mfma_f32_16x16x32_bf16 a[148:151], a[188:191], a[212:215], a[148:151]
s_cmp_ge_u32 s32, 163840
s_cselect_b32 s32, s48, s32
v_xor_b32 v7, 64, v5
v_mfma_f32_16x16x32_bf16 a[152:155], a[188:191], a[216:219], a[152:155]
v_xor_b32 v8, 80, v5
v_xor_b32 v9, 128, v5
v_xor_b32 v10, 144, v5
v_mfma_f32_16x16x32_bf16 a[156:159], a[188:191], a[220:223], a[156:159]
v_xor_b32 v11, 192, v5
v_xor_b32 v12, 208, v5
v_cndmask_b32 v3, v3, v19, vcc
v_xor_b32 v4, 64, v3
s_waitcnt vmcnt(21) lgkmcnt(0)
s_barrier
v_mfma_f32_16x16x32_bf16 v[160:163], a[160:163], a[224:227], v[160:163]
ds_read_b128 a[192:195], v3 offset:0
v_mfma_f32_16x16x32_bf16 v[164:167], a[160:163], a[228:231], v[164:167]
s_add_u32 s37, s31, 0
v_mfma_f32_16x16x32_bf16 v[168:171], a[160:163], a[232:235], v[168:171]
s_add_u32 m0, s33, 0
ds_read_b128 a[196:199], v4 offset:1024
v_mfma_f32_16x16x32_bf16 v[172:175], a[160:163], a[236:239], v[172:175]
buffer_load_dwordx4 v2, s[20:23], s37 offen  lds
s_add_u32 s29, s29, s44
v_mfma_f32_16x16x32_bf16 v[176:179], a[160:163], a[240:243], v[176:179]
ds_read_b128 a[200:203], v3 offset:4096
v_mfma_f32_16x16x32_bf16 v[180:183], a[160:163], a[244:247], v[180:183]
buffer_store_dwordx4 v[76:79], v13, s[8:11], s29 offen sc1
v_mfma_f32_16x16x32_bf16 v[184:187], a[160:163], a[248:251], v[184:187]
ds_read_b128 a[204:207], v4 offset:5120
v_mfma_f32_16x16x32_bf16 v[188:191], a[160:163], a[252:255], v[188:191]
ds_read_b64_tr_b16 a[160:161], v5 offset:0
v_mfma_f32_16x16x32_bf16 v[192:195], a[164:167], a[224:227], v[192:195]
ds_read_b64_tr_b16 a[162:163], v5 offset:1024
ds_read_b128 a[208:211], v3 offset:8192
v_mfma_f32_16x16x32_bf16 v[196:199], a[164:167], a[228:231], v[196:199]
s_add_u32 s37, s31, 32768
v_mfma_f32_16x16x32_bf16 v[200:203], a[164:167], a[232:235], v[200:203]
s_add_u32 m0, s33, 1024
ds_read_b128 a[212:215], v4 offset:9216
v_mfma_f32_16x16x32_bf16 v[204:207], a[164:167], a[236:239], v[204:207]
buffer_load_dwordx4 v2, s[20:23], s37 offen  lds
v_mfma_f32_16x16x32_bf16 v[208:211], a[164:167], a[240:243], v[208:211]
ds_read_b128 a[216:219], v3 offset:12288
v_mfma_f32_16x16x32_bf16 v[212:215], a[164:167], a[244:247], v[212:215]
v_mfma_f32_16x16x32_bf16 v[216:219], a[164:167], a[248:251], v[216:219]
ds_read_b128 a[220:223], v4 offset:13312
v_mfma_f32_16x16x32_bf16 v[220:223], a[164:167], a[252:255], v[220:223]
ds_read_b64_tr_b16 a[164:165], v6 offset:0
v_mfma_f32_16x16x32_bf16 v[224:227], a[168:171], a[224:227], v[224:227]
ds_read_b64_tr_b16 a[166:167], v6 offset:1024
ds_read_b64_tr_b16 a[188:189], v12 offset:0
v_mfma_f32_16x16x32_bf16 v[228:231], a[168:171], a[228:231], v[228:231]
s_add_u32 s37, s31, 131072
v_mfma_f32_16x16x32_bf16 v[232:235], a[168:171], a[232:235], v[232:235]
s_add_u32 m0, s33, 4096
ds_read_b64_tr_b16 a[190:191], v12 offset:1024
v_mfma_f32_16x16x32_bf16 v[236:239], a[168:171], a[236:239], v[236:239]
buffer_load_dwordx4 v2, s[20:23], s37 offen  lds
v_mfma_f32_16x16x32_bf16 v[240:243], a[168:171], a[240:243], v[240:243]
v_mfma_f32_16x16x32_bf16 v[244:247], a[168:171], a[244:247], v[244:247]
v_mfma_f32_16x16x32_bf16 v[248:251], a[168:171], a[248:251], v[248:251]
v_mfma_f32_16x16x32_bf16 v[252:255], a[168:171], a[252:255], v[252:255]
ds_read_b64_tr_b16 a[168:169], v7 offset:0
v_mfma_f32_16x16x32_bf16 a[0:3], a[172:175], a[224:227], a[0:3]
ds_read_b64_tr_b16 a[170:171], v7 offset:1024
v_mfma_f32_16x16x32_bf16 a[4:7], a[172:175], a[228:231], a[4:7]
s_add_u32 s37, s31, 163840
v_mfma_f32_16x16x32_bf16 a[8:11], a[172:175], a[232:235], a[8:11]
s_add_u32 m0, s33, 5120
v_mfma_f32_16x16x32_bf16 a[12:15], a[172:175], a[236:239], a[12:15]
buffer_load_dwordx4 v2, s[20:23], s37 offen  lds
s_add_u32 s29, s29, s93
v_mfma_f32_16x16x32_bf16 a[16:19], a[172:175], a[240:243], a[16:19]
v_mfma_f32_16x16x32_bf16 a[20:23], a[172:175], a[244:247], a[20:23]
buffer_store_dwordx4 v[80:83], v13, s[8:11], s29 offen sc1
v_mfma_f32_16x16x32_bf16 a[24:27], a[172:175], a[248:251], a[24:27]
v_mfma_f32_16x16x32_bf16 a[28:31], a[172:175], a[252:255], a[28:31]
ds_read_b64_tr_b16 a[172:173], v8 offset:0
v_mfma_f32_16x16x32_bf16 a[32:35], a[176:179], a[224:227], a[32:35]
ds_read_b64_tr_b16 a[174:175], v8 offset:1024
s_add_u32 s31, s31, 262144
v_mfma_f32_16x16x32_bf16 a[36:39], a[176:179], a[228:231], a[36:39]
s_mov_b32 s48, s30
s_add_u32 s33, s33, 16384
v_mfma_f32_16x16x32_bf16 a[40:43], a[176:179], a[232:235], a[40:43]
s_add_u32 m0, s32, 0
s_and_b32 s33, s33, 65535
v_mfma_f32_16x16x32_bf16 a[44:47], a[176:179], a[236:239], a[44:47]
buffer_load_dwordx4 v1, s[12:15], s48 offen lds
v_mfma_f32_16x16x32_bf16 a[48:51], a[176:179], a[240:243], a[48:51]
v_mfma_f32_16x16x32_bf16 a[52:55], a[176:179], a[244:247], a[52:55]
v_mfma_f32_16x16x32_bf16 a[56:59], a[176:179], a[248:251], a[56:59]
v_mfma_f32_16x16x32_bf16 a[60:63], a[176:179], a[252:255], a[60:63]
ds_read_b64_tr_b16 a[176:177], v9 offset:0
v_mfma_f32_16x16x32_bf16 a[64:67], a[180:183], a[224:227], a[64:67]
ds_read_b64_tr_b16 a[178:179], v9 offset:1024
v_mfma_f32_16x16x32_bf16 a[68:71], a[180:183], a[228:231], a[68:71]
s_add_u32 s48, s48, s34
v_mfma_f32_16x16x32_bf16 a[72:75], a[180:183], a[232:235], a[72:75]
s_add_u32 m0, s32, 4096
v_mfma_f32_16x16x32_bf16 a[76:79], a[180:183], a[236:239], a[76:79]
buffer_load_dwordx4 v1, s[12:15], s48 offen lds
v_mfma_f32_16x16x32_bf16 a[80:83], a[180:183], a[240:243], a[80:83]
v_mfma_f32_16x16x32_bf16 a[84:87], a[180:183], a[244:247], a[84:87]
v_mfma_f32_16x16x32_bf16 a[88:91], a[180:183], a[248:251], a[88:91]
v_mfma_f32_16x16x32_bf16 a[92:95], a[180:183], a[252:255], a[92:95]
ds_read_b64_tr_b16 a[180:181], v10 offset:0
v_mfma_f32_16x16x32_bf16 a[96:99], a[184:187], a[224:227], a[96:99]
ds_read_b64_tr_b16 a[182:183], v10 offset:1024
v_mfma_f32_16x16x32_bf16 a[100:103], a[184:187], a[228:231], a[100:103]
s_add_u32 s48, s48, s34
v_mfma_f32_16x16x32_bf16 a[104:107], a[184:187], a[232:235], a[104:107]
s_add_u32 m0, s32, 8192
v_mfma_f32_16x16x32_bf16 a[108:111], a[184:187], a[236:239], a[108:111]
buffer_load_dwordx4 v1, s[12:15], s48 offen lds
s_add_u32 s29, s29, s44
v_mfma_f32_16x16x32_bf16 a[112:115], a[184:187], a[240:243], a[112:115]
v_mfma_f32_16x16x32_bf16 a[116:119], a[184:187], a[244:247], a[116:119]
buffer_store_dwordx4 v[84:87], v13, s[8:11], s29 offen sc1
v_mfma_f32_16x16x32_bf16 a[120:123], a[184:187], a[248:251], a[120:123]
v_mfma_f32_16x16x32_bf16 a[124:127], a[184:187], a[252:255], a[124:127]
ds_read_b64_tr_b16 a[184:185], v11 offset:0
v_mfma_f32_16x16x32_bf16 a[128:131], v[28:31], a[224:227], a[128:131]
ds_read_b64_tr_b16 a[186:187], v11 offset:1024
v_mfma_f32_16x16x32_bf16 a[132:135], v[28:31], a[228:231], a[132:135]
s_add_u32 s48, s48, s34
v_add_u32 v5, 16384, v5
v_and_b32 v5, 65535, v5
v_mfma_f32_16x16x32_bf16 a[136:139], v[28:31], a[232:235], a[136:139]
s_add_u32 m0, s32, 12288
v_xor_b32 v6, 16, v5
v_xor_b32 v7, 64, v5
v_mfma_f32_16x16x32_bf16 a[140:143], v[28:31], a[236:239], a[140:143]
buffer_load_dwordx4 v1, s[12:15], s48 offen lds
v_xor_b32 v8, 80, v5
v_xor_b32 v9, 128, v5
v_mfma_f32_16x16x32_bf16 a[144:147], v[28:31], a[240:243], a[144:147]
v_xor_b32 v10, 144, v5
v_xor_b32 v11, 192, v5
v_xor_b32 v12, 208, v5
v_mfma_f32_16x16x32_bf16 a[148:151], v[28:31], a[244:247], a[148:151]
v_mfma_f32_16x16x32_bf16 a[152:155], v[28:31], a[248:251], a[152:155]
v_mfma_f32_16x16x32_bf16 a[156:159], v[28:31], a[252:255], a[156:159]
s_waitcnt vmcnt(22) lgkmcnt(0)
s_barrier
v_mfma_f32_16x16x32_bf16 v[160:163], a[160:163], a[192:195], v[160:163]
ds_read_b128 a[224:227], v4 offset:0
v_mfma_f32_16x16x32_bf16 v[164:167], a[160:163], a[196:199], v[164:167]
s_add_u32 s37, s31, 0
v_mfma_f32_16x16x32_bf16 v[168:171], a[160:163], a[200:203], v[168:171]
s_add_u32 m0, s33, 0
ds_read_b128 a[228:231], v3 offset:1024
v_mfma_f32_16x16x32_bf16 v[172:175], a[160:163], a[204:207], v[172:175]
buffer_load_dwordx4 v2, s[20:23], s37 offen  lds
s_add_u32 s29, s29, s93
v_mfma_f32_16x16x32_bf16 v[176:179], a[160:163], a[208:211], v[176:179]
ds_read_b128 a[232:235], v4 offset:4096
v_mfma_f32_16x16x32_bf16 v[180:183], a[160:163], a[212:215], v[180:183]
buffer_store_dwordx4 v[88:91], v13, s[8:11], s29 offen sc1
v_mfma_f32_16x16x32_bf16 v[184:187], a[160:163], a[216:219], v[184:187]
ds_read_b128 a[236:239], v3 offset:5120
v_mfma_f32_16x16x32_bf16 v[188:191], a[160:163], a[220:223], v[188:191]
ds_read_b64_tr_b16 a[160:161], v5 offset:0
v_mfma_f32_16x16x32_bf16 v[192:195], a[164:167], a[192:195], v[192:195]
ds_read_b64_tr_b16 a[162:163], v5 offset:1024
ds_read_b128 a[240:243], v4 offset:8192
v_mfma_f32_16x16x32_bf16 v[196:199], a[164:167], a[196:199], v[196:199]
s_add_u32 s37, s31, 32768
v_mfma_f32_16x16x32_bf16 v[200:203], a[164:167], a[200:203], v[200:203]
s_add_u32 m0, s33, 1024
ds_read_b128 a[244:247], v3 offset:9216
v_mfma_f32_16x16x32_bf16 v[204:207], a[164:167], a[204:207], v[204:207]
buffer_load_dwordx4 v2, s[20:23], s37 offen  lds
v_mfma_f32_16x16x32_bf16 v[208:211], a[164:167], a[208:211], v[208:211]
ds_read_b128 a[248:251], v4 offset:12288
v_mfma_f32_16x16x32_bf16 v[212:215], a[164:167], a[212:215], v[212:215]
v_mfma_f32_16x16x32_bf16 v[216:219], a[164:167], a[216:219], v[216:219]
ds_read_b128 a[252:255], v3 offset:13312
v_mfma_f32_16x16x32_bf16 v[220:223], a[164:167], a[220:223], v[220:223]
ds_read_b64_tr_b16 a[164:165], v6 offset:0
v_mfma_f32_16x16x32_bf16 v[224:227], a[168:171], a[192:195], v[224:227]
ds_read_b64_tr_b16 a[166:167], v6 offset:1024
ds_read_b64_tr_b16 v[28:29], v12 offset:0
v_mfma_f32_16x16x32_bf16 v[228:231], a[168:171], a[196:199], v[228:231]
s_add_u32 s37, s31, 131072
v_mfma_f32_16x16x32_bf16 v[232:235], a[168:171], a[200:203], v[232:235]
s_add_u32 m0, s33, 4096
ds_read_b64_tr_b16 v[30:31], v12 offset:1024
v_mfma_f32_16x16x32_bf16 v[236:239], a[168:171], a[204:207], v[236:239]
buffer_load_dwordx4 v2, s[20:23], s37 offen  lds
v_mfma_f32_16x16x32_bf16 v[240:243], a[168:171], a[208:211], v[240:243]
v_mfma_f32_16x16x32_bf16 v[244:247], a[168:171], a[212:215], v[244:247]
v_mfma_f32_16x16x32_bf16 v[248:251], a[168:171], a[216:219], v[248:251]
v_mfma_f32_16x16x32_bf16 v[252:255], a[168:171], a[220:223], v[252:255]
ds_read_b64_tr_b16 a[168:169], v7 offset:0
v_mfma_f32_16x16x32_bf16 a[0:3], a[172:175], a[192:195], a[0:3]
ds_read_b64_tr_b16 a[170:171], v7 offset:1024
v_mfma_f32_16x16x32_bf16 a[4:7], a[172:175], a[196:199], a[4:7]
s_add_u32 s37, s31, 163840
v_mfma_f32_16x16x32_bf16 a[8:11], a[172:175], a[200:203], a[8:11]
s_add_u32 m0, s33, 5120
v_mfma_f32_16x16x32_bf16 a[12:15], a[172:175], a[204:207], a[12:15]
buffer_load_dwordx4 v2, s[20:23], s37 offen  lds
s_add_u32 s29, s29, s44
v_mfma_f32_16x16x32_bf16 a[16:19], a[172:175], a[208:211], a[16:19]
v_mfma_f32_16x16x32_bf16 a[20:23], a[172:175], a[212:215], a[20:23]
buffer_store_dwordx4 v[92:95], v13, s[8:11], s29 offen sc1
v_mfma_f32_16x16x32_bf16 a[24:27], a[172:175], a[216:219], a[24:27]
v_mfma_f32_16x16x32_bf16 a[28:31], a[172:175], a[220:223], a[28:31]
ds_read_b64_tr_b16 a[172:173], v8 offset:0
v_mfma_f32_16x16x32_bf16 a[32:35], a[176:179], a[192:195], a[32:35]
ds_read_b64_tr_b16 a[174:175], v8 offset:1024
s_add_u32 s31, s31, 262144
v_mfma_f32_16x16x32_bf16 a[36:39], a[176:179], a[196:199], a[36:39]
s_add_u32 s48, s48, s34
s_add_u32 s33, s33, 16384
v_mfma_f32_16x16x32_bf16 a[40:43], a[176:179], a[200:203], a[40:43]
s_add_u32 m0, s32, 16384
s_and_b32 s33, s33, 65535
v_mfma_f32_16x16x32_bf16 a[44:47], a[176:179], a[204:207], a[44:47]
buffer_load_dwordx4 v1, s[12:15], s48 offen lds
v_mfma_f32_16x16x32_bf16 a[48:51], a[176:179], a[208:211], a[48:51]
v_mfma_f32_16x16x32_bf16 a[52:55], a[176:179], a[212:215], a[52:55]
v_mfma_f32_16x16x32_bf16 a[56:59], a[176:179], a[216:219], a[56:59]
v_mfma_f32_16x16x32_bf16 a[60:63], a[176:179], a[220:223], a[60:63]
ds_read_b64_tr_b16 a[176:177], v9 offset:0
v_mfma_f32_16x16x32_bf16 a[64:67], a[180:183], a[192:195], a[64:67]
ds_read_b64_tr_b16 a[178:179], v9 offset:1024
v_mfma_f32_16x16x32_bf16 a[68:71], a[180:183], a[196:199], a[68:71]
s_add_u32 s48, s48, s34
v_mfma_f32_16x16x32_bf16 a[72:75], a[180:183], a[200:203], a[72:75]
s_add_u32 m0, s32, 20480
v_mfma_f32_16x16x32_bf16 a[76:79], a[180:183], a[204:207], a[76:79]
buffer_load_dwordx4 v1, s[12:15], s48 offen lds
v_mfma_f32_16x16x32_bf16 a[80:83], a[180:183], a[208:211], a[80:83]
v_mfma_f32_16x16x32_bf16 a[84:87], a[180:183], a[212:215], a[84:87]
v_mfma_f32_16x16x32_bf16 a[88:91], a[180:183], a[216:219], a[88:91]
buffer_load_dword v15, v14, s[96:99], s100 offen
s_add_u32 s100, s100, 8192
v_mfma_f32_16x16x32_bf16 a[92:95], a[180:183], a[220:223], a[92:95]
ds_read_b64_tr_b16 a[180:181], v10 offset:0
v_mfma_f32_16x16x32_bf16 a[96:99], a[184:187], a[192:195], a[96:99]
ds_read_b64_tr_b16 a[182:183], v10 offset:1024
v_mfma_f32_16x16x32_bf16 a[100:103], a[184:187], a[196:199], a[100:103]
s_add_u32 s48, s48, s34
v_mfma_f32_16x16x32_bf16 a[104:107], a[184:187], a[200:203], a[104:107]
s_add_u32 m0, s32, 24576
v_mfma_f32_16x16x32_bf16 a[108:111], a[184:187], a[204:207], a[108:111]
buffer_load_dwordx4 v1, s[12:15], s48 offen lds
v_mfma_f32_16x16x32_bf16 a[112:115], a[184:187], a[208:211], a[112:115]
v_mfma_f32_16x16x32_bf16 a[116:119], a[184:187], a[212:215], a[116:119]
v_mfma_f32_16x16x32_bf16 a[120:123], a[184:187], a[216:219], a[120:123]
v_mfma_f32_16x16x32_bf16 a[124:127], a[184:187], a[220:223], a[124:127]
ds_read_b64_tr_b16 a[184:185], v11 offset:0
v_mfma_f32_16x16x32_bf16 a[128:131], a[188:191], a[192:195], a[128:131]
ds_read_b64_tr_b16 a[186:187], v11 offset:1024
v_mfma_f32_16x16x32_bf16 a[132:135], a[188:191], a[196:199], a[132:135]
s_add_u32 s48, s48, s34
v_add_u32 v3, 32768, v3
v_subrev_u32 v19, 98304, v3
v_mfma_f32_16x16x32_bf16 a[136:139], a[188:191], a[200:203], a[136:139]
s_add_u32 m0, s32, 28672
v_cmp_le_u32 vcc, 163840, v3
v_add_u32 v5, 16384, v5
v_mfma_f32_16x16x32_bf16 a[140:143], a[188:191], a[204:207], a[140:143]
buffer_load_dwordx4 v1, s[12:15], s48 offen lds
v_and_b32 v5, 65535, v5
v_xor_b32 v6, 16, v5
v_mfma_f32_16x16x32_bf16 a[144:147], a[188:191], a[208:211], a[144:147]
s_add_u32 s30, s30, 128
s_add_u32 s32, s32, 32768
s_sub_u32 s48, s32, 98304
v_mfma_f32_16x16x32_bf16 a[148:151], a[188:191], a[212:215], a[148:151]
s_cmp_ge_u32 s32, 163840
s_cselect_b32 s32, s48, s32
v_xor_b32 v7, 64, v5
v_mfma_f32_16x16x32_bf16 a[152:155], a[188:191], a[216:219], a[152:155]
v_xor_b32 v8, 80, v5
v_xor_b32 v9, 128, v5
v_xor_b32 v10, 144, v5
v_mfma_f32_16x16x32_bf16 a[156:159], a[188:191], a[220:223], a[156:159]
v_xor_b32 v11, 192, v5
v_xor_b32 v12, 208, v5
v_cndmask_b32 v3, v3, v19, vcc
v_xor_b32 v4, 64, v3
s_waitcnt vmcnt(22) lgkmcnt(0)
s_barrier
v_mfma_f32_16x16x32_bf16 v[160:163], a[160:163], a[224:227], v[160:163]
ds_read_b128 a[192:195], v3 offset:0
v_mfma_f32_16x16x32_bf16 v[164:167], a[160:163], a[228:231], v[164:167]
s_add_u32 s37, s31, 0
v_mfma_f32_16x16x32_bf16 v[168:171], a[160:163], a[232:235], v[168:171]
s_add_u32 m0, s33, 0
ds_read_b128 a[196:199], v4 offset:1024
v_mfma_f32_16x16x32_bf16 v[172:175], a[160:163], a[236:239], v[172:175]
buffer_load_dwordx4 v2, s[20:23], s37 offen  lds
s_add_u32 s60, s60, s92
v_mfma_f32_16x16x32_bf16 v[176:179], a[160:163], a[240:243], v[176:179]
s_mov_b32 s29, s60
ds_read_b128 a[200:203], v3 offset:4096
v_mfma_f32_16x16x32_bf16 v[180:183], a[160:163], a[244:247], v[180:183]
buffer_store_dwordx4 v[96:99], v13, s[8:11], s29 offen sc1
v_mfma_f32_16x16x32_bf16 v[184:187], a[160:163], a[248:251], v[184:187]
ds_read_b128 a[204:207], v4 offset:5120
v_mfma_f32_16x16x32_bf16 v[188:191], a[160:163], a[252:255], v[188:191]
ds_read_b64_tr_b16 a[160:161], v5 offset:0
v_mfma_f32_16x16x32_bf16 v[192:195], a[164:167], a[224:227], v[192:195]
ds_read_b64_tr_b16 a[162:163], v5 offset:1024
ds_read_b128 a[208:211], v3 offset:8192
v_mfma_f32_16x16x32_bf16 v[196:199], a[164:167], a[228:231], v[196:199]
s_add_u32 s37, s31, 32768
v_mfma_f32_16x16x32_bf16 v[200:203], a[164:167], a[232:235], v[200:203]
s_add_u32 m0, s33, 1024
ds_read_b128 a[212:215], v4 offset:9216
v_mfma_f32_16x16x32_bf16 v[204:207], a[164:167], a[236:239], v[204:207]
buffer_load_dwordx4 v2, s[20:23], s37 offen  lds
v_mfma_f32_16x16x32_bf16 v[208:211], a[164:167], a[240:243], v[208:211]
ds_read_b128 a[216:219], v3 offset:12288
v_mfma_f32_16x16x32_bf16 v[212:215], a[164:167], a[244:247], v[212:215]
v_mfma_f32_16x16x32_bf16 v[216:219], a[164:167], a[248:251], v[216:219]
ds_read_b128 a[220:223], v4 offset:13312
v_mfma_f32_16x16x32_bf16 v[220:223], a[164:167], a[252:255], v[220:223]
ds_read_b64_tr_b16 a[164:165], v6 offset:0
v_mfma_f32_16x16x32_bf16 v[224:227], a[168:171], a[224:227], v[224:227]
ds_read_b64_tr_b16 a[166:167], v6 offset:1024
ds_read_b64_tr_b16 a[188:189], v12 offset:0
v_mfma_f32_16x16x32_bf16 v[228:231], a[168:171], a[228:231], v[228:231]
s_add_u32 s37, s31, 131072
v_mfma_f32_16x16x32_bf16 v[232:235], a[168:171], a[232:235], v[232:235]
s_add_u32 m0, s33, 4096
ds_read_b64_tr_b16 a[190:191], v12 offset:1024
v_mfma_f32_16x16x32_bf16 v[236:239], a[168:171], a[236:239], v[236:239]
buffer_load_dwordx4 v2, s[20:23], s37 offen  lds
v_mfma_f32_16x16x32_bf16 v[240:243], a[168:171], a[240:243], v[240:243]
v_mfma_f32_16x16x32_bf16 v[244:247], a[168:171], a[244:247], v[244:247]
v_mfma_f32_16x16x32_bf16 v[248:251], a[168:171], a[248:251], v[248:251]
v_mfma_f32_16x16x32_bf16 v[252:255], a[168:171], a[252:255], v[252:255]
ds_read_b64_tr_b16 a[168:169], v7 offset:0
v_mfma_f32_16x16x32_bf16 a[0:3], a[172:175], a[224:227], a[0:3]
ds_read_b64_tr_b16 a[170:171], v7 offset:1024
v_mfma_f32_16x16x32_bf16 a[4:7], a[172:175], a[228:231], a[4:7]
s_add_u32 s37, s31, 163840
v_mfma_f32_16x16x32_bf16 a[8:11], a[172:175], a[232:235], a[8:11]
s_add_u32 m0, s33, 5120
v_mfma_f32_16x16x32_bf16 a[12:15], a[172:175], a[236:239], a[12:15]
buffer_load_dwordx4 v2, s[20:23], s37 offen  lds
s_add_u32 s29, s29, s44
v_mfma_f32_16x16x32_bf16 a[16:19], a[172:175], a[240:243], a[16:19]
v_mfma_f32_16x16x32_bf16 a[20:23], a[172:175], a[244:247], a[20:23]
buffer_store_dwordx4 v[100:103], v13, s[8:11], s29 offen sc1
v_mfma_f32_16x16x32_bf16 a[24:27], a[172:175], a[248:251], a[24:27]
v_mfma_f32_16x16x32_bf16 a[28:31], a[172:175], a[252:255], a[28:31]
ds_read_b64_tr_b16 a[172:173], v8 offset:0
v_mfma_f32_16x16x32_bf16 a[32:35], a[176:179], a[224:227], a[32:35]
ds_read_b64_tr_b16 a[174:175], v8 offset:1024
s_add_u32 s31, s31, 262144
v_mfma_f32_16x16x32_bf16 a[36:39], a[176:179], a[228:231], a[36:39]
s_mov_b32 s48, s30
s_add_u32 s33, s33, 16384
v_mfma_f32_16x16x32_bf16 a[40:43], a[176:179], a[232:235], a[40:43]
s_add_u32 m0, s32, 0
s_and_b32 s33, s33, 65535
v_mfma_f32_16x16x32_bf16 a[44:47], a[176:179], a[236:239], a[44:47]
buffer_load_dwordx4 v1, s[12:15], s48 offen lds
v_mfma_f32_16x16x32_bf16 a[48:51], a[176:179], a[240:243], a[48:51]
v_mfma_f32_16x16x32_bf16 a[52:55], a[176:179], a[244:247], a[52:55]
v_mfma_f32_16x16x32_bf16 a[56:59], a[176:179], a[248:251], a[56:59]
v_mfma_f32_16x16x32_bf16 a[60:63], a[176:179], a[252:255], a[60:63]
ds_read_b64_tr_b16 a[176:177], v9 offset:0
v_mfma_f32_16x16x32_bf16 a[64:67], a[180:183], a[224:227], a[64:67]
ds_read_b64_tr_b16 a[178:179], v9 offset:1024
v_mfma_f32_16x16x32_bf16 a[68:71], a[180:183], a[228:231], a[68:71]
s_add_u32 s48, s48, s34
v_mfma_f32_16x16x32_bf16 a[72:75], a[180:183], a[232:235], a[72:75]
s_add_u32 m0, s32, 4096
v_mfma_f32_16x16x32_bf16 a[76:79], a[180:183], a[236:239], a[76:79]
buffer_load_dwordx4 v1, s[12:15], s48 offen lds
v_mfma_f32_16x16x32_bf16 a[80:83], a[180:183], a[240:243], a[80:83]
v_mfma_f32_16x16x32_bf16 a[84:87], a[180:183], a[244:247], a[84:87]
v_mfma_f32_16x16x32_bf16 a[88:91], a[180:183], a[248:251], a[88:91]
buffer_load_dword v15, v14, s[96:99], s100 offen
s_add_u32 s100, s100, 8192
v_mfma_f32_16x16x32_bf16 a[92:95], a[180:183], a[252:255], a[92:95]
ds_read_b64_tr_b16 a[180:181], v10 offset:0
v_mfma_f32_16x16x32_bf16 a[96:99], a[184:187], a[224:227], a[96:99]
ds_read_b64_tr_b16 a[182:183], v10 offset:1024
v_mfma_f32_16x16x32_bf16 a[100:103], a[184:187], a[228:231], a[100:103]
s_add_u32 s48, s48, s34
v_mfma_f32_16x16x32_bf16 a[104:107], a[184:187], a[232:235], a[104:107]
s_add_u32 m0, s32, 8192
v_mfma_f32_16x16x32_bf16 a[108:111], a[184:187], a[236:239], a[108:111]
buffer_load_dwordx4 v1, s[12:15], s48 offen lds
s_add_u32 s29, s29, s93
v_mfma_f32_16x16x32_bf16 a[112:115], a[184:187], a[240:243], a[112:115]
v_mfma_f32_16x16x32_bf16 a[116:119], a[184:187], a[244:247], a[116:119]
buffer_store_dwordx4 v[104:107], v13, s[8:11], s29 offen sc1
v_mfma_f32_16x16x32_bf16 a[120:123], a[184:187], a[248:251], a[120:123]
v_mfma_f32_16x16x32_bf16 a[124:127], a[184:187], a[252:255], a[124:127]
ds_read_b64_tr_b16 a[184:185], v11 offset:0
v_mfma_f32_16x16x32_bf16 a[128:131], v[28:31], a[224:227], a[128:131]
ds_read_b64_tr_b16 a[186:187], v11 offset:1024
v_mfma_f32_16x16x32_bf16 a[132:135], v[28:31], a[228:231], a[132:135]
s_add_u32 s48, s48, s34
v_add_u32 v5, 16384, v5
v_and_b32 v5, 65535, v5
v_mfma_f32_16x16x32_bf16 a[136:139], v[28:31], a[232:235], a[136:139]
s_add_u32 m0, s32, 12288
v_xor_b32 v6, 16, v5
v_xor_b32 v7, 64, v5
v_mfma_f32_16x16x32_bf16 a[140:143], v[28:31], a[236:239], a[140:143]
buffer_load_dwordx4 v1, s[12:15], s48 offen lds
v_xor_b32 v8, 80, v5
v_xor_b32 v9, 128, v5
v_mfma_f32_16x16x32_bf16 a[144:147], v[28:31], a[240:243], a[144:147]
v_xor_b32 v10, 144, v5
v_xor_b32 v11, 192, v5
v_xor_b32 v12, 208, v5
v_mfma_f32_16x16x32_bf16 a[148:151], v[28:31], a[244:247], a[148:151]
v_mfma_f32_16x16x32_bf16 a[152:155], v[28:31], a[248:251], a[152:155]
v_mfma_f32_16x16x32_bf16 a[156:159], v[28:31], a[252:255], a[156:159]
s_waitcnt vmcnt(23) lgkmcnt(0)
s_barrier
v_mfma_f32_16x16x32_bf16 v[160:163], a[160:163], a[192:195], v[160:163]
ds_read_b128 a[224:227], v4 offset:0
v_mfma_f32_16x16x32_bf16 v[164:167], a[160:163], a[196:199], v[164:167]
s_add_u32 s37, s31, 0
v_mfma_f32_16x16x32_bf16 v[168:171], a[160:163], a[200:203], v[168:171]
s_add_u32 m0, s33, 0
ds_read_b128 a[228:231], v3 offset:1024
v_mfma_f32_16x16x32_bf16 v[172:175], a[160:163], a[204:207], v[172:175]
buffer_load_dwordx4 v2, s[20:23], s37 offen  lds
s_add_u32 s29, s29, s44
v_mfma_f32_16x16x32_bf16 v[176:179], a[160:163], a[208:211], v[176:179]
ds_read_b128 a[232:235], v4 offset:4096
v_mfma_f32_16x16x32_bf16 v[180:183], a[160:163], a[212:215], v[180:183]
buffer_store_dwordx4 v[108:111], v13, s[8:11], s29 offen sc1
v_mfma_f32_16x16x32_bf16 v[184:187], a[160:163], a[216:219], v[184:187]
ds_read_b128 a[236:239], v3 offset:5120
v_mfma_f32_16x16x32_bf16 v[188:191], a[160:163], a[220:223], v[188:191]
ds_read_b64_tr_b16 a[160:161], v5 offset:0
v_mfma_f32_16x16x32_bf16 v[192:195], a[164:167], a[192:195], v[192:195]
ds_read_b64_tr_b16 a[162:163], v5 offset:1024
ds_read_b128 a[240:243], v4 offset:8192
v_mfma_f32_16x16x32_bf16 v[196:199], a[164:167], a[196:199], v[196:199]
s_add_u32 s37, s31, 32768
v_mfma_f32_16x16x32_bf16 v[200:203], a[164:167], a[200:203], v[200:203]
s_add_u32 m0, s33, 1024
ds_read_b128 a[244:247], v3 offset:9216
v_mfma_f32_16x16x32_bf16 v[204:207], a[164:167], a[204:207], v[204:207]
buffer_load_dwordx4 v2, s[20:23], s37 offen  lds
v_mfma_f32_16x16x32_bf16 v[208:211], a[164:167], a[208:211], v[208:211]
ds_read_b128 a[248:251], v4 offset:12288
v_mfma_f32_16x16x32_bf16 v[212:215], a[164:167], a[212:215], v[212:215]
v_mfma_f32_16x16x32_bf16 v[216:219], a[164:167], a[216:219], v[216:219]
ds_read_b128 a[252:255], v3 offset:13312
v_mfma_f32_16x16x32_bf16 v[220:223], a[164:167], a[220:223], v[220:223]
ds_read_b64_tr_b16 a[164:165], v6 offset:0
v_mfma_f32_16x16x32_bf16 v[224:227], a[168:171], a[192:195], v[224:227]
ds_read_b64_tr_b16 a[166:167], v6 offset:1024
ds_read_b64_tr_b16 v[28:29], v12 offset:0
v_mfma_f32_16x16x32_bf16 v[228:231], a[168:171], a[196:199], v[228:231]
s_add_u32 s37, s31, 131072
v_mfma_f32_16x16x32_bf16 v[232:235], a[168:171], a[200:203], v[232:235]
s_add_u32 m0, s33, 4096
ds_read_b64_tr_b16 v[30:31], v12 offset:1024
v_mfma_f32_16x16x32_bf16 v[236:239], a[168:171], a[204:207], v[236:239]
buffer_load_dwordx4 v2, s[20:23], s37 offen  lds
v_mfma_f32_16x16x32_bf16 v[240:243], a[168:171], a[208:211], v[240:243]
v_mfma_f32_16x16x32_bf16 v[244:247], a[168:171], a[212:215], v[244:247]
v_mfma_f32_16x16x32_bf16 v[248:251], a[168:171], a[216:219], v[248:251]
v_mfma_f32_16x16x32_bf16 v[252:255], a[168:171], a[220:223], v[252:255]
ds_read_b64_tr_b16 a[168:169], v7 offset:0
v_mfma_f32_16x16x32_bf16 a[0:3], a[172:175], a[192:195], a[0:3]
ds_read_b64_tr_b16 a[170:171], v7 offset:1024
v_mfma_f32_16x16x32_bf16 a[4:7], a[172:175], a[196:199], a[4:7]
s_add_u32 s37, s31, 163840
v_mfma_f32_16x16x32_bf16 a[8:11], a[172:175], a[200:203], a[8:11]
s_add_u32 m0, s33, 5120
v_mfma_f32_16x16x32_bf16 a[12:15], a[172:175], a[204:207], a[12:15]
buffer_load_dwordx4 v2, s[20:23], s37 offen  lds
s_add_u32 s29, s29, s93
v_mfma_f32_16x16x32_bf16 a[16:19], a[172:175], a[208:211], a[16:19]
v_mfma_f32_16x16x32_bf16 a[20:23], a[172:175], a[212:215], a[20:23]
buffer_store_dwordx4 v[112:115], v13, s[8:11], s29 offen sc1
v_mfma_f32_16x16x32_bf16 a[24:27], a[172:175], a[216:219], a[24:27]
v_mfma_f32_16x16x32_bf16 a[28:31], a[172:175], a[220:223], a[28:31]
ds_read_b64_tr_b16 a[172:173], v8 offset:0
v_mfma_f32_16x16x32_bf16 a[32:35], a[176:179], a[192:195], a[32:35]
ds_read_b64_tr_b16 a[174:175], v8 offset:1024
s_add_u32 s31, s31, 262144
v_mfma_f32_16x16x32_bf16 a[36:39], a[176:179], a[196:199], a[36:39]
s_add_u32 s48, s48, s34
s_add_u32 s33, s33, 16384
v_mfma_f32_16x16x32_bf16 a[40:43], a[176:179], a[200:203], a[40:43]
s_add_u32 m0, s32, 16384
s_and_b32 s33, s33, 65535
v_mfma_f32_16x16x32_bf16 a[44:47], a[176:179], a[204:207], a[44:47]
buffer_load_dwordx4 v1, s[12:15], s48 offen lds
v_mfma_f32_16x16x32_bf16 a[48:51], a[176:179], a[208:211], a[48:51]
v_mfma_f32_16x16x32_bf16 a[52:55], a[176:179], a[212:215], a[52:55]
v_mfma_f32_16x16x32_bf16 a[56:59], a[176:179], a[216:219], a[56:59]
v_mfma_f32_16x16x32_bf16 a[60:63], a[176:179], a[220:223], a[60:63]
ds_read_b64_tr_b16 a[176:177], v9 offset:0
v_mfma_f32_16x16x32_bf16 a[64:67], a[180:183], a[192:195], a[64:67]
ds_read_b64_tr_b16 a[178:179], v9 offset:1024
v_mfma_f32_16x16x32_bf16 a[68:71], a[180:183], a[196:199], a[68:71]
s_add_u32 s48, s48, s34
v_mfma_f32_16x16x32_bf16 a[72:75], a[180:183], a[200:203], a[72:75]
s_add_u32 m0, s32, 20480
v_mfma_f32_16x16x32_bf16 a[76:79], a[180:183], a[204:207], a[76:79]
buffer_load_dwordx4 v1, s[12:15], s48 offen lds
v_mfma_f32_16x16x32_bf16 a[80:83], a[180:183], a[208:211], a[80:83]
v_mfma_f32_16x16x32_bf16 a[84:87], a[180:183], a[212:215], a[84:87]
v_mfma_f32_16x16x32_bf16 a[88:91], a[180:183], a[216:219], a[88:91]
buffer_load_dword v15, v14, s[96:99], s100 offen
s_add_u32 s100, s100, 8192
v_mfma_f32_16x16x32_bf16 a[92:95], a[180:183], a[220:223], a[92:95]
ds_read_b64_tr_b16 a[180:181], v10 offset:0
v_mfma_f32_16x16x32_bf16 a[96:99], a[184:187], a[192:195], a[96:99]
ds_read_b64_tr_b16 a[182:183], v10 offset:1024
v_mfma_f32_16x16x32_bf16 a[100:103], a[184:187], a[196:199], a[100:103]
s_add_u32 s48, s48, s34
v_mfma_f32_16x16x32_bf16 a[104:107], a[184:187], a[200:203], a[104:107]
s_add_u32 m0, s32, 24576
v_mfma_f32_16x16x32_bf16 a[108:111], a[184:187], a[204:207], a[108:111]
buffer_load_dwordx4 v1, s[12:15], s48 offen lds
s_add_u32 s29, s29, s44
v_mfma_f32_16x16x32_bf16 a[112:115], a[184:187], a[208:211], a[112:115]
v_mfma_f32_16x16x32_bf16 a[116:119], a[184:187], a[212:215], a[116:119]
buffer_store_dwordx4 v[116:119], v13, s[8:11], s29 offen sc1
v_mfma_f32_16x16x32_bf16 a[120:123], a[184:187], a[216:219], a[120:123]
v_mfma_f32_16x16x32_bf16 a[124:127], a[184:187], a[220:223], a[124:127]
ds_read_b64_tr_b16 a[184:185], v11 offset:0
v_mfma_f32_16x16x32_bf16 a[128:131], a[188:191], a[192:195], a[128:131]
ds_read_b64_tr_b16 a[186:187], v11 offset:1024
v_mfma_f32_16x16x32_bf16 a[132:135], a[188:191], a[196:199], a[132:135]
s_add_u32 s48, s48, s34
v_add_u32 v3, 32768, v3
v_subrev_u32 v19, 98304, v3
v_mfma_f32_16x16x32_bf16 a[136:139], a[188:191], a[200:203], a[136:139]
s_add_u32 m0, s32, 28672
v_cmp_le_u32 vcc, 163840, v3
v_add_u32 v5, 16384, v5
v_mfma_f32_16x16x32_bf16 a[140:143], a[188:191], a[204:207], a[140:143]
buffer_load_dwordx4 v1, s[12:15], s48 offen lds
v_and_b32 v5, 65535, v5
v_xor_b32 v6, 16, v5
v_mfma_f32_16x16x32_bf16 a[144:147], a[188:191], a[208:211], a[144:147]
s_add_u32 s30, s30, 128
s_add_u32 s32, s32, 32768
s_sub_u32 s48, s32, 98304
v_mfma_f32_16x16x32_bf16 a[148:151], a[188:191], a[212:215], a[148:151]
s_cmp_ge_u32 s32, 163840
s_cselect_b32 s32, s48, s32
v_xor_b32 v7, 64, v5
v_mfma_f32_16x16x32_bf16 a[152:155], a[188:191], a[216:219], a[152:155]
v_xor_b32 v8, 80, v5
v_xor_b32 v9, 128, v5
v_xor_b32 v10, 144, v5
v_mfma_f32_16x16x32_bf16 a[156:159], a[188:191], a[220:223], a[156:159]
v_xor_b32 v11, 192, v5
v_xor_b32 v12, 208, v5
v_cndmask_b32 v3, v3, v19, vcc
v_xor_b32 v4, 64, v3
s_waitcnt vmcnt(24) lgkmcnt(0)
s_barrier
v_mfma_f32_16x16x32_bf16 v[160:163], a[160:163], a[224:227], v[160:163]
ds_read_b128 a[192:195], v3 offset:0
v_mfma_f32_16x16x32_bf16 v[164:167], a[160:163], a[228:231], v[164:167]
s_add_u32 s37, s31, 0
v_mfma_f32_16x16x32_bf16 v[168:171], a[160:163], a[232:235], v[168:171]
s_add_u32 m0, s33, 0
ds_read_b128 a[196:199], v4 offset:1024
v_mfma_f32_16x16x32_bf16 v[172:175], a[160:163], a[236:239], v[172:175]
buffer_load_dwordx4 v2, s[20:23], s37 offen  lds
s_add_u32 s29, s29, s93
v_mfma_f32_16x16x32_bf16 v[176:179], a[160:163], a[240:243], v[176:179]
ds_read_b128 a[200:203], v3 offset:4096
v_mfma_f32_16x16x32_bf16 v[180:183], a[160:163], a[244:247], v[180:183]
buffer_store_dwordx4 v[120:123], v13, s[8:11], s29 offen sc1
v_mfma_f32_16x16x32_bf16 v[184:187], a[160:163], a[248:251], v[184:187]
ds_read_b128 a[204:207], v4 offset:5120
v_mfma_f32_16x16x32_bf16 v[188:191], a[160:163], a[252:255], v[188:191]
ds_read_b64_tr_b16 a[160:161], v5 offset:0
v_mfma_f32_16x16x32_bf16 v[192:195], a[164:167], a[224:227], v[192:195]
ds_read_b64_tr_b16 a[162:163], v5 offset:1024
ds_read_b128 a[208:211], v3 offset:8192
v_mfma_f32_16x16x32_bf16 v[196:199], a[164:167], a[228:231], v[196:199]
s_add_u32 s37, s31, 32768
v_mfma_f32_16x16x32_bf16 v[200:203], a[164:167], a[232:235], v[200:203]
s_add_u32 m0, s33, 1024
ds_read_b128 a[212:215], v4 offset:9216
v_mfma_f32_16x16x32_bf16 v[204:207], a[164:167], a[236:239], v[204:207]
buffer_load_dwordx4 v2, s[20:23], s37 offen  lds
v_mfma_f32_16x16x32_bf16 v[208:211], a[164:167], a[240:243], v[208:211]
ds_read_b128 a[216:219], v3 offset:12288
v_mfma_f32_16x16x32_bf16 v[212:215], a[164:167], a[244:247], v[212:215]
v_mfma_f32_16x16x32_bf16 v[216:219], a[164:167], a[248:251], v[216:219]
ds_read_b128 a[220:223], v4 offset:13312
v_mfma_f32_16x16x32_bf16 v[220:223], a[164:167], a[252:255], v[220:223]
ds_read_b64_tr_b16 a[164:165], v6 offset:0
v_mfma_f32_16x16x32_bf16 v[224:227], a[168:171], a[224:227], v[224:227]
ds_read_b64_tr_b16 a[166:167], v6 offset:1024
ds_read_b64_tr_b16 a[188:189], v12 offset:0
v_mfma_f32_16x16x32_bf16 v[228:231], a[168:171], a[228:231], v[228:231]
s_add_u32 s37, s31, 131072
v_mfma_f32_16x16x32_bf16 v[232:235], a[168:171], a[232:235], v[232:235]
s_add_u32 m0, s33, 4096
ds_read_b64_tr_b16 a[190:191], v12 offset:1024
v_mfma_f32_16x16x32_bf16 v[236:239], a[168:171], a[236:239], v[236:239]
buffer_load_dwordx4 v2, s[20:23], s37 offen  lds
v_mfma_f32_16x16x32_bf16 v[240:243], a[168:171], a[240:243], v[240:243]
v_mfma_f32_16x16x32_bf16 v[244:247], a[168:171], a[244:247], v[244:247]
v_mfma_f32_16x16x32_bf16 v[248:251], a[168:171], a[248:251], v[248:251]
v_mfma_f32_16x16x32_bf16 v[252:255], a[168:171], a[252:255], v[252:255]
ds_read_b64_tr_b16 a[168:169], v7 offset:0
v_mfma_f32_16x16x32_bf16 a[0:3], a[172:175], a[224:227], a[0:3]
ds_read_b64_tr_b16 a[170:171], v7 offset:1024
v_mfma_f32_16x16x32_bf16 a[4:7], a[172:175], a[228:231], a[4:7]
s_add_u32 s37, s31, 163840
v_mfma_f32_16x16x32_bf16 a[8:11], a[172:175], a[232:235], a[8:11]
s_add_u32 m0, s33, 5120
v_mfma_f32_16x16x32_bf16 a[12:15], a[172:175], a[236:239], a[12:15]
buffer_load_dwordx4 v2, s[20:23], s37 offen  lds
s_add_u32 s29, s29, s44
v_mfma_f32_16x16x32_bf16 a[16:19], a[172:175], a[240:243], a[16:19]
v_mfma_f32_16x16x32_bf16 a[20:23], a[172:175], a[244:247], a[20:23]
buffer_store_dwordx4 v[124:127], v13, s[8:11], s29 offen sc1
v_mfma_f32_16x16x32_bf16 a[24:27], a[172:175], a[248:251], a[24:27]
v_mfma_f32_16x16x32_bf16 a[28:31], a[172:175], a[252:255], a[28:31]
ds_read_b64_tr_b16 a[172:173], v8 offset:0
v_mfma_f32_16x16x32_bf16 a[32:35], a[176:179], a[224:227], a[32:35]
ds_read_b64_tr_b16 a[174:175], v8 offset:1024
s_add_u32 s31, s31, 262144
v_mfma_f32_16x16x32_bf16 a[36:39], a[176:179], a[228:231], a[36:39]
s_mov_b32 s48, s30
s_add_u32 s33, s33, 16384
v_mfma_f32_16x16x32_bf16 a[40:43], a[176:179], a[232:235], a[40:43]
s_add_u32 m0, s32, 0
s_and_b32 s33, s33, 65535
v_mfma_f32_16x16x32_bf16 a[44:47], a[176:179], a[236:239], a[44:47]
buffer_load_dwordx4 v1, s[12:15], s48 offen lds
v_mfma_f32_16x16x32_bf16 a[48:51], a[176:179], a[240:243], a[48:51]
v_mfma_f32_16x16x32_bf16 a[52:55], a[176:179], a[244:247], a[52:55]
v_mfma_f32_16x16x32_bf16 a[56:59], a[176:179], a[248:251], a[56:59]
v_mfma_f32_16x16x32_bf16 a[60:63], a[176:179], a[252:255], a[60:63]
ds_read_b64_tr_b16 a[176:177], v9 offset:0
v_mfma_f32_16x16x32_bf16 a[64:67], a[180:183], a[224:227], a[64:67]
ds_read_b64_tr_b16 a[178:179], v9 offset:1024
v_mfma_f32_16x16x32_bf16 a[68:71], a[180:183], a[228:231], a[68:71]
s_add_u32 s48, s48, s34
v_mfma_f32_16x16x32_bf16 a[72:75], a[180:183], a[232:235], a[72:75]
s_add_u32 m0, s32, 4096
v_mfma_f32_16x16x32_bf16 a[76:79], a[180:183], a[236:239], a[76:79]
buffer_load_dwordx4 v1, s[12:15], s48 offen lds
v_mfma_f32_16x16x32_bf16 a[80:83], a[180:183], a[240:243], a[80:83]
v_mfma_f32_16x16x32_bf16 a[84:87], a[180:183], a[244:247], a[84:87]
v_mfma_f32_16x16x32_bf16 a[88:91], a[180:183], a[248:251], a[88:91]
buffer_load_dword v15, v14, s[96:99], s100 offen
s_add_u32 s100, s100, 8192
v_mfma_f32_16x16x32_bf16 a[92:95], a[180:183], a[252:255], a[92:95]
ds_read_b64_tr_b16 a[180:181], v10 offset:0
v_mfma_f32_16x16x32_bf16 a[96:99], a[184:187], a[224:227], a[96:99]
ds_read_b64_tr_b16 a[182:183], v10 offset:1024
v_mfma_f32_16x16x32_bf16 a[100:103], a[184:187], a[228:231], a[100:103]
s_add_u32 s48, s48, s34
v_mfma_f32_16x16x32_bf16 a[104:107], a[184:187], a[232:235], a[104:107]
s_add_u32 m0, s32, 8192
v_mfma_f32_16x16x32_bf16 a[108:111], a[184:187], a[236:239], a[108:111]
buffer_load_dwordx4 v1, s[12:15], s48 offen lds
v_mfma_f32_16x16x32_bf16 a[112:115], a[184:187], a[240:243], a[112:115]
v_mfma_f32_16x16x32_bf16 a[116:119], a[184:187], a[244:247], a[116:119]
v_mfma_f32_16x16x32_bf16 a[120:123], a[184:187], a[248:251], a[120:123]
v_mfma_f32_16x16x32_bf16 a[124:127], a[184:187], a[252:255], a[124:127]
ds_read_b64_tr_b16 a[184:185], v11 offset:0
v_mfma_f32_16x16x32_bf16 a[128:131], v[28:31], a[224:227], a[128:131]
ds_read_b64_tr_b16 a[186:187], v11 offset:1024
v_mfma_f32_16x16x32_bf16 a[132:135], v[28:31], a[228:231], a[132:135]
s_add_u32 s48, s48, s34
v_add_u32 v5, 16384, v5
v_and_b32 v5, 65535, v5
v_mfma_f32_16x16x32_bf16 a[136:139], v[28:31], a[232:235], a[136:139]
s_add_u32 m0, s32, 12288
v_xor_b32 v6, 16, v5
v_xor_b32 v7, 64, v5
v_mfma_f32_16x16x32_bf16 a[140:143], v[28:31], a[236:239], a[140:143]
buffer_load_dwordx4 v1, s[12:15], s48 offen lds
v_xor_b32 v8, 80, v5
v_xor_b32 v9, 128, v5
v_mfma_f32_16x16x32_bf16 a[144:147], v[28:31], a[240:243], a[144:147]
v_xor_b32 v10, 144, v5
v_xor_b32 v11, 192, v5
v_xor_b32 v12, 208, v5
v_mfma_f32_16x16x32_bf16 a[148:151], v[28:31], a[244:247], a[148:151]
v_mfma_f32_16x16x32_bf16 a[152:155], v[28:31], a[248:251], a[152:155]
v_mfma_f32_16x16x32_bf16 a[156:159], v[28:31], a[252:255], a[156:159]
s_cmp_eq_u32 s36, 0
s_cbranch_scc1 L_g_k12
s_waitcnt vmcnt(23) lgkmcnt(0)
s_barrier
v_mfma_f32_16x16x32_bf16 v[160:163], a[160:163], a[192:195], v[160:163]
ds_read_b128 a[224:227], v4 offset:0
v_mfma_f32_16x16x32_bf16 v[164:167], a[160:163], a[196:199], v[164:167]
s_add_u32 s37, s31, 0
v_mfma_f32_16x16x32_bf16 v[168:171], a[160:163], a[200:203], v[168:171]
s_add_u32 m0, s33, 0
ds_read_b128 a[228:231], v3 offset:1024
v_mfma_f32_16x16x32_bf16 v[172:175], a[160:163], a[204:207], v[172:175]
buffer_load_dwordx4 v2, s[20:23], s37 offen  lds
v_mfma_f32_16x16x32_bf16 v[176:179], a[160:163], a[208:211], v[176:179]
ds_read_b128 a[232:235], v4 offset:4096
v_mfma_f32_16x16x32_bf16 v[180:183], a[160:163], a[212:215], v[180:183]
v_mfma_f32_16x16x32_bf16 v[184:187], a[160:163], a[216:219], v[184:187]
ds_read_b128 a[236:239], v3 offset:5120
v_mfma_f32_16x16x32_bf16 v[188:191], a[160:163], a[220:223], v[188:191]
ds_read_b64_tr_b16 a[160:161], v5 offset:0
v_mfma_f32_16x16x32_bf16 v[192:195], a[164:167], a[192:195], v[192:195]
ds_read_b64_tr_b16 a[162:163], v5 offset:1024
ds_read_b128 a[240:243], v4 offset:8192
v_mfma_f32_16x16x32_bf16 v[196:199], a[164:167], a[196:199], v[196:199]
s_add_u32 s37, s31, 32768
v_mfma_f32_16x16x32_bf16 v[200:203], a[164:167], a[200:203], v[200:203]
s_add_u32 m0, s33, 1024
ds_read_b128 a[244:247], v3 offset:9216
v_mfma_f32_16x16x32_bf16 v[204:207], a[164:167], a[204:207], v[204:207]
buffer_load_dwordx4 v2, s[20:23], s37 offen  lds
v_mfma_f32_16x16x32_bf16 v[208:211], a[164:167], a[208:211], v[208:211]
ds_read_b128 a[248:251], v4 offset:12288
v_mfma_f32_16x16x32_bf16 v[212:215], a[164:167], a[212:215], v[212:215]
v_mfma_f32_16x16x32_bf16 v[216:219], a[164:167], a[216:219], v[216:219]
ds_read_b128 a[252:255], v3 offset:13312
v_mfma_f32_16x16x32_bf16 v[220:223], a[164:167], a[220:223], v[220:223]
ds_read_b64_tr_b16 a[164:165], v6 offset:0
v_mfma_f32_16x16x32_bf16 v[224:227], a[168:171], a[192:195], v[224:227]
ds_read_b64_tr_b16 a[166:167], v6 offset:1024
ds_read_b64_tr_b16 v[28:29], v12 offset:0
v_mfma_f32_16x16x32_bf16 v[228:231], a[168:171], a[196:199], v[228:231]
s_add_u32 s37, s31, 131072
v_mfma_f32_16x16x32_bf16 v[232:235], a[168:171], a[200:203], v[232:235]
s_add_u32 m0, s33, 4096
ds_read_b64_tr_b16 v[30:31], v12 offset:1024
v_mfma_f32_16x16x32_bf16 v[236:239], a[168:171], a[204:207], v[236:239]
buffer_load_dwordx4 v2, s[20:23], s37 offen  lds
v_mfma_f32_16x16x32_bf16 v[240:243], a[168:171], a[208:211], v[240:243]
v_mfma_f32_16x16x32_bf16 v[244:247], a[168:171], a[212:215], v[244:247]
v_mfma_f32_16x16x32_bf16 v[248:251], a[168:171], a[216:219], v[248:251]
v_mfma_f32_16x16x32_bf16 v[252:255], a[168:171], a[220:223], v[252:255]
ds_read_b64_tr_b16 a[168:169], v7 offset:0
v_mfma_f32_16x16x32_bf16 a[0:3], a[172:175], a[192:195], a[0:3]
ds_read_b64_tr_b16 a[170:171], v7 offset:1024
v_mfma_f32_16x16x32_bf16 a[4:7], a[172:175], a[196:199], a[4:7]
s_add_u32 s37, s31, 163840
v_mfma_f32_16x16x32_bf16 a[8:11], a[172:175], a[200:203], a[8:11]
s_add_u32 m0, s33, 5120
v_mfma_f32_16x16x32_bf16 a[12:15], a[172:175], a[204:207], a[12:15]
buffer_load_dwordx4 v2, s[20:23], s37 offen  lds
v_mfma_f32_16x16x32_bf16 a[16:19], a[172:175], a[208:211], a[16:19]
v_mfma_f32_16x16x32_bf16 a[20:23], a[172:175], a[212:215], a[20:23]
v_mfma_f32_16x16x32_bf16 a[24:27], a[172:175], a[216:219], a[24:27]
v_mfma_f32_16x16x32_bf16 a[28:31], a[172:175], a[220:223], a[28:31]
ds_read_b64_tr_b16 a[172:173], v8 offset:0
v_mfma_f32_16x16x32_bf16 a[32:35], a[176:179], a[192:195], a[32:35]
ds_read_b64_tr_b16 a[174:175], v8 offset:1024
s_add_u32 s31, s31, 262144
v_mfma_f32_16x16x32_bf16 a[36:39], a[176:179], a[196:199], a[36:39]
s_add_u32 s48, s48, s34
s_add_u32 s33, s33, 16384
v_mfma_f32_16x16x32_bf16 a[40:43], a[176:179], a[200:203], a[40:43]
s_add_u32 m0, s32, 16384
s_and_b32 s33, s33, 65535
v_mfma_f32_16x16x32_bf16 a[44:47], a[176:179], a[204:207], a[44:47]
buffer_load_dwordx4 v1, s[12:15], s48 offen lds
v_mfma_f32_16x16x32_bf16 a[48:51], a[176:179], a[208:211], a[48:51]
v_mfma_f32_16x16x32_bf16 a[52:55], a[176:179], a[212:215], a[52:55]
v_mfma_f32_16x16x32_bf16 a[56:59], a[176:179], a[216:219], a[56:59]
v_mfma_f32_16x16x32_bf16 a[60:63], a[176:179], a[220:223], a[60:63]
ds_read_b64_tr_b16 a[176:177], v9 offset:0
v_mfma_f32_16x16x32_bf16 a[64:67], a[180:183], a[192:195], a[64:67]
ds_read_b64_tr_b16 a[178:179], v9 offset:1024
v_mfma_f32_16x16x32_bf16 a[68:71], a[180:183], a[196:199], a[68:71]
s_add_u32 s48, s48, s34
v_mfma_f32_16x16x32_bf16 a[72:75], a[180:183], a[200:203], a[72:75]
s_add_u32 m0, s32, 20480
v_mfma_f32_16x16x32_bf16 a[76:79], a[180:183], a[204:207], a[76:79]
buffer_load_dwordx4 v1, s[12:15], s48 offen lds
v_mfma_f32_16x16x32_bf16 a[80:83], a[180:183], a[208:211], a[80:83]
v_mfma_f32_16x16x32_bf16 a[84:87], a[180:183], a[212:215], a[84:87]
v_mfma_f32_16x16x32_bf16 a[88:91], a[180:183], a[216:219], a[88:91]
v_mfma_f32_16x16x32_bf16 a[92:95], a[180:183], a[220:223], a[92:95]
ds_read_b64_tr_b16 a[180:181], v10 offset:0
v_mfma_f32_16x16x32_bf16 a[96:99], a[184:187], a[192:195], a[96:99]
ds_read_b64_tr_b16 a[182:183], v10 offset:1024
v_mfma_f32_16x16x32_bf16 a[100:103], a[184:187], a[196:199], a[100:103]
s_add_u32 s48, s48, s34
v_mfma_f32_16x16x32_bf16 a[104:107], a[184:187], a[200:203], a[104:107]
s_add_u32 m0, s32, 24576
v_mfma_f32_16x16x32_bf16 a[108:111], a[184:187], a[204:207], a[108:111]
buffer_load_dwordx4 v1, s[12:15], s48 offen lds
v_mfma_f32_16x16x32_bf16 a[112:115], a[184:187], a[208:211], a[112:115]
v_mfma_f32_16x16x32_bf16 a[116:119], a[184:187], a[212:215], a[116:119]
v_mfma_f32_16x16x32_bf16 a[120:123], a[184:187], a[216:219], a[120:123]
v_mfma_f32_16x16x32_bf16 a[124:127], a[184:187], a[220:223], a[124:127]
ds_read_b64_tr_b16 a[184:185], v11 offset:0
v_mfma_f32_16x16x32_bf16 a[128:131], a[188:191], a[192:195], a[128:131]
ds_read_b64_tr_b16 a[186:187], v11 offset:1024
v_mfma_f32_16x16x32_bf16 a[132:135], a[188:191], a[196:199], a[132:135]
s_add_u32 s48, s48, s34
v_add_u32 v3, 32768, v3
v_subrev_u32 v19, 98304, v3
v_mfma_f32_16x16x32_bf16 a[136:139], a[188:191], a[200:203], a[136:139]
s_add_u32 m0, s32, 28672
v_cmp_le_u32 vcc, 163840, v3
v_add_u32 v5, 16384, v5
v_mfma_f32_16x16x32_bf16 a[140:143], a[188:191], a[204:207], a[140:143]
buffer_load_dwordx4 v1, s[12:15], s48 offen lds
v_and_b32 v5, 65535, v5
v_xor_b32 v6, 16, v5
v_mfma_f32_16x16x32_bf16 a[144:147], a[188:191], a[208:211], a[144:147]
s_add_u32 s30, s30, 128
s_add_u32 s32, s32, 32768
s_sub_u32 s48, s32, 98304
v_mfma_f32_16x16x32_bf16 a[148:151], a[188:191], a[212:215], a[148:151]
s_cmp_ge_u32 s32, 163840
s_cselect_b32 s32, s48, s32
v_xor_b32 v7, 64, v5
v_mfma_f32_16x16x32_bf16 a[152:155], a[188:191], a[216:219], a[152:155]
v_xor_b32 v8, 80, v5
v_xor_b32 v9, 128, v5
v_xor_b32 v10, 144, v5
v_mfma_f32_16x16x32_bf16 a[156:159], a[188:191], a[220:223], a[156:159]
v_xor_b32 v11, 192, v5
v_xor_b32 v12, 208, v5
v_cndmask_b32 v3, v3, v19, vcc
v_xor_b32 v4, 64, v3
s_waitcnt vmcnt(19) lgkmcnt(0)
s_barrier
v_mfma_f32_16x16x32_bf16 v[160:163], a[160:163], a[224:227], v[160:163]
ds_read_b128 a[192:195], v3 offset:0
v_mfma_f32_16x16x32_bf16 v[164:167], a[160:163], a[228:231], v[164:167]
s_add_u32 s37, s31, 0
v_mfma_f32_16x16x32_bf16 v[168:171], a[160:163], a[232:235], v[168:171]
s_add_u32 m0, s33, 0
ds_read_b128 a[196:199], v4 offset:1024
v_mfma_f32_16x16x32_bf16 v[172:175], a[160:163], a[236:239], v[172:175]
buffer_load_dwordx4 v2, s[20:23], s37 offen  lds
v_mfma_f32_16x16x32_bf16 v[176:179], a[160:163], a[240:243], v[176:179]
ds_read_b128 a[200:203], v3 offset:4096
v_mfma_f32_16x16x32_bf16 v[180:183], a[160:163], a[244:247], v[180:183]
v_mfma_f32_16x16x32_bf16 v[184:187], a[160:163], a[248:251], v[184:187]
ds_read_b128 a[204:207], v4 offset:5120
v_mfma_f32_16x16x32_bf16 v[188:191], a[160:163], a[252:255], v[188:191]
ds_read_b64_tr_b16 a[160:161], v5 offset:0
v_mfma_f32_16x16x32_bf16 v[192:195], a[164:167], a[224:227], v[192:195]
ds_read_b64_tr_b16 a[162:163], v5 offset:1024
ds_read_b128 a[208:211], v3 offset:8192
v_mfma_f32_16x16x32_bf16 v[196:199], a[164:167], a[228:231], v[196:199]
s_add_u32 s37, s31, 32768
v_mfma_f32_16x16x32_bf16 v[200:203], a[164:167], a[232:235], v[200:203]
s_add_u32 m0, s33, 1024
ds_read_b128 a[212:215], v4 offset:9216
v_mfma_f32_16x16x32_bf16 v[204:207], a[164:167], a[236:239], v[204:207]
buffer_load_dwordx4 v2, s[20:23], s37 offen  lds
v_mfma_f32_16x16x32_bf16 v[208:211], a[164:167], a[240:243], v[208:211]
ds_read_b128 a[216:219], v3 offset:12288
v_mfma_f32_16x16x32_bf16 v[212:215], a[164:167], a[244:247], v[212:215]
v_mfma_f32_16x16x32_bf16 v[216:219], a[164:167], a[248:251], v[216:219]
ds_read_b128 a[220:223], v4 offset:13312
v_mfma_f32_16x16x32_bf16 v[220:223], a[164:167], a[252:255], v[220:223]
ds_read_b64_tr_b16 a[164:165], v6 offset:0
v_mfma_f32_16x16x32_bf16 v[224:227], a[168:171], a[224:227], v[224:227]
ds_read_b64_tr_b16 a[166:167], v6 offset:1024
ds_read_b64_tr_b16 a[188:189], v12 offset:0
v_mfma_f32_16x16x32_bf16 v[228:231], a[168:171], a[228:231], v[228:231]
s_add_u32 s37, s31, 131072
v_mfma_f32_16x16x32_bf16 v[232:235], a[168:171], a[232:235], v[232:235]
s_add_u32 m0, s33, 4096
ds_read_b64_tr_b16 a[190:191], v12 offset:1024
v_mfma_f32_16x16x32_bf16 v[236:239], a[168:171], a[236:239], v[236:239]
buffer_load_dwordx4 v2, s[20:23], s37 offen  lds
v_mfma_f32_16x16x32_bf16 v[240:243], a[168:171], a[240:243], v[240:243]
v_mfma_f32_16x16x32_bf16 v[244:247], a[168:171], a[244:247], v[244:247]
v_mfma_f32_16x16x32_bf16 v[248:251], a[168:171], a[248:251], v[248:251]
v_mfma_f32_16x16x32_bf16 v[252:255], a[168:171], a[252:255], v[252:255]
ds_read_b64_tr_b16 a[168:169], v7 offset:0
v_mfma_f32_16x16x32_bf16 a[0:3], a[172:175], a[224:227], a[0:3]
ds_read_b64_tr_b16 a[170:171], v7 offset:1024
v_mfma_f32_16x16x32_bf16 a[4:7], a[172:175], a[228:231], a[4:7]
s_add_u32 s37, s31, 163840
v_mfma_f32_16x16x32_bf16 a[8:11], a[172:175], a[232:235], a[8:11]
s_add_u32 m0, s33, 5120
v_mfma_f32_16x16x32_bf16 a[12:15], a[172:175], a[236:239], a[12:15]
buffer_load_dwordx4 v2, s[20:23], s37 offen  lds
v_mfma_f32_16x16x32_bf16 a[16:19], a[172:175], a[240:243], a[16:19]
v_mfma_f32_16x16x32_bf16 a[20:23], a[172:175], a[244:247], a[20:23]
v_mfma_f32_16x16x32_bf16 a[24:27], a[172:175], a[248:251], a[24:27]
v_mfma_f32_16x16x32_bf16 a[28:31], a[172:175], a[252:255], a[28:31]
ds_read_b64_tr_b16 a[172:173], v8 offset:0
v_mfma_f32_16x16x32_bf16 a[32:35], a[176:179], a[224:227], a[32:35]
ds_read_b64_tr_b16 a[174:175], v8 offset:1024
s_add_u32 s31, s31, 262144
v_mfma_f32_16x16x32_bf16 a[36:39], a[176:179], a[228:231], a[36:39]
s_mov_b32 s48, s30
s_add_u32 s33, s33, 16384
v_mfma_f32_16x16x32_bf16 a[40:43], a[176:179], a[232:235], a[40:43]
s_add_u32 m0, s32, 0
s_and_b32 s33, s33, 65535
v_mfma_f32_16x16x32_bf16 a[44:47], a[176:179], a[236:239], a[44:47]
buffer_load_dwordx4 v1, s[12:15], s48 offen lds
v_mfma_f32_16x16x32_bf16 a[48:51], a[176:179], a[240:243], a[48:51]
v_mfma_f32_16x16x32_bf16 a[52:55], a[176:179], a[244:247], a[52:55]
v_mfma_f32_16x16x32_bf16 a[56:59], a[176:179], a[248:251], a[56:59]
v_mfma_f32_16x16x32_bf16 a[60:63], a[176:179], a[252:255], a[60:63]
ds_read_b64_tr_b16 a[176:177], v9 offset:0
v_mfma_f32_16x16x32_bf16 a[64:67], a[180:183], a[224:227], a[64:67]
ds_read_b64_tr_b16 a[178:179], v9 offset:1024
v_mfma_f32_16x16x32_bf16 a[68:71], a[180:183], a[228:231], a[68:71]
s_add_u32 s48, s48, s34
v_mfma_f32_16x16x32_bf16 a[72:75], a[180:183], a[232:235], a[72:75]
s_add_u32 m0, s32, 4096
v_mfma_f32_16x16x32_bf16 a[76:79], a[180:183], a[236:239], a[76:79]
buffer_load_dwordx4 v1, s[12:15], s48 offen lds
v_mfma_f32_16x16x32_bf16 a[80:83], a[180:183], a[240:243], a[80:83]
v_mfma_f32_16x16x32_bf16 a[84:87], a[180:183], a[244:247], a[84:87]
v_mfma_f32_16x16x32_bf16 a[88:91], a[180:183], a[248:251], a[88:91]
v_mfma_f32_16x16x32_bf16 a[92:95], a[180:183], a[252:255], a[92:95]
ds_read_b64_tr_b16 a[180:181], v10 offset:0
v_mfma_f32_16x16x32_bf16 a[96:99], a[184:187], a[224:227], a[96:99]
ds_read_b64_tr_b16 a[182:183], v10 offset:1024
v_mfma_f32_16x16x32_bf16 a[100:103], a[184:187], a[228:231], a[100:103]
s_add_u32 s48, s48, s34
v_mfma_f32_16x16x32_bf16 a[104:107], a[184:187], a[232:235], a[104:107]
s_add_u32 m0, s32, 8192
v_mfma_f32_16x16x32_bf16 a[108:111], a[184:187], a[236:239], a[108:111]
buffer_load_dwordx4 v1, s[12:15], s48 offen lds
v_mfma_f32_16x16x32_bf16 a[112:115], a[184:187], a[240:243], a[112:115]
v_mfma_f32_16x16x32_bf16 a[116:119], a[184:187], a[244:247], a[116:119]
v_mfma_f32_16x16x32_bf16 a[120:123], a[184:187], a[248:251], a[120:123]
v_mfma_f32_16x16x32_bf16 a[124:127], a[184:187], a[252:255], a[124:127]
ds_read_b64_tr_b16 a[184:185], v11 offset:0
v_mfma_f32_16x16x32_bf16 a[128:131], v[28:31], a[224:227], a[128:131]
ds_read_b64_tr_b16 a[186:187], v11 offset:1024
v_mfma_f32_16x16x32_bf16 a[132:135], v[28:31], a[228:231], a[132:135]
s_add_u32 s48, s48, s34
v_add_u32 v5, 16384, v5
v_and_b32 v5, 65535, v5
v_mfma_f32_16x16x32_bf16 a[136:139], v[28:31], a[232:235], a[136:139]
s_add_u32 m0, s32, 12288
v_xor_b32 v6, 16, v5
v_xor_b32 v7, 64, v5
v_mfma_f32_16x16x32_bf16 a[140:143], v[28:31], a[236:239], a[140:143]
buffer_load_dwordx4 v1, s[12:15], s48 offen lds
v_xor_b32 v8, 80, v5
v_xor_b32 v9, 128, v5
v_mfma_f32_16x16x32_bf16 a[144:147], v[28:31], a[240:243], a[144:147]
v_xor_b32 v10, 144, v5
v_xor_b32 v11, 192, v5
v_xor_b32 v12, 208, v5
v_mfma_f32_16x16x32_bf16 a[148:151], v[28:31], a[244:247], a[148:151]
v_mfma_f32_16x16x32_bf16 a[152:155], v[28:31], a[248:251], a[152:155]
v_mfma_f32_16x16x32_bf16 a[156:159], v[28:31], a[252:255], a[156:159]
L_g_k12:
s_waitcnt vmcnt(16) lgkmcnt(0)
s_barrier
v_mfma_f32_16x16x32_bf16 v[160:163], a[160:163], a[192:195], v[160:163]
ds_read_b128 a[224:227], v4 offset:0
s_lshl_b32 s24, s35, 2
s_lshr_b32 s26, s88, s24
v_mfma_f32_16x16x32_bf16 v[164:167], a[160:163], a[196:199], v[164:167]
s_add_u32 s37, s31, 0
s_bfe_u32 s2, s26, 0x10003
s_and_b32 s26, s26, 7
v_mfma_f32_16x16x32_bf16 v[168:171], a[160:163], a[200:203], v[168:171]
s_add_u32 m0, s33, 0
ds_read_b128 a[228:231], v3 offset:1024
s_or_b32 s40, s2, s61
v_mfma_f32_16x16x32_bf16 v[172:175], a[160:163], a[204:207], v[172:175]
buffer_load_dwordx4 v2, s[20:23], s37 offen  lds
s_add_u32 s60, s60, s92
s_lshr_b32 s24, s17, 1
v_mfma_f32_16x16x32_bf16 v[176:179], a[160:163], a[208:211], v[176:179]
s_mov_b32 s29, s60
ds_read_b128 a[232:235], v4 offset:4096
v_mfma_f32_16x16x32_bf16 v[180:183], a[160:163], a[212:215], v[180:183]
buffer_store_dwordx4 v[128:131], v13, s[8:11], s29 offen sc1
v_mfma_f32_16x16x32_bf16 v[184:187], a[160:163], a[216:219], v[184:187]
ds_read_b128 a[236:239], v3 offset:5120
v_mfma_f32_16x16x32_bf16 v[188:191], a[160:163], a[220:223], v[188:191]
ds_read_b64_tr_b16 a[160:161], v5 offset:0
v_mfma_f32_16x16x32_bf16 v[192:195], a[164:167], a[192:195], v[192:195]
ds_read_b64_tr_b16 a[162:163], v5 offset:1024
ds_read_b128 a[240:243], v4 offset:8192
v_mfma_f32_16x16x32_bf16 v[196:199], a[164:167], a[196:199], v[196:199]
s_add_u32 s37, s31, 32768
v_mfma_f32_16x16x32_bf16 v[200:203], a[164:167], a[200:203], v[200:203]
s_add_u32 m0, s33, 1024
ds_read_b128 a[244:247], v3 offset:9216
v_mfma_f32_16x16x32_bf16 v[204:207], a[164:167], a[204:207], v[204:207]
buffer_load_dwordx4 v2, s[20:23], s37 offen  lds
v_mfma_f32_16x16x32_bf16 v[208:211], a[164:167], a[208:211], v[208:211]
ds_read_b128 a[248:251], v4 offset:12288
v_mfma_f32_16x16x32_bf16 v[212:215], a[164:167], a[212:215], v[212:215]
s_cmp_eq_u32 s2, 0
s_cselect_b32 s41, s24, 0
s_cselect_b32 s27, s89, s90
v_mfma_f32_16x16x32_bf16 v[216:219], a[164:167], a[216:219], v[216:219]
ds_read_b128 a[252:255], v3 offset:13312
s_sub_u32 s25, s24, s41
s_and_b32 s51, s41, s61
v_mfma_f32_16x16x32_bf16 v[220:223], a[164:167], a[220:223], v[220:223]
ds_read_b64_tr_b16 a[164:165], v6 offset:0
s_lshl_b32 s51, s51, 1
s_or_b32 s51, s51, s41
v_mfma_f32_16x16x32_bf16 v[224:227], a[168:171], a[192:195], v[224:227]
ds_read_b64_tr_b16 a[166:167], v6 offset:1024
ds_read_b64_tr_b16 v[28:29], v12 offset:0
s_lshl_b32 s46, s27, s2
v_mfma_f32_16x16x32_bf16 v[228:231], a[168:171], a[196:199], v[228:231]
s_add_u32 s37, s31, 131072
s_add_u32 s46, s46, s25
s_lshl_b32 s46, s46, 8
v_mfma_f32_16x16x32_bf16 v[232:235], a[168:171], a[200:203], v[232:235]
s_add_u32 m0, s33, 4096
ds_read_b64_tr_b16 v[30:31], v12 offset:1024
s_lshl_b32 s47, s40, 7
v_mfma_f32_16x16x32_bf16 v[236:239], a[168:171], a[204:207], v[236:239]
buffer_load_dwordx4 v2, s[20:23], s37 offen  lds
s_add_u32 s47, s47, 1024
s_mul_i32 s101, s26, s47
v_mfma_f32_16x16x32_bf16 v[240:243], a[168:171], a[208:211], v[240:243]
s_lshl_b32 s101, s101, 8
s_lshl_b32 s42, s27, 3
s_add_u32 s42, s42, s26
v_mfma_f32_16x16x32_bf16 v[244:247], a[168:171], a[212:215], v[244:247]
s_lshl_b32 s42, s42, 1
s_and_b32 s25, s17, 1
s_add_u32 s42, s42, s25
v_mfma_f32_16x16x32_bf16 v[248:251], a[168:171], a[216:219], v[248:251]
s_lshl_b32 s42, s42, 3
s_add_u32 s42, s42, s24
s_lshl_b32 s42, s42, 13
v_mfma_f32_16x16x32_bf16 v[252:255], a[168:171], a[220:223], v[252:255]
ds_read_b64_tr_b16 a[168:169], v7 offset:0
s_lshl_b32 s43, s27, 5
s_add_u32 s43, s43, s26
v_mfma_f32_16x16x32_bf16 a[0:3], a[172:175], a[192:195], a[0:3]
ds_read_b64_tr_b16 a[170:171], v7 offset:1024
s_lshl_b32 s43, s43, 2
s_lshl_b32 s24, s2, 1
v_mfma_f32_16x16x32_bf16 a[4:7], a[172:175], a[196:199], a[4:7]
s_add_u32 s37, s31, 163840
s_add_u32 s24, s24, s61
s_lshl_b32 s24, s24, 2
v_mfma_f32_16x16x32_bf16 a[8:11], a[172:175], a[200:203], a[8:11]
s_add_u32 m0, s33, 5120
s_lshr_b32 s25, 0x8720, s24
s_and_b32 s25, s25, 15
v_mfma_f32_16x16x32_bf16 a[12:15], a[172:175], a[204:207], a[12:15]
buffer_load_dwordx4 v2, s[20:23], s37 offen  lds
s_add_u32 s29, s29, s44
s_lshl_b32 s25, s25, 24
v_mfma_f32_16x16x32_bf16 a[16:19], a[172:175], a[208:211], a[16:19]
s_add_u32 s42, s42, s25
s_lshr_b32 s25, 0x7604, s24
s_and_b32 s25, s25, 15
v_mfma_f32_16x16x32_bf16 a[20:23], a[172:175], a[212:215], a[20:23]
buffer_store_dwordx4 v[132:135], v13, s[8:11], s29 offen sc1
s_lshl_b32 s25, s25, 12
s_add_u32 s43, s43, s25
v_mfma_f32_16x16x32_bf16 a[24:27], a[172:175], a[216:219], a[24:27]
s_add_u32 s43, s43, 111149056
v_mfma_f32_16x16x32_bf16 a[28:31], a[172:175], a[220:223], a[28:31]
ds_read_b64_tr_b16 a[172:173], v8 offset:0
v_mfma_f32_16x16x32_bf16 a[32:35], a[176:179], a[192:195], a[32:35]
ds_read_b64_tr_b16 a[174:175], v8 offset:1024
s_add_u32 s31, s31, 262144
v_mfma_f32_16x16x32_bf16 a[36:39], a[176:179], a[196:199], a[36:39]
s_add_u32 s48, s48, s34
s_add_u32 s33, s33, 16384
v_mfma_f32_16x16x32_bf16 a[40:43], a[176:179], a[200:203], a[40:43]
s_add_u32 m0, s32, 16384
s_and_b32 s33, s33, 65535
v_mfma_f32_16x16x32_bf16 a[44:47], a[176:179], a[204:207], a[44:47]
buffer_load_dwordx4 v1, s[12:15], s48 offen lds
v_mfma_f32_16x16x32_bf16 a[48:51], a[176:179], a[208:211], a[48:51]
s_cmp_lt_u32 s35, s45
s_cselect_b32 s101, s101, 536870912
s_cselect_b32 s46, s46, 536870912
v_mfma_f32_16x16x32_bf16 a[52:55], a[176:179], a[212:215], a[52:55]
v_mfma_f32_16x16x32_bf16 a[56:59], a[176:179], a[216:219], a[56:59]
v_mfma_f32_16x16x32_bf16 a[60:63], a[176:179], a[220:223], a[60:63]
ds_read_b64_tr_b16 a[176:177], v9 offset:0
v_mfma_f32_16x16x32_bf16 a[64:67], a[180:183], a[192:195], a[64:67]
ds_read_b64_tr_b16 a[178:179], v9 offset:1024
v_mfma_f32_16x16x32_bf16 a[68:71], a[180:183], a[196:199], a[68:71]
s_add_u32 s48, s48, s34
v_mfma_f32_16x16x32_bf16 a[72:75], a[180:183], a[200:203], a[72:75]
s_add_u32 m0, s32, 20480
v_mfma_f32_16x16x32_bf16 a[76:79], a[180:183], a[204:207], a[76:79]
buffer_load_dwordx4 v1, s[12:15], s48 offen lds
v_mfma_f32_16x16x32_bf16 a[80:83], a[180:183], a[208:211], a[80:83]
v_mfma_f32_16x16x32_bf16 a[84:87], a[180:183], a[212:215], a[84:87]
v_mfma_f32_16x16x32_bf16 a[88:91], a[180:183], a[216:219], a[88:91]
buffer_load_dword v15, v14, s[96:99], s100 offen
s_add_u32 s100, s100, 8192
v_mfma_f32_16x16x32_bf16 a[92:95], a[180:183], a[220:223], a[92:95]
ds_read_b64_tr_b16 a[180:181], v10 offset:0
v_mfma_f32_16x16x32_bf16 a[96:99], a[184:187], a[192:195], a[96:99]
ds_read_b64_tr_b16 a[182:183], v10 offset:1024
v_mfma_f32_16x16x32_bf16 a[100:103], a[184:187], a[196:199], a[100:103]
s_add_u32 s48, s48, s34
v_mfma_f32_16x16x32_bf16 a[104:107], a[184:187], a[200:203], a[104:107]
s_add_u32 m0, s32, 24576
v_mfma_f32_16x16x32_bf16 a[108:111], a[184:187], a[204:207], a[108:111]
buffer_load_dwordx4 v1, s[12:15], s48 offen lds
s_add_u32 s29, s29, s93
v_mfma_f32_16x16x32_bf16 a[112:115], a[184:187], a[208:211], a[112:115]
v_mfma_f32_16x16x32_bf16 a[116:119], a[184:187], a[212:215], a[116:119]
buffer_store_dwordx4 v[136:139], v13, s[8:11], s29 offen sc1
v_mfma_f32_16x16x32_bf16 a[120:123], a[184:187], a[216:219], a[120:123]
v_mfma_f32_16x16x32_bf16 a[124:127], a[184:187], a[220:223], a[124:127]
ds_read_b64_tr_b16 a[184:185], v11 offset:0
v_mfma_f32_16x16x32_bf16 a[128:131], a[188:191], a[192:195], a[128:131]
ds_read_b64_tr_b16 a[186:187], v11 offset:1024
v_mfma_f32_16x16x32_bf16 a[132:135], a[188:191], a[196:199], a[132:135]
s_add_u32 s48, s48, s34
v_add_u32 v3, 32768, v3
v_subrev_u32 v19, 98304, v3
v_mfma_f32_16x16x32_bf16 a[136:139], a[188:191], a[200:203], a[136:139]
s_add_u32 m0, s32, 28672
v_cmp_le_u32 vcc, 163840, v3
v_add_u32 v5, 16384, v5
v_mfma_f32_16x16x32_bf16 a[140:143], a[188:191], a[204:207], a[140:143]
buffer_load_dwordx4 v1, s[12:15], s48 offen lds
v_and_b32 v5, 65535, v5
v_xor_b32 v6, 16, v5
v_mfma_f32_16x16x32_bf16 a[144:147], a[188:191], a[208:211], a[144:147]
s_add_u32 s30, s30, 128
s_add_u32 s32, s32, 32768
s_sub_u32 s48, s32, 98304
v_mfma_f32_16x16x32_bf16 a[148:151], a[188:191], a[212:215], a[148:151]
s_cmp_ge_u32 s32, 163840
s_cselect_b32 s32, s48, s32
v_xor_b32 v7, 64, v5
v_mfma_f32_16x16x32_bf16 a[152:155], a[188:191], a[216:219], a[152:155]
v_xor_b32 v8, 80, v5
v_xor_b32 v9, 128, v5
v_xor_b32 v10, 144, v5
v_mfma_f32_16x16x32_bf16 a[156:159], a[188:191], a[220:223], a[156:159]
v_xor_b32 v11, 192, v5
v_xor_b32 v12, 208, v5
v_cndmask_b32 v3, v3, v19, vcc
v_xor_b32 v4, 64, v3
s_waitcnt vmcnt(20) lgkmcnt(0)
s_barrier
v_mfma_f32_16x16x32_bf16 v[160:163], a[160:163], a[224:227], v[160:163]
ds_read_b128 a[192:195], v3 offset:0
v_mfma_f32_16x16x32_bf16 v[164:167], a[160:163], a[228:231], v[164:167]
s_add_u32 s37, s31, 0
v_mfma_f32_16x16x32_bf16 v[168:171], a[160:163], a[232:235], v[168:171]
s_add_u32 m0, s33, 0
ds_read_b128 a[196:199], v4 offset:1024
v_mfma_f32_16x16x32_bf16 v[172:175], a[160:163], a[236:239], v[172:175]
buffer_load_dwordx4 v2, s[20:23], s37 offen  lds
s_add_u32 s29, s29, s44
v_mfma_f32_16x16x32_bf16 v[176:179], a[160:163], a[240:243], v[176:179]
ds_read_b128 a[200:203], v3 offset:4096
v_mfma_f32_16x16x32_bf16 v[180:183], a[160:163], a[244:247], v[180:183]
buffer_store_dwordx4 v[140:143], v13, s[8:11], s29 offen sc1
v_mfma_f32_16x16x32_bf16 v[184:187], a[160:163], a[248:251], v[184:187]
ds_read_b128 a[204:207], v4 offset:5120
v_mfma_f32_16x16x32_bf16 v[188:191], a[160:163], a[252:255], v[188:191]
ds_read_b64_tr_b16 a[160:161], v5 offset:0
v_mfma_f32_16x16x32_bf16 v[192:195], a[164:167], a[224:227], v[192:195]
ds_read_b64_tr_b16 a[162:163], v5 offset:1024
ds_read_b128 a[208:211], v3 offset:8192
v_mfma_f32_16x16x32_bf16 v[196:199], a[164:167], a[228:231], v[196:199]
s_add_u32 s37, s31, 32768
v_mfma_f32_16x16x32_bf16 v[200:203], a[164:167], a[232:235], v[200:203]
s_add_u32 m0, s33, 1024
ds_read_b128 a[212:215], v4 offset:9216
v_mfma_f32_16x16x32_bf16 v[204:207], a[164:167], a[236:239], v[204:207]
buffer_load_dwordx4 v2, s[20:23], s37 offen  lds
v_mfma_f32_16x16x32_bf16 v[208:211], a[164:167], a[240:243], v[208:211]
ds_read_b128 a[216:219], v3 offset:12288
v_mfma_f32_16x16x32_bf16 v[212:215], a[164:167], a[244:247], v[212:215]
s_cmp_eq_u32 s2, 0
s_cselect_b64 s[4:5], s[52:53], s[54:55]
v_mfma_f32_16x16x32_bf16 v[216:219], a[164:167], a[248:251], v[216:219]
ds_read_b128 a[220:223], v4 offset:13312
s_mov_b32 s12, s4
v_mfma_f32_16x16x32_bf16 v[220:223], a[164:167], a[252:255], v[220:223]
ds_read_b64_tr_b16 a[164:165], v6 offset:0
s_and_b32 s13, s5, 0xffff
v_mfma_f32_16x16x32_bf16 v[224:227], a[168:171], a[224:227], v[224:227]
ds_read_b64_tr_b16 a[166:167], v6 offset:1024
ds_read_b64_tr_b16 a[188:189], v12 offset:0
v_mfma_f32_16x16x32_bf16 v[228:231], a[168:171], a[228:231], v[228:231]
s_add_u32 s37, s31, 131072
s_lshl_b32 s14, s47, 11
v_mfma_f32_16x16x32_bf16 v[232:235], a[168:171], a[232:235], v[232:235]
s_add_u32 m0, s33, 4096
ds_read_b64_tr_b16 a[190:191], v12 offset:1024
v_mfma_f32_16x16x32_bf16 v[236:239], a[168:171], a[236:239], v[236:239]
buffer_load_dwordx4 v2, s[20:23], s37 offen  lds
s_mov_b32 s15, 0x20000
v_mfma_f32_16x16x32_bf16 v[240:243], a[168:171], a[240:243], v[240:243]
s_mov_b32 s30, s101
v_lshrrev_b32 v16, 3, v0
v_mfma_f32_16x16x32_bf16 v[244:247], a[168:171], a[244:247], v[244:247]
v_mul_lo_u32 v16, v16, s47
v_and_b32 v1, 0x70, v1
v_mfma_f32_16x16x32_bf16 v[248:251], a[168:171], a[248:251], v[248:251]
v_add_u32 v1, v1, v16
s_lshl_b32 s34, s47, 5
v_mfma_f32_16x16x32_bf16 v[252:255], a[168:171], a[252:255], v[252:255]
ds_read_b64_tr_b16 a[168:169], v7 offset:0
v_mfma_f32_16x16x32_bf16 a[0:3], a[172:175], a[224:227], a[0:3]
ds_read_b64_tr_b16 a[170:171], v7 offset:1024
v_mfma_f32_16x16x32_bf16 a[4:7], a[172:175], a[228:231], a[4:7]
s_add_u32 s37, s31, 163840
v_mfma_f32_16x16x32_bf16 a[8:11], a[172:175], a[232:235], a[8:11]
s_add_u32 m0, s33, 5120
v_mfma_f32_16x16x32_bf16 a[12:15], a[172:175], a[236:239], a[12:15]
buffer_load_dwordx4 v2, s[20:23], s37 offen  lds
s_add_u32 s29, s29, s93
v_mfma_f32_16x16x32_bf16 a[16:19], a[172:175], a[240:243], a[16:19]
v_mfma_f32_16x16x32_bf16 a[20:23], a[172:175], a[244:247], a[20:23]
buffer_store_dwordx4 v[144:147], v13, s[8:11], s29 offen sc1
v_mfma_f32_16x16x32_bf16 a[24:27], a[172:175], a[248:251], a[24:27]
v_mfma_f32_16x16x32_bf16 a[28:31], a[172:175], a[252:255], a[28:31]
ds_read_b64_tr_b16 a[172:173], v8 offset:0
v_mfma_f32_16x16x32_bf16 a[32:35], a[176:179], a[224:227], a[32:35]
ds_read_b64_tr_b16 a[174:175], v8 offset:1024
s_add_u32 s31, s31, 262144
v_mfma_f32_16x16x32_bf16 a[36:39], a[176:179], a[228:231], a[36:39]
s_mov_b32 s48, s30
s_add_u32 s33, s33, 16384
v_mfma_f32_16x16x32_bf16 a[40:43], a[176:179], a[232:235], a[40:43]
s_add_u32 m0, s32, 0
s_and_b32 s33, s33, 65535
v_mfma_f32_16x16x32_bf16 a[44:47], a[176:179], a[236:239], a[44:47]
buffer_load_dwordx4 v1, s[12:15], s48 offen lds
v_mfma_f32_16x16x32_bf16 a[48:51], a[176:179], a[240:243], a[48:51]
v_mfma_f32_16x16x32_bf16 a[52:55], a[176:179], a[244:247], a[52:55]
v_mfma_f32_16x16x32_bf16 a[56:59], a[176:179], a[248:251], a[56:59]
v_mfma_f32_16x16x32_bf16 a[60:63], a[176:179], a[252:255], a[60:63]
ds_read_b64_tr_b16 a[176:177], v9 offset:0
v_mfma_f32_16x16x32_bf16 a[64:67], a[180:183], a[224:227], a[64:67]
ds_read_b64_tr_b16 a[178:179], v9 offset:1024
v_mfma_f32_16x16x32_bf16 a[68:71], a[180:183], a[228:231], a[68:71]
s_add_u32 s48, s48, s34
v_mfma_f32_16x16x32_bf16 a[72:75], a[180:183], a[232:235], a[72:75]
s_add_u32 m0, s32, 4096
v_mfma_f32_16x16x32_bf16 a[76:79], a[180:183], a[236:239], a[76:79]
buffer_load_dwordx4 v1, s[12:15], s48 offen lds
v_mfma_f32_16x16x32_bf16 a[80:83], a[180:183], a[240:243], a[80:83]
s_cmp_eq_u32 s2, 0
s_cselect_b64 s[4:5], s[6:7], s[18:19]
s_mov_b32 s20, s4
v_mfma_f32_16x16x32_bf16 a[84:87], a[180:183], a[244:247], a[84:87]
s_and_b32 s21, s5, 0xffff
s_lshl_b32 s22, s47, 12
s_mov_b32 s23, 0x20000
v_mfma_f32_16x16x32_bf16 a[88:91], a[180:183], a[248:251], a[88:91]
buffer_load_dword v15, v14, s[96:99], s100 offen
s_add_u32 s100, s100, 8192
s_mov_b32 s31, s46
v_mfma_f32_16x16x32_bf16 a[92:95], a[180:183], a[252:255], a[92:95]
ds_read_b64_tr_b16 a[180:181], v10 offset:0
v_mfma_f32_16x16x32_bf16 a[96:99], a[184:187], a[224:227], a[96:99]
ds_read_b64_tr_b16 a[182:183], v10 offset:1024
v_mfma_f32_16x16x32_bf16 a[100:103], a[184:187], a[228:231], a[100:103]
s_add_u32 s48, s48, s34
v_mfma_f32_16x16x32_bf16 a[104:107], a[184:187], a[232:235], a[104:107]
s_add_u32 m0, s32, 8192
v_mfma_f32_16x16x32_bf16 a[108:111], a[184:187], a[236:239], a[108:111]
buffer_load_dwordx4 v1, s[12:15], s48 offen lds
s_add_u32 s29, s29, s44
v_mfma_f32_16x16x32_bf16 a[112:115], a[184:187], a[240:243], a[112:115]
v_mfma_f32_16x16x32_bf16 a[116:119], a[184:187], a[244:247], a[116:119]
buffer_store_dwordx4 v[148:151], v13, s[8:11], s29 offen sc1
v_mfma_f32_16x16x32_bf16 a[120:123], a[184:187], a[248:251], a[120:123]
v_mfma_f32_16x16x32_bf16 a[124:127], a[184:187], a[252:255], a[124:127]
ds_read_b64_tr_b16 a[184:185], v11 offset:0
v_mfma_f32_16x16x32_bf16 a[128:131], v[28:31], a[224:227], a[128:131]
ds_read_b64_tr_b16 a[186:187], v11 offset:1024
v_mfma_f32_16x16x32_bf16 a[132:135], v[28:31], a[228:231], a[132:135]
s_add_u32 s48, s48, s34
v_add_u32 v5, 16384, v5
v_and_b32 v5, 65535, v5
v_mfma_f32_16x16x32_bf16 a[136:139], v[28:31], a[232:235], a[136:139]
s_add_u32 m0, s32, 12288
v_xor_b32 v6, 16, v5
v_xor_b32 v7, 64, v5
v_mfma_f32_16x16x32_bf16 a[140:143], v[28:31], a[236:239], a[140:143]
buffer_load_dwordx4 v1, s[12:15], s48 offen lds
v_xor_b32 v8, 80, v5
v_xor_b32 v9, 128, v5
v_mfma_f32_16x16x32_bf16 a[144:147], v[28:31], a[240:243], a[144:147]
v_xor_b32 v10, 144, v5
v_xor_b32 v11, 192, v5
v_xor_b32 v12, 208, v5
v_mfma_f32_16x16x32_bf16 a[148:151], v[28:31], a[244:247], a[148:151]
v_mfma_f32_16x16x32_bf16 a[152:155], v[28:31], a[248:251], a[152:155]
v_mfma_f32_16x16x32_bf16 a[156:159], v[28:31], a[252:255], a[156:159]
s_waitcnt vmcnt(24) lgkmcnt(0)
s_barrier
v_mfma_f32_16x16x32_bf16 v[160:163], a[160:163], a[192:195], v[160:163]
ds_read_b128 a[224:227], v4 offset:0
v_mfma_f32_16x16x32_bf16 v[164:167], a[160:163], a[196:199], v[164:167]
s_add_u32 s37, s31, 0
v_mfma_f32_16x16x32_bf16 v[168:171], a[160:163], a[200:203], v[168:171]
s_add_u32 m0, s33, 0
ds_read_b128 a[228:231], v3 offset:1024
v_mfma_f32_16x16x32_bf16 v[172:175], a[160:163], a[204:207], v[172:175]
buffer_load_dwordx4 v2, s[20:23], s37 offen  lds
s_add_u32 s29, s29, s93
v_mfma_f32_16x16x32_bf16 v[176:179], a[160:163], a[208:211], v[176:179]
ds_read_b128 a[232:235], v4 offset:4096
v_mfma_f32_16x16x32_bf16 v[180:183], a[160:163], a[212:215], v[180:183]
buffer_store_dwordx4 v[152:155], v13, s[8:11], s29 offen sc1
v_mfma_f32_16x16x32_bf16 v[184:187], a[160:163], a[216:219], v[184:187]
ds_read_b128 a[236:239], v3 offset:5120
v_mfma_f32_16x16x32_bf16 v[188:191], a[160:163], a[220:223], v[188:191]
ds_read_b64_tr_b16 a[160:161], v5 offset:0
v_mfma_f32_16x16x32_bf16 v[192:195], a[164:167], a[192:195], v[192:195]
ds_read_b64_tr_b16 a[162:163], v5 offset:1024
ds_read_b128 a[240:243], v4 offset:8192
v_mfma_f32_16x16x32_bf16 v[196:199], a[164:167], a[196:199], v[196:199]
s_add_u32 s37, s31, 32768
v_mfma_f32_16x16x32_bf16 v[200:203], a[164:167], a[200:203], v[200:203]
s_add_u32 m0, s33, 1024
ds_read_b128 a[244:247], v3 offset:9216
v_mfma_f32_16x16x32_bf16 v[204:207], a[164:167], a[204:207], v[204:207]
buffer_load_dwordx4 v2, s[20:23], s37 offen  lds
v_mfma_f32_16x16x32_bf16 v[208:211], a[164:167], a[208:211], v[208:211]
ds_read_b128 a[248:251], v4 offset:12288
v_mfma_f32_16x16x32_bf16 v[212:215], a[164:167], a[212:215], v[212:215]
v_mfma_f32_16x16x32_bf16 v[216:219], a[164:167], a[216:219], v[216:219]
ds_read_b128 a[252:255], v3 offset:13312
v_mfma_f32_16x16x32_bf16 v[220:223], a[164:167], a[220:223], v[220:223]
ds_read_b64_tr_b16 a[164:165], v6 offset:0
v_mfma_f32_16x16x32_bf16 v[224:227], a[168:171], a[192:195], v[224:227]
ds_read_b64_tr_b16 a[166:167], v6 offset:1024
ds_read_b64_tr_b16 v[28:29], v12 offset:0
v_mfma_f32_16x16x32_bf16 v[228:231], a[168:171], a[196:199], v[228:231]
s_add_u32 s37, s31, 131072
v_mfma_f32_16x16x32_bf16 v[232:235], a[168:171], a[200:203], v[232:235]
s_add_u32 m0, s33, 4096
ds_read_b64_tr_b16 v[30:31], v12 offset:1024
v_mfma_f32_16x16x32_bf16 v[236:239], a[168:171], a[204:207], v[236:239]
buffer_load_dwordx4 v2, s[20:23], s37 offen  lds
v_mfma_f32_16x16x32_bf16 v[240:243], a[168:171], a[208:211], v[240:243]
v_mfma_f32_16x16x32_bf16 v[244:247], a[168:171], a[212:215], v[244:247]
v_mfma_f32_16x16x32_bf16 v[248:251], a[168:171], a[216:219], v[248:251]
v_mfma_f32_16x16x32_bf16 v[252:255], a[168:171], a[220:223], v[252:255]
ds_read_b64_tr_b16 a[168:169], v7 offset:0
v_mfma_f32_16x16x32_bf16 a[0:3], a[172:175], a[192:195], a[0:3]
ds_read_b64_tr_b16 a[170:171], v7 offset:1024
v_mfma_f32_16x16x32_bf16 a[4:7], a[172:175], a[196:199], a[4:7]
s_add_u32 s37, s31, 163840
v_mfma_f32_16x16x32_bf16 a[8:11], a[172:175], a[200:203], a[8:11]
s_add_u32 m0, s33, 5120
v_mfma_f32_16x16x32_bf16 a[12:15], a[172:175], a[204:207], a[12:15]
buffer_load_dwordx4 v2, s[20:23], s37 offen  lds
s_add_u32 s29, s29, s44
v_mfma_f32_16x16x32_bf16 a[16:19], a[172:175], a[208:211], a[16:19]
v_mfma_f32_16x16x32_bf16 a[20:23], a[172:175], a[212:215], a[20:23]
buffer_store_dwordx4 v[156:159], v13, s[8:11], s29 offen sc1
v_mfma_f32_16x16x32_bf16 a[24:27], a[172:175], a[216:219], a[24:27]
v_mfma_f32_16x16x32_bf16 a[28:31], a[172:175], a[220:223], a[28:31]
ds_read_b64_tr_b16 a[172:173], v8 offset:0
v_mfma_f32_16x16x32_bf16 a[32:35], a[176:179], a[192:195], a[32:35]
ds_read_b64_tr_b16 a[174:175], v8 offset:1024
s_add_u32 s31, s31, 262144
v_mfma_f32_16x16x32_bf16 a[36:39], a[176:179], a[196:199], a[36:39]
s_add_u32 s48, s48, s34
s_add_u32 s33, s33, 16384
v_mfma_f32_16x16x32_bf16 a[40:43], a[176:179], a[200:203], a[40:43]
s_add_u32 m0, s32, 16384
s_and_b32 s33, s33, 65535
v_mfma_f32_16x16x32_bf16 a[44:47], a[176:179], a[204:207], a[44:47]
buffer_load_dwordx4 v1, s[12:15], s48 offen lds
v_mfma_f32_16x16x32_bf16 a[48:51], a[176:179], a[208:211], a[48:51]
v_mfma_f32_16x16x32_bf16 a[52:55], a[176:179], a[212:215], a[52:55]
v_mfma_f32_16x16x32_bf16 a[56:59], a[176:179], a[216:219], a[56:59]
v_mfma_f32_16x16x32_bf16 a[60:63], a[176:179], a[220:223], a[60:63]
ds_read_b64_tr_b16 a[176:177], v9 offset:0
v_mfma_f32_16x16x32_bf16 a[64:67], a[180:183], a[192:195], a[64:67]
ds_read_b64_tr_b16 a[178:179], v9 offset:1024
v_mfma_f32_16x16x32_bf16 a[68:71], a[180:183], a[196:199], a[68:71]
s_add_u32 s48, s48, s34
v_mfma_f32_16x16x32_bf16 a[72:75], a[180:183], a[200:203], a[72:75]
s_add_u32 m0, s32, 20480
v_mfma_f32_16x16x32_bf16 a[76:79], a[180:183], a[204:207], a[76:79]
buffer_load_dwordx4 v1, s[12:15], s48 offen lds
v_mfma_f32_16x16x32_bf16 a[80:83], a[180:183], a[208:211], a[80:83]
v_mfma_f32_16x16x32_bf16 a[84:87], a[180:183], a[212:215], a[84:87]
v_mfma_f32_16x16x32_bf16 a[88:91], a[180:183], a[216:219], a[88:91]
buffer_load_dword v15, v14, s[96:99], s100 offen
s_add_u32 s100, s100, 8192
v_mfma_f32_16x16x32_bf16 a[92:95], a[180:183], a[220:223], a[92:95]
ds_read_b64_tr_b16 a[180:181], v10 offset:0
v_mfma_f32_16x16x32_bf16 a[96:99], a[184:187], a[192:195], a[96:99]
ds_read_b64_tr_b16 a[182:183], v10 offset:1024
v_mfma_f32_16x16x32_bf16 a[100:103], a[184:187], a[196:199], a[100:103]
s_add_u32 s48, s48, s34
v_mfma_f32_16x16x32_bf16 a[104:107], a[184:187], a[200:203], a[104:107]
s_add_u32 m0, s32, 24576
v_mfma_f32_16x16x32_bf16 a[108:111], a[184:187], a[204:207], a[108:111]
buffer_load_dwordx4 v1, s[12:15], s48 offen lds
v_mfma_f32_16x16x32_bf16 a[112:115], a[184:187], a[208:211], a[112:115]
v_mfma_f32_16x16x32_bf16 a[116:119], a[184:187], a[212:215], a[116:119]
v_mfma_f32_16x16x32_bf16 a[120:123], a[184:187], a[216:219], a[120:123]
v_mfma_f32_16x16x32_bf16 a[124:127], a[184:187], a[220:223], a[124:127]
ds_read_b64_tr_b16 a[184:185], v11 offset:0
v_mfma_f32_16x16x32_bf16 a[128:131], a[188:191], a[192:195], a[128:131]
ds_read_b64_tr_b16 a[186:187], v11 offset:1024
v_mfma_f32_16x16x32_bf16 a[132:135], a[188:191], a[196:199], a[132:135]
s_add_u32 s48, s48, s34
v_add_u32 v3, 32768, v3
v_subrev_u32 v19, 98304, v3
v_mfma_f32_16x16x32_bf16 a[136:139], a[188:191], a[200:203], a[136:139]
s_add_u32 m0, s32, 28672
v_cmp_le_u32 vcc, 163840, v3
v_add_u32 v5, 16384, v5
v_mfma_f32_16x16x32_bf16 a[140:143], a[188:191], a[204:207], a[140:143]
buffer_load_dwordx4 v1, s[12:15], s48 offen lds
v_and_b32 v5, 65535, v5
v_xor_b32 v6, 16, v5
v_mfma_f32_16x16x32_bf16 a[144:147], a[188:191], a[208:211], a[144:147]
s_add_u32 s30, s30, 128
s_add_u32 s32, s32, 32768
s_sub_u32 s48, s32, 98304
v_mfma_f32_16x16x32_bf16 a[148:151], a[188:191], a[212:215], a[148:151]
s_cmp_ge_u32 s32, 163840
s_cselect_b32 s32, s48, s32
v_xor_b32 v7, 64, v5
v_mfma_f32_16x16x32_bf16 a[152:155], a[188:191], a[216:219], a[152:155]
v_xor_b32 v8, 80, v5
v_xor_b32 v9, 128, v5
v_xor_b32 v10, 144, v5
v_mfma_f32_16x16x32_bf16 a[156:159], a[188:191], a[220:223], a[156:159]
v_xor_b32 v11, 192, v5
v_xor_b32 v12, 208, v5
v_cndmask_b32 v3, v3, v19, vcc
v_xor_b32 v4, 64, v3
s_waitcnt vmcnt(23) lgkmcnt(0)
s_barrier
v_mfma_f32_16x16x32_bf16 v[160:163], a[160:163], a[224:227], v[160:163]
ds_read_b128 a[192:195], v3 offset:0
v_mfma_f32_16x16x32_bf16 v[164:167], a[160:163], a[228:231], v[164:167]
s_add_u32 s37, s31, 0
v_mfma_f32_16x16x32_bf16 v[168:171], a[160:163], a[232:235], v[168:171]
s_add_u32 m0, s33, 0
ds_read_b128 a[196:199], v4 offset:1024
v_mfma_f32_16x16x32_bf16 v[172:175], a[160:163], a[236:239], v[172:175]
buffer_load_dwordx4 v2, s[20:23], s37 offen  lds
v_mfma_f32_16x16x32_bf16 v[176:179], a[160:163], a[240:243], v[176:179]
ds_read_b128 a[200:203], v3 offset:4096
v_mfma_f32_16x16x32_bf16 v[180:183], a[160:163], a[244:247], v[180:183]
v_mfma_f32_16x16x32_bf16 v[184:187], a[160:163], a[248:251], v[184:187]
ds_read_b128 a[204:207], v4 offset:5120
v_mfma_f32_16x16x32_bf16 v[188:191], a[160:163], a[252:255], v[188:191]
ds_read_b64_tr_b16 a[160:161], v5 offset:0
v_mfma_f32_16x16x32_bf16 v[192:195], a[164:167], a[224:227], v[192:195]
ds_read_b64_tr_b16 a[162:163], v5 offset:1024
ds_read_b128 a[208:211], v3 offset:8192
v_mfma_f32_16x16x32_bf16 v[196:199], a[164:167], a[228:231], v[196:199]
s_add_u32 s37, s31, 32768
v_mfma_f32_16x16x32_bf16 v[200:203], a[164:167], a[232:235], v[200:203]
s_add_u32 m0, s33, 1024
ds_read_b128 a[212:215], v4 offset:9216
v_mfma_f32_16x16x32_bf16 v[204:207], a[164:167], a[236:239], v[204:207]
buffer_load_dwordx4 v2, s[20:23], s37 offen  lds
v_mfma_f32_16x16x32_bf16 v[208:211], a[164:167], a[240:243], v[208:211]
ds_read_b128 a[216:219], v3 offset:12288
v_mfma_f32_16x16x32_bf16 v[212:215], a[164:167], a[244:247], v[212:215]
v_mfma_f32_16x16x32_bf16 v[216:219], a[164:167], a[248:251], v[216:219]
ds_read_b128 a[220:223], v4 offset:13312
v_mfma_f32_16x16x32_bf16 v[220:223], a[164:167], a[252:255], v[220:223]
ds_read_b64_tr_b16 a[164:165], v6 offset:0
v_mfma_f32_16x16x32_bf16 v[224:227], a[168:171], a[224:227], v[224:227]
ds_read_b64_tr_b16 a[166:167], v6 offset:1024
ds_read_b64_tr_b16 a[188:189], v12 offset:0
v_mfma_f32_16x16x32_bf16 v[228:231], a[168:171], a[228:231], v[228:231]
s_add_u32 s37, s31, 131072
v_mfma_f32_16x16x32_bf16 v[232:235], a[168:171], a[232:235], v[232:235]
s_add_u32 m0, s33, 4096
ds_read_b64_tr_b16 a[190:191], v12 offset:1024
v_mfma_f32_16x16x32_bf16 v[236:239], a[168:171], a[236:239], v[236:239]
buffer_load_dwordx4 v2, s[20:23], s37 offen  lds
v_mfma_f32_16x16x32_bf16 v[240:243], a[168:171], a[240:243], v[240:243]
v_mfma_f32_16x16x32_bf16 v[244:247], a[168:171], a[244:247], v[244:247]
v_mfma_f32_16x16x32_bf16 v[248:251], a[168:171], a[248:251], v[248:251]
v_mfma_f32_16x16x32_bf16 v[252:255], a[168:171], a[252:255], v[252:255]
ds_read_b64_tr_b16 a[168:169], v7 offset:0
v_mfma_f32_16x16x32_bf16 a[0:3], a[172:175], a[224:227], a[0:3]
ds_read_b64_tr_b16 a[170:171], v7 offset:1024
v_mfma_f32_16x16x32_bf16 a[4:7], a[172:175], a[228:231], a[4:7]
s_add_u32 s37, s31, 163840
v_mfma_f32_16x16x32_bf16 a[8:11], a[172:175], a[232:235], a[8:11]
s_add_u32 m0, s33, 5120
v_mfma_f32_16x16x32_bf16 a[12:15], a[172:175], a[236:239], a[12:15]
buffer_load_dwordx4 v2, s[20:23], s37 offen  lds
v_mfma_f32_16x16x32_bf16 a[16:19], a[172:175], a[240:243], a[16:19]
v_mfma_f32_16x16x32_bf16 a[20:23], a[172:175], a[244:247], a[20:23]
v_mfma_f32_16x16x32_bf16 a[24:27], a[172:175], a[248:251], a[24:27]
v_mfma_f32_16x16x32_bf16 a[28:31], a[172:175], a[252:255], a[28:31]
ds_read_b64_tr_b16 a[172:173], v8 offset:0
v_mfma_f32_16x16x32_bf16 a[32:35], a[176:179], a[224:227], a[32:35]
ds_read_b64_tr_b16 a[174:175], v8 offset:1024
s_add_u32 s31, s31, 262144
v_mfma_f32_16x16x32_bf16 a[36:39], a[176:179], a[228:231], a[36:39]
s_mov_b32 s48, s30
s_add_u32 s33, s33, 16384
v_mfma_f32_16x16x32_bf16 a[40:43], a[176:179], a[232:235], a[40:43]
s_add_u32 m0, s32, 0
s_and_b32 s33, s33, 65535
v_mfma_f32_16x16x32_bf16 a[44:47], a[176:179], a[236:239], a[44:47]
buffer_load_dwordx4 v1, s[12:15], s48 offen lds
v_mfma_f32_16x16x32_bf16 a[48:51], a[176:179], a[240:243], a[48:51]
v_mfma_f32_16x16x32_bf16 a[52:55], a[176:179], a[244:247], a[52:55]
v_mfma_f32_16x16x32_bf16 a[56:59], a[176:179], a[248:251], a[56:59]
v_mfma_f32_16x16x32_bf16 a[60:63], a[176:179], a[252:255], a[60:63]
ds_read_b64_tr_b16 a[176:177], v9 offset:0
v_mfma_f32_16x16x32_bf16 a[64:67], a[180:183], a[224:227], a[64:67]
ds_read_b64_tr_b16 a[178:179], v9 offset:1024
v_mfma_f32_16x16x32_bf16 a[68:71], a[180:183], a[228:231], a[68:71]
s_add_u32 s48, s48, s34
v_mfma_f32_16x16x32_bf16 a[72:75], a[180:183], a[232:235], a[72:75]
s_add_u32 m0, s32, 4096
v_mfma_f32_16x16x32_bf16 a[76:79], a[180:183], a[236:239], a[76:79]
buffer_load_dwordx4 v1, s[12:15], s48 offen lds
v_mfma_f32_16x16x32_bf16 a[80:83], a[180:183], a[240:243], a[80:83]
v_mfma_f32_16x16x32_bf16 a[84:87], a[180:183], a[244:247], a[84:87]
v_mfma_f32_16x16x32_bf16 a[88:91], a[180:183], a[248:251], a[88:91]
buffer_load_dword v15, v14, s[96:99], s100 offen
s_add_u32 s100, s100, 8192
v_mfma_f32_16x16x32_bf16 a[92:95], a[180:183], a[252:255], a[92:95]
ds_read_b64_tr_b16 a[180:181], v10 offset:0
v_mfma_f32_16x16x32_bf16 a[96:99], a[184:187], a[224:227], a[96:99]
ds_read_b64_tr_b16 a[182:183], v10 offset:1024
v_mfma_f32_16x16x32_bf16 a[100:103], a[184:187], a[228:231], a[100:103]
s_add_u32 s48, s48, s34
v_mfma_f32_16x16x32_bf16 a[104:107], a[184:187], a[232:235], a[104:107]
s_add_u32 m0, s32, 8192
v_mfma_f32_16x16x32_bf16 a[108:111], a[184:187], a[236:239], a[108:111]
buffer_load_dwordx4 v1, s[12:15], s48 offen lds
v_mfma_f32_16x16x32_bf16 a[112:115], a[184:187], a[240:243], a[112:115]
v_mfma_f32_16x16x32_bf16 a[116:119], a[184:187], a[244:247], a[116:119]
v_mfma_f32_16x16x32_bf16 a[120:123], a[184:187], a[248:251], a[120:123]
v_mfma_f32_16x16x32_bf16 a[124:127], a[184:187], a[252:255], a[124:127]
ds_read_b64_tr_b16 a[184:185], v11 offset:0
v_mfma_f32_16x16x32_bf16 a[128:131], v[28:31], a[224:227], a[128:131]
ds_read_b64_tr_b16 a[186:187], v11 offset:1024
v_mfma_f32_16x16x32_bf16 a[132:135], v[28:31], a[228:231], a[132:135]
s_add_u32 s48, s48, s34
v_add_u32 v5, 16384, v5
v_and_b32 v5, 65535, v5
v_mfma_f32_16x16x32_bf16 a[136:139], v[28:31], a[232:235], a[136:139]
s_add_u32 m0, s32, 12288
v_xor_b32 v6, 16, v5
v_xor_b32 v7, 64, v5
v_mfma_f32_16x16x32_bf16 a[140:143], v[28:31], a[236:239], a[140:143]
buffer_load_dwordx4 v1, s[12:15], s48 offen lds
v_xor_b32 v8, 80, v5
v_xor_b32 v9, 128, v5
v_mfma_f32_16x16x32_bf16 a[144:147], v[28:31], a[240:243], a[144:147]
v_xor_b32 v10, 144, v5
v_xor_b32 v11, 192, v5
v_xor_b32 v12, 208, v5
v_mfma_f32_16x16x32_bf16 a[148:151], v[28:31], a[244:247], a[148:151]
v_mfma_f32_16x16x32_bf16 a[152:155], v[28:31], a[248:251], a[152:155]
v_mfma_f32_16x16x32_bf16 a[156:159], v[28:31], a[252:255], a[156:159]
s_waitcnt vmcnt(20) lgkmcnt(0)
s_barrier
v_mfma_f32_16x16x32_bf16 v[160:163], a[160:163], a[192:195], v[160:163]
ds_read_b128 a[224:227], v4 offset:0
v_mfma_f32_16x16x32_bf16 v[164:167], a[160:163], a[196:199], v[164:167]
s_add_u32 s37, s31, 0
v_mfma_f32_16x16x32_bf16 v[168:171], a[160:163], a[200:203], v[168:171]
s_add_u32 m0, s33, 0
ds_read_b128 a[228:231], v3 offset:1024
v_mfma_f32_16x16x32_bf16 v[172:175], a[160:163], a[204:207], v[172:175]
buffer_load_dwordx4 v2, s[20:23], s37 offen  lds
v_mfma_f32_16x16x32_bf16 v[176:179], a[160:163], a[208:211], v[176:179]
ds_read_b128 a[232:235], v4 offset:4096
v_mfma_f32_16x16x32_bf16 v[180:183], a[160:163], a[212:215], v[180:183]
v_mfma_f32_16x16x32_bf16 v[184:187], a[160:163], a[216:219], v[184:187]
ds_read_b128 a[236:239], v3 offset:5120
v_mfma_f32_16x16x32_bf16 v[188:191], a[160:163], a[220:223], v[188:191]
ds_read_b64_tr_b16 a[160:161], v5 offset:0
v_mfma_f32_16x16x32_bf16 v[192:195], a[164:167], a[192:195], v[192:195]
ds_read_b64_tr_b16 a[162:163], v5 offset:1024
ds_read_b128 a[240:243], v4 offset:8192
v_mfma_f32_16x16x32_bf16 v[196:199], a[164:167], a[196:199], v[196:199]
s_add_u32 s37, s31, 32768
v_mfma_f32_16x16x32_bf16 v[200:203], a[164:167], a[200:203], v[200:203]
s_add_u32 m0, s33, 1024
ds_read_b128 a[244:247], v3 offset:9216
v_mfma_f32_16x16x32_bf16 v[204:207], a[164:167], a[204:207], v[204:207]
buffer_load_dwordx4 v2, s[20:23], s37 offen  lds
v_mfma_f32_16x16x32_bf16 v[208:211], a[164:167], a[208:211], v[208:211]
ds_read_b128 a[248:251], v4 offset:12288
v_mfma_f32_16x16x32_bf16 v[212:215], a[164:167], a[212:215], v[212:215]
v_mfma_f32_16x16x32_bf16 v[216:219], a[164:167], a[216:219], v[216:219]
ds_read_b128 a[252:255], v3 offset:13312
v_mfma_f32_16x16x32_bf16 v[220:223], a[164:167], a[220:223], v[220:223]
ds_read_b64_tr_b16 a[164:165], v6 offset:0
v_mfma_f32_16x16x32_bf16 v[224:227], a[168:171], a[192:195], v[224:227]
ds_read_b64_tr_b16 a[166:167], v6 offset:1024
ds_read_b64_tr_b16 v[28:29], v12 offset:0
v_mfma_f32_16x16x32_bf16 v[228:231], a[168:171], a[196:199], v[228:231]
s_add_u32 s37, s31, 131072
v_mfma_f32_16x16x32_bf16 v[232:235], a[168:171], a[200:203], v[232:235]
s_add_u32 m0, s33, 4096
ds_read_b64_tr_b16 v[30:31], v12 offset:1024
v_mfma_f32_16x16x32_bf16 v[236:239], a[168:171], a[204:207], v[236:239]
buffer_load_dwordx4 v2, s[20:23], s37 offen  lds
v_mfma_f32_16x16x32_bf16 v[240:243], a[168:171], a[208:211], v[240:243]
v_mfma_f32_16x16x32_bf16 v[244:247], a[168:171], a[212:215], v[244:247]
v_mfma_f32_16x16x32_bf16 v[248:251], a[168:171], a[216:219], v[248:251]
v_mfma_f32_16x16x32_bf16 v[252:255], a[168:171], a[220:223], v[252:255]
ds_read_b64_tr_b16 a[168:169], v7 offset:0
v_mfma_f32_16x16x32_bf16 a[0:3], a[172:175], a[192:195], a[0:3]
ds_read_b64_tr_b16 a[170:171], v7 offset:1024
v_mfma_f32_16x16x32_bf16 a[4:7], a[172:175], a[196:199], a[4:7]
s_add_u32 s37, s31, 163840
v_mfma_f32_16x16x32_bf16 a[8:11], a[172:175], a[200:203], a[8:11]
s_add_u32 m0, s33, 5120
v_mfma_f32_16x16x32_bf16 a[12:15], a[172:175], a[204:207], a[12:15]
buffer_load_dwordx4 v2, s[20:23], s37 offen  lds
v_mfma_f32_16x16x32_bf16 a[16:19], a[172:175], a[208:211], a[16:19]
v_mfma_f32_16x16x32_bf16 a[20:23], a[172:175], a[212:215], a[20:23]
v_mfma_f32_16x16x32_bf16 a[24:27], a[172:175], a[216:219], a[24:27]
v_mfma_f32_16x16x32_bf16 a[28:31], a[172:175], a[220:223], a[28:31]
ds_read_b64_tr_b16 a[172:173], v8 offset:0
v_mfma_f32_16x16x32_bf16 a[32:35], a[176:179], a[192:195], a[32:35]
ds_read_b64_tr_b16 a[174:175], v8 offset:1024
s_add_u32 s31, s31, 262144
v_mfma_f32_16x16x32_bf16 a[36:39], a[176:179], a[196:199], a[36:39]
s_add_u32 s48, s48, s34
s_add_u32 s33, s33, 16384
v_mfma_f32_16x16x32_bf16 a[40:43], a[176:179], a[200:203], a[40:43]
s_add_u32 m0, s32, 16384
s_and_b32 s33, s33, 65535
v_mfma_f32_16x16x32_bf16 a[44:47], a[176:179], a[204:207], a[44:47]
buffer_load_dwordx4 v1, s[12:15], s48 offen lds
v_mfma_f32_16x16x32_bf16 a[48:51], a[176:179], a[208:211], a[48:51]
v_mfma_f32_16x16x32_bf16 a[52:55], a[176:179], a[212:215], a[52:55]
v_mfma_f32_16x16x32_bf16 a[56:59], a[176:179], a[216:219], a[56:59]
v_mfma_f32_16x16x32_bf16 a[60:63], a[176:179], a[220:223], a[60:63]
ds_read_b64_tr_b16 a[176:177], v9 offset:0
v_mfma_f32_16x16x32_bf16 a[64:67], a[180:183], a[192:195], a[64:67]
ds_read_b64_tr_b16 a[178:179], v9 offset:1024
v_mfma_f32_16x16x32_bf16 a[68:71], a[180:183], a[196:199], a[68:71]
s_add_u32 s48, s48, s34
v_mfma_f32_16x16x32_bf16 a[72:75], a[180:183], a[200:203], a[72:75]
s_add_u32 m0, s32, 20480
v_mfma_f32_16x16x32_bf16 a[76:79], a[180:183], a[204:207], a[76:79]
buffer_load_dwordx4 v1, s[12:15], s48 offen lds
v_mfma_f32_16x16x32_bf16 a[80:83], a[180:183], a[208:211], a[80:83]
v_mfma_f32_16x16x32_bf16 a[84:87], a[180:183], a[212:215], a[84:87]
v_mfma_f32_16x16x32_bf16 a[88:91], a[180:183], a[216:219], a[88:91]
buffer_load_dword v15, v14, s[96:99], s100 offen
s_add_u32 s100, s100, 8192
v_mfma_f32_16x16x32_bf16 a[92:95], a[180:183], a[220:223], a[92:95]
ds_read_b64_tr_b16 a[180:181], v10 offset:0
v_mfma_f32_16x16x32_bf16 a[96:99], a[184:187], a[192:195], a[96:99]
ds_read_b64_tr_b16 a[182:183], v10 offset:1024
v_mfma_f32_16x16x32_bf16 a[100:103], a[184:187], a[196:199], a[100:103]
s_add_u32 s48, s48, s34
v_mfma_f32_16x16x32_bf16 a[104:107], a[184:187], a[200:203], a[104:107]
s_add_u32 m0, s32, 24576
v_mfma_f32_16x16x32_bf16 a[108:111], a[184:187], a[204:207], a[108:111]
buffer_load_dwordx4 v1, s[12:15], s48 offen lds
v_mfma_f32_16x16x32_bf16 a[112:115], a[184:187], a[208:211], a[112:115]
v_mfma_f32_16x16x32_bf16 a[116:119], a[184:187], a[212:215], a[116:119]
v_mfma_f32_16x16x32_bf16 a[120:123], a[184:187], a[216:219], a[120:123]
v_mfma_f32_16x16x32_bf16 a[124:127], a[184:187], a[220:223], a[124:127]
ds_read_b64_tr_b16 a[184:185], v11 offset:0
v_mfma_f32_16x16x32_bf16 a[128:131], a[188:191], a[192:195], a[128:131]
ds_read_b64_tr_b16 a[186:187], v11 offset:1024
v_mfma_f32_16x16x32_bf16 a[132:135], a[188:191], a[196:199], a[132:135]
s_add_u32 s48, s48, s34
v_add_u32 v3, 32768, v3
v_subrev_u32 v19, 98304, v3
v_mfma_f32_16x16x32_bf16 a[136:139], a[188:191], a[200:203], a[136:139]
s_add_u32 m0, s32, 28672
v_cmp_le_u32 vcc, 163840, v3
v_add_u32 v5, 16384, v5
v_mfma_f32_16x16x32_bf16 a[140:143], a[188:191], a[204:207], a[140:143]
buffer_load_dwordx4 v1, s[12:15], s48 offen lds
v_and_b32 v5, 65535, v5
v_xor_b32 v6, 16, v5
v_mfma_f32_16x16x32_bf16 a[144:147], a[188:191], a[208:211], a[144:147]
s_add_u32 s30, s30, 128
s_add_u32 s32, s32, 32768
s_sub_u32 s48, s32, 98304
v_mfma_f32_16x16x32_bf16 a[148:151], a[188:191], a[212:215], a[148:151]
s_cmp_ge_u32 s32, 163840
s_cselect_b32 s32, s48, s32
v_xor_b32 v7, 64, v5
v_mfma_f32_16x16x32_bf16 a[152:155], a[188:191], a[216:219], a[152:155]
v_xor_b32 v8, 80, v5
v_xor_b32 v9, 128, v5
v_xor_b32 v10, 144, v5
v_mfma_f32_16x16x32_bf16 a[156:159], a[188:191], a[220:223], a[156:159]
v_xor_b32 v11, 192, v5
v_xor_b32 v12, 208, v5
v_cndmask_b32 v3, v3, v19, vcc
v_xor_b32 v4, 64, v3
s_cmp_eq_u32 s41, 0
s_cbranch_scc0 L_g_k17v
s_waitcnt vmcnt(18) lgkmcnt(0)
s_barrier
v_mfma_f32_16x16x32_bf16 v[160:163], a[160:163], a[224:227], v[160:163]
ds_read_b128 a[192:195], v3 offset:0
v_mfma_f32_16x16x32_bf16 v[164:167], a[160:163], a[228:231], v[164:167]
s_add_u32 s37, s31, 0
v_mfma_f32_16x16x32_bf16 v[168:171], a[160:163], a[232:235], v[168:171]
s_add_u32 m0, s33, 0
ds_read_b128 a[196:199], v4 offset:1024
v_mfma_f32_16x16x32_bf16 v[172:175], a[160:163], a[236:239], v[172:175]
buffer_load_dwordx4 v2, s[20:23], s37 offen  lds
v_mfma_f32_16x16x32_bf16 v[176:179], a[160:163], a[240:243], v[176:179]
ds_read_b128 a[200:203], v3 offset:4096
v_cvt_pk_bf16_f32 v32, v160, v161
v_cvt_pk_bf16_f32 v33, v162, v163
v_mfma_f32_16x16x32_bf16 v[180:183], a[160:163], a[244:247], v[180:183]
v_cvt_pk_bf16_f32 v36, v164, v165
v_cvt_pk_bf16_f32 v37, v166, v167
v_mfma_f32_16x16x32_bf16 v[184:187], a[160:163], a[248:251], v[184:187]
ds_read_b128 a[204:207], v4 offset:5120
v_cvt_pk_bf16_f32 v40, v168, v169
v_cvt_pk_bf16_f32 v41, v170, v171
v_mfma_f32_16x16x32_bf16 v[188:191], a[160:163], a[252:255], v[188:191]
ds_read_b64_tr_b16 a[160:161], v5 offset:0
v_cvt_pk_bf16_f32 v44, v172, v173
v_cvt_pk_bf16_f32 v45, v174, v175
v_mfma_f32_16x16x32_bf16 v[192:195], a[164:167], a[224:227], v[192:195]
ds_read_b64_tr_b16 a[162:163], v5 offset:1024
ds_read_b128 a[208:211], v3 offset:8192
v_cvt_pk_bf16_f32 v48, v176, v177
v_cvt_pk_bf16_f32 v49, v178, v179
v_mfma_f32_16x16x32_bf16 v[196:199], a[164:167], a[228:231], v[196:199]
s_add_u32 s37, s31, 32768
v_cvt_pk_bf16_f32 v52, v180, v181
v_cvt_pk_bf16_f32 v53, v182, v183
v_mfma_f32_16x16x32_bf16 v[200:203], a[164:167], a[232:235], v[200:203]
s_add_u32 m0, s33, 1024
ds_read_b128 a[212:215], v4 offset:9216
v_cvt_pk_bf16_f32 v56, v184, v185
v_cvt_pk_bf16_f32 v57, v186, v187
v_mfma_f32_16x16x32_bf16 v[204:207], a[164:167], a[236:239], v[204:207]
buffer_load_dwordx4 v2, s[20:23], s37 offen  lds
v_cvt_pk_bf16_f32 v60, v188, v189
v_cvt_pk_bf16_f32 v61, v190, v191
v_mfma_f32_16x16x32_bf16 v[208:211], a[164:167], a[240:243], v[208:211]
ds_read_b128 a[216:219], v3 offset:12288
v_cvt_pk_bf16_f32 v34, v192, v193
v_cvt_pk_bf16_f32 v35, v194, v195
v_mfma_f32_16x16x32_bf16 v[212:215], a[164:167], a[244:247], v[212:215]
v_cvt_pk_bf16_f32 v38, v196, v197
v_cvt_pk_bf16_f32 v39, v198, v199
v_mfma_f32_16x16x32_bf16 v[216:219], a[164:167], a[248:251], v[216:219]
ds_read_b128 a[220:223], v4 offset:13312
v_cvt_pk_bf16_f32 v42, v200, v201
v_cvt_pk_bf16_f32 v43, v202, v203
v_mfma_f32_16x16x32_bf16 v[220:223], a[164:167], a[252:255], v[220:223]
ds_read_b64_tr_b16 a[164:165], v6 offset:0
v_cvt_pk_bf16_f32 v46, v204, v205
v_cvt_pk_bf16_f32 v47, v206, v207
v_mfma_f32_16x16x32_bf16 v[224:227], a[168:171], a[224:227], v[224:227]
ds_read_b64_tr_b16 a[166:167], v6 offset:1024
ds_read_b64_tr_b16 a[188:189], v12 offset:0
v_cvt_pk_bf16_f32 v50, v208, v209
v_cvt_pk_bf16_f32 v51, v210, v211
v_mfma_f32_16x16x32_bf16 v[228:231], a[168:171], a[228:231], v[228:231]
s_add_u32 s37, s31, 131072
v_cvt_pk_bf16_f32 v54, v212, v213
v_cvt_pk_bf16_f32 v55, v214, v215
v_mfma_f32_16x16x32_bf16 v[232:235], a[168:171], a[232:235], v[232:235]
s_add_u32 m0, s33, 4096
ds_read_b64_tr_b16 a[190:191], v12 offset:1024
v_cvt_pk_bf16_f32 v58, v216, v217
v_cvt_pk_bf16_f32 v59, v218, v219
v_mfma_f32_16x16x32_bf16 v[236:239], a[168:171], a[236:239], v[236:239]
buffer_load_dwordx4 v2, s[20:23], s37 offen  lds
v_cvt_pk_bf16_f32 v62, v220, v221
v_cvt_pk_bf16_f32 v63, v222, v223
v_mfma_f32_16x16x32_bf16 v[240:243], a[168:171], a[240:243], v[240:243]
v_cvt_pk_bf16_f32 v64, v224, v225
v_cvt_pk_bf16_f32 v65, v226, v227
v_mfma_f32_16x16x32_bf16 v[244:247], a[168:171], a[244:247], v[244:247]
v_cvt_pk_bf16_f32 v68, v228, v229
v_cvt_pk_bf16_f32 v69, v230, v231
v_mfma_f32_16x16x32_bf16 v[248:251], a[168:171], a[248:251], v[248:251]
v_cvt_pk_bf16_f32 v72, v232, v233
v_cvt_pk_bf16_f32 v73, v234, v235
v_mfma_f32_16x16x32_bf16 v[252:255], a[168:171], a[252:255], v[252:255]
ds_read_b64_tr_b16 a[168:169], v7 offset:0
v_cvt_pk_bf16_f32 v76, v236, v237
v_cvt_pk_bf16_f32 v77, v238, v239
v_mfma_f32_16x16x32_bf16 a[0:3], a[172:175], a[224:227], a[0:3]
ds_read_b64_tr_b16 a[170:171], v7 offset:1024
v_cvt_pk_bf16_f32 v80, v240, v241
v_cvt_pk_bf16_f32 v81, v242, v243
v_mfma_f32_16x16x32_bf16 a[4:7], a[172:175], a[228:231], a[4:7]
s_add_u32 s37, s31, 163840
v_cvt_pk_bf16_f32 v84, v244, v245
v_cvt_pk_bf16_f32 v85, v246, v247
v_mfma_f32_16x16x32_bf16 a[8:11], a[172:175], a[232:235], a[8:11]
s_add_u32 m0, s33, 5120
v_cvt_pk_bf16_f32 v88, v248, v249
v_cvt_pk_bf16_f32 v89, v250, v251
v_mfma_f32_16x16x32_bf16 a[12:15], a[172:175], a[236:239], a[12:15]
buffer_load_dwordx4 v2, s[20:23], s37 offen  lds
v_cvt_pk_bf16_f32 v92, v252, v253
v_cvt_pk_bf16_f32 v93, v254, v255
v_mfma_f32_16x16x32_bf16 a[16:19], a[172:175], a[240:243], a[16:19]
v_accvgpr_read_b32 v20, a0
v_accvgpr_read_b32 v21, a1
v_accvgpr_read_b32 v22, a2
v_accvgpr_read_b32 v23, a3
v_mfma_f32_16x16x32_bf16 a[20:23], a[172:175], a[244:247], a[20:23]
v_cvt_pk_bf16_f32 v66, v20, v21
v_cvt_pk_bf16_f32 v67, v22, v23
v_accvgpr_read_b32 v24, a4
v_accvgpr_read_b32 v25, a5
v_mfma_f32_16x16x32_bf16 a[24:27], a[172:175], a[248:251], a[24:27]
v_accvgpr_read_b32 v26, a6
v_accvgpr_read_b32 v27, a7
v_cvt_pk_bf16_f32 v70, v24, v25
v_cvt_pk_bf16_f32 v71, v26, v27
v_mfma_f32_16x16x32_bf16 a[28:31], a[172:175], a[252:255], a[28:31]
ds_read_b64_tr_b16 a[172:173], v8 offset:0
v_accvgpr_read_b32 v20, a8
v_accvgpr_read_b32 v21, a9
v_accvgpr_read_b32 v22, a10
v_mfma_f32_16x16x32_bf16 a[32:35], a[176:179], a[224:227], a[32:35]
ds_read_b64_tr_b16 a[174:175], v8 offset:1024
s_add_u32 s31, s31, 262144
v_accvgpr_read_b32 v23, a11
v_cvt_pk_bf16_f32 v74, v20, v21
v_mfma_f32_16x16x32_bf16 a[36:39], a[176:179], a[228:231], a[36:39]
s_mov_b32 s48, s30
s_add_u32 s33, s33, 16384
v_cvt_pk_bf16_f32 v75, v22, v23
v_accvgpr_read_b32 v24, a12
v_mfma_f32_16x16x32_bf16 a[40:43], a[176:179], a[232:235], a[40:43]
s_add_u32 m0, s32, 0
s_and_b32 s33, s33, 65535
v_accvgpr_read_b32 v25, a13
v_accvgpr_read_b32 v26, a14
v_mfma_f32_16x16x32_bf16 a[44:47], a[176:179], a[236:239], a[44:47]
buffer_load_dwordx4 v1, s[12:15], s48 offen lds
v_mov_b32 v16, 0
v_accvgpr_read_b32 v27, a15
v_cvt_pk_bf16_f32 v78, v24, v25
v_mfma_f32_16x16x32_bf16 a[48:51], a[176:179], a[240:243], a[48:51]
v_mov_b32 v17, 1
v_cvt_pk_bf16_f32 v79, v26, v27
v_accvgpr_read_b32 v20, a16
v_accvgpr_read_b32 v21, a17
v_mfma_f32_16x16x32_bf16 a[52:55], a[176:179], a[244:247], a[52:55]
s_cmp_eq_u32 s17, 0
s_cselect_b32 s29, s39, 536870912
v_accvgpr_read_b32 v22, a18
v_accvgpr_read_b32 v23, a19
v_mfma_f32_16x16x32_bf16 a[56:59], a[176:179], a[248:251], a[56:59]
s_mov_b64 exec, 1
buffer_store_dword v17, v16, s[8:11], s29 offen sc1
s_mov_b64 exec, -1
v_cvt_pk_bf16_f32 v82, v20, v21
v_mfma_f32_16x16x32_bf16 a[60:63], a[176:179], a[252:255], a[60:63]
ds_read_b64_tr_b16 a[176:177], v9 offset:0
v_cvt_pk_bf16_f32 v83, v22, v23
v_accvgpr_read_b32 v24, a20
v_accvgpr_read_b32 v25, a21
v_mfma_f32_16x16x32_bf16 a[64:67], a[180:183], a[224:227], a[64:67]
ds_read_b64_tr_b16 a[178:179], v9 offset:1024
v_accvgpr_read_b32 v26, a22
v_accvgpr_read_b32 v27, a23
v_cvt_pk_bf16_f32 v86, v24, v25
v_mfma_f32_16x16x32_bf16 a[68:71], a[180:183], a[228:231], a[68:71]
s_add_u32 s48, s48, s34
v_cvt_pk_bf16_f32 v87, v26, v27
v_accvgpr_read_b32 v20, a24
v_accvgpr_read_b32 v21, a25
v_mfma_f32_16x16x32_bf16 a[72:75], a[180:183], a[232:235], a[72:75]
s_add_u32 m0, s32, 4096
v_accvgpr_read_b32 v22, a26
v_accvgpr_read_b32 v23, a27
v_cvt_pk_bf16_f32 v90, v20, v21
v_mfma_f32_16x16x32_bf16 a[76:79], a[180:183], a[236:239], a[76:79]
buffer_load_dwordx4 v1, s[12:15], s48 offen lds
v_cvt_pk_bf16_f32 v91, v22, v23
v_accvgpr_read_b32 v24, a28
v_accvgpr_read_b32 v25, a29
v_mfma_f32_16x16x32_bf16 a[80:83], a[180:183], a[240:243], a[80:83]
v_accvgpr_read_b32 v26, a30
v_accvgpr_read_b32 v27, a31
v_cvt_pk_bf16_f32 v94, v24, v25
v_cvt_pk_bf16_f32 v95, v26, v27
v_mfma_f32_16x16x32_bf16 a[84:87], a[180:183], a[244:247], a[84:87]
v_accvgpr_read_b32 v20, a32
v_accvgpr_read_b32 v21, a33
v_accvgpr_read_b32 v22, a34
v_accvgpr_read_b32 v23, a35
v_mfma_f32_16x16x32_bf16 a[88:91], a[180:183], a[248:251], a[88:91]
buffer_load_dword v15, v14, s[96:99], s100 offen
s_add_u32 s100, s100, 8192
v_cvt_pk_bf16_f32 v96, v20, v21
v_cvt_pk_bf16_f32 v97, v22, v23
v_mfma_f32_16x16x32_bf16 a[92:95], a[180:183], a[252:255], a[92:95]
ds_read_b64_tr_b16 a[180:181], v10 offset:0
v_accvgpr_read_b32 v24, a36
v_accvgpr_read_b32 v25, a37
v_accvgpr_read_b32 v26, a38
v_mfma_f32_16x16x32_bf16 a[96:99], a[184:187], a[224:227], a[96:99]
ds_read_b64_tr_b16 a[182:183], v10 offset:1024
v_accvgpr_read_b32 v27, a39
v_cvt_pk_bf16_f32 v100, v24, v25
v_cvt_pk_bf16_f32 v101, v26, v27
v_mfma_f32_16x16x32_bf16 a[100:103], a[184:187], a[228:231], a[100:103]
s_add_u32 s48, s48, s34
v_accvgpr_read_b32 v20, a40
v_accvgpr_read_b32 v21, a41
v_accvgpr_read_b32 v22, a42
v_mfma_f32_16x16x32_bf16 a[104:107], a[184:187], a[232:235], a[104:107]
s_add_u32 m0, s32, 8192
v_accvgpr_read_b32 v23, a43
v_cvt_pk_bf16_f32 v104, v20, v21
v_cvt_pk_bf16_f32 v105, v22, v23
v_mfma_f32_16x16x32_bf16 a[108:111], a[184:187], a[236:239], a[108:111]
buffer_load_dwordx4 v1, s[12:15], s48 offen lds
v_accvgpr_read_b32 v24, a44
v_accvgpr_read_b32 v25, a45
v_accvgpr_read_b32 v26, a46
v_mfma_f32_16x16x32_bf16 a[112:115], a[184:187], a[240:243], a[112:115]
v_accvgpr_read_b32 v27, a47
v_cvt_pk_bf16_f32 v108, v24, v25
v_cvt_pk_bf16_f32 v109, v26, v27
v_accvgpr_read_b32 v20, a48
v_mfma_f32_16x16x32_bf16 a[116:119], a[184:187], a[244:247], a[116:119]
v_accvgpr_read_b32 v21, a49
v_accvgpr_read_b32 v22, a50
v_accvgpr_read_b32 v23, a51
v_cvt_pk_bf16_f32 v112, v20, v21
v_mfma_f32_16x16x32_bf16 a[120:123], a[184:187], a[248:251], a[120:123]
v_cvt_pk_bf16_f32 v113, v22, v23
v_accvgpr_read_b32 v24, a52
v_accvgpr_read_b32 v25, a53
v_accvgpr_read_b32 v26, a54
v_mfma_f32_16x16x32_bf16 a[124:127], a[184:187], a[252:255], a[124:127]
ds_read_b64_tr_b16 a[184:185], v11 offset:0
v_accvgpr_read_b32 v27, a55
v_cvt_pk_bf16_f32 v116, v24, v25
v_cvt_pk_bf16_f32 v117, v26, v27
v_mfma_f32_16x16x32_bf16 a[128:131], v[28:31], a[224:227], a[128:131]
ds_read_b64_tr_b16 a[186:187], v11 offset:1024
v_accvgpr_read_b32 v20, a56
v_accvgpr_read_b32 v21, a57
v_accvgpr_read_b32 v22, a58
v_mfma_f32_16x16x32_bf16 a[132:135], v[28:31], a[228:231], a[132:135]
s_add_u32 s48, s48, s34
v_add_u32 v5, 16384, v5
v_and_b32 v5, 65535, v5
v_accvgpr_read_b32 v23, a59
v_mfma_f32_16x16x32_bf16 a[136:139], v[28:31], a[232:235], a[136:139]
s_add_u32 m0, s32, 12288
v_xor_b32 v6, 16, v5
v_xor_b32 v7, 64, v5
v_cvt_pk_bf16_f32 v120, v20, v21
v_mfma_f32_16x16x32_bf16 a[140:143], v[28:31], a[236:239], a[140:143]
buffer_load_dwordx4 v1, s[12:15], s48 offen lds
v_xor_b32 v8, 80, v5
v_xor_b32 v9, 128, v5
v_cvt_pk_bf16_f32 v121, v22, v23
v_mfma_f32_16x16x32_bf16 a[144:147], v[28:31], a[240:243], a[144:147]
v_xor_b32 v10, 144, v5
v_xor_b32 v11, 192, v5
v_xor_b32 v12, 208, v5
v_accvgpr_read_b32 v24, a60
v_mfma_f32_16x16x32_bf16 a[148:151], v[28:31], a[244:247], a[148:151]
v_accvgpr_read_b32 v25, a61
v_accvgpr_read_b32 v26, a62
v_accvgpr_read_b32 v27, a63
v_cvt_pk_bf16_f32 v124, v24, v25
v_mfma_f32_16x16x32_bf16 a[152:155], v[28:31], a[248:251], a[152:155]
v_cvt_pk_bf16_f32 v125, v26, v27
v_mfma_f32_16x16x32_bf16 a[156:159], v[28:31], a[252:255], a[156:159]
s_cmp_lt_u32 s35, s45
s_cbranch_scc1 L_g_tile
s_branch L_g_end
L_g_k17v:
s_waitcnt vmcnt(18) lgkmcnt(0)
s_barrier
v_mfma_f32_16x16x32_bf16 v[160:163], a[160:163], a[224:227], v[160:163]
ds_read_b64_tr_b16 a[192:193], v5 offset:0
v_mfma_f32_16x16x32_bf16 v[164:167], a[160:163], a[228:231], v[164:167]
s_add_u32 s37, s31, 0
v_mfma_f32_16x16x32_bf16 v[168:171], a[160:163], a[232:235], v[168:171]
s_add_u32 m0, s33, 0
ds_read_b64_tr_b16 a[194:195], v5 offset:1024
v_mfma_f32_16x16x32_bf16 v[172:175], a[160:163], a[236:239], v[172:175]
buffer_load_dwordx4 v2, s[20:23], s37 offen  lds
v_mfma_f32_16x16x32_bf16 v[176:179], a[160:163], a[240:243], v[176:179]
ds_read_b64_tr_b16 a[196:197], v6 offset:0
v_cvt_pk_bf16_f32 v32, v160, v161
v_cvt_pk_bf16_f32 v33, v162, v163
v_mfma_f32_16x16x32_bf16 v[180:183], a[160:163], a[244:247], v[180:183]
v_cvt_pk_bf16_f32 v36, v164, v165
v_cvt_pk_bf16_f32 v37, v166, v167
v_mfma_f32_16x16x32_bf16 v[184:187], a[160:163], a[248:251], v[184:187]
ds_read_b64_tr_b16 a[198:199], v6 offset:1024
v_cvt_pk_bf16_f32 v40, v168, v169
v_cvt_pk_bf16_f32 v41, v170, v171
v_mfma_f32_16x16x32_bf16 v[188:191], a[160:163], a[252:255], v[188:191]
ds_read_b128 a[160:163], v3 offset:0
v_cvt_pk_bf16_f32 v44, v172, v173
v_cvt_pk_bf16_f32 v45, v174, v175
v_mfma_f32_16x16x32_bf16 v[192:195], a[164:167], a[224:227], v[192:195]
ds_read_b64_tr_b16 a[200:201], v7 offset:0
v_cvt_pk_bf16_f32 v48, v176, v177
v_cvt_pk_bf16_f32 v49, v178, v179
v_mfma_f32_16x16x32_bf16 v[196:199], a[164:167], a[228:231], v[196:199]
s_add_u32 s37, s31, 32768
v_cvt_pk_bf16_f32 v52, v180, v181
v_cvt_pk_bf16_f32 v53, v182, v183
v_mfma_f32_16x16x32_bf16 v[200:203], a[164:167], a[232:235], v[200:203]
s_add_u32 m0, s33, 1024
ds_read_b64_tr_b16 a[202:203], v7 offset:1024
v_cvt_pk_bf16_f32 v56, v184, v185
v_cvt_pk_bf16_f32 v57, v186, v187
v_mfma_f32_16x16x32_bf16 v[204:207], a[164:167], a[236:239], v[204:207]
buffer_load_dwordx4 v2, s[20:23], s37 offen  lds
v_cvt_pk_bf16_f32 v60, v188, v189
v_cvt_pk_bf16_f32 v61, v190, v191
v_mfma_f32_16x16x32_bf16 v[208:211], a[164:167], a[240:243], v[208:211]
ds_read_b64_tr_b16 a[204:205], v8 offset:0
v_cvt_pk_bf16_f32 v34, v192, v193
v_cvt_pk_bf16_f32 v35, v194, v195
v_mfma_f32_16x16x32_bf16 v[212:215], a[164:167], a[244:247], v[212:215]
v_cvt_pk_bf16_f32 v38, v196, v197
v_cvt_pk_bf16_f32 v39, v198, v199
v_mfma_f32_16x16x32_bf16 v[216:219], a[164:167], a[248:251], v[216:219]
ds_read_b64_tr_b16 a[206:207], v8 offset:1024
v_cvt_pk_bf16_f32 v42, v200, v201
v_cvt_pk_bf16_f32 v43, v202, v203
v_mfma_f32_16x16x32_bf16 v[220:223], a[164:167], a[252:255], v[220:223]
ds_read_b128 a[164:167], v4 offset:1024
v_cvt_pk_bf16_f32 v46, v204, v205
v_cvt_pk_bf16_f32 v47, v206, v207
v_mfma_f32_16x16x32_bf16 v[224:227], a[168:171], a[224:227], v[224:227]
ds_read_b64_tr_b16 a[208:209], v9 offset:0
v_cvt_pk_bf16_f32 v50, v208, v209
v_cvt_pk_bf16_f32 v51, v210, v211
v_mfma_f32_16x16x32_bf16 v[228:231], a[168:171], a[228:231], v[228:231]
s_add_u32 s37, s31, 131072
v_cvt_pk_bf16_f32 v54, v212, v213
v_cvt_pk_bf16_f32 v55, v214, v215
v_mfma_f32_16x16x32_bf16 v[232:235], a[168:171], a[232:235], v[232:235]
s_add_u32 m0, s33, 4096
ds_read_b64_tr_b16 a[210:211], v9 offset:1024
v_cvt_pk_bf16_f32 v58, v216, v217
v_cvt_pk_bf16_f32 v59, v218, v219
v_mfma_f32_16x16x32_bf16 v[236:239], a[168:171], a[236:239], v[236:239]
buffer_load_dwordx4 v2, s[20:23], s37 offen  lds
v_cvt_pk_bf16_f32 v62, v220, v221
v_cvt_pk_bf16_f32 v63, v222, v223
v_mfma_f32_16x16x32_bf16 v[240:243], a[168:171], a[240:243], v[240:243]
ds_read_b64_tr_b16 a[212:213], v10 offset:0
v_cvt_pk_bf16_f32 v64, v224, v225
v_cvt_pk_bf16_f32 v65, v226, v227
v_mfma_f32_16x16x32_bf16 v[244:247], a[168:171], a[244:247], v[244:247]
v_cvt_pk_bf16_f32 v68, v228, v229
v_cvt_pk_bf16_f32 v69, v230, v231
v_mfma_f32_16x16x32_bf16 v[248:251], a[168:171], a[248:251], v[248:251]
ds_read_b64_tr_b16 a[214:215], v10 offset:1024
v_cvt_pk_bf16_f32 v72, v232, v233
v_cvt_pk_bf16_f32 v73, v234, v235
v_mfma_f32_16x16x32_bf16 v[252:255], a[168:171], a[252:255], v[252:255]
ds_read_b128 a[168:171], v3 offset:4096
v_cvt_pk_bf16_f32 v76, v236, v237
v_cvt_pk_bf16_f32 v77, v238, v239
v_mfma_f32_16x16x32_bf16 a[0:3], a[172:175], a[224:227], a[0:3]
ds_read_b64_tr_b16 a[216:217], v11 offset:0
v_cvt_pk_bf16_f32 v80, v240, v241
v_cvt_pk_bf16_f32 v81, v242, v243
v_mfma_f32_16x16x32_bf16 a[4:7], a[172:175], a[228:231], a[4:7]
s_add_u32 s37, s31, 163840
v_cvt_pk_bf16_f32 v84, v244, v245
v_cvt_pk_bf16_f32 v85, v246, v247
v_mfma_f32_16x16x32_bf16 a[8:11], a[172:175], a[232:235], a[8:11]
s_add_u32 m0, s33, 5120
ds_read_b64_tr_b16 a[218:219], v11 offset:1024
v_cvt_pk_bf16_f32 v88, v248, v249
v_cvt_pk_bf16_f32 v89, v250, v251
v_mfma_f32_16x16x32_bf16 a[12:15], a[172:175], a[236:239], a[12:15]
buffer_load_dwordx4 v2, s[20:23], s37 offen  lds
v_cvt_pk_bf16_f32 v92, v252, v253
v_cvt_pk_bf16_f32 v93, v254, v255
v_mfma_f32_16x16x32_bf16 a[16:19], a[172:175], a[240:243], a[16:19]
ds_read_b64_tr_b16 a[220:221], v12 offset:0
v_accvgpr_read_b32 v20, a0
v_accvgpr_read_b32 v21, a1
v_accvgpr_read_b32 v22, a2
v_mfma_f32_16x16x32_bf16 a[20:23], a[172:175], a[244:247], a[20:23]
v_accvgpr_read_b32 v23, a3
v_cvt_pk_bf16_f32 v66, v20, v21
v_cvt_pk_bf16_f32 v67, v22, v23
v_accvgpr_read_b32 v24, a4
v_mfma_f32_16x16x32_bf16 a[24:27], a[172:175], a[248:251], a[24:27]
ds_read_b64_tr_b16 a[222:223], v12 offset:1024
v_accvgpr_read_b32 v25, a5
v_accvgpr_read_b32 v26, a6
v_accvgpr_read_b32 v27, a7
v_mfma_f32_16x16x32_bf16 a[28:31], a[172:175], a[252:255], a[28:31]
ds_read_b128 a[172:175], v4 offset:5120
v_cvt_pk_bf16_f32 v70, v24, v25
v_cvt_pk_bf16_f32 v71, v26, v27
v_accvgpr_read_b32 v20, a8
v_mfma_f32_16x16x32_bf16 a[32:35], a[176:179], a[224:227], a[32:35]
s_add_u32 s31, s31, 262144
s_add_u32 s33, s33, 16384
v_accvgpr_read_b32 v21, a9
v_accvgpr_read_b32 v22, a10
v_mfma_f32_16x16x32_bf16 a[36:39], a[176:179], a[228:231], a[36:39]
s_mov_b32 s48, s30
s_and_b32 s33, s33, 65535
v_accvgpr_read_b32 v23, a11
v_cvt_pk_bf16_f32 v74, v20, v21
v_mfma_f32_16x16x32_bf16 a[40:43], a[176:179], a[232:235], a[40:43]
s_add_u32 m0, s32, 0
ds_read_b128 a[188:191], v4 offset:13312
v_cvt_pk_bf16_f32 v75, v22, v23
v_accvgpr_read_b32 v24, a12
v_mfma_f32_16x16x32_bf16 a[44:47], a[176:179], a[236:239], a[44:47]
buffer_load_dwordx4 v1, s[12:15], s48 offen lds
v_mov_b32 v16, 0
v_accvgpr_read_b32 v25, a13
v_accvgpr_read_b32 v26, a14
v_mfma_f32_16x16x32_bf16 a[48:51], a[176:179], a[240:243], a[48:51]
v_mov_b32 v17, 1
v_accvgpr_read_b32 v27, a15
v_cvt_pk_bf16_f32 v78, v24, v25
v_cvt_pk_bf16_f32 v79, v26, v27
v_mfma_f32_16x16x32_bf16 a[52:55], a[176:179], a[244:247], a[52:55]
s_cmp_eq_u32 s17, 0
s_cselect_b32 s29, s39, 536870912
v_accvgpr_read_b32 v20, a16
v_accvgpr_read_b32 v21, a17
v_mfma_f32_16x16x32_bf16 a[56:59], a[176:179], a[248:251], a[56:59]
s_mov_b64 exec, 1
buffer_store_dword v17, v16, s[8:11], s29 offen sc1
s_mov_b64 exec, -1
v_accvgpr_read_b32 v22, a18
v_mfma_f32_16x16x32_bf16 a[60:63], a[176:179], a[252:255], a[60:63]
ds_read_b128 a[176:179], v3 offset:8192
v_accvgpr_read_b32 v23, a19
v_cvt_pk_bf16_f32 v82, v20, v21
v_cvt_pk_bf16_f32 v83, v22, v23
v_mfma_f32_16x16x32_bf16 a[64:67], a[180:183], a[224:227], a[64:67]
v_accvgpr_read_b32 v24, a20
v_accvgpr_read_b32 v25, a21
v_accvgpr_read_b32 v26, a22
v_accvgpr_read_b32 v27, a23
v_mfma_f32_16x16x32_bf16 a[68:71], a[180:183], a[228:231], a[68:71]
s_add_u32 s48, s48, s34
v_cvt_pk_bf16_f32 v86, v24, v25
v_cvt_pk_bf16_f32 v87, v26, v27
v_accvgpr_read_b32 v20, a24
v_mfma_f32_16x16x32_bf16 a[72:75], a[180:183], a[232:235], a[72:75]
s_add_u32 m0, s32, 4096
v_accvgpr_read_b32 v21, a25
v_accvgpr_read_b32 v22, a26
v_accvgpr_read_b32 v23, a27
v_mfma_f32_16x16x32_bf16 a[76:79], a[180:183], a[236:239], a[76:79]
buffer_load_dwordx4 v1, s[12:15], s48 offen lds
v_cvt_pk_bf16_f32 v90, v20, v21
v_cvt_pk_bf16_f32 v91, v22, v23
v_accvgpr_read_b32 v24, a28
v_mfma_f32_16x16x32_bf16 a[80:83], a[180:183], a[240:243], a[80:83]
v_accvgpr_read_b32 v25, a29
v_accvgpr_read_b32 v26, a30
v_accvgpr_read_b32 v27, a31
v_cvt_pk_bf16_f32 v94, v24, v25
v_mfma_f32_16x16x32_bf16 a[84:87], a[180:183], a[244:247], a[84:87]
v_cvt_pk_bf16_f32 v95, v26, v27
v_accvgpr_read_b32 v20, a32
v_accvgpr_read_b32 v21, a33
v_accvgpr_read_b32 v22, a34
v_mfma_f32_16x16x32_bf16 a[88:91], a[180:183], a[248:251], a[88:91]
buffer_load_dword v15, v14, s[96:99], s100 offen
s_add_u32 s100, s100, 8192
v_accvgpr_read_b32 v23, a35
v_cvt_pk_bf16_f32 v96, v20, v21
v_mfma_f32_16x16x32_bf16 a[92:95], a[180:183], a[252:255], a[92:95]
ds_read_b128 a[180:183], v4 offset:9216
v_cvt_pk_bf16_f32 v97, v22, v23
v_accvgpr_read_b32 v24, a36
v_accvgpr_read_b32 v25, a37
v_mfma_f32_16x16x32_bf16 a[96:99], a[184:187], a[224:227], a[96:99]
v_accvgpr_read_b32 v26, a38
v_accvgpr_read_b32 v27, a39
v_cvt_pk_bf16_f32 v100, v24, v25
v_cvt_pk_bf16_f32 v101, v26, v27
v_mfma_f32_16x16x32_bf16 a[100:103], a[184:187], a[228:231], a[100:103]
s_add_u32 s48, s48, s34
v_accvgpr_read_b32 v20, a40
v_accvgpr_read_b32 v21, a41
v_accvgpr_read_b32 v22, a42
v_mfma_f32_16x16x32_bf16 a[104:107], a[184:187], a[232:235], a[104:107]
s_add_u32 m0, s32, 8192
v_accvgpr_read_b32 v23, a43
v_cvt_pk_bf16_f32 v104, v20, v21
v_cvt_pk_bf16_f32 v105, v22, v23
v_mfma_f32_16x16x32_bf16 a[108:111], a[184:187], a[236:239], a[108:111]
buffer_load_dwordx4 v1, s[12:15], s48 offen lds
v_accvgpr_read_b32 v24, a44
v_accvgpr_read_b32 v25, a45
v_accvgpr_read_b32 v26, a46
v_mfma_f32_16x16x32_bf16 a[112:115], a[184:187], a[240:243], a[112:115]
v_accvgpr_read_b32 v27, a47
v_cvt_pk_bf16_f32 v108, v24, v25
v_cvt_pk_bf16_f32 v109, v26, v27
v_accvgpr_read_b32 v20, a48
v_mfma_f32_16x16x32_bf16 a[116:119], a[184:187], a[244:247], a[116:119]
v_accvgpr_read_b32 v21, a49
v_accvgpr_read_b32 v22, a50
v_accvgpr_read_b32 v23, a51
v_cvt_pk_bf16_f32 v112, v20, v21
v_mfma_f32_16x16x32_bf16 a[120:123], a[184:187], a[248:251], a[120:123]
v_cvt_pk_bf16_f32 v113, v22, v23
v_accvgpr_read_b32 v24, a52
v_accvgpr_read_b32 v25, a53
v_accvgpr_read_b32 v26, a54
v_mfma_f32_16x16x32_bf16 a[124:127], a[184:187], a[252:255], a[124:127]
ds_read_b128 a[184:187], v3 offset:12288
v_accvgpr_read_b32 v27, a55
v_cvt_pk_bf16_f32 v116, v24, v25
v_cvt_pk_bf16_f32 v117, v26, v27
v_mfma_f32_16x16x32_bf16 a[128:131], v[28:31], a[224:227], a[128:131]
v_accvgpr_read_b32 v20, a56
v_accvgpr_read_b32 v21, a57
v_accvgpr_read_b32 v22, a58
v_accvgpr_read_b32 v23, a59
v_mfma_f32_16x16x32_bf16 a[132:135], v[28:31], a[228:231], a[132:135]
s_add_u32 s48, s48, s34
v_add_u32 v5, 16384, v5
v_and_b32 v5, 65535, v5
v_cvt_pk_bf16_f32 v120, v20, v21
v_mfma_f32_16x16x32_bf16 a[136:139], v[28:31], a[232:235], a[136:139]
s_add_u32 m0, s32, 12288
v_xor_b32 v6, 16, v5
v_xor_b32 v7, 64, v5
v_cvt_pk_bf16_f32 v121, v22, v23
v_mfma_f32_16x16x32_bf16 a[140:143], v[28:31], a[236:239], a[140:143]
buffer_load_dwordx4 v1, s[12:15], s48 offen lds
v_xor_b32 v8, 80, v5
v_xor_b32 v9, 128, v5
v_accvgpr_read_b32 v24, a60
v_mfma_f32_16x16x32_bf16 a[144:147], v[28:31], a[240:243], a[144:147]
v_xor_b32 v10, 144, v5
v_xor_b32 v11, 192, v5
v_xor_b32 v12, 208, v5
v_accvgpr_read_b32 v25, a61
v_mfma_f32_16x16x32_bf16 a[148:151], v[28:31], a[244:247], a[148:151]
v_accvgpr_read_b32 v26, a62
v_accvgpr_read_b32 v27, a63
v_cvt_pk_bf16_f32 v124, v24, v25
v_cvt_pk_bf16_f32 v125, v26, v27
v_mfma_f32_16x16x32_bf16 a[152:155], v[28:31], a[248:251], a[152:155]
v_mfma_f32_16x16x32_bf16 a[156:159], v[28:31], a[252:255], a[156:159]
s_cmp_lt_u32 s35, s45
s_cbranch_scc1 L_g_tile
s_branch L_g_end
.p2align 3
L_g_v:
s_waitcnt vmcnt(16) lgkmcnt(0)
s_barrier
v_mfma_f32_16x16x32_bf16 v[160:163], a[160:163], a[192:195], 0
ds_read_b64_tr_b16 a[224:225], v5 offset:0
v_accvgpr_read_b32 v20, a64
v_accvgpr_read_b32 v21, a65
v_accvgpr_read_b32 v22, a66
v_mfma_f32_16x16x32_bf16 v[164:167], a[160:163], a[196:199], 0
v_accvgpr_read_b32 v23, a67
v_cvt_pk_bf16_f32 v98, v20, v21
v_cvt_pk_bf16_f32 v99, v22, v23
v_accvgpr_read_b32 v24, a68
v_mfma_f32_16x16x32_bf16 v[168:171], a[160:163], a[200:203], 0
ds_read_b64_tr_b16 a[226:227], v5 offset:1024
v_accvgpr_read_b32 v25, a69
v_accvgpr_read_b32 v26, a70
v_accvgpr_read_b32 v27, a71
v_mfma_f32_16x16x32_bf16 v[172:175], a[160:163], a[204:207], 0
s_add_u32 s37, s31, 0
v_cvt_pk_bf16_f32 v102, v24, v25
v_cvt_pk_bf16_f32 v103, v26, v27
v_accvgpr_read_b32 v20, a72
v_mfma_f32_16x16x32_bf16 v[176:179], a[160:163], a[208:211], 0
s_add_u32 m0, s33, 0
ds_read_b64_tr_b16 a[228:229], v6 offset:0
v_accvgpr_read_b32 v21, a73
v_accvgpr_read_b32 v22, a74
v_mfma_f32_16x16x32_bf16 v[180:183], a[160:163], a[212:215], 0
buffer_load_dwordx4 v2, s[20:23], s37 offen  lds
v_accvgpr_read_b32 v23, a75
v_cvt_pk_bf16_f32 v106, v20, v21
v_cvt_pk_bf16_f32 v107, v22, v23
v_mfma_f32_16x16x32_bf16 v[184:187], a[160:163], a[216:219], 0
ds_read_b64_tr_b16 a[230:231], v6 offset:1024
v_accvgpr_read_b32 v24, a76
v_accvgpr_read_b32 v25, a77
v_accvgpr_read_b32 v26, a78
v_mfma_f32_16x16x32_bf16 v[188:191], a[160:163], a[220:223], 0
ds_read_b128 a[160:163], v4 offset:0
v_accvgpr_read_b32 v27, a79
v_cvt_pk_bf16_f32 v110, v24, v25
v_cvt_pk_bf16_f32 v111, v26, v27
v_mfma_f32_16x16x32_bf16 v[192:195], a[164:167], a[192:195], 0
ds_read_b64_tr_b16 a[232:233], v7 offset:0
v_accvgpr_read_b32 v20, a80
v_accvgpr_read_b32 v21, a81
v_accvgpr_read_b32 v22, a82
v_mfma_f32_16x16x32_bf16 v[196:199], a[164:167], a[196:199], 0
v_accvgpr_read_b32 v23, a83
v_cvt_pk_bf16_f32 v114, v20, v21
v_cvt_pk_bf16_f32 v115, v22, v23
v_accvgpr_read_b32 v24, a84
v_mfma_f32_16x16x32_bf16 v[200:203], a[164:167], a[200:203], 0
ds_read_b64_tr_b16 a[234:235], v7 offset:1024
v_accvgpr_read_b32 v25, a85
v_accvgpr_read_b32 v26, a86
v_accvgpr_read_b32 v27, a87
v_mfma_f32_16x16x32_bf16 v[204:207], a[164:167], a[204:207], 0
s_add_u32 s37, s31, 32768
v_cvt_pk_bf16_f32 v118, v24, v25
v_cvt_pk_bf16_f32 v119, v26, v27
v_accvgpr_read_b32 v20, a88
v_mfma_f32_16x16x32_bf16 v[208:211], a[164:167], a[208:211], 0
s_add_u32 m0, s33, 1024
ds_read_b64_tr_b16 a[236:237], v8 offset:0
v_accvgpr_read_b32 v21, a89
v_accvgpr_read_b32 v22, a90
v_mfma_f32_16x16x32_bf16 v[212:215], a[164:167], a[212:215], 0
buffer_load_dwordx4 v2, s[20:23], s37 offen  lds
v_accvgpr_read_b32 v23, a91
v_cvt_pk_bf16_f32 v122, v20, v21
v_cvt_pk_bf16_f32 v123, v22, v23
v_mfma_f32_16x16x32_bf16 v[216:219], a[164:167], a[216:219], 0
ds_read_b64_tr_b16 a[238:239], v8 offset:1024
v_accvgpr_read_b32 v24, a92
v_accvgpr_read_b32 v25, a93
v_accvgpr_read_b32 v26, a94
v_mfma_f32_16x16x32_bf16 v[220:223], a[164:167], a[220:223], 0
ds_read_b128 a[164:167], v3 offset:1024
v_accvgpr_read_b32 v27, a95
v_cvt_pk_bf16_f32 v126, v24, v25
v_cvt_pk_bf16_f32 v127, v26, v27
v_mfma_f32_16x16x32_bf16 v[224:227], a[168:171], a[192:195], 0
ds_read_b64_tr_b16 a[240:241], v9 offset:0
v_accvgpr_read_b32 v20, a96
v_accvgpr_read_b32 v21, a97
v_accvgpr_read_b32 v22, a98
v_mfma_f32_16x16x32_bf16 v[228:231], a[168:171], a[196:199], 0
v_accvgpr_read_b32 v23, a99
v_cvt_pk_bf16_f32 v128, v20, v21
v_cvt_pk_bf16_f32 v129, v22, v23
v_accvgpr_read_b32 v24, a100
v_mfma_f32_16x16x32_bf16 v[232:235], a[168:171], a[200:203], 0
ds_read_b64_tr_b16 a[242:243], v9 offset:1024
v_accvgpr_read_b32 v25, a101
v_accvgpr_read_b32 v26, a102
v_accvgpr_read_b32 v27, a103
v_mfma_f32_16x16x32_bf16 v[236:239], a[168:171], a[204:207], 0
s_add_u32 s37, s31, 131072
v_cvt_pk_bf16_f32 v132, v24, v25
v_cvt_pk_bf16_f32 v133, v26, v27
v_accvgpr_read_b32 v20, a104
v_mfma_f32_16x16x32_bf16 v[240:243], a[168:171], a[208:211], 0
s_add_u32 m0, s33, 4096
ds_read_b64_tr_b16 a[244:245], v10 offset:0
v_accvgpr_read_b32 v21, a105
v_accvgpr_read_b32 v22, a106
v_mfma_f32_16x16x32_bf16 v[244:247], a[168:171], a[212:215], 0
buffer_load_dwordx4 v2, s[20:23], s37 offen  lds
v_accvgpr_read_b32 v23, a107
v_cvt_pk_bf16_f32 v136, v20, v21
v_cvt_pk_bf16_f32 v137, v22, v23
v_mfma_f32_16x16x32_bf16 v[248:251], a[168:171], a[216:219], 0
ds_read_b64_tr_b16 a[246:247], v10 offset:1024
v_accvgpr_read_b32 v24, a108
v_accvgpr_read_b32 v25, a109
v_accvgpr_read_b32 v26, a110
v_mfma_f32_16x16x32_bf16 v[252:255], a[168:171], a[220:223], 0
ds_read_b128 a[168:171], v4 offset:4096
v_accvgpr_read_b32 v27, a111
v_cvt_pk_bf16_f32 v140, v24, v25
v_cvt_pk_bf16_f32 v141, v26, v27
v_mfma_f32_16x16x32_bf16 a[0:3], a[172:175], a[192:195], 0
ds_read_b64_tr_b16 a[248:249], v11 offset:0
v_accvgpr_read_b32 v20, a112
v_accvgpr_read_b32 v21, a113
v_accvgpr_read_b32 v22, a114
v_mfma_f32_16x16x32_bf16 a[4:7], a[172:175], a[196:199], 0
v_accvgpr_read_b32 v23, a115
v_cvt_pk_bf16_f32 v144, v20, v21
v_cvt_pk_bf16_f32 v145, v22, v23
v_accvgpr_read_b32 v24, a116
v_mfma_f32_16x16x32_bf16 a[8:11], a[172:175], a[200:203], 0
ds_read_b64_tr_b16 a[250:251], v11 offset:1024
v_accvgpr_read_b32 v25, a117
v_accvgpr_read_b32 v26, a118
v_accvgpr_read_b32 v27, a119
v_mfma_f32_16x16x32_bf16 a[12:15], a[172:175], a[204:207], 0
s_add_u32 s37, s31, 163840
v_cvt_pk_bf16_f32 v148, v24, v25
v_cvt_pk_bf16_f32 v149, v26, v27
v_accvgpr_read_b32 v20, a120
v_mfma_f32_16x16x32_bf16 a[16:19], a[172:175], a[208:211], 0
s_add_u32 m0, s33, 5120
ds_read_b64_tr_b16 a[252:253], v12 offset:0
v_accvgpr_read_b32 v21, a121
v_accvgpr_read_b32 v22, a122
v_mfma_f32_16x16x32_bf16 a[20:23], a[172:175], a[212:215], 0
buffer_load_dwordx4 v2, s[20:23], s37 offen  lds
v_accvgpr_read_b32 v23, a123
v_cvt_pk_bf16_f32 v152, v20, v21
v_cvt_pk_bf16_f32 v153, v22, v23
v_mfma_f32_16x16x32_bf16 a[24:27], a[172:175], a[216:219], 0
ds_read_b64_tr_b16 a[254:255], v12 offset:1024
v_accvgpr_read_b32 v24, a124
v_accvgpr_read_b32 v25, a125
v_accvgpr_read_b32 v26, a126
s_mov_b32 s38, s62
v_mfma_f32_16x16x32_bf16 a[28:31], a[172:175], a[220:223], 0
ds_read_b128 a[172:175], v3 offset:5120
v_accvgpr_read_b32 v27, a127
v_cvt_pk_bf16_f32 v156, v24, v25
v_cvt_pk_bf16_f32 v157, v26, v27
s_mov_b32 s39, s63
v_mfma_f32_16x16x32_bf16 a[32:35], a[176:179], a[192:195], 0
s_add_u32 s31, s31, 262144
s_add_u32 s33, s33, 16384
v_accvgpr_read_b32 v20, a128
v_accvgpr_read_b32 v21, a129
s_mov_b32 s49, s50
v_mfma_f32_16x16x32_bf16 a[36:39], a[176:179], a[196:199], 0
s_and_b32 s33, s33, 65535
ds_read_b128 v[28:31], v3 offset:13312
v_accvgpr_read_b32 v22, a130
v_accvgpr_read_b32 v23, a131
s_mov_b32 s62, s42
v_mfma_f32_16x16x32_bf16 a[40:43], a[176:179], a[200:203], 0
v_cvt_pk_bf16_f32 v130, v20, v21
v_cvt_pk_bf16_f32 v131, v22, v23
v_accvgpr_read_b32 v24, a132
v_accvgpr_read_b32 v25, a133
s_mov_b32 s63, s43
v_mfma_f32_16x16x32_bf16 a[44:47], a[176:179], a[204:207], 0
s_add_u32 s48, s48, s34
v_accvgpr_read_b32 v26, a134
v_accvgpr_read_b32 v27, a135
v_cvt_pk_bf16_f32 v134, v24, v25
s_mov_b32 s50, s51
v_mfma_f32_16x16x32_bf16 a[48:51], a[176:179], a[208:211], 0
s_add_u32 m0, s32, 16384
v_cvt_pk_bf16_f32 v135, v26, v27
v_accvgpr_read_b32 v20, a136
v_accvgpr_read_b32 v21, a137
s_mov_b32 s36, s40
v_mfma_f32_16x16x32_bf16 a[52:55], a[176:179], a[212:215], 0
buffer_load_dwordx4 v1, s[12:15], s48 offen lds
v_accvgpr_read_b32 v22, a138
v_accvgpr_read_b32 v23, a139
v_cvt_pk_bf16_f32 v138, v20, v21
s_add_u32 s35, s35, 1
v_mfma_f32_16x16x32_bf16 a[56:59], a[176:179], a[216:219], 0
v_cvt_pk_bf16_f32 v139, v22, v23
v_accvgpr_read_b32 v24, a140
v_accvgpr_read_b32 v25, a141
v_accvgpr_read_b32 v26, a142
v_bfe_u32 v16, v0, 3, 3
v_mfma_f32_16x16x32_bf16 a[60:63], a[176:179], a[220:223], 0
ds_read_b128 a[176:179], v4 offset:8192
v_accvgpr_read_b32 v27, a143
v_cvt_pk_bf16_f32 v142, v24, v25
v_cvt_pk_bf16_f32 v143, v26, v27
v_lshlrev_b32 v16, 4, v16
v_mfma_f32_16x16x32_bf16 a[64:67], a[180:183], a[192:195], 0
v_accvgpr_read_b32 v20, a144
v_accvgpr_read_b32 v21, a145
v_accvgpr_read_b32 v22, a146
v_accvgpr_read_b32 v23, a147
v_and_or_b32 v16, v0, 7, v16
v_mfma_f32_16x16x32_bf16 a[68:71], a[180:183], a[196:199], 0
v_cvt_pk_bf16_f32 v146, v20, v21
v_cvt_pk_bf16_f32 v147, v22, v23
v_accvgpr_read_b32 v24, a148
v_accvgpr_read_b32 v25, a149
v_bfe_u32 v17, v0, 4, 2
v_mfma_f32_16x16x32_bf16 a[72:75], a[180:183], a[200:203], 0
v_accvgpr_read_b32 v26, a150
v_accvgpr_read_b32 v27, a151
v_cvt_pk_bf16_f32 v150, v24, v25
v_cvt_pk_bf16_f32 v151, v26, v27
v_lshlrev_b32 v17, 5, v17
v_mfma_f32_16x16x32_bf16 a[76:79], a[180:183], a[204:207], 0
s_add_u32 s48, s48, s34
v_accvgpr_read_b32 v20, a152
v_accvgpr_read_b32 v21, a153
v_accvgpr_read_b32 v22, a154
v_and_or_b32 v17, v0, 8, v17
v_mfma_f32_16x16x32_bf16 a[80:83], a[180:183], a[208:211], 0
s_add_u32 m0, s32, 20480
v_accvgpr_read_b32 v23, a155
v_cvt_pk_bf16_f32 v154, v20, v21
v_cvt_pk_bf16_f32 v155, v22, v23
v_bfe_u32 v18, v0, 1, 2
v_mfma_f32_16x16x32_bf16 a[84:87], a[180:183], a[212:215], 0
buffer_load_dwordx4 v1, s[12:15], s48 offen lds
v_accvgpr_read_b32 v24, a156
v_accvgpr_read_b32 v25, a157
v_accvgpr_read_b32 v26, a158
v_or_b32 v17, v17, v18
v_mfma_f32_16x16x32_bf16 a[88:91], a[180:183], a[216:219], 0
v_accvgpr_read_b32 v27, a159
v_cvt_pk_bf16_f32 v158, v24, v25
v_cvt_pk_bf16_f32 v159, v26, v27
v_and_b32 v18, 1, v0
v_lshl_or_b32 v17, v18, 4, v17
v_mfma_f32_16x16x32_bf16 a[92:95], a[180:183], a[220:223], 0
ds_read_b128 a[180:183], v3 offset:9216
s_bitcmp1_b32 s49, 1
s_cselect_b64 vcc, -1, 0
s_cselect_b32 s44, 64, 0x80
v_cndmask_b32 v16, v16, v17, vcc
v_mfma_f32_16x16x32_bf16 a[96:99], a[184:187], a[192:195], 0
v_lshlrev_b32 v13, 4, v16
s_movk_i32 s92, 0x800
s_bitcmp1_b32 s49, 0
s_cselect_b32 s92, 0x4000, s92
s_xor_b32 s93, s92, 0x4800
v_mfma_f32_16x16x32_bf16 a[100:103], a[184:187], a[196:199], 0
s_sub_u32 s93, s93, s44
v_mfma_f32_16x16x32_bf16 a[104:107], a[184:187], a[200:203], 0
v_mfma_f32_16x16x32_bf16 a[108:111], a[184:187], a[204:207], 0
s_add_u32 s48, s48, s34
v_mfma_f32_16x16x32_bf16 a[112:115], a[184:187], a[208:211], 0
s_add_u32 m0, s32, 24576
v_mfma_f32_16x16x32_bf16 a[116:119], a[184:187], a[212:215], 0
buffer_load_dwordx4 v1, s[12:15], s48 offen lds
v_mfma_f32_16x16x32_bf16 a[120:123], a[184:187], a[216:219], 0
v_mfma_f32_16x16x32_bf16 a[124:127], a[184:187], a[220:223], 0
ds_read_b128 a[184:187], v4 offset:12288
v_mfma_f32_16x16x32_bf16 a[128:131], a[188:191], a[192:195], 0
v_mfma_f32_16x16x32_bf16 a[132:135], a[188:191], a[196:199], 0
v_add_u32 v3, 32768, v3
v_subrev_u32 v19, 98304, v3
v_cmp_le_u32 vcc, 163840, v3
v_mfma_f32_16x16x32_bf16 a[136:139], a[188:191], a[200:203], 0
v_add_u32 v5, 16384, v5
v_and_b32 v5, 65535, v5
v_xor_b32 v6, 16, v5
v_mfma_f32_16x16x32_bf16 a[140:143], a[188:191], a[204:207], 0
s_add_u32 s48, s48, s34
v_xor_b32 v7, 64, v5
v_xor_b32 v8, 80, v5
v_mfma_f32_16x16x32_bf16 a[144:147], a[188:191], a[208:211], 0
s_add_u32 m0, s32, 28672
v_xor_b32 v9, 128, v5
v_xor_b32 v10, 144, v5
v_mfma_f32_16x16x32_bf16 a[148:151], a[188:191], a[212:215], 0
buffer_load_dwordx4 v1, s[12:15], s48 offen lds
v_xor_b32 v11, 192, v5
v_xor_b32 v12, 208, v5
v_mfma_f32_16x16x32_bf16 a[152:155], a[188:191], a[216:219], 0
s_add_u32 s30, s30, 128
s_add_u32 s32, s32, 32768
s_sub_u32 s48, s32, 98304
v_mfma_f32_16x16x32_bf16 a[156:159], a[188:191], a[220:223], 0
s_cmp_ge_u32 s32, 163840
s_cselect_b32 s32, s48, s32
v_cndmask_b32 v3, v3, v19, vcc
v_xor_b32 v4, 64, v3
s_waitcnt vmcnt(16) lgkmcnt(0)
s_barrier
v_mfma_f32_16x16x32_bf16 v[160:163], a[160:163], a[224:227], v[160:163]
ds_read_b64_tr_b16 a[192:193], v5 offset:0
v_mfma_f32_16x16x32_bf16 v[164:167], a[160:163], a[228:231], v[164:167]
v_mfma_f32_16x16x32_bf16 v[168:171], a[160:163], a[232:235], v[168:171]
ds_read_b64_tr_b16 a[194:195], v5 offset:1024
v_mfma_f32_16x16x32_bf16 v[172:175], a[160:163], a[236:239], v[172:175]
s_add_u32 s37, s31, 0
v_mfma_f32_16x16x32_bf16 v[176:179], a[160:163], a[240:243], v[176:179]
s_add_u32 m0, s33, 0
ds_read_b64_tr_b16 a[196:197], v6 offset:0
v_mfma_f32_16x16x32_bf16 v[180:183], a[160:163], a[244:247], v[180:183]
buffer_load_dwordx4 v2, s[20:23], s37 offen  lds
v_mfma_f32_16x16x32_bf16 v[184:187], a[160:163], a[248:251], v[184:187]
ds_read_b64_tr_b16 a[198:199], v6 offset:1024
v_mfma_f32_16x16x32_bf16 v[188:191], a[160:163], a[252:255], v[188:191]
ds_read_b128 a[160:163], v3 offset:0
s_mov_b32 s60, s38
v_mfma_f32_16x16x32_bf16 v[192:195], a[164:167], a[224:227], v[192:195]
s_mov_b32 s29, s38
ds_read_b64_tr_b16 a[200:201], v7 offset:0
v_mfma_f32_16x16x32_bf16 v[196:199], a[164:167], a[228:231], v[196:199]
buffer_store_dwordx4 v[32:35], v13, s[8:11], s29 offen sc1
v_mfma_f32_16x16x32_bf16 v[200:203], a[164:167], a[232:235], v[200:203]
ds_read_b64_tr_b16 a[202:203], v7 offset:1024
v_mfma_f32_16x16x32_bf16 v[204:207], a[164:167], a[236:239], v[204:207]
s_add_u32 s37, s31, 32768
v_mfma_f32_16x16x32_bf16 v[208:211], a[164:167], a[240:243], v[208:211]
s_add_u32 m0, s33, 1024
ds_read_b64_tr_b16 a[204:205], v8 offset:0
v_mfma_f32_16x16x32_bf16 v[212:215], a[164:167], a[244:247], v[212:215]
buffer_load_dwordx4 v2, s[20:23], s37 offen  lds
v_mfma_f32_16x16x32_bf16 v[216:219], a[164:167], a[248:251], v[216:219]
ds_read_b64_tr_b16 a[206:207], v8 offset:1024
v_mfma_f32_16x16x32_bf16 v[220:223], a[164:167], a[252:255], v[220:223]
ds_read_b128 a[164:167], v4 offset:1024
v_mfma_f32_16x16x32_bf16 v[224:227], a[168:171], a[224:227], v[224:227]
ds_read_b64_tr_b16 a[208:209], v9 offset:0
v_mfma_f32_16x16x32_bf16 v[228:231], a[168:171], a[228:231], v[228:231]
v_mfma_f32_16x16x32_bf16 v[232:235], a[168:171], a[232:235], v[232:235]
ds_read_b64_tr_b16 a[210:211], v9 offset:1024
v_mfma_f32_16x16x32_bf16 v[236:239], a[168:171], a[236:239], v[236:239]
s_add_u32 s37, s31, 131072
v_mfma_f32_16x16x32_bf16 v[240:243], a[168:171], a[240:243], v[240:243]
s_add_u32 m0, s33, 4096
ds_read_b64_tr_b16 a[212:213], v10 offset:0
v_mfma_f32_16x16x32_bf16 v[244:247], a[168:171], a[244:247], v[244:247]
buffer_load_dwordx4 v2, s[20:23], s37 offen  lds
v_mfma_f32_16x16x32_bf16 v[248:251], a[168:171], a[248:251], v[248:251]
ds_read_b64_tr_b16 a[214:215], v10 offset:1024
v_mfma_f32_16x16x32_bf16 v[252:255], a[168:171], a[252:255], v[252:255]
ds_read_b128 a[168:171], v3 offset:4096
v_mfma_f32_16x16x32_bf16 a[0:3], a[172:175], a[224:227], a[0:3]
ds_read_b64_tr_b16 a[216:217], v11 offset:0
v_mfma_f32_16x16x32_bf16 a[4:7], a[172:175], a[228:231], a[4:7]
v_mfma_f32_16x16x32_bf16 a[8:11], a[172:175], a[232:235], a[8:11]
ds_read_b64_tr_b16 a[218:219], v11 offset:1024
v_mfma_f32_16x16x32_bf16 a[12:15], a[172:175], a[236:239], a[12:15]
s_add_u32 s37, s31, 163840
v_mfma_f32_16x16x32_bf16 a[16:19], a[172:175], a[240:243], a[16:19]
s_add_u32 m0, s33, 5120
ds_read_b64_tr_b16 a[220:221], v12 offset:0
v_mfma_f32_16x16x32_bf16 a[20:23], a[172:175], a[244:247], a[20:23]
buffer_load_dwordx4 v2, s[20:23], s37 offen  lds
v_mfma_f32_16x16x32_bf16 a[24:27], a[172:175], a[248:251], a[24:27]
ds_read_b64_tr_b16 a[222:223], v12 offset:1024
v_mfma_f32_16x16x32_bf16 a[28:31], a[172:175], a[252:255], a[28:31]
ds_read_b128 a[172:175], v4 offset:5120
s_add_u32 s29, s29, s44
v_mfma_f32_16x16x32_bf16 a[32:35], a[176:179], a[224:227], a[32:35]
s_add_u32 s31, s31, 262144
s_add_u32 s33, s33, 16384
v_mfma_f32_16x16x32_bf16 a[36:39], a[176:179], a[228:231], a[36:39]
s_and_b32 s33, s33, 65535
buffer_store_dwordx4 v[36:39], v13, s[8:11], s29 offen sc1
v_mfma_f32_16x16x32_bf16 a[40:43], a[176:179], a[232:235], a[40:43]
ds_read_b128 a[188:191], v4 offset:13312
v_mfma_f32_16x16x32_bf16 a[44:47], a[176:179], a[236:239], a[44:47]
s_mov_b32 s48, s30
v_mfma_f32_16x16x32_bf16 a[48:51], a[176:179], a[240:243], a[48:51]
s_add_u32 m0, s32, 0
v_mfma_f32_16x16x32_bf16 a[52:55], a[176:179], a[244:247], a[52:55]
buffer_load_dwordx4 v1, s[12:15], s48 offen lds
v_mfma_f32_16x16x32_bf16 a[56:59], a[176:179], a[248:251], a[56:59]
v_mfma_f32_16x16x32_bf16 a[60:63], a[176:179], a[252:255], a[60:63]
ds_read_b128 a[176:179], v3 offset:8192
v_mfma_f32_16x16x32_bf16 a[64:67], a[180:183], a[224:227], a[64:67]
v_mfma_f32_16x16x32_bf16 a[68:71], a[180:183], a[228:231], a[68:71]
v_mfma_f32_16x16x32_bf16 a[72:75], a[180:183], a[232:235], a[72:75]
v_mfma_f32_16x16x32_bf16 a[76:79], a[180:183], a[236:239], a[76:79]
s_add_u32 s48, s48, s34
v_mfma_f32_16x16x32_bf16 a[80:83], a[180:183], a[240:243], a[80:83]
s_add_u32 m0, s32, 4096
v_mfma_f32_16x16x32_bf16 a[84:87], a[180:183], a[244:247], a[84:87]
buffer_load_dwordx4 v1, s[12:15], s48 offen lds
v_mfma_f32_16x16x32_bf16 a[88:91], a[180:183], a[248:251], a[88:91]
v_mfma_f32_16x16x32_bf16 a[92:95], a[180:183], a[252:255], a[92:95]
ds_read_b128 a[180:183], v4 offset:9216
v_mfma_f32_16x16x32_bf16 a[96:99], a[184:187], a[224:227], a[96:99]
v_mfma_f32_16x16x32_bf16 a[100:103], a[184:187], a[228:231], a[100:103]
v_mfma_f32_16x16x32_bf16 a[104:107], a[184:187], a[232:235], a[104:107]
v_mfma_f32_16x16x32_bf16 a[108:111], a[184:187], a[236:239], a[108:111]
s_add_u32 s48, s48, s34
v_mfma_f32_16x16x32_bf16 a[112:115], a[184:187], a[240:243], a[112:115]
s_add_u32 m0, s32, 8192
v_mfma_f32_16x16x32_bf16 a[116:119], a[184:187], a[244:247], a[116:119]
buffer_load_dwordx4 v1, s[12:15], s48 offen lds
v_mfma_f32_16x16x32_bf16 a[120:123], a[184:187], a[248:251], a[120:123]
v_mfma_f32_16x16x32_bf16 a[124:127], a[184:187], a[252:255], a[124:127]
ds_read_b128 a[184:187], v3 offset:12288
s_add_u32 s29, s29, s93
v_mfma_f32_16x16x32_bf16 a[128:131], v[28:31], a[224:227], a[128:131]
v_mfma_f32_16x16x32_bf16 a[132:135], v[28:31], a[228:231], a[132:135]
buffer_store_dwordx4 v[40:43], v13, s[8:11], s29 offen sc1
v_add_u32 v5, 16384, v5
v_and_b32 v5, 65535, v5
v_mfma_f32_16x16x32_bf16 a[136:139], v[28:31], a[232:235], a[136:139]
v_xor_b32 v6, 16, v5
v_xor_b32 v7, 64, v5
v_xor_b32 v8, 80, v5
v_mfma_f32_16x16x32_bf16 a[140:143], v[28:31], a[236:239], a[140:143]
s_add_u32 s48, s48, s34
v_xor_b32 v9, 128, v5
v_xor_b32 v10, 144, v5
v_mfma_f32_16x16x32_bf16 a[144:147], v[28:31], a[240:243], a[144:147]
s_add_u32 m0, s32, 12288
v_xor_b32 v11, 192, v5
v_xor_b32 v12, 208, v5
v_mfma_f32_16x16x32_bf16 a[148:151], v[28:31], a[244:247], a[148:151]
buffer_load_dwordx4 v1, s[12:15], s48 offen lds
v_mfma_f32_16x16x32_bf16 a[152:155], v[28:31], a[248:251], a[152:155]
v_mfma_f32_16x16x32_bf16 a[156:159], v[28:31], a[252:255], a[156:159]
s_waitcnt vmcnt(19) lgkmcnt(0)
s_barrier
v_mfma_f32_16x16x32_bf16 v[160:163], a[160:163], a[192:195], v[160:163]
ds_read_b64_tr_b16 a[224:225], v5 offset:0
v_mfma_f32_16x16x32_bf16 v[164:167], a[160:163], a[196:199], v[164:167]
v_mfma_f32_16x16x32_bf16 v[168:171], a[160:163], a[200:203], v[168:171]
ds_read_b64_tr_b16 a[226:227], v5 offset:1024
v_mfma_f32_16x16x32_bf16 v[172:175], a[160:163], a[204:207], v[172:175]
s_add_u32 s37, s31, 0
v_mfma_f32_16x16x32_bf16 v[176:179], a[160:163], a[208:211], v[176:179]
s_add_u32 m0, s33, 0
ds_read_b64_tr_b16 a[228:229], v6 offset:0
v_mfma_f32_16x16x32_bf16 v[180:183], a[160:163], a[212:215], v[180:183]
buffer_load_dwordx4 v2, s[20:23], s37 offen  lds
v_mfma_f32_16x16x32_bf16 v[184:187], a[160:163], a[216:219], v[184:187]
ds_read_b64_tr_b16 a[230:231], v6 offset:1024
v_mfma_f32_16x16x32_bf16 v[188:191], a[160:163], a[220:223], v[188:191]
ds_read_b128 a[160:163], v4 offset:0
s_add_u32 s29, s29, s44
v_mfma_f32_16x16x32_bf16 v[192:195], a[164:167], a[192:195], v[192:195]
ds_read_b64_tr_b16 a[232:233], v7 offset:0
v_mfma_f32_16x16x32_bf16 v[196:199], a[164:167], a[196:199], v[196:199]
buffer_store_dwordx4 v[44:47], v13, s[8:11], s29 offen sc1
v_mfma_f32_16x16x32_bf16 v[200:203], a[164:167], a[200:203], v[200:203]
ds_read_b64_tr_b16 a[234:235], v7 offset:1024
v_mfma_f32_16x16x32_bf16 v[204:207], a[164:167], a[204:207], v[204:207]
s_add_u32 s37, s31, 32768
v_mfma_f32_16x16x32_bf16 v[208:211], a[164:167], a[208:211], v[208:211]
s_add_u32 m0, s33, 1024
ds_read_b64_tr_b16 a[236:237], v8 offset:0
v_mfma_f32_16x16x32_bf16 v[212:215], a[164:167], a[212:215], v[212:215]
buffer_load_dwordx4 v2, s[20:23], s37 offen  lds
v_mfma_f32_16x16x32_bf16 v[216:219], a[164:167], a[216:219], v[216:219]
ds_read_b64_tr_b16 a[238:239], v8 offset:1024
v_mfma_f32_16x16x32_bf16 v[220:223], a[164:167], a[220:223], v[220:223]
ds_read_b128 a[164:167], v3 offset:1024
v_mfma_f32_16x16x32_bf16 v[224:227], a[168:171], a[192:195], v[224:227]
ds_read_b64_tr_b16 a[240:241], v9 offset:0
v_mfma_f32_16x16x32_bf16 v[228:231], a[168:171], a[196:199], v[228:231]
v_mfma_f32_16x16x32_bf16 v[232:235], a[168:171], a[200:203], v[232:235]
ds_read_b64_tr_b16 a[242:243], v9 offset:1024
v_mfma_f32_16x16x32_bf16 v[236:239], a[168:171], a[204:207], v[236:239]
s_add_u32 s37, s31, 131072
v_mfma_f32_16x16x32_bf16 v[240:243], a[168:171], a[208:211], v[240:243]
s_add_u32 m0, s33, 4096
ds_read_b64_tr_b16 a[244:245], v10 offset:0
v_mfma_f32_16x16x32_bf16 v[244:247], a[168:171], a[212:215], v[244:247]
buffer_load_dwordx4 v2, s[20:23], s37 offen  lds
v_mfma_f32_16x16x32_bf16 v[248:251], a[168:171], a[216:219], v[248:251]
ds_read_b64_tr_b16 a[246:247], v10 offset:1024
v_mfma_f32_16x16x32_bf16 v[252:255], a[168:171], a[220:223], v[252:255]
ds_read_b128 a[168:171], v4 offset:4096
v_mfma_f32_16x16x32_bf16 a[0:3], a[172:175], a[192:195], a[0:3]
ds_read_b64_tr_b16 a[248:249], v11 offset:0
v_mfma_f32_16x16x32_bf16 a[4:7], a[172:175], a[196:199], a[4:7]
v_mfma_f32_16x16x32_bf16 a[8:11], a[172:175], a[200:203], a[8:11]
ds_read_b64_tr_b16 a[250:251], v11 offset:1024
v_mfma_f32_16x16x32_bf16 a[12:15], a[172:175], a[204:207], a[12:15]
s_add_u32 s37, s31, 163840
v_mfma_f32_16x16x32_bf16 a[16:19], a[172:175], a[208:211], a[16:19]
s_add_u32 m0, s33, 5120
ds_read_b64_tr_b16 a[252:253], v12 offset:0
v_mfma_f32_16x16x32_bf16 a[20:23], a[172:175], a[212:215], a[20:23]
buffer_load_dwordx4 v2, s[20:23], s37 offen  lds
v_mfma_f32_16x16x32_bf16 a[24:27], a[172:175], a[216:219], a[24:27]
ds_read_b64_tr_b16 a[254:255], v12 offset:1024
v_mfma_f32_16x16x32_bf16 a[28:31], a[172:175], a[220:223], a[28:31]
ds_read_b128 a[172:175], v3 offset:5120
s_add_u32 s29, s29, s93
v_mfma_f32_16x16x32_bf16 a[32:35], a[176:179], a[192:195], a[32:35]
s_add_u32 s31, s31, 262144
s_add_u32 s33, s33, 16384
v_mfma_f32_16x16x32_bf16 a[36:39], a[176:179], a[196:199], a[36:39]
s_and_b32 s33, s33, 65535
buffer_store_dwordx4 v[48:51], v13, s[8:11], s29 offen sc1
v_mfma_f32_16x16x32_bf16 a[40:43], a[176:179], a[200:203], a[40:43]
ds_read_b128 v[28:31], v3 offset:13312
v_mfma_f32_16x16x32_bf16 a[44:47], a[176:179], a[204:207], a[44:47]
s_add_u32 s48, s48, s34
v_mfma_f32_16x16x32_bf16 a[48:51], a[176:179], a[208:211], a[48:51]
s_add_u32 m0, s32, 16384
v_mfma_f32_16x16x32_bf16 a[52:55], a[176:179], a[212:215], a[52:55]
buffer_load_dwordx4 v1, s[12:15], s48 offen lds
v_mfma_f32_16x16x32_bf16 a[56:59], a[176:179], a[216:219], a[56:59]
v_mfma_f32_16x16x32_bf16 a[60:63], a[176:179], a[220:223], a[60:63]
ds_read_b128 a[176:179], v4 offset:8192
v_mfma_f32_16x16x32_bf16 a[64:67], a[180:183], a[192:195], a[64:67]
v_mfma_f32_16x16x32_bf16 a[68:71], a[180:183], a[196:199], a[68:71]
v_mfma_f32_16x16x32_bf16 a[72:75], a[180:183], a[200:203], a[72:75]
v_mfma_f32_16x16x32_bf16 a[76:79], a[180:183], a[204:207], a[76:79]
s_add_u32 s48, s48, s34
v_mfma_f32_16x16x32_bf16 a[80:83], a[180:183], a[208:211], a[80:83]
s_add_u32 m0, s32, 20480
v_mfma_f32_16x16x32_bf16 a[84:87], a[180:183], a[212:215], a[84:87]
buffer_load_dwordx4 v1, s[12:15], s48 offen lds
v_mfma_f32_16x16x32_bf16 a[88:91], a[180:183], a[216:219], a[88:91]
v_mfma_f32_16x16x32_bf16 a[92:95], a[180:183], a[220:223], a[92:95]
ds_read_b128 a[180:183], v3 offset:9216
v_mfma_f32_16x16x32_bf16 a[96:99], a[184:187], a[192:195], a[96:99]
v_mfma_f32_16x16x32_bf16 a[100:103], a[184:187], a[196:199], a[100:103]
v_mfma_f32_16x16x32_bf16 a[104:107], a[184:187], a[200:203], a[104:107]
v_mfma_f32_16x16x32_bf16 a[108:111], a[184:187], a[204:207], a[108:111]
s_add_u32 s48, s48, s34
v_mfma_f32_16x16x32_bf16 a[112:115], a[184:187], a[208:211], a[112:115]
s_add_u32 m0, s32, 24576
v_mfma_f32_16x16x32_bf16 a[116:119], a[184:187], a[212:215], a[116:119]
buffer_load_dwordx4 v1, s[12:15], s48 offen lds
v_mfma_f32_16x16x32_bf16 a[120:123], a[184:187], a[216:219], a[120:123]
v_mfma_f32_16x16x32_bf16 a[124:127], a[184:187], a[220:223], a[124:127]
ds_read_b128 a[184:187], v4 offset:12288
s_add_u32 s29, s29, s44
v_mfma_f32_16x16x32_bf16 a[128:131], a[188:191], a[192:195], a[128:131]
v_mfma_f32_16x16x32_bf16 a[132:135], a[188:191], a[196:199], a[132:135]
buffer_store_dwordx4 v[52:55], v13, s[8:11], s29 offen sc1
v_add_u32 v3, 32768, v3
v_subrev_u32 v19, 98304, v3
v_mfma_f32_16x16x32_bf16 a[136:139], a[188:191], a[200:203], a[136:139]
v_cmp_le_u32 vcc, 163840, v3
v_add_u32 v5, 16384, v5
v_and_b32 v5, 65535, v5
v_mfma_f32_16x16x32_bf16 a[140:143], a[188:191], a[204:207], a[140:143]
s_add_u32 s48, s48, s34
v_xor_b32 v6, 16, v5
v_xor_b32 v7, 64, v5
v_mfma_f32_16x16x32_bf16 a[144:147], a[188:191], a[208:211], a[144:147]
s_add_u32 m0, s32, 28672
v_xor_b32 v8, 80, v5
v_xor_b32 v9, 128, v5
v_mfma_f32_16x16x32_bf16 a[148:151], a[188:191], a[212:215], a[148:151]
buffer_load_dwordx4 v1, s[12:15], s48 offen lds
v_xor_b32 v10, 144, v5
v_xor_b32 v11, 192, v5
v_mfma_f32_16x16x32_bf16 a[152:155], a[188:191], a[216:219], a[152:155]
s_add_u32 s30, s30, 128
s_add_u32 s32, s32, 32768
s_sub_u32 s48, s32, 98304
v_mfma_f32_16x16x32_bf16 a[156:159], a[188:191], a[220:223], a[156:159]
s_cmp_ge_u32 s32, 163840
s_cselect_b32 s32, s48, s32
v_xor_b32 v12, 208, v5
v_cndmask_b32 v3, v3, v19, vcc
v_xor_b32 v4, 64, v3
s_waitcnt vmcnt(22) lgkmcnt(0)
s_barrier
v_mfma_f32_16x16x32_bf16 v[160:163], a[160:163], a[224:227], v[160:163]
ds_read_b64_tr_b16 a[192:193], v5 offset:0
v_mfma_f32_16x16x32_bf16 v[164:167], a[160:163], a[228:231], v[164:167]
v_mfma_f32_16x16x32_bf16 v[168:171], a[160:163], a[232:235], v[168:171]
ds_read_b64_tr_b16 a[194:195], v5 offset:1024
v_mfma_f32_16x16x32_bf16 v[172:175], a[160:163], a[236:239], v[172:175]
s_add_u32 s37, s31, 0
v_mfma_f32_16x16x32_bf16 v[176:179], a[160:163], a[240:243], v[176:179]
s_add_u32 m0, s33, 0
ds_read_b64_tr_b16 a[196:197], v6 offset:0
v_mfma_f32_16x16x32_bf16 v[180:183], a[160:163], a[244:247], v[180:183]
buffer_load_dwordx4 v2, s[20:23], s37 offen  lds
v_mfma_f32_16x16x32_bf16 v[184:187], a[160:163], a[248:251], v[184:187]
ds_read_b64_tr_b16 a[198:199], v6 offset:1024
v_mfma_f32_16x16x32_bf16 v[188:191], a[160:163], a[252:255], v[188:191]
ds_read_b128 a[160:163], v3 offset:0
s_add_u32 s29, s29, s93
v_mfma_f32_16x16x32_bf16 v[192:195], a[164:167], a[224:227], v[192:195]
ds_read_b64_tr_b16 a[200:201], v7 offset:0
v_mfma_f32_16x16x32_bf16 v[196:199], a[164:167], a[228:231], v[196:199]
buffer_store_dwordx4 v[56:59], v13, s[8:11], s29 offen sc1
v_mfma_f32_16x16x32_bf16 v[200:203], a[164:167], a[232:235], v[200:203]
ds_read_b64_tr_b16 a[202:203], v7 offset:1024
v_mfma_f32_16x16x32_bf16 v[204:207], a[164:167], a[236:239], v[204:207]
s_add_u32 s37, s31, 32768
v_mfma_f32_16x16x32_bf16 v[208:211], a[164:167], a[240:243], v[208:211]
s_add_u32 m0, s33, 1024
ds_read_b64_tr_b16 a[204:205], v8 offset:0
v_mfma_f32_16x16x32_bf16 v[212:215], a[164:167], a[244:247], v[212:215]
buffer_load_dwordx4 v2, s[20:23], s37 offen  lds
v_mfma_f32_16x16x32_bf16 v[216:219], a[164:167], a[248:251], v[216:219]
ds_read_b64_tr_b16 a[206:207], v8 offset:1024
v_mfma_f32_16x16x32_bf16 v[220:223], a[164:167], a[252:255], v[220:223]
ds_read_b128 a[164:167], v4 offset:1024
v_mfma_f32_16x16x32_bf16 v[224:227], a[168:171], a[224:227], v[224:227]
ds_read_b64_tr_b16 a[208:209], v9 offset:0
v_mfma_f32_16x16x32_bf16 v[228:231], a[168:171], a[228:231], v[228:231]
v_mfma_f32_16x16x32_bf16 v[232:235], a[168:171], a[232:235], v[232:235]
ds_read_b64_tr_b16 a[210:211], v9 offset:1024
v_mfma_f32_16x16x32_bf16 v[236:239], a[168:171], a[236:239], v[236:239]
s_add_u32 s37, s31, 131072
v_mfma_f32_16x16x32_bf16 v[240:243], a[168:171], a[240:243], v[240:243]
s_add_u32 m0, s33, 4096
ds_read_b64_tr_b16 a[212:213], v10 offset:0
v_mfma_f32_16x16x32_bf16 v[244:247], a[168:171], a[244:247], v[244:247]
buffer_load_dwordx4 v2, s[20:23], s37 offen  lds
v_mfma_f32_16x16x32_bf16 v[248:251], a[168:171], a[248:251], v[248:251]
ds_read_b64_tr_b16 a[214:215], v10 offset:1024
v_mfma_f32_16x16x32_bf16 v[252:255], a[168:171], a[252:255], v[252:255]
ds_read_b128 a[168:171], v3 offset:4096
v_mfma_f32_16x16x32_bf16 a[0:3], a[172:175], a[224:227], a[0:3]
ds_read_b64_tr_b16 a[216:217], v11 offset:0
v_mfma_f32_16x16x32_bf16 a[4:7], a[172:175], a[228:231], a[4:7]
v_mfma_f32_16x16x32_bf16 a[8:11], a[172:175], a[232:235], a[8:11]
ds_read_b64_tr_b16 a[218:219], v11 offset:1024
v_mfma_f32_16x16x32_bf16 a[12:15], a[172:175], a[236:239], a[12:15]
s_add_u32 s37, s31, 163840
v_mfma_f32_16x16x32_bf16 a[16:19], a[172:175], a[240:243], a[16:19]
s_add_u32 m0, s33, 5120
ds_read_b64_tr_b16 a[220:221], v12 offset:0
v_mfma_f32_16x16x32_bf16 a[20:23], a[172:175], a[244:247], a[20:23]
buffer_load_dwordx4 v2, s[20:23], s37 offen  lds
v_mfma_f32_16x16x32_bf16 a[24:27], a[172:175], a[248:251], a[24:27]
ds_read_b64_tr_b16 a[222:223], v12 offset:1024
v_mfma_f32_16x16x32_bf16 a[28:31], a[172:175], a[252:255], a[28:31]
ds_read_b128 a[172:175], v4 offset:5120
s_add_u32 s29, s29, s44
v_mfma_f32_16x16x32_bf16 a[32:35], a[176:179], a[224:227], a[32:35]
s_add_u32 s31, s31, 262144
s_add_u32 s33, s33, 16384
v_mfma_f32_16x16x32_bf16 a[36:39], a[176:179], a[228:231], a[36:39]
s_and_b32 s33, s33, 65535
buffer_store_dwordx4 v[60:63], v13, s[8:11], s29 offen sc1
v_mfma_f32_16x16x32_bf16 a[40:43], a[176:179], a[232:235], a[40:43]
ds_read_b128 a[188:191], v4 offset:13312
v_mfma_f32_16x16x32_bf16 a[44:47], a[176:179], a[236:239], a[44:47]
s_mov_b32 s48, s30
v_mfma_f32_16x16x32_bf16 a[48:51], a[176:179], a[240:243], a[48:51]
s_add_u32 m0, s32, 0
v_mfma_f32_16x16x32_bf16 a[52:55], a[176:179], a[244:247], a[52:55]
buffer_load_dwordx4 v1, s[12:15], s48 offen lds
v_mfma_f32_16x16x32_bf16 a[56:59], a[176:179], a[248:251], a[56:59]
v_mfma_f32_16x16x32_bf16 a[60:63], a[176:179], a[252:255], a[60:63]
ds_read_b128 a[176:179], v3 offset:8192
v_mfma_f32_16x16x32_bf16 a[64:67], a[180:183], a[224:227], a[64:67]
v_mfma_f32_16x16x32_bf16 a[68:71], a[180:183], a[228:231], a[68:71]
v_mfma_f32_16x16x32_bf16 a[72:75], a[180:183], a[232:235], a[72:75]
v_mfma_f32_16x16x32_bf16 a[76:79], a[180:183], a[236:239], a[76:79]
s_add_u32 s48, s48, s34
v_mfma_f32_16x16x32_bf16 a[80:83], a[180:183], a[240:243], a[80:83]
s_add_u32 m0, s32, 4096
v_mfma_f32_16x16x32_bf16 a[84:87], a[180:183], a[244:247], a[84:87]
buffer_load_dwordx4 v1, s[12:15], s48 offen lds
v_mfma_f32_16x16x32_bf16 a[88:91], a[180:183], a[248:251], a[88:91]
v_mfma_f32_16x16x32_bf16 a[92:95], a[180:183], a[252:255], a[92:95]
ds_read_b128 a[180:183], v4 offset:9216
v_mfma_f32_16x16x32_bf16 a[96:99], a[184:187], a[224:227], a[96:99]
v_mfma_f32_16x16x32_bf16 a[100:103], a[184:187], a[228:231], a[100:103]
v_mfma_f32_16x16x32_bf16 a[104:107], a[184:187], a[232:235], a[104:107]
v_mfma_f32_16x16x32_bf16 a[108:111], a[184:187], a[236:239], a[108:111]
s_add_u32 s48, s48, s34
v_mfma_f32_16x16x32_bf16 a[112:115], a[184:187], a[240:243], a[112:115]
s_add_u32 m0, s32, 8192
v_mfma_f32_16x16x32_bf16 a[116:119], a[184:187], a[244:247], a[116:119]
buffer_load_dwordx4 v1, s[12:15], s48 offen lds
v_mfma_f32_16x16x32_bf16 a[120:123], a[184:187], a[248:251], a[120:123]
v_mfma_f32_16x16x32_bf16 a[124:127], a[184:187], a[252:255], a[124:127]
ds_read_b128 a[184:187], v3 offset:12288
v_mfma_f32_16x16x32_bf16 a[128:131], v[28:31], a[224:227], a[128:131]
v_mfma_f32_16x16x32_bf16 a[132:135], v[28:31], a[228:231], a[132:135]
v_add_u32 v5, 16384, v5
v_and_b32 v5, 65535, v5
v_xor_b32 v6, 16, v5
v_mfma_f32_16x16x32_bf16 a[136:139], v[28:31], a[232:235], a[136:139]
v_xor_b32 v7, 64, v5
v_xor_b32 v8, 80, v5
v_xor_b32 v9, 128, v5
v_mfma_f32_16x16x32_bf16 a[140:143], v[28:31], a[236:239], a[140:143]
s_add_u32 s48, s48, s34
v_xor_b32 v10, 144, v5
v_xor_b32 v11, 192, v5
v_mfma_f32_16x16x32_bf16 a[144:147], v[28:31], a[240:243], a[144:147]
s_add_u32 m0, s32, 12288
v_xor_b32 v12, 208, v5
v_mfma_f32_16x16x32_bf16 a[148:151], v[28:31], a[244:247], a[148:151]
buffer_load_dwordx4 v1, s[12:15], s48 offen lds
v_mfma_f32_16x16x32_bf16 a[152:155], v[28:31], a[248:251], a[152:155]
v_mfma_f32_16x16x32_bf16 a[156:159], v[28:31], a[252:255], a[156:159]
s_waitcnt vmcnt(21) lgkmcnt(0)
s_barrier
v_mfma_f32_16x16x32_bf16 v[160:163], a[160:163], a[192:195], v[160:163]
ds_read_b64_tr_b16 a[224:225], v5 offset:0
v_mfma_f32_16x16x32_bf16 v[164:167], a[160:163], a[196:199], v[164:167]
v_mfma_f32_16x16x32_bf16 v[168:171], a[160:163], a[200:203], v[168:171]
ds_read_b64_tr_b16 a[226:227], v5 offset:1024
v_mfma_f32_16x16x32_bf16 v[172:175], a[160:163], a[204:207], v[172:175]
s_add_u32 s37, s31, 0
v_mfma_f32_16x16x32_bf16 v[176:179], a[160:163], a[208:211], v[176:179]
s_add_u32 m0, s33, 0
ds_read_b64_tr_b16 a[228:229], v6 offset:0
v_mfma_f32_16x16x32_bf16 v[180:183], a[160:163], a[212:215], v[180:183]
buffer_load_dwordx4 v2, s[20:23], s37 offen  lds
v_mfma_f32_16x16x32_bf16 v[184:187], a[160:163], a[216:219], v[184:187]
ds_read_b64_tr_b16 a[230:231], v6 offset:1024
v_mfma_f32_16x16x32_bf16 v[188:191], a[160:163], a[220:223], v[188:191]
ds_read_b128 a[160:163], v4 offset:0
s_add_u32 s60, s60, s92
v_mfma_f32_16x16x32_bf16 v[192:195], a[164:167], a[192:195], v[192:195]
s_mov_b32 s29, s60
ds_read_b64_tr_b16 a[232:233], v7 offset:0
v_mfma_f32_16x16x32_bf16 v[196:199], a[164:167], a[196:199], v[196:199]
buffer_store_dwordx4 v[64:67], v13, s[8:11], s29 offen sc1
v_mfma_f32_16x16x32_bf16 v[200:203], a[164:167], a[200:203], v[200:203]
ds_read_b64_tr_b16 a[234:235], v7 offset:1024
v_mfma_f32_16x16x32_bf16 v[204:207], a[164:167], a[204:207], v[204:207]
s_add_u32 s37, s31, 32768
v_mfma_f32_16x16x32_bf16 v[208:211], a[164:167], a[208:211], v[208:211]
s_add_u32 m0, s33, 1024
ds_read_b64_tr_b16 a[236:237], v8 offset:0
v_mfma_f32_16x16x32_bf16 v[212:215], a[164:167], a[212:215], v[212:215]
buffer_load_dwordx4 v2, s[20:23], s37 offen  lds
v_mfma_f32_16x16x32_bf16 v[216:219], a[164:167], a[216:219], v[216:219]
ds_read_b64_tr_b16 a[238:239], v8 offset:1024
v_mfma_f32_16x16x32_bf16 v[220:223], a[164:167], a[220:223], v[220:223]
ds_read_b128 a[164:167], v3 offset:1024
v_mfma_f32_16x16x32_bf16 v[224:227], a[168:171], a[192:195], v[224:227]
ds_read_b64_tr_b16 a[240:241], v9 offset:0
v_mfma_f32_16x16x32_bf16 v[228:231], a[168:171], a[196:199], v[228:231]
v_mfma_f32_16x16x32_bf16 v[232:235], a[168:171], a[200:203], v[232:235]
ds_read_b64_tr_b16 a[242:243], v9 offset:1024
v_mfma_f32_16x16x32_bf16 v[236:239], a[168:171], a[204:207], v[236:239]
s_add_u32 s37, s31, 131072
v_mfma_f32_16x16x32_bf16 v[240:243], a[168:171], a[208:211], v[240:243]
s_add_u32 m0, s33, 4096
ds_read_b64_tr_b16 a[244:245], v10 offset:0
v_mfma_f32_16x16x32_bf16 v[244:247], a[168:171], a[212:215], v[244:247]
buffer_load_dwordx4 v2, s[20:23], s37 offen  lds
v_mfma_f32_16x16x32_bf16 v[248:251], a[168:171], a[216:219], v[248:251]
ds_read_b64_tr_b16 a[246:247], v10 offset:1024
v_mfma_f32_16x16x32_bf16 v[252:255], a[168:171], a[220:223], v[252:255]
ds_read_b128 a[168:171], v4 offset:4096
v_mfma_f32_16x16x32_bf16 a[0:3], a[172:175], a[192:195], a[0:3]
ds_read_b64_tr_b16 a[248:249], v11 offset:0
v_mfma_f32_16x16x32_bf16 a[4:7], a[172:175], a[196:199], a[4:7]
v_mfma_f32_16x16x32_bf16 a[8:11], a[172:175], a[200:203], a[8:11]
ds_read_b64_tr_b16 a[250:251], v11 offset:1024
v_mfma_f32_16x16x32_bf16 a[12:15], a[172:175], a[204:207], a[12:15]
s_add_u32 s37, s31, 163840
v_mfma_f32_16x16x32_bf16 a[16:19], a[172:175], a[208:211], a[16:19]
s_add_u32 m0, s33, 5120
ds_read_b64_tr_b16 a[252:253], v12 offset:0
v_mfma_f32_16x16x32_bf16 a[20:23], a[172:175], a[212:215], a[20:23]
buffer_load_dwordx4 v2, s[20:23], s37 offen  lds
v_mfma_f32_16x16x32_bf16 a[24:27], a[172:175], a[216:219], a[24:27]
ds_read_b64_tr_b16 a[254:255], v12 offset:1024
v_mfma_f32_16x16x32_bf16 a[28:31], a[172:175], a[220:223], a[28:31]
ds_read_b128 a[172:175], v3 offset:5120
s_add_u32 s29, s29, s44
v_mfma_f32_16x16x32_bf16 a[32:35], a[176:179], a[192:195], a[32:35]
s_add_u32 s31, s31, 262144
s_add_u32 s33, s33, 16384
v_mfma_f32_16x16x32_bf16 a[36:39], a[176:179], a[196:199], a[36:39]
s_and_b32 s33, s33, 65535
buffer_store_dwordx4 v[68:71], v13, s[8:11], s29 offen sc1
v_mfma_f32_16x16x32_bf16 a[40:43], a[176:179], a[200:203], a[40:43]
ds_read_b128 v[28:31], v3 offset:13312
v_mfma_f32_16x16x32_bf16 a[44:47], a[176:179], a[204:207], a[44:47]
s_add_u32 s48, s48, s34
v_mfma_f32_16x16x32_bf16 a[48:51], a[176:179], a[208:211], a[48:51]
s_add_u32 m0, s32, 16384
v_mfma_f32_16x16x32_bf16 a[52:55], a[176:179], a[212:215], a[52:55]
buffer_load_dwordx4 v1, s[12:15], s48 offen lds
v_mfma_f32_16x16x32_bf16 a[56:59], a[176:179], a[216:219], a[56:59]
v_mfma_f32_16x16x32_bf16 a[60:63], a[176:179], a[220:223], a[60:63]
ds_read_b128 a[176:179], v4 offset:8192
v_mfma_f32_16x16x32_bf16 a[64:67], a[180:183], a[192:195], a[64:67]
v_mfma_f32_16x16x32_bf16 a[68:71], a[180:183], a[196:199], a[68:71]
v_mfma_f32_16x16x32_bf16 a[72:75], a[180:183], a[200:203], a[72:75]
v_mfma_f32_16x16x32_bf16 a[76:79], a[180:183], a[204:207], a[76:79]
s_add_u32 s48, s48, s34
v_mfma_f32_16x16x32_bf16 a[80:83], a[180:183], a[208:211], a[80:83]
s_add_u32 m0, s32, 20480
v_mfma_f32_16x16x32_bf16 a[84:87], a[180:183], a[212:215], a[84:87]
buffer_load_dwordx4 v1, s[12:15], s48 offen lds
v_mfma_f32_16x16x32_bf16 a[88:91], a[180:183], a[216:219], a[88:91]
v_mfma_f32_16x16x32_bf16 a[92:95], a[180:183], a[220:223], a[92:95]
ds_read_b128 a[180:183], v3 offset:9216
v_mfma_f32_16x16x32_bf16 a[96:99], a[184:187], a[192:195], a[96:99]
v_mfma_f32_16x16x32_bf16 a[100:103], a[184:187], a[196:199], a[100:103]
v_mfma_f32_16x16x32_bf16 a[104:107], a[184:187], a[200:203], a[104:107]
v_mfma_f32_16x16x32_bf16 a[108:111], a[184:187], a[204:207], a[108:111]
s_add_u32 s48, s48, s34
v_mfma_f32_16x16x32_bf16 a[112:115], a[184:187], a[208:211], a[112:115]
s_add_u32 m0, s32, 24576
v_mfma_f32_16x16x32_bf16 a[116:119], a[184:187], a[212:215], a[116:119]
buffer_load_dwordx4 v1, s[12:15], s48 offen lds
v_mfma_f32_16x16x32_bf16 a[120:123], a[184:187], a[216:219], a[120:123]
v_mfma_f32_16x16x32_bf16 a[124:127], a[184:187], a[220:223], a[124:127]
ds_read_b128 a[184:187], v4 offset:12288
s_add_u32 s29, s29, s93
v_mfma_f32_16x16x32_bf16 a[128:131], a[188:191], a[192:195], a[128:131]
v_mfma_f32_16x16x32_bf16 a[132:135], a[188:191], a[196:199], a[132:135]
buffer_store_dwordx4 v[72:75], v13, s[8:11], s29 offen sc1
v_add_u32 v3, 32768, v3
v_subrev_u32 v19, 98304, v3
v_mfma_f32_16x16x32_bf16 a[136:139], a[188:191], a[200:203], a[136:139]
v_cmp_le_u32 vcc, 163840, v3
v_add_u32 v5, 16384, v5
v_and_b32 v5, 65535, v5
v_mfma_f32_16x16x32_bf16 a[140:143], a[188:191], a[204:207], a[140:143]
s_add_u32 s48, s48, s34
v_xor_b32 v6, 16, v5
v_xor_b32 v7, 64, v5
v_mfma_f32_16x16x32_bf16 a[144:147], a[188:191], a[208:211], a[144:147]
s_add_u32 m0, s32, 28672
v_xor_b32 v8, 80, v5
v_xor_b32 v9, 128, v5
v_mfma_f32_16x16x32_bf16 a[148:151], a[188:191], a[212:215], a[148:151]
buffer_load_dwordx4 v1, s[12:15], s48 offen lds
v_xor_b32 v10, 144, v5
v_xor_b32 v11, 192, v5
v_mfma_f32_16x16x32_bf16 a[152:155], a[188:191], a[216:219], a[152:155]
s_add_u32 s30, s30, 128
s_add_u32 s32, s32, 32768
s_sub_u32 s48, s32, 98304
v_mfma_f32_16x16x32_bf16 a[156:159], a[188:191], a[220:223], a[156:159]
s_cmp_ge_u32 s32, 163840
s_cselect_b32 s32, s48, s32
v_xor_b32 v12, 208, v5
v_cndmask_b32 v3, v3, v19, vcc
v_xor_b32 v4, 64, v3
s_waitcnt vmcnt(21) lgkmcnt(0)
s_barrier
v_mfma_f32_16x16x32_bf16 v[160:163], a[160:163], a[224:227], v[160:163]
ds_read_b64_tr_b16 a[192:193], v5 offset:0
v_mfma_f32_16x16x32_bf16 v[164:167], a[160:163], a[228:231], v[164:167]
v_mfma_f32_16x16x32_bf16 v[168:171], a[160:163], a[232:235], v[168:171]
ds_read_b64_tr_b16 a[194:195], v5 offset:1024
v_mfma_f32_16x16x32_bf16 v[172:175], a[160:163], a[236:239], v[172:175]
s_add_u32 s37, s31, 0
v_mfma_f32_16x16x32_bf16 v[176:179], a[160:163], a[240:243], v[176:179]
s_add_u32 m0, s33, 0
ds_read_b64_tr_b16 a[196:197], v6 offset:0
v_mfma_f32_16x16x32_bf16 v[180:183], a[160:163], a[244:247], v[180:183]
buffer_load_dwordx4 v2, s[20:23], s37 offen  lds
v_mfma_f32_16x16x32_bf16 v[184:187], a[160:163], a[248:251], v[184:187]
ds_read_b64_tr_b16 a[198:199], v6 offset:1024
v_mfma_f32_16x16x32_bf16 v[188:191], a[160:163], a[252:255], v[188:191]
ds_read_b128 a[160:163], v3 offset:0
s_add_u32 s29, s29, s44
v_mfma_f32_16x16x32_bf16 v[192:195], a[164:167], a[224:227], v[192:195]
ds_read_b64_tr_b16 a[200:201], v7 offset:0
v_mfma_f32_16x16x32_bf16 v[196:199], a[164:167], a[228:231], v[196:199]
buffer_store_dwordx4 v[76:79], v13, s[8:11], s29 offen sc1
v_mfma_f32_16x16x32_bf16 v[200:203], a[164:167], a[232:235], v[200:203]
ds_read_b64_tr_b16 a[202:203], v7 offset:1024
v_mfma_f32_16x16x32_bf16 v[204:207], a[164:167], a[236:239], v[204:207]
s_add_u32 s37, s31, 32768
v_mfma_f32_16x16x32_bf16 v[208:211], a[164:167], a[240:243], v[208:211]
s_add_u32 m0, s33, 1024
ds_read_b64_tr_b16 a[204:205], v8 offset:0
v_mfma_f32_16x16x32_bf16 v[212:215], a[164:167], a[244:247], v[212:215]
buffer_load_dwordx4 v2, s[20:23], s37 offen  lds
v_mfma_f32_16x16x32_bf16 v[216:219], a[164:167], a[248:251], v[216:219]
ds_read_b64_tr_b16 a[206:207], v8 offset:1024
v_mfma_f32_16x16x32_bf16 v[220:223], a[164:167], a[252:255], v[220:223]
ds_read_b128 a[164:167], v4 offset:1024
v_mfma_f32_16x16x32_bf16 v[224:227], a[168:171], a[224:227], v[224:227]
ds_read_b64_tr_b16 a[208:209], v9 offset:0
v_mfma_f32_16x16x32_bf16 v[228:231], a[168:171], a[228:231], v[228:231]
v_mfma_f32_16x16x32_bf16 v[232:235], a[168:171], a[232:235], v[232:235]
ds_read_b64_tr_b16 a[210:211], v9 offset:1024
v_mfma_f32_16x16x32_bf16 v[236:239], a[168:171], a[236:239], v[236:239]
s_add_u32 s37, s31, 131072
v_mfma_f32_16x16x32_bf16 v[240:243], a[168:171], a[240:243], v[240:243]
s_add_u32 m0, s33, 4096
ds_read_b64_tr_b16 a[212:213], v10 offset:0
v_mfma_f32_16x16x32_bf16 v[244:247], a[168:171], a[244:247], v[244:247]
buffer_load_dwordx4 v2, s[20:23], s37 offen  lds
v_mfma_f32_16x16x32_bf16 v[248:251], a[168:171], a[248:251], v[248:251]
ds_read_b64_tr_b16 a[214:215], v10 offset:1024
v_mfma_f32_16x16x32_bf16 v[252:255], a[168:171], a[252:255], v[252:255]
ds_read_b128 a[168:171], v3 offset:4096
v_mfma_f32_16x16x32_bf16 a[0:3], a[172:175], a[224:227], a[0:3]
ds_read_b64_tr_b16 a[216:217], v11 offset:0
v_mfma_f32_16x16x32_bf16 a[4:7], a[172:175], a[228:231], a[4:7]
v_mfma_f32_16x16x32_bf16 a[8:11], a[172:175], a[232:235], a[8:11]
ds_read_b64_tr_b16 a[218:219], v11 offset:1024
v_mfma_f32_16x16x32_bf16 a[12:15], a[172:175], a[236:239], a[12:15]
s_add_u32 s37, s31, 163840
v_mfma_f32_16x16x32_bf16 a[16:19], a[172:175], a[240:243], a[16:19]
s_add_u32 m0, s33, 5120
ds_read_b64_tr_b16 a[220:221], v12 offset:0
v_mfma_f32_16x16x32_bf16 a[20:23], a[172:175], a[244:247], a[20:23]
buffer_load_dwordx4 v2, s[20:23], s37 offen  lds
v_mfma_f32_16x16x32_bf16 a[24:27], a[172:175], a[248:251], a[24:27]
ds_read_b64_tr_b16 a[222:223], v12 offset:1024
v_mfma_f32_16x16x32_bf16 a[28:31], a[172:175], a[252:255], a[28:31]
ds_read_b128 a[172:175], v4 offset:5120
s_add_u32 s29, s29, s93
v_mfma_f32_16x16x32_bf16 a[32:35], a[176:179], a[224:227], a[32:35]
s_add_u32 s31, s31, 262144
s_add_u32 s33, s33, 16384
v_mfma_f32_16x16x32_bf16 a[36:39], a[176:179], a[228:231], a[36:39]
s_and_b32 s33, s33, 65535
buffer_store_dwordx4 v[80:83], v13, s[8:11], s29 offen sc1
v_mfma_f32_16x16x32_bf16 a[40:43], a[176:179], a[232:235], a[40:43]
ds_read_b128 a[188:191], v4 offset:13312
v_mfma_f32_16x16x32_bf16 a[44:47], a[176:179], a[236:239], a[44:47]
s_mov_b32 s48, s30
v_mfma_f32_16x16x32_bf16 a[48:51], a[176:179], a[240:243], a[48:51]
s_add_u32 m0, s32, 0
v_mfma_f32_16x16x32_bf16 a[52:55], a[176:179], a[244:247], a[52:55]
buffer_load_dwordx4 v1, s[12:15], s48 offen lds
v_mfma_f32_16x16x32_bf16 a[56:59], a[176:179], a[248:251], a[56:59]
v_mfma_f32_16x16x32_bf16 a[60:63], a[176:179], a[252:255], a[60:63]
ds_read_b128 a[176:179], v3 offset:8192
v_mfma_f32_16x16x32_bf16 a[64:67], a[180:183], a[224:227], a[64:67]
v_mfma_f32_16x16x32_bf16 a[68:71], a[180:183], a[228:231], a[68:71]
v_mfma_f32_16x16x32_bf16 a[72:75], a[180:183], a[232:235], a[72:75]
v_mfma_f32_16x16x32_bf16 a[76:79], a[180:183], a[236:239], a[76:79]
s_add_u32 s48, s48, s34
v_mfma_f32_16x16x32_bf16 a[80:83], a[180:183], a[240:243], a[80:83]
s_add_u32 m0, s32, 4096
v_mfma_f32_16x16x32_bf16 a[84:87], a[180:183], a[244:247], a[84:87]
buffer_load_dwordx4 v1, s[12:15], s48 offen lds
v_mfma_f32_16x16x32_bf16 a[88:91], a[180:183], a[248:251], a[88:91]
v_mfma_f32_16x16x32_bf16 a[92:95], a[180:183], a[252:255], a[92:95]
ds_read_b128 a[180:183], v4 offset:9216
v_mfma_f32_16x16x32_bf16 a[96:99], a[184:187], a[224:227], a[96:99]
v_mfma_f32_16x16x32_bf16 a[100:103], a[184:187], a[228:231], a[100:103]
v_mfma_f32_16x16x32_bf16 a[104:107], a[184:187], a[232:235], a[104:107]
v_mfma_f32_16x16x32_bf16 a[108:111], a[184:187], a[236:239], a[108:111]
s_add_u32 s48, s48, s34
v_mfma_f32_16x16x32_bf16 a[112:115], a[184:187], a[240:243], a[112:115]
s_add_u32 m0, s32, 8192
v_mfma_f32_16x16x32_bf16 a[116:119], a[184:187], a[244:247], a[116:119]
buffer_load_dwordx4 v1, s[12:15], s48 offen lds
v_mfma_f32_16x16x32_bf16 a[120:123], a[184:187], a[248:251], a[120:123]
v_mfma_f32_16x16x32_bf16 a[124:127], a[184:187], a[252:255], a[124:127]
ds_read_b128 a[184:187], v3 offset:12288
s_add_u32 s29, s29, s44
v_mfma_f32_16x16x32_bf16 a[128:131], v[28:31], a[224:227], a[128:131]
v_mfma_f32_16x16x32_bf16 a[132:135], v[28:31], a[228:231], a[132:135]
buffer_store_dwordx4 v[84:87], v13, s[8:11], s29 offen sc1
v_add_u32 v5, 16384, v5
v_and_b32 v5, 65535, v5
v_mfma_f32_16x16x32_bf16 a[136:139], v[28:31], a[232:235], a[136:139]
v_xor_b32 v6, 16, v5
v_xor_b32 v7, 64, v5
v_xor_b32 v8, 80, v5
v_mfma_f32_16x16x32_bf16 a[140:143], v[28:31], a[236:239], a[140:143]
s_add_u32 s48, s48, s34
v_xor_b32 v9, 128, v5
v_xor_b32 v10, 144, v5
v_mfma_f32_16x16x32_bf16 a[144:147], v[28:31], a[240:243], a[144:147]
s_add_u32 m0, s32, 12288
v_xor_b32 v11, 192, v5
v_xor_b32 v12, 208, v5
v_mfma_f32_16x16x32_bf16 a[148:151], v[28:31], a[244:247], a[148:151]
buffer_load_dwordx4 v1, s[12:15], s48 offen lds
v_mfma_f32_16x16x32_bf16 a[152:155], v[28:31], a[248:251], a[152:155]
v_mfma_f32_16x16x32_bf16 a[156:159], v[28:31], a[252:255], a[156:159]
s_waitcnt vmcnt(22) lgkmcnt(0)
s_barrier
v_mfma_f32_16x16x32_bf16 v[160:163], a[160:163], a[192:195], v[160:163]
ds_read_b64_tr_b16 a[224:225], v5 offset:0
v_mfma_f32_16x16x32_bf16 v[164:167], a[160:163], a[196:199], v[164:167]
v_mfma_f32_16x16x32_bf16 v[168:171], a[160:163], a[200:203], v[168:171]
ds_read_b64_tr_b16 a[226:227], v5 offset:1024
v_mfma_f32_16x16x32_bf16 v[172:175], a[160:163], a[204:207], v[172:175]
s_add_u32 s37, s31, 0
v_mfma_f32_16x16x32_bf16 v[176:179], a[160:163], a[208:211], v[176:179]
s_add_u32 m0, s33, 0
ds_read_b64_tr_b16 a[228:229], v6 offset:0
v_mfma_f32_16x16x32_bf16 v[180:183], a[160:163], a[212:215], v[180:183]
buffer_load_dwordx4 v2, s[20:23], s37 offen  lds
v_mfma_f32_16x16x32_bf16 v[184:187], a[160:163], a[216:219], v[184:187]
ds_read_b64_tr_b16 a[230:231], v6 offset:1024
v_mfma_f32_16x16x32_bf16 v[188:191], a[160:163], a[220:223], v[188:191]
ds_read_b128 a[160:163], v4 offset:0
s_add_u32 s29, s29, s93
v_mfma_f32_16x16x32_bf16 v[192:195], a[164:167], a[192:195], v[192:195]
ds_read_b64_tr_b16 a[232:233], v7 offset:0
v_mfma_f32_16x16x32_bf16 v[196:199], a[164:167], a[196:199], v[196:199]
buffer_store_dwordx4 v[88:91], v13, s[8:11], s29 offen sc1
v_mfma_f32_16x16x32_bf16 v[200:203], a[164:167], a[200:203], v[200:203]
ds_read_b64_tr_b16 a[234:235], v7 offset:1024
v_mfma_f32_16x16x32_bf16 v[204:207], a[164:167], a[204:207], v[204:207]
s_add_u32 s37, s31, 32768
v_mfma_f32_16x16x32_bf16 v[208:211], a[164:167], a[208:211], v[208:211]
s_add_u32 m0, s33, 1024
ds_read_b64_tr_b16 a[236:237], v8 offset:0
v_mfma_f32_16x16x32_bf16 v[212:215], a[164:167], a[212:215], v[212:215]
buffer_load_dwordx4 v2, s[20:23], s37 offen  lds
v_mfma_f32_16x16x32_bf16 v[216:219], a[164:167], a[216:219], v[216:219]
ds_read_b64_tr_b16 a[238:239], v8 offset:1024
v_mfma_f32_16x16x32_bf16 v[220:223], a[164:167], a[220:223], v[220:223]
ds_read_b128 a[164:167], v3 offset:1024
v_mfma_f32_16x16x32_bf16 v[224:227], a[168:171], a[192:195], v[224:227]
ds_read_b64_tr_b16 a[240:241], v9 offset:0
v_mfma_f32_16x16x32_bf16 v[228:231], a[168:171], a[196:199], v[228:231]
v_mfma_f32_16x16x32_bf16 v[232:235], a[168:171], a[200:203], v[232:235]
ds_read_b64_tr_b16 a[242:243], v9 offset:1024
v_mfma_f32_16x16x32_bf16 v[236:239], a[168:171], a[204:207], v[236:239]
s_add_u32 s37, s31, 131072
v_mfma_f32_16x16x32_bf16 v[240:243], a[168:171], a[208:211], v[240:243]
s_add_u32 m0, s33, 4096
ds_read_b64_tr_b16 a[244:245], v10 offset:0
v_mfma_f32_16x16x32_bf16 v[244:247], a[168:171], a[212:215], v[244:247]
buffer_load_dwordx4 v2, s[20:23], s37 offen  lds
v_mfma_f32_16x16x32_bf16 v[248:251], a[168:171], a[216:219], v[248:251]
ds_read_b64_tr_b16 a[246:247], v10 offset:1024
v_mfma_f32_16x16x32_bf16 v[252:255], a[168:171], a[220:223], v[252:255]
ds_read_b128 a[168:171], v4 offset:4096
v_mfma_f32_16x16x32_bf16 a[0:3], a[172:175], a[192:195], a[0:3]
ds_read_b64_tr_b16 a[248:249], v11 offset:0
v_mfma_f32_16x16x32_bf16 a[4:7], a[172:175], a[196:199], a[4:7]
v_mfma_f32_16x16x32_bf16 a[8:11], a[172:175], a[200:203], a[8:11]
ds_read_b64_tr_b16 a[250:251], v11 offset:1024
v_mfma_f32_16x16x32_bf16 a[12:15], a[172:175], a[204:207], a[12:15]
s_add_u32 s37, s31, 163840
v_mfma_f32_16x16x32_bf16 a[16:19], a[172:175], a[208:211], a[16:19]
s_add_u32 m0, s33, 5120
ds_read_b64_tr_b16 a[252:253], v12 offset:0
v_mfma_f32_16x16x32_bf16 a[20:23], a[172:175], a[212:215], a[20:23]
buffer_load_dwordx4 v2, s[20:23], s37 offen  lds
v_mfma_f32_16x16x32_bf16 a[24:27], a[172:175], a[216:219], a[24:27]
ds_read_b64_tr_b16 a[254:255], v12 offset:1024
v_mfma_f32_16x16x32_bf16 a[28:31], a[172:175], a[220:223], a[28:31]
ds_read_b128 a[172:175], v3 offset:5120
s_add_u32 s29, s29, s44
v_mfma_f32_16x16x32_bf16 a[32:35], a[176:179], a[192:195], a[32:35]
s_add_u32 s31, s31, 262144
s_add_u32 s33, s33, 16384
v_mfma_f32_16x16x32_bf16 a[36:39], a[176:179], a[196:199], a[36:39]
s_and_b32 s33, s33, 65535
buffer_store_dwordx4 v[92:95], v13, s[8:11], s29 offen sc1
v_mfma_f32_16x16x32_bf16 a[40:43], a[176:179], a[200:203], a[40:43]
ds_read_b128 v[28:31], v3 offset:13312
v_mfma_f32_16x16x32_bf16 a[44:47], a[176:179], a[204:207], a[44:47]
s_add_u32 s48, s48, s34
v_mfma_f32_16x16x32_bf16 a[48:51], a[176:179], a[208:211], a[48:51]
s_add_u32 m0, s32, 16384
v_mfma_f32_16x16x32_bf16 a[52:55], a[176:179], a[212:215], a[52:55]
buffer_load_dwordx4 v1, s[12:15], s48 offen lds
v_mfma_f32_16x16x32_bf16 a[56:59], a[176:179], a[216:219], a[56:59]
v_mfma_f32_16x16x32_bf16 a[60:63], a[176:179], a[220:223], a[60:63]
ds_read_b128 a[176:179], v4 offset:8192
v_mfma_f32_16x16x32_bf16 a[64:67], a[180:183], a[192:195], a[64:67]
v_mfma_f32_16x16x32_bf16 a[68:71], a[180:183], a[196:199], a[68:71]
v_mfma_f32_16x16x32_bf16 a[72:75], a[180:183], a[200:203], a[72:75]
v_mfma_f32_16x16x32_bf16 a[76:79], a[180:183], a[204:207], a[76:79]
s_add_u32 s48, s48, s34
v_mfma_f32_16x16x32_bf16 a[80:83], a[180:183], a[208:211], a[80:83]
s_add_u32 m0, s32, 20480
v_mfma_f32_16x16x32_bf16 a[84:87], a[180:183], a[212:215], a[84:87]
buffer_load_dwordx4 v1, s[12:15], s48 offen lds
v_mfma_f32_16x16x32_bf16 a[88:91], a[180:183], a[216:219], a[88:91]
buffer_load_dword v15, v14, s[96:99], s100 offen
s_add_u32 s100, s100, 8192
v_mfma_f32_16x16x32_bf16 a[92:95], a[180:183], a[220:223], a[92:95]
ds_read_b128 a[180:183], v3 offset:9216
v_mfma_f32_16x16x32_bf16 a[96:99], a[184:187], a[192:195], a[96:99]
v_mfma_f32_16x16x32_bf16 a[100:103], a[184:187], a[196:199], a[100:103]
v_mfma_f32_16x16x32_bf16 a[104:107], a[184:187], a[200:203], a[104:107]
v_mfma_f32_16x16x32_bf16 a[108:111], a[184:187], a[204:207], a[108:111]
s_add_u32 s48, s48, s34
v_mfma_f32_16x16x32_bf16 a[112:115], a[184:187], a[208:211], a[112:115]
s_add_u32 m0, s32, 24576
v_mfma_f32_16x16x32_bf16 a[116:119], a[184:187], a[212:215], a[116:119]
buffer_load_dwordx4 v1, s[12:15], s48 offen lds
v_mfma_f32_16x16x32_bf16 a[120:123], a[184:187], a[216:219], a[120:123]
v_mfma_f32_16x16x32_bf16 a[124:127], a[184:187], a[220:223], a[124:127]
ds_read_b128 a[184:187], v4 offset:12288
v_mfma_f32_16x16x32_bf16 a[128:131], a[188:191], a[192:195], a[128:131]
v_mfma_f32_16x16x32_bf16 a[132:135], a[188:191], a[196:199], a[132:135]
v_add_u32 v3, 32768, v3
v_subrev_u32 v19, 98304, v3
v_cmp_le_u32 vcc, 163840, v3
v_mfma_f32_16x16x32_bf16 a[136:139], a[188:191], a[200:203], a[136:139]
v_add_u32 v5, 16384, v5
v_and_b32 v5, 65535, v5
v_xor_b32 v6, 16, v5
v_mfma_f32_16x16x32_bf16 a[140:143], a[188:191], a[204:207], a[140:143]
s_add_u32 s48, s48, s34
v_xor_b32 v7, 64, v5
v_xor_b32 v8, 80, v5
v_mfma_f32_16x16x32_bf16 a[144:147], a[188:191], a[208:211], a[144:147]
s_add_u32 m0, s32, 28672
v_xor_b32 v9, 128, v5
v_xor_b32 v10, 144, v5
v_mfma_f32_16x16x32_bf16 a[148:151], a[188:191], a[212:215], a[148:151]
buffer_load_dwordx4 v1, s[12:15], s48 offen lds
v_xor_b32 v11, 192, v5
v_xor_b32 v12, 208, v5
v_mfma_f32_16x16x32_bf16 a[152:155], a[188:191], a[216:219], a[152:155]
s_add_u32 s30, s30, 128
s_add_u32 s32, s32, 32768
s_sub_u32 s48, s32, 98304
v_mfma_f32_16x16x32_bf16 a[156:159], a[188:191], a[220:223], a[156:159]
s_cmp_ge_u32 s32, 163840
s_cselect_b32 s32, s48, s32
v_cndmask_b32 v3, v3, v19, vcc
v_xor_b32 v4, 64, v3
s_waitcnt vmcnt(22) lgkmcnt(0)
s_barrier
v_mfma_f32_16x16x32_bf16 v[160:163], a[160:163], a[224:227], v[160:163]
ds_read_b64_tr_b16 a[192:193], v5 offset:0
v_mfma_f32_16x16x32_bf16 v[164:167], a[160:163], a[228:231], v[164:167]
v_mfma_f32_16x16x32_bf16 v[168:171], a[160:163], a[232:235], v[168:171]
ds_read_b64_tr_b16 a[194:195], v5 offset:1024
v_mfma_f32_16x16x32_bf16 v[172:175], a[160:163], a[236:239], v[172:175]
s_add_u32 s37, s31, 0
v_mfma_f32_16x16x32_bf16 v[176:179], a[160:163], a[240:243], v[176:179]
s_add_u32 m0, s33, 0
ds_read_b64_tr_b16 a[196:197], v6 offset:0
v_mfma_f32_16x16x32_bf16 v[180:183], a[160:163], a[244:247], v[180:183]
buffer_load_dwordx4 v2, s[20:23], s37 offen  lds
v_mfma_f32_16x16x32_bf16 v[184:187], a[160:163], a[248:251], v[184:187]
ds_read_b64_tr_b16 a[198:199], v6 offset:1024
v_mfma_f32_16x16x32_bf16 v[188:191], a[160:163], a[252:255], v[188:191]
ds_read_b128 a[160:163], v3 offset:0
s_add_u32 s60, s60, s92
v_mfma_f32_16x16x32_bf16 v[192:195], a[164:167], a[224:227], v[192:195]
s_mov_b32 s29, s60
ds_read_b64_tr_b16 a[200:201], v7 offset:0
v_mfma_f32_16x16x32_bf16 v[196:199], a[164:167], a[228:231], v[196:199]
buffer_store_dwordx4 v[96:99], v13, s[8:11], s29 offen sc1
v_mfma_f32_16x16x32_bf16 v[200:203], a[164:167], a[232:235], v[200:203]
ds_read_b64_tr_b16 a[202:203], v7 offset:1024
v_mfma_f32_16x16x32_bf16 v[204:207], a[164:167], a[236:239], v[204:207]
s_add_u32 s37, s31, 32768
v_mfma_f32_16x16x32_bf16 v[208:211], a[164:167], a[240:243], v[208:211]
s_add_u32 m0, s33, 1024
ds_read_b64_tr_b16 a[204:205], v8 offset:0
v_mfma_f32_16x16x32_bf16 v[212:215], a[164:167], a[244:247], v[212:215]
buffer_load_dwordx4 v2, s[20:23], s37 offen  lds
v_mfma_f32_16x16x32_bf16 v[216:219], a[164:167], a[248:251], v[216:219]
ds_read_b64_tr_b16 a[206:207], v8 offset:1024
v_mfma_f32_16x16x32_bf16 v[220:223], a[164:167], a[252:255], v[220:223]
ds_read_b128 a[164:167], v4 offset:1024
v_mfma_f32_16x16x32_bf16 v[224:227], a[168:171], a[224:227], v[224:227]
ds_read_b64_tr_b16 a[208:209], v9 offset:0
v_mfma_f32_16x16x32_bf16 v[228:231], a[168:171], a[228:231], v[228:231]
v_mfma_f32_16x16x32_bf16 v[232:235], a[168:171], a[232:235], v[232:235]
ds_read_b64_tr_b16 a[210:211], v9 offset:1024
v_mfma_f32_16x16x32_bf16 v[236:239], a[168:171], a[236:239], v[236:239]
s_add_u32 s37, s31, 131072
v_mfma_f32_16x16x32_bf16 v[240:243], a[168:171], a[240:243], v[240:243]
s_add_u32 m0, s33, 4096
ds_read_b64_tr_b16 a[212:213], v10 offset:0
v_mfma_f32_16x16x32_bf16 v[244:247], a[168:171], a[244:247], v[244:247]
buffer_load_dwordx4 v2, s[20:23], s37 offen  lds
v_mfma_f32_16x16x32_bf16 v[248:251], a[168:171], a[248:251], v[248:251]
ds_read_b64_tr_b16 a[214:215], v10 offset:1024
v_mfma_f32_16x16x32_bf16 v[252:255], a[168:171], a[252:255], v[252:255]
ds_read_b128 a[168:171], v3 offset:4096
v_mfma_f32_16x16x32_bf16 a[0:3], a[172:175], a[224:227], a[0:3]
ds_read_b64_tr_b16 a[216:217], v11 offset:0
v_mfma_f32_16x16x32_bf16 a[4:7], a[172:175], a[228:231], a[4:7]
v_mfma_f32_16x16x32_bf16 a[8:11], a[172:175], a[232:235], a[8:11]
ds_read_b64_tr_b16 a[218:219], v11 offset:1024
v_mfma_f32_16x16x32_bf16 a[12:15], a[172:175], a[236:239], a[12:15]
s_add_u32 s37, s31, 163840
v_mfma_f32_16x16x32_bf16 a[16:19], a[172:175], a[240:243], a[16:19]
s_add_u32 m0, s33, 5120
ds_read_b64_tr_b16 a[220:221], v12 offset:0
v_mfma_f32_16x16x32_bf16 a[20:23], a[172:175], a[244:247], a[20:23]
buffer_load_dwordx4 v2, s[20:23], s37 offen  lds
v_mfma_f32_16x16x32_bf16 a[24:27], a[172:175], a[248:251], a[24:27]
ds_read_b64_tr_b16 a[222:223], v12 offset:1024
v_mfma_f32_16x16x32_bf16 a[28:31], a[172:175], a[252:255], a[28:31]
ds_read_b128 a[172:175], v4 offset:5120
s_add_u32 s29, s29, s44
v_mfma_f32_16x16x32_bf16 a[32:35], a[176:179], a[224:227], a[32:35]
s_add_u32 s31, s31, 262144
s_add_u32 s33, s33, 16384
v_mfma_f32_16x16x32_bf16 a[36:39], a[176:179], a[228:231], a[36:39]
s_and_b32 s33, s33, 65535
buffer_store_dwordx4 v[100:103], v13, s[8:11], s29 offen sc1
v_mfma_f32_16x16x32_bf16 a[40:43], a[176:179], a[232:235], a[40:43]
ds_read_b128 a[188:191], v4 offset:13312
v_mfma_f32_16x16x32_bf16 a[44:47], a[176:179], a[236:239], a[44:47]
s_mov_b32 s48, s30
v_mfma_f32_16x16x32_bf16 a[48:51], a[176:179], a[240:243], a[48:51]
s_add_u32 m0, s32, 0
v_mfma_f32_16x16x32_bf16 a[52:55], a[176:179], a[244:247], a[52:55]
buffer_load_dwordx4 v1, s[12:15], s48 offen lds
v_mfma_f32_16x16x32_bf16 a[56:59], a[176:179], a[248:251], a[56:59]
v_mfma_f32_16x16x32_bf16 a[60:63], a[176:179], a[252:255], a[60:63]
ds_read_b128 a[176:179], v3 offset:8192
v_mfma_f32_16x16x32_bf16 a[64:67], a[180:183], a[224:227], a[64:67]
v_mfma_f32_16x16x32_bf16 a[68:71], a[180:183], a[228:231], a[68:71]
v_mfma_f32_16x16x32_bf16 a[72:75], a[180:183], a[232:235], a[72:75]
v_mfma_f32_16x16x32_bf16 a[76:79], a[180:183], a[236:239], a[76:79]
s_add_u32 s48, s48, s34
v_mfma_f32_16x16x32_bf16 a[80:83], a[180:183], a[240:243], a[80:83]
s_add_u32 m0, s32, 4096
v_mfma_f32_16x16x32_bf16 a[84:87], a[180:183], a[244:247], a[84:87]
buffer_load_dwordx4 v1, s[12:15], s48 offen lds
v_mfma_f32_16x16x32_bf16 a[88:91], a[180:183], a[248:251], a[88:91]
buffer_load_dword v15, v14, s[96:99], s100 offen
s_add_u32 s100, s100, 8192
v_mfma_f32_16x16x32_bf16 a[92:95], a[180:183], a[252:255], a[92:95]
ds_read_b128 a[180:183], v4 offset:9216
v_mfma_f32_16x16x32_bf16 a[96:99], a[184:187], a[224:227], a[96:99]
v_mfma_f32_16x16x32_bf16 a[100:103], a[184:187], a[228:231], a[100:103]
v_mfma_f32_16x16x32_bf16 a[104:107], a[184:187], a[232:235], a[104:107]
v_mfma_f32_16x16x32_bf16 a[108:111], a[184:187], a[236:239], a[108:111]
s_add_u32 s48, s48, s34
v_mfma_f32_16x16x32_bf16 a[112:115], a[184:187], a[240:243], a[112:115]
s_add_u32 m0, s32, 8192
v_mfma_f32_16x16x32_bf16 a[116:119], a[184:187], a[244:247], a[116:119]
buffer_load_dwordx4 v1, s[12:15], s48 offen lds
v_mfma_f32_16x16x32_bf16 a[120:123], a[184:187], a[248:251], a[120:123]
v_mfma_f32_16x16x32_bf16 a[124:127], a[184:187], a[252:255], a[124:127]
ds_read_b128 a[184:187], v3 offset:12288
s_add_u32 s29, s29, s93
v_mfma_f32_16x16x32_bf16 a[128:131], v[28:31], a[224:227], a[128:131]
v_mfma_f32_16x16x32_bf16 a[132:135], v[28:31], a[228:231], a[132:135]
buffer_store_dwordx4 v[104:107], v13, s[8:11], s29 offen sc1
v_add_u32 v5, 16384, v5
v_and_b32 v5, 65535, v5
v_mfma_f32_16x16x32_bf16 a[136:139], v[28:31], a[232:235], a[136:139]
v_xor_b32 v6, 16, v5
v_xor_b32 v7, 64, v5
v_xor_b32 v8, 80, v5
v_mfma_f32_16x16x32_bf16 a[140:143], v[28:31], a[236:239], a[140:143]
s_add_u32 s48, s48, s34
v_xor_b32 v9, 128, v5
v_xor_b32 v10, 144, v5
v_mfma_f32_16x16x32_bf16 a[144:147], v[28:31], a[240:243], a[144:147]
s_add_u32 m0, s32, 12288
v_xor_b32 v11, 192, v5
v_xor_b32 v12, 208, v5
v_mfma_f32_16x16x32_bf16 a[148:151], v[28:31], a[244:247], a[148:151]
buffer_load_dwordx4 v1, s[12:15], s48 offen lds
v_mfma_f32_16x16x32_bf16 a[152:155], v[28:31], a[248:251], a[152:155]
v_mfma_f32_16x16x32_bf16 a[156:159], v[28:31], a[252:255], a[156:159]
s_waitcnt vmcnt(23) lgkmcnt(0)
s_barrier
v_mfma_f32_16x16x32_bf16 v[160:163], a[160:163], a[192:195], v[160:163]
ds_read_b64_tr_b16 a[224:225], v5 offset:0
v_mfma_f32_16x16x32_bf16 v[164:167], a[160:163], a[196:199], v[164:167]
v_mfma_f32_16x16x32_bf16 v[168:171], a[160:163], a[200:203], v[168:171]
ds_read_b64_tr_b16 a[226:227], v5 offset:1024
v_mfma_f32_16x16x32_bf16 v[172:175], a[160:163], a[204:207], v[172:175]
s_add_u32 s37, s31, 0
v_mfma_f32_16x16x32_bf16 v[176:179], a[160:163], a[208:211], v[176:179]
s_add_u32 m0, s33, 0
ds_read_b64_tr_b16 a[228:229], v6 offset:0
v_mfma_f32_16x16x32_bf16 v[180:183], a[160:163], a[212:215], v[180:183]
buffer_load_dwordx4 v2, s[20:23], s37 offen  lds
v_mfma_f32_16x16x32_bf16 v[184:187], a[160:163], a[216:219], v[184:187]
ds_read_b64_tr_b16 a[230:231], v6 offset:1024
v_mfma_f32_16x16x32_bf16 v[188:191], a[160:163], a[220:223], v[188:191]
ds_read_b128 a[160:163], v4 offset:0
s_add_u32 s29, s29, s44
v_mfma_f32_16x16x32_bf16 v[192:195], a[164:167], a[192:195], v[192:195]
ds_read_b64_tr_b16 a[232:233], v7 offset:0
v_mfma_f32_16x16x32_bf16 v[196:199], a[164:167], a[196:199], v[196:199]
buffer_store_dwordx4 v[108:111], v13, s[8:11], s29 offen sc1
v_mfma_f32_16x16x32_bf16 v[200:203], a[164:167], a[200:203], v[200:203]
ds_read_b64_tr_b16 a[234:235], v7 offset:1024
v_mfma_f32_16x16x32_bf16 v[204:207], a[164:167], a[204:207], v[204:207]
s_add_u32 s37, s31, 32768
v_mfma_f32_16x16x32_bf16 v[208:211], a[164:167], a[208:211], v[208:211]
s_add_u32 m0, s33, 1024
ds_read_b64_tr_b16 a[236:237], v8 offset:0
v_mfma_f32_16x16x32_bf16 v[212:215], a[164:167], a[212:215], v[212:215]
buffer_load_dwordx4 v2, s[20:23], s37 offen  lds
v_mfma_f32_16x16x32_bf16 v[216:219], a[164:167], a[216:219], v[216:219]
ds_read_b64_tr_b16 a[238:239], v8 offset:1024
v_mfma_f32_16x16x32_bf16 v[220:223], a[164:167], a[220:223], v[220:223]
ds_read_b128 a[164:167], v3 offset:1024
v_mfma_f32_16x16x32_bf16 v[224:227], a[168:171], a[192:195], v[224:227]
ds_read_b64_tr_b16 a[240:241], v9 offset:0
v_mfma_f32_16x16x32_bf16 v[228:231], a[168:171], a[196:199], v[228:231]
v_mfma_f32_16x16x32_bf16 v[232:235], a[168:171], a[200:203], v[232:235]
ds_read_b64_tr_b16 a[242:243], v9 offset:1024
v_mfma_f32_16x16x32_bf16 v[236:239], a[168:171], a[204:207], v[236:239]
s_add_u32 s37, s31, 131072
v_mfma_f32_16x16x32_bf16 v[240:243], a[168:171], a[208:211], v[240:243]
s_add_u32 m0, s33, 4096
ds_read_b64_tr_b16 a[244:245], v10 offset:0
v_mfma_f32_16x16x32_bf16 v[244:247], a[168:171], a[212:215], v[244:247]
buffer_load_dwordx4 v2, s[20:23], s37 offen  lds
v_mfma_f32_16x16x32_bf16 v[248:251], a[168:171], a[216:219], v[248:251]
ds_read_b64_tr_b16 a[246:247], v10 offset:1024
v_mfma_f32_16x16x32_bf16 v[252:255], a[168:171], a[220:223], v[252:255]
ds_read_b128 a[168:171], v4 offset:4096
v_mfma_f32_16x16x32_bf16 a[0:3], a[172:175], a[192:195], a[0:3]
ds_read_b64_tr_b16 a[248:249], v11 offset:0
v_mfma_f32_16x16x32_bf16 a[4:7], a[172:175], a[196:199], a[4:7]
v_mfma_f32_16x16x32_bf16 a[8:11], a[172:175], a[200:203], a[8:11]
ds_read_b64_tr_b16 a[250:251], v11 offset:1024
v_mfma_f32_16x16x32_bf16 a[12:15], a[172:175], a[204:207], a[12:15]
s_add_u32 s37, s31, 163840
v_mfma_f32_16x16x32_bf16 a[16:19], a[172:175], a[208:211], a[16:19]
s_add_u32 m0, s33, 5120
ds_read_b64_tr_b16 a[252:253], v12 offset:0
v_mfma_f32_16x16x32_bf16 a[20:23], a[172:175], a[212:215], a[20:23]
buffer_load_dwordx4 v2, s[20:23], s37 offen  lds
v_mfma_f32_16x16x32_bf16 a[24:27], a[172:175], a[216:219], a[24:27]
ds_read_b64_tr_b16 a[254:255], v12 offset:1024
v_mfma_f32_16x16x32_bf16 a[28:31], a[172:175], a[220:223], a[28:31]
ds_read_b128 a[172:175], v3 offset:5120
s_add_u32 s29, s29, s93
v_mfma_f32_16x16x32_bf16 a[32:35], a[176:179], a[192:195], a[32:35]
s_add_u32 s31, s31, 262144
s_add_u32 s33, s33, 16384
v_mfma_f32_16x16x32_bf16 a[36:39], a[176:179], a[196:199], a[36:39]
s_and_b32 s33, s33, 65535
buffer_store_dwordx4 v[112:115], v13, s[8:11], s29 offen sc1
v_mfma_f32_16x16x32_bf16 a[40:43], a[176:179], a[200:203], a[40:43]
ds_read_b128 v[28:31], v3 offset:13312
v_mfma_f32_16x16x32_bf16 a[44:47], a[176:179], a[204:207], a[44:47]
s_add_u32 s48, s48, s34
v_mfma_f32_16x16x32_bf16 a[48:51], a[176:179], a[208:211], a[48:51]
s_add_u32 m0, s32, 16384
v_mfma_f32_16x16x32_bf16 a[52:55], a[176:179], a[212:215], a[52:55]
buffer_load_dwordx4 v1, s[12:15], s48 offen lds
v_mfma_f32_16x16x32_bf16 a[56:59], a[176:179], a[216:219], a[56:59]
v_mfma_f32_16x16x32_bf16 a[60:63], a[176:179], a[220:223], a[60:63]
ds_read_b128 a[176:179], v4 offset:8192
v_mfma_f32_16x16x32_bf16 a[64:67], a[180:183], a[192:195], a[64:67]
v_mfma_f32_16x16x32_bf16 a[68:71], a[180:183], a[196:199], a[68:71]
v_mfma_f32_16x16x32_bf16 a[72:75], a[180:183], a[200:203], a[72:75]
v_mfma_f32_16x16x32_bf16 a[76:79], a[180:183], a[204:207], a[76:79]
s_add_u32 s48, s48, s34
v_mfma_f32_16x16x32_bf16 a[80:83], a[180:183], a[208:211], a[80:83]
s_add_u32 m0, s32, 20480
v_mfma_f32_16x16x32_bf16 a[84:87], a[180:183], a[212:215], a[84:87]
buffer_load_dwordx4 v1, s[12:15], s48 offen lds
v_mfma_f32_16x16x32_bf16 a[88:91], a[180:183], a[216:219], a[88:91]
buffer_load_dword v15, v14, s[96:99], s100 offen
s_add_u32 s100, s100, 8192
v_mfma_f32_16x16x32_bf16 a[92:95], a[180:183], a[220:223], a[92:95]
ds_read_b128 a[180:183], v3 offset:9216
v_mfma_f32_16x16x32_bf16 a[96:99], a[184:187], a[192:195], a[96:99]
v_mfma_f32_16x16x32_bf16 a[100:103], a[184:187], a[196:199], a[100:103]
v_mfma_f32_16x16x32_bf16 a[104:107], a[184:187], a[200:203], a[104:107]
v_mfma_f32_16x16x32_bf16 a[108:111], a[184:187], a[204:207], a[108:111]
s_add_u32 s48, s48, s34
v_mfma_f32_16x16x32_bf16 a[112:115], a[184:187], a[208:211], a[112:115]
s_add_u32 m0, s32, 24576
v_mfma_f32_16x16x32_bf16 a[116:119], a[184:187], a[212:215], a[116:119]
buffer_load_dwordx4 v1, s[12:15], s48 offen lds
v_mfma_f32_16x16x32_bf16 a[120:123], a[184:187], a[216:219], a[120:123]
v_mfma_f32_16x16x32_bf16 a[124:127], a[184:187], a[220:223], a[124:127]
ds_read_b128 a[184:187], v4 offset:12288
s_add_u32 s29, s29, s44
v_mfma_f32_16x16x32_bf16 a[128:131], a[188:191], a[192:195], a[128:131]
v_mfma_f32_16x16x32_bf16 a[132:135], a[188:191], a[196:199], a[132:135]
buffer_store_dwordx4 v[116:119], v13, s[8:11], s29 offen sc1
v_add_u32 v3, 32768, v3
v_subrev_u32 v19, 98304, v3
v_mfma_f32_16x16x32_bf16 a[136:139], a[188:191], a[200:203], a[136:139]
v_cmp_le_u32 vcc, 163840, v3
v_add_u32 v5, 16384, v5
v_and_b32 v5, 65535, v5
v_mfma_f32_16x16x32_bf16 a[140:143], a[188:191], a[204:207], a[140:143]
s_add_u32 s48, s48, s34
v_xor_b32 v6, 16, v5
v_xor_b32 v7, 64, v5
v_mfma_f32_16x16x32_bf16 a[144:147], a[188:191], a[208:211], a[144:147]
s_add_u32 m0, s32, 28672
v_xor_b32 v8, 80, v5
v_xor_b32 v9, 128, v5
v_mfma_f32_16x16x32_bf16 a[148:151], a[188:191], a[212:215], a[148:151]
buffer_load_dwordx4 v1, s[12:15], s48 offen lds
v_xor_b32 v10, 144, v5
v_xor_b32 v11, 192, v5
v_mfma_f32_16x16x32_bf16 a[152:155], a[188:191], a[216:219], a[152:155]
s_add_u32 s30, s30, 128
s_add_u32 s32, s32, 32768
s_sub_u32 s48, s32, 98304
v_mfma_f32_16x16x32_bf16 a[156:159], a[188:191], a[220:223], a[156:159]
s_cmp_ge_u32 s32, 163840
s_cselect_b32 s32, s48, s32
v_xor_b32 v12, 208, v5
v_cndmask_b32 v3, v3, v19, vcc
v_xor_b32 v4, 64, v3
s_waitcnt vmcnt(24) lgkmcnt(0)
s_barrier
v_mfma_f32_16x16x32_bf16 v[160:163], a[160:163], a[224:227], v[160:163]
ds_read_b64_tr_b16 a[192:193], v5 offset:0
v_mfma_f32_16x16x32_bf16 v[164:167], a[160:163], a[228:231], v[164:167]
v_mfma_f32_16x16x32_bf16 v[168:171], a[160:163], a[232:235], v[168:171]
ds_read_b64_tr_b16 a[194:195], v5 offset:1024
v_mfma_f32_16x16x32_bf16 v[172:175], a[160:163], a[236:239], v[172:175]
s_add_u32 s37, s31, 0
v_mfma_f32_16x16x32_bf16 v[176:179], a[160:163], a[240:243], v[176:179]
s_add_u32 m0, s33, 0
ds_read_b64_tr_b16 a[196:197], v6 offset:0
v_mfma_f32_16x16x32_bf16 v[180:183], a[160:163], a[244:247], v[180:183]
buffer_load_dwordx4 v2, s[20:23], s37 offen  lds
v_mfma_f32_16x16x32_bf16 v[184:187], a[160:163], a[248:251], v[184:187]
ds_read_b64_tr_b16 a[198:199], v6 offset:1024
v_mfma_f32_16x16x32_bf16 v[188:191], a[160:163], a[252:255], v[188:191]
ds_read_b128 a[160:163], v3 offset:0
s_add_u32 s29, s29, s93
v_mfma_f32_16x16x32_bf16 v[192:195], a[164:167], a[224:227], v[192:195]
ds_read_b64_tr_b16 a[200:201], v7 offset:0
v_mfma_f32_16x16x32_bf16 v[196:199], a[164:167], a[228:231], v[196:199]
buffer_store_dwordx4 v[120:123], v13, s[8:11], s29 offen sc1
v_mfma_f32_16x16x32_bf16 v[200:203], a[164:167], a[232:235], v[200:203]
ds_read_b64_tr_b16 a[202:203], v7 offset:1024
v_mfma_f32_16x16x32_bf16 v[204:207], a[164:167], a[236:239], v[204:207]
s_add_u32 s37, s31, 32768
v_mfma_f32_16x16x32_bf16 v[208:211], a[164:167], a[240:243], v[208:211]
s_add_u32 m0, s33, 1024
ds_read_b64_tr_b16 a[204:205], v8 offset:0
v_mfma_f32_16x16x32_bf16 v[212:215], a[164:167], a[244:247], v[212:215]
buffer_load_dwordx4 v2, s[20:23], s37 offen  lds
v_mfma_f32_16x16x32_bf16 v[216:219], a[164:167], a[248:251], v[216:219]
ds_read_b64_tr_b16 a[206:207], v8 offset:1024
v_mfma_f32_16x16x32_bf16 v[220:223], a[164:167], a[252:255], v[220:223]
ds_read_b128 a[164:167], v4 offset:1024
v_mfma_f32_16x16x32_bf16 v[224:227], a[168:171], a[224:227], v[224:227]
ds_read_b64_tr_b16 a[208:209], v9 offset:0
v_mfma_f32_16x16x32_bf16 v[228:231], a[168:171], a[228:231], v[228:231]
v_mfma_f32_16x16x32_bf16 v[232:235], a[168:171], a[232:235], v[232:235]
ds_read_b64_tr_b16 a[210:211], v9 offset:1024
v_mfma_f32_16x16x32_bf16 v[236:239], a[168:171], a[236:239], v[236:239]
s_add_u32 s37, s31, 131072
v_mfma_f32_16x16x32_bf16 v[240:243], a[168:171], a[240:243], v[240:243]
s_add_u32 m0, s33, 4096
ds_read_b64_tr_b16 a[212:213], v10 offset:0
v_mfma_f32_16x16x32_bf16 v[244:247], a[168:171], a[244:247], v[244:247]
buffer_load_dwordx4 v2, s[20:23], s37 offen  lds
v_mfma_f32_16x16x32_bf16 v[248:251], a[168:171], a[248:251], v[248:251]
ds_read_b64_tr_b16 a[214:215], v10 offset:1024
v_mfma_f32_16x16x32_bf16 v[252:255], a[168:171], a[252:255], v[252:255]
ds_read_b128 a[168:171], v3 offset:4096
v_mfma_f32_16x16x32_bf16 a[0:3], a[172:175], a[224:227], a[0:3]
ds_read_b64_tr_b16 a[216:217], v11 offset:0
v_mfma_f32_16x16x32_bf16 a[4:7], a[172:175], a[228:231], a[4:7]
v_mfma_f32_16x16x32_bf16 a[8:11], a[172:175], a[232:235], a[8:11]
ds_read_b64_tr_b16 a[218:219], v11 offset:1024
v_mfma_f32_16x16x32_bf16 a[12:15], a[172:175], a[236:239], a[12:15]
s_add_u32 s37, s31, 163840
v_mfma_f32_16x16x32_bf16 a[16:19], a[172:175], a[240:243], a[16:19]
s_add_u32 m0, s33, 5120
ds_read_b64_tr_b16 a[220:221], v12 offset:0
v_mfma_f32_16x16x32_bf16 a[20:23], a[172:175], a[244:247], a[20:23]
buffer_load_dwordx4 v2, s[20:23], s37 offen  lds
v_mfma_f32_16x16x32_bf16 a[24:27], a[172:175], a[248:251], a[24:27]
ds_read_b64_tr_b16 a[222:223], v12 offset:1024
v_mfma_f32_16x16x32_bf16 a[28:31], a[172:175], a[252:255], a[28:31]
ds_read_b128 a[172:175], v4 offset:5120
s_add_u32 s29, s29, s44
v_mfma_f32_16x16x32_bf16 a[32:35], a[176:179], a[224:227], a[32:35]
s_add_u32 s31, s31, 262144
s_add_u32 s33, s33, 16384
v_mfma_f32_16x16x32_bf16 a[36:39], a[176:179], a[228:231], a[36:39]
s_and_b32 s33, s33, 65535
buffer_store_dwordx4 v[124:127], v13, s[8:11], s29 offen sc1
v_mfma_f32_16x16x32_bf16 a[40:43], a[176:179], a[232:235], a[40:43]
ds_read_b128 a[188:191], v4 offset:13312
v_mfma_f32_16x16x32_bf16 a[44:47], a[176:179], a[236:239], a[44:47]
s_mov_b32 s48, s30
v_mfma_f32_16x16x32_bf16 a[48:51], a[176:179], a[240:243], a[48:51]
s_add_u32 m0, s32, 0
v_mfma_f32_16x16x32_bf16 a[52:55], a[176:179], a[244:247], a[52:55]
buffer_load_dwordx4 v1, s[12:15], s48 offen lds
v_mfma_f32_16x16x32_bf16 a[56:59], a[176:179], a[248:251], a[56:59]
v_mfma_f32_16x16x32_bf16 a[60:63], a[176:179], a[252:255], a[60:63]
ds_read_b128 a[176:179], v3 offset:8192
v_mfma_f32_16x16x32_bf16 a[64:67], a[180:183], a[224:227], a[64:67]
v_mfma_f32_16x16x32_bf16 a[68:71], a[180:183], a[228:231], a[68:71]
v_mfma_f32_16x16x32_bf16 a[72:75], a[180:183], a[232:235], a[72:75]
v_mfma_f32_16x16x32_bf16 a[76:79], a[180:183], a[236:239], a[76:79]
s_add_u32 s48, s48, s34
v_mfma_f32_16x16x32_bf16 a[80:83], a[180:183], a[240:243], a[80:83]
s_add_u32 m0, s32, 4096
v_mfma_f32_16x16x32_bf16 a[84:87], a[180:183], a[244:247], a[84:87]
buffer_load_dwordx4 v1, s[12:15], s48 offen lds
v_mfma_f32_16x16x32_bf16 a[88:91], a[180:183], a[248:251], a[88:91]
buffer_load_dword v15, v14, s[96:99], s100 offen
s_add_u32 s100, s100, 8192
v_mfma_f32_16x16x32_bf16 a[92:95], a[180:183], a[252:255], a[92:95]
ds_read_b128 a[180:183], v4 offset:9216
v_mfma_f32_16x16x32_bf16 a[96:99], a[184:187], a[224:227], a[96:99]
v_mfma_f32_16x16x32_bf16 a[100:103], a[184:187], a[228:231], a[100:103]
v_mfma_f32_16x16x32_bf16 a[104:107], a[184:187], a[232:235], a[104:107]
v_mfma_f32_16x16x32_bf16 a[108:111], a[184:187], a[236:239], a[108:111]
s_add_u32 s48, s48, s34
v_mfma_f32_16x16x32_bf16 a[112:115], a[184:187], a[240:243], a[112:115]
s_add_u32 m0, s32, 8192
v_mfma_f32_16x16x32_bf16 a[116:119], a[184:187], a[244:247], a[116:119]
buffer_load_dwordx4 v1, s[12:15], s48 offen lds
v_mfma_f32_16x16x32_bf16 a[120:123], a[184:187], a[248:251], a[120:123]
v_mfma_f32_16x16x32_bf16 a[124:127], a[184:187], a[252:255], a[124:127]
ds_read_b128 a[184:187], v3 offset:12288
v_mfma_f32_16x16x32_bf16 a[128:131], v[28:31], a[224:227], a[128:131]
v_mfma_f32_16x16x32_bf16 a[132:135], v[28:31], a[228:231], a[132:135]
v_add_u32 v5, 16384, v5
v_and_b32 v5, 65535, v5
v_xor_b32 v6, 16, v5
v_mfma_f32_16x16x32_bf16 a[136:139], v[28:31], a[232:235], a[136:139]
v_xor_b32 v7, 64, v5
v_xor_b32 v8, 80, v5
v_xor_b32 v9, 128, v5
v_mfma_f32_16x16x32_bf16 a[140:143], v[28:31], a[236:239], a[140:143]
s_add_u32 s48, s48, s34
v_xor_b32 v10, 144, v5
v_xor_b32 v11, 192, v5
v_mfma_f32_16x16x32_bf16 a[144:147], v[28:31], a[240:243], a[144:147]
s_add_u32 m0, s32, 12288
v_xor_b32 v12, 208, v5
v_mfma_f32_16x16x32_bf16 a[148:151], v[28:31], a[244:247], a[148:151]
buffer_load_dwordx4 v1, s[12:15], s48 offen lds
v_mfma_f32_16x16x32_bf16 a[152:155], v[28:31], a[248:251], a[152:155]
v_mfma_f32_16x16x32_bf16 a[156:159], v[28:31], a[252:255], a[156:159]
s_cmp_eq_u32 s36, 0
s_cbranch_scc1 L_g_v12
s_waitcnt vmcnt(23) lgkmcnt(0)
s_barrier
v_mfma_f32_16x16x32_bf16 v[160:163], a[160:163], a[192:195], v[160:163]
ds_read_b64_tr_b16 a[224:225], v5 offset:0
v_mfma_f32_16x16x32_bf16 v[164:167], a[160:163], a[196:199], v[164:167]
v_mfma_f32_16x16x32_bf16 v[168:171], a[160:163], a[200:203], v[168:171]
ds_read_b64_tr_b16 a[226:227], v5 offset:1024
v_mfma_f32_16x16x32_bf16 v[172:175], a[160:163], a[204:207], v[172:175]
s_add_u32 s37, s31, 0
v_mfma_f32_16x16x32_bf16 v[176:179], a[160:163], a[208:211], v[176:179]
s_add_u32 m0, s33, 0
ds_read_b64_tr_b16 a[228:229], v6 offset:0
v_mfma_f32_16x16x32_bf16 v[180:183], a[160:163], a[212:215], v[180:183]
buffer_load_dwordx4 v2, s[20:23], s37 offen  lds
v_mfma_f32_16x16x32_bf16 v[184:187], a[160:163], a[216:219], v[184:187]
ds_read_b64_tr_b16 a[230:231], v6 offset:1024
v_mfma_f32_16x16x32_bf16 v[188:191], a[160:163], a[220:223], v[188:191]
ds_read_b128 a[160:163], v4 offset:0
v_mfma_f32_16x16x32_bf16 v[192:195], a[164:167], a[192:195], v[192:195]
ds_read_b64_tr_b16 a[232:233], v7 offset:0
v_mfma_f32_16x16x32_bf16 v[196:199], a[164:167], a[196:199], v[196:199]
v_mfma_f32_16x16x32_bf16 v[200:203], a[164:167], a[200:203], v[200:203]
ds_read_b64_tr_b16 a[234:235], v7 offset:1024
v_mfma_f32_16x16x32_bf16 v[204:207], a[164:167], a[204:207], v[204:207]
s_add_u32 s37, s31, 32768
v_mfma_f32_16x16x32_bf16 v[208:211], a[164:167], a[208:211], v[208:211]
s_add_u32 m0, s33, 1024
ds_read_b64_tr_b16 a[236:237], v8 offset:0
v_mfma_f32_16x16x32_bf16 v[212:215], a[164:167], a[212:215], v[212:215]
buffer_load_dwordx4 v2, s[20:23], s37 offen  lds
v_mfma_f32_16x16x32_bf16 v[216:219], a[164:167], a[216:219], v[216:219]
ds_read_b64_tr_b16 a[238:239], v8 offset:1024
v_mfma_f32_16x16x32_bf16 v[220:223], a[164:167], a[220:223], v[220:223]
ds_read_b128 a[164:167], v3 offset:1024
v_mfma_f32_16x16x32_bf16 v[224:227], a[168:171], a[192:195], v[224:227]
ds_read_b64_tr_b16 a[240:241], v9 offset:0
v_mfma_f32_16x16x32_bf16 v[228:231], a[168:171], a[196:199], v[228:231]
v_mfma_f32_16x16x32_bf16 v[232:235], a[168:171], a[200:203], v[232:235]
ds_read_b64_tr_b16 a[242:243], v9 offset:1024
v_mfma_f32_16x16x32_bf16 v[236:239], a[168:171], a[204:207], v[236:239]
s_add_u32 s37, s31, 131072
v_mfma_f32_16x16x32_bf16 v[240:243], a[168:171], a[208:211], v[240:243]
s_add_u32 m0, s33, 4096
ds_read_b64_tr_b16 a[244:245], v10 offset:0
v_mfma_f32_16x16x32_bf16 v[244:247], a[168:171], a[212:215], v[244:247]
buffer_load_dwordx4 v2, s[20:23], s37 offen  lds
v_mfma_f32_16x16x32_bf16 v[248:251], a[168:171], a[216:219], v[248:251]
ds_read_b64_tr_b16 a[246:247], v10 offset:1024
v_mfma_f32_16x16x32_bf16 v[252:255], a[168:171], a[220:223], v[252:255]
ds_read_b128 a[168:171], v4 offset:4096
v_mfma_f32_16x16x32_bf16 a[0:3], a[172:175], a[192:195], a[0:3]
ds_read_b64_tr_b16 a[248:249], v11 offset:0
v_mfma_f32_16x16x32_bf16 a[4:7], a[172:175], a[196:199], a[4:7]
v_mfma_f32_16x16x32_bf16 a[8:11], a[172:175], a[200:203], a[8:11]
ds_read_b64_tr_b16 a[250:251], v11 offset:1024
v_mfma_f32_16x16x32_bf16 a[12:15], a[172:175], a[204:207], a[12:15]
s_add_u32 s37, s31, 163840
v_mfma_f32_16x16x32_bf16 a[16:19], a[172:175], a[208:211], a[16:19]
s_add_u32 m0, s33, 5120
ds_read_b64_tr_b16 a[252:253], v12 offset:0
v_mfma_f32_16x16x32_bf16 a[20:23], a[172:175], a[212:215], a[20:23]
buffer_load_dwordx4 v2, s[20:23], s37 offen  lds
v_mfma_f32_16x16x32_bf16 a[24:27], a[172:175], a[216:219], a[24:27]
ds_read_b64_tr_b16 a[254:255], v12 offset:1024
v_mfma_f32_16x16x32_bf16 a[28:31], a[172:175], a[220:223], a[28:31]
ds_read_b128 a[172:175], v3 offset:5120
v_mfma_f32_16x16x32_bf16 a[32:35], a[176:179], a[192:195], a[32:35]
s_add_u32 s31, s31, 262144
s_add_u32 s33, s33, 16384
v_mfma_f32_16x16x32_bf16 a[36:39], a[176:179], a[196:199], a[36:39]
s_and_b32 s33, s33, 65535
ds_read_b128 v[28:31], v3 offset:13312
v_mfma_f32_16x16x32_bf16 a[40:43], a[176:179], a[200:203], a[40:43]
v_mfma_f32_16x16x32_bf16 a[44:47], a[176:179], a[204:207], a[44:47]
s_add_u32 s48, s48, s34
v_mfma_f32_16x16x32_bf16 a[48:51], a[176:179], a[208:211], a[48:51]
s_add_u32 m0, s32, 16384
v_mfma_f32_16x16x32_bf16 a[52:55], a[176:179], a[212:215], a[52:55]
buffer_load_dwordx4 v1, s[12:15], s48 offen lds
v_mfma_f32_16x16x32_bf16 a[56:59], a[176:179], a[216:219], a[56:59]
v_mfma_f32_16x16x32_bf16 a[60:63], a[176:179], a[220:223], a[60:63]
ds_read_b128 a[176:179], v4 offset:8192
v_mfma_f32_16x16x32_bf16 a[64:67], a[180:183], a[192:195], a[64:67]
v_mfma_f32_16x16x32_bf16 a[68:71], a[180:183], a[196:199], a[68:71]
v_mfma_f32_16x16x32_bf16 a[72:75], a[180:183], a[200:203], a[72:75]
v_mfma_f32_16x16x32_bf16 a[76:79], a[180:183], a[204:207], a[76:79]
s_add_u32 s48, s48, s34
v_mfma_f32_16x16x32_bf16 a[80:83], a[180:183], a[208:211], a[80:83]
s_add_u32 m0, s32, 20480
v_mfma_f32_16x16x32_bf16 a[84:87], a[180:183], a[212:215], a[84:87]
buffer_load_dwordx4 v1, s[12:15], s48 offen lds
v_mfma_f32_16x16x32_bf16 a[88:91], a[180:183], a[216:219], a[88:91]
v_mfma_f32_16x16x32_bf16 a[92:95], a[180:183], a[220:223], a[92:95]
ds_read_b128 a[180:183], v3 offset:9216
v_mfma_f32_16x16x32_bf16 a[96:99], a[184:187], a[192:195], a[96:99]
v_mfma_f32_16x16x32_bf16 a[100:103], a[184:187], a[196:199], a[100:103]
v_mfma_f32_16x16x32_bf16 a[104:107], a[184:187], a[200:203], a[104:107]
v_mfma_f32_16x16x32_bf16 a[108:111], a[184:187], a[204:207], a[108:111]
s_add_u32 s48, s48, s34
v_mfma_f32_16x16x32_bf16 a[112:115], a[184:187], a[208:211], a[112:115]
s_add_u32 m0, s32, 24576
v_mfma_f32_16x16x32_bf16 a[116:119], a[184:187], a[212:215], a[116:119]
buffer_load_dwordx4 v1, s[12:15], s48 offen lds
v_mfma_f32_16x16x32_bf16 a[120:123], a[184:187], a[216:219], a[120:123]
v_mfma_f32_16x16x32_bf16 a[124:127], a[184:187], a[220:223], a[124:127]
ds_read_b128 a[184:187], v4 offset:12288
v_mfma_f32_16x16x32_bf16 a[128:131], a[188:191], a[192:195], a[128:131]
v_mfma_f32_16x16x32_bf16 a[132:135], a[188:191], a[196:199], a[132:135]
v_add_u32 v3, 32768, v3
v_subrev_u32 v19, 98304, v3
v_cmp_le_u32 vcc, 163840, v3
v_mfma_f32_16x16x32_bf16 a[136:139], a[188:191], a[200:203], a[136:139]
v_add_u32 v5, 16384, v5
v_and_b32 v5, 65535, v5
v_xor_b32 v6, 16, v5
v_mfma_f32_16x16x32_bf16 a[140:143], a[188:191], a[204:207], a[140:143]
s_add_u32 s48, s48, s34
v_xor_b32 v7, 64, v5
v_xor_b32 v8, 80, v5
v_mfma_f32_16x16x32_bf16 a[144:147], a[188:191], a[208:211], a[144:147]
s_add_u32 m0, s32, 28672
v_xor_b32 v9, 128, v5
v_xor_b32 v10, 144, v5
v_mfma_f32_16x16x32_bf16 a[148:151], a[188:191], a[212:215], a[148:151]
buffer_load_dwordx4 v1, s[12:15], s48 offen lds
v_xor_b32 v11, 192, v5
v_xor_b32 v12, 208, v5
v_mfma_f32_16x16x32_bf16 a[152:155], a[188:191], a[216:219], a[152:155]
s_add_u32 s30, s30, 128
s_add_u32 s32, s32, 32768
s_sub_u32 s48, s32, 98304
v_mfma_f32_16x16x32_bf16 a[156:159], a[188:191], a[220:223], a[156:159]
s_cmp_ge_u32 s32, 163840
s_cselect_b32 s32, s48, s32
v_cndmask_b32 v3, v3, v19, vcc
v_xor_b32 v4, 64, v3
s_waitcnt vmcnt(19) lgkmcnt(0)
s_barrier
v_mfma_f32_16x16x32_bf16 v[160:163], a[160:163], a[224:227], v[160:163]
ds_read_b64_tr_b16 a[192:193], v5 offset:0
v_mfma_f32_16x16x32_bf16 v[164:167], a[160:163], a[228:231], v[164:167]
v_mfma_f32_16x16x32_bf16 v[168:171], a[160:163], a[232:235], v[168:171]
ds_read_b64_tr_b16 a[194:195], v5 offset:1024
v_mfma_f32_16x16x32_bf16 v[172:175], a[160:163], a[236:239], v[172:175]
s_add_u32 s37, s31, 0
v_mfma_f32_16x16x32_bf16 v[176:179], a[160:163], a[240:243], v[176:179]
s_add_u32 m0, s33, 0
ds_read_b64_tr_b16 a[196:197], v6 offset:0
v_mfma_f32_16x16x32_bf16 v[180:183], a[160:163], a[244:247], v[180:183]
buffer_load_dwordx4 v2, s[20:23], s37 offen  lds
v_mfma_f32_16x16x32_bf16 v[184:187], a[160:163], a[248:251], v[184:187]
ds_read_b64_tr_b16 a[198:199], v6 offset:1024
v_mfma_f32_16x16x32_bf16 v[188:191], a[160:163], a[252:255], v[188:191]
ds_read_b128 a[160:163], v3 offset:0
v_mfma_f32_16x16x32_bf16 v[192:195], a[164:167], a[224:227], v[192:195]
ds_read_b64_tr_b16 a[200:201], v7 offset:0
v_mfma_f32_16x16x32_bf16 v[196:199], a[164:167], a[228:231], v[196:199]
v_mfma_f32_16x16x32_bf16 v[200:203], a[164:167], a[232:235], v[200:203]
ds_read_b64_tr_b16 a[202:203], v7 offset:1024
v_mfma_f32_16x16x32_bf16 v[204:207], a[164:167], a[236:239], v[204:207]
s_add_u32 s37, s31, 32768
v_mfma_f32_16x16x32_bf16 v[208:211], a[164:167], a[240:243], v[208:211]
s_add_u32 m0, s33, 1024
ds_read_b64_tr_b16 a[204:205], v8 offset:0
v_mfma_f32_16x16x32_bf16 v[212:215], a[164:167], a[244:247], v[212:215]
buffer_load_dwordx4 v2, s[20:23], s37 offen  lds
v_mfma_f32_16x16x32_bf16 v[216:219], a[164:167], a[248:251], v[216:219]
ds_read_b64_tr_b16 a[206:207], v8 offset:1024
v_mfma_f32_16x16x32_bf16 v[220:223], a[164:167], a[252:255], v[220:223]
ds_read_b128 a[164:167], v4 offset:1024
v_mfma_f32_16x16x32_bf16 v[224:227], a[168:171], a[224:227], v[224:227]
ds_read_b64_tr_b16 a[208:209], v9 offset:0
v_mfma_f32_16x16x32_bf16 v[228:231], a[168:171], a[228:231], v[228:231]
v_mfma_f32_16x16x32_bf16 v[232:235], a[168:171], a[232:235], v[232:235]
ds_read_b64_tr_b16 a[210:211], v9 offset:1024
v_mfma_f32_16x16x32_bf16 v[236:239], a[168:171], a[236:239], v[236:239]
s_add_u32 s37, s31, 131072
v_mfma_f32_16x16x32_bf16 v[240:243], a[168:171], a[240:243], v[240:243]
s_add_u32 m0, s33, 4096
ds_read_b64_tr_b16 a[212:213], v10 offset:0
v_mfma_f32_16x16x32_bf16 v[244:247], a[168:171], a[244:247], v[244:247]
buffer_load_dwordx4 v2, s[20:23], s37 offen  lds
v_mfma_f32_16x16x32_bf16 v[248:251], a[168:171], a[248:251], v[248:251]
ds_read_b64_tr_b16 a[214:215], v10 offset:1024
v_mfma_f32_16x16x32_bf16 v[252:255], a[168:171], a[252:255], v[252:255]
ds_read_b128 a[168:171], v3 offset:4096
v_mfma_f32_16x16x32_bf16 a[0:3], a[172:175], a[224:227], a[0:3]
ds_read_b64_tr_b16 a[216:217], v11 offset:0
v_mfma_f32_16x16x32_bf16 a[4:7], a[172:175], a[228:231], a[4:7]
v_mfma_f32_16x16x32_bf16 a[8:11], a[172:175], a[232:235], a[8:11]
ds_read_b64_tr_b16 a[218:219], v11 offset:1024
v_mfma_f32_16x16x32_bf16 a[12:15], a[172:175], a[236:239], a[12:15]
s_add_u32 s37, s31, 163840
v_mfma_f32_16x16x32_bf16 a[16:19], a[172:175], a[240:243], a[16:19]
s_add_u32 m0, s33, 5120
ds_read_b64_tr_b16 a[220:221], v12 offset:0
v_mfma_f32_16x16x32_bf16 a[20:23], a[172:175], a[244:247], a[20:23]
buffer_load_dwordx4 v2, s[20:23], s37 offen  lds
v_mfma_f32_16x16x32_bf16 a[24:27], a[172:175], a[248:251], a[24:27]
ds_read_b64_tr_b16 a[222:223], v12 offset:1024
v_mfma_f32_16x16x32_bf16 a[28:31], a[172:175], a[252:255], a[28:31]
ds_read_b128 a[172:175], v4 offset:5120
v_mfma_f32_16x16x32_bf16 a[32:35], a[176:179], a[224:227], a[32:35]
s_add_u32 s31, s31, 262144
s_add_u32 s33, s33, 16384
v_mfma_f32_16x16x32_bf16 a[36:39], a[176:179], a[228:231], a[36:39]
s_and_b32 s33, s33, 65535
ds_read_b128 a[188:191], v4 offset:13312
v_mfma_f32_16x16x32_bf16 a[40:43], a[176:179], a[232:235], a[40:43]
v_mfma_f32_16x16x32_bf16 a[44:47], a[176:179], a[236:239], a[44:47]
s_mov_b32 s48, s30
v_mfma_f32_16x16x32_bf16 a[48:51], a[176:179], a[240:243], a[48:51]
s_add_u32 m0, s32, 0
v_mfma_f32_16x16x32_bf16 a[52:55], a[176:179], a[244:247], a[52:55]
buffer_load_dwordx4 v1, s[12:15], s48 offen lds
v_mfma_f32_16x16x32_bf16 a[56:59], a[176:179], a[248:251], a[56:59]
v_mfma_f32_16x16x32_bf16 a[60:63], a[176:179], a[252:255], a[60:63]
ds_read_b128 a[176:179], v3 offset:8192
v_mfma_f32_16x16x32_bf16 a[64:67], a[180:183], a[224:227], a[64:67]
v_mfma_f32_16x16x32_bf16 a[68:71], a[180:183], a[228:231], a[68:71]
v_mfma_f32_16x16x32_bf16 a[72:75], a[180:183], a[232:235], a[72:75]
v_mfma_f32_16x16x32_bf16 a[76:79], a[180:183], a[236:239], a[76:79]
s_add_u32 s48, s48, s34
v_mfma_f32_16x16x32_bf16 a[80:83], a[180:183], a[240:243], a[80:83]
s_add_u32 m0, s32, 4096
v_mfma_f32_16x16x32_bf16 a[84:87], a[180:183], a[244:247], a[84:87]
buffer_load_dwordx4 v1, s[12:15], s48 offen lds
v_mfma_f32_16x16x32_bf16 a[88:91], a[180:183], a[248:251], a[88:91]
v_mfma_f32_16x16x32_bf16 a[92:95], a[180:183], a[252:255], a[92:95]
ds_read_b128 a[180:183], v4 offset:9216
v_mfma_f32_16x16x32_bf16 a[96:99], a[184:187], a[224:227], a[96:99]
v_mfma_f32_16x16x32_bf16 a[100:103], a[184:187], a[228:231], a[100:103]
v_mfma_f32_16x16x32_bf16 a[104:107], a[184:187], a[232:235], a[104:107]
v_mfma_f32_16x16x32_bf16 a[108:111], a[184:187], a[236:239], a[108:111]
s_add_u32 s48, s48, s34
v_mfma_f32_16x16x32_bf16 a[112:115], a[184:187], a[240:243], a[112:115]
s_add_u32 m0, s32, 8192
v_mfma_f32_16x16x32_bf16 a[116:119], a[184:187], a[244:247], a[116:119]
buffer_load_dwordx4 v1, s[12:15], s48 offen lds
v_mfma_f32_16x16x32_bf16 a[120:123], a[184:187], a[248:251], a[120:123]
v_mfma_f32_16x16x32_bf16 a[124:127], a[184:187], a[252:255], a[124:127]
ds_read_b128 a[184:187], v3 offset:12288
v_mfma_f32_16x16x32_bf16 a[128:131], v[28:31], a[224:227], a[128:131]
v_mfma_f32_16x16x32_bf16 a[132:135], v[28:31], a[228:231], a[132:135]
v_add_u32 v5, 16384, v5
v_and_b32 v5, 65535, v5
v_xor_b32 v6, 16, v5
v_mfma_f32_16x16x32_bf16 a[136:139], v[28:31], a[232:235], a[136:139]
v_xor_b32 v7, 64, v5
v_xor_b32 v8, 80, v5
v_xor_b32 v9, 128, v5
v_mfma_f32_16x16x32_bf16 a[140:143], v[28:31], a[236:239], a[140:143]
s_add_u32 s48, s48, s34
v_xor_b32 v10, 144, v5
v_xor_b32 v11, 192, v5
v_mfma_f32_16x16x32_bf16 a[144:147], v[28:31], a[240:243], a[144:147]
s_add_u32 m0, s32, 12288
v_xor_b32 v12, 208, v5
v_mfma_f32_16x16x32_bf16 a[148:151], v[28:31], a[244:247], a[148:151]
buffer_load_dwordx4 v1, s[12:15], s48 offen lds
v_mfma_f32_16x16x32_bf16 a[152:155], v[28:31], a[248:251], a[152:155]
v_mfma_f32_16x16x32_bf16 a[156:159], v[28:31], a[252:255], a[156:159]
L_g_v12:
s_waitcnt vmcnt(16) lgkmcnt(0)
s_barrier
v_mfma_f32_16x16x32_bf16 v[160:163], a[160:163], a[192:195], v[160:163]
ds_read_b64_tr_b16 a[224:225], v5 offset:0
s_lshl_b32 s24, s35, 2
s_lshr_b32 s26, s88, s24
v_mfma_f32_16x16x32_bf16 v[164:167], a[160:163], a[196:199], v[164:167]
s_bfe_u32 s2, s26, 0x10003
s_and_b32 s26, s26, 7
s_or_b32 s40, s2, s61
v_mfma_f32_16x16x32_bf16 v[168:171], a[160:163], a[200:203], v[168:171]
ds_read_b64_tr_b16 a[226:227], v5 offset:1024
s_lshr_b32 s24, s17, 1
v_mfma_f32_16x16x32_bf16 v[172:175], a[160:163], a[204:207], v[172:175]
s_add_u32 s37, s31, 0
v_mfma_f32_16x16x32_bf16 v[176:179], a[160:163], a[208:211], v[176:179]
s_add_u32 m0, s33, 0
ds_read_b64_tr_b16 a[228:229], v6 offset:0
v_mfma_f32_16x16x32_bf16 v[180:183], a[160:163], a[212:215], v[180:183]
buffer_load_dwordx4 v2, s[20:23], s37 offen  lds
v_mfma_f32_16x16x32_bf16 v[184:187], a[160:163], a[216:219], v[184:187]
ds_read_b64_tr_b16 a[230:231], v6 offset:1024
v_mfma_f32_16x16x32_bf16 v[188:191], a[160:163], a[220:223], v[188:191]
ds_read_b128 a[160:163], v4 offset:0
s_add_u32 s60, s60, s92
v_mfma_f32_16x16x32_bf16 v[192:195], a[164:167], a[192:195], v[192:195]
s_mov_b32 s29, s60
ds_read_b64_tr_b16 a[232:233], v7 offset:0
v_mfma_f32_16x16x32_bf16 v[196:199], a[164:167], a[196:199], v[196:199]
buffer_store_dwordx4 v[128:131], v13, s[8:11], s29 offen sc1
v_mfma_f32_16x16x32_bf16 v[200:203], a[164:167], a[200:203], v[200:203]
ds_read_b64_tr_b16 a[234:235], v7 offset:1024
v_mfma_f32_16x16x32_bf16 v[204:207], a[164:167], a[204:207], v[204:207]
s_add_u32 s37, s31, 32768
v_mfma_f32_16x16x32_bf16 v[208:211], a[164:167], a[208:211], v[208:211]
s_add_u32 m0, s33, 1024
ds_read_b64_tr_b16 a[236:237], v8 offset:0
v_mfma_f32_16x16x32_bf16 v[212:215], a[164:167], a[212:215], v[212:215]
buffer_load_dwordx4 v2, s[20:23], s37 offen  lds
v_mfma_f32_16x16x32_bf16 v[216:219], a[164:167], a[216:219], v[216:219]
ds_read_b64_tr_b16 a[238:239], v8 offset:1024
v_mfma_f32_16x16x32_bf16 v[220:223], a[164:167], a[220:223], v[220:223]
ds_read_b128 a[164:167], v3 offset:1024
v_mfma_f32_16x16x32_bf16 v[224:227], a[168:171], a[192:195], v[224:227]
ds_read_b64_tr_b16 a[240:241], v9 offset:0
v_mfma_f32_16x16x32_bf16 v[228:231], a[168:171], a[196:199], v[228:231]
s_cmp_eq_u32 s2, 0
s_cselect_b32 s41, s24, 0
s_cselect_b32 s27, s89, s90
v_mfma_f32_16x16x32_bf16 v[232:235], a[168:171], a[200:203], v[232:235]
ds_read_b64_tr_b16 a[242:243], v9 offset:1024
s_sub_u32 s25, s24, s41
s_and_b32 s51, s41, s61
v_mfma_f32_16x16x32_bf16 v[236:239], a[168:171], a[204:207], v[236:239]
s_add_u32 s37, s31, 131072
s_lshl_b32 s51, s51, 1
s_or_b32 s51, s51, s41
v_mfma_f32_16x16x32_bf16 v[240:243], a[168:171], a[208:211], v[240:243]
s_add_u32 m0, s33, 4096
ds_read_b64_tr_b16 a[244:245], v10 offset:0
s_lshl_b32 s46, s27, s2
v_mfma_f32_16x16x32_bf16 v[244:247], a[168:171], a[212:215], v[244:247]
buffer_load_dwordx4 v2, s[20:23], s37 offen  lds
s_add_u32 s46, s46, s25
s_lshl_b32 s46, s46, 8
v_mfma_f32_16x16x32_bf16 v[248:251], a[168:171], a[216:219], v[248:251]
ds_read_b64_tr_b16 a[246:247], v10 offset:1024
s_lshl_b32 s47, s40, 7
s_add_u32 s47, s47, 1024
v_mfma_f32_16x16x32_bf16 v[252:255], a[168:171], a[220:223], v[252:255]
ds_read_b128 a[168:171], v4 offset:4096
s_mul_i32 s101, s26, s47
s_lshl_b32 s101, s101, 8
v_mfma_f32_16x16x32_bf16 a[0:3], a[172:175], a[192:195], a[0:3]
ds_read_b64_tr_b16 a[248:249], v11 offset:0
s_lshl_b32 s42, s27, 3
s_add_u32 s42, s42, s26
v_mfma_f32_16x16x32_bf16 a[4:7], a[172:175], a[196:199], a[4:7]
s_lshl_b32 s42, s42, 1
s_and_b32 s25, s17, 1
s_add_u32 s42, s42, s25
v_mfma_f32_16x16x32_bf16 a[8:11], a[172:175], a[200:203], a[8:11]
ds_read_b64_tr_b16 a[250:251], v11 offset:1024
s_lshl_b32 s42, s42, 3
s_add_u32 s42, s42, s24
v_mfma_f32_16x16x32_bf16 a[12:15], a[172:175], a[204:207], a[12:15]
s_add_u32 s37, s31, 163840
s_lshl_b32 s42, s42, 13
s_lshl_b32 s43, s27, 5
v_mfma_f32_16x16x32_bf16 a[16:19], a[172:175], a[208:211], a[16:19]
s_add_u32 m0, s33, 5120
ds_read_b64_tr_b16 a[252:253], v12 offset:0
s_add_u32 s43, s43, s26
v_mfma_f32_16x16x32_bf16 a[20:23], a[172:175], a[212:215], a[20:23]
buffer_load_dwordx4 v2, s[20:23], s37 offen  lds
s_lshl_b32 s43, s43, 2
s_lshl_b32 s24, s2, 1
v_mfma_f32_16x16x32_bf16 a[24:27], a[172:175], a[216:219], a[24:27]
ds_read_b64_tr_b16 a[254:255], v12 offset:1024
s_add_u32 s24, s24, s61
s_lshl_b32 s24, s24, 2
v_mfma_f32_16x16x32_bf16 a[28:31], a[172:175], a[220:223], a[28:31]
ds_read_b128 a[172:175], v3 offset:5120
s_add_u32 s29, s29, s44
s_lshr_b32 s25, 0x8720, s24
v_mfma_f32_16x16x32_bf16 a[32:35], a[176:179], a[192:195], a[32:35]
s_add_u32 s31, s31, 262144
s_add_u32 s33, s33, 16384
s_and_b32 s25, s25, 15
v_mfma_f32_16x16x32_bf16 a[36:39], a[176:179], a[196:199], a[36:39]
s_and_b32 s33, s33, 65535
buffer_store_dwordx4 v[132:135], v13, s[8:11], s29 offen sc1
s_lshl_b32 s25, s25, 24
v_mfma_f32_16x16x32_bf16 a[40:43], a[176:179], a[200:203], a[40:43]
ds_read_b128 v[28:31], v3 offset:13312
s_add_u32 s42, s42, s25
s_lshr_b32 s25, 0x7604, s24
v_mfma_f32_16x16x32_bf16 a[44:47], a[176:179], a[204:207], a[44:47]
s_add_u32 s48, s48, s34
s_and_b32 s25, s25, 15
s_lshl_b32 s25, s25, 12
v_mfma_f32_16x16x32_bf16 a[48:51], a[176:179], a[208:211], a[48:51]
s_add_u32 m0, s32, 16384
s_add_u32 s43, s43, s25
s_add_u32 s43, s43, 111149056
v_mfma_f32_16x16x32_bf16 a[52:55], a[176:179], a[212:215], a[52:55]
buffer_load_dwordx4 v1, s[12:15], s48 offen lds
v_mfma_f32_16x16x32_bf16 a[56:59], a[176:179], a[216:219], a[56:59]
s_cmp_lt_u32 s35, s45
s_cselect_b32 s101, s101, 536870912
s_cselect_b32 s46, s46, 536870912
v_mfma_f32_16x16x32_bf16 a[60:63], a[176:179], a[220:223], a[60:63]
ds_read_b128 a[176:179], v4 offset:8192
v_mfma_f32_16x16x32_bf16 a[64:67], a[180:183], a[192:195], a[64:67]
v_mfma_f32_16x16x32_bf16 a[68:71], a[180:183], a[196:199], a[68:71]
v_mfma_f32_16x16x32_bf16 a[72:75], a[180:183], a[200:203], a[72:75]
v_mfma_f32_16x16x32_bf16 a[76:79], a[180:183], a[204:207], a[76:79]
s_add_u32 s48, s48, s34
v_mfma_f32_16x16x32_bf16 a[80:83], a[180:183], a[208:211], a[80:83]
s_add_u32 m0, s32, 20480
v_mfma_f32_16x16x32_bf16 a[84:87], a[180:183], a[212:215], a[84:87]
buffer_load_dwordx4 v1, s[12:15], s48 offen lds
v_mfma_f32_16x16x32_bf16 a[88:91], a[180:183], a[216:219], a[88:91]
buffer_load_dword v15, v14, s[96:99], s100 offen
s_add_u32 s100, s100, 8192
v_mfma_f32_16x16x32_bf16 a[92:95], a[180:183], a[220:223], a[92:95]
ds_read_b128 a[180:183], v3 offset:9216
v_mfma_f32_16x16x32_bf16 a[96:99], a[184:187], a[192:195], a[96:99]
v_mfma_f32_16x16x32_bf16 a[100:103], a[184:187], a[196:199], a[100:103]
v_mfma_f32_16x16x32_bf16 a[104:107], a[184:187], a[200:203], a[104:107]
v_mfma_f32_16x16x32_bf16 a[108:111], a[184:187], a[204:207], a[108:111]
s_add_u32 s48, s48, s34
v_mfma_f32_16x16x32_bf16 a[112:115], a[184:187], a[208:211], a[112:115]
s_add_u32 m0, s32, 24576
v_mfma_f32_16x16x32_bf16 a[116:119], a[184:187], a[212:215], a[116:119]
buffer_load_dwordx4 v1, s[12:15], s48 offen lds
v_mfma_f32_16x16x32_bf16 a[120:123], a[184:187], a[216:219], a[120:123]
v_mfma_f32_16x16x32_bf16 a[124:127], a[184:187], a[220:223], a[124:127]
ds_read_b128 a[184:187], v4 offset:12288
s_add_u32 s29, s29, s93
v_mfma_f32_16x16x32_bf16 a[128:131], a[188:191], a[192:195], a[128:131]
v_mfma_f32_16x16x32_bf16 a[132:135], a[188:191], a[196:199], a[132:135]
buffer_store_dwordx4 v[136:139], v13, s[8:11], s29 offen sc1
v_add_u32 v3, 32768, v3
v_subrev_u32 v19, 98304, v3
v_mfma_f32_16x16x32_bf16 a[136:139], a[188:191], a[200:203], a[136:139]
v_cmp_le_u32 vcc, 163840, v3
v_add_u32 v5, 16384, v5
v_and_b32 v5, 65535, v5
v_mfma_f32_16x16x32_bf16 a[140:143], a[188:191], a[204:207], a[140:143]
s_add_u32 s48, s48, s34
v_xor_b32 v6, 16, v5
v_xor_b32 v7, 64, v5
v_mfma_f32_16x16x32_bf16 a[144:147], a[188:191], a[208:211], a[144:147]
s_add_u32 m0, s32, 28672
v_xor_b32 v8, 80, v5
v_xor_b32 v9, 128, v5
v_mfma_f32_16x16x32_bf16 a[148:151], a[188:191], a[212:215], a[148:151]
buffer_load_dwordx4 v1, s[12:15], s48 offen lds
v_xor_b32 v10, 144, v5
v_xor_b32 v11, 192, v5
v_mfma_f32_16x16x32_bf16 a[152:155], a[188:191], a[216:219], a[152:155]
s_add_u32 s30, s30, 128
s_add_u32 s32, s32, 32768
s_sub_u32 s48, s32, 98304
v_mfma_f32_16x16x32_bf16 a[156:159], a[188:191], a[220:223], a[156:159]
s_cmp_ge_u32 s32, 163840
s_cselect_b32 s32, s48, s32
v_xor_b32 v12, 208, v5
v_cndmask_b32 v3, v3, v19, vcc
v_xor_b32 v4, 64, v3
s_waitcnt vmcnt(20) lgkmcnt(0)
s_barrier
v_mfma_f32_16x16x32_bf16 v[160:163], a[160:163], a[224:227], v[160:163]
ds_read_b64_tr_b16 a[192:193], v5 offset:0
v_mfma_f32_16x16x32_bf16 v[164:167], a[160:163], a[228:231], v[164:167]
s_cmp_eq_u32 s2, 0
s_cselect_b64 s[4:5], s[52:53], s[54:55]
v_mfma_f32_16x16x32_bf16 v[168:171], a[160:163], a[232:235], v[168:171]
ds_read_b64_tr_b16 a[194:195], v5 offset:1024
s_mov_b32 s12, s4
v_mfma_f32_16x16x32_bf16 v[172:175], a[160:163], a[236:239], v[172:175]
s_add_u32 s37, s31, 0
s_and_b32 s13, s5, 0xffff
v_mfma_f32_16x16x32_bf16 v[176:179], a[160:163], a[240:243], v[176:179]
s_add_u32 m0, s33, 0
ds_read_b64_tr_b16 a[196:197], v6 offset:0
v_mfma_f32_16x16x32_bf16 v[180:183], a[160:163], a[244:247], v[180:183]
buffer_load_dwordx4 v2, s[20:23], s37 offen  lds
s_lshl_b32 s14, s47, 11
v_mfma_f32_16x16x32_bf16 v[184:187], a[160:163], a[248:251], v[184:187]
ds_read_b64_tr_b16 a[198:199], v6 offset:1024
s_mov_b32 s15, 0x20000
v_mfma_f32_16x16x32_bf16 v[188:191], a[160:163], a[252:255], v[188:191]
ds_read_b128 a[160:163], v3 offset:0
s_add_u32 s29, s29, s44
v_mfma_f32_16x16x32_bf16 v[192:195], a[164:167], a[224:227], v[192:195]
ds_read_b64_tr_b16 a[200:201], v7 offset:0
s_mov_b32 s30, s101
v_mfma_f32_16x16x32_bf16 v[196:199], a[164:167], a[228:231], v[196:199]
buffer_store_dwordx4 v[140:143], v13, s[8:11], s29 offen sc1
v_lshrrev_b32 v16, 3, v0
v_mfma_f32_16x16x32_bf16 v[200:203], a[164:167], a[232:235], v[200:203]
ds_read_b64_tr_b16 a[202:203], v7 offset:1024
v_mul_lo_u32 v16, v16, s47
v_mfma_f32_16x16x32_bf16 v[204:207], a[164:167], a[236:239], v[204:207]
s_add_u32 s37, s31, 32768
v_and_b32 v1, 0x70, v1
v_mfma_f32_16x16x32_bf16 v[208:211], a[164:167], a[240:243], v[208:211]
s_add_u32 m0, s33, 1024
ds_read_b64_tr_b16 a[204:205], v8 offset:0
v_mfma_f32_16x16x32_bf16 v[212:215], a[164:167], a[244:247], v[212:215]
buffer_load_dwordx4 v2, s[20:23], s37 offen  lds
v_add_u32 v1, v1, v16
v_mfma_f32_16x16x32_bf16 v[216:219], a[164:167], a[248:251], v[216:219]
ds_read_b64_tr_b16 a[206:207], v8 offset:1024
s_lshl_b32 s34, s47, 5
v_mfma_f32_16x16x32_bf16 v[220:223], a[164:167], a[252:255], v[220:223]
ds_read_b128 a[164:167], v4 offset:1024
v_mfma_f32_16x16x32_bf16 v[224:227], a[168:171], a[224:227], v[224:227]
ds_read_b64_tr_b16 a[208:209], v9 offset:0
v_mfma_f32_16x16x32_bf16 v[228:231], a[168:171], a[228:231], v[228:231]
v_mfma_f32_16x16x32_bf16 v[232:235], a[168:171], a[232:235], v[232:235]
ds_read_b64_tr_b16 a[210:211], v9 offset:1024
v_mfma_f32_16x16x32_bf16 v[236:239], a[168:171], a[236:239], v[236:239]
s_add_u32 s37, s31, 131072
v_mfma_f32_16x16x32_bf16 v[240:243], a[168:171], a[240:243], v[240:243]
s_add_u32 m0, s33, 4096
ds_read_b64_tr_b16 a[212:213], v10 offset:0
v_mfma_f32_16x16x32_bf16 v[244:247], a[168:171], a[244:247], v[244:247]
buffer_load_dwordx4 v2, s[20:23], s37 offen  lds
v_mfma_f32_16x16x32_bf16 v[248:251], a[168:171], a[248:251], v[248:251]
ds_read_b64_tr_b16 a[214:215], v10 offset:1024
v_mfma_f32_16x16x32_bf16 v[252:255], a[168:171], a[252:255], v[252:255]
ds_read_b128 a[168:171], v3 offset:4096
v_mfma_f32_16x16x32_bf16 a[0:3], a[172:175], a[224:227], a[0:3]
ds_read_b64_tr_b16 a[216:217], v11 offset:0
v_mfma_f32_16x16x32_bf16 a[4:7], a[172:175], a[228:231], a[4:7]
v_mfma_f32_16x16x32_bf16 a[8:11], a[172:175], a[232:235], a[8:11]
ds_read_b64_tr_b16 a[218:219], v11 offset:1024
v_mfma_f32_16x16x32_bf16 a[12:15], a[172:175], a[236:239], a[12:15]
s_add_u32 s37, s31, 163840
v_mfma_f32_16x16x32_bf16 a[16:19], a[172:175], a[240:243], a[16:19]
s_add_u32 m0, s33, 5120
ds_read_b64_tr_b16 a[220:221], v12 offset:0
v_mfma_f32_16x16x32_bf16 a[20:23], a[172:175], a[244:247], a[20:23]
buffer_load_dwordx4 v2, s[20:23], s37 offen  lds
v_mfma_f32_16x16x32_bf16 a[24:27], a[172:175], a[248:251], a[24:27]
ds_read_b64_tr_b16 a[222:223], v12 offset:1024
v_mfma_f32_16x16x32_bf16 a[28:31], a[172:175], a[252:255], a[28:31]
ds_read_b128 a[172:175], v4 offset:5120
s_add_u32 s29, s29, s93
v_mfma_f32_16x16x32_bf16 a[32:35], a[176:179], a[224:227], a[32:35]
s_add_u32 s31, s31, 262144
s_add_u32 s33, s33, 16384
v_mfma_f32_16x16x32_bf16 a[36:39], a[176:179], a[228:231], a[36:39]
s_and_b32 s33, s33, 65535
buffer_store_dwordx4 v[144:147], v13, s[8:11], s29 offen sc1
v_mfma_f32_16x16x32_bf16 a[40:43], a[176:179], a[232:235], a[40:43]
ds_read_b128 a[188:191], v4 offset:13312
v_mfma_f32_16x16x32_bf16 a[44:47], a[176:179], a[236:239], a[44:47]
s_mov_b32 s48, s30
v_mfma_f32_16x16x32_bf16 a[48:51], a[176:179], a[240:243], a[48:51]
s_add_u32 m0, s32, 0
v_mfma_f32_16x16x32_bf16 a[52:55], a[176:179], a[244:247], a[52:55]
buffer_load_dwordx4 v1, s[12:15], s48 offen lds
v_mfma_f32_16x16x32_bf16 a[56:59], a[176:179], a[248:251], a[56:59]
v_mfma_f32_16x16x32_bf16 a[60:63], a[176:179], a[252:255], a[60:63]
ds_read_b128 a[176:179], v3 offset:8192
v_mfma_f32_16x16x32_bf16 a[64:67], a[180:183], a[224:227], a[64:67]
v_mfma_f32_16x16x32_bf16 a[68:71], a[180:183], a[228:231], a[68:71]
v_mfma_f32_16x16x32_bf16 a[72:75], a[180:183], a[232:235], a[72:75]
v_mfma_f32_16x16x32_bf16 a[76:79], a[180:183], a[236:239], a[76:79]
s_add_u32 s48, s48, s34
v_mfma_f32_16x16x32_bf16 a[80:83], a[180:183], a[240:243], a[80:83]
s_add_u32 m0, s32, 4096
s_cmp_eq_u32 s2, 0
s_cselect_b64 s[4:5], s[6:7], s[18:19]
v_mfma_f32_16x16x32_bf16 a[84:87], a[180:183], a[244:247], a[84:87]
buffer_load_dwordx4 v1, s[12:15], s48 offen lds
s_mov_b32 s20, s4
s_and_b32 s21, s5, 0xffff
v_mfma_f32_16x16x32_bf16 a[88:91], a[180:183], a[248:251], a[88:91]
buffer_load_dword v15, v14, s[96:99], s100 offen
s_add_u32 s100, s100, 8192
s_lshl_b32 s22, s47, 12
v_mfma_f32_16x16x32_bf16 a[92:95], a[180:183], a[252:255], a[92:95]
ds_read_b128 a[180:183], v4 offset:9216
s_mov_b32 s23, 0x20000
s_mov_b32 s31, s46
v_mfma_f32_16x16x32_bf16 a[96:99], a[184:187], a[224:227], a[96:99]
v_mfma_f32_16x16x32_bf16 a[100:103], a[184:187], a[228:231], a[100:103]
v_mfma_f32_16x16x32_bf16 a[104:107], a[184:187], a[232:235], a[104:107]
v_mfma_f32_16x16x32_bf16 a[108:111], a[184:187], a[236:239], a[108:111]
s_add_u32 s48, s48, s34
v_mfma_f32_16x16x32_bf16 a[112:115], a[184:187], a[240:243], a[112:115]
s_add_u32 m0, s32, 8192
v_mfma_f32_16x16x32_bf16 a[116:119], a[184:187], a[244:247], a[116:119]
buffer_load_dwordx4 v1, s[12:15], s48 offen lds
v_mfma_f32_16x16x32_bf16 a[120:123], a[184:187], a[248:251], a[120:123]
v_mfma_f32_16x16x32_bf16 a[124:127], a[184:187], a[252:255], a[124:127]
ds_read_b128 a[184:187], v3 offset:12288
s_add_u32 s29, s29, s44
v_mfma_f32_16x16x32_bf16 a[128:131], v[28:31], a[224:227], a[128:131]
v_mfma_f32_16x16x32_bf16 a[132:135], v[28:31], a[228:231], a[132:135]
buffer_store_dwordx4 v[148:151], v13, s[8:11], s29 offen sc1
v_add_u32 v5, 16384, v5
v_and_b32 v5, 65535, v5
v_mfma_f32_16x16x32_bf16 a[136:139], v[28:31], a[232:235], a[136:139]
v_xor_b32 v6, 16, v5
v_xor_b32 v7, 64, v5
v_xor_b32 v8, 80, v5
v_mfma_f32_16x16x32_bf16 a[140:143], v[28:31], a[236:239], a[140:143]
s_add_u32 s48, s48, s34
v_xor_b32 v9, 128, v5
v_xor_b32 v10, 144, v5
v_mfma_f32_16x16x32_bf16 a[144:147], v[28:31], a[240:243], a[144:147]
s_add_u32 m0, s32, 12288
v_xor_b32 v11, 192, v5
v_xor_b32 v12, 208, v5
v_mfma_f32_16x16x32_bf16 a[148:151], v[28:31], a[244:247], a[148:151]
buffer_load_dwordx4 v1, s[12:15], s48 offen lds
v_mfma_f32_16x16x32_bf16 a[152:155], v[28:31], a[248:251], a[152:155]
v_mfma_f32_16x16x32_bf16 a[156:159], v[28:31], a[252:255], a[156:159]
s_waitcnt vmcnt(24) lgkmcnt(0)
s_barrier
v_mfma_f32_16x16x32_bf16 v[160:163], a[160:163], a[192:195], v[160:163]
ds_read_b64_tr_b16 a[224:225], v5 offset:0
v_mfma_f32_16x16x32_bf16 v[164:167], a[160:163], a[196:199], v[164:167]
v_mfma_f32_16x16x32_bf16 v[168:171], a[160:163], a[200:203], v[168:171]
ds_read_b64_tr_b16 a[226:227], v5 offset:1024
v_mfma_f32_16x16x32_bf16 v[172:175], a[160:163], a[204:207], v[172:175]
s_add_u32 s37, s31, 0
v_mfma_f32_16x16x32_bf16 v[176:179], a[160:163], a[208:211], v[176:179]
s_add_u32 m0, s33, 0
ds_read_b64_tr_b16 a[228:229], v6 offset:0
v_mfma_f32_16x16x32_bf16 v[180:183], a[160:163], a[212:215], v[180:183]
buffer_load_dwordx4 v2, s[20:23], s37 offen  lds
v_mfma_f32_16x16x32_bf16 v[184:187], a[160:163], a[216:219], v[184:187]
ds_read_b64_tr_b16 a[230:231], v6 offset:1024
v_mfma_f32_16x16x32_bf16 v[188:191], a[160:163], a[220:223], v[188:191]
ds_read_b128 a[160:163], v4 offset:0
s_add_u32 s29, s29, s93
v_mfma_f32_16x16x32_bf16 v[192:195], a[164:167], a[192:195], v[192:195]
ds_read_b64_tr_b16 a[232:233], v7 offset:0
v_mfma_f32_16x16x32_bf16 v[196:199], a[164:167], a[196:199], v[196:199]
buffer_store_dwordx4 v[152:155], v13, s[8:11], s29 offen sc1
v_mfma_f32_16x16x32_bf16 v[200:203], a[164:167], a[200:203], v[200:203]
ds_read_b64_tr_b16 a[234:235], v7 offset:1024
v_mfma_f32_16x16x32_bf16 v[204:207], a[164:167], a[204:207], v[204:207]
s_add_u32 s37, s31, 32768
v_mfma_f32_16x16x32_bf16 v[208:211], a[164:167], a[208:211], v[208:211]
s_add_u32 m0, s33, 1024
ds_read_b64_tr_b16 a[236:237], v8 offset:0
v_mfma_f32_16x16x32_bf16 v[212:215], a[164:167], a[212:215], v[212:215]
buffer_load_dwordx4 v2, s[20:23], s37 offen  lds
v_mfma_f32_16x16x32_bf16 v[216:219], a[164:167], a[216:219], v[216:219]
ds_read_b64_tr_b16 a[238:239], v8 offset:1024
v_mfma_f32_16x16x32_bf16 v[220:223], a[164:167], a[220:223], v[220:223]
ds_read_b128 a[164:167], v3 offset:1024
v_mfma_f32_16x16x32_bf16 v[224:227], a[168:171], a[192:195], v[224:227]
ds_read_b64_tr_b16 a[240:241], v9 offset:0
v_mfma_f32_16x16x32_bf16 v[228:231], a[168:171], a[196:199], v[228:231]
v_mfma_f32_16x16x32_bf16 v[232:235], a[168:171], a[200:203], v[232:235]
ds_read_b64_tr_b16 a[242:243], v9 offset:1024
v_mfma_f32_16x16x32_bf16 v[236:239], a[168:171], a[204:207], v[236:239]
s_add_u32 s37, s31, 131072
v_mfma_f32_16x16x32_bf16 v[240:243], a[168:171], a[208:211], v[240:243]
s_add_u32 m0, s33, 4096
ds_read_b64_tr_b16 a[244:245], v10 offset:0
v_mfma_f32_16x16x32_bf16 v[244:247], a[168:171], a[212:215], v[244:247]
buffer_load_dwordx4 v2, s[20:23], s37 offen  lds
v_mfma_f32_16x16x32_bf16 v[248:251], a[168:171], a[216:219], v[248:251]
ds_read_b64_tr_b16 a[246:247], v10 offset:1024
v_mfma_f32_16x16x32_bf16 v[252:255], a[168:171], a[220:223], v[252:255]
ds_read_b128 a[168:171], v4 offset:4096
v_mfma_f32_16x16x32_bf16 a[0:3], a[172:175], a[192:195], a[0:3]
ds_read_b64_tr_b16 a[248:249], v11 offset:0
v_mfma_f32_16x16x32_bf16 a[4:7], a[172:175], a[196:199], a[4:7]
v_mfma_f32_16x16x32_bf16 a[8:11], a[172:175], a[200:203], a[8:11]
ds_read_b64_tr_b16 a[250:251], v11 offset:1024
v_mfma_f32_16x16x32_bf16 a[12:15], a[172:175], a[204:207], a[12:15]
s_add_u32 s37, s31, 163840
v_mfma_f32_16x16x32_bf16 a[16:19], a[172:175], a[208:211], a[16:19]
s_add_u32 m0, s33, 5120
ds_read_b64_tr_b16 a[252:253], v12 offset:0
v_mfma_f32_16x16x32_bf16 a[20:23], a[172:175], a[212:215], a[20:23]
buffer_load_dwordx4 v2, s[20:23], s37 offen  lds
v_mfma_f32_16x16x32_bf16 a[24:27], a[172:175], a[216:219], a[24:27]
ds_read_b64_tr_b16 a[254:255], v12 offset:1024
v_mfma_f32_16x16x32_bf16 a[28:31], a[172:175], a[220:223], a[28:31]
ds_read_b128 a[172:175], v3 offset:5120
s_add_u32 s29, s29, s44
v_mfma_f32_16x16x32_bf16 a[32:35], a[176:179], a[192:195], a[32:35]
s_add_u32 s31, s31, 262144
s_add_u32 s33, s33, 16384
v_mfma_f32_16x16x32_bf16 a[36:39], a[176:179], a[196:199], a[36:39]
s_and_b32 s33, s33, 65535
buffer_store_dwordx4 v[156:159], v13, s[8:11], s29 offen sc1
v_mfma_f32_16x16x32_bf16 a[40:43], a[176:179], a[200:203], a[40:43]
ds_read_b128 v[28:31], v3 offset:13312
v_mfma_f32_16x16x32_bf16 a[44:47], a[176:179], a[204:207], a[44:47]
s_add_u32 s48, s48, s34
v_mfma_f32_16x16x32_bf16 a[48:51], a[176:179], a[208:211], a[48:51]
s_add_u32 m0, s32, 16384
v_mfma_f32_16x16x32_bf16 a[52:55], a[176:179], a[212:215], a[52:55]
buffer_load_dwordx4 v1, s[12:15], s48 offen lds
v_mfma_f32_16x16x32_bf16 a[56:59], a[176:179], a[216:219], a[56:59]
v_mfma_f32_16x16x32_bf16 a[60:63], a[176:179], a[220:223], a[60:63]
ds_read_b128 a[176:179], v4 offset:8192
v_mfma_f32_16x16x32_bf16 a[64:67], a[180:183], a[192:195], a[64:67]
v_mfma_f32_16x16x32_bf16 a[68:71], a[180:183], a[196:199], a[68:71]
v_mfma_f32_16x16x32_bf16 a[72:75], a[180:183], a[200:203], a[72:75]
v_mfma_f32_16x16x32_bf16 a[76:79], a[180:183], a[204:207], a[76:79]
s_add_u32 s48, s48, s34
v_mfma_f32_16x16x32_bf16 a[80:83], a[180:183], a[208:211], a[80:83]
s_add_u32 m0, s32, 20480
v_mfma_f32_16x16x32_bf16 a[84:87], a[180:183], a[212:215], a[84:87]
buffer_load_dwordx4 v1, s[12:15], s48 offen lds
v_mfma_f32_16x16x32_bf16 a[88:91], a[180:183], a[216:219], a[88:91]
buffer_load_dword v15, v14, s[96:99], s100 offen
s_add_u32 s100, s100, 8192
v_mfma_f32_16x16x32_bf16 a[92:95], a[180:183], a[220:223], a[92:95]
ds_read_b128 a[180:183], v3 offset:9216
v_mfma_f32_16x16x32_bf16 a[96:99], a[184:187], a[192:195], a[96:99]
v_mfma_f32_16x16x32_bf16 a[100:103], a[184:187], a[196:199], a[100:103]
v_mfma_f32_16x16x32_bf16 a[104:107], a[184:187], a[200:203], a[104:107]
v_mfma_f32_16x16x32_bf16 a[108:111], a[184:187], a[204:207], a[108:111]
s_add_u32 s48, s48, s34
v_mfma_f32_16x16x32_bf16 a[112:115], a[184:187], a[208:211], a[112:115]
s_add_u32 m0, s32, 24576
v_mfma_f32_16x16x32_bf16 a[116:119], a[184:187], a[212:215], a[116:119]
buffer_load_dwordx4 v1, s[12:15], s48 offen lds
v_mfma_f32_16x16x32_bf16 a[120:123], a[184:187], a[216:219], a[120:123]
v_mfma_f32_16x16x32_bf16 a[124:127], a[184:187], a[220:223], a[124:127]
ds_read_b128 a[184:187], v4 offset:12288
v_mfma_f32_16x16x32_bf16 a[128:131], a[188:191], a[192:195], a[128:131]
v_mfma_f32_16x16x32_bf16 a[132:135], a[188:191], a[196:199], a[132:135]
v_add_u32 v3, 32768, v3
v_subrev_u32 v19, 98304, v3
v_cmp_le_u32 vcc, 163840, v3
v_mfma_f32_16x16x32_bf16 a[136:139], a[188:191], a[200:203], a[136:139]
v_add_u32 v5, 16384, v5
v_and_b32 v5, 65535, v5
v_xor_b32 v6, 16, v5
v_mfma_f32_16x16x32_bf16 a[140:143], a[188:191], a[204:207], a[140:143]
s_add_u32 s48, s48, s34
v_xor_b32 v7, 64, v5
v_xor_b32 v8, 80, v5
v_mfma_f32_16x16x32_bf16 a[144:147], a[188:191], a[208:211], a[144:147]
s_add_u32 m0, s32, 28672
v_xor_b32 v9, 128, v5
v_xor_b32 v10, 144, v5
v_mfma_f32_16x16x32_bf16 a[148:151], a[188:191], a[212:215], a[148:151]
buffer_load_dwordx4 v1, s[12:15], s48 offen lds
v_xor_b32 v11, 192, v5
v_xor_b32 v12, 208, v5
v_mfma_f32_16x16x32_bf16 a[152:155], a[188:191], a[216:219], a[152:155]
s_add_u32 s30, s30, 128
s_add_u32 s32, s32, 32768
s_sub_u32 s48, s32, 98304
v_mfma_f32_16x16x32_bf16 a[156:159], a[188:191], a[220:223], a[156:159]
s_cmp_ge_u32 s32, 163840
s_cselect_b32 s32, s48, s32
v_cndmask_b32 v3, v3, v19, vcc
v_xor_b32 v4, 64, v3
s_waitcnt vmcnt(23) lgkmcnt(0)
s_barrier
v_mfma_f32_16x16x32_bf16 v[160:163], a[160:163], a[224:227], v[160:163]
ds_read_b64_tr_b16 a[192:193], v5 offset:0
v_mfma_f32_16x16x32_bf16 v[164:167], a[160:163], a[228:231], v[164:167]
v_mfma_f32_16x16x32_bf16 v[168:171], a[160:163], a[232:235], v[168:171]
ds_read_b64_tr_b16 a[194:195], v5 offset:1024
v_mfma_f32_16x16x32_bf16 v[172:175], a[160:163], a[236:239], v[172:175]
s_add_u32 s37, s31, 0
v_mfma_f32_16x16x32_bf16 v[176:179], a[160:163], a[240:243], v[176:179]
s_add_u32 m0, s33, 0
ds_read_b64_tr_b16 a[196:197], v6 offset:0
v_mfma_f32_16x16x32_bf16 v[180:183], a[160:163], a[244:247], v[180:183]
buffer_load_dwordx4 v2, s[20:23], s37 offen  lds
v_mfma_f32_16x16x32_bf16 v[184:187], a[160:163], a[248:251], v[184:187]
ds_read_b64_tr_b16 a[198:199], v6 offset:1024
v_mfma_f32_16x16x32_bf16 v[188:191], a[160:163], a[252:255], v[188:191]
ds_read_b128 a[160:163], v3 offset:0
v_mfma_f32_16x16x32_bf16 v[192:195], a[164:167], a[224:227], v[192:195]
ds_read_b64_tr_b16 a[200:201], v7 offset:0
v_mfma_f32_16x16x32_bf16 v[196:199], a[164:167], a[228:231], v[196:199]
v_mfma_f32_16x16x32_bf16 v[200:203], a[164:167], a[232:235], v[200:203]
ds_read_b64_tr_b16 a[202:203], v7 offset:1024
v_mfma_f32_16x16x32_bf16 v[204:207], a[164:167], a[236:239], v[204:207]
s_add_u32 s37, s31, 32768
v_mfma_f32_16x16x32_bf16 v[208:211], a[164:167], a[240:243], v[208:211]
s_add_u32 m0, s33, 1024
ds_read_b64_tr_b16 a[204:205], v8 offset:0
v_mfma_f32_16x16x32_bf16 v[212:215], a[164:167], a[244:247], v[212:215]
buffer_load_dwordx4 v2, s[20:23], s37 offen  lds
v_mfma_f32_16x16x32_bf16 v[216:219], a[164:167], a[248:251], v[216:219]
ds_read_b64_tr_b16 a[206:207], v8 offset:1024
v_mfma_f32_16x16x32_bf16 v[220:223], a[164:167], a[252:255], v[220:223]
ds_read_b128 a[164:167], v4 offset:1024
v_mfma_f32_16x16x32_bf16 v[224:227], a[168:171], a[224:227], v[224:227]
ds_read_b64_tr_b16 a[208:209], v9 offset:0
v_mfma_f32_16x16x32_bf16 v[228:231], a[168:171], a[228:231], v[228:231]
v_mfma_f32_16x16x32_bf16 v[232:235], a[168:171], a[232:235], v[232:235]
ds_read_b64_tr_b16 a[210:211], v9 offset:1024
v_mfma_f32_16x16x32_bf16 v[236:239], a[168:171], a[236:239], v[236:239]
s_add_u32 s37, s31, 131072
v_mfma_f32_16x16x32_bf16 v[240:243], a[168:171], a[240:243], v[240:243]
s_add_u32 m0, s33, 4096
ds_read_b64_tr_b16 a[212:213], v10 offset:0
v_mfma_f32_16x16x32_bf16 v[244:247], a[168:171], a[244:247], v[244:247]
buffer_load_dwordx4 v2, s[20:23], s37 offen  lds
v_mfma_f32_16x16x32_bf16 v[248:251], a[168:171], a[248:251], v[248:251]
ds_read_b64_tr_b16 a[214:215], v10 offset:1024
v_mfma_f32_16x16x32_bf16 v[252:255], a[168:171], a[252:255], v[252:255]
ds_read_b128 a[168:171], v3 offset:4096
v_mfma_f32_16x16x32_bf16 a[0:3], a[172:175], a[224:227], a[0:3]
ds_read_b64_tr_b16 a[216:217], v11 offset:0
v_mfma_f32_16x16x32_bf16 a[4:7], a[172:175], a[228:231], a[4:7]
v_mfma_f32_16x16x32_bf16 a[8:11], a[172:175], a[232:235], a[8:11]
ds_read_b64_tr_b16 a[218:219], v11 offset:1024
v_mfma_f32_16x16x32_bf16 a[12:15], a[172:175], a[236:239], a[12:15]
s_add_u32 s37, s31, 163840
v_mfma_f32_16x16x32_bf16 a[16:19], a[172:175], a[240:243], a[16:19]
s_add_u32 m0, s33, 5120
ds_read_b64_tr_b16 a[220:221], v12 offset:0
v_mfma_f32_16x16x32_bf16 a[20:23], a[172:175], a[244:247], a[20:23]
buffer_load_dwordx4 v2, s[20:23], s37 offen  lds
v_mfma_f32_16x16x32_bf16 a[24:27], a[172:175], a[248:251], a[24:27]
ds_read_b64_tr_b16 a[222:223], v12 offset:1024
v_mfma_f32_16x16x32_bf16 a[28:31], a[172:175], a[252:255], a[28:31]
ds_read_b128 a[172:175], v4 offset:5120
v_mfma_f32_16x16x32_bf16 a[32:35], a[176:179], a[224:227], a[32:35]
s_add_u32 s31, s31, 262144
s_add_u32 s33, s33, 16384
v_mfma_f32_16x16x32_bf16 a[36:39], a[176:179], a[228:231], a[36:39]
s_and_b32 s33, s33, 65535
ds_read_b128 a[188:191], v4 offset:13312
v_mfma_f32_16x16x32_bf16 a[40:43], a[176:179], a[232:235], a[40:43]
v_mfma_f32_16x16x32_bf16 a[44:47], a[176:179], a[236:239], a[44:47]
s_mov_b32 s48, s30
v_mfma_f32_16x16x32_bf16 a[48:51], a[176:179], a[240:243], a[48:51]
s_add_u32 m0, s32, 0
v_mfma_f32_16x16x32_bf16 a[52:55], a[176:179], a[244:247], a[52:55]
buffer_load_dwordx4 v1, s[12:15], s48 offen lds
v_mfma_f32_16x16x32_bf16 a[56:59], a[176:179], a[248:251], a[56:59]
v_mfma_f32_16x16x32_bf16 a[60:63], a[176:179], a[252:255], a[60:63]
ds_read_b128 a[176:179], v3 offset:8192
v_mfma_f32_16x16x32_bf16 a[64:67], a[180:183], a[224:227], a[64:67]
v_mfma_f32_16x16x32_bf16 a[68:71], a[180:183], a[228:231], a[68:71]
v_mfma_f32_16x16x32_bf16 a[72:75], a[180:183], a[232:235], a[72:75]
v_mfma_f32_16x16x32_bf16 a[76:79], a[180:183], a[236:239], a[76:79]
s_add_u32 s48, s48, s34
v_mfma_f32_16x16x32_bf16 a[80:83], a[180:183], a[240:243], a[80:83]
s_add_u32 m0, s32, 4096
v_mfma_f32_16x16x32_bf16 a[84:87], a[180:183], a[244:247], a[84:87]
buffer_load_dwordx4 v1, s[12:15], s48 offen lds
v_mfma_f32_16x16x32_bf16 a[88:91], a[180:183], a[248:251], a[88:91]
buffer_load_dword v15, v14, s[96:99], s100 offen
s_add_u32 s100, s100, 8192
v_mfma_f32_16x16x32_bf16 a[92:95], a[180:183], a[252:255], a[92:95]
ds_read_b128 a[180:183], v4 offset:9216
v_mfma_f32_16x16x32_bf16 a[96:99], a[184:187], a[224:227], a[96:99]
v_mfma_f32_16x16x32_bf16 a[100:103], a[184:187], a[228:231], a[100:103]
v_mfma_f32_16x16x32_bf16 a[104:107], a[184:187], a[232:235], a[104:107]
v_mfma_f32_16x16x32_bf16 a[108:111], a[184:187], a[236:239], a[108:111]
s_add_u32 s48, s48, s34
v_mfma_f32_16x16x32_bf16 a[112:115], a[184:187], a[240:243], a[112:115]
s_add_u32 m0, s32, 8192
v_mfma_f32_16x16x32_bf16 a[116:119], a[184:187], a[244:247], a[116:119]
buffer_load_dwordx4 v1, s[12:15], s48 offen lds
v_mfma_f32_16x16x32_bf16 a[120:123], a[184:187], a[248:251], a[120:123]
v_mfma_f32_16x16x32_bf16 a[124:127], a[184:187], a[252:255], a[124:127]
ds_read_b128 a[184:187], v3 offset:12288
v_mfma_f32_16x16x32_bf16 a[128:131], v[28:31], a[224:227], a[128:131]
v_mfma_f32_16x16x32_bf16 a[132:135], v[28:31], a[228:231], a[132:135]
v_add_u32 v5, 16384, v5
v_and_b32 v5, 65535, v5
v_xor_b32 v6, 16, v5
v_mfma_f32_16x16x32_bf16 a[136:139], v[28:31], a[232:235], a[136:139]
v_xor_b32 v7, 64, v5
v_xor_b32 v8, 80, v5
v_xor_b32 v9, 128, v5
v_mfma_f32_16x16x32_bf16 a[140:143], v[28:31], a[236:239], a[140:143]
s_add_u32 s48, s48, s34
v_xor_b32 v10, 144, v5
v_xor_b32 v11, 192, v5
v_mfma_f32_16x16x32_bf16 a[144:147], v[28:31], a[240:243], a[144:147]
s_add_u32 m0, s32, 12288
v_xor_b32 v12, 208, v5
v_mfma_f32_16x16x32_bf16 a[148:151], v[28:31], a[244:247], a[148:151]
buffer_load_dwordx4 v1, s[12:15], s48 offen lds
v_mfma_f32_16x16x32_bf16 a[152:155], v[28:31], a[248:251], a[152:155]
v_mfma_f32_16x16x32_bf16 a[156:159], v[28:31], a[252:255], a[156:159]
s_waitcnt vmcnt(20) lgkmcnt(0)
s_barrier
v_mfma_f32_16x16x32_bf16 v[160:163], a[160:163], a[192:195], v[160:163]
ds_read_b64_tr_b16 a[224:225], v5 offset:0
v_mfma_f32_16x16x32_bf16 v[164:167], a[160:163], a[196:199], v[164:167]
v_mfma_f32_16x16x32_bf16 v[168:171], a[160:163], a[200:203], v[168:171]
ds_read_b64_tr_b16 a[226:227], v5 offset:1024
v_mfma_f32_16x16x32_bf16 v[172:175], a[160:163], a[204:207], v[172:175]
s_add_u32 s37, s31, 0
v_mfma_f32_16x16x32_bf16 v[176:179], a[160:163], a[208:211], v[176:179]
s_add_u32 m0, s33, 0
ds_read_b64_tr_b16 a[228:229], v6 offset:0
v_mfma_f32_16x16x32_bf16 v[180:183], a[160:163], a[212:215], v[180:183]
buffer_load_dwordx4 v2, s[20:23], s37 offen  lds
v_mfma_f32_16x16x32_bf16 v[184:187], a[160:163], a[216:219], v[184:187]
ds_read_b64_tr_b16 a[230:231], v6 offset:1024
v_mfma_f32_16x16x32_bf16 v[188:191], a[160:163], a[220:223], v[188:191]
ds_read_b128 a[160:163], v4 offset:0
v_mfma_f32_16x16x32_bf16 v[192:195], a[164:167], a[192:195], v[192:195]
ds_read_b64_tr_b16 a[232:233], v7 offset:0
v_mfma_f32_16x16x32_bf16 v[196:199], a[164:167], a[196:199], v[196:199]
v_mfma_f32_16x16x32_bf16 v[200:203], a[164:167], a[200:203], v[200:203]
ds_read_b64_tr_b16 a[234:235], v7 offset:1024
v_mfma_f32_16x16x32_bf16 v[204:207], a[164:167], a[204:207], v[204:207]
s_add_u32 s37, s31, 32768
v_mfma_f32_16x16x32_bf16 v[208:211], a[164:167], a[208:211], v[208:211]
s_add_u32 m0, s33, 1024
ds_read_b64_tr_b16 a[236:237], v8 offset:0
v_mfma_f32_16x16x32_bf16 v[212:215], a[164:167], a[212:215], v[212:215]
buffer_load_dwordx4 v2, s[20:23], s37 offen  lds
v_mfma_f32_16x16x32_bf16 v[216:219], a[164:167], a[216:219], v[216:219]
ds_read_b64_tr_b16 a[238:239], v8 offset:1024
v_mfma_f32_16x16x32_bf16 v[220:223], a[164:167], a[220:223], v[220:223]
ds_read_b128 a[164:167], v3 offset:1024
v_mfma_f32_16x16x32_bf16 v[224:227], a[168:171], a[192:195], v[224:227]
ds_read_b64_tr_b16 a[240:241], v9 offset:0
v_mfma_f32_16x16x32_bf16 v[228:231], a[168:171], a[196:199], v[228:231]
v_mfma_f32_16x16x32_bf16 v[232:235], a[168:171], a[200:203], v[232:235]
ds_read_b64_tr_b16 a[242:243], v9 offset:1024
v_mfma_f32_16x16x32_bf16 v[236:239], a[168:171], a[204:207], v[236:239]
s_add_u32 s37, s31, 131072
v_mfma_f32_16x16x32_bf16 v[240:243], a[168:171], a[208:211], v[240:243]
s_add_u32 m0, s33, 4096
ds_read_b64_tr_b16 a[244:245], v10 offset:0
v_mfma_f32_16x16x32_bf16 v[244:247], a[168:171], a[212:215], v[244:247]
buffer_load_dwordx4 v2, s[20:23], s37 offen  lds
v_mfma_f32_16x16x32_bf16 v[248:251], a[168:171], a[216:219], v[248:251]
ds_read_b64_tr_b16 a[246:247], v10 offset:1024
v_mfma_f32_16x16x32_bf16 v[252:255], a[168:171], a[220:223], v[252:255]
ds_read_b128 a[168:171], v4 offset:4096
v_mfma_f32_16x16x32_bf16 a[0:3], a[172:175], a[192:195], a[0:3]
ds_read_b64_tr_b16 a[248:249], v11 offset:0
v_mfma_f32_16x16x32_bf16 a[4:7], a[172:175], a[196:199], a[4:7]
v_mfma_f32_16x16x32_bf16 a[8:11], a[172:175], a[200:203], a[8:11]
ds_read_b64_tr_b16 a[250:251], v11 offset:1024
v_mfma_f32_16x16x32_bf16 a[12:15], a[172:175], a[204:207], a[12:15]
s_add_u32 s37, s31, 163840
v_mfma_f32_16x16x32_bf16 a[16:19], a[172:175], a[208:211], a[16:19]
s_add_u32 m0, s33, 5120
ds_read_b64_tr_b16 a[252:253], v12 offset:0
v_mfma_f32_16x16x32_bf16 a[20:23], a[172:175], a[212:215], a[20:23]
buffer_load_dwordx4 v2, s[20:23], s37 offen  lds
v_mfma_f32_16x16x32_bf16 a[24:27], a[172:175], a[216:219], a[24:27]
ds_read_b64_tr_b16 a[254:255], v12 offset:1024
v_mfma_f32_16x16x32_bf16 a[28:31], a[172:175], a[220:223], a[28:31]
ds_read_b128 a[172:175], v3 offset:5120
v_mfma_f32_16x16x32_bf16 a[32:35], a[176:179], a[192:195], a[32:35]
s_add_u32 s31, s31, 262144
s_add_u32 s33, s33, 16384
v_mfma_f32_16x16x32_bf16 a[36:39], a[176:179], a[196:199], a[36:39]
s_and_b32 s33, s33, 65535
ds_read_b128 v[28:31], v3 offset:13312
v_mfma_f32_16x16x32_bf16 a[40:43], a[176:179], a[200:203], a[40:43]
v_mfma_f32_16x16x32_bf16 a[44:47], a[176:179], a[204:207], a[44:47]
s_add_u32 s48, s48, s34
v_mfma_f32_16x16x32_bf16 a[48:51], a[176:179], a[208:211], a[48:51]
s_add_u32 m0, s32, 16384
v_mfma_f32_16x16x32_bf16 a[52:55], a[176:179], a[212:215], a[52:55]
buffer_load_dwordx4 v1, s[12:15], s48 offen lds
v_mfma_f32_16x16x32_bf16 a[56:59], a[176:179], a[216:219], a[56:59]
v_mfma_f32_16x16x32_bf16 a[60:63], a[176:179], a[220:223], a[60:63]
ds_read_b128 a[176:179], v4 offset:8192
v_mfma_f32_16x16x32_bf16 a[64:67], a[180:183], a[192:195], a[64:67]
v_mfma_f32_16x16x32_bf16 a[68:71], a[180:183], a[196:199], a[68:71]
v_mfma_f32_16x16x32_bf16 a[72:75], a[180:183], a[200:203], a[72:75]
v_mfma_f32_16x16x32_bf16 a[76:79], a[180:183], a[204:207], a[76:79]
s_add_u32 s48, s48, s34
v_mfma_f32_16x16x32_bf16 a[80:83], a[180:183], a[208:211], a[80:83]
s_add_u32 m0, s32, 20480
v_mfma_f32_16x16x32_bf16 a[84:87], a[180:183], a[212:215], a[84:87]
buffer_load_dwordx4 v1, s[12:15], s48 offen lds
v_mfma_f32_16x16x32_bf16 a[88:91], a[180:183], a[216:219], a[88:91]
buffer_load_dword v15, v14, s[96:99], s100 offen
s_add_u32 s100, s100, 8192
v_mfma_f32_16x16x32_bf16 a[92:95], a[180:183], a[220:223], a[92:95]
ds_read_b128 a[180:183], v3 offset:9216
v_mfma_f32_16x16x32_bf16 a[96:99], a[184:187], a[192:195], a[96:99]
v_mfma_f32_16x16x32_bf16 a[100:103], a[184:187], a[196:199], a[100:103]
v_mfma_f32_16x16x32_bf16 a[104:107], a[184:187], a[200:203], a[104:107]
v_mfma_f32_16x16x32_bf16 a[108:111], a[184:187], a[204:207], a[108:111]
s_add_u32 s48, s48, s34
v_mfma_f32_16x16x32_bf16 a[112:115], a[184:187], a[208:211], a[112:115]
s_add_u32 m0, s32, 24576
v_mfma_f32_16x16x32_bf16 a[116:119], a[184:187], a[212:215], a[116:119]
buffer_load_dwordx4 v1, s[12:15], s48 offen lds
v_mfma_f32_16x16x32_bf16 a[120:123], a[184:187], a[216:219], a[120:123]
v_mfma_f32_16x16x32_bf16 a[124:127], a[184:187], a[220:223], a[124:127]
ds_read_b128 a[184:187], v4 offset:12288
v_mfma_f32_16x16x32_bf16 a[128:131], a[188:191], a[192:195], a[128:131]
v_mfma_f32_16x16x32_bf16 a[132:135], a[188:191], a[196:199], a[132:135]
v_add_u32 v3, 32768, v3
v_subrev_u32 v19, 98304, v3
v_cmp_le_u32 vcc, 163840, v3
v_mfma_f32_16x16x32_bf16 a[136:139], a[188:191], a[200:203], a[136:139]
v_add_u32 v5, 16384, v5
v_and_b32 v5, 65535, v5
v_xor_b32 v6, 16, v5
v_mfma_f32_16x16x32_bf16 a[140:143], a[188:191], a[204:207], a[140:143]
s_add_u32 s48, s48, s34
v_xor_b32 v7, 64, v5
v_xor_b32 v8, 80, v5
v_mfma_f32_16x16x32_bf16 a[144:147], a[188:191], a[208:211], a[144:147]
s_add_u32 m0, s32, 28672
v_xor_b32 v9, 128, v5
v_xor_b32 v10, 144, v5
v_mfma_f32_16x16x32_bf16 a[148:151], a[188:191], a[212:215], a[148:151]
buffer_load_dwordx4 v1, s[12:15], s48 offen lds
v_xor_b32 v11, 192, v5
v_xor_b32 v12, 208, v5
v_mfma_f32_16x16x32_bf16 a[152:155], a[188:191], a[216:219], a[152:155]
s_add_u32 s30, s30, 128
s_add_u32 s32, s32, 32768
s_sub_u32 s48, s32, 98304
v_mfma_f32_16x16x32_bf16 a[156:159], a[188:191], a[220:223], a[156:159]
s_cmp_ge_u32 s32, 163840
s_cselect_b32 s32, s48, s32
v_cndmask_b32 v3, v3, v19, vcc
v_xor_b32 v4, 64, v3
s_cmp_eq_u32 s41, 0
s_cbranch_scc0 L_g_v17v
s_waitcnt vmcnt(18) lgkmcnt(0)
s_barrier
v_mfma_f32_16x16x32_bf16 v[160:163], a[160:163], a[224:227], v[160:163]
ds_read_b128 a[192:195], v3 offset:0
v_mfma_f32_16x16x32_bf16 v[164:167], a[160:163], a[228:231], v[164:167]
v_mfma_f32_16x16x32_bf16 v[168:171], a[160:163], a[232:235], v[168:171]
ds_read_b128 a[196:199], v4 offset:1024
v_mfma_f32_16x16x32_bf16 v[172:175], a[160:163], a[236:239], v[172:175]
s_add_u32 s37, s31, 0
v_mfma_f32_16x16x32_bf16 v[176:179], a[160:163], a[240:243], v[176:179]
s_add_u32 m0, s33, 0
ds_read_b128 a[200:203], v3 offset:4096
v_cvt_pk_bf16_f32 v32, v160, v161
v_cvt_pk_bf16_f32 v33, v162, v163
v_mfma_f32_16x16x32_bf16 v[180:183], a[160:163], a[244:247], v[180:183]
buffer_load_dwordx4 v2, s[20:23], s37 offen  lds
v_cvt_pk_bf16_f32 v36, v164, v165
v_cvt_pk_bf16_f32 v37, v166, v167
v_mfma_f32_16x16x32_bf16 v[184:187], a[160:163], a[248:251], v[184:187]
ds_read_b128 a[204:207], v4 offset:5120
v_cvt_pk_bf16_f32 v40, v168, v169
v_cvt_pk_bf16_f32 v41, v170, v171
v_mfma_f32_16x16x32_bf16 v[188:191], a[160:163], a[252:255], v[188:191]
ds_read_b64_tr_b16 a[160:161], v5 offset:0
v_cvt_pk_bf16_f32 v44, v172, v173
v_cvt_pk_bf16_f32 v45, v174, v175
v_mfma_f32_16x16x32_bf16 v[192:195], a[164:167], a[224:227], v[192:195]
ds_read_b64_tr_b16 a[162:163], v5 offset:1024
ds_read_b128 a[208:211], v3 offset:8192
v_cvt_pk_bf16_f32 v48, v176, v177
v_cvt_pk_bf16_f32 v49, v178, v179
v_mfma_f32_16x16x32_bf16 v[196:199], a[164:167], a[228:231], v[196:199]
v_cvt_pk_bf16_f32 v52, v180, v181
v_cvt_pk_bf16_f32 v53, v182, v183
v_mfma_f32_16x16x32_bf16 v[200:203], a[164:167], a[232:235], v[200:203]
ds_read_b128 a[212:215], v4 offset:9216
v_cvt_pk_bf16_f32 v56, v184, v185
v_cvt_pk_bf16_f32 v57, v186, v187
v_mfma_f32_16x16x32_bf16 v[204:207], a[164:167], a[236:239], v[204:207]
s_add_u32 s37, s31, 32768
v_cvt_pk_bf16_f32 v60, v188, v189
v_cvt_pk_bf16_f32 v61, v190, v191
v_mfma_f32_16x16x32_bf16 v[208:211], a[164:167], a[240:243], v[208:211]
s_add_u32 m0, s33, 1024
ds_read_b128 a[216:219], v3 offset:12288
v_cvt_pk_bf16_f32 v34, v192, v193
v_cvt_pk_bf16_f32 v35, v194, v195
v_mfma_f32_16x16x32_bf16 v[212:215], a[164:167], a[244:247], v[212:215]
buffer_load_dwordx4 v2, s[20:23], s37 offen  lds
v_cvt_pk_bf16_f32 v38, v196, v197
v_cvt_pk_bf16_f32 v39, v198, v199
v_mfma_f32_16x16x32_bf16 v[216:219], a[164:167], a[248:251], v[216:219]
ds_read_b128 a[220:223], v4 offset:13312
v_cvt_pk_bf16_f32 v42, v200, v201
v_cvt_pk_bf16_f32 v43, v202, v203
v_mfma_f32_16x16x32_bf16 v[220:223], a[164:167], a[252:255], v[220:223]
ds_read_b64_tr_b16 a[164:165], v6 offset:0
v_cvt_pk_bf16_f32 v46, v204, v205
v_cvt_pk_bf16_f32 v47, v206, v207
v_mfma_f32_16x16x32_bf16 v[224:227], a[168:171], a[224:227], v[224:227]
ds_read_b64_tr_b16 a[166:167], v6 offset:1024
ds_read_b64_tr_b16 a[188:189], v12 offset:0
v_cvt_pk_bf16_f32 v50, v208, v209
v_cvt_pk_bf16_f32 v51, v210, v211
v_mfma_f32_16x16x32_bf16 v[228:231], a[168:171], a[228:231], v[228:231]
v_cvt_pk_bf16_f32 v54, v212, v213
v_cvt_pk_bf16_f32 v55, v214, v215
v_mfma_f32_16x16x32_bf16 v[232:235], a[168:171], a[232:235], v[232:235]
ds_read_b64_tr_b16 a[190:191], v12 offset:1024
v_cvt_pk_bf16_f32 v58, v216, v217
v_cvt_pk_bf16_f32 v59, v218, v219
v_mfma_f32_16x16x32_bf16 v[236:239], a[168:171], a[236:239], v[236:239]
s_add_u32 s37, s31, 131072
v_cvt_pk_bf16_f32 v62, v220, v221
v_cvt_pk_bf16_f32 v63, v222, v223
v_mfma_f32_16x16x32_bf16 v[240:243], a[168:171], a[240:243], v[240:243]
s_add_u32 m0, s33, 4096
v_cvt_pk_bf16_f32 v64, v224, v225
v_cvt_pk_bf16_f32 v65, v226, v227
v_mfma_f32_16x16x32_bf16 v[244:247], a[168:171], a[244:247], v[244:247]
buffer_load_dwordx4 v2, s[20:23], s37 offen  lds
v_cvt_pk_bf16_f32 v68, v228, v229
v_cvt_pk_bf16_f32 v69, v230, v231
v_mfma_f32_16x16x32_bf16 v[248:251], a[168:171], a[248:251], v[248:251]
v_cvt_pk_bf16_f32 v72, v232, v233
v_cvt_pk_bf16_f32 v73, v234, v235
v_mfma_f32_16x16x32_bf16 v[252:255], a[168:171], a[252:255], v[252:255]
ds_read_b64_tr_b16 a[168:169], v7 offset:0
v_cvt_pk_bf16_f32 v76, v236, v237
v_cvt_pk_bf16_f32 v77, v238, v239
v_mfma_f32_16x16x32_bf16 a[0:3], a[172:175], a[224:227], a[0:3]
ds_read_b64_tr_b16 a[170:171], v7 offset:1024
v_cvt_pk_bf16_f32 v80, v240, v241
v_cvt_pk_bf16_f32 v81, v242, v243
v_mfma_f32_16x16x32_bf16 a[4:7], a[172:175], a[228:231], a[4:7]
v_cvt_pk_bf16_f32 v84, v244, v245
v_cvt_pk_bf16_f32 v85, v246, v247
v_mfma_f32_16x16x32_bf16 a[8:11], a[172:175], a[232:235], a[8:11]
v_cvt_pk_bf16_f32 v88, v248, v249
v_cvt_pk_bf16_f32 v89, v250, v251
v_mfma_f32_16x16x32_bf16 a[12:15], a[172:175], a[236:239], a[12:15]
s_add_u32 s37, s31, 163840
v_cvt_pk_bf16_f32 v92, v252, v253
v_cvt_pk_bf16_f32 v93, v254, v255
v_mfma_f32_16x16x32_bf16 a[16:19], a[172:175], a[240:243], a[16:19]
s_add_u32 m0, s33, 5120
v_accvgpr_read_b32 v20, a0
v_accvgpr_read_b32 v21, a1
v_accvgpr_read_b32 v22, a2
v_mfma_f32_16x16x32_bf16 a[20:23], a[172:175], a[244:247], a[20:23]
buffer_load_dwordx4 v2, s[20:23], s37 offen  lds
v_accvgpr_read_b32 v23, a3
v_cvt_pk_bf16_f32 v66, v20, v21
v_cvt_pk_bf16_f32 v67, v22, v23
v_mfma_f32_16x16x32_bf16 a[24:27], a[172:175], a[248:251], a[24:27]
v_accvgpr_read_b32 v24, a4
v_accvgpr_read_b32 v25, a5
v_accvgpr_read_b32 v26, a6
v_accvgpr_read_b32 v27, a7
v_mfma_f32_16x16x32_bf16 a[28:31], a[172:175], a[252:255], a[28:31]
ds_read_b64_tr_b16 a[172:173], v8 offset:0
v_cvt_pk_bf16_f32 v70, v24, v25
v_cvt_pk_bf16_f32 v71, v26, v27
v_accvgpr_read_b32 v20, a8
v_mfma_f32_16x16x32_bf16 a[32:35], a[176:179], a[224:227], a[32:35]
ds_read_b64_tr_b16 a[174:175], v8 offset:1024
s_add_u32 s31, s31, 262144
v_accvgpr_read_b32 v21, a9
v_accvgpr_read_b32 v22, a10
v_mfma_f32_16x16x32_bf16 a[36:39], a[176:179], a[228:231], a[36:39]
s_add_u32 s33, s33, 16384
s_and_b32 s33, s33, 65535
v_accvgpr_read_b32 v23, a11
v_cvt_pk_bf16_f32 v74, v20, v21
v_mfma_f32_16x16x32_bf16 a[40:43], a[176:179], a[232:235], a[40:43]
v_mov_b32 v16, 0
v_mov_b32 v17, 1
v_cvt_pk_bf16_f32 v75, v22, v23
v_accvgpr_read_b32 v24, a12
v_mfma_f32_16x16x32_bf16 a[44:47], a[176:179], a[236:239], a[44:47]
s_mov_b32 s48, s30
v_accvgpr_read_b32 v25, a13
v_accvgpr_read_b32 v26, a14
v_accvgpr_read_b32 v27, a15
v_mfma_f32_16x16x32_bf16 a[48:51], a[176:179], a[240:243], a[48:51]
s_add_u32 m0, s32, 0
v_cvt_pk_bf16_f32 v78, v24, v25
v_cvt_pk_bf16_f32 v79, v26, v27
v_accvgpr_read_b32 v20, a16
v_mfma_f32_16x16x32_bf16 a[52:55], a[176:179], a[244:247], a[52:55]
buffer_load_dwordx4 v1, s[12:15], s48 offen lds
v_accvgpr_read_b32 v21, a17
v_accvgpr_read_b32 v22, a18
v_accvgpr_read_b32 v23, a19
v_mfma_f32_16x16x32_bf16 a[56:59], a[176:179], a[248:251], a[56:59]
s_cmp_eq_u32 s17, 0
s_cselect_b32 s29, s39, 536870912
v_cvt_pk_bf16_f32 v82, v20, v21
v_cvt_pk_bf16_f32 v83, v22, v23
v_mfma_f32_16x16x32_bf16 a[60:63], a[176:179], a[252:255], a[60:63]
ds_read_b64_tr_b16 a[176:177], v9 offset:0
v_accvgpr_read_b32 v24, a20
v_accvgpr_read_b32 v25, a21
v_accvgpr_read_b32 v26, a22
v_mfma_f32_16x16x32_bf16 a[64:67], a[180:183], a[224:227], a[64:67]
ds_read_b64_tr_b16 a[178:179], v9 offset:1024
v_accvgpr_read_b32 v27, a23
v_cvt_pk_bf16_f32 v86, v24, v25
v_cvt_pk_bf16_f32 v87, v26, v27
v_mfma_f32_16x16x32_bf16 a[68:71], a[180:183], a[228:231], a[68:71]
s_mov_b64 exec, 1
buffer_store_dword v17, v16, s[8:11], s29 offen sc1
s_mov_b64 exec, -1
v_accvgpr_read_b32 v20, a24
v_mfma_f32_16x16x32_bf16 a[72:75], a[180:183], a[232:235], a[72:75]
v_accvgpr_read_b32 v21, a25
v_accvgpr_read_b32 v22, a26
v_accvgpr_read_b32 v23, a27
v_cvt_pk_bf16_f32 v90, v20, v21
v_mfma_f32_16x16x32_bf16 a[76:79], a[180:183], a[236:239], a[76:79]
s_add_u32 s48, s48, s34
v_cvt_pk_bf16_f32 v91, v22, v23
v_accvgpr_read_b32 v24, a28
v_accvgpr_read_b32 v25, a29
v_mfma_f32_16x16x32_bf16 a[80:83], a[180:183], a[240:243], a[80:83]
s_add_u32 m0, s32, 4096
v_accvgpr_read_b32 v26, a30
v_accvgpr_read_b32 v27, a31
v_cvt_pk_bf16_f32 v94, v24, v25
v_mfma_f32_16x16x32_bf16 a[84:87], a[180:183], a[244:247], a[84:87]
buffer_load_dwordx4 v1, s[12:15], s48 offen lds
v_cvt_pk_bf16_f32 v95, v26, v27
v_accvgpr_read_b32 v20, a32
v_accvgpr_read_b32 v21, a33
v_mfma_f32_16x16x32_bf16 a[88:91], a[180:183], a[248:251], a[88:91]
buffer_load_dword v15, v14, s[96:99], s100 offen
s_add_u32 s100, s100, 8192
v_accvgpr_read_b32 v22, a34
v_accvgpr_read_b32 v23, a35
v_mfma_f32_16x16x32_bf16 a[92:95], a[180:183], a[252:255], a[92:95]
ds_read_b64_tr_b16 a[180:181], v10 offset:0
v_cvt_pk_bf16_f32 v96, v20, v21
v_cvt_pk_bf16_f32 v97, v22, v23
v_accvgpr_read_b32 v24, a36
v_mfma_f32_16x16x32_bf16 a[96:99], a[184:187], a[224:227], a[96:99]
ds_read_b64_tr_b16 a[182:183], v10 offset:1024
v_accvgpr_read_b32 v25, a37
v_accvgpr_read_b32 v26, a38
v_accvgpr_read_b32 v27, a39
v_mfma_f32_16x16x32_bf16 a[100:103], a[184:187], a[228:231], a[100:103]
v_cvt_pk_bf16_f32 v100, v24, v25
v_cvt_pk_bf16_f32 v101, v26, v27
v_accvgpr_read_b32 v20, a40
v_accvgpr_read_b32 v21, a41
v_mfma_f32_16x16x32_bf16 a[104:107], a[184:187], a[232:235], a[104:107]
v_accvgpr_read_b32 v22, a42
v_accvgpr_read_b32 v23, a43
v_cvt_pk_bf16_f32 v104, v20, v21
v_cvt_pk_bf16_f32 v105, v22, v23
v_mfma_f32_16x16x32_bf16 a[108:111], a[184:187], a[236:239], a[108:111]
s_add_u32 s48, s48, s34
v_accvgpr_read_b32 v24, a44
v_accvgpr_read_b32 v25, a45
v_accvgpr_read_b32 v26, a46
v_mfma_f32_16x16x32_bf16 a[112:115], a[184:187], a[240:243], a[112:115]
s_add_u32 m0, s32, 8192
v_accvgpr_read_b32 v27, a47
v_cvt_pk_bf16_f32 v108, v24, v25
v_cvt_pk_bf16_f32 v109, v26, v27
v_mfma_f32_16x16x32_bf16 a[116:119], a[184:187], a[244:247], a[116:119]
buffer_load_dwordx4 v1, s[12:15], s48 offen lds
v_accvgpr_read_b32 v20, a48
v_accvgpr_read_b32 v21, a49
v_accvgpr_read_b32 v22, a50
v_mfma_f32_16x16x32_bf16 a[120:123], a[184:187], a[248:251], a[120:123]
v_accvgpr_read_b32 v23, a51
v_cvt_pk_bf16_f32 v112, v20, v21
v_cvt_pk_bf16_f32 v113, v22, v23
v_accvgpr_read_b32 v24, a52
v_mfma_f32_16x16x32_bf16 a[124:127], a[184:187], a[252:255], a[124:127]
ds_read_b64_tr_b16 a[184:185], v11 offset:0
v_accvgpr_read_b32 v25, a53
v_accvgpr_read_b32 v26, a54
v_accvgpr_read_b32 v27, a55
v_mfma_f32_16x16x32_bf16 a[128:131], v[28:31], a[224:227], a[128:131]
ds_read_b64_tr_b16 a[186:187], v11 offset:1024
v_cvt_pk_bf16_f32 v116, v24, v25
v_cvt_pk_bf16_f32 v117, v26, v27
v_accvgpr_read_b32 v20, a56
v_mfma_f32_16x16x32_bf16 a[132:135], v[28:31], a[228:231], a[132:135]
v_add_u32 v5, 16384, v5
v_and_b32 v5, 65535, v5
v_xor_b32 v6, 16, v5
v_accvgpr_read_b32 v21, a57
v_mfma_f32_16x16x32_bf16 a[136:139], v[28:31], a[232:235], a[136:139]
v_xor_b32 v7, 64, v5
v_xor_b32 v8, 80, v5
v_xor_b32 v9, 128, v5
v_accvgpr_read_b32 v22, a58
v_mfma_f32_16x16x32_bf16 a[140:143], v[28:31], a[236:239], a[140:143]
s_add_u32 s48, s48, s34
v_xor_b32 v10, 144, v5
v_xor_b32 v11, 192, v5
v_accvgpr_read_b32 v23, a59
v_mfma_f32_16x16x32_bf16 a[144:147], v[28:31], a[240:243], a[144:147]
s_add_u32 m0, s32, 12288
v_xor_b32 v12, 208, v5
v_cvt_pk_bf16_f32 v120, v20, v21
v_cvt_pk_bf16_f32 v121, v22, v23
v_mfma_f32_16x16x32_bf16 a[148:151], v[28:31], a[244:247], a[148:151]
buffer_load_dwordx4 v1, s[12:15], s48 offen lds
v_accvgpr_read_b32 v24, a60
v_accvgpr_read_b32 v25, a61
v_accvgpr_read_b32 v26, a62
v_mfma_f32_16x16x32_bf16 a[152:155], v[28:31], a[248:251], a[152:155]
v_accvgpr_read_b32 v27, a63
v_cvt_pk_bf16_f32 v124, v24, v25
v_cvt_pk_bf16_f32 v125, v26, v27
v_mfma_f32_16x16x32_bf16 a[156:159], v[28:31], a[252:255], a[156:159]
s_cmp_lt_u32 s35, s45
s_cbranch_scc1 L_g_tile
s_branch L_g_end
L_g_v17v:
s_waitcnt vmcnt(18) lgkmcnt(0)
s_barrier
v_mfma_f32_16x16x32_bf16 v[160:163], a[160:163], a[224:227], v[160:163]
ds_read_b64_tr_b16 a[192:193], v5 offset:0
v_mfma_f32_16x16x32_bf16 v[164:167], a[160:163], a[228:231], v[164:167]
v_mfma_f32_16x16x32_bf16 v[168:171], a[160:163], a[232:235], v[168:171]
ds_read_b64_tr_b16 a[194:195], v5 offset:1024
v_mfma_f32_16x16x32_bf16 v[172:175], a[160:163], a[236:239], v[172:175]
s_add_u32 s37, s31, 0
v_mfma_f32_16x16x32_bf16 v[176:179], a[160:163], a[240:243], v[176:179]
s_add_u32 m0, s33, 0
ds_read_b64_tr_b16 a[196:197], v6 offset:0
v_cvt_pk_bf16_f32 v32, v160, v161
v_cvt_pk_bf16_f32 v33, v162, v163
v_mfma_f32_16x16x32_bf16 v[180:183], a[160:163], a[244:247], v[180:183]
buffer_load_dwordx4 v2, s[20:23], s37 offen  lds
v_cvt_pk_bf16_f32 v36, v164, v165
v_cvt_pk_bf16_f32 v37, v166, v167
v_mfma_f32_16x16x32_bf16 v[184:187], a[160:163], a[248:251], v[184:187]
ds_read_b64_tr_b16 a[198:199], v6 offset:1024
v_cvt_pk_bf16_f32 v40, v168, v169
v_cvt_pk_bf16_f32 v41, v170, v171
v_mfma_f32_16x16x32_bf16 v[188:191], a[160:163], a[252:255], v[188:191]
ds_read_b128 a[160:163], v3 offset:0
v_cvt_pk_bf16_f32 v44, v172, v173
v_cvt_pk_bf16_f32 v45, v174, v175
v_mfma_f32_16x16x32_bf16 v[192:195], a[164:167], a[224:227], v[192:195]
ds_read_b64_tr_b16 a[200:201], v7 offset:0
v_cvt_pk_bf16_f32 v48, v176, v177
v_cvt_pk_bf16_f32 v49, v178, v179
v_mfma_f32_16x16x32_bf16 v[196:199], a[164:167], a[228:231], v[196:199]
v_cvt_pk_bf16_f32 v52, v180, v181
v_cvt_pk_bf16_f32 v53, v182, v183
v_mfma_f32_16x16x32_bf16 v[200:203], a[164:167], a[232:235], v[200:203]
ds_read_b64_tr_b16 a[202:203], v7 offset:1024
v_cvt_pk_bf16_f32 v56, v184, v185
v_cvt_pk_bf16_f32 v57, v186, v187
v_mfma_f32_16x16x32_bf16 v[204:207], a[164:167], a[236:239], v[204:207]
s_add_u32 s37, s31, 32768
v_cvt_pk_bf16_f32 v60, v188, v189
v_cvt_pk_bf16_f32 v61, v190, v191
v_mfma_f32_16x16x32_bf16 v[208:211], a[164:167], a[240:243], v[208:211]
s_add_u32 m0, s33, 1024
ds_read_b64_tr_b16 a[204:205], v8 offset:0
v_cvt_pk_bf16_f32 v34, v192, v193
v_cvt_pk_bf16_f32 v35, v194, v195
v_mfma_f32_16x16x32_bf16 v[212:215], a[164:167], a[244:247], v[212:215]
buffer_load_dwordx4 v2, s[20:23], s37 offen  lds
v_cvt_pk_bf16_f32 v38, v196, v197
v_cvt_pk_bf16_f32 v39, v198, v199
v_mfma_f32_16x16x32_bf16 v[216:219], a[164:167], a[248:251], v[216:219]
ds_read_b64_tr_b16 a[206:207], v8 offset:1024
v_cvt_pk_bf16_f32 v42, v200, v201
v_cvt_pk_bf16_f32 v43, v202, v203
v_mfma_f32_16x16x32_bf16 v[220:223], a[164:167], a[252:255], v[220:223]
ds_read_b128 a[164:167], v4 offset:1024
v_cvt_pk_bf16_f32 v46, v204, v205
v_cvt_pk_bf16_f32 v47, v206, v207
v_mfma_f32_16x16x32_bf16 v[224:227], a[168:171], a[224:227], v[224:227]
ds_read_b64_tr_b16 a[208:209], v9 offset:0
v_cvt_pk_bf16_f32 v50, v208, v209
v_cvt_pk_bf16_f32 v51, v210, v211
v_mfma_f32_16x16x32_bf16 v[228:231], a[168:171], a[228:231], v[228:231]
v_cvt_pk_bf16_f32 v54, v212, v213
v_cvt_pk_bf16_f32 v55, v214, v215
v_mfma_f32_16x16x32_bf16 v[232:235], a[168:171], a[232:235], v[232:235]
ds_read_b64_tr_b16 a[210:211], v9 offset:1024
v_cvt_pk_bf16_f32 v58, v216, v217
v_cvt_pk_bf16_f32 v59, v218, v219
v_mfma_f32_16x16x32_bf16 v[236:239], a[168:171], a[236:239], v[236:239]
s_add_u32 s37, s31, 131072
v_cvt_pk_bf16_f32 v62, v220, v221
v_cvt_pk_bf16_f32 v63, v222, v223
v_mfma_f32_16x16x32_bf16 v[240:243], a[168:171], a[240:243], v[240:243]
s_add_u32 m0, s33, 4096
ds_read_b64_tr_b16 a[212:213], v10 offset:0
v_cvt_pk_bf16_f32 v64, v224, v225
v_cvt_pk_bf16_f32 v65, v226, v227
v_mfma_f32_16x16x32_bf16 v[244:247], a[168:171], a[244:247], v[244:247]
buffer_load_dwordx4 v2, s[20:23], s37 offen  lds
v_cvt_pk_bf16_f32 v68, v228, v229
v_cvt_pk_bf16_f32 v69, v230, v231
v_mfma_f32_16x16x32_bf16 v[248:251], a[168:171], a[248:251], v[248:251]
ds_read_b64_tr_b16 a[214:215], v10 offset:1024
v_cvt_pk_bf16_f32 v72, v232, v233
v_cvt_pk_bf16_f32 v73, v234, v235
v_mfma_f32_16x16x32_bf16 v[252:255], a[168:171], a[252:255], v[252:255]
ds_read_b128 a[168:171], v3 offset:4096
v_cvt_pk_bf16_f32 v76, v236, v237
v_cvt_pk_bf16_f32 v77, v238, v239
v_mfma_f32_16x16x32_bf16 a[0:3], a[172:175], a[224:227], a[0:3]
ds_read_b64_tr_b16 a[216:217], v11 offset:0
v_cvt_pk_bf16_f32 v80, v240, v241
v_cvt_pk_bf16_f32 v81, v242, v243
v_mfma_f32_16x16x32_bf16 a[4:7], a[172:175], a[228:231], a[4:7]
v_cvt_pk_bf16_f32 v84, v244, v245
v_cvt_pk_bf16_f32 v85, v246, v247
v_mfma_f32_16x16x32_bf16 a[8:11], a[172:175], a[232:235], a[8:11]
ds_read_b64_tr_b16 a[218:219], v11 offset:1024
v_cvt_pk_bf16_f32 v88, v248, v249
v_cvt_pk_bf16_f32 v89, v250, v251
v_mfma_f32_16x16x32_bf16 a[12:15], a[172:175], a[236:239], a[12:15]
s_add_u32 s37, s31, 163840
v_cvt_pk_bf16_f32 v92, v252, v253
v_cvt_pk_bf16_f32 v93, v254, v255
v_mfma_f32_16x16x32_bf16 a[16:19], a[172:175], a[240:243], a[16:19]
s_add_u32 m0, s33, 5120
ds_read_b64_tr_b16 a[220:221], v12 offset:0
v_accvgpr_read_b32 v20, a0
v_accvgpr_read_b32 v21, a1
v_mfma_f32_16x16x32_bf16 a[20:23], a[172:175], a[244:247], a[20:23]
buffer_load_dwordx4 v2, s[20:23], s37 offen  lds
v_accvgpr_read_b32 v22, a2
v_accvgpr_read_b32 v23, a3
v_cvt_pk_bf16_f32 v66, v20, v21
v_mfma_f32_16x16x32_bf16 a[24:27], a[172:175], a[248:251], a[24:27]
ds_read_b64_tr_b16 a[222:223], v12 offset:1024
v_cvt_pk_bf16_f32 v67, v22, v23
v_accvgpr_read_b32 v24, a4
v_accvgpr_read_b32 v25, a5
v_mfma_f32_16x16x32_bf16 a[28:31], a[172:175], a[252:255], a[28:31]
ds_read_b128 a[172:175], v4 offset:5120
v_accvgpr_read_b32 v26, a6
v_accvgpr_read_b32 v27, a7
v_cvt_pk_bf16_f32 v70, v24, v25
v_mfma_f32_16x16x32_bf16 a[32:35], a[176:179], a[224:227], a[32:35]
s_add_u32 s31, s31, 262144
s_add_u32 s33, s33, 16384
v_cvt_pk_bf16_f32 v71, v26, v27
v_accvgpr_read_b32 v20, a8
v_mfma_f32_16x16x32_bf16 a[36:39], a[176:179], a[228:231], a[36:39]
s_and_b32 s33, s33, 65535
ds_read_b128 a[188:191], v4 offset:13312
v_accvgpr_read_b32 v21, a9
v_accvgpr_read_b32 v22, a10
v_mfma_f32_16x16x32_bf16 a[40:43], a[176:179], a[232:235], a[40:43]
v_mov_b32 v16, 0
v_mov_b32 v17, 1
v_accvgpr_read_b32 v23, a11
v_cvt_pk_bf16_f32 v74, v20, v21
v_mfma_f32_16x16x32_bf16 a[44:47], a[176:179], a[236:239], a[44:47]
s_mov_b32 s48, s30
v_cvt_pk_bf16_f32 v75, v22, v23
v_accvgpr_read_b32 v24, a12
v_accvgpr_read_b32 v25, a13
v_mfma_f32_16x16x32_bf16 a[48:51], a[176:179], a[240:243], a[48:51]
s_add_u32 m0, s32, 0
v_accvgpr_read_b32 v26, a14
v_accvgpr_read_b32 v27, a15
v_cvt_pk_bf16_f32 v78, v24, v25
v_mfma_f32_16x16x32_bf16 a[52:55], a[176:179], a[244:247], a[52:55]
buffer_load_dwordx4 v1, s[12:15], s48 offen lds
v_cvt_pk_bf16_f32 v79, v26, v27
v_accvgpr_read_b32 v20, a16
v_accvgpr_read_b32 v21, a17
v_mfma_f32_16x16x32_bf16 a[56:59], a[176:179], a[248:251], a[56:59]
s_cmp_eq_u32 s17, 0
s_cselect_b32 s29, s39, 536870912
v_accvgpr_read_b32 v22, a18
v_accvgpr_read_b32 v23, a19
v_mfma_f32_16x16x32_bf16 a[60:63], a[176:179], a[252:255], a[60:63]
ds_read_b128 a[176:179], v3 offset:8192
v_cvt_pk_bf16_f32 v82, v20, v21
v_cvt_pk_bf16_f32 v83, v22, v23
v_accvgpr_read_b32 v24, a20
v_mfma_f32_16x16x32_bf16 a[64:67], a[180:183], a[224:227], a[64:67]
s_mov_b64 exec, 1
buffer_store_dword v17, v16, s[8:11], s29 offen sc1
s_mov_b64 exec, -1
v_accvgpr_read_b32 v25, a21
v_mfma_f32_16x16x32_bf16 a[68:71], a[180:183], a[228:231], a[68:71]
v_accvgpr_read_b32 v26, a22
v_accvgpr_read_b32 v27, a23
v_cvt_pk_bf16_f32 v86, v24, v25
v_cvt_pk_bf16_f32 v87, v26, v27
v_mfma_f32_16x16x32_bf16 a[72:75], a[180:183], a[232:235], a[72:75]
v_accvgpr_read_b32 v20, a24
v_accvgpr_read_b32 v21, a25
v_accvgpr_read_b32 v22, a26
v_accvgpr_read_b32 v23, a27
v_mfma_f32_16x16x32_bf16 a[76:79], a[180:183], a[236:239], a[76:79]
s_add_u32 s48, s48, s34
v_cvt_pk_bf16_f32 v90, v20, v21
v_cvt_pk_bf16_f32 v91, v22, v23
v_accvgpr_read_b32 v24, a28
v_mfma_f32_16x16x32_bf16 a[80:83], a[180:183], a[240:243], a[80:83]
s_add_u32 m0, s32, 4096
v_accvgpr_read_b32 v25, a29
v_accvgpr_read_b32 v26, a30
v_accvgpr_read_b32 v27, a31
v_mfma_f32_16x16x32_bf16 a[84:87], a[180:183], a[244:247], a[84:87]
buffer_load_dwordx4 v1, s[12:15], s48 offen lds
v_cvt_pk_bf16_f32 v94, v24, v25
v_cvt_pk_bf16_f32 v95, v26, v27
v_accvgpr_read_b32 v20, a32
v_mfma_f32_16x16x32_bf16 a[88:91], a[180:183], a[248:251], a[88:91]
buffer_load_dword v15, v14, s[96:99], s100 offen
s_add_u32 s100, s100, 8192
v_accvgpr_read_b32 v21, a33
v_accvgpr_read_b32 v22, a34
v_mfma_f32_16x16x32_bf16 a[92:95], a[180:183], a[252:255], a[92:95]
ds_read_b128 a[180:183], v4 offset:9216
v_accvgpr_read_b32 v23, a35
v_cvt_pk_bf16_f32 v96, v20, v21
v_cvt_pk_bf16_f32 v97, v22, v23
v_mfma_f32_16x16x32_bf16 a[96:99], a[184:187], a[224:227], a[96:99]
v_accvgpr_read_b32 v24, a36
v_accvgpr_read_b32 v25, a37
v_accvgpr_read_b32 v26, a38
v_accvgpr_read_b32 v27, a39
v_mfma_f32_16x16x32_bf16 a[100:103], a[184:187], a[228:231], a[100:103]
v_cvt_pk_bf16_f32 v100, v24, v25
v_cvt_pk_bf16_f32 v101, v26, v27
v_accvgpr_read_b32 v20, a40
v_accvgpr_read_b32 v21, a41
v_mfma_f32_16x16x32_bf16 a[104:107], a[184:187], a[232:235], a[104:107]
v_accvgpr_read_b32 v22, a42
v_accvgpr_read_b32 v23, a43
v_cvt_pk_bf16_f32 v104, v20, v21
v_cvt_pk_bf16_f32 v105, v22, v23
v_mfma_f32_16x16x32_bf16 a[108:111], a[184:187], a[236:239], a[108:111]
s_add_u32 s48, s48, s34
v_accvgpr_read_b32 v24, a44
v_accvgpr_read_b32 v25, a45
v_accvgpr_read_b32 v26, a46
v_mfma_f32_16x16x32_bf16 a[112:115], a[184:187], a[240:243], a[112:115]
s_add_u32 m0, s32, 8192
v_accvgpr_read_b32 v27, a47
v_cvt_pk_bf16_f32 v108, v24, v25
v_cvt_pk_bf16_f32 v109, v26, v27
v_mfma_f32_16x16x32_bf16 a[116:119], a[184:187], a[244:247], a[116:119]
buffer_load_dwordx4 v1, s[12:15], s48 offen lds
v_accvgpr_read_b32 v20, a48
v_accvgpr_read_b32 v21, a49
v_accvgpr_read_b32 v22, a50
v_mfma_f32_16x16x32_bf16 a[120:123], a[184:187], a[248:251], a[120:123]
v_accvgpr_read_b32 v23, a51
v_cvt_pk_bf16_f32 v112, v20, v21
v_cvt_pk_bf16_f32 v113, v22, v23
v_accvgpr_read_b32 v24, a52
v_mfma_f32_16x16x32_bf16 a[124:127], a[184:187], a[252:255], a[124:127]
ds_read_b128 a[184:187], v3 offset:12288
v_accvgpr_read_b32 v25, a53
v_accvgpr_read_b32 v26, a54
v_accvgpr_read_b32 v27, a55
v_mfma_f32_16x16x32_bf16 a[128:131], v[28:31], a[224:227], a[128:131]
v_cvt_pk_bf16_f32 v116, v24, v25
v_cvt_pk_bf16_f32 v117, v26, v27
v_accvgpr_read_b32 v20, a56
v_accvgpr_read_b32 v21, a57
v_mfma_f32_16x16x32_bf16 a[132:135], v[28:31], a[228:231], a[132:135]
v_add_u32 v5, 16384, v5
v_and_b32 v5, 65535, v5
v_xor_b32 v6, 16, v5
v_accvgpr_read_b32 v22, a58
v_mfma_f32_16x16x32_bf16 a[136:139], v[28:31], a[232:235], a[136:139]
v_xor_b32 v7, 64, v5
v_xor_b32 v8, 80, v5
v_xor_b32 v9, 128, v5
v_accvgpr_read_b32 v23, a59
v_mfma_f32_16x16x32_bf16 a[140:143], v[28:31], a[236:239], a[140:143]
s_add_u32 s48, s48, s34
v_xor_b32 v10, 144, v5
v_xor_b32 v11, 192, v5
v_cvt_pk_bf16_f32 v120, v20, v21
v_mfma_f32_16x16x32_bf16 a[144:147], v[28:31], a[240:243], a[144:147]
s_add_u32 m0, s32, 12288
v_xor_b32 v12, 208, v5
v_cvt_pk_bf16_f32 v121, v22, v23
v_accvgpr_read_b32 v24, a60
v_mfma_f32_16x16x32_bf16 a[148:151], v[28:31], a[244:247], a[148:151]
buffer_load_dwordx4 v1, s[12:15], s48 offen lds
v_accvgpr_read_b32 v25, a61
v_accvgpr_read_b32 v26, a62
v_accvgpr_read_b32 v27, a63
v_mfma_f32_16x16x32_bf16 a[152:155], v[28:31], a[248:251], a[152:155]
v_cvt_pk_bf16_f32 v124, v24, v25
v_cvt_pk_bf16_f32 v125, v26, v27
v_mfma_f32_16x16x32_bf16 a[156:159], v[28:31], a[252:255], a[156:159]
s_cmp_lt_u32 s35, s45
s_cbranch_scc1 L_g_tile
s_branch L_g_end
L_g_first:
s_mov_b32 s100, 536870912
s_cmp_eq_u32 s61, 0
s_cbranch_scc0 L_g_end
v_mov_b32 v20, 128
s_mov_b32 s28, 0
L_poll_6:
buffer_load_dword v21, v20, s[56:59], 0 offen sc1
s_add_u32 s28, s28, 1
s_cmp_gt_u32 s28, 40000
s_cbranch_scc1 L_end
s_waitcnt vmcnt(0)
v_cmp_ne_u32 vcc, 8, v21
s_cbranch_vccz L_pd_7
s_sleep 1
s_branch L_poll_6
L_pd_7:
s_branch L_g_go
L_g_end:
v_bfe_u32 v16, v0, 3, 3
v_lshlrev_b32 v16, 4, v16
v_and_or_b32 v16, v0, 7, v16
v_bfe_u32 v17, v0, 4, 2
v_lshlrev_b32 v17, 5, v17
v_and_or_b32 v17, v0, 8, v17
v_bfe_u32 v18, v0, 1, 2
v_or_b32 v17, v17, v18
v_and_b32 v18, 1, v0
v_lshl_or_b32 v17, v18, 4, v17
s_bitcmp1_b32 s50, 1
s_cselect_b64 vcc, -1, 0
s_cselect_b32 s44, 64, 0x80
v_cndmask_b32 v16, v16, v17, vcc
v_lshlrev_b32 v13, 4, v16
s_movk_i32 s92, 0x800
s_bitcmp1_b32 s50, 0
s_cselect_b32 s92, 0x4000, s92
s_xor_b32 s93, s92, 0x4800
s_sub_u32 s93, s93, s44
v_pk_mul_f32 v[20:21], v[160:161], s[94:95] op_sel_hi:[1,0]
v_pk_mul_f32 v[22:23], v[162:163], s[94:95] op_sel_hi:[1,0]
v_cvt_pk_bf16_f32 v32, v20, v21
v_cvt_pk_bf16_f32 v33, v22, v23
v_pk_mul_f32 v[20:21], v[192:193], s[94:95] op_sel_hi:[1,0]
v_pk_mul_f32 v[22:23], v[194:195], s[94:95] op_sel_hi:[1,0]
v_cvt_pk_bf16_f32 v34, v20, v21
v_cvt_pk_bf16_f32 v35, v22, v23
s_mov_b32 s60, s62
s_mov_b32 s29, s62
buffer_store_dwordx4 v[32:35], v13, s[8:11], s29 offen sc1
v_pk_mul_f32 v[24:25], v[164:165], s[94:95] op_sel_hi:[1,0]
v_pk_mul_f32 v[26:27], v[166:167], s[94:95] op_sel_hi:[1,0]
v_cvt_pk_bf16_f32 v36, v24, v25
v_cvt_pk_bf16_f32 v37, v26, v27
v_pk_mul_f32 v[24:25], v[196:197], s[94:95] op_sel_hi:[1,0]
v_pk_mul_f32 v[26:27], v[198:199], s[94:95] op_sel_hi:[1,0]
v_cvt_pk_bf16_f32 v38, v24, v25
v_cvt_pk_bf16_f32 v39, v26, v27
s_add_u32 s29, s29, s44
buffer_store_dwordx4 v[36:39], v13, s[8:11], s29 offen sc1
v_pk_mul_f32 v[20:21], v[168:169], s[94:95] op_sel_hi:[1,0]
v_pk_mul_f32 v[22:23], v[170:171], s[94:95] op_sel_hi:[1,0]
v_cvt_pk_bf16_f32 v40, v20, v21
v_cvt_pk_bf16_f32 v41, v22, v23
v_pk_mul_f32 v[20:21], v[200:201], s[94:95] op_sel_hi:[1,0]
v_pk_mul_f32 v[22:23], v[202:203], s[94:95] op_sel_hi:[1,0]
v_cvt_pk_bf16_f32 v42, v20, v21
v_cvt_pk_bf16_f32 v43, v22, v23
s_add_u32 s29, s29, s93
buffer_store_dwordx4 v[40:43], v13, s[8:11], s29 offen sc1
v_pk_mul_f32 v[24:25], v[172:173], s[94:95] op_sel_hi:[1,0]
v_pk_mul_f32 v[26:27], v[174:175], s[94:95] op_sel_hi:[1,0]
v_cvt_pk_bf16_f32 v44, v24, v25
v_cvt_pk_bf16_f32 v45, v26, v27
v_pk_mul_f32 v[24:25], v[204:205], s[94:95] op_sel_hi:[1,0]
v_pk_mul_f32 v[26:27], v[206:207], s[94:95] op_sel_hi:[1,0]
v_cvt_pk_bf16_f32 v46, v24, v25
v_cvt_pk_bf16_f32 v47, v26, v27
s_add_u32 s29, s29, s44
buffer_store_dwordx4 v[44:47], v13, s[8:11], s29 offen sc1
v_pk_mul_f32 v[20:21], v[176:177], s[94:95] op_sel_hi:[1,0]
v_pk_mul_f32 v[22:23], v[178:179], s[94:95] op_sel_hi:[1,0]
v_cvt_pk_bf16_f32 v48, v20, v21
v_cvt_pk_bf16_f32 v49, v22, v23
v_pk_mul_f32 v[20:21], v[208:209], s[94:95] op_sel_hi:[1,0]
v_pk_mul_f32 v[22:23], v[210:211], s[94:95] op_sel_hi:[1,0]
v_cvt_pk_bf16_f32 v50, v20, v21
v_cvt_pk_bf16_f32 v51, v22, v23
s_add_u32 s29, s29, s93
buffer_store_dwordx4 v[48:51], v13, s[8:11], s29 offen sc1
v_pk_mul_f32 v[24:25], v[180:181], s[94:95] op_sel_hi:[1,0]
v_pk_mul_f32 v[26:27], v[182:183], s[94:95] op_sel_hi:[1,0]
v_cvt_pk_bf16_f32 v52, v24, v25
v_cvt_pk_bf16_f32 v53, v26, v27
v_pk_mul_f32 v[24:25], v[212:213], s[94:95] op_sel_hi:[1,0]
v_pk_mul_f32 v[26:27], v[214:215], s[94:95] op_sel_hi:[1,0]
v_cvt_pk_bf16_f32 v54, v24, v25
v_cvt_pk_bf16_f32 v55, v26, v27
s_add_u32 s29, s29, s44
buffer_store_dwordx4 v[52:55], v13, s[8:11], s29 offen sc1
v_pk_mul_f32 v[20:21], v[184:185], s[94:95] op_sel_hi:[1,0]
v_pk_mul_f32 v[22:23], v[186:187], s[94:95] op_sel_hi:[1,0]
v_cvt_pk_bf16_f32 v56, v20, v21
v_cvt_pk_bf16_f32 v57, v22, v23
v_pk_mul_f32 v[20:21], v[216:217], s[94:95] op_sel_hi:[1,0]
v_pk_mul_f32 v[22:23], v[218:219], s[94:95] op_sel_hi:[1,0]
v_cvt_pk_bf16_f32 v58, v20, v21
v_cvt_pk_bf16_f32 v59, v22, v23
s_add_u32 s29, s29, s93
buffer_store_dwordx4 v[56:59], v13, s[8:11], s29 offen sc1
v_pk_mul_f32 v[24:25], v[188:189], s[94:95] op_sel_hi:[1,0]
v_pk_mul_f32 v[26:27], v[190:191], s[94:95] op_sel_hi:[1,0]
v_cvt_pk_bf16_f32 v60, v24, v25
v_cvt_pk_bf16_f32 v61, v26, v27
v_pk_mul_f32 v[24:25], v[220:221], s[94:95] op_sel_hi:[1,0]
v_pk_mul_f32 v[26:27], v[222:223], s[94:95] op_sel_hi:[1,0]
v_cvt_pk_bf16_f32 v62, v24, v25
v_cvt_pk_bf16_f32 v63, v26, v27
s_add_u32 s29, s29, s44
buffer_store_dwordx4 v[60:63], v13, s[8:11], s29 offen sc1
v_pk_mul_f32 v[20:21], v[224:225], s[94:95] op_sel_hi:[1,0]
v_pk_mul_f32 v[22:23], v[226:227], s[94:95] op_sel_hi:[1,0]
v_cvt_pk_bf16_f32 v64, v20, v21
v_cvt_pk_bf16_f32 v65, v22, v23
v_accvgpr_read_b32 v20, a0
v_accvgpr_read_b32 v21, a1
v_accvgpr_read_b32 v22, a2
v_accvgpr_read_b32 v23, a3
v_pk_mul_f32 v[20:21], v[20:21], s[94:95] op_sel_hi:[1,0]
v_pk_mul_f32 v[22:23], v[22:23], s[94:95] op_sel_hi:[1,0]
v_cvt_pk_bf16_f32 v66, v20, v21
v_cvt_pk_bf16_f32 v67, v22, v23
s_add_u32 s60, s60, s92
s_mov_b32 s29, s60
buffer_store_dwordx4 v[64:67], v13, s[8:11], s29 offen sc1
v_pk_mul_f32 v[24:25], v[228:229], s[94:95] op_sel_hi:[1,0]
v_pk_mul_f32 v[26:27], v[230:231], s[94:95] op_sel_hi:[1,0]
v_cvt_pk_bf16_f32 v68, v24, v25
v_cvt_pk_bf16_f32 v69, v26, v27
v_accvgpr_read_b32 v24, a4
v_accvgpr_read_b32 v25, a5
v_accvgpr_read_b32 v26, a6
v_accvgpr_read_b32 v27, a7
v_pk_mul_f32 v[24:25], v[24:25], s[94:95] op_sel_hi:[1,0]
v_pk_mul_f32 v[26:27], v[26:27], s[94:95] op_sel_hi:[1,0]
v_cvt_pk_bf16_f32 v70, v24, v25
v_cvt_pk_bf16_f32 v71, v26, v27
s_add_u32 s29, s29, s44
buffer_store_dwordx4 v[68:71], v13, s[8:11], s29 offen sc1
v_pk_mul_f32 v[20:21], v[232:233], s[94:95] op_sel_hi:[1,0]
v_pk_mul_f32 v[22:23], v[234:235], s[94:95] op_sel_hi:[1,0]
v_cvt_pk_bf16_f32 v72, v20, v21
v_cvt_pk_bf16_f32 v73, v22, v23
v_accvgpr_read_b32 v20, a8
v_accvgpr_read_b32 v21, a9
v_accvgpr_read_b32 v22, a10
v_accvgpr_read_b32 v23, a11
v_pk_mul_f32 v[20:21], v[20:21], s[94:95] op_sel_hi:[1,0]
v_pk_mul_f32 v[22:23], v[22:23], s[94:95] op_sel_hi:[1,0]
v_cvt_pk_bf16_f32 v74, v20, v21
v_cvt_pk_bf16_f32 v75, v22, v23
s_add_u32 s29, s29, s93
buffer_store_dwordx4 v[72:75], v13, s[8:11], s29 offen sc1
v_pk_mul_f32 v[24:25], v[236:237], s[94:95] op_sel_hi:[1,0]
v_pk_mul_f32 v[26:27], v[238:239], s[94:95] op_sel_hi:[1,0]
v_cvt_pk_bf16_f32 v76, v24, v25
v_cvt_pk_bf16_f32 v77, v26, v27
v_accvgpr_read_b32 v24, a12
v_accvgpr_read_b32 v25, a13
v_accvgpr_read_b32 v26, a14
v_accvgpr_read_b32 v27, a15
v_pk_mul_f32 v[24:25], v[24:25], s[94:95] op_sel_hi:[1,0]
v_pk_mul_f32 v[26:27], v[26:27], s[94:95] op_sel_hi:[1,0]
v_cvt_pk_bf16_f32 v78, v24, v25
v_cvt_pk_bf16_f32 v79, v26, v27
s_add_u32 s29, s29, s44
buffer_store_dwordx4 v[76:79], v13, s[8:11], s29 offen sc1
v_pk_mul_f32 v[20:21], v[240:241], s[94:95] op_sel_hi:[1,0]
v_pk_mul_f32 v[22:23], v[242:243], s[94:95] op_sel_hi:[1,0]
v_cvt_pk_bf16_f32 v80, v20, v21
v_cvt_pk_bf16_f32 v81, v22, v23
v_accvgpr_read_b32 v20, a16
v_accvgpr_read_b32 v21, a17
v_accvgpr_read_b32 v22, a18
v_accvgpr_read_b32 v23, a19
v_pk_mul_f32 v[20:21], v[20:21], s[94:95] op_sel_hi:[1,0]
v_pk_mul_f32 v[22:23], v[22:23], s[94:95] op_sel_hi:[1,0]
v_cvt_pk_bf16_f32 v82, v20, v21
v_cvt_pk_bf16_f32 v83, v22, v23
s_add_u32 s29, s29, s93
buffer_store_dwordx4 v[80:83], v13, s[8:11], s29 offen sc1
v_pk_mul_f32 v[24:25], v[244:245], s[94:95] op_sel_hi:[1,0]
v_pk_mul_f32 v[26:27], v[246:247], s[94:95] op_sel_hi:[1,0]
v_cvt_pk_bf16_f32 v84, v24, v25
v_cvt_pk_bf16_f32 v85, v26, v27
v_accvgpr_read_b32 v24, a20
v_accvgpr_read_b32 v25, a21
v_accvgpr_read_b32 v26, a22
v_accvgpr_read_b32 v27, a23
v_pk_mul_f32 v[24:25], v[24:25], s[94:95] op_sel_hi:[1,0]
v_pk_mul_f32 v[26:27], v[26:27], s[94:95] op_sel_hi:[1,0]
v_cvt_pk_bf16_f32 v86, v24, v25
v_cvt_pk_bf16_f32 v87, v26, v27
s_add_u32 s29, s29, s44
buffer_store_dwordx4 v[84:87], v13, s[8:11], s29 offen sc1
v_pk_mul_f32 v[20:21], v[248:249], s[94:95] op_sel_hi:[1,0]
v_pk_mul_f32 v[22:23], v[250:251], s[94:95] op_sel_hi:[1,0]
v_cvt_pk_bf16_f32 v88, v20, v21
v_cvt_pk_bf16_f32 v89, v22, v23
v_accvgpr_read_b32 v20, a24
v_accvgpr_read_b32 v21, a25
v_accvgpr_read_b32 v22, a26
v_accvgpr_read_b32 v23, a27
v_pk_mul_f32 v[20:21], v[20:21], s[94:95] op_sel_hi:[1,0]
v_pk_mul_f32 v[22:23], v[22:23], s[94:95] op_sel_hi:[1,0]
v_cvt_pk_bf16_f32 v90, v20, v21
v_cvt_pk_bf16_f32 v91, v22, v23
s_add_u32 s29, s29, s93
buffer_store_dwordx4 v[88:91], v13, s[8:11], s29 offen sc1
v_pk_mul_f32 v[24:25], v[252:253], s[94:95] op_sel_hi:[1,0]
v_pk_mul_f32 v[26:27], v[254:255], s[94:95] op_sel_hi:[1,0]
v_cvt_pk_bf16_f32 v92, v24, v25
v_cvt_pk_bf16_f32 v93, v26, v27
v_accvgpr_read_b32 v24, a28
v_accvgpr_read_b32 v25, a29
v_accvgpr_read_b32 v26, a30
v_accvgpr_read_b32 v27, a31
v_pk_mul_f32 v[24:25], v[24:25], s[94:95] op_sel_hi:[1,0]
v_pk_mul_f32 v[26:27], v[26:27], s[94:95] op_sel_hi:[1,0]
v_cvt_pk_bf16_f32 v94, v24, v25
v_cvt_pk_bf16_f32 v95, v26, v27
s_add_u32 s29, s29, s44
buffer_store_dwordx4 v[92:95], v13, s[8:11], s29 offen sc1
v_accvgpr_read_b32 v20, a32
v_accvgpr_read_b32 v21, a33
v_accvgpr_read_b32 v22, a34
v_accvgpr_read_b32 v23, a35
v_pk_mul_f32 v[20:21], v[20:21], s[94:95] op_sel_hi:[1,0]
v_pk_mul_f32 v[22:23], v[22:23], s[94:95] op_sel_hi:[1,0]
v_cvt_pk_bf16_f32 v96, v20, v21
v_cvt_pk_bf16_f32 v97, v22, v23
v_accvgpr_read_b32 v20, a64
v_accvgpr_read_b32 v21, a65
v_accvgpr_read_b32 v22, a66
v_accvgpr_read_b32 v23, a67
v_pk_mul_f32 v[20:21], v[20:21], s[94:95] op_sel_hi:[1,0]
v_pk_mul_f32 v[22:23], v[22:23], s[94:95] op_sel_hi:[1,0]
v_cvt_pk_bf16_f32 v98, v20, v21
v_cvt_pk_bf16_f32 v99, v22, v23
s_add_u32 s60, s60, s92
s_mov_b32 s29, s60
buffer_store_dwordx4 v[96:99], v13, s[8:11], s29 offen sc1
v_accvgpr_read_b32 v24, a36
v_accvgpr_read_b32 v25, a37
v_accvgpr_read_b32 v26, a38
v_accvgpr_read_b32 v27, a39
v_pk_mul_f32 v[24:25], v[24:25], s[94:95] op_sel_hi:[1,0]
v_pk_mul_f32 v[26:27], v[26:27], s[94:95] op_sel_hi:[1,0]
v_cvt_pk_bf16_f32 v100, v24, v25
v_cvt_pk_bf16_f32 v101, v26, v27
v_accvgpr_read_b32 v24, a68
v_accvgpr_read_b32 v25, a69
v_accvgpr_read_b32 v26, a70
v_accvgpr_read_b32 v27, a71
v_pk_mul_f32 v[24:25], v[24:25], s[94:95] op_sel_hi:[1,0]
v_pk_mul_f32 v[26:27], v[26:27], s[94:95] op_sel_hi:[1,0]
v_cvt_pk_bf16_f32 v102, v24, v25
v_cvt_pk_bf16_f32 v103, v26, v27
s_add_u32 s29, s29, s44
buffer_store_dwordx4 v[100:103], v13, s[8:11], s29 offen sc1
v_accvgpr_read_b32 v20, a40
v_accvgpr_read_b32 v21, a41
v_accvgpr_read_b32 v22, a42
v_accvgpr_read_b32 v23, a43
v_pk_mul_f32 v[20:21], v[20:21], s[94:95] op_sel_hi:[1,0]
v_pk_mul_f32 v[22:23], v[22:23], s[94:95] op_sel_hi:[1,0]
v_cvt_pk_bf16_f32 v104, v20, v21
v_cvt_pk_bf16_f32 v105, v22, v23
v_accvgpr_read_b32 v20, a72
v_accvgpr_read_b32 v21, a73
v_accvgpr_read_b32 v22, a74
v_accvgpr_read_b32 v23, a75
v_pk_mul_f32 v[20:21], v[20:21], s[94:95] op_sel_hi:[1,0]
v_pk_mul_f32 v[22:23], v[22:23], s[94:95] op_sel_hi:[1,0]
v_cvt_pk_bf16_f32 v106, v20, v21
v_cvt_pk_bf16_f32 v107, v22, v23
s_add_u32 s29, s29, s93
buffer_store_dwordx4 v[104:107], v13, s[8:11], s29 offen sc1
v_accvgpr_read_b32 v24, a44
v_accvgpr_read_b32 v25, a45
v_accvgpr_read_b32 v26, a46
v_accvgpr_read_b32 v27, a47
v_pk_mul_f32 v[24:25], v[24:25], s[94:95] op_sel_hi:[1,0]
v_pk_mul_f32 v[26:27], v[26:27], s[94:95] op_sel_hi:[1,0]
v_cvt_pk_bf16_f32 v108, v24, v25
v_cvt_pk_bf16_f32 v109, v26, v27
v_accvgpr_read_b32 v24, a76
v_accvgpr_read_b32 v25, a77
v_accvgpr_read_b32 v26, a78
v_accvgpr_read_b32 v27, a79
v_pk_mul_f32 v[24:25], v[24:25], s[94:95] op_sel_hi:[1,0]
v_pk_mul_f32 v[26:27], v[26:27], s[94:95] op_sel_hi:[1,0]
v_cvt_pk_bf16_f32 v110, v24, v25
v_cvt_pk_bf16_f32 v111, v26, v27
s_add_u32 s29, s29, s44
buffer_store_dwordx4 v[108:111], v13, s[8:11], s29 offen sc1
v_accvgpr_read_b32 v20, a48
v_accvgpr_read_b32 v21, a49
v_accvgpr_read_b32 v22, a50
v_accvgpr_read_b32 v23, a51
v_pk_mul_f32 v[20:21], v[20:21], s[94:95] op_sel_hi:[1,0]
v_pk_mul_f32 v[22:23], v[22:23], s[94:95] op_sel_hi:[1,0]
v_cvt_pk_bf16_f32 v112, v20, v21
v_cvt_pk_bf16_f32 v113, v22, v23
v_accvgpr_read_b32 v20, a80
v_accvgpr_read_b32 v21, a81
v_accvgpr_read_b32 v22, a82
v_accvgpr_read_b32 v23, a83
v_pk_mul_f32 v[20:21], v[20:21], s[94:95] op_sel_hi:[1,0]
v_pk_mul_f32 v[22:23], v[22:23], s[94:95] op_sel_hi:[1,0]
v_cvt_pk_bf16_f32 v114, v20, v21
v_cvt_pk_bf16_f32 v115, v22, v23
s_add_u32 s29, s29, s93
buffer_store_dwordx4 v[112:115], v13, s[8:11], s29 offen sc1
v_accvgpr_read_b32 v24, a52
v_accvgpr_read_b32 v25, a53
v_accvgpr_read_b32 v26, a54
v_accvgpr_read_b32 v27, a55
v_pk_mul_f32 v[24:25], v[24:25], s[94:95] op_sel_hi:[1,0]
v_pk_mul_f32 v[26:27], v[26:27], s[94:95] op_sel_hi:[1,0]
v_cvt_pk_bf16_f32 v116, v24, v25
v_cvt_pk_bf16_f32 v117, v26, v27
v_accvgpr_read_b32 v24, a84
v_accvgpr_read_b32 v25, a85
v_accvgpr_read_b32 v26, a86
v_accvgpr_read_b32 v27, a87
v_pk_mul_f32 v[24:25], v[24:25], s[94:95] op_sel_hi:[1,0]
v_pk_mul_f32 v[26:27], v[26:27], s[94:95] op_sel_hi:[1,0]
v_cvt_pk_bf16_f32 v118, v24, v25
v_cvt_pk_bf16_f32 v119, v26, v27
s_add_u32 s29, s29, s44
buffer_store_dwordx4 v[116:119], v13, s[8:11], s29 offen sc1
v_accvgpr_read_b32 v20, a56
v_accvgpr_read_b32 v21, a57
v_accvgpr_read_b32 v22, a58
v_accvgpr_read_b32 v23, a59
v_pk_mul_f32 v[20:21], v[20:21], s[94:95] op_sel_hi:[1,0]
v_pk_mul_f32 v[22:23], v[22:23], s[94:95] op_sel_hi:[1,0]
v_cvt_pk_bf16_f32 v120, v20, v21
v_cvt_pk_bf16_f32 v121, v22, v23
v_accvgpr_read_b32 v20, a88
v_accvgpr_read_b32 v21, a89
v_accvgpr_read_b32 v22, a90
v_accvgpr_read_b32 v23, a91
v_pk_mul_f32 v[20:21], v[20:21], s[94:95] op_sel_hi:[1,0]
v_pk_mul_f32 v[22:23], v[22:23], s[94:95] op_sel_hi:[1,0]
v_cvt_pk_bf16_f32 v122, v20, v21
v_cvt_pk_bf16_f32 v123, v22, v23
s_add_u32 s29, s29, s93
buffer_store_dwordx4 v[120:123], v13, s[8:11], s29 offen sc1
v_accvgpr_read_b32 v24, a60
v_accvgpr_read_b32 v25, a61
v_accvgpr_read_b32 v26, a62
v_accvgpr_read_b32 v27, a63
v_pk_mul_f32 v[24:25], v[24:25], s[94:95] op_sel_hi:[1,0]
v_pk_mul_f32 v[26:27], v[26:27], s[94:95] op_sel_hi:[1,0]
v_cvt_pk_bf16_f32 v124, v24, v25
v_cvt_pk_bf16_f32 v125, v26, v27
v_accvgpr_read_b32 v24, a92
v_accvgpr_read_b32 v25, a93
v_accvgpr_read_b32 v26, a94
v_accvgpr_read_b32 v27, a95
v_pk_mul_f32 v[24:25], v[24:25], s[94:95] op_sel_hi:[1,0]
v_pk_mul_f32 v[26:27], v[26:27], s[94:95] op_sel_hi:[1,0]
v_cvt_pk_bf16_f32 v126, v24, v25
v_cvt_pk_bf16_f32 v127, v26, v27
s_add_u32 s29, s29, s44
buffer_store_dwordx4 v[124:127], v13, s[8:11], s29 offen sc1
v_accvgpr_read_b32 v20, a96
v_accvgpr_read_b32 v21, a97
v_accvgpr_read_b32 v22, a98
v_accvgpr_read_b32 v23, a99
v_pk_mul_f32 v[20:21], v[20:21], s[94:95] op_sel_hi:[1,0]
v_pk_mul_f32 v[22:23], v[22:23], s[94:95] op_sel_hi:[1,0]
v_cvt_pk_bf16_f32 v128, v20, v21
v_cvt_pk_bf16_f32 v129, v22, v23
v_accvgpr_read_b32 v20, a128
v_accvgpr_read_b32 v21, a129
v_accvgpr_read_b32 v22, a130
v_accvgpr_read_b32 v23, a131
v_pk_mul_f32 v[20:21], v[20:21], s[94:95] op_sel_hi:[1,0]
v_pk_mul_f32 v[22:23], v[22:23], s[94:95] op_sel_hi:[1,0]
v_cvt_pk_bf16_f32 v130, v20, v21
v_cvt_pk_bf16_f32 v131, v22, v23
s_add_u32 s60, s60, s92
s_mov_b32 s29, s60
buffer_store_dwordx4 v[128:131], v13, s[8:11], s29 offen sc1
v_accvgpr_read_b32 v24, a100
v_accvgpr_read_b32 v25, a101
v_accvgpr_read_b32 v26, a102
v_accvgpr_read_b32 v27, a103
v_pk_mul_f32 v[24:25], v[24:25], s[94:95] op_sel_hi:[1,0]
v_pk_mul_f32 v[26:27], v[26:27], s[94:95] op_sel_hi:[1,0]
v_cvt_pk_bf16_f32 v132, v24, v25
v_cvt_pk_bf16_f32 v133, v26, v27
v_accvgpr_read_b32 v24, a132
v_accvgpr_read_b32 v25, a133
v_accvgpr_read_b32 v26, a134
v_accvgpr_read_b32 v27, a135
v_pk_mul_f32 v[24:25], v[24:25], s[94:95] op_sel_hi:[1,0]
v_pk_mul_f32 v[26:27], v[26:27], s[94:95] op_sel_hi:[1,0]
v_cvt_pk_bf16_f32 v134, v24, v25
v_cvt_pk_bf16_f32 v135, v26, v27
s_add_u32 s29, s29, s44
buffer_store_dwordx4 v[132:135], v13, s[8:11], s29 offen sc1
v_accvgpr_read_b32 v20, a104
v_accvgpr_read_b32 v21, a105
v_accvgpr_read_b32 v22, a106
v_accvgpr_read_b32 v23, a107
v_pk_mul_f32 v[20:21], v[20:21], s[94:95] op_sel_hi:[1,0]
v_pk_mul_f32 v[22:23], v[22:23], s[94:95] op_sel_hi:[1,0]
v_cvt_pk_bf16_f32 v136, v20, v21
v_cvt_pk_bf16_f32 v137, v22, v23
v_accvgpr_read_b32 v20, a136
v_accvgpr_read_b32 v21, a137
v_accvgpr_read_b32 v22, a138
v_accvgpr_read_b32 v23, a139
v_pk_mul_f32 v[20:21], v[20:21], s[94:95] op_sel_hi:[1,0]
v_pk_mul_f32 v[22:23], v[22:23], s[94:95] op_sel_hi:[1,0]
v_cvt_pk_bf16_f32 v138, v20, v21
v_cvt_pk_bf16_f32 v139, v22, v23
s_add_u32 s29, s29, s93
buffer_store_dwordx4 v[136:139], v13, s[8:11], s29 offen sc1
v_accvgpr_read_b32 v24, a108
v_accvgpr_read_b32 v25, a109
v_accvgpr_read_b32 v26, a110
v_accvgpr_read_b32 v27, a111
v_pk_mul_f32 v[24:25], v[24:25], s[94:95] op_sel_hi:[1,0]
v_pk_mul_f32 v[26:27], v[26:27], s[94:95] op_sel_hi:[1,0]
v_cvt_pk_bf16_f32 v140, v24, v25
v_cvt_pk_bf16_f32 v141, v26, v27
v_accvgpr_read_b32 v24, a140
v_accvgpr_read_b32 v25, a141
v_accvgpr_read_b32 v26, a142
v_accvgpr_read_b32 v27, a143
v_pk_mul_f32 v[24:25], v[24:25], s[94:95] op_sel_hi:[1,0]
v_pk_mul_f32 v[26:27], v[26:27], s[94:95] op_sel_hi:[1,0]
v_cvt_pk_bf16_f32 v142, v24, v25
v_cvt_pk_bf16_f32 v143, v26, v27
s_add_u32 s29, s29, s44
buffer_store_dwordx4 v[140:143], v13, s[8:11], s29 offen sc1
v_accvgpr_read_b32 v20, a112
v_accvgpr_read_b32 v21, a113
v_accvgpr_read_b32 v22, a114
v_accvgpr_read_b32 v23, a115
v_pk_mul_f32 v[20:21], v[20:21], s[94:95] op_sel_hi:[1,0]
v_pk_mul_f32 v[22:23], v[22:23], s[94:95] op_sel_hi:[1,0]
v_cvt_pk_bf16_f32 v144, v20, v21
v_cvt_pk_bf16_f32 v145, v22, v23
v_accvgpr_read_b32 v20, a144
v_accvgpr_read_b32 v21, a145
v_accvgpr_read_b32 v22, a146
v_accvgpr_read_b32 v23, a147
v_pk_mul_f32 v[20:21], v[20:21], s[94:95] op_sel_hi:[1,0]
v_pk_mul_f32 v[22:23], v[22:23], s[94:95] op_sel_hi:[1,0]
v_cvt_pk_bf16_f32 v146, v20, v21
v_cvt_pk_bf16_f32 v147, v22, v23
s_add_u32 s29, s29, s93
buffer_store_dwordx4 v[144:147], v13, s[8:11], s29 offen sc1
v_accvgpr_read_b32 v24, a116
v_accvgpr_read_b32 v25, a117
v_accvgpr_read_b32 v26, a118
v_accvgpr_read_b32 v27, a119
v_pk_mul_f32 v[24:25], v[24:25], s[94:95] op_sel_hi:[1,0]
v_pk_mul_f32 v[26:27], v[26:27], s[94:95] op_sel_hi:[1,0]
v_cvt_pk_bf16_f32 v148, v24, v25
v_cvt_pk_bf16_f32 v149, v26, v27
v_accvgpr_read_b32 v24, a148
v_accvgpr_read_b32 v25, a149
v_accvgpr_read_b32 v26, a150
v_accvgpr_read_b32 v27, a151
v_pk_mul_f32 v[24:25], v[24:25], s[94:95] op_sel_hi:[1,0]
v_pk_mul_f32 v[26:27], v[26:27], s[94:95] op_sel_hi:[1,0]
v_cvt_pk_bf16_f32 v150, v24, v25
v_cvt_pk_bf16_f32 v151, v26, v27
s_add_u32 s29, s29, s44
buffer_store_dwordx4 v[148:151], v13, s[8:11], s29 offen sc1
v_accvgpr_read_b32 v20, a120
v_accvgpr_read_b32 v21, a121
v_accvgpr_read_b32 v22, a122
v_accvgpr_read_b32 v23, a123
v_pk_mul_f32 v[20:21], v[20:21], s[94:95] op_sel_hi:[1,0]
v_pk_mul_f32 v[22:23], v[22:23], s[94:95] op_sel_hi:[1,0]
v_cvt_pk_bf16_f32 v152, v20, v21
v_cvt_pk_bf16_f32 v153, v22, v23
v_accvgpr_read_b32 v20, a152
v_accvgpr_read_b32 v21, a153
v_accvgpr_read_b32 v22, a154
v_accvgpr_read_b32 v23, a155
v_pk_mul_f32 v[20:21], v[20:21], s[94:95] op_sel_hi:[1,0]
v_pk_mul_f32 v[22:23], v[22:23], s[94:95] op_sel_hi:[1,0]
v_cvt_pk_bf16_f32 v154, v20, v21
v_cvt_pk_bf16_f32 v155, v22, v23
s_add_u32 s29, s29, s93
buffer_store_dwordx4 v[152:155], v13, s[8:11], s29 offen sc1
v_accvgpr_read_b32 v24, a124
v_accvgpr_read_b32 v25, a125
v_accvgpr_read_b32 v26, a126
v_accvgpr_read_b32 v27, a127
v_pk_mul_f32 v[24:25], v[24:25], s[94:95] op_sel_hi:[1,0]
v_pk_mul_f32 v[26:27], v[26:27], s[94:95] op_sel_hi:[1,0]
v_cvt_pk_bf16_f32 v156, v24, v25
v_cvt_pk_bf16_f32 v157, v26, v27
v_accvgpr_read_b32 v24, a156
v_accvgpr_read_b32 v25, a157
v_accvgpr_read_b32 v26, a158
v_accvgpr_read_b32 v27, a159
v_pk_mul_f32 v[24:25], v[24:25], s[94:95] op_sel_hi:[1,0]
v_pk_mul_f32 v[26:27], v[26:27], s[94:95] op_sel_hi:[1,0]
v_cvt_pk_bf16_f32 v158, v24, v25
v_cvt_pk_bf16_f32 v159, v26, v27
s_add_u32 s29, s29, s44
buffer_store_dwordx4 v[156:159], v13, s[8:11], s29 offen sc1
v_mov_b32 v20, 128
s_mov_b32 s28, 0
L_poll_8:
buffer_load_dword v21, v20, s[56:59], 0 offen sc1
s_add_u32 s28, s28, 1
s_cmp_gt_u32 s28, 40000
s_cbranch_scc1 L_end
s_waitcnt vmcnt(0)
v_cmp_ne_u32 vcc, 8, v21
s_cbranch_vccz L_pd_9
s_sleep 1
s_branch L_poll_8
L_pd_9:
s_waitcnt vmcnt(0) lgkmcnt(0)
s_barrier
v_mov_b32 v16, 0
v_mov_b32 v17, 1
s_cmp_eq_u32 s17, 0
s_cselect_b32 s29, s63, 536870912
s_mov_b64 exec, 1
buffer_store_dword v17, v16, s[8:11], s29 offen sc1
s_mov_b64 exec, -1
s_mov_b32 s62, 536870912
s_mov_b32 s63, 536870912
s_cmp_lt_u32 s35, s45
s_cbranch_scc1 L_g_go
s_cmp_eq_u32 s3, 1
s_cbranch_scc1 L_part
s_cmp_eq_u32 s61, 1
s_cbranch_scc1 L_bdie
s_sub_u32 s24, s3, 4
s_lshl_b32 s24, s24, 3
s_lshr_b32 s42, s16, 2
s_add_u32 s42, s42, s24
s_and_b32 s62, s16, 3
s_mov_b32 s40, 0x3e0293ee
s_mov_b32 s50, 0xf149f2ca
s_mov_b32 s51, 0x41a00000
v_and_b32 v20, 7, v0
v_lshlrev_b32 v20, 2, v20
v_bfe_u32 v21, v0, 3, 1
s_lshl_b32 s25, s42, 7
s_add_u32 s25, s25, 111165440
s_lshr_b32 s24, s42, 1
s_lshl_b32 s24, s24, 7
s_add_u32 s24, s24, 111173632
s_sub_u32 s24, s24, s25
v_mad_u32_u24 v20, v21, s24, v20
s_mov_b32 s28, 0
L_poll_10:
buffer_load_dword v21, v20, s[8:11], s25 offen sc1
s_add_u32 s28, s28, 1
s_cmp_gt_u32 s28, 40000
s_cbranch_scc1 L_end
s_waitcnt vmcnt(0)
v_cmp_ne_u32 vcc, 1, v21
s_cbranch_vccz L_pd_11
s_sleep 1
s_branch L_poll_10
L_pd_11:
s_sub_u32 s41, 7, s62
s_mov_b32 s60, 0
L_aat:
v_and_b32 v5, 31, v0
v_bfe_u32 v26, v0, 5, 1
v_lshlrev_b32 v27, 2, v26
v_sub_u32 v5, v5, v27
v_bfe_u32 v27, v0, 4, 1
v_lshlrev_b32 v6, 17, v27
v_lshl_add_u32 v6, v26, 8, v6
v_and_b32 v27, 15, v0
v_lshl_add_u32 v6, v27, 4, v6
v_and_b32 v2, 63, v0
v_lshlrev_b32 v2, 4, v2
s_lshl_b32 s24, s17, 13
v_add_u32 v1, s24, v2
v_add_u32 v3, 32768, v2
v_mov_b32 v4, v2
s_lshl_b32 s46, s42, 20
s_add_u32 s46, s46, 0
s_mov_b32 s47, s24
s_lshl_b32 s44, s41, 2
s_add_u32 s45, s44, 4
s_add_u32 s44, s44, s17
s_mov_b32 s43, 0
s_mov_b32 s48, 0
s_mov_b32 s54, s50
s_mov_b32 s55, s50
s_barrier
s_lshr_b32 s26, s42, 1
s_lshl_b32 s26, s26, 6
s_lshl_b32 s27, s44, 1
s_add_u32 s26, s26, s27
s_lshl_b32 s26, s26, 1
s_and_b32 s27, s42, 1
s_add_u32 s26, s26, s27
s_lshl_b32 s26, s26, 13
s_add_u32 s26, s26, 117440512
s_add_u32 s27, s26, 0
buffer_load_dwordx4 a[0:3], v2, s[8:11], s27 offen offset:0 sc1
buffer_load_dwordx4 a[4:7], v2, s[8:11], s27 offen offset:1024 sc1
buffer_load_dwordx4 a[8:11], v2, s[8:11], s27 offen offset:2048 sc1
buffer_load_dwordx4 a[12:15], v2, s[8:11], s27 offen offset:3072 sc1
s_add_u32 s27, s26, 4096
buffer_load_dwordx4 a[16:19], v2, s[8:11], s27 offen offset:0 sc1
buffer_load_dwordx4 a[20:23], v2, s[8:11], s27 offen offset:1024 sc1
buffer_load_dwordx4 a[24:27], v2, s[8:11], s27 offen offset:2048 sc1
buffer_load_dwordx4 a[28:31], v2, s[8:11], s27 offen offset:3072 sc1
s_add_u32 s27, s26, 16384
buffer_load_dwordx4 a[32:35], v2, s[8:11], s27 offen offset:0 sc1
buffer_load_dwordx4 a[36:39], v2, s[8:11], s27 offen offset:1024 sc1
buffer_load_dwordx4 a[40:43], v2, s[8:11], s27 offen offset:2048 sc1
buffer_load_dwordx4 a[44:47], v2, s[8:11], s27 offen offset:3072 sc1
s_add_u32 s27, s26, 20480
buffer_load_dwordx4 a[48:51], v2, s[8:11], s27 offen offset:0 sc1
buffer_load_dwordx4 a[52:55], v2, s[8:11], s27 offen offset:1024 sc1
buffer_load_dwordx4 a[56:59], v2, s[8:11], s27 offen offset:2048 sc1
buffer_load_dwordx4 a[60:63], v2, s[8:11], s27 offen offset:3072 sc1
s_mov_b32 m0, s47
s_add_u32 s24, s46, 4096
buffer_load_dwordx4 v1, s[8:11], s46 offen offset:0 sc1 lds
buffer_load_dwordx4 v1, s[8:11], s46 offen offset:1024 sc1 lds
buffer_load_dwordx4 v1, s[8:11], s46 offen offset:2048 sc1 lds
buffer_load_dwordx4 v1, s[8:11], s46 offen offset:3072 sc1 lds
s_add_u32 m0, s47, 4096
s_nop 0
buffer_load_dwordx4 v1, s[8:11], s24 offen offset:0 sc1 lds
buffer_load_dwordx4 v1, s[8:11], s24 offen offset:1024 sc1 lds
buffer_load_dwordx4 v1, s[8:11], s24 offen offset:2048 sc1 lds
buffer_load_dwordx4 v1, s[8:11], s24 offen offset:3072 sc1 lds
s_add_u32 s46, s46, 32768
s_add_u32 s47, s47, 32768
s_and_b32 s47, s47, 131071
s_mov_b32 m0, s47
s_add_u32 s24, s46, 4096
buffer_load_dwordx4 v1, s[8:11], s46 offen offset:0 sc1 lds
buffer_load_dwordx4 v1, s[8:11], s46 offen offset:1024 sc1 lds
buffer_load_dwordx4 v1, s[8:11], s46 offen offset:2048 sc1 lds
buffer_load_dwordx4 v1, s[8:11], s46 offen offset:3072 sc1 lds
s_add_u32 m0, s47, 4096
s_nop 0
buffer_load_dwordx4 v1, s[8:11], s24 offen offset:0 sc1 lds
buffer_load_dwordx4 v1, s[8:11], s24 offen offset:1024 sc1 lds
buffer_load_dwordx4 v1, s[8:11], s24 offen offset:2048 sc1 lds
buffer_load_dwordx4 v1, s[8:11], s24 offen offset:3072 sc1 lds
s_add_u32 s46, s46, 32768
s_add_u32 s47, s47, 32768
s_and_b32 s47, s47, 131071
s_mov_b32 m0, s47
s_add_u32 s24, s46, 4096
buffer_load_dwordx4 v1, s[8:11], s46 offen offset:0 sc1 lds
buffer_load_dwordx4 v1, s[8:11], s46 offen offset:1024 sc1 lds
buffer_load_dwordx4 v1, s[8:11], s46 offen offset:2048 sc1 lds
buffer_load_dwordx4 v1, s[8:11], s46 offen offset:3072 sc1 lds
s_add_u32 m0, s47, 4096
s_nop 0
buffer_load_dwordx4 v1, s[8:11], s24 offen offset:0 sc1 lds
buffer_load_dwordx4 v1, s[8:11], s24 offen offset:1024 sc1 lds
buffer_load_dwordx4 v1, s[8:11], s24 offen offset:2048 sc1 lds
buffer_load_dwordx4 v1, s[8:11], s24 offen offset:3072 sc1 lds
s_add_u32 s46, s46, 32768
s_add_u32 s47, s47, 32768
s_and_b32 s47, s47, 131071
v_accvgpr_write_b32 a96, 0
v_accvgpr_write_b32 a97, 0
v_accvgpr_write_b32 a98, 0
v_accvgpr_write_b32 a99, 0
v_accvgpr_write_b32 a100, 0
v_accvgpr_write_b32 a101, 0
v_accvgpr_write_b32 a102, 0
v_accvgpr_write_b32 a103, 0
v_accvgpr_write_b32 a104, 0
v_accvgpr_write_b32 a105, 0
v_accvgpr_write_b32 a106, 0
v_accvgpr_write_b32 a107, 0
v_accvgpr_write_b32 a108, 0
v_accvgpr_write_b32 a109, 0
v_accvgpr_write_b32 a110, 0
v_accvgpr_write_b32 a111, 0
v_accvgpr_write_b32 a112, 0
v_accvgpr_write_b32 a113, 0
v_accvgpr_write_b32 a114, 0
v_accvgpr_write_b32 a115, 0
v_accvgpr_write_b32 a116, 0
v_accvgpr_write_b32 a117, 0
v_accvgpr_write_b32 a118, 0
v_accvgpr_write_b32 a119, 0
v_accvgpr_write_b32 a120, 0
v_accvgpr_write_b32 a121, 0
v_accvgpr_write_b32 a122, 0
v_accvgpr_write_b32 a123, 0
v_accvgpr_write_b32 a124, 0
v_accvgpr_write_b32 a125, 0
v_accvgpr_write_b32 a126, 0
v_accvgpr_write_b32 a127, 0
v_accvgpr_write_b32 a128, 0
v_accvgpr_write_b32 a129, 0
v_accvgpr_write_b32 a130, 0
v_accvgpr_write_b32 a131, 0
v_accvgpr_write_b32 a132, 0
v_accvgpr_write_b32 a133, 0
v_accvgpr_write_b32 a134, 0
v_accvgpr_write_b32 a135, 0
v_accvgpr_write_b32 a136, 0
v_accvgpr_write_b32 a137, 0
v_accvgpr_write_b32 a138, 0
v_accvgpr_write_b32 a139, 0
v_accvgpr_write_b32 a140, 0
v_accvgpr_write_b32 a141, 0
v_accvgpr_write_b32 a142, 0
v_accvgpr_write_b32 a143, 0
v_accvgpr_write_b32 a144, 0
v_accvgpr_write_b32 a145, 0
v_accvgpr_write_b32 a146, 0
v_accvgpr_write_b32 a147, 0
v_accvgpr_write_b32 a148, 0
v_accvgpr_write_b32 a149, 0
v_accvgpr_write_b32 a150, 0
v_accvgpr_write_b32 a151, 0
v_accvgpr_write_b32 a152, 0
v_accvgpr_write_b32 a153, 0
v_accvgpr_write_b32 a154, 0
v_accvgpr_write_b32 a155, 0
v_accvgpr_write_b32 a156, 0
v_accvgpr_write_b32 a157, 0
v_accvgpr_write_b32 a158, 0
v_accvgpr_write_b32 a159, 0
v_accvgpr_write_b32 a160, 0
v_accvgpr_write_b32 a161, 0
v_accvgpr_write_b32 a162, 0
v_accvgpr_write_b32 a163, 0
v_accvgpr_write_b32 a164, 0
v_accvgpr_write_b32 a165, 0
v_accvgpr_write_b32 a166, 0
v_accvgpr_write_b32 a167, 0
v_accvgpr_write_b32 a168, 0
v_accvgpr_write_b32 a169, 0
v_accvgpr_write_b32 a170, 0
v_accvgpr_write_b32 a171, 0
v_accvgpr_write_b32 a172, 0
v_accvgpr_write_b32 a173, 0
v_accvgpr_write_b32 a174, 0
v_accvgpr_write_b32 a175, 0
v_accvgpr_write_b32 a176, 0
v_accvgpr_write_b32 a177, 0
v_accvgpr_write_b32 a178, 0
v_accvgpr_write_b32 a179, 0
v_accvgpr_write_b32 a180, 0
v_accvgpr_write_b32 a181, 0
v_accvgpr_write_b32 a182, 0
v_accvgpr_write_b32 a183, 0
v_accvgpr_write_b32 a184, 0
v_accvgpr_write_b32 a185, 0
v_accvgpr_write_b32 a186, 0
v_accvgpr_write_b32 a187, 0
v_accvgpr_write_b32 a188, 0
v_accvgpr_write_b32 a189, 0
v_accvgpr_write_b32 a190, 0
v_accvgpr_write_b32 a191, 0
v_accvgpr_write_b32 a192, 0
v_accvgpr_write_b32 a193, 0
v_accvgpr_write_b32 a194, 0
v_accvgpr_write_b32 a195, 0
v_accvgpr_write_b32 a196, 0
v_accvgpr_write_b32 a197, 0
v_accvgpr_write_b32 a198, 0
v_accvgpr_write_b32 a199, 0
v_accvgpr_write_b32 a200, 0
v_accvgpr_write_b32 a201, 0
v_accvgpr_write_b32 a202, 0
v_accvgpr_write_b32 a203, 0
v_accvgpr_write_b32 a204, 0
v_accvgpr_write_b32 a205, 0
v_accvgpr_write_b32 a206, 0
v_accvgpr_write_b32 a207, 0
v_accvgpr_write_b32 a208, 0
v_accvgpr_write_b32 a209, 0
v_accvgpr_write_b32 a210, 0
v_accvgpr_write_b32 a211, 0
v_accvgpr_write_b32 a212, 0
v_accvgpr_write_b32 a213, 0
v_accvgpr_write_b32 a214, 0
v_accvgpr_write_b32 a215, 0
v_accvgpr_write_b32 a216, 0
v_accvgpr_write_b32 a217, 0
v_accvgpr_write_b32 a218, 0
v_accvgpr_write_b32 a219, 0
v_accvgpr_write_b32 a220, 0
v_accvgpr_write_b32 a221, 0
v_accvgpr_write_b32 a222, 0
v_accvgpr_write_b32 a223, 0
v_mov_b64 v[112:113], 0
v_mov_b64 v[114:115], 0
v_mov_b64 v[116:117], 0
v_mov_b64 v[118:119], 0
v_mov_b64 v[120:121], 0
v_mov_b64 v[122:123], 0
v_mov_b64 v[124:125], 0
v_mov_b64 v[126:127], 0
v_mov_b64 v[128:129], 0
v_mov_b64 v[130:131], 0
v_mov_b64 v[132:133], 0
v_mov_b64 v[134:135], 0
v_mov_b64 v[136:137], 0
v_mov_b64 v[138:139], 0
v_mov_b64 v[140:141], 0
v_mov_b64 v[142:143], 0
v_mov_b64 v[144:145], 0
v_mov_b64 v[146:147], 0
v_mov_b64 v[148:149], 0
v_mov_b64 v[150:151], 0
v_mov_b64 v[152:153], 0
v_mov_b64 v[154:155], 0
v_mov_b64 v[156:157], 0
v_mov_b64 v[158:159], 0
v_mov_b64 v[22:23], 0
s_waitcnt vmcnt(16)
s_barrier
ds_read_b128 a[64:67], v2 offset:0
ds_read_b128 a[68:71], v2 offset:1024
ds_read_b128 a[72:75], v2 offset:2048
ds_read_b128 a[76:79], v2 offset:3072
s_waitcnt lgkmcnt(3)
v_mfma_f32_32x32x16_bf16 v[32:47], a[64:67], a[0:3], v[128:143]
ds_read_b128 a[80:83], v2 offset:4096
v_mfma_f32_32x32x16_bf16 v[48:63], a[64:67], a[32:35], v[144:159]
s_waitcnt lgkmcnt(3)
v_mfma_f32_32x32x16_bf16 v[32:47], a[68:71], a[4:7], v[32:47]
ds_read_b128 a[84:87], v2 offset:5120
v_mfma_f32_32x32x16_bf16 v[48:63], a[68:71], a[36:39], v[48:63]
s_waitcnt lgkmcnt(3)
v_mfma_f32_32x32x16_bf16 v[32:47], a[72:75], a[8:11], v[32:47]
ds_read_b128 a[88:91], v2 offset:6144
v_mfma_f32_32x32x16_bf16 v[48:63], a[72:75], a[40:43], v[48:63]
s_waitcnt lgkmcnt(3)
v_mfma_f32_32x32x16_bf16 v[32:47], a[76:79], a[12:15], v[32:47]
ds_read_b128 a[92:95], v2 offset:7168
v_mfma_f32_32x32x16_bf16 v[48:63], a[76:79], a[44:47], v[48:63]
s_waitcnt lgkmcnt(3)
v_mfma_f32_32x32x16_bf16 v[32:47], a[80:83], a[16:19], v[32:47]
ds_read_b128 a[64:67], v4 offset:24576
v_mfma_f32_32x32x16_bf16 v[48:63], a[80:83], a[48:51], v[48:63]
s_waitcnt lgkmcnt(3)
v_mfma_f32_32x32x16_bf16 v[32:47], a[84:87], a[20:23], v[32:47]
ds_read_b128 a[68:71], v4 offset:25600
v_mfma_f32_32x32x16_bf16 v[48:63], a[84:87], a[52:55], v[48:63]
s_waitcnt lgkmcnt(3)
v_mfma_f32_32x32x16_bf16 v[32:47], a[88:91], a[24:27], v[32:47]
ds_read_b128 a[72:75], v4 offset:26624
v_mfma_f32_32x32x16_bf16 v[48:63], a[88:91], a[56:59], v[48:63]
s_waitcnt lgkmcnt(3)
v_mfma_f32_32x32x16_bf16 v[32:47], a[92:95], a[28:31], v[32:47]
ds_read_b128 a[76:79], v4 offset:27648
v_mfma_f32_32x32x16_bf16 v[48:63], a[92:95], a[60:63], v[48:63]
s_waitcnt lgkmcnt(3)
s_cmp_eq_u32 s44, 0
s_cbranch_scc1 L_at_last
.p2align 3
L_at_loop:
v_mfma_f32_32x32x16_bf16 a[96:111], a[64:67], v[112:115], a[96:111]
ds_read_b128 a[80:83], v4 offset:28672
v_mfma_f32_32x32x16_bf16 a[112:127], a[64:67], v[120:123], a[112:127]
s_waitcnt lgkmcnt(3)
s_add_u32 s24, s43, 3
v_mfma_f32_32x32x16_bf16 a[96:111], a[68:71], v[116:119], a[96:111]
ds_read_b128 a[84:87], v4 offset:29696
v_max3_f32 v26, v32, v33, v34
v_max3_f32 v26, v26, v35, v36
v_max3_f32 v26, v26, v37, v38
v_max3_f32 v26, v26, v39, v40
v_mfma_f32_32x32x16_bf16 a[112:127], a[68:71], v[124:127], a[112:127]
s_waitcnt lgkmcnt(3)
s_cmp_lt_u32 s24, s45
s_cselect_b32 s46, s46, 536870912
v_max3_f32 v26, v26, v41, v42
v_max3_f32 v26, v26, v43, v44
v_max3_f32 v26, v26, v45, v46
v_max3_f32 v26, v26, v47, v48
v_max3_f32 v26, v26, v49, v50
v_mfma_f32_32x32x16_bf16 a[128:143], a[72:75], v[112:115], a[128:143]
ds_read_b128 a[88:91], v4 offset:30720
v_max3_f32 v26, v26, v51, v52
v_max3_f32 v26, v26, v53, v54
v_max3_f32 v26, v26, v55, v56
v_max3_f32 v26, v26, v57, v58
v_mfma_f32_32x32x16_bf16 a[144:159], a[72:75], v[120:123], a[144:159]
s_waitcnt lgkmcnt(3)
v_max3_f32 v26, v26, v59, v60
v_max3_f32 v26, v26, v61, v62
v_max_f32 v26, v26, v63
v_cmp_lt_f32 vcc, s54, v26
v_mfma_f32_32x32x16_bf16 a[128:143], a[76:79], v[116:119], a[128:143]
ds_read_b128 a[92:95], v4 offset:31744
s_cbranch_vccnz L_at_upa
L_at_upra:
v_exp_f32 v32, v32
v_exp_f32 v33, v33
v_mfma_f32_32x32x16_bf16 a[144:159], a[76:79], v[124:127], a[144:159]
s_waitcnt lgkmcnt(3)
v_exp_f32 v34, v34
v_add_f32 v22, v22, v32
v_add_f32 v22, v22, v33
v_mfma_f32_32x32x16_bf16 a[160:175], a[80:83], v[112:115], a[160:175]
ds_read_b128 a[64:67], v2 offset:16384
v_exp_f32 v35, v35
v_cvt_pk_bf16_f32 v96, v32, v33
v_exp_f32 v36, v36
v_mfma_f32_32x32x16_bf16 a[176:191], a[80:83], v[120:123], a[176:191]
s_waitcnt lgkmcnt(3)
v_add_f32 v22, v22, v34
v_add_f32 v22, v22, v35
v_exp_f32 v37, v37
v_mfma_f32_32x32x16_bf16 a[160:175], a[84:87], v[116:119], a[160:175]
ds_read_b128 a[68:71], v2 offset:17408
v_cvt_pk_bf16_f32 v97, v34, v35
v_exp_f32 v38, v38
v_add_f32 v22, v22, v36
v_add_f32 v22, v22, v37
v_mfma_f32_32x32x16_bf16 a[176:191], a[84:87], v[124:127], a[176:191]
s_waitcnt lgkmcnt(3)
v_exp_f32 v39, v39
v_cvt_pk_bf16_f32 v98, v36, v37
v_mfma_f32_32x32x16_bf16 a[192:207], a[88:91], v[112:115], a[192:207]
ds_read_b128 a[72:75], v2 offset:18432
v_exp_f32 v40, v40
v_add_f32 v22, v22, v38
v_add_f32 v22, v22, v39
v_exp_f32 v41, v41
v_mfma_f32_32x32x16_bf16 a[208:223], a[88:91], v[120:123], a[208:223]
s_waitcnt lgkmcnt(3)
v_cvt_pk_bf16_f32 v99, v38, v39
v_exp_f32 v42, v42
v_mfma_f32_32x32x16_bf16 a[192:207], a[92:95], v[116:119], a[192:207]
ds_read_b128 a[76:79], v2 offset:19456
v_add_f32 v22, v22, v40
v_add_f32 v22, v22, v41
v_exp_f32 v43, v43
v_cvt_pk_bf16_f32 v100, v40, v41
v_mfma_f32_32x32x16_bf16 a[208:223], a[92:95], v[124:127], a[208:223]
s_waitcnt lgkmcnt(3)
s_cmp_eq_u32 s48, 0
s_cbranch_scc0 L_at_rsa
L_at_rsra:
v_exp_f32 v44, v44
v_add_f32 v22, v22, v42
v_add_f32 v22, v22, v43
v_mfma_f32_32x32x16_bf16 v[64:79], a[64:67], a[0:3], v[128:143]
ds_read_b128 a[80:83], v2 offset:20480
v_exp_f32 v45, v45
v_cvt_pk_bf16_f32 v101, v42, v43
v_exp_f32 v46, v46
v_mfma_f32_32x32x16_bf16 v[80:95], a[64:67], a[32:35], v[144:159]
s_waitcnt lgkmcnt(3)
v_add_f32 v22, v22, v44
v_add_f32 v22, v22, v45
v_exp_f32 v47, v47
v_mfma_f32_32x32x16_bf16 v[64:79], a[68:71], a[4:7], v[64:79]
ds_read_b128 a[84:87], v2 offset:21504
v_cvt_pk_bf16_f32 v102, v44, v45
v_exp_f32 v48, v48
v_add_f32 v22, v22, v46
v_mfma_f32_32x32x16_bf16 v[80:95], a[68:71], a[36:39], v[80:95]
s_waitcnt lgkmcnt(3)
v_add_f32 v22, v22, v47
v_exp_f32 v49, v49
v_cvt_pk_bf16_f32 v103, v46, v47
v_mfma_f32_32x32x16_bf16 v[64:79], a[72:75], a[8:11], v[64:79]
ds_read_b128 a[88:91], v2 offset:22528
v_exp_f32 v50, v50
v_add_f32 v23, v23, v48
v_add_f32 v23, v23, v49
v_mfma_f32_32x32x16_bf16 v[80:95], a[72:75], a[40:43], v[80:95]
s_waitcnt lgkmcnt(3)
v_exp_f32 v51, v51
v_cvt_pk_bf16_f32 v104, v48, v49
v_exp_f32 v52, v52
v_mfma_f32_32x32x16_bf16 v[64:79], a[76:79], a[12:15], v[64:79]
ds_read_b128 a[92:95], v2 offset:23552
v_add_f32 v23, v23, v50
v_add_f32 v23, v23, v51
v_exp_f32 v53, v53
v_mfma_f32_32x32x16_bf16 v[80:95], a[76:79], a[44:47], v[80:95]
s_waitcnt lgkmcnt(3)
v_cvt_pk_bf16_f32 v105, v50, v51
v_exp_f32 v54, v54
v_add_f32 v23, v23, v52
v_add_f32 v23, v23, v53
v_mfma_f32_32x32x16_bf16 v[64:79], a[80:83], a[16:19], v[64:79]
ds_read_b128 a[64:67], v2 offset:8192
v_exp_f32 v55, v55
v_cvt_pk_bf16_f32 v106, v52, v53
v_mfma_f32_32x32x16_bf16 v[80:95], a[80:83], a[48:51], v[80:95]
s_waitcnt lgkmcnt(3)
v_exp_f32 v56, v56
v_add_f32 v23, v23, v54
v_add_f32 v23, v23, v55
v_exp_f32 v57, v57
v_mfma_f32_32x32x16_bf16 v[64:79], a[84:87], a[20:23], v[64:79]
ds_read_b128 a[68:71], v2 offset:9216
v_cvt_pk_bf16_f32 v107, v54, v55
v_exp_f32 v58, v58
v_mfma_f32_32x32x16_bf16 v[80:95], a[84:87], a[52:55], v[80:95]
s_waitcnt lgkmcnt(3)
v_add_f32 v23, v23, v56
v_add_f32 v23, v23, v57
v_exp_f32 v59, v59
v_cvt_pk_bf16_f32 v108, v56, v57
v_mfma_f32_32x32x16_bf16 v[64:79], a[88:91], a[24:27], v[64:79]
ds_read_b128 a[72:75], v2 offset:10240
v_exp_f32 v60, v60
v_add_f32 v23, v23, v58
v_add_f32 v23, v23, v59
v_mfma_f32_32x32x16_bf16 v[80:95], a[88:91], a[56:59], v[80:95]
s_waitcnt lgkmcnt(3)
v_exp_f32 v61, v61
v_cvt_pk_bf16_f32 v109, v58, v59
v_exp_f32 v62, v62
v_mfma_f32_32x32x16_bf16 v[64:79], a[92:95], a[28:31], v[64:79]
ds_read_b128 a[76:79], v2 offset:11264
v_add_f32 v23, v23, v60
v_add_f32 v23, v23, v61
v_exp_f32 v63, v63
v_mfma_f32_32x32x16_bf16 v[80:95], a[92:95], a[60:63], v[80:95]
s_waitcnt lgkmcnt(3)
v_cvt_pk_bf16_f32 v110, v60, v61
v_add_f32 v23, v23, v62
v_add_f32 v23, v23, v63
v_cvt_pk_bf16_f32 v111, v62, v63
s_waitcnt vmcnt(8)
s_barrier
v_mfma_f32_32x32x16_bf16 a[96:111], a[64:67], v[96:99], a[96:111]
ds_read_b128 a[80:83], v2 offset:12288
v_mfma_f32_32x32x16_bf16 a[112:127], a[64:67], v[104:107], a[112:127]
s_waitcnt lgkmcnt(3)
s_mov_b32 m0, s47
v_mfma_f32_32x32x16_bf16 a[96:111], a[68:71], v[100:103], a[96:111]
ds_read_b128 a[84:87], v2 offset:13312
v_max3_f32 v26, v64, v65, v66
v_max3_f32 v26, v26, v67, v68
v_max3_f32 v26, v26, v69, v70
v_max3_f32 v26, v26, v71, v72
v_mfma_f32_32x32x16_bf16 a[112:127], a[68:71], v[108:111], a[112:127]
s_waitcnt lgkmcnt(3)
s_add_u32 s24, s46, 4096
v_max3_f32 v26, v26, v73, v74
v_max3_f32 v26, v26, v75, v76
v_max3_f32 v26, v26, v77, v78
v_max3_f32 v26, v26, v79, v80
v_max3_f32 v26, v26, v81, v82
v_mfma_f32_32x32x16_bf16 a[128:143], a[72:75], v[96:99], a[128:143]
ds_read_b128 a[88:91], v2 offset:14336
v_max3_f32 v26, v26, v83, v84
v_max3_f32 v26, v26, v85, v86
v_max3_f32 v26, v26, v87, v88
v_max3_f32 v26, v26, v89, v90
v_mfma_f32_32x32x16_bf16 a[144:159], a[72:75], v[104:107], a[144:159]
s_waitcnt lgkmcnt(3)
buffer_load_dwordx4 v1, s[8:11], s46 offen offset:0 sc1 lds
v_max3_f32 v26, v26, v91, v92
v_max3_f32 v26, v26, v93, v94
v_max_f32 v26, v26, v95
v_cmp_lt_f32 vcc, s54, v26
v_mfma_f32_32x32x16_bf16 a[128:143], a[76:79], v[100:103], a[128:143]
ds_read_b128 a[92:95], v2 offset:15360
s_cbranch_vccnz L_at_upb
L_at_uprb:
v_exp_f32 v64, v64
v_exp_f32 v65, v65
v_mfma_f32_32x32x16_bf16 a[144:159], a[76:79], v[108:111], a[144:159]
s_waitcnt lgkmcnt(3)
buffer_load_dwordx4 v1, s[8:11], s46 offen offset:1024 sc1 lds
v_exp_f32 v66, v66
v_add_f32 v22, v22, v64
v_add_f32 v22, v22, v65
v_mfma_f32_32x32x16_bf16 a[160:175], a[80:83], v[96:99], a[160:175]
ds_read_b128 a[64:67], v3 offset:0
v_exp_f32 v67, v67
v_cvt_pk_bf16_f32 v112, v64, v65
v_exp_f32 v68, v68
v_mfma_f32_32x32x16_bf16 a[176:191], a[80:83], v[104:107], a[176:191]
s_waitcnt lgkmcnt(3)
buffer_load_dwordx4 v1, s[8:11], s46 offen offset:2048 sc1 lds
v_add_f32 v22, v22, v66
v_add_f32 v22, v22, v67
v_exp_f32 v69, v69
v_cvt_pk_bf16_f32 v113, v66, v67
v_mfma_f32_32x32x16_bf16 a[160:175], a[84:87], v[100:103], a[160:175]
ds_read_b128 a[68:71], v3 offset:1024
v_exp_f32 v70, v70
v_add_f32 v22, v22, v68
v_add_f32 v22, v22, v69
v_mfma_f32_32x32x16_bf16 a[176:191], a[84:87], v[108:111], a[176:191]
s_waitcnt lgkmcnt(3)
buffer_load_dwordx4 v1, s[8:11], s46 offen offset:3072 sc1 lds
v_exp_f32 v71, v71
v_cvt_pk_bf16_f32 v114, v68, v69
v_exp_f32 v72, v72
v_mfma_f32_32x32x16_bf16 a[192:207], a[88:91], v[96:99], a[192:207]
ds_read_b128 a[72:75], v3 offset:2048
v_add_f32 v22, v22, v70
v_add_f32 v22, v22, v71
v_exp_f32 v73, v73
v_mfma_f32_32x32x16_bf16 a[208:223], a[88:91], v[104:107], a[208:223]
s_waitcnt lgkmcnt(3)
s_add_u32 m0, s47, 4096
v_cvt_pk_bf16_f32 v115, v70, v71
v_exp_f32 v74, v74
v_add_f32 v22, v22, v72
v_add_f32 v22, v22, v73
v_mfma_f32_32x32x16_bf16 a[192:207], a[92:95], v[100:103], a[192:207]
ds_read_b128 a[76:79], v3 offset:3072
v_exp_f32 v75, v75
v_cvt_pk_bf16_f32 v116, v72, v73
v_exp_f32 v76, v76
v_mfma_f32_32x32x16_bf16 a[208:223], a[92:95], v[108:111], a[208:223]
s_waitcnt lgkmcnt(3)
buffer_load_dwordx4 v1, s[8:11], s24 offen offset:0 sc1 lds
s_cmp_eq_u32 s48, 0
s_cbranch_scc0 L_at_rsb
L_at_rsrb:
v_add_f32 v22, v22, v74
v_add_f32 v22, v22, v75
v_exp_f32 v77, v77
v_mfma_f32_32x32x16_bf16 v[32:47], a[64:67], a[0:3], v[128:143]
ds_read_b128 a[80:83], v3 offset:4096
v_cvt_pk_bf16_f32 v117, v74, v75
v_exp_f32 v78, v78
v_add_f32 v22, v22, v76
v_mfma_f32_32x32x16_bf16 v[48:63], a[64:67], a[32:35], v[144:159]
s_waitcnt lgkmcnt(3)
buffer_load_dwordx4 v1, s[8:11], s24 offen offset:1024 sc1 lds
v_add_f32 v22, v22, v77
v_exp_f32 v79, v79
v_cvt_pk_bf16_f32 v118, v76, v77
v_mfma_f32_32x32x16_bf16 v[32:47], a[68:71], a[4:7], v[32:47]
ds_read_b128 a[84:87], v3 offset:5120
v_exp_f32 v80, v80
v_add_f32 v22, v22, v78
v_add_f32 v22, v22, v79
v_exp_f32 v81, v81
v_mfma_f32_32x32x16_bf16 v[48:63], a[68:71], a[36:39], v[48:63]
s_waitcnt lgkmcnt(3)
buffer_load_dwordx4 v1, s[8:11], s24 offen offset:2048 sc1 lds
v_cvt_pk_bf16_f32 v119, v78, v79
v_exp_f32 v82, v82
v_mfma_f32_32x32x16_bf16 v[32:47], a[72:75], a[8:11], v[32:47]
ds_read_b128 a[88:91], v3 offset:6144
v_add_f32 v23, v23, v80
v_add_f32 v23, v23, v81
v_exp_f32 v83, v83
v_cvt_pk_bf16_f32 v120, v80, v81
v_mfma_f32_32x32x16_bf16 v[48:63], a[72:75], a[40:43], v[48:63]
s_waitcnt lgkmcnt(3)
buffer_load_dwordx4 v1, s[8:11], s24 offen offset:3072 sc1 lds
v_exp_f32 v84, v84
v_add_f32 v23, v23, v82
v_add_f32 v23, v23, v83
v_mfma_f32_32x32x16_bf16 v[32:47], a[76:79], a[12:15], v[32:47]
ds_read_b128 a[92:95], v3 offset:7168
v_exp_f32 v85, v85
v_cvt_pk_bf16_f32 v121, v82, v83
v_exp_f32 v86, v86
v_mfma_f32_32x32x16_bf16 v[48:63], a[76:79], a[44:47], v[48:63]
s_waitcnt lgkmcnt(3)
s_add_u32 s46, s46, 32768
v_add_f32 v23, v23, v84
v_add_f32 v23, v23, v85
v_exp_f32 v87, v87
v_mfma_f32_32x32x16_bf16 v[32:47], a[80:83], a[16:19], v[32:47]
ds_read_b128 a[64:67], v2 offset:24576
v_cvt_pk_bf16_f32 v122, v84, v85
v_exp_f32 v88, v88
v_add_f32 v23, v23, v86
v_add_f32 v23, v23, v87
v_mfma_f32_32x32x16_bf16 v[48:63], a[80:83], a[48:51], v[48:63]
s_waitcnt lgkmcnt(3)
s_add_u32 s47, s47, 32768
v_exp_f32 v89, v89
v_cvt_pk_bf16_f32 v123, v86, v87
v_exp_f32 v90, v90
v_mfma_f32_32x32x16_bf16 v[32:47], a[84:87], a[20:23], v[32:47]
ds_read_b128 a[68:71], v2 offset:25600
v_add_f32 v23, v23, v88
v_add_f32 v23, v23, v89
v_exp_f32 v91, v91
v_mfma_f32_32x32x16_bf16 v[48:63], a[84:87], a[52:55], v[48:63]
s_waitcnt lgkmcnt(3)
s_and_b32 s47, s47, 131071
v_cvt_pk_bf16_f32 v124, v88, v89
v_exp_f32 v92, v92
v_add_f32 v23, v23, v90
v_mfma_f32_32x32x16_bf16 v[32:47], a[88:91], a[24:27], v[32:47]
ds_read_b128 a[72:75], v2 offset:26624
v_add_f32 v23, v23, v91
v_exp_f32 v93, v93
v_cvt_pk_bf16_f32 v125, v90, v91
v_mfma_f32_32x32x16_bf16 v[48:63], a[88:91], a[56:59], v[48:63]
s_waitcnt lgkmcnt(3)
s_add_u32 s43, s43, 1
v_exp_f32 v94, v94
v_add_f32 v23, v23, v92
v_add_f32 v23, v23, v93
v_exp_f32 v95, v95
v_mfma_f32_32x32x16_bf16 v[32:47], a[92:95], a[28:31], v[32:47]
ds_read_b128 a[76:79], v2 offset:27648
v_cvt_pk_bf16_f32 v126, v92, v93
v_add_f32 v23, v23, v94
v_add_f32 v23, v23, v95
v_cvt_pk_bf16_f32 v127, v94, v95
v_mfma_f32_32x32x16_bf16 v[48:63], a[92:95], a[60:63], v[48:63]
s_waitcnt lgkmcnt(3)
s_cmp_lt_u32 s43, s44
v_mov_b32 v4, v2
v_mov_b32 v2, v3
v_add_u32 v3, 32768, v3
v_and_b32 v3, 131071, v3
s_cbranch_scc1 L_at_loop
L_at_last:
v_mfma_f32_32x32x16_bf16 a[96:111], a[64:67], v[112:115], a[96:111]
ds_read_b128 a[80:83], v4 offset:28672
v_mfma_f32_32x32x16_bf16 a[112:127], a[64:67], v[120:123], a[112:127]
s_waitcnt lgkmcnt(3)
s_add_u32 s24, s43, 3
v_mfma_f32_32x32x16_bf16 a[96:111], a[68:71], v[116:119], a[96:111]
ds_read_b128 a[84:87], v4 offset:29696
v_mov_b32 v31, s50
v_cmp_le_i32 vcc, 0, v5
s_nop 1
v_cndmask_b32 v32, v31, v32, vcc
v_cmp_le_i32 vcc, 1, v5
v_mfma_f32_32x32x16_bf16 a[112:127], a[68:71], v[124:127], a[112:127]
s_waitcnt lgkmcnt(3)
s_cmp_lt_u32 s24, s45
s_cselect_b32 s46, s46, 536870912
v_cndmask_b32 v33, v31, v33, vcc
v_cmp_le_i32 vcc, 2, v5
s_nop 1
v_cndmask_b32 v34, v31, v34, vcc
v_cmp_le_i32 vcc, 3, v5
v_mfma_f32_32x32x16_bf16 a[128:143], a[72:75], v[112:115], a[128:143]
ds_read_b128 a[88:91], v4 offset:30720
v_cndmask_b32 v35, v31, v35, vcc
v_cmp_le_i32 vcc, 8, v5
s_nop 1
v_cndmask_b32 v36, v31, v36, vcc
v_cmp_le_i32 vcc, 9, v5
s_nop 1
v_cndmask_b32 v37, v31, v37, vcc
v_mfma_f32_32x32x16_bf16 a[144:159], a[72:75], v[120:123], a[144:159]
s_waitcnt lgkmcnt(3)
v_cmp_le_i32 vcc, 10, v5
s_nop 1
v_cndmask_b32 v38, v31, v38, vcc
v_cmp_le_i32 vcc, 11, v5
s_nop 1
v_cndmask_b32 v39, v31, v39, vcc
v_mfma_f32_32x32x16_bf16 a[128:143], a[76:79], v[116:119], a[128:143]
ds_read_b128 a[92:95], v4 offset:31744
v_cmp_le_i32 vcc, 16, v5
s_nop 1
v_cndmask_b32 v40, v31, v40, vcc
v_cmp_le_i32 vcc, 17, v5
s_nop 1
v_cndmask_b32 v41, v31, v41, vcc
v_mfma_f32_32x32x16_bf16 a[144:159], a[76:79], v[124:127], a[144:159]
s_waitcnt lgkmcnt(3)
v_cmp_le_i32 vcc, 18, v5
s_nop 1
v_cndmask_b32 v42, v31, v42, vcc
v_cmp_le_i32 vcc, 19, v5
s_nop 1
v_cndmask_b32 v43, v31, v43, vcc
v_mfma_f32_32x32x16_bf16 a[160:175], a[80:83], v[112:115], a[160:175]
ds_read_b128 a[64:67], v2 offset:16384
v_cmp_le_i32 vcc, 24, v5
s_nop 1
v_cndmask_b32 v44, v31, v44, vcc
v_cmp_le_i32 vcc, 25, v5
s_nop 1
v_cndmask_b32 v45, v31, v45, vcc
v_mfma_f32_32x32x16_bf16 a[176:191], a[80:83], v[120:123], a[176:191]
s_waitcnt lgkmcnt(3)
v_cmp_le_i32 vcc, 26, v5
s_nop 1
v_cndmask_b32 v46, v31, v46, vcc
v_cmp_le_i32 vcc, 27, v5
s_nop 1
v_cndmask_b32 v47, v31, v47, vcc
v_mfma_f32_32x32x16_bf16 a[160:175], a[84:87], v[116:119], a[160:175]
ds_read_b128 a[68:71], v2 offset:17408
v_max3_f32 v26, v32, v33, v34
v_max3_f32 v26, v26, v35, v36
v_max3_f32 v26, v26, v37, v38
v_max3_f32 v26, v26, v39, v40
v_max3_f32 v26, v26, v41, v42
v_mfma_f32_32x32x16_bf16 a[176:191], a[84:87], v[124:127], a[176:191]
s_waitcnt lgkmcnt(3)
v_max3_f32 v26, v26, v43, v44
v_max3_f32 v26, v26, v45, v46
v_max3_f32 v26, v26, v47, v48
v_max3_f32 v26, v26, v49, v50
v_mfma_f32_32x32x16_bf16 a[192:207], a[88:91], v[112:115], a[192:207]
ds_read_b128 a[72:75], v2 offset:18432
v_max3_f32 v26, v26, v51, v52
v_max3_f32 v26, v26, v53, v54
v_max3_f32 v26, v26, v55, v56
v_max3_f32 v26, v26, v57, v58
v_mfma_f32_32x32x16_bf16 a[208:223], a[88:91], v[120:123], a[208:223]
s_waitcnt lgkmcnt(3)
v_max3_f32 v26, v26, v59, v60
v_max3_f32 v26, v26, v61, v62
v_max_f32 v26, v26, v63
v_cmp_lt_f32 vcc, s54, v26
v_mfma_f32_32x32x16_bf16 a[192:207], a[92:95], v[116:119], a[192:207]
ds_read_b128 a[76:79], v2 offset:19456
s_cbranch_vccnz L_at_upc
L_at_uprc:
v_exp_f32 v32, v32
v_exp_f32 v33, v33
v_exp_f32 v34, v34
v_mfma_f32_32x32x16_bf16 a[208:223], a[92:95], v[124:127], a[208:223]
s_waitcnt lgkmcnt(3)
s_cmp_eq_u32 s48, 0
s_cbranch_scc0 L_at_rsc
L_at_rsrc:
v_add_f32 v22, v22, v32
v_add_f32 v22, v22, v33
v_exp_f32 v35, v35
v_cvt_pk_bf16_f32 v96, v32, v33
v_exp_f32 v36, v36
v_mfma_f32_32x32x16_bf16 v[64:79], a[64:67], a[0:3], v[128:143]
ds_read_b128 a[80:83], v2 offset:20480
v_add_f32 v22, v22, v34
v_add_f32 v22, v22, v35
v_exp_f32 v37, v37
v_cvt_pk_bf16_f32 v97, v34, v35
v_mfma_f32_32x32x16_bf16 v[80:95], a[64:67], a[32:35], v[144:159]
s_waitcnt lgkmcnt(3)
v_exp_f32 v38, v38
v_add_f32 v22, v22, v36
v_add_f32 v22, v22, v37
v_exp_f32 v39, v39
v_cvt_pk_bf16_f32 v98, v36, v37
v_mfma_f32_32x32x16_bf16 v[64:79], a[68:71], a[4:7], v[64:79]
ds_read_b128 a[84:87], v2 offset:21504
v_exp_f32 v40, v40
v_add_f32 v22, v22, v38
v_add_f32 v22, v22, v39
v_exp_f32 v41, v41
v_mfma_f32_32x32x16_bf16 v[80:95], a[68:71], a[36:39], v[80:95]
s_waitcnt lgkmcnt(3)
v_cvt_pk_bf16_f32 v99, v38, v39
v_exp_f32 v42, v42
v_add_f32 v22, v22, v40
v_add_f32 v22, v22, v41
v_exp_f32 v43, v43
v_mfma_f32_32x32x16_bf16 v[64:79], a[72:75], a[8:11], v[64:79]
ds_read_b128 a[88:91], v2 offset:22528
v_cvt_pk_bf16_f32 v100, v40, v41
v_exp_f32 v44, v44
v_add_f32 v22, v22, v42
v_add_f32 v22, v22, v43
v_mfma_f32_32x32x16_bf16 v[80:95], a[72:75], a[40:43], v[80:95]
s_waitcnt lgkmcnt(3)
v_exp_f32 v45, v45
v_cvt_pk_bf16_f32 v101, v42, v43
v_exp_f32 v46, v46
v_add_f32 v22, v22, v44
v_add_f32 v22, v22, v45
v_mfma_f32_32x32x16_bf16 v[64:79], a[76:79], a[12:15], v[64:79]
ds_read_b128 a[92:95], v2 offset:23552
v_exp_f32 v47, v47
v_cvt_pk_bf16_f32 v102, v44, v45
v_exp_f32 v48, v48
v_add_f32 v22, v22, v46
v_mfma_f32_32x32x16_bf16 v[80:95], a[76:79], a[44:47], v[80:95]
s_waitcnt lgkmcnt(3)
v_add_f32 v22, v22, v47
v_exp_f32 v49, v49
v_cvt_pk_bf16_f32 v103, v46, v47
v_exp_f32 v50, v50
v_mfma_f32_32x32x16_bf16 v[64:79], a[80:83], a[16:19], v[64:79]
ds_read_b128 a[64:67], v2 offset:8192
v_add_f32 v23, v23, v48
v_add_f32 v23, v23, v49
v_exp_f32 v51, v51
v_cvt_pk_bf16_f32 v104, v48, v49
v_exp_f32 v52, v52
v_mfma_f32_32x32x16_bf16 v[80:95], a[80:83], a[48:51], v[80:95]
s_waitcnt lgkmcnt(3)
v_add_f32 v23, v23, v50
v_add_f32 v23, v23, v51
v_exp_f32 v53, v53
v_cvt_pk_bf16_f32 v105, v50, v51
v_mfma_f32_32x32x16_bf16 v[64:79], a[84:87], a[20:23], v[64:79]
ds_read_b128 a[68:71], v2 offset:9216
v_exp_f32 v54, v54
v_add_f32 v23, v23, v52
v_add_f32 v23, v23, v53
v_exp_f32 v55, v55
v_cvt_pk_bf16_f32 v106, v52, v53
v_mfma_f32_32x32x16_bf16 v[80:95], a[84:87], a[52:55], v[80:95]
s_waitcnt lgkmcnt(3)
v_exp_f32 v56, v56
v_add_f32 v23, v23, v54
v_add_f32 v23, v23, v55
v_exp_f32 v57, v57
v_mfma_f32_32x32x16_bf16 v[64:79], a[88:91], a[24:27], v[64:79]
ds_read_b128 a[72:75], v2 offset:10240
v_cvt_pk_bf16_f32 v107, v54, v55
v_exp_f32 v58, v58
v_add_f32 v23, v23, v56
v_add_f32 v23, v23, v57
v_exp_f32 v59, v59
v_mfma_f32_32x32x16_bf16 v[80:95], a[88:91], a[56:59], v[80:95]
s_waitcnt lgkmcnt(3)
v_cvt_pk_bf16_f32 v108, v56, v57
v_exp_f32 v60, v60
v_add_f32 v23, v23, v58
v_add_f32 v23, v23, v59
v_mfma_f32_32x32x16_bf16 v[64:79], a[92:95], a[28:31], v[64:79]
ds_read_b128 a[76:79], v2 offset:11264
v_exp_f32 v61, v61
v_cvt_pk_bf16_f32 v109, v58, v59
v_exp_f32 v62, v62
v_add_f32 v23, v23, v60
v_add_f32 v23, v23, v61
v_mfma_f32_32x32x16_bf16 v[80:95], a[92:95], a[60:63], v[80:95]
s_waitcnt lgkmcnt(3)
v_exp_f32 v63, v63
v_cvt_pk_bf16_f32 v110, v60, v61
v_add_f32 v23, v23, v62
v_add_f32 v23, v23, v63
v_cvt_pk_bf16_f32 v111, v62, v63
s_waitcnt vmcnt(8)
s_barrier
v_mfma_f32_32x32x16_bf16 a[96:111], a[64:67], v[96:99], a[96:111]
ds_read_b128 a[80:83], v2 offset:12288
s_mov_b32 m0, s47
v_mfma_f32_32x32x16_bf16 a[112:127], a[64:67], v[104:107], a[112:127]
s_waitcnt lgkmcnt(3)
s_add_u32 s24, s46, 4096
v_mfma_f32_32x32x16_bf16 a[96:111], a[68:71], v[100:103], a[96:111]
ds_read_b128 a[84:87], v2 offset:13312
buffer_load_dwordx4 v1, s[8:11], s46 offen offset:0 sc1 lds
v_mov_b32 v31, s50
v_cmp_le_i32 vcc, 0, v5
s_nop 1
v_cndmask_b32 v80, v31, v80, vcc
v_cmp_le_i32 vcc, 1, v5
s_nop 1
v_cndmask_b32 v81, v31, v81, vcc
v_cmp_le_i32 vcc, 2, v5
v_mfma_f32_32x32x16_bf16 a[112:127], a[68:71], v[108:111], a[112:127]
s_waitcnt lgkmcnt(3)
buffer_load_dwordx4 v1, s[8:11], s46 offen offset:1024 sc1 lds
v_cndmask_b32 v82, v31, v82, vcc
v_cmp_le_i32 vcc, 3, v5
s_nop 1
v_cndmask_b32 v83, v31, v83, vcc
v_cmp_le_i32 vcc, 8, v5
s_nop 1
v_cndmask_b32 v84, v31, v84, vcc
v_mfma_f32_32x32x16_bf16 a[128:143], a[72:75], v[96:99], a[128:143]
ds_read_b128 a[88:91], v2 offset:14336
buffer_load_dwordx4 v1, s[8:11], s46 offen offset:2048 sc1 lds
v_cmp_le_i32 vcc, 9, v5
s_nop 1
v_cndmask_b32 v85, v31, v85, vcc
v_cmp_le_i32 vcc, 10, v5
s_nop 1
v_cndmask_b32 v86, v31, v86, vcc
v_cmp_le_i32 vcc, 11, v5
s_nop 1
v_cndmask_b32 v87, v31, v87, vcc
v_mfma_f32_32x32x16_bf16 a[144:159], a[72:75], v[104:107], a[144:159]
s_waitcnt lgkmcnt(3)
buffer_load_dwordx4 v1, s[8:11], s46 offen offset:3072 sc1 lds
v_cmp_le_i32 vcc, 16, v5
s_nop 1
v_cndmask_b32 v88, v31, v88, vcc
v_cmp_le_i32 vcc, 17, v5
s_nop 1
v_cndmask_b32 v89, v31, v89, vcc
v_cmp_le_i32 vcc, 18, v5
v_mfma_f32_32x32x16_bf16 a[128:143], a[76:79], v[100:103], a[128:143]
ds_read_b128 a[92:95], v2 offset:15360
s_add_u32 m0, s47, 4096
v_cndmask_b32 v90, v31, v90, vcc
v_cmp_le_i32 vcc, 19, v5
s_nop 1
v_cndmask_b32 v91, v31, v91, vcc
v_cmp_le_i32 vcc, 24, v5
s_nop 1
v_cndmask_b32 v92, v31, v92, vcc
v_cmp_le_i32 vcc, 25, v5
v_mfma_f32_32x32x16_bf16 a[144:159], a[76:79], v[108:111], a[144:159]
s_waitcnt lgkmcnt(3)
buffer_load_dwordx4 v1, s[8:11], s24 offen offset:0 sc1 lds
v_cndmask_b32 v93, v31, v93, vcc
v_cmp_le_i32 vcc, 26, v5
s_nop 1
v_cndmask_b32 v94, v31, v94, vcc
v_cmp_le_i32 vcc, 27, v5
s_nop 1
v_cndmask_b32 v95, v31, v95, vcc
v_mfma_f32_32x32x16_bf16 a[160:175], a[80:83], v[96:99], a[160:175]
ds_read_b128 a[64:67], v2 offset:24576
buffer_load_dwordx4 v1, s[8:11], s24 offen offset:1024 sc1 lds
v_mov_b32 v64, v31
v_mov_b32 v65, v31
v_mov_b32 v66, v31
v_mov_b32 v67, v31
v_mov_b32 v68, v31
v_mov_b32 v69, v31
v_mfma_f32_32x32x16_bf16 a[176:191], a[80:83], v[104:107], a[176:191]
s_waitcnt lgkmcnt(3)
buffer_load_dwordx4 v1, s[8:11], s24 offen offset:2048 sc1 lds
v_mov_b32 v70, v31
v_mov_b32 v71, v31
v_mov_b32 v72, v31
v_mov_b32 v73, v31
v_mov_b32 v74, v31
v_mfma_f32_32x32x16_bf16 a[160:175], a[84:87], v[100:103], a[160:175]
ds_read_b128 a[68:71], v2 offset:25600
buffer_load_dwordx4 v1, s[8:11], s24 offen offset:3072 sc1 lds
v_mov_b32 v75, v31
v_mov_b32 v76, v31
v_mov_b32 v77, v31
v_mov_b32 v78, v31
v_mov_b32 v79, v31
v_max3_f32 v26, v64, v65, v66
v_mfma_f32_32x32x16_bf16 a[176:191], a[84:87], v[108:111], a[176:191]
s_waitcnt lgkmcnt(3)
s_add_u32 s46, s46, 32768
v_max3_f32 v26, v26, v67, v68
v_max3_f32 v26, v26, v69, v70
v_max3_f32 v26, v26, v71, v72
v_max3_f32 v26, v26, v73, v74
v_max3_f32 v26, v26, v75, v76
v_mfma_f32_32x32x16_bf16 a[192:207], a[88:91], v[96:99], a[192:207]
ds_read_b128 a[72:75], v2 offset:26624
s_add_u32 s47, s47, 32768
v_max3_f32 v26, v26, v77, v78
v_max3_f32 v26, v26, v79, v80
v_max3_f32 v26, v26, v81, v82
v_max3_f32 v26, v26, v83, v84
v_max3_f32 v26, v26, v85, v86
v_max3_f32 v26, v26, v87, v88
v_mfma_f32_32x32x16_bf16 a[208:223], a[88:91], v[104:107], a[208:223]
s_waitcnt lgkmcnt(3)
s_and_b32 s47, s47, 131071
v_max3_f32 v26, v26, v89, v90
v_max3_f32 v26, v26, v91, v92
v_max3_f32 v26, v26, v93, v94
v_max_f32 v26, v26, v95
v_cmp_lt_f32 vcc, s54, v26
v_mfma_f32_32x32x16_bf16 a[192:207], a[92:95], v[100:103], a[192:207]
ds_read_b128 a[76:79], v2 offset:27648
s_cbranch_vccnz L_at_upd
L_at_uprd:
v_exp_f32 v64, v64
v_exp_f32 v65, v65
v_exp_f32 v66, v66
v_add_f32 v22, v22, v64
v_add_f32 v22, v22, v65
v_exp_f32 v67, v67
v_cvt_pk_bf16_f32 v112, v64, v65
v_exp_f32 v68, v68
v_add_f32 v22, v22, v66
v_add_f32 v22, v22, v67
v_exp_f32 v69, v69
v_cvt_pk_bf16_f32 v113, v66, v67
v_exp_f32 v70, v70
v_add_f32 v22, v22, v68
v_add_f32 v22, v22, v69
v_exp_f32 v71, v71
v_cvt_pk_bf16_f32 v114, v68, v69
v_exp_f32 v72, v72
v_add_f32 v22, v22, v70
v_add_f32 v22, v22, v71
v_exp_f32 v73, v73
v_cvt_pk_bf16_f32 v115, v70, v71
v_exp_f32 v74, v74
v_add_f32 v22, v22, v72
v_add_f32 v22, v22, v73
v_exp_f32 v75, v75
v_cvt_pk_bf16_f32 v116, v72, v73
v_exp_f32 v76, v76
v_add_f32 v22, v22, v74
v_add_f32 v22, v22, v75
v_exp_f32 v77, v77
v_cvt_pk_bf16_f32 v117, v74, v75
v_exp_f32 v78, v78
v_add_f32 v22, v22, v76
v_add_f32 v22, v22, v77
v_exp_f32 v79, v79
v_cvt_pk_bf16_f32 v118, v76, v77
v_exp_f32 v80, v80
v_add_f32 v22, v22, v78
v_mfma_f32_32x32x16_bf16 a[208:223], a[92:95], v[108:111], a[208:223]
s_waitcnt lgkmcnt(3)
s_cmp_eq_u32 s48, 0
s_cbranch_scc0 L_at_rsd
L_at_rsrd:
v_add_f32 v22, v22, v79
v_exp_f32 v81, v81
v_cvt_pk_bf16_f32 v119, v78, v79
v_exp_f32 v82, v82
v_add_f32 v23, v23, v80
v_add_f32 v23, v23, v81
v_exp_f32 v83, v83
v_cvt_pk_bf16_f32 v120, v80, v81
v_exp_f32 v84, v84
v_add_f32 v23, v23, v82
v_add_f32 v23, v23, v83
v_exp_f32 v85, v85
v_cvt_pk_bf16_f32 v121, v82, v83
v_exp_f32 v86, v86
v_add_f32 v23, v23, v84
v_add_f32 v23, v23, v85
v_exp_f32 v87, v87
v_cvt_pk_bf16_f32 v122, v84, v85
v_exp_f32 v88, v88
v_add_f32 v23, v23, v86
v_add_f32 v23, v23, v87
v_exp_f32 v89, v89
v_cvt_pk_bf16_f32 v123, v86, v87
v_exp_f32 v90, v90
v_add_f32 v23, v23, v88
v_add_f32 v23, v23, v89
v_exp_f32 v91, v91
v_cvt_pk_bf16_f32 v124, v88, v89
v_exp_f32 v92, v92
v_add_f32 v23, v23, v90
v_add_f32 v23, v23, v91
v_exp_f32 v93, v93
v_cvt_pk_bf16_f32 v125, v90, v91
v_exp_f32 v94, v94
v_add_f32 v23, v23, v92
v_add_f32 v23, v23, v93
v_exp_f32 v95, v95
v_cvt_pk_bf16_f32 v126, v92, v93
v_add_f32 v23, v23, v94
v_add_f32 v23, v23, v95
v_cvt_pk_bf16_f32 v127, v94, v95
v_mfma_f32_32x32x16_bf16 a[96:111], a[64:67], v[112:115], a[96:111]
ds_read_b128 a[80:83], v2 offset:28672
v_mfma_f32_32x32x16_bf16 a[112:127], a[64:67], v[120:123], a[112:127]
s_waitcnt lgkmcnt(3)
v_mfma_f32_32x32x16_bf16 a[96:111], a[68:71], v[116:119], a[96:111]
ds_read_b128 a[84:87], v2 offset:29696
v_mfma_f32_32x32x16_bf16 a[112:127], a[68:71], v[124:127], a[112:127]
s_waitcnt lgkmcnt(3)
v_mfma_f32_32x32x16_bf16 a[128:143], a[72:75], v[112:115], a[128:143]
ds_read_b128 a[88:91], v2 offset:30720
v_mfma_f32_32x32x16_bf16 a[144:159], a[72:75], v[120:123], a[144:159]
s_waitcnt lgkmcnt(3)
v_mfma_f32_32x32x16_bf16 a[128:143], a[76:79], v[116:119], a[128:143]
ds_read_b128 a[92:95], v2 offset:31744
v_mfma_f32_32x32x16_bf16 a[144:159], a[76:79], v[124:127], a[144:159]
s_waitcnt lgkmcnt(3)
v_mfma_f32_32x32x16_bf16 a[160:175], a[80:83], v[112:115], a[160:175]
v_mfma_f32_32x32x16_bf16 a[176:191], a[80:83], v[120:123], a[176:191]
s_waitcnt lgkmcnt(2)
v_mfma_f32_32x32x16_bf16 a[160:175], a[84:87], v[116:119], a[160:175]
v_mfma_f32_32x32x16_bf16 a[176:191], a[84:87], v[124:127], a[176:191]
s_waitcnt lgkmcnt(1)
v_mfma_f32_32x32x16_bf16 a[192:207], a[88:91], v[112:115], a[192:207]
v_mfma_f32_32x32x16_bf16 a[208:223], a[88:91], v[120:123], a[208:223]
s_waitcnt lgkmcnt(0)
v_mfma_f32_32x32x16_bf16 a[192:207], a[92:95], v[116:119], a[192:207]
v_mfma_f32_32x32x16_bf16 a[208:223], a[92:95], v[124:127], a[208:223]
s_lshl_b32 s26, s44, 19
s_lshl_b32 s27, s42, 12
s_add_u32 s26, s26, s27
s_add_u32 s26, s26, 67108864
s_add_u32 s27, s26, 262144
L_at_idle:
s_add_u32 s43, s43, 1
s_cmp_ge_u32 s43, s45
s_cbranch_scc1 L_at_fin
s_waitcnt vmcnt(0)
s_barrier
s_branch L_at_idle
L_at_upa:
v_max3_f32 v26, v32, v33, v34
v_max3_f32 v26, v26, v35, v36
v_max3_f32 v26, v26, v37, v38
v_max3_f32 v26, v26, v39, v40
v_max3_f32 v26, v26, v41, v42
v_max3_f32 v26, v26, v43, v44
v_max3_f32 v26, v26, v45, v46
v_max_f32 v26, v26, v47
v_mov_b32 v27, v26
s_nop 1
v_permlane32_swap_b32 v27, v26
v_max3_f32 v26, v26, v27, s55
v_exp_f32 v24, -v26
v_sub_f32 v32, v32, v26
v_sub_f32 v128, v128, v26
v_sub_f32 v33, v33, v26
v_sub_f32 v129, v129, v26
v_sub_f32 v34, v34, v26
v_sub_f32 v130, v130, v26
v_sub_f32 v35, v35, v26
v_sub_f32 v131, v131, v26
v_sub_f32 v36, v36, v26
v_sub_f32 v132, v132, v26
v_sub_f32 v37, v37, v26
v_sub_f32 v133, v133, v26
v_sub_f32 v38, v38, v26
v_sub_f32 v134, v134, v26
v_sub_f32 v39, v39, v26
v_sub_f32 v135, v135, v26
v_sub_f32 v40, v40, v26
v_sub_f32 v136, v136, v26
v_sub_f32 v41, v41, v26
v_sub_f32 v137, v137, v26
v_sub_f32 v42, v42, v26
v_sub_f32 v138, v138, v26
v_sub_f32 v43, v43, v26
v_sub_f32 v139, v139, v26
v_sub_f32 v44, v44, v26
v_sub_f32 v140, v140, v26
v_sub_f32 v45, v45, v26
v_sub_f32 v141, v141, v26
v_sub_f32 v46, v46, v26
v_sub_f32 v142, v142, v26
v_sub_f32 v47, v47, v26
v_sub_f32 v143, v143, v26
v_min_f32 v24, 1.0, v24
v_mul_f32 v22, v22, v24
v_max3_f32 v26, v48, v49, v50
v_max3_f32 v26, v26, v51, v52
v_max3_f32 v26, v26, v53, v54
v_max3_f32 v26, v26, v55, v56
v_max3_f32 v26, v26, v57, v58
v_max3_f32 v26, v26, v59, v60
v_max3_f32 v26, v26, v61, v62
v_max_f32 v26, v26, v63
v_mov_b32 v27, v26
s_nop 1
v_permlane32_swap_b32 v27, v26
v_max3_f32 v26, v26, v27, s55
v_exp_f32 v25, -v26
v_sub_f32 v48, v48, v26
v_sub_f32 v144, v144, v26
v_sub_f32 v49, v49, v26
v_sub_f32 v145, v145, v26
v_sub_f32 v50, v50, v26
v_sub_f32 v146, v146, v26
v_sub_f32 v51, v51, v26
v_sub_f32 v147, v147, v26
v_sub_f32 v52, v52, v26
v_sub_f32 v148, v148, v26
v_sub_f32 v53, v53, v26
v_sub_f32 v149, v149, v26
v_sub_f32 v54, v54, v26
v_sub_f32 v150, v150, v26
v_sub_f32 v55, v55, v26
v_sub_f32 v151, v151, v26
v_sub_f32 v56, v56, v26
v_sub_f32 v152, v152, v26
v_sub_f32 v57, v57, v26
v_sub_f32 v153, v153, v26
v_sub_f32 v58, v58, v26
v_sub_f32 v154, v154, v26
v_sub_f32 v59, v59, v26
v_sub_f32 v155, v155, v26
v_sub_f32 v60, v60, v26
v_sub_f32 v156, v156, v26
v_sub_f32 v61, v61, v26
v_sub_f32 v157, v157, v26
v_sub_f32 v62, v62, v26
v_sub_f32 v158, v158, v26
v_sub_f32 v63, v63, v26
v_sub_f32 v159, v159, v26
v_min_f32 v25, 1.0, v25
v_mul_f32 v23, v23, v25
s_cmp_eq_u32 s55, 0
s_cselect_b32 s48, 1, 0
s_mov_b32 s55, 0
s_mov_b32 s54, s51
s_branch L_at_upra
L_at_rsa:
s_getpc_b64 s[52:53]
s_add_u32 s52, s52, 12
s_addc_u32 s53, s53, 0
s_branch L_at_rescale
s_branch L_at_rsra
L_at_upb:
v_max3_f32 v26, v64, v65, v66
v_max3_f32 v26, v26, v67, v68
v_max3_f32 v26, v26, v69, v70
v_max3_f32 v26, v26, v71, v72
v_max3_f32 v26, v26, v73, v74
v_max3_f32 v26, v26, v75, v76
v_max3_f32 v26, v26, v77, v78
v_max_f32 v26, v26, v79
v_mov_b32 v27, v26
s_nop 1
v_permlane32_swap_b32 v27, v26
v_max3_f32 v26, v26, v27, s55
v_exp_f32 v24, -v26
v_sub_f32 v64, v64, v26
v_sub_f32 v128, v128, v26
v_sub_f32 v65, v65, v26
v_sub_f32 v129, v129, v26
v_sub_f32 v66, v66, v26
v_sub_f32 v130, v130, v26
v_sub_f32 v67, v67, v26
v_sub_f32 v131, v131, v26
v_sub_f32 v68, v68, v26
v_sub_f32 v132, v132, v26
v_sub_f32 v69, v69, v26
v_sub_f32 v133, v133, v26
v_sub_f32 v70, v70, v26
v_sub_f32 v134, v134, v26
v_sub_f32 v71, v71, v26
v_sub_f32 v135, v135, v26
v_sub_f32 v72, v72, v26
v_sub_f32 v136, v136, v26
v_sub_f32 v73, v73, v26
v_sub_f32 v137, v137, v26
v_sub_f32 v74, v74, v26
v_sub_f32 v138, v138, v26
v_sub_f32 v75, v75, v26
v_sub_f32 v139, v139, v26
v_sub_f32 v76, v76, v26
v_sub_f32 v140, v140, v26
v_sub_f32 v77, v77, v26
v_sub_f32 v141, v141, v26
v_sub_f32 v78, v78, v26
v_sub_f32 v142, v142, v26
v_sub_f32 v79, v79, v26
v_sub_f32 v143, v143, v26
v_min_f32 v24, 1.0, v24
v_mul_f32 v22, v22, v24
v_max3_f32 v26, v80, v81, v82
v_max3_f32 v26, v26, v83, v84
v_max3_f32 v26, v26, v85, v86
v_max3_f32 v26, v26, v87, v88
v_max3_f32 v26, v26, v89, v90
v_max3_f32 v26, v26, v91, v92
v_max3_f32 v26, v26, v93, v94
v_max_f32 v26, v26, v95
v_mov_b32 v27, v26
s_nop 1
v_permlane32_swap_b32 v27, v26
v_max3_f32 v26, v26, v27, s55
v_exp_f32 v25, -v26
v_sub_f32 v80, v80, v26
v_sub_f32 v144, v144, v26
v_sub_f32 v81, v81, v26
v_sub_f32 v145, v145, v26
v_sub_f32 v82, v82, v26
v_sub_f32 v146, v146, v26
v_sub_f32 v83, v83, v26
v_sub_f32 v147, v147, v26
v_sub_f32 v84, v84, v26
v_sub_f32 v148, v148, v26
v_sub_f32 v85, v85, v26
v_sub_f32 v149, v149, v26
v_sub_f32 v86, v86, v26
v_sub_f32 v150, v150, v26
v_sub_f32 v87, v87, v26
v_sub_f32 v151, v151, v26
v_sub_f32 v88, v88, v26
v_sub_f32 v152, v152, v26
v_sub_f32 v89, v89, v26
v_sub_f32 v153, v153, v26
v_sub_f32 v90, v90, v26
v_sub_f32 v154, v154, v26
v_sub_f32 v91, v91, v26
v_sub_f32 v155, v155, v26
v_sub_f32 v92, v92, v26
v_sub_f32 v156, v156, v26
v_sub_f32 v93, v93, v26
v_sub_f32 v157, v157, v26
v_sub_f32 v94, v94, v26
v_sub_f32 v158, v158, v26
v_sub_f32 v95, v95, v26
v_sub_f32 v159, v159, v26
v_min_f32 v25, 1.0, v25
v_mul_f32 v23, v23, v25
s_cmp_eq_u32 s55, 0
s_cselect_b32 s48, 1, 0
s_mov_b32 s55, 0
s_mov_b32 s54, s51
s_branch L_at_uprb
L_at_rsb:
s_getpc_b64 s[52:53]
s_add_u32 s52, s52, 12
s_addc_u32 s53, s53, 0
s_branch L_at_rescale
s_branch L_at_rsrb
L_at_upc:
v_max3_f32 v26, v32, v33, v34
v_max3_f32 v26, v26, v35, v36
v_max3_f32 v26, v26, v37, v38
v_max3_f32 v26, v26, v39, v40
v_max3_f32 v26, v26, v41, v42
v_max3_f32 v26, v26, v43, v44
v_max3_f32 v26, v26, v45, v46
v_max_f32 v26, v26, v47
v_mov_b32 v27, v26
s_nop 1
v_permlane32_swap_b32 v27, v26
v_max3_f32 v26, v26, v27, s55
v_exp_f32 v24, -v26
v_sub_f32 v32, v32, v26
v_sub_f32 v128, v128, v26
v_sub_f32 v33, v33, v26
v_sub_f32 v129, v129, v26
v_sub_f32 v34, v34, v26
v_sub_f32 v130, v130, v26
v_sub_f32 v35, v35, v26
v_sub_f32 v131, v131, v26
v_sub_f32 v36, v36, v26
v_sub_f32 v132, v132, v26
v_sub_f32 v37, v37, v26
v_sub_f32 v133, v133, v26
v_sub_f32 v38, v38, v26
v_sub_f32 v134, v134, v26
v_sub_f32 v39, v39, v26
v_sub_f32 v135, v135, v26
v_sub_f32 v40, v40, v26
v_sub_f32 v136, v136, v26
v_sub_f32 v41, v41, v26
v_sub_f32 v137, v137, v26
v_sub_f32 v42, v42, v26
v_sub_f32 v138, v138, v26
v_sub_f32 v43, v43, v26
v_sub_f32 v139, v139, v26
v_sub_f32 v44, v44, v26
v_sub_f32 v140, v140, v26
v_sub_f32 v45, v45, v26
v_sub_f32 v141, v141, v26
v_sub_f32 v46, v46, v26
v_sub_f32 v142, v142, v26
v_sub_f32 v47, v47, v26
v_sub_f32 v143, v143, v26
v_min_f32 v24, 1.0, v24
v_mul_f32 v22, v22, v24
v_max3_f32 v26, v48, v49, v50
v_max3_f32 v26, v26, v51, v52
v_max3_f32 v26, v26, v53, v54
v_max3_f32 v26, v26, v55, v56
v_max3_f32 v26, v26, v57, v58
v_max3_f32 v26, v26, v59, v60
v_max3_f32 v26, v26, v61, v62
v_max_f32 v26, v26, v63
v_mov_b32 v27, v26
s_nop 1
v_permlane32_swap_b32 v27, v26
v_max3_f32 v26, v26, v27, s55
v_exp_f32 v25, -v26
v_sub_f32 v48, v48, v26
v_sub_f32 v144, v144, v26
v_sub_f32 v49, v49, v26
v_sub_f32 v145, v145, v26
v_sub_f32 v50, v50, v26
v_sub_f32 v146, v146, v26
v_sub_f32 v51, v51, v26
v_sub_f32 v147, v147, v26
v_sub_f32 v52, v52, v26
v_sub_f32 v148, v148, v26
v_sub_f32 v53, v53, v26
v_sub_f32 v149, v149, v26
v_sub_f32 v54, v54, v26
v_sub_f32 v150, v150, v26
v_sub_f32 v55, v55, v26
v_sub_f32 v151, v151, v26
v_sub_f32 v56, v56, v26
v_sub_f32 v152, v152, v26
v_sub_f32 v57, v57, v26
v_sub_f32 v153, v153, v26
v_sub_f32 v58, v58, v26
v_sub_f32 v154, v154, v26
v_sub_f32 v59, v59, v26
v_sub_f32 v155, v155, v26
v_sub_f32 v60, v60, v26
v_sub_f32 v156, v156, v26
v_sub_f32 v61, v61, v26
v_sub_f32 v157, v157, v26
v_sub_f32 v62, v62, v26
v_sub_f32 v158, v158, v26
v_sub_f32 v63, v63, v26
v_sub_f32 v159, v159, v26
v_min_f32 v25, 1.0, v25
v_mul_f32 v23, v23, v25
s_cmp_eq_u32 s55, 0
s_cselect_b32 s48, 1, 0
s_mov_b32 s55, 0
s_mov_b32 s54, s51
s_branch L_at_uprc
L_at_rsc:
s_getpc_b64 s[52:53]
s_add_u32 s52, s52, 12
s_addc_u32 s53, s53, 0
s_branch L_at_rescale
s_branch L_at_rsrc
L_at_upd:
v_max3_f32 v26, v64, v65, v66
v_max3_f32 v26, v26, v67, v68
v_max3_f32 v26, v26, v69, v70
v_max3_f32 v26, v26, v71, v72
v_max3_f32 v26, v26, v73, v74
v_max3_f32 v26, v26, v75, v76
v_max3_f32 v26, v26, v77, v78
v_max_f32 v26, v26, v79
v_mov_b32 v27, v26
s_nop 1
v_permlane32_swap_b32 v27, v26
v_max3_f32 v26, v26, v27, s55
v_exp_f32 v24, -v26
v_sub_f32 v64, v64, v26
v_sub_f32 v128, v128, v26
v_sub_f32 v65, v65, v26
v_sub_f32 v129, v129, v26
v_sub_f32 v66, v66, v26
v_sub_f32 v130, v130, v26
v_sub_f32 v67, v67, v26
v_sub_f32 v131, v131, v26
v_sub_f32 v68, v68, v26
v_sub_f32 v132, v132, v26
v_sub_f32 v69, v69, v26
v_sub_f32 v133, v133, v26
v_sub_f32 v70, v70, v26
v_sub_f32 v134, v134, v26
v_sub_f32 v71, v71, v26
v_sub_f32 v135, v135, v26
v_sub_f32 v72, v72, v26
v_sub_f32 v136, v136, v26
v_sub_f32 v73, v73, v26
v_sub_f32 v137, v137, v26
v_sub_f32 v74, v74, v26
v_sub_f32 v138, v138, v26
v_sub_f32 v75, v75, v26
v_sub_f32 v139, v139, v26
v_sub_f32 v76, v76, v26
v_sub_f32 v140, v140, v26
v_sub_f32 v77, v77, v26
v_sub_f32 v141, v141, v26
v_sub_f32 v78, v78, v26
v_sub_f32 v142, v142, v26
v_sub_f32 v79, v79, v26
v_sub_f32 v143, v143, v26
v_min_f32 v24, 1.0, v24
v_mul_f32 v22, v22, v24
v_max3_f32 v26, v80, v81, v82
v_max3_f32 v26, v26, v83, v84
v_max3_f32 v26, v26, v85, v86
v_max3_f32 v26, v26, v87, v88
v_max3_f32 v26, v26, v89, v90
v_max3_f32 v26, v26, v91, v92
v_max3_f32 v26, v26, v93, v94
v_max_f32 v26, v26, v95
v_mov_b32 v27, v26
s_nop 1
v_permlane32_swap_b32 v27, v26
v_max3_f32 v26, v26, v27, s55
v_exp_f32 v25, -v26
v_sub_f32 v80, v80, v26
v_sub_f32 v144, v144, v26
v_sub_f32 v81, v81, v26
v_sub_f32 v145, v145, v26
v_sub_f32 v82, v82, v26
v_sub_f32 v146, v146, v26
v_sub_f32 v83, v83, v26
v_sub_f32 v147, v147, v26
v_sub_f32 v84, v84, v26
v_sub_f32 v148, v148, v26
v_sub_f32 v85, v85, v26
v_sub_f32 v149, v149, v26
v_sub_f32 v86, v86, v26
v_sub_f32 v150, v150, v26
v_sub_f32 v87, v87, v26
v_sub_f32 v151, v151, v26
v_sub_f32 v88, v88, v26
v_sub_f32 v152, v152, v26
v_sub_f32 v89, v89, v26
v_sub_f32 v153, v153, v26
v_sub_f32 v90, v90, v26
v_sub_f32 v154, v154, v26
v_sub_f32 v91, v91, v26
v_sub_f32 v155, v155, v26
v_sub_f32 v92, v92, v26
v_sub_f32 v156, v156, v26
v_sub_f32 v93, v93, v26
v_sub_f32 v157, v157, v26
v_sub_f32 v94, v94, v26
v_sub_f32 v158, v158, v26
v_sub_f32 v95, v95, v26
v_sub_f32 v159, v159, v26
v_min_f32 v25, 1.0, v25
v_mul_f32 v23, v23, v25
s_cmp_eq_u32 s55, 0
s_cselect_b32 s48, 1, 0
s_mov_b32 s55, 0
s_mov_b32 s54, s51
s_branch L_at_uprd
L_at_rsd:
s_getpc_b64 s[52:53]
s_add_u32 s52, s52, 12
s_addc_u32 s53, s53, 0
s_branch L_at_rescale
s_branch L_at_rsrd
L_at_rescale:
s_nop 7
s_nop 3
v_accvgpr_read_b32 v160, a96
v_accvgpr_read_b32 v161, a97
v_accvgpr_read_b32 v162, a98
v_accvgpr_read_b32 v163, a99
v_accvgpr_read_b32 v164, a100
v_accvgpr_read_b32 v165, a101
v_accvgpr_read_b32 v166, a102
v_accvgpr_read_b32 v167, a103
v_mul_f32 v160, v160, v24
v_mul_f32 v161, v161, v24
v_mul_f32 v162, v162, v24
v_mul_f32 v163, v163, v24
v_mul_f32 v164, v164, v24
v_mul_f32 v165, v165, v24
v_mul_f32 v166, v166, v24
v_mul_f32 v167, v167, v24
v_accvgpr_write_b32 a96, v160
v_accvgpr_write_b32 a97, v161
v_accvgpr_write_b32 a98, v162
v_accvgpr_write_b32 a99, v163
v_accvgpr_write_b32 a100, v164
v_accvgpr_write_b32 a101, v165
v_accvgpr_write_b32 a102, v166
v_accvgpr_write_b32 a103, v167
v_accvgpr_read_b32 v160, a104
v_accvgpr_read_b32 v161, a105
v_accvgpr_read_b32 v162, a106
v_accvgpr_read_b32 v163, a107
v_accvgpr_read_b32 v164, a108
v_accvgpr_read_b32 v165, a109
v_accvgpr_read_b32 v166, a110
v_accvgpr_read_b32 v167, a111
v_mul_f32 v160, v160, v24
v_mul_f32 v161, v161, v24
v_mul_f32 v162, v162, v24
v_mul_f32 v163, v163, v24
v_mul_f32 v164, v164, v24
v_mul_f32 v165, v165, v24
v_mul_f32 v166, v166, v24
v_mul_f32 v167, v167, v24
v_accvgpr_write_b32 a104, v160
v_accvgpr_write_b32 a105, v161
v_accvgpr_write_b32 a106, v162
v_accvgpr_write_b32 a107, v163
v_accvgpr_write_b32 a108, v164
v_accvgpr_write_b32 a109, v165
v_accvgpr_write_b32 a110, v166
v_accvgpr_write_b32 a111, v167
v_accvgpr_read_b32 v160, a112
v_accvgpr_read_b32 v161, a113
v_accvgpr_read_b32 v162, a114
v_accvgpr_read_b32 v163, a115
v_accvgpr_read_b32 v164, a116
v_accvgpr_read_b32 v165, a117
v_accvgpr_read_b32 v166, a118
v_accvgpr_read_b32 v167, a119
v_mul_f32 v160, v160, v25
v_mul_f32 v161, v161, v25
v_mul_f32 v162, v162, v25
v_mul_f32 v163, v163, v25
v_mul_f32 v164, v164, v25
v_mul_f32 v165, v165, v25
v_mul_f32 v166, v166, v25
v_mul_f32 v167, v167, v25
v_accvgpr_write_b32 a112, v160
v_accvgpr_write_b32 a113, v161
v_accvgpr_write_b32 a114, v162
v_accvgpr_write_b32 a115, v163
v_accvgpr_write_b32 a116, v164
v_accvgpr_write_b32 a117, v165
v_accvgpr_write_b32 a118, v166
v_accvgpr_write_b32 a119, v167
v_accvgpr_read_b32 v160, a120
v_accvgpr_read_b32 v161, a121
v_accvgpr_read_b32 v162, a122
v_accvgpr_read_b32 v163, a123
v_accvgpr_read_b32 v164, a124
v_accvgpr_read_b32 v165, a125
v_accvgpr_read_b32 v166, a126
v_accvgpr_read_b32 v167, a127
v_mul_f32 v160, v160, v25
v_mul_f32 v161, v161, v25
v_mul_f32 v162, v162, v25
v_mul_f32 v163, v163, v25
v_mul_f32 v164, v164, v25
v_mul_f32 v165, v165, v25
v_mul_f32 v166, v166, v25
v_mul_f32 v167, v167, v25
v_accvgpr_write_b32 a120, v160
v_accvgpr_write_b32 a121, v161
v_accvgpr_write_b32 a122, v162
v_accvgpr_write_b32 a123, v163
v_accvgpr_write_b32 a124, v164
v_accvgpr_write_b32 a125, v165
v_accvgpr_write_b32 a126, v166
v_accvgpr_write_b32 a127, v167
v_accvgpr_read_b32 v160, a128
v_accvgpr_read_b32 v161, a129
v_accvgpr_read_b32 v162, a130
v_accvgpr_read_b32 v163, a131
v_accvgpr_read_b32 v164, a132
v_accvgpr_read_b32 v165, a133
v_accvgpr_read_b32 v166, a134
v_accvgpr_read_b32 v167, a135
v_mul_f32 v160, v160, v24
v_mul_f32 v161, v161, v24
v_mul_f32 v162, v162, v24
v_mul_f32 v163, v163, v24
v_mul_f32 v164, v164, v24
v_mul_f32 v165, v165, v24
v_mul_f32 v166, v166, v24
v_mul_f32 v167, v167, v24
v_accvgpr_write_b32 a128, v160
v_accvgpr_write_b32 a129, v161
v_accvgpr_write_b32 a130, v162
v_accvgpr_write_b32 a131, v163
v_accvgpr_write_b32 a132, v164
v_accvgpr_write_b32 a133, v165
v_accvgpr_write_b32 a134, v166
v_accvgpr_write_b32 a135, v167
v_accvgpr_read_b32 v160, a136
v_accvgpr_read_b32 v161, a137
v_accvgpr_read_b32 v162, a138
v_accvgpr_read_b32 v163, a139
v_accvgpr_read_b32 v164, a140
v_accvgpr_read_b32 v165, a141
v_accvgpr_read_b32 v166, a142
v_accvgpr_read_b32 v167, a143
v_mul_f32 v160, v160, v24
v_mul_f32 v161, v161, v24
v_mul_f32 v162, v162, v24
v_mul_f32 v163, v163, v24
v_mul_f32 v164, v164, v24
v_mul_f32 v165, v165, v24
v_mul_f32 v166, v166, v24
v_mul_f32 v167, v167, v24
v_accvgpr_write_b32 a136, v160
v_accvgpr_write_b32 a137, v161
v_accvgpr_write_b32 a138, v162
v_accvgpr_write_b32 a139, v163
v_accvgpr_write_b32 a140, v164
v_accvgpr_write_b32 a141, v165
v_accvgpr_write_b32 a142, v166
v_accvgpr_write_b32 a143, v167
v_accvgpr_read_b32 v160, a144
v_accvgpr_read_b32 v161, a145
v_accvgpr_read_b32 v162, a146
v_accvgpr_read_b32 v163, a147
v_accvgpr_read_b32 v164, a148
v_accvgpr_read_b32 v165, a149
v_accvgpr_read_b32 v166, a150
v_accvgpr_read_b32 v167, a151
v_mul_f32 v160, v160, v25
v_mul_f32 v161, v161, v25
v_mul_f32 v162, v162, v25
v_mul_f32 v163, v163, v25
v_mul_f32 v164, v164, v25
v_mul_f32 v165, v165, v25
v_mul_f32 v166, v166, v25
v_mul_f32 v167, v167, v25
v_accvgpr_write_b32 a144, v160
v_accvgpr_write_b32 a145, v161
v_accvgpr_write_b32 a146, v162
v_accvgpr_write_b32 a147, v163
v_accvgpr_write_b32 a148, v164
v_accvgpr_write_b32 a149, v165
v_accvgpr_write_b32 a150, v166
v_accvgpr_write_b32 a151, v167
v_accvgpr_read_b32 v160, a152
v_accvgpr_read_b32 v161, a153
v_accvgpr_read_b32 v162, a154
v_accvgpr_read_b32 v163, a155
v_accvgpr_read_b32 v164, a156
v_accvgpr_read_b32 v165, a157
v_accvgpr_read_b32 v166, a158
v_accvgpr_read_b32 v167, a159
v_mul_f32 v160, v160, v25
v_mul_f32 v161, v161, v25
v_mul_f32 v162, v162, v25
v_mul_f32 v163, v163, v25
v_mul_f32 v164, v164, v25
v_mul_f32 v165, v165, v25
v_mul_f32 v166, v166, v25
v_mul_f32 v167, v167, v25
v_accvgpr_write_b32 a152, v160
v_accvgpr_write_b32 a153, v161
v_accvgpr_write_b32 a154, v162
v_accvgpr_write_b32 a155, v163
v_accvgpr_write_b32 a156, v164
v_accvgpr_write_b32 a157, v165
v_accvgpr_write_b32 a158, v166
v_accvgpr_write_b32 a159, v167
v_accvgpr_read_b32 v160, a160
v_accvgpr_read_b32 v161, a161
v_accvgpr_read_b32 v162, a162
v_accvgpr_read_b32 v163, a163
v_accvgpr_read_b32 v164, a164
v_accvgpr_read_b32 v165, a165
v_accvgpr_read_b32 v166, a166
v_accvgpr_read_b32 v167, a167
v_mul_f32 v160, v160, v24
v_mul_f32 v161, v161, v24
v_mul_f32 v162, v162, v24
v_mul_f32 v163, v163, v24
v_mul_f32 v164, v164, v24
v_mul_f32 v165, v165, v24
v_mul_f32 v166, v166, v24
v_mul_f32 v167, v167, v24
v_accvgpr_write_b32 a160, v160
v_accvgpr_write_b32 a161, v161
v_accvgpr_write_b32 a162, v162
v_accvgpr_write_b32 a163, v163
v_accvgpr_write_b32 a164, v164
v_accvgpr_write_b32 a165, v165
v_accvgpr_write_b32 a166, v166
v_accvgpr_write_b32 a167, v167
v_accvgpr_read_b32 v160, a168
v_accvgpr_read_b32 v161, a169
v_accvgpr_read_b32 v162, a170
v_accvgpr_read_b32 v163, a171
v_accvgpr_read_b32 v164, a172
v_accvgpr_read_b32 v165, a173
v_accvgpr_read_b32 v166, a174
v_accvgpr_read_b32 v167, a175
v_mul_f32 v160, v160, v24
v_mul_f32 v161, v161, v24
v_mul_f32 v162, v162, v24
v_mul_f32 v163, v163, v24
v_mul_f32 v164, v164, v24
v_mul_f32 v165, v165, v24
v_mul_f32 v166, v166, v24
v_mul_f32 v167, v167, v24
v_accvgpr_write_b32 a168, v160
v_accvgpr_write_b32 a169, v161
v_accvgpr_write_b32 a170, v162
v_accvgpr_write_b32 a171, v163
v_accvgpr_write_b32 a172, v164
v_accvgpr_write_b32 a173, v165
v_accvgpr_write_b32 a174, v166
v_accvgpr_write_b32 a175, v167
v_accvgpr_read_b32 v160, a176
v_accvgpr_read_b32 v161, a177
v_accvgpr_read_b32 v162, a178
v_accvgpr_read_b32 v163, a179
v_accvgpr_read_b32 v164, a180
v_accvgpr_read_b32 v165, a181
v_accvgpr_read_b32 v166, a182
v_accvgpr_read_b32 v167, a183
v_mul_f32 v160, v160, v25
v_mul_f32 v161, v161, v25
v_mul_f32 v162, v162, v25
v_mul_f32 v163, v163, v25
v_mul_f32 v164, v164, v25
v_mul_f32 v165, v165, v25
v_mul_f32 v166, v166, v25
v_mul_f32 v167, v167, v25
v_accvgpr_write_b32 a176, v160
v_accvgpr_write_b32 a177, v161
v_accvgpr_write_b32 a178, v162
v_accvgpr_write_b32 a179, v163
v_accvgpr_write_b32 a180, v164
v_accvgpr_write_b32 a181, v165
v_accvgpr_write_b32 a182, v166
v_accvgpr_write_b32 a183, v167
v_accvgpr_read_b32 v160, a184
v_accvgpr_read_b32 v161, a185
v_accvgpr_read_b32 v162, a186
v_accvgpr_read_b32 v163, a187
v_accvgpr_read_b32 v164, a188
v_accvgpr_read_b32 v165, a189
v_accvgpr_read_b32 v166, a190
v_accvgpr_read_b32 v167, a191
v_mul_f32 v160, v160, v25
v_mul_f32 v161, v161, v25
v_mul_f32 v162, v162, v25
v_mul_f32 v163, v163, v25
v_mul_f32 v164, v164, v25
v_mul_f32 v165, v165, v25
v_mul_f32 v166, v166, v25
v_mul_f32 v167, v167, v25
v_accvgpr_write_b32 a184, v160
v_accvgpr_write_b32 a185, v161
v_accvgpr_write_b32 a186, v162
v_accvgpr_write_b32 a187, v163
v_accvgpr_write_b32 a188, v164
v_accvgpr_write_b32 a189, v165
v_accvgpr_write_b32 a190, v166
v_accvgpr_write_b32 a191, v167
v_accvgpr_read_b32 v160, a192
v_accvgpr_read_b32 v161, a193
v_accvgpr_read_b32 v162, a194
v_accvgpr_read_b32 v163, a195
v_accvgpr_read_b32 v164, a196
v_accvgpr_read_b32 v165, a197
v_accvgpr_read_b32 v166, a198
v_accvgpr_read_b32 v167, a199
v_mul_f32 v160, v160, v24
v_mul_f32 v161, v161, v24
v_mul_f32 v162, v162, v24
v_mul_f32 v163, v163, v24
v_mul_f32 v164, v164, v24
v_mul_f32 v165, v165, v24
v_mul_f32 v166, v166, v24
v_mul_f32 v167, v167, v24
v_accvgpr_write_b32 a192, v160
v_accvgpr_write_b32 a193, v161
v_accvgpr_write_b32 a194, v162
v_accvgpr_write_b32 a195, v163
v_accvgpr_write_b32 a196, v164
v_accvgpr_write_b32 a197, v165
v_accvgpr_write_b32 a198, v166
v_accvgpr_write_b32 a199, v167
v_accvgpr_read_b32 v160, a200
v_accvgpr_read_b32 v161, a201
v_accvgpr_read_b32 v162, a202
v_accvgpr_read_b32 v163, a203
v_accvgpr_read_b32 v164, a204
v_accvgpr_read_b32 v165, a205
v_accvgpr_read_b32 v166, a206
v_accvgpr_read_b32 v167, a207
v_mul_f32 v160, v160, v24
v_mul_f32 v161, v161, v24
v_mul_f32 v162, v162, v24
v_mul_f32 v163, v163, v24
v_mul_f32 v164, v164, v24
v_mul_f32 v165, v165, v24
v_mul_f32 v166, v166, v24
v_mul_f32 v167, v167, v24
v_accvgpr_write_b32 a200, v160
v_accvgpr_write_b32 a201, v161
v_accvgpr_write_b32 a202, v162
v_accvgpr_write_b32 a203, v163
v_accvgpr_write_b32 a204, v164
v_accvgpr_write_b32 a205, v165
v_accvgpr_write_b32 a206, v166
v_accvgpr_write_b32 a207, v167
v_accvgpr_read_b32 v160, a208
v_accvgpr_read_b32 v161, a209
v_accvgpr_read_b32 v162, a210
v_accvgpr_read_b32 v163, a211
v_accvgpr_read_b32 v164, a212
v_accvgpr_read_b32 v165, a213
v_accvgpr_read_b32 v166, a214
v_accvgpr_read_b32 v167, a215
v_mul_f32 v160, v160, v25
v_mul_f32 v161, v161, v25
v_mul_f32 v162, v162, v25
v_mul_f32 v163, v163, v25
v_mul_f32 v164, v164, v25
v_mul_f32 v165, v165, v25
v_mul_f32 v166, v166, v25
v_mul_f32 v167, v167, v25
v_accvgpr_write_b32 a208, v160
v_accvgpr_write_b32 a209, v161
v_accvgpr_write_b32 a210, v162
v_accvgpr_write_b32 a211, v163
v_accvgpr_write_b32 a212, v164
v_accvgpr_write_b32 a213, v165
v_accvgpr_write_b32 a214, v166
v_accvgpr_write_b32 a215, v167
v_accvgpr_read_b32 v160, a216
v_accvgpr_read_b32 v161, a217
v_accvgpr_read_b32 v162, a218
v_accvgpr_read_b32 v163, a219
v_accvgpr_read_b32 v164, a220
v_accvgpr_read_b32 v165, a221
v_accvgpr_read_b32 v166, a222
v_accvgpr_read_b32 v167, a223
v_mul_f32 v160, v160, v25
v_mul_f32 v161, v161, v25
v_mul_f32 v162, v162, v25
v_mul_f32 v163, v163, v25
v_mul_f32 v164, v164, v25
v_mul_f32 v165, v165, v25
v_mul_f32 v166, v166, v25
v_mul_f32 v167, v167, v25
v_accvgpr_write_b32 a216, v160
v_accvgpr_write_b32 a217, v161
v_accvgpr_write_b32 a218, v162
v_accvgpr_write_b32 a219, v163
v_accvgpr_write_b32 a220, v164
v_accvgpr_write_b32 a221, v165
v_accvgpr_write_b32 a222, v166
v_accvgpr_write_b32 a223, v167
s_mov_b32 s48, 0
s_nop 1
s_setpc_b64 s[52:53]
L_at_fin:
v_accvgpr_read_b32 v128, a96
v_accvgpr_read_b32 v129, a97
v_accvgpr_read_b32 v130, a98
v_accvgpr_read_b32 v131, a99
v_accvgpr_read_b32 v132, a100
v_accvgpr_read_b32 v133, a101
v_accvgpr_read_b32 v134, a102
v_accvgpr_read_b32 v135, a103
v_accvgpr_read_b32 v136, a104
v_accvgpr_read_b32 v137, a105
v_accvgpr_read_b32 v138, a106
v_accvgpr_read_b32 v139, a107
v_accvgpr_read_b32 v140, a108
v_accvgpr_read_b32 v141, a109
v_accvgpr_read_b32 v142, a110
v_accvgpr_read_b32 v143, a111
v_accvgpr_read_b32 v144, a112
v_accvgpr_read_b32 v145, a113
v_accvgpr_read_b32 v146, a114
v_accvgpr_read_b32 v147, a115
v_accvgpr_read_b32 v148, a116
v_accvgpr_read_b32 v149, a117
v_accvgpr_read_b32 v150, a118
v_accvgpr_read_b32 v151, a119
v_accvgpr_read_b32 v152, a120
v_accvgpr_read_b32 v153, a121
v_accvgpr_read_b32 v154, a122
v_accvgpr_read_b32 v155, a123
v_accvgpr_read_b32 v156, a124
v_accvgpr_read_b32 v157, a125
v_accvgpr_read_b32 v158, a126
v_accvgpr_read_b32 v159, a127
v_accvgpr_read_b32 v160, a128
v_accvgpr_read_b32 v161, a129
v_accvgpr_read_b32 v162, a130
v_accvgpr_read_b32 v163, a131
v_accvgpr_read_b32 v164, a132
v_accvgpr_read_b32 v165, a133
v_accvgpr_read_b32 v166, a134
v_accvgpr_read_b32 v167, a135
v_accvgpr_read_b32 v168, a136
v_accvgpr_read_b32 v169, a137
v_accvgpr_read_b32 v170, a138
v_accvgpr_read_b32 v171, a139
v_accvgpr_read_b32 v172, a140
v_accvgpr_read_b32 v173, a141
v_accvgpr_read_b32 v174, a142
v_accvgpr_read_b32 v175, a143
v_accvgpr_read_b32 v176, a144
v_accvgpr_read_b32 v177, a145
v_accvgpr_read_b32 v178, a146
v_accvgpr_read_b32 v179, a147
v_accvgpr_read_b32 v180, a148
v_accvgpr_read_b32 v181, a149
v_accvgpr_read_b32 v182, a150
v_accvgpr_read_b32 v183, a151
v_accvgpr_read_b32 v184, a152
v_accvgpr_read_b32 v185, a153
v_accvgpr_read_b32 v186, a154
v_accvgpr_read_b32 v187, a155
v_accvgpr_read_b32 v188, a156
v_accvgpr_read_b32 v189, a157
v_accvgpr_read_b32 v190, a158
v_accvgpr_read_b32 v191, a159
v_accvgpr_read_b32 v192, a160
v_accvgpr_read_b32 v193, a161
v_accvgpr_read_b32 v194, a162
v_accvgpr_read_b32 v195, a163
v_accvgpr_read_b32 v196, a164
v_accvgpr_read_b32 v197, a165
v_accvgpr_read_b32 v198, a166
v_accvgpr_read_b32 v199, a167
v_accvgpr_read_b32 v200, a168
v_accvgpr_read_b32 v201, a169
v_accvgpr_read_b32 v202, a170
v_accvgpr_read_b32 v203, a171
v_accvgpr_read_b32 v204, a172
v_accvgpr_read_b32 v205, a173
v_accvgpr_read_b32 v206, a174
v_accvgpr_read_b32 v207, a175
v_accvgpr_read_b32 v208, a176
v_accvgpr_read_b32 v209, a177
v_accvgpr_read_b32 v210, a178
v_accvgpr_read_b32 v211, a179
v_accvgpr_read_b32 v212, a180
v_accvgpr_read_b32 v213, a181
v_accvgpr_read_b32 v214, a182
v_accvgpr_read_b32 v215, a183
v_accvgpr_read_b32 v216, a184
v_accvgpr_read_b32 v217, a185
v_accvgpr_read_b32 v218, a186
v_accvgpr_read_b32 v219, a187
v_accvgpr_read_b32 v220, a188
v_accvgpr_read_b32 v221, a189
v_accvgpr_read_b32 v222, a190
v_accvgpr_read_b32 v223, a191
v_accvgpr_read_b32 v224, a192
v_accvgpr_read_b32 v225, a193
v_accvgpr_read_b32 v226, a194
v_accvgpr_read_b32 v227, a195
v_accvgpr_read_b32 v228, a196
v_accvgpr_read_b32 v229, a197
v_accvgpr_read_b32 v230, a198
v_accvgpr_read_b32 v231, a199
v_accvgpr_read_b32 v232, a200
v_accvgpr_read_b32 v233, a201
v_accvgpr_read_b32 v234, a202
v_accvgpr_read_b32 v235, a203
v_accvgpr_read_b32 v236, a204
v_accvgpr_read_b32 v237, a205
v_accvgpr_read_b32 v238, a206
v_accvgpr_read_b32 v239, a207
v_accvgpr_read_b32 v240, a208
v_accvgpr_read_b32 v241, a209
v_accvgpr_read_b32 v242, a210
v_accvgpr_read_b32 v243, a211
v_accvgpr_read_b32 v244, a212
v_accvgpr_read_b32 v245, a213
v_accvgpr_read_b32 v246, a214
v_accvgpr_read_b32 v247, a215
v_accvgpr_read_b32 v248, a216
v_accvgpr_read_b32 v249, a217
v_accvgpr_read_b32 v250, a218
v_accvgpr_read_b32 v251, a219
v_accvgpr_read_b32 v252, a220
v_accvgpr_read_b32 v253, a221
v_accvgpr_read_b32 v254, a222
v_accvgpr_read_b32 v255, a223
v_mov_b32 v26, v22
s_nop 1
v_permlane32_swap_b32 v26, v22
v_add_f32 v26, v26, v22
v_rcp_f32 v26, v26
s_nop 0
v_pk_mul_f32 v[128:129], v[128:129], v[26:27] op_sel_hi:[1,0]
v_pk_mul_f32 v[130:131], v[130:131], v[26:27] op_sel_hi:[1,0]
v_pk_mul_f32 v[132:133], v[132:133], v[26:27] op_sel_hi:[1,0]
v_pk_mul_f32 v[134:135], v[134:135], v[26:27] op_sel_hi:[1,0]
v_pk_mul_f32 v[136:137], v[136:137], v[26:27] op_sel_hi:[1,0]
v_pk_mul_f32 v[138:139], v[138:139], v[26:27] op_sel_hi:[1,0]
v_pk_mul_f32 v[140:141], v[140:141], v[26:27] op_sel_hi:[1,0]
v_pk_mul_f32 v[142:143], v[142:143], v[26:27] op_sel_hi:[1,0]
v_cvt_pk_bf16_f32 v128, v128, v129
v_cvt_pk_bf16_f32 v129, v130, v131
v_cvt_pk_bf16_f32 v130, v132, v133
v_cvt_pk_bf16_f32 v131, v134, v135
buffer_store_dwordx4 v[128:131], v6, s[8:11], s26 offen offset:0 sc1
v_cvt_pk_bf16_f32 v136, v136, v137
v_cvt_pk_bf16_f32 v137, v138, v139
v_cvt_pk_bf16_f32 v138, v140, v141
v_cvt_pk_bf16_f32 v139, v142, v143
buffer_store_dwordx4 v[136:139], v6, s[8:11], s26 offen offset:512 sc1
v_pk_mul_f32 v[160:161], v[160:161], v[26:27] op_sel_hi:[1,0]
v_pk_mul_f32 v[162:163], v[162:163], v[26:27] op_sel_hi:[1,0]
v_pk_mul_f32 v[164:165], v[164:165], v[26:27] op_sel_hi:[1,0]
v_pk_mul_f32 v[166:167], v[166:167], v[26:27] op_sel_hi:[1,0]
v_pk_mul_f32 v[168:169], v[168:169], v[26:27] op_sel_hi:[1,0]
v_pk_mul_f32 v[170:171], v[170:171], v[26:27] op_sel_hi:[1,0]
v_pk_mul_f32 v[172:173], v[172:173], v[26:27] op_sel_hi:[1,0]
v_pk_mul_f32 v[174:175], v[174:175], v[26:27] op_sel_hi:[1,0]
v_cvt_pk_bf16_f32 v160, v160, v161
v_cvt_pk_bf16_f32 v161, v162, v163
v_cvt_pk_bf16_f32 v162, v164, v165
v_cvt_pk_bf16_f32 v163, v166, v167
buffer_store_dwordx4 v[160:163], v6, s[8:11], s26 offen offset:1024 sc1
v_cvt_pk_bf16_f32 v168, v168, v169
v_cvt_pk_bf16_f32 v169, v170, v171
v_cvt_pk_bf16_f32 v170, v172, v173
v_cvt_pk_bf16_f32 v171, v174, v175
buffer_store_dwordx4 v[168:171], v6, s[8:11], s26 offen offset:1536 sc1
v_pk_mul_f32 v[192:193], v[192:193], v[26:27] op_sel_hi:[1,0]
v_pk_mul_f32 v[194:195], v[194:195], v[26:27] op_sel_hi:[1,0]
v_pk_mul_f32 v[196:197], v[196:197], v[26:27] op_sel_hi:[1,0]
v_pk_mul_f32 v[198:199], v[198:199], v[26:27] op_sel_hi:[1,0]
v_pk_mul_f32 v[200:201], v[200:201], v[26:27] op_sel_hi:[1,0]
v_pk_mul_f32 v[202:203], v[202:203], v[26:27] op_sel_hi:[1,0]
v_pk_mul_f32 v[204:205], v[204:205], v[26:27] op_sel_hi:[1,0]
v_pk_mul_f32 v[206:207], v[206:207], v[26:27] op_sel_hi:[1,0]
v_cvt_pk_bf16_f32 v192, v192, v193
v_cvt_pk_bf16_f32 v193, v194, v195
v_cvt_pk_bf16_f32 v194, v196, v197
v_cvt_pk_bf16_f32 v195, v198, v199
buffer_store_dwordx4 v[192:195], v6, s[8:11], s26 offen offset:2048 sc1
v_cvt_pk_bf16_f32 v200, v200, v201
v_cvt_pk_bf16_f32 v201, v202, v203
v_cvt_pk_bf16_f32 v202, v204, v205
v_cvt_pk_bf16_f32 v203, v206, v207
buffer_store_dwordx4 v[200:203], v6, s[8:11], s26 offen offset:2560 sc1
v_pk_mul_f32 v[224:225], v[224:225], v[26:27] op_sel_hi:[1,0]
v_pk_mul_f32 v[226:227], v[226:227], v[26:27] op_sel_hi:[1,0]
v_pk_mul_f32 v[228:229], v[228:229], v[26:27] op_sel_hi:[1,0]
v_pk_mul_f32 v[230:231], v[230:231], v[26:27] op_sel_hi:[1,0]
v_pk_mul_f32 v[232:233], v[232:233], v[26:27] op_sel_hi:[1,0]
v_pk_mul_f32 v[234:235], v[234:235], v[26:27] op_sel_hi:[1,0]
v_pk_mul_f32 v[236:237], v[236:237], v[26:27] op_sel_hi:[1,0]
v_pk_mul_f32 v[238:239], v[238:239], v[26:27] op_sel_hi:[1,0]
v_cvt_pk_bf16_f32 v224, v224, v225
v_cvt_pk_bf16_f32 v225, v226, v227
v_cvt_pk_bf16_f32 v226, v228, v229
v_cvt_pk_bf16_f32 v227, v230, v231
buffer_store_dwordx4 v[224:227], v6, s[8:11], s26 offen offset:3072 sc1
v_cvt_pk_bf16_f32 v232, v232, v233
v_cvt_pk_bf16_f32 v233, v234, v235
v_cvt_pk_bf16_f32 v234, v236, v237
v_cvt_pk_bf16_f32 v235, v238, v239
buffer_store_dwordx4 v[232:235], v6, s[8:11], s26 offen offset:3584 sc1
v_mov_b32 v26, v23
s_nop 1
v_permlane32_swap_b32 v26, v23
v_add_f32 v26, v26, v23
v_rcp_f32 v26, v26
s_nop 0
v_pk_mul_f32 v[144:145], v[144:145], v[26:27] op_sel_hi:[1,0]
v_pk_mul_f32 v[146:147], v[146:147], v[26:27] op_sel_hi:[1,0]
v_pk_mul_f32 v[148:149], v[148:149], v[26:27] op_sel_hi:[1,0]
v_pk_mul_f32 v[150:151], v[150:151], v[26:27] op_sel_hi:[1,0]
v_pk_mul_f32 v[152:153], v[152:153], v[26:27] op_sel_hi:[1,0]
v_pk_mul_f32 v[154:155], v[154:155], v[26:27] op_sel_hi:[1,0]
v_pk_mul_f32 v[156:157], v[156:157], v[26:27] op_sel_hi:[1,0]
v_pk_mul_f32 v[158:159], v[158:159], v[26:27] op_sel_hi:[1,0]
v_cvt_pk_bf16_f32 v144, v144, v145
v_cvt_pk_bf16_f32 v145, v146, v147
v_cvt_pk_bf16_f32 v146, v148, v149
v_cvt_pk_bf16_f32 v147, v150, v151
buffer_store_dwordx4 v[144:147], v6, s[8:11], s27 offen offset:0 sc1
v_cvt_pk_bf16_f32 v152, v152, v153
v_cvt_pk_bf16_f32 v153, v154, v155
v_cvt_pk_bf16_f32 v154, v156, v157
v_cvt_pk_bf16_f32 v155, v158, v159
buffer_store_dwordx4 v[152:155], v6, s[8:11], s27 offen offset:512 sc1
v_pk_mul_f32 v[176:177], v[176:177], v[26:27] op_sel_hi:[1,0]
v_pk_mul_f32 v[178:179], v[178:179], v[26:27] op_sel_hi:[1,0]
v_pk_mul_f32 v[180:181], v[180:181], v[26:27] op_sel_hi:[1,0]
v_pk_mul_f32 v[182:183], v[182:183], v[26:27] op_sel_hi:[1,0]
v_pk_mul_f32 v[184:185], v[184:185], v[26:27] op_sel_hi:[1,0]
v_pk_mul_f32 v[186:187], v[186:187], v[26:27] op_sel_hi:[1,0]
v_pk_mul_f32 v[188:189], v[188:189], v[26:27] op_sel_hi:[1,0]
v_pk_mul_f32 v[190:191], v[190:191], v[26:27] op_sel_hi:[1,0]
v_cvt_pk_bf16_f32 v176, v176, v177
v_cvt_pk_bf16_f32 v177, v178, v179
v_cvt_pk_bf16_f32 v178, v180, v181
v_cvt_pk_bf16_f32 v179, v182, v183
buffer_store_dwordx4 v[176:179], v6, s[8:11], s27 offen offset:1024 sc1
v_cvt_pk_bf16_f32 v184, v184, v185
v_cvt_pk_bf16_f32 v185, v186, v187
v_cvt_pk_bf16_f32 v186, v188, v189
v_cvt_pk_bf16_f32 v187, v190, v191
buffer_store_dwordx4 v[184:187], v6, s[8:11], s27 offen offset:1536 sc1
v_pk_mul_f32 v[208:209], v[208:209], v[26:27] op_sel_hi:[1,0]
v_pk_mul_f32 v[210:211], v[210:211], v[26:27] op_sel_hi:[1,0]
v_pk_mul_f32 v[212:213], v[212:213], v[26:27] op_sel_hi:[1,0]
v_pk_mul_f32 v[214:215], v[214:215], v[26:27] op_sel_hi:[1,0]
v_pk_mul_f32 v[216:217], v[216:217], v[26:27] op_sel_hi:[1,0]
v_pk_mul_f32 v[218:219], v[218:219], v[26:27] op_sel_hi:[1,0]
v_pk_mul_f32 v[220:221], v[220:221], v[26:27] op_sel_hi:[1,0]
v_pk_mul_f32 v[222:223], v[222:223], v[26:27] op_sel_hi:[1,0]
v_cvt_pk_bf16_f32 v208, v208, v209
v_cvt_pk_bf16_f32 v209, v210, v211
v_cvt_pk_bf16_f32 v210, v212, v213
v_cvt_pk_bf16_f32 v211, v214, v215
buffer_store_dwordx4 v[208:211], v6, s[8:11], s27 offen offset:2048 sc1
v_cvt_pk_bf16_f32 v216, v216, v217
v_cvt_pk_bf16_f32 v217, v218, v219
v_cvt_pk_bf16_f32 v218, v220, v221
v_cvt_pk_bf16_f32 v219, v222, v223
buffer_store_dwordx4 v[216:219], v6, s[8:11], s27 offen offset:2560 sc1
v_pk_mul_f32 v[240:241], v[240:241], v[26:27] op_sel_hi:[1,0]
v_pk_mul_f32 v[242:243], v[242:243], v[26:27] op_sel_hi:[1,0]
v_pk_mul_f32 v[244:245], v[244:245], v[26:27] op_sel_hi:[1,0]
v_pk_mul_f32 v[246:247], v[246:247], v[26:27] op_sel_hi:[1,0]
v_pk_mul_f32 v[248:249], v[248:249], v[26:27] op_sel_hi:[1,0]
v_pk_mul_f32 v[250:251], v[250:251], v[26:27] op_sel_hi:[1,0]
v_pk_mul_f32 v[252:253], v[252:253], v[26:27] op_sel_hi:[1,0]
v_pk_mul_f32 v[254:255], v[254:255], v[26:27] op_sel_hi:[1,0]
v_cvt_pk_bf16_f32 v240, v240, v241
v_cvt_pk_bf16_f32 v241, v242, v243
v_cvt_pk_bf16_f32 v242, v244, v245
v_cvt_pk_bf16_f32 v243, v246, v247
buffer_store_dwordx4 v[240:243], v6, s[8:11], s27 offen offset:3072 sc1
v_cvt_pk_bf16_f32 v248, v248, v249
v_cvt_pk_bf16_f32 v249, v250, v251
v_cvt_pk_bf16_f32 v250, v252, v253
v_cvt_pk_bf16_f32 v251, v254, v255
buffer_store_dwordx4 v[248:251], v6, s[8:11], s27 offen offset:3584 sc1
s_lshl_b32 s61, s41, 5
s_add_u32 s61, s61, s42
s_lshl_b32 s61, s61, 2
s_add_u32 s61, s61, 111169536
s_waitcnt vmcnt(0)
s_barrier
s_cmp_lg_u32 s17, 0
s_cbranch_scc1 L_sf_12
v_mov_b32 v20, 0
v_mov_b32 v21, 1
s_mov_b64 exec, 1
buffer_store_dword v21, v20, s[8:11], s61 offen sc1
s_mov_b64 exec, -1
L_sf_12:
s_mov_b32 s41, s62
s_add_u32 s60, s60, 1
s_cmp_lt_u32 s60, 2
s_cbranch_scc1 L_aat
s_cmp_ge_u32 s16, 27
s_cbranch_scc1 L_done
s_load_dwordx2 s[4:5], s[0:1], 40
s_waitcnt lgkmcnt(0)
s_mov_b32 s20, s4
s_and_b32 s21, s5, 0xffff
s_mov_b32 s22, 4718592
s_mov_b32 s23, 0x20000
s_mul_i32 s24, s16, 57
s_lshr_b32 s24, s24, 9
s_mul_i32 s25, s24, 9
s_sub_u32 s40, s16, s25
s_sub_u32 s25, s3, 4
s_mul_i32 s25, s25, 3
s_add_u32 s25, s25, s24
s_and_b32 s51, s25, 1
s_add_u32 s51, s51, 64
s_lshr_b32 s25, s25, 1
s_cmp_eq_u32 s25, 0
s_cselect_b32 s42, 0x10410449, s42
s_cselect_b32 s43, 0x4104104, s43
s_cmp_eq_u32 s25, 1
s_cselect_b32 s42, 0x20820892, s42
s_cselect_b32 s43, 0x8208208, s43
s_cmp_eq_u32 s25, 2
s_cselect_b32 s42, 0x41041124, s42
s_cselect_b32 s43, 0x10410410, s43
s_cmp_eq_u32 s25, 3
s_cselect_b32 s42, 0x82082200, s42
s_cselect_b32 s43, 0x20820820, s43
s_cmp_eq_u32 s25, 4
s_cselect_b32 s42, 0x4104000, s42
s_cselect_b32 s43, 0x41041041, s43
s_cmp_eq_u32 s25, 5
s_cselect_b32 s42, 0x8208000, s42
s_cselect_b32 s43, 0x82082082, s43
s_mov_b32 s44, 67108864
s_mov_b32 s45, 111169536
s_mov_b32 s46, 4
s_mov_b32 s47, 0
s_branch L_op
L_bdie:
s_and_b32 s27, s3, 1
s_lshr_b32 s26, s16, 2
s_lshl_b32 s26, s26, 1
s_and_b32 s24, s16, 1
s_add_u32 s26, s26, s24
s_mov_b32 s4, 0x555f0000
s_mov_b32 s5, 0x55555555
s_bitcmp1_b32 s16, 1
s_cbranch_scc1 L_crew
s_mov_b32 s4, 0xaaa00000
s_mov_b32 s5, 0xaaaaaaaa
s_branch L_crew
L_part:
s_and_b32 s27, s16, 1
s_lshr_b32 s26, s16, 1
s_mov_b32 s4, 0xffff
s_mov_b32 s5, 0x0
L_crew:
s_cmp_eq_u64 s[4:5], 0
s_cbranch_scc1 L_done
s_cmp_lt_u32 s26, 9
s_cbranch_scc1 L_bo
s_mov_b64 s[52:53], s[4:5]
s_sub_u32 s41, s26, 9
s_lshl_b32 s41, s41, 1
s_add_u32 s41, s41, s27
s_mul_i32 s24, s17, 14
s_add_u32 s41, s41, s24
s_mov_b32 s40, 0x3e0293ee
s_mov_b32 s50, 0xf149f2ca
s_mov_b32 s51, 0x41a00000
v_and_b32 v5, 31, v0
v_bfe_u32 v26, v0, 5, 1
v_lshlrev_b32 v27, 2, v26
v_sub_u32 v5, v5, v27
v_bfe_u32 v27, v0, 4, 1
v_lshlrev_b32 v6, 17, v27
v_lshl_add_u32 v6, v26, 8, v6
v_and_b32 v27, 15, v0
v_lshl_add_u32 v6, v27, 4, v6
v_and_b32 v1, 63, v0
v_min_u32 v17, 47, v1
v_lshlrev_b32 v1, 4, v1
v_bfe_u32 v26, v0, 5, 1
v_and_b32 v27, 7, v0
v_xor_b32 v27, v27, v26
v_lshlrev_b32 v27, 4, v27
v_lshl_add_u32 v2, v26, 7, v27
v_xor_b32 v7, 64, v2
v_and_b32 v27, 31, v0
v_lshlrev_b32 v27, 2, v27
v_lshl_add_u32 v3, v26, 8, v27
v_mov_b32 v4, 0
v_lshlrev_b32 v17, 7, v17
v_mul_u32_u24 v26, 24576, v26
v_add_u32 v17, v17, v26
v_add_u32 v17, 111149056, v17
v_bfe_u32 v26, v0, 1, 4
v_and_b32 v27, 1, v0
v_lshl_add_u32 v26, v27, 4, v26
v_and_or_b32 v26, v0, 32, v26
v_lshlrev_b32 v16, 4, v26
v_mov_b32 v31, s50
s_mov_b32 s49, 0
s_mov_b32 s45, -1
v_cmp_le_i32 s[64:65], 0, v5
v_cmp_le_i32 s[66:67], 1, v5
v_cmp_le_i32 s[68:69], 2, v5
v_cmp_le_i32 s[70:71], 3, v5
v_cmp_le_i32 s[72:73], 8, v5
v_cmp_le_i32 s[74:75], 9, v5
v_cmp_le_i32 s[76:77], 10, v5
v_cmp_le_i32 s[78:79], 11, v5
v_cmp_le_i32 s[80:81], 16, v5
v_cmp_le_i32 s[82:83], 17, v5
v_cmp_le_i32 s[84:85], 18, v5
v_cmp_le_i32 s[86:87], 19, v5
v_cmp_le_i32 s[88:89], 24, v5
v_cmp_le_i32 s[90:91], 25, v5
v_cmp_le_i32 s[92:93], 26, v5
v_cmp_le_i32 s[94:95], 27, v5
L_nb_14:
s_ff1_i32_b64 s47, s[52:53]
s_cmp_lt_u32 s41, 32
s_cbranch_scc1 L_nb_15
s_bitset0_b64 s[52:53], s47
s_sub_u32 s41, s41, 32
s_branch L_nb_14
L_nb_15:
s_lshl_b32 s47, s47, 5
s_add_u32 s47, s47, s41
s_add_u32 s41, s41, 56
s_and_b32 s24, s47, 31
s_lshr_b32 s25, s47, 5
s_lshl_b32 s46, s24, 6
s_add_u32 s46, s46, s25
s_lshl_b32 s46, s46, 14
s_add_u32 s46, s46, 33554432
s_lshr_b32 s44, s24, 1
s_lshl_b32 s44, s44, 6
s_add_u32 s44, s44, s25
s_lshl_b32 s44, s44, 1
s_and_b32 s24, s24, 1
s_add_u32 s44, s44, s24
s_lshl_b32 s44, s44, 13
s_add_u32 s44, s44, 134217728
s_cmp_ge_u32 s47, 2048
s_cselect_b32 s44, 536870912, s44
s_cselect_b32 s46, 536870912, s46
s_cbranch_scc1 L_nb_13
s_lshr_b32 s25, s47, 8
s_lshl_b32 s25, s25, 2
s_cmp_eq_u32 s25, s45
s_cbranch_scc1 L_nb_13
s_mov_b32 s45, s25
s_mov_b32 s28, 0
L_poll_16:
buffer_load_dword v26, v17, s[8:11], s45 offen sc1
s_add_u32 s28, s28, 1
s_cmp_gt_u32 s28, 40000
s_cbranch_scc1 L_end
s_waitcnt vmcnt(0)
v_cmp_ne_u32 vcc, 1, v26
s_cbranch_vccz L_pd_17
s_sleep 8
s_branch L_poll_16
L_pd_17:
L_nb_13:
s_cmp_ge_u32 s47, 2048
s_cbranch_scc1 L_bt_x
s_add_u32 s25, s44, 0
buffer_load_dwordx4 a[0:3], v1, s[8:11], s25 offen offset:0 sc1
buffer_load_dwordx4 a[4:7], v1, s[8:11], s25 offen offset:1024 sc1
buffer_load_dwordx4 a[8:11], v1, s[8:11], s25 offen offset:2048 sc1
buffer_load_dwordx4 a[12:15], v1, s[8:11], s25 offen offset:3072 sc1
s_add_u32 s25, s44, 4096
buffer_load_dwordx4 a[16:19], v1, s[8:11], s25 offen offset:0 sc1
buffer_load_dwordx4 a[20:23], v1, s[8:11], s25 offen offset:1024 sc1
buffer_load_dwordx4 a[24:27], v1, s[8:11], s25 offen offset:2048 sc1
buffer_load_dwordx4 a[28:31], v1, s[8:11], s25 offen offset:3072 sc1
s_add_u32 s25, s46, 0
buffer_load_dwordx4 a[32:35], v1, s[8:11], s25 offen offset:0 sc1
buffer_load_dwordx4 a[36:39], v1, s[8:11], s25 offen offset:1024 sc1
buffer_load_dwordx4 a[40:43], v1, s[8:11], s25 offen offset:2048 sc1
buffer_load_dwordx4 a[44:47], v1, s[8:11], s25 offen offset:3072 sc1
s_add_u32 s25, s46, 4096
buffer_load_dwordx4 a[48:51], v1, s[8:11], s25 offen offset:0 sc1
buffer_load_dwordx4 a[52:55], v1, s[8:11], s25 offen offset:1024 sc1
buffer_load_dwordx4 a[56:59], v1, s[8:11], s25 offen offset:2048 sc1
buffer_load_dwordx4 a[60:63], v1, s[8:11], s25 offen offset:3072 sc1
s_add_u32 s25, s46, 8192
buffer_load_dwordx4 a[64:67], v16, s[8:11], s25 offen offset:0 sc1
buffer_load_dwordx4 a[68:71], v16, s[8:11], s25 offen offset:1024 sc1
buffer_load_dwordx4 a[72:75], v16, s[8:11], s25 offen offset:2048 sc1
buffer_load_dwordx4 a[76:79], v16, s[8:11], s25 offen offset:3072 sc1
s_add_u32 s25, s46, 12288
buffer_load_dwordx4 a[80:83], v16, s[8:11], s25 offen offset:0 sc1
buffer_load_dwordx4 a[84:87], v16, s[8:11], s25 offen offset:1024 sc1
buffer_load_dwordx4 a[88:91], v16, s[8:11], s25 offen offset:2048 sc1
buffer_load_dwordx4 a[92:95], v16, s[8:11], s25 offen offset:3072 sc1
s_waitcnt vmcnt(0)
L_bt:
v_mfma_f32_32x32x16_bf16 v[32:47], a[32:35], a[0:3], 0
v_mfma_f32_32x32x16_bf16 v[32:47], a[36:39], a[4:7], v[32:47]
v_mfma_f32_32x32x16_bf16 v[32:47], a[40:43], a[8:11], v[32:47]
v_mfma_f32_32x32x16_bf16 v[32:47], a[44:47], a[12:15], v[32:47]
v_mfma_f32_32x32x16_bf16 v[32:47], a[48:51], a[16:19], v[32:47]
v_mfma_f32_32x32x16_bf16 v[32:47], a[52:55], a[20:23], v[32:47]
v_mfma_f32_32x32x16_bf16 v[32:47], a[56:59], a[24:27], v[32:47]
v_mfma_f32_32x32x16_bf16 v[32:47], a[60:63], a[28:31], v[32:47]
s_and_b32 s42, s47, 31
s_lshr_b32 s43, s47, 5
L_nb_19:
s_ff1_i32_b64 s48, s[52:53]
s_cmp_lt_u32 s41, 32
s_cbranch_scc1 L_nb_20
s_bitset0_b64 s[52:53], s48
s_sub_u32 s41, s41, 32
s_branch L_nb_19
L_nb_20:
s_lshl_b32 s48, s48, 5
s_add_u32 s48, s48, s41
s_add_u32 s41, s41, 56
s_and_b32 s24, s48, 31
s_lshr_b32 s25, s48, 5
s_lshl_b32 s46, s24, 6
s_add_u32 s46, s46, s25
s_lshl_b32 s46, s46, 14
s_add_u32 s46, s46, 33554432
s_lshr_b32 s44, s24, 1
s_lshl_b32 s44, s44, 6
s_add_u32 s44, s44, s25
s_lshl_b32 s44, s44, 1
s_and_b32 s24, s24, 1
s_add_u32 s44, s44, s24
s_lshl_b32 s44, s44, 13
s_add_u32 s44, s44, 134217728
s_cmp_ge_u32 s48, 2048
s_cselect_b32 s44, 536870912, s44
s_cselect_b32 s46, 536870912, s46
s_cbranch_scc1 L_nb_18
s_lshr_b32 s25, s48, 8
s_lshl_b32 s25, s25, 2
s_cmp_eq_u32 s25, s45
s_cbranch_scc1 L_nb_18
s_mov_b32 s45, s25
s_mov_b32 s28, 0
L_poll_21:
buffer_load_dword v26, v17, s[8:11], s45 offen sc1
s_add_u32 s28, s28, 1
s_cmp_gt_u32 s28, 40000
s_cbranch_scc1 L_end
s_waitcnt vmcnt(0)
v_cmp_ne_u32 vcc, 1, v26
s_cbranch_vccz L_pd_22
s_sleep 8
s_branch L_poll_21
L_pd_22:
L_nb_18:
s_add_u32 s25, s44, 0
buffer_load_dwordx4 a[96:99], v1, s[8:11], s25 offen offset:0 sc1
buffer_load_dwordx4 a[100:103], v1, s[8:11], s25 offen offset:1024 sc1
buffer_load_dwordx4 a[104:107], v1, s[8:11], s25 offen offset:2048 sc1
buffer_load_dwordx4 a[108:111], v1, s[8:11], s25 offen offset:3072 sc1
s_add_u32 s25, s44, 4096
buffer_load_dwordx4 a[112:115], v1, s[8:11], s25 offen offset:0 sc1
buffer_load_dwordx4 a[116:119], v1, s[8:11], s25 offen offset:1024 sc1
buffer_load_dwordx4 a[120:123], v1, s[8:11], s25 offen offset:2048 sc1
buffer_load_dwordx4 a[124:127], v1, s[8:11], s25 offen offset:3072 sc1
s_add_u32 s25, s46, 0
buffer_load_dwordx4 a[128:131], v1, s[8:11], s25 offen offset:0 sc1
buffer_load_dwordx4 a[132:135], v1, s[8:11], s25 offen offset:1024 sc1
buffer_load_dwordx4 a[136:139], v1, s[8:11], s25 offen offset:2048 sc1
buffer_load_dwordx4 a[140:143], v1, s[8:11], s25 offen offset:3072 sc1
s_add_u32 s25, s46, 4096
buffer_load_dwordx4 a[144:147], v1, s[8:11], s25 offen offset:0 sc1
buffer_load_dwordx4 a[148:151], v1, s[8:11], s25 offen offset:1024 sc1
buffer_load_dwordx4 a[152:155], v1, s[8:11], s25 offen offset:2048 sc1
buffer_load_dwordx4 a[156:159], v1, s[8:11], s25 offen offset:3072 sc1
s_add_u32 s25, s46, 8192
buffer_load_dwordx4 a[160:163], v16, s[8:11], s25 offen offset:0 sc1
buffer_load_dwordx4 a[164:167], v16, s[8:11], s25 offen offset:1024 sc1
buffer_load_dwordx4 a[168:171], v16, s[8:11], s25 offen offset:2048 sc1
buffer_load_dwordx4 a[172:175], v16, s[8:11], s25 offen offset:3072 sc1
s_add_u32 s25, s46, 12288
buffer_load_dwordx4 a[176:179], v16, s[8:11], s25 offen offset:0 sc1
buffer_load_dwordx4 a[180:183], v16, s[8:11], s25 offen offset:1024 sc1
buffer_load_dwordx4 a[184:187], v16, s[8:11], s25 offen offset:2048 sc1
buffer_load_dwordx4 a[188:191], v16, s[8:11], s25 offen offset:3072 sc1
v_cndmask_b32 v32, v31, v32, s[64:65]
v_cndmask_b32 v33, v31, v33, s[66:67]
v_cndmask_b32 v34, v31, v34, s[68:69]
v_cndmask_b32 v35, v31, v35, s[70:71]
v_cndmask_b32 v36, v31, v36, s[72:73]
v_cndmask_b32 v37, v31, v37, s[74:75]
v_cndmask_b32 v38, v31, v38, s[76:77]
v_cndmask_b32 v39, v31, v39, s[78:79]
v_cndmask_b32 v40, v31, v40, s[80:81]
v_cndmask_b32 v41, v31, v41, s[82:83]
v_cndmask_b32 v42, v31, v42, s[84:85]
v_cndmask_b32 v43, v31, v43, s[86:87]
v_cndmask_b32 v44, v31, v44, s[88:89]
v_cndmask_b32 v45, v31, v45, s[90:91]
v_cndmask_b32 v46, v31, v46, s[92:93]
v_cndmask_b32 v47, v31, v47, s[94:95]
v_max3_f32 v20, v32, v33, v34
v_max3_f32 v20, v20, v35, v36
v_max3_f32 v20, v20, v37, v38
v_max3_f32 v20, v20, v39, v40
v_max3_f32 v20, v20, v41, v42
v_max3_f32 v20, v20, v43, v44
v_max3_f32 v20, v20, v45, v46
v_max_f32 v20, v20, v47
s_lshl_b32 s25, s42, 7
s_add_u32 s25, s25, 111153152
s_lshl_b32 s24, s47, 12
s_add_u32 s24, s24, 100663296
s_cmp_lt_u32 s43, s49
s_cbranch_scc1 L_kn_23
s_mov_b32 s28, 0
L_poll_24:
buffer_load_dword v26, v4, s[8:11], s25 offen sc1
s_add_u32 s28, s28, 1
s_cmp_gt_u32 s28, 40000
s_cbranch_scc1 L_end
s_waitcnt vmcnt(0)
v_cmp_ge_u32 vcc, s43, v26
s_cbranch_vccz L_pd_25
s_sleep 1
s_branch L_poll_24
L_pd_25:
v_readfirstlane_b32 s49, v26
s_nop 0
s_min_u32 s49, s49, 63
s_sub_u32 s49, s49, 1
L_kn_23:
buffer_load_dwordx4 v[96:99], v2, s[8:11], s24 offen offset:0 sc1
buffer_load_dwordx4 v[100:103], v7, s[8:11], s24 offen offset:256 sc1
buffer_load_dwordx4 v[104:107], v2, s[8:11], s24 offen offset:512 sc1
buffer_load_dwordx4 v[108:111], v7, s[8:11], s24 offen offset:768 sc1
buffer_load_dwordx4 v[112:115], v2, s[8:11], s24 offen offset:1024 sc1
buffer_load_dwordx4 v[116:119], v7, s[8:11], s24 offen offset:1280 sc1
buffer_load_dwordx4 v[120:123], v2, s[8:11], s24 offen offset:1536 sc1
buffer_load_dwordx4 v[124:127], v7, s[8:11], s24 offen offset:1792 sc1
buffer_load_dword v8, v3, s[8:11], s24 offen offset:2048 sc1
buffer_load_dword v9, v3, s[8:11], s24 offen offset:2176 sc1
buffer_load_dword v10, v3, s[8:11], s24 offen offset:2560 sc1
buffer_load_dword v11, v3, s[8:11], s24 offen offset:2688 sc1
buffer_load_dword v12, v3, s[8:11], s24 offen offset:3072 sc1
buffer_load_dword v13, v3, s[8:11], s24 offen offset:3200 sc1
buffer_load_dword v14, v3, s[8:11], s24 offen offset:3584 sc1
buffer_load_dword v15, v3, s[8:11], s24 offen offset:3712 sc1
s_waitcnt vmcnt(15)
v_mfma_f32_32x32x16_bf16 v[64:79], v[96:99], a[0:3], 0
s_waitcnt vmcnt(14)
v_mfma_f32_32x32x16_bf16 v[64:79], v[100:103], a[4:7], v[64:79]
s_waitcnt vmcnt(13)
v_mfma_f32_32x32x16_bf16 v[64:79], v[104:107], a[8:11], v[64:79]
s_waitcnt vmcnt(12)
v_mfma_f32_32x32x16_bf16 v[64:79], v[108:111], a[12:15], v[64:79]
s_waitcnt vmcnt(11)
v_mfma_f32_32x32x16_bf16 v[64:79], v[112:115], a[16:19], v[64:79]
s_waitcnt vmcnt(10)
v_mfma_f32_32x32x16_bf16 v[64:79], v[116:119], a[20:23], v[64:79]
s_waitcnt vmcnt(9)
v_mfma_f32_32x32x16_bf16 v[64:79], v[120:123], a[24:27], v[64:79]
s_waitcnt vmcnt(8)
v_mfma_f32_32x32x16_bf16 v[64:79], v[124:127], a[28:31], v[64:79]
s_nop 11
v_max3_f32 v20, v20, v64, v65
v_max3_f32 v20, v20, v66, v67
v_mov_b32 v26, v20
s_nop 1
v_permlane32_swap_b32 v26, v20
v_max_f32 v20, v20, v26
v_mul_f32 v20, s40, v20
v_fma_f32 v64, v64, s40, -v20
v_fma_f32 v65, v65, s40, -v20
v_fma_f32 v66, v66, s40, -v20
v_fma_f32 v67, v67, s40, -v20
v_fma_f32 v32, v32, s40, -v20
v_fma_f32 v33, v33, s40, -v20
v_fma_f32 v34, v34, s40, -v20
v_fma_f32 v35, v35, s40, -v20
v_fma_f32 v36, v36, s40, -v20
v_fma_f32 v37, v37, s40, -v20
v_fma_f32 v38, v38, s40, -v20
v_fma_f32 v39, v39, s40, -v20
v_fma_f32 v40, v40, s40, -v20
v_fma_f32 v41, v41, s40, -v20
v_fma_f32 v42, v42, s40, -v20
v_fma_f32 v43, v43, s40, -v20
v_fma_f32 v44, v44, s40, -v20
v_fma_f32 v45, v45, s40, -v20
v_fma_f32 v46, v46, s40, -v20
v_fma_f32 v47, v47, s40, -v20
v_exp_f32 v64, v64
v_exp_f32 v65, v65
v_exp_f32 v66, v66
v_exp_f32 v67, v67
v_exp_f32 v32, v32
v_exp_f32 v33, v33
v_exp_f32 v34, v34
v_exp_f32 v35, v35
v_exp_f32 v36, v36
v_exp_f32 v37, v37
v_exp_f32 v38, v38
v_exp_f32 v39, v39
v_exp_f32 v40, v40
v_exp_f32 v41, v41
v_exp_f32 v42, v42
v_exp_f32 v43, v43
v_exp_f32 v44, v44
v_exp_f32 v45, v45
v_exp_f32 v46, v46
v_exp_f32 v47, v47
v_cvt_pk_bf16_f32 v88, v64, v65
v_cvt_pk_bf16_f32 v89, v66, v67
v_cvt_pk_bf16_f32 v80, v32, v33
v_cvt_pk_bf16_f32 v81, v34, v35
v_cvt_pk_bf16_f32 v82, v36, v37
v_cvt_pk_bf16_f32 v83, v38, v39
v_cvt_pk_bf16_f32 v84, v40, v41
v_cvt_pk_bf16_f32 v85, v42, v43
v_cvt_pk_bf16_f32 v86, v44, v45
v_cvt_pk_bf16_f32 v87, v46, v47
s_waitcnt vmcnt(0)
v_mfma_f32_32x32x8_bf16 v[128:143], v[8:9], v[88:89], 0
v_add_f32 v22, v64, v65
v_add_f32 v22, v22, v66
v_mfma_f32_32x32x16_bf16 v[128:143], a[64:67], v[80:83], v[128:143]
v_add_f32 v22, v22, v67
v_add_f32 v22, v22, v32
v_add_f32 v22, v22, v33
v_mfma_f32_32x32x16_bf16 v[128:143], a[68:71], v[84:87], v[128:143]
v_add_f32 v22, v22, v34
v_add_f32 v22, v22, v35
v_mfma_f32_32x32x8_bf16 v[160:175], v[10:11], v[88:89], 0
v_add_f32 v22, v22, v36
v_add_f32 v22, v22, v37
v_add_f32 v22, v22, v38
v_mfma_f32_32x32x16_bf16 v[160:175], a[72:75], v[80:83], v[160:175]
v_add_f32 v22, v22, v39
v_add_f32 v22, v22, v40
v_mfma_f32_32x32x16_bf16 v[160:175], a[76:79], v[84:87], v[160:175]
v_add_f32 v22, v22, v41
v_add_f32 v22, v22, v42
v_mfma_f32_32x32x8_bf16 v[192:207], v[12:13], v[88:89], 0
v_add_f32 v22, v22, v43
v_add_f32 v22, v22, v44
v_add_f32 v22, v22, v45
v_mfma_f32_32x32x16_bf16 v[192:207], a[80:83], v[80:83], v[192:207]
v_add_f32 v22, v22, v46
v_add_f32 v22, v22, v47
v_mfma_f32_32x32x16_bf16 v[192:207], a[84:87], v[84:87], v[192:207]
v_mfma_f32_32x32x8_bf16 v[224:239], v[14:15], v[88:89], 0
v_mfma_f32_32x32x16_bf16 v[224:239], a[88:91], v[80:83], v[224:239]
v_mfma_f32_32x32x16_bf16 v[224:239], a[92:95], v[84:87], v[224:239]
s_lshl_b32 s26, s43, 18
s_lshl_b32 s27, s42, 12
s_add_u32 s26, s26, s27
s_add_u32 s26, s26, 83886080
v_mov_b32 v26, v22
s_nop 1
v_permlane32_swap_b32 v26, v22
v_add_f32 v26, v26, v22
v_rcp_f32 v26, v26
s_nop 0
v_pk_mul_f32 v[128:129], v[128:129], v[26:27] op_sel_hi:[1,0]
v_pk_mul_f32 v[130:131], v[130:131], v[26:27] op_sel_hi:[1,0]
v_pk_mul_f32 v[132:133], v[132:133], v[26:27] op_sel_hi:[1,0]
v_pk_mul_f32 v[134:135], v[134:135], v[26:27] op_sel_hi:[1,0]
v_pk_mul_f32 v[136:137], v[136:137], v[26:27] op_sel_hi:[1,0]
v_pk_mul_f32 v[138:139], v[138:139], v[26:27] op_sel_hi:[1,0]
v_pk_mul_f32 v[140:141], v[140:141], v[26:27] op_sel_hi:[1,0]
v_pk_mul_f32 v[142:143], v[142:143], v[26:27] op_sel_hi:[1,0]
v_cvt_pk_bf16_f32 v128, v128, v129
v_cvt_pk_bf16_f32 v129, v130, v131
v_cvt_pk_bf16_f32 v130, v132, v133
v_cvt_pk_bf16_f32 v131, v134, v135
buffer_store_dwordx4 v[128:131], v6, s[8:11], s26 offen offset:0 sc1
v_cvt_pk_bf16_f32 v136, v136, v137
v_cvt_pk_bf16_f32 v137, v138, v139
v_cvt_pk_bf16_f32 v138, v140, v141
v_cvt_pk_bf16_f32 v139, v142, v143
buffer_store_dwordx4 v[136:139], v6, s[8:11], s26 offen offset:512 sc1
v_pk_mul_f32 v[160:161], v[160:161], v[26:27] op_sel_hi:[1,0]
v_pk_mul_f32 v[162:163], v[162:163], v[26:27] op_sel_hi:[1,0]
v_pk_mul_f32 v[164:165], v[164:165], v[26:27] op_sel_hi:[1,0]
v_pk_mul_f32 v[166:167], v[166:167], v[26:27] op_sel_hi:[1,0]
v_pk_mul_f32 v[168:169], v[168:169], v[26:27] op_sel_hi:[1,0]
v_pk_mul_f32 v[170:171], v[170:171], v[26:27] op_sel_hi:[1,0]
v_pk_mul_f32 v[172:173], v[172:173], v[26:27] op_sel_hi:[1,0]
v_pk_mul_f32 v[174:175], v[174:175], v[26:27] op_sel_hi:[1,0]
v_cvt_pk_bf16_f32 v160, v160, v161
v_cvt_pk_bf16_f32 v161, v162, v163
v_cvt_pk_bf16_f32 v162, v164, v165
v_cvt_pk_bf16_f32 v163, v166, v167
buffer_store_dwordx4 v[160:163], v6, s[8:11], s26 offen offset:1024 sc1
v_cvt_pk_bf16_f32 v168, v168, v169
v_cvt_pk_bf16_f32 v169, v170, v171
v_cvt_pk_bf16_f32 v170, v172, v173
v_cvt_pk_bf16_f32 v171, v174, v175
buffer_store_dwordx4 v[168:171], v6, s[8:11], s26 offen offset:1536 sc1
v_pk_mul_f32 v[192:193], v[192:193], v[26:27] op_sel_hi:[1,0]
v_pk_mul_f32 v[194:195], v[194:195], v[26:27] op_sel_hi:[1,0]
v_pk_mul_f32 v[196:197], v[196:197], v[26:27] op_sel_hi:[1,0]
v_pk_mul_f32 v[198:199], v[198:199], v[26:27] op_sel_hi:[1,0]
v_pk_mul_f32 v[200:201], v[200:201], v[26:27] op_sel_hi:[1,0]
v_pk_mul_f32 v[202:203], v[202:203], v[26:27] op_sel_hi:[1,0]
v_pk_mul_f32 v[204:205], v[204:205], v[26:27] op_sel_hi:[1,0]
v_pk_mul_f32 v[206:207], v[206:207], v[26:27] op_sel_hi:[1,0]
v_cvt_pk_bf16_f32 v192, v192, v193
v_cvt_pk_bf16_f32 v193, v194, v195
v_cvt_pk_bf16_f32 v194, v196, v197
v_cvt_pk_bf16_f32 v195, v198, v199
buffer_store_dwordx4 v[192:195], v6, s[8:11], s26 offen offset:2048 sc1
v_cvt_pk_bf16_f32 v200, v200, v201
v_cvt_pk_bf16_f32 v201, v202, v203
v_cvt_pk_bf16_f32 v202, v204, v205
v_cvt_pk_bf16_f32 v203, v206, v207
buffer_store_dwordx4 v[200:203], v6, s[8:11], s26 offen offset:2560 sc1
v_pk_mul_f32 v[224:225], v[224:225], v[26:27] op_sel_hi:[1,0]
v_pk_mul_f32 v[226:227], v[226:227], v[26:27] op_sel_hi:[1,0]
v_pk_mul_f32 v[228:229], v[228:229], v[26:27] op_sel_hi:[1,0]
v_pk_mul_f32 v[230:231], v[230:231], v[26:27] op_sel_hi:[1,0]
v_pk_mul_f32 v[232:233], v[232:233], v[26:27] op_sel_hi:[1,0]
v_pk_mul_f32 v[234:235], v[234:235], v[26:27] op_sel_hi:[1,0]
v_pk_mul_f32 v[236:237], v[236:237], v[26:27] op_sel_hi:[1,0]
v_pk_mul_f32 v[238:239], v[238:239], v[26:27] op_sel_hi:[1,0]
v_cvt_pk_bf16_f32 v224, v224, v225
v_cvt_pk_bf16_f32 v225, v226, v227
v_cvt_pk_bf16_f32 v226, v228, v229
v_cvt_pk_bf16_f32 v227, v230, v231
buffer_store_dwordx4 v[224:227], v6, s[8:11], s26 offen offset:3072 sc1
v_cvt_pk_bf16_f32 v232, v232, v233
v_cvt_pk_bf16_f32 v233, v234, v235
v_cvt_pk_bf16_f32 v234, v236, v237
v_cvt_pk_bf16_f32 v235, v238, v239
buffer_store_dwordx4 v[232:235], v6, s[8:11], s26 offen offset:3584 sc1
s_lshl_b32 s26, s47, 2
s_add_u32 s26, s26, 111157248
v_mov_b32 v26, 1
s_waitcnt vmcnt(0)
s_mov_b64 exec, 1
buffer_store_dword v26, v4, s[8:11], s26 offen sc1
s_mov_b64 exec, -1
s_mov_b32 s47, s48
s_cmp_lt_u32 s47, 2048
s_cbranch_scc0 L_bt_x
v_mfma_f32_32x32x16_bf16 v[32:47], a[128:131], a[96:99], 0
v_mfma_f32_32x32x16_bf16 v[32:47], a[132:135], a[100:103], v[32:47]
v_mfma_f32_32x32x16_bf16 v[32:47], a[136:139], a[104:107], v[32:47]
v_mfma_f32_32x32x16_bf16 v[32:47], a[140:143], a[108:111], v[32:47]
v_mfma_f32_32x32x16_bf16 v[32:47], a[144:147], a[112:115], v[32:47]
v_mfma_f32_32x32x16_bf16 v[32:47], a[148:151], a[116:119], v[32:47]
v_mfma_f32_32x32x16_bf16 v[32:47], a[152:155], a[120:123], v[32:47]
v_mfma_f32_32x32x16_bf16 v[32:47], a[156:159], a[124:127], v[32:47]
s_and_b32 s42, s47, 31
s_lshr_b32 s43, s47, 5
L_nb_27:
s_ff1_i32_b64 s48, s[52:53]
s_cmp_lt_u32 s41, 32
s_cbranch_scc1 L_nb_28
s_bitset0_b64 s[52:53], s48
s_sub_u32 s41, s41, 32
s_branch L_nb_27
L_nb_28:
s_lshl_b32 s48, s48, 5
s_add_u32 s48, s48, s41
s_add_u32 s41, s41, 56
s_and_b32 s24, s48, 31
s_lshr_b32 s25, s48, 5
s_lshl_b32 s46, s24, 6
s_add_u32 s46, s46, s25
s_lshl_b32 s46, s46, 14
s_add_u32 s46, s46, 33554432
s_lshr_b32 s44, s24, 1
s_lshl_b32 s44, s44, 6
s_add_u32 s44, s44, s25
s_lshl_b32 s44, s44, 1
s_and_b32 s24, s24, 1
s_add_u32 s44, s44, s24
s_lshl_b32 s44, s44, 13
s_add_u32 s44, s44, 134217728
s_cmp_ge_u32 s48, 2048
s_cselect_b32 s44, 536870912, s44
s_cselect_b32 s46, 536870912, s46
s_cbranch_scc1 L_nb_26
s_lshr_b32 s25, s48, 8
s_lshl_b32 s25, s25, 2
s_cmp_eq_u32 s25, s45
s_cbranch_scc1 L_nb_26
s_mov_b32 s45, s25
s_mov_b32 s28, 0
L_poll_29:
buffer_load_dword v26, v17, s[8:11], s45 offen sc1
s_add_u32 s28, s28, 1
s_cmp_gt_u32 s28, 40000
s_cbranch_scc1 L_end
s_waitcnt vmcnt(0)
v_cmp_ne_u32 vcc, 1, v26
s_cbranch_vccz L_pd_30
s_sleep 8
s_branch L_poll_29
L_pd_30:
L_nb_26:
s_add_u32 s25, s44, 0
buffer_load_dwordx4 a[0:3], v1, s[8:11], s25 offen offset:0 sc1
buffer_load_dwordx4 a[4:7], v1, s[8:11], s25 offen offset:1024 sc1
buffer_load_dwordx4 a[8:11], v1, s[8:11], s25 offen offset:2048 sc1
buffer_load_dwordx4 a[12:15], v1, s[8:11], s25 offen offset:3072 sc1
s_add_u32 s25, s44, 4096
buffer_load_dwordx4 a[16:19], v1, s[8:11], s25 offen offset:0 sc1
buffer_load_dwordx4 a[20:23], v1, s[8:11], s25 offen offset:1024 sc1
buffer_load_dwordx4 a[24:27], v1, s[8:11], s25 offen offset:2048 sc1
buffer_load_dwordx4 a[28:31], v1, s[8:11], s25 offen offset:3072 sc1
s_add_u32 s25, s46, 0
buffer_load_dwordx4 a[32:35], v1, s[8:11], s25 offen offset:0 sc1
buffer_load_dwordx4 a[36:39], v1, s[8:11], s25 offen offset:1024 sc1
buffer_load_dwordx4 a[40:43], v1, s[8:11], s25 offen offset:2048 sc1
buffer_load_dwordx4 a[44:47], v1, s[8:11], s25 offen offset:3072 sc1
s_add_u32 s25, s46, 4096
buffer_load_dwordx4 a[48:51], v1, s[8:11], s25 offen offset:0 sc1
buffer_load_dwordx4 a[52:55], v1, s[8:11], s25 offen offset:1024 sc1
buffer_load_dwordx4 a[56:59], v1, s[8:11], s25 offen offset:2048 sc1
buffer_load_dwordx4 a[60:63], v1, s[8:11], s25 offen offset:3072 sc1
s_add_u32 s25, s46, 8192
buffer_load_dwordx4 a[64:67], v16, s[8:11], s25 offen offset:0 sc1
buffer_load_dwordx4 a[68:71], v16, s[8:11], s25 offen offset:1024 sc1
buffer_load_dwordx4 a[72:75], v16, s[8:11], s25 offen offset:2048 sc1
buffer_load_dwordx4 a[76:79], v16, s[8:11], s25 offen offset:3072 sc1
s_add_u32 s25, s46, 12288
buffer_load_dwordx4 a[80:83], v16, s[8:11], s25 offen offset:0 sc1
buffer_load_dwordx4 a[84:87], v16, s[8:11], s25 offen offset:1024 sc1
buffer_load_dwordx4 a[88:91], v16, s[8:11], s25 offen offset:2048 sc1
buffer_load_dwordx4 a[92:95], v16, s[8:11], s25 offen offset:3072 sc1
v_cndmask_b32 v32, v31, v32, s[64:65]
v_cndmask_b32 v33, v31, v33, s[66:67]
v_cndmask_b32 v34, v31, v34, s[68:69]
v_cndmask_b32 v35, v31, v35, s[70:71]
v_cndmask_b32 v36, v31, v36, s[72:73]
v_cndmask_b32 v37, v31, v37, s[74:75]
v_cndmask_b32 v38, v31, v38, s[76:77]
v_cndmask_b32 v39, v31, v39, s[78:79]
v_cndmask_b32 v40, v31, v40, s[80:81]
v_cndmask_b32 v41, v31, v41, s[82:83]
v_cndmask_b32 v42, v31, v42, s[84:85]
v_cndmask_b32 v43, v31, v43, s[86:87]
v_cndmask_b32 v44, v31, v44, s[88:89]
v_cndmask_b32 v45, v31, v45, s[90:91]
v_cndmask_b32 v46, v31, v46, s[92:93]
v_cndmask_b32 v47, v31, v47, s[94:95]
v_max3_f32 v20, v32, v33, v34
v_max3_f32 v20, v20, v35, v36
v_max3_f32 v20, v20, v37, v38
v_max3_f32 v20, v20, v39, v40
v_max3_f32 v20, v20, v41, v42
v_max3_f32 v20, v20, v43, v44
v_max3_f32 v20, v20, v45, v46
v_max_f32 v20, v20, v47
s_lshl_b32 s25, s42, 7
s_add_u32 s25, s25, 111153152
s_lshl_b32 s24, s47, 12
s_add_u32 s24, s24, 100663296
s_cmp_lt_u32 s43, s49
s_cbranch_scc1 L_kn_31
s_mov_b32 s28, 0
L_poll_32:
buffer_load_dword v26, v4, s[8:11], s25 offen sc1
s_add_u32 s28, s28, 1
s_cmp_gt_u32 s28, 40000
s_cbranch_scc1 L_end
s_waitcnt vmcnt(0)
v_cmp_ge_u32 vcc, s43, v26
s_cbranch_vccz L_pd_33
s_sleep 1
s_branch L_poll_32
L_pd_33:
v_readfirstlane_b32 s49, v26
s_nop 0
s_min_u32 s49, s49, 63
s_sub_u32 s49, s49, 1
L_kn_31:
buffer_load_dwordx4 v[96:99], v2, s[8:11], s24 offen offset:0 sc1
buffer_load_dwordx4 v[100:103], v7, s[8:11], s24 offen offset:256 sc1
buffer_load_dwordx4 v[104:107], v2, s[8:11], s24 offen offset:512 sc1
buffer_load_dwordx4 v[108:111], v7, s[8:11], s24 offen offset:768 sc1
buffer_load_dwordx4 v[112:115], v2, s[8:11], s24 offen offset:1024 sc1
buffer_load_dwordx4 v[116:119], v7, s[8:11], s24 offen offset:1280 sc1
buffer_load_dwordx4 v[120:123], v2, s[8:11], s24 offen offset:1536 sc1
buffer_load_dwordx4 v[124:127], v7, s[8:11], s24 offen offset:1792 sc1
buffer_load_dword v8, v3, s[8:11], s24 offen offset:2048 sc1
buffer_load_dword v9, v3, s[8:11], s24 offen offset:2176 sc1
buffer_load_dword v10, v3, s[8:11], s24 offen offset:2560 sc1
buffer_load_dword v11, v3, s[8:11], s24 offen offset:2688 sc1
buffer_load_dword v12, v3, s[8:11], s24 offen offset:3072 sc1
buffer_load_dword v13, v3, s[8:11], s24 offen offset:3200 sc1
buffer_load_dword v14, v3, s[8:11], s24 offen offset:3584 sc1
buffer_load_dword v15, v3, s[8:11], s24 offen offset:3712 sc1
s_waitcnt vmcnt(15)
v_mfma_f32_32x32x16_bf16 v[64:79], v[96:99], a[96:99], 0
s_waitcnt vmcnt(14)
v_mfma_f32_32x32x16_bf16 v[64:79], v[100:103], a[100:103], v[64:79]
s_waitcnt vmcnt(13)
v_mfma_f32_32x32x16_bf16 v[64:79], v[104:107], a[104:107], v[64:79]
s_waitcnt vmcnt(12)
v_mfma_f32_32x32x16_bf16 v[64:79], v[108:111], a[108:111], v[64:79]
s_waitcnt vmcnt(11)
v_mfma_f32_32x32x16_bf16 v[64:79], v[112:115], a[112:115], v[64:79]
s_waitcnt vmcnt(10)
v_mfma_f32_32x32x16_bf16 v[64:79], v[116:119], a[116:119], v[64:79]
s_waitcnt vmcnt(9)
v_mfma_f32_32x32x16_bf16 v[64:79], v[120:123], a[120:123], v[64:79]
s_waitcnt vmcnt(8)
v_mfma_f32_32x32x16_bf16 v[64:79], v[124:127], a[124:127], v[64:79]
s_nop 11
v_max3_f32 v20, v20, v64, v65
v_max3_f32 v20, v20, v66, v67
v_mov_b32 v26, v20
s_nop 1
v_permlane32_swap_b32 v26, v20
v_max_f32 v20, v20, v26
v_mul_f32 v20, s40, v20
v_fma_f32 v64, v64, s40, -v20
v_fma_f32 v65, v65, s40, -v20
v_fma_f32 v66, v66, s40, -v20
v_fma_f32 v67, v67, s40, -v20
v_fma_f32 v32, v32, s40, -v20
v_fma_f32 v33, v33, s40, -v20
v_fma_f32 v34, v34, s40, -v20
v_fma_f32 v35, v35, s40, -v20
v_fma_f32 v36, v36, s40, -v20
v_fma_f32 v37, v37, s40, -v20
v_fma_f32 v38, v38, s40, -v20
v_fma_f32 v39, v39, s40, -v20
v_fma_f32 v40, v40, s40, -v20
v_fma_f32 v41, v41, s40, -v20
v_fma_f32 v42, v42, s40, -v20
v_fma_f32 v43, v43, s40, -v20
v_fma_f32 v44, v44, s40, -v20
v_fma_f32 v45, v45, s40, -v20
v_fma_f32 v46, v46, s40, -v20
v_fma_f32 v47, v47, s40, -v20
v_exp_f32 v64, v64
v_exp_f32 v65, v65
v_exp_f32 v66, v66
v_exp_f32 v67, v67
v_exp_f32 v32, v32
v_exp_f32 v33, v33
v_exp_f32 v34, v34
v_exp_f32 v35, v35
v_exp_f32 v36, v36
v_exp_f32 v37, v37
v_exp_f32 v38, v38
v_exp_f32 v39, v39
v_exp_f32 v40, v40
v_exp_f32 v41, v41
v_exp_f32 v42, v42
v_exp_f32 v43, v43
v_exp_f32 v44, v44
v_exp_f32 v45, v45
v_exp_f32 v46, v46
v_exp_f32 v47, v47
v_cvt_pk_bf16_f32 v88, v64, v65
v_cvt_pk_bf16_f32 v89, v66, v67
v_cvt_pk_bf16_f32 v80, v32, v33
v_cvt_pk_bf16_f32 v81, v34, v35
v_cvt_pk_bf16_f32 v82, v36, v37
v_cvt_pk_bf16_f32 v83, v38, v39
v_cvt_pk_bf16_f32 v84, v40, v41
v_cvt_pk_bf16_f32 v85, v42, v43
v_cvt_pk_bf16_f32 v86, v44, v45
v_cvt_pk_bf16_f32 v87, v46, v47
s_waitcnt vmcnt(0)
v_mfma_f32_32x32x8_bf16 v[128:143], v[8:9], v[88:89], 0
v_add_f32 v22, v64, v65
v_add_f32 v22, v22, v66
v_mfma_f32_32x32x16_bf16 v[128:143], a[160:163], v[80:83], v[128:143]
v_add_f32 v22, v22, v67
v_add_f32 v22, v22, v32
v_add_f32 v22, v22, v33
v_mfma_f32_32x32x16_bf16 v[128:143], a[164:167], v[84:87], v[128:143]
v_add_f32 v22, v22, v34
v_add_f32 v22, v22, v35
v_mfma_f32_32x32x8_bf16 v[160:175], v[10:11], v[88:89], 0
v_add_f32 v22, v22, v36
v_add_f32 v22, v22, v37
v_add_f32 v22, v22, v38
v_mfma_f32_32x32x16_bf16 v[160:175], a[168:171], v[80:83], v[160:175]
v_add_f32 v22, v22, v39
v_add_f32 v22, v22, v40
v_mfma_f32_32x32x16_bf16 v[160:175], a[172:175], v[84:87], v[160:175]
v_add_f32 v22, v22, v41
v_add_f32 v22, v22, v42
v_mfma_f32_32x32x8_bf16 v[192:207], v[12:13], v[88:89], 0
v_add_f32 v22, v22, v43
v_add_f32 v22, v22, v44
v_add_f32 v22, v22, v45
v_mfma_f32_32x32x16_bf16 v[192:207], a[176:179], v[80:83], v[192:207]
v_add_f32 v22, v22, v46
v_add_f32 v22, v22, v47
v_mfma_f32_32x32x16_bf16 v[192:207], a[180:183], v[84:87], v[192:207]
v_mfma_f32_32x32x8_bf16 v[224:239], v[14:15], v[88:89], 0
v_mfma_f32_32x32x16_bf16 v[224:239], a[184:187], v[80:83], v[224:239]
v_mfma_f32_32x32x16_bf16 v[224:239], a[188:191], v[84:87], v[224:239]
s_lshl_b32 s26, s43, 18
s_lshl_b32 s27, s42, 12
s_add_u32 s26, s26, s27
s_add_u32 s26, s26, 83886080
v_mov_b32 v26, v22
s_nop 1
v_permlane32_swap_b32 v26, v22
v_add_f32 v26, v26, v22
v_rcp_f32 v26, v26
s_nop 0
v_pk_mul_f32 v[128:129], v[128:129], v[26:27] op_sel_hi:[1,0]
v_pk_mul_f32 v[130:131], v[130:131], v[26:27] op_sel_hi:[1,0]
v_pk_mul_f32 v[132:133], v[132:133], v[26:27] op_sel_hi:[1,0]
v_pk_mul_f32 v[134:135], v[134:135], v[26:27] op_sel_hi:[1,0]
v_pk_mul_f32 v[136:137], v[136:137], v[26:27] op_sel_hi:[1,0]
v_pk_mul_f32 v[138:139], v[138:139], v[26:27] op_sel_hi:[1,0]
v_pk_mul_f32 v[140:141], v[140:141], v[26:27] op_sel_hi:[1,0]
v_pk_mul_f32 v[142:143], v[142:143], v[26:27] op_sel_hi:[1,0]
v_cvt_pk_bf16_f32 v128, v128, v129
v_cvt_pk_bf16_f32 v129, v130, v131
v_cvt_pk_bf16_f32 v130, v132, v133
v_cvt_pk_bf16_f32 v131, v134, v135
buffer_store_dwordx4 v[128:131], v6, s[8:11], s26 offen offset:0 sc1
v_cvt_pk_bf16_f32 v136, v136, v137
v_cvt_pk_bf16_f32 v137, v138, v139
v_cvt_pk_bf16_f32 v138, v140, v141
v_cvt_pk_bf16_f32 v139, v142, v143
buffer_store_dwordx4 v[136:139], v6, s[8:11], s26 offen offset:512 sc1
v_pk_mul_f32 v[160:161], v[160:161], v[26:27] op_sel_hi:[1,0]
v_pk_mul_f32 v[162:163], v[162:163], v[26:27] op_sel_hi:[1,0]
v_pk_mul_f32 v[164:165], v[164:165], v[26:27] op_sel_hi:[1,0]
v_pk_mul_f32 v[166:167], v[166:167], v[26:27] op_sel_hi:[1,0]
v_pk_mul_f32 v[168:169], v[168:169], v[26:27] op_sel_hi:[1,0]
v_pk_mul_f32 v[170:171], v[170:171], v[26:27] op_sel_hi:[1,0]
v_pk_mul_f32 v[172:173], v[172:173], v[26:27] op_sel_hi:[1,0]
v_pk_mul_f32 v[174:175], v[174:175], v[26:27] op_sel_hi:[1,0]
v_cvt_pk_bf16_f32 v160, v160, v161
v_cvt_pk_bf16_f32 v161, v162, v163
v_cvt_pk_bf16_f32 v162, v164, v165
v_cvt_pk_bf16_f32 v163, v166, v167
buffer_store_dwordx4 v[160:163], v6, s[8:11], s26 offen offset:1024 sc1
v_cvt_pk_bf16_f32 v168, v168, v169
v_cvt_pk_bf16_f32 v169, v170, v171
v_cvt_pk_bf16_f32 v170, v172, v173
v_cvt_pk_bf16_f32 v171, v174, v175
buffer_store_dwordx4 v[168:171], v6, s[8:11], s26 offen offset:1536 sc1
v_pk_mul_f32 v[192:193], v[192:193], v[26:27] op_sel_hi:[1,0]
v_pk_mul_f32 v[194:195], v[194:195], v[26:27] op_sel_hi:[1,0]
v_pk_mul_f32 v[196:197], v[196:197], v[26:27] op_sel_hi:[1,0]
v_pk_mul_f32 v[198:199], v[198:199], v[26:27] op_sel_hi:[1,0]
v_pk_mul_f32 v[200:201], v[200:201], v[26:27] op_sel_hi:[1,0]
v_pk_mul_f32 v[202:203], v[202:203], v[26:27] op_sel_hi:[1,0]
v_pk_mul_f32 v[204:205], v[204:205], v[26:27] op_sel_hi:[1,0]
v_pk_mul_f32 v[206:207], v[206:207], v[26:27] op_sel_hi:[1,0]
v_cvt_pk_bf16_f32 v192, v192, v193
v_cvt_pk_bf16_f32 v193, v194, v195
v_cvt_pk_bf16_f32 v194, v196, v197
v_cvt_pk_bf16_f32 v195, v198, v199
buffer_store_dwordx4 v[192:195], v6, s[8:11], s26 offen offset:2048 sc1
v_cvt_pk_bf16_f32 v200, v200, v201
v_cvt_pk_bf16_f32 v201, v202, v203
v_cvt_pk_bf16_f32 v202, v204, v205
v_cvt_pk_bf16_f32 v203, v206, v207
buffer_store_dwordx4 v[200:203], v6, s[8:11], s26 offen offset:2560 sc1
v_pk_mul_f32 v[224:225], v[224:225], v[26:27] op_sel_hi:[1,0]
v_pk_mul_f32 v[226:227], v[226:227], v[26:27] op_sel_hi:[1,0]
v_pk_mul_f32 v[228:229], v[228:229], v[26:27] op_sel_hi:[1,0]
v_pk_mul_f32 v[230:231], v[230:231], v[26:27] op_sel_hi:[1,0]
v_pk_mul_f32 v[232:233], v[232:233], v[26:27] op_sel_hi:[1,0]
v_pk_mul_f32 v[234:235], v[234:235], v[26:27] op_sel_hi:[1,0]
v_pk_mul_f32 v[236:237], v[236:237], v[26:27] op_sel_hi:[1,0]
v_pk_mul_f32 v[238:239], v[238:239], v[26:27] op_sel_hi:[1,0]
v_cvt_pk_bf16_f32 v224, v224, v225
v_cvt_pk_bf16_f32 v225, v226, v227
v_cvt_pk_bf16_f32 v226, v228, v229
v_cvt_pk_bf16_f32 v227, v230, v231
buffer_store_dwordx4 v[224:227], v6, s[8:11], s26 offen offset:3072 sc1
v_cvt_pk_bf16_f32 v232, v232, v233
v_cvt_pk_bf16_f32 v233, v234, v235
v_cvt_pk_bf16_f32 v234, v236, v237
v_cvt_pk_bf16_f32 v235, v238, v239
buffer_store_dwordx4 v[232:235], v6, s[8:11], s26 offen offset:3584 sc1
s_lshl_b32 s26, s47, 2
s_add_u32 s26, s26, 111157248
v_mov_b32 v26, 1
s_waitcnt vmcnt(0)
s_mov_b64 exec, 1
buffer_store_dword v26, v4, s[8:11], s26 offen sc1
s_mov_b64 exec, -1
s_mov_b32 s47, s48
s_cmp_lt_u32 s47, 2048
s_cbranch_scc1 L_bt
L_bt_x:
s_branch L_done
L_bo:
s_mov_b64 s[42:43], s[4:5]
s_mov_b32 s51, s27
s_mov_b32 s40, s26
s_mov_b32 s44, 83886080
s_mov_b32 s45, 111157248
s_mov_b32 s46, 1
s_mov_b32 s47, 1152
s_load_dwordx2 s[4:5], s[0:1], 88
s_waitcnt lgkmcnt(0)
s_mov_b32 s20, s4
s_and_b32 s21, s5, 0xffff
s_mov_b32 s22, 4718592
s_mov_b32 s23, 0x20000
L_op:
s_load_dwordx2 s[4:5], s[0:1], 104
s_waitcnt lgkmcnt(0)
s_mov_b32 s12, s4
s_and_b32 s13, s5, 0xffff
s_mov_b32 s14, 4718592
s_mov_b32 s15, 0x20000
v_and_b32 v1, 63, v0
v_lshlrev_b32 v1, 4, v1
v_bfe_u32 v12, v0, 3, 3
v_mul_u32_u24 v12, 1152, v12
v_bfe_u32 v13, v0, 4, 2
v_lshlrev_b32 v13, 1, v13
v_and_b32 v14, 7, v0
v_xor_b32 v13, v13, v14
v_lshl_add_u32 v12, v13, 4, v12
s_mul_i32 s24, s17, 1179648
s_lshl_b32 s25, s40, 7
s_add_u32 s24, s24, s25
v_add_u32 v2, s24, v12
s_lshl_b32 s26, s17, 15
v_bfe_u32 v12, v0, 2, 3
v_lshlrev_b32 v12, 7, v12
v_bfe_u32 v13, v0, 5, 1
v_lshl_add_u32 v12, v13, 11, v12
v_bfe_u32 v13, v0, 3, 2
v_lshl_add_u32 v12, v13, 5, v12
v_and_b32 v13, 3, v0
v_lshl_add_u32 v12, v13, 3, v12
v_add_u32 v8, s26, v12
v_xor_b32 v9, 32, v8
v_xor_b32 v10, 64, v8
v_xor_b32 v11, 96, v8
s_add_u32 s24, s40, 0
s_and_b32 s24, s24, 7
s_lshl_b32 s30, s24, 12
s_add_u32 s24, s40, 1
s_and_b32 s24, s24, 7
s_lshl_b32 s31, s24, 12
s_add_u32 s24, s40, 2
s_and_b32 s24, s24, 7
s_lshl_b32 s32, s24, 12
s_add_u32 s24, s40, 3
s_and_b32 s24, s24, 7
s_lshl_b32 s33, s24, 12
s_add_u32 s24, s40, 4
s_and_b32 s24, s24, 7
s_lshl_b32 s34, s24, 12
s_add_u32 s24, s40, 5
s_and_b32 s24, s24, 7
s_lshl_b32 s35, s24, 12
s_add_u32 s24, s40, 6
s_and_b32 s24, s24, 7
s_lshl_b32 s36, s24, 12
s_add_u32 s24, s40, 7
s_and_b32 s24, s24, 7
s_lshl_b32 s37, s24, 12
s_mul_i32 s25, s30, 36
s_add_u32 m0, s26, 0
s_add_u32 s24, s25, 0
buffer_load_dwordx4 v2, s[20:23], s24 offen lds
s_add_u32 m0, s26, 1024
s_add_u32 s24, s25, 9216
buffer_load_dwordx4 v2, s[20:23], s24 offen lds
s_add_u32 m0, s26, 2048
s_add_u32 s24, s25, 18432
buffer_load_dwordx4 v2, s[20:23], s24 offen lds
s_add_u32 m0, s26, 3072
s_add_u32 s24, s25, 27648
buffer_load_dwordx4 v2, s[20:23], s24 offen lds
s_mul_i32 s25, s30, 36
s_add_u32 m0, s26, 4096
s_add_u32 s24, s25, 36864
buffer_load_dwordx4 v2, s[20:23], s24 offen lds
s_add_u32 m0, s26, 5120
s_add_u32 s24, s25, 46080
buffer_load_dwordx4 v2, s[20:23], s24 offen lds
s_add_u32 m0, s26, 6144
s_add_u32 s24, s25, 55296
buffer_load_dwordx4 v2, s[20:23], s24 offen lds
s_add_u32 m0, s26, 7168
s_add_u32 s24, s25, 64512
buffer_load_dwordx4 v2, s[20:23], s24 offen lds
s_mul_i32 s25, s30, 36
s_add_u32 m0, s26, 8192
s_add_u32 s24, s25, 73728
buffer_load_dwordx4 v2, s[20:23], s24 offen lds
s_add_u32 m0, s26, 9216
s_add_u32 s24, s25, 82944
buffer_load_dwordx4 v2, s[20:23], s24 offen lds
s_add_u32 m0, s26, 10240
s_add_u32 s24, s25, 92160
buffer_load_dwordx4 v2, s[20:23], s24 offen lds
s_add_u32 m0, s26, 11264
s_add_u32 s24, s25, 101376
buffer_load_dwordx4 v2, s[20:23], s24 offen lds
s_mul_i32 s25, s31, 36
s_add_u32 m0, s26, 12288
s_add_u32 s24, s25, 0
buffer_load_dwordx4 v2, s[20:23], s24 offen lds
s_add_u32 m0, s26, 13312
s_add_u32 s24, s25, 9216
buffer_load_dwordx4 v2, s[20:23], s24 offen lds
s_add_u32 m0, s26, 14336
s_add_u32 s24, s25, 18432
buffer_load_dwordx4 v2, s[20:23], s24 offen lds
s_add_u32 m0, s26, 15360
s_add_u32 s24, s25, 27648
buffer_load_dwordx4 v2, s[20:23], s24 offen lds
s_mul_i32 s25, s31, 36
s_add_u32 m0, s26, 16384
s_add_u32 s24, s25, 36864
buffer_load_dwordx4 v2, s[20:23], s24 offen lds
s_add_u32 m0, s26, 17408
s_add_u32 s24, s25, 46080
buffer_load_dwordx4 v2, s[20:23], s24 offen lds
s_add_u32 m0, s26, 18432
s_add_u32 s24, s25, 55296
buffer_load_dwordx4 v2, s[20:23], s24 offen lds
s_add_u32 m0, s26, 19456
s_add_u32 s24, s25, 64512
buffer_load_dwordx4 v2, s[20:23], s24 offen lds
s_mul_i32 s25, s31, 36
s_add_u32 m0, s26, 20480
s_add_u32 s24, s25, 73728
buffer_load_dwordx4 v2, s[20:23], s24 offen lds
s_add_u32 m0, s26, 21504
s_add_u32 s24, s25, 82944
buffer_load_dwordx4 v2, s[20:23], s24 offen lds
s_add_u32 m0, s26, 22528
s_add_u32 s24, s25, 92160
buffer_load_dwordx4 v2, s[20:23], s24 offen lds
s_add_u32 m0, s26, 23552
s_add_u32 s24, s25, 101376
buffer_load_dwordx4 v2, s[20:23], s24 offen lds
s_mul_i32 s25, s32, 36
s_add_u32 m0, s26, 24576
s_add_u32 s24, s25, 0
buffer_load_dwordx4 v2, s[20:23], s24 offen lds
s_add_u32 m0, s26, 25600
s_add_u32 s24, s25, 9216
buffer_load_dwordx4 v2, s[20:23], s24 offen lds
s_add_u32 m0, s26, 26624
s_add_u32 s24, s25, 18432
buffer_load_dwordx4 v2, s[20:23], s24 offen lds
s_add_u32 m0, s26, 27648
s_add_u32 s24, s25, 27648
buffer_load_dwordx4 v2, s[20:23], s24 offen lds
s_mul_i32 s25, s32, 36
s_add_u32 m0, s26, 28672
s_add_u32 s24, s25, 36864
buffer_load_dwordx4 v2, s[20:23], s24 offen lds
s_add_u32 m0, s26, 29696
s_add_u32 s24, s25, 46080
buffer_load_dwordx4 v2, s[20:23], s24 offen lds
s_add_u32 m0, s26, 30720
s_add_u32 s24, s25, 55296
buffer_load_dwordx4 v2, s[20:23], s24 offen lds
s_add_u32 m0, s26, 31744
s_add_u32 s24, s25, 64512
buffer_load_dwordx4 v2, s[20:23], s24 offen lds
s_waitcnt vmcnt(28)
ds_read_b64_tr_b16 v[128:129], v8 offset:0
ds_read_b64_tr_b16 v[130:131], v8 offset:1024
ds_read_b64_tr_b16 v[132:133], v9 offset:0
ds_read_b64_tr_b16 v[134:135], v9 offset:1024
ds_read_b64_tr_b16 v[136:137], v10 offset:0
ds_read_b64_tr_b16 v[138:139], v10 offset:1024
ds_read_b64_tr_b16 v[140:141], v11 offset:0
ds_read_b64_tr_b16 v[142:143], v11 offset:1024
s_waitcnt lgkmcnt(0)
s_mul_i32 s25, s32, 36
s_add_u32 m0, s26, 0
s_add_u32 s24, s25, 73728
buffer_load_dwordx4 v2, s[20:23], s24 offen lds
s_add_u32 m0, s26, 1024
s_add_u32 s24, s25, 82944
buffer_load_dwordx4 v2, s[20:23], s24 offen lds
s_add_u32 m0, s26, 2048
s_add_u32 s24, s25, 92160
buffer_load_dwordx4 v2, s[20:23], s24 offen lds
s_add_u32 m0, s26, 3072
s_add_u32 s24, s25, 101376
buffer_load_dwordx4 v2, s[20:23], s24 offen lds
s_waitcnt vmcnt(28)
ds_read_b64_tr_b16 v[144:145], v8 offset:4096
ds_read_b64_tr_b16 v[146:147], v8 offset:5120
ds_read_b64_tr_b16 v[148:149], v9 offset:4096
ds_read_b64_tr_b16 v[150:151], v9 offset:5120
ds_read_b64_tr_b16 v[152:153], v10 offset:4096
ds_read_b64_tr_b16 v[154:155], v10 offset:5120
ds_read_b64_tr_b16 v[156:157], v11 offset:4096
ds_read_b64_tr_b16 v[158:159], v11 offset:5120
s_waitcnt lgkmcnt(0)
s_mul_i32 s25, s33, 36
s_add_u32 m0, s26, 4096
s_add_u32 s24, s25, 0
buffer_load_dwordx4 v2, s[20:23], s24 offen lds
s_add_u32 m0, s26, 5120
s_add_u32 s24, s25, 9216
buffer_load_dwordx4 v2, s[20:23], s24 offen lds
s_add_u32 m0, s26, 6144
s_add_u32 s24, s25, 18432
buffer_load_dwordx4 v2, s[20:23], s24 offen lds
s_add_u32 m0, s26, 7168
s_add_u32 s24, s25, 27648
buffer_load_dwordx4 v2, s[20:23], s24 offen lds
s_waitcnt vmcnt(28)
ds_read_b64_tr_b16 v[160:161], v8 offset:8192
ds_read_b64_tr_b16 v[162:163], v8 offset:9216
ds_read_b64_tr_b16 v[164:165], v9 offset:8192
ds_read_b64_tr_b16 v[166:167], v9 offset:9216
ds_read_b64_tr_b16 v[168:169], v10 offset:8192
ds_read_b64_tr_b16 v[170:171], v10 offset:9216
ds_read_b64_tr_b16 v[172:173], v11 offset:8192
ds_read_b64_tr_b16 v[174:175], v11 offset:9216
s_waitcnt lgkmcnt(0)
s_mul_i32 s25, s33, 36
s_add_u32 m0, s26, 8192
s_add_u32 s24, s25, 36864
buffer_load_dwordx4 v2, s[20:23], s24 offen lds
s_add_u32 m0, s26, 9216
s_add_u32 s24, s25, 46080
buffer_load_dwordx4 v2, s[20:23], s24 offen lds
s_add_u32 m0, s26, 10240
s_add_u32 s24, s25, 55296
buffer_load_dwordx4 v2, s[20:23], s24 offen lds
s_add_u32 m0, s26, 11264
s_add_u32 s24, s25, 64512
buffer_load_dwordx4 v2, s[20:23], s24 offen lds
s_waitcnt vmcnt(28)
ds_read_b64_tr_b16 v[176:177], v8 offset:12288
ds_read_b64_tr_b16 v[178:179], v8 offset:13312
ds_read_b64_tr_b16 v[180:181], v9 offset:12288
ds_read_b64_tr_b16 v[182:183], v9 offset:13312
ds_read_b64_tr_b16 v[184:185], v10 offset:12288
ds_read_b64_tr_b16 v[186:187], v10 offset:13312
ds_read_b64_tr_b16 v[188:189], v11 offset:12288
ds_read_b64_tr_b16 v[190:191], v11 offset:13312
s_waitcnt lgkmcnt(0)
s_mul_i32 s25, s33, 36
s_add_u32 m0, s26, 12288
s_add_u32 s24, s25, 73728
buffer_load_dwordx4 v2, s[20:23], s24 offen lds
s_add_u32 m0, s26, 13312
s_add_u32 s24, s25, 82944
buffer_load_dwordx4 v2, s[20:23], s24 offen lds
s_add_u32 m0, s26, 14336
s_add_u32 s24, s25, 92160
buffer_load_dwordx4 v2, s[20:23], s24 offen lds
s_add_u32 m0, s26, 15360
s_add_u32 s24, s25, 101376
buffer_load_dwordx4 v2, s[20:23], s24 offen lds
s_waitcnt vmcnt(28)
ds_read_b64_tr_b16 v[192:193], v8 offset:16384
ds_read_b64_tr_b16 v[194:195], v8 offset:17408
ds_read_b64_tr_b16 v[196:197], v9 offset:16384
ds_read_b64_tr_b16 v[198:199], v9 offset:17408
ds_read_b64_tr_b16 v[200:201], v10 offset:16384
ds_read_b64_tr_b16 v[202:203], v10 offset:17408
ds_read_b64_tr_b16 v[204:205], v11 offset:16384
ds_read_b64_tr_b16 v[206:207], v11 offset:17408
s_waitcnt lgkmcnt(0)
s_mul_i32 s25, s34, 36
s_add_u32 m0, s26, 16384
s_add_u32 s24, s25, 0
buffer_load_dwordx4 v2, s[20:23], s24 offen lds
s_add_u32 m0, s26, 17408
s_add_u32 s24, s25, 9216
buffer_load_dwordx4 v2, s[20:23], s24 offen lds
s_add_u32 m0, s26, 18432
s_add_u32 s24, s25, 18432
buffer_load_dwordx4 v2, s[20:23], s24 offen lds
s_add_u32 m0, s26, 19456
s_add_u32 s24, s25, 27648
buffer_load_dwordx4 v2, s[20:23], s24 offen lds
s_waitcnt vmcnt(28)
ds_read_b64_tr_b16 v[208:209], v8 offset:20480
ds_read_b64_tr_b16 v[210:211], v8 offset:21504
ds_read_b64_tr_b16 v[212:213], v9 offset:20480
ds_read_b64_tr_b16 v[214:215], v9 offset:21504
ds_read_b64_tr_b16 v[216:217], v10 offset:20480
ds_read_b64_tr_b16 v[218:219], v10 offset:21504
ds_read_b64_tr_b16 v[220:221], v11 offset:20480
ds_read_b64_tr_b16 v[222:223], v11 offset:21504
s_waitcnt lgkmcnt(0)
s_mul_i32 s25, s34, 36
s_add_u32 m0, s26, 20480
s_add_u32 s24, s25, 36864
buffer_load_dwordx4 v2, s[20:23], s24 offen lds
s_add_u32 m0, s26, 21504
s_add_u32 s24, s25, 46080
buffer_load_dwordx4 v2, s[20:23], s24 offen lds
s_add_u32 m0, s26, 22528
s_add_u32 s24, s25, 55296
buffer_load_dwordx4 v2, s[20:23], s24 offen lds
s_add_u32 m0, s26, 23552
s_add_u32 s24, s25, 64512
buffer_load_dwordx4 v2, s[20:23], s24 offen lds
s_waitcnt vmcnt(28)
ds_read_b64_tr_b16 v[224:225], v8 offset:24576
ds_read_b64_tr_b16 v[226:227], v8 offset:25600
ds_read_b64_tr_b16 v[228:229], v9 offset:24576
ds_read_b64_tr_b16 v[230:231], v9 offset:25600
ds_read_b64_tr_b16 v[232:233], v10 offset:24576
ds_read_b64_tr_b16 v[234:235], v10 offset:25600
ds_read_b64_tr_b16 v[236:237], v11 offset:24576
ds_read_b64_tr_b16 v[238:239], v11 offset:25600
s_waitcnt lgkmcnt(0)
s_mul_i32 s25, s34, 36
s_add_u32 m0, s26, 24576
s_add_u32 s24, s25, 73728
buffer_load_dwordx4 v2, s[20:23], s24 offen lds
s_add_u32 m0, s26, 25600
s_add_u32 s24, s25, 82944
buffer_load_dwordx4 v2, s[20:23], s24 offen lds
s_add_u32 m0, s26, 26624
s_add_u32 s24, s25, 92160
buffer_load_dwordx4 v2, s[20:23], s24 offen lds
s_add_u32 m0, s26, 27648
s_add_u32 s24, s25, 101376
buffer_load_dwordx4 v2, s[20:23], s24 offen lds
s_waitcnt vmcnt(28)
ds_read_b64_tr_b16 v[240:241], v8 offset:28672
ds_read_b64_tr_b16 v[242:243], v8 offset:29696
ds_read_b64_tr_b16 v[244:245], v9 offset:28672
ds_read_b64_tr_b16 v[246:247], v9 offset:29696
ds_read_b64_tr_b16 v[248:249], v10 offset:28672
ds_read_b64_tr_b16 v[250:251], v10 offset:29696
ds_read_b64_tr_b16 v[252:253], v11 offset:28672
ds_read_b64_tr_b16 v[254:255], v11 offset:29696
s_waitcnt lgkmcnt(0)
s_mul_i32 s25, s35, 36
s_add_u32 m0, s26, 28672
s_add_u32 s24, s25, 0
buffer_load_dwordx4 v2, s[20:23], s24 offen lds
s_add_u32 m0, s26, 29696
s_add_u32 s24, s25, 9216
buffer_load_dwordx4 v2, s[20:23], s24 offen lds
s_add_u32 m0, s26, 30720
s_add_u32 s24, s25, 18432
buffer_load_dwordx4 v2, s[20:23], s24 offen lds
s_add_u32 m0, s26, 31744
s_add_u32 s24, s25, 27648
buffer_load_dwordx4 v2, s[20:23], s24 offen lds
s_waitcnt vmcnt(28)
ds_read_b64_tr_b16 a[0:1], v8 offset:0
ds_read_b64_tr_b16 a[2:3], v8 offset:1024
ds_read_b64_tr_b16 a[4:5], v9 offset:0
ds_read_b64_tr_b16 a[6:7], v9 offset:1024
ds_read_b64_tr_b16 a[8:9], v10 offset:0
ds_read_b64_tr_b16 a[10:11], v10 offset:1024
ds_read_b64_tr_b16 a[12:13], v11 offset:0
ds_read_b64_tr_b16 a[14:15], v11 offset:1024
s_waitcnt lgkmcnt(0)
s_mul_i32 s25, s35, 36
s_add_u32 m0, s26, 0
s_add_u32 s24, s25, 36864
buffer_load_dwordx4 v2, s[20:23], s24 offen lds
s_add_u32 m0, s26, 1024
s_add_u32 s24, s25, 46080
buffer_load_dwordx4 v2, s[20:23], s24 offen lds
s_add_u32 m0, s26, 2048
s_add_u32 s24, s25, 55296
buffer_load_dwordx4 v2, s[20:23], s24 offen lds
s_add_u32 m0, s26, 3072
s_add_u32 s24, s25, 64512
buffer_load_dwordx4 v2, s[20:23], s24 offen lds
s_waitcnt vmcnt(28)
ds_read_b64_tr_b16 a[16:17], v8 offset:4096
ds_read_b64_tr_b16 a[18:19], v8 offset:5120
ds_read_b64_tr_b16 a[20:21], v9 offset:4096
ds_read_b64_tr_b16 a[22:23], v9 offset:5120
ds_read_b64_tr_b16 a[24:25], v10 offset:4096
ds_read_b64_tr_b16 a[26:27], v10 offset:5120
ds_read_b64_tr_b16 a[28:29], v11 offset:4096
ds_read_b64_tr_b16 a[30:31], v11 offset:5120
s_waitcnt lgkmcnt(0)
s_mul_i32 s25, s35, 36
s_add_u32 m0, s26, 4096
s_add_u32 s24, s25, 73728
buffer_load_dwordx4 v2, s[20:23], s24 offen lds
s_add_u32 m0, s26, 5120
s_add_u32 s24, s25, 82944
buffer_load_dwordx4 v2, s[20:23], s24 offen lds
s_add_u32 m0, s26, 6144
s_add_u32 s24, s25, 92160
buffer_load_dwordx4 v2, s[20:23], s24 offen lds
s_add_u32 m0, s26, 7168
s_add_u32 s24, s25, 101376
buffer_load_dwordx4 v2, s[20:23], s24 offen lds
s_waitcnt vmcnt(28)
ds_read_b64_tr_b16 a[32:33], v8 offset:8192
ds_read_b64_tr_b16 a[34:35], v8 offset:9216
ds_read_b64_tr_b16 a[36:37], v9 offset:8192
ds_read_b64_tr_b16 a[38:39], v9 offset:9216
ds_read_b64_tr_b16 a[40:41], v10 offset:8192
ds_read_b64_tr_b16 a[42:43], v10 offset:9216
ds_read_b64_tr_b16 a[44:45], v11 offset:8192
ds_read_b64_tr_b16 a[46:47], v11 offset:9216
s_waitcnt lgkmcnt(0)
s_mul_i32 s25, s36, 36
s_add_u32 m0, s26, 8192
s_add_u32 s24, s25, 0
buffer_load_dwordx4 v2, s[20:23], s24 offen lds
s_add_u32 m0, s26, 9216
s_add_u32 s24, s25, 9216
buffer_load_dwordx4 v2, s[20:23], s24 offen lds
s_add_u32 m0, s26, 10240
s_add_u32 s24, s25, 18432
buffer_load_dwordx4 v2, s[20:23], s24 offen lds
s_add_u32 m0, s26, 11264
s_add_u32 s24, s25, 27648
buffer_load_dwordx4 v2, s[20:23], s24 offen lds
s_waitcnt vmcnt(28)
ds_read_b64_tr_b16 a[48:49], v8 offset:12288
ds_read_b64_tr_b16 a[50:51], v8 offset:13312
ds_read_b64_tr_b16 a[52:53], v9 offset:12288
ds_read_b64_tr_b16 a[54:55], v9 offset:13312
ds_read_b64_tr_b16 a[56:57], v10 offset:12288
ds_read_b64_tr_b16 a[58:59], v10 offset:13312
ds_read_b64_tr_b16 a[60:61], v11 offset:12288
ds_read_b64_tr_b16 a[62:63], v11 offset:13312
s_waitcnt lgkmcnt(0)
s_mul_i32 s25, s36, 36
s_add_u32 m0, s26, 12288
s_add_u32 s24, s25, 36864
buffer_load_dwordx4 v2, s[20:23], s24 offen lds
s_add_u32 m0, s26, 13312
s_add_u32 s24, s25, 46080
buffer_load_dwordx4 v2, s[20:23], s24 offen lds
s_add_u32 m0, s26, 14336
s_add_u32 s24, s25, 55296
buffer_load_dwordx4 v2, s[20:23], s24 offen lds
s_add_u32 m0, s26, 15360
s_add_u32 s24, s25, 64512
buffer_load_dwordx4 v2, s[20:23], s24 offen lds
s_waitcnt vmcnt(28)
ds_read_b64_tr_b16 a[64:65], v8 offset:16384
ds_read_b64_tr_b16 a[66:67], v8 offset:17408
ds_read_b64_tr_b16 a[68:69], v9 offset:16384
ds_read_b64_tr_b16 a[70:71], v9 offset:17408
ds_read_b64_tr_b16 a[72:73], v10 offset:16384
ds_read_b64_tr_b16 a[74:75], v10 offset:17408
ds_read_b64_tr_b16 a[76:77], v11 offset:16384
ds_read_b64_tr_b16 a[78:79], v11 offset:17408
s_waitcnt lgkmcnt(0)
s_mul_i32 s25, s36, 36
s_add_u32 m0, s26, 16384
s_add_u32 s24, s25, 73728
buffer_load_dwordx4 v2, s[20:23], s24 offen lds
s_add_u32 m0, s26, 17408
s_add_u32 s24, s25, 82944
buffer_load_dwordx4 v2, s[20:23], s24 offen lds
s_add_u32 m0, s26, 18432
s_add_u32 s24, s25, 92160
buffer_load_dwordx4 v2, s[20:23], s24 offen lds
s_add_u32 m0, s26, 19456
s_add_u32 s24, s25, 101376
buffer_load_dwordx4 v2, s[20:23], s24 offen lds
s_waitcnt vmcnt(28)
ds_read_b64_tr_b16 a[80:81], v8 offset:20480
ds_read_b64_tr_b16 a[82:83], v8 offset:21504
ds_read_b64_tr_b16 a[84:85], v9 offset:20480
ds_read_b64_tr_b16 a[86:87], v9 offset:21504
ds_read_b64_tr_b16 a[88:89], v10 offset:20480
ds_read_b64_tr_b16 a[90:91], v10 offset:21504
ds_read_b64_tr_b16 a[92:93], v11 offset:20480
ds_read_b64_tr_b16 a[94:95], v11 offset:21504
s_waitcnt lgkmcnt(0)
s_mul_i32 s25, s37, 36
s_add_u32 m0, s26, 20480
s_add_u32 s24, s25, 0
buffer_load_dwordx4 v2, s[20:23], s24 offen lds
s_add_u32 m0, s26, 21504
s_add_u32 s24, s25, 9216
buffer_load_dwordx4 v2, s[20:23], s24 offen lds
s_add_u32 m0, s26, 22528
s_add_u32 s24, s25, 18432
buffer_load_dwordx4 v2, s[20:23], s24 offen lds
s_add_u32 m0, s26, 23552
s_add_u32 s24, s25, 27648
buffer_load_dwordx4 v2, s[20:23], s24 offen lds
s_waitcnt vmcnt(28)
ds_read_b64_tr_b16 a[96:97], v8 offset:24576
ds_read_b64_tr_b16 a[98:99], v8 offset:25600
ds_read_b64_tr_b16 a[100:101], v9 offset:24576
ds_read_b64_tr_b16 a[102:103], v9 offset:25600
ds_read_b64_tr_b16 a[104:105], v10 offset:24576
ds_read_b64_tr_b16 a[106:107], v10 offset:25600
ds_read_b64_tr_b16 a[108:109], v11 offset:24576
ds_read_b64_tr_b16 a[110:111], v11 offset:25600
s_waitcnt lgkmcnt(0)
s_mul_i32 s25, s37, 36
s_add_u32 m0, s26, 24576
s_add_u32 s24, s25, 36864
buffer_load_dwordx4 v2, s[20:23], s24 offen lds
s_add_u32 m0, s26, 25600
s_add_u32 s24, s25, 46080
buffer_load_dwordx4 v2, s[20:23], s24 offen lds
s_add_u32 m0, s26, 26624
s_add_u32 s24, s25, 55296
buffer_load_dwordx4 v2, s[20:23], s24 offen lds
s_add_u32 m0, s26, 27648
s_add_u32 s24, s25, 64512
buffer_load_dwordx4 v2, s[20:23], s24 offen lds
s_waitcnt vmcnt(28)
ds_read_b64_tr_b16 a[112:113], v8 offset:28672
ds_read_b64_tr_b16 a[114:115], v8 offset:29696
ds_read_b64_tr_b16 a[116:117], v9 offset:28672
ds_read_b64_tr_b16 a[118:119], v9 offset:29696
ds_read_b64_tr_b16 a[120:121], v10 offset:28672
ds_read_b64_tr_b16 a[122:123], v10 offset:29696
ds_read_b64_tr_b16 a[124:125], v11 offset:28672
ds_read_b64_tr_b16 a[126:127], v11 offset:29696
s_waitcnt lgkmcnt(0)
s_mul_i32 s25, s37, 36
s_add_u32 m0, s26, 28672
s_add_u32 s24, s25, 73728
buffer_load_dwordx4 v2, s[20:23], s24 offen lds
s_add_u32 m0, s26, 29696
s_add_u32 s24, s25, 82944
buffer_load_dwordx4 v2, s[20:23], s24 offen lds
s_add_u32 m0, s26, 30720
s_add_u32 s24, s25, 92160
buffer_load_dwordx4 v2, s[20:23], s24 offen lds
s_add_u32 m0, s26, 31744
s_add_u32 s24, s25, 101376
buffer_load_dwordx4 v2, s[20:23], s24 offen lds
s_waitcnt vmcnt(28)
ds_read_b64_tr_b16 a[128:129], v8 offset:0
ds_read_b64_tr_b16 a[130:131], v8 offset:1024
ds_read_b64_tr_b16 a[132:133], v9 offset:0
ds_read_b64_tr_b16 a[134:135], v9 offset:1024
ds_read_b64_tr_b16 a[136:137], v10 offset:0
ds_read_b64_tr_b16 a[138:139], v10 offset:1024
ds_read_b64_tr_b16 a[140:141], v11 offset:0
ds_read_b64_tr_b16 a[142:143], v11 offset:1024
s_waitcnt lgkmcnt(0)
s_mul_i32 s25, s30, 36
s_add_u32 m0, s26, 0
s_add_u32 s24, s25, 110592
buffer_load_dwordx4 v2, s[20:23], s24 offen lds
s_add_u32 m0, s26, 1024
s_add_u32 s24, s25, 119808
buffer_load_dwordx4 v2, s[20:23], s24 offen lds
s_add_u32 m0, s26, 2048
s_add_u32 s24, s25, 129024
buffer_load_dwordx4 v2, s[20:23], s24 offen lds
s_add_u32 m0, s26, 3072
s_add_u32 s24, s25, 138240
buffer_load_dwordx4 v2, s[20:23], s24 offen lds
s_waitcnt vmcnt(28)
ds_read_b64_tr_b16 a[144:145], v8 offset:4096
ds_read_b64_tr_b16 a[146:147], v8 offset:5120
ds_read_b64_tr_b16 a[148:149], v9 offset:4096
ds_read_b64_tr_b16 a[150:151], v9 offset:5120
ds_read_b64_tr_b16 a[152:153], v10 offset:4096
ds_read_b64_tr_b16 a[154:155], v10 offset:5120
ds_read_b64_tr_b16 a[156:157], v11 offset:4096
ds_read_b64_tr_b16 a[158:159], v11 offset:5120
s_waitcnt lgkmcnt(0)
s_mul_i32 s25, s31, 36
s_add_u32 m0, s26, 4096
s_add_u32 s24, s25, 110592
buffer_load_dwordx4 v2, s[20:23], s24 offen lds
s_add_u32 m0, s26, 5120
s_add_u32 s24, s25, 119808
buffer_load_dwordx4 v2, s[20:23], s24 offen lds
s_add_u32 m0, s26, 6144
s_add_u32 s24, s25, 129024
buffer_load_dwordx4 v2, s[20:23], s24 offen lds
s_add_u32 m0, s26, 7168
s_add_u32 s24, s25, 138240
buffer_load_dwordx4 v2, s[20:23], s24 offen lds
s_waitcnt vmcnt(28)
ds_read_b64_tr_b16 a[160:161], v8 offset:8192
ds_read_b64_tr_b16 a[162:163], v8 offset:9216
ds_read_b64_tr_b16 a[164:165], v9 offset:8192
ds_read_b64_tr_b16 a[166:167], v9 offset:9216
ds_read_b64_tr_b16 a[168:169], v10 offset:8192
ds_read_b64_tr_b16 a[170:171], v10 offset:9216
ds_read_b64_tr_b16 a[172:173], v11 offset:8192
ds_read_b64_tr_b16 a[174:175], v11 offset:9216
s_waitcnt lgkmcnt(0)
s_mul_i32 s25, s32, 36
s_add_u32 m0, s26, 8192
s_add_u32 s24, s25, 110592
buffer_load_dwordx4 v2, s[20:23], s24 offen lds
s_add_u32 m0, s26, 9216
s_add_u32 s24, s25, 119808
buffer_load_dwordx4 v2, s[20:23], s24 offen lds
s_add_u32 m0, s26, 10240
s_add_u32 s24, s25, 129024
buffer_load_dwordx4 v2, s[20:23], s24 offen lds
s_add_u32 m0, s26, 11264
s_add_u32 s24, s25, 138240
buffer_load_dwordx4 v2, s[20:23], s24 offen lds
s_waitcnt vmcnt(28)
ds_read_b64_tr_b16 a[176:177], v8 offset:12288
ds_read_b64_tr_b16 a[178:179], v8 offset:13312
ds_read_b64_tr_b16 a[180:181], v9 offset:12288
ds_read_b64_tr_b16 a[182:183], v9 offset:13312
ds_read_b64_tr_b16 a[184:185], v10 offset:12288
ds_read_b64_tr_b16 a[186:187], v10 offset:13312
ds_read_b64_tr_b16 a[188:189], v11 offset:12288
ds_read_b64_tr_b16 a[190:191], v11 offset:13312
s_waitcnt lgkmcnt(0)
s_mul_i32 s25, s33, 36
s_add_u32 m0, s26, 12288
s_add_u32 s24, s25, 110592
buffer_load_dwordx4 v2, s[20:23], s24 offen lds
s_add_u32 m0, s26, 13312
s_add_u32 s24, s25, 119808
buffer_load_dwordx4 v2, s[20:23], s24 offen lds
s_add_u32 m0, s26, 14336
s_add_u32 s24, s25, 129024
buffer_load_dwordx4 v2, s[20:23], s24 offen lds
s_add_u32 m0, s26, 15360
s_add_u32 s24, s25, 138240
buffer_load_dwordx4 v2, s[20:23], s24 offen lds
s_waitcnt vmcnt(28)
ds_read_b64_tr_b16 a[192:193], v8 offset:16384
ds_read_b64_tr_b16 a[194:195], v8 offset:17408
ds_read_b64_tr_b16 a[196:197], v9 offset:16384
ds_read_b64_tr_b16 a[198:199], v9 offset:17408
ds_read_b64_tr_b16 a[200:201], v10 offset:16384
ds_read_b64_tr_b16 a[202:203], v10 offset:17408
ds_read_b64_tr_b16 a[204:205], v11 offset:16384
ds_read_b64_tr_b16 a[206:207], v11 offset:17408
s_waitcnt lgkmcnt(0)
s_mul_i32 s25, s34, 36
s_add_u32 m0, s26, 16384
s_add_u32 s24, s25, 110592
buffer_load_dwordx4 v2, s[20:23], s24 offen lds
s_add_u32 m0, s26, 17408
s_add_u32 s24, s25, 119808
buffer_load_dwordx4 v2, s[20:23], s24 offen lds
s_add_u32 m0, s26, 18432
s_add_u32 s24, s25, 129024
buffer_load_dwordx4 v2, s[20:23], s24 offen lds
s_add_u32 m0, s26, 19456
s_add_u32 s24, s25, 138240
buffer_load_dwordx4 v2, s[20:23], s24 offen lds
s_waitcnt vmcnt(28)
ds_read_b64_tr_b16 a[208:209], v8 offset:20480
ds_read_b64_tr_b16 a[210:211], v8 offset:21504
ds_read_b64_tr_b16 a[212:213], v9 offset:20480
ds_read_b64_tr_b16 a[214:215], v9 offset:21504
ds_read_b64_tr_b16 a[216:217], v10 offset:20480
ds_read_b64_tr_b16 a[218:219], v10 offset:21504
ds_read_b64_tr_b16 a[220:221], v11 offset:20480
ds_read_b64_tr_b16 a[222:223], v11 offset:21504
s_waitcnt lgkmcnt(0)
s_mul_i32 s25, s35, 36
s_add_u32 m0, s26, 20480
s_add_u32 s24, s25, 110592
buffer_load_dwordx4 v2, s[20:23], s24 offen lds
s_add_u32 m0, s26, 21504
s_add_u32 s24, s25, 119808
buffer_load_dwordx4 v2, s[20:23], s24 offen lds
s_add_u32 m0, s26, 22528
s_add_u32 s24, s25, 129024
buffer_load_dwordx4 v2, s[20:23], s24 offen lds
s_add_u32 m0, s26, 23552
s_add_u32 s24, s25, 138240
buffer_load_dwordx4 v2, s[20:23], s24 offen lds
s_waitcnt vmcnt(28)
ds_read_b64_tr_b16 a[224:225], v8 offset:24576
ds_read_b64_tr_b16 a[226:227], v8 offset:25600
ds_read_b64_tr_b16 a[228:229], v9 offset:24576
ds_read_b64_tr_b16 a[230:231], v9 offset:25600
ds_read_b64_tr_b16 a[232:233], v10 offset:24576
ds_read_b64_tr_b16 a[234:235], v10 offset:25600
ds_read_b64_tr_b16 a[236:237], v11 offset:24576
ds_read_b64_tr_b16 a[238:239], v11 offset:25600
s_waitcnt lgkmcnt(0)
s_mul_i32 s25, s36, 36
s_add_u32 m0, s26, 24576
s_add_u32 s24, s25, 110592
buffer_load_dwordx4 v2, s[20:23], s24 offen lds
s_add_u32 m0, s26, 25600
s_add_u32 s24, s25, 119808
buffer_load_dwordx4 v2, s[20:23], s24 offen lds
s_add_u32 m0, s26, 26624
s_add_u32 s24, s25, 129024
buffer_load_dwordx4 v2, s[20:23], s24 offen lds
s_add_u32 m0, s26, 27648
s_add_u32 s24, s25, 138240
buffer_load_dwordx4 v2, s[20:23], s24 offen lds
s_waitcnt vmcnt(28)
ds_read_b64_tr_b16 a[240:241], v8 offset:28672
ds_read_b64_tr_b16 a[242:243], v8 offset:29696
ds_read_b64_tr_b16 a[244:245], v9 offset:28672
ds_read_b64_tr_b16 a[246:247], v9 offset:29696
ds_read_b64_tr_b16 a[248:249], v10 offset:28672
ds_read_b64_tr_b16 a[250:251], v10 offset:29696
ds_read_b64_tr_b16 a[252:253], v11 offset:28672
ds_read_b64_tr_b16 a[254:255], v11 offset:29696
s_waitcnt lgkmcnt(0)
s_mul_i32 s25, s37, 36
s_add_u32 m0, s26, 28672
s_add_u32 s24, s25, 110592
buffer_load_dwordx4 v2, s[20:23], s24 offen lds
s_add_u32 m0, s26, 29696
s_add_u32 s24, s25, 119808
buffer_load_dwordx4 v2, s[20:23], s24 offen lds
s_add_u32 m0, s26, 30720
s_add_u32 s24, s25, 129024
buffer_load_dwordx4 v2, s[20:23], s24 offen lds
s_add_u32 m0, s26, 31744
s_add_u32 s24, s25, 138240
buffer_load_dwordx4 v2, s[20:23], s24 offen lds
s_waitcnt vmcnt(0)
v_and_b32 v12, 15, v0
v_mul_u32_u24 v12, 2304, v12
v_lshrrev_b32 v13, 4, v0
v_lshl_add_u32 v12, v13, 3, v12
s_lshl_b32 s24, s40, 7
s_add_u32 s24, s24, s47
v_add_u32 v4, s24, v12
v_and_b32 v5, 7, v0
v_lshlrev_b32 v5, 2, v5
s_lshl_b32 s24, s17, 5
v_add_u32 v5, s24, v5
v_lshlrev_b32 v3, 4, v0
v_add_u32 v3, 131072, v3
s_lshl_b32 s24, s17, 12
s_add_u32 s24, s24, 131072
v_add_u32 v7, s24, v1
s_lshl_b32 s24, s17, 15
s_add_u32 s44, s44, s24
ds_read_b64_tr_b16 v[112:113], v8 offset:0
ds_read_b64_tr_b16 v[114:115], v8 offset:1024
ds_read_b64_tr_b16 v[116:117], v9 offset:0
ds_read_b64_tr_b16 v[118:119], v9 offset:1024
ds_read_b64_tr_b16 v[120:121], v10 offset:0
ds_read_b64_tr_b16 v[122:123], v10 offset:1024
ds_read_b64_tr_b16 v[124:125], v11 offset:0
ds_read_b64_tr_b16 v[126:127], v11 offset:1024
s_ff1_i32_b64 s41, s[42:43]
s_bitset0_b64 s[42:43], s41
s_lshl_b32 s41, s41, 1
s_add_u32 s41, s41, s51
s_and_b32 s41, s41, 127
L_opl_w:
s_lshr_b32 s25, s41, s46
s_lshl_b32 s25, s25, 7
s_add_u32 s25, s25, s45
s_mov_b32 s28, 0
L_poll_34:
buffer_load_dword v6, v5, s[8:11], s25 offen sc1
s_add_u32 s28, s28, 1
s_cmp_gt_u32 s28, 40000
s_cbranch_scc1 L_end
s_waitcnt vmcnt(0)
v_cmp_ne_u32 vcc, 1, v6
s_cbranch_vccz L_pd_35
s_sleep 1
s_branch L_poll_34
L_pd_35:
s_lshl_b32 s48, s41, 17
s_add_u32 s48, s48, s44
s_add_u32 s24, s48, s30
buffer_load_dwordx4 v[16:19], v1, s[8:11], s24 offen offset:0 sc1
buffer_load_dwordx4 v[20:23], v1, s[8:11], s24 offen offset:1024 sc1
buffer_load_dwordx4 v[24:27], v1, s[8:11], s24 offen offset:2048 sc1
buffer_load_dwordx4 v[28:31], v1, s[8:11], s24 offen offset:3072 sc1
s_add_u32 s24, s48, s31
buffer_load_dwordx4 v[32:35], v1, s[8:11], s24 offen offset:0 sc1
buffer_load_dwordx4 v[36:39], v1, s[8:11], s24 offen offset:1024 sc1
buffer_load_dwordx4 v[40:43], v1, s[8:11], s24 offen offset:2048 sc1
buffer_load_dwordx4 v[44:47], v1, s[8:11], s24 offen offset:3072 sc1
s_add_u32 s24, s48, s32
buffer_load_dwordx4 v[48:51], v1, s[8:11], s24 offen offset:0 sc1
buffer_load_dwordx4 v[52:55], v1, s[8:11], s24 offen offset:1024 sc1
buffer_load_dwordx4 v[56:59], v1, s[8:11], s24 offen offset:2048 sc1
buffer_load_dwordx4 v[60:63], v1, s[8:11], s24 offen offset:3072 sc1
s_add_u32 s24, s48, s33
buffer_load_dwordx4 v[64:67], v1, s[8:11], s24 offen offset:0 sc1
buffer_load_dwordx4 v[68:71], v1, s[8:11], s24 offen offset:1024 sc1
buffer_load_dwordx4 v[72:75], v1, s[8:11], s24 offen offset:2048 sc1
buffer_load_dwordx4 v[76:79], v1, s[8:11], s24 offen offset:3072 sc1
s_add_u32 s24, s48, s34
buffer_load_dwordx4 v[80:83], v1, s[8:11], s24 offen offset:0 sc1
buffer_load_dwordx4 v[84:87], v1, s[8:11], s24 offen offset:1024 sc1
buffer_load_dwordx4 v[88:91], v1, s[8:11], s24 offen offset:2048 sc1
buffer_load_dwordx4 v[92:95], v1, s[8:11], s24 offen offset:3072 sc1
buffer_load_dword v6, v5, s[8:11], s25 offen sc1
L_opl_r0:
s_cmp_lg_u64 s[42:43], 0
s_cselect_b32 s52, 1, 0
s_ff1_i32_b64 s27, s[42:43]
s_bitset0_b64 s[42:43], s27
s_lshl_b32 s27, s27, 1
s_add_u32 s27, s27, s51
s_and_b32 s27, s27, 127
s_lshr_b32 s25, s27, s46
s_lshl_b32 s25, s25, 7
s_add_u32 s25, s25, s45
buffer_load_dword v6, v5, s[8:11], s25 offen sc1
s_lshl_b32 s49, s27, 17
s_add_u32 s49, s49, s44
s_waitcnt vmcnt(21)
v_mfma_f32_16x16x32_bf16 v[96:99], v[128:131], v[16:19], 0
v_mfma_f32_16x16x32_bf16 v[100:103], v[132:135], v[16:19], 0
v_mfma_f32_16x16x32_bf16 v[104:107], v[136:139], v[16:19], 0
v_mfma_f32_16x16x32_bf16 v[108:111], v[140:143], v[16:19], 0
s_add_u32 s24, s48, s35
buffer_load_dwordx4 v[16:19], v1, s[8:11], s24 offen offset:0 sc1
s_waitcnt vmcnt(21)
v_mfma_f32_16x16x32_bf16 v[96:99], v[144:147], v[20:23], v[96:99]
v_mfma_f32_16x16x32_bf16 v[100:103], v[148:151], v[20:23], v[100:103]
v_mfma_f32_16x16x32_bf16 v[104:107], v[152:155], v[20:23], v[104:107]
v_mfma_f32_16x16x32_bf16 v[108:111], v[156:159], v[20:23], v[108:111]
buffer_load_dwordx4 v[20:23], v1, s[8:11], s24 offen offset:1024 sc1
s_waitcnt vmcnt(21)
v_mfma_f32_16x16x32_bf16 v[96:99], v[160:163], v[24:27], v[96:99]
v_mfma_f32_16x16x32_bf16 v[100:103], v[164:167], v[24:27], v[100:103]
v_mfma_f32_16x16x32_bf16 v[104:107], v[168:171], v[24:27], v[104:107]
v_mfma_f32_16x16x32_bf16 v[108:111], v[172:175], v[24:27], v[108:111]
buffer_load_dwordx4 v[24:27], v1, s[8:11], s24 offen offset:2048 sc1
s_waitcnt vmcnt(21) lgkmcnt(0)
v_mfma_f32_16x16x32_bf16 v[96:99], v[112:115], v[28:31], v[96:99]
v_mfma_f32_16x16x32_bf16 v[100:103], v[116:119], v[28:31], v[100:103]
v_mfma_f32_16x16x32_bf16 v[104:107], v[120:123], v[28:31], v[104:107]
v_mfma_f32_16x16x32_bf16 v[108:111], v[124:127], v[28:31], v[108:111]
buffer_load_dwordx4 v[28:31], v1, s[8:11], s24 offen offset:3072 sc1
s_waitcnt vmcnt(21)
v_mfma_f32_16x16x32_bf16 v[96:99], v[176:179], v[32:35], v[96:99]
ds_read_b64_tr_b16 v[112:113], v8 offset:4096
v_mfma_f32_16x16x32_bf16 v[100:103], v[180:183], v[32:35], v[100:103]
ds_read_b64_tr_b16 v[114:115], v8 offset:5120
v_mfma_f32_16x16x32_bf16 v[104:107], v[184:187], v[32:35], v[104:107]
ds_read_b64_tr_b16 v[116:117], v9 offset:4096
v_mfma_f32_16x16x32_bf16 v[108:111], v[188:191], v[32:35], v[108:111]
ds_read_b64_tr_b16 v[118:119], v9 offset:5120
s_add_u32 s24, s48, s36
buffer_load_dwordx4 v[32:35], v1, s[8:11], s24 offen offset:0 sc1
s_waitcnt vmcnt(21)
v_mfma_f32_16x16x32_bf16 v[96:99], v[192:195], v[36:39], v[96:99]
ds_read_b64_tr_b16 v[120:121], v10 offset:4096
v_mfma_f32_16x16x32_bf16 v[100:103], v[196:199], v[36:39], v[100:103]
ds_read_b64_tr_b16 v[122:123], v10 offset:5120
v_mfma_f32_16x16x32_bf16 v[104:107], v[200:203], v[36:39], v[104:107]
ds_read_b64_tr_b16 v[124:125], v11 offset:4096
v_mfma_f32_16x16x32_bf16 v[108:111], v[204:207], v[36:39], v[108:111]
ds_read_b64_tr_b16 v[126:127], v11 offset:5120
buffer_load_dwordx4 v[36:39], v1, s[8:11], s24 offen offset:1024 sc1
s_waitcnt vmcnt(21)
v_mfma_f32_16x16x32_bf16 v[96:99], v[208:211], v[40:43], v[96:99]
v_mfma_f32_16x16x32_bf16 v[100:103], v[212:215], v[40:43], v[100:103]
v_mfma_f32_16x16x32_bf16 v[104:107], v[216:219], v[40:43], v[104:107]
v_mfma_f32_16x16x32_bf16 v[108:111], v[220:223], v[40:43], v[108:111]
buffer_load_dwordx4 v[40:43], v1, s[8:11], s24 offen offset:2048 sc1
s_waitcnt vmcnt(21) lgkmcnt(0)
v_mfma_f32_16x16x32_bf16 v[96:99], v[112:115], v[44:47], v[96:99]
v_mfma_f32_16x16x32_bf16 v[100:103], v[116:119], v[44:47], v[100:103]
v_mfma_f32_16x16x32_bf16 v[104:107], v[120:123], v[44:47], v[104:107]
v_mfma_f32_16x16x32_bf16 v[108:111], v[124:127], v[44:47], v[108:111]
buffer_load_dwordx4 v[44:47], v1, s[8:11], s24 offen offset:3072 sc1
s_waitcnt vmcnt(21)
v_mfma_f32_16x16x32_bf16 v[96:99], v[224:227], v[48:51], v[96:99]
ds_read_b64_tr_b16 v[112:113], v8 offset:8192
v_mfma_f32_16x16x32_bf16 v[100:103], v[228:231], v[48:51], v[100:103]
ds_read_b64_tr_b16 v[114:115], v8 offset:9216
v_mfma_f32_16x16x32_bf16 v[104:107], v[232:235], v[48:51], v[104:107]
ds_read_b64_tr_b16 v[116:117], v9 offset:8192
v_mfma_f32_16x16x32_bf16 v[108:111], v[236:239], v[48:51], v[108:111]
ds_read_b64_tr_b16 v[118:119], v9 offset:9216
s_add_u32 s24, s48, s37
buffer_load_dwordx4 v[48:51], v1, s[8:11], s24 offen offset:0 sc1
s_waitcnt vmcnt(21)
v_mfma_f32_16x16x32_bf16 v[96:99], v[240:243], v[52:55], v[96:99]
ds_read_b64_tr_b16 v[120:121], v10 offset:8192
v_mfma_f32_16x16x32_bf16 v[100:103], v[244:247], v[52:55], v[100:103]
ds_read_b64_tr_b16 v[122:123], v10 offset:9216
v_mfma_f32_16x16x32_bf16 v[104:107], v[248:251], v[52:55], v[104:107]
ds_read_b64_tr_b16 v[124:125], v11 offset:8192
v_mfma_f32_16x16x32_bf16 v[108:111], v[252:255], v[52:55], v[108:111]
ds_read_b64_tr_b16 v[126:127], v11 offset:9216
buffer_load_dwordx4 v[52:55], v1, s[8:11], s24 offen offset:1024 sc1
s_waitcnt vmcnt(21)
v_mfma_f32_16x16x32_bf16 v[96:99], a[0:3], v[56:59], v[96:99]
v_mfma_f32_16x16x32_bf16 v[100:103], a[4:7], v[56:59], v[100:103]
v_mfma_f32_16x16x32_bf16 v[104:107], a[8:11], v[56:59], v[104:107]
v_mfma_f32_16x16x32_bf16 v[108:111], a[12:15], v[56:59], v[108:111]
buffer_load_dwordx4 v[56:59], v1, s[8:11], s24 offen offset:2048 sc1
s_waitcnt vmcnt(21) lgkmcnt(0)
v_mfma_f32_16x16x32_bf16 v[96:99], v[112:115], v[60:63], v[96:99]
v_mfma_f32_16x16x32_bf16 v[100:103], v[116:119], v[60:63], v[100:103]
v_mfma_f32_16x16x32_bf16 v[104:107], v[120:123], v[60:63], v[104:107]
v_mfma_f32_16x16x32_bf16 v[108:111], v[124:127], v[60:63], v[108:111]
buffer_load_dwordx4 v[60:63], v1, s[8:11], s24 offen offset:3072 sc1
s_waitcnt vmcnt(21)
v_mfma_f32_16x16x32_bf16 v[96:99], a[16:19], v[64:67], v[96:99]
ds_read_b64_tr_b16 v[112:113], v8 offset:12288
v_mfma_f32_16x16x32_bf16 v[100:103], a[20:23], v[64:67], v[100:103]
ds_read_b64_tr_b16 v[114:115], v8 offset:13312
v_mfma_f32_16x16x32_bf16 v[104:107], a[24:27], v[64:67], v[104:107]
ds_read_b64_tr_b16 v[116:117], v9 offset:12288
v_mfma_f32_16x16x32_bf16 v[108:111], a[28:31], v[64:67], v[108:111]
ds_read_b64_tr_b16 v[118:119], v9 offset:13312
s_waitcnt vmcnt(12)
v_cmp_ne_u32 vcc, 1, v6
s_nop 0
s_cmp_eq_u64 vcc, 0
s_cselect_b32 s50, s52, 0
s_cmp_eq_u32 s50, 1
s_cselect_b32 s49, s49, 536870912
s_add_u32 s24, s49, s30
buffer_load_dwordx4 v[64:67], v1, s[8:11], s24 offen offset:0 sc1
s_waitcnt vmcnt(21)
v_mfma_f32_16x16x32_bf16 v[96:99], a[32:35], v[68:71], v[96:99]
ds_read_b64_tr_b16 v[120:121], v10 offset:12288
v_mfma_f32_16x16x32_bf16 v[100:103], a[36:39], v[68:71], v[100:103]
ds_read_b64_tr_b16 v[122:123], v10 offset:13312
v_mfma_f32_16x16x32_bf16 v[104:107], a[40:43], v[68:71], v[104:107]
ds_read_b64_tr_b16 v[124:125], v11 offset:12288
v_mfma_f32_16x16x32_bf16 v[108:111], a[44:47], v[68:71], v[108:111]
ds_read_b64_tr_b16 v[126:127], v11 offset:13312
buffer_load_dwordx4 v[68:71], v1, s[8:11], s24 offen offset:1024 sc1
s_waitcnt vmcnt(21)
v_mfma_f32_16x16x32_bf16 v[96:99], a[48:51], v[72:75], v[96:99]
v_mfma_f32_16x16x32_bf16 v[100:103], a[52:55], v[72:75], v[100:103]
v_mfma_f32_16x16x32_bf16 v[104:107], a[56:59], v[72:75], v[104:107]
v_mfma_f32_16x16x32_bf16 v[108:111], a[60:63], v[72:75], v[108:111]
buffer_load_dwordx4 v[72:75], v1, s[8:11], s24 offen offset:2048 sc1
s_waitcnt vmcnt(21) lgkmcnt(0)
v_mfma_f32_16x16x32_bf16 v[96:99], v[112:115], v[76:79], v[96:99]
v_mfma_f32_16x16x32_bf16 v[100:103], v[116:119], v[76:79], v[100:103]
v_mfma_f32_16x16x32_bf16 v[104:107], v[120:123], v[76:79], v[104:107]
v_mfma_f32_16x16x32_bf16 v[108:111], v[124:127], v[76:79], v[108:111]
buffer_load_dwordx4 v[76:79], v1, s[8:11], s24 offen offset:3072 sc1
s_waitcnt vmcnt(21)
v_mfma_f32_16x16x32_bf16 v[96:99], a[64:67], v[80:83], v[96:99]
ds_read_b64_tr_b16 v[112:113], v8 offset:16384
v_mfma_f32_16x16x32_bf16 v[100:103], a[68:71], v[80:83], v[100:103]
ds_read_b64_tr_b16 v[114:115], v8 offset:17408
v_mfma_f32_16x16x32_bf16 v[104:107], a[72:75], v[80:83], v[104:107]
ds_read_b64_tr_b16 v[116:117], v9 offset:16384
v_mfma_f32_16x16x32_bf16 v[108:111], a[76:79], v[80:83], v[108:111]
ds_read_b64_tr_b16 v[118:119], v9 offset:17408
s_add_u32 s24, s49, s31
buffer_load_dwordx4 v[80:83], v1, s[8:11], s24 offen offset:0 sc1
s_waitcnt vmcnt(21)
v_mfma_f32_16x16x32_bf16 v[96:99], a[80:83], v[84:87], v[96:99]
ds_read_b64_tr_b16 v[120:121], v10 offset:16384
v_mfma_f32_16x16x32_bf16 v[100:103], a[84:87], v[84:87], v[100:103]
ds_read_b64_tr_b16 v[122:123], v10 offset:17408
v_mfma_f32_16x16x32_bf16 v[104:107], a[88:91], v[84:87], v[104:107]
ds_read_b64_tr_b16 v[124:125], v11 offset:16384
v_mfma_f32_16x16x32_bf16 v[108:111], a[92:95], v[84:87], v[108:111]
ds_read_b64_tr_b16 v[126:127], v11 offset:17408
buffer_load_dwordx4 v[84:87], v1, s[8:11], s24 offen offset:1024 sc1
s_waitcnt vmcnt(21)
v_mfma_f32_16x16x32_bf16 v[96:99], a[96:99], v[88:91], v[96:99]
v_mfma_f32_16x16x32_bf16 v[100:103], a[100:103], v[88:91], v[100:103]
v_mfma_f32_16x16x32_bf16 v[104:107], a[104:107], v[88:91], v[104:107]
v_mfma_f32_16x16x32_bf16 v[108:111], a[108:111], v[88:91], v[108:111]
buffer_load_dwordx4 v[88:91], v1, s[8:11], s24 offen offset:2048 sc1
s_waitcnt vmcnt(21) lgkmcnt(0)
v_mfma_f32_16x16x32_bf16 v[96:99], v[112:115], v[92:95], v[96:99]
v_mfma_f32_16x16x32_bf16 v[100:103], v[116:119], v[92:95], v[100:103]
v_mfma_f32_16x16x32_bf16 v[104:107], v[120:123], v[92:95], v[104:107]
v_mfma_f32_16x16x32_bf16 v[108:111], v[124:127], v[92:95], v[108:111]
buffer_load_dwordx4 v[92:95], v1, s[8:11], s24 offen offset:3072 sc1
s_waitcnt vmcnt(19)
v_mfma_f32_16x16x32_bf16 v[96:99], a[112:115], v[16:19], v[96:99]
ds_read_b64_tr_b16 v[112:113], v8 offset:20480
v_mfma_f32_16x16x32_bf16 v[100:103], a[116:119], v[16:19], v[100:103]
ds_read_b64_tr_b16 v[114:115], v8 offset:21504
v_mfma_f32_16x16x32_bf16 v[104:107], a[120:123], v[16:19], v[104:107]
ds_read_b64_tr_b16 v[116:117], v9 offset:20480
v_mfma_f32_16x16x32_bf16 v[108:111], a[124:127], v[16:19], v[108:111]
ds_read_b64_tr_b16 v[118:119], v9 offset:21504
s_add_u32 s24, s49, s32
buffer_load_dwordx4 v[16:19], v1, s[8:11], s24 offen offset:0 sc1
s_waitcnt vmcnt(19)
v_mfma_f32_16x16x32_bf16 v[96:99], a[128:131], v[20:23], v[96:99]
ds_read_b64_tr_b16 v[120:121], v10 offset:20480
v_mfma_f32_16x16x32_bf16 v[100:103], a[132:135], v[20:23], v[100:103]
ds_read_b64_tr_b16 v[122:123], v10 offset:21504
v_mfma_f32_16x16x32_bf16 v[104:107], a[136:139], v[20:23], v[104:107]
ds_read_b64_tr_b16 v[124:125], v11 offset:20480
v_mfma_f32_16x16x32_bf16 v[108:111], a[140:143], v[20:23], v[108:111]
ds_read_b64_tr_b16 v[126:127], v11 offset:21504
buffer_load_dwordx4 v[20:23], v1, s[8:11], s24 offen offset:1024 sc1
s_waitcnt vmcnt(19)
v_mfma_f32_16x16x32_bf16 v[96:99], a[144:147], v[24:27], v[96:99]
v_mfma_f32_16x16x32_bf16 v[100:103], a[148:151], v[24:27], v[100:103]
v_mfma_f32_16x16x32_bf16 v[104:107], a[152:155], v[24:27], v[104:107]
v_mfma_f32_16x16x32_bf16 v[108:111], a[156:159], v[24:27], v[108:111]
buffer_load_dwordx4 v[24:27], v1, s[8:11], s24 offen offset:2048 sc1
s_waitcnt vmcnt(19) lgkmcnt(0)
v_mfma_f32_16x16x32_bf16 v[96:99], v[112:115], v[28:31], v[96:99]
v_mfma_f32_16x16x32_bf16 v[100:103], v[116:119], v[28:31], v[100:103]
v_mfma_f32_16x16x32_bf16 v[104:107], v[120:123], v[28:31], v[104:107]
v_mfma_f32_16x16x32_bf16 v[108:111], v[124:127], v[28:31], v[108:111]
buffer_load_dwordx4 v[28:31], v1, s[8:11], s24 offen offset:3072 sc1
s_waitcnt vmcnt(19)
v_mfma_f32_16x16x32_bf16 v[96:99], a[160:163], v[32:35], v[96:99]
ds_read_b64_tr_b16 v[112:113], v8 offset:24576
v_mfma_f32_16x16x32_bf16 v[100:103], a[164:167], v[32:35], v[100:103]
ds_read_b64_tr_b16 v[114:115], v8 offset:25600
v_mfma_f32_16x16x32_bf16 v[104:107], a[168:171], v[32:35], v[104:107]
ds_read_b64_tr_b16 v[116:117], v9 offset:24576
v_mfma_f32_16x16x32_bf16 v[108:111], a[172:175], v[32:35], v[108:111]
ds_read_b64_tr_b16 v[118:119], v9 offset:25600
s_add_u32 s24, s49, s33
buffer_load_dwordx4 v[32:35], v1, s[8:11], s24 offen offset:0 sc1
s_waitcnt vmcnt(19)
v_mfma_f32_16x16x32_bf16 v[96:99], a[176:179], v[36:39], v[96:99]
ds_read_b64_tr_b16 v[120:121], v10 offset:24576
v_mfma_f32_16x16x32_bf16 v[100:103], a[180:183], v[36:39], v[100:103]
ds_read_b64_tr_b16 v[122:123], v10 offset:25600
v_mfma_f32_16x16x32_bf16 v[104:107], a[184:187], v[36:39], v[104:107]
ds_read_b64_tr_b16 v[124:125], v11 offset:24576
v_mfma_f32_16x16x32_bf16 v[108:111], a[188:191], v[36:39], v[108:111]
ds_read_b64_tr_b16 v[126:127], v11 offset:25600
buffer_load_dwordx4 v[36:39], v1, s[8:11], s24 offen offset:1024 sc1
s_waitcnt vmcnt(19)
v_mfma_f32_16x16x32_bf16 v[96:99], a[192:195], v[40:43], v[96:99]
v_mfma_f32_16x16x32_bf16 v[100:103], a[196:199], v[40:43], v[100:103]
v_mfma_f32_16x16x32_bf16 v[104:107], a[200:203], v[40:43], v[104:107]
v_mfma_f32_16x16x32_bf16 v[108:111], a[204:207], v[40:43], v[108:111]
buffer_load_dwordx4 v[40:43], v1, s[8:11], s24 offen offset:2048 sc1
s_waitcnt vmcnt(19) lgkmcnt(0)
v_mfma_f32_16x16x32_bf16 v[96:99], v[112:115], v[44:47], v[96:99]
v_mfma_f32_16x16x32_bf16 v[100:103], v[116:119], v[44:47], v[100:103]
v_mfma_f32_16x16x32_bf16 v[104:107], v[120:123], v[44:47], v[104:107]
v_mfma_f32_16x16x32_bf16 v[108:111], v[124:127], v[44:47], v[108:111]
buffer_load_dwordx4 v[44:47], v1, s[8:11], s24 offen offset:3072 sc1
s_waitcnt vmcnt(19)
v_mfma_f32_16x16x32_bf16 v[96:99], a[208:211], v[48:51], v[96:99]
ds_read_b64_tr_b16 v[112:113], v8 offset:28672
v_mfma_f32_16x16x32_bf16 v[100:103], a[212:215], v[48:51], v[100:103]
ds_read_b64_tr_b16 v[114:115], v8 offset:29696
v_mfma_f32_16x16x32_bf16 v[104:107], a[216:219], v[48:51], v[104:107]
ds_read_b64_tr_b16 v[116:117], v9 offset:28672
v_mfma_f32_16x16x32_bf16 v[108:111], a[220:223], v[48:51], v[108:111]
ds_read_b64_tr_b16 v[118:119], v9 offset:29696
s_add_u32 s24, s49, s34
buffer_load_dwordx4 v[48:51], v1, s[8:11], s24 offen offset:0 sc1
s_waitcnt vmcnt(19)
v_mfma_f32_16x16x32_bf16 v[96:99], a[224:227], v[52:55], v[96:99]
ds_read_b64_tr_b16 v[120:121], v10 offset:28672
v_mfma_f32_16x16x32_bf16 v[100:103], a[228:231], v[52:55], v[100:103]
ds_read_b64_tr_b16 v[122:123], v10 offset:29696
v_mfma_f32_16x16x32_bf16 v[104:107], a[232:235], v[52:55], v[104:107]
ds_read_b64_tr_b16 v[124:125], v11 offset:28672
v_mfma_f32_16x16x32_bf16 v[108:111], a[236:239], v[52:55], v[108:111]
ds_read_b64_tr_b16 v[126:127], v11 offset:29696
buffer_load_dwordx4 v[52:55], v1, s[8:11], s24 offen offset:1024 sc1
s_waitcnt vmcnt(19)
v_mfma_f32_16x16x32_bf16 v[96:99], a[240:243], v[56:59], v[96:99]
v_mfma_f32_16x16x32_bf16 v[100:103], a[244:247], v[56:59], v[100:103]
v_mfma_f32_16x16x32_bf16 v[104:107], a[248:251], v[56:59], v[104:107]
v_mfma_f32_16x16x32_bf16 v[108:111], a[252:255], v[56:59], v[108:111]
buffer_load_dwordx4 v[56:59], v1, s[8:11], s24 offen offset:2048 sc1
s_waitcnt vmcnt(19) lgkmcnt(0)
v_mfma_f32_16x16x32_bf16 v[96:99], v[112:115], v[60:63], v[96:99]
v_mfma_f32_16x16x32_bf16 v[100:103], v[116:119], v[60:63], v[100:103]
v_mfma_f32_16x16x32_bf16 v[104:107], v[120:123], v[60:63], v[104:107]
v_mfma_f32_16x16x32_bf16 v[108:111], v[124:127], v[60:63], v[108:111]
buffer_load_dwordx4 v[60:63], v1, s[8:11], s24 offen offset:3072 sc1
s_nop 3
ds_write_b128 v3, v[96:99] offset:0
ds_write_b128 v3, v[100:103] offset:4096
ds_write_b128 v3, v[104:107] offset:8192
ds_write_b128 v3, v[108:111] offset:12288
s_waitcnt lgkmcnt(0)
s_barrier
ds_read_b128 v[96:99], v7 offset:0
ds_read_b128 v[100:103], v7 offset:1024
ds_read_b128 v[104:107], v7 offset:2048
ds_read_b128 v[108:111], v7 offset:3072
ds_read_b64_tr_b16 v[112:113], v8 offset:0
ds_read_b64_tr_b16 v[114:115], v8 offset:1024
ds_read_b64_tr_b16 v[116:117], v9 offset:0
ds_read_b64_tr_b16 v[118:119], v9 offset:1024
ds_read_b64_tr_b16 v[120:121], v10 offset:0
ds_read_b64_tr_b16 v[122:123], v10 offset:1024
ds_read_b64_tr_b16 v[124:125], v11 offset:0
ds_read_b64_tr_b16 v[126:127], v11 offset:1024
s_mul_i32 s24, s41, 36864
s_waitcnt lgkmcnt(10)
v_pk_add_f32 v[96:97], v[96:97], v[100:101]
v_pk_add_f32 v[98:99], v[98:99], v[102:103]
s_waitcnt lgkmcnt(9)
v_pk_add_f32 v[96:97], v[96:97], v[104:105]
v_pk_add_f32 v[98:99], v[98:99], v[106:107]
s_waitcnt lgkmcnt(8)
v_pk_add_f32 v[96:97], v[96:97], v[108:109]
v_pk_add_f32 v[98:99], v[98:99], v[110:111]
v_cvt_pk_bf16_f32 v12, v96, v97
v_cvt_pk_bf16_f32 v13, v98, v99
buffer_store_dwordx2 v[12:13], v4, s[12:15], s24 offen
v_xor_b32 v3, 16384, v3
v_xor_b32 v7, 16384, v7
s_mov_b32 s41, s27
s_mov_b32 s48, s49
s_cmp_eq_u32 s50, 0
s_cbranch_scc1 L_opl_c
L_opl_r1:
s_cmp_lg_u64 s[42:43], 0
s_cselect_b32 s52, 1, 0
s_ff1_i32_b64 s27, s[42:43]
s_bitset0_b64 s[42:43], s27
s_lshl_b32 s27, s27, 1
s_add_u32 s27, s27, s51
s_and_b32 s27, s27, 127
s_lshr_b32 s25, s27, s46
s_lshl_b32 s25, s25, 7
s_add_u32 s25, s25, s45
buffer_load_dword v6, v5, s[8:11], s25 offen sc1
s_lshl_b32 s49, s27, 17
s_add_u32 s49, s49, s44
s_waitcnt vmcnt(21)
v_mfma_f32_16x16x32_bf16 v[96:99], v[128:131], v[64:67], 0
v_mfma_f32_16x16x32_bf16 v[100:103], v[132:135], v[64:67], 0
v_mfma_f32_16x16x32_bf16 v[104:107], v[136:139], v[64:67], 0
v_mfma_f32_16x16x32_bf16 v[108:111], v[140:143], v[64:67], 0
s_add_u32 s24, s48, s35
buffer_load_dwordx4 v[64:67], v1, s[8:11], s24 offen offset:0 sc1
s_waitcnt vmcnt(21)
v_mfma_f32_16x16x32_bf16 v[96:99], v[144:147], v[68:71], v[96:99]
v_mfma_f32_16x16x32_bf16 v[100:103], v[148:151], v[68:71], v[100:103]
v_mfma_f32_16x16x32_bf16 v[104:107], v[152:155], v[68:71], v[104:107]
v_mfma_f32_16x16x32_bf16 v[108:111], v[156:159], v[68:71], v[108:111]
buffer_load_dwordx4 v[68:71], v1, s[8:11], s24 offen offset:1024 sc1
s_waitcnt vmcnt(21)
v_mfma_f32_16x16x32_bf16 v[96:99], v[160:163], v[72:75], v[96:99]
v_mfma_f32_16x16x32_bf16 v[100:103], v[164:167], v[72:75], v[100:103]
v_mfma_f32_16x16x32_bf16 v[104:107], v[168:171], v[72:75], v[104:107]
v_mfma_f32_16x16x32_bf16 v[108:111], v[172:175], v[72:75], v[108:111]
buffer_load_dwordx4 v[72:75], v1, s[8:11], s24 offen offset:2048 sc1
s_waitcnt vmcnt(21) lgkmcnt(0)
v_mfma_f32_16x16x32_bf16 v[96:99], v[112:115], v[76:79], v[96:99]
v_mfma_f32_16x16x32_bf16 v[100:103], v[116:119], v[76:79], v[100:103]
v_mfma_f32_16x16x32_bf16 v[104:107], v[120:123], v[76:79], v[104:107]
v_mfma_f32_16x16x32_bf16 v[108:111], v[124:127], v[76:79], v[108:111]
buffer_load_dwordx4 v[76:79], v1, s[8:11], s24 offen offset:3072 sc1
s_waitcnt vmcnt(21)
v_mfma_f32_16x16x32_bf16 v[96:99], v[176:179], v[80:83], v[96:99]
ds_read_b64_tr_b16 v[112:113], v8 offset:4096
v_mfma_f32_16x16x32_bf16 v[100:103], v[180:183], v[80:83], v[100:103]
ds_read_b64_tr_b16 v[114:115], v8 offset:5120
v_mfma_f32_16x16x32_bf16 v[104:107], v[184:187], v[80:83], v[104:107]
ds_read_b64_tr_b16 v[116:117], v9 offset:4096
v_mfma_f32_16x16x32_bf16 v[108:111], v[188:191], v[80:83], v[108:111]
ds_read_b64_tr_b16 v[118:119], v9 offset:5120
s_add_u32 s24, s48, s36
buffer_load_dwordx4 v[80:83], v1, s[8:11], s24 offen offset:0 sc1
s_waitcnt vmcnt(21)
v_mfma_f32_16x16x32_bf16 v[96:99], v[192:195], v[84:87], v[96:99]
ds_read_b64_tr_b16 v[120:121], v10 offset:4096
v_mfma_f32_16x16x32_bf16 v[100:103], v[196:199], v[84:87], v[100:103]
ds_read_b64_tr_b16 v[122:123], v10 offset:5120
v_mfma_f32_16x16x32_bf16 v[104:107], v[200:203], v[84:87], v[104:107]
ds_read_b64_tr_b16 v[124:125], v11 offset:4096
v_mfma_f32_16x16x32_bf16 v[108:111], v[204:207], v[84:87], v[108:111]
ds_read_b64_tr_b16 v[126:127], v11 offset:5120
buffer_load_dwordx4 v[84:87], v1, s[8:11], s24 offen offset:1024 sc1
s_waitcnt vmcnt(21)
v_mfma_f32_16x16x32_bf16 v[96:99], v[208:211], v[88:91], v[96:99]
v_mfma_f32_16x16x32_bf16 v[100:103], v[212:215], v[88:91], v[100:103]
v_mfma_f32_16x16x32_bf16 v[104:107], v[216:219], v[88:91], v[104:107]
v_mfma_f32_16x16x32_bf16 v[108:111], v[220:223], v[88:91], v[108:111]
buffer_load_dwordx4 v[88:91], v1, s[8:11], s24 offen offset:2048 sc1
s_waitcnt vmcnt(21) lgkmcnt(0)
v_mfma_f32_16x16x32_bf16 v[96:99], v[112:115], v[92:95], v[96:99]
v_mfma_f32_16x16x32_bf16 v[100:103], v[116:119], v[92:95], v[100:103]
v_mfma_f32_16x16x32_bf16 v[104:107], v[120:123], v[92:95], v[104:107]
v_mfma_f32_16x16x32_bf16 v[108:111], v[124:127], v[92:95], v[108:111]
buffer_load_dwordx4 v[92:95], v1, s[8:11], s24 offen offset:3072 sc1
s_waitcnt vmcnt(21)
v_mfma_f32_16x16x32_bf16 v[96:99], v[224:227], v[16:19], v[96:99]
ds_read_b64_tr_b16 v[112:113], v8 offset:8192
v_mfma_f32_16x16x32_bf16 v[100:103], v[228:231], v[16:19], v[100:103]
ds_read_b64_tr_b16 v[114:115], v8 offset:9216
v_mfma_f32_16x16x32_bf16 v[104:107], v[232:235], v[16:19], v[104:107]
ds_read_b64_tr_b16 v[116:117], v9 offset:8192
v_mfma_f32_16x16x32_bf16 v[108:111], v[236:239], v[16:19], v[108:111]
ds_read_b64_tr_b16 v[118:119], v9 offset:9216
s_add_u32 s24, s48, s37
buffer_load_dwordx4 v[16:19], v1, s[8:11], s24 offen offset:0 sc1
s_waitcnt vmcnt(21)
v_mfma_f32_16x16x32_bf16 v[96:99], v[240:243], v[20:23], v[96:99]
ds_read_b64_tr_b16 v[120:121], v10 offset:8192
v_mfma_f32_16x16x32_bf16 v[100:103], v[244:247], v[20:23], v[100:103]
ds_read_b64_tr_b16 v[122:123], v10 offset:9216
v_mfma_f32_16x16x32_bf16 v[104:107], v[248:251], v[20:23], v[104:107]
ds_read_b64_tr_b16 v[124:125], v11 offset:8192
v_mfma_f32_16x16x32_bf16 v[108:111], v[252:255], v[20:23], v[108:111]
ds_read_b64_tr_b16 v[126:127], v11 offset:9216
buffer_load_dwordx4 v[20:23], v1, s[8:11], s24 offen offset:1024 sc1
s_waitcnt vmcnt(21)
v_mfma_f32_16x16x32_bf16 v[96:99], a[0:3], v[24:27], v[96:99]
v_mfma_f32_16x16x32_bf16 v[100:103], a[4:7], v[24:27], v[100:103]
v_mfma_f32_16x16x32_bf16 v[104:107], a[8:11], v[24:27], v[104:107]
v_mfma_f32_16x16x32_bf16 v[108:111], a[12:15], v[24:27], v[108:111]
buffer_load_dwordx4 v[24:27], v1, s[8:11], s24 offen offset:2048 sc1
s_waitcnt vmcnt(21) lgkmcnt(0)
v_mfma_f32_16x16x32_bf16 v[96:99], v[112:115], v[28:31], v[96:99]
v_mfma_f32_16x16x32_bf16 v[100:103], v[116:119], v[28:31], v[100:103]
v_mfma_f32_16x16x32_bf16 v[104:107], v[120:123], v[28:31], v[104:107]
v_mfma_f32_16x16x32_bf16 v[108:111], v[124:127], v[28:31], v[108:111]
buffer_load_dwordx4 v[28:31], v1, s[8:11], s24 offen offset:3072 sc1
s_waitcnt vmcnt(21)
v_mfma_f32_16x16x32_bf16 v[96:99], a[16:19], v[32:35], v[96:99]
ds_read_b64_tr_b16 v[112:113], v8 offset:12288
v_mfma_f32_16x16x32_bf16 v[100:103], a[20:23], v[32:35], v[100:103]
ds_read_b64_tr_b16 v[114:115], v8 offset:13312
v_mfma_f32_16x16x32_bf16 v[104:107], a[24:27], v[32:35], v[104:107]
ds_read_b64_tr_b16 v[116:117], v9 offset:12288
v_mfma_f32_16x16x32_bf16 v[108:111], a[28:31], v[32:35], v[108:111]
ds_read_b64_tr_b16 v[118:119], v9 offset:13312
s_waitcnt vmcnt(12)
v_cmp_ne_u32 vcc, 1, v6
s_nop 0
s_cmp_eq_u64 vcc, 0
s_cselect_b32 s50, s52, 0
s_cmp_eq_u32 s50, 1
s_cselect_b32 s49, s49, 536870912
s_add_u32 s24, s49, s30
buffer_load_dwordx4 v[32:35], v1, s[8:11], s24 offen offset:0 sc1
s_waitcnt vmcnt(21)
v_mfma_f32_16x16x32_bf16 v[96:99], a[32:35], v[36:39], v[96:99]
ds_read_b64_tr_b16 v[120:121], v10 offset:12288
v_mfma_f32_16x16x32_bf16 v[100:103], a[36:39], v[36:39], v[100:103]
ds_read_b64_tr_b16 v[122:123], v10 offset:13312
v_mfma_f32_16x16x32_bf16 v[104:107], a[40:43], v[36:39], v[104:107]
ds_read_b64_tr_b16 v[124:125], v11 offset:12288
v_mfma_f32_16x16x32_bf16 v[108:111], a[44:47], v[36:39], v[108:111]
ds_read_b64_tr_b16 v[126:127], v11 offset:13312
buffer_load_dwordx4 v[36:39], v1, s[8:11], s24 offen offset:1024 sc1
s_waitcnt vmcnt(21)
v_mfma_f32_16x16x32_bf16 v[96:99], a[48:51], v[40:43], v[96:99]
v_mfma_f32_16x16x32_bf16 v[100:103], a[52:55], v[40:43], v[100:103]
v_mfma_f32_16x16x32_bf16 v[104:107], a[56:59], v[40:43], v[104:107]
v_mfma_f32_16x16x32_bf16 v[108:111], a[60:63], v[40:43], v[108:111]
buffer_load_dwordx4 v[40:43], v1, s[8:11], s24 offen offset:2048 sc1
s_waitcnt vmcnt(21) lgkmcnt(0)
v_mfma_f32_16x16x32_bf16 v[96:99], v[112:115], v[44:47], v[96:99]
v_mfma_f32_16x16x32_bf16 v[100:103], v[116:119], v[44:47], v[100:103]
v_mfma_f32_16x16x32_bf16 v[104:107], v[120:123], v[44:47], v[104:107]
v_mfma_f32_16x16x32_bf16 v[108:111], v[124:127], v[44:47], v[108:111]
buffer_load_dwordx4 v[44:47], v1, s[8:11], s24 offen offset:3072 sc1
s_waitcnt vmcnt(21)
v_mfma_f32_16x16x32_bf16 v[96:99], a[64:67], v[48:51], v[96:99]
ds_read_b64_tr_b16 v[112:113], v8 offset:16384
v_mfma_f32_16x16x32_bf16 v[100:103], a[68:71], v[48:51], v[100:103]
ds_read_b64_tr_b16 v[114:115], v8 offset:17408
v_mfma_f32_16x16x32_bf16 v[104:107], a[72:75], v[48:51], v[104:107]
ds_read_b64_tr_b16 v[116:117], v9 offset:16384
v_mfma_f32_16x16x32_bf16 v[108:111], a[76:79], v[48:51], v[108:111]
ds_read_b64_tr_b16 v[118:119], v9 offset:17408
s_add_u32 s24, s49, s31
buffer_load_dwordx4 v[48:51], v1, s[8:11], s24 offen offset:0 sc1
s_waitcnt vmcnt(21)
v_mfma_f32_16x16x32_bf16 v[96:99], a[80:83], v[52:55], v[96:99]
ds_read_b64_tr_b16 v[120:121], v10 offset:16384
v_mfma_f32_16x16x32_bf16 v[100:103], a[84:87], v[52:55], v[100:103]
ds_read_b64_tr_b16 v[122:123], v10 offset:17408
v_mfma_f32_16x16x32_bf16 v[104:107], a[88:91], v[52:55], v[104:107]
ds_read_b64_tr_b16 v[124:125], v11 offset:16384
v_mfma_f32_16x16x32_bf16 v[108:111], a[92:95], v[52:55], v[108:111]
ds_read_b64_tr_b16 v[126:127], v11 offset:17408
buffer_load_dwordx4 v[52:55], v1, s[8:11], s24 offen offset:1024 sc1
s_waitcnt vmcnt(21)
v_mfma_f32_16x16x32_bf16 v[96:99], a[96:99], v[56:59], v[96:99]
v_mfma_f32_16x16x32_bf16 v[100:103], a[100:103], v[56:59], v[100:103]
v_mfma_f32_16x16x32_bf16 v[104:107], a[104:107], v[56:59], v[104:107]
v_mfma_f32_16x16x32_bf16 v[108:111], a[108:111], v[56:59], v[108:111]
buffer_load_dwordx4 v[56:59], v1, s[8:11], s24 offen offset:2048 sc1
s_waitcnt vmcnt(21) lgkmcnt(0)
v_mfma_f32_16x16x32_bf16 v[96:99], v[112:115], v[60:63], v[96:99]
v_mfma_f32_16x16x32_bf16 v[100:103], v[116:119], v[60:63], v[100:103]
v_mfma_f32_16x16x32_bf16 v[104:107], v[120:123], v[60:63], v[104:107]
v_mfma_f32_16x16x32_bf16 v[108:111], v[124:127], v[60:63], v[108:111]
buffer_load_dwordx4 v[60:63], v1, s[8:11], s24 offen offset:3072 sc1
s_waitcnt vmcnt(19)
v_mfma_f32_16x16x32_bf16 v[96:99], a[112:115], v[64:67], v[96:99]
ds_read_b64_tr_b16 v[112:113], v8 offset:20480
v_mfma_f32_16x16x32_bf16 v[100:103], a[116:119], v[64:67], v[100:103]
ds_read_b64_tr_b16 v[114:115], v8 offset:21504
v_mfma_f32_16x16x32_bf16 v[104:107], a[120:123], v[64:67], v[104:107]
ds_read_b64_tr_b16 v[116:117], v9 offset:20480
v_mfma_f32_16x16x32_bf16 v[108:111], a[124:127], v[64:67], v[108:111]
ds_read_b64_tr_b16 v[118:119], v9 offset:21504
s_add_u32 s24, s49, s32
buffer_load_dwordx4 v[64:67], v1, s[8:11], s24 offen offset:0 sc1
s_waitcnt vmcnt(19)
v_mfma_f32_16x16x32_bf16 v[96:99], a[128:131], v[68:71], v[96:99]
ds_read_b64_tr_b16 v[120:121], v10 offset:20480
v_mfma_f32_16x16x32_bf16 v[100:103], a[132:135], v[68:71], v[100:103]
ds_read_b64_tr_b16 v[122:123], v10 offset:21504
v_mfma_f32_16x16x32_bf16 v[104:107], a[136:139], v[68:71], v[104:107]
ds_read_b64_tr_b16 v[124:125], v11 offset:20480
v_mfma_f32_16x16x32_bf16 v[108:111], a[140:143], v[68:71], v[108:111]
ds_read_b64_tr_b16 v[126:127], v11 offset:21504
buffer_load_dwordx4 v[68:71], v1, s[8:11], s24 offen offset:1024 sc1
s_waitcnt vmcnt(19)
v_mfma_f32_16x16x32_bf16 v[96:99], a[144:147], v[72:75], v[96:99]
v_mfma_f32_16x16x32_bf16 v[100:103], a[148:151], v[72:75], v[100:103]
v_mfma_f32_16x16x32_bf16 v[104:107], a[152:155], v[72:75], v[104:107]
v_mfma_f32_16x16x32_bf16 v[108:111], a[156:159], v[72:75], v[108:111]
buffer_load_dwordx4 v[72:75], v1, s[8:11], s24 offen offset:2048 sc1
s_waitcnt vmcnt(19) lgkmcnt(0)
v_mfma_f32_16x16x32_bf16 v[96:99], v[112:115], v[76:79], v[96:99]
v_mfma_f32_16x16x32_bf16 v[100:103], v[116:119], v[76:79], v[100:103]
v_mfma_f32_16x16x32_bf16 v[104:107], v[120:123], v[76:79], v[104:107]
v_mfma_f32_16x16x32_bf16 v[108:111], v[124:127], v[76:79], v[108:111]
buffer_load_dwordx4 v[76:79], v1, s[8:11], s24 offen offset:3072 sc1
s_waitcnt vmcnt(19)
v_mfma_f32_16x16x32_bf16 v[96:99], a[160:163], v[80:83], v[96:99]
ds_read_b64_tr_b16 v[112:113], v8 offset:24576
v_mfma_f32_16x16x32_bf16 v[100:103], a[164:167], v[80:83], v[100:103]
ds_read_b64_tr_b16 v[114:115], v8 offset:25600
v_mfma_f32_16x16x32_bf16 v[104:107], a[168:171], v[80:83], v[104:107]
ds_read_b64_tr_b16 v[116:117], v9 offset:24576
v_mfma_f32_16x16x32_bf16 v[108:111], a[172:175], v[80:83], v[108:111]
ds_read_b64_tr_b16 v[118:119], v9 offset:25600
s_add_u32 s24, s49, s33
buffer_load_dwordx4 v[80:83], v1, s[8:11], s24 offen offset:0 sc1
s_waitcnt vmcnt(19)
v_mfma_f32_16x16x32_bf16 v[96:99], a[176:179], v[84:87], v[96:99]
ds_read_b64_tr_b16 v[120:121], v10 offset:24576
v_mfma_f32_16x16x32_bf16 v[100:103], a[180:183], v[84:87], v[100:103]
ds_read_b64_tr_b16 v[122:123], v10 offset:25600
v_mfma_f32_16x16x32_bf16 v[104:107], a[184:187], v[84:87], v[104:107]
ds_read_b64_tr_b16 v[124:125], v11 offset:24576
v_mfma_f32_16x16x32_bf16 v[108:111], a[188:191], v[84:87], v[108:111]
ds_read_b64_tr_b16 v[126:127], v11 offset:25600
buffer_load_dwordx4 v[84:87], v1, s[8:11], s24 offen offset:1024 sc1
s_waitcnt vmcnt(19)
v_mfma_f32_16x16x32_bf16 v[96:99], a[192:195], v[88:91], v[96:99]
v_mfma_f32_16x16x32_bf16 v[100:103], a[196:199], v[88:91], v[100:103]
v_mfma_f32_16x16x32_bf16 v[104:107], a[200:203], v[88:91], v[104:107]
v_mfma_f32_16x16x32_bf16 v[108:111], a[204:207], v[88:91], v[108:111]
buffer_load_dwordx4 v[88:91], v1, s[8:11], s24 offen offset:2048 sc1
s_waitcnt vmcnt(19) lgkmcnt(0)
v_mfma_f32_16x16x32_bf16 v[96:99], v[112:115], v[92:95], v[96:99]
v_mfma_f32_16x16x32_bf16 v[100:103], v[116:119], v[92:95], v[100:103]
v_mfma_f32_16x16x32_bf16 v[104:107], v[120:123], v[92:95], v[104:107]
v_mfma_f32_16x16x32_bf16 v[108:111], v[124:127], v[92:95], v[108:111]
buffer_load_dwordx4 v[92:95], v1, s[8:11], s24 offen offset:3072 sc1
s_waitcnt vmcnt(19)
v_mfma_f32_16x16x32_bf16 v[96:99], a[208:211], v[16:19], v[96:99]
ds_read_b64_tr_b16 v[112:113], v8 offset:28672
v_mfma_f32_16x16x32_bf16 v[100:103], a[212:215], v[16:19], v[100:103]
ds_read_b64_tr_b16 v[114:115], v8 offset:29696
v_mfma_f32_16x16x32_bf16 v[104:107], a[216:219], v[16:19], v[104:107]
ds_read_b64_tr_b16 v[116:117], v9 offset:28672
v_mfma_f32_16x16x32_bf16 v[108:111], a[220:223], v[16:19], v[108:111]
ds_read_b64_tr_b16 v[118:119], v9 offset:29696
s_add_u32 s24, s49, s34
buffer_load_dwordx4 v[16:19], v1, s[8:11], s24 offen offset:0 sc1
s_waitcnt vmcnt(19)
v_mfma_f32_16x16x32_bf16 v[96:99], a[224:227], v[20:23], v[96:99]
ds_read_b64_tr_b16 v[120:121], v10 offset:28672
v_mfma_f32_16x16x32_bf16 v[100:103], a[228:231], v[20:23], v[100:103]
ds_read_b64_tr_b16 v[122:123], v10 offset:29696
v_mfma_f32_16x16x32_bf16 v[104:107], a[232:235], v[20:23], v[104:107]
ds_read_b64_tr_b16 v[124:125], v11 offset:28672
v_mfma_f32_16x16x32_bf16 v[108:111], a[236:239], v[20:23], v[108:111]
ds_read_b64_tr_b16 v[126:127], v11 offset:29696
buffer_load_dwordx4 v[20:23], v1, s[8:11], s24 offen offset:1024 sc1
s_waitcnt vmcnt(19)
v_mfma_f32_16x16x32_bf16 v[96:99], a[240:243], v[24:27], v[96:99]
v_mfma_f32_16x16x32_bf16 v[100:103], a[244:247], v[24:27], v[100:103]
v_mfma_f32_16x16x32_bf16 v[104:107], a[248:251], v[24:27], v[104:107]
v_mfma_f32_16x16x32_bf16 v[108:111], a[252:255], v[24:27], v[108:111]
buffer_load_dwordx4 v[24:27], v1, s[8:11], s24 offen offset:2048 sc1
s_waitcnt vmcnt(19) lgkmcnt(0)
v_mfma_f32_16x16x32_bf16 v[96:99], v[112:115], v[28:31], v[96:99]
v_mfma_f32_16x16x32_bf16 v[100:103], v[116:119], v[28:31], v[100:103]
v_mfma_f32_16x16x32_bf16 v[104:107], v[120:123], v[28:31], v[104:107]
v_mfma_f32_16x16x32_bf16 v[108:111], v[124:127], v[28:31], v[108:111]
buffer_load_dwordx4 v[28:31], v1, s[8:11], s24 offen offset:3072 sc1
s_nop 3
ds_write_b128 v3, v[96:99] offset:0
ds_write_b128 v3, v[100:103] offset:4096
ds_write_b128 v3, v[104:107] offset:8192
ds_write_b128 v3, v[108:111] offset:12288
s_waitcnt lgkmcnt(0)
s_barrier
ds_read_b128 v[96:99], v7 offset:0
ds_read_b128 v[100:103], v7 offset:1024
ds_read_b128 v[104:107], v7 offset:2048
ds_read_b128 v[108:111], v7 offset:3072
ds_read_b64_tr_b16 v[112:113], v8 offset:0
ds_read_b64_tr_b16 v[114:115], v8 offset:1024
ds_read_b64_tr_b16 v[116:117], v9 offset:0
ds_read_b64_tr_b16 v[118:119], v9 offset:1024
ds_read_b64_tr_b16 v[120:121], v10 offset:0
ds_read_b64_tr_b16 v[122:123], v10 offset:1024
ds_read_b64_tr_b16 v[124:125], v11 offset:0
ds_read_b64_tr_b16 v[126:127], v11 offset:1024
s_mul_i32 s24, s41, 36864
s_waitcnt lgkmcnt(10)
v_pk_add_f32 v[96:97], v[96:97], v[100:101]
v_pk_add_f32 v[98:99], v[98:99], v[102:103]
s_waitcnt lgkmcnt(9)
v_pk_add_f32 v[96:97], v[96:97], v[104:105]
v_pk_add_f32 v[98:99], v[98:99], v[106:107]
s_waitcnt lgkmcnt(8)
v_pk_add_f32 v[96:97], v[96:97], v[108:109]
v_pk_add_f32 v[98:99], v[98:99], v[110:111]
v_cvt_pk_bf16_f32 v12, v96, v97
v_cvt_pk_bf16_f32 v13, v98, v99
buffer_store_dwordx2 v[12:13], v4, s[12:15], s24 offen
v_xor_b32 v3, 16384, v3
v_xor_b32 v7, 16384, v7
s_mov_b32 s41, s27
s_mov_b32 s48, s49
s_cmp_eq_u32 s50, 0
s_cbranch_scc1 L_opl_c
L_opl_r2:
s_cmp_lg_u64 s[42:43], 0
s_cselect_b32 s52, 1, 0
s_ff1_i32_b64 s27, s[42:43]
s_bitset0_b64 s[42:43], s27
s_lshl_b32 s27, s27, 1
s_add_u32 s27, s27, s51
s_and_b32 s27, s27, 127
s_lshr_b32 s25, s27, s46
s_lshl_b32 s25, s25, 7
s_add_u32 s25, s25, s45
buffer_load_dword v6, v5, s[8:11], s25 offen sc1
s_lshl_b32 s49, s27, 17
s_add_u32 s49, s49, s44
s_waitcnt vmcnt(21)
v_mfma_f32_16x16x32_bf16 v[96:99], v[128:131], v[32:35], 0
v_mfma_f32_16x16x32_bf16 v[100:103], v[132:135], v[32:35], 0
v_mfma_f32_16x16x32_bf16 v[104:107], v[136:139], v[32:35], 0
v_mfma_f32_16x16x32_bf16 v[108:111], v[140:143], v[32:35], 0
s_add_u32 s24, s48, s35
buffer_load_dwordx4 v[32:35], v1, s[8:11], s24 offen offset:0 sc1
s_waitcnt vmcnt(21)
v_mfma_f32_16x16x32_bf16 v[96:99], v[144:147], v[36:39], v[96:99]
v_mfma_f32_16x16x32_bf16 v[100:103], v[148:151], v[36:39], v[100:103]
v_mfma_f32_16x16x32_bf16 v[104:107], v[152:155], v[36:39], v[104:107]
v_mfma_f32_16x16x32_bf16 v[108:111], v[156:159], v[36:39], v[108:111]
buffer_load_dwordx4 v[36:39], v1, s[8:11], s24 offen offset:1024 sc1
s_waitcnt vmcnt(21)
v_mfma_f32_16x16x32_bf16 v[96:99], v[160:163], v[40:43], v[96:99]
v_mfma_f32_16x16x32_bf16 v[100:103], v[164:167], v[40:43], v[100:103]
v_mfma_f32_16x16x32_bf16 v[104:107], v[168:171], v[40:43], v[104:107]
v_mfma_f32_16x16x32_bf16 v[108:111], v[172:175], v[40:43], v[108:111]
buffer_load_dwordx4 v[40:43], v1, s[8:11], s24 offen offset:2048 sc1
s_waitcnt vmcnt(21) lgkmcnt(0)
v_mfma_f32_16x16x32_bf16 v[96:99], v[112:115], v[44:47], v[96:99]
v_mfma_f32_16x16x32_bf16 v[100:103], v[116:119], v[44:47], v[100:103]
v_mfma_f32_16x16x32_bf16 v[104:107], v[120:123], v[44:47], v[104:107]
v_mfma_f32_16x16x32_bf16 v[108:111], v[124:127], v[44:47], v[108:111]
buffer_load_dwordx4 v[44:47], v1, s[8:11], s24 offen offset:3072 sc1
s_waitcnt vmcnt(21)
v_mfma_f32_16x16x32_bf16 v[96:99], v[176:179], v[48:51], v[96:99]
ds_read_b64_tr_b16 v[112:113], v8 offset:4096
v_mfma_f32_16x16x32_bf16 v[100:103], v[180:183], v[48:51], v[100:103]
ds_read_b64_tr_b16 v[114:115], v8 offset:5120
v_mfma_f32_16x16x32_bf16 v[104:107], v[184:187], v[48:51], v[104:107]
ds_read_b64_tr_b16 v[116:117], v9 offset:4096
v_mfma_f32_16x16x32_bf16 v[108:111], v[188:191], v[48:51], v[108:111]
ds_read_b64_tr_b16 v[118:119], v9 offset:5120
s_add_u32 s24, s48, s36
buffer_load_dwordx4 v[48:51], v1, s[8:11], s24 offen offset:0 sc1
s_waitcnt vmcnt(21)
v_mfma_f32_16x16x32_bf16 v[96:99], v[192:195], v[52:55], v[96:99]
ds_read_b64_tr_b16 v[120:121], v10 offset:4096
v_mfma_f32_16x16x32_bf16 v[100:103], v[196:199], v[52:55], v[100:103]
ds_read_b64_tr_b16 v[122:123], v10 offset:5120
v_mfma_f32_16x16x32_bf16 v[104:107], v[200:203], v[52:55], v[104:107]
ds_read_b64_tr_b16 v[124:125], v11 offset:4096
v_mfma_f32_16x16x32_bf16 v[108:111], v[204:207], v[52:55], v[108:111]
ds_read_b64_tr_b16 v[126:127], v11 offset:5120
buffer_load_dwordx4 v[52:55], v1, s[8:11], s24 offen offset:1024 sc1
s_waitcnt vmcnt(21)
v_mfma_f32_16x16x32_bf16 v[96:99], v[208:211], v[56:59], v[96:99]
v_mfma_f32_16x16x32_bf16 v[100:103], v[212:215], v[56:59], v[100:103]
v_mfma_f32_16x16x32_bf16 v[104:107], v[216:219], v[56:59], v[104:107]
v_mfma_f32_16x16x32_bf16 v[108:111], v[220:223], v[56:59], v[108:111]
buffer_load_dwordx4 v[56:59], v1, s[8:11], s24 offen offset:2048 sc1
s_waitcnt vmcnt(21) lgkmcnt(0)
v_mfma_f32_16x16x32_bf16 v[96:99], v[112:115], v[60:63], v[96:99]
v_mfma_f32_16x16x32_bf16 v[100:103], v[116:119], v[60:63], v[100:103]
v_mfma_f32_16x16x32_bf16 v[104:107], v[120:123], v[60:63], v[104:107]
v_mfma_f32_16x16x32_bf16 v[108:111], v[124:127], v[60:63], v[108:111]
buffer_load_dwordx4 v[60:63], v1, s[8:11], s24 offen offset:3072 sc1
s_waitcnt vmcnt(21)
v_mfma_f32_16x16x32_bf16 v[96:99], v[224:227], v[64:67], v[96:99]
ds_read_b64_tr_b16 v[112:113], v8 offset:8192
v_mfma_f32_16x16x32_bf16 v[100:103], v[228:231], v[64:67], v[100:103]
ds_read_b64_tr_b16 v[114:115], v8 offset:9216
v_mfma_f32_16x16x32_bf16 v[104:107], v[232:235], v[64:67], v[104:107]
ds_read_b64_tr_b16 v[116:117], v9 offset:8192
v_mfma_f32_16x16x32_bf16 v[108:111], v[236:239], v[64:67], v[108:111]
ds_read_b64_tr_b16 v[118:119], v9 offset:9216
s_add_u32 s24, s48, s37
buffer_load_dwordx4 v[64:67], v1, s[8:11], s24 offen offset:0 sc1
s_waitcnt vmcnt(21)
v_mfma_f32_16x16x32_bf16 v[96:99], v[240:243], v[68:71], v[96:99]
ds_read_b64_tr_b16 v[120:121], v10 offset:8192
v_mfma_f32_16x16x32_bf16 v[100:103], v[244:247], v[68:71], v[100:103]
ds_read_b64_tr_b16 v[122:123], v10 offset:9216
v_mfma_f32_16x16x32_bf16 v[104:107], v[248:251], v[68:71], v[104:107]
ds_read_b64_tr_b16 v[124:125], v11 offset:8192
v_mfma_f32_16x16x32_bf16 v[108:111], v[252:255], v[68:71], v[108:111]
ds_read_b64_tr_b16 v[126:127], v11 offset:9216
buffer_load_dwordx4 v[68:71], v1, s[8:11], s24 offen offset:1024 sc1
s_waitcnt vmcnt(21)
v_mfma_f32_16x16x32_bf16 v[96:99], a[0:3], v[72:75], v[96:99]
v_mfma_f32_16x16x32_bf16 v[100:103], a[4:7], v[72:75], v[100:103]
v_mfma_f32_16x16x32_bf16 v[104:107], a[8:11], v[72:75], v[104:107]
v_mfma_f32_16x16x32_bf16 v[108:111], a[12:15], v[72:75], v[108:111]
buffer_load_dwordx4 v[72:75], v1, s[8:11], s24 offen offset:2048 sc1
s_waitcnt vmcnt(21) lgkmcnt(0)
v_mfma_f32_16x16x32_bf16 v[96:99], v[112:115], v[76:79], v[96:99]
v_mfma_f32_16x16x32_bf16 v[100:103], v[116:119], v[76:79], v[100:103]
v_mfma_f32_16x16x32_bf16 v[104:107], v[120:123], v[76:79], v[104:107]
v_mfma_f32_16x16x32_bf16 v[108:111], v[124:127], v[76:79], v[108:111]
buffer_load_dwordx4 v[76:79], v1, s[8:11], s24 offen offset:3072 sc1
s_waitcnt vmcnt(21)
v_mfma_f32_16x16x32_bf16 v[96:99], a[16:19], v[80:83], v[96:99]
ds_read_b64_tr_b16 v[112:113], v8 offset:12288
v_mfma_f32_16x16x32_bf16 v[100:103], a[20:23], v[80:83], v[100:103]
ds_read_b64_tr_b16 v[114:115], v8 offset:13312
v_mfma_f32_16x16x32_bf16 v[104:107], a[24:27], v[80:83], v[104:107]
ds_read_b64_tr_b16 v[116:117], v9 offset:12288
v_mfma_f32_16x16x32_bf16 v[108:111], a[28:31], v[80:83], v[108:111]
ds_read_b64_tr_b16 v[118:119], v9 offset:13312
s_waitcnt vmcnt(12)
v_cmp_ne_u32 vcc, 1, v6
s_nop 0
s_cmp_eq_u64 vcc, 0
s_cselect_b32 s50, s52, 0
s_cmp_eq_u32 s50, 1
s_cselect_b32 s49, s49, 536870912
s_add_u32 s24, s49, s30
buffer_load_dwordx4 v[80:83], v1, s[8:11], s24 offen offset:0 sc1
s_waitcnt vmcnt(21)
v_mfma_f32_16x16x32_bf16 v[96:99], a[32:35], v[84:87], v[96:99]
ds_read_b64_tr_b16 v[120:121], v10 offset:12288
v_mfma_f32_16x16x32_bf16 v[100:103], a[36:39], v[84:87], v[100:103]
ds_read_b64_tr_b16 v[122:123], v10 offset:13312
v_mfma_f32_16x16x32_bf16 v[104:107], a[40:43], v[84:87], v[104:107]
ds_read_b64_tr_b16 v[124:125], v11 offset:12288
v_mfma_f32_16x16x32_bf16 v[108:111], a[44:47], v[84:87], v[108:111]
ds_read_b64_tr_b16 v[126:127], v11 offset:13312
buffer_load_dwordx4 v[84:87], v1, s[8:11], s24 offen offset:1024 sc1
s_waitcnt vmcnt(21)
v_mfma_f32_16x16x32_bf16 v[96:99], a[48:51], v[88:91], v[96:99]
v_mfma_f32_16x16x32_bf16 v[100:103], a[52:55], v[88:91], v[100:103]
v_mfma_f32_16x16x32_bf16 v[104:107], a[56:59], v[88:91], v[104:107]
v_mfma_f32_16x16x32_bf16 v[108:111], a[60:63], v[88:91], v[108:111]
buffer_load_dwordx4 v[88:91], v1, s[8:11], s24 offen offset:2048 sc1
s_waitcnt vmcnt(21) lgkmcnt(0)
v_mfma_f32_16x16x32_bf16 v[96:99], v[112:115], v[92:95], v[96:99]
v_mfma_f32_16x16x32_bf16 v[100:103], v[116:119], v[92:95], v[100:103]
v_mfma_f32_16x16x32_bf16 v[104:107], v[120:123], v[92:95], v[104:107]
v_mfma_f32_16x16x32_bf16 v[108:111], v[124:127], v[92:95], v[108:111]
buffer_load_dwordx4 v[92:95], v1, s[8:11], s24 offen offset:3072 sc1
s_waitcnt vmcnt(21)
v_mfma_f32_16x16x32_bf16 v[96:99], a[64:67], v[16:19], v[96:99]
ds_read_b64_tr_b16 v[112:113], v8 offset:16384
v_mfma_f32_16x16x32_bf16 v[100:103], a[68:71], v[16:19], v[100:103]
ds_read_b64_tr_b16 v[114:115], v8 offset:17408
v_mfma_f32_16x16x32_bf16 v[104:107], a[72:75], v[16:19], v[104:107]
ds_read_b64_tr_b16 v[116:117], v9 offset:16384
v_mfma_f32_16x16x32_bf16 v[108:111], a[76:79], v[16:19], v[108:111]
ds_read_b64_tr_b16 v[118:119], v9 offset:17408
s_add_u32 s24, s49, s31
buffer_load_dwordx4 v[16:19], v1, s[8:11], s24 offen offset:0 sc1
s_waitcnt vmcnt(21)
v_mfma_f32_16x16x32_bf16 v[96:99], a[80:83], v[20:23], v[96:99]
ds_read_b64_tr_b16 v[120:121], v10 offset:16384
v_mfma_f32_16x16x32_bf16 v[100:103], a[84:87], v[20:23], v[100:103]
ds_read_b64_tr_b16 v[122:123], v10 offset:17408
v_mfma_f32_16x16x32_bf16 v[104:107], a[88:91], v[20:23], v[104:107]
ds_read_b64_tr_b16 v[124:125], v11 offset:16384
v_mfma_f32_16x16x32_bf16 v[108:111], a[92:95], v[20:23], v[108:111]
ds_read_b64_tr_b16 v[126:127], v11 offset:17408
buffer_load_dwordx4 v[20:23], v1, s[8:11], s24 offen offset:1024 sc1
s_waitcnt vmcnt(21)
v_mfma_f32_16x16x32_bf16 v[96:99], a[96:99], v[24:27], v[96:99]
v_mfma_f32_16x16x32_bf16 v[100:103], a[100:103], v[24:27], v[100:103]
v_mfma_f32_16x16x32_bf16 v[104:107], a[104:107], v[24:27], v[104:107]
v_mfma_f32_16x16x32_bf16 v[108:111], a[108:111], v[24:27], v[108:111]
buffer_load_dwordx4 v[24:27], v1, s[8:11], s24 offen offset:2048 sc1
s_waitcnt vmcnt(21) lgkmcnt(0)
v_mfma_f32_16x16x32_bf16 v[96:99], v[112:115], v[28:31], v[96:99]
v_mfma_f32_16x16x32_bf16 v[100:103], v[116:119], v[28:31], v[100:103]
v_mfma_f32_16x16x32_bf16 v[104:107], v[120:123], v[28:31], v[104:107]
v_mfma_f32_16x16x32_bf16 v[108:111], v[124:127], v[28:31], v[108:111]
buffer_load_dwordx4 v[28:31], v1, s[8:11], s24 offen offset:3072 sc1
s_waitcnt vmcnt(19)
v_mfma_f32_16x16x32_bf16 v[96:99], a[112:115], v[32:35], v[96:99]
ds_read_b64_tr_b16 v[112:113], v8 offset:20480
v_mfma_f32_16x16x32_bf16 v[100:103], a[116:119], v[32:35], v[100:103]
ds_read_b64_tr_b16 v[114:115], v8 offset:21504
v_mfma_f32_16x16x32_bf16 v[104:107], a[120:123], v[32:35], v[104:107]
ds_read_b64_tr_b16 v[116:117], v9 offset:20480
v_mfma_f32_16x16x32_bf16 v[108:111], a[124:127], v[32:35], v[108:111]
ds_read_b64_tr_b16 v[118:119], v9 offset:21504
s_add_u32 s24, s49, s32
buffer_load_dwordx4 v[32:35], v1, s[8:11], s24 offen offset:0 sc1
s_waitcnt vmcnt(19)
v_mfma_f32_16x16x32_bf16 v[96:99], a[128:131], v[36:39], v[96:99]
ds_read_b64_tr_b16 v[120:121], v10 offset:20480
v_mfma_f32_16x16x32_bf16 v[100:103], a[132:135], v[36:39], v[100:103]
ds_read_b64_tr_b16 v[122:123], v10 offset:21504
v_mfma_f32_16x16x32_bf16 v[104:107], a[136:139], v[36:39], v[104:107]
ds_read_b64_tr_b16 v[124:125], v11 offset:20480
v_mfma_f32_16x16x32_bf16 v[108:111], a[140:143], v[36:39], v[108:111]
ds_read_b64_tr_b16 v[126:127], v11 offset:21504
buffer_load_dwordx4 v[36:39], v1, s[8:11], s24 offen offset:1024 sc1
s_waitcnt vmcnt(19)
v_mfma_f32_16x16x32_bf16 v[96:99], a[144:147], v[40:43], v[96:99]
v_mfma_f32_16x16x32_bf16 v[100:103], a[148:151], v[40:43], v[100:103]
v_mfma_f32_16x16x32_bf16 v[104:107], a[152:155], v[40:43], v[104:107]
v_mfma_f32_16x16x32_bf16 v[108:111], a[156:159], v[40:43], v[108:111]
buffer_load_dwordx4 v[40:43], v1, s[8:11], s24 offen offset:2048 sc1
s_waitcnt vmcnt(19) lgkmcnt(0)
v_mfma_f32_16x16x32_bf16 v[96:99], v[112:115], v[44:47], v[96:99]
v_mfma_f32_16x16x32_bf16 v[100:103], v[116:119], v[44:47], v[100:103]
v_mfma_f32_16x16x32_bf16 v[104:107], v[120:123], v[44:47], v[104:107]
v_mfma_f32_16x16x32_bf16 v[108:111], v[124:127], v[44:47], v[108:111]
buffer_load_dwordx4 v[44:47], v1, s[8:11], s24 offen offset:3072 sc1
s_waitcnt vmcnt(19)
v_mfma_f32_16x16x32_bf16 v[96:99], a[160:163], v[48:51], v[96:99]
ds_read_b64_tr_b16 v[112:113], v8 offset:24576
v_mfma_f32_16x16x32_bf16 v[100:103], a[164:167], v[48:51], v[100:103]
ds_read_b64_tr_b16 v[114:115], v8 offset:25600
v_mfma_f32_16x16x32_bf16 v[104:107], a[168:171], v[48:51], v[104:107]
ds_read_b64_tr_b16 v[116:117], v9 offset:24576
v_mfma_f32_16x16x32_bf16 v[108:111], a[172:175], v[48:51], v[108:111]
ds_read_b64_tr_b16 v[118:119], v9 offset:25600
s_add_u32 s24, s49, s33
buffer_load_dwordx4 v[48:51], v1, s[8:11], s24 offen offset:0 sc1
s_waitcnt vmcnt(19)
v_mfma_f32_16x16x32_bf16 v[96:99], a[176:179], v[52:55], v[96:99]
ds_read_b64_tr_b16 v[120:121], v10 offset:24576
v_mfma_f32_16x16x32_bf16 v[100:103], a[180:183], v[52:55], v[100:103]
ds_read_b64_tr_b16 v[122:123], v10 offset:25600
v_mfma_f32_16x16x32_bf16 v[104:107], a[184:187], v[52:55], v[104:107]
ds_read_b64_tr_b16 v[124:125], v11 offset:24576
v_mfma_f32_16x16x32_bf16 v[108:111], a[188:191], v[52:55], v[108:111]
ds_read_b64_tr_b16 v[126:127], v11 offset:25600
buffer_load_dwordx4 v[52:55], v1, s[8:11], s24 offen offset:1024 sc1
s_waitcnt vmcnt(19)
v_mfma_f32_16x16x32_bf16 v[96:99], a[192:195], v[56:59], v[96:99]
v_mfma_f32_16x16x32_bf16 v[100:103], a[196:199], v[56:59], v[100:103]
v_mfma_f32_16x16x32_bf16 v[104:107], a[200:203], v[56:59], v[104:107]
v_mfma_f32_16x16x32_bf16 v[108:111], a[204:207], v[56:59], v[108:111]
buffer_load_dwordx4 v[56:59], v1, s[8:11], s24 offen offset:2048 sc1
s_waitcnt vmcnt(19) lgkmcnt(0)
v_mfma_f32_16x16x32_bf16 v[96:99], v[112:115], v[60:63], v[96:99]
v_mfma_f32_16x16x32_bf16 v[100:103], v[116:119], v[60:63], v[100:103]
v_mfma_f32_16x16x32_bf16 v[104:107], v[120:123], v[60:63], v[104:107]
v_mfma_f32_16x16x32_bf16 v[108:111], v[124:127], v[60:63], v[108:111]
buffer_load_dwordx4 v[60:63], v1, s[8:11], s24 offen offset:3072 sc1
s_waitcnt vmcnt(19)
v_mfma_f32_16x16x32_bf16 v[96:99], a[208:211], v[64:67], v[96:99]
ds_read_b64_tr_b16 v[112:113], v8 offset:28672
v_mfma_f32_16x16x32_bf16 v[100:103], a[212:215], v[64:67], v[100:103]
ds_read_b64_tr_b16 v[114:115], v8 offset:29696
v_mfma_f32_16x16x32_bf16 v[104:107], a[216:219], v[64:67], v[104:107]
ds_read_b64_tr_b16 v[116:117], v9 offset:28672
v_mfma_f32_16x16x32_bf16 v[108:111], a[220:223], v[64:67], v[108:111]
ds_read_b64_tr_b16 v[118:119], v9 offset:29696
s_add_u32 s24, s49, s34
buffer_load_dwordx4 v[64:67], v1, s[8:11], s24 offen offset:0 sc1
s_waitcnt vmcnt(19)
v_mfma_f32_16x16x32_bf16 v[96:99], a[224:227], v[68:71], v[96:99]
ds_read_b64_tr_b16 v[120:121], v10 offset:28672
v_mfma_f32_16x16x32_bf16 v[100:103], a[228:231], v[68:71], v[100:103]
ds_read_b64_tr_b16 v[122:123], v10 offset:29696
v_mfma_f32_16x16x32_bf16 v[104:107], a[232:235], v[68:71], v[104:107]
ds_read_b64_tr_b16 v[124:125], v11 offset:28672
v_mfma_f32_16x16x32_bf16 v[108:111], a[236:239], v[68:71], v[108:111]
ds_read_b64_tr_b16 v[126:127], v11 offset:29696
buffer_load_dwordx4 v[68:71], v1, s[8:11], s24 offen offset:1024 sc1
s_waitcnt vmcnt(19)
v_mfma_f32_16x16x32_bf16 v[96:99], a[240:243], v[72:75], v[96:99]
v_mfma_f32_16x16x32_bf16 v[100:103], a[244:247], v[72:75], v[100:103]
v_mfma_f32_16x16x32_bf16 v[104:107], a[248:251], v[72:75], v[104:107]
v_mfma_f32_16x16x32_bf16 v[108:111], a[252:255], v[72:75], v[108:111]
buffer_load_dwordx4 v[72:75], v1, s[8:11], s24 offen offset:2048 sc1
s_waitcnt vmcnt(19) lgkmcnt(0)
v_mfma_f32_16x16x32_bf16 v[96:99], v[112:115], v[76:79], v[96:99]
v_mfma_f32_16x16x32_bf16 v[100:103], v[116:119], v[76:79], v[100:103]
v_mfma_f32_16x16x32_bf16 v[104:107], v[120:123], v[76:79], v[104:107]
v_mfma_f32_16x16x32_bf16 v[108:111], v[124:127], v[76:79], v[108:111]
buffer_load_dwordx4 v[76:79], v1, s[8:11], s24 offen offset:3072 sc1
s_nop 3
ds_write_b128 v3, v[96:99] offset:0
ds_write_b128 v3, v[100:103] offset:4096
ds_write_b128 v3, v[104:107] offset:8192
ds_write_b128 v3, v[108:111] offset:12288
s_waitcnt lgkmcnt(0)
s_barrier
ds_read_b128 v[96:99], v7 offset:0
ds_read_b128 v[100:103], v7 offset:1024
ds_read_b128 v[104:107], v7 offset:2048
ds_read_b128 v[108:111], v7 offset:3072
ds_read_b64_tr_b16 v[112:113], v8 offset:0
ds_read_b64_tr_b16 v[114:115], v8 offset:1024
ds_read_b64_tr_b16 v[116:117], v9 offset:0
ds_read_b64_tr_b16 v[118:119], v9 offset:1024
ds_read_b64_tr_b16 v[120:121], v10 offset:0
ds_read_b64_tr_b16 v[122:123], v10 offset:1024
ds_read_b64_tr_b16 v[124:125], v11 offset:0
ds_read_b64_tr_b16 v[126:127], v11 offset:1024
s_mul_i32 s24, s41, 36864
s_waitcnt lgkmcnt(10)
v_pk_add_f32 v[96:97], v[96:97], v[100:101]
v_pk_add_f32 v[98:99], v[98:99], v[102:103]
s_waitcnt lgkmcnt(9)
v_pk_add_f32 v[96:97], v[96:97], v[104:105]
v_pk_add_f32 v[98:99], v[98:99], v[106:107]
s_waitcnt lgkmcnt(8)
v_pk_add_f32 v[96:97], v[96:97], v[108:109]
v_pk_add_f32 v[98:99], v[98:99], v[110:111]
v_cvt_pk_bf16_f32 v12, v96, v97
v_cvt_pk_bf16_f32 v13, v98, v99
buffer_store_dwordx2 v[12:13], v4, s[12:15], s24 offen
v_xor_b32 v3, 16384, v3
v_xor_b32 v7, 16384, v7
s_mov_b32 s41, s27
s_mov_b32 s48, s49
s_cmp_eq_u32 s50, 0
s_cbranch_scc1 L_opl_c
L_opl_r3:
s_cmp_lg_u64 s[42:43], 0
s_cselect_b32 s52, 1, 0
s_ff1_i32_b64 s27, s[42:43]
s_bitset0_b64 s[42:43], s27
s_lshl_b32 s27, s27, 1
s_add_u32 s27, s27, s51
s_and_b32 s27, s27, 127
s_lshr_b32 s25, s27, s46
s_lshl_b32 s25, s25, 7
s_add_u32 s25, s25, s45
buffer_load_dword v6, v5, s[8:11], s25 offen sc1
s_lshl_b32 s49, s27, 17
s_add_u32 s49, s49, s44
s_waitcnt vmcnt(21)
v_mfma_f32_16x16x32_bf16 v[96:99], v[128:131], v[80:83], 0
v_mfma_f32_16x16x32_bf16 v[100:103], v[132:135], v[80:83], 0
v_mfma_f32_16x16x32_bf16 v[104:107], v[136:139], v[80:83], 0
v_mfma_f32_16x16x32_bf16 v[108:111], v[140:143], v[80:83], 0
s_add_u32 s24, s48, s35
buffer_load_dwordx4 v[80:83], v1, s[8:11], s24 offen offset:0 sc1
s_waitcnt vmcnt(21)
v_mfma_f32_16x16x32_bf16 v[96:99], v[144:147], v[84:87], v[96:99]
v_mfma_f32_16x16x32_bf16 v[100:103], v[148:151], v[84:87], v[100:103]
v_mfma_f32_16x16x32_bf16 v[104:107], v[152:155], v[84:87], v[104:107]
v_mfma_f32_16x16x32_bf16 v[108:111], v[156:159], v[84:87], v[108:111]
buffer_load_dwordx4 v[84:87], v1, s[8:11], s24 offen offset:1024 sc1
s_waitcnt vmcnt(21)
v_mfma_f32_16x16x32_bf16 v[96:99], v[160:163], v[88:91], v[96:99]
v_mfma_f32_16x16x32_bf16 v[100:103], v[164:167], v[88:91], v[100:103]
v_mfma_f32_16x16x32_bf16 v[104:107], v[168:171], v[88:91], v[104:107]
v_mfma_f32_16x16x32_bf16 v[108:111], v[172:175], v[88:91], v[108:111]
buffer_load_dwordx4 v[88:91], v1, s[8:11], s24 offen offset:2048 sc1
s_waitcnt vmcnt(21) lgkmcnt(0)
v_mfma_f32_16x16x32_bf16 v[96:99], v[112:115], v[92:95], v[96:99]
v_mfma_f32_16x16x32_bf16 v[100:103], v[116:119], v[92:95], v[100:103]
v_mfma_f32_16x16x32_bf16 v[104:107], v[120:123], v[92:95], v[104:107]
v_mfma_f32_16x16x32_bf16 v[108:111], v[124:127], v[92:95], v[108:111]
buffer_load_dwordx4 v[92:95], v1, s[8:11], s24 offen offset:3072 sc1
s_waitcnt vmcnt(21)
v_mfma_f32_16x16x32_bf16 v[96:99], v[176:179], v[16:19], v[96:99]
ds_read_b64_tr_b16 v[112:113], v8 offset:4096
v_mfma_f32_16x16x32_bf16 v[100:103], v[180:183], v[16:19], v[100:103]
ds_read_b64_tr_b16 v[114:115], v8 offset:5120
v_mfma_f32_16x16x32_bf16 v[104:107], v[184:187], v[16:19], v[104:107]
ds_read_b64_tr_b16 v[116:117], v9 offset:4096
v_mfma_f32_16x16x32_bf16 v[108:111], v[188:191], v[16:19], v[108:111]
ds_read_b64_tr_b16 v[118:119], v9 offset:5120
s_add_u32 s24, s48, s36
buffer_load_dwordx4 v[16:19], v1, s[8:11], s24 offen offset:0 sc1
s_waitcnt vmcnt(21)
v_mfma_f32_16x16x32_bf16 v[96:99], v[192:195], v[20:23], v[96:99]
ds_read_b64_tr_b16 v[120:121], v10 offset:4096
v_mfma_f32_16x16x32_bf16 v[100:103], v[196:199], v[20:23], v[100:103]
ds_read_b64_tr_b16 v[122:123], v10 offset:5120
v_mfma_f32_16x16x32_bf16 v[104:107], v[200:203], v[20:23], v[104:107]
ds_read_b64_tr_b16 v[124:125], v11 offset:4096
v_mfma_f32_16x16x32_bf16 v[108:111], v[204:207], v[20:23], v[108:111]
ds_read_b64_tr_b16 v[126:127], v11 offset:5120
buffer_load_dwordx4 v[20:23], v1, s[8:11], s24 offen offset:1024 sc1
s_waitcnt vmcnt(21)
v_mfma_f32_16x16x32_bf16 v[96:99], v[208:211], v[24:27], v[96:99]
v_mfma_f32_16x16x32_bf16 v[100:103], v[212:215], v[24:27], v[100:103]
v_mfma_f32_16x16x32_bf16 v[104:107], v[216:219], v[24:27], v[104:107]
v_mfma_f32_16x16x32_bf16 v[108:111], v[220:223], v[24:27], v[108:111]
buffer_load_dwordx4 v[24:27], v1, s[8:11], s24 offen offset:2048 sc1
s_waitcnt vmcnt(21) lgkmcnt(0)
v_mfma_f32_16x16x32_bf16 v[96:99], v[112:115], v[28:31], v[96:99]
v_mfma_f32_16x16x32_bf16 v[100:103], v[116:119], v[28:31], v[100:103]
v_mfma_f32_16x16x32_bf16 v[104:107], v[120:123], v[28:31], v[104:107]
v_mfma_f32_16x16x32_bf16 v[108:111], v[124:127], v[28:31], v[108:111]
buffer_load_dwordx4 v[28:31], v1, s[8:11], s24 offen offset:3072 sc1
s_waitcnt vmcnt(21)
v_mfma_f32_16x16x32_bf16 v[96:99], v[224:227], v[32:35], v[96:99]
ds_read_b64_tr_b16 v[112:113], v8 offset:8192
v_mfma_f32_16x16x32_bf16 v[100:103], v[228:231], v[32:35], v[100:103]
ds_read_b64_tr_b16 v[114:115], v8 offset:9216
v_mfma_f32_16x16x32_bf16 v[104:107], v[232:235], v[32:35], v[104:107]
ds_read_b64_tr_b16 v[116:117], v9 offset:8192
v_mfma_f32_16x16x32_bf16 v[108:111], v[236:239], v[32:35], v[108:111]
ds_read_b64_tr_b16 v[118:119], v9 offset:9216
s_add_u32 s24, s48, s37
buffer_load_dwordx4 v[32:35], v1, s[8:11], s24 offen offset:0 sc1
s_waitcnt vmcnt(21)
v_mfma_f32_16x16x32_bf16 v[96:99], v[240:243], v[36:39], v[96:99]
ds_read_b64_tr_b16 v[120:121], v10 offset:8192
v_mfma_f32_16x16x32_bf16 v[100:103], v[244:247], v[36:39], v[100:103]
ds_read_b64_tr_b16 v[122:123], v10 offset:9216
v_mfma_f32_16x16x32_bf16 v[104:107], v[248:251], v[36:39], v[104:107]
ds_read_b64_tr_b16 v[124:125], v11 offset:8192
v_mfma_f32_16x16x32_bf16 v[108:111], v[252:255], v[36:39], v[108:111]
ds_read_b64_tr_b16 v[126:127], v11 offset:9216
buffer_load_dwordx4 v[36:39], v1, s[8:11], s24 offen offset:1024 sc1
s_waitcnt vmcnt(21)
v_mfma_f32_16x16x32_bf16 v[96:99], a[0:3], v[40:43], v[96:99]
v_mfma_f32_16x16x32_bf16 v[100:103], a[4:7], v[40:43], v[100:103]
v_mfma_f32_16x16x32_bf16 v[104:107], a[8:11], v[40:43], v[104:107]
v_mfma_f32_16x16x32_bf16 v[108:111], a[12:15], v[40:43], v[108:111]
buffer_load_dwordx4 v[40:43], v1, s[8:11], s24 offen offset:2048 sc1
s_waitcnt vmcnt(21) lgkmcnt(0)
v_mfma_f32_16x16x32_bf16 v[96:99], v[112:115], v[44:47], v[96:99]
v_mfma_f32_16x16x32_bf16 v[100:103], v[116:119], v[44:47], v[100:103]
v_mfma_f32_16x16x32_bf16 v[104:107], v[120:123], v[44:47], v[104:107]
v_mfma_f32_16x16x32_bf16 v[108:111], v[124:127], v[44:47], v[108:111]
buffer_load_dwordx4 v[44:47], v1, s[8:11], s24 offen offset:3072 sc1
s_waitcnt vmcnt(21)
v_mfma_f32_16x16x32_bf16 v[96:99], a[16:19], v[48:51], v[96:99]
ds_read_b64_tr_b16 v[112:113], v8 offset:12288
v_mfma_f32_16x16x32_bf16 v[100:103], a[20:23], v[48:51], v[100:103]
ds_read_b64_tr_b16 v[114:115], v8 offset:13312
v_mfma_f32_16x16x32_bf16 v[104:107], a[24:27], v[48:51], v[104:107]
ds_read_b64_tr_b16 v[116:117], v9 offset:12288
v_mfma_f32_16x16x32_bf16 v[108:111], a[28:31], v[48:51], v[108:111]
ds_read_b64_tr_b16 v[118:119], v9 offset:13312
s_waitcnt vmcnt(12)
v_cmp_ne_u32 vcc, 1, v6
s_nop 0
s_cmp_eq_u64 vcc, 0
s_cselect_b32 s50, s52, 0
s_cmp_eq_u32 s50, 1
s_cselect_b32 s49, s49, 536870912
s_add_u32 s24, s49, s30
buffer_load_dwordx4 v[48:51], v1, s[8:11], s24 offen offset:0 sc1
s_waitcnt vmcnt(21)
v_mfma_f32_16x16x32_bf16 v[96:99], a[32:35], v[52:55], v[96:99]
ds_read_b64_tr_b16 v[120:121], v10 offset:12288
v_mfma_f32_16x16x32_bf16 v[100:103], a[36:39], v[52:55], v[100:103]
ds_read_b64_tr_b16 v[122:123], v10 offset:13312
v_mfma_f32_16x16x32_bf16 v[104:107], a[40:43], v[52:55], v[104:107]
ds_read_b64_tr_b16 v[124:125], v11 offset:12288
v_mfma_f32_16x16x32_bf16 v[108:111], a[44:47], v[52:55], v[108:111]
ds_read_b64_tr_b16 v[126:127], v11 offset:13312
buffer_load_dwordx4 v[52:55], v1, s[8:11], s24 offen offset:1024 sc1
s_waitcnt vmcnt(21)
v_mfma_f32_16x16x32_bf16 v[96:99], a[48:51], v[56:59], v[96:99]
v_mfma_f32_16x16x32_bf16 v[100:103], a[52:55], v[56:59], v[100:103]
v_mfma_f32_16x16x32_bf16 v[104:107], a[56:59], v[56:59], v[104:107]
v_mfma_f32_16x16x32_bf16 v[108:111], a[60:63], v[56:59], v[108:111]
buffer_load_dwordx4 v[56:59], v1, s[8:11], s24 offen offset:2048 sc1
s_waitcnt vmcnt(21) lgkmcnt(0)
v_mfma_f32_16x16x32_bf16 v[96:99], v[112:115], v[60:63], v[96:99]
v_mfma_f32_16x16x32_bf16 v[100:103], v[116:119], v[60:63], v[100:103]
v_mfma_f32_16x16x32_bf16 v[104:107], v[120:123], v[60:63], v[104:107]
v_mfma_f32_16x16x32_bf16 v[108:111], v[124:127], v[60:63], v[108:111]
buffer_load_dwordx4 v[60:63], v1, s[8:11], s24 offen offset:3072 sc1
s_waitcnt vmcnt(21)
v_mfma_f32_16x16x32_bf16 v[96:99], a[64:67], v[64:67], v[96:99]
ds_read_b64_tr_b16 v[112:113], v8 offset:16384
v_mfma_f32_16x16x32_bf16 v[100:103], a[68:71], v[64:67], v[100:103]
ds_read_b64_tr_b16 v[114:115], v8 offset:17408
v_mfma_f32_16x16x32_bf16 v[104:107], a[72:75], v[64:67], v[104:107]
ds_read_b64_tr_b16 v[116:117], v9 offset:16384
v_mfma_f32_16x16x32_bf16 v[108:111], a[76:79], v[64:67], v[108:111]
ds_read_b64_tr_b16 v[118:119], v9 offset:17408
s_add_u32 s24, s49, s31
buffer_load_dwordx4 v[64:67], v1, s[8:11], s24 offen offset:0 sc1
s_waitcnt vmcnt(21)
v_mfma_f32_16x16x32_bf16 v[96:99], a[80:83], v[68:71], v[96:99]
ds_read_b64_tr_b16 v[120:121], v10 offset:16384
v_mfma_f32_16x16x32_bf16 v[100:103], a[84:87], v[68:71], v[100:103]
ds_read_b64_tr_b16 v[122:123], v10 offset:17408
v_mfma_f32_16x16x32_bf16 v[104:107], a[88:91], v[68:71], v[104:107]
ds_read_b64_tr_b16 v[124:125], v11 offset:16384
v_mfma_f32_16x16x32_bf16 v[108:111], a[92:95], v[68:71], v[108:111]
ds_read_b64_tr_b16 v[126:127], v11 offset:17408
buffer_load_dwordx4 v[68:71], v1, s[8:11], s24 offen offset:1024 sc1
s_waitcnt vmcnt(21)
v_mfma_f32_16x16x32_bf16 v[96:99], a[96:99], v[72:75], v[96:99]
v_mfma_f32_16x16x32_bf16 v[100:103], a[100:103], v[72:75], v[100:103]
v_mfma_f32_16x16x32_bf16 v[104:107], a[104:107], v[72:75], v[104:107]
v_mfma_f32_16x16x32_bf16 v[108:111], a[108:111], v[72:75], v[108:111]
buffer_load_dwordx4 v[72:75], v1, s[8:11], s24 offen offset:2048 sc1
s_waitcnt vmcnt(21) lgkmcnt(0)
v_mfma_f32_16x16x32_bf16 v[96:99], v[112:115], v[76:79], v[96:99]
v_mfma_f32_16x16x32_bf16 v[100:103], v[116:119], v[76:79], v[100:103]
v_mfma_f32_16x16x32_bf16 v[104:107], v[120:123], v[76:79], v[104:107]
v_mfma_f32_16x16x32_bf16 v[108:111], v[124:127], v[76:79], v[108:111]
buffer_load_dwordx4 v[76:79], v1, s[8:11], s24 offen offset:3072 sc1
s_waitcnt vmcnt(19)
v_mfma_f32_16x16x32_bf16 v[96:99], a[112:115], v[80:83], v[96:99]
ds_read_b64_tr_b16 v[112:113], v8 offset:20480
v_mfma_f32_16x16x32_bf16 v[100:103], a[116:119], v[80:83], v[100:103]
ds_read_b64_tr_b16 v[114:115], v8 offset:21504
v_mfma_f32_16x16x32_bf16 v[104:107], a[120:123], v[80:83], v[104:107]
ds_read_b64_tr_b16 v[116:117], v9 offset:20480
v_mfma_f32_16x16x32_bf16 v[108:111], a[124:127], v[80:83], v[108:111]
ds_read_b64_tr_b16 v[118:119], v9 offset:21504
s_add_u32 s24, s49, s32
buffer_load_dwordx4 v[80:83], v1, s[8:11], s24 offen offset:0 sc1
s_waitcnt vmcnt(19)
v_mfma_f32_16x16x32_bf16 v[96:99], a[128:131], v[84:87], v[96:99]
ds_read_b64_tr_b16 v[120:121], v10 offset:20480
v_mfma_f32_16x16x32_bf16 v[100:103], a[132:135], v[84:87], v[100:103]
ds_read_b64_tr_b16 v[122:123], v10 offset:21504
v_mfma_f32_16x16x32_bf16 v[104:107], a[136:139], v[84:87], v[104:107]
ds_read_b64_tr_b16 v[124:125], v11 offset:20480
v_mfma_f32_16x16x32_bf16 v[108:111], a[140:143], v[84:87], v[108:111]
ds_read_b64_tr_b16 v[126:127], v11 offset:21504
buffer_load_dwordx4 v[84:87], v1, s[8:11], s24 offen offset:1024 sc1
s_waitcnt vmcnt(19)
v_mfma_f32_16x16x32_bf16 v[96:99], a[144:147], v[88:91], v[96:99]
v_mfma_f32_16x16x32_bf16 v[100:103], a[148:151], v[88:91], v[100:103]
v_mfma_f32_16x16x32_bf16 v[104:107], a[152:155], v[88:91], v[104:107]
v_mfma_f32_16x16x32_bf16 v[108:111], a[156:159], v[88:91], v[108:111]
buffer_load_dwordx4 v[88:91], v1, s[8:11], s24 offen offset:2048 sc1
s_waitcnt vmcnt(19) lgkmcnt(0)
v_mfma_f32_16x16x32_bf16 v[96:99], v[112:115], v[92:95], v[96:99]
v_mfma_f32_16x16x32_bf16 v[100:103], v[116:119], v[92:95], v[100:103]
v_mfma_f32_16x16x32_bf16 v[104:107], v[120:123], v[92:95], v[104:107]
v_mfma_f32_16x16x32_bf16 v[108:111], v[124:127], v[92:95], v[108:111]
buffer_load_dwordx4 v[92:95], v1, s[8:11], s24 offen offset:3072 sc1
s_waitcnt vmcnt(19)
v_mfma_f32_16x16x32_bf16 v[96:99], a[160:163], v[16:19], v[96:99]
ds_read_b64_tr_b16 v[112:113], v8 offset:24576
v_mfma_f32_16x16x32_bf16 v[100:103], a[164:167], v[16:19], v[100:103]
ds_read_b64_tr_b16 v[114:115], v8 offset:25600
v_mfma_f32_16x16x32_bf16 v[104:107], a[168:171], v[16:19], v[104:107]
ds_read_b64_tr_b16 v[116:117], v9 offset:24576
v_mfma_f32_16x16x32_bf16 v[108:111], a[172:175], v[16:19], v[108:111]
ds_read_b64_tr_b16 v[118:119], v9 offset:25600
s_add_u32 s24, s49, s33
buffer_load_dwordx4 v[16:19], v1, s[8:11], s24 offen offset:0 sc1
s_waitcnt vmcnt(19)
v_mfma_f32_16x16x32_bf16 v[96:99], a[176:179], v[20:23], v[96:99]
ds_read_b64_tr_b16 v[120:121], v10 offset:24576
v_mfma_f32_16x16x32_bf16 v[100:103], a[180:183], v[20:23], v[100:103]
ds_read_b64_tr_b16 v[122:123], v10 offset:25600
v_mfma_f32_16x16x32_bf16 v[104:107], a[184:187], v[20:23], v[104:107]
ds_read_b64_tr_b16 v[124:125], v11 offset:24576
v_mfma_f32_16x16x32_bf16 v[108:111], a[188:191], v[20:23], v[108:111]
ds_read_b64_tr_b16 v[126:127], v11 offset:25600
buffer_load_dwordx4 v[20:23], v1, s[8:11], s24 offen offset:1024 sc1
s_waitcnt vmcnt(19)
v_mfma_f32_16x16x32_bf16 v[96:99], a[192:195], v[24:27], v[96:99]
v_mfma_f32_16x16x32_bf16 v[100:103], a[196:199], v[24:27], v[100:103]
v_mfma_f32_16x16x32_bf16 v[104:107], a[200:203], v[24:27], v[104:107]
v_mfma_f32_16x16x32_bf16 v[108:111], a[204:207], v[24:27], v[108:111]
buffer_load_dwordx4 v[24:27], v1, s[8:11], s24 offen offset:2048 sc1
s_waitcnt vmcnt(19) lgkmcnt(0)
v_mfma_f32_16x16x32_bf16 v[96:99], v[112:115], v[28:31], v[96:99]
v_mfma_f32_16x16x32_bf16 v[100:103], v[116:119], v[28:31], v[100:103]
v_mfma_f32_16x16x32_bf16 v[104:107], v[120:123], v[28:31], v[104:107]
v_mfma_f32_16x16x32_bf16 v[108:111], v[124:127], v[28:31], v[108:111]
buffer_load_dwordx4 v[28:31], v1, s[8:11], s24 offen offset:3072 sc1
s_waitcnt vmcnt(19)
v_mfma_f32_16x16x32_bf16 v[96:99], a[208:211], v[32:35], v[96:99]
ds_read_b64_tr_b16 v[112:113], v8 offset:28672
v_mfma_f32_16x16x32_bf16 v[100:103], a[212:215], v[32:35], v[100:103]
ds_read_b64_tr_b16 v[114:115], v8 offset:29696
v_mfma_f32_16x16x32_bf16 v[104:107], a[216:219], v[32:35], v[104:107]
ds_read_b64_tr_b16 v[116:117], v9 offset:28672
v_mfma_f32_16x16x32_bf16 v[108:111], a[220:223], v[32:35], v[108:111]
ds_read_b64_tr_b16 v[118:119], v9 offset:29696
s_add_u32 s24, s49, s34
buffer_load_dwordx4 v[32:35], v1, s[8:11], s24 offen offset:0 sc1
s_waitcnt vmcnt(19)
v_mfma_f32_16x16x32_bf16 v[96:99], a[224:227], v[36:39], v[96:99]
ds_read_b64_tr_b16 v[120:121], v10 offset:28672
v_mfma_f32_16x16x32_bf16 v[100:103], a[228:231], v[36:39], v[100:103]
ds_read_b64_tr_b16 v[122:123], v10 offset:29696
v_mfma_f32_16x16x32_bf16 v[104:107], a[232:235], v[36:39], v[104:107]
ds_read_b64_tr_b16 v[124:125], v11 offset:28672
v_mfma_f32_16x16x32_bf16 v[108:111], a[236:239], v[36:39], v[108:111]
ds_read_b64_tr_b16 v[126:127], v11 offset:29696
buffer_load_dwordx4 v[36:39], v1, s[8:11], s24 offen offset:1024 sc1
s_waitcnt vmcnt(19)
v_mfma_f32_16x16x32_bf16 v[96:99], a[240:243], v[40:43], v[96:99]
v_mfma_f32_16x16x32_bf16 v[100:103], a[244:247], v[40:43], v[100:103]
v_mfma_f32_16x16x32_bf16 v[104:107], a[248:251], v[40:43], v[104:107]
v_mfma_f32_16x16x32_bf16 v[108:111], a[252:255], v[40:43], v[108:111]
buffer_load_dwordx4 v[40:43], v1, s[8:11], s24 offen offset:2048 sc1
s_waitcnt vmcnt(19) lgkmcnt(0)
v_mfma_f32_16x16x32_bf16 v[96:99], v[112:115], v[44:47], v[96:99]
v_mfma_f32_16x16x32_bf16 v[100:103], v[116:119], v[44:47], v[100:103]
v_mfma_f32_16x16x32_bf16 v[104:107], v[120:123], v[44:47], v[104:107]
v_mfma_f32_16x16x32_bf16 v[108:111], v[124:127], v[44:47], v[108:111]
buffer_load_dwordx4 v[44:47], v1, s[8:11], s24 offen offset:3072 sc1
s_nop 3
ds_write_b128 v3, v[96:99] offset:0
ds_write_b128 v3, v[100:103] offset:4096
ds_write_b128 v3, v[104:107] offset:8192
ds_write_b128 v3, v[108:111] offset:12288
s_waitcnt lgkmcnt(0)
s_barrier
ds_read_b128 v[96:99], v7 offset:0
ds_read_b128 v[100:103], v7 offset:1024
ds_read_b128 v[104:107], v7 offset:2048
ds_read_b128 v[108:111], v7 offset:3072
ds_read_b64_tr_b16 v[112:113], v8 offset:0
ds_read_b64_tr_b16 v[114:115], v8 offset:1024
ds_read_b64_tr_b16 v[116:117], v9 offset:0
ds_read_b64_tr_b16 v[118:119], v9 offset:1024
ds_read_b64_tr_b16 v[120:121], v10 offset:0
ds_read_b64_tr_b16 v[122:123], v10 offset:1024
ds_read_b64_tr_b16 v[124:125], v11 offset:0
ds_read_b64_tr_b16 v[126:127], v11 offset:1024
s_mul_i32 s24, s41, 36864
s_waitcnt lgkmcnt(10)
v_pk_add_f32 v[96:97], v[96:97], v[100:101]
v_pk_add_f32 v[98:99], v[98:99], v[102:103]
s_waitcnt lgkmcnt(9)
v_pk_add_f32 v[96:97], v[96:97], v[104:105]
v_pk_add_f32 v[98:99], v[98:99], v[106:107]
s_waitcnt lgkmcnt(8)
v_pk_add_f32 v[96:97], v[96:97], v[108:109]
v_pk_add_f32 v[98:99], v[98:99], v[110:111]
v_cvt_pk_bf16_f32 v12, v96, v97
v_cvt_pk_bf16_f32 v13, v98, v99
buffer_store_dwordx2 v[12:13], v4, s[12:15], s24 offen
v_xor_b32 v3, 16384, v3
v_xor_b32 v7, 16384, v7
s_mov_b32 s41, s27
s_mov_b32 s48, s49
s_cmp_eq_u32 s50, 0
s_cbranch_scc1 L_opl_c
L_opl_r4:
s_cmp_lg_u64 s[42:43], 0
s_cselect_b32 s52, 1, 0
s_ff1_i32_b64 s27, s[42:43]
s_bitset0_b64 s[42:43], s27
s_lshl_b32 s27, s27, 1
s_add_u32 s27, s27, s51
s_and_b32 s27, s27, 127
s_lshr_b32 s25, s27, s46
s_lshl_b32 s25, s25, 7
s_add_u32 s25, s25, s45
buffer_load_dword v6, v5, s[8:11], s25 offen sc1
s_lshl_b32 s49, s27, 17
s_add_u32 s49, s49, s44
s_waitcnt vmcnt(21)
v_mfma_f32_16x16x32_bf16 v[96:99], v[128:131], v[48:51], 0
v_mfma_f32_16x16x32_bf16 v[100:103], v[132:135], v[48:51], 0
v_mfma_f32_16x16x32_bf16 v[104:107], v[136:139], v[48:51], 0
v_mfma_f32_16x16x32_bf16 v[108:111], v[140:143], v[48:51], 0
s_add_u32 s24, s48, s35
buffer_load_dwordx4 v[48:51], v1, s[8:11], s24 offen offset:0 sc1
s_waitcnt vmcnt(21)
v_mfma_f32_16x16x32_bf16 v[96:99], v[144:147], v[52:55], v[96:99]
v_mfma_f32_16x16x32_bf16 v[100:103], v[148:151], v[52:55], v[100:103]
v_mfma_f32_16x16x32_bf16 v[104:107], v[152:155], v[52:55], v[104:107]
v_mfma_f32_16x16x32_bf16 v[108:111], v[156:159], v[52:55], v[108:111]
buffer_load_dwordx4 v[52:55], v1, s[8:11], s24 offen offset:1024 sc1
s_waitcnt vmcnt(21)
v_mfma_f32_16x16x32_bf16 v[96:99], v[160:163], v[56:59], v[96:99]
v_mfma_f32_16x16x32_bf16 v[100:103], v[164:167], v[56:59], v[100:103]
v_mfma_f32_16x16x32_bf16 v[104:107], v[168:171], v[56:59], v[104:107]
v_mfma_f32_16x16x32_bf16 v[108:111], v[172:175], v[56:59], v[108:111]
buffer_load_dwordx4 v[56:59], v1, s[8:11], s24 offen offset:2048 sc1
s_waitcnt vmcnt(21) lgkmcnt(0)
v_mfma_f32_16x16x32_bf16 v[96:99], v[112:115], v[60:63], v[96:99]
v_mfma_f32_16x16x32_bf16 v[100:103], v[116:119], v[60:63], v[100:103]
v_mfma_f32_16x16x32_bf16 v[104:107], v[120:123], v[60:63], v[104:107]
v_mfma_f32_16x16x32_bf16 v[108:111], v[124:127], v[60:63], v[108:111]
buffer_load_dwordx4 v[60:63], v1, s[8:11], s24 offen offset:3072 sc1
s_waitcnt vmcnt(21)
v_mfma_f32_16x16x32_bf16 v[96:99], v[176:179], v[64:67], v[96:99]
ds_read_b64_tr_b16 v[112:113], v8 offset:4096
v_mfma_f32_16x16x32_bf16 v[100:103], v[180:183], v[64:67], v[100:103]
ds_read_b64_tr_b16 v[114:115], v8 offset:5120
v_mfma_f32_16x16x32_bf16 v[104:107], v[184:187], v[64:67], v[104:107]
ds_read_b64_tr_b16 v[116:117], v9 offset:4096
v_mfma_f32_16x16x32_bf16 v[108:111], v[188:191], v[64:67], v[108:111]
ds_read_b64_tr_b16 v[118:119], v9 offset:5120
s_add_u32 s24, s48, s36
buffer_load_dwordx4 v[64:67], v1, s[8:11], s24 offen offset:0 sc1
s_waitcnt vmcnt(21)
v_mfma_f32_16x16x32_bf16 v[96:99], v[192:195], v[68:71], v[96:99]
ds_read_b64_tr_b16 v[120:121], v10 offset:4096
v_mfma_f32_16x16x32_bf16 v[100:103], v[196:199], v[68:71], v[100:103]
ds_read_b64_tr_b16 v[122:123], v10 offset:5120
v_mfma_f32_16x16x32_bf16 v[104:107], v[200:203], v[68:71], v[104:107]
ds_read_b64_tr_b16 v[124:125], v11 offset:4096
v_mfma_f32_16x16x32_bf16 v[108:111], v[204:207], v[68:71], v[108:111]
ds_read_b64_tr_b16 v[126:127], v11 offset:5120
buffer_load_dwordx4 v[68:71], v1, s[8:11], s24 offen offset:1024 sc1
s_waitcnt vmcnt(21)
v_mfma_f32_16x16x32_bf16 v[96:99], v[208:211], v[72:75], v[96:99]
v_mfma_f32_16x16x32_bf16 v[100:103], v[212:215], v[72:75], v[100:103]
v_mfma_f32_16x16x32_bf16 v[104:107], v[216:219], v[72:75], v[104:107]
v_mfma_f32_16x16x32_bf16 v[108:111], v[220:223], v[72:75], v[108:111]
buffer_load_dwordx4 v[72:75], v1, s[8:11], s24 offen offset:2048 sc1
s_waitcnt vmcnt(21) lgkmcnt(0)
v_mfma_f32_16x16x32_bf16 v[96:99], v[112:115], v[76:79], v[96:99]
v_mfma_f32_16x16x32_bf16 v[100:103], v[116:119], v[76:79], v[100:103]
v_mfma_f32_16x16x32_bf16 v[104:107], v[120:123], v[76:79], v[104:107]
v_mfma_f32_16x16x32_bf16 v[108:111], v[124:127], v[76:79], v[108:111]
buffer_load_dwordx4 v[76:79], v1, s[8:11], s24 offen offset:3072 sc1
s_waitcnt vmcnt(21)
v_mfma_f32_16x16x32_bf16 v[96:99], v[224:227], v[80:83], v[96:99]
ds_read_b64_tr_b16 v[112:113], v8 offset:8192
v_mfma_f32_16x16x32_bf16 v[100:103], v[228:231], v[80:83], v[100:103]
ds_read_b64_tr_b16 v[114:115], v8 offset:9216
v_mfma_f32_16x16x32_bf16 v[104:107], v[232:235], v[80:83], v[104:107]
ds_read_b64_tr_b16 v[116:117], v9 offset:8192
v_mfma_f32_16x16x32_bf16 v[108:111], v[236:239], v[80:83], v[108:111]
ds_read_b64_tr_b16 v[118:119], v9 offset:9216
s_add_u32 s24, s48, s37
buffer_load_dwordx4 v[80:83], v1, s[8:11], s24 offen offset:0 sc1
s_waitcnt vmcnt(21)
v_mfma_f32_16x16x32_bf16 v[96:99], v[240:243], v[84:87], v[96:99]
ds_read_b64_tr_b16 v[120:121], v10 offset:8192
v_mfma_f32_16x16x32_bf16 v[100:103], v[244:247], v[84:87], v[100:103]
ds_read_b64_tr_b16 v[122:123], v10 offset:9216
v_mfma_f32_16x16x32_bf16 v[104:107], v[248:251], v[84:87], v[104:107]
ds_read_b64_tr_b16 v[124:125], v11 offset:8192
v_mfma_f32_16x16x32_bf16 v[108:111], v[252:255], v[84:87], v[108:111]
ds_read_b64_tr_b16 v[126:127], v11 offset:9216
buffer_load_dwordx4 v[84:87], v1, s[8:11], s24 offen offset:1024 sc1
s_waitcnt vmcnt(21)
v_mfma_f32_16x16x32_bf16 v[96:99], a[0:3], v[88:91], v[96:99]
v_mfma_f32_16x16x32_bf16 v[100:103], a[4:7], v[88:91], v[100:103]
v_mfma_f32_16x16x32_bf16 v[104:107], a[8:11], v[88:91], v[104:107]
v_mfma_f32_16x16x32_bf16 v[108:111], a[12:15], v[88:91], v[108:111]
buffer_load_dwordx4 v[88:91], v1, s[8:11], s24 offen offset:2048 sc1
s_waitcnt vmcnt(21) lgkmcnt(0)
v_mfma_f32_16x16x32_bf16 v[96:99], v[112:115], v[92:95], v[96:99]
v_mfma_f32_16x16x32_bf16 v[100:103], v[116:119], v[92:95], v[100:103]
v_mfma_f32_16x16x32_bf16 v[104:107], v[120:123], v[92:95], v[104:107]
v_mfma_f32_16x16x32_bf16 v[108:111], v[124:127], v[92:95], v[108:111]
buffer_load_dwordx4 v[92:95], v1, s[8:11], s24 offen offset:3072 sc1
s_waitcnt vmcnt(21)
v_mfma_f32_16x16x32_bf16 v[96:99], a[16:19], v[16:19], v[96:99]
ds_read_b64_tr_b16 v[112:113], v8 offset:12288
v_mfma_f32_16x16x32_bf16 v[100:103], a[20:23], v[16:19], v[100:103]
ds_read_b64_tr_b16 v[114:115], v8 offset:13312
v_mfma_f32_16x16x32_bf16 v[104:107], a[24:27], v[16:19], v[104:107]
ds_read_b64_tr_b16 v[116:117], v9 offset:12288
v_mfma_f32_16x16x32_bf16 v[108:111], a[28:31], v[16:19], v[108:111]
ds_read_b64_tr_b16 v[118:119], v9 offset:13312
s_waitcnt vmcnt(12)
v_cmp_ne_u32 vcc, 1, v6
s_nop 0
s_cmp_eq_u64 vcc, 0
s_cselect_b32 s50, s52, 0
s_cmp_eq_u32 s50, 1
s_cselect_b32 s49, s49, 536870912
s_add_u32 s24, s49, s30
buffer_load_dwordx4 v[16:19], v1, s[8:11], s24 offen offset:0 sc1
s_waitcnt vmcnt(21)
v_mfma_f32_16x16x32_bf16 v[96:99], a[32:35], v[20:23], v[96:99]
ds_read_b64_tr_b16 v[120:121], v10 offset:12288
v_mfma_f32_16x16x32_bf16 v[100:103], a[36:39], v[20:23], v[100:103]
ds_read_b64_tr_b16 v[122:123], v10 offset:13312
v_mfma_f32_16x16x32_bf16 v[104:107], a[40:43], v[20:23], v[104:107]
ds_read_b64_tr_b16 v[124:125], v11 offset:12288
v_mfma_f32_16x16x32_bf16 v[108:111], a[44:47], v[20:23], v[108:111]
ds_read_b64_tr_b16 v[126:127], v11 offset:13312
buffer_load_dwordx4 v[20:23], v1, s[8:11], s24 offen offset:1024 sc1
s_waitcnt vmcnt(21)
v_mfma_f32_16x16x32_bf16 v[96:99], a[48:51], v[24:27], v[96:99]
v_mfma_f32_16x16x32_bf16 v[100:103], a[52:55], v[24:27], v[100:103]
v_mfma_f32_16x16x32_bf16 v[104:107], a[56:59], v[24:27], v[104:107]
v_mfma_f32_16x16x32_bf16 v[108:111], a[60:63], v[24:27], v[108:111]
buffer_load_dwordx4 v[24:27], v1, s[8:11], s24 offen offset:2048 sc1
s_waitcnt vmcnt(21) lgkmcnt(0)
v_mfma_f32_16x16x32_bf16 v[96:99], v[112:115], v[28:31], v[96:99]
v_mfma_f32_16x16x32_bf16 v[100:103], v[116:119], v[28:31], v[100:103]
v_mfma_f32_16x16x32_bf16 v[104:107], v[120:123], v[28:31], v[104:107]
v_mfma_f32_16x16x32_bf16 v[108:111], v[124:127], v[28:31], v[108:111]
buffer_load_dwordx4 v[28:31], v1, s[8:11], s24 offen offset:3072 sc1
s_waitcnt vmcnt(21)
v_mfma_f32_16x16x32_bf16 v[96:99], a[64:67], v[32:35], v[96:99]
ds_read_b64_tr_b16 v[112:113], v8 offset:16384
v_mfma_f32_16x16x32_bf16 v[100:103], a[68:71], v[32:35], v[100:103]
ds_read_b64_tr_b16 v[114:115], v8 offset:17408
v_mfma_f32_16x16x32_bf16 v[104:107], a[72:75], v[32:35], v[104:107]
ds_read_b64_tr_b16 v[116:117], v9 offset:16384
v_mfma_f32_16x16x32_bf16 v[108:111], a[76:79], v[32:35], v[108:111]
ds_read_b64_tr_b16 v[118:119], v9 offset:17408
s_add_u32 s24, s49, s31
buffer_load_dwordx4 v[32:35], v1, s[8:11], s24 offen offset:0 sc1
s_waitcnt vmcnt(21)
v_mfma_f32_16x16x32_bf16 v[96:99], a[80:83], v[36:39], v[96:99]
ds_read_b64_tr_b16 v[120:121], v10 offset:16384
v_mfma_f32_16x16x32_bf16 v[100:103], a[84:87], v[36:39], v[100:103]
ds_read_b64_tr_b16 v[122:123], v10 offset:17408
v_mfma_f32_16x16x32_bf16 v[104:107], a[88:91], v[36:39], v[104:107]
ds_read_b64_tr_b16 v[124:125], v11 offset:16384
v_mfma_f32_16x16x32_bf16 v[108:111], a[92:95], v[36:39], v[108:111]
ds_read_b64_tr_b16 v[126:127], v11 offset:17408
buffer_load_dwordx4 v[36:39], v1, s[8:11], s24 offen offset:1024 sc1
s_waitcnt vmcnt(21)
v_mfma_f32_16x16x32_bf16 v[96:99], a[96:99], v[40:43], v[96:99]
v_mfma_f32_16x16x32_bf16 v[100:103], a[100:103], v[40:43], v[100:103]
v_mfma_f32_16x16x32_bf16 v[104:107], a[104:107], v[40:43], v[104:107]
v_mfma_f32_16x16x32_bf16 v[108:111], a[108:111], v[40:43], v[108:111]
buffer_load_dwordx4 v[40:43], v1, s[8:11], s24 offen offset:2048 sc1
s_waitcnt vmcnt(21) lgkmcnt(0)
v_mfma_f32_16x16x32_bf16 v[96:99], v[112:115], v[44:47], v[96:99]
v_mfma_f32_16x16x32_bf16 v[100:103], v[116:119], v[44:47], v[100:103]
v_mfma_f32_16x16x32_bf16 v[104:107], v[120:123], v[44:47], v[104:107]
v_mfma_f32_16x16x32_bf16 v[108:111], v[124:127], v[44:47], v[108:111]
buffer_load_dwordx4 v[44:47], v1, s[8:11], s24 offen offset:3072 sc1
s_waitcnt vmcnt(19)
v_mfma_f32_16x16x32_bf16 v[96:99], a[112:115], v[48:51], v[96:99]
ds_read_b64_tr_b16 v[112:113], v8 offset:20480
v_mfma_f32_16x16x32_bf16 v[100:103], a[116:119], v[48:51], v[100:103]
ds_read_b64_tr_b16 v[114:115], v8 offset:21504
v_mfma_f32_16x16x32_bf16 v[104:107], a[120:123], v[48:51], v[104:107]
ds_read_b64_tr_b16 v[116:117], v9 offset:20480
v_mfma_f32_16x16x32_bf16 v[108:111], a[124:127], v[48:51], v[108:111]
ds_read_b64_tr_b16 v[118:119], v9 offset:21504
s_add_u32 s24, s49, s32
buffer_load_dwordx4 v[48:51], v1, s[8:11], s24 offen offset:0 sc1
s_waitcnt vmcnt(19)
v_mfma_f32_16x16x32_bf16 v[96:99], a[128:131], v[52:55], v[96:99]
ds_read_b64_tr_b16 v[120:121], v10 offset:20480
v_mfma_f32_16x16x32_bf16 v[100:103], a[132:135], v[52:55], v[100:103]
ds_read_b64_tr_b16 v[122:123], v10 offset:21504
v_mfma_f32_16x16x32_bf16 v[104:107], a[136:139], v[52:55], v[104:107]
ds_read_b64_tr_b16 v[124:125], v11 offset:20480
v_mfma_f32_16x16x32_bf16 v[108:111], a[140:143], v[52:55], v[108:111]
ds_read_b64_tr_b16 v[126:127], v11 offset:21504
buffer_load_dwordx4 v[52:55], v1, s[8:11], s24 offen offset:1024 sc1
s_waitcnt vmcnt(19)
v_mfma_f32_16x16x32_bf16 v[96:99], a[144:147], v[56:59], v[96:99]
v_mfma_f32_16x16x32_bf16 v[100:103], a[148:151], v[56:59], v[100:103]
v_mfma_f32_16x16x32_bf16 v[104:107], a[152:155], v[56:59], v[104:107]
v_mfma_f32_16x16x32_bf16 v[108:111], a[156:159], v[56:59], v[108:111]
buffer_load_dwordx4 v[56:59], v1, s[8:11], s24 offen offset:2048 sc1
s_waitcnt vmcnt(19) lgkmcnt(0)
v_mfma_f32_16x16x32_bf16 v[96:99], v[112:115], v[60:63], v[96:99]
v_mfma_f32_16x16x32_bf16 v[100:103], v[116:119], v[60:63], v[100:103]
v_mfma_f32_16x16x32_bf16 v[104:107], v[120:123], v[60:63], v[104:107]
v_mfma_f32_16x16x32_bf16 v[108:111], v[124:127], v[60:63], v[108:111]
buffer_load_dwordx4 v[60:63], v1, s[8:11], s24 offen offset:3072 sc1
s_waitcnt vmcnt(19)
v_mfma_f32_16x16x32_bf16 v[96:99], a[160:163], v[64:67], v[96:99]
ds_read_b64_tr_b16 v[112:113], v8 offset:24576
v_mfma_f32_16x16x32_bf16 v[100:103], a[164:167], v[64:67], v[100:103]
ds_read_b64_tr_b16 v[114:115], v8 offset:25600
v_mfma_f32_16x16x32_bf16 v[104:107], a[168:171], v[64:67], v[104:107]
ds_read_b64_tr_b16 v[116:117], v9 offset:24576
v_mfma_f32_16x16x32_bf16 v[108:111], a[172:175], v[64:67], v[108:111]
ds_read_b64_tr_b16 v[118:119], v9 offset:25600
s_add_u32 s24, s49, s33
buffer_load_dwordx4 v[64:67], v1, s[8:11], s24 offen offset:0 sc1
s_waitcnt vmcnt(19)
v_mfma_f32_16x16x32_bf16 v[96:99], a[176:179], v[68:71], v[96:99]
ds_read_b64_tr_b16 v[120:121], v10 offset:24576
v_mfma_f32_16x16x32_bf16 v[100:103], a[180:183], v[68:71], v[100:103]
ds_read_b64_tr_b16 v[122:123], v10 offset:25600
v_mfma_f32_16x16x32_bf16 v[104:107], a[184:187], v[68:71], v[104:107]
ds_read_b64_tr_b16 v[124:125], v11 offset:24576
v_mfma_f32_16x16x32_bf16 v[108:111], a[188:191], v[68:71], v[108:111]
ds_read_b64_tr_b16 v[126:127], v11 offset:25600
buffer_load_dwordx4 v[68:71], v1, s[8:11], s24 offen offset:1024 sc1
s_waitcnt vmcnt(19)
v_mfma_f32_16x16x32_bf16 v[96:99], a[192:195], v[72:75], v[96:99]
v_mfma_f32_16x16x32_bf16 v[100:103], a[196:199], v[72:75], v[100:103]
v_mfma_f32_16x16x32_bf16 v[104:107], a[200:203], v[72:75], v[104:107]
v_mfma_f32_16x16x32_bf16 v[108:111], a[204:207], v[72:75], v[108:111]
buffer_load_dwordx4 v[72:75], v1, s[8:11], s24 offen offset:2048 sc1
s_waitcnt vmcnt(19) lgkmcnt(0)
v_mfma_f32_16x16x32_bf16 v[96:99], v[112:115], v[76:79], v[96:99]
v_mfma_f32_16x16x32_bf16 v[100:103], v[116:119], v[76:79], v[100:103]
v_mfma_f32_16x16x32_bf16 v[104:107], v[120:123], v[76:79], v[104:107]
v_mfma_f32_16x16x32_bf16 v[108:111], v[124:127], v[76:79], v[108:111]
buffer_load_dwordx4 v[76:79], v1, s[8:11], s24 offen offset:3072 sc1
s_waitcnt vmcnt(19)
v_mfma_f32_16x16x32_bf16 v[96:99], a[208:211], v[80:83], v[96:99]
ds_read_b64_tr_b16 v[112:113], v8 offset:28672
v_mfma_f32_16x16x32_bf16 v[100:103], a[212:215], v[80:83], v[100:103]
ds_read_b64_tr_b16 v[114:115], v8 offset:29696
v_mfma_f32_16x16x32_bf16 v[104:107], a[216:219], v[80:83], v[104:107]
ds_read_b64_tr_b16 v[116:117], v9 offset:28672
v_mfma_f32_16x16x32_bf16 v[108:111], a[220:223], v[80:83], v[108:111]
ds_read_b64_tr_b16 v[118:119], v9 offset:29696
s_add_u32 s24, s49, s34
buffer_load_dwordx4 v[80:83], v1, s[8:11], s24 offen offset:0 sc1
s_waitcnt vmcnt(19)
v_mfma_f32_16x16x32_bf16 v[96:99], a[224:227], v[84:87], v[96:99]
ds_read_b64_tr_b16 v[120:121], v10 offset:28672
v_mfma_f32_16x16x32_bf16 v[100:103], a[228:231], v[84:87], v[100:103]
ds_read_b64_tr_b16 v[122:123], v10 offset:29696
v_mfma_f32_16x16x32_bf16 v[104:107], a[232:235], v[84:87], v[104:107]
ds_read_b64_tr_b16 v[124:125], v11 offset:28672
v_mfma_f32_16x16x32_bf16 v[108:111], a[236:239], v[84:87], v[108:111]
ds_read_b64_tr_b16 v[126:127], v11 offset:29696
buffer_load_dwordx4 v[84:87], v1, s[8:11], s24 offen offset:1024 sc1
s_waitcnt vmcnt(19)
v_mfma_f32_16x16x32_bf16 v[96:99], a[240:243], v[88:91], v[96:99]
v_mfma_f32_16x16x32_bf16 v[100:103], a[244:247], v[88:91], v[100:103]
v_mfma_f32_16x16x32_bf16 v[104:107], a[248:251], v[88:91], v[104:107]
v_mfma_f32_16x16x32_bf16 v[108:111], a[252:255], v[88:91], v[108:111]
buffer_load_dwordx4 v[88:91], v1, s[8:11], s24 offen offset:2048 sc1
s_waitcnt vmcnt(19) lgkmcnt(0)
v_mfma_f32_16x16x32_bf16 v[96:99], v[112:115], v[92:95], v[96:99]
v_mfma_f32_16x16x32_bf16 v[100:103], v[116:119], v[92:95], v[100:103]
v_mfma_f32_16x16x32_bf16 v[104:107], v[120:123], v[92:95], v[104:107]
v_mfma_f32_16x16x32_bf16 v[108:111], v[124:127], v[92:95], v[108:111]
buffer_load_dwordx4 v[92:95], v1, s[8:11], s24 offen offset:3072 sc1
s_nop 3
ds_write_b128 v3, v[96:99] offset:0
ds_write_b128 v3, v[100:103] offset:4096
ds_write_b128 v3, v[104:107] offset:8192
ds_write_b128 v3, v[108:111] offset:12288
s_waitcnt lgkmcnt(0)
s_barrier
ds_read_b128 v[96:99], v7 offset:0
ds_read_b128 v[100:103], v7 offset:1024
ds_read_b128 v[104:107], v7 offset:2048
ds_read_b128 v[108:111], v7 offset:3072
ds_read_b64_tr_b16 v[112:113], v8 offset:0
ds_read_b64_tr_b16 v[114:115], v8 offset:1024
ds_read_b64_tr_b16 v[116:117], v9 offset:0
ds_read_b64_tr_b16 v[118:119], v9 offset:1024
ds_read_b64_tr_b16 v[120:121], v10 offset:0
ds_read_b64_tr_b16 v[122:123], v10 offset:1024
ds_read_b64_tr_b16 v[124:125], v11 offset:0
ds_read_b64_tr_b16 v[126:127], v11 offset:1024
s_mul_i32 s24, s41, 36864
s_waitcnt lgkmcnt(10)
v_pk_add_f32 v[96:97], v[96:97], v[100:101]
v_pk_add_f32 v[98:99], v[98:99], v[102:103]
s_waitcnt lgkmcnt(9)
v_pk_add_f32 v[96:97], v[96:97], v[104:105]
v_pk_add_f32 v[98:99], v[98:99], v[106:107]
s_waitcnt lgkmcnt(8)
v_pk_add_f32 v[96:97], v[96:97], v[108:109]
v_pk_add_f32 v[98:99], v[98:99], v[110:111]
v_cvt_pk_bf16_f32 v12, v96, v97
v_cvt_pk_bf16_f32 v13, v98, v99
buffer_store_dwordx2 v[12:13], v4, s[12:15], s24 offen
v_xor_b32 v3, 16384, v3
v_xor_b32 v7, 16384, v7
s_mov_b32 s41, s27
s_mov_b32 s48, s49
s_cmp_eq_u32 s50, 0
s_cbranch_scc1 L_opl_c
s_branch L_opl_r0
L_opl_c:
s_cmp_lg_u32 s52, 0
s_cbranch_scc1 L_opl_w
s_waitcnt lgkmcnt(0)
s_branch L_done
L_team:
v_mov_b32 v12, v0
v_and_b32 v13, 15, v0
v_bfe_u32 v14, v0, 4, 2
v_lshlrev_b32 v1, 4, v12
v_and_b32 v2, 0x3f0, v1
s_mul_i32 s20, s17, 34816
s_add_u32 s20, s20, 24576
v_add_u32 v2, s20, v2
v_and_b32 v15, 1, v12
v_mul_u32_u24 v0, 0xaaaa, v15
v_add_u32 v0, 0xffff4444, v0
v_lshrrev_b32 v18, 2, v13
v_lshl_add_u32 v18, v18, 1, v15
v_bfe_u32 v19, v13, 1, 1
v_lshrrev_b32 v16, 5, v12
v_lshlrev_b32 v16, 8, v16
v_lshl_add_u32 v16, v18, 5, v16
v_and_b32 v17, 1, v14
v_lshl_add_u32 v16, v17, 4, v16
v_and_b32 v17, 0x7f, v16
v_xor_b32 v17, 16, v17
v_add_u32 v16, 4224, v16
v_add_u32 v17, 6272, v17
v_cmp_eq_u32 vcc, 1, v19
s_nop 1
v_cndmask_b32 v7, v17, v16, vcc
v_and_b32 v16, 1, v14
v_xor_b32 v16, v18, v16
v_and_b32 v17, 2, v14
v_lshlrev_b32 v17, 1, v17
v_xor_b32 v16, v16, v17
v_lshlrev_b32 v16, 4, v16
v_lshl_add_u32 v16, v14, 7, v16
v_mul_u32_u24 v17, 2176, v19
v_add_u32 v16, v16, v17
v_add_u32 v5, 0, v16
v_bfe_u32 v20, v13, 3, 1
v_bfe_u32 v21, v13, 1, 1
v_lshlrev_b32 v16, 1, v14
v_xor_b32 v16, v16, v21
v_lshlrev_b32 v17, 2, v20
v_xor_b32 v16, v16, v17
v_lshlrev_b32 v16, 4, v16
v_lshl_add_u32 v16, v20, 8, v16
v_lshl_add_u32 v16, v21, 7, v16
v_bfe_u32 v17, v13, 2, 1
v_lshl_add_u32 v16, v17, 3, v16
v_lshl_add_u32 v16, v15, 2, v16
s_lshl_b32 s20, s17, 9
s_add_u32 s20, s20, 0
v_add_u32 v4, s20, v16
v_xor_b32 v3, 16, v4
v_lshrrev_b32 v16, 4, v12
v_xor_b32 v17, s16, v16
v_lshlrev_b32 v16, 12, v16
v_lshl_add_u32 v16, v17, 7, v16
v_lshl_add_u32 v9, v13, 3, v16
s_lshr_b32 s20, s17, 1
s_lshl_b32 s20, s20, 2
v_add_u32 v16, s20, v14
v_xor_b32 v17, s16, v16
v_lshlrev_b32 v16, 12, v16
v_lshl_add_u32 v16, v17, 7, v16
v_lshl_add_u32 v16, v13, 2, v16
s_and_b32 s20, s17, 1
s_lshl_b32 s20, s20, 6
s_add_u32 s20, s20, 262144
v_add_u32 v10, s20, v16
v_bfe_u32 v16, v13, 2, 1
v_lshlrev_b32 v16, 5, v16
v_and_b32 v17, 1, v14
v_lshl_add_u32 v16, v17, 8, v16
v_lshrrev_b32 v17, 1, v14
v_lshl_add_u32 v16, v17, 4, v16
v_and_b32 v17, 3, v13
v_lshl_add_u32 v11, v17, 2, v16
v_lshlrev_b32 v6, 7, v12
v_lshlrev_b32 v8, 2, v12
s_mov_b32 s36, 0x11111111
s_mov_b32 s37, 0x11111111
s_mov_b32 s38, 0x22222222
s_mov_b32 s39, 0x22222222
s_mov_b32 s40, 0x44444444
s_mov_b32 s41, 0x44444444
s_mov_b32 s42, 0x88888888
s_mov_b32 s43, 0x88888888
s_mov_b32 s44, 0xf0f0f0f0
s_mov_b32 s45, 0xf0f0f0f0
s_mov_b32 s18, 0x3e0293ee
s_lshl_b32 s20, s17, 5
s_add_u32 s20, s20, s16
s_cmp_lt_u32 s20, 72
s_cselect_b32 s48, 1, 0
s_lshl_b32 s23, s20, 12
s_lshl_b32 s21, s17, 10
s_sub_u32 s23, s23, s21
s_lshr_b32 s24, s20, 2
s_lshl_b32 s24, s24, 9
s_and_b32 s21, s20, 3
s_lshl_b32 s21, s21, 6
s_add_u32 s24, s24, s21
s_add_u32 s24, s24, 110100480
s_cmp_lt_u32 s20, 72
s_cselect_b32 s24, s24, 536870912
s_lshl_b32 s25, s16, 12
s_add_u32 s26, s25, 131072
s_add_u32 s27, s25, 262144
s_cmp_lt_u32 s16, 8
s_cselect_b32 s27, s27, 536870912
s_mov_b32 s28, 109051904
s_mov_b32 s29, 109346816
s_lshl_b32 s30, s16, 20
s_add_u32 s30, s30, 33554432
s_lshl_b32 s31, s16, 12
s_add_u32 s31, s31, 100663296
s_add_u32 s35, s24, 32768
s_mov_b32 s53, 0x3f803f80
s_mov_b32 s86, 0x33333333
s_mov_b32 s87, 0x33333333
s_lshl_b32 s84, s17, 13
s_sub_u32 s84, s20, s84
s_add_u32 s84, s84, 110886912
s_cmp_lt_u32 s20, 72
s_cselect_b32 s84, s84, 536870912
s_and_b32 s21, s16, 3
s_lshl_b32 s21, s21, 7
s_add_u32 s21, s21, 110886144
s_cmp_eq_u32 s17, 3
s_cselect_b32 s84, s21, s84
s_lshl_b32 s82, s16, 7
s_add_u32 s83, s82, 111152384
s_add_u32 s82, s82, 111148288
s_mov_b32 s19, 0
v_mov_b32 v64, -1
v_mov_b32 v65, -1
v_mov_b32 v66, -1
v_mov_b32 v67, -1
s_add_u32 s20, s28, s25
buffer_store_dwordx4 v[64:67], v1, s[8:11], s20 offen
s_add_u32 s20, s28, s26
buffer_store_dwordx4 v[64:67], v1, s[8:11], s20 offen
s_add_u32 s20, s28, s27
buffer_store_dwordx4 v[64:67], v1, s[8:11], s20 offen
s_add_u32 s20, s29, s25
buffer_store_dwordx4 v[64:67], v1, s[8:11], s20 offen
s_add_u32 s20, s29, s26
buffer_store_dwordx4 v[64:67], v1, s[8:11], s20 offen
s_add_u32 s20, s29, s27
buffer_store_dwordx4 v[64:67], v1, s[8:11], s20 offen
s_add_u32 s20, s24, 16384
buffer_store_dword v64, v11, s[8:11], s20 offen
s_cmp_eq_u32 s17, 3
s_cselect_b32 s20, 536870912, s84
s_mov_b64 exec, 15
buffer_store_byte v64, v6, s[8:11], s20 offen
s_mov_b64 exec, -1
v_lshrrev_b32 v0, 4, v1
s_waitcnt vmcnt(0)
s_barrier
s_cmp_eq_u32 s17, 0
s_cbranch_scc0 L_tw
s_mov_b64 exec, 1
v_mov_b32 v1, 1
v_mov_b32 v2, 64
buffer_atomic_add v1, v2, s[56:59], 0 offen
s_mov_b64 exec, -1
L_tw:
s_mov_b32 s46, 0x05040100
s_mov_b32 s47, 0x07060302
v_and_b32 v3, 63, v0
v_lshlrev_b32 v3, 4, v3
s_mul_i32 s20, s17, 34816
s_add_u32 s20, s20, 24576
v_add_u32 v3, s20, v3
v_bfe_u32 v64, v0, 5, 1
v_bfe_u32 v65, v0, 4, 1
v_and_b32 v66, 15, v0
v_lshlrev_b32 v1, 17, v64
v_lshl_add_u32 v1, v65, 14, v1
v_lshl_add_u32 v1, v66, 2, v1
s_lshl_b32 s20, s16, 8
s_lshl_b32 s21, s17, 6
s_add_u32 s20, s20, s21
v_add_u32 v1, s20, v1
v_lshlrev_b32 v2, 4, v64
v_lshl_add_u32 v2, v65, 2, v2
v_mul_u32_u24 v2, 1152, v2
s_mul_i32 s20, s16, 147456
v_add_u32 v2, s20, v2
v_and_b32 v4, 15, v0
s_lshl_b32 s20, s17, 4
v_add_u32 v4, s20, v4
v_lshlrev_b32 v4, 1, v4
v_add_u32 v2, v2, v4
v_add_u32 v4, v2, v4
s_load_dwordx2 s[50:51], s[0:1], 88
s_waitcnt lgkmcnt(0)
s_mov_b32 s12, s50
s_and_b32 s13, s51, 0xffff
s_mov_b32 s14, 4718592
s_mov_b32 s15, 0x20000
s_mov_b32 s20, 0
buffer_load_dword v6, v4, s[12:15], s20 offen
s_mov_b32 s21, 1152
buffer_load_dword v7, v4, s[12:15], s21 offen
s_mov_b32 s20, 9216
buffer_load_dword v8, v4, s[12:15], s20 offen
s_mov_b32 s21, 10368
buffer_load_dword v9, v4, s[12:15], s21 offen
s_mov_b32 s20, 2304
buffer_load_dword v10, v4, s[12:15], s20 offen
s_mov_b32 s21, 3456
buffer_load_dword v11, v4, s[12:15], s21 offen
s_mov_b32 s20, 11520
buffer_load_dword v12, v4, s[12:15], s20 offen
s_mov_b32 s21, 12672
buffer_load_dword v13, v4, s[12:15], s21 offen
s_mov_b32 s20, 36864
buffer_load_dword v14, v4, s[12:15], s20 offen
s_mov_b32 s21, 38016
buffer_load_dword v15, v4, s[12:15], s21 offen
s_mov_b32 s20, 46080
buffer_load_dword v16, v4, s[12:15], s20 offen
s_mov_b32 s21, 47232
buffer_load_dword v17, v4, s[12:15], s21 offen
s_mov_b32 s20, 39168
buffer_load_dword v18, v4, s[12:15], s20 offen
s_mov_b32 s21, 40320
buffer_load_dword v19, v4, s[12:15], s21 offen
s_mov_b32 s20, 48384
buffer_load_dword v20, v4, s[12:15], s20 offen
s_mov_b32 s21, 49536
buffer_load_dword v21, v4, s[12:15], s21 offen
s_mov_b32 s20, 73728
buffer_load_dword v22, v4, s[12:15], s20 offen
s_mov_b32 s21, 74880
buffer_load_dword v23, v4, s[12:15], s21 offen
s_mov_b32 s20, 82944
buffer_load_dword v24, v4, s[12:15], s20 offen
s_mov_b32 s21, 84096
buffer_load_dword v25, v4, s[12:15], s21 offen
s_mov_b32 s20, 76032
buffer_load_dword v26, v4, s[12:15], s20 offen
s_mov_b32 s21, 77184
buffer_load_dword v27, v4, s[12:15], s21 offen
s_mov_b32 s20, 85248
buffer_load_dword v28, v4, s[12:15], s20 offen
s_mov_b32 s21, 86400
buffer_load_dword v29, v4, s[12:15], s21 offen
s_mov_b32 s20, 110592
buffer_load_dword v30, v4, s[12:15], s20 offen
s_mov_b32 s21, 111744
buffer_load_dword v31, v4, s[12:15], s21 offen
s_mov_b32 s20, 119808
buffer_load_dword v32, v4, s[12:15], s20 offen
s_mov_b32 s21, 120960
buffer_load_dword v33, v4, s[12:15], s21 offen
s_mov_b32 s20, 112896
buffer_load_dword v34, v4, s[12:15], s20 offen
s_mov_b32 s21, 114048
buffer_load_dword v35, v4, s[12:15], s21 offen
s_mov_b32 s20, 122112
buffer_load_dword v36, v4, s[12:15], s20 offen
s_mov_b32 s21, 123264
buffer_load_dword v37, v4, s[12:15], s21 offen
s_mov_b32 s20, 256
buffer_load_dword v38, v4, s[12:15], s20 offen
s_mov_b32 s21, 1408
buffer_load_dword v39, v4, s[12:15], s21 offen
s_mov_b32 s20, 9472
buffer_load_dword v40, v4, s[12:15], s20 offen
s_mov_b32 s21, 10624
buffer_load_dword v41, v4, s[12:15], s21 offen
s_mov_b32 s20, 2560
buffer_load_dword v42, v4, s[12:15], s20 offen
s_mov_b32 s21, 3712
buffer_load_dword v43, v4, s[12:15], s21 offen
s_mov_b32 s20, 11776
buffer_load_dword v44, v4, s[12:15], s20 offen
s_mov_b32 s21, 12928
buffer_load_dword v45, v4, s[12:15], s21 offen
s_mov_b32 s20, 37120
buffer_load_dword v46, v4, s[12:15], s20 offen
s_mov_b32 s21, 38272
buffer_load_dword v47, v4, s[12:15], s21 offen
s_mov_b32 s20, 46336
buffer_load_dword v48, v4, s[12:15], s20 offen
s_mov_b32 s21, 47488
buffer_load_dword v49, v4, s[12:15], s21 offen
s_mov_b32 s20, 39424
buffer_load_dword v50, v4, s[12:15], s20 offen
s_mov_b32 s21, 40576
buffer_load_dword v51, v4, s[12:15], s21 offen
s_mov_b32 s20, 48640
buffer_load_dword v52, v4, s[12:15], s20 offen
s_mov_b32 s21, 49792
buffer_load_dword v53, v4, s[12:15], s21 offen
s_mov_b32 s20, 73984
buffer_load_dword v54, v4, s[12:15], s20 offen
s_mov_b32 s21, 75136
buffer_load_dword v55, v4, s[12:15], s21 offen
s_mov_b32 s20, 83200
buffer_load_dword v56, v4, s[12:15], s20 offen
s_mov_b32 s21, 84352
buffer_load_dword v57, v4, s[12:15], s21 offen
s_mov_b32 s20, 76288
buffer_load_dword v58, v4, s[12:15], s20 offen
s_mov_b32 s21, 77440
buffer_load_dword v59, v4, s[12:15], s21 offen
s_mov_b32 s20, 85504
buffer_load_dword v60, v4, s[12:15], s20 offen
s_mov_b32 s21, 86656
buffer_load_dword v61, v4, s[12:15], s21 offen
s_mov_b32 s20, 110848
buffer_load_dword v62, v4, s[12:15], s20 offen
s_mov_b32 s21, 112000
buffer_load_dword v63, v4, s[12:15], s21 offen
s_waitcnt vmcnt(56)
v_perm_b32 v64, v7, v6, s46
v_accvgpr_write_b32 a176, v64
v_perm_b32 v68, v7, v6, s47
v_accvgpr_write_b32 a184, v68
s_mov_b32 s20, 120064
buffer_load_dword v6, v4, s[12:15], s20 offen
s_mov_b32 s21, 121216
buffer_load_dword v7, v4, s[12:15], s21 offen
s_waitcnt vmcnt(56)
v_perm_b32 v65, v9, v8, s46
v_accvgpr_write_b32 a177, v65
v_perm_b32 v69, v9, v8, s47
v_accvgpr_write_b32 a185, v69
s_mov_b32 s20, 113152
buffer_load_dword v8, v4, s[12:15], s20 offen
s_mov_b32 s21, 114304
buffer_load_dword v9, v4, s[12:15], s21 offen
s_waitcnt vmcnt(56)
v_perm_b32 v66, v11, v10, s46
v_accvgpr_write_b32 a178, v66
v_perm_b32 v70, v11, v10, s47
v_accvgpr_write_b32 a186, v70
s_mov_b32 s20, 122368
buffer_load_dword v10, v4, s[12:15], s20 offen
s_mov_b32 s21, 123520
buffer_load_dword v11, v4, s[12:15], s21 offen
s_waitcnt vmcnt(56)
v_perm_b32 v67, v13, v12, s46
v_accvgpr_write_b32 a179, v67
v_perm_b32 v71, v13, v12, s47
v_accvgpr_write_b32 a187, v71
s_mov_b32 s20, 512
buffer_load_dword v12, v4, s[12:15], s20 offen
s_mov_b32 s21, 1664
buffer_load_dword v13, v4, s[12:15], s21 offen
s_waitcnt vmcnt(56)
v_perm_b32 v64, v15, v14, s46
v_accvgpr_write_b32 a180, v64
v_perm_b32 v68, v15, v14, s47
v_accvgpr_write_b32 a188, v68
s_mov_b32 s20, 9728
buffer_load_dword v14, v4, s[12:15], s20 offen
s_mov_b32 s21, 10880
buffer_load_dword v15, v4, s[12:15], s21 offen
s_waitcnt vmcnt(56)
v_perm_b32 v65, v17, v16, s46
v_accvgpr_write_b32 a181, v65
v_perm_b32 v69, v17, v16, s47
v_accvgpr_write_b32 a189, v69
s_mov_b32 s20, 2816
buffer_load_dword v16, v4, s[12:15], s20 offen
s_mov_b32 s21, 3968
buffer_load_dword v17, v4, s[12:15], s21 offen
s_waitcnt vmcnt(56)
v_perm_b32 v66, v19, v18, s46
v_accvgpr_write_b32 a182, v66
v_perm_b32 v70, v19, v18, s47
v_accvgpr_write_b32 a190, v70
s_mov_b32 s20, 12032
buffer_load_dword v18, v4, s[12:15], s20 offen
s_mov_b32 s21, 13184
buffer_load_dword v19, v4, s[12:15], s21 offen
s_waitcnt vmcnt(56)
v_perm_b32 v67, v21, v20, s46
v_accvgpr_write_b32 a183, v67
v_perm_b32 v71, v21, v20, s47
v_accvgpr_write_b32 a191, v71
s_mov_b32 s20, 37376
buffer_load_dword v20, v4, s[12:15], s20 offen
s_mov_b32 s21, 38528
buffer_load_dword v21, v4, s[12:15], s21 offen
s_waitcnt vmcnt(56)
v_perm_b32 v64, v23, v22, s46
v_perm_b32 v68, v23, v22, s47
s_mov_b32 s20, 46592
buffer_load_dword v22, v4, s[12:15], s20 offen
s_mov_b32 s21, 47744
buffer_load_dword v23, v4, s[12:15], s21 offen
s_waitcnt vmcnt(56)
v_perm_b32 v65, v25, v24, s46
v_perm_b32 v69, v25, v24, s47
s_mov_b32 s20, 39680
buffer_load_dword v24, v4, s[12:15], s20 offen
s_mov_b32 s21, 40832
buffer_load_dword v25, v4, s[12:15], s21 offen
s_waitcnt vmcnt(56)
v_perm_b32 v66, v27, v26, s46
v_perm_b32 v70, v27, v26, s47
s_mov_b32 s20, 48896
buffer_load_dword v26, v4, s[12:15], s20 offen
s_mov_b32 s21, 50048
buffer_load_dword v27, v4, s[12:15], s21 offen
s_waitcnt vmcnt(56)
v_perm_b32 v67, v29, v28, s46
ds_write_b128 v3, v[64:67] offset:20480
s_waitcnt lgkmcnt(0)
v_perm_b32 v71, v29, v28, s47
ds_write_b128 v3, v[68:71] offset:22528
s_waitcnt lgkmcnt(0)
s_mov_b32 s20, 74240
buffer_load_dword v28, v4, s[12:15], s20 offen
s_mov_b32 s21, 75392
buffer_load_dword v29, v4, s[12:15], s21 offen
s_waitcnt vmcnt(56)
v_perm_b32 v64, v31, v30, s46
v_perm_b32 v68, v31, v30, s47
s_mov_b32 s20, 83456
buffer_load_dword v30, v4, s[12:15], s20 offen
s_mov_b32 s21, 84608
buffer_load_dword v31, v4, s[12:15], s21 offen
s_waitcnt vmcnt(56)
v_perm_b32 v65, v33, v32, s46
v_perm_b32 v69, v33, v32, s47
s_mov_b32 s20, 76544
buffer_load_dword v32, v4, s[12:15], s20 offen
s_mov_b32 s21, 77696
buffer_load_dword v33, v4, s[12:15], s21 offen
s_waitcnt vmcnt(56)
v_perm_b32 v66, v35, v34, s46
v_perm_b32 v70, v35, v34, s47
s_mov_b32 s20, 85760
buffer_load_dword v34, v4, s[12:15], s20 offen
s_mov_b32 s21, 86912
buffer_load_dword v35, v4, s[12:15], s21 offen
s_waitcnt vmcnt(56)
v_perm_b32 v67, v37, v36, s46
ds_write_b128 v3, v[64:67] offset:21504
s_waitcnt lgkmcnt(0)
v_perm_b32 v71, v37, v36, s47
ds_write_b128 v3, v[68:71] offset:23552
s_waitcnt lgkmcnt(0)
s_mov_b32 s20, 111104
buffer_load_dword v36, v4, s[12:15], s20 offen
s_mov_b32 s21, 112256
buffer_load_dword v37, v4, s[12:15], s21 offen
s_waitcnt vmcnt(56)
v_perm_b32 v64, v39, v38, s46
v_accvgpr_write_b32 a192, v64
v_perm_b32 v68, v39, v38, s47
v_accvgpr_write_b32 a200, v68
s_mov_b32 s20, 120320
buffer_load_dword v38, v4, s[12:15], s20 offen
s_mov_b32 s21, 121472
buffer_load_dword v39, v4, s[12:15], s21 offen
s_waitcnt vmcnt(56)
v_perm_b32 v65, v41, v40, s46
v_accvgpr_write_b32 a193, v65
v_perm_b32 v69, v41, v40, s47
v_accvgpr_write_b32 a201, v69
s_mov_b32 s20, 113408
buffer_load_dword v40, v4, s[12:15], s20 offen
s_mov_b32 s21, 114560
buffer_load_dword v41, v4, s[12:15], s21 offen
s_waitcnt vmcnt(56)
v_perm_b32 v66, v43, v42, s46
v_accvgpr_write_b32 a194, v66
v_perm_b32 v70, v43, v42, s47
v_accvgpr_write_b32 a202, v70
s_mov_b32 s20, 122624
buffer_load_dword v42, v4, s[12:15], s20 offen
s_mov_b32 s21, 123776
buffer_load_dword v43, v4, s[12:15], s21 offen
s_waitcnt vmcnt(56)
v_perm_b32 v67, v45, v44, s46
v_accvgpr_write_b32 a195, v67
v_perm_b32 v71, v45, v44, s47
v_accvgpr_write_b32 a203, v71
s_mov_b32 s20, 768
buffer_load_dword v44, v4, s[12:15], s20 offen
s_mov_b32 s21, 1920
buffer_load_dword v45, v4, s[12:15], s21 offen
s_waitcnt vmcnt(56)
v_perm_b32 v64, v47, v46, s46
v_accvgpr_write_b32 a196, v64
v_perm_b32 v68, v47, v46, s47
v_accvgpr_write_b32 a204, v68
s_mov_b32 s20, 9984
buffer_load_dword v46, v4, s[12:15], s20 offen
s_mov_b32 s21, 11136
buffer_load_dword v47, v4, s[12:15], s21 offen
s_waitcnt vmcnt(56)
v_perm_b32 v65, v49, v48, s46
v_accvgpr_write_b32 a197, v65
v_perm_b32 v69, v49, v48, s47
v_accvgpr_write_b32 a205, v69
s_mov_b32 s20, 3072
buffer_load_dword v48, v4, s[12:15], s20 offen
s_mov_b32 s21, 4224
buffer_load_dword v49, v4, s[12:15], s21 offen
s_waitcnt vmcnt(56)
v_perm_b32 v66, v51, v50, s46
v_accvgpr_write_b32 a198, v66
v_perm_b32 v70, v51, v50, s47
v_accvgpr_write_b32 a206, v70
s_mov_b32 s20, 12288
buffer_load_dword v50, v4, s[12:15], s20 offen
s_mov_b32 s21, 13440
buffer_load_dword v51, v4, s[12:15], s21 offen
s_waitcnt vmcnt(56)
v_perm_b32 v67, v53, v52, s46
v_accvgpr_write_b32 a199, v67
v_perm_b32 v71, v53, v52, s47
v_accvgpr_write_b32 a207, v71
s_mov_b32 s20, 37632
buffer_load_dword v52, v4, s[12:15], s20 offen
s_mov_b32 s21, 38784
buffer_load_dword v53, v4, s[12:15], s21 offen
s_waitcnt vmcnt(56)
v_perm_b32 v64, v55, v54, s46
v_perm_b32 v68, v55, v54, s47
s_mov_b32 s20, 46848
buffer_load_dword v54, v4, s[12:15], s20 offen
s_mov_b32 s21, 48000
buffer_load_dword v55, v4, s[12:15], s21 offen
s_waitcnt vmcnt(56)
v_perm_b32 v65, v57, v56, s46
v_perm_b32 v69, v57, v56, s47
s_mov_b32 s20, 39936
buffer_load_dword v56, v4, s[12:15], s20 offen
s_mov_b32 s21, 41088
buffer_load_dword v57, v4, s[12:15], s21 offen
s_waitcnt vmcnt(56)
v_perm_b32 v66, v59, v58, s46
v_perm_b32 v70, v59, v58, s47
s_mov_b32 s20, 49152
buffer_load_dword v58, v4, s[12:15], s20 offen
s_mov_b32 s21, 50304
buffer_load_dword v59, v4, s[12:15], s21 offen
s_waitcnt vmcnt(56)
v_perm_b32 v67, v61, v60, s46
ds_write_b128 v3, v[64:67] offset:24576
s_waitcnt lgkmcnt(0)
v_perm_b32 v71, v61, v60, s47
ds_write_b128 v3, v[68:71] offset:26624
s_waitcnt lgkmcnt(0)
s_mov_b32 s20, 74496
buffer_load_dword v60, v4, s[12:15], s20 offen
s_mov_b32 s21, 75648
buffer_load_dword v61, v4, s[12:15], s21 offen
s_waitcnt vmcnt(56)
v_perm_b32 v64, v63, v62, s46
v_perm_b32 v68, v63, v62, s47
s_mov_b32 s20, 83712
buffer_load_dword v62, v4, s[12:15], s20 offen
s_mov_b32 s21, 84864
buffer_load_dword v63, v4, s[12:15], s21 offen
s_waitcnt vmcnt(56)
v_perm_b32 v65, v7, v6, s46
v_perm_b32 v69, v7, v6, s47
s_mov_b32 s20, 76800
buffer_load_dword v6, v4, s[12:15], s20 offen
s_mov_b32 s21, 77952
buffer_load_dword v7, v4, s[12:15], s21 offen
s_waitcnt vmcnt(56)
v_perm_b32 v66, v9, v8, s46
v_perm_b32 v70, v9, v8, s47
s_mov_b32 s20, 86016
buffer_load_dword v8, v4, s[12:15], s20 offen
s_mov_b32 s21, 87168
buffer_load_dword v9, v4, s[12:15], s21 offen
s_waitcnt vmcnt(56)
v_perm_b32 v67, v11, v10, s46
ds_write_b128 v3, v[64:67] offset:25600
s_waitcnt lgkmcnt(0)
v_perm_b32 v71, v11, v10, s47
ds_write_b128 v3, v[68:71] offset:27648
s_waitcnt lgkmcnt(0)
s_mov_b32 s20, 111360
buffer_load_dword v10, v4, s[12:15], s20 offen
s_mov_b32 s21, 112512
buffer_load_dword v11, v4, s[12:15], s21 offen
s_waitcnt vmcnt(56)
v_perm_b32 v64, v13, v12, s46
v_accvgpr_write_b32 a208, v64
v_perm_b32 v68, v13, v12, s47
v_accvgpr_write_b32 a216, v68
s_mov_b32 s20, 120576
buffer_load_dword v12, v4, s[12:15], s20 offen
s_mov_b32 s21, 121728
buffer_load_dword v13, v4, s[12:15], s21 offen
s_waitcnt vmcnt(56)
v_perm_b32 v65, v15, v14, s46
v_accvgpr_write_b32 a209, v65
v_perm_b32 v69, v15, v14, s47
v_accvgpr_write_b32 a217, v69
s_mov_b32 s20, 113664
buffer_load_dword v14, v4, s[12:15], s20 offen
s_mov_b32 s21, 114816
buffer_load_dword v15, v4, s[12:15], s21 offen
s_waitcnt vmcnt(56)
v_perm_b32 v66, v17, v16, s46
v_accvgpr_write_b32 a210, v66
v_perm_b32 v70, v17, v16, s47
v_accvgpr_write_b32 a218, v70
s_mov_b32 s20, 122880
buffer_load_dword v16, v4, s[12:15], s20 offen
s_mov_b32 s21, 124032
buffer_load_dword v17, v4, s[12:15], s21 offen
s_waitcnt vmcnt(56)
v_perm_b32 v67, v19, v18, s46
v_accvgpr_write_b32 a211, v67
v_perm_b32 v71, v19, v18, s47
v_accvgpr_write_b32 a219, v71
s_mov_b32 s20, 1024
buffer_load_ushort v18, v2, s[12:15], s20 offen
s_mov_b32 s21, 2176
buffer_load_ushort v19, v2, s[12:15], s21 offen
s_waitcnt vmcnt(56)
v_perm_b32 v64, v21, v20, s46
v_accvgpr_write_b32 a212, v64
v_perm_b32 v68, v21, v20, s47
v_accvgpr_write_b32 a220, v68
s_mov_b32 s20, 10240
buffer_load_ushort v20, v2, s[12:15], s20 offen
s_mov_b32 s21, 11392
buffer_load_ushort v21, v2, s[12:15], s21 offen
s_waitcnt vmcnt(56)
v_perm_b32 v65, v23, v22, s46
v_accvgpr_write_b32 a213, v65
v_perm_b32 v69, v23, v22, s47
v_accvgpr_write_b32 a221, v69
s_mov_b32 s20, 3328
buffer_load_ushort v22, v2, s[12:15], s20 offen
s_mov_b32 s21, 4480
buffer_load_ushort v23, v2, s[12:15], s21 offen
s_waitcnt vmcnt(56)
v_perm_b32 v66, v25, v24, s46
v_accvgpr_write_b32 a214, v66
v_perm_b32 v70, v25, v24, s47
v_accvgpr_write_b32 a222, v70
s_mov_b32 s20, 12544
buffer_load_ushort v24, v2, s[12:15], s20 offen
s_mov_b32 s21, 13696
buffer_load_ushort v25, v2, s[12:15], s21 offen
s_waitcnt vmcnt(56)
v_perm_b32 v67, v27, v26, s46
v_accvgpr_write_b32 a215, v67
v_perm_b32 v71, v27, v26, s47
v_accvgpr_write_b32 a223, v71
s_mov_b32 s20, 37888
buffer_load_ushort v26, v2, s[12:15], s20 offen
s_mov_b32 s21, 39040
buffer_load_ushort v27, v2, s[12:15], s21 offen
s_waitcnt vmcnt(56)
v_perm_b32 v64, v29, v28, s46
v_perm_b32 v68, v29, v28, s47
s_mov_b32 s20, 47104
buffer_load_ushort v28, v2, s[12:15], s20 offen
s_mov_b32 s21, 48256
buffer_load_ushort v29, v2, s[12:15], s21 offen
s_waitcnt vmcnt(56)
v_perm_b32 v65, v31, v30, s46
v_perm_b32 v69, v31, v30, s47
s_mov_b32 s20, 40192
buffer_load_ushort v30, v2, s[12:15], s20 offen
s_mov_b32 s21, 41344
buffer_load_ushort v31, v2, s[12:15], s21 offen
s_waitcnt vmcnt(56)
v_perm_b32 v66, v33, v32, s46
v_perm_b32 v70, v33, v32, s47
s_mov_b32 s20, 49408
buffer_load_ushort v32, v2, s[12:15], s20 offen
s_mov_b32 s21, 50560
buffer_load_ushort v33, v2, s[12:15], s21 offen
s_waitcnt vmcnt(56)
v_perm_b32 v67, v35, v34, s46
ds_write_b128 v3, v[64:67] offset:28672
s_waitcnt lgkmcnt(0)
v_perm_b32 v71, v35, v34, s47
ds_write_b128 v3, v[68:71] offset:30720
s_waitcnt lgkmcnt(0)
s_mov_b32 s20, 74752
buffer_load_ushort v34, v2, s[12:15], s20 offen
s_mov_b32 s21, 75904
buffer_load_ushort v35, v2, s[12:15], s21 offen
s_waitcnt vmcnt(56)
v_perm_b32 v64, v37, v36, s46
v_perm_b32 v68, v37, v36, s47
s_mov_b32 s20, 83968
buffer_load_ushort v36, v2, s[12:15], s20 offen
s_mov_b32 s21, 85120
buffer_load_ushort v37, v2, s[12:15], s21 offen
s_waitcnt vmcnt(56)
v_perm_b32 v65, v39, v38, s46
v_perm_b32 v69, v39, v38, s47
s_mov_b32 s20, 77056
buffer_load_ushort v38, v2, s[12:15], s20 offen
s_mov_b32 s21, 78208
buffer_load_ushort v39, v2, s[12:15], s21 offen
s_waitcnt vmcnt(56)
v_perm_b32 v66, v41, v40, s46
v_perm_b32 v70, v41, v40, s47
s_mov_b32 s20, 86272
buffer_load_ushort v40, v2, s[12:15], s20 offen
s_mov_b32 s21, 87424
buffer_load_ushort v41, v2, s[12:15], s21 offen
s_waitcnt vmcnt(56)
v_perm_b32 v67, v43, v42, s46
ds_write_b128 v3, v[64:67] offset:29696
s_waitcnt lgkmcnt(0)
v_perm_b32 v71, v43, v42, s47
ds_write_b128 v3, v[68:71] offset:31744
s_waitcnt lgkmcnt(0)
s_mov_b32 s20, 111616
buffer_load_ushort v42, v2, s[12:15], s20 offen
s_mov_b32 s21, 112768
buffer_load_ushort v43, v2, s[12:15], s21 offen
s_waitcnt vmcnt(56)
v_perm_b32 v64, v45, v44, s46
v_accvgpr_write_b32 a224, v64
v_perm_b32 v68, v45, v44, s47
v_accvgpr_write_b32 a232, v68
s_mov_b32 s20, 120832
buffer_load_ushort v44, v2, s[12:15], s20 offen
s_mov_b32 s21, 121984
buffer_load_ushort v45, v2, s[12:15], s21 offen
s_waitcnt vmcnt(56)
v_perm_b32 v65, v47, v46, s46
v_accvgpr_write_b32 a225, v65
v_perm_b32 v69, v47, v46, s47
v_accvgpr_write_b32 a233, v69
s_mov_b32 s20, 113920
buffer_load_ushort v46, v2, s[12:15], s20 offen
s_mov_b32 s21, 115072
buffer_load_ushort v47, v2, s[12:15], s21 offen
s_waitcnt vmcnt(56)
v_perm_b32 v66, v49, v48, s46
v_accvgpr_write_b32 a226, v66
v_perm_b32 v70, v49, v48, s47
v_accvgpr_write_b32 a234, v70
s_mov_b32 s20, 123136
buffer_load_ushort v48, v2, s[12:15], s20 offen
s_mov_b32 s21, 124288
buffer_load_ushort v49, v2, s[12:15], s21 offen
s_waitcnt vmcnt(56)
v_perm_b32 v67, v51, v50, s46
v_accvgpr_write_b32 a227, v67
v_perm_b32 v71, v51, v50, s47
v_accvgpr_write_b32 a235, v71
s_load_dwordx2 s[50:51], s[0:1], 64
s_waitcnt lgkmcnt(0)
s_mov_b32 s12, s50
s_and_b32 s13, s51, 0xffff
s_mov_b32 s14, 4718592
s_mov_b32 s15, 0x20000
s_mov_b32 s20, 0
buffer_load_dword v50, v1, s[12:15], s20 offen
s_mov_b32 s21, 32768
buffer_load_dword v51, v1, s[12:15], s21 offen
s_waitcnt vmcnt(56)
v_perm_b32 v64, v53, v52, s46
v_accvgpr_write_b32 a228, v64
v_perm_b32 v68, v53, v52, s47
v_accvgpr_write_b32 a236, v68
s_mov_b32 s20, 65536
buffer_load_dword v52, v1, s[12:15], s20 offen
s_mov_b32 s21, 98304
buffer_load_dword v53, v1, s[12:15], s21 offen
s_waitcnt vmcnt(56)
v_perm_b32 v65, v55, v54, s46
v_accvgpr_write_b32 a229, v65
v_perm_b32 v69, v55, v54, s47
v_accvgpr_write_b32 a237, v69
s_mov_b32 s20, 8192
buffer_load_dword v54, v1, s[12:15], s20 offen
s_mov_b32 s21, 40960
buffer_load_dword v55, v1, s[12:15], s21 offen
s_waitcnt vmcnt(56)
v_perm_b32 v66, v57, v56, s46
v_accvgpr_write_b32 a230, v66
v_perm_b32 v70, v57, v56, s47
v_accvgpr_write_b32 a238, v70
s_mov_b32 s20, 73728
buffer_load_dword v56, v1, s[12:15], s20 offen
s_mov_b32 s21, 106496
buffer_load_dword v57, v1, s[12:15], s21 offen
s_waitcnt vmcnt(56)
v_perm_b32 v67, v59, v58, s46
v_accvgpr_write_b32 a231, v67
v_perm_b32 v71, v59, v58, s47
v_accvgpr_write_b32 a239, v71
s_mov_b32 s20, 262144
buffer_load_dword v58, v1, s[12:15], s20 offen
s_mov_b32 s21, 294912
buffer_load_dword v59, v1, s[12:15], s21 offen
s_waitcnt vmcnt(56)
v_perm_b32 v64, v61, v60, s46
v_perm_b32 v68, v61, v60, s47
v_accvgpr_write_b32 a240, v68
s_mov_b32 s20, 327680
buffer_load_dword v60, v1, s[12:15], s20 offen
s_mov_b32 s21, 360448
buffer_load_dword v61, v1, s[12:15], s21 offen
s_waitcnt vmcnt(56)
v_perm_b32 v65, v63, v62, s46
v_perm_b32 v69, v63, v62, s47
v_accvgpr_write_b32 a241, v69
s_mov_b32 s20, 270336
buffer_load_dword v62, v1, s[12:15], s20 offen
s_mov_b32 s21, 303104
buffer_load_dword v63, v1, s[12:15], s21 offen
s_waitcnt vmcnt(56)
v_perm_b32 v66, v7, v6, s46
v_perm_b32 v70, v7, v6, s47
v_accvgpr_write_b32 a242, v70
s_mov_b32 s20, 335872
buffer_load_dword v6, v1, s[12:15], s20 offen
s_mov_b32 s21, 368640
buffer_load_dword v7, v1, s[12:15], s21 offen
s_waitcnt vmcnt(56)
v_perm_b32 v67, v9, v8, s46
ds_write_b128 v3, v[64:67] offset:32768
s_waitcnt lgkmcnt(0)
v_perm_b32 v71, v9, v8, s47
v_accvgpr_write_b32 a243, v71
s_mov_b32 s20, 524288
buffer_load_dword v8, v1, s[12:15], s20 offen
s_mov_b32 s21, 557056
buffer_load_dword v9, v1, s[12:15], s21 offen
s_waitcnt vmcnt(56)
v_perm_b32 v64, v11, v10, s46
v_perm_b32 v68, v11, v10, s47
v_accvgpr_write_b32 a244, v68
s_mov_b32 s20, 589824
buffer_load_dword v10, v1, s[12:15], s20 offen
s_mov_b32 s21, 622592
buffer_load_dword v11, v1, s[12:15], s21 offen
s_waitcnt vmcnt(56)
v_perm_b32 v65, v13, v12, s46
v_perm_b32 v69, v13, v12, s47
v_accvgpr_write_b32 a245, v69
s_mov_b32 s20, 532480
buffer_load_dword v12, v1, s[12:15], s20 offen
s_mov_b32 s21, 565248
buffer_load_dword v13, v1, s[12:15], s21 offen
s_waitcnt vmcnt(56)
v_perm_b32 v66, v15, v14, s46
v_perm_b32 v70, v15, v14, s47
v_accvgpr_write_b32 a246, v70
s_mov_b32 s20, 598016
buffer_load_dword v14, v1, s[12:15], s20 offen
s_mov_b32 s21, 630784
buffer_load_dword v15, v1, s[12:15], s21 offen
s_waitcnt vmcnt(56)
v_perm_b32 v67, v17, v16, s46
ds_write_b128 v3, v[64:67] offset:33792
s_waitcnt lgkmcnt(0)
v_perm_b32 v71, v17, v16, s47
v_accvgpr_write_b32 a247, v71
s_mov_b32 s20, 786432
buffer_load_dword v16, v1, s[12:15], s20 offen
s_mov_b32 s21, 819200
buffer_load_dword v17, v1, s[12:15], s21 offen
s_waitcnt vmcnt(56)
v_perm_b32 v64, v19, v18, s46
v_accvgpr_write_b32 a248, v64
s_mov_b32 s20, 851968
buffer_load_dword v18, v1, s[12:15], s20 offen
s_mov_b32 s21, 884736
buffer_load_dword v19, v1, s[12:15], s21 offen
s_waitcnt vmcnt(56)
v_perm_b32 v65, v21, v20, s46
v_accvgpr_write_b32 a249, v65
s_mov_b32 s20, 794624
buffer_load_dword v20, v1, s[12:15], s20 offen
s_mov_b32 s21, 827392
buffer_load_dword v21, v1, s[12:15], s21 offen
s_waitcnt vmcnt(56)
v_perm_b32 v66, v23, v22, s46
v_accvgpr_write_b32 a250, v66
s_mov_b32 s20, 860160
buffer_load_dword v22, v1, s[12:15], s20 offen
s_mov_b32 s21, 892928
buffer_load_dword v23, v1, s[12:15], s21 offen
s_waitcnt vmcnt(56)
v_perm_b32 v67, v25, v24, s46
v_accvgpr_write_b32 a251, v67
s_mov_b32 s20, 1048576
buffer_load_dword v24, v1, s[12:15], s20 offen
s_mov_b32 s21, 1081344
buffer_load_dword v25, v1, s[12:15], s21 offen
s_waitcnt vmcnt(56)
v_perm_b32 v64, v27, v26, s46
v_accvgpr_write_b32 a252, v64
s_mov_b32 s20, 1114112
buffer_load_dword v26, v1, s[12:15], s20 offen
s_mov_b32 s21, 1146880
buffer_load_dword v27, v1, s[12:15], s21 offen
s_waitcnt vmcnt(56)
v_perm_b32 v65, v29, v28, s46
v_accvgpr_write_b32 a253, v65
s_mov_b32 s20, 1056768
buffer_load_dword v28, v1, s[12:15], s20 offen
s_mov_b32 s21, 1089536
buffer_load_dword v29, v1, s[12:15], s21 offen
s_waitcnt vmcnt(56)
v_perm_b32 v66, v31, v30, s46
v_accvgpr_write_b32 a254, v66
s_mov_b32 s20, 1122304
buffer_load_dword v30, v1, s[12:15], s20 offen
s_mov_b32 s21, 1155072
buffer_load_dword v31, v1, s[12:15], s21 offen
s_waitcnt vmcnt(56)
v_perm_b32 v67, v33, v32, s46
v_accvgpr_write_b32 a255, v67
s_mov_b32 s20, 1310720
buffer_load_dword v32, v1, s[12:15], s20 offen
s_mov_b32 s21, 1343488
buffer_load_dword v33, v1, s[12:15], s21 offen
s_waitcnt vmcnt(56)
v_perm_b32 v64, v35, v34, s46
s_mov_b32 s20, 1376256
buffer_load_dword v34, v1, s[12:15], s20 offen
s_mov_b32 s21, 1409024
buffer_load_dword v35, v1, s[12:15], s21 offen
s_waitcnt vmcnt(56)
v_perm_b32 v65, v37, v36, s46
s_mov_b32 s20, 1318912
buffer_load_dword v36, v1, s[12:15], s20 offen
s_mov_b32 s21, 1351680
buffer_load_dword v37, v1, s[12:15], s21 offen
s_waitcnt vmcnt(56)
v_perm_b32 v66, v39, v38, s46
s_mov_b32 s20, 1384448
buffer_load_dword v38, v1, s[12:15], s20 offen
s_mov_b32 s21, 1417216
buffer_load_dword v39, v1, s[12:15], s21 offen
s_waitcnt vmcnt(56)
v_perm_b32 v67, v41, v40, s46
ds_write_b128 v3, v[64:67] offset:18432
s_waitcnt lgkmcnt(0)
s_mov_b32 s20, 1572864
buffer_load_dword v40, v1, s[12:15], s20 offen
s_mov_b32 s21, 1605632
buffer_load_dword v41, v1, s[12:15], s21 offen
s_waitcnt vmcnt(56)
v_perm_b32 v64, v43, v42, s46
s_mov_b32 s20, 1638400
buffer_load_dword v42, v1, s[12:15], s20 offen
s_mov_b32 s21, 1671168
buffer_load_dword v43, v1, s[12:15], s21 offen
s_waitcnt vmcnt(56)
v_perm_b32 v65, v45, v44, s46
s_mov_b32 s20, 1581056
buffer_load_dword v44, v1, s[12:15], s20 offen
s_mov_b32 s21, 1613824
buffer_load_dword v45, v1, s[12:15], s21 offen
s_waitcnt vmcnt(56)
v_perm_b32 v66, v47, v46, s46
s_mov_b32 s20, 1646592
buffer_load_dword v46, v1, s[12:15], s20 offen
s_mov_b32 s21, 1679360
buffer_load_dword v47, v1, s[12:15], s21 offen
s_waitcnt vmcnt(56)
v_perm_b32 v67, v49, v48, s46
ds_write_b128 v3, v[64:67] offset:19456
s_waitcnt lgkmcnt(0)
s_mov_b32 s20, 1835008
buffer_load_dword v48, v1, s[12:15], s20 offen
s_mov_b32 s21, 1867776
buffer_load_dword v49, v1, s[12:15], s21 offen
s_waitcnt vmcnt(56)
v_perm_b32 v72, v51, v50, s46
v_perm_b32 v80, v51, v50, s47
s_mov_b32 s20, 1900544
buffer_load_dword v50, v1, s[12:15], s20 offen
s_mov_b32 s21, 1933312
buffer_load_dword v51, v1, s[12:15], s21 offen
s_waitcnt vmcnt(56)
v_perm_b32 v73, v53, v52, s46
v_perm_b32 v81, v53, v52, s47
s_mov_b32 s20, 1843200
buffer_load_dword v52, v1, s[12:15], s20 offen
s_mov_b32 s21, 1875968
buffer_load_dword v53, v1, s[12:15], s21 offen
s_waitcnt vmcnt(56)
v_perm_b32 v74, v55, v54, s46
v_perm_b32 v82, v55, v54, s47
s_mov_b32 s20, 1908736
buffer_load_dword v54, v1, s[12:15], s20 offen
s_mov_b32 s21, 1941504
buffer_load_dword v55, v1, s[12:15], s21 offen
s_waitcnt vmcnt(56)
v_perm_b32 v75, v57, v56, s46
v_perm_b32 v83, v57, v56, s47
s_mov_b32 s20, 2097152
buffer_load_dword v56, v1, s[12:15], s20 offen
s_mov_b32 s21, 2129920
buffer_load_dword v57, v1, s[12:15], s21 offen
s_waitcnt vmcnt(56)
v_perm_b32 v76, v59, v58, s46
v_perm_b32 v84, v59, v58, s47
s_mov_b32 s20, 2162688
buffer_load_dword v58, v1, s[12:15], s20 offen
s_mov_b32 s21, 2195456
buffer_load_dword v59, v1, s[12:15], s21 offen
s_waitcnt vmcnt(56)
v_perm_b32 v77, v61, v60, s46
v_perm_b32 v85, v61, v60, s47
s_mov_b32 s20, 2105344
buffer_load_dword v60, v1, s[12:15], s20 offen
s_mov_b32 s21, 2138112
buffer_load_dword v61, v1, s[12:15], s21 offen
s_waitcnt vmcnt(56)
v_perm_b32 v78, v63, v62, s46
v_perm_b32 v86, v63, v62, s47
s_mov_b32 s20, 2170880
buffer_load_dword v62, v1, s[12:15], s20 offen
s_mov_b32 s21, 2203648
buffer_load_dword v63, v1, s[12:15], s21 offen
s_waitcnt vmcnt(56)
v_perm_b32 v79, v7, v6, s46
v_perm_b32 v87, v7, v6, s47
s_mov_b32 s20, 2359296
buffer_load_dword v6, v1, s[12:15], s20 offen
s_mov_b32 s21, 2392064
buffer_load_dword v7, v1, s[12:15], s21 offen
s_waitcnt vmcnt(56)
v_perm_b32 v96, v9, v8, s46
v_perm_b32 v104, v9, v8, s47
s_mov_b32 s20, 2424832
buffer_load_dword v8, v1, s[12:15], s20 offen
s_mov_b32 s21, 2457600
buffer_load_dword v9, v1, s[12:15], s21 offen
s_waitcnt vmcnt(56)
v_perm_b32 v97, v11, v10, s46
v_perm_b32 v105, v11, v10, s47
s_mov_b32 s20, 2367488
buffer_load_dword v10, v1, s[12:15], s20 offen
s_mov_b32 s21, 2400256
buffer_load_dword v11, v1, s[12:15], s21 offen
s_waitcnt vmcnt(56)
v_perm_b32 v98, v13, v12, s46
v_perm_b32 v106, v13, v12, s47
s_mov_b32 s20, 2433024
buffer_load_dword v12, v1, s[12:15], s20 offen
s_mov_b32 s21, 2465792
buffer_load_dword v13, v1, s[12:15], s21 offen
s_waitcnt vmcnt(56)
v_perm_b32 v99, v15, v14, s46
v_perm_b32 v107, v15, v14, s47
s_mov_b32 s20, 2621440
buffer_load_dword v14, v1, s[12:15], s20 offen
s_mov_b32 s21, 2654208
buffer_load_dword v15, v1, s[12:15], s21 offen
s_waitcnt vmcnt(56)
v_perm_b32 v100, v17, v16, s46
v_perm_b32 v108, v17, v16, s47
s_mov_b32 s20, 2686976
buffer_load_dword v16, v1, s[12:15], s20 offen
s_mov_b32 s21, 2719744
buffer_load_dword v17, v1, s[12:15], s21 offen
s_waitcnt vmcnt(56)
v_perm_b32 v101, v19, v18, s46
v_perm_b32 v109, v19, v18, s47
s_mov_b32 s20, 2629632
buffer_load_dword v18, v1, s[12:15], s20 offen
s_mov_b32 s21, 2662400
buffer_load_dword v19, v1, s[12:15], s21 offen
s_waitcnt vmcnt(56)
v_perm_b32 v102, v21, v20, s46
v_perm_b32 v110, v21, v20, s47
s_mov_b32 s20, 2695168
buffer_load_dword v20, v1, s[12:15], s20 offen
s_mov_b32 s21, 2727936
buffer_load_dword v21, v1, s[12:15], s21 offen
s_waitcnt vmcnt(56)
v_perm_b32 v103, v23, v22, s46
v_perm_b32 v111, v23, v22, s47
s_mov_b32 s20, 2883584
buffer_load_dword v22, v1, s[12:15], s20 offen
s_mov_b32 s21, 2916352
buffer_load_dword v23, v1, s[12:15], s21 offen
s_waitcnt vmcnt(56)
v_perm_b32 v120, v25, v24, s46
v_perm_b32 v128, v25, v24, s47
s_mov_b32 s20, 2949120
buffer_load_dword v24, v1, s[12:15], s20 offen
s_mov_b32 s21, 2981888
buffer_load_dword v25, v1, s[12:15], s21 offen
s_waitcnt vmcnt(56)
v_perm_b32 v121, v27, v26, s46
v_perm_b32 v129, v27, v26, s47
s_mov_b32 s20, 2891776
buffer_load_dword v26, v1, s[12:15], s20 offen
s_mov_b32 s21, 2924544
buffer_load_dword v27, v1, s[12:15], s21 offen
s_waitcnt vmcnt(56)
v_perm_b32 v122, v29, v28, s46
v_perm_b32 v130, v29, v28, s47
s_mov_b32 s20, 2957312
buffer_load_dword v28, v1, s[12:15], s20 offen
s_mov_b32 s21, 2990080
buffer_load_dword v29, v1, s[12:15], s21 offen
s_waitcnt vmcnt(56)
v_perm_b32 v123, v31, v30, s46
v_perm_b32 v131, v31, v30, s47
s_mov_b32 s20, 3145728
buffer_load_dword v30, v1, s[12:15], s20 offen
s_mov_b32 s21, 3178496
buffer_load_dword v31, v1, s[12:15], s21 offen
s_waitcnt vmcnt(56)
v_perm_b32 v124, v33, v32, s46
v_perm_b32 v132, v33, v32, s47
s_mov_b32 s20, 3211264
buffer_load_dword v32, v1, s[12:15], s20 offen
s_mov_b32 s21, 3244032
buffer_load_dword v33, v1, s[12:15], s21 offen
s_waitcnt vmcnt(56)
v_perm_b32 v125, v35, v34, s46
v_perm_b32 v133, v35, v34, s47
s_mov_b32 s20, 3153920
buffer_load_dword v34, v1, s[12:15], s20 offen
s_mov_b32 s21, 3186688
buffer_load_dword v35, v1, s[12:15], s21 offen
s_waitcnt vmcnt(56)
v_perm_b32 v126, v37, v36, s46
v_perm_b32 v134, v37, v36, s47
s_mov_b32 s20, 3219456
buffer_load_dword v36, v1, s[12:15], s20 offen
s_mov_b32 s21, 3252224
buffer_load_dword v37, v1, s[12:15], s21 offen
s_waitcnt vmcnt(56)
v_perm_b32 v127, v39, v38, s46
v_perm_b32 v135, v39, v38, s47
s_mov_b32 s20, 3407872
buffer_load_dword v38, v1, s[12:15], s20 offen
s_mov_b32 s21, 3440640
buffer_load_dword v39, v1, s[12:15], s21 offen
s_waitcnt vmcnt(56)
v_perm_b32 v144, v41, v40, s46
v_perm_b32 v152, v41, v40, s47
s_mov_b32 s20, 3473408
buffer_load_dword v40, v1, s[12:15], s20 offen
s_mov_b32 s21, 3506176
buffer_load_dword v41, v1, s[12:15], s21 offen
s_waitcnt vmcnt(56)
v_perm_b32 v145, v43, v42, s46
v_perm_b32 v153, v43, v42, s47
s_mov_b32 s20, 3416064
buffer_load_dword v42, v1, s[12:15], s20 offen
s_mov_b32 s21, 3448832
buffer_load_dword v43, v1, s[12:15], s21 offen
s_waitcnt vmcnt(56)
v_perm_b32 v146, v45, v44, s46
v_perm_b32 v154, v45, v44, s47
s_mov_b32 s20, 3481600
buffer_load_dword v44, v1, s[12:15], s20 offen
s_mov_b32 s21, 3514368
buffer_load_dword v45, v1, s[12:15], s21 offen
s_waitcnt vmcnt(56)
v_perm_b32 v147, v47, v46, s46
v_perm_b32 v155, v47, v46, s47
s_mov_b32 s20, 3670016
buffer_load_dword v46, v1, s[12:15], s20 offen
s_mov_b32 s21, 3702784
buffer_load_dword v47, v1, s[12:15], s21 offen
s_waitcnt vmcnt(56)
v_perm_b32 v148, v49, v48, s46
v_perm_b32 v156, v49, v48, s47
s_mov_b32 s20, 3735552
buffer_load_dword v48, v1, s[12:15], s20 offen
s_mov_b32 s21, 3768320
buffer_load_dword v49, v1, s[12:15], s21 offen
s_waitcnt vmcnt(56)
v_perm_b32 v149, v51, v50, s46
v_perm_b32 v157, v51, v50, s47
s_mov_b32 s20, 3678208
buffer_load_dword v50, v1, s[12:15], s20 offen
s_mov_b32 s21, 3710976
buffer_load_dword v51, v1, s[12:15], s21 offen
s_waitcnt vmcnt(56)
v_perm_b32 v150, v53, v52, s46
v_perm_b32 v158, v53, v52, s47
s_mov_b32 s20, 3743744
buffer_load_dword v52, v1, s[12:15], s20 offen
s_mov_b32 s21, 3776512
buffer_load_dword v53, v1, s[12:15], s21 offen
s_waitcnt vmcnt(56)
v_perm_b32 v151, v55, v54, s46
v_perm_b32 v159, v55, v54, s47
s_mov_b32 s20, 3932160
buffer_load_dword v54, v1, s[12:15], s20 offen
s_mov_b32 s21, 3964928
buffer_load_dword v55, v1, s[12:15], s21 offen
s_waitcnt vmcnt(56)
v_perm_b32 v168, v57, v56, s46
v_perm_b32 v176, v57, v56, s47
s_mov_b32 s20, 3997696
buffer_load_dword v56, v1, s[12:15], s20 offen
s_mov_b32 s21, 4030464
buffer_load_dword v57, v1, s[12:15], s21 offen
s_waitcnt vmcnt(56)
v_perm_b32 v169, v59, v58, s46
v_perm_b32 v177, v59, v58, s47
s_mov_b32 s20, 3940352
buffer_load_dword v58, v1, s[12:15], s20 offen
s_mov_b32 s21, 3973120
buffer_load_dword v59, v1, s[12:15], s21 offen
s_waitcnt vmcnt(56)
v_perm_b32 v170, v61, v60, s46
v_perm_b32 v178, v61, v60, s47
s_mov_b32 s20, 4005888
buffer_load_dword v60, v1, s[12:15], s20 offen
s_mov_b32 s21, 4038656
buffer_load_dword v61, v1, s[12:15], s21 offen
s_waitcnt vmcnt(56)
v_perm_b32 v171, v63, v62, s46
v_perm_b32 v179, v63, v62, s47
s_mov_b32 s20, 4194304
buffer_load_dword v62, v1, s[12:15], s20 offen
s_mov_b32 s21, 4227072
buffer_load_dword v63, v1, s[12:15], s21 offen
s_waitcnt vmcnt(56)
v_perm_b32 v172, v7, v6, s46
v_perm_b32 v180, v7, v6, s47
s_mov_b32 s20, 4259840
buffer_load_dword v6, v1, s[12:15], s20 offen
s_mov_b32 s21, 4292608
buffer_load_dword v7, v1, s[12:15], s21 offen
s_waitcnt vmcnt(56)
v_perm_b32 v173, v9, v8, s46
v_perm_b32 v181, v9, v8, s47
s_mov_b32 s20, 4202496
buffer_load_dword v8, v1, s[12:15], s20 offen
s_mov_b32 s21, 4235264
buffer_load_dword v9, v1, s[12:15], s21 offen
s_waitcnt vmcnt(56)
v_perm_b32 v174, v11, v10, s46
v_perm_b32 v182, v11, v10, s47
s_mov_b32 s20, 4268032
buffer_load_dword v10, v1, s[12:15], s20 offen
s_mov_b32 s21, 4300800
buffer_load_dword v11, v1, s[12:15], s21 offen
s_waitcnt vmcnt(56)
v_perm_b32 v175, v13, v12, s46
v_perm_b32 v183, v13, v12, s47
s_mov_b32 s20, 4456448
buffer_load_dword v12, v1, s[12:15], s20 offen
s_mov_b32 s21, 4489216
buffer_load_dword v13, v1, s[12:15], s21 offen
s_waitcnt vmcnt(56)
v_perm_b32 v192, v15, v14, s46
v_perm_b32 v200, v15, v14, s47
s_mov_b32 s20, 4521984
buffer_load_dword v14, v1, s[12:15], s20 offen
s_mov_b32 s21, 4554752
buffer_load_dword v15, v1, s[12:15], s21 offen
s_waitcnt vmcnt(56)
v_perm_b32 v193, v17, v16, s46
v_perm_b32 v201, v17, v16, s47
s_mov_b32 s20, 4464640
buffer_load_dword v16, v1, s[12:15], s20 offen
s_mov_b32 s21, 4497408
buffer_load_dword v17, v1, s[12:15], s21 offen
s_waitcnt vmcnt(56)
v_perm_b32 v194, v19, v18, s46
v_perm_b32 v202, v19, v18, s47
s_mov_b32 s20, 4530176
buffer_load_dword v18, v1, s[12:15], s20 offen
s_mov_b32 s21, 4562944
buffer_load_dword v19, v1, s[12:15], s21 offen
s_waitcnt vmcnt(56)
v_perm_b32 v195, v21, v20, s46
v_perm_b32 v203, v21, v20, s47
s_load_dwordx2 s[50:51], s[0:1], 72
s_waitcnt lgkmcnt(0)
s_mov_b32 s12, s50
s_and_b32 s13, s51, 0xffff
s_mov_b32 s14, 4718592
s_mov_b32 s15, 0x20000
s_mov_b32 s20, 0
buffer_load_dword v20, v1, s[12:15], s20 offen
s_mov_b32 s21, 32768
buffer_load_dword v21, v1, s[12:15], s21 offen
s_waitcnt vmcnt(56)
v_perm_b32 v196, v23, v22, s46
v_perm_b32 v204, v23, v22, s47
s_mov_b32 s20, 65536
buffer_load_dword v22, v1, s[12:15], s20 offen
s_mov_b32 s21, 98304
buffer_load_dword v23, v1, s[12:15], s21 offen
s_waitcnt vmcnt(56)
v_perm_b32 v197, v25, v24, s46
v_perm_b32 v205, v25, v24, s47
s_mov_b32 s20, 8192
buffer_load_dword v24, v1, s[12:15], s20 offen
s_mov_b32 s21, 40960
buffer_load_dword v25, v1, s[12:15], s21 offen
s_waitcnt vmcnt(56)
v_perm_b32 v198, v27, v26, s46
v_perm_b32 v206, v27, v26, s47
s_mov_b32 s20, 73728
buffer_load_dword v26, v1, s[12:15], s20 offen
s_mov_b32 s21, 106496
buffer_load_dword v27, v1, s[12:15], s21 offen
s_waitcnt vmcnt(56)
v_perm_b32 v199, v29, v28, s46
v_perm_b32 v207, v29, v28, s47
s_mov_b32 s20, 262144
buffer_load_dword v28, v1, s[12:15], s20 offen
s_mov_b32 s21, 294912
buffer_load_dword v29, v1, s[12:15], s21 offen
s_waitcnt vmcnt(56)
v_perm_b32 v216, v31, v30, s46
v_perm_b32 v224, v31, v30, s47
s_mov_b32 s20, 327680
buffer_load_dword v30, v1, s[12:15], s20 offen
s_mov_b32 s21, 360448
buffer_load_dword v31, v1, s[12:15], s21 offen
s_waitcnt vmcnt(56)
v_perm_b32 v217, v33, v32, s46
v_perm_b32 v225, v33, v32, s47
s_mov_b32 s20, 270336
buffer_load_dword v32, v1, s[12:15], s20 offen
s_mov_b32 s21, 303104
buffer_load_dword v33, v1, s[12:15], s21 offen
s_waitcnt vmcnt(56)
v_perm_b32 v218, v35, v34, s46
v_perm_b32 v226, v35, v34, s47
s_mov_b32 s20, 335872
buffer_load_dword v34, v1, s[12:15], s20 offen
s_mov_b32 s21, 368640
buffer_load_dword v35, v1, s[12:15], s21 offen
s_waitcnt vmcnt(56)
v_perm_b32 v219, v37, v36, s46
v_perm_b32 v227, v37, v36, s47
s_mov_b32 s20, 524288
buffer_load_dword v36, v1, s[12:15], s20 offen
s_mov_b32 s21, 557056
buffer_load_dword v37, v1, s[12:15], s21 offen
s_waitcnt vmcnt(56)
v_perm_b32 v220, v39, v38, s46
v_perm_b32 v228, v39, v38, s47
s_mov_b32 s20, 589824
buffer_load_dword v38, v1, s[12:15], s20 offen
s_mov_b32 s21, 622592
buffer_load_dword v39, v1, s[12:15], s21 offen
s_waitcnt vmcnt(56)
v_perm_b32 v221, v41, v40, s46
v_perm_b32 v229, v41, v40, s47
s_mov_b32 s20, 532480
buffer_load_dword v40, v1, s[12:15], s20 offen
s_mov_b32 s21, 565248
buffer_load_dword v41, v1, s[12:15], s21 offen
s_waitcnt vmcnt(56)
v_perm_b32 v222, v43, v42, s46
v_perm_b32 v230, v43, v42, s47
s_mov_b32 s20, 598016
buffer_load_dword v42, v1, s[12:15], s20 offen
s_mov_b32 s21, 630784
buffer_load_dword v43, v1, s[12:15], s21 offen
s_waitcnt vmcnt(56)
v_perm_b32 v223, v45, v44, s46
v_perm_b32 v231, v45, v44, s47
s_mov_b32 s20, 786432
buffer_load_dword v44, v1, s[12:15], s20 offen
s_mov_b32 s21, 819200
buffer_load_dword v45, v1, s[12:15], s21 offen
s_waitcnt vmcnt(56)
v_perm_b32 v240, v47, v46, s46
v_perm_b32 v248, v47, v46, s47
s_mov_b32 s20, 851968
buffer_load_dword v46, v1, s[12:15], s20 offen
s_mov_b32 s21, 884736
buffer_load_dword v47, v1, s[12:15], s21 offen
s_waitcnt vmcnt(56)
v_perm_b32 v241, v49, v48, s46
v_perm_b32 v249, v49, v48, s47
s_mov_b32 s20, 794624
buffer_load_dword v48, v1, s[12:15], s20 offen
s_mov_b32 s21, 827392
buffer_load_dword v49, v1, s[12:15], s21 offen
s_waitcnt vmcnt(56)
v_perm_b32 v242, v51, v50, s46
v_perm_b32 v250, v51, v50, s47
s_mov_b32 s20, 860160
buffer_load_dword v50, v1, s[12:15], s20 offen
s_mov_b32 s21, 892928
buffer_load_dword v51, v1, s[12:15], s21 offen
s_waitcnt vmcnt(56)
v_perm_b32 v243, v53, v52, s46
v_perm_b32 v251, v53, v52, s47
s_mov_b32 s20, 1048576
buffer_load_dword v52, v1, s[12:15], s20 offen
s_mov_b32 s21, 1081344
buffer_load_dword v53, v1, s[12:15], s21 offen
s_waitcnt vmcnt(56)
v_perm_b32 v244, v55, v54, s46
v_perm_b32 v252, v55, v54, s47
s_mov_b32 s20, 1114112
buffer_load_dword v54, v1, s[12:15], s20 offen
s_mov_b32 s21, 1146880
buffer_load_dword v55, v1, s[12:15], s21 offen
s_waitcnt vmcnt(56)
v_perm_b32 v245, v57, v56, s46
v_perm_b32 v253, v57, v56, s47
s_mov_b32 s20, 1056768
buffer_load_dword v56, v1, s[12:15], s20 offen
s_mov_b32 s21, 1089536
buffer_load_dword v57, v1, s[12:15], s21 offen
s_waitcnt vmcnt(56)
v_perm_b32 v246, v59, v58, s46
v_perm_b32 v254, v59, v58, s47
s_mov_b32 s20, 1122304
buffer_load_dword v58, v1, s[12:15], s20 offen
s_mov_b32 s21, 1155072
buffer_load_dword v59, v1, s[12:15], s21 offen
s_waitcnt vmcnt(56)
v_perm_b32 v247, v61, v60, s46
v_perm_b32 v255, v61, v60, s47
s_mov_b32 s20, 1310720
buffer_load_dword v60, v1, s[12:15], s20 offen
s_mov_b32 s21, 1343488
buffer_load_dword v61, v1, s[12:15], s21 offen
s_waitcnt vmcnt(56)
v_perm_b32 v64, v63, v62, s46
v_accvgpr_write_b32 a8, v64
v_perm_b32 v68, v63, v62, s47
v_accvgpr_write_b32 a16, v68
s_mov_b32 s20, 1376256
buffer_load_dword v62, v1, s[12:15], s20 offen
s_mov_b32 s21, 1409024
buffer_load_dword v63, v1, s[12:15], s21 offen
s_waitcnt vmcnt(56)
v_perm_b32 v65, v7, v6, s46
v_accvgpr_write_b32 a9, v65
v_perm_b32 v69, v7, v6, s47
v_accvgpr_write_b32 a17, v69
s_mov_b32 s20, 1318912
buffer_load_dword v6, v1, s[12:15], s20 offen
s_mov_b32 s21, 1351680
buffer_load_dword v7, v1, s[12:15], s21 offen
s_waitcnt vmcnt(56)
v_perm_b32 v66, v9, v8, s46
v_accvgpr_write_b32 a10, v66
v_perm_b32 v70, v9, v8, s47
v_accvgpr_write_b32 a18, v70
s_mov_b32 s20, 1384448
buffer_load_dword v8, v1, s[12:15], s20 offen
s_mov_b32 s21, 1417216
buffer_load_dword v9, v1, s[12:15], s21 offen
s_waitcnt vmcnt(56)
v_perm_b32 v67, v11, v10, s46
v_accvgpr_write_b32 a11, v67
v_perm_b32 v71, v11, v10, s47
v_accvgpr_write_b32 a19, v71
s_mov_b32 s20, 1572864
buffer_load_dword v10, v1, s[12:15], s20 offen
s_mov_b32 s21, 1605632
buffer_load_dword v11, v1, s[12:15], s21 offen
s_waitcnt vmcnt(56)
v_perm_b32 v64, v13, v12, s46
v_accvgpr_write_b32 a12, v64
v_perm_b32 v68, v13, v12, s47
v_accvgpr_write_b32 a20, v68
s_mov_b32 s20, 1638400
buffer_load_dword v12, v1, s[12:15], s20 offen
s_mov_b32 s21, 1671168
buffer_load_dword v13, v1, s[12:15], s21 offen
s_waitcnt vmcnt(56)
v_perm_b32 v65, v15, v14, s46
v_accvgpr_write_b32 a13, v65
v_perm_b32 v69, v15, v14, s47
v_accvgpr_write_b32 a21, v69
s_mov_b32 s20, 1581056
buffer_load_dword v14, v1, s[12:15], s20 offen
s_mov_b32 s21, 1613824
buffer_load_dword v15, v1, s[12:15], s21 offen
s_waitcnt vmcnt(56)
v_perm_b32 v66, v17, v16, s46
v_accvgpr_write_b32 a14, v66
v_perm_b32 v70, v17, v16, s47
v_accvgpr_write_b32 a22, v70
s_mov_b32 s20, 1646592
buffer_load_dword v16, v1, s[12:15], s20 offen
s_mov_b32 s21, 1679360
buffer_load_dword v17, v1, s[12:15], s21 offen
s_waitcnt vmcnt(56)
v_perm_b32 v67, v19, v18, s46
v_accvgpr_write_b32 a15, v67
v_perm_b32 v71, v19, v18, s47
v_accvgpr_write_b32 a23, v71
s_mov_b32 s20, 1835008
buffer_load_dword v18, v1, s[12:15], s20 offen
s_mov_b32 s21, 1867776
buffer_load_dword v19, v1, s[12:15], s21 offen
s_waitcnt vmcnt(56)
v_perm_b32 v88, v21, v20, s46
v_perm_b32 v68, v21, v20, s47
s_mov_b32 s20, 1900544
buffer_load_dword v20, v1, s[12:15], s20 offen
s_mov_b32 s21, 1933312
buffer_load_dword v21, v1, s[12:15], s21 offen
s_waitcnt vmcnt(56)
v_perm_b32 v89, v23, v22, s46
v_perm_b32 v69, v23, v22, s47
s_mov_b32 s20, 1843200
buffer_load_dword v22, v1, s[12:15], s20 offen
s_mov_b32 s21, 1875968
buffer_load_dword v23, v1, s[12:15], s21 offen
s_waitcnt vmcnt(56)
v_perm_b32 v90, v25, v24, s46
v_perm_b32 v70, v25, v24, s47
s_mov_b32 s20, 1908736
buffer_load_dword v24, v1, s[12:15], s20 offen
s_mov_b32 s21, 1941504
buffer_load_dword v25, v1, s[12:15], s21 offen
s_waitcnt vmcnt(56)
v_perm_b32 v91, v27, v26, s46
v_perm_b32 v71, v27, v26, s47
ds_write_b128 v3, v[68:71] offset:0
s_waitcnt lgkmcnt(0)
s_mov_b32 s20, 2097152
buffer_load_dword v26, v1, s[12:15], s20 offen
s_mov_b32 s21, 2129920
buffer_load_dword v27, v1, s[12:15], s21 offen
s_waitcnt vmcnt(56)
v_perm_b32 v92, v29, v28, s46
v_perm_b32 v68, v29, v28, s47
s_mov_b32 s20, 2162688
buffer_load_dword v28, v1, s[12:15], s20 offen
s_mov_b32 s21, 2195456
buffer_load_dword v29, v1, s[12:15], s21 offen
s_waitcnt vmcnt(56)
v_perm_b32 v93, v31, v30, s46
v_perm_b32 v69, v31, v30, s47
s_mov_b32 s20, 2105344
buffer_load_dword v30, v1, s[12:15], s20 offen
s_mov_b32 s21, 2138112
buffer_load_dword v31, v1, s[12:15], s21 offen
s_waitcnt vmcnt(56)
v_perm_b32 v94, v33, v32, s46
v_perm_b32 v70, v33, v32, s47
s_mov_b32 s20, 2170880
buffer_load_dword v32, v1, s[12:15], s20 offen
s_mov_b32 s21, 2203648
buffer_load_dword v33, v1, s[12:15], s21 offen
s_waitcnt vmcnt(56)
v_perm_b32 v95, v35, v34, s46
v_perm_b32 v71, v35, v34, s47
ds_write_b128 v3, v[68:71] offset:1024
s_waitcnt lgkmcnt(0)
s_mov_b32 s20, 2359296
buffer_load_dword v34, v1, s[12:15], s20 offen
s_mov_b32 s21, 2392064
buffer_load_dword v35, v1, s[12:15], s21 offen
s_waitcnt vmcnt(56)
v_perm_b32 v112, v37, v36, s46
v_perm_b32 v68, v37, v36, s47
s_mov_b32 s20, 2424832
buffer_load_dword v36, v1, s[12:15], s20 offen
s_mov_b32 s21, 2457600
buffer_load_dword v37, v1, s[12:15], s21 offen
s_waitcnt vmcnt(56)
v_perm_b32 v113, v39, v38, s46
v_perm_b32 v69, v39, v38, s47
s_mov_b32 s20, 2367488
buffer_load_dword v38, v1, s[12:15], s20 offen
s_mov_b32 s21, 2400256
buffer_load_dword v39, v1, s[12:15], s21 offen
s_waitcnt vmcnt(56)
v_perm_b32 v114, v41, v40, s46
v_perm_b32 v70, v41, v40, s47
s_mov_b32 s20, 2433024
buffer_load_dword v40, v1, s[12:15], s20 offen
s_mov_b32 s21, 2465792
buffer_load_dword v41, v1, s[12:15], s21 offen
s_waitcnt vmcnt(56)
v_perm_b32 v115, v43, v42, s46
v_perm_b32 v71, v43, v42, s47
ds_write_b128 v3, v[68:71] offset:2048
s_waitcnt lgkmcnt(0)
s_mov_b32 s20, 2621440
buffer_load_dword v42, v1, s[12:15], s20 offen
s_mov_b32 s21, 2654208
buffer_load_dword v43, v1, s[12:15], s21 offen
s_waitcnt vmcnt(56)
v_perm_b32 v116, v45, v44, s46
v_perm_b32 v68, v45, v44, s47
s_mov_b32 s20, 2686976
buffer_load_dword v44, v1, s[12:15], s20 offen
s_mov_b32 s21, 2719744
buffer_load_dword v45, v1, s[12:15], s21 offen
s_waitcnt vmcnt(56)
v_perm_b32 v117, v47, v46, s46
v_perm_b32 v69, v47, v46, s47
s_mov_b32 s20, 2629632
buffer_load_dword v46, v1, s[12:15], s20 offen
s_mov_b32 s21, 2662400
buffer_load_dword v47, v1, s[12:15], s21 offen
s_waitcnt vmcnt(56)
v_perm_b32 v118, v49, v48, s46
v_perm_b32 v70, v49, v48, s47
s_mov_b32 s20, 2695168
buffer_load_dword v48, v1, s[12:15], s20 offen
s_mov_b32 s21, 2727936
buffer_load_dword v49, v1, s[12:15], s21 offen
s_waitcnt vmcnt(56)
v_perm_b32 v119, v51, v50, s46
v_perm_b32 v71, v51, v50, s47
ds_write_b128 v3, v[68:71] offset:3072
s_waitcnt lgkmcnt(0)
s_mov_b32 s20, 2883584
buffer_load_dword v50, v1, s[12:15], s20 offen
s_mov_b32 s21, 2916352
buffer_load_dword v51, v1, s[12:15], s21 offen
s_waitcnt vmcnt(56)
v_perm_b32 v136, v53, v52, s46
v_perm_b32 v68, v53, v52, s47
s_mov_b32 s20, 2949120
buffer_load_dword v52, v1, s[12:15], s20 offen
s_mov_b32 s21, 2981888
buffer_load_dword v53, v1, s[12:15], s21 offen
s_waitcnt vmcnt(56)
v_perm_b32 v137, v55, v54, s46
v_perm_b32 v69, v55, v54, s47
s_mov_b32 s20, 2891776
buffer_load_dword v54, v1, s[12:15], s20 offen
s_mov_b32 s21, 2924544
buffer_load_dword v55, v1, s[12:15], s21 offen
s_waitcnt vmcnt(56)
v_perm_b32 v138, v57, v56, s46
v_perm_b32 v70, v57, v56, s47
s_mov_b32 s20, 2957312
buffer_load_dword v56, v1, s[12:15], s20 offen
s_mov_b32 s21, 2990080
buffer_load_dword v57, v1, s[12:15], s21 offen
s_waitcnt vmcnt(56)
v_perm_b32 v139, v59, v58, s46
v_perm_b32 v71, v59, v58, s47
ds_write_b128 v3, v[68:71] offset:4096
s_waitcnt lgkmcnt(0)
s_mov_b32 s20, 3145728
buffer_load_dword v58, v1, s[12:15], s20 offen
s_mov_b32 s21, 3178496
buffer_load_dword v59, v1, s[12:15], s21 offen
s_waitcnt vmcnt(56)
v_perm_b32 v140, v61, v60, s46
v_perm_b32 v68, v61, v60, s47
s_mov_b32 s20, 3211264
buffer_load_dword v60, v1, s[12:15], s20 offen
s_mov_b32 s21, 3244032
buffer_load_dword v61, v1, s[12:15], s21 offen
s_waitcnt vmcnt(56)
v_perm_b32 v141, v63, v62, s46
v_perm_b32 v69, v63, v62, s47
s_mov_b32 s20, 3153920
buffer_load_dword v62, v1, s[12:15], s20 offen
s_mov_b32 s21, 3186688
buffer_load_dword v63, v1, s[12:15], s21 offen
s_waitcnt vmcnt(56)
v_perm_b32 v142, v7, v6, s46
v_perm_b32 v70, v7, v6, s47
s_mov_b32 s20, 3219456
buffer_load_dword v6, v1, s[12:15], s20 offen
s_mov_b32 s21, 3252224
buffer_load_dword v7, v1, s[12:15], s21 offen
s_waitcnt vmcnt(56)
v_perm_b32 v143, v9, v8, s46
v_perm_b32 v71, v9, v8, s47
ds_write_b128 v3, v[68:71] offset:5120
s_waitcnt lgkmcnt(0)
s_mov_b32 s20, 3407872
buffer_load_dword v8, v1, s[12:15], s20 offen
s_mov_b32 s21, 3440640
buffer_load_dword v9, v1, s[12:15], s21 offen
s_waitcnt vmcnt(56)
v_perm_b32 v160, v11, v10, s46
v_perm_b32 v68, v11, v10, s47
s_mov_b32 s20, 3473408
buffer_load_dword v10, v1, s[12:15], s20 offen
s_mov_b32 s21, 3506176
buffer_load_dword v11, v1, s[12:15], s21 offen
s_waitcnt vmcnt(56)
v_perm_b32 v161, v13, v12, s46
v_perm_b32 v69, v13, v12, s47
s_mov_b32 s20, 3416064
buffer_load_dword v12, v1, s[12:15], s20 offen
s_mov_b32 s21, 3448832
buffer_load_dword v13, v1, s[12:15], s21 offen
s_waitcnt vmcnt(56)
v_perm_b32 v162, v15, v14, s46
v_perm_b32 v70, v15, v14, s47
s_mov_b32 s20, 3481600
buffer_load_dword v14, v1, s[12:15], s20 offen
s_mov_b32 s21, 3514368
buffer_load_dword v15, v1, s[12:15], s21 offen
s_waitcnt vmcnt(56)
v_perm_b32 v163, v17, v16, s46
v_perm_b32 v71, v17, v16, s47
ds_write_b128 v3, v[68:71] offset:6144
s_waitcnt lgkmcnt(0)
s_mov_b32 s20, 3670016
buffer_load_dword v16, v1, s[12:15], s20 offen
s_mov_b32 s21, 3702784
buffer_load_dword v17, v1, s[12:15], s21 offen
s_waitcnt vmcnt(56)
v_perm_b32 v164, v19, v18, s46
v_perm_b32 v68, v19, v18, s47
s_mov_b32 s20, 3735552
buffer_load_dword v18, v1, s[12:15], s20 offen
s_mov_b32 s21, 3768320
buffer_load_dword v19, v1, s[12:15], s21 offen
s_waitcnt vmcnt(56)
v_perm_b32 v165, v21, v20, s46
v_perm_b32 v69, v21, v20, s47
s_mov_b32 s20, 3678208
buffer_load_dword v20, v1, s[12:15], s20 offen
s_mov_b32 s21, 3710976
buffer_load_dword v21, v1, s[12:15], s21 offen
s_waitcnt vmcnt(56)
v_perm_b32 v166, v23, v22, s46
v_perm_b32 v70, v23, v22, s47
s_mov_b32 s20, 3743744
buffer_load_dword v22, v1, s[12:15], s20 offen
s_mov_b32 s21, 3776512
buffer_load_dword v23, v1, s[12:15], s21 offen
s_waitcnt vmcnt(56)
v_perm_b32 v167, v25, v24, s46
v_perm_b32 v71, v25, v24, s47
ds_write_b128 v3, v[68:71] offset:7168
s_waitcnt lgkmcnt(0)
s_mov_b32 s20, 3932160
buffer_load_dword v24, v1, s[12:15], s20 offen
s_mov_b32 s21, 3964928
buffer_load_dword v25, v1, s[12:15], s21 offen
s_waitcnt vmcnt(56)
v_perm_b32 v184, v27, v26, s46
v_perm_b32 v68, v27, v26, s47
s_mov_b32 s20, 3997696
buffer_load_dword v26, v1, s[12:15], s20 offen
s_mov_b32 s21, 4030464
buffer_load_dword v27, v1, s[12:15], s21 offen
s_waitcnt vmcnt(56)
v_perm_b32 v185, v29, v28, s46
v_perm_b32 v69, v29, v28, s47
s_mov_b32 s20, 3940352
buffer_load_dword v28, v1, s[12:15], s20 offen
s_mov_b32 s21, 3973120
buffer_load_dword v29, v1, s[12:15], s21 offen
s_waitcnt vmcnt(56)
v_perm_b32 v186, v31, v30, s46
v_perm_b32 v70, v31, v30, s47
s_mov_b32 s20, 4005888
buffer_load_dword v30, v1, s[12:15], s20 offen
s_mov_b32 s21, 4038656
buffer_load_dword v31, v1, s[12:15], s21 offen
s_waitcnt vmcnt(56)
v_perm_b32 v187, v33, v32, s46
v_perm_b32 v71, v33, v32, s47
ds_write_b128 v3, v[68:71] offset:8192
s_waitcnt lgkmcnt(0)
s_mov_b32 s20, 4194304
buffer_load_dword v32, v1, s[12:15], s20 offen
s_mov_b32 s21, 4227072
buffer_load_dword v33, v1, s[12:15], s21 offen
s_waitcnt vmcnt(56)
v_perm_b32 v188, v35, v34, s46
v_perm_b32 v68, v35, v34, s47
s_mov_b32 s20, 4259840
buffer_load_dword v34, v1, s[12:15], s20 offen
s_mov_b32 s21, 4292608
buffer_load_dword v35, v1, s[12:15], s21 offen
s_waitcnt vmcnt(56)
v_perm_b32 v189, v37, v36, s46
v_perm_b32 v69, v37, v36, s47
s_mov_b32 s20, 4202496
buffer_load_dword v36, v1, s[12:15], s20 offen
s_mov_b32 s21, 4235264
buffer_load_dword v37, v1, s[12:15], s21 offen
s_waitcnt vmcnt(56)
v_perm_b32 v190, v39, v38, s46
v_perm_b32 v70, v39, v38, s47
s_mov_b32 s20, 4268032
buffer_load_dword v38, v1, s[12:15], s20 offen
s_mov_b32 s21, 4300800
buffer_load_dword v39, v1, s[12:15], s21 offen
s_waitcnt vmcnt(56)
v_perm_b32 v191, v41, v40, s46
v_perm_b32 v71, v41, v40, s47
ds_write_b128 v3, v[68:71] offset:9216
s_waitcnt lgkmcnt(0)
s_mov_b32 s20, 4456448
buffer_load_dword v40, v1, s[12:15], s20 offen
s_mov_b32 s21, 4489216
buffer_load_dword v41, v1, s[12:15], s21 offen
s_waitcnt vmcnt(56)
v_perm_b32 v208, v43, v42, s46
v_perm_b32 v68, v43, v42, s47
s_mov_b32 s20, 4521984
buffer_load_dword v42, v1, s[12:15], s20 offen
s_mov_b32 s21, 4554752
buffer_load_dword v43, v1, s[12:15], s21 offen
s_waitcnt vmcnt(56)
v_perm_b32 v209, v45, v44, s46
v_perm_b32 v69, v45, v44, s47
s_mov_b32 s20, 4464640
buffer_load_dword v44, v1, s[12:15], s20 offen
s_mov_b32 s21, 4497408
buffer_load_dword v45, v1, s[12:15], s21 offen
s_waitcnt vmcnt(56)
v_perm_b32 v210, v47, v46, s46
v_perm_b32 v70, v47, v46, s47
s_mov_b32 s20, 4530176
buffer_load_dword v46, v1, s[12:15], s20 offen
s_mov_b32 s21, 4562944
buffer_load_dword v47, v1, s[12:15], s21 offen
s_waitcnt vmcnt(56)
v_perm_b32 v211, v49, v48, s46
v_perm_b32 v71, v49, v48, s47
ds_write_b128 v3, v[68:71] offset:10240
s_waitcnt lgkmcnt(0)
s_load_dwordx2 s[50:51], s[0:1], 80
s_waitcnt lgkmcnt(0)
s_mov_b32 s12, s50
s_and_b32 s13, s51, 0xffff
s_mov_b32 s14, 4718592
s_mov_b32 s15, 0x20000
s_mov_b32 s20, 0
buffer_load_dword v48, v1, s[12:15], s20 offen
s_mov_b32 s21, 32768
buffer_load_dword v49, v1, s[12:15], s21 offen
s_waitcnt vmcnt(56)
v_perm_b32 v212, v51, v50, s46
v_perm_b32 v68, v51, v50, s47
s_mov_b32 s20, 65536
buffer_load_dword v50, v1, s[12:15], s20 offen
s_mov_b32 s21, 98304
buffer_load_dword v51, v1, s[12:15], s21 offen
s_waitcnt vmcnt(56)
v_perm_b32 v213, v53, v52, s46
v_perm_b32 v69, v53, v52, s47
s_mov_b32 s20, 8192
buffer_load_dword v52, v1, s[12:15], s20 offen
s_mov_b32 s21, 40960
buffer_load_dword v53, v1, s[12:15], s21 offen
s_waitcnt vmcnt(56)
v_perm_b32 v214, v55, v54, s46
v_perm_b32 v70, v55, v54, s47
s_mov_b32 s20, 73728
buffer_load_dword v54, v1, s[12:15], s20 offen
s_mov_b32 s21, 106496
buffer_load_dword v55, v1, s[12:15], s21 offen
s_waitcnt vmcnt(56)
v_perm_b32 v215, v57, v56, s46
v_perm_b32 v71, v57, v56, s47
ds_write_b128 v3, v[68:71] offset:11264
s_waitcnt lgkmcnt(0)
s_mov_b32 s20, 262144
buffer_load_dword v56, v1, s[12:15], s20 offen
s_mov_b32 s21, 294912
buffer_load_dword v57, v1, s[12:15], s21 offen
s_waitcnt vmcnt(56)
v_perm_b32 v232, v59, v58, s46
v_perm_b32 v68, v59, v58, s47
s_mov_b32 s20, 327680
buffer_load_dword v58, v1, s[12:15], s20 offen
s_mov_b32 s21, 360448
buffer_load_dword v59, v1, s[12:15], s21 offen
s_waitcnt vmcnt(56)
v_perm_b32 v233, v61, v60, s46
v_perm_b32 v69, v61, v60, s47
s_mov_b32 s20, 270336
buffer_load_dword v60, v1, s[12:15], s20 offen
s_mov_b32 s21, 303104
buffer_load_dword v61, v1, s[12:15], s21 offen
s_waitcnt vmcnt(56)
v_perm_b32 v234, v63, v62, s46
v_perm_b32 v70, v63, v62, s47
s_mov_b32 s20, 335872
buffer_load_dword v62, v1, s[12:15], s20 offen
s_mov_b32 s21, 368640
buffer_load_dword v63, v1, s[12:15], s21 offen
s_waitcnt vmcnt(56)
v_perm_b32 v235, v7, v6, s46
v_perm_b32 v71, v7, v6, s47
ds_write_b128 v3, v[68:71] offset:12288
s_waitcnt lgkmcnt(0)
s_mov_b32 s20, 524288
buffer_load_dword v6, v1, s[12:15], s20 offen
s_mov_b32 s21, 557056
buffer_load_dword v7, v1, s[12:15], s21 offen
s_waitcnt vmcnt(56)
v_perm_b32 v236, v9, v8, s46
v_perm_b32 v68, v9, v8, s47
s_mov_b32 s20, 589824
buffer_load_dword v8, v1, s[12:15], s20 offen
s_mov_b32 s21, 622592
buffer_load_dword v9, v1, s[12:15], s21 offen
s_waitcnt vmcnt(56)
v_perm_b32 v237, v11, v10, s46
v_perm_b32 v69, v11, v10, s47
s_mov_b32 s20, 532480
buffer_load_dword v10, v1, s[12:15], s20 offen
s_mov_b32 s21, 565248
buffer_load_dword v11, v1, s[12:15], s21 offen
s_waitcnt vmcnt(56)
v_perm_b32 v238, v13, v12, s46
v_perm_b32 v70, v13, v12, s47
s_mov_b32 s20, 598016
buffer_load_dword v12, v1, s[12:15], s20 offen
s_mov_b32 s21, 630784
buffer_load_dword v13, v1, s[12:15], s21 offen
s_waitcnt vmcnt(56)
v_perm_b32 v239, v15, v14, s46
v_perm_b32 v71, v15, v14, s47
ds_write_b128 v3, v[68:71] offset:13312
s_waitcnt lgkmcnt(0)
s_mov_b32 s20, 786432
buffer_load_dword v14, v1, s[12:15], s20 offen
s_mov_b32 s21, 819200
buffer_load_dword v15, v1, s[12:15], s21 offen
s_waitcnt vmcnt(56)
v_perm_b32 v64, v17, v16, s46
v_accvgpr_write_b32 a0, v64
v_perm_b32 v68, v17, v16, s47
s_mov_b32 s20, 851968
buffer_load_dword v16, v1, s[12:15], s20 offen
s_mov_b32 s21, 884736
buffer_load_dword v17, v1, s[12:15], s21 offen
s_waitcnt vmcnt(56)
v_perm_b32 v65, v19, v18, s46
v_accvgpr_write_b32 a1, v65
v_perm_b32 v69, v19, v18, s47
s_mov_b32 s20, 794624
buffer_load_dword v18, v1, s[12:15], s20 offen
s_mov_b32 s21, 827392
buffer_load_dword v19, v1, s[12:15], s21 offen
s_waitcnt vmcnt(56)
v_perm_b32 v66, v21, v20, s46
v_accvgpr_write_b32 a2, v66
v_perm_b32 v70, v21, v20, s47
s_mov_b32 s20, 860160
buffer_load_dword v20, v1, s[12:15], s20 offen
s_mov_b32 s21, 892928
buffer_load_dword v21, v1, s[12:15], s21 offen
s_waitcnt vmcnt(56)
v_perm_b32 v67, v23, v22, s46
v_accvgpr_write_b32 a3, v67
v_perm_b32 v71, v23, v22, s47
ds_write_b128 v3, v[68:71] offset:14336
s_waitcnt lgkmcnt(0)
s_mov_b32 s20, 1048576
buffer_load_dword v22, v1, s[12:15], s20 offen
s_mov_b32 s21, 1081344
buffer_load_dword v23, v1, s[12:15], s21 offen
s_waitcnt vmcnt(56)
v_perm_b32 v64, v25, v24, s46
v_accvgpr_write_b32 a4, v64
v_perm_b32 v68, v25, v24, s47
s_mov_b32 s20, 1114112
buffer_load_dword v24, v1, s[12:15], s20 offen
s_mov_b32 s21, 1146880
buffer_load_dword v25, v1, s[12:15], s21 offen
s_waitcnt vmcnt(56)
v_perm_b32 v65, v27, v26, s46
v_accvgpr_write_b32 a5, v65
v_perm_b32 v69, v27, v26, s47
s_mov_b32 s20, 1056768
buffer_load_dword v26, v1, s[12:15], s20 offen
s_mov_b32 s21, 1089536
buffer_load_dword v27, v1, s[12:15], s21 offen
s_waitcnt vmcnt(56)
v_perm_b32 v66, v29, v28, s46
v_accvgpr_write_b32 a6, v66
v_perm_b32 v70, v29, v28, s47
s_mov_b32 s20, 1122304
buffer_load_dword v28, v1, s[12:15], s20 offen
s_mov_b32 s21, 1155072
buffer_load_dword v29, v1, s[12:15], s21 offen
s_waitcnt vmcnt(56)
v_perm_b32 v67, v31, v30, s46
v_accvgpr_write_b32 a7, v67
v_perm_b32 v71, v31, v30, s47
ds_write_b128 v3, v[68:71] offset:15360
s_waitcnt lgkmcnt(0)
s_mov_b32 s20, 1310720
buffer_load_dword v30, v1, s[12:15], s20 offen
s_mov_b32 s21, 1343488
buffer_load_dword v31, v1, s[12:15], s21 offen
s_waitcnt vmcnt(56)
v_perm_b32 v64, v33, v32, s46
v_accvgpr_write_b32 a24, v64
v_perm_b32 v68, v33, v32, s47
s_mov_b32 s20, 1376256
buffer_load_dword v32, v1, s[12:15], s20 offen
s_mov_b32 s21, 1409024
buffer_load_dword v33, v1, s[12:15], s21 offen
s_waitcnt vmcnt(56)
v_perm_b32 v65, v35, v34, s46
v_accvgpr_write_b32 a25, v65
v_perm_b32 v69, v35, v34, s47
s_mov_b32 s20, 1318912
buffer_load_dword v34, v1, s[12:15], s20 offen
s_mov_b32 s21, 1351680
buffer_load_dword v35, v1, s[12:15], s21 offen
s_waitcnt vmcnt(56)
v_perm_b32 v66, v37, v36, s46
v_accvgpr_write_b32 a26, v66
v_perm_b32 v70, v37, v36, s47
s_mov_b32 s20, 1384448
buffer_load_dword v36, v1, s[12:15], s20 offen
s_mov_b32 s21, 1417216
buffer_load_dword v37, v1, s[12:15], s21 offen
s_waitcnt vmcnt(56)
v_perm_b32 v67, v39, v38, s46
v_accvgpr_write_b32 a27, v67
v_perm_b32 v71, v39, v38, s47
ds_write_b128 v3, v[68:71] offset:16384
s_waitcnt lgkmcnt(0)
s_mov_b32 s20, 1572864
buffer_load_dword v38, v1, s[12:15], s20 offen
s_mov_b32 s21, 1605632
buffer_load_dword v39, v1, s[12:15], s21 offen
s_waitcnt vmcnt(56)
v_perm_b32 v64, v41, v40, s46
v_accvgpr_write_b32 a28, v64
v_perm_b32 v68, v41, v40, s47
s_mov_b32 s20, 1638400
buffer_load_dword v40, v1, s[12:15], s20 offen
s_mov_b32 s21, 1671168
buffer_load_dword v41, v1, s[12:15], s21 offen
s_waitcnt vmcnt(56)
v_perm_b32 v65, v43, v42, s46
v_accvgpr_write_b32 a29, v65
v_perm_b32 v69, v43, v42, s47
s_mov_b32 s20, 1581056
buffer_load_dword v42, v1, s[12:15], s20 offen
s_mov_b32 s21, 1613824
buffer_load_dword v43, v1, s[12:15], s21 offen
s_waitcnt vmcnt(56)
v_perm_b32 v66, v45, v44, s46
v_accvgpr_write_b32 a30, v66
v_perm_b32 v70, v45, v44, s47
s_mov_b32 s20, 1646592
buffer_load_dword v44, v1, s[12:15], s20 offen
s_mov_b32 s21, 1679360
buffer_load_dword v45, v1, s[12:15], s21 offen
s_waitcnt vmcnt(56)
v_perm_b32 v67, v47, v46, s46
v_accvgpr_write_b32 a31, v67
v_perm_b32 v71, v47, v46, s47
ds_write_b128 v3, v[68:71] offset:17408
s_waitcnt lgkmcnt(0)
s_mov_b32 s20, 1835008
buffer_load_dword v46, v1, s[12:15], s20 offen
s_mov_b32 s21, 1867776
buffer_load_dword v47, v1, s[12:15], s21 offen
s_waitcnt vmcnt(56)
v_perm_b32 v64, v49, v48, s46
v_accvgpr_write_b32 a32, v64
v_perm_b32 v68, v49, v48, s47
v_accvgpr_write_b32 a40, v68
s_mov_b32 s20, 1900544
buffer_load_dword v48, v1, s[12:15], s20 offen
s_mov_b32 s21, 1933312
buffer_load_dword v49, v1, s[12:15], s21 offen
s_waitcnt vmcnt(56)
v_perm_b32 v65, v51, v50, s46
v_accvgpr_write_b32 a33, v65
v_perm_b32 v69, v51, v50, s47
v_accvgpr_write_b32 a41, v69
s_mov_b32 s20, 1843200
buffer_load_dword v50, v1, s[12:15], s20 offen
s_mov_b32 s21, 1875968
buffer_load_dword v51, v1, s[12:15], s21 offen
s_waitcnt vmcnt(56)
v_perm_b32 v66, v53, v52, s46
v_accvgpr_write_b32 a34, v66
v_perm_b32 v70, v53, v52, s47
v_accvgpr_write_b32 a42, v70
s_mov_b32 s20, 1908736
buffer_load_dword v52, v1, s[12:15], s20 offen
s_mov_b32 s21, 1941504
buffer_load_dword v53, v1, s[12:15], s21 offen
s_waitcnt vmcnt(56)
v_perm_b32 v67, v55, v54, s46
v_accvgpr_write_b32 a35, v67
v_perm_b32 v71, v55, v54, s47
v_accvgpr_write_b32 a43, v71
s_mov_b32 s20, 2097152
buffer_load_dword v54, v1, s[12:15], s20 offen
s_mov_b32 s21, 2129920
buffer_load_dword v55, v1, s[12:15], s21 offen
s_waitcnt vmcnt(56)
v_perm_b32 v64, v57, v56, s46
v_accvgpr_write_b32 a36, v64
v_perm_b32 v68, v57, v56, s47
v_accvgpr_write_b32 a44, v68
s_mov_b32 s20, 2162688
buffer_load_dword v56, v1, s[12:15], s20 offen
s_mov_b32 s21, 2195456
buffer_load_dword v57, v1, s[12:15], s21 offen
s_waitcnt vmcnt(56)
v_perm_b32 v65, v59, v58, s46
v_accvgpr_write_b32 a37, v65
v_perm_b32 v69, v59, v58, s47
v_accvgpr_write_b32 a45, v69
s_mov_b32 s20, 2105344
buffer_load_dword v58, v1, s[12:15], s20 offen
s_mov_b32 s21, 2138112
buffer_load_dword v59, v1, s[12:15], s21 offen
s_waitcnt vmcnt(56)
v_perm_b32 v66, v61, v60, s46
v_accvgpr_write_b32 a38, v66
v_perm_b32 v70, v61, v60, s47
v_accvgpr_write_b32 a46, v70
s_mov_b32 s20, 2170880
buffer_load_dword v60, v1, s[12:15], s20 offen
s_mov_b32 s21, 2203648
buffer_load_dword v61, v1, s[12:15], s21 offen
s_waitcnt vmcnt(56)
v_perm_b32 v67, v63, v62, s46
v_accvgpr_write_b32 a39, v67
v_perm_b32 v71, v63, v62, s47
v_accvgpr_write_b32 a47, v71
s_mov_b32 s20, 2359296
buffer_load_dword v62, v1, s[12:15], s20 offen
s_mov_b32 s21, 2392064
buffer_load_dword v63, v1, s[12:15], s21 offen
s_waitcnt vmcnt(56)
v_perm_b32 v64, v7, v6, s46
v_accvgpr_write_b32 a48, v64
v_perm_b32 v68, v7, v6, s47
v_accvgpr_write_b32 a56, v68
s_mov_b32 s20, 2424832
buffer_load_dword v6, v1, s[12:15], s20 offen
s_mov_b32 s21, 2457600
buffer_load_dword v7, v1, s[12:15], s21 offen
s_waitcnt vmcnt(56)
v_perm_b32 v65, v9, v8, s46
v_accvgpr_write_b32 a49, v65
v_perm_b32 v69, v9, v8, s47
v_accvgpr_write_b32 a57, v69
s_mov_b32 s20, 2367488
buffer_load_dword v8, v1, s[12:15], s20 offen
s_mov_b32 s21, 2400256
buffer_load_dword v9, v1, s[12:15], s21 offen
s_waitcnt vmcnt(56)
v_perm_b32 v66, v11, v10, s46
v_accvgpr_write_b32 a50, v66
v_perm_b32 v70, v11, v10, s47
v_accvgpr_write_b32 a58, v70
s_mov_b32 s20, 2433024
buffer_load_dword v10, v1, s[12:15], s20 offen
s_mov_b32 s21, 2465792
buffer_load_dword v11, v1, s[12:15], s21 offen
s_waitcnt vmcnt(56)
v_perm_b32 v67, v13, v12, s46
v_accvgpr_write_b32 a51, v67
v_perm_b32 v71, v13, v12, s47
v_accvgpr_write_b32 a59, v71
s_mov_b32 s20, 2621440
buffer_load_dword v12, v1, s[12:15], s20 offen
s_mov_b32 s21, 2654208
buffer_load_dword v13, v1, s[12:15], s21 offen
s_waitcnt vmcnt(56)
v_perm_b32 v64, v15, v14, s46
v_accvgpr_write_b32 a52, v64
v_perm_b32 v68, v15, v14, s47
v_accvgpr_write_b32 a60, v68
s_mov_b32 s20, 2686976
buffer_load_dword v14, v1, s[12:15], s20 offen
s_mov_b32 s21, 2719744
buffer_load_dword v15, v1, s[12:15], s21 offen
s_waitcnt vmcnt(56)
v_perm_b32 v65, v17, v16, s46
v_accvgpr_write_b32 a53, v65
v_perm_b32 v69, v17, v16, s47
v_accvgpr_write_b32 a61, v69
s_mov_b32 s20, 2629632
buffer_load_dword v16, v1, s[12:15], s20 offen
s_mov_b32 s21, 2662400
buffer_load_dword v17, v1, s[12:15], s21 offen
s_waitcnt vmcnt(56)
v_perm_b32 v66, v19, v18, s46
v_accvgpr_write_b32 a54, v66
v_perm_b32 v70, v19, v18, s47
v_accvgpr_write_b32 a62, v70
s_mov_b32 s20, 2695168
buffer_load_dword v18, v1, s[12:15], s20 offen
s_mov_b32 s21, 2727936
buffer_load_dword v19, v1, s[12:15], s21 offen
s_waitcnt vmcnt(56)
v_perm_b32 v67, v21, v20, s46
v_accvgpr_write_b32 a55, v67
v_perm_b32 v71, v21, v20, s47
v_accvgpr_write_b32 a63, v71
s_mov_b32 s20, 2883584
buffer_load_dword v20, v1, s[12:15], s20 offen
s_mov_b32 s21, 2916352
buffer_load_dword v21, v1, s[12:15], s21 offen
s_waitcnt vmcnt(56)
v_perm_b32 v64, v23, v22, s46
v_accvgpr_write_b32 a64, v64
v_perm_b32 v68, v23, v22, s47
v_accvgpr_write_b32 a72, v68
s_mov_b32 s20, 2949120
buffer_load_dword v22, v1, s[12:15], s20 offen
s_mov_b32 s21, 2981888
buffer_load_dword v23, v1, s[12:15], s21 offen
s_waitcnt vmcnt(56)
v_perm_b32 v65, v25, v24, s46
v_accvgpr_write_b32 a65, v65
v_perm_b32 v69, v25, v24, s47
v_accvgpr_write_b32 a73, v69
s_mov_b32 s20, 2891776
buffer_load_dword v24, v1, s[12:15], s20 offen
s_mov_b32 s21, 2924544
buffer_load_dword v25, v1, s[12:15], s21 offen
s_waitcnt vmcnt(56)
v_perm_b32 v66, v27, v26, s46
v_accvgpr_write_b32 a66, v66
v_perm_b32 v70, v27, v26, s47
v_accvgpr_write_b32 a74, v70
s_mov_b32 s20, 2957312
buffer_load_dword v26, v1, s[12:15], s20 offen
s_mov_b32 s21, 2990080
buffer_load_dword v27, v1, s[12:15], s21 offen
s_waitcnt vmcnt(56)
v_perm_b32 v67, v29, v28, s46
v_accvgpr_write_b32 a67, v67
v_perm_b32 v71, v29, v28, s47
v_accvgpr_write_b32 a75, v71
s_mov_b32 s20, 3145728
buffer_load_dword v28, v1, s[12:15], s20 offen
s_mov_b32 s21, 3178496
buffer_load_dword v29, v1, s[12:15], s21 offen
s_waitcnt vmcnt(56)
v_perm_b32 v64, v31, v30, s46
v_accvgpr_write_b32 a68, v64
v_perm_b32 v68, v31, v30, s47
v_accvgpr_write_b32 a76, v68
s_mov_b32 s20, 3211264
buffer_load_dword v30, v1, s[12:15], s20 offen
s_mov_b32 s21, 3244032
buffer_load_dword v31, v1, s[12:15], s21 offen
s_waitcnt vmcnt(56)
v_perm_b32 v65, v33, v32, s46
v_accvgpr_write_b32 a69, v65
v_perm_b32 v69, v33, v32, s47
v_accvgpr_write_b32 a77, v69
s_mov_b32 s20, 3153920
buffer_load_dword v32, v1, s[12:15], s20 offen
s_mov_b32 s21, 3186688
buffer_load_dword v33, v1, s[12:15], s21 offen
s_waitcnt vmcnt(56)
v_perm_b32 v66, v35, v34, s46
v_accvgpr_write_b32 a70, v66
v_perm_b32 v70, v35, v34, s47
v_accvgpr_write_b32 a78, v70
s_mov_b32 s20, 3219456
buffer_load_dword v34, v1, s[12:15], s20 offen
s_mov_b32 s21, 3252224
buffer_load_dword v35, v1, s[12:15], s21 offen
s_waitcnt vmcnt(56)
v_perm_b32 v67, v37, v36, s46
v_accvgpr_write_b32 a71, v67
v_perm_b32 v71, v37, v36, s47
v_accvgpr_write_b32 a79, v71
s_mov_b32 s20, 3407872
buffer_load_dword v36, v1, s[12:15], s20 offen
s_mov_b32 s21, 3440640
buffer_load_dword v37, v1, s[12:15], s21 offen
s_waitcnt vmcnt(56)
v_perm_b32 v64, v39, v38, s46
v_accvgpr_write_b32 a80, v64
v_perm_b32 v68, v39, v38, s47
v_accvgpr_write_b32 a88, v68
s_mov_b32 s20, 3473408
buffer_load_dword v38, v1, s[12:15], s20 offen
s_mov_b32 s21, 3506176
buffer_load_dword v39, v1, s[12:15], s21 offen
s_waitcnt vmcnt(56)
v_perm_b32 v65, v41, v40, s46
v_accvgpr_write_b32 a81, v65
v_perm_b32 v69, v41, v40, s47
v_accvgpr_write_b32 a89, v69
s_mov_b32 s20, 3416064
buffer_load_dword v40, v1, s[12:15], s20 offen
s_mov_b32 s21, 3448832
buffer_load_dword v41, v1, s[12:15], s21 offen
s_waitcnt vmcnt(56)
v_perm_b32 v66, v43, v42, s46
v_accvgpr_write_b32 a82, v66
v_perm_b32 v70, v43, v42, s47
v_accvgpr_write_b32 a90, v70
s_mov_b32 s20, 3481600
buffer_load_dword v42, v1, s[12:15], s20 offen
s_mov_b32 s21, 3514368
buffer_load_dword v43, v1, s[12:15], s21 offen
s_waitcnt vmcnt(56)
v_perm_b32 v67, v45, v44, s46
v_accvgpr_write_b32 a83, v67
v_perm_b32 v71, v45, v44, s47
v_accvgpr_write_b32 a91, v71
s_mov_b32 s20, 3670016
buffer_load_dword v44, v1, s[12:15], s20 offen
s_mov_b32 s21, 3702784
buffer_load_dword v45, v1, s[12:15], s21 offen
s_waitcnt vmcnt(56)
v_perm_b32 v64, v47, v46, s46
v_accvgpr_write_b32 a84, v64
v_perm_b32 v68, v47, v46, s47
v_accvgpr_write_b32 a92, v68
s_mov_b32 s20, 3735552
buffer_load_dword v46, v1, s[12:15], s20 offen
s_mov_b32 s21, 3768320
buffer_load_dword v47, v1, s[12:15], s21 offen
s_waitcnt vmcnt(56)
v_perm_b32 v65, v49, v48, s46
v_accvgpr_write_b32 a85, v65
v_perm_b32 v69, v49, v48, s47
v_accvgpr_write_b32 a93, v69
s_mov_b32 s20, 3678208
buffer_load_dword v48, v1, s[12:15], s20 offen
s_mov_b32 s21, 3710976
buffer_load_dword v49, v1, s[12:15], s21 offen
s_waitcnt vmcnt(56)
v_perm_b32 v66, v51, v50, s46
v_accvgpr_write_b32 a86, v66
v_perm_b32 v70, v51, v50, s47
v_accvgpr_write_b32 a94, v70
s_mov_b32 s20, 3743744
buffer_load_dword v50, v1, s[12:15], s20 offen
s_mov_b32 s21, 3776512
buffer_load_dword v51, v1, s[12:15], s21 offen
s_waitcnt vmcnt(56)
v_perm_b32 v67, v53, v52, s46
v_accvgpr_write_b32 a87, v67
v_perm_b32 v71, v53, v52, s47
v_accvgpr_write_b32 a95, v71
s_mov_b32 s20, 3932160
buffer_load_dword v52, v1, s[12:15], s20 offen
s_mov_b32 s21, 3964928
buffer_load_dword v53, v1, s[12:15], s21 offen
s_waitcnt vmcnt(56)
v_perm_b32 v64, v55, v54, s46
v_accvgpr_write_b32 a96, v64
v_perm_b32 v68, v55, v54, s47
v_accvgpr_write_b32 a104, v68
s_mov_b32 s20, 3997696
buffer_load_dword v54, v1, s[12:15], s20 offen
s_mov_b32 s21, 4030464
buffer_load_dword v55, v1, s[12:15], s21 offen
s_waitcnt vmcnt(56)
v_perm_b32 v65, v57, v56, s46
v_accvgpr_write_b32 a97, v65
v_perm_b32 v69, v57, v56, s47
v_accvgpr_write_b32 a105, v69
s_mov_b32 s20, 3940352
buffer_load_dword v56, v1, s[12:15], s20 offen
s_mov_b32 s21, 3973120
buffer_load_dword v57, v1, s[12:15], s21 offen
s_waitcnt vmcnt(56)
v_perm_b32 v66, v59, v58, s46
v_accvgpr_write_b32 a98, v66
v_perm_b32 v70, v59, v58, s47
v_accvgpr_write_b32 a106, v70
s_mov_b32 s20, 4005888
buffer_load_dword v58, v1, s[12:15], s20 offen
s_mov_b32 s21, 4038656
buffer_load_dword v59, v1, s[12:15], s21 offen
s_waitcnt vmcnt(56)
v_perm_b32 v67, v61, v60, s46
v_accvgpr_write_b32 a99, v67
v_perm_b32 v71, v61, v60, s47
v_accvgpr_write_b32 a107, v71
s_mov_b32 s20, 4194304
buffer_load_dword v60, v1, s[12:15], s20 offen
s_mov_b32 s21, 4227072
buffer_load_dword v61, v1, s[12:15], s21 offen
s_waitcnt vmcnt(56)
v_perm_b32 v64, v63, v62, s46
v_accvgpr_write_b32 a100, v64
v_perm_b32 v68, v63, v62, s47
v_accvgpr_write_b32 a108, v68
s_mov_b32 s20, 4259840
buffer_load_dword v62, v1, s[12:15], s20 offen
s_mov_b32 s21, 4292608
buffer_load_dword v63, v1, s[12:15], s21 offen
s_waitcnt vmcnt(56)
v_perm_b32 v65, v7, v6, s46
v_accvgpr_write_b32 a101, v65
v_perm_b32 v69, v7, v6, s47
v_accvgpr_write_b32 a109, v69
s_mov_b32 s20, 4202496
buffer_load_dword v6, v1, s[12:15], s20 offen
s_mov_b32 s21, 4235264
buffer_load_dword v7, v1, s[12:15], s21 offen
s_waitcnt vmcnt(56)
v_perm_b32 v66, v9, v8, s46
v_accvgpr_write_b32 a102, v66
v_perm_b32 v70, v9, v8, s47
v_accvgpr_write_b32 a110, v70
s_mov_b32 s20, 4268032
buffer_load_dword v8, v1, s[12:15], s20 offen
s_mov_b32 s21, 4300800
buffer_load_dword v9, v1, s[12:15], s21 offen
s_waitcnt vmcnt(56)
v_perm_b32 v67, v11, v10, s46
v_accvgpr_write_b32 a103, v67
v_perm_b32 v71, v11, v10, s47
v_accvgpr_write_b32 a111, v71
s_mov_b32 s20, 4456448
buffer_load_dword v10, v1, s[12:15], s20 offen
s_mov_b32 s21, 4489216
buffer_load_dword v11, v1, s[12:15], s21 offen
s_waitcnt vmcnt(56)
v_perm_b32 v64, v13, v12, s46
v_accvgpr_write_b32 a112, v64
v_perm_b32 v68, v13, v12, s47
v_accvgpr_write_b32 a120, v68
s_mov_b32 s20, 4521984
buffer_load_dword v12, v1, s[12:15], s20 offen
s_mov_b32 s21, 4554752
buffer_load_dword v13, v1, s[12:15], s21 offen
s_waitcnt vmcnt(56)
v_perm_b32 v65, v15, v14, s46
v_accvgpr_write_b32 a113, v65
v_perm_b32 v69, v15, v14, s47
v_accvgpr_write_b32 a121, v69
s_mov_b32 s20, 4464640
buffer_load_dword v14, v1, s[12:15], s20 offen
s_mov_b32 s21, 4497408
buffer_load_dword v15, v1, s[12:15], s21 offen
s_waitcnt vmcnt(56)
v_perm_b32 v66, v17, v16, s46
v_accvgpr_write_b32 a114, v66
v_perm_b32 v70, v17, v16, s47
v_accvgpr_write_b32 a122, v70
s_mov_b32 s20, 4530176
buffer_load_dword v16, v1, s[12:15], s20 offen
s_mov_b32 s21, 4562944
buffer_load_dword v17, v1, s[12:15], s21 offen
s_waitcnt vmcnt(56)
v_perm_b32 v67, v19, v18, s46
v_accvgpr_write_b32 a115, v67
v_perm_b32 v71, v19, v18, s47
v_accvgpr_write_b32 a123, v71
s_waitcnt vmcnt(54)
v_perm_b32 v64, v21, v20, s46
v_accvgpr_write_b32 a116, v64
v_perm_b32 v68, v21, v20, s47
v_accvgpr_write_b32 a124, v68
s_waitcnt vmcnt(52)
v_perm_b32 v65, v23, v22, s46
v_accvgpr_write_b32 a117, v65
v_perm_b32 v69, v23, v22, s47
v_accvgpr_write_b32 a125, v69
s_waitcnt vmcnt(50)
v_perm_b32 v66, v25, v24, s46
v_accvgpr_write_b32 a118, v66
v_perm_b32 v70, v25, v24, s47
v_accvgpr_write_b32 a126, v70
s_waitcnt vmcnt(48)
v_perm_b32 v67, v27, v26, s46
v_accvgpr_write_b32 a119, v67
v_perm_b32 v71, v27, v26, s47
v_accvgpr_write_b32 a127, v71
s_waitcnt vmcnt(46)
v_perm_b32 v64, v29, v28, s46
v_accvgpr_write_b32 a128, v64
v_perm_b32 v68, v29, v28, s47
v_accvgpr_write_b32 a136, v68
s_waitcnt vmcnt(44)
v_perm_b32 v65, v31, v30, s46
v_accvgpr_write_b32 a129, v65
v_perm_b32 v69, v31, v30, s47
v_accvgpr_write_b32 a137, v69
s_waitcnt vmcnt(42)
v_perm_b32 v66, v33, v32, s46
v_accvgpr_write_b32 a130, v66
v_perm_b32 v70, v33, v32, s47
v_accvgpr_write_b32 a138, v70
s_waitcnt vmcnt(40)
v_perm_b32 v67, v35, v34, s46
v_accvgpr_write_b32 a131, v67
v_perm_b32 v71, v35, v34, s47
v_accvgpr_write_b32 a139, v71
s_waitcnt vmcnt(38)
v_perm_b32 v64, v37, v36, s46
v_accvgpr_write_b32 a132, v64
v_perm_b32 v68, v37, v36, s47
v_accvgpr_write_b32 a140, v68
s_waitcnt vmcnt(36)
v_perm_b32 v65, v39, v38, s46
v_accvgpr_write_b32 a133, v65
v_perm_b32 v69, v39, v38, s47
v_accvgpr_write_b32 a141, v69
s_waitcnt vmcnt(34)
v_perm_b32 v66, v41, v40, s46
v_accvgpr_write_b32 a134, v66
v_perm_b32 v70, v41, v40, s47
v_accvgpr_write_b32 a142, v70
s_waitcnt vmcnt(32)
v_perm_b32 v67, v43, v42, s46
v_accvgpr_write_b32 a135, v67
v_perm_b32 v71, v43, v42, s47
v_accvgpr_write_b32 a143, v71
s_waitcnt vmcnt(30)
v_perm_b32 v64, v45, v44, s46
v_accvgpr_write_b32 a144, v64
v_perm_b32 v68, v45, v44, s47
v_accvgpr_write_b32 a152, v68
s_waitcnt vmcnt(28)
v_perm_b32 v65, v47, v46, s46
v_accvgpr_write_b32 a145, v65
v_perm_b32 v69, v47, v46, s47
v_accvgpr_write_b32 a153, v69
s_waitcnt vmcnt(26)
v_perm_b32 v66, v49, v48, s46
v_accvgpr_write_b32 a146, v66
v_perm_b32 v70, v49, v48, s47
v_accvgpr_write_b32 a154, v70
s_waitcnt vmcnt(24)
v_perm_b32 v67, v51, v50, s46
v_accvgpr_write_b32 a147, v67
v_perm_b32 v71, v51, v50, s47
v_accvgpr_write_b32 a155, v71
s_waitcnt vmcnt(22)
v_perm_b32 v64, v53, v52, s46
v_accvgpr_write_b32 a148, v64
v_perm_b32 v68, v53, v52, s47
v_accvgpr_write_b32 a156, v68
s_waitcnt vmcnt(20)
v_perm_b32 v65, v55, v54, s46
v_accvgpr_write_b32 a149, v65
v_perm_b32 v69, v55, v54, s47
v_accvgpr_write_b32 a157, v69
s_waitcnt vmcnt(18)
v_perm_b32 v66, v57, v56, s46
v_accvgpr_write_b32 a150, v66
v_perm_b32 v70, v57, v56, s47
v_accvgpr_write_b32 a158, v70
s_waitcnt vmcnt(16)
v_perm_b32 v67, v59, v58, s46
v_accvgpr_write_b32 a151, v67
v_perm_b32 v71, v59, v58, s47
v_accvgpr_write_b32 a159, v71
s_waitcnt vmcnt(14)
v_perm_b32 v64, v61, v60, s46
v_accvgpr_write_b32 a160, v64
v_perm_b32 v68, v61, v60, s47
v_accvgpr_write_b32 a168, v68
s_waitcnt vmcnt(12)
v_perm_b32 v65, v63, v62, s46
v_accvgpr_write_b32 a161, v65
v_perm_b32 v69, v63, v62, s47
v_accvgpr_write_b32 a169, v69
s_waitcnt vmcnt(10)
v_perm_b32 v66, v7, v6, s46
v_accvgpr_write_b32 a162, v66
v_perm_b32 v70, v7, v6, s47
v_accvgpr_write_b32 a170, v70
s_waitcnt vmcnt(8)
v_perm_b32 v67, v9, v8, s46
v_accvgpr_write_b32 a163, v67
v_perm_b32 v71, v9, v8, s47
v_accvgpr_write_b32 a171, v71
s_waitcnt vmcnt(6)
v_perm_b32 v64, v11, v10, s46
v_accvgpr_write_b32 a164, v64
v_perm_b32 v68, v11, v10, s47
v_accvgpr_write_b32 a172, v68
s_waitcnt vmcnt(4)
v_perm_b32 v65, v13, v12, s46
v_accvgpr_write_b32 a165, v65
v_perm_b32 v69, v13, v12, s47
v_accvgpr_write_b32 a173, v69
s_waitcnt vmcnt(2)
v_perm_b32 v66, v15, v14, s46
v_accvgpr_write_b32 a166, v66
v_perm_b32 v70, v15, v14, s47
v_accvgpr_write_b32 a174, v70
s_waitcnt vmcnt(0)
v_perm_b32 v67, v17, v16, s46
v_accvgpr_write_b32 a167, v67
v_perm_b32 v71, v17, v16, s47
v_accvgpr_write_b32 a175, v71
v_mov_b32 v12, v0
v_and_b32 v13, 15, v0
v_bfe_u32 v14, v0, 4, 2
v_lshlrev_b32 v1, 4, v12
v_and_b32 v2, 0x3f0, v1
s_mul_i32 s20, s17, 34816
s_add_u32 s20, s20, 24576
v_add_u32 v2, s20, v2
v_and_b32 v15, 1, v12
v_mul_u32_u24 v0, 0xaaaa, v15
v_add_u32 v0, 0xffff4444, v0
v_lshrrev_b32 v18, 2, v13
v_lshl_add_u32 v18, v18, 1, v15
v_bfe_u32 v19, v13, 1, 1
v_lshrrev_b32 v16, 5, v12
v_lshlrev_b32 v16, 8, v16
v_lshl_add_u32 v16, v18, 5, v16
v_and_b32 v17, 1, v14
v_lshl_add_u32 v16, v17, 4, v16
v_and_b32 v17, 0x7f, v16
v_xor_b32 v17, 16, v17
v_add_u32 v16, 4224, v16
v_add_u32 v17, 6272, v17
v_cmp_eq_u32 vcc, 1, v19
s_nop 1
v_cndmask_b32 v7, v17, v16, vcc
v_and_b32 v16, 1, v14
v_xor_b32 v16, v18, v16
v_and_b32 v17, 2, v14
v_lshlrev_b32 v17, 1, v17
v_xor_b32 v16, v16, v17
v_lshlrev_b32 v16, 4, v16
v_lshl_add_u32 v16, v14, 7, v16
v_mul_u32_u24 v17, 2176, v19
v_add_u32 v16, v16, v17
v_add_u32 v5, 0, v16
v_bfe_u32 v20, v13, 3, 1
v_bfe_u32 v21, v13, 1, 1
v_lshlrev_b32 v16, 1, v14
v_xor_b32 v16, v16, v21
v_lshlrev_b32 v17, 2, v20
v_xor_b32 v16, v16, v17
v_lshlrev_b32 v16, 4, v16
v_lshl_add_u32 v16, v20, 8, v16
v_lshl_add_u32 v16, v21, 7, v16
v_bfe_u32 v17, v13, 2, 1
v_lshl_add_u32 v16, v17, 3, v16
v_lshl_add_u32 v16, v15, 2, v16
s_lshl_b32 s20, s17, 9
s_add_u32 s20, s20, 0
v_add_u32 v4, s20, v16
v_xor_b32 v3, 16, v4
v_lshrrev_b32 v16, 4, v12
v_xor_b32 v17, s16, v16
v_lshlrev_b32 v16, 12, v16
v_lshl_add_u32 v16, v17, 7, v16
v_lshl_add_u32 v9, v13, 3, v16
s_lshr_b32 s20, s17, 1
s_lshl_b32 s20, s20, 2
v_add_u32 v16, s20, v14
v_xor_b32 v17, s16, v16
v_lshlrev_b32 v16, 12, v16
v_lshl_add_u32 v16, v17, 7, v16
v_lshl_add_u32 v16, v13, 2, v16
s_and_b32 s20, s17, 1
s_lshl_b32 s20, s20, 6
s_add_u32 s20, s20, 262144
v_add_u32 v10, s20, v16
v_bfe_u32 v16, v13, 2, 1
v_lshlrev_b32 v16, 5, v16
v_and_b32 v17, 1, v14
v_lshl_add_u32 v16, v17, 8, v16
v_lshrrev_b32 v17, 1, v14
v_lshl_add_u32 v16, v17, 4, v16
v_and_b32 v17, 3, v13
v_lshl_add_u32 v11, v17, 2, v16
v_lshlrev_b32 v6, 7, v12
v_lshlrev_b32 v8, 2, v12
s_mov_b32 s36, 0x11111111
s_mov_b32 s37, 0x11111111
s_mov_b32 s38, 0x22222222
s_mov_b32 s39, 0x22222222
s_mov_b32 s40, 0x44444444
s_mov_b32 s41, 0x44444444
s_mov_b32 s42, 0x88888888
s_mov_b32 s43, 0x88888888
s_mov_b32 s44, 0xf0f0f0f0
s_mov_b32 s45, 0xf0f0f0f0
s_mov_b32 s18, 0x3e0293ee
s_lshl_b32 s20, s17, 5
s_add_u32 s20, s20, s16
s_cmp_lt_u32 s20, 72
s_cselect_b32 s48, 1, 0
s_lshl_b32 s23, s20, 12
s_lshl_b32 s21, s17, 10
s_sub_u32 s23, s23, s21
s_lshr_b32 s24, s20, 2
s_lshl_b32 s24, s24, 9
s_and_b32 s21, s20, 3
s_lshl_b32 s21, s21, 6
s_add_u32 s24, s24, s21
s_add_u32 s24, s24, 110100480
s_cmp_lt_u32 s20, 72
s_cselect_b32 s24, s24, 536870912
s_lshl_b32 s25, s16, 12
s_add_u32 s26, s25, 131072
s_add_u32 s27, s25, 262144
s_cmp_lt_u32 s16, 8
s_cselect_b32 s27, s27, 536870912
s_mov_b32 s28, 109051904
s_mov_b32 s29, 109346816
s_lshl_b32 s30, s16, 20
s_add_u32 s30, s30, 33554432
s_lshl_b32 s31, s16, 12
s_add_u32 s31, s31, 100663296
s_add_u32 s35, s24, 32768
s_mov_b32 s53, 0x3f803f80
s_mov_b32 s86, 0x33333333
s_mov_b32 s87, 0x33333333
s_lshl_b32 s84, s17, 13
s_sub_u32 s84, s20, s84
s_add_u32 s84, s84, 110886912
s_cmp_lt_u32 s20, 72
s_cselect_b32 s84, s84, 536870912
s_and_b32 s21, s16, 3
s_lshl_b32 s21, s21, 7
s_add_u32 s21, s21, 110886144
s_cmp_eq_u32 s17, 3
s_cselect_b32 s84, s21, s84
s_lshl_b32 s82, s16, 7
s_add_u32 s83, s82, 111152384
s_add_u32 s82, s82, 111148288
s_mov_b32 s19, 0
s_getpc_b64 s[4:5]
L_pc2:
s_mov_b32 s12, s4
s_and_b32 s13, s5, 0xffff
s_mov_b32 s14, L_end-L_pc2
s_mov_b32 s15, 0x20000
buffer_load_dword v40, v6, s[12:15], 0 offen
s_mul_i32 s20, s16, 18432
s_add_u32 s20, s20, 109051904
s_lshl_b32 s21, s16, 11
s_add_u32 s21, s21, 110075904
s_cmp_eq_u32 s17, 3
s_cselect_b32 s20, s21, s20
buffer_load_dword v41, v6, s[8:11], s20 offen sc1
s_load_dwordx2 s[50:51], s[0:1], 56
s_waitcnt lgkmcnt(0)
s_mov_b32 s12, s50
s_and_b32 s13, s51, 0xffff
s_mov_b32 s14, 9216
s_mov_b32 s15, 0x20000
v_bfe_u32 v64, v1, 5, 3
v_mul_u32_u24 v64, 1152, v64
v_lshrrev_b32 v65, 8, v1
v_lshl_add_u32 v64, v65, 5, v64
v_and_b32 v65, 16, v1
v_add_u32 v64, v64, v65
buffer_load_dwordx4 v[24:27], v64, s[12:15], 0 offen offset:0
buffer_load_dwordx4 v[28:31], v64, s[12:15], 0 offen offset:512
buffer_load_dwordx4 v[32:35], v64, s[12:15], 0 offen offset:1024
s_waitcnt vmcnt(0)
v_perm_b32 v12, v26, v24, s46
v_perm_b32 v13, v26, v24, s47
v_perm_b32 v14, v27, v25, s46
v_perm_b32 v15, v27, v25, s47
v_min_u32 v12, 0xfffeffff, v12
v_min_u32 v13, 0xfffeffff, v13
v_min_u32 v14, 0xfffeffff, v14
v_min_u32 v15, 0xfffeffff, v15
v_perm_b32 v16, v30, v28, s46
v_perm_b32 v17, v30, v28, s47
v_perm_b32 v18, v31, v29, s46
v_perm_b32 v19, v31, v29, s47
v_min_u32 v16, 0xfffeffff, v16
v_min_u32 v17, 0xfffeffff, v17
v_min_u32 v18, 0xfffeffff, v18
v_min_u32 v19, 0xfffeffff, v19
v_perm_b32 v20, v34, v32, s46
v_perm_b32 v21, v34, v32, s47
v_perm_b32 v22, v35, v33, s46
v_perm_b32 v23, v35, v33, s47
v_min_u32 v20, 0xfffeffff, v20
v_min_u32 v21, 0xfffeffff, v21
v_min_u32 v22, 0xfffeffff, v22
v_min_u32 v23, 0xfffeffff, v23
s_cmp_lg_u32 s17, 0
s_cbranch_scc1 L_m0_36
ds_write_b128 v1, v[20:23] offset:14848
v_mov_b32 v64, 6528
v_mov_b32 v56, 0
v_mov_b32 v57, 0
v_mov_b32 v58, 0
v_mov_b32 v59, 0
ds_write_b128 v64, v[56:59]
L_m0_36:
s_waitcnt lgkmcnt(0)
s_barrier
ds_read_b32 v20, v8 offset:14848
s_waitcnt lgkmcnt(0)
s_mov_b32 s33, 110100480
s_mov_b32 s6, 110100480
s_mov_b32 s7, 110100480
v_and_b32 v66, 16, v1
v_lshlrev_b32 v64, 2, v66
v_add_u32 v64, 64, v64
v_mul_u32_u24 v66, 3, v66
v_lshrrev_b32 v66, 1, v66
v_sub_u32 v66, 32, v66
s_mov_b32 s22, 0
L_poll_37:
buffer_load_dword v65, v64, s[56:59], 0 offen sc1
s_add_u32 s22, s22, 1
s_cmp_gt_u32 s22, 40000
s_cbranch_scc1 L_end
s_waitcnt vmcnt(0)
v_cmp_ne_u32 vcc, v66, v65
s_cbranch_vccz L_pd_38
s_sleep 1
s_branch L_poll_37
L_pd_38:
v_mov_b32 v64, 0
s_lshl_b32 s21, s16, 7
s_add_u32 s21, s21, 111149056
s_mov_b32 s22, 0
L_poll_39:
buffer_load_dword v65, v64, s[8:11], s21 offen sc1
s_add_u32 s22, s22, 1
s_cmp_gt_u32 s22, 40000
s_cbranch_scc1 L_end
s_waitcnt vmcnt(0)
v_cmp_ne_u32 vcc, 1, v65
s_cbranch_vccz L_pd_40
s_sleep 1
s_branch L_poll_39
L_pd_40:
s_mov_b32 s22, 0
s_cmp_eq_u32 s17, 0
s_cbranch_scc1 L_ent0
s_cmp_eq_u32 s17, 1
s_cbranch_scc1 L_ent1
s_cmp_eq_u32 s17, 2
s_cbranch_scc1 L_ent2
s_cmp_eq_u32 s17, 3
s_cbranch_scc1 L_ent3
s_branch L_end
L_ent0:
v_mov_b64 v[24:25], 0
v_mov_b64 v[26:27], 0
v_mov_b64 v[28:29], 0
v_mov_b64 v[30:31], 0
v_and_b32 v69, 0x380, v1
v_add_u32 v69, v69, v1
v_and_b32 v70, 0xf00, v1
v_add_u32 v70, v70, v1
v_mov_b64 v[64:65], -1
v_mov_b64 v[66:67], -1
v_xor_b32 v3, 16, v4
ds_read_b128 v[48:51], v2 offset:8192
ds_read_b128 v[52:55], v2 offset:9216
ds_read_b128 v[40:43], v2 offset:0
ds_read_b128 v[44:47], v2 offset:1024
v_mov_b64 v[32:33], 0
v_mov_b64 v[34:35], 0
v_mov_b64 v[36:37], 0
v_mov_b64 v[38:39], 0
v_mov_b64 v[56:57], 0
v_mov_b64 v[58:59], 0
v_mov_b64 v[60:61], 0
v_mov_b64 v[62:63], 0
s_add_u32 s20, s30, 0
s_add_u32 s21, s30, 8192
s_add_u32 s49, s29, s25
s_add_u32 s50, s29, s26
s_add_u32 s51, s29, s27
s_add_u32 s52, s30, 16384
s_mov_b32 m0, 15872
s_nop 0
buffer_load_dwordx4 v69, s[8:11], s20 offen sc1 lds
s_mov_b32 m0, 16768
s_nop 0
buffer_load_dwordx4 v69, s[8:11], s20 offen offset:128 sc1 lds
s_waitcnt vmcnt(0) lgkmcnt(0)
s_branch L_step0
L_gr0:
buffer_load_dwordx4 v[12:15], v1, s[8:11], s33 offen sc1
buffer_load_dword v20, v8, s[8:11], s7 offen sc1
buffer_load_dwordx4 v[16:19], v1, s[8:11], s6 offen sc1
s_add_u32 s22, s22, 1
s_cmp_gt_u32 s22, 40000
s_cbranch_scc1 L_end
buffer_load_dwordx4 v[16:19], v1, s[8:11], s6 offen sc1
v_mov_b64 v[24:25], 0
v_mov_b64 v[26:27], 0
v_mov_b64 v[28:29], 0
v_mov_b64 v[30:31], 0
v_mov_b64 v[32:33], 0
v_mov_b64 v[34:35], 0
v_mov_b64 v[36:37], 0
v_mov_b64 v[38:39], 0
v_mov_b64 v[56:57], 0
v_mov_b64 v[58:59], 0
v_mov_b64 v[60:61], 0
v_mov_b64 v[62:63], 0
s_waitcnt lgkmcnt(0)
s_branch L_step0
.p2align 3
L_gat0:
buffer_load_dwordx4 v[12:15], v1, s[8:11], s33 offen sc1
buffer_load_dword v20, v8, s[8:11], s7 offen sc1
buffer_load_dwordx4 v[16:19], v1, s[8:11], s6 offen sc1
s_add_u32 s20, s30, 0
s_add_u32 s21, s30, 8192
s_add_u32 s49, s29, s25
s_add_u32 s50, s29, s26
s_add_u32 s51, s29, s27
s_add_u32 s52, s30, 16384
s_mov_b32 m0, 15872
s_waitcnt vmcnt(4)
ds_read_b128 v[40:43], v2 offset:0
ds_read_b128 v[44:47], v2 offset:1024
v_mov_b64 v[32:33], 0
v_mov_b64 v[34:35], 0
v_mov_b64 v[36:37], 0
v_mov_b64 v[38:39], 0
v_mov_b64 v[56:57], 0
v_mov_b64 v[58:59], 0
v_mov_b64 v[60:61], 0
v_mov_b64 v[62:63], 0
s_nop 6
buffer_load_dwordx4 v[16:19], v1, s[8:11], s6 offen sc1
s_waitcnt lgkmcnt(0)
L_step0:
s_waitcnt vmcnt(3)
v_smfmac_f32_16x16x64_bf16 v[24:27], v[12:15], v[72:79], v0
ds_write_b128 v1, v[12:15] offset:6656
v_smfmac_f32_16x16x64_bf16 v[28:31], v[12:15], v[80:87], v0
s_waitcnt vmcnt(2)
v_max3_u32 v21, v12, v13, v14
v_max3_u32 v21, v21, v15, v20
v_cmp_le_u32 vcc, 0xffff0000, v21
v_smfmac_f32_16x16x64_bf16 v[32:35], v[12:15], v[88:95], v0
s_cbranch_vccnz L_gr0
s_waitcnt vmcnt(1)
v_max3_u32 v21, v16, v17, v18
v_max_u32 v21, v21, v19
v_cmp_le_u32 vcc, 0xffff0000, v21
ds_write_b32 v8, v20 offset:14848
v_smfmac_f32_16x16x64_bf16 v[56:59], v[12:15], a[32:39], v0
s_cbranch_vccnz L_g3r0
L_g30:
ds_write_b128 v1, v[16:19] offset:10752
v_smfmac_f32_16x16x64_bf16 v[60:63], v[12:15], a[40:47], v0
v_smfmac_f32_16x16x64_bf16 v[36:39], v[12:15], v[40:47], v0
v_smfmac_f32_16x16x64_bf16 v[24:27], v[16:19], v[168:175], v0
v_smfmac_f32_16x16x64_bf16 v[28:31], v[16:19], v[176:183], v0
s_waitcnt lgkmcnt(0)
s_barrier
ds_read_b128 v[20:23], v1 offset:7680
v_smfmac_f32_16x16x64_bf16 v[32:35], v[16:19], v[184:191], v0
ds_read_b128 v[12:15], v1 offset:8704
s_mov_b32 m0, 6272
buffer_store_dword v0, v11, s[8:11], s35 offen
v_smfmac_f32_16x16x64_bf16 v[56:59], v[16:19], a[96:103], v0
ds_read_b128 v[40:43], v2 offset:2048
buffer_store_dwordx4 v[64:67], v1, s[8:11], s49 offen
v_smfmac_f32_16x16x64_bf16 v[60:63], v[16:19], a[104:111], v0
ds_read_b128 v[44:47], v2 offset:3072
v_smfmac_f32_16x16x64_bf16 v[36:39], v[16:19], v[48:55], v0
s_waitcnt vmcnt(2)
ds_read_b128 v[16:19], v1 offset:9728
buffer_store_dwordx4 v[64:67], v1, s[8:11], s50 offen
s_waitcnt lgkmcnt(4)
v_smfmac_f32_16x16x64_bf16 v[24:27], v[20:23], v[96:103], v0
ds_read_b128 v[48:51], v2 offset:4096
v_smfmac_f32_16x16x64_bf16 v[28:31], v[20:23], v[104:111], v0
ds_read_b128 v[52:55], v2 offset:5120
buffer_store_dwordx4 v[64:67], v1, s[8:11], s51 offen
v_smfmac_f32_16x16x64_bf16 v[32:35], v[20:23], v[112:119], v0
s_waitcnt lgkmcnt(3)
v_smfmac_f32_16x16x64_bf16 v[36:39], v[20:23], v[40:47], v0
ds_read_b128 v[20:23], v1 offset:11776
buffer_load_dwordx4 v[64:67], v70, s[8:11], s21 offen sc1
v_smfmac_f32_16x16x64_bf16 v[24:27], v[12:15], v[120:127], v0
ds_read_b128 v[40:43], v2 offset:6144
v_smfmac_f32_16x16x64_bf16 v[28:31], v[12:15], v[128:135], v0
ds_read_b128 v[44:47], v2 offset:7168
buffer_load_dwordx4 v[68:71], v70, s[8:11], s21 offen offset:256 sc1
v_smfmac_f32_16x16x64_bf16 v[32:35], v[12:15], v[136:143], v0
s_waitcnt lgkmcnt(3)
v_smfmac_f32_16x16x64_bf16 v[36:39], v[12:15], v[48:55], v0
ds_read_b128 v[12:15], v1 offset:12800
v_smfmac_f32_16x16x64_bf16 v[24:27], v[16:19], v[144:151], v0
ds_read_b128 v[48:51], v2 offset:10240
v_smfmac_f32_16x16x64_bf16 v[28:31], v[16:19], v[152:159], v0
ds_read_b128 v[52:55], v2 offset:11264
v_smfmac_f32_16x16x64_bf16 v[32:35], v[16:19], v[160:167], v0
s_waitcnt lgkmcnt(3)
buffer_load_dword v6, s[8:11], s52 offen sc1 lds
v_smfmac_f32_16x16x64_bf16 v[36:39], v[16:19], v[40:47], v0
ds_read_b128 v[16:19], v1 offset:13824
v_smfmac_f32_16x16x64_bf16 v[24:27], v[20:23], v[192:199], v0
ds_read_b128 v[40:43], v2 offset:12288
v_smfmac_f32_16x16x64_bf16 v[28:31], v[20:23], v[200:207], v0
ds_read_b128 v[44:47], v2 offset:13312
v_smfmac_f32_16x16x64_bf16 v[32:35], v[20:23], v[208:215], v0
s_waitcnt lgkmcnt(3)
v_smfmac_f32_16x16x64_bf16 v[36:39], v[20:23], v[48:55], v0
ds_read_b128 v[20:23], v1 offset:14848
v_smfmac_f32_16x16x64_bf16 v[24:27], v[12:15], v[216:223], v0
ds_read_b128 v[48:51], v2 offset:14336
v_smfmac_f32_16x16x64_bf16 v[28:31], v[12:15], v[224:231], v0
ds_read_b128 v[52:55], v2 offset:15360
v_smfmac_f32_16x16x64_bf16 v[32:35], v[12:15], v[232:239], v0
s_waitcnt lgkmcnt(3)
v_smfmac_f32_16x16x64_bf16 v[36:39], v[12:15], v[40:47], v0
ds_read_b128 v[12:15], v1 offset:7680
v_smfmac_f32_16x16x64_bf16 v[24:27], v[16:19], v[240:247], v0
ds_read_b128 v[40:43], v2 offset:16384
v_smfmac_f32_16x16x64_bf16 v[28:31], v[16:19], v[248:255], v0
s_waitcnt lgkmcnt(4)
ds_read_b128 v[44:47], v2 offset:17408
v_smfmac_f32_16x16x64_bf16 v[24:27], v[20:23], a[8:15], v0
v_smfmac_f32_16x16x64_bf16 v[28:31], v[20:23], a[16:23], v0
v_smfmac_f32_16x16x64_bf16 v[32:35], v[16:19], a[0:7], v0
s_waitcnt lgkmcnt(3)
v_smfmac_f32_16x16x64_bf16 v[36:39], v[16:19], v[48:55], v0
ds_read_b128 v[16:19], v1 offset:8704
s_nop 2
v_add_f32 v24, v24, v25
v_smfmac_f32_16x16x64_bf16 v[32:35], v[20:23], a[24:31], v0
s_waitcnt lgkmcnt(1)
ds_read_b128 v[48:51], v1 offset:19968
v_add_f32 v26, v26, v27
v_smfmac_f32_16x16x64_bf16 v[36:39], v[20:23], v[40:47], v0
ds_read_b128 v[52:55], v1 offset:22016
v_add_f32 v28, v28, v29
v_smfmac_f32_16x16x64_bf16 v[56:59], v[12:15], a[48:55], v0
ds_read_b128 v[20:23], v1 offset:9728
v_add_f32 v30, v30, v31
v_cvt_pk_bf16_f32 v24, v24, v28
ds_write_b32 v4, v24 offset:2176
v_smfmac_f32_16x16x64_bf16 v[60:63], v[12:15], a[56:63], v0
s_waitcnt lgkmcnt(4)
ds_read_b128 v[12:15], v1 offset:11776
v_cvt_pk_bf16_f32 v26, v26, v30
ds_write_b32 v3, v26 offset:2176
v_add_f32 v32, v32, v33
v_smfmac_f32_16x16x64_bf16 v[56:59], v[16:19], a[64:71], v0
ds_read_b128 v[40:43], v1 offset:15872
v_add_f32 v34, v34, v35
v_add_f32 v36, v36, v37
v_add_f32 v38, v38, v39
v_smfmac_f32_16x16x64_bf16 v[60:63], v[16:19], a[72:79], v0
s_waitcnt lgkmcnt(4)
ds_read_b128 v[16:19], v1 offset:12800
v_cvt_pk_bf16_f32 v32, v32, v36
ds_write_b32 v4, v32 offset:0
v_cvt_pk_bf16_f32 v34, v34, v38
v_smfmac_f32_16x16x64_bf16 v[56:59], v[20:23], a[80:87], v0
ds_read_b128 v[44:47], v1 offset:17920
ds_write_b32 v3, v34 offset:0
v_smfmac_f32_16x16x64_bf16 v[60:63], v[20:23], a[88:95], v0
s_waitcnt lgkmcnt(6)
ds_read_b128 v[20:23], v1 offset:13824
v_smfmac_f32_16x16x64_bf16 v[56:59], v[12:15], a[112:119], v0
v_smfmac_f32_16x16x64_bf16 v[60:63], v[12:15], a[120:127], v0
s_waitcnt lgkmcnt(4)
ds_read_b128 v[12:15], v1 offset:14848
v_smfmac_f32_16x16x64_bf16 v[56:59], v[16:19], a[128:135], v0
v_smfmac_f32_16x16x64_bf16 v[60:63], v[16:19], a[136:143], v0
s_waitcnt lgkmcnt(1)
v_smfmac_f32_16x16x64_bf16 v[56:59], v[20:23], a[144:151], v0
s_barrier
ds_read_b128 v[24:27], v5 offset:0
v_smfmac_f32_16x16x64_bf16 v[60:63], v[20:23], a[152:159], v0
s_waitcnt lgkmcnt(1)
ds_read_b128 v[28:31], v5 offset:512
v_smfmac_f32_16x16x64_bf16 v[56:59], v[12:15], a[160:167], v0
ds_read_b128 v[32:35], v5 offset:1024
v_smfmac_f32_16x16x64_bf16 v[60:63], v[12:15], a[168:175], v0
s_waitcnt lgkmcnt(2)
ds_read_b128 v[36:39], v5 offset:1536
v_mfma_f32_16x16x32_bf16 v[16:19], v[40:43], v[24:27], 0
ds_read_b128 v[40:43], v1 offset:16896
s_mov_b64 exec, s[86:87]
buffer_store_dwordx4 v[24:27], v5, s[8:11], s31 offen offset:0 sc1
s_mov_b64 exec, -1
s_waitcnt lgkmcnt(3)
v_mfma_f32_16x16x32_bf16 v[16:19], v[44:47], v[28:31], v[16:19]
s_waitcnt lgkmcnt(2)
ds_read_b128 v[44:47], v1 offset:18944
v_mfma_f32_16x16x32_bf16 v[16:19], v[48:51], v[32:35], v[16:19]
s_waitcnt lgkmcnt(2)
ds_read_b128 v[48:51], v1 offset:20992
v_mfma_f32_16x16x32_bf16 v[16:19], v[52:55], v[36:39], v[16:19]
ds_read_b128 v[52:55], v1 offset:23040
v_mfma_f32_16x16x32_bf16 v[20:23], v[24:27], v[24:27], 0
v_add_f32 v56, v56, v57
v_add_f32 v58, v58, v59
v_mfma_f32_16x16x32_bf16 v[20:23], v[28:31], v[28:31], v[20:23]
v_add_f32 v60, v60, v61
v_add_f32 v62, v62, v63
v_mfma_f32_16x16x32_bf16 v[20:23], v[32:35], v[32:35], v[20:23]
v_cvt_pk_bf16_f32 v56, v56, v58
v_cvt_pk_bf16_f32 v57, v60, v62
v_mfma_f32_16x16x32_bf16 v[20:23], v[36:39], v[36:39], v[20:23]
s_waitcnt lgkmcnt(3)
v_lshrrev_b32 v58, 1, v1
v_max3_f32 v59, v16, v17, v18
v_mfma_f32_16x16x32_bf16 v[12:15], v[40:43], v[24:27], 0
s_waitcnt lgkmcnt(2)
ds_read_b128 v[40:43], v2 offset:18432
buffer_store_dwordx2 v[56:57], v58, s[8:11], s31 offen offset:2048 sc1
v_mfma_f32_16x16x32_bf16 v[12:15], v[44:47], v[28:31], v[12:15]
s_waitcnt lgkmcnt(2)
ds_read_b128 v[44:47], v2 offset:19456
v_mfma_f32_16x16x32_bf16 v[12:15], v[48:51], v[32:35], v[12:15]
s_waitcnt lgkmcnt(2)
ds_read_b128 v[48:51], v2 offset:20480
v_max3_f32 v59, v59, v19, v20
v_max_f32 v59, v59, v21
v_mfma_f32_16x16x32_bf16 v[12:15], v[52:55], v[36:39], v[12:15]
ds_read_b128 v[52:55], v2 offset:21504
v_mov_b32 v60, s53
s_add_u32 s49, s28, s23
v_mov_b32 v61, s53
s_add_u32 s50, s28, 65536
v_mov_b32 v62, s53
ds_read_b128 v[32:35], v2 offset:22528
v_mov_b32 v63, s53
v_max3_f32 v59, v59, v12, v13
v_max3_f32 v22, v59, v14, v15
v_max3_f32 v59, v59, v14, v15
s_add_u32 s51, s28, 131072
s_add_u32 s52, s28, 196608
v_permlane32_swap_b32 v22, v59
v_max_f32 v23, v59, v22
v_max_f32 v59, v59, v22
v_mov_b32 v22, 0
ds_read_b128 v[36:39], v2 offset:23552
v_permlane16_swap_b32 v23, v59
v_max_f32 v59, v59, v23
v_mul_f32 v58, s18, v59
v_pk_fma_f32 v[20:21], v[20:21], s[18:19], v[58:59] op_sel_hi:[1,0,0] neg_lo:[0,0,1] neg_hi:[0,0,1]
v_pk_fma_f32 v[16:17], v[16:17], s[18:19], v[58:59] op_sel_hi:[1,0,0] neg_lo:[0,0,1] neg_hi:[0,0,1]
v_pk_fma_f32 v[18:19], v[18:19], s[18:19], v[58:59] op_sel_hi:[1,0,0] neg_lo:[0,0,1] neg_hi:[0,0,1]
v_pk_fma_f32 v[12:13], v[12:13], s[18:19], v[58:59] op_sel_hi:[1,0,0] neg_lo:[0,0,1] neg_hi:[0,0,1]
v_pk_fma_f32 v[14:15], v[14:15], s[18:19], v[58:59] op_sel_hi:[1,0,0] neg_lo:[0,0,1] neg_hi:[0,0,1]
v_exp_f32 v20, v20
v_exp_f32 v21, v21
v_exp_f32 v16, v16
v_cvt_pk_bf16_f32 v23, v20, v21
v_cvt_pk_bf16_f32 v20, v20, v21
v_mov_b32 v21, 0
v_exp_f32 v17, v17
v_exp_f32 v18, v18
v_mfma_f32_16x16x16_bf16 v[24:27], v[56:57], v[20:21], 0
v_exp_f32 v19, v19
v_mfma_f32_16x16x16_bf16 v[28:31], v[56:57], v[22:23], 0
v_exp_f32 v12, v12
v_exp_f32 v13, v13
v_cvt_pk_bf16_f32 v16, v16, v17
v_cvt_pk_bf16_f32 v17, v18, v19
v_exp_f32 v14, v14
v_exp_f32 v15, v15
v_cvt_pk_bf16_f32 v18, v12, v13
v_cvt_pk_bf16_f32 v19, v14, v15
v_mfma_f32_16x16x16_bf16 v[12:15], v[60:61], v[20:21], 0
s_waitcnt vmcnt(3)
v_mfma_f32_16x16x32_bf16 v[12:15], v[60:63], v[16:19], v[12:15]
v_mov_b32 v20, 0
v_mov_b32 v23, 0
v_mfma_f32_16x16x32_bf16 v[24:27], v[64:67], v[16:19], v[24:27]
s_nop 1
v_mfma_f32_16x16x32_bf16 v[28:31], v[68:71], v[16:19], v[28:31]
v_mov_b32 v16, 0
v_mov_b32 v17, 0
v_rcp_f32 v12, v12
v_mov_b32 v18, 0
v_mov_b32 v19, 0
v_pk_mul_f32 v[24:25], v[24:25], v[12:13] op_sel_hi:[1,0]
v_pk_mul_f32 v[26:27], v[26:27], v[12:13] op_sel_hi:[1,0]
v_mov_b32 v15, 0
v_pk_mul_f32 v[28:29], v[28:29], v[12:13] op_sel_hi:[1,0]
v_pk_mul_f32 v[30:31], v[30:31], v[12:13] op_sel_hi:[1,0]
v_cvt_pk_bf16_f32 v24, v24, v28
v_cvt_pk_bf16_f32 v25, v25, v29
v_cvt_pk_bf16_f32 v26, v26, v30
v_cvt_pk_bf16_f32 v27, v27, v31
v_mfma_f32_16x16x32_bf16 v[56:59], v[20:23], v[20:23], 0
ds_write_b128 v7, v[24:27]
v_mfma_f32_16x16x32_bf16 v[60:63], v[20:23], v[20:23], 0
v_mov_b32 v12, 0
v_mov_b32 v13, 0
v_mov_b32 v14, 0
v_mov_b32 v3, 6528
v_and_b32 v8, 0x380, v1
v_add_u32 v8, v8, v1
v_mfma_f32_16x16x32_bf16 v[64:67], v[20:23], v[20:23], 0
s_add_u32 s20, s30, 16384
s_mov_b32 m0, 15872
s_cmp_eq_u32 s19, 63
s_cbranch_scc1 L_texit
s_waitcnt lgkmcnt(0)
s_barrier
ds_read_b128 v[24:27], v1 offset:4224
v_mfma_f32_16x16x32_bf16 v[68:71], v[20:23], v[20:23], 0
ds_read_b128 v[28:31], v1 offset:5248
s_nop 2
v_mfma_f32_16x16x32_bf16 v[68:71], v[20:23], v[20:23], 0
s_waitcnt lgkmcnt(1)
v_smfmac_f32_16x16x64_bf16 v[12:15], v[24:27], a[248:255], v0
buffer_load_dwordx4 v8, s[8:11], s20 offen sc1 lds
v_smfmac_f32_16x16x64_bf16 v[16:19], v[24:27], a[176:183], v0
s_mov_b32 m0, 16768
s_waitcnt lgkmcnt(0)
v_smfmac_f32_16x16x64_bf16 v[12:15], v[28:31], v[40:47], v0
ds_read_b128 v[40:43], v2 offset:24576
v_smfmac_f32_16x16x64_bf16 v[16:19], v[28:31], v[48:55], v0
ds_read_b128 v[44:47], v2 offset:25600
buffer_load_dwordx4 v8, s[8:11], s20 offen offset:128 sc1 lds
v_smfmac_f32_16x16x64_bf16 v[20:23], v[24:27], a[184:191], v0
ds_read_b128 v[48:51], v2 offset:26624
s_nop 1
v_add_f32 v12, v12, v13
v_add_f32 v14, v14, v15
v_cvt_pk_bf16_f32 v12, v12, v14
v_smfmac_f32_16x16x64_bf16 v[20:23], v[28:31], v[32:39], v0
ds_read_b128 v[52:55], v2 offset:27648
buffer_store_dword v12, v10, s[8:11], s28 offen
v_add_f32 v16, v16, v17
v_add_f32 v18, v18, v19
v_smfmac_f32_16x16x64_bf16 v[56:59], v[24:27], a[192:199], v0
s_waitcnt lgkmcnt(2)
ds_read_b128 v[32:35], v2 offset:28672
v_cvt_pk_bf16_f32 v16, v16, v18
v_smfmac_f32_16x16x64_bf16 v[56:59], v[28:31], v[40:47], v0
ds_read_b128 v[36:39], v2 offset:29696
v_add_f32 v20, v20, v21
v_add_f32 v22, v22, v23
v_cvt_pk_bf16_f32 v17, v20, v22
v_smfmac_f32_16x16x64_bf16 v[60:63], v[24:27], a[200:207], v0
s_waitcnt lgkmcnt(2)
ds_read_b128 v[12:15], v3
buffer_store_dwordx2 v[16:17], v9, s[8:11], s28 offen
v_smfmac_f32_16x16x64_bf16 v[60:63], v[28:31], v[48:55], v0
ds_read_b128 v[40:43], v2 offset:30720
v_add_f32 v56, v56, v57
v_add_f32 v58, v58, v59
v_cvt_pk_bf16_f32 v56, v56, v58
v_smfmac_f32_16x16x64_bf16 v[64:67], v[24:27], a[208:215], v0
s_waitcnt lgkmcnt(2)
ds_read_b128 v[44:47], v2 offset:31744
v_smfmac_f32_16x16x64_bf16 v[64:67], v[28:31], v[32:39], v0
ds_read_b128 v[20:23], v3
v_add_f32 v60, v60, v61
v_add_f32 v62, v62, v63
v_cvt_pk_bf16_f32 v57, v60, v62
v_smfmac_f32_16x16x64_bf16 v[68:71], v[24:27], a[216:223], v0
s_waitcnt lgkmcnt(1)
ds_read_b128 v[48:51], v2 offset:32768
buffer_store_dwordx2 v[56:57], v9, s[8:11], s50 offen
v_smfmac_f32_16x16x64_bf16 v[68:71], v[28:31], v[40:47], v0
ds_read_b128 v[52:55], v2 offset:33792
v_add_f32 v64, v64, v65
v_add_f32 v66, v66, v67
v_cvt_pk_bf16_f32 v64, v64, v66
v_smfmac_f32_16x16x64_bf16 v[12:15], v[24:27], a[224:231], v0
s_waitcnt lgkmcnt(0)
v_smfmac_f32_16x16x64_bf16 v[12:15], v[28:31], v[48:55], v0
s_nop 0
v_add_f32 v68, v68, v69
v_add_f32 v70, v70, v71
v_cvt_pk_bf16_f32 v65, v68, v70
v_smfmac_f32_16x16x64_bf16 v[20:23], v[24:27], a[232:239], v0
buffer_store_dwordx2 v[64:65], v9, s[8:11], s51 offen
v_smfmac_f32_16x16x64_bf16 v[20:23], v[28:31], a[240:247], v0
s_nop 0
v_add_f32 v12, v12, v13
v_add_f32 v14, v14, v15
v_cvt_pk_bf16_f32 v12, v12, v14
s_nop 3
v_add_f32 v20, v20, v21
v_add_f32 v22, v22, v23
v_cvt_pk_bf16_f32 v13, v20, v22
buffer_store_dwordx2 v[12:13], v9, s[8:11], s52 offen
s_waitcnt vmcnt(2)
L_lt0:
buffer_load_dwordx4 v[32:35], v1, s[8:11], s49 offen offset:0 sc1
buffer_load_dwordx4 v[36:39], v1, s[8:11], s49 offen offset:1024 sc1
buffer_load_dwordx4 v[40:43], v1, s[8:11], s49 offen offset:2048 sc1
buffer_load_dwordx4 v[44:47], v1, s[8:11], s49 offen offset:3072 sc1
s_add_u32 s19, s19, 1
s_mov_b32 s20, s28
s_mov_b32 s28, s29
s_mov_b32 s29, s20
s_and_b32 s20, s19, 3
s_lshl_b32 s20, s20, 14
s_add_u32 s33, s20, 110100480
s_add_u32 s34, s20, s24
s_xor_b32 s20, s20, 32768
s_add_u32 s35, s20, s24
s_add_u32 s30, s30, 16384
s_add_u32 s31, s31, 131072
s_add_u32 s6, s33, 4096
s_add_u32 s7, s33, 8192
s_mov_b32 s22, 0
v_mov_b64 v[24:25], 0
v_mov_b64 v[26:27], 0
v_mov_b64 v[28:29], 0
v_mov_b64 v[30:31], 0
v_and_b32 v70, 0xf00, v1
v_add_u32 v70, v70, v1
v_mov_b64 v[64:65], -1
v_mov_b64 v[66:67], -1
v_xor_b32 v3, 16, v4
ds_read_b128 v[48:51], v2 offset:8192
ds_read_b128 v[52:55], v2 offset:9216
v_lshrrev_b32 v8, 2, v1
v_mov_b32 v56, 0x3f80
v_cndmask_b32 v56, v56, 1.0, s[44:45]
v_cndmask_b32 v60, 0, v56, s[36:37]
buffer_load_dwordx4 v[32:35], v1, s[8:11], s49 offen offset:0 sc1
buffer_load_dwordx4 v[36:39], v1, s[8:11], s49 offen offset:1024 sc1
buffer_load_dwordx4 v[40:43], v1, s[8:11], s49 offen offset:2048 sc1
buffer_load_dwordx4 v[44:47], v1, s[8:11], s49 offen offset:3072 sc1
v_cndmask_b32 v61, 0, v56, s[38:39]
v_cndmask_b32 v62, 0, v56, s[40:41]
v_cndmask_b32 v63, 0, v56, s[42:43]
s_waitcnt vmcnt(7)
v_max3_u32 v16, v32, v33, v34
v_max_u32 v16, v16, v35
v_mfma_f32_16x16x32_bf16 v[56:59], v[32:35], v[60:63], 0
s_waitcnt vmcnt(6)
v_max3_u32 v16, v16, v36, v37
v_max3_u32 v16, v16, v38, v39
v_mfma_f32_16x16x32_bf16 v[56:59], v[36:39], v[60:63], v[56:59]
s_waitcnt vmcnt(5)
v_max3_u32 v16, v16, v40, v41
v_max3_u32 v16, v16, v42, v43
v_mfma_f32_16x16x32_bf16 v[56:59], v[40:43], v[60:63], v[56:59]
s_waitcnt vmcnt(4)
v_max3_u32 v16, v16, v44, v45
v_max3_u32 v16, v16, v46, v47
v_mfma_f32_16x16x32_bf16 v[56:59], v[44:47], v[60:63], v[56:59]
v_cmp_le_u32 vcc, 0xffff0000, v16
s_cbranch_vccnz L_red0
L_redb0:
s_nop 5
v_permlane32_swap_b32 v56, v58
v_permlane32_swap_b32 v57, v59
v_pk_add_f32 v[56:57], v[56:57], v[58:59]
v_cvt_pk_bf16_f32 v56, v56, v57
buffer_store_dword v56, v11, s[8:11], s34 offen
s_add_u32 s20, s30, 0
s_add_u32 s21, s30, 8192
s_add_u32 s49, s29, s25
s_add_u32 s50, s29, s26
s_add_u32 s51, s29, s27
s_add_u32 s52, s30, 16384
s_mov_b32 m0, 15872
s_nop 1
s_barrier
s_branch L_gat0
L_red0:
s_waitcnt vmcnt(3)
v_mfma_f32_16x16x32_bf16 v[56:59], v[32:35], v[60:63], 0
v_max3_u32 v16, v32, v33, v34
v_max_u32 v16, v16, v35
s_waitcnt vmcnt(2)
v_mfma_f32_16x16x32_bf16 v[56:59], v[36:39], v[60:63], v[56:59]
v_max3_u32 v16, v16, v36, v37
v_max3_u32 v16, v16, v38, v39
s_waitcnt vmcnt(1)
v_mfma_f32_16x16x32_bf16 v[56:59], v[40:43], v[60:63], v[56:59]
v_max3_u32 v16, v16, v40, v41
v_max3_u32 v16, v16, v42, v43
s_waitcnt vmcnt(0)
v_mfma_f32_16x16x32_bf16 v[56:59], v[44:47], v[60:63], v[56:59]
v_max3_u32 v16, v16, v44, v45
v_max3_u32 v16, v16, v46, v47
v_cmp_le_u32 vcc, 0xffff0000, v16
s_cbranch_vccz L_redb0
L_red0b:
buffer_load_dwordx4 v[32:35], v1, s[8:11], s49 offen offset:0 sc1
buffer_load_dwordx4 v[36:39], v1, s[8:11], s49 offen offset:1024 sc1
buffer_load_dwordx4 v[40:43], v1, s[8:11], s49 offen offset:2048 sc1
buffer_load_dwordx4 v[44:47], v1, s[8:11], s49 offen offset:3072 sc1
s_add_u32 s22, s22, 1
s_cmp_gt_u32 s22, 40000
s_cbranch_scc1 L_end
s_waitcnt vmcnt(3)
v_mfma_f32_16x16x32_bf16 v[56:59], v[32:35], v[60:63], 0
v_max3_u32 v16, v32, v33, v34
v_max_u32 v16, v16, v35
s_waitcnt vmcnt(2)
v_mfma_f32_16x16x32_bf16 v[56:59], v[36:39], v[60:63], v[56:59]
v_max3_u32 v16, v16, v36, v37
v_max3_u32 v16, v16, v38, v39
s_waitcnt vmcnt(1)
v_mfma_f32_16x16x32_bf16 v[56:59], v[40:43], v[60:63], v[56:59]
v_max3_u32 v16, v16, v40, v41
v_max3_u32 v16, v16, v42, v43
s_waitcnt vmcnt(0)
v_mfma_f32_16x16x32_bf16 v[56:59], v[44:47], v[60:63], v[56:59]
v_max3_u32 v16, v16, v44, v45
v_max3_u32 v16, v16, v46, v47
v_cmp_le_u32 vcc, 0xffff0000, v16
s_cbranch_vccz L_redb0
s_branch L_red0b
L_g3r0:
buffer_load_dwordx4 v[16:19], v1, s[8:11], s6 offen sc1
s_add_u32 s22, s22, 1
s_waitcnt vmcnt(1)
v_max3_u32 v21, v16, v17, v18
v_max_u32 v21, v21, v19
v_cmp_le_u32 vcc, 0xffff0000, v21
s_cmp_gt_u32 s22, 40000
s_cbranch_vccz L_g30
s_cbranch_scc0 L_g3r0
s_branch L_end
L_ent1:
v_mov_b64 v[24:25], 0
v_mov_b64 v[26:27], 0
v_mov_b64 v[28:29], 0
v_mov_b64 v[30:31], 0
v_and_b32 v69, 0x380, v1
v_add_u32 v69, v69, v1
v_and_b32 v70, 0xf00, v1
v_add_u32 v70, v70, v1
v_mov_b64 v[64:65], -1
v_mov_b64 v[66:67], -1
v_xor_b32 v3, 16, v4
ds_read_b128 v[48:51], v2 offset:10240
ds_read_b128 v[52:55], v2 offset:11264
ds_read_b128 v[40:43], v2 offset:2048
ds_read_b128 v[44:47], v2 offset:3072
v_mov_b64 v[32:33], 0
v_mov_b64 v[34:35], 0
v_mov_b64 v[36:37], 0
v_mov_b64 v[38:39], 0
v_mov_b64 v[56:57], 0
v_mov_b64 v[58:59], 0
v_mov_b64 v[60:61], 0
v_mov_b64 v[62:63], 0
s_add_u32 s20, s30, 1024
s_add_u32 s21, s30, 8192
s_add_u32 s49, s29, s25
s_add_u32 s50, s29, s26
s_add_u32 s51, s29, s27
s_add_u32 s52, s30, 16384
s_mov_b32 m0, 17920
s_nop 0
buffer_load_dwordx4 v69, s[8:11], s20 offen sc1 lds
s_mov_b32 m0, 18816
s_nop 0
buffer_load_dwordx4 v69, s[8:11], s20 offen offset:128 sc1 lds
s_waitcnt vmcnt(0) lgkmcnt(0)
s_branch L_step1
L_gr1:
buffer_load_dwordx4 v[12:15], v1, s[8:11], s33 offen sc1
buffer_load_dword v20, v8, s[8:11], s7 offen sc1
buffer_load_dwordx4 v[16:19], v1, s[8:11], s6 offen sc1
s_add_u32 s22, s22, 1
s_cmp_gt_u32 s22, 40000
s_cbranch_scc1 L_end
buffer_load_dwordx4 v[16:19], v1, s[8:11], s6 offen sc1
v_mov_b64 v[24:25], 0
v_mov_b64 v[26:27], 0
v_mov_b64 v[28:29], 0
v_mov_b64 v[30:31], 0
v_mov_b64 v[32:33], 0
v_mov_b64 v[34:35], 0
v_mov_b64 v[36:37], 0
v_mov_b64 v[38:39], 0
v_mov_b64 v[56:57], 0
v_mov_b64 v[58:59], 0
v_mov_b64 v[60:61], 0
v_mov_b64 v[62:63], 0
s_waitcnt lgkmcnt(0)
s_branch L_step1
.p2align 3
L_gat1:
buffer_load_dwordx4 v[12:15], v1, s[8:11], s33 offen sc1
buffer_load_dword v20, v8, s[8:11], s7 offen sc1
buffer_load_dwordx4 v[16:19], v1, s[8:11], s6 offen sc1
s_add_u32 s20, s30, 1024
s_add_u32 s21, s30, 8192
s_add_u32 s49, s29, s25
s_add_u32 s50, s29, s26
s_add_u32 s51, s29, s27
s_add_u32 s52, s30, 16384
s_mov_b32 m0, 17920
s_waitcnt vmcnt(4)
ds_read_b128 v[40:43], v2 offset:2048
ds_read_b128 v[44:47], v2 offset:3072
v_mov_b64 v[32:33], 0
v_mov_b64 v[34:35], 0
v_mov_b64 v[36:37], 0
v_mov_b64 v[38:39], 0
v_mov_b64 v[56:57], 0
v_mov_b64 v[58:59], 0
v_mov_b64 v[60:61], 0
v_mov_b64 v[62:63], 0
s_nop 6
buffer_load_dwordx4 v[16:19], v1, s[8:11], s6 offen sc1
s_waitcnt lgkmcnt(0)
L_step1:
s_waitcnt vmcnt(3)
v_smfmac_f32_16x16x64_bf16 v[24:27], v[12:15], v[96:103], v0
ds_write_b128 v1, v[12:15] offset:6656
v_smfmac_f32_16x16x64_bf16 v[28:31], v[12:15], v[104:111], v0
s_waitcnt vmcnt(2)
v_max3_u32 v21, v12, v13, v14
v_max3_u32 v21, v21, v15, v20
v_cmp_le_u32 vcc, 0xffff0000, v21
v_smfmac_f32_16x16x64_bf16 v[32:35], v[12:15], v[112:119], v0
s_cbranch_vccnz L_gr1
s_waitcnt vmcnt(1)
v_max3_u32 v21, v16, v17, v18
v_max_u32 v21, v21, v19
v_cmp_le_u32 vcc, 0xffff0000, v21
ds_write_b32 v8, v20 offset:14848
v_smfmac_f32_16x16x64_bf16 v[56:59], v[12:15], a[48:55], v0
s_cbranch_vccnz L_g3r1
L_g31:
ds_write_b128 v1, v[16:19] offset:10752
v_smfmac_f32_16x16x64_bf16 v[60:63], v[12:15], a[56:63], v0
v_smfmac_f32_16x16x64_bf16 v[36:39], v[12:15], v[40:47], v0
v_smfmac_f32_16x16x64_bf16 v[24:27], v[16:19], v[192:199], v0
v_smfmac_f32_16x16x64_bf16 v[28:31], v[16:19], v[200:207], v0
s_waitcnt lgkmcnt(0)
s_barrier
ds_read_b128 v[20:23], v1 offset:5632
v_smfmac_f32_16x16x64_bf16 v[32:35], v[16:19], v[208:215], v0
ds_read_b128 v[12:15], v1 offset:7680
s_mov_b32 m0, 6272
buffer_store_dword v0, v11, s[8:11], s35 offen
v_smfmac_f32_16x16x64_bf16 v[56:59], v[16:19], a[112:119], v0
ds_read_b128 v[40:43], v2 offset:0
v_smfmac_f32_16x16x64_bf16 v[60:63], v[16:19], a[120:127], v0
ds_read_b128 v[44:47], v2 offset:1024
buffer_store_dwordx4 v[64:67], v1, s[8:11], s49 offen
v_smfmac_f32_16x16x64_bf16 v[36:39], v[16:19], v[48:55], v0
s_waitcnt vmcnt(2)
ds_read_b128 v[16:19], v1 offset:8704
s_waitcnt lgkmcnt(4)
v_smfmac_f32_16x16x64_bf16 v[24:27], v[20:23], v[72:79], v0
ds_read_b128 v[48:51], v2 offset:4096
buffer_store_dwordx4 v[64:67], v1, s[8:11], s50 offen
v_smfmac_f32_16x16x64_bf16 v[28:31], v[20:23], v[80:87], v0
ds_read_b128 v[52:55], v2 offset:5120
v_smfmac_f32_16x16x64_bf16 v[32:35], v[20:23], v[88:95], v0
s_waitcnt lgkmcnt(3)
buffer_store_dwordx4 v[64:67], v1, s[8:11], s51 offen
v_smfmac_f32_16x16x64_bf16 v[36:39], v[20:23], v[40:47], v0
ds_read_b128 v[20:23], v1 offset:9728
buffer_load_dwordx4 v[64:67], v70, s[8:11], s21 offen sc1
v_smfmac_f32_16x16x64_bf16 v[24:27], v[12:15], v[120:127], v0
ds_read_b128 v[40:43], v2 offset:6144
v_smfmac_f32_16x16x64_bf16 v[28:31], v[12:15], v[128:135], v0
ds_read_b128 v[44:47], v2 offset:7168
buffer_load_dwordx4 v[68:71], v70, s[8:11], s21 offen offset:256 sc1
v_smfmac_f32_16x16x64_bf16 v[32:35], v[12:15], v[136:143], v0
s_waitcnt lgkmcnt(3)
v_smfmac_f32_16x16x64_bf16 v[36:39], v[12:15], v[48:55], v0
ds_read_b128 v[12:15], v1 offset:11776
v_smfmac_f32_16x16x64_bf16 v[24:27], v[16:19], v[144:151], v0
ds_read_b128 v[48:51], v2 offset:8192
v_smfmac_f32_16x16x64_bf16 v[28:31], v[16:19], v[152:159], v0
ds_read_b128 v[52:55], v2 offset:9216
v_smfmac_f32_16x16x64_bf16 v[32:35], v[16:19], v[160:167], v0
s_waitcnt lgkmcnt(3)
buffer_load_dword v6, s[8:11], s52 offen sc1 lds
v_smfmac_f32_16x16x64_bf16 v[36:39], v[16:19], v[40:47], v0
ds_read_b128 v[16:19], v1 offset:12800
v_smfmac_f32_16x16x64_bf16 v[24:27], v[20:23], v[168:175], v0
ds_read_b128 v[40:43], v2 offset:12288
v_smfmac_f32_16x16x64_bf16 v[28:31], v[20:23], v[176:183], v0
ds_read_b128 v[44:47], v2 offset:13312
v_smfmac_f32_16x16x64_bf16 v[32:35], v[20:23], v[184:191], v0
s_waitcnt lgkmcnt(3)
v_smfmac_f32_16x16x64_bf16 v[36:39], v[20:23], v[48:55], v0
ds_read_b128 v[20:23], v1 offset:13824
v_smfmac_f32_16x16x64_bf16 v[24:27], v[12:15], v[216:223], v0
ds_read_b128 v[48:51], v2 offset:14336
v_smfmac_f32_16x16x64_bf16 v[28:31], v[12:15], v[224:231], v0
ds_read_b128 v[52:55], v2 offset:15360
v_smfmac_f32_16x16x64_bf16 v[32:35], v[12:15], v[232:239], v0
s_waitcnt lgkmcnt(3)
v_smfmac_f32_16x16x64_bf16 v[36:39], v[12:15], v[40:47], v0
ds_read_b128 v[12:15], v1 offset:5632
v_smfmac_f32_16x16x64_bf16 v[24:27], v[16:19], v[240:247], v0
ds_read_b128 v[40:43], v2 offset:16384
v_smfmac_f32_16x16x64_bf16 v[28:31], v[16:19], v[248:255], v0
s_waitcnt lgkmcnt(4)
ds_read_b128 v[44:47], v2 offset:17408
v_smfmac_f32_16x16x64_bf16 v[24:27], v[20:23], a[8:15], v0
v_smfmac_f32_16x16x64_bf16 v[28:31], v[20:23], a[16:23], v0
v_smfmac_f32_16x16x64_bf16 v[32:35], v[16:19], a[0:7], v0
s_waitcnt lgkmcnt(3)
v_smfmac_f32_16x16x64_bf16 v[36:39], v[16:19], v[48:55], v0
ds_read_b128 v[16:19], v1 offset:7680
s_nop 2
v_add_f32 v24, v24, v25
v_smfmac_f32_16x16x64_bf16 v[32:35], v[20:23], a[24:31], v0
s_waitcnt lgkmcnt(1)
ds_read_b128 v[48:51], v1 offset:18944
v_add_f32 v26, v26, v27
v_smfmac_f32_16x16x64_bf16 v[36:39], v[20:23], v[40:47], v0
ds_read_b128 v[52:55], v1 offset:20992
v_add_f32 v28, v28, v29
v_smfmac_f32_16x16x64_bf16 v[56:59], v[12:15], a[32:39], v0
ds_read_b128 v[20:23], v1 offset:8704
v_add_f32 v30, v30, v31
v_cvt_pk_bf16_f32 v24, v24, v28
ds_write_b32 v4, v24 offset:2176
v_smfmac_f32_16x16x64_bf16 v[60:63], v[12:15], a[40:47], v0
s_waitcnt lgkmcnt(4)
ds_read_b128 v[12:15], v1 offset:9728
v_cvt_pk_bf16_f32 v26, v26, v30
ds_write_b32 v3, v26 offset:2176
v_add_f32 v32, v32, v33
v_smfmac_f32_16x16x64_bf16 v[56:59], v[16:19], a[64:71], v0
ds_read_b128 v[44:47], v1 offset:16896
v_add_f32 v34, v34, v35
v_add_f32 v36, v36, v37
v_add_f32 v38, v38, v39
v_smfmac_f32_16x16x64_bf16 v[60:63], v[16:19], a[72:79], v0
s_waitcnt lgkmcnt(4)
ds_read_b128 v[16:19], v1 offset:11776
v_cvt_pk_bf16_f32 v32, v32, v36
ds_write_b32 v4, v32 offset:0
v_cvt_pk_bf16_f32 v34, v34, v38
v_smfmac_f32_16x16x64_bf16 v[56:59], v[20:23], a[80:87], v0
ds_read_b128 v[40:43], v1 offset:14848
ds_write_b32 v3, v34 offset:0
v_smfmac_f32_16x16x64_bf16 v[60:63], v[20:23], a[88:95], v0
s_waitcnt lgkmcnt(6)
ds_read_b128 v[20:23], v1 offset:12800
v_smfmac_f32_16x16x64_bf16 v[56:59], v[12:15], a[96:103], v0
v_smfmac_f32_16x16x64_bf16 v[60:63], v[12:15], a[104:111], v0
s_waitcnt lgkmcnt(4)
ds_read_b128 v[12:15], v1 offset:13824
v_smfmac_f32_16x16x64_bf16 v[56:59], v[16:19], a[128:135], v0
v_smfmac_f32_16x16x64_bf16 v[60:63], v[16:19], a[136:143], v0
s_waitcnt lgkmcnt(1)
v_smfmac_f32_16x16x64_bf16 v[56:59], v[20:23], a[144:151], v0
s_barrier
ds_read_b128 v[28:31], v5 offset:512
v_smfmac_f32_16x16x64_bf16 v[60:63], v[20:23], a[152:159], v0
s_waitcnt lgkmcnt(1)
ds_read_b128 v[32:35], v5 offset:1024
v_smfmac_f32_16x16x64_bf16 v[56:59], v[12:15], a[160:167], v0
ds_read_b128 v[36:39], v5 offset:1536
v_smfmac_f32_16x16x64_bf16 v[60:63], v[12:15], a[168:175], v0
s_waitcnt lgkmcnt(2)
ds_read_b128 v[24:27], v5 offset:0
v_mfma_f32_16x16x32_bf16 v[16:19], v[44:47], v[28:31], 0
s_waitcnt lgkmcnt(2)
ds_read_b128 v[44:47], v1 offset:17920
v_mfma_f32_16x16x32_bf16 v[16:19], v[48:51], v[32:35], v[16:19]
ds_read_b128 v[48:51], v1 offset:19968
s_mov_b64 exec, s[86:87]
buffer_store_dwordx4 v[28:31], v5, s[8:11], s31 offen offset:512 sc1
s_mov_b64 exec, -1
s_waitcnt lgkmcnt(3)
v_mfma_f32_16x16x32_bf16 v[16:19], v[52:55], v[36:39], v[16:19]
s_waitcnt lgkmcnt(2)
ds_read_b128 v[52:55], v1 offset:22016
v_mfma_f32_16x16x32_bf16 v[16:19], v[40:43], v[24:27], v[16:19]
ds_read_b128 v[40:43], v1 offset:15872
v_mfma_f32_16x16x32_bf16 v[20:23], v[28:31], v[28:31], 0
v_add_f32 v56, v56, v57
v_add_f32 v58, v58, v59
v_mfma_f32_16x16x32_bf16 v[20:23], v[32:35], v[32:35], v[20:23]
v_add_f32 v60, v60, v61
v_add_f32 v62, v62, v63
v_mfma_f32_16x16x32_bf16 v[20:23], v[36:39], v[36:39], v[20:23]
v_cvt_pk_bf16_f32 v56, v56, v58
v_cvt_pk_bf16_f32 v57, v60, v62
v_mfma_f32_16x16x32_bf16 v[20:23], v[24:27], v[24:27], v[20:23]
s_waitcnt lgkmcnt(3)
v_lshrrev_b32 v58, 1, v1
v_max3_f32 v59, v16, v17, v18
v_mfma_f32_16x16x32_bf16 v[12:15], v[44:47], v[28:31], 0
s_waitcnt lgkmcnt(2)
ds_read_b128 v[44:47], v2 offset:19456
v_mfma_f32_16x16x32_bf16 v[12:15], v[48:51], v[32:35], v[12:15]
s_waitcnt lgkmcnt(2)
ds_read_b128 v[48:51], v2 offset:20480
buffer_store_dwordx2 v[56:57], v58, s[8:11], s31 offen offset:2048 sc1
v_mfma_f32_16x16x32_bf16 v[12:15], v[52:55], v[36:39], v[12:15]
s_waitcnt lgkmcnt(2)
ds_read_b128 v[52:55], v2 offset:21504
v_max3_f32 v59, v59, v19, v20
v_max_f32 v59, v59, v21
v_mfma_f32_16x16x32_bf16 v[12:15], v[40:43], v[24:27], v[12:15]
ds_read_b128 v[40:43], v2 offset:18432
v_mov_b32 v60, s53
s_add_u32 s49, s28, s23
v_mov_b32 v61, s53
s_add_u32 s50, s28, 65536
v_mov_b32 v62, s53
ds_read_b128 v[32:35], v2 offset:22528
v_mov_b32 v63, s53
v_max3_f32 v59, v59, v12, v13
v_max3_f32 v22, v59, v14, v15
v_max3_f32 v59, v59, v14, v15
s_add_u32 s51, s28, 131072
s_add_u32 s52, s28, 196608
v_permlane32_swap_b32 v22, v59
v_max_f32 v23, v59, v22
v_max_f32 v59, v59, v22
v_mov_b32 v22, 0
ds_read_b128 v[36:39], v2 offset:23552
v_permlane16_swap_b32 v23, v59
v_max_f32 v59, v59, v23
v_mul_f32 v58, s18, v59
v_pk_fma_f32 v[20:21], v[20:21], s[18:19], v[58:59] op_sel_hi:[1,0,0] neg_lo:[0,0,1] neg_hi:[0,0,1]
v_pk_fma_f32 v[16:17], v[16:17], s[18:19], v[58:59] op_sel_hi:[1,0,0] neg_lo:[0,0,1] neg_hi:[0,0,1]
v_pk_fma_f32 v[18:19], v[18:19], s[18:19], v[58:59] op_sel_hi:[1,0,0] neg_lo:[0,0,1] neg_hi:[0,0,1]
v_pk_fma_f32 v[12:13], v[12:13], s[18:19], v[58:59] op_sel_hi:[1,0,0] neg_lo:[0,0,1] neg_hi:[0,0,1]
v_pk_fma_f32 v[14:15], v[14:15], s[18:19], v[58:59] op_sel_hi:[1,0,0] neg_lo:[0,0,1] neg_hi:[0,0,1]
v_exp_f32 v20, v20
v_exp_f32 v21, v21
v_exp_f32 v16, v16
v_cvt_pk_bf16_f32 v23, v20, v21
v_cvt_pk_bf16_f32 v20, v20, v21
v_mov_b32 v21, 0
v_exp_f32 v17, v17
v_exp_f32 v18, v18
v_mfma_f32_16x16x16_bf16 v[24:27], v[56:57], v[20:21], 0
v_exp_f32 v19, v19
v_mfma_f32_16x16x16_bf16 v[28:31], v[56:57], v[22:23], 0
v_exp_f32 v12, v12
v_exp_f32 v13, v13
v_cvt_pk_bf16_f32 v16, v16, v17
v_cvt_pk_bf16_f32 v17, v18, v19
v_exp_f32 v14, v14
v_exp_f32 v15, v15
v_cvt_pk_bf16_f32 v18, v12, v13
v_cvt_pk_bf16_f32 v19, v14, v15
v_mfma_f32_16x16x16_bf16 v[12:15], v[60:61], v[20:21], 0
s_waitcnt vmcnt(3)
v_mfma_f32_16x16x32_bf16 v[12:15], v[60:63], v[16:19], v[12:15]
v_mov_b32 v20, 0
v_mov_b32 v23, 0
v_mfma_f32_16x16x32_bf16 v[24:27], v[64:67], v[16:19], v[24:27]
s_nop 1
v_mfma_f32_16x16x32_bf16 v[28:31], v[68:71], v[16:19], v[28:31]
v_mov_b32 v16, 0
v_mov_b32 v17, 0
v_rcp_f32 v12, v12
v_mov_b32 v18, 0
v_mov_b32 v19, 0
v_pk_mul_f32 v[24:25], v[24:25], v[12:13] op_sel_hi:[1,0]
v_pk_mul_f32 v[26:27], v[26:27], v[12:13] op_sel_hi:[1,0]
v_mov_b32 v15, 0
v_pk_mul_f32 v[28:29], v[28:29], v[12:13] op_sel_hi:[1,0]
v_pk_mul_f32 v[30:31], v[30:31], v[12:13] op_sel_hi:[1,0]
v_cvt_pk_bf16_f32 v24, v24, v28
v_cvt_pk_bf16_f32 v25, v25, v29
v_cvt_pk_bf16_f32 v26, v26, v30
v_cvt_pk_bf16_f32 v27, v27, v31
v_mfma_f32_16x16x32_bf16 v[56:59], v[20:23], v[20:23], 0
ds_write_b128 v7, v[24:27]
v_mfma_f32_16x16x32_bf16 v[60:63], v[20:23], v[20:23], 0
v_mov_b32 v12, 0
v_mov_b32 v13, 0
v_mov_b32 v14, 0
v_mov_b32 v3, 6528
v_and_b32 v8, 0x380, v1
v_add_u32 v8, v8, v1
v_mfma_f32_16x16x32_bf16 v[64:67], v[20:23], v[20:23], 0
s_add_u32 s20, s30, 17408
s_mov_b32 m0, 17920
s_cmp_eq_u32 s19, 63
s_cbranch_scc1 L_texit
s_waitcnt lgkmcnt(0)
s_barrier
ds_read_b128 v[24:27], v1 offset:3200
v_mfma_f32_16x16x32_bf16 v[68:71], v[20:23], v[20:23], 0
ds_read_b128 v[28:31], v1 offset:4224
s_nop 2
v_mfma_f32_16x16x32_bf16 v[68:71], v[20:23], v[20:23], 0
s_waitcnt lgkmcnt(1)
v_smfmac_f32_16x16x64_bf16 v[12:15], v[24:27], a[248:255], v0
buffer_load_dwordx4 v8, s[8:11], s20 offen sc1 lds
v_smfmac_f32_16x16x64_bf16 v[16:19], v[24:27], a[176:183], v0
s_mov_b32 m0, 18816
s_waitcnt lgkmcnt(0)
v_smfmac_f32_16x16x64_bf16 v[12:15], v[28:31], v[40:47], v0
ds_read_b128 v[40:43], v2 offset:24576
v_smfmac_f32_16x16x64_bf16 v[16:19], v[28:31], v[48:55], v0
ds_read_b128 v[44:47], v2 offset:25600
buffer_load_dwordx4 v8, s[8:11], s20 offen offset:128 sc1 lds
v_smfmac_f32_16x16x64_bf16 v[20:23], v[24:27], a[184:191], v0
ds_read_b128 v[48:51], v2 offset:26624
s_nop 1
v_add_f32 v12, v12, v13
v_add_f32 v14, v14, v15
v_cvt_pk_bf16_f32 v12, v12, v14
v_smfmac_f32_16x16x64_bf16 v[20:23], v[28:31], v[32:39], v0
ds_read_b128 v[52:55], v2 offset:27648
buffer_store_dword v12, v10, s[8:11], s28 offen
v_add_f32 v16, v16, v17
v_add_f32 v18, v18, v19
v_smfmac_f32_16x16x64_bf16 v[56:59], v[24:27], a[192:199], v0
s_waitcnt lgkmcnt(2)
ds_read_b128 v[32:35], v2 offset:28672
v_cvt_pk_bf16_f32 v16, v16, v18
v_smfmac_f32_16x16x64_bf16 v[56:59], v[28:31], v[40:47], v0
ds_read_b128 v[36:39], v2 offset:29696
v_add_f32 v20, v20, v21
v_add_f32 v22, v22, v23
v_cvt_pk_bf16_f32 v17, v20, v22
v_smfmac_f32_16x16x64_bf16 v[60:63], v[24:27], a[200:207], v0
s_waitcnt lgkmcnt(2)
ds_read_b128 v[12:15], v3
buffer_store_dwordx2 v[16:17], v9, s[8:11], s28 offen
v_smfmac_f32_16x16x64_bf16 v[60:63], v[28:31], v[48:55], v0
ds_read_b128 v[40:43], v2 offset:30720
v_add_f32 v56, v56, v57
v_add_f32 v58, v58, v59
v_cvt_pk_bf16_f32 v56, v56, v58
v_smfmac_f32_16x16x64_bf16 v[64:67], v[24:27], a[208:215], v0
s_waitcnt lgkmcnt(2)
ds_read_b128 v[44:47], v2 offset:31744
v_smfmac_f32_16x16x64_bf16 v[64:67], v[28:31], v[32:39], v0
ds_read_b128 v[20:23], v3
v_add_f32 v60, v60, v61
v_add_f32 v62, v62, v63
v_cvt_pk_bf16_f32 v57, v60, v62
v_smfmac_f32_16x16x64_bf16 v[68:71], v[24:27], a[216:223], v0
s_waitcnt lgkmcnt(1)
ds_read_b128 v[48:51], v2 offset:32768
buffer_store_dwordx2 v[56:57], v9, s[8:11], s50 offen
v_smfmac_f32_16x16x64_bf16 v[68:71], v[28:31], v[40:47], v0
ds_read_b128 v[52:55], v2 offset:33792
v_add_f32 v64, v64, v65
v_add_f32 v66, v66, v67
v_cvt_pk_bf16_f32 v64, v64, v66
v_smfmac_f32_16x16x64_bf16 v[12:15], v[24:27], a[224:231], v0
s_waitcnt lgkmcnt(0)
v_smfmac_f32_16x16x64_bf16 v[12:15], v[28:31], v[48:55], v0
s_nop 0
v_add_f32 v68, v68, v69
v_add_f32 v70, v70, v71
v_cvt_pk_bf16_f32 v65, v68, v70
v_smfmac_f32_16x16x64_bf16 v[20:23], v[24:27], a[232:239], v0
buffer_store_dwordx2 v[64:65], v9, s[8:11], s51 offen
v_smfmac_f32_16x16x64_bf16 v[20:23], v[28:31], a[240:247], v0
s_nop 0
v_add_f32 v12, v12, v13
v_add_f32 v14, v14, v15
v_cvt_pk_bf16_f32 v12, v12, v14
s_nop 3
v_add_f32 v20, v20, v21
v_add_f32 v22, v22, v23
v_cvt_pk_bf16_f32 v13, v20, v22
buffer_store_dwordx2 v[12:13], v9, s[8:11], s52 offen
s_waitcnt vmcnt(0)
L_lt1:
buffer_load_dwordx4 v[32:35], v1, s[8:11], s49 offen offset:0 sc1
buffer_load_dwordx4 v[36:39], v1, s[8:11], s49 offen offset:1024 sc1
buffer_load_dwordx4 v[40:43], v1, s[8:11], s49 offen offset:2048 sc1
buffer_load_dwordx4 v[44:47], v1, s[8:11], s49 offen offset:3072 sc1
s_add_u32 s19, s19, 1
s_mov_b32 s20, s28
s_mov_b32 s28, s29
s_mov_b32 s29, s20
s_and_b32 s20, s19, 3
s_lshl_b32 s20, s20, 14
s_add_u32 s33, s20, 110100480
s_add_u32 s34, s20, s24
s_xor_b32 s20, s20, 32768
s_add_u32 s35, s20, s24
s_add_u32 s30, s30, 16384
s_add_u32 s31, s31, 131072
s_add_u32 s6, s33, 4096
s_add_u32 s7, s33, 8192
s_mov_b32 s22, 0
v_mov_b64 v[24:25], 0
v_mov_b64 v[26:27], 0
v_mov_b64 v[28:29], 0
v_mov_b64 v[30:31], 0
buffer_load_dwordx4 v[32:35], v1, s[8:11], s49 offen offset:0 sc1
buffer_load_dwordx4 v[36:39], v1, s[8:11], s49 offen offset:1024 sc1
buffer_load_dwordx4 v[40:43], v1, s[8:11], s49 offen offset:2048 sc1
buffer_load_dwordx4 v[44:47], v1, s[8:11], s49 offen offset:3072 sc1
v_and_b32 v70, 0xf00, v1
v_add_u32 v70, v70, v1
v_mov_b64 v[64:65], -1
v_mov_b64 v[66:67], -1
v_xor_b32 v3, 16, v4
ds_read_b128 v[48:51], v2 offset:10240
ds_read_b128 v[52:55], v2 offset:11264
v_lshrrev_b32 v8, 2, v1
v_mov_b32 v56, 0x3f80
v_cndmask_b32 v56, v56, 1.0, s[44:45]
v_cndmask_b32 v60, 0, v56, s[36:37]
v_cndmask_b32 v61, 0, v56, s[38:39]
v_cndmask_b32 v62, 0, v56, s[40:41]
v_cndmask_b32 v63, 0, v56, s[42:43]
s_waitcnt vmcnt(7)
v_max3_u32 v16, v32, v33, v34
v_max_u32 v16, v16, v35
v_mfma_f32_16x16x32_bf16 v[56:59], v[32:35], v[60:63], 0
s_waitcnt vmcnt(6)
v_max3_u32 v16, v16, v36, v37
v_max3_u32 v16, v16, v38, v39
v_mfma_f32_16x16x32_bf16 v[56:59], v[36:39], v[60:63], v[56:59]
s_waitcnt vmcnt(5)
v_max3_u32 v16, v16, v40, v41
v_max3_u32 v16, v16, v42, v43
v_mfma_f32_16x16x32_bf16 v[56:59], v[40:43], v[60:63], v[56:59]
s_waitcnt vmcnt(4)
v_max3_u32 v16, v16, v44, v45
v_max3_u32 v16, v16, v46, v47
v_mfma_f32_16x16x32_bf16 v[56:59], v[44:47], v[60:63], v[56:59]
v_cmp_le_u32 vcc, 0xffff0000, v16
s_cbranch_vccnz L_red1
L_redb1:
s_nop 5
v_permlane32_swap_b32 v56, v58
v_permlane32_swap_b32 v57, v59
v_pk_add_f32 v[56:57], v[56:57], v[58:59]
v_cvt_pk_bf16_f32 v56, v56, v57
buffer_store_dword v56, v11, s[8:11], s34 offen
s_add_u32 s20, s30, 1024
s_add_u32 s21, s30, 8192
s_add_u32 s49, s29, s25
s_add_u32 s50, s29, s26
s_add_u32 s51, s29, s27
s_add_u32 s52, s30, 16384
s_mov_b32 m0, 17920
s_nop 1
s_barrier
s_branch L_gat1
L_red1:
s_waitcnt vmcnt(3)
v_mfma_f32_16x16x32_bf16 v[56:59], v[32:35], v[60:63], 0
v_max3_u32 v16, v32, v33, v34
v_max_u32 v16, v16, v35
s_waitcnt vmcnt(2)
v_mfma_f32_16x16x32_bf16 v[56:59], v[36:39], v[60:63], v[56:59]
v_max3_u32 v16, v16, v36, v37
v_max3_u32 v16, v16, v38, v39
s_waitcnt vmcnt(1)
v_mfma_f32_16x16x32_bf16 v[56:59], v[40:43], v[60:63], v[56:59]
v_max3_u32 v16, v16, v40, v41
v_max3_u32 v16, v16, v42, v43
s_waitcnt vmcnt(0)
v_mfma_f32_16x16x32_bf16 v[56:59], v[44:47], v[60:63], v[56:59]
v_max3_u32 v16, v16, v44, v45
v_max3_u32 v16, v16, v46, v47
v_cmp_le_u32 vcc, 0xffff0000, v16
s_cbranch_vccz L_redb1
L_red1b:
buffer_load_dwordx4 v[32:35], v1, s[8:11], s49 offen offset:0 sc1
buffer_load_dwordx4 v[36:39], v1, s[8:11], s49 offen offset:1024 sc1
buffer_load_dwordx4 v[40:43], v1, s[8:11], s49 offen offset:2048 sc1
buffer_load_dwordx4 v[44:47], v1, s[8:11], s49 offen offset:3072 sc1
s_add_u32 s22, s22, 1
s_cmp_gt_u32 s22, 40000
s_cbranch_scc1 L_end
s_waitcnt vmcnt(3)
v_mfma_f32_16x16x32_bf16 v[56:59], v[32:35], v[60:63], 0
v_max3_u32 v16, v32, v33, v34
v_max_u32 v16, v16, v35
s_waitcnt vmcnt(2)
v_mfma_f32_16x16x32_bf16 v[56:59], v[36:39], v[60:63], v[56:59]
v_max3_u32 v16, v16, v36, v37
v_max3_u32 v16, v16, v38, v39
s_waitcnt vmcnt(1)
v_mfma_f32_16x16x32_bf16 v[56:59], v[40:43], v[60:63], v[56:59]
v_max3_u32 v16, v16, v40, v41
v_max3_u32 v16, v16, v42, v43
s_waitcnt vmcnt(0)
v_mfma_f32_16x16x32_bf16 v[56:59], v[44:47], v[60:63], v[56:59]
v_max3_u32 v16, v16, v44, v45
v_max3_u32 v16, v16, v46, v47
v_cmp_le_u32 vcc, 0xffff0000, v16
s_cbranch_vccz L_redb1
s_branch L_red1b
L_g3r1:
buffer_load_dwordx4 v[16:19], v1, s[8:11], s6 offen sc1
s_add_u32 s22, s22, 1
s_waitcnt vmcnt(1)
v_max3_u32 v21, v16, v17, v18
v_max_u32 v21, v21, v19
v_cmp_le_u32 vcc, 0xffff0000, v21
s_cmp_gt_u32 s22, 40000
s_cbranch_vccz L_g31
s_cbranch_scc0 L_g3r1
s_branch L_end
L_ent2:
v_mov_b64 v[24:25], 0
v_mov_b64 v[26:27], 0
v_mov_b64 v[28:29], 0
v_mov_b64 v[30:31], 0
v_and_b32 v69, 0x380, v1
v_add_u32 v69, v69, v1
v_and_b32 v70, 0xf00, v1
v_add_u32 v70, v70, v1
v_mov_b64 v[64:65], -1
v_mov_b64 v[66:67], -1
v_xor_b32 v3, 16, v4
ds_read_b128 v[48:51], v2 offset:12288
ds_read_b128 v[52:55], v2 offset:13312
ds_read_b128 v[40:43], v2 offset:4096
ds_read_b128 v[44:47], v2 offset:5120
v_mov_b64 v[32:33], 0
v_mov_b64 v[34:35], 0
v_mov_b64 v[36:37], 0
v_mov_b64 v[38:39], 0
v_mov_b64 v[56:57], 0
v_mov_b64 v[58:59], 0
v_mov_b64 v[60:61], 0
v_mov_b64 v[62:63], 0
s_add_u32 s20, s30, 2048
s_add_u32 s21, s30, 8192
s_add_u32 s49, s29, s25
s_add_u32 s50, s29, s26
s_add_u32 s51, s29, s27
s_add_u32 s52, s30, 16384
s_mov_b32 m0, 19968
s_nop 0
buffer_load_dwordx4 v69, s[8:11], s20 offen sc1 lds
s_mov_b32 m0, 20864
s_nop 0
buffer_load_dwordx4 v69, s[8:11], s20 offen offset:128 sc1 lds
s_waitcnt vmcnt(0) lgkmcnt(0)
s_branch L_step2
L_gr2:
buffer_load_dwordx4 v[12:15], v1, s[8:11], s33 offen sc1
buffer_load_dword v20, v8, s[8:11], s7 offen sc1
buffer_load_dwordx4 v[16:19], v1, s[8:11], s6 offen sc1
s_add_u32 s22, s22, 1
s_cmp_gt_u32 s22, 40000
s_cbranch_scc1 L_end
buffer_load_dwordx4 v[16:19], v1, s[8:11], s6 offen sc1
v_mov_b64 v[24:25], 0
v_mov_b64 v[26:27], 0
v_mov_b64 v[28:29], 0
v_mov_b64 v[30:31], 0
v_mov_b64 v[32:33], 0
v_mov_b64 v[34:35], 0
v_mov_b64 v[36:37], 0
v_mov_b64 v[38:39], 0
v_mov_b64 v[56:57], 0
v_mov_b64 v[58:59], 0
v_mov_b64 v[60:61], 0
v_mov_b64 v[62:63], 0
s_waitcnt lgkmcnt(0)
s_branch L_step2
.p2align 3
L_gat2:
buffer_load_dwordx4 v[12:15], v1, s[8:11], s33 offen sc1
buffer_load_dword v20, v8, s[8:11], s7 offen sc1
buffer_load_dwordx4 v[16:19], v1, s[8:11], s6 offen sc1
s_add_u32 s20, s30, 2048
s_add_u32 s21, s30, 8192
s_add_u32 s49, s29, s25
s_add_u32 s50, s29, s26
s_add_u32 s51, s29, s27
s_add_u32 s52, s30, 16384
s_mov_b32 m0, 19968
ds_read_b128 v[40:43], v2 offset:4096
ds_read_b128 v[44:47], v2 offset:5120
v_mov_b64 v[32:33], 0
v_mov_b64 v[34:35], 0
v_mov_b64 v[36:37], 0
v_mov_b64 v[38:39], 0
v_mov_b64 v[56:57], 0
v_mov_b64 v[58:59], 0
v_mov_b64 v[60:61], 0
v_mov_b64 v[62:63], 0
s_nop 6
buffer_load_dwordx4 v[16:19], v1, s[8:11], s6 offen sc1
s_waitcnt lgkmcnt(0)
L_step2:
s_waitcnt vmcnt(3)
v_smfmac_f32_16x16x64_bf16 v[24:27], v[12:15], v[120:127], v0
ds_write_b128 v1, v[12:15] offset:6656
v_smfmac_f32_16x16x64_bf16 v[28:31], v[12:15], v[128:135], v0
s_waitcnt vmcnt(2)
v_max3_u32 v21, v12, v13, v14
v_max3_u32 v21, v21, v15, v20
v_cmp_le_u32 vcc, 0xffff0000, v21
v_smfmac_f32_16x16x64_bf16 v[32:35], v[12:15], v[136:143], v0
s_cbranch_vccnz L_gr2
s_waitcnt vmcnt(1)
v_max3_u32 v21, v16, v17, v18
v_max_u32 v21, v21, v19
v_cmp_le_u32 vcc, 0xffff0000, v21
ds_write_b32 v8, v20 offset:14848
v_smfmac_f32_16x16x64_bf16 v[56:59], v[12:15], a[64:71], v0
s_cbranch_vccnz L_g3r2
L_g32:
ds_write_b128 v1, v[16:19] offset:10752
v_smfmac_f32_16x16x64_bf16 v[60:63], v[12:15], a[72:79], v0
v_smfmac_f32_16x16x64_bf16 v[36:39], v[12:15], v[40:47], v0
v_smfmac_f32_16x16x64_bf16 v[24:27], v[16:19], v[216:223], v0
v_smfmac_f32_16x16x64_bf16 v[28:31], v[16:19], v[224:231], v0
s_waitcnt lgkmcnt(0)
s_barrier
ds_read_b128 v[20:23], v1 offset:4608
v_smfmac_f32_16x16x64_bf16 v[32:35], v[16:19], v[232:239], v0
ds_read_b128 v[12:15], v1 offset:5632
s_mov_b32 m0, 6272
buffer_store_dword v0, v11, s[8:11], s35 offen
v_smfmac_f32_16x16x64_bf16 v[56:59], v[16:19], a[128:135], v0
ds_read_b128 v[40:43], v2 offset:0
v_smfmac_f32_16x16x64_bf16 v[60:63], v[16:19], a[136:143], v0
ds_read_b128 v[44:47], v2 offset:1024
buffer_store_dwordx4 v[64:67], v1, s[8:11], s49 offen
v_smfmac_f32_16x16x64_bf16 v[36:39], v[16:19], v[48:55], v0
s_waitcnt vmcnt(2)
ds_read_b128 v[16:19], v1 offset:7680
s_waitcnt lgkmcnt(4)
v_smfmac_f32_16x16x64_bf16 v[24:27], v[20:23], v[72:79], v0
ds_read_b128 v[48:51], v2 offset:2048
buffer_store_dwordx4 v[64:67], v1, s[8:11], s50 offen
v_smfmac_f32_16x16x64_bf16 v[28:31], v[20:23], v[80:87], v0
ds_read_b128 v[52:55], v2 offset:3072
v_smfmac_f32_16x16x64_bf16 v[32:35], v[20:23], v[88:95], v0
s_waitcnt lgkmcnt(3)
buffer_store_dwordx4 v[64:67], v1, s[8:11], s51 offen
v_smfmac_f32_16x16x64_bf16 v[36:39], v[20:23], v[40:47], v0
ds_read_b128 v[20:23], v1 offset:8704
buffer_load_dwordx4 v[64:67], v70, s[8:11], s21 offen sc1
v_smfmac_f32_16x16x64_bf16 v[24:27], v[12:15], v[96:103], v0
ds_read_b128 v[40:43], v2 offset:6144
v_smfmac_f32_16x16x64_bf16 v[28:31], v[12:15], v[104:111], v0
ds_read_b128 v[44:47], v2 offset:7168
buffer_load_dwordx4 v[68:71], v70, s[8:11], s21 offen offset:256 sc1
v_smfmac_f32_16x16x64_bf16 v[32:35], v[12:15], v[112:119], v0
s_waitcnt lgkmcnt(3)
v_smfmac_f32_16x16x64_bf16 v[36:39], v[12:15], v[48:55], v0
ds_read_b128 v[12:15], v1 offset:9728
v_smfmac_f32_16x16x64_bf16 v[24:27], v[16:19], v[144:151], v0
ds_read_b128 v[48:51], v2 offset:8192
v_smfmac_f32_16x16x64_bf16 v[28:31], v[16:19], v[152:159], v0
ds_read_b128 v[52:55], v2 offset:9216
v_smfmac_f32_16x16x64_bf16 v[32:35], v[16:19], v[160:167], v0
s_waitcnt lgkmcnt(3)
v_smfmac_f32_16x16x64_bf16 v[36:39], v[16:19], v[40:47], v0
ds_read_b128 v[16:19], v1 offset:11776
v_smfmac_f32_16x16x64_bf16 v[24:27], v[20:23], v[168:175], v0
ds_read_b128 v[40:43], v2 offset:10240
v_smfmac_f32_16x16x64_bf16 v[28:31], v[20:23], v[176:183], v0
ds_read_b128 v[44:47], v2 offset:11264
v_smfmac_f32_16x16x64_bf16 v[32:35], v[20:23], v[184:191], v0
s_waitcnt lgkmcnt(3)
v_smfmac_f32_16x16x64_bf16 v[36:39], v[20:23], v[48:55], v0
ds_read_b128 v[20:23], v1 offset:12800
v_smfmac_f32_16x16x64_bf16 v[24:27], v[12:15], v[192:199], v0
ds_read_b128 v[48:51], v2 offset:14336
v_smfmac_f32_16x16x64_bf16 v[28:31], v[12:15], v[200:207], v0
ds_read_b128 v[52:55], v2 offset:15360
v_smfmac_f32_16x16x64_bf16 v[32:35], v[12:15], v[208:215], v0
s_waitcnt lgkmcnt(3)
v_smfmac_f32_16x16x64_bf16 v[36:39], v[12:15], v[40:47], v0
ds_read_b128 v[12:15], v1 offset:4608
v_smfmac_f32_16x16x64_bf16 v[24:27], v[16:19], v[240:247], v0
ds_read_b128 v[40:43], v2 offset:16384
v_smfmac_f32_16x16x64_bf16 v[28:31], v[16:19], v[248:255], v0
s_waitcnt lgkmcnt(4)
ds_read_b128 v[44:47], v2 offset:17408
v_smfmac_f32_16x16x64_bf16 v[24:27], v[20:23], a[8:15], v0
v_smfmac_f32_16x16x64_bf16 v[28:31], v[20:23], a[16:23], v0
v_smfmac_f32_16x16x64_bf16 v[32:35], v[16:19], a[0:7], v0
s_waitcnt lgkmcnt(3)
v_smfmac_f32_16x16x64_bf16 v[36:39], v[16:19], v[48:55], v0
ds_read_b128 v[16:19], v1 offset:5632
s_nop 2
v_add_f32 v24, v24, v25
v_smfmac_f32_16x16x64_bf16 v[32:35], v[20:23], a[24:31], v0
s_waitcnt lgkmcnt(1)
ds_read_b128 v[48:51], v1 offset:17920
v_add_f32 v26, v26, v27
v_smfmac_f32_16x16x64_bf16 v[36:39], v[20:23], v[40:47], v0
ds_read_b128 v[52:55], v1 offset:19968
v_add_f32 v28, v28, v29
v_smfmac_f32_16x16x64_bf16 v[56:59], v[12:15], a[32:39], v0
ds_read_b128 v[20:23], v1 offset:7680
v_add_f32 v30, v30, v31
v_cvt_pk_bf16_f32 v24, v24, v28
ds_write_b32 v4, v24 offset:2176
v_smfmac_f32_16x16x64_bf16 v[60:63], v[12:15], a[40:47], v0
s_waitcnt lgkmcnt(4)
ds_read_b128 v[12:15], v1 offset:8704
v_cvt_pk_bf16_f32 v26, v26, v30
ds_write_b32 v3, v26 offset:2176
v_add_f32 v32, v32, v33
v_smfmac_f32_16x16x64_bf16 v[56:59], v[16:19], a[48:55], v0
ds_read_b128 v[40:43], v1 offset:13824
v_add_f32 v34, v34, v35
v_add_f32 v36, v36, v37
v_add_f32 v38, v38, v39
v_smfmac_f32_16x16x64_bf16 v[60:63], v[16:19], a[56:63], v0
s_waitcnt lgkmcnt(4)
ds_read_b128 v[16:19], v1 offset:9728
v_cvt_pk_bf16_f32 v32, v32, v36
ds_write_b32 v4, v32 offset:0
v_cvt_pk_bf16_f32 v34, v34, v38
v_smfmac_f32_16x16x64_bf16 v[56:59], v[20:23], a[80:87], v0
ds_read_b128 v[44:47], v1 offset:15872
ds_write_b32 v3, v34 offset:0
v_smfmac_f32_16x16x64_bf16 v[60:63], v[20:23], a[88:95], v0
s_waitcnt lgkmcnt(6)
ds_read_b128 v[20:23], v1 offset:11776
v_smfmac_f32_16x16x64_bf16 v[56:59], v[12:15], a[96:103], v0
v_smfmac_f32_16x16x64_bf16 v[60:63], v[12:15], a[104:111], v0
s_waitcnt lgkmcnt(4)
ds_read_b128 v[12:15], v1 offset:12800
v_smfmac_f32_16x16x64_bf16 v[56:59], v[16:19], a[112:119], v0
v_smfmac_f32_16x16x64_bf16 v[60:63], v[16:19], a[120:127], v0
s_waitcnt lgkmcnt(1)
v_smfmac_f32_16x16x64_bf16 v[56:59], v[20:23], a[144:151], v0
s_barrier
ds_read_b128 v[32:35], v5 offset:1024
v_smfmac_f32_16x16x64_bf16 v[60:63], v[20:23], a[152:159], v0
s_waitcnt lgkmcnt(1)
ds_read_b128 v[36:39], v5 offset:1536
v_smfmac_f32_16x16x64_bf16 v[56:59], v[12:15], a[160:167], v0
ds_read_b128 v[24:27], v5 offset:0
v_smfmac_f32_16x16x64_bf16 v[60:63], v[12:15], a[168:175], v0
s_waitcnt lgkmcnt(2)
ds_read_b128 v[28:31], v5 offset:512
v_mfma_f32_16x16x32_bf16 v[16:19], v[48:51], v[32:35], 0
s_waitcnt lgkmcnt(2)
ds_read_b128 v[48:51], v1 offset:18944
v_mfma_f32_16x16x32_bf16 v[16:19], v[52:55], v[36:39], v[16:19]
s_waitcnt lgkmcnt(2)
ds_read_b128 v[52:55], v1 offset:20992
v_mfma_f32_16x16x32_bf16 v[16:19], v[40:43], v[24:27], v[16:19]
ds_read_b128 v[40:43], v1 offset:14848
s_mov_b64 exec, s[86:87]
buffer_store_dwordx4 v[32:35], v5, s[8:11], s31 offen offset:1024 sc1
s_mov_b64 exec, -1
s_waitcnt lgkmcnt(3)
v_mfma_f32_16x16x32_bf16 v[16:19], v[44:47], v[28:31], v[16:19]
ds_read_b128 v[44:47], v1 offset:16896
v_mfma_f32_16x16x32_bf16 v[20:23], v[32:35], v[32:35], 0
v_add_f32 v56, v56, v57
v_add_f32 v58, v58, v59
v_mfma_f32_16x16x32_bf16 v[20:23], v[36:39], v[36:39], v[20:23]
v_add_f32 v60, v60, v61
v_add_f32 v62, v62, v63
v_mfma_f32_16x16x32_bf16 v[20:23], v[24:27], v[24:27], v[20:23]
v_cvt_pk_bf16_f32 v56, v56, v58
v_cvt_pk_bf16_f32 v57, v60, v62
v_mfma_f32_16x16x32_bf16 v[20:23], v[28:31], v[28:31], v[20:23]
s_waitcnt lgkmcnt(3)
v_lshrrev_b32 v58, 1, v1
v_max3_f32 v59, v16, v17, v18
v_mfma_f32_16x16x32_bf16 v[12:15], v[48:51], v[32:35], 0
s_waitcnt lgkmcnt(2)
ds_read_b128 v[48:51], v2 offset:20480
v_mfma_f32_16x16x32_bf16 v[12:15], v[52:55], v[36:39], v[12:15]
s_waitcnt lgkmcnt(2)
ds_read_b128 v[52:55], v2 offset:21504
v_mfma_f32_16x16x32_bf16 v[12:15], v[40:43], v[24:27], v[12:15]
s_waitcnt lgkmcnt(2)
ds_read_b128 v[40:43], v2 offset:18432
buffer_store_dwordx2 v[56:57], v58, s[8:11], s31 offen offset:2048 sc1
v_mfma_f32_16x16x32_bf16 v[12:15], v[44:47], v[28:31], v[12:15]
ds_read_b128 v[44:47], v2 offset:19456
v_max3_f32 v59, v59, v19, v20
v_max_f32 v59, v59, v21
v_mov_b32 v60, s53
s_add_u32 s49, s28, s23
v_mov_b32 v61, s53
s_add_u32 s50, s28, 65536
v_mov_b32 v62, s53
ds_read_b128 v[32:35], v2 offset:22528
v_mov_b32 v63, s53
v_max3_f32 v59, v59, v12, v13
v_max3_f32 v22, v59, v14, v15
v_max3_f32 v59, v59, v14, v15
s_add_u32 s51, s28, 131072
s_add_u32 s52, s28, 196608
v_permlane32_swap_b32 v22, v59
v_max_f32 v23, v59, v22
v_max_f32 v59, v59, v22
v_mov_b32 v22, 0
ds_read_b128 v[36:39], v2 offset:23552
v_permlane16_swap_b32 v23, v59
v_max_f32 v59, v59, v23
v_mul_f32 v58, s18, v59
v_pk_fma_f32 v[20:21], v[20:21], s[18:19], v[58:59] op_sel_hi:[1,0,0] neg_lo:[0,0,1] neg_hi:[0,0,1]
v_pk_fma_f32 v[16:17], v[16:17], s[18:19], v[58:59] op_sel_hi:[1,0,0] neg_lo:[0,0,1] neg_hi:[0,0,1]
v_pk_fma_f32 v[18:19], v[18:19], s[18:19], v[58:59] op_sel_hi:[1,0,0] neg_lo:[0,0,1] neg_hi:[0,0,1]
v_pk_fma_f32 v[12:13], v[12:13], s[18:19], v[58:59] op_sel_hi:[1,0,0] neg_lo:[0,0,1] neg_hi:[0,0,1]
v_pk_fma_f32 v[14:15], v[14:15], s[18:19], v[58:59] op_sel_hi:[1,0,0] neg_lo:[0,0,1] neg_hi:[0,0,1]
v_exp_f32 v20, v20
v_exp_f32 v21, v21
v_exp_f32 v16, v16
v_cvt_pk_bf16_f32 v23, v20, v21
v_cvt_pk_bf16_f32 v20, v20, v21
v_mov_b32 v21, 0
v_exp_f32 v17, v17
v_exp_f32 v18, v18
v_mfma_f32_16x16x16_bf16 v[24:27], v[56:57], v[20:21], 0
v_exp_f32 v19, v19
v_mfma_f32_16x16x16_bf16 v[28:31], v[56:57], v[22:23], 0
v_exp_f32 v12, v12
v_exp_f32 v13, v13
v_cvt_pk_bf16_f32 v16, v16, v17
v_cvt_pk_bf16_f32 v17, v18, v19
v_exp_f32 v14, v14
v_exp_f32 v15, v15
v_cvt_pk_bf16_f32 v18, v12, v13
v_cvt_pk_bf16_f32 v19, v14, v15
v_mfma_f32_16x16x16_bf16 v[12:15], v[60:61], v[20:21], 0
s_waitcnt vmcnt(2)
v_mfma_f32_16x16x32_bf16 v[12:15], v[60:63], v[16:19], v[12:15]
v_mov_b32 v20, 0
v_mov_b32 v23, 0
v_mfma_f32_16x16x32_bf16 v[24:27], v[64:67], v[16:19], v[24:27]
s_nop 1
v_mfma_f32_16x16x32_bf16 v[28:31], v[68:71], v[16:19], v[28:31]
v_mov_b32 v16, 0
v_mov_b32 v17, 0
v_rcp_f32 v12, v12
v_mov_b32 v18, 0
v_mov_b32 v19, 0
v_pk_mul_f32 v[24:25], v[24:25], v[12:13] op_sel_hi:[1,0]
v_pk_mul_f32 v[26:27], v[26:27], v[12:13] op_sel_hi:[1,0]
v_mov_b32 v15, 0
v_pk_mul_f32 v[28:29], v[28:29], v[12:13] op_sel_hi:[1,0]
v_pk_mul_f32 v[30:31], v[30:31], v[12:13] op_sel_hi:[1,0]
v_cvt_pk_bf16_f32 v24, v24, v28
v_cvt_pk_bf16_f32 v25, v25, v29
v_cvt_pk_bf16_f32 v26, v26, v30
v_cvt_pk_bf16_f32 v27, v27, v31
v_mfma_f32_16x16x32_bf16 v[56:59], v[20:23], v[20:23], 0
ds_write_b128 v7, v[24:27]
v_mfma_f32_16x16x32_bf16 v[60:63], v[20:23], v[20:23], 0
v_mov_b32 v12, 0
v_mov_b32 v13, 0
v_mov_b32 v14, 0
v_mov_b32 v3, 6528
v_and_b32 v8, 0x380, v1
v_add_u32 v8, v8, v1
v_mfma_f32_16x16x32_bf16 v[64:67], v[20:23], v[20:23], 0
s_add_u32 s20, s30, 18432
s_mov_b32 m0, 19968
s_cmp_eq_u32 s19, 63
s_cbranch_scc1 L_texit
s_waitcnt lgkmcnt(0)
s_barrier
ds_read_b128 v[24:27], v1 offset:2176
v_mfma_f32_16x16x32_bf16 v[68:71], v[20:23], v[20:23], 0
ds_read_b128 v[28:31], v1 offset:3200
s_nop 2
v_mfma_f32_16x16x32_bf16 v[68:71], v[20:23], v[20:23], 0
s_waitcnt lgkmcnt(1)
v_smfmac_f32_16x16x64_bf16 v[12:15], v[24:27], a[248:255], v0
buffer_load_dwordx4 v8, s[8:11], s20 offen sc1 lds
v_smfmac_f32_16x16x64_bf16 v[16:19], v[24:27], a[176:183], v0
s_mov_b32 m0, 20864
s_waitcnt lgkmcnt(0)
v_smfmac_f32_16x16x64_bf16 v[12:15], v[28:31], v[40:47], v0
ds_read_b128 v[40:43], v2 offset:24576
v_smfmac_f32_16x16x64_bf16 v[16:19], v[28:31], v[48:55], v0
ds_read_b128 v[44:47], v2 offset:25600
buffer_load_dwordx4 v8, s[8:11], s20 offen offset:128 sc1 lds
v_smfmac_f32_16x16x64_bf16 v[20:23], v[24:27], a[184:191], v0
ds_read_b128 v[48:51], v2 offset:26624
s_nop 1
v_add_f32 v12, v12, v13
v_add_f32 v14, v14, v15
v_cvt_pk_bf16_f32 v12, v12, v14
v_smfmac_f32_16x16x64_bf16 v[20:23], v[28:31], v[32:39], v0
ds_read_b128 v[52:55], v2 offset:27648
buffer_store_dword v12, v10, s[8:11], s28 offen
v_add_f32 v16, v16, v17
v_add_f32 v18, v18, v19
v_smfmac_f32_16x16x64_bf16 v[56:59], v[24:27], a[192:199], v0
s_waitcnt lgkmcnt(2)
ds_read_b128 v[32:35], v2 offset:28672
v_cvt_pk_bf16_f32 v16, v16, v18
v_smfmac_f32_16x16x64_bf16 v[56:59], v[28:31], v[40:47], v0
ds_read_b128 v[36:39], v2 offset:29696
v_add_f32 v20, v20, v21
v_add_f32 v22, v22, v23
v_cvt_pk_bf16_f32 v17, v20, v22
v_smfmac_f32_16x16x64_bf16 v[60:63], v[24:27], a[200:207], v0
s_waitcnt lgkmcnt(2)
ds_read_b128 v[12:15], v3
buffer_store_dwordx2 v[16:17], v9, s[8:11], s28 offen
v_smfmac_f32_16x16x64_bf16 v[60:63], v[28:31], v[48:55], v0
ds_read_b128 v[40:43], v2 offset:30720
v_add_f32 v56, v56, v57
v_add_f32 v58, v58, v59
v_cvt_pk_bf16_f32 v56, v56, v58
v_smfmac_f32_16x16x64_bf16 v[64:67], v[24:27], a[208:215], v0
s_waitcnt lgkmcnt(2)
ds_read_b128 v[44:47], v2 offset:31744
v_smfmac_f32_16x16x64_bf16 v[64:67], v[28:31], v[32:39], v0
ds_read_b128 v[20:23], v3
v_add_f32 v60, v60, v61
v_add_f32 v62, v62, v63
v_cvt_pk_bf16_f32 v57, v60, v62
v_smfmac_f32_16x16x64_bf16 v[68:71], v[24:27], a[216:223], v0
s_waitcnt lgkmcnt(1)
ds_read_b128 v[48:51], v2 offset:32768
buffer_store_dwordx2 v[56:57], v9, s[8:11], s50 offen
v_smfmac_f32_16x16x64_bf16 v[68:71], v[28:31], v[40:47], v0
ds_read_b128 v[52:55], v2 offset:33792
v_add_f32 v64, v64, v65
v_add_f32 v66, v66, v67
v_cvt_pk_bf16_f32 v64, v64, v66
v_smfmac_f32_16x16x64_bf16 v[12:15], v[24:27], a[224:231], v0
s_waitcnt lgkmcnt(0)
v_smfmac_f32_16x16x64_bf16 v[12:15], v[28:31], v[48:55], v0
s_nop 0
v_add_f32 v68, v68, v69
v_add_f32 v70, v70, v71
v_cvt_pk_bf16_f32 v65, v68, v70
v_smfmac_f32_16x16x64_bf16 v[20:23], v[24:27], a[232:239], v0
buffer_store_dwordx2 v[64:65], v9, s[8:11], s51 offen
v_smfmac_f32_16x16x64_bf16 v[20:23], v[28:31], a[240:247], v0
s_nop 0
v_add_f32 v12, v12, v13
v_add_f32 v14, v14, v15
v_cvt_pk_bf16_f32 v12, v12, v14
s_nop 3
v_add_f32 v20, v20, v21
v_add_f32 v22, v22, v23
v_cvt_pk_bf16_f32 v13, v20, v22
buffer_store_dwordx2 v[12:13], v9, s[8:11], s52 offen
s_cmp_eq_u32 s48, 0
s_cbranch_scc1 L_nojob2
L_lt2:
buffer_load_dwordx4 v[32:35], v1, s[8:11], s49 offen offset:0 sc1
buffer_load_dwordx4 v[36:39], v1, s[8:11], s49 offen offset:1024 sc1
buffer_load_dwordx4 v[40:43], v1, s[8:11], s49 offen offset:2048 sc1
buffer_load_dwordx4 v[44:47], v1, s[8:11], s49 offen offset:3072 sc1
s_add_u32 s19, s19, 1
s_mov_b32 s20, s28
s_mov_b32 s28, s29
s_mov_b32 s29, s20
s_and_b32 s20, s19, 3
s_lshl_b32 s20, s20, 14
s_add_u32 s33, s20, 110100480
s_add_u32 s34, s20, s24
s_xor_b32 s20, s20, 32768
s_add_u32 s35, s20, s24
s_add_u32 s30, s30, 16384
s_add_u32 s31, s31, 131072
s_add_u32 s6, s33, 4096
s_add_u32 s7, s33, 8192
s_mov_b32 s22, 0
v_mov_b64 v[24:25], 0
v_mov_b64 v[26:27], 0
v_mov_b64 v[28:29], 0
v_mov_b64 v[30:31], 0
v_and_b32 v70, 0xf00, v1
v_add_u32 v70, v70, v1
v_mov_b64 v[64:65], -1
v_mov_b64 v[66:67], -1
v_xor_b32 v3, 16, v4
ds_read_b128 v[48:51], v2 offset:12288
ds_read_b128 v[52:55], v2 offset:13312
v_lshrrev_b32 v8, 2, v1
v_mov_b32 v56, 0x3f80
v_cndmask_b32 v56, v56, 1.0, s[44:45]
v_cndmask_b32 v60, 0, v56, s[36:37]
v_cndmask_b32 v61, 0, v56, s[38:39]
v_cndmask_b32 v62, 0, v56, s[40:41]
v_cndmask_b32 v63, 0, v56, s[42:43]
s_waitcnt vmcnt(3)
s_nop 0
v_mfma_f32_16x16x32_bf16 v[56:59], v[32:35], v[60:63], 0
v_max3_u32 v16, v32, v33, v34
v_max_u32 v16, v16, v35
s_waitcnt vmcnt(2)
v_mfma_f32_16x16x32_bf16 v[56:59], v[36:39], v[60:63], v[56:59]
v_max3_u32 v16, v16, v36, v37
v_max3_u32 v16, v16, v38, v39
s_waitcnt vmcnt(1)
v_mfma_f32_16x16x32_bf16 v[56:59], v[40:43], v[60:63], v[56:59]
v_max3_u32 v16, v16, v40, v41
v_max3_u32 v16, v16, v42, v43
s_waitcnt vmcnt(0)
v_mfma_f32_16x16x32_bf16 v[56:59], v[44:47], v[60:63], v[56:59]
v_max3_u32 v16, v16, v44, v45
v_max3_u32 v16, v16, v46, v47
v_cmp_le_u32 vcc, 0xffff0000, v16
s_cbranch_vccnz L_red2
L_redb2:
s_nop 3
v_permlane32_swap_b32 v56, v58
v_permlane32_swap_b32 v57, v59
v_pk_add_f32 v[56:57], v[56:57], v[58:59]
v_cvt_pk_bf16_f32 v56, v56, v57
buffer_store_dword v56, v11, s[8:11], s34 offen
s_add_u32 s20, s30, 2048
s_add_u32 s21, s30, 8192
s_add_u32 s49, s29, s25
s_add_u32 s50, s29, s26
s_add_u32 s51, s29, s27
s_add_u32 s52, s30, 16384
s_mov_b32 m0, 19968
s_nop 1
s_barrier
s_branch L_gat2
L_red2:
L_red2b:
buffer_load_dwordx4 v[32:35], v1, s[8:11], s49 offen offset:0 sc1
buffer_load_dwordx4 v[36:39], v1, s[8:11], s49 offen offset:1024 sc1
buffer_load_dwordx4 v[40:43], v1, s[8:11], s49 offen offset:2048 sc1
buffer_load_dwordx4 v[44:47], v1, s[8:11], s49 offen offset:3072 sc1
s_add_u32 s22, s22, 1
s_cmp_gt_u32 s22, 40000
s_cbranch_scc1 L_end
s_waitcnt vmcnt(3)
v_mfma_f32_16x16x32_bf16 v[56:59], v[32:35], v[60:63], 0
v_max3_u32 v16, v32, v33, v34
v_max_u32 v16, v16, v35
s_waitcnt vmcnt(2)
v_mfma_f32_16x16x32_bf16 v[56:59], v[36:39], v[60:63], v[56:59]
v_max3_u32 v16, v16, v36, v37
v_max3_u32 v16, v16, v38, v39
s_waitcnt vmcnt(1)
v_mfma_f32_16x16x32_bf16 v[56:59], v[40:43], v[60:63], v[56:59]
v_max3_u32 v16, v16, v40, v41
v_max3_u32 v16, v16, v42, v43
s_waitcnt vmcnt(0)
v_mfma_f32_16x16x32_bf16 v[56:59], v[44:47], v[60:63], v[56:59]
v_max3_u32 v16, v16, v44, v45
v_max3_u32 v16, v16, v46, v47
v_cmp_le_u32 vcc, 0xffff0000, v16
s_cbranch_vccz L_redb2
s_branch L_red2b
L_g3r2:
buffer_load_dwordx4 v[16:19], v1, s[8:11], s6 offen sc1
s_add_u32 s22, s22, 1
s_waitcnt vmcnt(1)
v_max3_u32 v21, v16, v17, v18
v_max_u32 v21, v21, v19
v_cmp_le_u32 vcc, 0xffff0000, v21
s_cmp_gt_u32 s22, 40000
s_cbranch_vccz L_g32
s_cbranch_scc0 L_g3r2
s_branch L_end
L_nojob2:
s_add_u32 s19, s19, 1
s_mov_b32 s20, s28
s_mov_b32 s28, s29
s_mov_b32 s29, s20
s_and_b32 s20, s19, 3
s_lshl_b32 s20, s20, 14
s_add_u32 s33, s20, 110100480
s_add_u32 s34, s20, s24
s_xor_b32 s20, s20, 32768
s_add_u32 s35, s20, s24
s_add_u32 s30, s30, 16384
s_add_u32 s31, s31, 131072
s_add_u32 s6, s33, 4096
s_add_u32 s7, s33, 8192
s_mov_b32 s22, 0
v_mov_b64 v[24:25], 0
v_mov_b64 v[26:27], 0
v_mov_b64 v[28:29], 0
v_mov_b64 v[30:31], 0
v_and_b32 v70, 0xf00, v1
v_add_u32 v70, v70, v1
v_mov_b64 v[64:65], -1
v_mov_b64 v[66:67], -1
v_xor_b32 v3, 16, v4
ds_read_b128 v[48:51], v2 offset:12288
ds_read_b128 v[52:55], v2 offset:13312
v_lshrrev_b32 v8, 2, v1
s_barrier
s_branch L_gat2
L_ent3:
v_mov_b64 v[24:25], 0
v_mov_b64 v[26:27], 0
v_mov_b64 v[28:29], 0
v_mov_b64 v[30:31], 0
v_and_b32 v69, 0x380, v1
v_add_u32 v69, v69, v1
v_and_b32 v70, 0xf00, v1
v_add_u32 v70, v70, v1
v_mov_b64 v[64:65], -1
v_mov_b64 v[66:67], -1
v_xor_b32 v3, 16, v4
ds_read_b128 v[48:51], v2 offset:14336
ds_read_b128 v[52:55], v2 offset:15360
ds_read_b128 v[40:43], v2 offset:6144
ds_read_b128 v[44:47], v2 offset:7168
v_mov_b64 v[32:33], 0
v_mov_b64 v[34:35], 0
v_mov_b64 v[36:37], 0
v_mov_b64 v[38:39], 0
v_mov_b64 v[56:57], 0
v_mov_b64 v[58:59], 0
v_mov_b64 v[60:61], 0
v_mov_b64 v[62:63], 0
s_add_u32 s20, s30, 3072
s_add_u32 s21, s30, 8192
s_add_u32 s49, s29, s25
s_add_u32 s50, s29, s26
s_add_u32 s51, s29, s27
s_add_u32 s52, s30, 16384
s_mov_b32 m0, 22016
s_nop 0
buffer_load_dwordx4 v69, s[8:11], s20 offen sc1 lds
s_mov_b32 m0, 22912
s_nop 0
buffer_load_dwordx4 v69, s[8:11], s20 offen offset:128 sc1 lds
s_waitcnt vmcnt(0) lgkmcnt(0)
s_branch L_step3
L_gr3:
buffer_load_dwordx4 v[12:15], v1, s[8:11], s33 offen sc1
buffer_load_dword v20, v8, s[8:11], s7 offen sc1
buffer_load_dwordx4 v[16:19], v1, s[8:11], s6 offen sc1
s_add_u32 s22, s22, 1
s_cmp_gt_u32 s22, 40000
s_cbranch_scc1 L_end
buffer_load_dwordx4 v[16:19], v1, s[8:11], s6 offen sc1
v_mov_b64 v[24:25], 0
v_mov_b64 v[26:27], 0
v_mov_b64 v[28:29], 0
v_mov_b64 v[30:31], 0
v_mov_b64 v[32:33], 0
v_mov_b64 v[34:35], 0
v_mov_b64 v[36:37], 0
v_mov_b64 v[38:39], 0
v_mov_b64 v[56:57], 0
v_mov_b64 v[58:59], 0
v_mov_b64 v[60:61], 0
v_mov_b64 v[62:63], 0
s_waitcnt lgkmcnt(0)
s_branch L_step3
.p2align 3
L_gat3:
buffer_load_dwordx4 v[12:15], v1, s[8:11], s33 offen sc1
buffer_load_dword v20, v8, s[8:11], s7 offen sc1
buffer_load_dwordx4 v[16:19], v1, s[8:11], s6 offen sc1
s_add_u32 s20, s30, 3072
s_add_u32 s21, s30, 8192
s_add_u32 s49, s29, s25
s_add_u32 s50, s29, s26
s_add_u32 s51, s29, s27
s_add_u32 s52, s30, 16384
s_mov_b32 m0, 22016
ds_read_b128 v[40:43], v2 offset:6144
ds_read_b128 v[44:47], v2 offset:7168
v_mov_b64 v[32:33], 0
v_mov_b64 v[34:35], 0
v_mov_b64 v[36:37], 0
v_mov_b64 v[38:39], 0
v_mov_b64 v[56:57], 0
v_mov_b64 v[58:59], 0
v_mov_b64 v[60:61], 0
v_mov_b64 v[62:63], 0
s_nop 6
buffer_load_dwordx4 v[16:19], v1, s[8:11], s6 offen sc1
s_waitcnt lgkmcnt(0)
L_step3:
s_waitcnt vmcnt(3)
v_smfmac_f32_16x16x64_bf16 v[24:27], v[12:15], v[144:151], v0
ds_write_b128 v1, v[12:15] offset:6656
v_smfmac_f32_16x16x64_bf16 v[28:31], v[12:15], v[152:159], v0
s_waitcnt vmcnt(2)
v_max3_u32 v21, v12, v13, v14
v_max3_u32 v21, v21, v15, v20
v_cmp_le_u32 vcc, 0xffff0000, v21
v_smfmac_f32_16x16x64_bf16 v[32:35], v[12:15], v[160:167], v0
s_cbranch_vccnz L_gr3
s_waitcnt vmcnt(1)
v_max3_u32 v21, v16, v17, v18
v_max_u32 v21, v21, v19
v_cmp_le_u32 vcc, 0xffff0000, v21
ds_write_b32 v8, v20 offset:14848
v_smfmac_f32_16x16x64_bf16 v[56:59], v[12:15], a[80:87], v0
s_cbranch_vccnz L_g3r3
L_g33:
ds_write_b128 v1, v[16:19] offset:10752
v_smfmac_f32_16x16x64_bf16 v[60:63], v[12:15], a[88:95], v0
v_smfmac_f32_16x16x64_bf16 v[36:39], v[12:15], v[40:47], v0
v_smfmac_f32_16x16x64_bf16 v[24:27], v[16:19], v[240:247], v0
v_smfmac_f32_16x16x64_bf16 v[28:31], v[16:19], v[248:255], v0
s_waitcnt lgkmcnt(0)
s_barrier
ds_read_b128 v[20:23], v1 offset:3584
v_smfmac_f32_16x16x64_bf16 v[32:35], v[16:19], a[0:7], v0
ds_read_b128 v[12:15], v1 offset:4608
s_mov_b32 m0, 6272
v_smfmac_f32_16x16x64_bf16 v[56:59], v[16:19], a[144:151], v0
ds_read_b128 v[40:43], v2 offset:0
v_smfmac_f32_16x16x64_bf16 v[60:63], v[16:19], a[152:159], v0
ds_read_b128 v[44:47], v2 offset:1024
buffer_store_dwordx4 v[64:67], v1, s[8:11], s49 offen
v_smfmac_f32_16x16x64_bf16 v[36:39], v[16:19], v[48:55], v0
s_waitcnt vmcnt(1)
ds_read_b128 v[16:19], v1 offset:5632
s_waitcnt lgkmcnt(4)
v_smfmac_f32_16x16x64_bf16 v[24:27], v[20:23], v[72:79], v0
ds_read_b128 v[48:51], v2 offset:2048
buffer_store_dwordx4 v[64:67], v1, s[8:11], s50 offen
v_smfmac_f32_16x16x64_bf16 v[28:31], v[20:23], v[80:87], v0
ds_read_b128 v[52:55], v2 offset:3072
v_smfmac_f32_16x16x64_bf16 v[32:35], v[20:23], v[88:95], v0
s_waitcnt lgkmcnt(3)
buffer_store_dwordx4 v[64:67], v1, s[8:11], s51 offen
v_smfmac_f32_16x16x64_bf16 v[36:39], v[20:23], v[40:47], v0
ds_read_b128 v[20:23], v1 offset:7680
buffer_load_dwordx4 v[64:67], v70, s[8:11], s21 offen sc1
v_smfmac_f32_16x16x64_bf16 v[24:27], v[12:15], v[96:103], v0
ds_read_b128 v[40:43], v2 offset:4096
v_smfmac_f32_16x16x64_bf16 v[28:31], v[12:15], v[104:111], v0
ds_read_b128 v[44:47], v2 offset:5120
buffer_load_dwordx4 v[68:71], v70, s[8:11], s21 offen offset:256 sc1
v_smfmac_f32_16x16x64_bf16 v[32:35], v[12:15], v[112:119], v0
s_waitcnt lgkmcnt(3)
v_smfmac_f32_16x16x64_bf16 v[36:39], v[12:15], v[48:55], v0
ds_read_b128 v[12:15], v1 offset:8704
v_smfmac_f32_16x16x64_bf16 v[24:27], v[16:19], v[120:127], v0
ds_read_b128 v[48:51], v2 offset:8192
v_mov_b32 v11, s19
v_smfmac_f32_16x16x64_bf16 v[28:31], v[16:19], v[128:135], v0
ds_read_b128 v[52:55], v2 offset:9216
v_smfmac_f32_16x16x64_bf16 v[32:35], v[16:19], v[136:143], v0
s_mov_b64 exec, 1
buffer_store_dword v11, v8, s[8:11], s83 offen sc1
s_mov_b64 exec, -1
s_waitcnt lgkmcnt(3)
v_smfmac_f32_16x16x64_bf16 v[36:39], v[16:19], v[40:47], v0
ds_read_b128 v[16:19], v1 offset:9728
buffer_load_dword v11, v8, s[8:11], s82 offen sc1
v_smfmac_f32_16x16x64_bf16 v[24:27], v[20:23], v[168:175], v0
ds_read_b128 v[40:43], v2 offset:10240
v_smfmac_f32_16x16x64_bf16 v[28:31], v[20:23], v[176:183], v0
ds_read_b128 v[44:47], v2 offset:11264
v_smfmac_f32_16x16x64_bf16 v[32:35], v[20:23], v[184:191], v0
s_waitcnt lgkmcnt(3)
v_smfmac_f32_16x16x64_bf16 v[36:39], v[20:23], v[48:55], v0
ds_read_b128 v[20:23], v1 offset:11776
v_smfmac_f32_16x16x64_bf16 v[24:27], v[12:15], v[192:199], v0
ds_read_b128 v[48:51], v2 offset:12288
v_smfmac_f32_16x16x64_bf16 v[28:31], v[12:15], v[200:207], v0
ds_read_b128 v[52:55], v2 offset:13312
v_smfmac_f32_16x16x64_bf16 v[32:35], v[12:15], v[208:215], v0
s_waitcnt lgkmcnt(3)
v_smfmac_f32_16x16x64_bf16 v[36:39], v[12:15], v[40:47], v0
ds_read_b128 v[12:15], v1 offset:3584
v_smfmac_f32_16x16x64_bf16 v[24:27], v[16:19], v[216:223], v0
ds_read_b128 v[40:43], v2 offset:16384
v_smfmac_f32_16x16x64_bf16 v[28:31], v[16:19], v[224:231], v0
s_waitcnt lgkmcnt(4)
ds_read_b128 v[44:47], v2 offset:17408
v_smfmac_f32_16x16x64_bf16 v[24:27], v[20:23], a[8:15], v0
v_smfmac_f32_16x16x64_bf16 v[28:31], v[20:23], a[16:23], v0
v_smfmac_f32_16x16x64_bf16 v[32:35], v[16:19], v[232:239], v0
s_waitcnt lgkmcnt(3)
v_smfmac_f32_16x16x64_bf16 v[36:39], v[16:19], v[48:55], v0
ds_read_b128 v[16:19], v1 offset:4608
s_nop 2
v_add_f32 v24, v24, v25
v_smfmac_f32_16x16x64_bf16 v[32:35], v[20:23], a[24:31], v0
s_waitcnt lgkmcnt(1)
ds_read_b128 v[52:55], v1 offset:18944
v_add_f32 v26, v26, v27
v_smfmac_f32_16x16x64_bf16 v[36:39], v[20:23], v[40:47], v0
ds_read_b128 v[48:51], v1 offset:16896
v_add_f32 v28, v28, v29
v_smfmac_f32_16x16x64_bf16 v[56:59], v[12:15], a[32:39], v0
ds_read_b128 v[20:23], v1 offset:5632
v_add_f32 v30, v30, v31
v_cvt_pk_bf16_f32 v24, v24, v28
ds_write_b32 v4, v24 offset:2176
v_smfmac_f32_16x16x64_bf16 v[60:63], v[12:15], a[40:47], v0
s_waitcnt lgkmcnt(4)
ds_read_b128 v[12:15], v1 offset:7680
v_cvt_pk_bf16_f32 v26, v26, v30
ds_write_b32 v3, v26 offset:2176
v_add_f32 v32, v32, v33
v_smfmac_f32_16x16x64_bf16 v[56:59], v[16:19], a[48:55], v0
ds_read_b128 v[40:43], v1 offset:12800
v_add_f32 v34, v34, v35
v_add_f32 v36, v36, v37
v_add_f32 v38, v38, v39
v_smfmac_f32_16x16x64_bf16 v[60:63], v[16:19], a[56:63], v0
s_waitcnt lgkmcnt(4)
ds_read_b128 v[16:19], v1 offset:8704
v_cvt_pk_bf16_f32 v32, v32, v36
ds_write_b32 v4, v32 offset:0
v_cvt_pk_bf16_f32 v34, v34, v38
v_smfmac_f32_16x16x64_bf16 v[56:59], v[20:23], a[64:71], v0
ds_read_b128 v[44:47], v1 offset:14848
ds_write_b32 v3, v34 offset:0
v_smfmac_f32_16x16x64_bf16 v[60:63], v[20:23], a[72:79], v0
s_waitcnt lgkmcnt(6)
ds_read_b128 v[20:23], v1 offset:9728
v_smfmac_f32_16x16x64_bf16 v[56:59], v[12:15], a[96:103], v0
v_smfmac_f32_16x16x64_bf16 v[60:63], v[12:15], a[104:111], v0
s_waitcnt lgkmcnt(4)
ds_read_b128 v[12:15], v1 offset:11776
v_smfmac_f32_16x16x64_bf16 v[56:59], v[16:19], a[112:119], v0
v_smfmac_f32_16x16x64_bf16 v[60:63], v[16:19], a[120:127], v0
s_waitcnt lgkmcnt(1)
v_smfmac_f32_16x16x64_bf16 v[56:59], v[20:23], a[128:135], v0
s_barrier
ds_read_b128 v[36:39], v5 offset:1536
v_smfmac_f32_16x16x64_bf16 v[60:63], v[20:23], a[136:143], v0
s_waitcnt lgkmcnt(1)
ds_read_b128 v[24:27], v5 offset:0
v_smfmac_f32_16x16x64_bf16 v[56:59], v[12:15], a[160:167], v0
ds_read_b128 v[28:31], v5 offset:512
v_smfmac_f32_16x16x64_bf16 v[60:63], v[12:15], a[168:175], v0
s_waitcnt lgkmcnt(2)
ds_read_b128 v[32:35], v5 offset:1024
v_mfma_f32_16x16x32_bf16 v[16:19], v[52:55], v[36:39], 0
s_waitcnt lgkmcnt(2)
ds_read_b128 v[52:55], v1 offset:19968
v_mfma_f32_16x16x32_bf16 v[16:19], v[40:43], v[24:27], v[16:19]
s_waitcnt lgkmcnt(2)
ds_read_b128 v[40:43], v1 offset:13824
v_mfma_f32_16x16x32_bf16 v[16:19], v[44:47], v[28:31], v[16:19]
s_waitcnt lgkmcnt(2)
ds_read_b128 v[44:47], v1 offset:15872
v_mfma_f32_16x16x32_bf16 v[16:19], v[48:51], v[32:35], v[16:19]
ds_read_b128 v[48:51], v1 offset:17920
s_mov_b64 exec, s[86:87]
buffer_store_dwordx4 v[36:39], v5, s[8:11], s31 offen offset:1536 sc1
s_mov_b64 exec, -1
v_mfma_f32_16x16x32_bf16 v[20:23], v[36:39], v[36:39], 0
v_add_f32 v56, v56, v57
v_add_f32 v58, v58, v59
v_mfma_f32_16x16x32_bf16 v[20:23], v[24:27], v[24:27], v[20:23]
v_add_f32 v60, v60, v61
v_add_f32 v62, v62, v63
v_mfma_f32_16x16x32_bf16 v[20:23], v[28:31], v[28:31], v[20:23]
v_cvt_pk_bf16_f32 v56, v56, v58
v_cvt_pk_bf16_f32 v57, v60, v62
v_mfma_f32_16x16x32_bf16 v[20:23], v[32:35], v[32:35], v[20:23]
s_waitcnt lgkmcnt(3)
v_lshrrev_b32 v58, 1, v1
v_max3_f32 v59, v16, v17, v18
v_mfma_f32_16x16x32_bf16 v[12:15], v[52:55], v[36:39], 0
s_waitcnt lgkmcnt(2)
ds_read_b128 v[52:55], v2 offset:21504
v_mfma_f32_16x16x32_bf16 v[12:15], v[40:43], v[24:27], v[12:15]
s_waitcnt lgkmcnt(2)
ds_read_b128 v[40:43], v2 offset:18432
v_mfma_f32_16x16x32_bf16 v[12:15], v[44:47], v[28:31], v[12:15]
s_waitcnt lgkmcnt(2)
ds_read_b128 v[44:47], v2 offset:19456
v_max3_f32 v59, v59, v19, v20
v_max_f32 v59, v59, v21
v_mfma_f32_16x16x32_bf16 v[12:15], v[48:51], v[32:35], v[12:15]
ds_read_b128 v[48:51], v2 offset:20480
buffer_store_dwordx2 v[56:57], v58, s[8:11], s31 offen offset:2048 sc1
v_mov_b32 v60, s53
s_add_u32 s49, s28, s23
v_mov_b32 v61, s53
s_add_u32 s50, s28, 65536
v_mov_b32 v62, s53
ds_read_b128 v[32:35], v2 offset:22528
v_mov_b32 v63, s53
v_max3_f32 v59, v59, v12, v13
v_max3_f32 v22, v59, v14, v15
v_max3_f32 v59, v59, v14, v15
s_add_u32 s51, s28, 131072
s_add_u32 s52, s28, 196608
v_permlane32_swap_b32 v22, v59
v_max_f32 v23, v59, v22
v_max_f32 v59, v59, v22
v_mov_b32 v22, 0
ds_read_b128 v[36:39], v2 offset:23552
v_permlane16_swap_b32 v23, v59
v_max_f32 v59, v59, v23
v_mul_f32 v58, s18, v59
v_pk_fma_f32 v[20:21], v[20:21], s[18:19], v[58:59] op_sel_hi:[1,0,0] neg_lo:[0,0,1] neg_hi:[0,0,1]
v_pk_fma_f32 v[16:17], v[16:17], s[18:19], v[58:59] op_sel_hi:[1,0,0] neg_lo:[0,0,1] neg_hi:[0,0,1]
v_pk_fma_f32 v[18:19], v[18:19], s[18:19], v[58:59] op_sel_hi:[1,0,0] neg_lo:[0,0,1] neg_hi:[0,0,1]
v_pk_fma_f32 v[12:13], v[12:13], s[18:19], v[58:59] op_sel_hi:[1,0,0] neg_lo:[0,0,1] neg_hi:[0,0,1]
v_pk_fma_f32 v[14:15], v[14:15], s[18:19], v[58:59] op_sel_hi:[1,0,0] neg_lo:[0,0,1] neg_hi:[0,0,1]
v_exp_f32 v20, v20
v_exp_f32 v21, v21
v_exp_f32 v16, v16
v_cvt_pk_bf16_f32 v23, v20, v21
v_cvt_pk_bf16_f32 v20, v20, v21
v_mov_b32 v21, 0
v_exp_f32 v17, v17
v_exp_f32 v18, v18
v_mfma_f32_16x16x16_bf16 v[24:27], v[56:57], v[20:21], 0
v_exp_f32 v19, v19
v_mfma_f32_16x16x16_bf16 v[28:31], v[56:57], v[22:23], 0
v_exp_f32 v12, v12
v_exp_f32 v13, v13
v_cvt_pk_bf16_f32 v16, v16, v17
v_cvt_pk_bf16_f32 v17, v18, v19
v_exp_f32 v14, v14
v_exp_f32 v15, v15
v_cvt_pk_bf16_f32 v18, v12, v13
v_cvt_pk_bf16_f32 v19, v14, v15
v_mfma_f32_16x16x16_bf16 v[12:15], v[60:61], v[20:21], 0
s_waitcnt vmcnt(4)
v_mfma_f32_16x16x32_bf16 v[12:15], v[60:63], v[16:19], v[12:15]
v_mov_b32 v20, 0
v_mov_b32 v23, 0
v_mfma_f32_16x16x32_bf16 v[24:27], v[64:67], v[16:19], v[24:27]
s_nop 1
v_mfma_f32_16x16x32_bf16 v[28:31], v[68:71], v[16:19], v[28:31]
v_mov_b32 v16, 0
v_mov_b32 v17, 0
v_rcp_f32 v12, v12
v_mov_b32 v18, 0
v_mov_b32 v19, 0
v_pk_mul_f32 v[24:25], v[24:25], v[12:13] op_sel_hi:[1,0]
v_pk_mul_f32 v[26:27], v[26:27], v[12:13] op_sel_hi:[1,0]
v_mov_b32 v15, 0
v_pk_mul_f32 v[28:29], v[28:29], v[12:13] op_sel_hi:[1,0]
v_pk_mul_f32 v[30:31], v[30:31], v[12:13] op_sel_hi:[1,0]
v_cvt_pk_bf16_f32 v24, v24, v28
v_cvt_pk_bf16_f32 v25, v25, v29
v_cvt_pk_bf16_f32 v26, v26, v30
v_cvt_pk_bf16_f32 v27, v27, v31
v_mfma_f32_16x16x32_bf16 v[56:59], v[20:23], v[20:23], 0
ds_write_b128 v7, v[24:27]
v_mfma_f32_16x16x32_bf16 v[60:63], v[20:23], v[20:23], 0
v_mov_b32 v12, 0
v_mov_b32 v13, 0
v_mov_b32 v14, 0
v_mov_b32 v3, 6528
v_and_b32 v8, 0x380, v1
v_add_u32 v8, v8, v1
v_mfma_f32_16x16x32_bf16 v[64:67], v[20:23], v[20:23], 0
s_add_u32 s20, s30, 19456
s_mov_b32 m0, 22016
s_cmp_eq_u32 s19, 63
s_cbranch_scc1 L_texit
s_waitcnt lgkmcnt(0)
s_barrier
ds_read_b128 v[24:27], v1 offset:1152
v_mfma_f32_16x16x32_bf16 v[68:71], v[20:23], v[20:23], 0
ds_read_b128 v[28:31], v1 offset:2176
s_nop 2
v_mfma_f32_16x16x32_bf16 v[68:71], v[20:23], v[20:23], 0
s_waitcnt lgkmcnt(1)
v_smfmac_f32_16x16x64_bf16 v[12:15], v[24:27], a[248:255], v0
buffer_load_dwordx4 v8, s[8:11], s20 offen sc1 lds
v_smfmac_f32_16x16x64_bf16 v[16:19], v[24:27], a[176:183], v0
s_mov_b32 m0, 22912
s_waitcnt lgkmcnt(0)
v_smfmac_f32_16x16x64_bf16 v[12:15], v[28:31], v[40:47], v0
ds_read_b128 v[40:43], v2 offset:24576
v_smfmac_f32_16x16x64_bf16 v[16:19], v[28:31], v[48:55], v0
ds_read_b128 v[44:47], v2 offset:25600
buffer_load_dwordx4 v8, s[8:11], s20 offen offset:128 sc1 lds
v_smfmac_f32_16x16x64_bf16 v[20:23], v[24:27], a[184:191], v0
ds_read_b128 v[48:51], v2 offset:26624
s_nop 1
v_add_f32 v12, v12, v13
v_add_f32 v14, v14, v15
v_cvt_pk_bf16_f32 v12, v12, v14
v_smfmac_f32_16x16x64_bf16 v[20:23], v[28:31], v[32:39], v0
ds_read_b128 v[52:55], v2 offset:27648
buffer_store_dword v12, v10, s[8:11], s28 offen
v_add_f32 v16, v16, v17
v_add_f32 v18, v18, v19
v_smfmac_f32_16x16x64_bf16 v[56:59], v[24:27], a[192:199], v0
s_waitcnt lgkmcnt(2)
ds_read_b128 v[32:35], v2 offset:28672
v_cvt_pk_bf16_f32 v16, v16, v18
v_smfmac_f32_16x16x64_bf16 v[56:59], v[28:31], v[40:47], v0
ds_read_b128 v[36:39], v2 offset:29696
v_add_f32 v20, v20, v21
v_add_f32 v22, v22, v23
v_cvt_pk_bf16_f32 v17, v20, v22
v_smfmac_f32_16x16x64_bf16 v[60:63], v[24:27], a[200:207], v0
s_waitcnt lgkmcnt(2)
ds_read_b128 v[12:15], v3
buffer_store_dwordx2 v[16:17], v9, s[8:11], s28 offen
v_smfmac_f32_16x16x64_bf16 v[60:63], v[28:31], v[48:55], v0
ds_read_b128 v[40:43], v2 offset:30720
v_add_f32 v56, v56, v57
v_add_f32 v58, v58, v59
v_cvt_pk_bf16_f32 v56, v56, v58
v_smfmac_f32_16x16x64_bf16 v[64:67], v[24:27], a[208:215], v0
s_waitcnt lgkmcnt(2)
ds_read_b128 v[44:47], v2 offset:31744
v_smfmac_f32_16x16x64_bf16 v[64:67], v[28:31], v[32:39], v0
ds_read_b128 v[20:23], v3
v_add_f32 v60, v60, v61
v_add_f32 v62, v62, v63
v_cvt_pk_bf16_f32 v57, v60, v62
v_smfmac_f32_16x16x64_bf16 v[68:71], v[24:27], a[216:223], v0
s_waitcnt lgkmcnt(1)
ds_read_b128 v[48:51], v2 offset:32768
buffer_store_dwordx2 v[56:57], v9, s[8:11], s50 offen
v_smfmac_f32_16x16x64_bf16 v[68:71], v[28:31], v[40:47], v0
ds_read_b128 v[52:55], v2 offset:33792
v_add_f32 v64, v64, v65
v_add_f32 v66, v66, v67
v_cvt_pk_bf16_f32 v64, v64, v66
v_smfmac_f32_16x16x64_bf16 v[12:15], v[24:27], a[224:231], v0
s_waitcnt lgkmcnt(0)
v_smfmac_f32_16x16x64_bf16 v[12:15], v[28:31], v[48:55], v0
s_nop 0
v_add_f32 v68, v68, v69
v_add_f32 v70, v70, v71
v_cvt_pk_bf16_f32 v65, v68, v70
v_smfmac_f32_16x16x64_bf16 v[20:23], v[24:27], a[232:239], v0
buffer_store_dwordx2 v[64:65], v9, s[8:11], s51 offen
v_smfmac_f32_16x16x64_bf16 v[20:23], v[28:31], a[240:247], v0
s_nop 0
v_add_f32 v12, v12, v13
v_add_f32 v14, v14, v15
v_cvt_pk_bf16_f32 v12, v12, v14
s_nop 3
v_add_f32 v20, v20, v21
v_add_f32 v22, v22, v23
v_cvt_pk_bf16_f32 v13, v20, v22
buffer_store_dwordx2 v[12:13], v9, s[8:11], s52 offen
s_add_u32 s19, s19, 1
s_mov_b32 s20, s28
s_mov_b32 s28, s29
s_mov_b32 s29, s20
s_and_b32 s20, s19, 3
s_lshl_b32 s20, s20, 14
s_add_u32 s33, s20, 110100480
s_add_u32 s34, s20, s24
s_xor_b32 s20, s20, 32768
s_add_u32 s35, s20, s24
s_add_u32 s30, s30, 16384
s_add_u32 s31, s31, 131072
s_add_u32 s6, s33, 4096
s_add_u32 s7, s33, 8192
s_mov_b32 s22, 0
v_mov_b64 v[24:25], 0
v_mov_b64 v[26:27], 0
v_mov_b64 v[28:29], 0
v_mov_b64 v[30:31], 0
v_and_b32 v70, 0xf00, v1
v_add_u32 v70, v70, v1
v_mov_b64 v[64:65], -1
v_mov_b64 v[66:67], -1
v_xor_b32 v3, 16, v4
ds_read_b128 v[48:51], v2 offset:14336
ds_read_b128 v[52:55], v2 offset:15360
v_lshrrev_b32 v8, 2, v1
s_add_u32 s20, s19, 1
s_lshr_b32 s20, s20, 3
s_min_u32 s20, s20, 7
s_waitcnt vmcnt(9)
L_kvw:
v_readlane_b32 s21, v11, s20
s_nop 0
s_cmp_eq_u32 s21, 1
s_cbranch_scc0 L_kvp
s_barrier
s_branch L_gat3
L_g3r3:
buffer_load_dwordx4 v[16:19], v1, s[8:11], s6 offen sc1
s_add_u32 s22, s22, 1
s_waitcnt vmcnt(1)
v_max3_u32 v21, v16, v17, v18
v_max_u32 v21, v21, v19
v_cmp_le_u32 vcc, 0xffff0000, v21
s_cmp_gt_u32 s22, 40000
s_cbranch_vccz L_g33
s_cbranch_scc0 L_g3r3
s_branch L_end
L_kvp:
buffer_load_dword v11, v8, s[8:11], s82 offen sc1
s_add_u32 s22, s22, 1
s_cmp_gt_u32 s22, 40000
s_cbranch_scc1 L_end
s_waitcnt vmcnt(0)
s_branch L_kvw
L_texit:
s_lshl_b32 s61, s16, 7
s_add_u32 s61, s61, 111153152
s_waitcnt vmcnt(0)
s_barrier
s_cmp_lg_u32 s17, 0
s_cbranch_scc1 L_sf_41
v_mov_b32 v20, 0
v_mov_b32 v21, 64
s_mov_b64 exec, 1
buffer_store_dword v21, v20, s[8:11], s61 offen sc1
s_mov_b64 exec, -1
L_sf_41:
L_done:
L_end:
s_endpgm
.section .rodata,"a"
.p2align 6
.amdhsa_kernel concat_heads__compressed_kv_cla__memory_aug_recurrent_mem_tr__prompt_kernel
  .amdhsa_next_free_vgpr 512
  .amdhsa_next_free_sgpr 102
  .amdhsa_accum_offset 256
  .amdhsa_group_segment_fixed_size 0
  .amdhsa_kernarg_size 128
  .amdhsa_user_sgpr_count 2
  .amdhsa_user_sgpr_kernarg_segment_ptr 1
  .amdhsa_system_sgpr_workgroup_id_x 1
.end_amdhsa_kernel
```

```asm
; @launch grid=(256,1,1) block=(256,1,1) lds=163840
.amdgcn_target "amdgcn-amd-amdhsa--gfx950"
.text
.globl concat_heads__compressed_kv_cla__memory_aug_recurrent_mem_tr__prompt_kernel
.p2align 8
.type concat_heads__compressed_kv_cla__memory_aug_recurrent_mem_tr__prompt_kernel,@function
concat_heads__compressed_kv_cla__memory_aug_recurrent_mem_tr__prompt_kernel:
s_cmp_ge_u32 s2, 256
s_cbranch_scc1 L_end
s_getreg_b32 s3, hwreg(HW_REG_XCC_ID)
s_and_b32 s3, s3, 7
s_load_dwordx2 s[4:5], s[0:1], 120
s_load_dwordx2 s[6:7], s[0:1], 112
v_lshrrev_b32 v1, 6, v0
s_nop 0
v_readfirstlane_b32 s17, v1
s_waitcnt lgkmcnt(0)
s_mov_b32 s8, s4
s_and_b32 s9, s5, 0xffff
s_mov_b32 s10, 268435456
s_mov_b32 s11, 0x20000
s_mov_b32 s56, s6
s_and_b32 s57, s7, 0xffff
s_mov_b32 s58, 256
s_mov_b32 s59, 0x20000
s_getpc_b64 s[4:5]
L_pc:
s_mov_b32 s12, s4
s_and_b32 s13, s5, 0xffff
s_mov_b32 s14, L_end-L_pc
s_mov_b32 s15, 0x20000
s_lshr_b32 s25, s2, 3
s_lshl_b32 s25, s25, 7
v_lshlrev_b32 v3, 12, v0
buffer_load_dword v3, v3, s[12:15], s25 offen
s_lshl_b32 s24, s3, 2
s_cmp_eq_u32 s17, 0
s_cbranch_scc0 L_tk
s_mov_b64 exec, 1
v_mov_b32 v1, 1
v_mov_b32 v2, 0
buffer_atomic_add v1, v2, s[56:59], s24 offen sc0
s_waitcnt vmcnt(0)
ds_write_b32 v2, v1
s_waitcnt lgkmcnt(0)
s_mov_b64 exec, -1
L_tk:
s_waitcnt vmcnt(0)
s_barrier
v_mov_b32 v2, 0
ds_read_b32 v1, v2
s_lshr_b32 s3, 0x76350124, s24
s_and_b32 s3, s3, 7
s_waitcnt lgkmcnt(0)
v_readfirstlane_b32 s16, v1
s_barrier
s_cmp_ge_u32 s16, 32
s_cbranch_scc1 L_end
s_cmp_eq_u32 s3, 0
s_cbranch_scc1 L_team
s_cmp_eq_u32 s3, 1
s_cbranch_scc0 L_np
s_cmp_lt_u32 s16, 24
s_cbranch_scc1 L_np
v_lshlrev_b32 v1, 4, v0
v_mov_b64 v[4:5], 0
v_mov_b64 v[6:7], 0
s_sub_u32 s24, s16, 24
s_lshl_b32 s24, s24, 12
s_add_u32 s24, s24, 111149056
buffer_store_dwordx4 v[4:7], v1, s[8:11], s24 offen sc1
s_waitcnt vmcnt(0)
s_barrier
s_cmp_lg_u32 s17, 0
s_cbranch_scc1 L_np
v_mov_b32 v1, 1
v_mov_b32 v2, 128
s_mov_b64 exec, 1
buffer_atomic_add v1, v2, s[56:59], 0 offen
s_mov_b64 exec, -1
L_np:
s_cmp_lt_u32 s3, 4
s_cselect_b32 s61, 1, 0
s_cbranch_scc1 L_pb
s_load_dwordx2 s[52:53], s[0:1], 8
s_load_dwordx2 s[54:55], s[0:1], 0
s_load_dwordx2 s[6:7], s[0:1], 24
s_load_dwordx2 s[4:5], s[0:1], 32
s_load_dwordx2 s[18:19], s[0:1], 16
s_mov_b32 s45, 3
s_sub_u32 s24, s3, 4
s_lshl_b32 s24, s24, 5
s_add_u32 s24, s24, s16
s_lshr_b32 s89, s24, 2
s_lshr_b32 s90, s24, 3
s_and_b32 s24, s16, 3
s_mul_i32 s88, s24, 0x11
s_and_b32 s24, s16, 7
s_lshl_b32 s24, s24, 8
s_add_u32 s88, s88, s24
s_add_u32 s88, s88, 0x840
s_branch L_pg
L_pb:
s_load_dwordx2 s[52:53], s[0:1], 48
s_load_dwordx2 s[54:55], s[0:1], 48
s_load_dwordx2 s[6:7], s[0:1], 72
s_load_dwordx2 s[4:5], s[0:1], 80
s_load_dwordx2 s[18:19], s[0:1], 64
s_mov_b32 s45, 6
s_sub_u32 s24, s3, 2
s_lshl_b32 s24, s24, 5
s_add_u32 s24, s24, s16
s_lshr_b32 s89, s24, 1
s_lshr_b32 s90, s24, 2
s_mov_b32 s88, 0xe6a431
s_mov_b32 s25, 0xe6c431
s_bitcmp1_b32 s16, 0
s_cselect_b32 s88, 0xf7b582, s88
s_cselect_b32 s25, 0xf7d592, s25
s_bitcmp1_b32 s16, 1
s_cselect_b32 s88, s25, s88
s_cselect_b32 s45, 5, 6
s_add_u32 s45, s3, 3
s_cmp_eq_u32 s3, 1
s_cselect_b32 s45, 1, s45
s_cselect_b32 s88, 0, s88
s_cselect_b32 s89, s16, s89
L_pg:
s_waitcnt lgkmcnt(0)
s_cmp_ge_u32 s17, 2
s_cselect_b64 s[6:7], s[4:5], s[6:7]
s_cmp_eq_u32 s61, 0
s_cselect_b32 s24, 4, 1
s_mov_b32 s14, 884736
s_cselect_b32 s14, 1048576, s14
s_sub_u32 s24, s3, s24
s_lshl_b32 s24, s24, 5
s_add_u32 s24, s24, s16
s_lshl_b32 s24, s24, 13
s_mov_b32 s12, s52
s_and_b32 s13, s53, 0xffff
s_mov_b32 s15, 0x20000
v_lshlrev_b32 v15, 5, v0
buffer_load_dword v15, v15, s[12:15], s24 offen
s_sub_u32 s24, 7, s3
s_mul_i32 s25, s16, 6
s_add_u32 s24, s24, s25
s_cmp_ge_u32 s24, 36
s_cbranch_scc1 L_pf_1
s_load_dwordx2 s[4:5], s[0:1], 88
s_sub_u32 s25, s24, 0
s_mul_i32 s25, s25, 131072
s_add_u32 s25, s25, 0
s_min_u32 s25, s25, 4718592
s_sub_u32 s98, 4718592, s25
s_mov_b32 s100, 0x0
s_branch L_pfd
L_pf_1:
s_cmp_ge_u32 s24, 72
s_cbranch_scc1 L_pf_2
s_load_dwordx2 s[4:5], s[0:1], 64
s_sub_u32 s25, s24, 36
s_mul_i32 s25, s25, 131072
s_add_u32 s25, s25, 0
s_min_u32 s25, s25, 4718592
s_sub_u32 s98, 4718592, s25
s_mov_b32 s100, 0x0
s_branch L_pfd
L_pf_2:
s_cmp_ge_u32 s24, 80
s_cbranch_scc1 L_pf_3
s_load_dwordx2 s[4:5], s[0:1], 8
s_sub_u32 s25, s24, 72
s_mul_i32 s25, s25, 131072
s_add_u32 s25, s25, 1048576
s_min_u32 s25, s25, 2097152
s_sub_u32 s98, 2097152, s25
s_mov_b32 s100, 0xfffe0000
s_branch L_pfd
L_pf_3:
s_cmp_ge_u32 s24, 92
s_cbranch_scc1 L_pf_4
s_load_dwordx2 s[4:5], s[0:1], 48
s_sub_u32 s25, s24, 80
s_mul_i32 s25, s25, 131072
s_add_u32 s25, s25, 786432
s_min_u32 s25, s25, 2359296
s_sub_u32 s98, 2359296, s25
s_mov_b32 s100, 0xfffe0000
s_branch L_pfd
L_pf_4:
s_cmp_ge_u32 s24, 110
s_cbranch_scc1 L_pf_5
s_load_dwordx2 s[4:5], s[0:1], 0
s_sub_u32 s25, s24, 92
s_mul_i32 s25, s25, 131072
s_add_u32 s25, s25, 0
s_min_u32 s25, s25, 2359296
s_sub_u32 s98, 2359296, s25
s_mov_b32 s100, 0xfffe0000
s_branch L_pfd
L_pf_5:
s_cmp_ge_u32 s24, 146
s_cbranch_scc1 L_pf_6
s_load_dwordx2 s[4:5], s[0:1], 16
s_sub_u32 s25, s24, 110
s_mul_i32 s25, s25, 131072
s_add_u32 s25, s25, 0
s_min_u32 s25, s25, 4718592
s_sub_u32 s98, 4718592, s25
s_mov_b32 s100, 0xfffe0000
s_branch L_pfd
L_pf_6:
s_load_dwordx2 s[4:5], s[0:1], 40
s_sub_u32 s25, s24, 146
s_mul_i32 s25, s25, 131072
s_add_u32 s25, s25, 0
s_min_u32 s25, s25, 4718592
s_sub_u32 s98, 4718592, s25
s_mov_b32 s100, 0xfffe0000
s_branch L_pfd
L_pf_7:
L_pfd:
s_min_u32 s98, s98, 131072
s_waitcnt lgkmcnt(0)
s_add_u32 s96, s4, s25
s_addc_u32 s5, s5, 0
s_and_b32 s97, s5, 0xffff
s_mov_b32 s99, 0x20000
s_cmp_eq_u32 s3, 1
s_cselect_b32 s100, 536870912, s100
v_lshlrev_b32 v14, 6, v0
s_cmp_eq_u32 s61, 0
s_cselect_b32 s94, 0x3e0293ee, 1.0
s_cmp_eq_u32 s3, 1
s_cselect_b32 s91, 1, 0
v_bfe_u32 v16, v0, 4, 3
v_bfe_u32 v17, v0, 7, 1
v_lshlrev_b32 v17, 2, v17
v_xor_b32 v16, v16, v17
v_and_b32 v17, 7, v0
v_xor_b32 v16, v16, v17
v_lshlrev_b32 v1, 4, v16
v_bfe_u32 v17, v0, 4, 2
v_lshlrev_b32 v16, 2, v17
v_and_b32 v18, 15, v0
v_xor_b32 v16, v16, v18
v_bfe_u32 v18, v0, 6, 1
v_xor_b32 v16, v16, v18
v_lshlrev_b32 v16, 4, v16
v_lshl_add_u32 v16, v17, 13, v16
v_lshl_add_u32 v2, v18, 16, v16
s_and_b32 s24, s17, 1
s_lshr_b32 s25, s17, 1
s_lshl_b32 s25, s25, 13
s_lshl_b32 s33, s24, 11
s_add_u32 s33, s33, s25
s_lshl_b32 s32, s17, 10
s_add_u32 s32, s32, 65536
v_bfe_u32 v16, v0, 3, 1
v_lshlrev_b32 v16, 11, v16
v_and_b32 v18, 7, v0
v_lshl_add_u32 v16, v18, 7, v16
v_bfe_u32 v18, v0, 1, 3
v_xor_b32 v18, v18, v17
v_lshl_add_u32 v16, v18, 4, v16
s_lshl_b32 s24, s24, 14
s_add_u32 s24, s24, 65536
v_add_u32 v3, s24, v16
v_xor_b32 v4, 64, v3
v_bfe_u32 v18, v0, 2, 2
v_mul_u32_u24 v16, 320, v18
v_lshl_add_u32 v16, v17, 11, v16
v_bfe_u32 v18, v0, 1, 1
v_lshl_add_u32 v16, v18, 5, v16
v_bfe_u32 v18, v0, 4, 1
v_lshl_add_u32 v16, v18, 4, v16
v_and_b32 v18, 1, v0
v_lshl_add_u32 v16, v18, 3, v16
v_add_u32 v5, s25, v16
v_xor_b32 v6, 16, v5
v_xor_b32 v7, 64, v5
v_xor_b32 v8, 80, v5
v_xor_b32 v9, 128, v5
v_xor_b32 v10, 144, v5
v_xor_b32 v11, 192, v5
v_xor_b32 v12, 208, v5
s_mov_b32 s35, 0
s_lshr_b32 s24, s16, 1
s_cmp_eq_u32 s35, 5
s_cselect_b32 s90, s24, s90
s_lshl_b32 s24, s35, 2
s_lshr_b32 s26, s88, s24
s_bfe_u32 s2, s26, 0x10003
s_and_b32 s26, s26, 7
s_or_b32 s40, s2, s61
s_lshr_b32 s24, s17, 1
s_cmp_eq_u32 s2, 0
s_cselect_b32 s41, s24, 0
s_cselect_b32 s27, s89, s90
s_sub_u32 s25, s24, s41
s_and_b32 s51, s41, s61
s_lshl_b32 s51, s51, 1
s_or_b32 s51, s51, s41
s_lshl_b32 s46, s27, s2
s_add_u32 s46, s46, s25
s_lshl_b32 s46, s46, 8
s_lshl_b32 s47, s40, 7
s_add_u32 s47, s47, 1024
s_mul_i32 s101, s26, s47
s_lshl_b32 s101, s101, 8
s_lshl_b32 s42, s27, 3
s_add_u32 s42, s42, s26
s_lshl_b32 s42, s42, 1
s_and_b32 s25, s17, 1
s_add_u32 s42, s42, s25
s_lshl_b32 s42, s42, 3
s_add_u32 s42, s42, s24
s_lshl_b32 s42, s42, 13
s_lshl_b32 s43, s27, 5
s_add_u32 s43, s43, s26
s_lshl_b32 s43, s43, 2
s_lshl_b32 s24, s2, 1
s_add_u32 s24, s24, s61
s_lshl_b32 s24, s24, 2
s_lshr_b32 s25, 0x8720, s24
s_and_b32 s25, s25, 15
s_lshl_b32 s25, s25, 24
s_add_u32 s42, s42, s25
s_lshr_b32 s25, 0x7604, s24
s_and_b32 s25, s25, 15
s_lshl_b32 s25, s25, 12
s_add_u32 s43, s43, s25
s_add_u32 s43, s43, 111149056
s_cmp_lt_u32 s35, s45
s_cselect_b32 s101, s101, 536870912
s_cselect_b32 s46, s46, 536870912
s_cmp_eq_u32 s2, 0
s_cselect_b64 s[4:5], s[52:53], s[54:55]
s_mov_b32 s12, s4
s_and_b32 s13, s5, 0xffff
s_lshl_b32 s14, s47, 11
s_mov_b32 s15, 0x20000
s_mov_b32 s30, s101
v_lshrrev_b32 v16, 3, v0
v_mul_lo_u32 v16, v16, s47
v_and_b32 v1, 0x70, v1
v_add_u32 v1, v1, v16
s_lshl_b32 s34, s47, 5
s_cmp_eq_u32 s2, 0
s_cselect_b64 s[4:5], s[6:7], s[18:19]
s_mov_b32 s20, s4
s_and_b32 s21, s5, 0xffff
s_lshl_b32 s22, s47, 12
s_mov_b32 s23, 0x20000
s_mov_b32 s31, s46
s_mov_b32 s48, s30
s_add_u32 m0, s32, 0
s_nop 0
buffer_load_dwordx4 v1, s[12:15], s48 offen lds
s_add_u32 s48, s48, s34
s_add_u32 m0, s32, 4096
s_nop 0
buffer_load_dwordx4 v1, s[12:15], s48 offen lds
s_add_u32 s48, s48, s34
s_add_u32 m0, s32, 8192
s_nop 0
buffer_load_dwordx4 v1, s[12:15], s48 offen lds
s_add_u32 s48, s48, s34
s_add_u32 m0, s32, 12288
s_nop 0
buffer_load_dwordx4 v1, s[12:15], s48 offen lds
s_add_u32 s48, s48, s34
s_add_u32 m0, s32, 16384
s_nop 0
buffer_load_dwordx4 v1, s[12:15], s48 offen lds
s_add_u32 s48, s48, s34
s_add_u32 m0, s32, 20480
s_nop 0
buffer_load_dwordx4 v1, s[12:15], s48 offen lds
s_add_u32 s48, s48, s34
s_add_u32 m0, s32, 24576
s_nop 0
buffer_load_dwordx4 v1, s[12:15], s48 offen lds
s_add_u32 s48, s48, s34
s_add_u32 m0, s32, 28672
s_nop 0
buffer_load_dwordx4 v1, s[12:15], s48 offen lds
s_add_u32 s30, s30, 128
s_add_u32 s32, s32, 32768
s_sub_u32 s48, s32, 98304
s_cmp_ge_u32 s32, 163840
s_cselect_b32 s32, s48, s32
s_add_u32 s37, s31, 0
s_add_u32 m0, s33, 0
s_nop 0
buffer_load_dwordx4 v2, s[20:23], s37 offen  lds
s_add_u32 s37, s31, 32768
s_add_u32 m0, s33, 1024
s_nop 0
buffer_load_dwordx4 v2, s[20:23], s37 offen  lds
s_add_u32 s37, s31, 131072
s_add_u32 m0, s33, 4096
s_nop 0
buffer_load_dwordx4 v2, s[20:23], s37 offen  lds
s_add_u32 s37, s31, 163840
s_add_u32 m0, s33, 5120
s_nop 0
buffer_load_dwordx4 v2, s[20:23], s37 offen  lds
s_add_u32 s31, s31, 262144
s_add_u32 s33, s33, 16384
s_and_b32 s33, s33, 65535
s_add_u32 s37, s31, 0
s_add_u32 m0, s33, 0
s_nop 0
buffer_load_dwordx4 v2, s[20:23], s37 offen  lds
s_add_u32 s37, s31, 32768
s_add_u32 m0, s33, 1024
s_nop 0
buffer_load_dwordx4 v2, s[20:23], s37 offen  lds
s_add_u32 s37, s31, 131072
s_add_u32 m0, s33, 4096
s_nop 0
buffer_load_dwordx4 v2, s[20:23], s37 offen  lds
s_add_u32 s37, s31, 163840
s_add_u32 m0, s33, 5120
s_nop 0
buffer_load_dwordx4 v2, s[20:23], s37 offen  lds
s_add_u32 s31, s31, 262144
s_add_u32 s33, s33, 16384
s_and_b32 s33, s33, 65535
s_mov_b32 s48, s30
s_add_u32 m0, s32, 0
s_nop 0
buffer_load_dwordx4 v1, s[12:15], s48 offen lds
s_add_u32 s48, s48, s34
s_add_u32 m0, s32, 4096
s_nop 0
buffer_load_dwordx4 v1, s[12:15], s48 offen lds
s_add_u32 s48, s48, s34
s_add_u32 m0, s32, 8192
s_nop 0
buffer_load_dwordx4 v1, s[12:15], s48 offen lds
s_add_u32 s48, s48, s34
s_add_u32 m0, s32, 12288
s_nop 0
buffer_load_dwordx4 v1, s[12:15], s48 offen lds
s_add_u32 s37, s31, 0
s_add_u32 m0, s33, 0
s_nop 0
buffer_load_dwordx4 v2, s[20:23], s37 offen  lds
s_add_u32 s37, s31, 32768
s_add_u32 m0, s33, 1024
s_nop 0
buffer_load_dwordx4 v2, s[20:23], s37 offen  lds
s_add_u32 s37, s31, 131072
s_add_u32 m0, s33, 4096
s_nop 0
buffer_load_dwordx4 v2, s[20:23], s37 offen  lds
s_add_u32 s37, s31, 163840
s_add_u32 m0, s33, 5120
s_nop 0
buffer_load_dwordx4 v2, s[20:23], s37 offen  lds
s_add_u32 s31, s31, 262144
s_add_u32 s33, s33, 16384
s_and_b32 s33, s33, 65535
s_add_u32 s48, s48, s34
s_add_u32 m0, s32, 16384
s_nop 0
buffer_load_dwordx4 v1, s[12:15], s48 offen lds
s_add_u32 s48, s48, s34
s_add_u32 m0, s32, 20480
s_nop 0
buffer_load_dwordx4 v1, s[12:15], s48 offen lds
s_add_u32 s48, s48, s34
s_add_u32 m0, s32, 24576
s_nop 0
buffer_load_dwordx4 v1, s[12:15], s48 offen lds
s_add_u32 s48, s48, s34
s_add_u32 m0, s32, 28672
s_nop 0
buffer_load_dwordx4 v1, s[12:15], s48 offen lds
s_add_u32 s30, s30, 128
s_add_u32 s32, s32, 32768
s_sub_u32 s48, s32, 98304
s_cmp_ge_u32 s32, 163840
s_cselect_b32 s32, s48, s32
s_add_u32 s37, s31, 0
s_add_u32 m0, s33, 0
s_nop 0
buffer_load_dwordx4 v2, s[20:23], s37 offen  lds
s_add_u32 s37, s31, 32768
s_add_u32 m0, s33, 1024
s_nop 0
buffer_load_dwordx4 v2, s[20:23], s37 offen  lds
s_add_u32 s37, s31, 131072
s_add_u32 m0, s33, 4096
s_nop 0
buffer_load_dwordx4 v2, s[20:23], s37 offen  lds
s_add_u32 s37, s31, 163840
s_add_u32 m0, s33, 5120
s_nop 0
buffer_load_dwordx4 v2, s[20:23], s37 offen  lds
s_add_u32 s31, s31, 262144
s_add_u32 s33, s33, 16384
s_and_b32 s33, s33, 65535
s_mov_b32 s48, s30
s_add_u32 m0, s32, 0
s_nop 0
buffer_load_dwordx4 v1, s[12:15], s48 offen lds
s_add_u32 s48, s48, s34
s_add_u32 m0, s32, 4096
s_nop 0
buffer_load_dwordx4 v1, s[12:15], s48 offen lds
s_add_u32 s48, s48, s34
s_add_u32 m0, s32, 8192
s_nop 0
buffer_load_dwordx4 v1, s[12:15], s48 offen lds
s_add_u32 s48, s48, s34
s_add_u32 m0, s32, 12288
s_nop 0
buffer_load_dwordx4 v1, s[12:15], s48 offen lds
s_mov_b32 s62, 536870912
s_mov_b32 s63, 536870912
s_mov_b32 s50, 0
s_waitcnt vmcnt(24)
s_barrier
s_cmp_eq_u32 s41, 0
s_cbranch_scc0 L_g_p1
ds_read_b64_tr_b16 a[160:161], v5 offset:0
ds_read_b64_tr_b16 a[162:163], v5 offset:1024
ds_read_b64_tr_b16 a[164:165], v6 offset:0
ds_read_b64_tr_b16 a[166:167], v6 offset:1024
ds_read_b64_tr_b16 a[168:169], v7 offset:0
ds_read_b64_tr_b16 a[170:171], v7 offset:1024
ds_read_b64_tr_b16 a[172:173], v8 offset:0
ds_read_b64_tr_b16 a[174:175], v8 offset:1024
ds_read_b64_tr_b16 a[176:177], v9 offset:0
ds_read_b64_tr_b16 a[178:179], v9 offset:1024
ds_read_b64_tr_b16 a[180:181], v10 offset:0
ds_read_b64_tr_b16 a[182:183], v10 offset:1024
ds_read_b64_tr_b16 a[184:185], v11 offset:0
ds_read_b64_tr_b16 a[186:187], v11 offset:1024
ds_read_b64_tr_b16 a[188:189], v12 offset:0
ds_read_b64_tr_b16 a[190:191], v12 offset:1024
ds_read_b128 a[192:195], v3 offset:0
ds_read_b128 a[196:199], v4 offset:1024
ds_read_b128 a[200:203], v3 offset:4096
ds_read_b128 a[204:207], v4 offset:5120
ds_read_b128 a[208:211], v3 offset:8192
ds_read_b128 a[212:215], v4 offset:9216
ds_read_b128 a[216:219], v3 offset:12288
ds_read_b128 a[220:223], v4 offset:13312
s_branch L_g_p2
L_g_p1:
ds_read_b128 a[160:163], v3 offset:0
ds_read_b128 a[164:167], v4 offset:1024
ds_read_b128 a[168:171], v3 offset:4096
ds_read_b128 a[172:175], v4 offset:5120
ds_read_b128 a[176:179], v3 offset:8192
ds_read_b128 a[180:183], v4 offset:9216
ds_read_b128 a[184:187], v3 offset:12288
ds_read_b128 a[188:191], v4 offset:13312
ds_read_b64_tr_b16 a[192:193], v5 offset:0
ds_read_b64_tr_b16 a[194:195], v5 offset:1024
ds_read_b64_tr_b16 a[196:197], v6 offset:0
ds_read_b64_tr_b16 a[198:199], v6 offset:1024
ds_read_b64_tr_b16 a[200:201], v7 offset:0
ds_read_b64_tr_b16 a[202:203], v7 offset:1024
ds_read_b64_tr_b16 a[204:205], v8 offset:0
ds_read_b64_tr_b16 a[206:207], v8 offset:1024
ds_read_b64_tr_b16 a[208:209], v9 offset:0
ds_read_b64_tr_b16 a[210:211], v9 offset:1024
ds_read_b64_tr_b16 a[212:213], v10 offset:0
ds_read_b64_tr_b16 a[214:215], v10 offset:1024
ds_read_b64_tr_b16 a[216:217], v11 offset:0
ds_read_b64_tr_b16 a[218:219], v11 offset:1024
ds_read_b64_tr_b16 a[220:221], v12 offset:0
ds_read_b64_tr_b16 a[222:223], v12 offset:1024
L_g_p2:
v_add_u32 v5, 16384, v5
v_and_b32 v5, 65535, v5
v_xor_b32 v6, 16, v5
v_xor_b32 v7, 64, v5
v_xor_b32 v8, 80, v5
v_xor_b32 v9, 128, v5
v_xor_b32 v10, 144, v5
v_xor_b32 v11, 192, v5
v_xor_b32 v12, 208, v5
L_g_tile:
s_cmp_eq_u32 s35, 1
s_cbranch_scc1 L_g_first
L_g_go:
s_cmp_eq_u32 s41, 0
s_cbranch_scc0 L_g_v
.p2align 3
L_g_k:
s_waitcnt vmcnt(16) lgkmcnt(0)
s_barrier
v_mfma_f32_16x16x32_bf16 v[160:163], a[160:163], a[192:195], 0
ds_read_b128 a[224:227], v4 offset:0
v_accvgpr_read_b32 v20, a64
v_accvgpr_read_b32 v21, a65
v_accvgpr_read_b32 v22, a66
v_mfma_f32_16x16x32_bf16 v[164:167], a[160:163], a[196:199], 0
s_add_u32 s37, s31, 0
v_accvgpr_read_b32 v23, a67
v_cvt_pk_bf16_f32 v98, v20, v21
v_cvt_pk_bf16_f32 v99, v22, v23
v_accvgpr_read_b32 v24, a68
v_mfma_f32_16x16x32_bf16 v[168:171], a[160:163], a[200:203], 0
s_add_u32 m0, s33, 0
ds_read_b128 a[228:231], v3 offset:1024
v_accvgpr_read_b32 v25, a69
v_accvgpr_read_b32 v26, a70
v_accvgpr_read_b32 v27, a71
v_mfma_f32_16x16x32_bf16 v[172:175], a[160:163], a[204:207], 0
buffer_load_dwordx4 v2, s[20:23], s37 offen  lds
v_cvt_pk_bf16_f32 v102, v24, v25
v_cvt_pk_bf16_f32 v103, v26, v27
v_accvgpr_read_b32 v20, a72
v_mfma_f32_16x16x32_bf16 v[176:179], a[160:163], a[208:211], 0
ds_read_b128 a[232:235], v4 offset:4096
v_accvgpr_read_b32 v21, a73
v_accvgpr_read_b32 v22, a74
v_accvgpr_read_b32 v23, a75
v_mfma_f32_16x16x32_bf16 v[180:183], a[160:163], a[212:215], 0
v_cvt_pk_bf16_f32 v106, v20, v21
v_cvt_pk_bf16_f32 v107, v22, v23
v_accvgpr_read_b32 v24, a76
v_accvgpr_read_b32 v25, a77
v_mfma_f32_16x16x32_bf16 v[184:187], a[160:163], a[216:219], 0
ds_read_b128 a[236:239], v3 offset:5120
v_accvgpr_read_b32 v26, a78
v_accvgpr_read_b32 v27, a79
v_cvt_pk_bf16_f32 v110, v24, v25
v_mfma_f32_16x16x32_bf16 v[188:191], a[160:163], a[220:223], 0
ds_read_b64_tr_b16 a[160:161], v5 offset:0
v_cvt_pk_bf16_f32 v111, v26, v27
v_accvgpr_read_b32 v20, a80
v_accvgpr_read_b32 v21, a81
v_mfma_f32_16x16x32_bf16 v[192:195], a[164:167], a[192:195], 0
s_add_u32 s37, s31, 32768
ds_read_b64_tr_b16 a[162:163], v5 offset:1024
v_accvgpr_read_b32 v22, a82
v_accvgpr_read_b32 v23, a83
v_cvt_pk_bf16_f32 v114, v20, v21
v_mfma_f32_16x16x32_bf16 v[196:199], a[164:167], a[196:199], 0
s_add_u32 m0, s33, 1024
ds_read_b128 a[240:243], v4 offset:8192
v_add_u32 v5, 16384, v5
v_cvt_pk_bf16_f32 v115, v22, v23
v_accvgpr_read_b32 v24, a84
v_mfma_f32_16x16x32_bf16 v[200:203], a[164:167], a[200:203], 0
buffer_load_dwordx4 v2, s[20:23], s37 offen  lds
v_and_b32 v5, 65535, v5
v_accvgpr_read_b32 v25, a85
v_accvgpr_read_b32 v26, a86
v_mfma_f32_16x16x32_bf16 v[204:207], a[164:167], a[204:207], 0
ds_read_b128 a[244:247], v3 offset:9216
v_accvgpr_read_b32 v27, a87
v_cvt_pk_bf16_f32 v118, v24, v25
v_cvt_pk_bf16_f32 v119, v26, v27
v_mfma_f32_16x16x32_bf16 v[208:211], a[164:167], a[208:211], 0
v_accvgpr_read_b32 v20, a88
v_accvgpr_read_b32 v21, a89
v_accvgpr_read_b32 v22, a90
v_accvgpr_read_b32 v23, a91
v_mfma_f32_16x16x32_bf16 v[212:215], a[164:167], a[212:215], 0
ds_read_b128 a[248:251], v4 offset:12288
v_cvt_pk_bf16_f32 v122, v20, v21
v_cvt_pk_bf16_f32 v123, v22, v23
v_accvgpr_read_b32 v24, a92
v_mfma_f32_16x16x32_bf16 v[216:219], a[164:167], a[216:219], 0
v_accvgpr_read_b32 v25, a93
v_accvgpr_read_b32 v26, a94
v_accvgpr_read_b32 v27, a95
v_cvt_pk_bf16_f32 v126, v24, v25
v_mfma_f32_16x16x32_bf16 v[220:223], a[164:167], a[220:223], 0
s_add_u32 s37, s31, 131072
ds_read_b64_tr_b16 a[164:165], v6 offset:0
v_cvt_pk_bf16_f32 v127, v26, v27
v_accvgpr_read_b32 v20, a96
v_accvgpr_read_b32 v21, a97
v_mfma_f32_16x16x32_bf16 v[224:227], a[168:171], a[192:195], 0
s_add_u32 m0, s33, 4096
ds_read_b64_tr_b16 a[166:167], v6 offset:1024
v_accvgpr_read_b32 v22, a98
v_accvgpr_read_b32 v23, a99
v_cvt_pk_bf16_f32 v128, v20, v21
v_mfma_f32_16x16x32_bf16 v[228:231], a[168:171], a[196:199], 0
buffer_load_dwordx4 v2, s[20:23], s37 offen  lds
v_xor_b32 v6, 16, v5
v_cvt_pk_bf16_f32 v129, v22, v23
v_accvgpr_read_b32 v24, a100
v_mfma_f32_16x16x32_bf16 v[232:235], a[168:171], a[200:203], 0
ds_read_b128 a[252:255], v3 offset:13312
v_accvgpr_read_b32 v25, a101
v_accvgpr_read_b32 v26, a102
v_accvgpr_read_b32 v27, a103
v_mfma_f32_16x16x32_bf16 v[236:239], a[168:171], a[204:207], 0
v_cvt_pk_bf16_f32 v132, v24, v25
v_cvt_pk_bf16_f32 v133, v26, v27
v_accvgpr_read_b32 v20, a104
v_accvgpr_read_b32 v21, a105
v_mfma_f32_16x16x32_bf16 v[240:243], a[168:171], a[208:211], 0
ds_read_b64_tr_b16 v[28:29], v12 offset:0
v_accvgpr_read_b32 v22, a106
v_accvgpr_read_b32 v23, a107
v_cvt_pk_bf16_f32 v136, v20, v21
v_mfma_f32_16x16x32_bf16 v[244:247], a[168:171], a[212:215], 0
v_cvt_pk_bf16_f32 v137, v22, v23
v_accvgpr_read_b32 v24, a108
v_accvgpr_read_b32 v25, a109
v_accvgpr_read_b32 v26, a110
v_mfma_f32_16x16x32_bf16 v[248:251], a[168:171], a[216:219], 0
s_add_u32 s37, s31, 163840
ds_read_b64_tr_b16 v[30:31], v12 offset:1024
v_accvgpr_read_b32 v27, a111
v_cvt_pk_bf16_f32 v140, v24, v25
v_cvt_pk_bf16_f32 v141, v26, v27
v_mfma_f32_16x16x32_bf16 v[252:255], a[168:171], a[220:223], 0
s_add_u32 m0, s33, 5120
ds_read_b64_tr_b16 a[168:169], v7 offset:0
v_accvgpr_read_b32 v20, a112
v_accvgpr_read_b32 v21, a113
v_accvgpr_read_b32 v22, a114
v_mfma_f32_16x16x32_bf16 a[0:3], a[172:175], a[192:195], 0
buffer_load_dwordx4 v2, s[20:23], s37 offen  lds
ds_read_b64_tr_b16 a[170:171], v7 offset:1024
v_accvgpr_read_b32 v23, a115
v_cvt_pk_bf16_f32 v144, v20, v21
v_mfma_f32_16x16x32_bf16 a[4:7], a[172:175], a[196:199], 0
s_add_u32 s31, s31, 262144
v_xor_b32 v7, 64, v5
v_xor_b32 v12, 208, v5
v_cvt_pk_bf16_f32 v145, v22, v23
v_accvgpr_read_b32 v24, a116
v_mfma_f32_16x16x32_bf16 a[8:11], a[172:175], a[200:203], 0
s_add_u32 s33, s33, 16384
v_add_u32 v3, 32768, v3
v_accvgpr_read_b32 v25, a117
v_accvgpr_read_b32 v26, a118
v_accvgpr_read_b32 v27, a119
v_mfma_f32_16x16x32_bf16 a[12:15], a[172:175], a[204:207], 0
s_and_b32 s33, s33, 65535
v_subrev_u32 v19, 98304, v3
v_cvt_pk_bf16_f32 v148, v24, v25
v_cvt_pk_bf16_f32 v149, v26, v27
v_accvgpr_read_b32 v20, a120
v_mfma_f32_16x16x32_bf16 a[16:19], a[172:175], a[208:211], 0
v_cmp_le_u32 vcc, 163840, v3
v_accvgpr_read_b32 v21, a121
v_accvgpr_read_b32 v22, a122
v_accvgpr_read_b32 v23, a123
v_mfma_f32_16x16x32_bf16 a[20:23], a[172:175], a[212:215], 0
s_add_u32 s48, s48, s34
v_cndmask_b32 v3, v3, v19, vcc
v_cvt_pk_bf16_f32 v152, v20, v21
v_cvt_pk_bf16_f32 v153, v22, v23
v_accvgpr_read_b32 v24, a124
v_mfma_f32_16x16x32_bf16 a[24:27], a[172:175], a[216:219], 0
s_add_u32 m0, s32, 16384
v_xor_b32 v4, 64, v3
v_accvgpr_read_b32 v25, a125
v_accvgpr_read_b32 v26, a126
v_accvgpr_read_b32 v27, a127
v_mfma_f32_16x16x32_bf16 a[28:31], a[172:175], a[220:223], 0
buffer_load_dwordx4 v1, s[12:15], s48 offen lds
ds_read_b64_tr_b16 a[172:173], v8 offset:0
v_cvt_pk_bf16_f32 v156, v24, v25
v_cvt_pk_bf16_f32 v157, v26, v27
v_mfma_f32_16x16x32_bf16 a[32:35], a[176:179], a[192:195], 0
ds_read_b64_tr_b16 a[174:175], v8 offset:1024
v_accvgpr_read_b32 v20, a128
v_accvgpr_read_b32 v21, a129
v_accvgpr_read_b32 v22, a130
v_mfma_f32_16x16x32_bf16 a[36:39], a[176:179], a[196:199], 0
v_xor_b32 v8, 80, v5
v_accvgpr_read_b32 v23, a131
v_cvt_pk_bf16_f32 v130, v20, v21
v_cvt_pk_bf16_f32 v131, v22, v23
v_mfma_f32_16x16x32_bf16 a[40:43], a[176:179], a[200:203], 0
v_accvgpr_read_b32 v24, a132
v_accvgpr_read_b32 v25, a133
v_accvgpr_read_b32 v26, a134
v_accvgpr_read_b32 v27, a135
v_mfma_f32_16x16x32_bf16 a[44:47], a[176:179], a[204:207], 0
v_cvt_pk_bf16_f32 v134, v24, v25
v_cvt_pk_bf16_f32 v135, v26, v27
v_accvgpr_read_b32 v20, a136
v_accvgpr_read_b32 v21, a137
v_mfma_f32_16x16x32_bf16 a[48:51], a[176:179], a[208:211], 0
s_add_u32 s48, s48, s34
v_accvgpr_read_b32 v22, a138
v_accvgpr_read_b32 v23, a139
v_cvt_pk_bf16_f32 v138, v20, v21
v_cvt_pk_bf16_f32 v139, v22, v23
s_mov_b32 s38, s62
s_mov_b32 s39, s63
v_mfma_f32_16x16x32_bf16 a[52:55], a[176:179], a[212:215], 0
s_add_u32 m0, s32, 20480
v_accvgpr_read_b32 v24, a140
v_accvgpr_read_b32 v25, a141
v_accvgpr_read_b32 v26, a142
v_accvgpr_read_b32 v27, a143
s_mov_b32 s49, s50
s_mov_b32 s62, s42
v_mfma_f32_16x16x32_bf16 a[56:59], a[176:179], a[216:219], 0
buffer_load_dwordx4 v1, s[12:15], s48 offen lds
v_cvt_pk_bf16_f32 v142, v24, v25
v_cvt_pk_bf16_f32 v143, v26, v27
v_accvgpr_read_b32 v20, a144
s_mov_b32 s63, s43
s_mov_b32 s50, s51
v_mfma_f32_16x16x32_bf16 a[60:63], a[176:179], a[220:223], 0
ds_read_b64_tr_b16 a[176:177], v9 offset:0
v_accvgpr_read_b32 v21, a145
v_accvgpr_read_b32 v22, a146
v_accvgpr_read_b32 v23, a147
s_mov_b32 s36, s40
s_add_u32 s35, s35, 1
v_mfma_f32_16x16x32_bf16 a[64:67], a[180:183], a[192:195], 0
ds_read_b64_tr_b16 a[178:179], v9 offset:1024
v_cvt_pk_bf16_f32 v146, v20, v21
v_cvt_pk_bf16_f32 v147, v22, v23
v_accvgpr_read_b32 v24, a148
v_bfe_u32 v16, v0, 3, 3
v_lshlrev_b32 v16, 4, v16
v_mfma_f32_16x16x32_bf16 a[68:71], a[180:183], a[196:199], 0
v_xor_b32 v9, 128, v5
v_accvgpr_read_b32 v25, a149
v_accvgpr_read_b32 v26, a150
v_accvgpr_read_b32 v27, a151
v_and_or_b32 v16, v0, 7, v16
v_bfe_u32 v17, v0, 4, 2
v_mfma_f32_16x16x32_bf16 a[72:75], a[180:183], a[200:203], 0
v_cvt_pk_bf16_f32 v150, v24, v25
v_cvt_pk_bf16_f32 v151, v26, v27
v_accvgpr_read_b32 v20, a152
v_accvgpr_read_b32 v21, a153
v_lshlrev_b32 v17, 5, v17
v_bfe_u32 v18, v0, 1, 3
v_mfma_f32_16x16x32_bf16 a[76:79], a[180:183], a[204:207], 0
s_add_u32 s48, s48, s34
v_accvgpr_read_b32 v22, a154
v_accvgpr_read_b32 v23, a155
v_cvt_pk_bf16_f32 v154, v20, v21
v_cvt_pk_bf16_f32 v155, v22, v23
v_or_b32 v17, v17, v18
v_and_b32 v18, 1, v0
v_mfma_f32_16x16x32_bf16 a[80:83], a[180:183], a[208:211], 0
s_add_u32 m0, s32, 24576
v_accvgpr_read_b32 v24, a156
v_accvgpr_read_b32 v25, a157
v_accvgpr_read_b32 v26, a158
v_accvgpr_read_b32 v27, a159
v_lshl_or_b32 v17, v18, 4, v17
v_mfma_f32_16x16x32_bf16 a[84:87], a[180:183], a[212:215], 0
buffer_load_dwordx4 v1, s[12:15], s48 offen lds
v_cvt_pk_bf16_f32 v158, v24, v25
v_cvt_pk_bf16_f32 v159, v26, v27
s_bitcmp1_b32 s49, 1
s_cselect_b64 vcc, -1, 0
s_movk_i32 s44, 0x80
v_mfma_f32_16x16x32_bf16 a[88:91], a[180:183], a[216:219], 0
v_cndmask_b32 v16, v16, v17, vcc
v_lshlrev_b32 v13, 4, v16
s_movk_i32 s92, 0x800
s_bitcmp1_b32 s49, 0
s_cselect_b32 s92, 0x4000, s92
s_xor_b32 s93, s92, 0x4800
v_mfma_f32_16x16x32_bf16 a[92:95], a[180:183], a[220:223], 0
ds_read_b64_tr_b16 a[180:181], v10 offset:0
s_sub_u32 s93, s93, s44
v_mfma_f32_16x16x32_bf16 a[96:99], a[184:187], a[192:195], 0
ds_read_b64_tr_b16 a[182:183], v10 offset:1024
v_mfma_f32_16x16x32_bf16 a[100:103], a[184:187], a[196:199], 0
v_xor_b32 v10, 144, v5
v_mfma_f32_16x16x32_bf16 a[104:107], a[184:187], a[200:203], 0
s_add_u32 s48, s48, s34
v_mfma_f32_16x16x32_bf16 a[108:111], a[184:187], a[204:207], 0
s_add_u32 m0, s32, 28672
v_mfma_f32_16x16x32_bf16 a[112:115], a[184:187], a[208:211], 0
buffer_load_dwordx4 v1, s[12:15], s48 offen lds
v_mfma_f32_16x16x32_bf16 a[116:119], a[184:187], a[212:215], 0
s_add_u32 s30, s30, 128
v_mfma_f32_16x16x32_bf16 a[120:123], a[184:187], a[216:219], 0
s_add_u32 s32, s32, 32768
v_mfma_f32_16x16x32_bf16 a[124:127], a[184:187], a[220:223], 0
s_sub_u32 s48, s32, 98304
ds_read_b64_tr_b16 a[184:185], v11 offset:0
v_mfma_f32_16x16x32_bf16 a[128:131], a[188:191], a[192:195], 0
s_cmp_ge_u32 s32, 163840
s_cselect_b32 s32, s48, s32
ds_read_b64_tr_b16 a[186:187], v11 offset:1024
v_mfma_f32_16x16x32_bf16 a[132:135], a[188:191], a[196:199], 0
v_xor_b32 v11, 192, v5
v_mfma_f32_16x16x32_bf16 a[136:139], a[188:191], a[200:203], 0
buffer_load_dword v15, v14, s[96:99], s100 offen
v_mfma_f32_16x16x32_bf16 a[140:143], a[188:191], a[204:207], 0
s_add_u32 s100, s100, 16384
v_mfma_f32_16x16x32_bf16 a[144:147], a[188:191], a[208:211], 0
v_mfma_f32_16x16x32_bf16 a[148:151], a[188:191], a[212:215], 0
v_mfma_f32_16x16x32_bf16 a[152:155], a[188:191], a[216:219], 0
v_mfma_f32_16x16x32_bf16 a[156:159], a[188:191], a[220:223], 0
s_waitcnt vmcnt(17) lgkmcnt(0)
s_barrier
v_mfma_f32_16x16x32_bf16 v[160:163], a[160:163], a[224:227], v[160:163]
ds_read_b128 a[192:195], v3 offset:0
v_mfma_f32_16x16x32_bf16 v[164:167], a[160:163], a[228:231], v[164:167]
s_add_u32 s37, s31, 0
v_mfma_f32_16x16x32_bf16 v[168:171], a[160:163], a[232:235], v[168:171]
s_add_u32 m0, s33, 0
ds_read_b128 a[196:199], v4 offset:1024
v_mfma_f32_16x16x32_bf16 v[172:175], a[160:163], a[236:239], v[172:175]
buffer_load_dwordx4 v2, s[20:23], s37 offen  lds
v_mfma_f32_16x16x32_bf16 v[176:179], a[160:163], a[240:243], v[176:179]
s_mov_b32 s60, s38
ds_read_b128 a[200:203], v3 offset:4096
v_mfma_f32_16x16x32_bf16 v[180:183], a[160:163], a[244:247], v[180:183]
s_mov_b32 s29, s38
v_mfma_f32_16x16x32_bf16 v[184:187], a[160:163], a[248:251], v[184:187]
buffer_store_dwordx4 v[32:35], v13, s[8:11], s29 offen sc1
v_mfma_f32_16x16x32_bf16 v[188:191], a[160:163], a[252:255], v[188:191]
ds_read_b64_tr_b16 a[160:161], v5 offset:0
v_mfma_f32_16x16x32_bf16 v[192:195], a[164:167], a[224:227], v[192:195]
s_add_u32 s37, s31, 32768
ds_read_b64_tr_b16 a[162:163], v5 offset:1024
v_mfma_f32_16x16x32_bf16 v[196:199], a[164:167], a[228:231], v[196:199]
s_add_u32 m0, s33, 1024
ds_read_b128 a[204:207], v4 offset:5120
v_add_u32 v5, 16384, v5
v_mfma_f32_16x16x32_bf16 v[200:203], a[164:167], a[232:235], v[200:203]
buffer_load_dwordx4 v2, s[20:23], s37 offen  lds
v_and_b32 v5, 65535, v5
v_mfma_f32_16x16x32_bf16 v[204:207], a[164:167], a[236:239], v[204:207]
ds_read_b128 a[208:211], v3 offset:8192
v_mfma_f32_16x16x32_bf16 v[208:211], a[164:167], a[240:243], v[208:211]
v_mfma_f32_16x16x32_bf16 v[212:215], a[164:167], a[244:247], v[212:215]
ds_read_b128 a[212:215], v4 offset:9216
v_mfma_f32_16x16x32_bf16 v[216:219], a[164:167], a[248:251], v[216:219]
v_mfma_f32_16x16x32_bf16 v[220:223], a[164:167], a[252:255], v[220:223]
s_add_u32 s37, s31, 131072
ds_read_b64_tr_b16 a[164:165], v6 offset:0
v_mfma_f32_16x16x32_bf16 v[224:227], a[168:171], a[224:227], v[224:227]
s_add_u32 m0, s33, 4096
ds_read_b64_tr_b16 a[166:167], v6 offset:1024
v_mfma_f32_16x16x32_bf16 v[228:231], a[168:171], a[228:231], v[228:231]
buffer_load_dwordx4 v2, s[20:23], s37 offen  lds
v_xor_b32 v6, 16, v5
v_mfma_f32_16x16x32_bf16 v[232:235], a[168:171], a[232:235], v[232:235]
ds_read_b128 a[216:219], v3 offset:12288
v_mfma_f32_16x16x32_bf16 v[236:239], a[168:171], a[236:239], v[236:239]
v_mfma_f32_16x16x32_bf16 v[240:243], a[168:171], a[240:243], v[240:243]
ds_read_b128 a[220:223], v4 offset:13312
v_mfma_f32_16x16x32_bf16 v[244:247], a[168:171], a[244:247], v[244:247]
v_mfma_f32_16x16x32_bf16 v[248:251], a[168:171], a[248:251], v[248:251]
s_add_u32 s37, s31, 163840
ds_read_b64_tr_b16 a[188:189], v12 offset:0
v_mfma_f32_16x16x32_bf16 v[252:255], a[168:171], a[252:255], v[252:255]
s_add_u32 m0, s33, 5120
ds_read_b64_tr_b16 a[168:169], v7 offset:0
v_mfma_f32_16x16x32_bf16 a[0:3], a[172:175], a[224:227], a[0:3]
buffer_load_dwordx4 v2, s[20:23], s37 offen  lds
ds_read_b64_tr_b16 a[170:171], v7 offset:1024
v_mfma_f32_16x16x32_bf16 a[4:7], a[172:175], a[228:231], a[4:7]
s_add_u32 s31, s31, 262144
s_add_u32 s29, s29, s44
v_xor_b32 v7, 64, v5
v_mfma_f32_16x16x32_bf16 a[8:11], a[172:175], a[232:235], a[8:11]
s_add_u32 s33, s33, 16384
ds_read_b64_tr_b16 a[190:191], v12 offset:1024
v_mfma_f32_16x16x32_bf16 a[12:15], a[172:175], a[236:239], a[12:15]
s_and_b32 s33, s33, 65535
buffer_store_dwordx4 v[36:39], v13, s[8:11], s29 offen sc1
v_mfma_f32_16x16x32_bf16 a[16:19], a[172:175], a[240:243], a[16:19]
v_mfma_f32_16x16x32_bf16 a[20:23], a[172:175], a[244:247], a[20:23]
s_mov_b32 s48, s30
v_xor_b32 v12, 208, v5
v_mfma_f32_16x16x32_bf16 a[24:27], a[172:175], a[248:251], a[24:27]
s_add_u32 m0, s32, 0
v_mfma_f32_16x16x32_bf16 a[28:31], a[172:175], a[252:255], a[28:31]
buffer_load_dwordx4 v1, s[12:15], s48 offen lds
ds_read_b64_tr_b16 a[172:173], v8 offset:0
v_mfma_f32_16x16x32_bf16 a[32:35], a[176:179], a[224:227], a[32:35]
ds_read_b64_tr_b16 a[174:175], v8 offset:1024
v_mfma_f32_16x16x32_bf16 a[36:39], a[176:179], a[228:231], a[36:39]
v_xor_b32 v8, 80, v5
v_mfma_f32_16x16x32_bf16 a[40:43], a[176:179], a[232:235], a[40:43]
v_mfma_f32_16x16x32_bf16 a[44:47], a[176:179], a[236:239], a[44:47]
v_mfma_f32_16x16x32_bf16 a[48:51], a[176:179], a[240:243], a[48:51]
s_add_u32 s48, s48, s34
v_mfma_f32_16x16x32_bf16 a[52:55], a[176:179], a[244:247], a[52:55]
s_add_u32 m0, s32, 4096
v_mfma_f32_16x16x32_bf16 a[56:59], a[176:179], a[248:251], a[56:59]
buffer_load_dwordx4 v1, s[12:15], s48 offen lds
v_mfma_f32_16x16x32_bf16 a[60:63], a[176:179], a[252:255], a[60:63]
ds_read_b64_tr_b16 a[176:177], v9 offset:0
v_mfma_f32_16x16x32_bf16 a[64:67], a[180:183], a[224:227], a[64:67]
ds_read_b64_tr_b16 a[178:179], v9 offset:1024
v_mfma_f32_16x16x32_bf16 a[68:71], a[180:183], a[228:231], a[68:71]
v_xor_b32 v9, 128, v5
v_mfma_f32_16x16x32_bf16 a[72:75], a[180:183], a[232:235], a[72:75]
v_mfma_f32_16x16x32_bf16 a[76:79], a[180:183], a[236:239], a[76:79]
s_add_u32 s48, s48, s34
v_mfma_f32_16x16x32_bf16 a[80:83], a[180:183], a[240:243], a[80:83]
s_add_u32 m0, s32, 8192
v_mfma_f32_16x16x32_bf16 a[84:87], a[180:183], a[244:247], a[84:87]
buffer_load_dwordx4 v1, s[12:15], s48 offen lds
v_mfma_f32_16x16x32_bf16 a[88:91], a[180:183], a[248:251], a[88:91]
s_add_u32 s29, s29, s93
v_mfma_f32_16x16x32_bf16 a[92:95], a[180:183], a[252:255], a[92:95]
ds_read_b64_tr_b16 a[180:181], v10 offset:0
v_mfma_f32_16x16x32_bf16 a[96:99], a[184:187], a[224:227], a[96:99]
buffer_store_dwordx4 v[40:43], v13, s[8:11], s29 offen sc1
ds_read_b64_tr_b16 a[182:183], v10 offset:1024
v_mfma_f32_16x16x32_bf16 a[100:103], a[184:187], a[228:231], a[100:103]
v_xor_b32 v10, 144, v5
v_mfma_f32_16x16x32_bf16 a[104:107], a[184:187], a[232:235], a[104:107]
s_add_u32 s48, s48, s34
v_mfma_f32_16x16x32_bf16 a[108:111], a[184:187], a[236:239], a[108:111]
s_add_u32 m0, s32, 12288
v_mfma_f32_16x16x32_bf16 a[112:115], a[184:187], a[240:243], a[112:115]
buffer_load_dwordx4 v1, s[12:15], s48 offen lds
v_mfma_f32_16x16x32_bf16 a[116:119], a[184:187], a[244:247], a[116:119]
v_mfma_f32_16x16x32_bf16 a[120:123], a[184:187], a[248:251], a[120:123]
v_mfma_f32_16x16x32_bf16 a[124:127], a[184:187], a[252:255], a[124:127]
ds_read_b64_tr_b16 a[184:185], v11 offset:0
v_mfma_f32_16x16x32_bf16 a[128:131], v[28:31], a[224:227], a[128:131]
ds_read_b64_tr_b16 a[186:187], v11 offset:1024
v_mfma_f32_16x16x32_bf16 a[132:135], v[28:31], a[228:231], a[132:135]
v_xor_b32 v11, 192, v5
v_mfma_f32_16x16x32_bf16 a[136:139], v[28:31], a[232:235], a[136:139]
buffer_load_dword v15, v14, s[96:99], s100 offen
v_mfma_f32_16x16x32_bf16 a[140:143], v[28:31], a[236:239], a[140:143]
s_add_u32 s100, s100, 16384
v_mfma_f32_16x16x32_bf16 a[144:147], v[28:31], a[240:243], a[144:147]
v_mfma_f32_16x16x32_bf16 a[148:151], v[28:31], a[244:247], a[148:151]
v_mfma_f32_16x16x32_bf16 a[152:155], v[28:31], a[248:251], a[152:155]
v_mfma_f32_16x16x32_bf16 a[156:159], v[28:31], a[252:255], a[156:159]
s_waitcnt vmcnt(21) lgkmcnt(0)
s_barrier
v_mfma_f32_16x16x32_bf16 v[160:163], a[160:163], a[192:195], v[160:163]
ds_read_b128 a[224:227], v4 offset:0
v_mfma_f32_16x16x32_bf16 v[164:167], a[160:163], a[196:199], v[164:167]
s_add_u32 s37, s31, 0
v_mfma_f32_16x16x32_bf16 v[168:171], a[160:163], a[200:203], v[168:171]
s_add_u32 m0, s33, 0
ds_read_b128 a[228:231], v3 offset:1024
v_mfma_f32_16x16x32_bf16 v[172:175], a[160:163], a[204:207], v[172:175]
buffer_load_dwordx4 v2, s[20:23], s37 offen  lds
v_mfma_f32_16x16x32_bf16 v[176:179], a[160:163], a[208:211], v[176:179]
s_add_u32 s29, s29, s44
ds_read_b128 a[232:235], v4 offset:4096
v_mfma_f32_16x16x32_bf16 v[180:183], a[160:163], a[212:215], v[180:183]
v_mfma_f32_16x16x32_bf16 v[184:187], a[160:163], a[216:219], v[184:187]
buffer_store_dwordx4 v[44:47], v13, s[8:11], s29 offen sc1
v_mfma_f32_16x16x32_bf16 v[188:191], a[160:163], a[220:223], v[188:191]
ds_read_b64_tr_b16 a[160:161], v5 offset:0
v_mfma_f32_16x16x32_bf16 v[192:195], a[164:167], a[192:195], v[192:195]
s_add_u32 s37, s31, 32768
ds_read_b64_tr_b16 a[162:163], v5 offset:1024
v_mfma_f32_16x16x32_bf16 v[196:199], a[164:167], a[196:199], v[196:199]
s_add_u32 m0, s33, 1024
ds_read_b128 a[236:239], v3 offset:5120
v_add_u32 v5, 16384, v5
v_mfma_f32_16x16x32_bf16 v[200:203], a[164:167], a[200:203], v[200:203]
buffer_load_dwordx4 v2, s[20:23], s37 offen  lds
v_and_b32 v5, 65535, v5
v_mfma_f32_16x16x32_bf16 v[204:207], a[164:167], a[204:207], v[204:207]
ds_read_b128 a[240:243], v4 offset:8192
v_mfma_f32_16x16x32_bf16 v[208:211], a[164:167], a[208:211], v[208:211]
v_mfma_f32_16x16x32_bf16 v[212:215], a[164:167], a[212:215], v[212:215]
ds_read_b128 a[244:247], v3 offset:9216
v_mfma_f32_16x16x32_bf16 v[216:219], a[164:167], a[216:219], v[216:219]
v_mfma_f32_16x16x32_bf16 v[220:223], a[164:167], a[220:223], v[220:223]
s_add_u32 s37, s31, 131072
ds_read_b64_tr_b16 a[164:165], v6 offset:0
v_mfma_f32_16x16x32_bf16 v[224:227], a[168:171], a[192:195], v[224:227]
s_add_u32 m0, s33, 4096
ds_read_b64_tr_b16 a[166:167], v6 offset:1024
v_mfma_f32_16x16x32_bf16 v[228:231], a[168:171], a[196:199], v[228:231]
buffer_load_dwordx4 v2, s[20:23], s37 offen  lds
v_xor_b32 v6, 16, v5
v_mfma_f32_16x16x32_bf16 v[232:235], a[168:171], a[200:203], v[232:235]
ds_read_b128 a[248:251], v4 offset:12288
v_mfma_f32_16x16x32_bf16 v[236:239], a[168:171], a[204:207], v[236:239]
v_mfma_f32_16x16x32_bf16 v[240:243], a[168:171], a[208:211], v[240:243]
ds_read_b128 a[252:255], v3 offset:13312
v_mfma_f32_16x16x32_bf16 v[244:247], a[168:171], a[212:215], v[244:247]
v_mfma_f32_16x16x32_bf16 v[248:251], a[168:171], a[216:219], v[248:251]
s_add_u32 s37, s31, 163840
ds_read_b64_tr_b16 v[28:29], v12 offset:0
v_mfma_f32_16x16x32_bf16 v[252:255], a[168:171], a[220:223], v[252:255]
s_add_u32 m0, s33, 5120
ds_read_b64_tr_b16 a[168:169], v7 offset:0
v_mfma_f32_16x16x32_bf16 a[0:3], a[172:175], a[192:195], a[0:3]
buffer_load_dwordx4 v2, s[20:23], s37 offen  lds
ds_read_b64_tr_b16 a[170:171], v7 offset:1024
v_mfma_f32_16x16x32_bf16 a[4:7], a[172:175], a[196:199], a[4:7]
s_add_u32 s31, s31, 262144
s_add_u32 s29, s29, s93
v_xor_b32 v7, 64, v5
v_mfma_f32_16x16x32_bf16 a[8:11], a[172:175], a[200:203], a[8:11]
s_add_u32 s33, s33, 16384
ds_read_b64_tr_b16 v[30:31], v12 offset:1024
v_mfma_f32_16x16x32_bf16 a[12:15], a[172:175], a[204:207], a[12:15]
s_and_b32 s33, s33, 65535
buffer_store_dwordx4 v[48:51], v13, s[8:11], s29 offen sc1
v_mfma_f32_16x16x32_bf16 a[16:19], a[172:175], a[208:211], a[16:19]
v_mfma_f32_16x16x32_bf16 a[20:23], a[172:175], a[212:215], a[20:23]
s_add_u32 s48, s48, s34
v_xor_b32 v12, 208, v5
v_mfma_f32_16x16x32_bf16 a[24:27], a[172:175], a[216:219], a[24:27]
s_add_u32 m0, s32, 16384
v_add_u32 v3, 32768, v3
v_mfma_f32_16x16x32_bf16 a[28:31], a[172:175], a[220:223], a[28:31]
buffer_load_dwordx4 v1, s[12:15], s48 offen lds
ds_read_b64_tr_b16 a[172:173], v8 offset:0
v_mfma_f32_16x16x32_bf16 a[32:35], a[176:179], a[192:195], a[32:35]
ds_read_b64_tr_b16 a[174:175], v8 offset:1024
v_subrev_u32 v19, 98304, v3
v_mfma_f32_16x16x32_bf16 a[36:39], a[176:179], a[196:199], a[36:39]
v_xor_b32 v8, 80, v5
v_cmp_le_u32 vcc, 163840, v3
v_mfma_f32_16x16x32_bf16 a[40:43], a[176:179], a[200:203], a[40:43]
s_nop 0
v_cndmask_b32 v3, v3, v19, vcc
v_mfma_f32_16x16x32_bf16 a[44:47], a[176:179], a[204:207], a[44:47]
v_xor_b32 v4, 64, v3
v_mfma_f32_16x16x32_bf16 a[48:51], a[176:179], a[208:211], a[48:51]
s_add_u32 s48, s48, s34
v_mfma_f32_16x16x32_bf16 a[52:55], a[176:179], a[212:215], a[52:55]
s_add_u32 m0, s32, 20480
v_mfma_f32_16x16x32_bf16 a[56:59], a[176:179], a[216:219], a[56:59]
buffer_load_dwordx4 v1, s[12:15], s48 offen lds
v_mfma_f32_16x16x32_bf16 a[60:63], a[176:179], a[220:223], a[60:63]
ds_read_b64_tr_b16 a[176:177], v9 offset:0
v_mfma_f32_16x16x32_bf16 a[64:67], a[180:183], a[192:195], a[64:67]
ds_read_b64_tr_b16 a[178:179], v9 offset:1024
v_mfma_f32_16x16x32_bf16 a[68:71], a[180:183], a[196:199], a[68:71]
v_xor_b32 v9, 128, v5
v_mfma_f32_16x16x32_bf16 a[72:75], a[180:183], a[200:203], a[72:75]
v_mfma_f32_16x16x32_bf16 a[76:79], a[180:183], a[204:207], a[76:79]
s_add_u32 s48, s48, s34
v_mfma_f32_16x16x32_bf16 a[80:83], a[180:183], a[208:211], a[80:83]
s_add_u32 m0, s32, 24576
v_mfma_f32_16x16x32_bf16 a[84:87], a[180:183], a[212:215], a[84:87]
buffer_load_dwordx4 v1, s[12:15], s48 offen lds
v_mfma_f32_16x16x32_bf16 a[88:91], a[180:183], a[216:219], a[88:91]
s_add_u32 s29, s29, s44
v_mfma_f32_16x16x32_bf16 a[92:95], a[180:183], a[220:223], a[92:95]
ds_read_b64_tr_b16 a[180:181], v10 offset:0
v_mfma_f32_16x16x32_bf16 a[96:99], a[184:187], a[192:195], a[96:99]
buffer_store_dwordx4 v[52:55], v13, s[8:11], s29 offen sc1
ds_read_b64_tr_b16 a[182:183], v10 offset:1024
v_mfma_f32_16x16x32_bf16 a[100:103], a[184:187], a[196:199], a[100:103]
v_xor_b32 v10, 144, v5
v_mfma_f32_16x16x32_bf16 a[104:107], a[184:187], a[200:203], a[104:107]
s_add_u32 s48, s48, s34
v_mfma_f32_16x16x32_bf16 a[108:111], a[184:187], a[204:207], a[108:111]
s_add_u32 m0, s32, 28672
v_mfma_f32_16x16x32_bf16 a[112:115], a[184:187], a[208:211], a[112:115]
buffer_load_dwordx4 v1, s[12:15], s48 offen lds
v_mfma_f32_16x16x32_bf16 a[116:119], a[184:187], a[212:215], a[116:119]
s_add_u32 s30, s30, 128
v_mfma_f32_16x16x32_bf16 a[120:123], a[184:187], a[216:219], a[120:123]
s_add_u32 s32, s32, 32768
v_mfma_f32_16x16x32_bf16 a[124:127], a[184:187], a[220:223], a[124:127]
s_sub_u32 s48, s32, 98304
ds_read_b64_tr_b16 a[184:185], v11 offset:0
v_mfma_f32_16x16x32_bf16 a[128:131], a[188:191], a[192:195], a[128:131]
s_cmp_ge_u32 s32, 163840
s_cselect_b32 s32, s48, s32
ds_read_b64_tr_b16 a[186:187], v11 offset:1024
v_mfma_f32_16x16x32_bf16 a[132:135], a[188:191], a[196:199], a[132:135]
v_xor_b32 v11, 192, v5
v_mfma_f32_16x16x32_bf16 a[136:139], a[188:191], a[200:203], a[136:139]
buffer_load_dword v15, v14, s[96:99], s100 offen
v_mfma_f32_16x16x32_bf16 a[140:143], a[188:191], a[204:207], a[140:143]
s_add_u32 s100, s100, 16384
v_mfma_f32_16x16x32_bf16 a[144:147], a[188:191], a[208:211], a[144:147]
v_mfma_f32_16x16x32_bf16 a[148:151], a[188:191], a[212:215], a[148:151]
v_mfma_f32_16x16x32_bf16 a[152:155], a[188:191], a[216:219], a[152:155]
v_mfma_f32_16x16x32_bf16 a[156:159], a[188:191], a[220:223], a[156:159]
s_waitcnt vmcnt(24) lgkmcnt(0)
s_barrier
v_mfma_f32_16x16x32_bf16 v[160:163], a[160:163], a[224:227], v[160:163]
ds_read_b128 a[192:195], v3 offset:0
v_mfma_f32_16x16x32_bf16 v[164:167], a[160:163], a[228:231], v[164:167]
s_add_u32 s37, s31, 0
v_mfma_f32_16x16x32_bf16 v[168:171], a[160:163], a[232:235], v[168:171]
s_add_u32 m0, s33, 0
ds_read_b128 a[196:199], v4 offset:1024
v_mfma_f32_16x16x32_bf16 v[172:175], a[160:163], a[236:239], v[172:175]
buffer_load_dwordx4 v2, s[20:23], s37 offen  lds
v_mfma_f32_16x16x32_bf16 v[176:179], a[160:163], a[240:243], v[176:179]
s_add_u32 s29, s29, s93
ds_read_b128 a[200:203], v3 offset:4096
v_mfma_f32_16x16x32_bf16 v[180:183], a[160:163], a[244:247], v[180:183]
v_mfma_f32_16x16x32_bf16 v[184:187], a[160:163], a[248:251], v[184:187]
buffer_store_dwordx4 v[56:59], v13, s[8:11], s29 offen sc1
v_mfma_f32_16x16x32_bf16 v[188:191], a[160:163], a[252:255], v[188:191]
ds_read_b64_tr_b16 a[160:161], v5 offset:0
v_mfma_f32_16x16x32_bf16 v[192:195], a[164:167], a[224:227], v[192:195]
s_add_u32 s37, s31, 32768
ds_read_b64_tr_b16 a[162:163], v5 offset:1024
v_mfma_f32_16x16x32_bf16 v[196:199], a[164:167], a[228:231], v[196:199]
s_add_u32 m0, s33, 1024
ds_read_b128 a[204:207], v4 offset:5120
v_add_u32 v5, 16384, v5
v_mfma_f32_16x16x32_bf16 v[200:203], a[164:167], a[232:235], v[200:203]
buffer_load_dwordx4 v2, s[20:23], s37 offen  lds
v_and_b32 v5, 65535, v5
v_mfma_f32_16x16x32_bf16 v[204:207], a[164:167], a[236:239], v[204:207]
ds_read_b128 a[208:211], v3 offset:8192
v_mfma_f32_16x16x32_bf16 v[208:211], a[164:167], a[240:243], v[208:211]
v_mfma_f32_16x16x32_bf16 v[212:215], a[164:167], a[244:247], v[212:215]
ds_read_b128 a[212:215], v4 offset:9216
v_mfma_f32_16x16x32_bf16 v[216:219], a[164:167], a[248:251], v[216:219]
v_mfma_f32_16x16x32_bf16 v[220:223], a[164:167], a[252:255], v[220:223]
s_add_u32 s37, s31, 131072
ds_read_b64_tr_b16 a[164:165], v6 offset:0
v_mfma_f32_16x16x32_bf16 v[224:227], a[168:171], a[224:227], v[224:227]
s_add_u32 m0, s33, 4096
ds_read_b64_tr_b16 a[166:167], v6 offset:1024
v_mfma_f32_16x16x32_bf16 v[228:231], a[168:171], a[228:231], v[228:231]
buffer_load_dwordx4 v2, s[20:23], s37 offen  lds
v_xor_b32 v6, 16, v5
v_mfma_f32_16x16x32_bf16 v[232:235], a[168:171], a[232:235], v[232:235]
ds_read_b128 a[216:219], v3 offset:12288
v_mfma_f32_16x16x32_bf16 v[236:239], a[168:171], a[236:239], v[236:239]
v_mfma_f32_16x16x32_bf16 v[240:243], a[168:171], a[240:243], v[240:243]
ds_read_b128 a[220:223], v4 offset:13312
v_mfma_f32_16x16x32_bf16 v[244:247], a[168:171], a[244:247], v[244:247]
v_mfma_f32_16x16x32_bf16 v[248:251], a[168:171], a[248:251], v[248:251]
s_add_u32 s37, s31, 163840
ds_read_b64_tr_b16 a[188:189], v12 offset:0
v_mfma_f32_16x16x32_bf16 v[252:255], a[168:171], a[252:255], v[252:255]
s_add_u32 m0, s33, 5120
ds_read_b64_tr_b16 a[168:169], v7 offset:0
v_mfma_f32_16x16x32_bf16 a[0:3], a[172:175], a[224:227], a[0:3]
buffer_load_dwordx4 v2, s[20:23], s37 offen  lds
ds_read_b64_tr_b16 a[170:171], v7 offset:1024
v_mfma_f32_16x16x32_bf16 a[4:7], a[172:175], a[228:231], a[4:7]
s_add_u32 s31, s31, 262144
s_add_u32 s29, s29, s44
v_xor_b32 v7, 64, v5
v_mfma_f32_16x16x32_bf16 a[8:11], a[172:175], a[232:235], a[8:11]
s_add_u32 s33, s33, 16384
ds_read_b64_tr_b16 a[190:191], v12 offset:1024
v_mfma_f32_16x16x32_bf16 a[12:15], a[172:175], a[236:239], a[12:15]
s_and_b32 s33, s33, 65535
buffer_store_dwordx4 v[60:63], v13, s[8:11], s29 offen sc1
v_mfma_f32_16x16x32_bf16 a[16:19], a[172:175], a[240:243], a[16:19]
v_mfma_f32_16x16x32_bf16 a[20:23], a[172:175], a[244:247], a[20:23]
s_mov_b32 s48, s30
v_xor_b32 v12, 208, v5
v_mfma_f32_16x16x32_bf16 a[24:27], a[172:175], a[248:251], a[24:27]
s_add_u32 m0, s32, 0
v_mfma_f32_16x16x32_bf16 a[28:31], a[172:175], a[252:255], a[28:31]
buffer_load_dwordx4 v1, s[12:15], s48 offen lds
ds_read_b64_tr_b16 a[172:173], v8 offset:0
v_mfma_f32_16x16x32_bf16 a[32:35], a[176:179], a[224:227], a[32:35]
ds_read_b64_tr_b16 a[174:175], v8 offset:1024
v_mfma_f32_16x16x32_bf16 a[36:39], a[176:179], a[228:231], a[36:39]
v_xor_b32 v8, 80, v5
v_mfma_f32_16x16x32_bf16 a[40:43], a[176:179], a[232:235], a[40:43]
v_mfma_f32_16x16x32_bf16 a[44:47], a[176:179], a[236:239], a[44:47]
v_mfma_f32_16x16x32_bf16 a[48:51], a[176:179], a[240:243], a[48:51]
s_add_u32 s48, s48, s34
v_mfma_f32_16x16x32_bf16 a[52:55], a[176:179], a[244:247], a[52:55]
s_add_u32 m0, s32, 4096
v_mfma_f32_16x16x32_bf16 a[56:59], a[176:179], a[248:251], a[56:59]
buffer_load_dwordx4 v1, s[12:15], s48 offen lds
v_mfma_f32_16x16x32_bf16 a[60:63], a[176:179], a[252:255], a[60:63]
ds_read_b64_tr_b16 a[176:177], v9 offset:0
v_mfma_f32_16x16x32_bf16 a[64:67], a[180:183], a[224:227], a[64:67]
ds_read_b64_tr_b16 a[178:179], v9 offset:1024
v_mfma_f32_16x16x32_bf16 a[68:71], a[180:183], a[228:231], a[68:71]
v_xor_b32 v9, 128, v5
v_mfma_f32_16x16x32_bf16 a[72:75], a[180:183], a[232:235], a[72:75]
v_mfma_f32_16x16x32_bf16 a[76:79], a[180:183], a[236:239], a[76:79]
s_add_u32 s48, s48, s34
v_mfma_f32_16x16x32_bf16 a[80:83], a[180:183], a[240:243], a[80:83]
s_add_u32 m0, s32, 8192
v_mfma_f32_16x16x32_bf16 a[84:87], a[180:183], a[244:247], a[84:87]
buffer_load_dwordx4 v1, s[12:15], s48 offen lds
v_mfma_f32_16x16x32_bf16 a[88:91], a[180:183], a[248:251], a[88:91]
v_mfma_f32_16x16x32_bf16 a[92:95], a[180:183], a[252:255], a[92:95]
ds_read_b64_tr_b16 a[180:181], v10 offset:0
v_mfma_f32_16x16x32_bf16 a[96:99], a[184:187], a[224:227], a[96:99]
ds_read_b64_tr_b16 a[182:183], v10 offset:1024
v_mfma_f32_16x16x32_bf16 a[100:103], a[184:187], a[228:231], a[100:103]
v_xor_b32 v10, 144, v5
v_mfma_f32_16x16x32_bf16 a[104:107], a[184:187], a[232:235], a[104:107]
s_add_u32 s48, s48, s34
v_mfma_f32_16x16x32_bf16 a[108:111], a[184:187], a[236:239], a[108:111]
s_add_u32 m0, s32, 12288
v_mfma_f32_16x16x32_bf16 a[112:115], a[184:187], a[240:243], a[112:115]
buffer_load_dwordx4 v1, s[12:15], s48 offen lds
v_mfma_f32_16x16x32_bf16 a[116:119], a[184:187], a[244:247], a[116:119]
v_mfma_f32_16x16x32_bf16 a[120:123], a[184:187], a[248:251], a[120:123]
v_mfma_f32_16x16x32_bf16 a[124:127], a[184:187], a[252:255], a[124:127]
ds_read_b64_tr_b16 a[184:185], v11 offset:0
v_mfma_f32_16x16x32_bf16 a[128:131], v[28:31], a[224:227], a[128:131]
ds_read_b64_tr_b16 a[186:187], v11 offset:1024
v_mfma_f32_16x16x32_bf16 a[132:135], v[28:31], a[228:231], a[132:135]
v_xor_b32 v11, 192, v5
v_mfma_f32_16x16x32_bf16 a[136:139], v[28:31], a[232:235], a[136:139]
buffer_load_dword v15, v14, s[96:99], s100 offen
v_mfma_f32_16x16x32_bf16 a[140:143], v[28:31], a[236:239], a[140:143]
s_add_u32 s100, s100, 16384
v_mfma_f32_16x16x32_bf16 a[144:147], v[28:31], a[240:243], a[144:147]
v_mfma_f32_16x16x32_bf16 a[148:151], v[28:31], a[244:247], a[148:151]
v_mfma_f32_16x16x32_bf16 a[152:155], v[28:31], a[248:251], a[152:155]
v_mfma_f32_16x16x32_bf16 a[156:159], v[28:31], a[252:255], a[156:159]
s_waitcnt vmcnt(23) lgkmcnt(0)
s_barrier
v_mfma_f32_16x16x32_bf16 v[160:163], a[160:163], a[192:195], v[160:163]
ds_read_b128 a[224:227], v4 offset:0
v_mfma_f32_16x16x32_bf16 v[164:167], a[160:163], a[196:199], v[164:167]
s_add_u32 s37, s31, 0
v_mfma_f32_16x16x32_bf16 v[168:171], a[160:163], a[200:203], v[168:171]
s_add_u32 m0, s33, 0
ds_read_b128 a[228:231], v3 offset:1024
v_mfma_f32_16x16x32_bf16 v[172:175], a[160:163], a[204:207], v[172:175]
buffer_load_dwordx4 v2, s[20:23], s37 offen  lds
v_mfma_f32_16x16x32_bf16 v[176:179], a[160:163], a[208:211], v[176:179]
s_add_u32 s60, s60, s92
ds_read_b128 a[232:235], v4 offset:4096
v_mfma_f32_16x16x32_bf16 v[180:183], a[160:163], a[212:215], v[180:183]
s_mov_b32 s29, s60
v_mfma_f32_16x16x32_bf16 v[184:187], a[160:163], a[216:219], v[184:187]
buffer_store_dwordx4 v[64:67], v13, s[8:11], s29 offen sc1
v_mfma_f32_16x16x32_bf16 v[188:191], a[160:163], a[220:223], v[188:191]
ds_read_b64_tr_b16 a[160:161], v5 offset:0
v_mfma_f32_16x16x32_bf16 v[192:195], a[164:167], a[192:195], v[192:195]
s_add_u32 s37, s31, 32768
ds_read_b64_tr_b16 a[162:163], v5 offset:1024
v_mfma_f32_16x16x32_bf16 v[196:199], a[164:167], a[196:199], v[196:199]
s_add_u32 m0, s33, 1024
ds_read_b128 a[236:239], v3 offset:5120
v_add_u32 v5, 16384, v5
v_mfma_f32_16x16x32_bf16 v[200:203], a[164:167], a[200:203], v[200:203]
buffer_load_dwordx4 v2, s[20:23], s37 offen  lds
v_and_b32 v5, 65535, v5
v_mfma_f32_16x16x32_bf16 v[204:207], a[164:167], a[204:207], v[204:207]
ds_read_b128 a[240:243], v4 offset:8192
v_mfma_f32_16x16x32_bf16 v[208:211], a[164:167], a[208:211], v[208:211]
v_mfma_f32_16x16x32_bf16 v[212:215], a[164:167], a[212:215], v[212:215]
ds_read_b128 a[244:247], v3 offset:9216
v_mfma_f32_16x16x32_bf16 v[216:219], a[164:167], a[216:219], v[216:219]
v_mfma_f32_16x16x32_bf16 v[220:223], a[164:167], a[220:223], v[220:223]
s_add_u32 s37, s31, 131072
ds_read_b64_tr_b16 a[164:165], v6 offset:0
v_mfma_f32_16x16x32_bf16 v[224:227], a[168:171], a[192:195], v[224:227]
s_add_u32 m0, s33, 4096
ds_read_b64_tr_b16 a[166:167], v6 offset:1024
v_mfma_f32_16x16x32_bf16 v[228:231], a[168:171], a[196:199], v[228:231]
buffer_load_dwordx4 v2, s[20:23], s37 offen  lds
v_xor_b32 v6, 16, v5
v_mfma_f32_16x16x32_bf16 v[232:235], a[168:171], a[200:203], v[232:235]
ds_read_b128 a[248:251], v4 offset:12288
v_mfma_f32_16x16x32_bf16 v[236:239], a[168:171], a[204:207], v[236:239]
v_mfma_f32_16x16x32_bf16 v[240:243], a[168:171], a[208:211], v[240:243]
ds_read_b128 a[252:255], v3 offset:13312
v_mfma_f32_16x16x32_bf16 v[244:247], a[168:171], a[212:215], v[244:247]
v_mfma_f32_16x16x32_bf16 v[248:251], a[168:171], a[216:219], v[248:251]
s_add_u32 s37, s31, 163840
ds_read_b64_tr_b16 v[28:29], v12 offset:0
v_mfma_f32_16x16x32_bf16 v[252:255], a[168:171], a[220:223], v[252:255]
s_add_u32 m0, s33, 5120
ds_read_b64_tr_b16 a[168:169], v7 offset:0
v_mfma_f32_16x16x32_bf16 a[0:3], a[172:175], a[192:195], a[0:3]
buffer_load_dwordx4 v2, s[20:23], s37 offen  lds
ds_read_b64_tr_b16 a[170:171], v7 offset:1024
v_mfma_f32_16x16x32_bf16 a[4:7], a[172:175], a[196:199], a[4:7]
s_add_u32 s31, s31, 262144
s_add_u32 s29, s29, s44
v_xor_b32 v7, 64, v5
v_mfma_f32_16x16x32_bf16 a[8:11], a[172:175], a[200:203], a[8:11]
s_add_u32 s33, s33, 16384
ds_read_b64_tr_b16 v[30:31], v12 offset:1024
v_mfma_f32_16x16x32_bf16 a[12:15], a[172:175], a[204:207], a[12:15]
s_and_b32 s33, s33, 65535
buffer_store_dwordx4 v[68:71], v13, s[8:11], s29 offen sc1
v_mfma_f32_16x16x32_bf16 a[16:19], a[172:175], a[208:211], a[16:19]
v_mfma_f32_16x16x32_bf16 a[20:23], a[172:175], a[212:215], a[20:23]
s_add_u32 s48, s48, s34
v_xor_b32 v12, 208, v5
v_mfma_f32_16x16x32_bf16 a[24:27], a[172:175], a[216:219], a[24:27]
s_add_u32 m0, s32, 16384
v_add_u32 v3, 32768, v3
v_mfma_f32_16x16x32_bf16 a[28:31], a[172:175], a[220:223], a[28:31]
buffer_load_dwordx4 v1, s[12:15], s48 offen lds
ds_read_b64_tr_b16 a[172:173], v8 offset:0
v_mfma_f32_16x16x32_bf16 a[32:35], a[176:179], a[192:195], a[32:35]
ds_read_b64_tr_b16 a[174:175], v8 offset:1024
v_subrev_u32 v19, 98304, v3
v_mfma_f32_16x16x32_bf16 a[36:39], a[176:179], a[196:199], a[36:39]
v_xor_b32 v8, 80, v5
v_cmp_le_u32 vcc, 163840, v3
v_mfma_f32_16x16x32_bf16 a[40:43], a[176:179], a[200:203], a[40:43]
s_nop 0
v_cndmask_b32 v3, v3, v19, vcc
v_mfma_f32_16x16x32_bf16 a[44:47], a[176:179], a[204:207], a[44:47]
v_xor_b32 v4, 64, v3
v_mfma_f32_16x16x32_bf16 a[48:51], a[176:179], a[208:211], a[48:51]
s_add_u32 s48, s48, s34
v_mfma_f32_16x16x32_bf16 a[52:55], a[176:179], a[212:215], a[52:55]
s_add_u32 m0, s32, 20480
v_mfma_f32_16x16x32_bf16 a[56:59], a[176:179], a[216:219], a[56:59]
buffer_load_dwordx4 v1, s[12:15], s48 offen lds
v_mfma_f32_16x16x32_bf16 a[60:63], a[176:179], a[220:223], a[60:63]
ds_read_b64_tr_b16 a[176:177], v9 offset:0
v_mfma_f32_16x16x32_bf16 a[64:67], a[180:183], a[192:195], a[64:67]
ds_read_b64_tr_b16 a[178:179], v9 offset:1024
v_mfma_f32_16x16x32_bf16 a[68:71], a[180:183], a[196:199], a[68:71]
v_xor_b32 v9, 128, v5
v_mfma_f32_16x16x32_bf16 a[72:75], a[180:183], a[200:203], a[72:75]
v_mfma_f32_16x16x32_bf16 a[76:79], a[180:183], a[204:207], a[76:79]
s_add_u32 s48, s48, s34
v_mfma_f32_16x16x32_bf16 a[80:83], a[180:183], a[208:211], a[80:83]
s_add_u32 m0, s32, 24576
v_mfma_f32_16x16x32_bf16 a[84:87], a[180:183], a[212:215], a[84:87]
buffer_load_dwordx4 v1, s[12:15], s48 offen lds
v_mfma_f32_16x16x32_bf16 a[88:91], a[180:183], a[216:219], a[88:91]
s_add_u32 s29, s29, s93
v_mfma_f32_16x16x32_bf16 a[92:95], a[180:183], a[220:223], a[92:95]
ds_read_b64_tr_b16 a[180:181], v10 offset:0
v_mfma_f32_16x16x32_bf16 a[96:99], a[184:187], a[192:195], a[96:99]
buffer_store_dwordx4 v[72:75], v13, s[8:11], s29 offen sc1
ds_read_b64_tr_b16 a[182:183], v10 offset:1024
v_mfma_f32_16x16x32_bf16 a[100:103], a[184:187], a[196:199], a[100:103]
v_xor_b32 v10, 144, v5
v_mfma_f32_16x16x32_bf16 a[104:107], a[184:187], a[200:203], a[104:107]
s_add_u32 s48, s48, s34
v_mfma_f32_16x16x32_bf16 a[108:111], a[184:187], a[204:207], a[108:111]
s_add_u32 m0, s32, 28672
v_mfma_f32_16x16x32_bf16 a[112:115], a[184:187], a[208:211], a[112:115]
buffer_load_dwordx4 v1, s[12:15], s48 offen lds
v_mfma_f32_16x16x32_bf16 a[116:119], a[184:187], a[212:215], a[116:119]
s_add_u32 s30, s30, 128
v_mfma_f32_16x16x32_bf16 a[120:123], a[184:187], a[216:219], a[120:123]
s_add_u32 s32, s32, 32768
v_mfma_f32_16x16x32_bf16 a[124:127], a[184:187], a[220:223], a[124:127]
s_sub_u32 s48, s32, 98304
ds_read_b64_tr_b16 a[184:185], v11 offset:0
v_mfma_f32_16x16x32_bf16 a[128:131], a[188:191], a[192:195], a[128:131]
s_cmp_ge_u32 s32, 163840
s_cselect_b32 s32, s48, s32
ds_read_b64_tr_b16 a[186:187], v11 offset:1024
v_mfma_f32_16x16x32_bf16 a[132:135], a[188:191], a[196:199], a[132:135]
v_xor_b32 v11, 192, v5
v_mfma_f32_16x16x32_bf16 a[136:139], a[188:191], a[200:203], a[136:139]
buffer_load_dword v15, v14, s[96:99], s100 offen
v_mfma_f32_16x16x32_bf16 a[140:143], a[188:191], a[204:207], a[140:143]
s_add_u32 s100, s100, 16384
v_mfma_f32_16x16x32_bf16 a[144:147], a[188:191], a[208:211], a[144:147]
v_mfma_f32_16x16x32_bf16 a[148:151], a[188:191], a[212:215], a[148:151]
v_mfma_f32_16x16x32_bf16 a[152:155], a[188:191], a[216:219], a[152:155]
v_mfma_f32_16x16x32_bf16 a[156:159], a[188:191], a[220:223], a[156:159]
s_waitcnt vmcnt(23) lgkmcnt(0)
s_barrier
v_mfma_f32_16x16x32_bf16 v[160:163], a[160:163], a[224:227], v[160:163]
ds_read_b128 a[192:195], v3 offset:0
v_mfma_f32_16x16x32_bf16 v[164:167], a[160:163], a[228:231], v[164:167]
s_add_u32 s37, s31, 0
v_mfma_f32_16x16x32_bf16 v[168:171], a[160:163], a[232:235], v[168:171]
s_add_u32 m0, s33, 0
ds_read_b128 a[196:199], v4 offset:1024
v_mfma_f32_16x16x32_bf16 v[172:175], a[160:163], a[236:239], v[172:175]
buffer_load_dwordx4 v2, s[20:23], s37 offen  lds
v_mfma_f32_16x16x32_bf16 v[176:179], a[160:163], a[240:243], v[176:179]
s_add_u32 s29, s29, s44
ds_read_b128 a[200:203], v3 offset:4096
v_mfma_f32_16x16x32_bf16 v[180:183], a[160:163], a[244:247], v[180:183]
v_mfma_f32_16x16x32_bf16 v[184:187], a[160:163], a[248:251], v[184:187]
buffer_store_dwordx4 v[76:79], v13, s[8:11], s29 offen sc1
v_mfma_f32_16x16x32_bf16 v[188:191], a[160:163], a[252:255], v[188:191]
ds_read_b64_tr_b16 a[160:161], v5 offset:0
v_mfma_f32_16x16x32_bf16 v[192:195], a[164:167], a[224:227], v[192:195]
s_add_u32 s37, s31, 32768
ds_read_b64_tr_b16 a[162:163], v5 offset:1024
v_mfma_f32_16x16x32_bf16 v[196:199], a[164:167], a[228:231], v[196:199]
s_add_u32 m0, s33, 1024
ds_read_b128 a[204:207], v4 offset:5120
v_add_u32 v5, 16384, v5
v_mfma_f32_16x16x32_bf16 v[200:203], a[164:167], a[232:235], v[200:203]
buffer_load_dwordx4 v2, s[20:23], s37 offen  lds
v_and_b32 v5, 65535, v5
v_mfma_f32_16x16x32_bf16 v[204:207], a[164:167], a[236:239], v[204:207]
ds_read_b128 a[208:211], v3 offset:8192
v_mfma_f32_16x16x32_bf16 v[208:211], a[164:167], a[240:243], v[208:211]
v_mfma_f32_16x16x32_bf16 v[212:215], a[164:167], a[244:247], v[212:215]
ds_read_b128 a[212:215], v4 offset:9216
v_mfma_f32_16x16x32_bf16 v[216:219], a[164:167], a[248:251], v[216:219]
v_mfma_f32_16x16x32_bf16 v[220:223], a[164:167], a[252:255], v[220:223]
s_add_u32 s37, s31, 131072
ds_read_b64_tr_b16 a[164:165], v6 offset:0
v_mfma_f32_16x16x32_bf16 v[224:227], a[168:171], a[224:227], v[224:227]
s_add_u32 m0, s33, 4096
ds_read_b64_tr_b16 a[166:167], v6 offset:1024
v_mfma_f32_16x16x32_bf16 v[228:231], a[168:171], a[228:231], v[228:231]
buffer_load_dwordx4 v2, s[20:23], s37 offen  lds
v_xor_b32 v6, 16, v5
v_mfma_f32_16x16x32_bf16 v[232:235], a[168:171], a[232:235], v[232:235]
ds_read_b128 a[216:219], v3 offset:12288
v_mfma_f32_16x16x32_bf16 v[236:239], a[168:171], a[236:239], v[236:239]
v_mfma_f32_16x16x32_bf16 v[240:243], a[168:171], a[240:243], v[240:243]
ds_read_b128 a[220:223], v4 offset:13312
v_mfma_f32_16x16x32_bf16 v[244:247], a[168:171], a[244:247], v[244:247]
v_mfma_f32_16x16x32_bf16 v[248:251], a[168:171], a[248:251], v[248:251]
s_add_u32 s37, s31, 163840
ds_read_b64_tr_b16 a[188:189], v12 offset:0
v_mfma_f32_16x16x32_bf16 v[252:255], a[168:171], a[252:255], v[252:255]
s_add_u32 m0, s33, 5120
ds_read_b64_tr_b16 a[168:169], v7 offset:0
v_mfma_f32_16x16x32_bf16 a[0:3], a[172:175], a[224:227], a[0:3]
buffer_load_dwordx4 v2, s[20:23], s37 offen  lds
ds_read_b64_tr_b16 a[170:171], v7 offset:1024
v_mfma_f32_16x16x32_bf16 a[4:7], a[172:175], a[228:231], a[4:7]
s_add_u32 s31, s31, 262144
s_add_u32 s29, s29, s93
v_xor_b32 v7, 64, v5
v_mfma_f32_16x16x32_bf16 a[8:11], a[172:175], a[232:235], a[8:11]
s_add_u32 s33, s33, 16384
ds_read_b64_tr_b16 a[190:191], v12 offset:1024
v_mfma_f32_16x16x32_bf16 a[12:15], a[172:175], a[236:239], a[12:15]
s_and_b32 s33, s33, 65535
buffer_store_dwordx4 v[80:83], v13, s[8:11], s29 offen sc1
v_mfma_f32_16x16x32_bf16 a[16:19], a[172:175], a[240:243], a[16:19]
v_mfma_f32_16x16x32_bf16 a[20:23], a[172:175], a[244:247], a[20:23]
s_mov_b32 s48, s30
v_xor_b32 v12, 208, v5
v_mfma_f32_16x16x32_bf16 a[24:27], a[172:175], a[248:251], a[24:27]
s_add_u32 m0, s32, 0
v_mfma_f32_16x16x32_bf16 a[28:31], a[172:175], a[252:255], a[28:31]
buffer_load_dwordx4 v1, s[12:15], s48 offen lds
ds_read_b64_tr_b16 a[172:173], v8 offset:0
v_mfma_f32_16x16x32_bf16 a[32:35], a[176:179], a[224:227], a[32:35]
ds_read_b64_tr_b16 a[174:175], v8 offset:1024
v_mfma_f32_16x16x32_bf16 a[36:39], a[176:179], a[228:231], a[36:39]
v_xor_b32 v8, 80, v5
v_mfma_f32_16x16x32_bf16 a[40:43], a[176:179], a[232:235], a[40:43]
v_mfma_f32_16x16x32_bf16 a[44:47], a[176:179], a[236:239], a[44:47]
v_mfma_f32_16x16x32_bf16 a[48:51], a[176:179], a[240:243], a[48:51]
s_add_u32 s48, s48, s34
v_mfma_f32_16x16x32_bf16 a[52:55], a[176:179], a[244:247], a[52:55]
s_add_u32 m0, s32, 4096
v_mfma_f32_16x16x32_bf16 a[56:59], a[176:179], a[248:251], a[56:59]
buffer_load_dwordx4 v1, s[12:15], s48 offen lds
v_mfma_f32_16x16x32_bf16 a[60:63], a[176:179], a[252:255], a[60:63]
ds_read_b64_tr_b16 a[176:177], v9 offset:0
v_mfma_f32_16x16x32_bf16 a[64:67], a[180:183], a[224:227], a[64:67]
ds_read_b64_tr_b16 a[178:179], v9 offset:1024
v_mfma_f32_16x16x32_bf16 a[68:71], a[180:183], a[228:231], a[68:71]
v_xor_b32 v9, 128, v5
v_mfma_f32_16x16x32_bf16 a[72:75], a[180:183], a[232:235], a[72:75]
v_mfma_f32_16x16x32_bf16 a[76:79], a[180:183], a[236:239], a[76:79]
s_add_u32 s48, s48, s34
v_mfma_f32_16x16x32_bf16 a[80:83], a[180:183], a[240:243], a[80:83]
s_add_u32 m0, s32, 8192
v_mfma_f32_16x16x32_bf16 a[84:87], a[180:183], a[244:247], a[84:87]
buffer_load_dwordx4 v1, s[12:15], s48 offen lds
v_mfma_f32_16x16x32_bf16 a[88:91], a[180:183], a[248:251], a[88:91]
s_add_u32 s29, s29, s44
v_mfma_f32_16x16x32_bf16 a[92:95], a[180:183], a[252:255], a[92:95]
ds_read_b64_tr_b16 a[180:181], v10 offset:0
v_mfma_f32_16x16x32_bf16 a[96:99], a[184:187], a[224:227], a[96:99]
buffer_store_dwordx4 v[84:87], v13, s[8:11], s29 offen sc1
ds_read_b64_tr_b16 a[182:183], v10 offset:1024
v_mfma_f32_16x16x32_bf16 a[100:103], a[184:187], a[228:231], a[100:103]
v_xor_b32 v10, 144, v5
v_mfma_f32_16x16x32_bf16 a[104:107], a[184:187], a[232:235], a[104:107]
s_add_u32 s48, s48, s34
v_mfma_f32_16x16x32_bf16 a[108:111], a[184:187], a[236:239], a[108:111]
s_add_u32 m0, s32, 12288
v_mfma_f32_16x16x32_bf16 a[112:115], a[184:187], a[240:243], a[112:115]
buffer_load_dwordx4 v1, s[12:15], s48 offen lds
v_mfma_f32_16x16x32_bf16 a[116:119], a[184:187], a[244:247], a[116:119]
v_mfma_f32_16x16x32_bf16 a[120:123], a[184:187], a[248:251], a[120:123]
v_mfma_f32_16x16x32_bf16 a[124:127], a[184:187], a[252:255], a[124:127]
ds_read_b64_tr_b16 a[184:185], v11 offset:0
v_mfma_f32_16x16x32_bf16 a[128:131], v[28:31], a[224:227], a[128:131]
ds_read_b64_tr_b16 a[186:187], v11 offset:1024
v_mfma_f32_16x16x32_bf16 a[132:135], v[28:31], a[228:231], a[132:135]
v_xor_b32 v11, 192, v5
v_mfma_f32_16x16x32_bf16 a[136:139], v[28:31], a[232:235], a[136:139]
buffer_load_dword v15, v14, s[96:99], s100 offen
v_mfma_f32_16x16x32_bf16 a[140:143], v[28:31], a[236:239], a[140:143]
s_add_u32 s100, s100, 16384
v_mfma_f32_16x16x32_bf16 a[144:147], v[28:31], a[240:243], a[144:147]
v_mfma_f32_16x16x32_bf16 a[148:151], v[28:31], a[244:247], a[148:151]
v_mfma_f32_16x16x32_bf16 a[152:155], v[28:31], a[248:251], a[152:155]
v_mfma_f32_16x16x32_bf16 a[156:159], v[28:31], a[252:255], a[156:159]
s_waitcnt vmcnt(24) lgkmcnt(0)
s_barrier
v_mfma_f32_16x16x32_bf16 v[160:163], a[160:163], a[192:195], v[160:163]
ds_read_b128 a[224:227], v4 offset:0
v_mfma_f32_16x16x32_bf16 v[164:167], a[160:163], a[196:199], v[164:167]
s_add_u32 s37, s31, 0
v_mfma_f32_16x16x32_bf16 v[168:171], a[160:163], a[200:203], v[168:171]
s_add_u32 m0, s33, 0
ds_read_b128 a[228:231], v3 offset:1024
v_mfma_f32_16x16x32_bf16 v[172:175], a[160:163], a[204:207], v[172:175]
buffer_load_dwordx4 v2, s[20:23], s37 offen  lds
v_mfma_f32_16x16x32_bf16 v[176:179], a[160:163], a[208:211], v[176:179]
s_add_u32 s29, s29, s93
ds_read_b128 a[232:235], v4 offset:4096
v_mfma_f32_16x16x32_bf16 v[180:183], a[160:163], a[212:215], v[180:183]
v_mfma_f32_16x16x32_bf16 v[184:187], a[160:163], a[216:219], v[184:187]
buffer_store_dwordx4 v[88:91], v13, s[8:11], s29 offen sc1
v_mfma_f32_16x16x32_bf16 v[188:191], a[160:163], a[220:223], v[188:191]
ds_read_b64_tr_b16 a[160:161], v5 offset:0
v_mfma_f32_16x16x32_bf16 v[192:195], a[164:167], a[192:195], v[192:195]
s_add_u32 s37, s31, 32768
ds_read_b64_tr_b16 a[162:163], v5 offset:1024
v_mfma_f32_16x16x32_bf16 v[196:199], a[164:167], a[196:199], v[196:199]
s_add_u32 m0, s33, 1024
ds_read_b128 a[236:239], v3 offset:5120
v_add_u32 v5, 16384, v5
v_mfma_f32_16x16x32_bf16 v[200:203], a[164:167], a[200:203], v[200:203]
buffer_load_dwordx4 v2, s[20:23], s37 offen  lds
v_and_b32 v5, 65535, v5
v_mfma_f32_16x16x32_bf16 v[204:207], a[164:167], a[204:207], v[204:207]
ds_read_b128 a[240:243], v4 offset:8192
v_mfma_f32_16x16x32_bf16 v[208:211], a[164:167], a[208:211], v[208:211]
v_mfma_f32_16x16x32_bf16 v[212:215], a[164:167], a[212:215], v[212:215]
ds_read_b128 a[244:247], v3 offset:9216
v_mfma_f32_16x16x32_bf16 v[216:219], a[164:167], a[216:219], v[216:219]
v_mfma_f32_16x16x32_bf16 v[220:223], a[164:167], a[220:223], v[220:223]
s_add_u32 s37, s31, 131072
ds_read_b64_tr_b16 a[164:165], v6 offset:0
v_mfma_f32_16x16x32_bf16 v[224:227], a[168:171], a[192:195], v[224:227]
s_add_u32 m0, s33, 4096
ds_read_b64_tr_b16 a[166:167], v6 offset:1024
v_mfma_f32_16x16x32_bf16 v[228:231], a[168:171], a[196:199], v[228:231]
buffer_load_dwordx4 v2, s[20:23], s37 offen  lds
v_xor_b32 v6, 16, v5
v_mfma_f32_16x16x32_bf16 v[232:235], a[168:171], a[200:203], v[232:235]
ds_read_b128 a[248:251], v4 offset:12288
v_mfma_f32_16x16x32_bf16 v[236:239], a[168:171], a[204:207], v[236:239]
v_mfma_f32_16x16x32_bf16 v[240:243], a[168:171], a[208:211], v[240:243]
ds_read_b128 a[252:255], v3 offset:13312
v_mfma_f32_16x16x32_bf16 v[244:247], a[168:171], a[212:215], v[244:247]
v_mfma_f32_16x16x32_bf16 v[248:251], a[168:171], a[216:219], v[248:251]
s_add_u32 s37, s31, 163840
ds_read_b64_tr_b16 v[28:29], v12 offset:0
v_mfma_f32_16x16x32_bf16 v[252:255], a[168:171], a[220:223], v[252:255]
s_add_u32 m0, s33, 5120
ds_read_b64_tr_b16 a[168:169], v7 offset:0
v_mfma_f32_16x16x32_bf16 a[0:3], a[172:175], a[192:195], a[0:3]
buffer_load_dwordx4 v2, s[20:23], s37 offen  lds
ds_read_b64_tr_b16 a[170:171], v7 offset:1024
v_mfma_f32_16x16x32_bf16 a[4:7], a[172:175], a[196:199], a[4:7]
s_add_u32 s31, s31, 262144
s_add_u32 s29, s29, s44
v_xor_b32 v7, 64, v5
v_mfma_f32_16x16x32_bf16 a[8:11], a[172:175], a[200:203], a[8:11]
s_add_u32 s33, s33, 16384
ds_read_b64_tr_b16 v[30:31], v12 offset:1024
v_mfma_f32_16x16x32_bf16 a[12:15], a[172:175], a[204:207], a[12:15]
s_and_b32 s33, s33, 65535
buffer_store_dwordx4 v[92:95], v13, s[8:11], s29 offen sc1
v_mfma_f32_16x16x32_bf16 a[16:19], a[172:175], a[208:211], a[16:19]
v_mfma_f32_16x16x32_bf16 a[20:23], a[172:175], a[212:215], a[20:23]
s_add_u32 s48, s48, s34
v_xor_b32 v12, 208, v5
v_mfma_f32_16x16x32_bf16 a[24:27], a[172:175], a[216:219], a[24:27]
s_add_u32 m0, s32, 16384
v_add_u32 v3, 32768, v3
v_mfma_f32_16x16x32_bf16 a[28:31], a[172:175], a[220:223], a[28:31]
buffer_load_dwordx4 v1, s[12:15], s48 offen lds
ds_read_b64_tr_b16 a[172:173], v8 offset:0
v_mfma_f32_16x16x32_bf16 a[32:35], a[176:179], a[192:195], a[32:35]
ds_read_b64_tr_b16 a[174:175], v8 offset:1024
v_subrev_u32 v19, 98304, v3
v_mfma_f32_16x16x32_bf16 a[36:39], a[176:179], a[196:199], a[36:39]
v_xor_b32 v8, 80, v5
v_cmp_le_u32 vcc, 163840, v3
v_mfma_f32_16x16x32_bf16 a[40:43], a[176:179], a[200:203], a[40:43]
s_nop 0
v_cndmask_b32 v3, v3, v19, vcc
v_mfma_f32_16x16x32_bf16 a[44:47], a[176:179], a[204:207], a[44:47]
v_xor_b32 v4, 64, v3
v_mfma_f32_16x16x32_bf16 a[48:51], a[176:179], a[208:211], a[48:51]
s_add_u32 s48, s48, s34
v_mfma_f32_16x16x32_bf16 a[52:55], a[176:179], a[212:215], a[52:55]
s_add_u32 m0, s32, 20480
v_mfma_f32_16x16x32_bf16 a[56:59], a[176:179], a[216:219], a[56:59]
buffer_load_dwordx4 v1, s[12:15], s48 offen lds
v_mfma_f32_16x16x32_bf16 a[60:63], a[176:179], a[220:223], a[60:63]
ds_read_b64_tr_b16 a[176:177], v9 offset:0
v_mfma_f32_16x16x32_bf16 a[64:67], a[180:183], a[192:195], a[64:67]
ds_read_b64_tr_b16 a[178:179], v9 offset:1024
v_mfma_f32_16x16x32_bf16 a[68:71], a[180:183], a[196:199], a[68:71]
v_xor_b32 v9, 128, v5
v_mfma_f32_16x16x32_bf16 a[72:75], a[180:183], a[200:203], a[72:75]
v_mfma_f32_16x16x32_bf16 a[76:79], a[180:183], a[204:207], a[76:79]
s_add_u32 s48, s48, s34
v_mfma_f32_16x16x32_bf16 a[80:83], a[180:183], a[208:211], a[80:83]
s_add_u32 m0, s32, 24576
v_mfma_f32_16x16x32_bf16 a[84:87], a[180:183], a[212:215], a[84:87]
buffer_load_dwordx4 v1, s[12:15], s48 offen lds
v_mfma_f32_16x16x32_bf16 a[88:91], a[180:183], a[216:219], a[88:91]
v_mfma_f32_16x16x32_bf16 a[92:95], a[180:183], a[220:223], a[92:95]
ds_read_b64_tr_b16 a[180:181], v10 offset:0
v_mfma_f32_16x16x32_bf16 a[96:99], a[184:187], a[192:195], a[96:99]
ds_read_b64_tr_b16 a[182:183], v10 offset:1024
v_mfma_f32_16x16x32_bf16 a[100:103], a[184:187], a[196:199], a[100:103]
v_xor_b32 v10, 144, v5
v_mfma_f32_16x16x32_bf16 a[104:107], a[184:187], a[200:203], a[104:107]
s_add_u32 s48, s48, s34
v_mfma_f32_16x16x32_bf16 a[108:111], a[184:187], a[204:207], a[108:111]
s_add_u32 m0, s32, 28672
v_mfma_f32_16x16x32_bf16 a[112:115], a[184:187], a[208:211], a[112:115]
buffer_load_dwordx4 v1, s[12:15], s48 offen lds
v_mfma_f32_16x16x32_bf16 a[116:119], a[184:187], a[212:215], a[116:119]
s_add_u32 s30, s30, 128
v_mfma_f32_16x16x32_bf16 a[120:123], a[184:187], a[216:219], a[120:123]
s_add_u32 s32, s32, 32768
v_mfma_f32_16x16x32_bf16 a[124:127], a[184:187], a[220:223], a[124:127]
s_sub_u32 s48, s32, 98304
ds_read_b64_tr_b16 a[184:185], v11 offset:0
v_mfma_f32_16x16x32_bf16 a[128:131], a[188:191], a[192:195], a[128:131]
s_cmp_ge_u32 s32, 163840
s_cselect_b32 s32, s48, s32
ds_read_b64_tr_b16 a[186:187], v11 offset:1024
v_mfma_f32_16x16x32_bf16 a[132:135], a[188:191], a[196:199], a[132:135]
v_xor_b32 v11, 192, v5
v_mfma_f32_16x16x32_bf16 a[136:139], a[188:191], a[200:203], a[136:139]
buffer_load_dword v15, v14, s[96:99], s100 offen
v_mfma_f32_16x16x32_bf16 a[140:143], a[188:191], a[204:207], a[140:143]
s_add_u32 s100, s100, 16384
v_mfma_f32_16x16x32_bf16 a[144:147], a[188:191], a[208:211], a[144:147]
v_mfma_f32_16x16x32_bf16 a[148:151], a[188:191], a[212:215], a[148:151]
v_mfma_f32_16x16x32_bf16 a[152:155], a[188:191], a[216:219], a[152:155]
v_mfma_f32_16x16x32_bf16 a[156:159], a[188:191], a[220:223], a[156:159]
s_waitcnt vmcnt(23) lgkmcnt(0)
s_barrier
v_mfma_f32_16x16x32_bf16 v[160:163], a[160:163], a[224:227], v[160:163]
ds_read_b128 a[192:195], v3 offset:0
v_mfma_f32_16x16x32_bf16 v[164:167], a[160:163], a[228:231], v[164:167]
s_add_u32 s37, s31, 0
v_mfma_f32_16x16x32_bf16 v[168:171], a[160:163], a[232:235], v[168:171]
s_add_u32 m0, s33, 0
ds_read_b128 a[196:199], v4 offset:1024
v_mfma_f32_16x16x32_bf16 v[172:175], a[160:163], a[236:239], v[172:175]
buffer_load_dwordx4 v2, s[20:23], s37 offen  lds
v_mfma_f32_16x16x32_bf16 v[176:179], a[160:163], a[240:243], v[176:179]
s_add_u32 s60, s60, s92
ds_read_b128 a[200:203], v3 offset:4096
v_mfma_f32_16x16x32_bf16 v[180:183], a[160:163], a[244:247], v[180:183]
s_mov_b32 s29, s60
v_mfma_f32_16x16x32_bf16 v[184:187], a[160:163], a[248:251], v[184:187]
buffer_store_dwordx4 v[96:99], v13, s[8:11], s29 offen sc1
v_mfma_f32_16x16x32_bf16 v[188:191], a[160:163], a[252:255], v[188:191]
ds_read_b64_tr_b16 a[160:161], v5 offset:0
v_mfma_f32_16x16x32_bf16 v[192:195], a[164:167], a[224:227], v[192:195]
s_add_u32 s37, s31, 32768
ds_read_b64_tr_b16 a[162:163], v5 offset:1024
v_mfma_f32_16x16x32_bf16 v[196:199], a[164:167], a[228:231], v[196:199]
s_add_u32 m0, s33, 1024
ds_read_b128 a[204:207], v4 offset:5120
v_add_u32 v5, 16384, v5
v_mfma_f32_16x16x32_bf16 v[200:203], a[164:167], a[232:235], v[200:203]
buffer_load_dwordx4 v2, s[20:23], s37 offen  lds
v_and_b32 v5, 65535, v5
v_mfma_f32_16x16x32_bf16 v[204:207], a[164:167], a[236:239], v[204:207]
ds_read_b128 a[208:211], v3 offset:8192
v_mfma_f32_16x16x32_bf16 v[208:211], a[164:167], a[240:243], v[208:211]
v_mfma_f32_16x16x32_bf16 v[212:215], a[164:167], a[244:247], v[212:215]
ds_read_b128 a[212:215], v4 offset:9216
v_mfma_f32_16x16x32_bf16 v[216:219], a[164:167], a[248:251], v[216:219]
v_mfma_f32_16x16x32_bf16 v[220:223], a[164:167], a[252:255], v[220:223]
s_add_u32 s37, s31, 131072
ds_read_b64_tr_b16 a[164:165], v6 offset:0
v_mfma_f32_16x16x32_bf16 v[224:227], a[168:171], a[224:227], v[224:227]
s_add_u32 m0, s33, 4096
ds_read_b64_tr_b16 a[166:167], v6 offset:1024
v_mfma_f32_16x16x32_bf16 v[228:231], a[168:171], a[228:231], v[228:231]
buffer_load_dwordx4 v2, s[20:23], s37 offen  lds
v_xor_b32 v6, 16, v5
v_mfma_f32_16x16x32_bf16 v[232:235], a[168:171], a[232:235], v[232:235]
ds_read_b128 a[216:219], v3 offset:12288
v_mfma_f32_16x16x32_bf16 v[236:239], a[168:171], a[236:239], v[236:239]
v_mfma_f32_16x16x32_bf16 v[240:243], a[168:171], a[240:243], v[240:243]
ds_read_b128 a[220:223], v4 offset:13312
v_mfma_f32_16x16x32_bf16 v[244:247], a[168:171], a[244:247], v[244:247]
v_mfma_f32_16x16x32_bf16 v[248:251], a[168:171], a[248:251], v[248:251]
s_add_u32 s37, s31, 163840
ds_read_b64_tr_b16 a[188:189], v12 offset:0
v_mfma_f32_16x16x32_bf16 v[252:255], a[168:171], a[252:255], v[252:255]
s_add_u32 m0, s33, 5120
ds_read_b64_tr_b16 a[168:169], v7 offset:0
v_mfma_f32_16x16x32_bf16 a[0:3], a[172:175], a[224:227], a[0:3]
buffer_load_dwordx4 v2, s[20:23], s37 offen  lds
ds_read_b64_tr_b16 a[170:171], v7 offset:1024
v_mfma_f32_16x16x32_bf16 a[4:7], a[172:175], a[228:231], a[4:7]
s_add_u32 s31, s31, 262144
s_add_u32 s29, s29, s44
v_xor_b32 v7, 64, v5
v_mfma_f32_16x16x32_bf16 a[8:11], a[172:175], a[232:235], a[8:11]
s_add_u32 s33, s33, 16384
ds_read_b64_tr_b16 a[190:191], v12 offset:1024
v_mfma_f32_16x16x32_bf16 a[12:15], a[172:175], a[236:239], a[12:15]
s_and_b32 s33, s33, 65535
buffer_store_dwordx4 v[100:103], v13, s[8:11], s29 offen sc1
v_mfma_f32_16x16x32_bf16 a[16:19], a[172:175], a[240:243], a[16:19]
v_mfma_f32_16x16x32_bf16 a[20:23], a[172:175], a[244:247], a[20:23]
s_mov_b32 s48, s30
v_xor_b32 v12, 208, v5
v_mfma_f32_16x16x32_bf16 a[24:27], a[172:175], a[248:251], a[24:27]
s_add_u32 m0, s32, 0
v_mfma_f32_16x16x32_bf16 a[28:31], a[172:175], a[252:255], a[28:31]
buffer_load_dwordx4 v1, s[12:15], s48 offen lds
ds_read_b64_tr_b16 a[172:173], v8 offset:0
v_mfma_f32_16x16x32_bf16 a[32:35], a[176:179], a[224:227], a[32:35]
ds_read_b64_tr_b16 a[174:175], v8 offset:1024
v_mfma_f32_16x16x32_bf16 a[36:39], a[176:179], a[228:231], a[36:39]
v_xor_b32 v8, 80, v5
v_mfma_f32_16x16x32_bf16 a[40:43], a[176:179], a[232:235], a[40:43]
v_mfma_f32_16x16x32_bf16 a[44:47], a[176:179], a[236:239], a[44:47]
v_mfma_f32_16x16x32_bf16 a[48:51], a[176:179], a[240:243], a[48:51]
s_add_u32 s48, s48, s34
v_mfma_f32_16x16x32_bf16 a[52:55], a[176:179], a[244:247], a[52:55]
s_add_u32 m0, s32, 4096
v_mfma_f32_16x16x32_bf16 a[56:59], a[176:179], a[248:251], a[56:59]
buffer_load_dwordx4 v1, s[12:15], s48 offen lds
v_mfma_f32_16x16x32_bf16 a[60:63], a[176:179], a[252:255], a[60:63]
ds_read_b64_tr_b16 a[176:177], v9 offset:0
v_mfma_f32_16x16x32_bf16 a[64:67], a[180:183], a[224:227], a[64:67]
ds_read_b64_tr_b16 a[178:179], v9 offset:1024
v_mfma_f32_16x16x32_bf16 a[68:71], a[180:183], a[228:231], a[68:71]
v_xor_b32 v9, 128, v5
v_mfma_f32_16x16x32_bf16 a[72:75], a[180:183], a[232:235], a[72:75]
v_mfma_f32_16x16x32_bf16 a[76:79], a[180:183], a[236:239], a[76:79]
s_add_u32 s48, s48, s34
v_mfma_f32_16x16x32_bf16 a[80:83], a[180:183], a[240:243], a[80:83]
s_add_u32 m0, s32, 8192
v_mfma_f32_16x16x32_bf16 a[84:87], a[180:183], a[244:247], a[84:87]
buffer_load_dwordx4 v1, s[12:15], s48 offen lds
v_mfma_f32_16x16x32_bf16 a[88:91], a[180:183], a[248:251], a[88:91]
s_add_u32 s29, s29, s93
v_mfma_f32_16x16x32_bf16 a[92:95], a[180:183], a[252:255], a[92:95]
ds_read_b64_tr_b16 a[180:181], v10 offset:0
v_mfma_f32_16x16x32_bf16 a[96:99], a[184:187], a[224:227], a[96:99]
buffer_store_dwordx4 v[104:107], v13, s[8:11], s29 offen sc1
ds_read_b64_tr_b16 a[182:183], v10 offset:1024
v_mfma_f32_16x16x32_bf16 a[100:103], a[184:187], a[228:231], a[100:103]
v_xor_b32 v10, 144, v5
v_mfma_f32_16x16x32_bf16 a[104:107], a[184:187], a[232:235], a[104:107]
s_add_u32 s48, s48, s34
v_mfma_f32_16x16x32_bf16 a[108:111], a[184:187], a[236:239], a[108:111]
s_add_u32 m0, s32, 12288
v_mfma_f32_16x16x32_bf16 a[112:115], a[184:187], a[240:243], a[112:115]
buffer_load_dwordx4 v1, s[12:15], s48 offen lds
v_mfma_f32_16x16x32_bf16 a[116:119], a[184:187], a[244:247], a[116:119]
v_mfma_f32_16x16x32_bf16 a[120:123], a[184:187], a[248:251], a[120:123]
v_mfma_f32_16x16x32_bf16 a[124:127], a[184:187], a[252:255], a[124:127]
ds_read_b64_tr_b16 a[184:185], v11 offset:0
v_mfma_f32_16x16x32_bf16 a[128:131], v[28:31], a[224:227], a[128:131]
ds_read_b64_tr_b16 a[186:187], v11 offset:1024
v_mfma_f32_16x16x32_bf16 a[132:135], v[28:31], a[228:231], a[132:135]
v_xor_b32 v11, 192, v5
v_mfma_f32_16x16x32_bf16 a[136:139], v[28:31], a[232:235], a[136:139]
buffer_load_dword v15, v14, s[96:99], s100 offen
v_mfma_f32_16x16x32_bf16 a[140:143], v[28:31], a[236:239], a[140:143]
s_add_u32 s100, s100, 16384
v_mfma_f32_16x16x32_bf16 a[144:147], v[28:31], a[240:243], a[144:147]
v_mfma_f32_16x16x32_bf16 a[148:151], v[28:31], a[244:247], a[148:151]
v_mfma_f32_16x16x32_bf16 a[152:155], v[28:31], a[248:251], a[152:155]
v_mfma_f32_16x16x32_bf16 a[156:159], v[28:31], a[252:255], a[156:159]
s_waitcnt vmcnt(23) lgkmcnt(0)
s_barrier
v_mfma_f32_16x16x32_bf16 v[160:163], a[160:163], a[192:195], v[160:163]
ds_read_b128 a[224:227], v4 offset:0
v_mfma_f32_16x16x32_bf16 v[164:167], a[160:163], a[196:199], v[164:167]
s_add_u32 s37, s31, 0
v_mfma_f32_16x16x32_bf16 v[168:171], a[160:163], a[200:203], v[168:171]
s_add_u32 m0, s33, 0
ds_read_b128 a[228:231], v3 offset:1024
v_mfma_f32_16x16x32_bf16 v[172:175], a[160:163], a[204:207], v[172:175]
buffer_load_dwordx4 v2, s[20:23], s37 offen  lds
v_mfma_f32_16x16x32_bf16 v[176:179], a[160:163], a[208:211], v[176:179]
s_add_u32 s29, s29, s44
ds_read_b128 a[232:235], v4 offset:4096
v_mfma_f32_16x16x32_bf16 v[180:183], a[160:163], a[212:215], v[180:183]
v_mfma_f32_16x16x32_bf16 v[184:187], a[160:163], a[216:219], v[184:187]
buffer_store_dwordx4 v[108:111], v13, s[8:11], s29 offen sc1
v_mfma_f32_16x16x32_bf16 v[188:191], a[160:163], a[220:223], v[188:191]
ds_read_b64_tr_b16 a[160:161], v5 offset:0
v_mfma_f32_16x16x32_bf16 v[192:195], a[164:167], a[192:195], v[192:195]
s_add_u32 s37, s31, 32768
ds_read_b64_tr_b16 a[162:163], v5 offset:1024
v_mfma_f32_16x16x32_bf16 v[196:199], a[164:167], a[196:199], v[196:199]
s_add_u32 m0, s33, 1024
ds_read_b128 a[236:239], v3 offset:5120
v_add_u32 v5, 16384, v5
v_mfma_f32_16x16x32_bf16 v[200:203], a[164:167], a[200:203], v[200:203]
buffer_load_dwordx4 v2, s[20:23], s37 offen  lds
v_and_b32 v5, 65535, v5
v_mfma_f32_16x16x32_bf16 v[204:207], a[164:167], a[204:207], v[204:207]
ds_read_b128 a[240:243], v4 offset:8192
v_mfma_f32_16x16x32_bf16 v[208:211], a[164:167], a[208:211], v[208:211]
v_mfma_f32_16x16x32_bf16 v[212:215], a[164:167], a[212:215], v[212:215]
ds_read_b128 a[244:247], v3 offset:9216
v_mfma_f32_16x16x32_bf16 v[216:219], a[164:167], a[216:219], v[216:219]
v_mfma_f32_16x16x32_bf16 v[220:223], a[164:167], a[220:223], v[220:223]
s_add_u32 s37, s31, 131072
ds_read_b64_tr_b16 a[164:165], v6 offset:0
v_mfma_f32_16x16x32_bf16 v[224:227], a[168:171], a[192:195], v[224:227]
s_add_u32 m0, s33, 4096
ds_read_b64_tr_b16 a[166:167], v6 offset:1024
v_mfma_f32_16x16x32_bf16 v[228:231], a[168:171], a[196:199], v[228:231]
buffer_load_dwordx4 v2, s[20:23], s37 offen  lds
v_xor_b32 v6, 16, v5
v_mfma_f32_16x16x32_bf16 v[232:235], a[168:171], a[200:203], v[232:235]
ds_read_b128 a[248:251], v4 offset:12288
v_mfma_f32_16x16x32_bf16 v[236:239], a[168:171], a[204:207], v[236:239]
v_mfma_f32_16x16x32_bf16 v[240:243], a[168:171], a[208:211], v[240:243]
ds_read_b128 a[252:255], v3 offset:13312
v_mfma_f32_16x16x32_bf16 v[244:247], a[168:171], a[212:215], v[244:247]
v_mfma_f32_16x16x32_bf16 v[248:251], a[168:171], a[216:219], v[248:251]
s_add_u32 s37, s31, 163840
ds_read_b64_tr_b16 v[28:29], v12 offset:0
v_mfma_f32_16x16x32_bf16 v[252:255], a[168:171], a[220:223], v[252:255]
s_add_u32 m0, s33, 5120
ds_read_b64_tr_b16 a[168:169], v7 offset:0
v_mfma_f32_16x16x32_bf16 a[0:3], a[172:175], a[192:195], a[0:3]
buffer_load_dwordx4 v2, s[20:23], s37 offen  lds
ds_read_b64_tr_b16 a[170:171], v7 offset:1024
v_mfma_f32_16x16x32_bf16 a[4:7], a[172:175], a[196:199], a[4:7]
s_add_u32 s31, s31, 262144
s_add_u32 s29, s29, s93
v_xor_b32 v7, 64, v5
v_mfma_f32_16x16x32_bf16 a[8:11], a[172:175], a[200:203], a[8:11]
s_add_u32 s33, s33, 16384
ds_read_b64_tr_b16 v[30:31], v12 offset:1024
v_mfma_f32_16x16x32_bf16 a[12:15], a[172:175], a[204:207], a[12:15]
s_and_b32 s33, s33, 65535
buffer_store_dwordx4 v[112:115], v13, s[8:11], s29 offen sc1
v_mfma_f32_16x16x32_bf16 a[16:19], a[172:175], a[208:211], a[16:19]
v_mfma_f32_16x16x32_bf16 a[20:23], a[172:175], a[212:215], a[20:23]
s_add_u32 s48, s48, s34
v_xor_b32 v12, 208, v5
v_mfma_f32_16x16x32_bf16 a[24:27], a[172:175], a[216:219], a[24:27]
s_add_u32 m0, s32, 16384
v_add_u32 v3, 32768, v3
v_mfma_f32_16x16x32_bf16 a[28:31], a[172:175], a[220:223], a[28:31]
buffer_load_dwordx4 v1, s[12:15], s48 offen lds
ds_read_b64_tr_b16 a[172:173], v8 offset:0
v_mfma_f32_16x16x32_bf16 a[32:35], a[176:179], a[192:195], a[32:35]
ds_read_b64_tr_b16 a[174:175], v8 offset:1024
v_subrev_u32 v19, 98304, v3
v_mfma_f32_16x16x32_bf16 a[36:39], a[176:179], a[196:199], a[36:39]
v_xor_b32 v8, 80, v5
v_cmp_le_u32 vcc, 163840, v3
v_mfma_f32_16x16x32_bf16 a[40:43], a[176:179], a[200:203], a[40:43]
s_nop 0
v_cndmask_b32 v3, v3, v19, vcc
v_mfma_f32_16x16x32_bf16 a[44:47], a[176:179], a[204:207], a[44:47]
v_xor_b32 v4, 64, v3
v_mfma_f32_16x16x32_bf16 a[48:51], a[176:179], a[208:211], a[48:51]
s_add_u32 s48, s48, s34
v_mfma_f32_16x16x32_bf16 a[52:55], a[176:179], a[212:215], a[52:55]
s_add_u32 m0, s32, 20480
v_mfma_f32_16x16x32_bf16 a[56:59], a[176:179], a[216:219], a[56:59]
buffer_load_dwordx4 v1, s[12:15], s48 offen lds
v_mfma_f32_16x16x32_bf16 a[60:63], a[176:179], a[220:223], a[60:63]
ds_read_b64_tr_b16 a[176:177], v9 offset:0
v_mfma_f32_16x16x32_bf16 a[64:67], a[180:183], a[192:195], a[64:67]
ds_read_b64_tr_b16 a[178:179], v9 offset:1024
v_mfma_f32_16x16x32_bf16 a[68:71], a[180:183], a[196:199], a[68:71]
v_xor_b32 v9, 128, v5
v_mfma_f32_16x16x32_bf16 a[72:75], a[180:183], a[200:203], a[72:75]
v_mfma_f32_16x16x32_bf16 a[76:79], a[180:183], a[204:207], a[76:79]
s_add_u32 s48, s48, s34
v_mfma_f32_16x16x32_bf16 a[80:83], a[180:183], a[208:211], a[80:83]
s_add_u32 m0, s32, 24576
v_mfma_f32_16x16x32_bf16 a[84:87], a[180:183], a[212:215], a[84:87]
buffer_load_dwordx4 v1, s[12:15], s48 offen lds
v_mfma_f32_16x16x32_bf16 a[88:91], a[180:183], a[216:219], a[88:91]
s_add_u32 s29, s29, s44
v_mfma_f32_16x16x32_bf16 a[92:95], a[180:183], a[220:223], a[92:95]
ds_read_b64_tr_b16 a[180:181], v10 offset:0
v_mfma_f32_16x16x32_bf16 a[96:99], a[184:187], a[192:195], a[96:99]
buffer_store_dwordx4 v[116:119], v13, s[8:11], s29 offen sc1
ds_read_b64_tr_b16 a[182:183], v10 offset:1024
v_mfma_f32_16x16x32_bf16 a[100:103], a[184:187], a[196:199], a[100:103]
v_xor_b32 v10, 144, v5
v_mfma_f32_16x16x32_bf16 a[104:107], a[184:187], a[200:203], a[104:107]
s_add_u32 s48, s48, s34
v_mfma_f32_16x16x32_bf16 a[108:111], a[184:187], a[204:207], a[108:111]
s_add_u32 m0, s32, 28672
v_mfma_f32_16x16x32_bf16 a[112:115], a[184:187], a[208:211], a[112:115]
buffer_load_dwordx4 v1, s[12:15], s48 offen lds
v_mfma_f32_16x16x32_bf16 a[116:119], a[184:187], a[212:215], a[116:119]
s_add_u32 s30, s30, 128
v_mfma_f32_16x16x32_bf16 a[120:123], a[184:187], a[216:219], a[120:123]
s_add_u32 s32, s32, 32768
v_mfma_f32_16x16x32_bf16 a[124:127], a[184:187], a[220:223], a[124:127]
s_sub_u32 s48, s32, 98304
ds_read_b64_tr_b16 a[184:185], v11 offset:0
v_mfma_f32_16x16x32_bf16 a[128:131], a[188:191], a[192:195], a[128:131]
s_cmp_ge_u32 s32, 163840
s_cselect_b32 s32, s48, s32
ds_read_b64_tr_b16 a[186:187], v11 offset:1024
v_mfma_f32_16x16x32_bf16 a[132:135], a[188:191], a[196:199], a[132:135]
v_xor_b32 v11, 192, v5
v_mfma_f32_16x16x32_bf16 a[136:139], a[188:191], a[200:203], a[136:139]
buffer_load_dword v15, v14, s[96:99], s100 offen
v_mfma_f32_16x16x32_bf16 a[140:143], a[188:191], a[204:207], a[140:143]
s_add_u32 s100, s100, 16384
v_mfma_f32_16x16x32_bf16 a[144:147], a[188:191], a[208:211], a[144:147]
v_mfma_f32_16x16x32_bf16 a[148:151], a[188:191], a[212:215], a[148:151]
v_mfma_f32_16x16x32_bf16 a[152:155], a[188:191], a[216:219], a[152:155]
v_mfma_f32_16x16x32_bf16 a[156:159], a[188:191], a[220:223], a[156:159]
s_waitcnt vmcnt(24) lgkmcnt(0)
s_barrier
v_mfma_f32_16x16x32_bf16 v[160:163], a[160:163], a[224:227], v[160:163]
ds_read_b128 a[192:195], v3 offset:0
v_mfma_f32_16x16x32_bf16 v[164:167], a[160:163], a[228:231], v[164:167]
s_add_u32 s37, s31, 0
v_mfma_f32_16x16x32_bf16 v[168:171], a[160:163], a[232:235], v[168:171]
s_add_u32 m0, s33, 0
ds_read_b128 a[196:199], v4 offset:1024
v_mfma_f32_16x16x32_bf16 v[172:175], a[160:163], a[236:239], v[172:175]
buffer_load_dwordx4 v2, s[20:23], s37 offen  lds
v_mfma_f32_16x16x32_bf16 v[176:179], a[160:163], a[240:243], v[176:179]
s_add_u32 s29, s29, s93
ds_read_b128 a[200:203], v3 offset:4096
v_mfma_f32_16x16x32_bf16 v[180:183], a[160:163], a[244:247], v[180:183]
v_mfma_f32_16x16x32_bf16 v[184:187], a[160:163], a[248:251], v[184:187]
buffer_store_dwordx4 v[120:123], v13, s[8:11], s29 offen sc1
v_mfma_f32_16x16x32_bf16 v[188:191], a[160:163], a[252:255], v[188:191]
ds_read_b64_tr_b16 a[160:161], v5 offset:0
v_mfma_f32_16x16x32_bf16 v[192:195], a[164:167], a[224:227], v[192:195]
s_add_u32 s37, s31, 32768
ds_read_b64_tr_b16 a[162:163], v5 offset:1024
v_mfma_f32_16x16x32_bf16 v[196:199], a[164:167], a[228:231], v[196:199]
s_add_u32 m0, s33, 1024
ds_read_b128 a[204:207], v4 offset:5120
v_add_u32 v5, 16384, v5
v_mfma_f32_16x16x32_bf16 v[200:203], a[164:167], a[232:235], v[200:203]
buffer_load_dwordx4 v2, s[20:23], s37 offen  lds
v_and_b32 v5, 65535, v5
v_mfma_f32_16x16x32_bf16 v[204:207], a[164:167], a[236:239], v[204:207]
ds_read_b128 a[208:211], v3 offset:8192
v_mfma_f32_16x16x32_bf16 v[208:211], a[164:167], a[240:243], v[208:211]
v_mfma_f32_16x16x32_bf16 v[212:215], a[164:167], a[244:247], v[212:215]
ds_read_b128 a[212:215], v4 offset:9216
v_mfma_f32_16x16x32_bf16 v[216:219], a[164:167], a[248:251], v[216:219]
v_mfma_f32_16x16x32_bf16 v[220:223], a[164:167], a[252:255], v[220:223]
s_add_u32 s37, s31, 131072
ds_read_b64_tr_b16 a[164:165], v6 offset:0
v_mfma_f32_16x16x32_bf16 v[224:227], a[168:171], a[224:227], v[224:227]
s_add_u32 m0, s33, 4096
ds_read_b64_tr_b16 a[166:167], v6 offset:1024
v_mfma_f32_16x16x32_bf16 v[228:231], a[168:171], a[228:231], v[228:231]
buffer_load_dwordx4 v2, s[20:23], s37 offen  lds
v_xor_b32 v6, 16, v5
v_mfma_f32_16x16x32_bf16 v[232:235], a[168:171], a[232:235], v[232:235]
ds_read_b128 a[216:219], v3 offset:12288
v_mfma_f32_16x16x32_bf16 v[236:239], a[168:171], a[236:239], v[236:239]
v_mfma_f32_16x16x32_bf16 v[240:243], a[168:171], a[240:243], v[240:243]
ds_read_b128 a[220:223], v4 offset:13312
v_mfma_f32_16x16x32_bf16 v[244:247], a[168:171], a[244:247], v[244:247]
v_mfma_f32_16x16x32_bf16 v[248:251], a[168:171], a[248:251], v[248:251]
s_add_u32 s37, s31, 163840
ds_read_b64_tr_b16 a[188:189], v12 offset:0
v_mfma_f32_16x16x32_bf16 v[252:255], a[168:171], a[252:255], v[252:255]
s_add_u32 m0, s33, 5120
ds_read_b64_tr_b16 a[168:169], v7 offset:0
v_mfma_f32_16x16x32_bf16 a[0:3], a[172:175], a[224:227], a[0:3]
buffer_load_dwordx4 v2, s[20:23], s37 offen  lds
ds_read_b64_tr_b16 a[170:171], v7 offset:1024
v_mfma_f32_16x16x32_bf16 a[4:7], a[172:175], a[228:231], a[4:7]
s_add_u32 s31, s31, 262144
s_add_u32 s29, s29, s44
v_xor_b32 v7, 64, v5
v_mfma_f32_16x16x32_bf16 a[8:11], a[172:175], a[232:235], a[8:11]
s_add_u32 s33, s33, 16384
ds_read_b64_tr_b16 a[190:191], v12 offset:1024
v_mfma_f32_16x16x32_bf16 a[12:15], a[172:175], a[236:239], a[12:15]
s_and_b32 s33, s33, 65535
buffer_store_dwordx4 v[124:127], v13, s[8:11], s29 offen sc1
v_mfma_f32_16x16x32_bf16 a[16:19], a[172:175], a[240:243], a[16:19]
v_mfma_f32_16x16x32_bf16 a[20:23], a[172:175], a[244:247], a[20:23]
s_mov_b32 s48, s30
v_xor_b32 v12, 208, v5
v_mfma_f32_16x16x32_bf16 a[24:27], a[172:175], a[248:251], a[24:27]
s_add_u32 m0, s32, 0
v_mfma_f32_16x16x32_bf16 a[28:31], a[172:175], a[252:255], a[28:31]
buffer_load_dwordx4 v1, s[12:15], s48 offen lds
ds_read_b64_tr_b16 a[172:173], v8 offset:0
v_mfma_f32_16x16x32_bf16 a[32:35], a[176:179], a[224:227], a[32:35]
ds_read_b64_tr_b16 a[174:175], v8 offset:1024
v_mfma_f32_16x16x32_bf16 a[36:39], a[176:179], a[228:231], a[36:39]
v_xor_b32 v8, 80, v5
v_mfma_f32_16x16x32_bf16 a[40:43], a[176:179], a[232:235], a[40:43]
v_mfma_f32_16x16x32_bf16 a[44:47], a[176:179], a[236:239], a[44:47]
v_mfma_f32_16x16x32_bf16 a[48:51], a[176:179], a[240:243], a[48:51]
s_add_u32 s48, s48, s34
v_mfma_f32_16x16x32_bf16 a[52:55], a[176:179], a[244:247], a[52:55]
s_add_u32 m0, s32, 4096
v_mfma_f32_16x16x32_bf16 a[56:59], a[176:179], a[248:251], a[56:59]
buffer_load_dwordx4 v1, s[12:15], s48 offen lds
v_mfma_f32_16x16x32_bf16 a[60:63], a[176:179], a[252:255], a[60:63]
ds_read_b64_tr_b16 a[176:177], v9 offset:0
v_mfma_f32_16x16x32_bf16 a[64:67], a[180:183], a[224:227], a[64:67]
ds_read_b64_tr_b16 a[178:179], v9 offset:1024
v_mfma_f32_16x16x32_bf16 a[68:71], a[180:183], a[228:231], a[68:71]
v_xor_b32 v9, 128, v5
v_mfma_f32_16x16x32_bf16 a[72:75], a[180:183], a[232:235], a[72:75]
v_mfma_f32_16x16x32_bf16 a[76:79], a[180:183], a[236:239], a[76:79]
s_add_u32 s48, s48, s34
v_mfma_f32_16x16x32_bf16 a[80:83], a[180:183], a[240:243], a[80:83]
s_add_u32 m0, s32, 8192
v_mfma_f32_16x16x32_bf16 a[84:87], a[180:183], a[244:247], a[84:87]
buffer_load_dwordx4 v1, s[12:15], s48 offen lds
v_mfma_f32_16x16x32_bf16 a[88:91], a[180:183], a[248:251], a[88:91]
v_mfma_f32_16x16x32_bf16 a[92:95], a[180:183], a[252:255], a[92:95]
ds_read_b64_tr_b16 a[180:181], v10 offset:0
v_mfma_f32_16x16x32_bf16 a[96:99], a[184:187], a[224:227], a[96:99]
ds_read_b64_tr_b16 a[182:183], v10 offset:1024
v_mfma_f32_16x16x32_bf16 a[100:103], a[184:187], a[228:231], a[100:103]
v_xor_b32 v10, 144, v5
v_mfma_f32_16x16x32_bf16 a[104:107], a[184:187], a[232:235], a[104:107]
s_add_u32 s48, s48, s34
v_mfma_f32_16x16x32_bf16 a[108:111], a[184:187], a[236:239], a[108:111]
s_add_u32 m0, s32, 12288
v_mfma_f32_16x16x32_bf16 a[112:115], a[184:187], a[240:243], a[112:115]
buffer_load_dwordx4 v1, s[12:15], s48 offen lds
v_mfma_f32_16x16x32_bf16 a[116:119], a[184:187], a[244:247], a[116:119]
v_mfma_f32_16x16x32_bf16 a[120:123], a[184:187], a[248:251], a[120:123]
v_mfma_f32_16x16x32_bf16 a[124:127], a[184:187], a[252:255], a[124:127]
ds_read_b64_tr_b16 a[184:185], v11 offset:0
v_mfma_f32_16x16x32_bf16 a[128:131], v[28:31], a[224:227], a[128:131]
ds_read_b64_tr_b16 a[186:187], v11 offset:1024
v_mfma_f32_16x16x32_bf16 a[132:135], v[28:31], a[228:231], a[132:135]
v_xor_b32 v11, 192, v5
v_mfma_f32_16x16x32_bf16 a[136:139], v[28:31], a[232:235], a[136:139]
buffer_load_dword v15, v14, s[96:99], s100 offen
v_mfma_f32_16x16x32_bf16 a[140:143], v[28:31], a[236:239], a[140:143]
s_add_u32 s100, s100, 16384
v_mfma_f32_16x16x32_bf16 a[144:147], v[28:31], a[240:243], a[144:147]
v_mfma_f32_16x16x32_bf16 a[148:151], v[28:31], a[244:247], a[148:151]
v_mfma_f32_16x16x32_bf16 a[152:155], v[28:31], a[248:251], a[152:155]
v_mfma_f32_16x16x32_bf16 a[156:159], v[28:31], a[252:255], a[156:159]
s_cmp_eq_u32 s36, 0
s_cbranch_scc1 L_g_k12
s_waitcnt vmcnt(23) lgkmcnt(0)
s_barrier
v_mfma_f32_16x16x32_bf16 v[160:163], a[160:163], a[192:195], v[160:163]
ds_read_b128 a[224:227], v4 offset:0
v_mfma_f32_16x16x32_bf16 v[164:167], a[160:163], a[196:199], v[164:167]
s_add_u32 s37, s31, 0
v_mfma_f32_16x16x32_bf16 v[168:171], a[160:163], a[200:203], v[168:171]
s_add_u32 m0, s33, 0
ds_read_b128 a[228:231], v3 offset:1024
v_mfma_f32_16x16x32_bf16 v[172:175], a[160:163], a[204:207], v[172:175]
buffer_load_dwordx4 v2, s[20:23], s37 offen  lds
v_mfma_f32_16x16x32_bf16 v[176:179], a[160:163], a[208:211], v[176:179]
ds_read_b128 a[232:235], v4 offset:4096
v_mfma_f32_16x16x32_bf16 v[180:183], a[160:163], a[212:215], v[180:183]
v_mfma_f32_16x16x32_bf16 v[184:187], a[160:163], a[216:219], v[184:187]
ds_read_b128 a[236:239], v3 offset:5120
v_mfma_f32_16x16x32_bf16 v[188:191], a[160:163], a[220:223], v[188:191]
ds_read_b64_tr_b16 a[160:161], v5 offset:0
v_mfma_f32_16x16x32_bf16 v[192:195], a[164:167], a[192:195], v[192:195]
s_add_u32 s37, s31, 32768
ds_read_b64_tr_b16 a[162:163], v5 offset:1024
v_mfma_f32_16x16x32_bf16 v[196:199], a[164:167], a[196:199], v[196:199]
s_add_u32 m0, s33, 1024
ds_read_b128 a[240:243], v4 offset:8192
v_add_u32 v5, 16384, v5
v_mfma_f32_16x16x32_bf16 v[200:203], a[164:167], a[200:203], v[200:203]
buffer_load_dwordx4 v2, s[20:23], s37 offen  lds
v_and_b32 v5, 65535, v5
v_mfma_f32_16x16x32_bf16 v[204:207], a[164:167], a[204:207], v[204:207]
ds_read_b128 a[244:247], v3 offset:9216
v_mfma_f32_16x16x32_bf16 v[208:211], a[164:167], a[208:211], v[208:211]
v_mfma_f32_16x16x32_bf16 v[212:215], a[164:167], a[212:215], v[212:215]
ds_read_b128 a[248:251], v4 offset:12288
v_mfma_f32_16x16x32_bf16 v[216:219], a[164:167], a[216:219], v[216:219]
v_mfma_f32_16x16x32_bf16 v[220:223], a[164:167], a[220:223], v[220:223]
s_add_u32 s37, s31, 131072
ds_read_b64_tr_b16 a[164:165], v6 offset:0
v_mfma_f32_16x16x32_bf16 v[224:227], a[168:171], a[192:195], v[224:227]
s_add_u32 m0, s33, 4096
ds_read_b64_tr_b16 a[166:167], v6 offset:1024
v_mfma_f32_16x16x32_bf16 v[228:231], a[168:171], a[196:199], v[228:231]
buffer_load_dwordx4 v2, s[20:23], s37 offen  lds
v_xor_b32 v6, 16, v5
v_mfma_f32_16x16x32_bf16 v[232:235], a[168:171], a[200:203], v[232:235]
ds_read_b128 a[252:255], v3 offset:13312
v_mfma_f32_16x16x32_bf16 v[236:239], a[168:171], a[204:207], v[236:239]
v_mfma_f32_16x16x32_bf16 v[240:243], a[168:171], a[208:211], v[240:243]
ds_read_b64_tr_b16 v[28:29], v12 offset:0
v_mfma_f32_16x16x32_bf16 v[244:247], a[168:171], a[212:215], v[244:247]
v_mfma_f32_16x16x32_bf16 v[248:251], a[168:171], a[216:219], v[248:251]
s_add_u32 s37, s31, 163840
ds_read_b64_tr_b16 v[30:31], v12 offset:1024
v_mfma_f32_16x16x32_bf16 v[252:255], a[168:171], a[220:223], v[252:255]
s_add_u32 m0, s33, 5120
ds_read_b64_tr_b16 a[168:169], v7 offset:0
v_mfma_f32_16x16x32_bf16 a[0:3], a[172:175], a[192:195], a[0:3]
buffer_load_dwordx4 v2, s[20:23], s37 offen  lds
ds_read_b64_tr_b16 a[170:171], v7 offset:1024
v_mfma_f32_16x16x32_bf16 a[4:7], a[172:175], a[196:199], a[4:7]
s_add_u32 s31, s31, 262144
v_xor_b32 v7, 64, v5
v_xor_b32 v12, 208, v5
v_mfma_f32_16x16x32_bf16 a[8:11], a[172:175], a[200:203], a[8:11]
s_add_u32 s33, s33, 16384
v_add_u32 v3, 32768, v3
v_mfma_f32_16x16x32_bf16 a[12:15], a[172:175], a[204:207], a[12:15]
s_and_b32 s33, s33, 65535
v_subrev_u32 v19, 98304, v3
v_mfma_f32_16x16x32_bf16 a[16:19], a[172:175], a[208:211], a[16:19]
v_cmp_le_u32 vcc, 163840, v3
v_mfma_f32_16x16x32_bf16 a[20:23], a[172:175], a[212:215], a[20:23]
s_add_u32 s48, s48, s34
v_cndmask_b32 v3, v3, v19, vcc
v_mfma_f32_16x16x32_bf16 a[24:27], a[172:175], a[216:219], a[24:27]
s_add_u32 m0, s32, 16384
v_xor_b32 v4, 64, v3
v_mfma_f32_16x16x32_bf16 a[28:31], a[172:175], a[220:223], a[28:31]
buffer_load_dwordx4 v1, s[12:15], s48 offen lds
ds_read_b64_tr_b16 a[172:173], v8 offset:0
v_mfma_f32_16x16x32_bf16 a[32:35], a[176:179], a[192:195], a[32:35]
ds_read_b64_tr_b16 a[174:175], v8 offset:1024
v_mfma_f32_16x16x32_bf16 a[36:39], a[176:179], a[196:199], a[36:39]
v_xor_b32 v8, 80, v5
v_mfma_f32_16x16x32_bf16 a[40:43], a[176:179], a[200:203], a[40:43]
v_mfma_f32_16x16x32_bf16 a[44:47], a[176:179], a[204:207], a[44:47]
v_mfma_f32_16x16x32_bf16 a[48:51], a[176:179], a[208:211], a[48:51]
s_add_u32 s48, s48, s34
v_mfma_f32_16x16x32_bf16 a[52:55], a[176:179], a[212:215], a[52:55]
s_add_u32 m0, s32, 20480
v_mfma_f32_16x16x32_bf16 a[56:59], a[176:179], a[216:219], a[56:59]
buffer_load_dwordx4 v1, s[12:15], s48 offen lds
v_mfma_f32_16x16x32_bf16 a[60:63], a[176:179], a[220:223], a[60:63]
ds_read_b64_tr_b16 a[176:177], v9 offset:0
v_mfma_f32_16x16x32_bf16 a[64:67], a[180:183], a[192:195], a[64:67]
ds_read_b64_tr_b16 a[178:179], v9 offset:1024
v_mfma_f32_16x16x32_bf16 a[68:71], a[180:183], a[196:199], a[68:71]
v_xor_b32 v9, 128, v5
v_mfma_f32_16x16x32_bf16 a[72:75], a[180:183], a[200:203], a[72:75]
v_mfma_f32_16x16x32_bf16 a[76:79], a[180:183], a[204:207], a[76:79]
s_add_u32 s48, s48, s34
v_mfma_f32_16x16x32_bf16 a[80:83], a[180:183], a[208:211], a[80:83]
s_add_u32 m0, s32, 24576
v_mfma_f32_16x16x32_bf16 a[84:87], a[180:183], a[212:215], a[84:87]
buffer_load_dwordx4 v1, s[12:15], s48 offen lds
v_mfma_f32_16x16x32_bf16 a[88:91], a[180:183], a[216:219], a[88:91]
v_mfma_f32_16x16x32_bf16 a[92:95], a[180:183], a[220:223], a[92:95]
ds_read_b64_tr_b16 a[180:181], v10 offset:0
v_mfma_f32_16x16x32_bf16 a[96:99], a[184:187], a[192:195], a[96:99]
ds_read_b64_tr_b16 a[182:183], v10 offset:1024
v_mfma_f32_16x16x32_bf16 a[100:103], a[184:187], a[196:199], a[100:103]
v_xor_b32 v10, 144, v5
v_mfma_f32_16x16x32_bf16 a[104:107], a[184:187], a[200:203], a[104:107]
s_add_u32 s48, s48, s34
v_mfma_f32_16x16x32_bf16 a[108:111], a[184:187], a[204:207], a[108:111]
s_add_u32 m0, s32, 28672
v_mfma_f32_16x16x32_bf16 a[112:115], a[184:187], a[208:211], a[112:115]
buffer_load_dwordx4 v1, s[12:15], s48 offen lds
v_mfma_f32_16x16x32_bf16 a[116:119], a[184:187], a[212:215], a[116:119]
s_add_u32 s30, s30, 128
v_mfma_f32_16x16x32_bf16 a[120:123], a[184:187], a[216:219], a[120:123]
s_add_u32 s32, s32, 32768
v_mfma_f32_16x16x32_bf16 a[124:127], a[184:187], a[220:223], a[124:127]
s_sub_u32 s48, s32, 98304
ds_read_b64_tr_b16 a[184:185], v11 offset:0
v_mfma_f32_16x16x32_bf16 a[128:131], a[188:191], a[192:195], a[128:131]
s_cmp_ge_u32 s32, 163840
s_cselect_b32 s32, s48, s32
ds_read_b64_tr_b16 a[186:187], v11 offset:1024
v_mfma_f32_16x16x32_bf16 a[132:135], a[188:191], a[196:199], a[132:135]
v_xor_b32 v11, 192, v5
v_mfma_f32_16x16x32_bf16 a[136:139], a[188:191], a[200:203], a[136:139]
v_mfma_f32_16x16x32_bf16 a[140:143], a[188:191], a[204:207], a[140:143]
v_mfma_f32_16x16x32_bf16 a[144:147], a[188:191], a[208:211], a[144:147]
v_mfma_f32_16x16x32_bf16 a[148:151], a[188:191], a[212:215], a[148:151]
v_mfma_f32_16x16x32_bf16 a[152:155], a[188:191], a[216:219], a[152:155]
v_mfma_f32_16x16x32_bf16 a[156:159], a[188:191], a[220:223], a[156:159]
s_waitcnt vmcnt(19) lgkmcnt(0)
s_barrier
v_mfma_f32_16x16x32_bf16 v[160:163], a[160:163], a[224:227], v[160:163]
ds_read_b128 a[192:195], v3 offset:0
v_mfma_f32_16x16x32_bf16 v[164:167], a[160:163], a[228:231], v[164:167]
s_add_u32 s37, s31, 0
v_mfma_f32_16x16x32_bf16 v[168:171], a[160:163], a[232:235], v[168:171]
s_add_u32 m0, s33, 0
ds_read_b128 a[196:199], v4 offset:1024
v_mfma_f32_16x16x32_bf16 v[172:175], a[160:163], a[236:239], v[172:175]
buffer_load_dwordx4 v2, s[20:23], s37 offen  lds
v_mfma_f32_16x16x32_bf16 v[176:179], a[160:163], a[240:243], v[176:179]
ds_read_b128 a[200:203], v3 offset:4096
v_mfma_f32_16x16x32_bf16 v[180:183], a[160:163], a[244:247], v[180:183]
v_mfma_f32_16x16x32_bf16 v[184:187], a[160:163], a[248:251], v[184:187]
ds_read_b128 a[204:207], v4 offset:5120
v_mfma_f32_16x16x32_bf16 v[188:191], a[160:163], a[252:255], v[188:191]
ds_read_b64_tr_b16 a[160:161], v5 offset:0
v_mfma_f32_16x16x32_bf16 v[192:195], a[164:167], a[224:227], v[192:195]
s_add_u32 s37, s31, 32768
ds_read_b64_tr_b16 a[162:163], v5 offset:1024
v_mfma_f32_16x16x32_bf16 v[196:199], a[164:167], a[228:231], v[196:199]
s_add_u32 m0, s33, 1024
ds_read_b128 a[208:211], v3 offset:8192
v_add_u32 v5, 16384, v5
v_mfma_f32_16x16x32_bf16 v[200:203], a[164:167], a[232:235], v[200:203]
buffer_load_dwordx4 v2, s[20:23], s37 offen  lds
v_and_b32 v5, 65535, v5
v_mfma_f32_16x16x32_bf16 v[204:207], a[164:167], a[236:239], v[204:207]
ds_read_b128 a[212:215], v4 offset:9216
v_mfma_f32_16x16x32_bf16 v[208:211], a[164:167], a[240:243], v[208:211]
v_mfma_f32_16x16x32_bf16 v[212:215], a[164:167], a[244:247], v[212:215]
ds_read_b128 a[216:219], v3 offset:12288
v_mfma_f32_16x16x32_bf16 v[216:219], a[164:167], a[248:251], v[216:219]
v_mfma_f32_16x16x32_bf16 v[220:223], a[164:167], a[252:255], v[220:223]
s_add_u32 s37, s31, 131072
ds_read_b64_tr_b16 a[164:165], v6 offset:0
v_mfma_f32_16x16x32_bf16 v[224:227], a[168:171], a[224:227], v[224:227]
s_add_u32 m0, s33, 4096
ds_read_b64_tr_b16 a[166:167], v6 offset:1024
v_mfma_f32_16x16x32_bf16 v[228:231], a[168:171], a[228:231], v[228:231]
buffer_load_dwordx4 v2, s[20:23], s37 offen  lds
v_xor_b32 v6, 16, v5
v_mfma_f32_16x16x32_bf16 v[232:235], a[168:171], a[232:235], v[232:235]
ds_read_b128 a[220:223], v4 offset:13312
v_mfma_f32_16x16x32_bf16 v[236:239], a[168:171], a[236:239], v[236:239]
v_mfma_f32_16x16x32_bf16 v[240:243], a[168:171], a[240:243], v[240:243]
ds_read_b64_tr_b16 a[188:189], v12 offset:0
v_mfma_f32_16x16x32_bf16 v[244:247], a[168:171], a[244:247], v[244:247]
v_mfma_f32_16x16x32_bf16 v[248:251], a[168:171], a[248:251], v[248:251]
s_add_u32 s37, s31, 163840
ds_read_b64_tr_b16 a[190:191], v12 offset:1024
v_mfma_f32_16x16x32_bf16 v[252:255], a[168:171], a[252:255], v[252:255]
s_add_u32 m0, s33, 5120
ds_read_b64_tr_b16 a[168:169], v7 offset:0
v_mfma_f32_16x16x32_bf16 a[0:3], a[172:175], a[224:227], a[0:3]
buffer_load_dwordx4 v2, s[20:23], s37 offen  lds
ds_read_b64_tr_b16 a[170:171], v7 offset:1024
v_mfma_f32_16x16x32_bf16 a[4:7], a[172:175], a[228:231], a[4:7]
s_add_u32 s31, s31, 262144
v_xor_b32 v7, 64, v5
v_xor_b32 v12, 208, v5
v_mfma_f32_16x16x32_bf16 a[8:11], a[172:175], a[232:235], a[8:11]
s_add_u32 s33, s33, 16384
v_mfma_f32_16x16x32_bf16 a[12:15], a[172:175], a[236:239], a[12:15]
s_and_b32 s33, s33, 65535
v_mfma_f32_16x16x32_bf16 a[16:19], a[172:175], a[240:243], a[16:19]
v_mfma_f32_16x16x32_bf16 a[20:23], a[172:175], a[244:247], a[20:23]
s_mov_b32 s48, s30
v_mfma_f32_16x16x32_bf16 a[24:27], a[172:175], a[248:251], a[24:27]
s_add_u32 m0, s32, 0
v_mfma_f32_16x16x32_bf16 a[28:31], a[172:175], a[252:255], a[28:31]
buffer_load_dwordx4 v1, s[12:15], s48 offen lds
ds_read_b64_tr_b16 a[172:173], v8 offset:0
v_mfma_f32_16x16x32_bf16 a[32:35], a[176:179], a[224:227], a[32:35]
ds_read_b64_tr_b16 a[174:175], v8 offset:1024
v_mfma_f32_16x16x32_bf16 a[36:39], a[176:179], a[228:231], a[36:39]
v_xor_b32 v8, 80, v5
v_mfma_f32_16x16x32_bf16 a[40:43], a[176:179], a[232:235], a[40:43]
v_mfma_f32_16x16x32_bf16 a[44:47], a[176:179], a[236:239], a[44:47]
v_mfma_f32_16x16x32_bf16 a[48:51], a[176:179], a[240:243], a[48:51]
s_add_u32 s48, s48, s34
v_mfma_f32_16x16x32_bf16 a[52:55], a[176:179], a[244:247], a[52:55]
s_add_u32 m0, s32, 4096
v_mfma_f32_16x16x32_bf16 a[56:59], a[176:179], a[248:251], a[56:59]
buffer_load_dwordx4 v1, s[12:15], s48 offen lds
v_mfma_f32_16x16x32_bf16 a[60:63], a[176:179], a[252:255], a[60:63]
ds_read_b64_tr_b16 a[176:177], v9 offset:0
v_mfma_f32_16x16x32_bf16 a[64:67], a[180:183], a[224:227], a[64:67]
ds_read_b64_tr_b16 a[178:179], v9 offset:1024
v_mfma_f32_16x16x32_bf16 a[68:71], a[180:183], a[228:231], a[68:71]
v_xor_b32 v9, 128, v5
v_mfma_f32_16x16x32_bf16 a[72:75], a[180:183], a[232:235], a[72:75]
v_mfma_f32_16x16x32_bf16 a[76:79], a[180:183], a[236:239], a[76:79]
s_add_u32 s48, s48, s34
v_mfma_f32_16x16x32_bf16 a[80:83], a[180:183], a[240:243], a[80:83]
s_add_u32 m0, s32, 8192
v_mfma_f32_16x16x32_bf16 a[84:87], a[180:183], a[244:247], a[84:87]
buffer_load_dwordx4 v1, s[12:15], s48 offen lds
v_mfma_f32_16x16x32_bf16 a[88:91], a[180:183], a[248:251], a[88:91]
v_mfma_f32_16x16x32_bf16 a[92:95], a[180:183], a[252:255], a[92:95]
ds_read_b64_tr_b16 a[180:181], v10 offset:0
v_mfma_f32_16x16x32_bf16 a[96:99], a[184:187], a[224:227], a[96:99]
ds_read_b64_tr_b16 a[182:183], v10 offset:1024
v_mfma_f32_16x16x32_bf16 a[100:103], a[184:187], a[228:231], a[100:103]
v_xor_b32 v10, 144, v5
v_mfma_f32_16x16x32_bf16 a[104:107], a[184:187], a[232:235], a[104:107]
s_add_u32 s48, s48, s34
v_mfma_f32_16x16x32_bf16 a[108:111], a[184:187], a[236:239], a[108:111]
s_add_u32 m0, s32, 12288
v_mfma_f32_16x16x32_bf16 a[112:115], a[184:187], a[240:243], a[112:115]
buffer_load_dwordx4 v1, s[12:15], s48 offen lds
v_mfma_f32_16x16x32_bf16 a[116:119], a[184:187], a[244:247], a[116:119]
v_mfma_f32_16x16x32_bf16 a[120:123], a[184:187], a[248:251], a[120:123]
v_mfma_f32_16x16x32_bf16 a[124:127], a[184:187], a[252:255], a[124:127]
ds_read_b64_tr_b16 a[184:185], v11 offset:0
v_mfma_f32_16x16x32_bf16 a[128:131], v[28:31], a[224:227], a[128:131]
ds_read_b64_tr_b16 a[186:187], v11 offset:1024
v_mfma_f32_16x16x32_bf16 a[132:135], v[28:31], a[228:231], a[132:135]
v_xor_b32 v11, 192, v5
v_mfma_f32_16x16x32_bf16 a[136:139], v[28:31], a[232:235], a[136:139]
v_mfma_f32_16x16x32_bf16 a[140:143], v[28:31], a[236:239], a[140:143]
v_mfma_f32_16x16x32_bf16 a[144:147], v[28:31], a[240:243], a[144:147]
v_mfma_f32_16x16x32_bf16 a[148:151], v[28:31], a[244:247], a[148:151]
v_mfma_f32_16x16x32_bf16 a[152:155], v[28:31], a[248:251], a[152:155]
v_mfma_f32_16x16x32_bf16 a[156:159], v[28:31], a[252:255], a[156:159]
L_g_k12:
s_waitcnt vmcnt(16) lgkmcnt(0)
s_barrier
v_mfma_f32_16x16x32_bf16 v[160:163], a[160:163], a[192:195], v[160:163]
ds_read_b128 a[224:227], v4 offset:0
s_lshr_b32 s24, s16, 1
v_mfma_f32_16x16x32_bf16 v[164:167], a[160:163], a[196:199], v[164:167]
s_add_u32 s37, s31, 0
s_cmp_eq_u32 s35, 5
s_cselect_b32 s90, s24, s90
v_mfma_f32_16x16x32_bf16 v[168:171], a[160:163], a[200:203], v[168:171]
s_add_u32 m0, s33, 0
ds_read_b128 a[228:231], v3 offset:1024
s_lshl_b32 s24, s35, 2
v_mfma_f32_16x16x32_bf16 v[172:175], a[160:163], a[204:207], v[172:175]
buffer_load_dwordx4 v2, s[20:23], s37 offen  lds
s_lshr_b32 s26, s88, s24
v_mfma_f32_16x16x32_bf16 v[176:179], a[160:163], a[208:211], v[176:179]
s_add_u32 s60, s60, s92
ds_read_b128 a[232:235], v4 offset:4096
s_bfe_u32 s2, s26, 0x10003
v_mfma_f32_16x16x32_bf16 v[180:183], a[160:163], a[212:215], v[180:183]
s_mov_b32 s29, s60
s_and_b32 s26, s26, 7
s_or_b32 s40, s2, s61
v_mfma_f32_16x16x32_bf16 v[184:187], a[160:163], a[216:219], v[184:187]
buffer_store_dwordx4 v[128:131], v13, s[8:11], s29 offen sc1
s_lshr_b32 s24, s17, 1
v_mfma_f32_16x16x32_bf16 v[188:191], a[160:163], a[220:223], v[188:191]
ds_read_b64_tr_b16 a[160:161], v5 offset:0
v_mfma_f32_16x16x32_bf16 v[192:195], a[164:167], a[192:195], v[192:195]
s_add_u32 s37, s31, 32768
ds_read_b64_tr_b16 a[162:163], v5 offset:1024
v_mfma_f32_16x16x32_bf16 v[196:199], a[164:167], a[196:199], v[196:199]
s_add_u32 m0, s33, 1024
ds_read_b128 a[236:239], v3 offset:5120
v_add_u32 v5, 16384, v5
v_mfma_f32_16x16x32_bf16 v[200:203], a[164:167], a[200:203], v[200:203]
buffer_load_dwordx4 v2, s[20:23], s37 offen  lds
v_and_b32 v5, 65535, v5
v_mfma_f32_16x16x32_bf16 v[204:207], a[164:167], a[204:207], v[204:207]
ds_read_b128 a[240:243], v4 offset:8192
v_mfma_f32_16x16x32_bf16 v[208:211], a[164:167], a[208:211], v[208:211]
s_cmp_eq_u32 s2, 0
s_cselect_b32 s41, s24, 0
s_cselect_b32 s27, s89, s90
v_mfma_f32_16x16x32_bf16 v[212:215], a[164:167], a[212:215], v[212:215]
ds_read_b128 a[244:247], v3 offset:9216
s_sub_u32 s25, s24, s41
v_mfma_f32_16x16x32_bf16 v[216:219], a[164:167], a[216:219], v[216:219]
s_and_b32 s51, s41, s61
s_lshl_b32 s51, s51, 1
s_or_b32 s51, s51, s41
v_mfma_f32_16x16x32_bf16 v[220:223], a[164:167], a[220:223], v[220:223]
s_add_u32 s37, s31, 131072
ds_read_b64_tr_b16 a[164:165], v6 offset:0
s_lshl_b32 s46, s27, s2
v_mfma_f32_16x16x32_bf16 v[224:227], a[168:171], a[192:195], v[224:227]
s_add_u32 m0, s33, 4096
ds_read_b64_tr_b16 a[166:167], v6 offset:1024
s_add_u32 s46, s46, s25
v_mfma_f32_16x16x32_bf16 v[228:231], a[168:171], a[196:199], v[228:231]
buffer_load_dwordx4 v2, s[20:23], s37 offen  lds
s_lshl_b32 s46, s46, 8
v_mfma_f32_16x16x32_bf16 v[232:235], a[168:171], a[200:203], v[232:235]
ds_read_b128 a[248:251], v4 offset:12288
s_lshl_b32 s47, s40, 7
v_mfma_f32_16x16x32_bf16 v[236:239], a[168:171], a[204:207], v[236:239]
s_add_u32 s47, s47, 1024
s_mul_i32 s101, s26, s47
s_lshl_b32 s101, s101, 8
v_mfma_f32_16x16x32_bf16 v[240:243], a[168:171], a[208:211], v[240:243]
ds_read_b128 a[252:255], v3 offset:13312
s_lshl_b32 s42, s27, 3
v_mfma_f32_16x16x32_bf16 v[244:247], a[168:171], a[212:215], v[244:247]
s_add_u32 s42, s42, s26
s_lshl_b32 s42, s42, 1
s_and_b32 s25, s17, 1
v_mfma_f32_16x16x32_bf16 v[248:251], a[168:171], a[216:219], v[248:251]
s_add_u32 s37, s31, 163840
ds_read_b64_tr_b16 v[28:29], v12 offset:0
s_add_u32 s42, s42, s25
v_mfma_f32_16x16x32_bf16 v[252:255], a[168:171], a[220:223], v[252:255]
s_add_u32 m0, s33, 5120
ds_read_b64_tr_b16 a[168:169], v7 offset:0
s_lshl_b32 s42, s42, 3
v_mfma_f32_16x16x32_bf16 a[0:3], a[172:175], a[192:195], a[0:3]
buffer_load_dwordx4 v2, s[20:23], s37 offen  lds
ds_read_b64_tr_b16 a[170:171], v7 offset:1024
v_mfma_f32_16x16x32_bf16 a[4:7], a[172:175], a[196:199], a[4:7]
s_add_u32 s31, s31, 262144
s_add_u32 s29, s29, s44
s_add_u32 s42, s42, s24
v_mfma_f32_16x16x32_bf16 a[8:11], a[172:175], a[200:203], a[8:11]
s_add_u32 s33, s33, 16384
ds_read_b64_tr_b16 v[30:31], v12 offset:1024
s_lshl_b32 s42, s42, 13
v_mfma_f32_16x16x32_bf16 a[12:15], a[172:175], a[204:207], a[12:15]
s_and_b32 s33, s33, 65535
buffer_store_dwordx4 v[132:135], v13, s[8:11], s29 offen sc1
s_lshl_b32 s43, s27, 5
v_mfma_f32_16x16x32_bf16 a[16:19], a[172:175], a[208:211], a[16:19]
s_add_u32 s43, s43, s26
s_lshl_b32 s43, s43, 2
s_lshl_b32 s24, s2, 1
v_mfma_f32_16x16x32_bf16 a[20:23], a[172:175], a[212:215], a[20:23]
s_add_u32 s48, s48, s34
s_add_u32 s24, s24, s61
s_lshl_b32 s24, s24, 2
v_mfma_f32_16x16x32_bf16 a[24:27], a[172:175], a[216:219], a[24:27]
s_add_u32 m0, s32, 16384
s_lshr_b32 s25, 0x8720, s24
s_and_b32 s25, s25, 15
v_mfma_f32_16x16x32_bf16 a[28:31], a[172:175], a[220:223], a[28:31]
buffer_load_dwordx4 v1, s[12:15], s48 offen lds
ds_read_b64_tr_b16 a[172:173], v8 offset:0
v_mfma_f32_16x16x32_bf16 a[32:35], a[176:179], a[192:195], a[32:35]
ds_read_b64_tr_b16 a[174:175], v8 offset:1024
s_lshl_b32 s25, s25, 24
v_mfma_f32_16x16x32_bf16 a[36:39], a[176:179], a[196:199], a[36:39]
s_add_u32 s42, s42, s25
s_lshr_b32 s25, 0x7604, s24
s_and_b32 s25, s25, 15
v_mfma_f32_16x16x32_bf16 a[40:43], a[176:179], a[200:203], a[40:43]
s_lshl_b32 s25, s25, 12
s_add_u32 s43, s43, s25
s_add_u32 s43, s43, 111149056
v_mfma_f32_16x16x32_bf16 a[44:47], a[176:179], a[204:207], a[44:47]
s_cmp_lt_u32 s35, s45
s_cselect_b32 s101, s101, 536870912
s_cselect_b32 s46, s46, 536870912
v_mfma_f32_16x16x32_bf16 a[48:51], a[176:179], a[208:211], a[48:51]
s_add_u32 s48, s48, s34
v_xor_b32 v6, 16, v5
v_xor_b32 v7, 64, v5
v_mfma_f32_16x16x32_bf16 a[52:55], a[176:179], a[212:215], a[52:55]
s_add_u32 m0, s32, 20480
v_xor_b32 v8, 80, v5
v_xor_b32 v12, 208, v5
v_mfma_f32_16x16x32_bf16 a[56:59], a[176:179], a[216:219], a[56:59]
buffer_load_dwordx4 v1, s[12:15], s48 offen lds
v_add_u32 v3, 32768, v3
v_mfma_f32_16x16x32_bf16 a[60:63], a[176:179], a[220:223], a[60:63]
ds_read_b64_tr_b16 a[176:177], v9 offset:0
v_subrev_u32 v19, 98304, v3
v_mfma_f32_16x16x32_bf16 a[64:67], a[180:183], a[192:195], a[64:67]
ds_read_b64_tr_b16 a[178:179], v9 offset:1024
v_cmp_le_u32 vcc, 163840, v3
v_mfma_f32_16x16x32_bf16 a[68:71], a[180:183], a[196:199], a[68:71]
v_xor_b32 v9, 128, v5
v_cndmask_b32 v3, v3, v19, vcc
v_mfma_f32_16x16x32_bf16 a[72:75], a[180:183], a[200:203], a[72:75]
v_xor_b32 v4, 64, v3
v_mfma_f32_16x16x32_bf16 a[76:79], a[180:183], a[204:207], a[76:79]
s_add_u32 s48, s48, s34
v_mfma_f32_16x16x32_bf16 a[80:83], a[180:183], a[208:211], a[80:83]
s_add_u32 m0, s32, 24576
v_mfma_f32_16x16x32_bf16 a[84:87], a[180:183], a[212:215], a[84:87]
buffer_load_dwordx4 v1, s[12:15], s48 offen lds
v_mfma_f32_16x16x32_bf16 a[88:91], a[180:183], a[216:219], a[88:91]
s_add_u32 s29, s29, s93
v_mfma_f32_16x16x32_bf16 a[92:95], a[180:183], a[220:223], a[92:95]
ds_read_b64_tr_b16 a[180:181], v10 offset:0
v_mfma_f32_16x16x32_bf16 a[96:99], a[184:187], a[192:195], a[96:99]
buffer_store_dwordx4 v[136:139], v13, s[8:11], s29 offen sc1
ds_read_b64_tr_b16 a[182:183], v10 offset:1024
v_mfma_f32_16x16x32_bf16 a[100:103], a[184:187], a[196:199], a[100:103]
v_xor_b32 v10, 144, v5
v_mfma_f32_16x16x32_bf16 a[104:107], a[184:187], a[200:203], a[104:107]
s_add_u32 s48, s48, s34
v_mfma_f32_16x16x32_bf16 a[108:111], a[184:187], a[204:207], a[108:111]
s_add_u32 m0, s32, 28672
v_mfma_f32_16x16x32_bf16 a[112:115], a[184:187], a[208:211], a[112:115]
buffer_load_dwordx4 v1, s[12:15], s48 offen lds
v_mfma_f32_16x16x32_bf16 a[116:119], a[184:187], a[212:215], a[116:119]
s_add_u32 s30, s30, 128
v_mfma_f32_16x16x32_bf16 a[120:123], a[184:187], a[216:219], a[120:123]
s_add_u32 s32, s32, 32768
v_mfma_f32_16x16x32_bf16 a[124:127], a[184:187], a[220:223], a[124:127]
s_sub_u32 s48, s32, 98304
ds_read_b64_tr_b16 a[184:185], v11 offset:0
v_mfma_f32_16x16x32_bf16 a[128:131], a[188:191], a[192:195], a[128:131]
s_cmp_ge_u32 s32, 163840
s_cselect_b32 s32, s48, s32
ds_read_b64_tr_b16 a[186:187], v11 offset:1024
v_mfma_f32_16x16x32_bf16 a[132:135], a[188:191], a[196:199], a[132:135]
v_xor_b32 v11, 192, v5
v_mfma_f32_16x16x32_bf16 a[136:139], a[188:191], a[200:203], a[136:139]
buffer_load_dword v15, v14, s[96:99], s100 offen
v_mfma_f32_16x16x32_bf16 a[140:143], a[188:191], a[204:207], a[140:143]
s_add_u32 s100, s100, 16384
v_mfma_f32_16x16x32_bf16 a[144:147], a[188:191], a[208:211], a[144:147]
v_mfma_f32_16x16x32_bf16 a[148:151], a[188:191], a[212:215], a[148:151]
v_mfma_f32_16x16x32_bf16 a[152:155], a[188:191], a[216:219], a[152:155]
v_mfma_f32_16x16x32_bf16 a[156:159], a[188:191], a[220:223], a[156:159]
s_waitcnt vmcnt(20) lgkmcnt(0)
s_barrier
v_mfma_f32_16x16x32_bf16 v[160:163], a[160:163], a[224:227], v[160:163]
ds_read_b128 a[192:195], v3 offset:0
v_mfma_f32_16x16x32_bf16 v[164:167], a[160:163], a[228:231], v[164:167]
s_add_u32 s37, s31, 0
s_cmp_eq_u32 s2, 0
s_cselect_b64 s[4:5], s[52:53], s[54:55]
v_mfma_f32_16x16x32_bf16 v[168:171], a[160:163], a[232:235], v[168:171]
s_add_u32 m0, s33, 0
ds_read_b128 a[196:199], v4 offset:1024
s_mov_b32 s12, s4
v_mfma_f32_16x16x32_bf16 v[172:175], a[160:163], a[236:239], v[172:175]
buffer_load_dwordx4 v2, s[20:23], s37 offen  lds
s_and_b32 s13, s5, 0xffff
v_mfma_f32_16x16x32_bf16 v[176:179], a[160:163], a[240:243], v[176:179]
s_add_u32 s29, s29, s44
ds_read_b128 a[200:203], v3 offset:4096
s_lshl_b32 s14, s47, 11
v_mfma_f32_16x16x32_bf16 v[180:183], a[160:163], a[244:247], v[180:183]
s_mov_b32 s15, 0x20000
s_mov_b32 s30, s101
v_lshrrev_b32 v16, 3, v0
v_mfma_f32_16x16x32_bf16 v[184:187], a[160:163], a[248:251], v[184:187]
buffer_store_dwordx4 v[140:143], v13, s[8:11], s29 offen sc1
v_mul_lo_u32 v16, v16, s47
v_mfma_f32_16x16x32_bf16 v[188:191], a[160:163], a[252:255], v[188:191]
ds_read_b64_tr_b16 a[160:161], v5 offset:0
v_and_b32 v1, 0x70, v1
v_mfma_f32_16x16x32_bf16 v[192:195], a[164:167], a[224:227], v[192:195]
s_add_u32 s37, s31, 32768
ds_read_b64_tr_b16 a[162:163], v5 offset:1024
v_add_u32 v1, v1, v16
v_mfma_f32_16x16x32_bf16 v[196:199], a[164:167], a[228:231], v[196:199]
s_add_u32 m0, s33, 1024
ds_read_b128 a[204:207], v4 offset:5120
s_lshl_b32 s34, s47, 5
v_mfma_f32_16x16x32_bf16 v[200:203], a[164:167], a[232:235], v[200:203]
buffer_load_dwordx4 v2, s[20:23], s37 offen  lds
v_add_u32 v5, 16384, v5
v_mfma_f32_16x16x32_bf16 v[204:207], a[164:167], a[236:239], v[204:207]
ds_read_b128 a[208:211], v3 offset:8192
v_and_b32 v5, 65535, v5
v_mfma_f32_16x16x32_bf16 v[208:211], a[164:167], a[240:243], v[208:211]
v_mfma_f32_16x16x32_bf16 v[212:215], a[164:167], a[244:247], v[212:215]
ds_read_b128 a[212:215], v4 offset:9216
v_mfma_f32_16x16x32_bf16 v[216:219], a[164:167], a[248:251], v[216:219]
v_mfma_f32_16x16x32_bf16 v[220:223], a[164:167], a[252:255], v[220:223]
s_add_u32 s37, s31, 131072
ds_read_b64_tr_b16 a[164:165], v6 offset:0
v_mfma_f32_16x16x32_bf16 v[224:227], a[168:171], a[224:227], v[224:227]
s_add_u32 m0, s33, 4096
ds_read_b64_tr_b16 a[166:167], v6 offset:1024
v_mfma_f32_16x16x32_bf16 v[228:231], a[168:171], a[228:231], v[228:231]
buffer_load_dwordx4 v2, s[20:23], s37 offen  lds
v_xor_b32 v6, 16, v5
v_mfma_f32_16x16x32_bf16 v[232:235], a[168:171], a[232:235], v[232:235]
ds_read_b128 a[216:219], v3 offset:12288
v_mfma_f32_16x16x32_bf16 v[236:239], a[168:171], a[236:239], v[236:239]
v_mfma_f32_16x16x32_bf16 v[240:243], a[168:171], a[240:243], v[240:243]
ds_read_b128 a[220:223], v4 offset:13312
v_mfma_f32_16x16x32_bf16 v[244:247], a[168:171], a[244:247], v[244:247]
v_mfma_f32_16x16x32_bf16 v[248:251], a[168:171], a[248:251], v[248:251]
s_add_u32 s37, s31, 163840
ds_read_b64_tr_b16 a[188:189], v12 offset:0
v_mfma_f32_16x16x32_bf16 v[252:255], a[168:171], a[252:255], v[252:255]
s_add_u32 m0, s33, 5120
ds_read_b64_tr_b16 a[168:169], v7 offset:0
v_mfma_f32_16x16x32_bf16 a[0:3], a[172:175], a[224:227], a[0:3]
buffer_load_dwordx4 v2, s[20:23], s37 offen  lds
ds_read_b64_tr_b16 a[170:171], v7 offset:1024
v_mfma_f32_16x16x32_bf16 a[4:7], a[172:175], a[228:231], a[4:7]
s_add_u32 s31, s31, 262144
s_add_u32 s29, s29, s93
v_xor_b32 v7, 64, v5
v_mfma_f32_16x16x32_bf16 a[8:11], a[172:175], a[232:235], a[8:11]
s_add_u32 s33, s33, 16384
ds_read_b64_tr_b16 a[190:191], v12 offset:1024
v_mfma_f32_16x16x32_bf16 a[12:15], a[172:175], a[236:239], a[12:15]
s_and_b32 s33, s33, 65535
buffer_store_dwordx4 v[144:147], v13, s[8:11], s29 offen sc1
v_mfma_f32_16x16x32_bf16 a[16:19], a[172:175], a[240:243], a[16:19]
v_mfma_f32_16x16x32_bf16 a[20:23], a[172:175], a[244:247], a[20:23]
s_mov_b32 s48, s30
v_xor_b32 v12, 208, v5
v_mfma_f32_16x16x32_bf16 a[24:27], a[172:175], a[248:251], a[24:27]
s_add_u32 m0, s32, 0
v_mfma_f32_16x16x32_bf16 a[28:31], a[172:175], a[252:255], a[28:31]
buffer_load_dwordx4 v1, s[12:15], s48 offen lds
ds_read_b64_tr_b16 a[172:173], v8 offset:0
v_mfma_f32_16x16x32_bf16 a[32:35], a[176:179], a[224:227], a[32:35]
ds_read_b64_tr_b16 a[174:175], v8 offset:1024
v_mfma_f32_16x16x32_bf16 a[36:39], a[176:179], a[228:231], a[36:39]
v_xor_b32 v8, 80, v5
v_mfma_f32_16x16x32_bf16 a[40:43], a[176:179], a[232:235], a[40:43]
v_mfma_f32_16x16x32_bf16 a[44:47], a[176:179], a[236:239], a[44:47]
v_mfma_f32_16x16x32_bf16 a[48:51], a[176:179], a[240:243], a[48:51]
s_add_u32 s48, s48, s34
v_mfma_f32_16x16x32_bf16 a[52:55], a[176:179], a[244:247], a[52:55]
s_add_u32 m0, s32, 4096
v_mfma_f32_16x16x32_bf16 a[56:59], a[176:179], a[248:251], a[56:59]
buffer_load_dwordx4 v1, s[12:15], s48 offen lds
v_mfma_f32_16x16x32_bf16 a[60:63], a[176:179], a[252:255], a[60:63]
ds_read_b64_tr_b16 a[176:177], v9 offset:0
v_mfma_f32_16x16x32_bf16 a[64:67], a[180:183], a[224:227], a[64:67]
ds_read_b64_tr_b16 a[178:179], v9 offset:1024
v_mfma_f32_16x16x32_bf16 a[68:71], a[180:183], a[228:231], a[68:71]
v_xor_b32 v9, 128, v5
v_mfma_f32_16x16x32_bf16 a[72:75], a[180:183], a[232:235], a[72:75]
v_mfma_f32_16x16x32_bf16 a[76:79], a[180:183], a[236:239], a[76:79]
s_add_u32 s48, s48, s34
v_mfma_f32_16x16x32_bf16 a[80:83], a[180:183], a[240:243], a[80:83]
s_add_u32 m0, s32, 8192
s_cmp_eq_u32 s2, 0
s_cselect_b64 s[4:5], s[6:7], s[18:19]
v_mfma_f32_16x16x32_bf16 a[84:87], a[180:183], a[244:247], a[84:87]
buffer_load_dwordx4 v1, s[12:15], s48 offen lds
s_mov_b32 s20, s4
v_mfma_f32_16x16x32_bf16 a[88:91], a[180:183], a[248:251], a[88:91]
s_add_u32 s29, s29, s44
s_and_b32 s21, s5, 0xffff
s_lshl_b32 s22, s47, 12
v_mfma_f32_16x16x32_bf16 a[92:95], a[180:183], a[252:255], a[92:95]
ds_read_b64_tr_b16 a[180:181], v10 offset:0
s_mov_b32 s23, 0x20000
v_mfma_f32_16x16x32_bf16 a[96:99], a[184:187], a[224:227], a[96:99]
buffer_store_dwordx4 v[148:151], v13, s[8:11], s29 offen sc1
ds_read_b64_tr_b16 a[182:183], v10 offset:1024
v_mfma_f32_16x16x32_bf16 a[100:103], a[184:187], a[228:231], a[100:103]
s_mov_b32 s31, s46
v_xor_b32 v10, 144, v5
v_mfma_f32_16x16x32_bf16 a[104:107], a[184:187], a[232:235], a[104:107]
s_add_u32 s48, s48, s34
v_mfma_f32_16x16x32_bf16 a[108:111], a[184:187], a[236:239], a[108:111]
s_add_u32 m0, s32, 12288
v_mfma_f32_16x16x32_bf16 a[112:115], a[184:187], a[240:243], a[112:115]
buffer_load_dwordx4 v1, s[12:15], s48 offen lds
v_mfma_f32_16x16x32_bf16 a[116:119], a[184:187], a[244:247], a[116:119]
v_mfma_f32_16x16x32_bf16 a[120:123], a[184:187], a[248:251], a[120:123]
v_mfma_f32_16x16x32_bf16 a[124:127], a[184:187], a[252:255], a[124:127]
ds_read_b64_tr_b16 a[184:185], v11 offset:0
v_mfma_f32_16x16x32_bf16 a[128:131], v[28:31], a[224:227], a[128:131]
ds_read_b64_tr_b16 a[186:187], v11 offset:1024
v_mfma_f32_16x16x32_bf16 a[132:135], v[28:31], a[228:231], a[132:135]
v_xor_b32 v11, 192, v5
v_mfma_f32_16x16x32_bf16 a[136:139], v[28:31], a[232:235], a[136:139]
buffer_load_dword v15, v14, s[96:99], s100 offen
v_mfma_f32_16x16x32_bf16 a[140:143], v[28:31], a[236:239], a[140:143]
s_add_u32 s100, s100, 16384
v_mfma_f32_16x16x32_bf16 a[144:147], v[28:31], a[240:243], a[144:147]
v_mfma_f32_16x16x32_bf16 a[148:151], v[28:31], a[244:247], a[148:151]
v_mfma_f32_16x16x32_bf16 a[152:155], v[28:31], a[248:251], a[152:155]
v_mfma_f32_16x16x32_bf16 a[156:159], v[28:31], a[252:255], a[156:159]
s_waitcnt vmcnt(24) lgkmcnt(0)
s_barrier
v_mfma_f32_16x16x32_bf16 v[160:163], a[160:163], a[192:195], v[160:163]
ds_read_b128 a[224:227], v4 offset:0
v_mfma_f32_16x16x32_bf16 v[164:167], a[160:163], a[196:199], v[164:167]
s_add_u32 s37, s31, 0
v_mfma_f32_16x16x32_bf16 v[168:171], a[160:163], a[200:203], v[168:171]
s_add_u32 m0, s33, 0
ds_read_b128 a[228:231], v3 offset:1024
v_mfma_f32_16x16x32_bf16 v[172:175], a[160:163], a[204:207], v[172:175]
buffer_load_dwordx4 v2, s[20:23], s37 offen  lds
v_mfma_f32_16x16x32_bf16 v[176:179], a[160:163], a[208:211], v[176:179]
s_add_u32 s29, s29, s93
ds_read_b128 a[232:235], v4 offset:4096
v_mfma_f32_16x16x32_bf16 v[180:183], a[160:163], a[212:215], v[180:183]
v_mfma_f32_16x16x32_bf16 v[184:187], a[160:163], a[216:219], v[184:187]
buffer_store_dwordx4 v[152:155], v13, s[8:11], s29 offen sc1
v_mfma_f32_16x16x32_bf16 v[188:191], a[160:163], a[220:223], v[188:191]
ds_read_b64_tr_b16 a[160:161], v5 offset:0
v_mfma_f32_16x16x32_bf16 v[192:195], a[164:167], a[192:195], v[192:195]
s_add_u32 s37, s31, 32768
ds_read_b64_tr_b16 a[162:163], v5 offset:1024
v_mfma_f32_16x16x32_bf16 v[196:199], a[164:167], a[196:199], v[196:199]
s_add_u32 m0, s33, 1024
ds_read_b128 a[236:239], v3 offset:5120
v_add_u32 v5, 16384, v5
v_mfma_f32_16x16x32_bf16 v[200:203], a[164:167], a[200:203], v[200:203]
buffer_load_dwordx4 v2, s[20:23], s37 offen  lds
v_and_b32 v5, 65535, v5
v_mfma_f32_16x16x32_bf16 v[204:207], a[164:167], a[204:207], v[204:207]
ds_read_b128 a[240:243], v4 offset:8192
v_mfma_f32_16x16x32_bf16 v[208:211], a[164:167], a[208:211], v[208:211]
v_mfma_f32_16x16x32_bf16 v[212:215], a[164:167], a[212:215], v[212:215]
ds_read_b128 a[244:247], v3 offset:9216
v_mfma_f32_16x16x32_bf16 v[216:219], a[164:167], a[216:219], v[216:219]
v_mfma_f32_16x16x32_bf16 v[220:223], a[164:167], a[220:223], v[220:223]
s_add_u32 s37, s31, 131072
ds_read_b64_tr_b16 a[164:165], v6 offset:0
v_mfma_f32_16x16x32_bf16 v[224:227], a[168:171], a[192:195], v[224:227]
s_add_u32 m0, s33, 4096
ds_read_b64_tr_b16 a[166:167], v6 offset:1024
v_mfma_f32_16x16x32_bf16 v[228:231], a[168:171], a[196:199], v[228:231]
buffer_load_dwordx4 v2, s[20:23], s37 offen  lds
v_xor_b32 v6, 16, v5
v_mfma_f32_16x16x32_bf16 v[232:235], a[168:171], a[200:203], v[232:235]
ds_read_b128 a[248:251], v4 offset:12288
v_mfma_f32_16x16x32_bf16 v[236:239], a[168:171], a[204:207], v[236:239]
v_mfma_f32_16x16x32_bf16 v[240:243], a[168:171], a[208:211], v[240:243]
ds_read_b128 a[252:255], v3 offset:13312
v_mfma_f32_16x16x32_bf16 v[244:247], a[168:171], a[212:215], v[244:247]
v_mfma_f32_16x16x32_bf16 v[248:251], a[168:171], a[216:219], v[248:251]
s_add_u32 s37, s31, 163840
ds_read_b64_tr_b16 v[28:29], v12 offset:0
v_mfma_f32_16x16x32_bf16 v[252:255], a[168:171], a[220:223], v[252:255]
s_add_u32 m0, s33, 5120
ds_read_b64_tr_b16 a[168:169], v7 offset:0
v_mfma_f32_16x16x32_bf16 a[0:3], a[172:175], a[192:195], a[0:3]
buffer_load_dwordx4 v2, s[20:23], s37 offen  lds
ds_read_b64_tr_b16 a[170:171], v7 offset:1024
v_mfma_f32_16x16x32_bf16 a[4:7], a[172:175], a[196:199], a[4:7]
s_add_u32 s31, s31, 262144
s_add_u32 s29, s29, s44
v_xor_b32 v7, 64, v5
v_mfma_f32_16x16x32_bf16 a[8:11], a[172:175], a[200:203], a[8:11]
s_add_u32 s33, s33, 16384
ds_read_b64_tr_b16 v[30:31], v12 offset:1024
v_mfma_f32_16x16x32_bf16 a[12:15], a[172:175], a[204:207], a[12:15]
s_and_b32 s33, s33, 65535
buffer_store_dwordx4 v[156:159], v13, s[8:11], s29 offen sc1
v_mfma_f32_16x16x32_bf16 a[16:19], a[172:175], a[208:211], a[16:19]
v_mfma_f32_16x16x32_bf16 a[20:23], a[172:175], a[212:215], a[20:23]
s_add_u32 s48, s48, s34
v_xor_b32 v12, 208, v5
v_mfma_f32_16x16x32_bf16 a[24:27], a[172:175], a[216:219], a[24:27]
s_add_u32 m0, s32, 16384
v_add_u32 v3, 32768, v3
v_mfma_f32_16x16x32_bf16 a[28:31], a[172:175], a[220:223], a[28:31]
buffer_load_dwordx4 v1, s[12:15], s48 offen lds
ds_read_b64_tr_b16 a[172:173], v8 offset:0
v_mfma_f32_16x16x32_bf16 a[32:35], a[176:179], a[192:195], a[32:35]
ds_read_b64_tr_b16 a[174:175], v8 offset:1024
v_subrev_u32 v19, 98304, v3
v_mfma_f32_16x16x32_bf16 a[36:39], a[176:179], a[196:199], a[36:39]
v_xor_b32 v8, 80, v5
v_cmp_le_u32 vcc, 163840, v3
v_mfma_f32_16x16x32_bf16 a[40:43], a[176:179], a[200:203], a[40:43]
s_nop 0
v_cndmask_b32 v3, v3, v19, vcc
v_mfma_f32_16x16x32_bf16 a[44:47], a[176:179], a[204:207], a[44:47]
v_xor_b32 v4, 64, v3
v_mfma_f32_16x16x32_bf16 a[48:51], a[176:179], a[208:211], a[48:51]
s_add_u32 s48, s48, s34
v_mfma_f32_16x16x32_bf16 a[52:55], a[176:179], a[212:215], a[52:55]
s_add_u32 m0, s32, 20480
v_mfma_f32_16x16x32_bf16 a[56:59], a[176:179], a[216:219], a[56:59]
buffer_load_dwordx4 v1, s[12:15], s48 offen lds
v_mfma_f32_16x16x32_bf16 a[60:63], a[176:179], a[220:223], a[60:63]
ds_read_b64_tr_b16 a[176:177], v9 offset:0
v_mfma_f32_16x16x32_bf16 a[64:67], a[180:183], a[192:195], a[64:67]
ds_read_b64_tr_b16 a[178:179], v9 offset:1024
v_mfma_f32_16x16x32_bf16 a[68:71], a[180:183], a[196:199], a[68:71]
v_xor_b32 v9, 128, v5
v_mfma_f32_16x16x32_bf16 a[72:75], a[180:183], a[200:203], a[72:75]
v_mfma_f32_16x16x32_bf16 a[76:79], a[180:183], a[204:207], a[76:79]
s_add_u32 s48, s48, s34
v_mfma_f32_16x16x32_bf16 a[80:83], a[180:183], a[208:211], a[80:83]
s_add_u32 m0, s32, 24576
v_mfma_f32_16x16x32_bf16 a[84:87], a[180:183], a[212:215], a[84:87]
buffer_load_dwordx4 v1, s[12:15], s48 offen lds
v_mfma_f32_16x16x32_bf16 a[88:91], a[180:183], a[216:219], a[88:91]
v_mfma_f32_16x16x32_bf16 a[92:95], a[180:183], a[220:223], a[92:95]
ds_read_b64_tr_b16 a[180:181], v10 offset:0
v_mfma_f32_16x16x32_bf16 a[96:99], a[184:187], a[192:195], a[96:99]
ds_read_b64_tr_b16 a[182:183], v10 offset:1024
v_mfma_f32_16x16x32_bf16 a[100:103], a[184:187], a[196:199], a[100:103]
v_xor_b32 v10, 144, v5
v_mfma_f32_16x16x32_bf16 a[104:107], a[184:187], a[200:203], a[104:107]
s_add_u32 s48, s48, s34
v_mfma_f32_16x16x32_bf16 a[108:111], a[184:187], a[204:207], a[108:111]
s_add_u32 m0, s32, 28672
v_mfma_f32_16x16x32_bf16 a[112:115], a[184:187], a[208:211], a[112:115]
buffer_load_dwordx4 v1, s[12:15], s48 offen lds
v_mfma_f32_16x16x32_bf16 a[116:119], a[184:187], a[212:215], a[116:119]
s_add_u32 s30, s30, 128
v_mfma_f32_16x16x32_bf16 a[120:123], a[184:187], a[216:219], a[120:123]
s_add_u32 s32, s32, 32768
v_mfma_f32_16x16x32_bf16 a[124:127], a[184:187], a[220:223], a[124:127]
s_sub_u32 s48, s32, 98304
ds_read_b64_tr_b16 a[184:185], v11 offset:0
v_mfma_f32_16x16x32_bf16 a[128:131], a[188:191], a[192:195], a[128:131]
s_cmp_ge_u32 s32, 163840
s_cselect_b32 s32, s48, s32
ds_read_b64_tr_b16 a[186:187], v11 offset:1024
v_mfma_f32_16x16x32_bf16 a[132:135], a[188:191], a[196:199], a[132:135]
v_xor_b32 v11, 192, v5
v_mfma_f32_16x16x32_bf16 a[136:139], a[188:191], a[200:203], a[136:139]
buffer_load_dword v15, v14, s[96:99], s100 offen
v_mfma_f32_16x16x32_bf16 a[140:143], a[188:191], a[204:207], a[140:143]
s_add_u32 s100, s100, 16384
v_mfma_f32_16x16x32_bf16 a[144:147], a[188:191], a[208:211], a[144:147]
v_mfma_f32_16x16x32_bf16 a[148:151], a[188:191], a[212:215], a[148:151]
v_mfma_f32_16x16x32_bf16 a[152:155], a[188:191], a[216:219], a[152:155]
v_mfma_f32_16x16x32_bf16 a[156:159], a[188:191], a[220:223], a[156:159]
s_waitcnt vmcnt(23) lgkmcnt(0)
s_barrier
v_mfma_f32_16x16x32_bf16 v[160:163], a[160:163], a[224:227], v[160:163]
ds_read_b128 a[192:195], v3 offset:0
v_mfma_f32_16x16x32_bf16 v[164:167], a[160:163], a[228:231], v[164:167]
s_add_u32 s37, s31, 0
v_mfma_f32_16x16x32_bf16 v[168:171], a[160:163], a[232:235], v[168:171]
s_add_u32 m0, s33, 0
ds_read_b128 a[196:199], v4 offset:1024
v_mfma_f32_16x16x32_bf16 v[172:175], a[160:163], a[236:239], v[172:175]
buffer_load_dwordx4 v2, s[20:23], s37 offen  lds
v_mfma_f32_16x16x32_bf16 v[176:179], a[160:163], a[240:243], v[176:179]
ds_read_b128 a[200:203], v3 offset:4096
v_mfma_f32_16x16x32_bf16 v[180:183], a[160:163], a[244:247], v[180:183]
v_mfma_f32_16x16x32_bf16 v[184:187], a[160:163], a[248:251], v[184:187]
ds_read_b128 a[204:207], v4 offset:5120
v_mfma_f32_16x16x32_bf16 v[188:191], a[160:163], a[252:255], v[188:191]
ds_read_b64_tr_b16 a[160:161], v5 offset:0
v_mfma_f32_16x16x32_bf16 v[192:195], a[164:167], a[224:227], v[192:195]
s_add_u32 s37, s31, 32768
ds_read_b64_tr_b16 a[162:163], v5 offset:1024
v_mfma_f32_16x16x32_bf16 v[196:199], a[164:167], a[228:231], v[196:199]
s_add_u32 m0, s33, 1024
ds_read_b128 a[208:211], v3 offset:8192
v_add_u32 v5, 16384, v5
v_mfma_f32_16x16x32_bf16 v[200:203], a[164:167], a[232:235], v[200:203]
buffer_load_dwordx4 v2, s[20:23], s37 offen  lds
v_and_b32 v5, 65535, v5
v_mfma_f32_16x16x32_bf16 v[204:207], a[164:167], a[236:239], v[204:207]
ds_read_b128 a[212:215], v4 offset:9216
v_mfma_f32_16x16x32_bf16 v[208:211], a[164:167], a[240:243], v[208:211]
v_mfma_f32_16x16x32_bf16 v[212:215], a[164:167], a[244:247], v[212:215]
ds_read_b128 a[216:219], v3 offset:12288
v_mfma_f32_16x16x32_bf16 v[216:219], a[164:167], a[248:251], v[216:219]
v_mfma_f32_16x16x32_bf16 v[220:223], a[164:167], a[252:255], v[220:223]
s_add_u32 s37, s31, 131072
ds_read_b64_tr_b16 a[164:165], v6 offset:0
v_mfma_f32_16x16x32_bf16 v[224:227], a[168:171], a[224:227], v[224:227]
s_add_u32 m0, s33, 4096
ds_read_b64_tr_b16 a[166:167], v6 offset:1024
v_mfma_f32_16x16x32_bf16 v[228:231], a[168:171], a[228:231], v[228:231]
buffer_load_dwordx4 v2, s[20:23], s37 offen  lds
v_xor_b32 v6, 16, v5
v_mfma_f32_16x16x32_bf16 v[232:235], a[168:171], a[232:235], v[232:235]
ds_read_b128 a[220:223], v4 offset:13312
v_mfma_f32_16x16x32_bf16 v[236:239], a[168:171], a[236:239], v[236:239]
v_mfma_f32_16x16x32_bf16 v[240:243], a[168:171], a[240:243], v[240:243]
ds_read_b64_tr_b16 a[188:189], v12 offset:0
v_mfma_f32_16x16x32_bf16 v[244:247], a[168:171], a[244:247], v[244:247]
v_mfma_f32_16x16x32_bf16 v[248:251], a[168:171], a[248:251], v[248:251]
s_add_u32 s37, s31, 163840
ds_read_b64_tr_b16 a[190:191], v12 offset:1024
v_mfma_f32_16x16x32_bf16 v[252:255], a[168:171], a[252:255], v[252:255]
s_add_u32 m0, s33, 5120
ds_read_b64_tr_b16 a[168:169], v7 offset:0
v_mfma_f32_16x16x32_bf16 a[0:3], a[172:175], a[224:227], a[0:3]
buffer_load_dwordx4 v2, s[20:23], s37 offen  lds
ds_read_b64_tr_b16 a[170:171], v7 offset:1024
v_mfma_f32_16x16x32_bf16 a[4:7], a[172:175], a[228:231], a[4:7]
s_add_u32 s31, s31, 262144
v_xor_b32 v7, 64, v5
v_xor_b32 v12, 208, v5
v_mfma_f32_16x16x32_bf16 a[8:11], a[172:175], a[232:235], a[8:11]
s_add_u32 s33, s33, 16384
v_mfma_f32_16x16x32_bf16 a[12:15], a[172:175], a[236:239], a[12:15]
s_and_b32 s33, s33, 65535
v_mfma_f32_16x16x32_bf16 a[16:19], a[172:175], a[240:243], a[16:19]
v_mfma_f32_16x16x32_bf16 a[20:23], a[172:175], a[244:247], a[20:23]
s_mov_b32 s48, s30
v_mfma_f32_16x16x32_bf16 a[24:27], a[172:175], a[248:251], a[24:27]
s_add_u32 m0, s32, 0
v_mfma_f32_16x16x32_bf16 a[28:31], a[172:175], a[252:255], a[28:31]
buffer_load_dwordx4 v1, s[12:15], s48 offen lds
ds_read_b64_tr_b16 a[172:173], v8 offset:0
v_mfma_f32_16x16x32_bf16 a[32:35], a[176:179], a[224:227], a[32:35]
ds_read_b64_tr_b16 a[174:175], v8 offset:1024
v_mfma_f32_16x16x32_bf16 a[36:39], a[176:179], a[228:231], a[36:39]
v_xor_b32 v8, 80, v5
v_mfma_f32_16x16x32_bf16 a[40:43], a[176:179], a[232:235], a[40:43]
v_mfma_f32_16x16x32_bf16 a[44:47], a[176:179], a[236:239], a[44:47]
v_mfma_f32_16x16x32_bf16 a[48:51], a[176:179], a[240:243], a[48:51]
s_add_u32 s48, s48, s34
v_mfma_f32_16x16x32_bf16 a[52:55], a[176:179], a[244:247], a[52:55]
s_add_u32 m0, s32, 4096
v_mfma_f32_16x16x32_bf16 a[56:59], a[176:179], a[248:251], a[56:59]
buffer_load_dwordx4 v1, s[12:15], s48 offen lds
v_mfma_f32_16x16x32_bf16 a[60:63], a[176:179], a[252:255], a[60:63]
ds_read_b64_tr_b16 a[176:177], v9 offset:0
v_mfma_f32_16x16x32_bf16 a[64:67], a[180:183], a[224:227], a[64:67]
ds_read_b64_tr_b16 a[178:179], v9 offset:1024
v_mfma_f32_16x16x32_bf16 a[68:71], a[180:183], a[228:231], a[68:71]
v_xor_b32 v9, 128, v5
v_mfma_f32_16x16x32_bf16 a[72:75], a[180:183], a[232:235], a[72:75]
v_mfma_f32_16x16x32_bf16 a[76:79], a[180:183], a[236:239], a[76:79]
s_add_u32 s48, s48, s34
v_mfma_f32_16x16x32_bf16 a[80:83], a[180:183], a[240:243], a[80:83]
s_add_u32 m0, s32, 8192
v_mfma_f32_16x16x32_bf16 a[84:87], a[180:183], a[244:247], a[84:87]
buffer_load_dwordx4 v1, s[12:15], s48 offen lds
v_mfma_f32_16x16x32_bf16 a[88:91], a[180:183], a[248:251], a[88:91]
v_mfma_f32_16x16x32_bf16 a[92:95], a[180:183], a[252:255], a[92:95]
ds_read_b64_tr_b16 a[180:181], v10 offset:0
v_mfma_f32_16x16x32_bf16 a[96:99], a[184:187], a[224:227], a[96:99]
ds_read_b64_tr_b16 a[182:183], v10 offset:1024
v_mfma_f32_16x16x32_bf16 a[100:103], a[184:187], a[228:231], a[100:103]
v_xor_b32 v10, 144, v5
v_mfma_f32_16x16x32_bf16 a[104:107], a[184:187], a[232:235], a[104:107]
s_add_u32 s48, s48, s34
v_mfma_f32_16x16x32_bf16 a[108:111], a[184:187], a[236:239], a[108:111]
s_add_u32 m0, s32, 12288
v_mfma_f32_16x16x32_bf16 a[112:115], a[184:187], a[240:243], a[112:115]
buffer_load_dwordx4 v1, s[12:15], s48 offen lds
v_mfma_f32_16x16x32_bf16 a[116:119], a[184:187], a[244:247], a[116:119]
v_mfma_f32_16x16x32_bf16 a[120:123], a[184:187], a[248:251], a[120:123]
v_mfma_f32_16x16x32_bf16 a[124:127], a[184:187], a[252:255], a[124:127]
ds_read_b64_tr_b16 a[184:185], v11 offset:0
v_mfma_f32_16x16x32_bf16 a[128:131], v[28:31], a[224:227], a[128:131]
ds_read_b64_tr_b16 a[186:187], v11 offset:1024
v_mfma_f32_16x16x32_bf16 a[132:135], v[28:31], a[228:231], a[132:135]
v_xor_b32 v11, 192, v5
v_mfma_f32_16x16x32_bf16 a[136:139], v[28:31], a[232:235], a[136:139]
buffer_load_dword v15, v14, s[96:99], s100 offen
v_mfma_f32_16x16x32_bf16 a[140:143], v[28:31], a[236:239], a[140:143]
s_add_u32 s100, s100, 16384
v_mfma_f32_16x16x32_bf16 a[144:147], v[28:31], a[240:243], a[144:147]
v_mfma_f32_16x16x32_bf16 a[148:151], v[28:31], a[244:247], a[148:151]
v_mfma_f32_16x16x32_bf16 a[152:155], v[28:31], a[248:251], a[152:155]
v_mfma_f32_16x16x32_bf16 a[156:159], v[28:31], a[252:255], a[156:159]
s_waitcnt vmcnt(20) lgkmcnt(0)
s_barrier
v_mfma_f32_16x16x32_bf16 v[160:163], a[160:163], a[192:195], v[160:163]
ds_read_b128 a[224:227], v4 offset:0
v_mfma_f32_16x16x32_bf16 v[164:167], a[160:163], a[196:199], v[164:167]
s_add_u32 s37, s31, 0
v_mfma_f32_16x16x32_bf16 v[168:171], a[160:163], a[200:203], v[168:171]
s_add_u32 m0, s33, 0
ds_read_b128 a[228:231], v3 offset:1024
v_mfma_f32_16x16x32_bf16 v[172:175], a[160:163], a[204:207], v[172:175]
buffer_load_dwordx4 v2, s[20:23], s37 offen  lds
v_mfma_f32_16x16x32_bf16 v[176:179], a[160:163], a[208:211], v[176:179]
ds_read_b128 a[232:235], v4 offset:4096
v_mfma_f32_16x16x32_bf16 v[180:183], a[160:163], a[212:215], v[180:183]
v_mfma_f32_16x16x32_bf16 v[184:187], a[160:163], a[216:219], v[184:187]
ds_read_b128 a[236:239], v3 offset:5120
v_mfma_f32_16x16x32_bf16 v[188:191], a[160:163], a[220:223], v[188:191]
ds_read_b64_tr_b16 a[160:161], v5 offset:0
v_mfma_f32_16x16x32_bf16 v[192:195], a[164:167], a[192:195], v[192:195]
s_add_u32 s37, s31, 32768
ds_read_b64_tr_b16 a[162:163], v5 offset:1024
v_mfma_f32_16x16x32_bf16 v[196:199], a[164:167], a[196:199], v[196:199]
s_add_u32 m0, s33, 1024
ds_read_b128 a[240:243], v4 offset:8192
v_add_u32 v5, 16384, v5
v_mfma_f32_16x16x32_bf16 v[200:203], a[164:167], a[200:203], v[200:203]
buffer_load_dwordx4 v2, s[20:23], s37 offen  lds
v_and_b32 v5, 65535, v5
v_mfma_f32_16x16x32_bf16 v[204:207], a[164:167], a[204:207], v[204:207]
ds_read_b128 a[244:247], v3 offset:9216
v_mfma_f32_16x16x32_bf16 v[208:211], a[164:167], a[208:211], v[208:211]
v_mfma_f32_16x16x32_bf16 v[212:215], a[164:167], a[212:215], v[212:215]
ds_read_b128 a[248:251], v4 offset:12288
v_mfma_f32_16x16x32_bf16 v[216:219], a[164:167], a[216:219], v[216:219]
v_mfma_f32_16x16x32_bf16 v[220:223], a[164:167], a[220:223], v[220:223]
s_add_u32 s37, s31, 131072
ds_read_b64_tr_b16 a[164:165], v6 offset:0
v_mfma_f32_16x16x32_bf16 v[224:227], a[168:171], a[192:195], v[224:227]
s_add_u32 m0, s33, 4096
ds_read_b64_tr_b16 a[166:167], v6 offset:1024
v_mfma_f32_16x16x32_bf16 v[228:231], a[168:171], a[196:199], v[228:231]
buffer_load_dwordx4 v2, s[20:23], s37 offen  lds
v_xor_b32 v6, 16, v5
v_mfma_f32_16x16x32_bf16 v[232:235], a[168:171], a[200:203], v[232:235]
ds_read_b128 a[252:255], v3 offset:13312
v_mfma_f32_16x16x32_bf16 v[236:239], a[168:171], a[204:207], v[236:239]
v_mfma_f32_16x16x32_bf16 v[240:243], a[168:171], a[208:211], v[240:243]
ds_read_b64_tr_b16 v[28:29], v12 offset:0
v_mfma_f32_16x16x32_bf16 v[244:247], a[168:171], a[212:215], v[244:247]
v_mfma_f32_16x16x32_bf16 v[248:251], a[168:171], a[216:219], v[248:251]
s_add_u32 s37, s31, 163840
ds_read_b64_tr_b16 v[30:31], v12 offset:1024
v_mfma_f32_16x16x32_bf16 v[252:255], a[168:171], a[220:223], v[252:255]
s_add_u32 m0, s33, 5120
ds_read_b64_tr_b16 a[168:169], v7 offset:0
v_mfma_f32_16x16x32_bf16 a[0:3], a[172:175], a[192:195], a[0:3]
buffer_load_dwordx4 v2, s[20:23], s37 offen  lds
ds_read_b64_tr_b16 a[170:171], v7 offset:1024
v_mfma_f32_16x16x32_bf16 a[4:7], a[172:175], a[196:199], a[4:7]
s_add_u32 s31, s31, 262144
v_xor_b32 v7, 64, v5
v_xor_b32 v12, 208, v5
v_mfma_f32_16x16x32_bf16 a[8:11], a[172:175], a[200:203], a[8:11]
s_add_u32 s33, s33, 16384
v_add_u32 v3, 32768, v3
v_mfma_f32_16x16x32_bf16 a[12:15], a[172:175], a[204:207], a[12:15]
s_and_b32 s33, s33, 65535
v_subrev_u32 v19, 98304, v3
v_mfma_f32_16x16x32_bf16 a[16:19], a[172:175], a[208:211], a[16:19]
v_cmp_le_u32 vcc, 163840, v3
v_mfma_f32_16x16x32_bf16 a[20:23], a[172:175], a[212:215], a[20:23]
s_add_u32 s48, s48, s34
v_cndmask_b32 v3, v3, v19, vcc
v_mfma_f32_16x16x32_bf16 a[24:27], a[172:175], a[216:219], a[24:27]
s_add_u32 m0, s32, 16384
v_xor_b32 v4, 64, v3
v_mfma_f32_16x16x32_bf16 a[28:31], a[172:175], a[220:223], a[28:31]
buffer_load_dwordx4 v1, s[12:15], s48 offen lds
ds_read_b64_tr_b16 a[172:173], v8 offset:0
v_mfma_f32_16x16x32_bf16 a[32:35], a[176:179], a[192:195], a[32:35]
ds_read_b64_tr_b16 a[174:175], v8 offset:1024
v_mfma_f32_16x16x32_bf16 a[36:39], a[176:179], a[196:199], a[36:39]
v_xor_b32 v8, 80, v5
v_mfma_f32_16x16x32_bf16 a[40:43], a[176:179], a[200:203], a[40:43]
v_mfma_f32_16x16x32_bf16 a[44:47], a[176:179], a[204:207], a[44:47]
v_mfma_f32_16x16x32_bf16 a[48:51], a[176:179], a[208:211], a[48:51]
s_add_u32 s48, s48, s34
v_mfma_f32_16x16x32_bf16 a[52:55], a[176:179], a[212:215], a[52:55]
s_add_u32 m0, s32, 20480
v_mfma_f32_16x16x32_bf16 a[56:59], a[176:179], a[216:219], a[56:59]
buffer_load_dwordx4 v1, s[12:15], s48 offen lds
v_mfma_f32_16x16x32_bf16 a[60:63], a[176:179], a[220:223], a[60:63]
ds_read_b64_tr_b16 a[176:177], v9 offset:0
v_mfma_f32_16x16x32_bf16 a[64:67], a[180:183], a[192:195], a[64:67]
ds_read_b64_tr_b16 a[178:179], v9 offset:1024
v_mfma_f32_16x16x32_bf16 a[68:71], a[180:183], a[196:199], a[68:71]
v_xor_b32 v9, 128, v5
v_mfma_f32_16x16x32_bf16 a[72:75], a[180:183], a[200:203], a[72:75]
v_mfma_f32_16x16x32_bf16 a[76:79], a[180:183], a[204:207], a[76:79]
s_add_u32 s48, s48, s34
v_mfma_f32_16x16x32_bf16 a[80:83], a[180:183], a[208:211], a[80:83]
s_add_u32 m0, s32, 24576
v_mfma_f32_16x16x32_bf16 a[84:87], a[180:183], a[212:215], a[84:87]
buffer_load_dwordx4 v1, s[12:15], s48 offen lds
v_mfma_f32_16x16x32_bf16 a[88:91], a[180:183], a[216:219], a[88:91]
v_mfma_f32_16x16x32_bf16 a[92:95], a[180:183], a[220:223], a[92:95]
ds_read_b64_tr_b16 a[180:181], v10 offset:0
v_mfma_f32_16x16x32_bf16 a[96:99], a[184:187], a[192:195], a[96:99]
ds_read_b64_tr_b16 a[182:183], v10 offset:1024
v_mfma_f32_16x16x32_bf16 a[100:103], a[184:187], a[196:199], a[100:103]
v_xor_b32 v10, 144, v5
v_mfma_f32_16x16x32_bf16 a[104:107], a[184:187], a[200:203], a[104:107]
s_add_u32 s48, s48, s34
v_mfma_f32_16x16x32_bf16 a[108:111], a[184:187], a[204:207], a[108:111]
s_add_u32 m0, s32, 28672
v_mfma_f32_16x16x32_bf16 a[112:115], a[184:187], a[208:211], a[112:115]
buffer_load_dwordx4 v1, s[12:15], s48 offen lds
v_mfma_f32_16x16x32_bf16 a[116:119], a[184:187], a[212:215], a[116:119]
s_add_u32 s30, s30, 128
v_mfma_f32_16x16x32_bf16 a[120:123], a[184:187], a[216:219], a[120:123]
s_add_u32 s32, s32, 32768
v_mfma_f32_16x16x32_bf16 a[124:127], a[184:187], a[220:223], a[124:127]
s_sub_u32 s48, s32, 98304
ds_read_b64_tr_b16 a[184:185], v11 offset:0
v_mfma_f32_16x16x32_bf16 a[128:131], a[188:191], a[192:195], a[128:131]
s_cmp_ge_u32 s32, 163840
s_cselect_b32 s32, s48, s32
ds_read_b64_tr_b16 a[186:187], v11 offset:1024
v_mfma_f32_16x16x32_bf16 a[132:135], a[188:191], a[196:199], a[132:135]
v_xor_b32 v11, 192, v5
v_mfma_f32_16x16x32_bf16 a[136:139], a[188:191], a[200:203], a[136:139]
buffer_load_dword v15, v14, s[96:99], s100 offen
v_mfma_f32_16x16x32_bf16 a[140:143], a[188:191], a[204:207], a[140:143]
s_add_u32 s100, s100, 16384
v_mfma_f32_16x16x32_bf16 a[144:147], a[188:191], a[208:211], a[144:147]
v_mfma_f32_16x16x32_bf16 a[148:151], a[188:191], a[212:215], a[148:151]
v_mfma_f32_16x16x32_bf16 a[152:155], a[188:191], a[216:219], a[152:155]
v_mfma_f32_16x16x32_bf16 a[156:159], a[188:191], a[220:223], a[156:159]
s_cmp_eq_u32 s41, 0
s_cbranch_scc0 L_g_k17v
s_waitcnt vmcnt(18) lgkmcnt(0)
s_barrier
v_mfma_f32_16x16x32_bf16 v[160:163], a[160:163], a[224:227], v[160:163]
ds_read_b128 a[192:195], v3 offset:0
v_mfma_f32_16x16x32_bf16 v[164:167], a[160:163], a[228:231], v[164:167]
s_add_u32 s37, s31, 0
v_mfma_f32_16x16x32_bf16 v[168:171], a[160:163], a[232:235], v[168:171]
s_add_u32 m0, s33, 0
ds_read_b128 a[196:199], v4 offset:1024
v_mfma_f32_16x16x32_bf16 v[172:175], a[160:163], a[236:239], v[172:175]
buffer_load_dwordx4 v2, s[20:23], s37 offen  lds
v_mfma_f32_16x16x32_bf16 v[176:179], a[160:163], a[240:243], v[176:179]
ds_read_b128 a[200:203], v3 offset:4096
v_cvt_pk_bf16_f32 v32, v160, v161
v_cvt_pk_bf16_f32 v33, v162, v163
v_mfma_f32_16x16x32_bf16 v[180:183], a[160:163], a[244:247], v[180:183]
v_cvt_pk_bf16_f32 v36, v164, v165
v_cvt_pk_bf16_f32 v37, v166, v167
v_mfma_f32_16x16x32_bf16 v[184:187], a[160:163], a[248:251], v[184:187]
ds_read_b128 a[204:207], v4 offset:5120
v_cvt_pk_bf16_f32 v40, v168, v169
v_cvt_pk_bf16_f32 v41, v170, v171
v_mfma_f32_16x16x32_bf16 v[188:191], a[160:163], a[252:255], v[188:191]
ds_read_b64_tr_b16 a[160:161], v5 offset:0
v_cvt_pk_bf16_f32 v44, v172, v173
v_cvt_pk_bf16_f32 v45, v174, v175
v_mfma_f32_16x16x32_bf16 v[192:195], a[164:167], a[224:227], v[192:195]
s_add_u32 s37, s31, 32768
ds_read_b64_tr_b16 a[162:163], v5 offset:1024
v_cvt_pk_bf16_f32 v48, v176, v177
v_cvt_pk_bf16_f32 v49, v178, v179
v_mfma_f32_16x16x32_bf16 v[196:199], a[164:167], a[228:231], v[196:199]
s_add_u32 m0, s33, 1024
ds_read_b128 a[208:211], v3 offset:8192
v_add_u32 v5, 16384, v5
v_cvt_pk_bf16_f32 v52, v180, v181
v_cvt_pk_bf16_f32 v53, v182, v183
v_mfma_f32_16x16x32_bf16 v[200:203], a[164:167], a[232:235], v[200:203]
buffer_load_dwordx4 v2, s[20:23], s37 offen  lds
v_and_b32 v5, 65535, v5
v_cvt_pk_bf16_f32 v56, v184, v185
v_cvt_pk_bf16_f32 v57, v186, v187
v_mfma_f32_16x16x32_bf16 v[204:207], a[164:167], a[236:239], v[204:207]
ds_read_b128 a[212:215], v4 offset:9216
v_cvt_pk_bf16_f32 v60, v188, v189
v_cvt_pk_bf16_f32 v61, v190, v191
v_mfma_f32_16x16x32_bf16 v[208:211], a[164:167], a[240:243], v[208:211]
v_cvt_pk_bf16_f32 v34, v192, v193
v_cvt_pk_bf16_f32 v35, v194, v195
v_mfma_f32_16x16x32_bf16 v[212:215], a[164:167], a[244:247], v[212:215]
ds_read_b128 a[216:219], v3 offset:12288
v_cvt_pk_bf16_f32 v38, v196, v197
v_cvt_pk_bf16_f32 v39, v198, v199
v_mfma_f32_16x16x32_bf16 v[216:219], a[164:167], a[248:251], v[216:219]
v_cvt_pk_bf16_f32 v42, v200, v201
v_cvt_pk_bf16_f32 v43, v202, v203
v_mfma_f32_16x16x32_bf16 v[220:223], a[164:167], a[252:255], v[220:223]
s_add_u32 s37, s31, 131072
ds_read_b64_tr_b16 a[164:165], v6 offset:0
v_cvt_pk_bf16_f32 v46, v204, v205
v_cvt_pk_bf16_f32 v47, v206, v207
v_mfma_f32_16x16x32_bf16 v[224:227], a[168:171], a[224:227], v[224:227]
s_add_u32 m0, s33, 4096
ds_read_b64_tr_b16 a[166:167], v6 offset:1024
v_cvt_pk_bf16_f32 v50, v208, v209
v_cvt_pk_bf16_f32 v51, v210, v211
v_mfma_f32_16x16x32_bf16 v[228:231], a[168:171], a[228:231], v[228:231]
buffer_load_dwordx4 v2, s[20:23], s37 offen  lds
v_xor_b32 v6, 16, v5
v_cvt_pk_bf16_f32 v54, v212, v213
v_cvt_pk_bf16_f32 v55, v214, v215
v_mfma_f32_16x16x32_bf16 v[232:235], a[168:171], a[232:235], v[232:235]
ds_read_b128 a[220:223], v4 offset:13312
v_cvt_pk_bf16_f32 v58, v216, v217
v_cvt_pk_bf16_f32 v59, v218, v219
v_mfma_f32_16x16x32_bf16 v[236:239], a[168:171], a[236:239], v[236:239]
v_cvt_pk_bf16_f32 v62, v220, v221
v_cvt_pk_bf16_f32 v63, v222, v223
v_mfma_f32_16x16x32_bf16 v[240:243], a[168:171], a[240:243], v[240:243]
ds_read_b64_tr_b16 a[188:189], v12 offset:0
v_cvt_pk_bf16_f32 v64, v224, v225
v_cvt_pk_bf16_f32 v65, v226, v227
v_mfma_f32_16x16x32_bf16 v[244:247], a[168:171], a[244:247], v[244:247]
v_cvt_pk_bf16_f32 v68, v228, v229
v_cvt_pk_bf16_f32 v69, v230, v231
v_mfma_f32_16x16x32_bf16 v[248:251], a[168:171], a[248:251], v[248:251]
s_add_u32 s37, s31, 163840
ds_read_b64_tr_b16 a[190:191], v12 offset:1024
v_cvt_pk_bf16_f32 v72, v232, v233
v_cvt_pk_bf16_f32 v73, v234, v235
v_mfma_f32_16x16x32_bf16 v[252:255], a[168:171], a[252:255], v[252:255]
s_add_u32 m0, s33, 5120
ds_read_b64_tr_b16 a[168:169], v7 offset:0
v_cvt_pk_bf16_f32 v76, v236, v237
v_cvt_pk_bf16_f32 v77, v238, v239
v_mfma_f32_16x16x32_bf16 a[0:3], a[172:175], a[224:227], a[0:3]
buffer_load_dwordx4 v2, s[20:23], s37 offen  lds
ds_read_b64_tr_b16 a[170:171], v7 offset:1024
v_cvt_pk_bf16_f32 v80, v240, v241
v_cvt_pk_bf16_f32 v81, v242, v243
v_mfma_f32_16x16x32_bf16 a[4:7], a[172:175], a[228:231], a[4:7]
s_add_u32 s31, s31, 262144
v_xor_b32 v7, 64, v5
v_xor_b32 v12, 208, v5
v_cvt_pk_bf16_f32 v84, v244, v245
v_cvt_pk_bf16_f32 v85, v246, v247
v_mfma_f32_16x16x32_bf16 a[8:11], a[172:175], a[232:235], a[8:11]
s_add_u32 s33, s33, 16384
v_cvt_pk_bf16_f32 v88, v248, v249
v_cvt_pk_bf16_f32 v89, v250, v251
v_mfma_f32_16x16x32_bf16 a[12:15], a[172:175], a[236:239], a[12:15]
s_and_b32 s33, s33, 65535
v_cvt_pk_bf16_f32 v92, v252, v253
v_cvt_pk_bf16_f32 v93, v254, v255
v_mfma_f32_16x16x32_bf16 a[16:19], a[172:175], a[240:243], a[16:19]
v_accvgpr_read_b32 v20, a0
v_accvgpr_read_b32 v21, a1
v_accvgpr_read_b32 v22, a2
v_accvgpr_read_b32 v23, a3
v_mfma_f32_16x16x32_bf16 a[20:23], a[172:175], a[244:247], a[20:23]
s_mov_b32 s48, s30
v_cvt_pk_bf16_f32 v66, v20, v21
v_cvt_pk_bf16_f32 v67, v22, v23
v_accvgpr_read_b32 v24, a4
v_accvgpr_read_b32 v25, a5
v_mfma_f32_16x16x32_bf16 a[24:27], a[172:175], a[248:251], a[24:27]
s_add_u32 m0, s32, 0
v_accvgpr_read_b32 v26, a6
v_accvgpr_read_b32 v27, a7
v_cvt_pk_bf16_f32 v70, v24, v25
v_cvt_pk_bf16_f32 v71, v26, v27
v_mfma_f32_16x16x32_bf16 a[28:31], a[172:175], a[252:255], a[28:31]
buffer_load_dwordx4 v1, s[12:15], s48 offen lds
ds_read_b64_tr_b16 a[172:173], v8 offset:0
v_accvgpr_read_b32 v20, a8
v_accvgpr_read_b32 v21, a9
v_mfma_f32_16x16x32_bf16 a[32:35], a[176:179], a[224:227], a[32:35]
ds_read_b64_tr_b16 a[174:175], v8 offset:1024
v_mov_b32 v16, 0
v_accvgpr_read_b32 v22, a10
v_accvgpr_read_b32 v23, a11
v_mfma_f32_16x16x32_bf16 a[36:39], a[176:179], a[228:231], a[36:39]
v_mov_b32 v17, 1
v_xor_b32 v8, 80, v5
v_cvt_pk_bf16_f32 v74, v20, v21
v_cvt_pk_bf16_f32 v75, v22, v23
v_mfma_f32_16x16x32_bf16 a[40:43], a[176:179], a[232:235], a[40:43]
s_cmp_eq_u32 s17, 0
s_cselect_b32 s29, s39, 536870912
v_accvgpr_read_b32 v24, a12
v_accvgpr_read_b32 v25, a13
v_mfma_f32_16x16x32_bf16 a[44:47], a[176:179], a[236:239], a[44:47]
s_mov_b64 exec, 1
buffer_store_dword v17, v16, s[8:11], s29 offen sc1
s_mov_b64 exec, -1
v_accvgpr_read_b32 v26, a14
v_mfma_f32_16x16x32_bf16 a[48:51], a[176:179], a[240:243], a[48:51]
s_add_u32 s48, s48, s34
v_accvgpr_read_b32 v27, a15
v_cvt_pk_bf16_f32 v78, v24, v25
v_cvt_pk_bf16_f32 v79, v26, v27
v_accvgpr_read_b32 v20, a16
v_mfma_f32_16x16x32_bf16 a[52:55], a[176:179], a[244:247], a[52:55]
s_add_u32 m0, s32, 4096
v_accvgpr_read_b32 v21, a17
v_accvgpr_read_b32 v22, a18
v_accvgpr_read_b32 v23, a19
v_cvt_pk_bf16_f32 v82, v20, v21
v_mfma_f32_16x16x32_bf16 a[56:59], a[176:179], a[248:251], a[56:59]
buffer_load_dwordx4 v1, s[12:15], s48 offen lds
v_cvt_pk_bf16_f32 v83, v22, v23
v_accvgpr_read_b32 v24, a20
v_accvgpr_read_b32 v25, a21
v_mfma_f32_16x16x32_bf16 a[60:63], a[176:179], a[252:255], a[60:63]
ds_read_b64_tr_b16 a[176:177], v9 offset:0
v_accvgpr_read_b32 v26, a22
v_accvgpr_read_b32 v27, a23
v_cvt_pk_bf16_f32 v86, v24, v25
v_mfma_f32_16x16x32_bf16 a[64:67], a[180:183], a[224:227], a[64:67]
ds_read_b64_tr_b16 a[178:179], v9 offset:1024
v_cvt_pk_bf16_f32 v87, v26, v27
v_accvgpr_read_b32 v20, a24
v_accvgpr_read_b32 v21, a25
v_mfma_f32_16x16x32_bf16 a[68:71], a[180:183], a[228:231], a[68:71]
v_xor_b32 v9, 128, v5
v_accvgpr_read_b32 v22, a26
v_accvgpr_read_b32 v23, a27
v_cvt_pk_bf16_f32 v90, v20, v21
v_mfma_f32_16x16x32_bf16 a[72:75], a[180:183], a[232:235], a[72:75]
v_cvt_pk_bf16_f32 v91, v22, v23
v_accvgpr_read_b32 v24, a28
v_accvgpr_read_b32 v25, a29
v_accvgpr_read_b32 v26, a30
v_mfma_f32_16x16x32_bf16 a[76:79], a[180:183], a[236:239], a[76:79]
s_add_u32 s48, s48, s34
v_accvgpr_read_b32 v27, a31
v_cvt_pk_bf16_f32 v94, v24, v25
v_cvt_pk_bf16_f32 v95, v26, v27
v_accvgpr_read_b32 v20, a32
v_mfma_f32_16x16x32_bf16 a[80:83], a[180:183], a[240:243], a[80:83]
s_add_u32 m0, s32, 8192
v_accvgpr_read_b32 v21, a33
v_accvgpr_read_b32 v22, a34
v_accvgpr_read_b32 v23, a35
v_cvt_pk_bf16_f32 v96, v20, v21
v_mfma_f32_16x16x32_bf16 a[84:87], a[180:183], a[244:247], a[84:87]
buffer_load_dwordx4 v1, s[12:15], s48 offen lds
v_cvt_pk_bf16_f32 v97, v22, v23
v_accvgpr_read_b32 v24, a36
v_accvgpr_read_b32 v25, a37
v_mfma_f32_16x16x32_bf16 a[88:91], a[180:183], a[248:251], a[88:91]
v_accvgpr_read_b32 v26, a38
v_accvgpr_read_b32 v27, a39
v_cvt_pk_bf16_f32 v100, v24, v25
v_cvt_pk_bf16_f32 v101, v26, v27
v_mfma_f32_16x16x32_bf16 a[92:95], a[180:183], a[252:255], a[92:95]
ds_read_b64_tr_b16 a[180:181], v10 offset:0
v_accvgpr_read_b32 v20, a40
v_accvgpr_read_b32 v21, a41
v_accvgpr_read_b32 v22, a42
v_mfma_f32_16x16x32_bf16 a[96:99], a[184:187], a[224:227], a[96:99]
ds_read_b64_tr_b16 a[182:183], v10 offset:1024
v_accvgpr_read_b32 v23, a43
v_cvt_pk_bf16_f32 v104, v20, v21
v_cvt_pk_bf16_f32 v105, v22, v23
v_mfma_f32_16x16x32_bf16 a[100:103], a[184:187], a[228:231], a[100:103]
v_xor_b32 v10, 144, v5
v_accvgpr_read_b32 v24, a44
v_accvgpr_read_b32 v25, a45
v_accvgpr_read_b32 v26, a46
v_mfma_f32_16x16x32_bf16 a[104:107], a[184:187], a[232:235], a[104:107]
s_add_u32 s48, s48, s34
v_accvgpr_read_b32 v27, a47
v_cvt_pk_bf16_f32 v108, v24, v25
v_cvt_pk_bf16_f32 v109, v26, v27
v_accvgpr_read_b32 v20, a48
v_mfma_f32_16x16x32_bf16 a[108:111], a[184:187], a[236:239], a[108:111]
s_add_u32 m0, s32, 12288
v_accvgpr_read_b32 v21, a49
v_accvgpr_read_b32 v22, a50
v_accvgpr_read_b32 v23, a51
v_cvt_pk_bf16_f32 v112, v20, v21
v_mfma_f32_16x16x32_bf16 a[112:115], a[184:187], a[240:243], a[112:115]
buffer_load_dwordx4 v1, s[12:15], s48 offen lds
v_cvt_pk_bf16_f32 v113, v22, v23
v_accvgpr_read_b32 v24, a52
v_accvgpr_read_b32 v25, a53
v_mfma_f32_16x16x32_bf16 a[116:119], a[184:187], a[244:247], a[116:119]
v_accvgpr_read_b32 v26, a54
v_accvgpr_read_b32 v27, a55
v_cvt_pk_bf16_f32 v116, v24, v25
v_cvt_pk_bf16_f32 v117, v26, v27
v_mfma_f32_16x16x32_bf16 a[120:123], a[184:187], a[248:251], a[120:123]
v_accvgpr_read_b32 v20, a56
v_accvgpr_read_b32 v21, a57
v_accvgpr_read_b32 v22, a58
v_accvgpr_read_b32 v23, a59
v_mfma_f32_16x16x32_bf16 a[124:127], a[184:187], a[252:255], a[124:127]
ds_read_b64_tr_b16 a[184:185], v11 offset:0
v_cvt_pk_bf16_f32 v120, v20, v21
v_cvt_pk_bf16_f32 v121, v22, v23
v_accvgpr_read_b32 v24, a60
v_mfma_f32_16x16x32_bf16 a[128:131], v[28:31], a[224:227], a[128:131]
ds_read_b64_tr_b16 a[186:187], v11 offset:1024
v_accvgpr_read_b32 v25, a61
v_accvgpr_read_b32 v26, a62
v_accvgpr_read_b32 v27, a63
v_mfma_f32_16x16x32_bf16 a[132:135], v[28:31], a[228:231], a[132:135]
v_xor_b32 v11, 192, v5
v_cvt_pk_bf16_f32 v124, v24, v25
v_cvt_pk_bf16_f32 v125, v26, v27
v_mfma_f32_16x16x32_bf16 a[136:139], v[28:31], a[232:235], a[136:139]
buffer_load_dword v15, v14, s[96:99], s100 offen
v_mfma_f32_16x16x32_bf16 a[140:143], v[28:31], a[236:239], a[140:143]
s_add_u32 s100, s100, 16384
v_mfma_f32_16x16x32_bf16 a[144:147], v[28:31], a[240:243], a[144:147]
v_mfma_f32_16x16x32_bf16 a[148:151], v[28:31], a[244:247], a[148:151]
v_mfma_f32_16x16x32_bf16 a[152:155], v[28:31], a[248:251], a[152:155]
v_mfma_f32_16x16x32_bf16 a[156:159], v[28:31], a[252:255], a[156:159]
s_cmp_lt_u32 s35, s45
s_cbranch_scc1 L_g_tile
s_branch L_g_end
L_g_k17v:
s_waitcnt vmcnt(18) lgkmcnt(0)
s_barrier
v_mfma_f32_16x16x32_bf16 v[160:163], a[160:163], a[224:227], v[160:163]
ds_read_b64_tr_b16 a[192:193], v5 offset:0
v_mfma_f32_16x16x32_bf16 v[164:167], a[160:163], a[228:231], v[164:167]
s_add_u32 s37, s31, 0
v_mfma_f32_16x16x32_bf16 v[168:171], a[160:163], a[232:235], v[168:171]
s_add_u32 m0, s33, 0
ds_read_b64_tr_b16 a[194:195], v5 offset:1024
v_mfma_f32_16x16x32_bf16 v[172:175], a[160:163], a[236:239], v[172:175]
buffer_load_dwordx4 v2, s[20:23], s37 offen  lds
v_mfma_f32_16x16x32_bf16 v[176:179], a[160:163], a[240:243], v[176:179]
ds_read_b64_tr_b16 a[196:197], v6 offset:0
v_cvt_pk_bf16_f32 v32, v160, v161
v_cvt_pk_bf16_f32 v33, v162, v163
v_mfma_f32_16x16x32_bf16 v[180:183], a[160:163], a[244:247], v[180:183]
v_cvt_pk_bf16_f32 v36, v164, v165
v_cvt_pk_bf16_f32 v37, v166, v167
v_mfma_f32_16x16x32_bf16 v[184:187], a[160:163], a[248:251], v[184:187]
ds_read_b64_tr_b16 a[198:199], v6 offset:1024
v_cvt_pk_bf16_f32 v40, v168, v169
v_cvt_pk_bf16_f32 v41, v170, v171
v_mfma_f32_16x16x32_bf16 v[188:191], a[160:163], a[252:255], v[188:191]
ds_read_b128 a[160:163], v3 offset:0
v_cvt_pk_bf16_f32 v44, v172, v173
v_cvt_pk_bf16_f32 v45, v174, v175
v_mfma_f32_16x16x32_bf16 v[192:195], a[164:167], a[224:227], v[192:195]
s_add_u32 s37, s31, 32768
ds_read_b64_tr_b16 a[200:201], v7 offset:0
v_cvt_pk_bf16_f32 v48, v176, v177
v_cvt_pk_bf16_f32 v49, v178, v179
v_mfma_f32_16x16x32_bf16 v[196:199], a[164:167], a[228:231], v[196:199]
s_add_u32 m0, s33, 1024
v_cvt_pk_bf16_f32 v52, v180, v181
v_cvt_pk_bf16_f32 v53, v182, v183
v_mfma_f32_16x16x32_bf16 v[200:203], a[164:167], a[232:235], v[200:203]
buffer_load_dwordx4 v2, s[20:23], s37 offen  lds
v_cvt_pk_bf16_f32 v56, v184, v185
v_cvt_pk_bf16_f32 v57, v186, v187
v_mfma_f32_16x16x32_bf16 v[204:207], a[164:167], a[236:239], v[204:207]
ds_read_b64_tr_b16 a[202:203], v7 offset:1024
v_cvt_pk_bf16_f32 v60, v188, v189
v_cvt_pk_bf16_f32 v61, v190, v191
v_mfma_f32_16x16x32_bf16 v[208:211], a[164:167], a[240:243], v[208:211]
v_cvt_pk_bf16_f32 v34, v192, v193
v_cvt_pk_bf16_f32 v35, v194, v195
v_mfma_f32_16x16x32_bf16 v[212:215], a[164:167], a[244:247], v[212:215]
ds_read_b64_tr_b16 a[204:205], v8 offset:0
v_cvt_pk_bf16_f32 v38, v196, v197
v_cvt_pk_bf16_f32 v39, v198, v199
v_mfma_f32_16x16x32_bf16 v[216:219], a[164:167], a[248:251], v[216:219]
v_cvt_pk_bf16_f32 v42, v200, v201
v_cvt_pk_bf16_f32 v43, v202, v203
v_mfma_f32_16x16x32_bf16 v[220:223], a[164:167], a[252:255], v[220:223]
s_add_u32 s37, s31, 131072
ds_read_b128 a[164:167], v4 offset:1024
v_cvt_pk_bf16_f32 v46, v204, v205
v_cvt_pk_bf16_f32 v47, v206, v207
v_mfma_f32_16x16x32_bf16 v[224:227], a[168:171], a[224:227], v[224:227]
s_add_u32 m0, s33, 4096
ds_read_b64_tr_b16 a[206:207], v8 offset:1024
v_cvt_pk_bf16_f32 v50, v208, v209
v_cvt_pk_bf16_f32 v51, v210, v211
v_mfma_f32_16x16x32_bf16 v[228:231], a[168:171], a[228:231], v[228:231]
buffer_load_dwordx4 v2, s[20:23], s37 offen  lds
v_cvt_pk_bf16_f32 v54, v212, v213
v_cvt_pk_bf16_f32 v55, v214, v215
v_mfma_f32_16x16x32_bf16 v[232:235], a[168:171], a[232:235], v[232:235]
ds_read_b64_tr_b16 a[208:209], v9 offset:0
v_cvt_pk_bf16_f32 v58, v216, v217
v_cvt_pk_bf16_f32 v59, v218, v219
v_mfma_f32_16x16x32_bf16 v[236:239], a[168:171], a[236:239], v[236:239]
v_cvt_pk_bf16_f32 v62, v220, v221
v_cvt_pk_bf16_f32 v63, v222, v223
v_mfma_f32_16x16x32_bf16 v[240:243], a[168:171], a[240:243], v[240:243]
ds_read_b64_tr_b16 a[210:211], v9 offset:1024
v_cvt_pk_bf16_f32 v64, v224, v225
v_cvt_pk_bf16_f32 v65, v226, v227
v_mfma_f32_16x16x32_bf16 v[244:247], a[168:171], a[244:247], v[244:247]
v_cvt_pk_bf16_f32 v68, v228, v229
v_cvt_pk_bf16_f32 v69, v230, v231
v_mfma_f32_16x16x32_bf16 v[248:251], a[168:171], a[248:251], v[248:251]
s_add_u32 s37, s31, 163840
ds_read_b64_tr_b16 a[212:213], v10 offset:0
v_cvt_pk_bf16_f32 v72, v232, v233
v_cvt_pk_bf16_f32 v73, v234, v235
v_mfma_f32_16x16x32_bf16 v[252:255], a[168:171], a[252:255], v[252:255]
s_add_u32 m0, s33, 5120
ds_read_b128 a[168:171], v3 offset:4096
v_cvt_pk_bf16_f32 v76, v236, v237
v_cvt_pk_bf16_f32 v77, v238, v239
v_mfma_f32_16x16x32_bf16 a[0:3], a[172:175], a[224:227], a[0:3]
buffer_load_dwordx4 v2, s[20:23], s37 offen  lds
v_cvt_pk_bf16_f32 v80, v240, v241
v_cvt_pk_bf16_f32 v81, v242, v243
v_mfma_f32_16x16x32_bf16 a[4:7], a[172:175], a[228:231], a[4:7]
s_add_u32 s31, s31, 262144
ds_read_b64_tr_b16 a[214:215], v10 offset:1024
v_cvt_pk_bf16_f32 v84, v244, v245
v_cvt_pk_bf16_f32 v85, v246, v247
v_mfma_f32_16x16x32_bf16 a[8:11], a[172:175], a[232:235], a[8:11]
s_add_u32 s33, s33, 16384
v_cvt_pk_bf16_f32 v88, v248, v249
v_cvt_pk_bf16_f32 v89, v250, v251
v_mfma_f32_16x16x32_bf16 a[12:15], a[172:175], a[236:239], a[12:15]
s_and_b32 s33, s33, 65535
ds_read_b64_tr_b16 a[216:217], v11 offset:0
v_cvt_pk_bf16_f32 v92, v252, v253
v_cvt_pk_bf16_f32 v93, v254, v255
v_mfma_f32_16x16x32_bf16 a[16:19], a[172:175], a[240:243], a[16:19]
v_accvgpr_read_b32 v20, a0
v_accvgpr_read_b32 v21, a1
v_accvgpr_read_b32 v22, a2
v_accvgpr_read_b32 v23, a3
v_mfma_f32_16x16x32_bf16 a[20:23], a[172:175], a[244:247], a[20:23]
s_mov_b32 s48, s30
ds_read_b64_tr_b16 a[218:219], v11 offset:1024
v_cvt_pk_bf16_f32 v66, v20, v21
v_cvt_pk_bf16_f32 v67, v22, v23
v_accvgpr_read_b32 v24, a4
v_mfma_f32_16x16x32_bf16 a[24:27], a[172:175], a[248:251], a[24:27]
s_add_u32 m0, s32, 0
v_accvgpr_read_b32 v25, a5
v_accvgpr_read_b32 v26, a6
v_accvgpr_read_b32 v27, a7
v_cvt_pk_bf16_f32 v70, v24, v25
v_mfma_f32_16x16x32_bf16 a[28:31], a[172:175], a[252:255], a[28:31]
buffer_load_dwordx4 v1, s[12:15], s48 offen lds
ds_read_b128 a[172:175], v4 offset:5120
v_cvt_pk_bf16_f32 v71, v26, v27
v_accvgpr_read_b32 v20, a8
v_mfma_f32_16x16x32_bf16 a[32:35], a[176:179], a[224:227], a[32:35]
ds_read_b64_tr_b16 a[220:221], v12 offset:0
v_mov_b32 v16, 0
v_accvgpr_read_b32 v21, a9
v_accvgpr_read_b32 v22, a10
v_mfma_f32_16x16x32_bf16 a[36:39], a[176:179], a[228:231], a[36:39]
v_mov_b32 v17, 1
v_accvgpr_read_b32 v23, a11
v_cvt_pk_bf16_f32 v74, v20, v21
v_cvt_pk_bf16_f32 v75, v22, v23
v_mfma_f32_16x16x32_bf16 a[40:43], a[176:179], a[232:235], a[40:43]
ds_read_b64_tr_b16 a[222:223], v12 offset:1024
v_accvgpr_read_b32 v24, a12
v_accvgpr_read_b32 v25, a13
v_accvgpr_read_b32 v26, a14
v_mfma_f32_16x16x32_bf16 a[44:47], a[176:179], a[236:239], a[44:47]
s_cmp_eq_u32 s17, 0
s_cselect_b32 s29, s39, 536870912
v_accvgpr_read_b32 v27, a15
v_cvt_pk_bf16_f32 v78, v24, v25
v_mfma_f32_16x16x32_bf16 a[48:51], a[176:179], a[240:243], a[48:51]
s_add_u32 s48, s48, s34
ds_read_b128 a[188:191], v4 offset:13312
v_cvt_pk_bf16_f32 v79, v26, v27
v_accvgpr_read_b32 v20, a16
v_accvgpr_read_b32 v21, a17
v_mfma_f32_16x16x32_bf16 a[52:55], a[176:179], a[244:247], a[52:55]
s_add_u32 m0, s32, 4096
v_accvgpr_read_b32 v22, a18
v_accvgpr_read_b32 v23, a19
v_cvt_pk_bf16_f32 v82, v20, v21
v_cvt_pk_bf16_f32 v83, v22, v23
v_mfma_f32_16x16x32_bf16 a[56:59], a[176:179], a[248:251], a[56:59]
buffer_load_dwordx4 v1, s[12:15], s48 offen lds
v_accvgpr_read_b32 v24, a20
v_accvgpr_read_b32 v25, a21
v_accvgpr_read_b32 v26, a22
v_mfma_f32_16x16x32_bf16 a[60:63], a[176:179], a[252:255], a[60:63]
ds_read_b128 a[176:179], v3 offset:8192
v_add_u32 v5, 16384, v5
v_accvgpr_read_b32 v27, a23
v_cvt_pk_bf16_f32 v86, v24, v25
v_mfma_f32_16x16x32_bf16 a[64:67], a[180:183], a[224:227], a[64:67]
s_mov_b64 exec, 1
buffer_store_dword v17, v16, s[8:11], s29 offen sc1
s_mov_b64 exec, -1
v_cvt_pk_bf16_f32 v87, v26, v27
v_mfma_f32_16x16x32_bf16 a[68:71], a[180:183], a[228:231], a[68:71]
v_and_b32 v5, 65535, v5
v_xor_b32 v6, 16, v5
v_accvgpr_read_b32 v20, a24
v_accvgpr_read_b32 v21, a25
v_mfma_f32_16x16x32_bf16 a[72:75], a[180:183], a[232:235], a[72:75]
v_xor_b32 v7, 64, v5
v_xor_b32 v8, 80, v5
v_accvgpr_read_b32 v22, a26
v_accvgpr_read_b32 v23, a27
v_mfma_f32_16x16x32_bf16 a[76:79], a[180:183], a[236:239], a[76:79]
s_add_u32 s48, s48, s34
v_xor_b32 v9, 128, v5
v_xor_b32 v10, 144, v5
v_cvt_pk_bf16_f32 v90, v20, v21
v_cvt_pk_bf16_f32 v91, v22, v23
v_mfma_f32_16x16x32_bf16 a[80:83], a[180:183], a[240:243], a[80:83]
s_add_u32 m0, s32, 8192
v_xor_b32 v11, 192, v5
v_xor_b32 v12, 208, v5
v_accvgpr_read_b32 v24, a28
v_accvgpr_read_b32 v25, a29
v_mfma_f32_16x16x32_bf16 a[84:87], a[180:183], a[244:247], a[84:87]
buffer_load_dwordx4 v1, s[12:15], s48 offen lds
v_accvgpr_read_b32 v26, a30
v_accvgpr_read_b32 v27, a31
v_cvt_pk_bf16_f32 v94, v24, v25
v_mfma_f32_16x16x32_bf16 a[88:91], a[180:183], a[248:251], a[88:91]
v_cvt_pk_bf16_f32 v95, v26, v27
v_accvgpr_read_b32 v20, a32
v_accvgpr_read_b32 v21, a33
v_accvgpr_read_b32 v22, a34
v_mfma_f32_16x16x32_bf16 a[92:95], a[180:183], a[252:255], a[92:95]
ds_read_b128 a[180:183], v4 offset:9216
v_accvgpr_read_b32 v23, a35
v_cvt_pk_bf16_f32 v96, v20, v21
v_cvt_pk_bf16_f32 v97, v22, v23
v_mfma_f32_16x16x32_bf16 a[96:99], a[184:187], a[224:227], a[96:99]
v_accvgpr_read_b32 v24, a36
v_accvgpr_read_b32 v25, a37
v_accvgpr_read_b32 v26, a38
v_accvgpr_read_b32 v27, a39
v_mfma_f32_16x16x32_bf16 a[100:103], a[184:187], a[228:231], a[100:103]
v_cvt_pk_bf16_f32 v100, v24, v25
v_cvt_pk_bf16_f32 v101, v26, v27
v_accvgpr_read_b32 v20, a40
v_accvgpr_read_b32 v21, a41
v_mfma_f32_16x16x32_bf16 a[104:107], a[184:187], a[232:235], a[104:107]
s_add_u32 s48, s48, s34
v_accvgpr_read_b32 v22, a42
v_accvgpr_read_b32 v23, a43
v_cvt_pk_bf16_f32 v104, v20, v21
v_cvt_pk_bf16_f32 v105, v22, v23
v_mfma_f32_16x16x32_bf16 a[108:111], a[184:187], a[236:239], a[108:111]
s_add_u32 m0, s32, 12288
v_accvgpr_read_b32 v24, a44
v_accvgpr_read_b32 v25, a45
v_accvgpr_read_b32 v26, a46
v_accvgpr_read_b32 v27, a47
v_mfma_f32_16x16x32_bf16 a[112:115], a[184:187], a[240:243], a[112:115]
buffer_load_dwordx4 v1, s[12:15], s48 offen lds
v_cvt_pk_bf16_f32 v108, v24, v25
v_cvt_pk_bf16_f32 v109, v26, v27
v_accvgpr_read_b32 v20, a48
v_mfma_f32_16x16x32_bf16 a[116:119], a[184:187], a[244:247], a[116:119]
v_accvgpr_read_b32 v21, a49
v_accvgpr_read_b32 v22, a50
v_accvgpr_read_b32 v23, a51
v_cvt_pk_bf16_f32 v112, v20, v21
v_mfma_f32_16x16x32_bf16 a[120:123], a[184:187], a[248:251], a[120:123]
v_cvt_pk_bf16_f32 v113, v22, v23
v_accvgpr_read_b32 v24, a52
v_accvgpr_read_b32 v25, a53
v_accvgpr_read_b32 v26, a54
v_mfma_f32_16x16x32_bf16 a[124:127], a[184:187], a[252:255], a[124:127]
ds_read_b128 a[184:187], v3 offset:12288
v_accvgpr_read_b32 v27, a55
v_cvt_pk_bf16_f32 v116, v24, v25
v_cvt_pk_bf16_f32 v117, v26, v27
v_mfma_f32_16x16x32_bf16 a[128:131], v[28:31], a[224:227], a[128:131]
v_accvgpr_read_b32 v20, a56
v_accvgpr_read_b32 v21, a57
v_accvgpr_read_b32 v22, a58
v_accvgpr_read_b32 v23, a59
v_mfma_f32_16x16x32_bf16 a[132:135], v[28:31], a[228:231], a[132:135]
v_cvt_pk_bf16_f32 v120, v20, v21
v_cvt_pk_bf16_f32 v121, v22, v23
v_accvgpr_read_b32 v24, a60
v_accvgpr_read_b32 v25, a61
v_mfma_f32_16x16x32_bf16 a[136:139], v[28:31], a[232:235], a[136:139]
buffer_load_dword v15, v14, s[96:99], s100 offen
v_accvgpr_read_b32 v26, a62
v_accvgpr_read_b32 v27, a63
v_cvt_pk_bf16_f32 v124, v24, v25
v_mfma_f32_16x16x32_bf16 a[140:143], v[28:31], a[236:239], a[140:143]
s_add_u32 s100, s100, 16384
v_cvt_pk_bf16_f32 v125, v26, v27
v_mfma_f32_16x16x32_bf16 a[144:147], v[28:31], a[240:243], a[144:147]
v_mfma_f32_16x16x32_bf16 a[148:151], v[28:31], a[244:247], a[148:151]
v_mfma_f32_16x16x32_bf16 a[152:155], v[28:31], a[248:251], a[152:155]
v_mfma_f32_16x16x32_bf16 a[156:159], v[28:31], a[252:255], a[156:159]
s_cmp_lt_u32 s35, s45
s_cbranch_scc1 L_g_tile
s_branch L_g_end
.p2align 3
L_g_v:
s_waitcnt vmcnt(16) lgkmcnt(0)
s_barrier
v_mfma_f32_16x16x32_bf16 v[160:163], a[160:163], a[192:195], 0
ds_read_b64_tr_b16 a[224:225], v5 offset:0
v_accvgpr_read_b32 v20, a64
v_accvgpr_read_b32 v21, a65
v_accvgpr_read_b32 v22, a66
v_mfma_f32_16x16x32_bf16 v[164:167], a[160:163], a[196:199], 0
v_accvgpr_read_b32 v23, a67
v_cvt_pk_bf16_f32 v98, v20, v21
v_cvt_pk_bf16_f32 v99, v22, v23
v_accvgpr_read_b32 v24, a68
v_mfma_f32_16x16x32_bf16 v[168:171], a[160:163], a[200:203], 0
ds_read_b64_tr_b16 a[226:227], v5 offset:1024
v_accvgpr_read_b32 v25, a69
v_accvgpr_read_b32 v26, a70
v_accvgpr_read_b32 v27, a71
v_mfma_f32_16x16x32_bf16 v[172:175], a[160:163], a[204:207], 0
s_add_u32 s37, s31, 0
v_cvt_pk_bf16_f32 v102, v24, v25
v_cvt_pk_bf16_f32 v103, v26, v27
v_accvgpr_read_b32 v20, a72
v_accvgpr_read_b32 v21, a73
v_mfma_f32_16x16x32_bf16 v[176:179], a[160:163], a[208:211], 0
s_add_u32 m0, s33, 0
ds_read_b64_tr_b16 a[228:229], v6 offset:0
v_accvgpr_read_b32 v22, a74
v_accvgpr_read_b32 v23, a75
v_cvt_pk_bf16_f32 v106, v20, v21
v_mfma_f32_16x16x32_bf16 v[180:183], a[160:163], a[212:215], 0
buffer_load_dwordx4 v2, s[20:23], s37 offen  lds
v_cvt_pk_bf16_f32 v107, v22, v23
v_accvgpr_read_b32 v24, a76
v_accvgpr_read_b32 v25, a77
v_mfma_f32_16x16x32_bf16 v[184:187], a[160:163], a[216:219], 0
ds_read_b64_tr_b16 a[230:231], v6 offset:1024
v_accvgpr_read_b32 v26, a78
v_accvgpr_read_b32 v27, a79
v_cvt_pk_bf16_f32 v110, v24, v25
v_mfma_f32_16x16x32_bf16 v[188:191], a[160:163], a[220:223], 0
ds_read_b128 a[160:163], v4 offset:0
v_cvt_pk_bf16_f32 v111, v26, v27
v_accvgpr_read_b32 v20, a80
v_accvgpr_read_b32 v21, a81
v_mfma_f32_16x16x32_bf16 v[192:195], a[164:167], a[192:195], 0
ds_read_b64_tr_b16 a[232:233], v7 offset:0
v_accvgpr_read_b32 v22, a82
v_accvgpr_read_b32 v23, a83
v_cvt_pk_bf16_f32 v114, v20, v21
v_mfma_f32_16x16x32_bf16 v[196:199], a[164:167], a[196:199], 0
v_cvt_pk_bf16_f32 v115, v22, v23
v_accvgpr_read_b32 v24, a84
v_accvgpr_read_b32 v25, a85
v_accvgpr_read_b32 v26, a86
v_mfma_f32_16x16x32_bf16 v[200:203], a[164:167], a[200:203], 0
s_add_u32 s37, s31, 32768
ds_read_b64_tr_b16 a[234:235], v7 offset:1024
v_accvgpr_read_b32 v27, a87
v_cvt_pk_bf16_f32 v118, v24, v25
v_cvt_pk_bf16_f32 v119, v26, v27
v_mfma_f32_16x16x32_bf16 v[204:207], a[164:167], a[204:207], 0
s_add_u32 m0, s33, 1024
v_accvgpr_read_b32 v20, a88
v_accvgpr_read_b32 v21, a89
v_accvgpr_read_b32 v22, a90
v_accvgpr_read_b32 v23, a91
v_mfma_f32_16x16x32_bf16 v[208:211], a[164:167], a[208:211], 0
buffer_load_dwordx4 v2, s[20:23], s37 offen  lds
v_cvt_pk_bf16_f32 v122, v20, v21
v_cvt_pk_bf16_f32 v123, v22, v23
v_accvgpr_read_b32 v24, a92
v_mfma_f32_16x16x32_bf16 v[212:215], a[164:167], a[212:215], 0
ds_read_b64_tr_b16 a[236:237], v8 offset:0
v_accvgpr_read_b32 v25, a93
v_accvgpr_read_b32 v26, a94
v_accvgpr_read_b32 v27, a95
v_mfma_f32_16x16x32_bf16 v[216:219], a[164:167], a[216:219], 0
v_cvt_pk_bf16_f32 v126, v24, v25
v_cvt_pk_bf16_f32 v127, v26, v27
v_accvgpr_read_b32 v20, a96
v_accvgpr_read_b32 v21, a97
v_mfma_f32_16x16x32_bf16 v[220:223], a[164:167], a[220:223], 0
ds_read_b128 a[164:167], v3 offset:1024
v_accvgpr_read_b32 v22, a98
v_accvgpr_read_b32 v23, a99
v_cvt_pk_bf16_f32 v128, v20, v21
v_mfma_f32_16x16x32_bf16 v[224:227], a[168:171], a[192:195], 0
ds_read_b64_tr_b16 a[238:239], v8 offset:1024
v_cvt_pk_bf16_f32 v129, v22, v23
v_accvgpr_read_b32 v24, a100
v_accvgpr_read_b32 v25, a101
v_mfma_f32_16x16x32_bf16 v[228:231], a[168:171], a[196:199], 0
s_add_u32 s37, s31, 131072
v_accvgpr_read_b32 v26, a102
v_accvgpr_read_b32 v27, a103
v_cvt_pk_bf16_f32 v132, v24, v25
v_cvt_pk_bf16_f32 v133, v26, v27
v_mfma_f32_16x16x32_bf16 v[232:235], a[168:171], a[200:203], 0
s_add_u32 m0, s33, 4096
ds_read_b64_tr_b16 a[240:241], v9 offset:0
v_accvgpr_read_b32 v20, a104
v_accvgpr_read_b32 v21, a105
v_accvgpr_read_b32 v22, a106
v_mfma_f32_16x16x32_bf16 v[236:239], a[168:171], a[204:207], 0
buffer_load_dwordx4 v2, s[20:23], s37 offen  lds
v_accvgpr_read_b32 v23, a107
v_cvt_pk_bf16_f32 v136, v20, v21
v_cvt_pk_bf16_f32 v137, v22, v23
v_mfma_f32_16x16x32_bf16 v[240:243], a[168:171], a[208:211], 0
ds_read_b64_tr_b16 a[242:243], v9 offset:1024
v_accvgpr_read_b32 v24, a108
v_accvgpr_read_b32 v25, a109
v_accvgpr_read_b32 v26, a110
v_mfma_f32_16x16x32_bf16 v[244:247], a[168:171], a[212:215], 0
v_accvgpr_read_b32 v27, a111
v_cvt_pk_bf16_f32 v140, v24, v25
v_cvt_pk_bf16_f32 v141, v26, v27
v_accvgpr_read_b32 v20, a112
v_mfma_f32_16x16x32_bf16 v[248:251], a[168:171], a[216:219], 0
ds_read_b64_tr_b16 a[244:245], v10 offset:0
v_accvgpr_read_b32 v21, a113
v_accvgpr_read_b32 v22, a114
v_accvgpr_read_b32 v23, a115
v_mfma_f32_16x16x32_bf16 v[252:255], a[168:171], a[220:223], 0
ds_read_b128 a[168:171], v4 offset:4096
v_cvt_pk_bf16_f32 v144, v20, v21
v_cvt_pk_bf16_f32 v145, v22, v23
v_accvgpr_read_b32 v24, a116
v_mfma_f32_16x16x32_bf16 a[0:3], a[172:175], a[192:195], 0
s_add_u32 s37, s31, 163840
ds_read_b64_tr_b16 a[246:247], v10 offset:1024
v_accvgpr_read_b32 v25, a117
v_accvgpr_read_b32 v26, a118
v_accvgpr_read_b32 v27, a119
v_mfma_f32_16x16x32_bf16 a[4:7], a[172:175], a[196:199], 0
s_add_u32 m0, s33, 5120
v_cvt_pk_bf16_f32 v148, v24, v25
v_cvt_pk_bf16_f32 v149, v26, v27
v_accvgpr_read_b32 v20, a120
v_accvgpr_read_b32 v21, a121
v_mfma_f32_16x16x32_bf16 a[8:11], a[172:175], a[200:203], 0
buffer_load_dwordx4 v2, s[20:23], s37 offen  lds
v_accvgpr_read_b32 v22, a122
v_accvgpr_read_b32 v23, a123
v_cvt_pk_bf16_f32 v152, v20, v21
v_mfma_f32_16x16x32_bf16 a[12:15], a[172:175], a[204:207], 0
s_add_u32 s31, s31, 262144
ds_read_b64_tr_b16 a[248:249], v11 offset:0
v_cvt_pk_bf16_f32 v153, v22, v23
v_accvgpr_read_b32 v24, a124
v_accvgpr_read_b32 v25, a125
v_mfma_f32_16x16x32_bf16 a[16:19], a[172:175], a[208:211], 0
s_add_u32 s33, s33, 16384
v_accvgpr_read_b32 v26, a126
v_accvgpr_read_b32 v27, a127
v_cvt_pk_bf16_f32 v156, v24, v25
v_cvt_pk_bf16_f32 v157, v26, v27
v_mfma_f32_16x16x32_bf16 a[20:23], a[172:175], a[212:215], 0
s_and_b32 s33, s33, 65535
ds_read_b64_tr_b16 a[250:251], v11 offset:1024
v_accvgpr_read_b32 v20, a128
v_accvgpr_read_b32 v21, a129
v_accvgpr_read_b32 v22, a130
v_mfma_f32_16x16x32_bf16 a[24:27], a[172:175], a[216:219], 0
v_accvgpr_read_b32 v23, a131
v_cvt_pk_bf16_f32 v130, v20, v21
v_cvt_pk_bf16_f32 v131, v22, v23
v_accvgpr_read_b32 v24, a132
v_mfma_f32_16x16x32_bf16 a[28:31], a[172:175], a[220:223], 0
s_add_u32 s48, s48, s34
ds_read_b128 a[172:175], v3 offset:5120
v_accvgpr_read_b32 v25, a133
v_accvgpr_read_b32 v26, a134
v_accvgpr_read_b32 v27, a135
v_mfma_f32_16x16x32_bf16 a[32:35], a[176:179], a[192:195], 0
s_add_u32 m0, s32, 16384
ds_read_b64_tr_b16 a[252:253], v12 offset:0
v_cvt_pk_bf16_f32 v134, v24, v25
v_cvt_pk_bf16_f32 v135, v26, v27
v_accvgpr_read_b32 v20, a136
v_mfma_f32_16x16x32_bf16 a[36:39], a[176:179], a[196:199], 0
buffer_load_dwordx4 v1, s[12:15], s48 offen lds
v_accvgpr_read_b32 v21, a137
v_accvgpr_read_b32 v22, a138
v_accvgpr_read_b32 v23, a139
v_mfma_f32_16x16x32_bf16 a[40:43], a[176:179], a[200:203], 0
ds_read_b64_tr_b16 a[254:255], v12 offset:1024
v_cvt_pk_bf16_f32 v138, v20, v21
v_cvt_pk_bf16_f32 v139, v22, v23
v_accvgpr_read_b32 v24, a140
v_mfma_f32_16x16x32_bf16 a[44:47], a[176:179], a[204:207], 0
v_accvgpr_read_b32 v25, a141
v_accvgpr_read_b32 v26, a142
v_accvgpr_read_b32 v27, a143
v_cvt_pk_bf16_f32 v142, v24, v25
v_mfma_f32_16x16x32_bf16 a[48:51], a[176:179], a[208:211], 0
ds_read_b128 v[28:31], v3 offset:13312
v_cvt_pk_bf16_f32 v143, v26, v27
v_accvgpr_read_b32 v20, a144
v_accvgpr_read_b32 v21, a145
s_mov_b32 s38, s62
s_mov_b32 s39, s63
v_mfma_f32_16x16x32_bf16 a[52:55], a[176:179], a[212:215], 0
v_accvgpr_read_b32 v22, a146
v_accvgpr_read_b32 v23, a147
v_cvt_pk_bf16_f32 v146, v20, v21
v_cvt_pk_bf16_f32 v147, v22, v23
s_mov_b32 s49, s50
s_mov_b32 s62, s42
v_mfma_f32_16x16x32_bf16 a[56:59], a[176:179], a[216:219], 0
s_add_u32 s48, s48, s34
v_accvgpr_read_b32 v24, a148
v_accvgpr_read_b32 v25, a149
v_accvgpr_read_b32 v26, a150
v_accvgpr_read_b32 v27, a151
s_mov_b32 s63, s43
s_mov_b32 s50, s51
v_mfma_f32_16x16x32_bf16 a[60:63], a[176:179], a[220:223], 0
s_add_u32 m0, s32, 20480
ds_read_b128 a[176:179], v4 offset:8192
v_add_u32 v5, 16384, v5
v_cvt_pk_bf16_f32 v150, v24, v25
v_cvt_pk_bf16_f32 v151, v26, v27
s_mov_b32 s36, s40
s_add_u32 s35, s35, 1
v_mfma_f32_16x16x32_bf16 a[64:67], a[180:183], a[192:195], 0
buffer_load_dwordx4 v1, s[12:15], s48 offen lds
v_and_b32 v5, 65535, v5
v_accvgpr_read_b32 v20, a152
v_accvgpr_read_b32 v21, a153
v_bfe_u32 v16, v0, 3, 3
v_lshlrev_b32 v16, 4, v16
v_mfma_f32_16x16x32_bf16 a[68:71], a[180:183], a[196:199], 0
v_xor_b32 v6, 16, v5
v_xor_b32 v7, 64, v5
v_accvgpr_read_b32 v22, a154
v_accvgpr_read_b32 v23, a155
v_and_or_b32 v16, v0, 7, v16
v_bfe_u32 v17, v0, 4, 2
v_mfma_f32_16x16x32_bf16 a[72:75], a[180:183], a[200:203], 0
v_xor_b32 v8, 80, v5
v_xor_b32 v9, 128, v5
v_cvt_pk_bf16_f32 v154, v20, v21
v_cvt_pk_bf16_f32 v155, v22, v23
v_lshlrev_b32 v17, 5, v17
v_bfe_u32 v18, v0, 1, 3
v_mfma_f32_16x16x32_bf16 a[76:79], a[180:183], a[204:207], 0
v_xor_b32 v10, 144, v5
v_xor_b32 v11, 192, v5
v_accvgpr_read_b32 v24, a156
v_accvgpr_read_b32 v25, a157
v_or_b32 v17, v17, v18
v_and_b32 v18, 1, v0
v_mfma_f32_16x16x32_bf16 a[80:83], a[180:183], a[208:211], 0
v_xor_b32 v12, 208, v5
v_accvgpr_read_b32 v26, a158
v_accvgpr_read_b32 v27, a159
v_cvt_pk_bf16_f32 v158, v24, v25
v_lshl_or_b32 v17, v18, 4, v17
v_mfma_f32_16x16x32_bf16 a[84:87], a[180:183], a[212:215], 0
s_add_u32 s48, s48, s34
v_cvt_pk_bf16_f32 v159, v26, v27
s_bitcmp1_b32 s49, 1
s_cselect_b64 vcc, -1, 0
s_movk_i32 s44, 0x80
v_cndmask_b32 v16, v16, v17, vcc
v_lshlrev_b32 v13, 4, v16
v_mfma_f32_16x16x32_bf16 a[88:91], a[180:183], a[216:219], 0
s_add_u32 m0, s32, 24576
s_movk_i32 s92, 0x800
s_bitcmp1_b32 s49, 0
s_cselect_b32 s92, 0x4000, s92
s_xor_b32 s93, s92, 0x4800
s_sub_u32 s93, s93, s44
v_mfma_f32_16x16x32_bf16 a[92:95], a[180:183], a[220:223], 0
buffer_load_dwordx4 v1, s[12:15], s48 offen lds
ds_read_b128 a[180:183], v3 offset:9216
v_mfma_f32_16x16x32_bf16 a[96:99], a[184:187], a[192:195], 0
v_mfma_f32_16x16x32_bf16 a[100:103], a[184:187], a[196:199], 0
v_mfma_f32_16x16x32_bf16 a[104:107], a[184:187], a[200:203], 0
v_mfma_f32_16x16x32_bf16 a[108:111], a[184:187], a[204:207], 0
v_mfma_f32_16x16x32_bf16 a[112:115], a[184:187], a[208:211], 0
s_add_u32 s48, s48, s34
v_mfma_f32_16x16x32_bf16 a[116:119], a[184:187], a[212:215], 0
s_add_u32 m0, s32, 28672
v_mfma_f32_16x16x32_bf16 a[120:123], a[184:187], a[216:219], 0
buffer_load_dwordx4 v1, s[12:15], s48 offen lds
v_mfma_f32_16x16x32_bf16 a[124:127], a[184:187], a[220:223], 0
s_add_u32 s30, s30, 128
ds_read_b128 a[184:187], v4 offset:12288
v_mfma_f32_16x16x32_bf16 a[128:131], a[188:191], a[192:195], 0
s_add_u32 s32, s32, 32768
v_add_u32 v3, 32768, v3
v_mfma_f32_16x16x32_bf16 a[132:135], a[188:191], a[196:199], 0
s_sub_u32 s48, s32, 98304
v_subrev_u32 v19, 98304, v3
v_mfma_f32_16x16x32_bf16 a[136:139], a[188:191], a[200:203], 0
s_cmp_ge_u32 s32, 163840
s_cselect_b32 s32, s48, s32
buffer_load_dword v15, v14, s[96:99], s100 offen
v_mfma_f32_16x16x32_bf16 a[140:143], a[188:191], a[204:207], 0
s_add_u32 s100, s100, 16384
v_cmp_le_u32 vcc, 163840, v3
v_mfma_f32_16x16x32_bf16 a[144:147], a[188:191], a[208:211], 0
s_nop 0
v_cndmask_b32 v3, v3, v19, vcc
v_mfma_f32_16x16x32_bf16 a[148:151], a[188:191], a[212:215], 0
v_xor_b32 v4, 64, v3
v_mfma_f32_16x16x32_bf16 a[152:155], a[188:191], a[216:219], 0
v_mfma_f32_16x16x32_bf16 a[156:159], a[188:191], a[220:223], 0
s_waitcnt vmcnt(17) lgkmcnt(0)
s_barrier
v_mfma_f32_16x16x32_bf16 v[160:163], a[160:163], a[224:227], v[160:163]
ds_read_b64_tr_b16 a[192:193], v5 offset:0
v_mfma_f32_16x16x32_bf16 v[164:167], a[160:163], a[228:231], v[164:167]
v_mfma_f32_16x16x32_bf16 v[168:171], a[160:163], a[232:235], v[168:171]
ds_read_b64_tr_b16 a[194:195], v5 offset:1024
v_mfma_f32_16x16x32_bf16 v[172:175], a[160:163], a[236:239], v[172:175]
s_add_u32 s37, s31, 0
v_mfma_f32_16x16x32_bf16 v[176:179], a[160:163], a[240:243], v[176:179]
s_add_u32 m0, s33, 0
ds_read_b64_tr_b16 a[196:197], v6 offset:0
v_mfma_f32_16x16x32_bf16 v[180:183], a[160:163], a[244:247], v[180:183]
buffer_load_dwordx4 v2, s[20:23], s37 offen  lds
v_mfma_f32_16x16x32_bf16 v[184:187], a[160:163], a[248:251], v[184:187]
ds_read_b64_tr_b16 a[198:199], v6 offset:1024
v_mfma_f32_16x16x32_bf16 v[188:191], a[160:163], a[252:255], v[188:191]
ds_read_b128 a[160:163], v3 offset:0
v_mfma_f32_16x16x32_bf16 v[192:195], a[164:167], a[224:227], v[192:195]
ds_read_b64_tr_b16 a[200:201], v7 offset:0
v_mfma_f32_16x16x32_bf16 v[196:199], a[164:167], a[228:231], v[196:199]
v_mfma_f32_16x16x32_bf16 v[200:203], a[164:167], a[232:235], v[200:203]
s_add_u32 s37, s31, 32768
ds_read_b64_tr_b16 a[202:203], v7 offset:1024
v_mfma_f32_16x16x32_bf16 v[204:207], a[164:167], a[236:239], v[204:207]
s_add_u32 m0, s33, 1024
v_mfma_f32_16x16x32_bf16 v[208:211], a[164:167], a[240:243], v[208:211]
buffer_load_dwordx4 v2, s[20:23], s37 offen  lds
v_mfma_f32_16x16x32_bf16 v[212:215], a[164:167], a[244:247], v[212:215]
ds_read_b64_tr_b16 a[204:205], v8 offset:0
v_mfma_f32_16x16x32_bf16 v[216:219], a[164:167], a[248:251], v[216:219]
s_mov_b32 s60, s38
v_mfma_f32_16x16x32_bf16 v[220:223], a[164:167], a[252:255], v[220:223]
s_mov_b32 s29, s38
ds_read_b128 a[164:167], v4 offset:1024
v_mfma_f32_16x16x32_bf16 v[224:227], a[168:171], a[224:227], v[224:227]
buffer_store_dwordx4 v[32:35], v13, s[8:11], s29 offen sc1
v_mfma_f32_16x16x32_bf16 v[228:231], a[168:171], a[228:231], v[228:231]
s_add_u32 s37, s31, 131072
ds_read_b64_tr_b16 a[206:207], v8 offset:1024
v_mfma_f32_16x16x32_bf16 v[232:235], a[168:171], a[232:235], v[232:235]
s_add_u32 m0, s33, 4096
v_mfma_f32_16x16x32_bf16 v[236:239], a[168:171], a[236:239], v[236:239]
buffer_load_dwordx4 v2, s[20:23], s37 offen  lds
v_mfma_f32_16x16x32_bf16 v[240:243], a[168:171], a[240:243], v[240:243]
ds_read_b64_tr_b16 a[208:209], v9 offset:0
v_mfma_f32_16x16x32_bf16 v[244:247], a[168:171], a[244:247], v[244:247]
v_mfma_f32_16x16x32_bf16 v[248:251], a[168:171], a[248:251], v[248:251]
ds_read_b64_tr_b16 a[210:211], v9 offset:1024
v_mfma_f32_16x16x32_bf16 v[252:255], a[168:171], a[252:255], v[252:255]
ds_read_b128 a[168:171], v3 offset:4096
v_mfma_f32_16x16x32_bf16 a[0:3], a[172:175], a[224:227], a[0:3]
s_add_u32 s37, s31, 163840
ds_read_b64_tr_b16 a[212:213], v10 offset:0
v_mfma_f32_16x16x32_bf16 a[4:7], a[172:175], a[228:231], a[4:7]
s_add_u32 m0, s33, 5120
v_mfma_f32_16x16x32_bf16 a[8:11], a[172:175], a[232:235], a[8:11]
buffer_load_dwordx4 v2, s[20:23], s37 offen  lds
v_mfma_f32_16x16x32_bf16 a[12:15], a[172:175], a[236:239], a[12:15]
s_add_u32 s31, s31, 262144
ds_read_b64_tr_b16 a[214:215], v10 offset:1024
v_mfma_f32_16x16x32_bf16 a[16:19], a[172:175], a[240:243], a[16:19]
s_add_u32 s33, s33, 16384
v_mfma_f32_16x16x32_bf16 a[20:23], a[172:175], a[244:247], a[20:23]
s_and_b32 s33, s33, 65535
ds_read_b64_tr_b16 a[216:217], v11 offset:0
v_mfma_f32_16x16x32_bf16 a[24:27], a[172:175], a[248:251], a[24:27]
v_mfma_f32_16x16x32_bf16 a[28:31], a[172:175], a[252:255], a[28:31]
s_mov_b32 s48, s30
ds_read_b128 a[172:175], v4 offset:5120
v_mfma_f32_16x16x32_bf16 a[32:35], a[176:179], a[224:227], a[32:35]
s_add_u32 m0, s32, 0
ds_read_b64_tr_b16 a[218:219], v11 offset:1024
v_mfma_f32_16x16x32_bf16 a[36:39], a[176:179], a[228:231], a[36:39]
buffer_load_dwordx4 v1, s[12:15], s48 offen lds
v_mfma_f32_16x16x32_bf16 a[40:43], a[176:179], a[232:235], a[40:43]
ds_read_b64_tr_b16 a[220:221], v12 offset:0
v_mfma_f32_16x16x32_bf16 a[44:47], a[176:179], a[236:239], a[44:47]
s_add_u32 s29, s29, s44
v_mfma_f32_16x16x32_bf16 a[48:51], a[176:179], a[240:243], a[48:51]
ds_read_b64_tr_b16 a[222:223], v12 offset:1024
v_mfma_f32_16x16x32_bf16 a[52:55], a[176:179], a[244:247], a[52:55]
buffer_store_dwordx4 v[36:39], v13, s[8:11], s29 offen sc1
v_mfma_f32_16x16x32_bf16 a[56:59], a[176:179], a[248:251], a[56:59]
s_add_u32 s48, s48, s34
ds_read_b128 a[188:191], v4 offset:13312
v_mfma_f32_16x16x32_bf16 a[60:63], a[176:179], a[252:255], a[60:63]
s_add_u32 m0, s32, 4096
ds_read_b128 a[176:179], v3 offset:8192
v_mfma_f32_16x16x32_bf16 a[64:67], a[180:183], a[224:227], a[64:67]
buffer_load_dwordx4 v1, s[12:15], s48 offen lds
v_mfma_f32_16x16x32_bf16 a[68:71], a[180:183], a[228:231], a[68:71]
v_add_u32 v5, 16384, v5
v_and_b32 v5, 65535, v5
v_mfma_f32_16x16x32_bf16 a[72:75], a[180:183], a[232:235], a[72:75]
v_xor_b32 v6, 16, v5
v_xor_b32 v7, 64, v5
v_mfma_f32_16x16x32_bf16 a[76:79], a[180:183], a[236:239], a[76:79]
v_xor_b32 v8, 80, v5
v_xor_b32 v9, 128, v5
v_mfma_f32_16x16x32_bf16 a[80:83], a[180:183], a[240:243], a[80:83]
v_xor_b32 v10, 144, v5
v_xor_b32 v11, 192, v5
v_mfma_f32_16x16x32_bf16 a[84:87], a[180:183], a[244:247], a[84:87]
s_add_u32 s48, s48, s34
v_xor_b32 v12, 208, v5
v_mfma_f32_16x16x32_bf16 a[88:91], a[180:183], a[248:251], a[88:91]
s_add_u32 m0, s32, 8192
v_mfma_f32_16x16x32_bf16 a[92:95], a[180:183], a[252:255], a[92:95]
buffer_load_dwordx4 v1, s[12:15], s48 offen lds
ds_read_b128 a[180:183], v4 offset:9216
v_mfma_f32_16x16x32_bf16 a[96:99], a[184:187], a[224:227], a[96:99]
v_mfma_f32_16x16x32_bf16 a[100:103], a[184:187], a[228:231], a[100:103]
v_mfma_f32_16x16x32_bf16 a[104:107], a[184:187], a[232:235], a[104:107]
v_mfma_f32_16x16x32_bf16 a[108:111], a[184:187], a[236:239], a[108:111]
v_mfma_f32_16x16x32_bf16 a[112:115], a[184:187], a[240:243], a[112:115]
s_add_u32 s48, s48, s34
v_mfma_f32_16x16x32_bf16 a[116:119], a[184:187], a[244:247], a[116:119]
s_add_u32 m0, s32, 12288
v_mfma_f32_16x16x32_bf16 a[120:123], a[184:187], a[248:251], a[120:123]
buffer_load_dwordx4 v1, s[12:15], s48 offen lds
v_mfma_f32_16x16x32_bf16 a[124:127], a[184:187], a[252:255], a[124:127]
ds_read_b128 a[184:187], v3 offset:12288
v_mfma_f32_16x16x32_bf16 a[128:131], v[28:31], a[224:227], a[128:131]
s_add_u32 s29, s29, s93
v_mfma_f32_16x16x32_bf16 a[132:135], v[28:31], a[228:231], a[132:135]
v_mfma_f32_16x16x32_bf16 a[136:139], v[28:31], a[232:235], a[136:139]
buffer_store_dwordx4 v[40:43], v13, s[8:11], s29 offen sc1
buffer_load_dword v15, v14, s[96:99], s100 offen
v_mfma_f32_16x16x32_bf16 a[140:143], v[28:31], a[236:239], a[140:143]
s_add_u32 s100, s100, 16384
v_mfma_f32_16x16x32_bf16 a[144:147], v[28:31], a[240:243], a[144:147]
v_mfma_f32_16x16x32_bf16 a[148:151], v[28:31], a[244:247], a[148:151]
v_mfma_f32_16x16x32_bf16 a[152:155], v[28:31], a[248:251], a[152:155]
v_mfma_f32_16x16x32_bf16 a[156:159], v[28:31], a[252:255], a[156:159]
s_waitcnt vmcnt(21) lgkmcnt(0)
s_barrier
v_mfma_f32_16x16x32_bf16 v[160:163], a[160:163], a[192:195], v[160:163]
ds_read_b64_tr_b16 a[224:225], v5 offset:0
v_mfma_f32_16x16x32_bf16 v[164:167], a[160:163], a[196:199], v[164:167]
v_mfma_f32_16x16x32_bf16 v[168:171], a[160:163], a[200:203], v[168:171]
ds_read_b64_tr_b16 a[226:227], v5 offset:1024
v_mfma_f32_16x16x32_bf16 v[172:175], a[160:163], a[204:207], v[172:175]
s_add_u32 s37, s31, 0
v_mfma_f32_16x16x32_bf16 v[176:179], a[160:163], a[208:211], v[176:179]
s_add_u32 m0, s33, 0
ds_read_b64_tr_b16 a[228:229], v6 offset:0
v_mfma_f32_16x16x32_bf16 v[180:183], a[160:163], a[212:215], v[180:183]
buffer_load_dwordx4 v2, s[20:23], s37 offen  lds
v_mfma_f32_16x16x32_bf16 v[184:187], a[160:163], a[216:219], v[184:187]
ds_read_b64_tr_b16 a[230:231], v6 offset:1024
v_mfma_f32_16x16x32_bf16 v[188:191], a[160:163], a[220:223], v[188:191]
ds_read_b128 a[160:163], v4 offset:0
v_mfma_f32_16x16x32_bf16 v[192:195], a[164:167], a[192:195], v[192:195]
ds_read_b64_tr_b16 a[232:233], v7 offset:0
v_mfma_f32_16x16x32_bf16 v[196:199], a[164:167], a[196:199], v[196:199]
v_mfma_f32_16x16x32_bf16 v[200:203], a[164:167], a[200:203], v[200:203]
s_add_u32 s37, s31, 32768
ds_read_b64_tr_b16 a[234:235], v7 offset:1024
v_mfma_f32_16x16x32_bf16 v[204:207], a[164:167], a[204:207], v[204:207]
s_add_u32 m0, s33, 1024
v_mfma_f32_16x16x32_bf16 v[208:211], a[164:167], a[208:211], v[208:211]
buffer_load_dwordx4 v2, s[20:23], s37 offen  lds
v_mfma_f32_16x16x32_bf16 v[212:215], a[164:167], a[212:215], v[212:215]
ds_read_b64_tr_b16 a[236:237], v8 offset:0
v_mfma_f32_16x16x32_bf16 v[216:219], a[164:167], a[216:219], v[216:219]
s_add_u32 s29, s29, s44
v_mfma_f32_16x16x32_bf16 v[220:223], a[164:167], a[220:223], v[220:223]
ds_read_b128 a[164:167], v3 offset:1024
v_mfma_f32_16x16x32_bf16 v[224:227], a[168:171], a[192:195], v[224:227]
buffer_store_dwordx4 v[44:47], v13, s[8:11], s29 offen sc1
v_mfma_f32_16x16x32_bf16 v[228:231], a[168:171], a[196:199], v[228:231]
s_add_u32 s37, s31, 131072
ds_read_b64_tr_b16 a[238:239], v8 offset:1024
v_mfma_f32_16x16x32_bf16 v[232:235], a[168:171], a[200:203], v[232:235]
s_add_u32 m0, s33, 4096
v_mfma_f32_16x16x32_bf16 v[236:239], a[168:171], a[204:207], v[236:239]
buffer_load_dwordx4 v2, s[20:23], s37 offen  lds
v_mfma_f32_16x16x32_bf16 v[240:243], a[168:171], a[208:211], v[240:243]
ds_read_b64_tr_b16 a[240:241], v9 offset:0
v_mfma_f32_16x16x32_bf16 v[244:247], a[168:171], a[212:215], v[244:247]
v_mfma_f32_16x16x32_bf16 v[248:251], a[168:171], a[216:219], v[248:251]
ds_read_b64_tr_b16 a[242:243], v9 offset:1024
v_mfma_f32_16x16x32_bf16 v[252:255], a[168:171], a[220:223], v[252:255]
ds_read_b128 a[168:171], v4 offset:4096
v_mfma_f32_16x16x32_bf16 a[0:3], a[172:175], a[192:195], a[0:3]
s_add_u32 s37, s31, 163840
ds_read_b64_tr_b16 a[244:245], v10 offset:0
v_mfma_f32_16x16x32_bf16 a[4:7], a[172:175], a[196:199], a[4:7]
s_add_u32 m0, s33, 5120
v_mfma_f32_16x16x32_bf16 a[8:11], a[172:175], a[200:203], a[8:11]
buffer_load_dwordx4 v2, s[20:23], s37 offen  lds
v_mfma_f32_16x16x32_bf16 a[12:15], a[172:175], a[204:207], a[12:15]
s_add_u32 s31, s31, 262144
ds_read_b64_tr_b16 a[246:247], v10 offset:1024
v_mfma_f32_16x16x32_bf16 a[16:19], a[172:175], a[208:211], a[16:19]
s_add_u32 s33, s33, 16384
v_mfma_f32_16x16x32_bf16 a[20:23], a[172:175], a[212:215], a[20:23]
s_and_b32 s33, s33, 65535
ds_read_b64_tr_b16 a[248:249], v11 offset:0
v_mfma_f32_16x16x32_bf16 a[24:27], a[172:175], a[216:219], a[24:27]
v_mfma_f32_16x16x32_bf16 a[28:31], a[172:175], a[220:223], a[28:31]
s_add_u32 s48, s48, s34
ds_read_b128 a[172:175], v3 offset:5120
v_mfma_f32_16x16x32_bf16 a[32:35], a[176:179], a[192:195], a[32:35]
s_add_u32 m0, s32, 16384
ds_read_b64_tr_b16 a[250:251], v11 offset:1024
v_mfma_f32_16x16x32_bf16 a[36:39], a[176:179], a[196:199], a[36:39]
buffer_load_dwordx4 v1, s[12:15], s48 offen lds
v_mfma_f32_16x16x32_bf16 a[40:43], a[176:179], a[200:203], a[40:43]
ds_read_b64_tr_b16 a[252:253], v12 offset:0
v_mfma_f32_16x16x32_bf16 a[44:47], a[176:179], a[204:207], a[44:47]
s_add_u32 s29, s29, s93
v_mfma_f32_16x16x32_bf16 a[48:51], a[176:179], a[208:211], a[48:51]
ds_read_b64_tr_b16 a[254:255], v12 offset:1024
v_mfma_f32_16x16x32_bf16 a[52:55], a[176:179], a[212:215], a[52:55]
buffer_store_dwordx4 v[48:51], v13, s[8:11], s29 offen sc1
v_mfma_f32_16x16x32_bf16 a[56:59], a[176:179], a[216:219], a[56:59]
s_add_u32 s48, s48, s34
ds_read_b128 v[28:31], v3 offset:13312
v_mfma_f32_16x16x32_bf16 a[60:63], a[176:179], a[220:223], a[60:63]
s_add_u32 m0, s32, 20480
ds_read_b128 a[176:179], v4 offset:8192
v_mfma_f32_16x16x32_bf16 a[64:67], a[180:183], a[192:195], a[64:67]
buffer_load_dwordx4 v1, s[12:15], s48 offen lds
v_mfma_f32_16x16x32_bf16 a[68:71], a[180:183], a[196:199], a[68:71]
v_add_u32 v5, 16384, v5
v_and_b32 v5, 65535, v5
v_mfma_f32_16x16x32_bf16 a[72:75], a[180:183], a[200:203], a[72:75]
v_xor_b32 v6, 16, v5
v_xor_b32 v7, 64, v5
v_mfma_f32_16x16x32_bf16 a[76:79], a[180:183], a[204:207], a[76:79]
v_xor_b32 v8, 80, v5
v_xor_b32 v9, 128, v5
v_mfma_f32_16x16x32_bf16 a[80:83], a[180:183], a[208:211], a[80:83]
v_xor_b32 v10, 144, v5
v_xor_b32 v11, 192, v5
v_mfma_f32_16x16x32_bf16 a[84:87], a[180:183], a[212:215], a[84:87]
s_add_u32 s48, s48, s34
v_xor_b32 v12, 208, v5
v_mfma_f32_16x16x32_bf16 a[88:91], a[180:183], a[216:219], a[88:91]
s_add_u32 m0, s32, 24576
v_mfma_f32_16x16x32_bf16 a[92:95], a[180:183], a[220:223], a[92:95]
buffer_load_dwordx4 v1, s[12:15], s48 offen lds
ds_read_b128 a[180:183], v3 offset:9216
v_mfma_f32_16x16x32_bf16 a[96:99], a[184:187], a[192:195], a[96:99]
v_mfma_f32_16x16x32_bf16 a[100:103], a[184:187], a[196:199], a[100:103]
v_mfma_f32_16x16x32_bf16 a[104:107], a[184:187], a[200:203], a[104:107]
v_mfma_f32_16x16x32_bf16 a[108:111], a[184:187], a[204:207], a[108:111]
v_mfma_f32_16x16x32_bf16 a[112:115], a[184:187], a[208:211], a[112:115]
s_add_u32 s48, s48, s34
v_mfma_f32_16x16x32_bf16 a[116:119], a[184:187], a[212:215], a[116:119]
s_add_u32 m0, s32, 28672
v_mfma_f32_16x16x32_bf16 a[120:123], a[184:187], a[216:219], a[120:123]
buffer_load_dwordx4 v1, s[12:15], s48 offen lds
v_mfma_f32_16x16x32_bf16 a[124:127], a[184:187], a[220:223], a[124:127]
s_add_u32 s30, s30, 128
ds_read_b128 a[184:187], v4 offset:12288
v_mfma_f32_16x16x32_bf16 a[128:131], a[188:191], a[192:195], a[128:131]
s_add_u32 s32, s32, 32768
s_add_u32 s29, s29, s44
v_add_u32 v3, 32768, v3
v_mfma_f32_16x16x32_bf16 a[132:135], a[188:191], a[196:199], a[132:135]
s_sub_u32 s48, s32, 98304
v_subrev_u32 v19, 98304, v3
v_mfma_f32_16x16x32_bf16 a[136:139], a[188:191], a[200:203], a[136:139]
s_cmp_ge_u32 s32, 163840
s_cselect_b32 s32, s48, s32
buffer_store_dwordx4 v[52:55], v13, s[8:11], s29 offen sc1
buffer_load_dword v15, v14, s[96:99], s100 offen
v_mfma_f32_16x16x32_bf16 a[140:143], a[188:191], a[204:207], a[140:143]
s_add_u32 s100, s100, 16384
v_cmp_le_u32 vcc, 163840, v3
v_mfma_f32_16x16x32_bf16 a[144:147], a[188:191], a[208:211], a[144:147]
s_nop 0
v_cndmask_b32 v3, v3, v19, vcc
v_mfma_f32_16x16x32_bf16 a[148:151], a[188:191], a[212:215], a[148:151]
v_xor_b32 v4, 64, v3
v_mfma_f32_16x16x32_bf16 a[152:155], a[188:191], a[216:219], a[152:155]
v_mfma_f32_16x16x32_bf16 a[156:159], a[188:191], a[220:223], a[156:159]
s_waitcnt vmcnt(24) lgkmcnt(0)
s_barrier
v_mfma_f32_16x16x32_bf16 v[160:163], a[160:163], a[224:227], v[160:163]
ds_read_b64_tr_b16 a[192:193], v5 offset:0
v_mfma_f32_16x16x32_bf16 v[164:167], a[160:163], a[228:231], v[164:167]
v_mfma_f32_16x16x32_bf16 v[168:171], a[160:163], a[232:235], v[168:171]
ds_read_b64_tr_b16 a[194:195], v5 offset:1024
v_mfma_f32_16x16x32_bf16 v[172:175], a[160:163], a[236:239], v[172:175]
s_add_u32 s37, s31, 0
v_mfma_f32_16x16x32_bf16 v[176:179], a[160:163], a[240:243], v[176:179]
s_add_u32 m0, s33, 0
ds_read_b64_tr_b16 a[196:197], v6 offset:0
v_mfma_f32_16x16x32_bf16 v[180:183], a[160:163], a[244:247], v[180:183]
buffer_load_dwordx4 v2, s[20:23], s37 offen  lds
v_mfma_f32_16x16x32_bf16 v[184:187], a[160:163], a[248:251], v[184:187]
ds_read_b64_tr_b16 a[198:199], v6 offset:1024
v_mfma_f32_16x16x32_bf16 v[188:191], a[160:163], a[252:255], v[188:191]
ds_read_b128 a[160:163], v3 offset:0
v_mfma_f32_16x16x32_bf16 v[192:195], a[164:167], a[224:227], v[192:195]
ds_read_b64_tr_b16 a[200:201], v7 offset:0
v_mfma_f32_16x16x32_bf16 v[196:199], a[164:167], a[228:231], v[196:199]
v_mfma_f32_16x16x32_bf16 v[200:203], a[164:167], a[232:235], v[200:203]
s_add_u32 s37, s31, 32768
ds_read_b64_tr_b16 a[202:203], v7 offset:1024
v_mfma_f32_16x16x32_bf16 v[204:207], a[164:167], a[236:239], v[204:207]
s_add_u32 m0, s33, 1024
v_mfma_f32_16x16x32_bf16 v[208:211], a[164:167], a[240:243], v[208:211]
buffer_load_dwordx4 v2, s[20:23], s37 offen  lds
v_mfma_f32_16x16x32_bf16 v[212:215], a[164:167], a[244:247], v[212:215]
ds_read_b64_tr_b16 a[204:205], v8 offset:0
v_mfma_f32_16x16x32_bf16 v[216:219], a[164:167], a[248:251], v[216:219]
s_add_u32 s29, s29, s93
v_mfma_f32_16x16x32_bf16 v[220:223], a[164:167], a[252:255], v[220:223]
ds_read_b128 a[164:167], v4 offset:1024
v_mfma_f32_16x16x32_bf16 v[224:227], a[168:171], a[224:227], v[224:227]
buffer_store_dwordx4 v[56:59], v13, s[8:11], s29 offen sc1
v_mfma_f32_16x16x32_bf16 v[228:231], a[168:171], a[228:231], v[228:231]
s_add_u32 s37, s31, 131072
ds_read_b64_tr_b16 a[206:207], v8 offset:1024
v_mfma_f32_16x16x32_bf16 v[232:235], a[168:171], a[232:235], v[232:235]
s_add_u32 m0, s33, 4096
v_mfma_f32_16x16x32_bf16 v[236:239], a[168:171], a[236:239], v[236:239]
buffer_load_dwordx4 v2, s[20:23], s37 offen  lds
v_mfma_f32_16x16x32_bf16 v[240:243], a[168:171], a[240:243], v[240:243]
ds_read_b64_tr_b16 a[208:209], v9 offset:0
v_mfma_f32_16x16x32_bf16 v[244:247], a[168:171], a[244:247], v[244:247]
v_mfma_f32_16x16x32_bf16 v[248:251], a[168:171], a[248:251], v[248:251]
ds_read_b64_tr_b16 a[210:211], v9 offset:1024
v_mfma_f32_16x16x32_bf16 v[252:255], a[168:171], a[252:255], v[252:255]
ds_read_b128 a[168:171], v3 offset:4096
v_mfma_f32_16x16x32_bf16 a[0:3], a[172:175], a[224:227], a[0:3]
s_add_u32 s37, s31, 163840
ds_read_b64_tr_b16 a[212:213], v10 offset:0
v_mfma_f32_16x16x32_bf16 a[4:7], a[172:175], a[228:231], a[4:7]
s_add_u32 m0, s33, 5120
v_mfma_f32_16x16x32_bf16 a[8:11], a[172:175], a[232:235], a[8:11]
buffer_load_dwordx4 v2, s[20:23], s37 offen  lds
v_mfma_f32_16x16x32_bf16 a[12:15], a[172:175], a[236:239], a[12:15]
s_add_u32 s31, s31, 262144
ds_read_b64_tr_b16 a[214:215], v10 offset:1024
v_mfma_f32_16x16x32_bf16 a[16:19], a[172:175], a[240:243], a[16:19]
s_add_u32 s33, s33, 16384
v_mfma_f32_16x16x32_bf16 a[20:23], a[172:175], a[244:247], a[20:23]
s_and_b32 s33, s33, 65535
ds_read_b64_tr_b16 a[216:217], v11 offset:0
v_mfma_f32_16x16x32_bf16 a[24:27], a[172:175], a[248:251], a[24:27]
v_mfma_f32_16x16x32_bf16 a[28:31], a[172:175], a[252:255], a[28:31]
s_mov_b32 s48, s30
ds_read_b128 a[172:175], v4 offset:5120
v_mfma_f32_16x16x32_bf16 a[32:35], a[176:179], a[224:227], a[32:35]
s_add_u32 m0, s32, 0
ds_read_b64_tr_b16 a[218:219], v11 offset:1024
v_mfma_f32_16x16x32_bf16 a[36:39], a[176:179], a[228:231], a[36:39]
buffer_load_dwordx4 v1, s[12:15], s48 offen lds
v_mfma_f32_16x16x32_bf16 a[40:43], a[176:179], a[232:235], a[40:43]
ds_read_b64_tr_b16 a[220:221], v12 offset:0
v_mfma_f32_16x16x32_bf16 a[44:47], a[176:179], a[236:239], a[44:47]
s_add_u32 s29, s29, s44
v_mfma_f32_16x16x32_bf16 a[48:51], a[176:179], a[240:243], a[48:51]
ds_read_b64_tr_b16 a[222:223], v12 offset:1024
v_mfma_f32_16x16x32_bf16 a[52:55], a[176:179], a[244:247], a[52:55]
buffer_store_dwordx4 v[60:63], v13, s[8:11], s29 offen sc1
v_mfma_f32_16x16x32_bf16 a[56:59], a[176:179], a[248:251], a[56:59]
s_add_u32 s48, s48, s34
ds_read_b128 a[188:191], v4 offset:13312
v_mfma_f32_16x16x32_bf16 a[60:63], a[176:179], a[252:255], a[60:63]
s_add_u32 m0, s32, 4096
ds_read_b128 a[176:179], v3 offset:8192
v_mfma_f32_16x16x32_bf16 a[64:67], a[180:183], a[224:227], a[64:67]
buffer_load_dwordx4 v1, s[12:15], s48 offen lds
v_mfma_f32_16x16x32_bf16 a[68:71], a[180:183], a[228:231], a[68:71]
v_add_u32 v5, 16384, v5
v_and_b32 v5, 65535, v5
v_mfma_f32_16x16x32_bf16 a[72:75], a[180:183], a[232:235], a[72:75]
v_xor_b32 v6, 16, v5
v_xor_b32 v7, 64, v5
v_mfma_f32_16x16x32_bf16 a[76:79], a[180:183], a[236:239], a[76:79]
v_xor_b32 v8, 80, v5
v_xor_b32 v9, 128, v5
v_mfma_f32_16x16x32_bf16 a[80:83], a[180:183], a[240:243], a[80:83]
v_xor_b32 v10, 144, v5
v_xor_b32 v11, 192, v5
v_mfma_f32_16x16x32_bf16 a[84:87], a[180:183], a[244:247], a[84:87]
s_add_u32 s48, s48, s34
v_xor_b32 v12, 208, v5
v_mfma_f32_16x16x32_bf16 a[88:91], a[180:183], a[248:251], a[88:91]
s_add_u32 m0, s32, 8192
v_mfma_f32_16x16x32_bf16 a[92:95], a[180:183], a[252:255], a[92:95]
buffer_load_dwordx4 v1, s[12:15], s48 offen lds
ds_read_b128 a[180:183], v4 offset:9216
v_mfma_f32_16x16x32_bf16 a[96:99], a[184:187], a[224:227], a[96:99]
v_mfma_f32_16x16x32_bf16 a[100:103], a[184:187], a[228:231], a[100:103]
v_mfma_f32_16x16x32_bf16 a[104:107], a[184:187], a[232:235], a[104:107]
v_mfma_f32_16x16x32_bf16 a[108:111], a[184:187], a[236:239], a[108:111]
v_mfma_f32_16x16x32_bf16 a[112:115], a[184:187], a[240:243], a[112:115]
s_add_u32 s48, s48, s34
v_mfma_f32_16x16x32_bf16 a[116:119], a[184:187], a[244:247], a[116:119]
s_add_u32 m0, s32, 12288
v_mfma_f32_16x16x32_bf16 a[120:123], a[184:187], a[248:251], a[120:123]
buffer_load_dwordx4 v1, s[12:15], s48 offen lds
v_mfma_f32_16x16x32_bf16 a[124:127], a[184:187], a[252:255], a[124:127]
ds_read_b128 a[184:187], v3 offset:12288
v_mfma_f32_16x16x32_bf16 a[128:131], v[28:31], a[224:227], a[128:131]
v_mfma_f32_16x16x32_bf16 a[132:135], v[28:31], a[228:231], a[132:135]
v_mfma_f32_16x16x32_bf16 a[136:139], v[28:31], a[232:235], a[136:139]
buffer_load_dword v15, v14, s[96:99], s100 offen
v_mfma_f32_16x16x32_bf16 a[140:143], v[28:31], a[236:239], a[140:143]
s_add_u32 s100, s100, 16384
v_mfma_f32_16x16x32_bf16 a[144:147], v[28:31], a[240:243], a[144:147]
v_mfma_f32_16x16x32_bf16 a[148:151], v[28:31], a[244:247], a[148:151]
v_mfma_f32_16x16x32_bf16 a[152:155], v[28:31], a[248:251], a[152:155]
v_mfma_f32_16x16x32_bf16 a[156:159], v[28:31], a[252:255], a[156:159]
s_waitcnt vmcnt(23) lgkmcnt(0)
s_barrier
v_mfma_f32_16x16x32_bf16 v[160:163], a[160:163], a[192:195], v[160:163]
ds_read_b64_tr_b16 a[224:225], v5 offset:0
v_mfma_f32_16x16x32_bf16 v[164:167], a[160:163], a[196:199], v[164:167]
v_mfma_f32_16x16x32_bf16 v[168:171], a[160:163], a[200:203], v[168:171]
ds_read_b64_tr_b16 a[226:227], v5 offset:1024
v_mfma_f32_16x16x32_bf16 v[172:175], a[160:163], a[204:207], v[172:175]
s_add_u32 s37, s31, 0
v_mfma_f32_16x16x32_bf16 v[176:179], a[160:163], a[208:211], v[176:179]
s_add_u32 m0, s33, 0
ds_read_b64_tr_b16 a[228:229], v6 offset:0
v_mfma_f32_16x16x32_bf16 v[180:183], a[160:163], a[212:215], v[180:183]
buffer_load_dwordx4 v2, s[20:23], s37 offen  lds
v_mfma_f32_16x16x32_bf16 v[184:187], a[160:163], a[216:219], v[184:187]
ds_read_b64_tr_b16 a[230:231], v6 offset:1024
v_mfma_f32_16x16x32_bf16 v[188:191], a[160:163], a[220:223], v[188:191]
ds_read_b128 a[160:163], v4 offset:0
v_mfma_f32_16x16x32_bf16 v[192:195], a[164:167], a[192:195], v[192:195]
ds_read_b64_tr_b16 a[232:233], v7 offset:0
v_mfma_f32_16x16x32_bf16 v[196:199], a[164:167], a[196:199], v[196:199]
v_mfma_f32_16x16x32_bf16 v[200:203], a[164:167], a[200:203], v[200:203]
s_add_u32 s37, s31, 32768
ds_read_b64_tr_b16 a[234:235], v7 offset:1024
v_mfma_f32_16x16x32_bf16 v[204:207], a[164:167], a[204:207], v[204:207]
s_add_u32 m0, s33, 1024
v_mfma_f32_16x16x32_bf16 v[208:211], a[164:167], a[208:211], v[208:211]
buffer_load_dwordx4 v2, s[20:23], s37 offen  lds
v_mfma_f32_16x16x32_bf16 v[212:215], a[164:167], a[212:215], v[212:215]
ds_read_b64_tr_b16 a[236:237], v8 offset:0
v_mfma_f32_16x16x32_bf16 v[216:219], a[164:167], a[216:219], v[216:219]
s_add_u32 s60, s60, s92
v_mfma_f32_16x16x32_bf16 v[220:223], a[164:167], a[220:223], v[220:223]
s_mov_b32 s29, s60
ds_read_b128 a[164:167], v3 offset:1024
v_mfma_f32_16x16x32_bf16 v[224:227], a[168:171], a[192:195], v[224:227]
buffer_store_dwordx4 v[64:67], v13, s[8:11], s29 offen sc1
v_mfma_f32_16x16x32_bf16 v[228:231], a[168:171], a[196:199], v[228:231]
s_add_u32 s37, s31, 131072
ds_read_b64_tr_b16 a[238:239], v8 offset:1024
v_mfma_f32_16x16x32_bf16 v[232:235], a[168:171], a[200:203], v[232:235]
s_add_u32 m0, s33, 4096
v_mfma_f32_16x16x32_bf16 v[236:239], a[168:171], a[204:207], v[236:239]
buffer_load_dwordx4 v2, s[20:23], s37 offen  lds
v_mfma_f32_16x16x32_bf16 v[240:243], a[168:171], a[208:211], v[240:243]
ds_read_b64_tr_b16 a[240:241], v9 offset:0
v_mfma_f32_16x16x32_bf16 v[244:247], a[168:171], a[212:215], v[244:247]
v_mfma_f32_16x16x32_bf16 v[248:251], a[168:171], a[216:219], v[248:251]
ds_read_b64_tr_b16 a[242:243], v9 offset:1024
v_mfma_f32_16x16x32_bf16 v[252:255], a[168:171], a[220:223], v[252:255]
ds_read_b128 a[168:171], v4 offset:4096
v_mfma_f32_16x16x32_bf16 a[0:3], a[172:175], a[192:195], a[0:3]
s_add_u32 s37, s31, 163840
ds_read_b64_tr_b16 a[244:245], v10 offset:0
v_mfma_f32_16x16x32_bf16 a[4:7], a[172:175], a[196:199], a[4:7]
s_add_u32 m0, s33, 5120
v_mfma_f32_16x16x32_bf16 a[8:11], a[172:175], a[200:203], a[8:11]
buffer_load_dwordx4 v2, s[20:23], s37 offen  lds
v_mfma_f32_16x16x32_bf16 a[12:15], a[172:175], a[204:207], a[12:15]
s_add_u32 s31, s31, 262144
ds_read_b64_tr_b16 a[246:247], v10 offset:1024
v_mfma_f32_16x16x32_bf16 a[16:19], a[172:175], a[208:211], a[16:19]
s_add_u32 s33, s33, 16384
v_mfma_f32_16x16x32_bf16 a[20:23], a[172:175], a[212:215], a[20:23]
s_and_b32 s33, s33, 65535
ds_read_b64_tr_b16 a[248:249], v11 offset:0
v_mfma_f32_16x16x32_bf16 a[24:27], a[172:175], a[216:219], a[24:27]
v_mfma_f32_16x16x32_bf16 a[28:31], a[172:175], a[220:223], a[28:31]
s_add_u32 s48, s48, s34
ds_read_b128 a[172:175], v3 offset:5120
v_mfma_f32_16x16x32_bf16 a[32:35], a[176:179], a[192:195], a[32:35]
s_add_u32 m0, s32, 16384
ds_read_b64_tr_b16 a[250:251], v11 offset:1024
v_mfma_f32_16x16x32_bf16 a[36:39], a[176:179], a[196:199], a[36:39]
buffer_load_dwordx4 v1, s[12:15], s48 offen lds
v_mfma_f32_16x16x32_bf16 a[40:43], a[176:179], a[200:203], a[40:43]
ds_read_b64_tr_b16 a[252:253], v12 offset:0
v_mfma_f32_16x16x32_bf16 a[44:47], a[176:179], a[204:207], a[44:47]
s_add_u32 s29, s29, s44
v_mfma_f32_16x16x32_bf16 a[48:51], a[176:179], a[208:211], a[48:51]
ds_read_b64_tr_b16 a[254:255], v12 offset:1024
v_mfma_f32_16x16x32_bf16 a[52:55], a[176:179], a[212:215], a[52:55]
buffer_store_dwordx4 v[68:71], v13, s[8:11], s29 offen sc1
v_mfma_f32_16x16x32_bf16 a[56:59], a[176:179], a[216:219], a[56:59]
s_add_u32 s48, s48, s34
ds_read_b128 v[28:31], v3 offset:13312
v_mfma_f32_16x16x32_bf16 a[60:63], a[176:179], a[220:223], a[60:63]
s_add_u32 m0, s32, 20480
ds_read_b128 a[176:179], v4 offset:8192
v_mfma_f32_16x16x32_bf16 a[64:67], a[180:183], a[192:195], a[64:67]
buffer_load_dwordx4 v1, s[12:15], s48 offen lds
v_mfma_f32_16x16x32_bf16 a[68:71], a[180:183], a[196:199], a[68:71]
v_add_u32 v5, 16384, v5
v_and_b32 v5, 65535, v5
v_mfma_f32_16x16x32_bf16 a[72:75], a[180:183], a[200:203], a[72:75]
v_xor_b32 v6, 16, v5
v_xor_b32 v7, 64, v5
v_mfma_f32_16x16x32_bf16 a[76:79], a[180:183], a[204:207], a[76:79]
v_xor_b32 v8, 80, v5
v_xor_b32 v9, 128, v5
v_mfma_f32_16x16x32_bf16 a[80:83], a[180:183], a[208:211], a[80:83]
v_xor_b32 v10, 144, v5
v_xor_b32 v11, 192, v5
v_mfma_f32_16x16x32_bf16 a[84:87], a[180:183], a[212:215], a[84:87]
s_add_u32 s48, s48, s34
v_xor_b32 v12, 208, v5
v_mfma_f32_16x16x32_bf16 a[88:91], a[180:183], a[216:219], a[88:91]
s_add_u32 m0, s32, 24576
v_mfma_f32_16x16x32_bf16 a[92:95], a[180:183], a[220:223], a[92:95]
buffer_load_dwordx4 v1, s[12:15], s48 offen lds
ds_read_b128 a[180:183], v3 offset:9216
v_mfma_f32_16x16x32_bf16 a[96:99], a[184:187], a[192:195], a[96:99]
v_mfma_f32_16x16x32_bf16 a[100:103], a[184:187], a[196:199], a[100:103]
v_mfma_f32_16x16x32_bf16 a[104:107], a[184:187], a[200:203], a[104:107]
v_mfma_f32_16x16x32_bf16 a[108:111], a[184:187], a[204:207], a[108:111]
v_mfma_f32_16x16x32_bf16 a[112:115], a[184:187], a[208:211], a[112:115]
s_add_u32 s48, s48, s34
v_mfma_f32_16x16x32_bf16 a[116:119], a[184:187], a[212:215], a[116:119]
s_add_u32 m0, s32, 28672
v_mfma_f32_16x16x32_bf16 a[120:123], a[184:187], a[216:219], a[120:123]
buffer_load_dwordx4 v1, s[12:15], s48 offen lds
v_mfma_f32_16x16x32_bf16 a[124:127], a[184:187], a[220:223], a[124:127]
s_add_u32 s30, s30, 128
ds_read_b128 a[184:187], v4 offset:12288
v_mfma_f32_16x16x32_bf16 a[128:131], a[188:191], a[192:195], a[128:131]
s_add_u32 s32, s32, 32768
s_add_u32 s29, s29, s93
v_add_u32 v3, 32768, v3
v_mfma_f32_16x16x32_bf16 a[132:135], a[188:191], a[196:199], a[132:135]
s_sub_u32 s48, s32, 98304
v_subrev_u32 v19, 98304, v3
v_mfma_f32_16x16x32_bf16 a[136:139], a[188:191], a[200:203], a[136:139]
s_cmp_ge_u32 s32, 163840
s_cselect_b32 s32, s48, s32
buffer_store_dwordx4 v[72:75], v13, s[8:11], s29 offen sc1
buffer_load_dword v15, v14, s[96:99], s100 offen
v_mfma_f32_16x16x32_bf16 a[140:143], a[188:191], a[204:207], a[140:143]
s_add_u32 s100, s100, 16384
v_cmp_le_u32 vcc, 163840, v3
v_mfma_f32_16x16x32_bf16 a[144:147], a[188:191], a[208:211], a[144:147]
s_nop 0
v_cndmask_b32 v3, v3, v19, vcc
v_mfma_f32_16x16x32_bf16 a[148:151], a[188:191], a[212:215], a[148:151]
v_xor_b32 v4, 64, v3
v_mfma_f32_16x16x32_bf16 a[152:155], a[188:191], a[216:219], a[152:155]
v_mfma_f32_16x16x32_bf16 a[156:159], a[188:191], a[220:223], a[156:159]
s_waitcnt vmcnt(23) lgkmcnt(0)
s_barrier
v_mfma_f32_16x16x32_bf16 v[160:163], a[160:163], a[224:227], v[160:163]
ds_read_b64_tr_b16 a[192:193], v5 offset:0
v_mfma_f32_16x16x32_bf16 v[164:167], a[160:163], a[228:231], v[164:167]
v_mfma_f32_16x16x32_bf16 v[168:171], a[160:163], a[232:235], v[168:171]
ds_read_b64_tr_b16 a[194:195], v5 offset:1024
v_mfma_f32_16x16x32_bf16 v[172:175], a[160:163], a[236:239], v[172:175]
s_add_u32 s37, s31, 0
v_mfma_f32_16x16x32_bf16 v[176:179], a[160:163], a[240:243], v[176:179]
s_add_u32 m0, s33, 0
ds_read_b64_tr_b16 a[196:197], v6 offset:0
v_mfma_f32_16x16x32_bf16 v[180:183], a[160:163], a[244:247], v[180:183]
buffer_load_dwordx4 v2, s[20:23], s37 offen  lds
v_mfma_f32_16x16x32_bf16 v[184:187], a[160:163], a[248:251], v[184:187]
ds_read_b64_tr_b16 a[198:199], v6 offset:1024
v_mfma_f32_16x16x32_bf16 v[188:191], a[160:163], a[252:255], v[188:191]
ds_read_b128 a[160:163], v3 offset:0
v_mfma_f32_16x16x32_bf16 v[192:195], a[164:167], a[224:227], v[192:195]
ds_read_b64_tr_b16 a[200:201], v7 offset:0
v_mfma_f32_16x16x32_bf16 v[196:199], a[164:167], a[228:231], v[196:199]
v_mfma_f32_16x16x32_bf16 v[200:203], a[164:167], a[232:235], v[200:203]
s_add_u32 s37, s31, 32768
ds_read_b64_tr_b16 a[202:203], v7 offset:1024
v_mfma_f32_16x16x32_bf16 v[204:207], a[164:167], a[236:239], v[204:207]
s_add_u32 m0, s33, 1024
v_mfma_f32_16x16x32_bf16 v[208:211], a[164:167], a[240:243], v[208:211]
buffer_load_dwordx4 v2, s[20:23], s37 offen  lds
v_mfma_f32_16x16x32_bf16 v[212:215], a[164:167], a[244:247], v[212:215]
ds_read_b64_tr_b16 a[204:205], v8 offset:0
v_mfma_f32_16x16x32_bf16 v[216:219], a[164:167], a[248:251], v[216:219]
s_add_u32 s29, s29, s44
v_mfma_f32_16x16x32_bf16 v[220:223], a[164:167], a[252:255], v[220:223]
ds_read_b128 a[164:167], v4 offset:1024
v_mfma_f32_16x16x32_bf16 v[224:227], a[168:171], a[224:227], v[224:227]
buffer_store_dwordx4 v[76:79], v13, s[8:11], s29 offen sc1
v_mfma_f32_16x16x32_bf16 v[228:231], a[168:171], a[228:231], v[228:231]
s_add_u32 s37, s31, 131072
ds_read_b64_tr_b16 a[206:207], v8 offset:1024
v_mfma_f32_16x16x32_bf16 v[232:235], a[168:171], a[232:235], v[232:235]
s_add_u32 m0, s33, 4096
v_mfma_f32_16x16x32_bf16 v[236:239], a[168:171], a[236:239], v[236:239]
buffer_load_dwordx4 v2, s[20:23], s37 offen  lds
v_mfma_f32_16x16x32_bf16 v[240:243], a[168:171], a[240:243], v[240:243]
ds_read_b64_tr_b16 a[208:209], v9 offset:0
v_mfma_f32_16x16x32_bf16 v[244:247], a[168:171], a[244:247], v[244:247]
v_mfma_f32_16x16x32_bf16 v[248:251], a[168:171], a[248:251], v[248:251]
ds_read_b64_tr_b16 a[210:211], v9 offset:1024
v_mfma_f32_16x16x32_bf16 v[252:255], a[168:171], a[252:255], v[252:255]
ds_read_b128 a[168:171], v3 offset:4096
v_mfma_f32_16x16x32_bf16 a[0:3], a[172:175], a[224:227], a[0:3]
s_add_u32 s37, s31, 163840
ds_read_b64_tr_b16 a[212:213], v10 offset:0
v_mfma_f32_16x16x32_bf16 a[4:7], a[172:175], a[228:231], a[4:7]
s_add_u32 m0, s33, 5120
v_mfma_f32_16x16x32_bf16 a[8:11], a[172:175], a[232:235], a[8:11]
buffer_load_dwordx4 v2, s[20:23], s37 offen  lds
v_mfma_f32_16x16x32_bf16 a[12:15], a[172:175], a[236:239], a[12:15]
s_add_u32 s31, s31, 262144
ds_read_b64_tr_b16 a[214:215], v10 offset:1024
v_mfma_f32_16x16x32_bf16 a[16:19], a[172:175], a[240:243], a[16:19]
s_add_u32 s33, s33, 16384
v_mfma_f32_16x16x32_bf16 a[20:23], a[172:175], a[244:247], a[20:23]
s_and_b32 s33, s33, 65535
ds_read_b64_tr_b16 a[216:217], v11 offset:0
v_mfma_f32_16x16x32_bf16 a[24:27], a[172:175], a[248:251], a[24:27]
v_mfma_f32_16x16x32_bf16 a[28:31], a[172:175], a[252:255], a[28:31]
s_mov_b32 s48, s30
ds_read_b128 a[172:175], v4 offset:5120
v_mfma_f32_16x16x32_bf16 a[32:35], a[176:179], a[224:227], a[32:35]
s_add_u32 m0, s32, 0
ds_read_b64_tr_b16 a[218:219], v11 offset:1024
v_mfma_f32_16x16x32_bf16 a[36:39], a[176:179], a[228:231], a[36:39]
buffer_load_dwordx4 v1, s[12:15], s48 offen lds
v_mfma_f32_16x16x32_bf16 a[40:43], a[176:179], a[232:235], a[40:43]
ds_read_b64_tr_b16 a[220:221], v12 offset:0
v_mfma_f32_16x16x32_bf16 a[44:47], a[176:179], a[236:239], a[44:47]
s_add_u32 s29, s29, s93
v_mfma_f32_16x16x32_bf16 a[48:51], a[176:179], a[240:243], a[48:51]
ds_read_b64_tr_b16 a[222:223], v12 offset:1024
v_mfma_f32_16x16x32_bf16 a[52:55], a[176:179], a[244:247], a[52:55]
buffer_store_dwordx4 v[80:83], v13, s[8:11], s29 offen sc1
v_mfma_f32_16x16x32_bf16 a[56:59], a[176:179], a[248:251], a[56:59]
s_add_u32 s48, s48, s34
ds_read_b128 a[188:191], v4 offset:13312
v_mfma_f32_16x16x32_bf16 a[60:63], a[176:179], a[252:255], a[60:63]
s_add_u32 m0, s32, 4096
ds_read_b128 a[176:179], v3 offset:8192
v_mfma_f32_16x16x32_bf16 a[64:67], a[180:183], a[224:227], a[64:67]
buffer_load_dwordx4 v1, s[12:15], s48 offen lds
v_mfma_f32_16x16x32_bf16 a[68:71], a[180:183], a[228:231], a[68:71]
v_add_u32 v5, 16384, v5
v_and_b32 v5, 65535, v5
v_mfma_f32_16x16x32_bf16 a[72:75], a[180:183], a[232:235], a[72:75]
v_xor_b32 v6, 16, v5
v_xor_b32 v7, 64, v5
v_mfma_f32_16x16x32_bf16 a[76:79], a[180:183], a[236:239], a[76:79]
v_xor_b32 v8, 80, v5
v_xor_b32 v9, 128, v5
v_mfma_f32_16x16x32_bf16 a[80:83], a[180:183], a[240:243], a[80:83]
v_xor_b32 v10, 144, v5
v_xor_b32 v11, 192, v5
v_mfma_f32_16x16x32_bf16 a[84:87], a[180:183], a[244:247], a[84:87]
s_add_u32 s48, s48, s34
v_xor_b32 v12, 208, v5
v_mfma_f32_16x16x32_bf16 a[88:91], a[180:183], a[248:251], a[88:91]
s_add_u32 m0, s32, 8192
v_mfma_f32_16x16x32_bf16 a[92:95], a[180:183], a[252:255], a[92:95]
buffer_load_dwordx4 v1, s[12:15], s48 offen lds
ds_read_b128 a[180:183], v4 offset:9216
v_mfma_f32_16x16x32_bf16 a[96:99], a[184:187], a[224:227], a[96:99]
v_mfma_f32_16x16x32_bf16 a[100:103], a[184:187], a[228:231], a[100:103]
v_mfma_f32_16x16x32_bf16 a[104:107], a[184:187], a[232:235], a[104:107]
v_mfma_f32_16x16x32_bf16 a[108:111], a[184:187], a[236:239], a[108:111]
v_mfma_f32_16x16x32_bf16 a[112:115], a[184:187], a[240:243], a[112:115]
s_add_u32 s48, s48, s34
v_mfma_f32_16x16x32_bf16 a[116:119], a[184:187], a[244:247], a[116:119]
s_add_u32 m0, s32, 12288
v_mfma_f32_16x16x32_bf16 a[120:123], a[184:187], a[248:251], a[120:123]
buffer_load_dwordx4 v1, s[12:15], s48 offen lds
v_mfma_f32_16x16x32_bf16 a[124:127], a[184:187], a[252:255], a[124:127]
ds_read_b128 a[184:187], v3 offset:12288
v_mfma_f32_16x16x32_bf16 a[128:131], v[28:31], a[224:227], a[128:131]
s_add_u32 s29, s29, s44
v_mfma_f32_16x16x32_bf16 a[132:135], v[28:31], a[228:231], a[132:135]
v_mfma_f32_16x16x32_bf16 a[136:139], v[28:31], a[232:235], a[136:139]
buffer_store_dwordx4 v[84:87], v13, s[8:11], s29 offen sc1
buffer_load_dword v15, v14, s[96:99], s100 offen
v_mfma_f32_16x16x32_bf16 a[140:143], v[28:31], a[236:239], a[140:143]
s_add_u32 s100, s100, 16384
v_mfma_f32_16x16x32_bf16 a[144:147], v[28:31], a[240:243], a[144:147]
v_mfma_f32_16x16x32_bf16 a[148:151], v[28:31], a[244:247], a[148:151]
v_mfma_f32_16x16x32_bf16 a[152:155], v[28:31], a[248:251], a[152:155]
v_mfma_f32_16x16x32_bf16 a[156:159], v[28:31], a[252:255], a[156:159]
s_waitcnt vmcnt(24) lgkmcnt(0)
s_barrier
v_mfma_f32_16x16x32_bf16 v[160:163], a[160:163], a[192:195], v[160:163]
ds_read_b64_tr_b16 a[224:225], v5 offset:0
v_mfma_f32_16x16x32_bf16 v[164:167], a[160:163], a[196:199], v[164:167]
v_mfma_f32_16x16x32_bf16 v[168:171], a[160:163], a[200:203], v[168:171]
ds_read_b64_tr_b16 a[226:227], v5 offset:1024
v_mfma_f32_16x16x32_bf16 v[172:175], a[160:163], a[204:207], v[172:175]
s_add_u32 s37, s31, 0
v_mfma_f32_16x16x32_bf16 v[176:179], a[160:163], a[208:211], v[176:179]
s_add_u32 m0, s33, 0
ds_read_b64_tr_b16 a[228:229], v6 offset:0
v_mfma_f32_16x16x32_bf16 v[180:183], a[160:163], a[212:215], v[180:183]
buffer_load_dwordx4 v2, s[20:23], s37 offen  lds
v_mfma_f32_16x16x32_bf16 v[184:187], a[160:163], a[216:219], v[184:187]
ds_read_b64_tr_b16 a[230:231], v6 offset:1024
v_mfma_f32_16x16x32_bf16 v[188:191], a[160:163], a[220:223], v[188:191]
ds_read_b128 a[160:163], v4 offset:0
v_mfma_f32_16x16x32_bf16 v[192:195], a[164:167], a[192:195], v[192:195]
ds_read_b64_tr_b16 a[232:233], v7 offset:0
v_mfma_f32_16x16x32_bf16 v[196:199], a[164:167], a[196:199], v[196:199]
v_mfma_f32_16x16x32_bf16 v[200:203], a[164:167], a[200:203], v[200:203]
s_add_u32 s37, s31, 32768
ds_read_b64_tr_b16 a[234:235], v7 offset:1024
v_mfma_f32_16x16x32_bf16 v[204:207], a[164:167], a[204:207], v[204:207]
s_add_u32 m0, s33, 1024
v_mfma_f32_16x16x32_bf16 v[208:211], a[164:167], a[208:211], v[208:211]
buffer_load_dwordx4 v2, s[20:23], s37 offen  lds
v_mfma_f32_16x16x32_bf16 v[212:215], a[164:167], a[212:215], v[212:215]
ds_read_b64_tr_b16 a[236:237], v8 offset:0
v_mfma_f32_16x16x32_bf16 v[216:219], a[164:167], a[216:219], v[216:219]
s_add_u32 s29, s29, s93
v_mfma_f32_16x16x32_bf16 v[220:223], a[164:167], a[220:223], v[220:223]
ds_read_b128 a[164:167], v3 offset:1024
v_mfma_f32_16x16x32_bf16 v[224:227], a[168:171], a[192:195], v[224:227]
buffer_store_dwordx4 v[88:91], v13, s[8:11], s29 offen sc1
v_mfma_f32_16x16x32_bf16 v[228:231], a[168:171], a[196:199], v[228:231]
s_add_u32 s37, s31, 131072
ds_read_b64_tr_b16 a[238:239], v8 offset:1024
v_mfma_f32_16x16x32_bf16 v[232:235], a[168:171], a[200:203], v[232:235]
s_add_u32 m0, s33, 4096
v_mfma_f32_16x16x32_bf16 v[236:239], a[168:171], a[204:207], v[236:239]
buffer_load_dwordx4 v2, s[20:23], s37 offen  lds
v_mfma_f32_16x16x32_bf16 v[240:243], a[168:171], a[208:211], v[240:243]
ds_read_b64_tr_b16 a[240:241], v9 offset:0
v_mfma_f32_16x16x32_bf16 v[244:247], a[168:171], a[212:215], v[244:247]
v_mfma_f32_16x16x32_bf16 v[248:251], a[168:171], a[216:219], v[248:251]
ds_read_b64_tr_b16 a[242:243], v9 offset:1024
v_mfma_f32_16x16x32_bf16 v[252:255], a[168:171], a[220:223], v[252:255]
ds_read_b128 a[168:171], v4 offset:4096
v_mfma_f32_16x16x32_bf16 a[0:3], a[172:175], a[192:195], a[0:3]
s_add_u32 s37, s31, 163840
ds_read_b64_tr_b16 a[244:245], v10 offset:0
v_mfma_f32_16x16x32_bf16 a[4:7], a[172:175], a[196:199], a[4:7]
s_add_u32 m0, s33, 5120
v_mfma_f32_16x16x32_bf16 a[8:11], a[172:175], a[200:203], a[8:11]
buffer_load_dwordx4 v2, s[20:23], s37 offen  lds
v_mfma_f32_16x16x32_bf16 a[12:15], a[172:175], a[204:207], a[12:15]
s_add_u32 s31, s31, 262144
ds_read_b64_tr_b16 a[246:247], v10 offset:1024
v_mfma_f32_16x16x32_bf16 a[16:19], a[172:175], a[208:211], a[16:19]
s_add_u32 s33, s33, 16384
v_mfma_f32_16x16x32_bf16 a[20:23], a[172:175], a[212:215], a[20:23]
s_and_b32 s33, s33, 65535
ds_read_b64_tr_b16 a[248:249], v11 offset:0
v_mfma_f32_16x16x32_bf16 a[24:27], a[172:175], a[216:219], a[24:27]
v_mfma_f32_16x16x32_bf16 a[28:31], a[172:175], a[220:223], a[28:31]
s_add_u32 s48, s48, s34
ds_read_b128 a[172:175], v3 offset:5120
v_mfma_f32_16x16x32_bf16 a[32:35], a[176:179], a[192:195], a[32:35]
s_add_u32 m0, s32, 16384
ds_read_b64_tr_b16 a[250:251], v11 offset:1024
v_mfma_f32_16x16x32_bf16 a[36:39], a[176:179], a[196:199], a[36:39]
buffer_load_dwordx4 v1, s[12:15], s48 offen lds
v_mfma_f32_16x16x32_bf16 a[40:43], a[176:179], a[200:203], a[40:43]
ds_read_b64_tr_b16 a[252:253], v12 offset:0
v_mfma_f32_16x16x32_bf16 a[44:47], a[176:179], a[204:207], a[44:47]
s_add_u32 s29, s29, s44
v_mfma_f32_16x16x32_bf16 a[48:51], a[176:179], a[208:211], a[48:51]
ds_read_b64_tr_b16 a[254:255], v12 offset:1024
v_mfma_f32_16x16x32_bf16 a[52:55], a[176:179], a[212:215], a[52:55]
buffer_store_dwordx4 v[92:95], v13, s[8:11], s29 offen sc1
v_mfma_f32_16x16x32_bf16 a[56:59], a[176:179], a[216:219], a[56:59]
s_add_u32 s48, s48, s34
ds_read_b128 v[28:31], v3 offset:13312
v_mfma_f32_16x16x32_bf16 a[60:63], a[176:179], a[220:223], a[60:63]
s_add_u32 m0, s32, 20480
ds_read_b128 a[176:179], v4 offset:8192
v_mfma_f32_16x16x32_bf16 a[64:67], a[180:183], a[192:195], a[64:67]
buffer_load_dwordx4 v1, s[12:15], s48 offen lds
v_mfma_f32_16x16x32_bf16 a[68:71], a[180:183], a[196:199], a[68:71]
v_add_u32 v5, 16384, v5
v_and_b32 v5, 65535, v5
v_mfma_f32_16x16x32_bf16 a[72:75], a[180:183], a[200:203], a[72:75]
v_xor_b32 v6, 16, v5
v_xor_b32 v7, 64, v5
v_mfma_f32_16x16x32_bf16 a[76:79], a[180:183], a[204:207], a[76:79]
v_xor_b32 v8, 80, v5
v_xor_b32 v9, 128, v5
v_mfma_f32_16x16x32_bf16 a[80:83], a[180:183], a[208:211], a[80:83]
v_xor_b32 v10, 144, v5
v_xor_b32 v11, 192, v5
v_mfma_f32_16x16x32_bf16 a[84:87], a[180:183], a[212:215], a[84:87]
s_add_u32 s48, s48, s34
v_xor_b32 v12, 208, v5
v_mfma_f32_16x16x32_bf16 a[88:91], a[180:183], a[216:219], a[88:91]
s_add_u32 m0, s32, 24576
v_mfma_f32_16x16x32_bf16 a[92:95], a[180:183], a[220:223], a[92:95]
buffer_load_dwordx4 v1, s[12:15], s48 offen lds
ds_read_b128 a[180:183], v3 offset:9216
v_mfma_f32_16x16x32_bf16 a[96:99], a[184:187], a[192:195], a[96:99]
v_mfma_f32_16x16x32_bf16 a[100:103], a[184:187], a[196:199], a[100:103]
v_mfma_f32_16x16x32_bf16 a[104:107], a[184:187], a[200:203], a[104:107]
v_mfma_f32_16x16x32_bf16 a[108:111], a[184:187], a[204:207], a[108:111]
v_mfma_f32_16x16x32_bf16 a[112:115], a[184:187], a[208:211], a[112:115]
s_add_u32 s48, s48, s34
v_mfma_f32_16x16x32_bf16 a[116:119], a[184:187], a[212:215], a[116:119]
s_add_u32 m0, s32, 28672
v_mfma_f32_16x16x32_bf16 a[120:123], a[184:187], a[216:219], a[120:123]
buffer_load_dwordx4 v1, s[12:15], s48 offen lds
v_mfma_f32_16x16x32_bf16 a[124:127], a[184:187], a[220:223], a[124:127]
s_add_u32 s30, s30, 128
ds_read_b128 a[184:187], v4 offset:12288
v_mfma_f32_16x16x32_bf16 a[128:131], a[188:191], a[192:195], a[128:131]
s_add_u32 s32, s32, 32768
v_add_u32 v3, 32768, v3
v_mfma_f32_16x16x32_bf16 a[132:135], a[188:191], a[196:199], a[132:135]
s_sub_u32 s48, s32, 98304
v_subrev_u32 v19, 98304, v3
v_mfma_f32_16x16x32_bf16 a[136:139], a[188:191], a[200:203], a[136:139]
s_cmp_ge_u32 s32, 163840
s_cselect_b32 s32, s48, s32
buffer_load_dword v15, v14, s[96:99], s100 offen
v_mfma_f32_16x16x32_bf16 a[140:143], a[188:191], a[204:207], a[140:143]
s_add_u32 s100, s100, 16384
v_cmp_le_u32 vcc, 163840, v3
v_mfma_f32_16x16x32_bf16 a[144:147], a[188:191], a[208:211], a[144:147]
s_nop 0
v_cndmask_b32 v3, v3, v19, vcc
v_mfma_f32_16x16x32_bf16 a[148:151], a[188:191], a[212:215], a[148:151]
v_xor_b32 v4, 64, v3
v_mfma_f32_16x16x32_bf16 a[152:155], a[188:191], a[216:219], a[152:155]
v_mfma_f32_16x16x32_bf16 a[156:159], a[188:191], a[220:223], a[156:159]
s_waitcnt vmcnt(23) lgkmcnt(0)
s_barrier
v_mfma_f32_16x16x32_bf16 v[160:163], a[160:163], a[224:227], v[160:163]
ds_read_b64_tr_b16 a[192:193], v5 offset:0
v_mfma_f32_16x16x32_bf16 v[164:167], a[160:163], a[228:231], v[164:167]
v_mfma_f32_16x16x32_bf16 v[168:171], a[160:163], a[232:235], v[168:171]
ds_read_b64_tr_b16 a[194:195], v5 offset:1024
v_mfma_f32_16x16x32_bf16 v[172:175], a[160:163], a[236:239], v[172:175]
s_add_u32 s37, s31, 0
v_mfma_f32_16x16x32_bf16 v[176:179], a[160:163], a[240:243], v[176:179]
s_add_u32 m0, s33, 0
ds_read_b64_tr_b16 a[196:197], v6 offset:0
v_mfma_f32_16x16x32_bf16 v[180:183], a[160:163], a[244:247], v[180:183]
buffer_load_dwordx4 v2, s[20:23], s37 offen  lds
v_mfma_f32_16x16x32_bf16 v[184:187], a[160:163], a[248:251], v[184:187]
ds_read_b64_tr_b16 a[198:199], v6 offset:1024
v_mfma_f32_16x16x32_bf16 v[188:191], a[160:163], a[252:255], v[188:191]
ds_read_b128 a[160:163], v3 offset:0
v_mfma_f32_16x16x32_bf16 v[192:195], a[164:167], a[224:227], v[192:195]
ds_read_b64_tr_b16 a[200:201], v7 offset:0
v_mfma_f32_16x16x32_bf16 v[196:199], a[164:167], a[228:231], v[196:199]
v_mfma_f32_16x16x32_bf16 v[200:203], a[164:167], a[232:235], v[200:203]
s_add_u32 s37, s31, 32768
ds_read_b64_tr_b16 a[202:203], v7 offset:1024
v_mfma_f32_16x16x32_bf16 v[204:207], a[164:167], a[236:239], v[204:207]
s_add_u32 m0, s33, 1024
v_mfma_f32_16x16x32_bf16 v[208:211], a[164:167], a[240:243], v[208:211]
buffer_load_dwordx4 v2, s[20:23], s37 offen  lds
v_mfma_f32_16x16x32_bf16 v[212:215], a[164:167], a[244:247], v[212:215]
ds_read_b64_tr_b16 a[204:205], v8 offset:0
v_mfma_f32_16x16x32_bf16 v[216:219], a[164:167], a[248:251], v[216:219]
s_add_u32 s60, s60, s92
v_mfma_f32_16x16x32_bf16 v[220:223], a[164:167], a[252:255], v[220:223]
s_mov_b32 s29, s60
ds_read_b128 a[164:167], v4 offset:1024
v_mfma_f32_16x16x32_bf16 v[224:227], a[168:171], a[224:227], v[224:227]
buffer_store_dwordx4 v[96:99], v13, s[8:11], s29 offen sc1
v_mfma_f32_16x16x32_bf16 v[228:231], a[168:171], a[228:231], v[228:231]
s_add_u32 s37, s31, 131072
ds_read_b64_tr_b16 a[206:207], v8 offset:1024
v_mfma_f32_16x16x32_bf16 v[232:235], a[168:171], a[232:235], v[232:235]
s_add_u32 m0, s33, 4096
v_mfma_f32_16x16x32_bf16 v[236:239], a[168:171], a[236:239], v[236:239]
buffer_load_dwordx4 v2, s[20:23], s37 offen  lds
v_mfma_f32_16x16x32_bf16 v[240:243], a[168:171], a[240:243], v[240:243]
ds_read_b64_tr_b16 a[208:209], v9 offset:0
v_mfma_f32_16x16x32_bf16 v[244:247], a[168:171], a[244:247], v[244:247]
v_mfma_f32_16x16x32_bf16 v[248:251], a[168:171], a[248:251], v[248:251]
ds_read_b64_tr_b16 a[210:211], v9 offset:1024
v_mfma_f32_16x16x32_bf16 v[252:255], a[168:171], a[252:255], v[252:255]
ds_read_b128 a[168:171], v3 offset:4096
v_mfma_f32_16x16x32_bf16 a[0:3], a[172:175], a[224:227], a[0:3]
s_add_u32 s37, s31, 163840
ds_read_b64_tr_b16 a[212:213], v10 offset:0
v_mfma_f32_16x16x32_bf16 a[4:7], a[172:175], a[228:231], a[4:7]
s_add_u32 m0, s33, 5120
v_mfma_f32_16x16x32_bf16 a[8:11], a[172:175], a[232:235], a[8:11]
buffer_load_dwordx4 v2, s[20:23], s37 offen  lds
v_mfma_f32_16x16x32_bf16 a[12:15], a[172:175], a[236:239], a[12:15]
s_add_u32 s31, s31, 262144
ds_read_b64_tr_b16 a[214:215], v10 offset:1024
v_mfma_f32_16x16x32_bf16 a[16:19], a[172:175], a[240:243], a[16:19]
s_add_u32 s33, s33, 16384
v_mfma_f32_16x16x32_bf16 a[20:23], a[172:175], a[244:247], a[20:23]
s_and_b32 s33, s33, 65535
ds_read_b64_tr_b16 a[216:217], v11 offset:0
v_mfma_f32_16x16x32_bf16 a[24:27], a[172:175], a[248:251], a[24:27]
v_mfma_f32_16x16x32_bf16 a[28:31], a[172:175], a[252:255], a[28:31]
s_mov_b32 s48, s30
ds_read_b128 a[172:175], v4 offset:5120
v_mfma_f32_16x16x32_bf16 a[32:35], a[176:179], a[224:227], a[32:35]
s_add_u32 m0, s32, 0
ds_read_b64_tr_b16 a[218:219], v11 offset:1024
v_mfma_f32_16x16x32_bf16 a[36:39], a[176:179], a[228:231], a[36:39]
buffer_load_dwordx4 v1, s[12:15], s48 offen lds
v_mfma_f32_16x16x32_bf16 a[40:43], a[176:179], a[232:235], a[40:43]
ds_read_b64_tr_b16 a[220:221], v12 offset:0
v_mfma_f32_16x16x32_bf16 a[44:47], a[176:179], a[236:239], a[44:47]
s_add_u32 s29, s29, s44
v_mfma_f32_16x16x32_bf16 a[48:51], a[176:179], a[240:243], a[48:51]
ds_read_b64_tr_b16 a[222:223], v12 offset:1024
v_mfma_f32_16x16x32_bf16 a[52:55], a[176:179], a[244:247], a[52:55]
buffer_store_dwordx4 v[100:103], v13, s[8:11], s29 offen sc1
v_mfma_f32_16x16x32_bf16 a[56:59], a[176:179], a[248:251], a[56:59]
s_add_u32 s48, s48, s34
ds_read_b128 a[188:191], v4 offset:13312
v_mfma_f32_16x16x32_bf16 a[60:63], a[176:179], a[252:255], a[60:63]
s_add_u32 m0, s32, 4096
ds_read_b128 a[176:179], v3 offset:8192
v_mfma_f32_16x16x32_bf16 a[64:67], a[180:183], a[224:227], a[64:67]
buffer_load_dwordx4 v1, s[12:15], s48 offen lds
v_mfma_f32_16x16x32_bf16 a[68:71], a[180:183], a[228:231], a[68:71]
v_add_u32 v5, 16384, v5
v_and_b32 v5, 65535, v5
v_mfma_f32_16x16x32_bf16 a[72:75], a[180:183], a[232:235], a[72:75]
v_xor_b32 v6, 16, v5
v_xor_b32 v7, 64, v5
v_mfma_f32_16x16x32_bf16 a[76:79], a[180:183], a[236:239], a[76:79]
v_xor_b32 v8, 80, v5
v_xor_b32 v9, 128, v5
v_mfma_f32_16x16x32_bf16 a[80:83], a[180:183], a[240:243], a[80:83]
v_xor_b32 v10, 144, v5
v_xor_b32 v11, 192, v5
v_mfma_f32_16x16x32_bf16 a[84:87], a[180:183], a[244:247], a[84:87]
s_add_u32 s48, s48, s34
v_xor_b32 v12, 208, v5
v_mfma_f32_16x16x32_bf16 a[88:91], a[180:183], a[248:251], a[88:91]
s_add_u32 m0, s32, 8192
v_mfma_f32_16x16x32_bf16 a[92:95], a[180:183], a[252:255], a[92:95]
buffer_load_dwordx4 v1, s[12:15], s48 offen lds
ds_read_b128 a[180:183], v4 offset:9216
v_mfma_f32_16x16x32_bf16 a[96:99], a[184:187], a[224:227], a[96:99]
v_mfma_f32_16x16x32_bf16 a[100:103], a[184:187], a[228:231], a[100:103]
v_mfma_f32_16x16x32_bf16 a[104:107], a[184:187], a[232:235], a[104:107]
v_mfma_f32_16x16x32_bf16 a[108:111], a[184:187], a[236:239], a[108:111]
v_mfma_f32_16x16x32_bf16 a[112:115], a[184:187], a[240:243], a[112:115]
s_add_u32 s48, s48, s34
v_mfma_f32_16x16x32_bf16 a[116:119], a[184:187], a[244:247], a[116:119]
s_add_u32 m0, s32, 12288
v_mfma_f32_16x16x32_bf16 a[120:123], a[184:187], a[248:251], a[120:123]
buffer_load_dwordx4 v1, s[12:15], s48 offen lds
v_mfma_f32_16x16x32_bf16 a[124:127], a[184:187], a[252:255], a[124:127]
ds_read_b128 a[184:187], v3 offset:12288
v_mfma_f32_16x16x32_bf16 a[128:131], v[28:31], a[224:227], a[128:131]
s_add_u32 s29, s29, s93
v_mfma_f32_16x16x32_bf16 a[132:135], v[28:31], a[228:231], a[132:135]
v_mfma_f32_16x16x32_bf16 a[136:139], v[28:31], a[232:235], a[136:139]
buffer_store_dwordx4 v[104:107], v13, s[8:11], s29 offen sc1
buffer_load_dword v15, v14, s[96:99], s100 offen
v_mfma_f32_16x16x32_bf16 a[140:143], v[28:31], a[236:239], a[140:143]
s_add_u32 s100, s100, 16384
v_mfma_f32_16x16x32_bf16 a[144:147], v[28:31], a[240:243], a[144:147]
v_mfma_f32_16x16x32_bf16 a[148:151], v[28:31], a[244:247], a[148:151]
v_mfma_f32_16x16x32_bf16 a[152:155], v[28:31], a[248:251], a[152:155]
v_mfma_f32_16x16x32_bf16 a[156:159], v[28:31], a[252:255], a[156:159]
s_waitcnt vmcnt(23) lgkmcnt(0)
s_barrier
v_mfma_f32_16x16x32_bf16 v[160:163], a[160:163], a[192:195], v[160:163]
ds_read_b64_tr_b16 a[224:225], v5 offset:0
v_mfma_f32_16x16x32_bf16 v[164:167], a[160:163], a[196:199], v[164:167]
v_mfma_f32_16x16x32_bf16 v[168:171], a[160:163], a[200:203], v[168:171]
ds_read_b64_tr_b16 a[226:227], v5 offset:1024
v_mfma_f32_16x16x32_bf16 v[172:175], a[160:163], a[204:207], v[172:175]
s_add_u32 s37, s31, 0
v_mfma_f32_16x16x32_bf16 v[176:179], a[160:163], a[208:211], v[176:179]
s_add_u32 m0, s33, 0
ds_read_b64_tr_b16 a[228:229], v6 offset:0
v_mfma_f32_16x16x32_bf16 v[180:183], a[160:163], a[212:215], v[180:183]
buffer_load_dwordx4 v2, s[20:23], s37 offen  lds
v_mfma_f32_16x16x32_bf16 v[184:187], a[160:163], a[216:219], v[184:187]
ds_read_b64_tr_b16 a[230:231], v6 offset:1024
v_mfma_f32_16x16x32_bf16 v[188:191], a[160:163], a[220:223], v[188:191]
ds_read_b128 a[160:163], v4 offset:0
v_mfma_f32_16x16x32_bf16 v[192:195], a[164:167], a[192:195], v[192:195]
ds_read_b64_tr_b16 a[232:233], v7 offset:0
v_mfma_f32_16x16x32_bf16 v[196:199], a[164:167], a[196:199], v[196:199]
v_mfma_f32_16x16x32_bf16 v[200:203], a[164:167], a[200:203], v[200:203]
s_add_u32 s37, s31, 32768
ds_read_b64_tr_b16 a[234:235], v7 offset:1024
v_mfma_f32_16x16x32_bf16 v[204:207], a[164:167], a[204:207], v[204:207]
s_add_u32 m0, s33, 1024
v_mfma_f32_16x16x32_bf16 v[208:211], a[164:167], a[208:211], v[208:211]
buffer_load_dwordx4 v2, s[20:23], s37 offen  lds
v_mfma_f32_16x16x32_bf16 v[212:215], a[164:167], a[212:215], v[212:215]
ds_read_b64_tr_b16 a[236:237], v8 offset:0
v_mfma_f32_16x16x32_bf16 v[216:219], a[164:167], a[216:219], v[216:219]
s_add_u32 s29, s29, s44
v_mfma_f32_16x16x32_bf16 v[220:223], a[164:167], a[220:223], v[220:223]
ds_read_b128 a[164:167], v3 offset:1024
v_mfma_f32_16x16x32_bf16 v[224:227], a[168:171], a[192:195], v[224:227]
buffer_store_dwordx4 v[108:111], v13, s[8:11], s29 offen sc1
v_mfma_f32_16x16x32_bf16 v[228:231], a[168:171], a[196:199], v[228:231]
s_add_u32 s37, s31, 131072
ds_read_b64_tr_b16 a[238:239], v8 offset:1024
v_mfma_f32_16x16x32_bf16 v[232:235], a[168:171], a[200:203], v[232:235]
s_add_u32 m0, s33, 4096
v_mfma_f32_16x16x32_bf16 v[236:239], a[168:171], a[204:207], v[236:239]
buffer_load_dwordx4 v2, s[20:23], s37 offen  lds
v_mfma_f32_16x16x32_bf16 v[240:243], a[168:171], a[208:211], v[240:243]
ds_read_b64_tr_b16 a[240:241], v9 offset:0
v_mfma_f32_16x16x32_bf16 v[244:247], a[168:171], a[212:215], v[244:247]
v_mfma_f32_16x16x32_bf16 v[248:251], a[168:171], a[216:219], v[248:251]
ds_read_b64_tr_b16 a[242:243], v9 offset:1024
v_mfma_f32_16x16x32_bf16 v[252:255], a[168:171], a[220:223], v[252:255]
ds_read_b128 a[168:171], v4 offset:4096
v_mfma_f32_16x16x32_bf16 a[0:3], a[172:175], a[192:195], a[0:3]
s_add_u32 s37, s31, 163840
ds_read_b64_tr_b16 a[244:245], v10 offset:0
v_mfma_f32_16x16x32_bf16 a[4:7], a[172:175], a[196:199], a[4:7]
s_add_u32 m0, s33, 5120
v_mfma_f32_16x16x32_bf16 a[8:11], a[172:175], a[200:203], a[8:11]
buffer_load_dwordx4 v2, s[20:23], s37 offen  lds
v_mfma_f32_16x16x32_bf16 a[12:15], a[172:175], a[204:207], a[12:15]
s_add_u32 s31, s31, 262144
ds_read_b64_tr_b16 a[246:247], v10 offset:1024
v_mfma_f32_16x16x32_bf16 a[16:19], a[172:175], a[208:211], a[16:19]
s_add_u32 s33, s33, 16384
v_mfma_f32_16x16x32_bf16 a[20:23], a[172:175], a[212:215], a[20:23]
s_and_b32 s33, s33, 65535
ds_read_b64_tr_b16 a[248:249], v11 offset:0
v_mfma_f32_16x16x32_bf16 a[24:27], a[172:175], a[216:219], a[24:27]
v_mfma_f32_16x16x32_bf16 a[28:31], a[172:175], a[220:223], a[28:31]
s_add_u32 s48, s48, s34
ds_read_b128 a[172:175], v3 offset:5120
v_mfma_f32_16x16x32_bf16 a[32:35], a[176:179], a[192:195], a[32:35]
s_add_u32 m0, s32, 16384
ds_read_b64_tr_b16 a[250:251], v11 offset:1024
v_mfma_f32_16x16x32_bf16 a[36:39], a[176:179], a[196:199], a[36:39]
buffer_load_dwordx4 v1, s[12:15], s48 offen lds
v_mfma_f32_16x16x32_bf16 a[40:43], a[176:179], a[200:203], a[40:43]
ds_read_b64_tr_b16 a[252:253], v12 offset:0
v_mfma_f32_16x16x32_bf16 a[44:47], a[176:179], a[204:207], a[44:47]
s_add_u32 s29, s29, s93
v_mfma_f32_16x16x32_bf16 a[48:51], a[176:179], a[208:211], a[48:51]
ds_read_b64_tr_b16 a[254:255], v12 offset:1024
v_mfma_f32_16x16x32_bf16 a[52:55], a[176:179], a[212:215], a[52:55]
buffer_store_dwordx4 v[112:115], v13, s[8:11], s29 offen sc1
v_mfma_f32_16x16x32_bf16 a[56:59], a[176:179], a[216:219], a[56:59]
s_add_u32 s48, s48, s34
ds_read_b128 v[28:31], v3 offset:13312
v_mfma_f32_16x16x32_bf16 a[60:63], a[176:179], a[220:223], a[60:63]
s_add_u32 m0, s32, 20480
ds_read_b128 a[176:179], v4 offset:8192
v_mfma_f32_16x16x32_bf16 a[64:67], a[180:183], a[192:195], a[64:67]
buffer_load_dwordx4 v1, s[12:15], s48 offen lds
v_mfma_f32_16x16x32_bf16 a[68:71], a[180:183], a[196:199], a[68:71]
v_add_u32 v5, 16384, v5
v_and_b32 v5, 65535, v5
v_mfma_f32_16x16x32_bf16 a[72:75], a[180:183], a[200:203], a[72:75]
v_xor_b32 v6, 16, v5
v_xor_b32 v7, 64, v5
v_mfma_f32_16x16x32_bf16 a[76:79], a[180:183], a[204:207], a[76:79]
v_xor_b32 v8, 80, v5
v_xor_b32 v9, 128, v5
v_mfma_f32_16x16x32_bf16 a[80:83], a[180:183], a[208:211], a[80:83]
v_xor_b32 v10, 144, v5
v_xor_b32 v11, 192, v5
v_mfma_f32_16x16x32_bf16 a[84:87], a[180:183], a[212:215], a[84:87]
s_add_u32 s48, s48, s34
v_xor_b32 v12, 208, v5
v_mfma_f32_16x16x32_bf16 a[88:91], a[180:183], a[216:219], a[88:91]
s_add_u32 m0, s32, 24576
v_mfma_f32_16x16x32_bf16 a[92:95], a[180:183], a[220:223], a[92:95]
buffer_load_dwordx4 v1, s[12:15], s48 offen lds
ds_read_b128 a[180:183], v3 offset:9216
v_mfma_f32_16x16x32_bf16 a[96:99], a[184:187], a[192:195], a[96:99]
v_mfma_f32_16x16x32_bf16 a[100:103], a[184:187], a[196:199], a[100:103]
v_mfma_f32_16x16x32_bf16 a[104:107], a[184:187], a[200:203], a[104:107]
v_mfma_f32_16x16x32_bf16 a[108:111], a[184:187], a[204:207], a[108:111]
v_mfma_f32_16x16x32_bf16 a[112:115], a[184:187], a[208:211], a[112:115]
s_add_u32 s48, s48, s34
v_mfma_f32_16x16x32_bf16 a[116:119], a[184:187], a[212:215], a[116:119]
s_add_u32 m0, s32, 28672
v_mfma_f32_16x16x32_bf16 a[120:123], a[184:187], a[216:219], a[120:123]
buffer_load_dwordx4 v1, s[12:15], s48 offen lds
v_mfma_f32_16x16x32_bf16 a[124:127], a[184:187], a[220:223], a[124:127]
s_add_u32 s30, s30, 128
ds_read_b128 a[184:187], v4 offset:12288
v_mfma_f32_16x16x32_bf16 a[128:131], a[188:191], a[192:195], a[128:131]
s_add_u32 s32, s32, 32768
s_add_u32 s29, s29, s44
v_add_u32 v3, 32768, v3
v_mfma_f32_16x16x32_bf16 a[132:135], a[188:191], a[196:199], a[132:135]
s_sub_u32 s48, s32, 98304
v_subrev_u32 v19, 98304, v3
v_mfma_f32_16x16x32_bf16 a[136:139], a[188:191], a[200:203], a[136:139]
s_cmp_ge_u32 s32, 163840
s_cselect_b32 s32, s48, s32
buffer_store_dwordx4 v[116:119], v13, s[8:11], s29 offen sc1
buffer_load_dword v15, v14, s[96:99], s100 offen
v_mfma_f32_16x16x32_bf16 a[140:143], a[188:191], a[204:207], a[140:143]
s_add_u32 s100, s100, 16384
v_cmp_le_u32 vcc, 163840, v3
v_mfma_f32_16x16x32_bf16 a[144:147], a[188:191], a[208:211], a[144:147]
s_nop 0
v_cndmask_b32 v3, v3, v19, vcc
v_mfma_f32_16x16x32_bf16 a[148:151], a[188:191], a[212:215], a[148:151]
v_xor_b32 v4, 64, v3
v_mfma_f32_16x16x32_bf16 a[152:155], a[188:191], a[216:219], a[152:155]
v_mfma_f32_16x16x32_bf16 a[156:159], a[188:191], a[220:223], a[156:159]
s_waitcnt vmcnt(24) lgkmcnt(0)
s_barrier
v_mfma_f32_16x16x32_bf16 v[160:163], a[160:163], a[224:227], v[160:163]
ds_read_b64_tr_b16 a[192:193], v5 offset:0
v_mfma_f32_16x16x32_bf16 v[164:167], a[160:163], a[228:231], v[164:167]
v_mfma_f32_16x16x32_bf16 v[168:171], a[160:163], a[232:235], v[168:171]
ds_read_b64_tr_b16 a[194:195], v5 offset:1024
v_mfma_f32_16x16x32_bf16 v[172:175], a[160:163], a[236:239], v[172:175]
s_add_u32 s37, s31, 0
v_mfma_f32_16x16x32_bf16 v[176:179], a[160:163], a[240:243], v[176:179]
s_add_u32 m0, s33, 0
ds_read_b64_tr_b16 a[196:197], v6 offset:0
v_mfma_f32_16x16x32_bf16 v[180:183], a[160:163], a[244:247], v[180:183]
buffer_load_dwordx4 v2, s[20:23], s37 offen  lds
v_mfma_f32_16x16x32_bf16 v[184:187], a[160:163], a[248:251], v[184:187]
ds_read_b64_tr_b16 a[198:199], v6 offset:1024
v_mfma_f32_16x16x32_bf16 v[188:191], a[160:163], a[252:255], v[188:191]
ds_read_b128 a[160:163], v3 offset:0
v_mfma_f32_16x16x32_bf16 v[192:195], a[164:167], a[224:227], v[192:195]
ds_read_b64_tr_b16 a[200:201], v7 offset:0
v_mfma_f32_16x16x32_bf16 v[196:199], a[164:167], a[228:231], v[196:199]
v_mfma_f32_16x16x32_bf16 v[200:203], a[164:167], a[232:235], v[200:203]
s_add_u32 s37, s31, 32768
ds_read_b64_tr_b16 a[202:203], v7 offset:1024
v_mfma_f32_16x16x32_bf16 v[204:207], a[164:167], a[236:239], v[204:207]
s_add_u32 m0, s33, 1024
v_mfma_f32_16x16x32_bf16 v[208:211], a[164:167], a[240:243], v[208:211]
buffer_load_dwordx4 v2, s[20:23], s37 offen  lds
v_mfma_f32_16x16x32_bf16 v[212:215], a[164:167], a[244:247], v[212:215]
ds_read_b64_tr_b16 a[204:205], v8 offset:0
v_mfma_f32_16x16x32_bf16 v[216:219], a[164:167], a[248:251], v[216:219]
s_add_u32 s29, s29, s93
v_mfma_f32_16x16x32_bf16 v[220:223], a[164:167], a[252:255], v[220:223]
ds_read_b128 a[164:167], v4 offset:1024
v_mfma_f32_16x16x32_bf16 v[224:227], a[168:171], a[224:227], v[224:227]
buffer_store_dwordx4 v[120:123], v13, s[8:11], s29 offen sc1
v_mfma_f32_16x16x32_bf16 v[228:231], a[168:171], a[228:231], v[228:231]
s_add_u32 s37, s31, 131072
ds_read_b64_tr_b16 a[206:207], v8 offset:1024
v_mfma_f32_16x16x32_bf16 v[232:235], a[168:171], a[232:235], v[232:235]
s_add_u32 m0, s33, 4096
v_mfma_f32_16x16x32_bf16 v[236:239], a[168:171], a[236:239], v[236:239]
buffer_load_dwordx4 v2, s[20:23], s37 offen  lds
v_mfma_f32_16x16x32_bf16 v[240:243], a[168:171], a[240:243], v[240:243]
ds_read_b64_tr_b16 a[208:209], v9 offset:0
v_mfma_f32_16x16x32_bf16 v[244:247], a[168:171], a[244:247], v[244:247]
v_mfma_f32_16x16x32_bf16 v[248:251], a[168:171], a[248:251], v[248:251]
ds_read_b64_tr_b16 a[210:211], v9 offset:1024
v_mfma_f32_16x16x32_bf16 v[252:255], a[168:171], a[252:255], v[252:255]
ds_read_b128 a[168:171], v3 offset:4096
v_mfma_f32_16x16x32_bf16 a[0:3], a[172:175], a[224:227], a[0:3]
s_add_u32 s37, s31, 163840
ds_read_b64_tr_b16 a[212:213], v10 offset:0
v_mfma_f32_16x16x32_bf16 a[4:7], a[172:175], a[228:231], a[4:7]
s_add_u32 m0, s33, 5120
v_mfma_f32_16x16x32_bf16 a[8:11], a[172:175], a[232:235], a[8:11]
buffer_load_dwordx4 v2, s[20:23], s37 offen  lds
v_mfma_f32_16x16x32_bf16 a[12:15], a[172:175], a[236:239], a[12:15]
s_add_u32 s31, s31, 262144
ds_read_b64_tr_b16 a[214:215], v10 offset:1024
v_mfma_f32_16x16x32_bf16 a[16:19], a[172:175], a[240:243], a[16:19]
s_add_u32 s33, s33, 16384
v_mfma_f32_16x16x32_bf16 a[20:23], a[172:175], a[244:247], a[20:23]
s_and_b32 s33, s33, 65535
ds_read_b64_tr_b16 a[216:217], v11 offset:0
v_mfma_f32_16x16x32_bf16 a[24:27], a[172:175], a[248:251], a[24:27]
v_mfma_f32_16x16x32_bf16 a[28:31], a[172:175], a[252:255], a[28:31]
s_mov_b32 s48, s30
ds_read_b128 a[172:175], v4 offset:5120
v_mfma_f32_16x16x32_bf16 a[32:35], a[176:179], a[224:227], a[32:35]
s_add_u32 m0, s32, 0
ds_read_b64_tr_b16 a[218:219], v11 offset:1024
v_mfma_f32_16x16x32_bf16 a[36:39], a[176:179], a[228:231], a[36:39]
buffer_load_dwordx4 v1, s[12:15], s48 offen lds
v_mfma_f32_16x16x32_bf16 a[40:43], a[176:179], a[232:235], a[40:43]
ds_read_b64_tr_b16 a[220:221], v12 offset:0
v_mfma_f32_16x16x32_bf16 a[44:47], a[176:179], a[236:239], a[44:47]
s_add_u32 s29, s29, s44
v_mfma_f32_16x16x32_bf16 a[48:51], a[176:179], a[240:243], a[48:51]
ds_read_b64_tr_b16 a[222:223], v12 offset:1024
v_mfma_f32_16x16x32_bf16 a[52:55], a[176:179], a[244:247], a[52:55]
buffer_store_dwordx4 v[124:127], v13, s[8:11], s29 offen sc1
v_mfma_f32_16x16x32_bf16 a[56:59], a[176:179], a[248:251], a[56:59]
s_add_u32 s48, s48, s34
ds_read_b128 a[188:191], v4 offset:13312
v_mfma_f32_16x16x32_bf16 a[60:63], a[176:179], a[252:255], a[60:63]
s_add_u32 m0, s32, 4096
ds_read_b128 a[176:179], v3 offset:8192
v_mfma_f32_16x16x32_bf16 a[64:67], a[180:183], a[224:227], a[64:67]
buffer_load_dwordx4 v1, s[12:15], s48 offen lds
v_mfma_f32_16x16x32_bf16 a[68:71], a[180:183], a[228:231], a[68:71]
v_add_u32 v5, 16384, v5
v_and_b32 v5, 65535, v5
v_mfma_f32_16x16x32_bf16 a[72:75], a[180:183], a[232:235], a[72:75]
v_xor_b32 v6, 16, v5
v_xor_b32 v7, 64, v5
v_mfma_f32_16x16x32_bf16 a[76:79], a[180:183], a[236:239], a[76:79]
v_xor_b32 v8, 80, v5
v_xor_b32 v9, 128, v5
v_mfma_f32_16x16x32_bf16 a[80:83], a[180:183], a[240:243], a[80:83]
v_xor_b32 v10, 144, v5
v_xor_b32 v11, 192, v5
v_mfma_f32_16x16x32_bf16 a[84:87], a[180:183], a[244:247], a[84:87]
s_add_u32 s48, s48, s34
v_xor_b32 v12, 208, v5
v_mfma_f32_16x16x32_bf16 a[88:91], a[180:183], a[248:251], a[88:91]
s_add_u32 m0, s32, 8192
v_mfma_f32_16x16x32_bf16 a[92:95], a[180:183], a[252:255], a[92:95]
buffer_load_dwordx4 v1, s[12:15], s48 offen lds
ds_read_b128 a[180:183], v4 offset:9216
v_mfma_f32_16x16x32_bf16 a[96:99], a[184:187], a[224:227], a[96:99]
v_mfma_f32_16x16x32_bf16 a[100:103], a[184:187], a[228:231], a[100:103]
v_mfma_f32_16x16x32_bf16 a[104:107], a[184:187], a[232:235], a[104:107]
v_mfma_f32_16x16x32_bf16 a[108:111], a[184:187], a[236:239], a[108:111]
v_mfma_f32_16x16x32_bf16 a[112:115], a[184:187], a[240:243], a[112:115]
s_add_u32 s48, s48, s34
v_mfma_f32_16x16x32_bf16 a[116:119], a[184:187], a[244:247], a[116:119]
s_add_u32 m0, s32, 12288
v_mfma_f32_16x16x32_bf16 a[120:123], a[184:187], a[248:251], a[120:123]
buffer_load_dwordx4 v1, s[12:15], s48 offen lds
v_mfma_f32_16x16x32_bf16 a[124:127], a[184:187], a[252:255], a[124:127]
ds_read_b128 a[184:187], v3 offset:12288
v_mfma_f32_16x16x32_bf16 a[128:131], v[28:31], a[224:227], a[128:131]
v_mfma_f32_16x16x32_bf16 a[132:135], v[28:31], a[228:231], a[132:135]
v_mfma_f32_16x16x32_bf16 a[136:139], v[28:31], a[232:235], a[136:139]
buffer_load_dword v15, v14, s[96:99], s100 offen
v_mfma_f32_16x16x32_bf16 a[140:143], v[28:31], a[236:239], a[140:143]
s_add_u32 s100, s100, 16384
v_mfma_f32_16x16x32_bf16 a[144:147], v[28:31], a[240:243], a[144:147]
v_mfma_f32_16x16x32_bf16 a[148:151], v[28:31], a[244:247], a[148:151]
v_mfma_f32_16x16x32_bf16 a[152:155], v[28:31], a[248:251], a[152:155]
v_mfma_f32_16x16x32_bf16 a[156:159], v[28:31], a[252:255], a[156:159]
s_cmp_eq_u32 s36, 0
s_cbranch_scc1 L_g_v12
s_waitcnt vmcnt(23) lgkmcnt(0)
s_barrier
v_mfma_f32_16x16x32_bf16 v[160:163], a[160:163], a[192:195], v[160:163]
ds_read_b64_tr_b16 a[224:225], v5 offset:0
v_mfma_f32_16x16x32_bf16 v[164:167], a[160:163], a[196:199], v[164:167]
v_mfma_f32_16x16x32_bf16 v[168:171], a[160:163], a[200:203], v[168:171]
ds_read_b64_tr_b16 a[226:227], v5 offset:1024
v_mfma_f32_16x16x32_bf16 v[172:175], a[160:163], a[204:207], v[172:175]
s_add_u32 s37, s31, 0
v_mfma_f32_16x16x32_bf16 v[176:179], a[160:163], a[208:211], v[176:179]
s_add_u32 m0, s33, 0
ds_read_b64_tr_b16 a[228:229], v6 offset:0
v_mfma_f32_16x16x32_bf16 v[180:183], a[160:163], a[212:215], v[180:183]
buffer_load_dwordx4 v2, s[20:23], s37 offen  lds
v_mfma_f32_16x16x32_bf16 v[184:187], a[160:163], a[216:219], v[184:187]
ds_read_b64_tr_b16 a[230:231], v6 offset:1024
v_mfma_f32_16x16x32_bf16 v[188:191], a[160:163], a[220:223], v[188:191]
ds_read_b128 a[160:163], v4 offset:0
v_mfma_f32_16x16x32_bf16 v[192:195], a[164:167], a[192:195], v[192:195]
ds_read_b64_tr_b16 a[232:233], v7 offset:0
v_mfma_f32_16x16x32_bf16 v[196:199], a[164:167], a[196:199], v[196:199]
v_mfma_f32_16x16x32_bf16 v[200:203], a[164:167], a[200:203], v[200:203]
s_add_u32 s37, s31, 32768
ds_read_b64_tr_b16 a[234:235], v7 offset:1024
v_mfma_f32_16x16x32_bf16 v[204:207], a[164:167], a[204:207], v[204:207]
s_add_u32 m0, s33, 1024
v_mfma_f32_16x16x32_bf16 v[208:211], a[164:167], a[208:211], v[208:211]
buffer_load_dwordx4 v2, s[20:23], s37 offen  lds
v_mfma_f32_16x16x32_bf16 v[212:215], a[164:167], a[212:215], v[212:215]
ds_read_b64_tr_b16 a[236:237], v8 offset:0
v_mfma_f32_16x16x32_bf16 v[216:219], a[164:167], a[216:219], v[216:219]
v_mfma_f32_16x16x32_bf16 v[220:223], a[164:167], a[220:223], v[220:223]
ds_read_b128 a[164:167], v3 offset:1024
v_mfma_f32_16x16x32_bf16 v[224:227], a[168:171], a[192:195], v[224:227]
ds_read_b64_tr_b16 a[238:239], v8 offset:1024
v_mfma_f32_16x16x32_bf16 v[228:231], a[168:171], a[196:199], v[228:231]
s_add_u32 s37, s31, 131072
v_mfma_f32_16x16x32_bf16 v[232:235], a[168:171], a[200:203], v[232:235]
s_add_u32 m0, s33, 4096
ds_read_b64_tr_b16 a[240:241], v9 offset:0
v_mfma_f32_16x16x32_bf16 v[236:239], a[168:171], a[204:207], v[236:239]
buffer_load_dwordx4 v2, s[20:23], s37 offen  lds
v_mfma_f32_16x16x32_bf16 v[240:243], a[168:171], a[208:211], v[240:243]
ds_read_b64_tr_b16 a[242:243], v9 offset:1024
v_mfma_f32_16x16x32_bf16 v[244:247], a[168:171], a[212:215], v[244:247]
v_mfma_f32_16x16x32_bf16 v[248:251], a[168:171], a[216:219], v[248:251]
ds_read_b64_tr_b16 a[244:245], v10 offset:0
v_mfma_f32_16x16x32_bf16 v[252:255], a[168:171], a[220:223], v[252:255]
ds_read_b128 a[168:171], v4 offset:4096
v_mfma_f32_16x16x32_bf16 a[0:3], a[172:175], a[192:195], a[0:3]
s_add_u32 s37, s31, 163840
ds_read_b64_tr_b16 a[246:247], v10 offset:1024
v_mfma_f32_16x16x32_bf16 a[4:7], a[172:175], a[196:199], a[4:7]
s_add_u32 m0, s33, 5120
v_mfma_f32_16x16x32_bf16 a[8:11], a[172:175], a[200:203], a[8:11]
buffer_load_dwordx4 v2, s[20:23], s37 offen  lds
v_mfma_f32_16x16x32_bf16 a[12:15], a[172:175], a[204:207], a[12:15]
s_add_u32 s31, s31, 262144
ds_read_b64_tr_b16 a[248:249], v11 offset:0
v_mfma_f32_16x16x32_bf16 a[16:19], a[172:175], a[208:211], a[16:19]
s_add_u32 s33, s33, 16384
v_mfma_f32_16x16x32_bf16 a[20:23], a[172:175], a[212:215], a[20:23]
s_and_b32 s33, s33, 65535
ds_read_b64_tr_b16 a[250:251], v11 offset:1024
v_mfma_f32_16x16x32_bf16 a[24:27], a[172:175], a[216:219], a[24:27]
v_mfma_f32_16x16x32_bf16 a[28:31], a[172:175], a[220:223], a[28:31]
s_add_u32 s48, s48, s34
ds_read_b128 a[172:175], v3 offset:5120
v_mfma_f32_16x16x32_bf16 a[32:35], a[176:179], a[192:195], a[32:35]
s_add_u32 m0, s32, 16384
ds_read_b64_tr_b16 a[252:253], v12 offset:0
v_mfma_f32_16x16x32_bf16 a[36:39], a[176:179], a[196:199], a[36:39]
buffer_load_dwordx4 v1, s[12:15], s48 offen lds
v_mfma_f32_16x16x32_bf16 a[40:43], a[176:179], a[200:203], a[40:43]
ds_read_b64_tr_b16 a[254:255], v12 offset:1024
v_mfma_f32_16x16x32_bf16 a[44:47], a[176:179], a[204:207], a[44:47]
v_mfma_f32_16x16x32_bf16 a[48:51], a[176:179], a[208:211], a[48:51]
ds_read_b128 v[28:31], v3 offset:13312
v_mfma_f32_16x16x32_bf16 a[52:55], a[176:179], a[212:215], a[52:55]
v_mfma_f32_16x16x32_bf16 a[56:59], a[176:179], a[216:219], a[56:59]
s_add_u32 s48, s48, s34
v_mfma_f32_16x16x32_bf16 a[60:63], a[176:179], a[220:223], a[60:63]
s_add_u32 m0, s32, 20480
ds_read_b128 a[176:179], v4 offset:8192
v_add_u32 v5, 16384, v5
v_mfma_f32_16x16x32_bf16 a[64:67], a[180:183], a[192:195], a[64:67]
buffer_load_dwordx4 v1, s[12:15], s48 offen lds
v_and_b32 v5, 65535, v5
v_mfma_f32_16x16x32_bf16 a[68:71], a[180:183], a[196:199], a[68:71]
v_xor_b32 v6, 16, v5
v_xor_b32 v7, 64, v5
v_mfma_f32_16x16x32_bf16 a[72:75], a[180:183], a[200:203], a[72:75]
v_xor_b32 v8, 80, v5
v_xor_b32 v9, 128, v5
v_mfma_f32_16x16x32_bf16 a[76:79], a[180:183], a[204:207], a[76:79]
v_xor_b32 v10, 144, v5
v_xor_b32 v11, 192, v5
v_mfma_f32_16x16x32_bf16 a[80:83], a[180:183], a[208:211], a[80:83]
v_xor_b32 v12, 208, v5
v_mfma_f32_16x16x32_bf16 a[84:87], a[180:183], a[212:215], a[84:87]
s_add_u32 s48, s48, s34
v_mfma_f32_16x16x32_bf16 a[88:91], a[180:183], a[216:219], a[88:91]
s_add_u32 m0, s32, 24576
v_mfma_f32_16x16x32_bf16 a[92:95], a[180:183], a[220:223], a[92:95]
buffer_load_dwordx4 v1, s[12:15], s48 offen lds
ds_read_b128 a[180:183], v3 offset:9216
v_mfma_f32_16x16x32_bf16 a[96:99], a[184:187], a[192:195], a[96:99]
v_mfma_f32_16x16x32_bf16 a[100:103], a[184:187], a[196:199], a[100:103]
v_mfma_f32_16x16x32_bf16 a[104:107], a[184:187], a[200:203], a[104:107]
v_mfma_f32_16x16x32_bf16 a[108:111], a[184:187], a[204:207], a[108:111]
v_mfma_f32_16x16x32_bf16 a[112:115], a[184:187], a[208:211], a[112:115]
s_add_u32 s48, s48, s34
v_mfma_f32_16x16x32_bf16 a[116:119], a[184:187], a[212:215], a[116:119]
s_add_u32 m0, s32, 28672
v_mfma_f32_16x16x32_bf16 a[120:123], a[184:187], a[216:219], a[120:123]
buffer_load_dwordx4 v1, s[12:15], s48 offen lds
v_mfma_f32_16x16x32_bf16 a[124:127], a[184:187], a[220:223], a[124:127]
s_add_u32 s30, s30, 128
ds_read_b128 a[184:187], v4 offset:12288
v_mfma_f32_16x16x32_bf16 a[128:131], a[188:191], a[192:195], a[128:131]
s_add_u32 s32, s32, 32768
v_add_u32 v3, 32768, v3
v_mfma_f32_16x16x32_bf16 a[132:135], a[188:191], a[196:199], a[132:135]
s_sub_u32 s48, s32, 98304
v_subrev_u32 v19, 98304, v3
v_mfma_f32_16x16x32_bf16 a[136:139], a[188:191], a[200:203], a[136:139]
s_cmp_ge_u32 s32, 163840
s_cselect_b32 s32, s48, s32
v_mfma_f32_16x16x32_bf16 a[140:143], a[188:191], a[204:207], a[140:143]
v_cmp_le_u32 vcc, 163840, v3
v_mfma_f32_16x16x32_bf16 a[144:147], a[188:191], a[208:211], a[144:147]
s_nop 0
v_cndmask_b32 v3, v3, v19, vcc
v_mfma_f32_16x16x32_bf16 a[148:151], a[188:191], a[212:215], a[148:151]
v_xor_b32 v4, 64, v3
v_mfma_f32_16x16x32_bf16 a[152:155], a[188:191], a[216:219], a[152:155]
v_mfma_f32_16x16x32_bf16 a[156:159], a[188:191], a[220:223], a[156:159]
s_waitcnt vmcnt(19) lgkmcnt(0)
s_barrier
v_mfma_f32_16x16x32_bf16 v[160:163], a[160:163], a[224:227], v[160:163]
ds_read_b64_tr_b16 a[192:193], v5 offset:0
v_mfma_f32_16x16x32_bf16 v[164:167], a[160:163], a[228:231], v[164:167]
v_mfma_f32_16x16x32_bf16 v[168:171], a[160:163], a[232:235], v[168:171]
ds_read_b64_tr_b16 a[194:195], v5 offset:1024
v_mfma_f32_16x16x32_bf16 v[172:175], a[160:163], a[236:239], v[172:175]
s_add_u32 s37, s31, 0
v_mfma_f32_16x16x32_bf16 v[176:179], a[160:163], a[240:243], v[176:179]
s_add_u32 m0, s33, 0
ds_read_b64_tr_b16 a[196:197], v6 offset:0
v_mfma_f32_16x16x32_bf16 v[180:183], a[160:163], a[244:247], v[180:183]
buffer_load_dwordx4 v2, s[20:23], s37 offen  lds
v_mfma_f32_16x16x32_bf16 v[184:187], a[160:163], a[248:251], v[184:187]
ds_read_b64_tr_b16 a[198:199], v6 offset:1024
v_mfma_f32_16x16x32_bf16 v[188:191], a[160:163], a[252:255], v[188:191]
ds_read_b128 a[160:163], v3 offset:0
v_mfma_f32_16x16x32_bf16 v[192:195], a[164:167], a[224:227], v[192:195]
ds_read_b64_tr_b16 a[200:201], v7 offset:0
v_mfma_f32_16x16x32_bf16 v[196:199], a[164:167], a[228:231], v[196:199]
v_mfma_f32_16x16x32_bf16 v[200:203], a[164:167], a[232:235], v[200:203]
s_add_u32 s37, s31, 32768
ds_read_b64_tr_b16 a[202:203], v7 offset:1024
v_mfma_f32_16x16x32_bf16 v[204:207], a[164:167], a[236:239], v[204:207]
s_add_u32 m0, s33, 1024
v_mfma_f32_16x16x32_bf16 v[208:211], a[164:167], a[240:243], v[208:211]
buffer_load_dwordx4 v2, s[20:23], s37 offen  lds
v_mfma_f32_16x16x32_bf16 v[212:215], a[164:167], a[244:247], v[212:215]
ds_read_b64_tr_b16 a[204:205], v8 offset:0
v_mfma_f32_16x16x32_bf16 v[216:219], a[164:167], a[248:251], v[216:219]
v_mfma_f32_16x16x32_bf16 v[220:223], a[164:167], a[252:255], v[220:223]
ds_read_b128 a[164:167], v4 offset:1024
v_mfma_f32_16x16x32_bf16 v[224:227], a[168:171], a[224:227], v[224:227]
ds_read_b64_tr_b16 a[206:207], v8 offset:1024
v_mfma_f32_16x16x32_bf16 v[228:231], a[168:171], a[228:231], v[228:231]
s_add_u32 s37, s31, 131072
v_mfma_f32_16x16x32_bf16 v[232:235], a[168:171], a[232:235], v[232:235]
s_add_u32 m0, s33, 4096
ds_read_b64_tr_b16 a[208:209], v9 offset:0
v_mfma_f32_16x16x32_bf16 v[236:239], a[168:171], a[236:239], v[236:239]
buffer_load_dwordx4 v2, s[20:23], s37 offen  lds
v_mfma_f32_16x16x32_bf16 v[240:243], a[168:171], a[240:243], v[240:243]
ds_read_b64_tr_b16 a[210:211], v9 offset:1024
v_mfma_f32_16x16x32_bf16 v[244:247], a[168:171], a[244:247], v[244:247]
v_mfma_f32_16x16x32_bf16 v[248:251], a[168:171], a[248:251], v[248:251]
ds_read_b64_tr_b16 a[212:213], v10 offset:0
v_mfma_f32_16x16x32_bf16 v[252:255], a[168:171], a[252:255], v[252:255]
ds_read_b128 a[168:171], v3 offset:4096
v_mfma_f32_16x16x32_bf16 a[0:3], a[172:175], a[224:227], a[0:3]
s_add_u32 s37, s31, 163840
ds_read_b64_tr_b16 a[214:215], v10 offset:1024
v_mfma_f32_16x16x32_bf16 a[4:7], a[172:175], a[228:231], a[4:7]
s_add_u32 m0, s33, 5120
v_mfma_f32_16x16x32_bf16 a[8:11], a[172:175], a[232:235], a[8:11]
buffer_load_dwordx4 v2, s[20:23], s37 offen  lds
v_mfma_f32_16x16x32_bf16 a[12:15], a[172:175], a[236:239], a[12:15]
s_add_u32 s31, s31, 262144
ds_read_b64_tr_b16 a[216:217], v11 offset:0
v_mfma_f32_16x16x32_bf16 a[16:19], a[172:175], a[240:243], a[16:19]
s_add_u32 s33, s33, 16384
v_mfma_f32_16x16x32_bf16 a[20:23], a[172:175], a[244:247], a[20:23]
s_and_b32 s33, s33, 65535
ds_read_b64_tr_b16 a[218:219], v11 offset:1024
v_mfma_f32_16x16x32_bf16 a[24:27], a[172:175], a[248:251], a[24:27]
v_mfma_f32_16x16x32_bf16 a[28:31], a[172:175], a[252:255], a[28:31]
s_mov_b32 s48, s30
ds_read_b128 a[172:175], v4 offset:5120
v_mfma_f32_16x16x32_bf16 a[32:35], a[176:179], a[224:227], a[32:35]
s_add_u32 m0, s32, 0
ds_read_b64_tr_b16 a[220:221], v12 offset:0
v_mfma_f32_16x16x32_bf16 a[36:39], a[176:179], a[228:231], a[36:39]
buffer_load_dwordx4 v1, s[12:15], s48 offen lds
v_mfma_f32_16x16x32_bf16 a[40:43], a[176:179], a[232:235], a[40:43]
ds_read_b64_tr_b16 a[222:223], v12 offset:1024
v_mfma_f32_16x16x32_bf16 a[44:47], a[176:179], a[236:239], a[44:47]
v_mfma_f32_16x16x32_bf16 a[48:51], a[176:179], a[240:243], a[48:51]
ds_read_b128 a[188:191], v4 offset:13312
v_mfma_f32_16x16x32_bf16 a[52:55], a[176:179], a[244:247], a[52:55]
v_mfma_f32_16x16x32_bf16 a[56:59], a[176:179], a[248:251], a[56:59]
s_add_u32 s48, s48, s34
v_mfma_f32_16x16x32_bf16 a[60:63], a[176:179], a[252:255], a[60:63]
s_add_u32 m0, s32, 4096
ds_read_b128 a[176:179], v3 offset:8192
v_add_u32 v5, 16384, v5
v_mfma_f32_16x16x32_bf16 a[64:67], a[180:183], a[224:227], a[64:67]
buffer_load_dwordx4 v1, s[12:15], s48 offen lds
v_and_b32 v5, 65535, v5
v_mfma_f32_16x16x32_bf16 a[68:71], a[180:183], a[228:231], a[68:71]
v_xor_b32 v6, 16, v5
v_xor_b32 v7, 64, v5
v_mfma_f32_16x16x32_bf16 a[72:75], a[180:183], a[232:235], a[72:75]
v_xor_b32 v8, 80, v5
v_xor_b32 v9, 128, v5
v_mfma_f32_16x16x32_bf16 a[76:79], a[180:183], a[236:239], a[76:79]
v_xor_b32 v10, 144, v5
v_xor_b32 v11, 192, v5
v_mfma_f32_16x16x32_bf16 a[80:83], a[180:183], a[240:243], a[80:83]
v_xor_b32 v12, 208, v5
v_mfma_f32_16x16x32_bf16 a[84:87], a[180:183], a[244:247], a[84:87]
s_add_u32 s48, s48, s34
v_mfma_f32_16x16x32_bf16 a[88:91], a[180:183], a[248:251], a[88:91]
s_add_u32 m0, s32, 8192
v_mfma_f32_16x16x32_bf16 a[92:95], a[180:183], a[252:255], a[92:95]
buffer_load_dwordx4 v1, s[12:15], s48 offen lds
ds_read_b128 a[180:183], v4 offset:9216
v_mfma_f32_16x16x32_bf16 a[96:99], a[184:187], a[224:227], a[96:99]
v_mfma_f32_16x16x32_bf16 a[100:103], a[184:187], a[228:231], a[100:103]
v_mfma_f32_16x16x32_bf16 a[104:107], a[184:187], a[232:235], a[104:107]
v_mfma_f32_16x16x32_bf16 a[108:111], a[184:187], a[236:239], a[108:111]
v_mfma_f32_16x16x32_bf16 a[112:115], a[184:187], a[240:243], a[112:115]
s_add_u32 s48, s48, s34
v_mfma_f32_16x16x32_bf16 a[116:119], a[184:187], a[244:247], a[116:119]
s_add_u32 m0, s32, 12288
v_mfma_f32_16x16x32_bf16 a[120:123], a[184:187], a[248:251], a[120:123]
buffer_load_dwordx4 v1, s[12:15], s48 offen lds
v_mfma_f32_16x16x32_bf16 a[124:127], a[184:187], a[252:255], a[124:127]
ds_read_b128 a[184:187], v3 offset:12288
v_mfma_f32_16x16x32_bf16 a[128:131], v[28:31], a[224:227], a[128:131]
v_mfma_f32_16x16x32_bf16 a[132:135], v[28:31], a[228:231], a[132:135]
v_mfma_f32_16x16x32_bf16 a[136:139], v[28:31], a[232:235], a[136:139]
v_mfma_f32_16x16x32_bf16 a[140:143], v[28:31], a[236:239], a[140:143]
v_mfma_f32_16x16x32_bf16 a[144:147], v[28:31], a[240:243], a[144:147]
v_mfma_f32_16x16x32_bf16 a[148:151], v[28:31], a[244:247], a[148:151]
v_mfma_f32_16x16x32_bf16 a[152:155], v[28:31], a[248:251], a[152:155]
v_mfma_f32_16x16x32_bf16 a[156:159], v[28:31], a[252:255], a[156:159]
L_g_v12:
s_waitcnt vmcnt(16) lgkmcnt(0)
s_barrier
v_mfma_f32_16x16x32_bf16 v[160:163], a[160:163], a[192:195], v[160:163]
ds_read_b64_tr_b16 a[224:225], v5 offset:0
s_lshr_b32 s24, s16, 1
v_mfma_f32_16x16x32_bf16 v[164:167], a[160:163], a[196:199], v[164:167]
s_cmp_eq_u32 s35, 5
s_cselect_b32 s90, s24, s90
v_mfma_f32_16x16x32_bf16 v[168:171], a[160:163], a[200:203], v[168:171]
ds_read_b64_tr_b16 a[226:227], v5 offset:1024
s_lshl_b32 s24, s35, 2
v_mfma_f32_16x16x32_bf16 v[172:175], a[160:163], a[204:207], v[172:175]
s_add_u32 s37, s31, 0
s_lshr_b32 s26, s88, s24
s_bfe_u32 s2, s26, 0x10003
v_mfma_f32_16x16x32_bf16 v[176:179], a[160:163], a[208:211], v[176:179]
s_add_u32 m0, s33, 0
ds_read_b64_tr_b16 a[228:229], v6 offset:0
s_and_b32 s26, s26, 7
v_mfma_f32_16x16x32_bf16 v[180:183], a[160:163], a[212:215], v[180:183]
buffer_load_dwordx4 v2, s[20:23], s37 offen  lds
s_or_b32 s40, s2, s61
v_mfma_f32_16x16x32_bf16 v[184:187], a[160:163], a[216:219], v[184:187]
ds_read_b64_tr_b16 a[230:231], v6 offset:1024
s_lshr_b32 s24, s17, 1
v_mfma_f32_16x16x32_bf16 v[188:191], a[160:163], a[220:223], v[188:191]
ds_read_b128 a[160:163], v4 offset:0
v_mfma_f32_16x16x32_bf16 v[192:195], a[164:167], a[192:195], v[192:195]
ds_read_b64_tr_b16 a[232:233], v7 offset:0
v_mfma_f32_16x16x32_bf16 v[196:199], a[164:167], a[196:199], v[196:199]
s_cmp_eq_u32 s2, 0
s_cselect_b32 s41, s24, 0
s_cselect_b32 s27, s89, s90
v_mfma_f32_16x16x32_bf16 v[200:203], a[164:167], a[200:203], v[200:203]
s_add_u32 s37, s31, 32768
ds_read_b64_tr_b16 a[234:235], v7 offset:1024
s_sub_u32 s25, s24, s41
v_mfma_f32_16x16x32_bf16 v[204:207], a[164:167], a[204:207], v[204:207]
s_add_u32 m0, s33, 1024
s_and_b32 s51, s41, s61
s_lshl_b32 s51, s51, 1
v_mfma_f32_16x16x32_bf16 v[208:211], a[164:167], a[208:211], v[208:211]
buffer_load_dwordx4 v2, s[20:23], s37 offen  lds
s_or_b32 s51, s51, s41
v_mfma_f32_16x16x32_bf16 v[212:215], a[164:167], a[212:215], v[212:215]
ds_read_b64_tr_b16 a[236:237], v8 offset:0
s_lshl_b32 s46, s27, s2
v_mfma_f32_16x16x32_bf16 v[216:219], a[164:167], a[216:219], v[216:219]
s_add_u32 s60, s60, s92
s_add_u32 s46, s46, s25
s_lshl_b32 s46, s46, 8
v_mfma_f32_16x16x32_bf16 v[220:223], a[164:167], a[220:223], v[220:223]
s_mov_b32 s29, s60
ds_read_b128 a[164:167], v3 offset:1024
s_lshl_b32 s47, s40, 7
v_mfma_f32_16x16x32_bf16 v[224:227], a[168:171], a[192:195], v[224:227]
buffer_store_dwordx4 v[128:131], v13, s[8:11], s29 offen sc1
s_add_u32 s47, s47, 1024
v_mfma_f32_16x16x32_bf16 v[228:231], a[168:171], a[196:199], v[228:231]
s_add_u32 s37, s31, 131072
ds_read_b64_tr_b16 a[238:239], v8 offset:1024
s_mul_i32 s101, s26, s47
v_mfma_f32_16x16x32_bf16 v[232:235], a[168:171], a[200:203], v[232:235]
s_add_u32 m0, s33, 4096
s_lshl_b32 s101, s101, 8
s_lshl_b32 s42, s27, 3
v_mfma_f32_16x16x32_bf16 v[236:239], a[168:171], a[204:207], v[236:239]
buffer_load_dwordx4 v2, s[20:23], s37 offen  lds
s_add_u32 s42, s42, s26
v_mfma_f32_16x16x32_bf16 v[240:243], a[168:171], a[208:211], v[240:243]
ds_read_b64_tr_b16 a[240:241], v9 offset:0
s_lshl_b32 s42, s42, 1
v_mfma_f32_16x16x32_bf16 v[244:247], a[168:171], a[212:215], v[244:247]
s_and_b32 s25, s17, 1
s_add_u32 s42, s42, s25
s_lshl_b32 s42, s42, 3
v_mfma_f32_16x16x32_bf16 v[248:251], a[168:171], a[216:219], v[248:251]
ds_read_b64_tr_b16 a[242:243], v9 offset:1024
s_add_u32 s42, s42, s24
v_mfma_f32_16x16x32_bf16 v[252:255], a[168:171], a[220:223], v[252:255]
ds_read_b128 a[168:171], v4 offset:4096
s_lshl_b32 s42, s42, 13
v_mfma_f32_16x16x32_bf16 a[0:3], a[172:175], a[192:195], a[0:3]
s_add_u32 s37, s31, 163840
ds_read_b64_tr_b16 a[244:245], v10 offset:0
s_lshl_b32 s43, s27, 5
v_mfma_f32_16x16x32_bf16 a[4:7], a[172:175], a[196:199], a[4:7]
s_add_u32 m0, s33, 5120
s_add_u32 s43, s43, s26
s_lshl_b32 s43, s43, 2
v_mfma_f32_16x16x32_bf16 a[8:11], a[172:175], a[200:203], a[8:11]
buffer_load_dwordx4 v2, s[20:23], s37 offen  lds
s_lshl_b32 s24, s2, 1
v_mfma_f32_16x16x32_bf16 a[12:15], a[172:175], a[204:207], a[12:15]
s_add_u32 s31, s31, 262144
ds_read_b64_tr_b16 a[246:247], v10 offset:1024
s_add_u32 s24, s24, s61
v_mfma_f32_16x16x32_bf16 a[16:19], a[172:175], a[208:211], a[16:19]
s_add_u32 s33, s33, 16384
s_lshl_b32 s24, s24, 2
s_lshr_b32 s25, 0x8720, s24
v_mfma_f32_16x16x32_bf16 a[20:23], a[172:175], a[212:215], a[20:23]
s_and_b32 s33, s33, 65535
ds_read_b64_tr_b16 a[248:249], v11 offset:0
s_and_b32 s25, s25, 15
v_mfma_f32_16x16x32_bf16 a[24:27], a[172:175], a[216:219], a[24:27]
s_lshl_b32 s25, s25, 24
s_add_u32 s42, s42, s25
s_lshr_b32 s25, 0x7604, s24
v_mfma_f32_16x16x32_bf16 a[28:31], a[172:175], a[220:223], a[28:31]
s_add_u32 s48, s48, s34
ds_read_b128 a[172:175], v3 offset:5120
s_and_b32 s25, s25, 15
v_mfma_f32_16x16x32_bf16 a[32:35], a[176:179], a[192:195], a[32:35]
s_add_u32 m0, s32, 16384
ds_read_b64_tr_b16 a[250:251], v11 offset:1024
s_lshl_b32 s25, s25, 12
v_mfma_f32_16x16x32_bf16 a[36:39], a[176:179], a[196:199], a[36:39]
buffer_load_dwordx4 v1, s[12:15], s48 offen lds
s_add_u32 s43, s43, s25
v_mfma_f32_16x16x32_bf16 a[40:43], a[176:179], a[200:203], a[40:43]
ds_read_b64_tr_b16 a[252:253], v12 offset:0
s_add_u32 s43, s43, 111149056
v_mfma_f32_16x16x32_bf16 a[44:47], a[176:179], a[204:207], a[44:47]
s_add_u32 s29, s29, s44
v_mfma_f32_16x16x32_bf16 a[48:51], a[176:179], a[208:211], a[48:51]
ds_read_b64_tr_b16 a[254:255], v12 offset:1024
v_mfma_f32_16x16x32_bf16 a[52:55], a[176:179], a[212:215], a[52:55]
buffer_store_dwordx4 v[132:135], v13, s[8:11], s29 offen sc1
v_mfma_f32_16x16x32_bf16 a[56:59], a[176:179], a[216:219], a[56:59]
s_add_u32 s48, s48, s34
ds_read_b128 v[28:31], v3 offset:13312
v_mfma_f32_16x16x32_bf16 a[60:63], a[176:179], a[220:223], a[60:63]
s_add_u32 m0, s32, 20480
ds_read_b128 a[176:179], v4 offset:8192
v_mfma_f32_16x16x32_bf16 a[64:67], a[180:183], a[192:195], a[64:67]
buffer_load_dwordx4 v1, s[12:15], s48 offen lds
v_mfma_f32_16x16x32_bf16 a[68:71], a[180:183], a[196:199], a[68:71]
s_cmp_lt_u32 s35, s45
s_cselect_b32 s101, s101, 536870912
s_cselect_b32 s46, s46, 536870912
v_mfma_f32_16x16x32_bf16 a[72:75], a[180:183], a[200:203], a[72:75]
v_add_u32 v5, 16384, v5
v_and_b32 v5, 65535, v5
v_mfma_f32_16x16x32_bf16 a[76:79], a[180:183], a[204:207], a[76:79]
v_xor_b32 v6, 16, v5
v_xor_b32 v7, 64, v5
v_mfma_f32_16x16x32_bf16 a[80:83], a[180:183], a[208:211], a[80:83]
v_xor_b32 v8, 80, v5
v_xor_b32 v9, 128, v5
v_mfma_f32_16x16x32_bf16 a[84:87], a[180:183], a[212:215], a[84:87]
s_add_u32 s48, s48, s34
v_xor_b32 v10, 144, v5
v_xor_b32 v11, 192, v5
v_mfma_f32_16x16x32_bf16 a[88:91], a[180:183], a[216:219], a[88:91]
s_add_u32 m0, s32, 24576
v_xor_b32 v12, 208, v5
v_mfma_f32_16x16x32_bf16 a[92:95], a[180:183], a[220:223], a[92:95]
buffer_load_dwordx4 v1, s[12:15], s48 offen lds
ds_read_b128 a[180:183], v3 offset:9216
v_mfma_f32_16x16x32_bf16 a[96:99], a[184:187], a[192:195], a[96:99]
v_mfma_f32_16x16x32_bf16 a[100:103], a[184:187], a[196:199], a[100:103]
v_mfma_f32_16x16x32_bf16 a[104:107], a[184:187], a[200:203], a[104:107]
v_mfma_f32_16x16x32_bf16 a[108:111], a[184:187], a[204:207], a[108:111]
v_mfma_f32_16x16x32_bf16 a[112:115], a[184:187], a[208:211], a[112:115]
s_add_u32 s48, s48, s34
v_mfma_f32_16x16x32_bf16 a[116:119], a[184:187], a[212:215], a[116:119]
s_add_u32 m0, s32, 28672
v_mfma_f32_16x16x32_bf16 a[120:123], a[184:187], a[216:219], a[120:123]
buffer_load_dwordx4 v1, s[12:15], s48 offen lds
v_mfma_f32_16x16x32_bf16 a[124:127], a[184:187], a[220:223], a[124:127]
s_add_u32 s30, s30, 128
ds_read_b128 a[184:187], v4 offset:12288
v_mfma_f32_16x16x32_bf16 a[128:131], a[188:191], a[192:195], a[128:131]
s_add_u32 s32, s32, 32768
s_add_u32 s29, s29, s93
v_add_u32 v3, 32768, v3
v_mfma_f32_16x16x32_bf16 a[132:135], a[188:191], a[196:199], a[132:135]
s_sub_u32 s48, s32, 98304
v_subrev_u32 v19, 98304, v3
v_mfma_f32_16x16x32_bf16 a[136:139], a[188:191], a[200:203], a[136:139]
s_cmp_ge_u32 s32, 163840
s_cselect_b32 s32, s48, s32
buffer_store_dwordx4 v[136:139], v13, s[8:11], s29 offen sc1
buffer_load_dword v15, v14, s[96:99], s100 offen
v_mfma_f32_16x16x32_bf16 a[140:143], a[188:191], a[204:207], a[140:143]
s_add_u32 s100, s100, 16384
v_cmp_le_u32 vcc, 163840, v3
v_mfma_f32_16x16x32_bf16 a[144:147], a[188:191], a[208:211], a[144:147]
s_nop 0
v_cndmask_b32 v3, v3, v19, vcc
v_mfma_f32_16x16x32_bf16 a[148:151], a[188:191], a[212:215], a[148:151]
v_xor_b32 v4, 64, v3
v_mfma_f32_16x16x32_bf16 a[152:155], a[188:191], a[216:219], a[152:155]
v_mfma_f32_16x16x32_bf16 a[156:159], a[188:191], a[220:223], a[156:159]
s_waitcnt vmcnt(20) lgkmcnt(0)
s_barrier
v_mfma_f32_16x16x32_bf16 v[160:163], a[160:163], a[224:227], v[160:163]
ds_read_b64_tr_b16 a[192:193], v5 offset:0
v_mfma_f32_16x16x32_bf16 v[164:167], a[160:163], a[228:231], v[164:167]
s_cmp_eq_u32 s2, 0
s_cselect_b64 s[4:5], s[52:53], s[54:55]
v_mfma_f32_16x16x32_bf16 v[168:171], a[160:163], a[232:235], v[168:171]
ds_read_b64_tr_b16 a[194:195], v5 offset:1024
s_mov_b32 s12, s4
v_mfma_f32_16x16x32_bf16 v[172:175], a[160:163], a[236:239], v[172:175]
s_add_u32 s37, s31, 0
s_and_b32 s13, s5, 0xffff
s_lshl_b32 s14, s47, 11
v_mfma_f32_16x16x32_bf16 v[176:179], a[160:163], a[240:243], v[176:179]
s_add_u32 m0, s33, 0
ds_read_b64_tr_b16 a[196:197], v6 offset:0
s_mov_b32 s15, 0x20000
v_mfma_f32_16x16x32_bf16 v[180:183], a[160:163], a[244:247], v[180:183]
buffer_load_dwordx4 v2, s[20:23], s37 offen  lds
s_mov_b32 s30, s101
v_mfma_f32_16x16x32_bf16 v[184:187], a[160:163], a[248:251], v[184:187]
ds_read_b64_tr_b16 a[198:199], v6 offset:1024
v_lshrrev_b32 v16, 3, v0
v_mfma_f32_16x16x32_bf16 v[188:191], a[160:163], a[252:255], v[188:191]
ds_read_b128 a[160:163], v3 offset:0
v_mul_lo_u32 v16, v16, s47
v_mfma_f32_16x16x32_bf16 v[192:195], a[164:167], a[224:227], v[192:195]
ds_read_b64_tr_b16 a[200:201], v7 offset:0
v_and_b32 v1, 0x70, v1
v_mfma_f32_16x16x32_bf16 v[196:199], a[164:167], a[228:231], v[196:199]
v_add_u32 v1, v1, v16
s_lshl_b32 s34, s47, 5
v_mfma_f32_16x16x32_bf16 v[200:203], a[164:167], a[232:235], v[200:203]
s_add_u32 s37, s31, 32768
ds_read_b64_tr_b16 a[202:203], v7 offset:1024
v_mfma_f32_16x16x32_bf16 v[204:207], a[164:167], a[236:239], v[204:207]
s_add_u32 m0, s33, 1024
v_mfma_f32_16x16x32_bf16 v[208:211], a[164:167], a[240:243], v[208:211]
buffer_load_dwordx4 v2, s[20:23], s37 offen  lds
v_mfma_f32_16x16x32_bf16 v[212:215], a[164:167], a[244:247], v[212:215]
ds_read_b64_tr_b16 a[204:205], v8 offset:0
v_mfma_f32_16x16x32_bf16 v[216:219], a[164:167], a[248:251], v[216:219]
s_add_u32 s29, s29, s44
v_mfma_f32_16x16x32_bf16 v[220:223], a[164:167], a[252:255], v[220:223]
ds_read_b128 a[164:167], v4 offset:1024
v_mfma_f32_16x16x32_bf16 v[224:227], a[168:171], a[224:227], v[224:227]
buffer_store_dwordx4 v[140:143], v13, s[8:11], s29 offen sc1
v_mfma_f32_16x16x32_bf16 v[228:231], a[168:171], a[228:231], v[228:231]
s_add_u32 s37, s31, 131072
ds_read_b64_tr_b16 a[206:207], v8 offset:1024
v_mfma_f32_16x16x32_bf16 v[232:235], a[168:171], a[232:235], v[232:235]
s_add_u32 m0, s33, 4096
v_mfma_f32_16x16x32_bf16 v[236:239], a[168:171], a[236:239], v[236:239]
buffer_load_dwordx4 v2, s[20:23], s37 offen  lds
v_mfma_f32_16x16x32_bf16 v[240:243], a[168:171], a[240:243], v[240:243]
ds_read_b64_tr_b16 a[208:209], v9 offset:0
v_mfma_f32_16x16x32_bf16 v[244:247], a[168:171], a[244:247], v[244:247]
v_mfma_f32_16x16x32_bf16 v[248:251], a[168:171], a[248:251], v[248:251]
ds_read_b64_tr_b16 a[210:211], v9 offset:1024
v_mfma_f32_16x16x32_bf16 v[252:255], a[168:171], a[252:255], v[252:255]
ds_read_b128 a[168:171], v3 offset:4096
v_mfma_f32_16x16x32_bf16 a[0:3], a[172:175], a[224:227], a[0:3]
s_add_u32 s37, s31, 163840
ds_read_b64_tr_b16 a[212:213], v10 offset:0
v_mfma_f32_16x16x32_bf16 a[4:7], a[172:175], a[228:231], a[4:7]
s_add_u32 m0, s33, 5120
v_mfma_f32_16x16x32_bf16 a[8:11], a[172:175], a[232:235], a[8:11]
buffer_load_dwordx4 v2, s[20:23], s37 offen  lds
v_mfma_f32_16x16x32_bf16 a[12:15], a[172:175], a[236:239], a[12:15]
s_add_u32 s31, s31, 262144
ds_read_b64_tr_b16 a[214:215], v10 offset:1024
v_mfma_f32_16x16x32_bf16 a[16:19], a[172:175], a[240:243], a[16:19]
s_add_u32 s33, s33, 16384
v_mfma_f32_16x16x32_bf16 a[20:23], a[172:175], a[244:247], a[20:23]
s_and_b32 s33, s33, 65535
ds_read_b64_tr_b16 a[216:217], v11 offset:0
v_mfma_f32_16x16x32_bf16 a[24:27], a[172:175], a[248:251], a[24:27]
v_mfma_f32_16x16x32_bf16 a[28:31], a[172:175], a[252:255], a[28:31]
s_mov_b32 s48, s30
ds_read_b128 a[172:175], v4 offset:5120
v_mfma_f32_16x16x32_bf16 a[32:35], a[176:179], a[224:227], a[32:35]
s_add_u32 m0, s32, 0
ds_read_b64_tr_b16 a[218:219], v11 offset:1024
v_mfma_f32_16x16x32_bf16 a[36:39], a[176:179], a[228:231], a[36:39]
buffer_load_dwordx4 v1, s[12:15], s48 offen lds
v_mfma_f32_16x16x32_bf16 a[40:43], a[176:179], a[232:235], a[40:43]
ds_read_b64_tr_b16 a[220:221], v12 offset:0
v_mfma_f32_16x16x32_bf16 a[44:47], a[176:179], a[236:239], a[44:47]
s_add_u32 s29, s29, s93
v_mfma_f32_16x16x32_bf16 a[48:51], a[176:179], a[240:243], a[48:51]
ds_read_b64_tr_b16 a[222:223], v12 offset:1024
v_mfma_f32_16x16x32_bf16 a[52:55], a[176:179], a[244:247], a[52:55]
buffer_store_dwordx4 v[144:147], v13, s[8:11], s29 offen sc1
v_mfma_f32_16x16x32_bf16 a[56:59], a[176:179], a[248:251], a[56:59]
s_add_u32 s48, s48, s34
ds_read_b128 a[188:191], v4 offset:13312
v_mfma_f32_16x16x32_bf16 a[60:63], a[176:179], a[252:255], a[60:63]
s_add_u32 m0, s32, 4096
ds_read_b128 a[176:179], v3 offset:8192
v_mfma_f32_16x16x32_bf16 a[64:67], a[180:183], a[224:227], a[64:67]
buffer_load_dwordx4 v1, s[12:15], s48 offen lds
v_mfma_f32_16x16x32_bf16 a[68:71], a[180:183], a[228:231], a[68:71]
v_add_u32 v5, 16384, v5
v_and_b32 v5, 65535, v5
v_mfma_f32_16x16x32_bf16 a[72:75], a[180:183], a[232:235], a[72:75]
v_xor_b32 v6, 16, v5
v_xor_b32 v7, 64, v5
v_mfma_f32_16x16x32_bf16 a[76:79], a[180:183], a[236:239], a[76:79]
v_xor_b32 v8, 80, v5
v_xor_b32 v9, 128, v5
v_mfma_f32_16x16x32_bf16 a[80:83], a[180:183], a[240:243], a[80:83]
s_cmp_eq_u32 s2, 0
s_cselect_b64 s[4:5], s[6:7], s[18:19]
v_mfma_f32_16x16x32_bf16 a[84:87], a[180:183], a[244:247], a[84:87]
s_add_u32 s48, s48, s34
s_mov_b32 s20, s4
s_and_b32 s21, s5, 0xffff
v_mfma_f32_16x16x32_bf16 a[88:91], a[180:183], a[248:251], a[88:91]
s_add_u32 m0, s32, 8192
s_lshl_b32 s22, s47, 12
s_mov_b32 s23, 0x20000
v_mfma_f32_16x16x32_bf16 a[92:95], a[180:183], a[252:255], a[92:95]
buffer_load_dwordx4 v1, s[12:15], s48 offen lds
ds_read_b128 a[180:183], v4 offset:9216
v_mfma_f32_16x16x32_bf16 a[96:99], a[184:187], a[224:227], a[96:99]
s_mov_b32 s31, s46
v_xor_b32 v10, 144, v5
v_xor_b32 v11, 192, v5
v_mfma_f32_16x16x32_bf16 a[100:103], a[184:187], a[228:231], a[100:103]
v_xor_b32 v12, 208, v5
v_mfma_f32_16x16x32_bf16 a[104:107], a[184:187], a[232:235], a[104:107]
v_mfma_f32_16x16x32_bf16 a[108:111], a[184:187], a[236:239], a[108:111]
v_mfma_f32_16x16x32_bf16 a[112:115], a[184:187], a[240:243], a[112:115]
s_add_u32 s48, s48, s34
v_mfma_f32_16x16x32_bf16 a[116:119], a[184:187], a[244:247], a[116:119]
s_add_u32 m0, s32, 12288
v_mfma_f32_16x16x32_bf16 a[120:123], a[184:187], a[248:251], a[120:123]
buffer_load_dwordx4 v1, s[12:15], s48 offen lds
v_mfma_f32_16x16x32_bf16 a[124:127], a[184:187], a[252:255], a[124:127]
ds_read_b128 a[184:187], v3 offset:12288
v_mfma_f32_16x16x32_bf16 a[128:131], v[28:31], a[224:227], a[128:131]
s_add_u32 s29, s29, s44
v_mfma_f32_16x16x32_bf16 a[132:135], v[28:31], a[228:231], a[132:135]
v_mfma_f32_16x16x32_bf16 a[136:139], v[28:31], a[232:235], a[136:139]
buffer_store_dwordx4 v[148:151], v13, s[8:11], s29 offen sc1
buffer_load_dword v15, v14, s[96:99], s100 offen
v_mfma_f32_16x16x32_bf16 a[140:143], v[28:31], a[236:239], a[140:143]
s_add_u32 s100, s100, 16384
v_mfma_f32_16x16x32_bf16 a[144:147], v[28:31], a[240:243], a[144:147]
v_mfma_f32_16x16x32_bf16 a[148:151], v[28:31], a[244:247], a[148:151]
v_mfma_f32_16x16x32_bf16 a[152:155], v[28:31], a[248:251], a[152:155]
v_mfma_f32_16x16x32_bf16 a[156:159], v[28:31], a[252:255], a[156:159]
s_waitcnt vmcnt(24) lgkmcnt(0)
s_barrier
v_mfma_f32_16x16x32_bf16 v[160:163], a[160:163], a[192:195], v[160:163]
ds_read_b64_tr_b16 a[224:225], v5 offset:0
v_mfma_f32_16x16x32_bf16 v[164:167], a[160:163], a[196:199], v[164:167]
v_mfma_f32_16x16x32_bf16 v[168:171], a[160:163], a[200:203], v[168:171]
ds_read_b64_tr_b16 a[226:227], v5 offset:1024
v_mfma_f32_16x16x32_bf16 v[172:175], a[160:163], a[204:207], v[172:175]
s_add_u32 s37, s31, 0
v_mfma_f32_16x16x32_bf16 v[176:179], a[160:163], a[208:211], v[176:179]
s_add_u32 m0, s33, 0
ds_read_b64_tr_b16 a[228:229], v6 offset:0
v_mfma_f32_16x16x32_bf16 v[180:183], a[160:163], a[212:215], v[180:183]
buffer_load_dwordx4 v2, s[20:23], s37 offen  lds
v_mfma_f32_16x16x32_bf16 v[184:187], a[160:163], a[216:219], v[184:187]
ds_read_b64_tr_b16 a[230:231], v6 offset:1024
v_mfma_f32_16x16x32_bf16 v[188:191], a[160:163], a[220:223], v[188:191]
ds_read_b128 a[160:163], v4 offset:0
v_mfma_f32_16x16x32_bf16 v[192:195], a[164:167], a[192:195], v[192:195]
ds_read_b64_tr_b16 a[232:233], v7 offset:0
v_mfma_f32_16x16x32_bf16 v[196:199], a[164:167], a[196:199], v[196:199]
v_mfma_f32_16x16x32_bf16 v[200:203], a[164:167], a[200:203], v[200:203]
s_add_u32 s37, s31, 32768
ds_read_b64_tr_b16 a[234:235], v7 offset:1024
v_mfma_f32_16x16x32_bf16 v[204:207], a[164:167], a[204:207], v[204:207]
s_add_u32 m0, s33, 1024
v_mfma_f32_16x16x32_bf16 v[208:211], a[164:167], a[208:211], v[208:211]
buffer_load_dwordx4 v2, s[20:23], s37 offen  lds
v_mfma_f32_16x16x32_bf16 v[212:215], a[164:167], a[212:215], v[212:215]
ds_read_b64_tr_b16 a[236:237], v8 offset:0
v_mfma_f32_16x16x32_bf16 v[216:219], a[164:167], a[216:219], v[216:219]
s_add_u32 s29, s29, s93
v_mfma_f32_16x16x32_bf16 v[220:223], a[164:167], a[220:223], v[220:223]
ds_read_b128 a[164:167], v3 offset:1024
v_mfma_f32_16x16x32_bf16 v[224:227], a[168:171], a[192:195], v[224:227]
buffer_store_dwordx4 v[152:155], v13, s[8:11], s29 offen sc1
v_mfma_f32_16x16x32_bf16 v[228:231], a[168:171], a[196:199], v[228:231]
s_add_u32 s37, s31, 131072
ds_read_b64_tr_b16 a[238:239], v8 offset:1024
v_mfma_f32_16x16x32_bf16 v[232:235], a[168:171], a[200:203], v[232:235]
s_add_u32 m0, s33, 4096
v_mfma_f32_16x16x32_bf16 v[236:239], a[168:171], a[204:207], v[236:239]
buffer_load_dwordx4 v2, s[20:23], s37 offen  lds
v_mfma_f32_16x16x32_bf16 v[240:243], a[168:171], a[208:211], v[240:243]
ds_read_b64_tr_b16 a[240:241], v9 offset:0
v_mfma_f32_16x16x32_bf16 v[244:247], a[168:171], a[212:215], v[244:247]
v_mfma_f32_16x16x32_bf16 v[248:251], a[168:171], a[216:219], v[248:251]
ds_read_b64_tr_b16 a[242:243], v9 offset:1024
v_mfma_f32_16x16x32_bf16 v[252:255], a[168:171], a[220:223], v[252:255]
ds_read_b128 a[168:171], v4 offset:4096
v_mfma_f32_16x16x32_bf16 a[0:3], a[172:175], a[192:195], a[0:3]
s_add_u32 s37, s31, 163840
ds_read_b64_tr_b16 a[244:245], v10 offset:0
v_mfma_f32_16x16x32_bf16 a[4:7], a[172:175], a[196:199], a[4:7]
s_add_u32 m0, s33, 5120
v_mfma_f32_16x16x32_bf16 a[8:11], a[172:175], a[200:203], a[8:11]
buffer_load_dwordx4 v2, s[20:23], s37 offen  lds
v_mfma_f32_16x16x32_bf16 a[12:15], a[172:175], a[204:207], a[12:15]
s_add_u32 s31, s31, 262144
ds_read_b64_tr_b16 a[246:247], v10 offset:1024
v_mfma_f32_16x16x32_bf16 a[16:19], a[172:175], a[208:211], a[16:19]
s_add_u32 s33, s33, 16384
v_mfma_f32_16x16x32_bf16 a[20:23], a[172:175], a[212:215], a[20:23]
s_and_b32 s33, s33, 65535
ds_read_b64_tr_b16 a[248:249], v11 offset:0
v_mfma_f32_16x16x32_bf16 a[24:27], a[172:175], a[216:219], a[24:27]
v_mfma_f32_16x16x32_bf16 a[28:31], a[172:175], a[220:223], a[28:31]
s_add_u32 s48, s48, s34
ds_read_b128 a[172:175], v3 offset:5120
v_mfma_f32_16x16x32_bf16 a[32:35], a[176:179], a[192:195], a[32:35]
s_add_u32 m0, s32, 16384
ds_read_b64_tr_b16 a[250:251], v11 offset:1024
v_mfma_f32_16x16x32_bf16 a[36:39], a[176:179], a[196:199], a[36:39]
buffer_load_dwordx4 v1, s[12:15], s48 offen lds
v_mfma_f32_16x16x32_bf16 a[40:43], a[176:179], a[200:203], a[40:43]
ds_read_b64_tr_b16 a[252:253], v12 offset:0
v_mfma_f32_16x16x32_bf16 a[44:47], a[176:179], a[204:207], a[44:47]
s_add_u32 s29, s29, s44
v_mfma_f32_16x16x32_bf16 a[48:51], a[176:179], a[208:211], a[48:51]
ds_read_b64_tr_b16 a[254:255], v12 offset:1024
v_mfma_f32_16x16x32_bf16 a[52:55], a[176:179], a[212:215], a[52:55]
buffer_store_dwordx4 v[156:159], v13, s[8:11], s29 offen sc1
v_mfma_f32_16x16x32_bf16 a[56:59], a[176:179], a[216:219], a[56:59]
s_add_u32 s48, s48, s34
ds_read_b128 v[28:31], v3 offset:13312
v_mfma_f32_16x16x32_bf16 a[60:63], a[176:179], a[220:223], a[60:63]
s_add_u32 m0, s32, 20480
ds_read_b128 a[176:179], v4 offset:8192
v_mfma_f32_16x16x32_bf16 a[64:67], a[180:183], a[192:195], a[64:67]
buffer_load_dwordx4 v1, s[12:15], s48 offen lds
v_mfma_f32_16x16x32_bf16 a[68:71], a[180:183], a[196:199], a[68:71]
v_add_u32 v5, 16384, v5
v_and_b32 v5, 65535, v5
v_mfma_f32_16x16x32_bf16 a[72:75], a[180:183], a[200:203], a[72:75]
v_xor_b32 v6, 16, v5
v_xor_b32 v7, 64, v5
v_mfma_f32_16x16x32_bf16 a[76:79], a[180:183], a[204:207], a[76:79]
v_xor_b32 v8, 80, v5
v_xor_b32 v9, 128, v5
v_mfma_f32_16x16x32_bf16 a[80:83], a[180:183], a[208:211], a[80:83]
v_xor_b32 v10, 144, v5
v_xor_b32 v11, 192, v5
v_mfma_f32_16x16x32_bf16 a[84:87], a[180:183], a[212:215], a[84:87]
s_add_u32 s48, s48, s34
v_xor_b32 v12, 208, v5
v_mfma_f32_16x16x32_bf16 a[88:91], a[180:183], a[216:219], a[88:91]
s_add_u32 m0, s32, 24576
v_mfma_f32_16x16x32_bf16 a[92:95], a[180:183], a[220:223], a[92:95]
buffer_load_dwordx4 v1, s[12:15], s48 offen lds
ds_read_b128 a[180:183], v3 offset:9216
v_mfma_f32_16x16x32_bf16 a[96:99], a[184:187], a[192:195], a[96:99]
v_mfma_f32_16x16x32_bf16 a[100:103], a[184:187], a[196:199], a[100:103]
v_mfma_f32_16x16x32_bf16 a[104:107], a[184:187], a[200:203], a[104:107]
v_mfma_f32_16x16x32_bf16 a[108:111], a[184:187], a[204:207], a[108:111]
v_mfma_f32_16x16x32_bf16 a[112:115], a[184:187], a[208:211], a[112:115]
s_add_u32 s48, s48, s34
v_mfma_f32_16x16x32_bf16 a[116:119], a[184:187], a[212:215], a[116:119]
s_add_u32 m0, s32, 28672
v_mfma_f32_16x16x32_bf16 a[120:123], a[184:187], a[216:219], a[120:123]
buffer_load_dwordx4 v1, s[12:15], s48 offen lds
v_mfma_f32_16x16x32_bf16 a[124:127], a[184:187], a[220:223], a[124:127]
s_add_u32 s30, s30, 128
ds_read_b128 a[184:187], v4 offset:12288
v_mfma_f32_16x16x32_bf16 a[128:131], a[188:191], a[192:195], a[128:131]
s_add_u32 s32, s32, 32768
v_add_u32 v3, 32768, v3
v_mfma_f32_16x16x32_bf16 a[132:135], a[188:191], a[196:199], a[132:135]
s_sub_u32 s48, s32, 98304
v_subrev_u32 v19, 98304, v3
v_mfma_f32_16x16x32_bf16 a[136:139], a[188:191], a[200:203], a[136:139]
s_cmp_ge_u32 s32, 163840
s_cselect_b32 s32, s48, s32
buffer_load_dword v15, v14, s[96:99], s100 offen
v_mfma_f32_16x16x32_bf16 a[140:143], a[188:191], a[204:207], a[140:143]
s_add_u32 s100, s100, 16384
v_cmp_le_u32 vcc, 163840, v3
v_mfma_f32_16x16x32_bf16 a[144:147], a[188:191], a[208:211], a[144:147]
s_nop 0
v_cndmask_b32 v3, v3, v19, vcc
v_mfma_f32_16x16x32_bf16 a[148:151], a[188:191], a[212:215], a[148:151]
v_xor_b32 v4, 64, v3
v_mfma_f32_16x16x32_bf16 a[152:155], a[188:191], a[216:219], a[152:155]
v_mfma_f32_16x16x32_bf16 a[156:159], a[188:191], a[220:223], a[156:159]
s_waitcnt vmcnt(23) lgkmcnt(0)
s_barrier
v_mfma_f32_16x16x32_bf16 v[160:163], a[160:163], a[224:227], v[160:163]
ds_read_b64_tr_b16 a[192:193], v5 offset:0
v_mfma_f32_16x16x32_bf16 v[164:167], a[160:163], a[228:231], v[164:167]
v_mfma_f32_16x16x32_bf16 v[168:171], a[160:163], a[232:235], v[168:171]
ds_read_b64_tr_b16 a[194:195], v5 offset:1024
v_mfma_f32_16x16x32_bf16 v[172:175], a[160:163], a[236:239], v[172:175]
s_add_u32 s37, s31, 0
v_mfma_f32_16x16x32_bf16 v[176:179], a[160:163], a[240:243], v[176:179]
s_add_u32 m0, s33, 0
ds_read_b64_tr_b16 a[196:197], v6 offset:0
v_mfma_f32_16x16x32_bf16 v[180:183], a[160:163], a[244:247], v[180:183]
buffer_load_dwordx4 v2, s[20:23], s37 offen  lds
v_mfma_f32_16x16x32_bf16 v[184:187], a[160:163], a[248:251], v[184:187]
ds_read_b64_tr_b16 a[198:199], v6 offset:1024
v_mfma_f32_16x16x32_bf16 v[188:191], a[160:163], a[252:255], v[188:191]
ds_read_b128 a[160:163], v3 offset:0
v_mfma_f32_16x16x32_bf16 v[192:195], a[164:167], a[224:227], v[192:195]
ds_read_b64_tr_b16 a[200:201], v7 offset:0
v_mfma_f32_16x16x32_bf16 v[196:199], a[164:167], a[228:231], v[196:199]
v_mfma_f32_16x16x32_bf16 v[200:203], a[164:167], a[232:235], v[200:203]
s_add_u32 s37, s31, 32768
ds_read_b64_tr_b16 a[202:203], v7 offset:1024
v_mfma_f32_16x16x32_bf16 v[204:207], a[164:167], a[236:239], v[204:207]
s_add_u32 m0, s33, 1024
v_mfma_f32_16x16x32_bf16 v[208:211], a[164:167], a[240:243], v[208:211]
buffer_load_dwordx4 v2, s[20:23], s37 offen  lds
v_mfma_f32_16x16x32_bf16 v[212:215], a[164:167], a[244:247], v[212:215]
ds_read_b64_tr_b16 a[204:205], v8 offset:0
v_mfma_f32_16x16x32_bf16 v[216:219], a[164:167], a[248:251], v[216:219]
v_mfma_f32_16x16x32_bf16 v[220:223], a[164:167], a[252:255], v[220:223]
ds_read_b128 a[164:167], v4 offset:1024
v_mfma_f32_16x16x32_bf16 v[224:227], a[168:171], a[224:227], v[224:227]
ds_read_b64_tr_b16 a[206:207], v8 offset:1024
v_mfma_f32_16x16x32_bf16 v[228:231], a[168:171], a[228:231], v[228:231]
s_add_u32 s37, s31, 131072
v_mfma_f32_16x16x32_bf16 v[232:235], a[168:171], a[232:235], v[232:235]
s_add_u32 m0, s33, 4096
ds_read_b64_tr_b16 a[208:209], v9 offset:0
v_mfma_f32_16x16x32_bf16 v[236:239], a[168:171], a[236:239], v[236:239]
buffer_load_dwordx4 v2, s[20:23], s37 offen  lds
v_mfma_f32_16x16x32_bf16 v[240:243], a[168:171], a[240:243], v[240:243]
ds_read_b64_tr_b16 a[210:211], v9 offset:1024
v_mfma_f32_16x16x32_bf16 v[244:247], a[168:171], a[244:247], v[244:247]
v_mfma_f32_16x16x32_bf16 v[248:251], a[168:171], a[248:251], v[248:251]
ds_read_b64_tr_b16 a[212:213], v10 offset:0
v_mfma_f32_16x16x32_bf16 v[252:255], a[168:171], a[252:255], v[252:255]
ds_read_b128 a[168:171], v3 offset:4096
v_mfma_f32_16x16x32_bf16 a[0:3], a[172:175], a[224:227], a[0:3]
s_add_u32 s37, s31, 163840
ds_read_b64_tr_b16 a[214:215], v10 offset:1024
v_mfma_f32_16x16x32_bf16 a[4:7], a[172:175], a[228:231], a[4:7]
s_add_u32 m0, s33, 5120
v_mfma_f32_16x16x32_bf16 a[8:11], a[172:175], a[232:235], a[8:11]
buffer_load_dwordx4 v2, s[20:23], s37 offen  lds
v_mfma_f32_16x16x32_bf16 a[12:15], a[172:175], a[236:239], a[12:15]
s_add_u32 s31, s31, 262144
ds_read_b64_tr_b16 a[216:217], v11 offset:0
v_mfma_f32_16x16x32_bf16 a[16:19], a[172:175], a[240:243], a[16:19]
s_add_u32 s33, s33, 16384
v_mfma_f32_16x16x32_bf16 a[20:23], a[172:175], a[244:247], a[20:23]
s_and_b32 s33, s33, 65535
ds_read_b64_tr_b16 a[218:219], v11 offset:1024
v_mfma_f32_16x16x32_bf16 a[24:27], a[172:175], a[248:251], a[24:27]
v_mfma_f32_16x16x32_bf16 a[28:31], a[172:175], a[252:255], a[28:31]
s_mov_b32 s48, s30
ds_read_b128 a[172:175], v4 offset:5120
v_mfma_f32_16x16x32_bf16 a[32:35], a[176:179], a[224:227], a[32:35]
s_add_u32 m0, s32, 0
ds_read_b64_tr_b16 a[220:221], v12 offset:0
v_mfma_f32_16x16x32_bf16 a[36:39], a[176:179], a[228:231], a[36:39]
buffer_load_dwordx4 v1, s[12:15], s48 offen lds
v_mfma_f32_16x16x32_bf16 a[40:43], a[176:179], a[232:235], a[40:43]
ds_read_b64_tr_b16 a[222:223], v12 offset:1024
v_mfma_f32_16x16x32_bf16 a[44:47], a[176:179], a[236:239], a[44:47]
v_mfma_f32_16x16x32_bf16 a[48:51], a[176:179], a[240:243], a[48:51]
ds_read_b128 a[188:191], v4 offset:13312
v_mfma_f32_16x16x32_bf16 a[52:55], a[176:179], a[244:247], a[52:55]
v_mfma_f32_16x16x32_bf16 a[56:59], a[176:179], a[248:251], a[56:59]
s_add_u32 s48, s48, s34
v_mfma_f32_16x16x32_bf16 a[60:63], a[176:179], a[252:255], a[60:63]
s_add_u32 m0, s32, 4096
ds_read_b128 a[176:179], v3 offset:8192
v_add_u32 v5, 16384, v5
v_mfma_f32_16x16x32_bf16 a[64:67], a[180:183], a[224:227], a[64:67]
buffer_load_dwordx4 v1, s[12:15], s48 offen lds
v_and_b32 v5, 65535, v5
v_mfma_f32_16x16x32_bf16 a[68:71], a[180:183], a[228:231], a[68:71]
v_xor_b32 v6, 16, v5
v_xor_b32 v7, 64, v5
v_mfma_f32_16x16x32_bf16 a[72:75], a[180:183], a[232:235], a[72:75]
v_xor_b32 v8, 80, v5
v_xor_b32 v9, 128, v5
v_mfma_f32_16x16x32_bf16 a[76:79], a[180:183], a[236:239], a[76:79]
v_xor_b32 v10, 144, v5
v_xor_b32 v11, 192, v5
v_mfma_f32_16x16x32_bf16 a[80:83], a[180:183], a[240:243], a[80:83]
v_xor_b32 v12, 208, v5
v_mfma_f32_16x16x32_bf16 a[84:87], a[180:183], a[244:247], a[84:87]
s_add_u32 s48, s48, s34
v_mfma_f32_16x16x32_bf16 a[88:91], a[180:183], a[248:251], a[88:91]
s_add_u32 m0, s32, 8192
v_mfma_f32_16x16x32_bf16 a[92:95], a[180:183], a[252:255], a[92:95]
buffer_load_dwordx4 v1, s[12:15], s48 offen lds
ds_read_b128 a[180:183], v4 offset:9216
v_mfma_f32_16x16x32_bf16 a[96:99], a[184:187], a[224:227], a[96:99]
v_mfma_f32_16x16x32_bf16 a[100:103], a[184:187], a[228:231], a[100:103]
v_mfma_f32_16x16x32_bf16 a[104:107], a[184:187], a[232:235], a[104:107]
v_mfma_f32_16x16x32_bf16 a[108:111], a[184:187], a[236:239], a[108:111]
v_mfma_f32_16x16x32_bf16 a[112:115], a[184:187], a[240:243], a[112:115]
s_add_u32 s48, s48, s34
v_mfma_f32_16x16x32_bf16 a[116:119], a[184:187], a[244:247], a[116:119]
s_add_u32 m0, s32, 12288
v_mfma_f32_16x16x32_bf16 a[120:123], a[184:187], a[248:251], a[120:123]
buffer_load_dwordx4 v1, s[12:15], s48 offen lds
v_mfma_f32_16x16x32_bf16 a[124:127], a[184:187], a[252:255], a[124:127]
ds_read_b128 a[184:187], v3 offset:12288
v_mfma_f32_16x16x32_bf16 a[128:131], v[28:31], a[224:227], a[128:131]
v_mfma_f32_16x16x32_bf16 a[132:135], v[28:31], a[228:231], a[132:135]
v_mfma_f32_16x16x32_bf16 a[136:139], v[28:31], a[232:235], a[136:139]
buffer_load_dword v15, v14, s[96:99], s100 offen
v_mfma_f32_16x16x32_bf16 a[140:143], v[28:31], a[236:239], a[140:143]
s_add_u32 s100, s100, 16384
v_mfma_f32_16x16x32_bf16 a[144:147], v[28:31], a[240:243], a[144:147]
v_mfma_f32_16x16x32_bf16 a[148:151], v[28:31], a[244:247], a[148:151]
v_mfma_f32_16x16x32_bf16 a[152:155], v[28:31], a[248:251], a[152:155]
v_mfma_f32_16x16x32_bf16 a[156:159], v[28:31], a[252:255], a[156:159]
s_waitcnt vmcnt(20) lgkmcnt(0)
s_barrier
v_mfma_f32_16x16x32_bf16 v[160:163], a[160:163], a[192:195], v[160:163]
ds_read_b64_tr_b16 a[224:225], v5 offset:0
v_mfma_f32_16x16x32_bf16 v[164:167], a[160:163], a[196:199], v[164:167]
v_mfma_f32_16x16x32_bf16 v[168:171], a[160:163], a[200:203], v[168:171]
ds_read_b64_tr_b16 a[226:227], v5 offset:1024
v_mfma_f32_16x16x32_bf16 v[172:175], a[160:163], a[204:207], v[172:175]
s_add_u32 s37, s31, 0
v_mfma_f32_16x16x32_bf16 v[176:179], a[160:163], a[208:211], v[176:179]
s_add_u32 m0, s33, 0
ds_read_b64_tr_b16 a[228:229], v6 offset:0
v_mfma_f32_16x16x32_bf16 v[180:183], a[160:163], a[212:215], v[180:183]
buffer_load_dwordx4 v2, s[20:23], s37 offen  lds
v_mfma_f32_16x16x32_bf16 v[184:187], a[160:163], a[216:219], v[184:187]
ds_read_b64_tr_b16 a[230:231], v6 offset:1024
v_mfma_f32_16x16x32_bf16 v[188:191], a[160:163], a[220:223], v[188:191]
ds_read_b128 a[160:163], v4 offset:0
v_mfma_f32_16x16x32_bf16 v[192:195], a[164:167], a[192:195], v[192:195]
ds_read_b64_tr_b16 a[232:233], v7 offset:0
v_mfma_f32_16x16x32_bf16 v[196:199], a[164:167], a[196:199], v[196:199]
v_mfma_f32_16x16x32_bf16 v[200:203], a[164:167], a[200:203], v[200:203]
s_add_u32 s37, s31, 32768
ds_read_b64_tr_b16 a[234:235], v7 offset:1024
v_mfma_f32_16x16x32_bf16 v[204:207], a[164:167], a[204:207], v[204:207]
s_add_u32 m0, s33, 1024
v_mfma_f32_16x16x32_bf16 v[208:211], a[164:167], a[208:211], v[208:211]
buffer_load_dwordx4 v2, s[20:23], s37 offen  lds
v_mfma_f32_16x16x32_bf16 v[212:215], a[164:167], a[212:215], v[212:215]
ds_read_b64_tr_b16 a[236:237], v8 offset:0
v_mfma_f32_16x16x32_bf16 v[216:219], a[164:167], a[216:219], v[216:219]
v_mfma_f32_16x16x32_bf16 v[220:223], a[164:167], a[220:223], v[220:223]
ds_read_b128 a[164:167], v3 offset:1024
v_mfma_f32_16x16x32_bf16 v[224:227], a[168:171], a[192:195], v[224:227]
ds_read_b64_tr_b16 a[238:239], v8 offset:1024
v_mfma_f32_16x16x32_bf16 v[228:231], a[168:171], a[196:199], v[228:231]
s_add_u32 s37, s31, 131072
v_mfma_f32_16x16x32_bf16 v[232:235], a[168:171], a[200:203], v[232:235]
s_add_u32 m0, s33, 4096
ds_read_b64_tr_b16 a[240:241], v9 offset:0
v_mfma_f32_16x16x32_bf16 v[236:239], a[168:171], a[204:207], v[236:239]
buffer_load_dwordx4 v2, s[20:23], s37 offen  lds
v_mfma_f32_16x16x32_bf16 v[240:243], a[168:171], a[208:211], v[240:243]
ds_read_b64_tr_b16 a[242:243], v9 offset:1024
v_mfma_f32_16x16x32_bf16 v[244:247], a[168:171], a[212:215], v[244:247]
v_mfma_f32_16x16x32_bf16 v[248:251], a[168:171], a[216:219], v[248:251]
ds_read_b64_tr_b16 a[244:245], v10 offset:0
v_mfma_f32_16x16x32_bf16 v[252:255], a[168:171], a[220:223], v[252:255]
ds_read_b128 a[168:171], v4 offset:4096
v_mfma_f32_16x16x32_bf16 a[0:3], a[172:175], a[192:195], a[0:3]
s_add_u32 s37, s31, 163840
ds_read_b64_tr_b16 a[246:247], v10 offset:1024
v_mfma_f32_16x16x32_bf16 a[4:7], a[172:175], a[196:199], a[4:7]
s_add_u32 m0, s33, 5120
v_mfma_f32_16x16x32_bf16 a[8:11], a[172:175], a[200:203], a[8:11]
buffer_load_dwordx4 v2, s[20:23], s37 offen  lds
v_mfma_f32_16x16x32_bf16 a[12:15], a[172:175], a[204:207], a[12:15]
s_add_u32 s31, s31, 262144
ds_read_b64_tr_b16 a[248:249], v11 offset:0
v_mfma_f32_16x16x32_bf16 a[16:19], a[172:175], a[208:211], a[16:19]
s_add_u32 s33, s33, 16384
v_mfma_f32_16x16x32_bf16 a[20:23], a[172:175], a[212:215], a[20:23]
s_and_b32 s33, s33, 65535
ds_read_b64_tr_b16 a[250:251], v11 offset:1024
v_mfma_f32_16x16x32_bf16 a[24:27], a[172:175], a[216:219], a[24:27]
v_mfma_f32_16x16x32_bf16 a[28:31], a[172:175], a[220:223], a[28:31]
s_add_u32 s48, s48, s34
ds_read_b128 a[172:175], v3 offset:5120
v_mfma_f32_16x16x32_bf16 a[32:35], a[176:179], a[192:195], a[32:35]
s_add_u32 m0, s32, 16384
ds_read_b64_tr_b16 a[252:253], v12 offset:0
v_mfma_f32_16x16x32_bf16 a[36:39], a[176:179], a[196:199], a[36:39]
buffer_load_dwordx4 v1, s[12:15], s48 offen lds
v_mfma_f32_16x16x32_bf16 a[40:43], a[176:179], a[200:203], a[40:43]
ds_read_b64_tr_b16 a[254:255], v12 offset:1024
v_mfma_f32_16x16x32_bf16 a[44:47], a[176:179], a[204:207], a[44:47]
v_mfma_f32_16x16x32_bf16 a[48:51], a[176:179], a[208:211], a[48:51]
ds_read_b128 v[28:31], v3 offset:13312
v_mfma_f32_16x16x32_bf16 a[52:55], a[176:179], a[212:215], a[52:55]
v_mfma_f32_16x16x32_bf16 a[56:59], a[176:179], a[216:219], a[56:59]
s_add_u32 s48, s48, s34
v_mfma_f32_16x16x32_bf16 a[60:63], a[176:179], a[220:223], a[60:63]
s_add_u32 m0, s32, 20480
ds_read_b128 a[176:179], v4 offset:8192
v_add_u32 v5, 16384, v5
v_mfma_f32_16x16x32_bf16 a[64:67], a[180:183], a[192:195], a[64:67]
buffer_load_dwordx4 v1, s[12:15], s48 offen lds
v_and_b32 v5, 65535, v5
v_mfma_f32_16x16x32_bf16 a[68:71], a[180:183], a[196:199], a[68:71]
v_xor_b32 v6, 16, v5
v_xor_b32 v7, 64, v5
v_mfma_f32_16x16x32_bf16 a[72:75], a[180:183], a[200:203], a[72:75]
v_xor_b32 v8, 80, v5
v_xor_b32 v9, 128, v5
v_mfma_f32_16x16x32_bf16 a[76:79], a[180:183], a[204:207], a[76:79]
v_xor_b32 v10, 144, v5
v_xor_b32 v11, 192, v5
v_mfma_f32_16x16x32_bf16 a[80:83], a[180:183], a[208:211], a[80:83]
v_xor_b32 v12, 208, v5
v_mfma_f32_16x16x32_bf16 a[84:87], a[180:183], a[212:215], a[84:87]
s_add_u32 s48, s48, s34
v_mfma_f32_16x16x32_bf16 a[88:91], a[180:183], a[216:219], a[88:91]
s_add_u32 m0, s32, 24576
v_mfma_f32_16x16x32_bf16 a[92:95], a[180:183], a[220:223], a[92:95]
buffer_load_dwordx4 v1, s[12:15], s48 offen lds
ds_read_b128 a[180:183], v3 offset:9216
v_mfma_f32_16x16x32_bf16 a[96:99], a[184:187], a[192:195], a[96:99]
v_mfma_f32_16x16x32_bf16 a[100:103], a[184:187], a[196:199], a[100:103]
v_mfma_f32_16x16x32_bf16 a[104:107], a[184:187], a[200:203], a[104:107]
v_mfma_f32_16x16x32_bf16 a[108:111], a[184:187], a[204:207], a[108:111]
v_mfma_f32_16x16x32_bf16 a[112:115], a[184:187], a[208:211], a[112:115]
s_add_u32 s48, s48, s34
v_mfma_f32_16x16x32_bf16 a[116:119], a[184:187], a[212:215], a[116:119]
s_add_u32 m0, s32, 28672
v_mfma_f32_16x16x32_bf16 a[120:123], a[184:187], a[216:219], a[120:123]
buffer_load_dwordx4 v1, s[12:15], s48 offen lds
v_mfma_f32_16x16x32_bf16 a[124:127], a[184:187], a[220:223], a[124:127]
s_add_u32 s30, s30, 128
ds_read_b128 a[184:187], v4 offset:12288
v_mfma_f32_16x16x32_bf16 a[128:131], a[188:191], a[192:195], a[128:131]
s_add_u32 s32, s32, 32768
v_add_u32 v3, 32768, v3
v_mfma_f32_16x16x32_bf16 a[132:135], a[188:191], a[196:199], a[132:135]
s_sub_u32 s48, s32, 98304
v_subrev_u32 v19, 98304, v3
v_mfma_f32_16x16x32_bf16 a[136:139], a[188:191], a[200:203], a[136:139]
s_cmp_ge_u32 s32, 163840
s_cselect_b32 s32, s48, s32
buffer_load_dword v15, v14, s[96:99], s100 offen
v_mfma_f32_16x16x32_bf16 a[140:143], a[188:191], a[204:207], a[140:143]
s_add_u32 s100, s100, 16384
v_cmp_le_u32 vcc, 163840, v3
v_mfma_f32_16x16x32_bf16 a[144:147], a[188:191], a[208:211], a[144:147]
s_nop 0
v_cndmask_b32 v3, v3, v19, vcc
v_mfma_f32_16x16x32_bf16 a[148:151], a[188:191], a[212:215], a[148:151]
v_xor_b32 v4, 64, v3
v_mfma_f32_16x16x32_bf16 a[152:155], a[188:191], a[216:219], a[152:155]
v_mfma_f32_16x16x32_bf16 a[156:159], a[188:191], a[220:223], a[156:159]
s_cmp_eq_u32 s41, 0
s_cbranch_scc0 L_g_v17v
s_waitcnt vmcnt(18) lgkmcnt(0)
s_barrier
v_mfma_f32_16x16x32_bf16 v[160:163], a[160:163], a[224:227], v[160:163]
ds_read_b128 a[192:195], v3 offset:0
v_mfma_f32_16x16x32_bf16 v[164:167], a[160:163], a[228:231], v[164:167]
v_mfma_f32_16x16x32_bf16 v[168:171], a[160:163], a[232:235], v[168:171]
ds_read_b128 a[196:199], v4 offset:1024
v_mfma_f32_16x16x32_bf16 v[172:175], a[160:163], a[236:239], v[172:175]
s_add_u32 s37, s31, 0
v_mfma_f32_16x16x32_bf16 v[176:179], a[160:163], a[240:243], v[176:179]
s_add_u32 m0, s33, 0
ds_read_b128 a[200:203], v3 offset:4096
v_cvt_pk_bf16_f32 v32, v160, v161
v_cvt_pk_bf16_f32 v33, v162, v163
v_mfma_f32_16x16x32_bf16 v[180:183], a[160:163], a[244:247], v[180:183]
buffer_load_dwordx4 v2, s[20:23], s37 offen  lds
v_cvt_pk_bf16_f32 v36, v164, v165
v_cvt_pk_bf16_f32 v37, v166, v167
v_mfma_f32_16x16x32_bf16 v[184:187], a[160:163], a[248:251], v[184:187]
ds_read_b128 a[204:207], v4 offset:5120
v_cvt_pk_bf16_f32 v40, v168, v169
v_cvt_pk_bf16_f32 v41, v170, v171
v_mfma_f32_16x16x32_bf16 v[188:191], a[160:163], a[252:255], v[188:191]
ds_read_b64_tr_b16 a[160:161], v5 offset:0
v_cvt_pk_bf16_f32 v44, v172, v173
v_cvt_pk_bf16_f32 v45, v174, v175
v_mfma_f32_16x16x32_bf16 v[192:195], a[164:167], a[224:227], v[192:195]
ds_read_b64_tr_b16 a[162:163], v5 offset:1024
v_cvt_pk_bf16_f32 v48, v176, v177
v_cvt_pk_bf16_f32 v49, v178, v179
v_mfma_f32_16x16x32_bf16 v[196:199], a[164:167], a[228:231], v[196:199]
ds_read_b128 a[208:211], v3 offset:8192
v_add_u32 v5, 16384, v5
v_cvt_pk_bf16_f32 v52, v180, v181
v_cvt_pk_bf16_f32 v53, v182, v183
v_mfma_f32_16x16x32_bf16 v[200:203], a[164:167], a[232:235], v[200:203]
s_add_u32 s37, s31, 32768
v_and_b32 v5, 65535, v5
v_cvt_pk_bf16_f32 v56, v184, v185
v_cvt_pk_bf16_f32 v57, v186, v187
v_mfma_f32_16x16x32_bf16 v[204:207], a[164:167], a[236:239], v[204:207]
s_add_u32 m0, s33, 1024
ds_read_b128 a[212:215], v4 offset:9216
v_cvt_pk_bf16_f32 v60, v188, v189
v_cvt_pk_bf16_f32 v61, v190, v191
v_mfma_f32_16x16x32_bf16 v[208:211], a[164:167], a[240:243], v[208:211]
buffer_load_dwordx4 v2, s[20:23], s37 offen  lds
v_cvt_pk_bf16_f32 v34, v192, v193
v_cvt_pk_bf16_f32 v35, v194, v195
v_mfma_f32_16x16x32_bf16 v[212:215], a[164:167], a[244:247], v[212:215]
ds_read_b128 a[216:219], v3 offset:12288
v_cvt_pk_bf16_f32 v38, v196, v197
v_cvt_pk_bf16_f32 v39, v198, v199
v_mfma_f32_16x16x32_bf16 v[216:219], a[164:167], a[248:251], v[216:219]
v_cvt_pk_bf16_f32 v42, v200, v201
v_cvt_pk_bf16_f32 v43, v202, v203
v_mfma_f32_16x16x32_bf16 v[220:223], a[164:167], a[252:255], v[220:223]
ds_read_b64_tr_b16 a[164:165], v6 offset:0
v_cvt_pk_bf16_f32 v46, v204, v205
v_cvt_pk_bf16_f32 v47, v206, v207
v_mfma_f32_16x16x32_bf16 v[224:227], a[168:171], a[224:227], v[224:227]
ds_read_b64_tr_b16 a[166:167], v6 offset:1024
v_cvt_pk_bf16_f32 v50, v208, v209
v_cvt_pk_bf16_f32 v51, v210, v211
v_mfma_f32_16x16x32_bf16 v[228:231], a[168:171], a[228:231], v[228:231]
s_add_u32 s37, s31, 131072
ds_read_b128 a[220:223], v4 offset:13312
v_xor_b32 v6, 16, v5
v_cvt_pk_bf16_f32 v54, v212, v213
v_cvt_pk_bf16_f32 v55, v214, v215
v_mfma_f32_16x16x32_bf16 v[232:235], a[168:171], a[232:235], v[232:235]
s_add_u32 m0, s33, 4096
v_cvt_pk_bf16_f32 v58, v216, v217
v_cvt_pk_bf16_f32 v59, v218, v219
v_mfma_f32_16x16x32_bf16 v[236:239], a[168:171], a[236:239], v[236:239]
buffer_load_dwordx4 v2, s[20:23], s37 offen  lds
v_cvt_pk_bf16_f32 v62, v220, v221
v_cvt_pk_bf16_f32 v63, v222, v223
v_mfma_f32_16x16x32_bf16 v[240:243], a[168:171], a[240:243], v[240:243]
ds_read_b64_tr_b16 a[188:189], v12 offset:0
v_cvt_pk_bf16_f32 v64, v224, v225
v_cvt_pk_bf16_f32 v65, v226, v227
v_mfma_f32_16x16x32_bf16 v[244:247], a[168:171], a[244:247], v[244:247]
v_cvt_pk_bf16_f32 v68, v228, v229
v_cvt_pk_bf16_f32 v69, v230, v231
v_mfma_f32_16x16x32_bf16 v[248:251], a[168:171], a[248:251], v[248:251]
ds_read_b64_tr_b16 a[190:191], v12 offset:1024
v_cvt_pk_bf16_f32 v72, v232, v233
v_cvt_pk_bf16_f32 v73, v234, v235
v_mfma_f32_16x16x32_bf16 v[252:255], a[168:171], a[252:255], v[252:255]
ds_read_b64_tr_b16 a[168:169], v7 offset:0
v_cvt_pk_bf16_f32 v76, v236, v237
v_cvt_pk_bf16_f32 v77, v238, v239
v_mfma_f32_16x16x32_bf16 a[0:3], a[172:175], a[224:227], a[0:3]
s_add_u32 s37, s31, 163840
ds_read_b64_tr_b16 a[170:171], v7 offset:1024
v_cvt_pk_bf16_f32 v80, v240, v241
v_cvt_pk_bf16_f32 v81, v242, v243
v_mfma_f32_16x16x32_bf16 a[4:7], a[172:175], a[228:231], a[4:7]
s_add_u32 m0, s33, 5120
v_xor_b32 v7, 64, v5
v_xor_b32 v12, 208, v5
v_cvt_pk_bf16_f32 v84, v244, v245
v_cvt_pk_bf16_f32 v85, v246, v247
v_mfma_f32_16x16x32_bf16 a[8:11], a[172:175], a[232:235], a[8:11]
buffer_load_dwordx4 v2, s[20:23], s37 offen  lds
v_cvt_pk_bf16_f32 v88, v248, v249
v_cvt_pk_bf16_f32 v89, v250, v251
v_mfma_f32_16x16x32_bf16 a[12:15], a[172:175], a[236:239], a[12:15]
s_add_u32 s31, s31, 262144
v_cvt_pk_bf16_f32 v92, v252, v253
v_cvt_pk_bf16_f32 v93, v254, v255
v_mfma_f32_16x16x32_bf16 a[16:19], a[172:175], a[240:243], a[16:19]
s_add_u32 s33, s33, 16384
v_accvgpr_read_b32 v20, a0
v_accvgpr_read_b32 v21, a1
v_accvgpr_read_b32 v22, a2
v_accvgpr_read_b32 v23, a3
v_mfma_f32_16x16x32_bf16 a[20:23], a[172:175], a[244:247], a[20:23]
s_and_b32 s33, s33, 65535
v_cvt_pk_bf16_f32 v66, v20, v21
v_cvt_pk_bf16_f32 v67, v22, v23
v_accvgpr_read_b32 v24, a4
v_accvgpr_read_b32 v25, a5
v_mfma_f32_16x16x32_bf16 a[24:27], a[172:175], a[248:251], a[24:27]
v_accvgpr_read_b32 v26, a6
v_accvgpr_read_b32 v27, a7
v_cvt_pk_bf16_f32 v70, v24, v25
v_cvt_pk_bf16_f32 v71, v26, v27
v_mfma_f32_16x16x32_bf16 a[28:31], a[172:175], a[252:255], a[28:31]
s_mov_b32 s48, s30
ds_read_b64_tr_b16 a[172:173], v8 offset:0
v_accvgpr_read_b32 v20, a8
v_accvgpr_read_b32 v21, a9
v_accvgpr_read_b32 v22, a10
v_mfma_f32_16x16x32_bf16 a[32:35], a[176:179], a[224:227], a[32:35]
s_add_u32 m0, s32, 0
ds_read_b64_tr_b16 a[174:175], v8 offset:1024
v_mov_b32 v16, 0
v_accvgpr_read_b32 v23, a11
v_cvt_pk_bf16_f32 v74, v20, v21
v_mfma_f32_16x16x32_bf16 a[36:39], a[176:179], a[228:231], a[36:39]
buffer_load_dwordx4 v1, s[12:15], s48 offen lds
v_mov_b32 v17, 1
v_cvt_pk_bf16_f32 v75, v22, v23
v_accvgpr_read_b32 v24, a12
v_mfma_f32_16x16x32_bf16 a[40:43], a[176:179], a[232:235], a[40:43]
s_cmp_eq_u32 s17, 0
s_cselect_b32 s29, s39, 536870912
v_accvgpr_read_b32 v25, a13
v_accvgpr_read_b32 v26, a14
v_mfma_f32_16x16x32_bf16 a[44:47], a[176:179], a[236:239], a[44:47]
s_mov_b64 exec, 1
buffer_store_dword v17, v16, s[8:11], s29 offen sc1
s_mov_b64 exec, -1
v_accvgpr_read_b32 v27, a15
v_mfma_f32_16x16x32_bf16 a[48:51], a[176:179], a[240:243], a[48:51]
v_xor_b32 v8, 80, v5
v_cvt_pk_bf16_f32 v78, v24, v25
v_cvt_pk_bf16_f32 v79, v26, v27
v_accvgpr_read_b32 v20, a16
v_mfma_f32_16x16x32_bf16 a[52:55], a[176:179], a[244:247], a[52:55]
v_accvgpr_read_b32 v21, a17
v_accvgpr_read_b32 v22, a18
v_accvgpr_read_b32 v23, a19
v_cvt_pk_bf16_f32 v82, v20, v21
v_mfma_f32_16x16x32_bf16 a[56:59], a[176:179], a[248:251], a[56:59]
s_add_u32 s48, s48, s34
v_cvt_pk_bf16_f32 v83, v22, v23
v_accvgpr_read_b32 v24, a20
v_accvgpr_read_b32 v25, a21
v_accvgpr_read_b32 v26, a22
v_mfma_f32_16x16x32_bf16 a[60:63], a[176:179], a[252:255], a[60:63]
s_add_u32 m0, s32, 4096
ds_read_b64_tr_b16 a[176:177], v9 offset:0
v_accvgpr_read_b32 v27, a23
v_cvt_pk_bf16_f32 v86, v24, v25
v_cvt_pk_bf16_f32 v87, v26, v27
v_mfma_f32_16x16x32_bf16 a[64:67], a[180:183], a[224:227], a[64:67]
buffer_load_dwordx4 v1, s[12:15], s48 offen lds
ds_read_b64_tr_b16 a[178:179], v9 offset:1024
v_accvgpr_read_b32 v20, a24
v_accvgpr_read_b32 v21, a25
v_mfma_f32_16x16x32_bf16 a[68:71], a[180:183], a[228:231], a[68:71]
v_xor_b32 v9, 128, v5
v_accvgpr_read_b32 v22, a26
v_accvgpr_read_b32 v23, a27
v_cvt_pk_bf16_f32 v90, v20, v21
v_mfma_f32_16x16x32_bf16 a[72:75], a[180:183], a[232:235], a[72:75]
v_cvt_pk_bf16_f32 v91, v22, v23
v_accvgpr_read_b32 v24, a28
v_accvgpr_read_b32 v25, a29
v_accvgpr_read_b32 v26, a30
v_mfma_f32_16x16x32_bf16 a[76:79], a[180:183], a[236:239], a[76:79]
v_accvgpr_read_b32 v27, a31
v_cvt_pk_bf16_f32 v94, v24, v25
v_cvt_pk_bf16_f32 v95, v26, v27
v_accvgpr_read_b32 v20, a32
v_mfma_f32_16x16x32_bf16 a[80:83], a[180:183], a[240:243], a[80:83]
v_accvgpr_read_b32 v21, a33
v_accvgpr_read_b32 v22, a34
v_accvgpr_read_b32 v23, a35
v_cvt_pk_bf16_f32 v96, v20, v21
v_mfma_f32_16x16x32_bf16 a[84:87], a[180:183], a[244:247], a[84:87]
s_add_u32 s48, s48, s34
v_cvt_pk_bf16_f32 v97, v22, v23
v_accvgpr_read_b32 v24, a36
v_accvgpr_read_b32 v25, a37
v_accvgpr_read_b32 v26, a38
v_mfma_f32_16x16x32_bf16 a[88:91], a[180:183], a[248:251], a[88:91]
s_add_u32 m0, s32, 8192
v_accvgpr_read_b32 v27, a39
v_cvt_pk_bf16_f32 v100, v24, v25
v_cvt_pk_bf16_f32 v101, v26, v27
v_accvgpr_read_b32 v20, a40
v_mfma_f32_16x16x32_bf16 a[92:95], a[180:183], a[252:255], a[92:95]
buffer_load_dwordx4 v1, s[12:15], s48 offen lds
ds_read_b64_tr_b16 a[180:181], v10 offset:0
v_accvgpr_read_b32 v21, a41
v_accvgpr_read_b32 v22, a42
v_mfma_f32_16x16x32_bf16 a[96:99], a[184:187], a[224:227], a[96:99]
ds_read_b64_tr_b16 a[182:183], v10 offset:1024
v_accvgpr_read_b32 v23, a43
v_cvt_pk_bf16_f32 v104, v20, v21
v_cvt_pk_bf16_f32 v105, v22, v23
v_mfma_f32_16x16x32_bf16 a[100:103], a[184:187], a[228:231], a[100:103]
v_xor_b32 v10, 144, v5
v_accvgpr_read_b32 v24, a44
v_accvgpr_read_b32 v25, a45
v_accvgpr_read_b32 v26, a46
v_mfma_f32_16x16x32_bf16 a[104:107], a[184:187], a[232:235], a[104:107]
v_accvgpr_read_b32 v27, a47
v_cvt_pk_bf16_f32 v108, v24, v25
v_cvt_pk_bf16_f32 v109, v26, v27
v_accvgpr_read_b32 v20, a48
v_mfma_f32_16x16x32_bf16 a[108:111], a[184:187], a[236:239], a[108:111]
v_accvgpr_read_b32 v21, a49
v_accvgpr_read_b32 v22, a50
v_accvgpr_read_b32 v23, a51
v_cvt_pk_bf16_f32 v112, v20, v21
v_mfma_f32_16x16x32_bf16 a[112:115], a[184:187], a[240:243], a[112:115]
s_add_u32 s48, s48, s34
v_cvt_pk_bf16_f32 v113, v22, v23
v_accvgpr_read_b32 v24, a52
v_accvgpr_read_b32 v25, a53
v_accvgpr_read_b32 v26, a54
v_mfma_f32_16x16x32_bf16 a[116:119], a[184:187], a[244:247], a[116:119]
s_add_u32 m0, s32, 12288
v_accvgpr_read_b32 v27, a55
v_cvt_pk_bf16_f32 v116, v24, v25
v_cvt_pk_bf16_f32 v117, v26, v27
v_accvgpr_read_b32 v20, a56
v_mfma_f32_16x16x32_bf16 a[120:123], a[184:187], a[248:251], a[120:123]
buffer_load_dwordx4 v1, s[12:15], s48 offen lds
v_accvgpr_read_b32 v21, a57
v_accvgpr_read_b32 v22, a58
v_accvgpr_read_b32 v23, a59
v_mfma_f32_16x16x32_bf16 a[124:127], a[184:187], a[252:255], a[124:127]
ds_read_b64_tr_b16 a[184:185], v11 offset:0
v_cvt_pk_bf16_f32 v120, v20, v21
v_cvt_pk_bf16_f32 v121, v22, v23
v_accvgpr_read_b32 v24, a60
v_mfma_f32_16x16x32_bf16 a[128:131], v[28:31], a[224:227], a[128:131]
ds_read_b64_tr_b16 a[186:187], v11 offset:1024
v_accvgpr_read_b32 v25, a61
v_accvgpr_read_b32 v26, a62
v_accvgpr_read_b32 v27, a63
v_mfma_f32_16x16x32_bf16 a[132:135], v[28:31], a[228:231], a[132:135]
v_xor_b32 v11, 192, v5
v_cvt_pk_bf16_f32 v124, v24, v25
v_cvt_pk_bf16_f32 v125, v26, v27
v_mfma_f32_16x16x32_bf16 a[136:139], v[28:31], a[232:235], a[136:139]
buffer_load_dword v15, v14, s[96:99], s100 offen
v_mfma_f32_16x16x32_bf16 a[140:143], v[28:31], a[236:239], a[140:143]
s_add_u32 s100, s100, 16384
v_mfma_f32_16x16x32_bf16 a[144:147], v[28:31], a[240:243], a[144:147]
v_mfma_f32_16x16x32_bf16 a[148:151], v[28:31], a[244:247], a[148:151]
v_mfma_f32_16x16x32_bf16 a[152:155], v[28:31], a[248:251], a[152:155]
v_mfma_f32_16x16x32_bf16 a[156:159], v[28:31], a[252:255], a[156:159]
s_cmp_lt_u32 s35, s45
s_cbranch_scc1 L_g_tile
s_branch L_g_end
L_g_v17v:
s_waitcnt vmcnt(18) lgkmcnt(0)
s_barrier
v_mfma_f32_16x16x32_bf16 v[160:163], a[160:163], a[224:227], v[160:163]
ds_read_b64_tr_b16 a[192:193], v5 offset:0
v_mfma_f32_16x16x32_bf16 v[164:167], a[160:163], a[228:231], v[164:167]
v_mfma_f32_16x16x32_bf16 v[168:171], a[160:163], a[232:235], v[168:171]
ds_read_b64_tr_b16 a[194:195], v5 offset:1024
v_mfma_f32_16x16x32_bf16 v[172:175], a[160:163], a[236:239], v[172:175]
s_add_u32 s37, s31, 0
v_mfma_f32_16x16x32_bf16 v[176:179], a[160:163], a[240:243], v[176:179]
s_add_u32 m0, s33, 0
ds_read_b64_tr_b16 a[196:197], v6 offset:0
v_cvt_pk_bf16_f32 v32, v160, v161
v_cvt_pk_bf16_f32 v33, v162, v163
v_mfma_f32_16x16x32_bf16 v[180:183], a[160:163], a[244:247], v[180:183]
buffer_load_dwordx4 v2, s[20:23], s37 offen  lds
v_cvt_pk_bf16_f32 v36, v164, v165
v_cvt_pk_bf16_f32 v37, v166, v167
v_mfma_f32_16x16x32_bf16 v[184:187], a[160:163], a[248:251], v[184:187]
ds_read_b64_tr_b16 a[198:199], v6 offset:1024
v_cvt_pk_bf16_f32 v40, v168, v169
v_cvt_pk_bf16_f32 v41, v170, v171
v_mfma_f32_16x16x32_bf16 v[188:191], a[160:163], a[252:255], v[188:191]
ds_read_b128 a[160:163], v3 offset:0
v_cvt_pk_bf16_f32 v44, v172, v173
v_cvt_pk_bf16_f32 v45, v174, v175
v_mfma_f32_16x16x32_bf16 v[192:195], a[164:167], a[224:227], v[192:195]
ds_read_b64_tr_b16 a[200:201], v7 offset:0
v_cvt_pk_bf16_f32 v48, v176, v177
v_cvt_pk_bf16_f32 v49, v178, v179
v_mfma_f32_16x16x32_bf16 v[196:199], a[164:167], a[228:231], v[196:199]
v_cvt_pk_bf16_f32 v52, v180, v181
v_cvt_pk_bf16_f32 v53, v182, v183
v_mfma_f32_16x16x32_bf16 v[200:203], a[164:167], a[232:235], v[200:203]
s_add_u32 s37, s31, 32768
ds_read_b64_tr_b16 a[202:203], v7 offset:1024
v_cvt_pk_bf16_f32 v56, v184, v185
v_cvt_pk_bf16_f32 v57, v186, v187
v_mfma_f32_16x16x32_bf16 v[204:207], a[164:167], a[236:239], v[204:207]
s_add_u32 m0, s33, 1024
v_cvt_pk_bf16_f32 v60, v188, v189
v_cvt_pk_bf16_f32 v61, v190, v191
v_mfma_f32_16x16x32_bf16 v[208:211], a[164:167], a[240:243], v[208:211]
buffer_load_dwordx4 v2, s[20:23], s37 offen  lds
v_cvt_pk_bf16_f32 v34, v192, v193
v_cvt_pk_bf16_f32 v35, v194, v195
v_mfma_f32_16x16x32_bf16 v[212:215], a[164:167], a[244:247], v[212:215]
ds_read_b64_tr_b16 a[204:205], v8 offset:0
v_cvt_pk_bf16_f32 v38, v196, v197
v_cvt_pk_bf16_f32 v39, v198, v199
v_mfma_f32_16x16x32_bf16 v[216:219], a[164:167], a[248:251], v[216:219]
v_cvt_pk_bf16_f32 v42, v200, v201
v_cvt_pk_bf16_f32 v43, v202, v203
v_mfma_f32_16x16x32_bf16 v[220:223], a[164:167], a[252:255], v[220:223]
ds_read_b128 a[164:167], v4 offset:1024
v_cvt_pk_bf16_f32 v46, v204, v205
v_cvt_pk_bf16_f32 v47, v206, v207
v_mfma_f32_16x16x32_bf16 v[224:227], a[168:171], a[224:227], v[224:227]
ds_read_b64_tr_b16 a[206:207], v8 offset:1024
v_cvt_pk_bf16_f32 v50, v208, v209
v_cvt_pk_bf16_f32 v51, v210, v211
v_mfma_f32_16x16x32_bf16 v[228:231], a[168:171], a[228:231], v[228:231]
s_add_u32 s37, s31, 131072
v_cvt_pk_bf16_f32 v54, v212, v213
v_cvt_pk_bf16_f32 v55, v214, v215
v_mfma_f32_16x16x32_bf16 v[232:235], a[168:171], a[232:235], v[232:235]
s_add_u32 m0, s33, 4096
ds_read_b64_tr_b16 a[208:209], v9 offset:0
v_cvt_pk_bf16_f32 v58, v216, v217
v_cvt_pk_bf16_f32 v59, v218, v219
v_mfma_f32_16x16x32_bf16 v[236:239], a[168:171], a[236:239], v[236:239]
buffer_load_dwordx4 v2, s[20:23], s37 offen  lds
v_cvt_pk_bf16_f32 v62, v220, v221
v_cvt_pk_bf16_f32 v63, v222, v223
v_mfma_f32_16x16x32_bf16 v[240:243], a[168:171], a[240:243], v[240:243]
ds_read_b64_tr_b16 a[210:211], v9 offset:1024
v_cvt_pk_bf16_f32 v64, v224, v225
v_cvt_pk_bf16_f32 v65, v226, v227
v_mfma_f32_16x16x32_bf16 v[244:247], a[168:171], a[244:247], v[244:247]
v_cvt_pk_bf16_f32 v68, v228, v229
v_cvt_pk_bf16_f32 v69, v230, v231
v_mfma_f32_16x16x32_bf16 v[248:251], a[168:171], a[248:251], v[248:251]
ds_read_b64_tr_b16 a[212:213], v10 offset:0
v_cvt_pk_bf16_f32 v72, v232, v233
v_cvt_pk_bf16_f32 v73, v234, v235
v_mfma_f32_16x16x32_bf16 v[252:255], a[168:171], a[252:255], v[252:255]
ds_read_b128 a[168:171], v3 offset:4096
v_cvt_pk_bf16_f32 v76, v236, v237
v_cvt_pk_bf16_f32 v77, v238, v239
v_mfma_f32_16x16x32_bf16 a[0:3], a[172:175], a[224:227], a[0:3]
s_add_u32 s37, s31, 163840
ds_read_b64_tr_b16 a[214:215], v10 offset:1024
v_cvt_pk_bf16_f32 v80, v240, v241
v_cvt_pk_bf16_f32 v81, v242, v243
v_mfma_f32_16x16x32_bf16 a[4:7], a[172:175], a[228:231], a[4:7]
s_add_u32 m0, s33, 5120
v_cvt_pk_bf16_f32 v84, v244, v245
v_cvt_pk_bf16_f32 v85, v246, v247
v_mfma_f32_16x16x32_bf16 a[8:11], a[172:175], a[232:235], a[8:11]
buffer_load_dwordx4 v2, s[20:23], s37 offen  lds
v_cvt_pk_bf16_f32 v88, v248, v249
v_cvt_pk_bf16_f32 v89, v250, v251
v_mfma_f32_16x16x32_bf16 a[12:15], a[172:175], a[236:239], a[12:15]
s_add_u32 s31, s31, 262144
ds_read_b64_tr_b16 a[216:217], v11 offset:0
v_cvt_pk_bf16_f32 v92, v252, v253
v_cvt_pk_bf16_f32 v93, v254, v255
v_mfma_f32_16x16x32_bf16 a[16:19], a[172:175], a[240:243], a[16:19]
s_add_u32 s33, s33, 16384
v_accvgpr_read_b32 v20, a0
v_accvgpr_read_b32 v21, a1
v_accvgpr_read_b32 v22, a2
v_accvgpr_read_b32 v23, a3
v_mfma_f32_16x16x32_bf16 a[20:23], a[172:175], a[244:247], a[20:23]
s_and_b32 s33, s33, 65535
ds_read_b64_tr_b16 a[218:219], v11 offset:1024
v_cvt_pk_bf16_f32 v66, v20, v21
v_cvt_pk_bf16_f32 v67, v22, v23
v_accvgpr_read_b32 v24, a4
v_mfma_f32_16x16x32_bf16 a[24:27], a[172:175], a[248:251], a[24:27]
v_accvgpr_read_b32 v25, a5
v_accvgpr_read_b32 v26, a6
v_accvgpr_read_b32 v27, a7
v_cvt_pk_bf16_f32 v70, v24, v25
v_mfma_f32_16x16x32_bf16 a[28:31], a[172:175], a[252:255], a[28:31]
s_mov_b32 s48, s30
ds_read_b128 a[172:175], v4 offset:5120
v_cvt_pk_bf16_f32 v71, v26, v27
v_accvgpr_read_b32 v20, a8
v_accvgpr_read_b32 v21, a9
v_mfma_f32_16x16x32_bf16 a[32:35], a[176:179], a[224:227], a[32:35]
s_add_u32 m0, s32, 0
ds_read_b64_tr_b16 a[220:221], v12 offset:0
v_mov_b32 v16, 0
v_accvgpr_read_b32 v22, a10
v_accvgpr_read_b32 v23, a11
v_mfma_f32_16x16x32_bf16 a[36:39], a[176:179], a[228:231], a[36:39]
buffer_load_dwordx4 v1, s[12:15], s48 offen lds
v_mov_b32 v17, 1
v_cvt_pk_bf16_f32 v74, v20, v21
v_cvt_pk_bf16_f32 v75, v22, v23
v_mfma_f32_16x16x32_bf16 a[40:43], a[176:179], a[232:235], a[40:43]
ds_read_b64_tr_b16 a[222:223], v12 offset:1024
v_accvgpr_read_b32 v24, a12
v_accvgpr_read_b32 v25, a13
v_accvgpr_read_b32 v26, a14
v_mfma_f32_16x16x32_bf16 a[44:47], a[176:179], a[236:239], a[44:47]
s_cmp_eq_u32 s17, 0
s_cselect_b32 s29, s39, 536870912
v_accvgpr_read_b32 v27, a15
v_cvt_pk_bf16_f32 v78, v24, v25
v_mfma_f32_16x16x32_bf16 a[48:51], a[176:179], a[240:243], a[48:51]
ds_read_b128 a[188:191], v4 offset:13312
v_cvt_pk_bf16_f32 v79, v26, v27
v_accvgpr_read_b32 v20, a16
v_accvgpr_read_b32 v21, a17
v_mfma_f32_16x16x32_bf16 a[52:55], a[176:179], a[244:247], a[52:55]
s_mov_b64 exec, 1
buffer_store_dword v17, v16, s[8:11], s29 offen sc1
s_mov_b64 exec, -1
v_accvgpr_read_b32 v22, a18
v_mfma_f32_16x16x32_bf16 a[56:59], a[176:179], a[248:251], a[56:59]
s_add_u32 s48, s48, s34
v_accvgpr_read_b32 v23, a19
v_cvt_pk_bf16_f32 v82, v20, v21
v_cvt_pk_bf16_f32 v83, v22, v23
v_accvgpr_read_b32 v24, a20
v_mfma_f32_16x16x32_bf16 a[60:63], a[176:179], a[252:255], a[60:63]
s_add_u32 m0, s32, 4096
ds_read_b128 a[176:179], v3 offset:8192
v_add_u32 v5, 16384, v5
v_accvgpr_read_b32 v25, a21
v_accvgpr_read_b32 v26, a22
v_mfma_f32_16x16x32_bf16 a[64:67], a[180:183], a[224:227], a[64:67]
buffer_load_dwordx4 v1, s[12:15], s48 offen lds
v_and_b32 v5, 65535, v5
v_accvgpr_read_b32 v27, a23
v_cvt_pk_bf16_f32 v86, v24, v25
v_mfma_f32_16x16x32_bf16 a[68:71], a[180:183], a[228:231], a[68:71]
v_xor_b32 v6, 16, v5
v_xor_b32 v7, 64, v5
v_cvt_pk_bf16_f32 v87, v26, v27
v_accvgpr_read_b32 v20, a24
v_mfma_f32_16x16x32_bf16 a[72:75], a[180:183], a[232:235], a[72:75]
v_xor_b32 v8, 80, v5
v_xor_b32 v9, 128, v5
v_accvgpr_read_b32 v21, a25
v_accvgpr_read_b32 v22, a26
v_mfma_f32_16x16x32_bf16 a[76:79], a[180:183], a[236:239], a[76:79]
v_xor_b32 v10, 144, v5
v_xor_b32 v11, 192, v5
v_accvgpr_read_b32 v23, a27
v_cvt_pk_bf16_f32 v90, v20, v21
v_mfma_f32_16x16x32_bf16 a[80:83], a[180:183], a[240:243], a[80:83]
v_xor_b32 v12, 208, v5
v_cvt_pk_bf16_f32 v91, v22, v23
v_accvgpr_read_b32 v24, a28
v_accvgpr_read_b32 v25, a29
v_mfma_f32_16x16x32_bf16 a[84:87], a[180:183], a[244:247], a[84:87]
s_add_u32 s48, s48, s34
v_accvgpr_read_b32 v26, a30
v_accvgpr_read_b32 v27, a31
v_cvt_pk_bf16_f32 v94, v24, v25
v_cvt_pk_bf16_f32 v95, v26, v27
v_mfma_f32_16x16x32_bf16 a[88:91], a[180:183], a[248:251], a[88:91]
s_add_u32 m0, s32, 8192
v_accvgpr_read_b32 v20, a32
v_accvgpr_read_b32 v21, a33
v_accvgpr_read_b32 v22, a34
v_accvgpr_read_b32 v23, a35
v_mfma_f32_16x16x32_bf16 a[92:95], a[180:183], a[252:255], a[92:95]
buffer_load_dwordx4 v1, s[12:15], s48 offen lds
ds_read_b128 a[180:183], v4 offset:9216
v_cvt_pk_bf16_f32 v96, v20, v21
v_cvt_pk_bf16_f32 v97, v22, v23
v_mfma_f32_16x16x32_bf16 a[96:99], a[184:187], a[224:227], a[96:99]
v_accvgpr_read_b32 v24, a36
v_accvgpr_read_b32 v25, a37
v_accvgpr_read_b32 v26, a38
v_accvgpr_read_b32 v27, a39
v_mfma_f32_16x16x32_bf16 a[100:103], a[184:187], a[228:231], a[100:103]
v_cvt_pk_bf16_f32 v100, v24, v25
v_cvt_pk_bf16_f32 v101, v26, v27
v_accvgpr_read_b32 v20, a40
v_accvgpr_read_b32 v21, a41
v_mfma_f32_16x16x32_bf16 a[104:107], a[184:187], a[232:235], a[104:107]
v_accvgpr_read_b32 v22, a42
v_accvgpr_read_b32 v23, a43
v_cvt_pk_bf16_f32 v104, v20, v21
v_cvt_pk_bf16_f32 v105, v22, v23
v_mfma_f32_16x16x32_bf16 a[108:111], a[184:187], a[236:239], a[108:111]
v_accvgpr_read_b32 v24, a44
v_accvgpr_read_b32 v25, a45
v_accvgpr_read_b32 v26, a46
v_accvgpr_read_b32 v27, a47
v_mfma_f32_16x16x32_bf16 a[112:115], a[184:187], a[240:243], a[112:115]
s_add_u32 s48, s48, s34
v_cvt_pk_bf16_f32 v108, v24, v25
v_cvt_pk_bf16_f32 v109, v26, v27
v_accvgpr_read_b32 v20, a48
v_accvgpr_read_b32 v21, a49
v_mfma_f32_16x16x32_bf16 a[116:119], a[184:187], a[244:247], a[116:119]
s_add_u32 m0, s32, 12288
v_accvgpr_read_b32 v22, a50
v_accvgpr_read_b32 v23, a51
v_cvt_pk_bf16_f32 v112, v20, v21
v_cvt_pk_bf16_f32 v113, v22, v23
v_mfma_f32_16x16x32_bf16 a[120:123], a[184:187], a[248:251], a[120:123]
buffer_load_dwordx4 v1, s[12:15], s48 offen lds
v_accvgpr_read_b32 v24, a52
v_accvgpr_read_b32 v25, a53
v_accvgpr_read_b32 v26, a54
v_mfma_f32_16x16x32_bf16 a[124:127], a[184:187], a[252:255], a[124:127]
ds_read_b128 a[184:187], v3 offset:12288
v_accvgpr_read_b32 v27, a55
v_cvt_pk_bf16_f32 v116, v24, v25
v_cvt_pk_bf16_f32 v117, v26, v27
v_mfma_f32_16x16x32_bf16 a[128:131], v[28:31], a[224:227], a[128:131]
v_accvgpr_read_b32 v20, a56
v_accvgpr_read_b32 v21, a57
v_accvgpr_read_b32 v22, a58
v_accvgpr_read_b32 v23, a59
v_mfma_f32_16x16x32_bf16 a[132:135], v[28:31], a[228:231], a[132:135]
v_cvt_pk_bf16_f32 v120, v20, v21
v_cvt_pk_bf16_f32 v121, v22, v23
v_accvgpr_read_b32 v24, a60
v_accvgpr_read_b32 v25, a61
v_mfma_f32_16x16x32_bf16 a[136:139], v[28:31], a[232:235], a[136:139]
buffer_load_dword v15, v14, s[96:99], s100 offen
v_accvgpr_read_b32 v26, a62
v_accvgpr_read_b32 v27, a63
v_cvt_pk_bf16_f32 v124, v24, v25
v_mfma_f32_16x16x32_bf16 a[140:143], v[28:31], a[236:239], a[140:143]
s_add_u32 s100, s100, 16384
v_cvt_pk_bf16_f32 v125, v26, v27
v_mfma_f32_16x16x32_bf16 a[144:147], v[28:31], a[240:243], a[144:147]
v_mfma_f32_16x16x32_bf16 a[148:151], v[28:31], a[244:247], a[148:151]
v_mfma_f32_16x16x32_bf16 a[152:155], v[28:31], a[248:251], a[152:155]
v_mfma_f32_16x16x32_bf16 a[156:159], v[28:31], a[252:255], a[156:159]
s_cmp_lt_u32 s35, s45
s_cbranch_scc1 L_g_tile
s_branch L_g_end
L_g_first:
s_mov_b32 s100, 536870912
s_cmp_eq_u32 s61, 0
s_cbranch_scc0 L_g_end
v_mov_b32 v20, 128
s_mov_b32 s28, 0
L_poll_8:
buffer_load_dword v21, v20, s[56:59], 0 offen sc1
s_add_u32 s28, s28, 1
s_cmp_gt_u32 s28, 40000
s_cbranch_scc1 L_end
s_waitcnt vmcnt(0)
v_cmp_ne_u32 vcc, 8, v21
s_cbranch_vccz L_pd_9
s_sleep 1
s_branch L_poll_8
L_pd_9:
s_branch L_g_go
L_g_end:
v_bfe_u32 v16, v0, 3, 3
v_lshlrev_b32 v16, 4, v16
v_and_or_b32 v16, v0, 7, v16
v_bfe_u32 v17, v0, 4, 2
v_lshlrev_b32 v17, 5, v17
v_bfe_u32 v18, v0, 1, 3
v_or_b32 v17, v17, v18
v_and_b32 v18, 1, v0
v_lshl_or_b32 v17, v18, 4, v17
s_bitcmp1_b32 s50, 1
s_cselect_b64 vcc, -1, 0
s_movk_i32 s44, 0x80
v_cndmask_b32 v16, v16, v17, vcc
v_lshlrev_b32 v13, 4, v16
s_movk_i32 s92, 0x800
s_bitcmp1_b32 s50, 0
s_cselect_b32 s92, 0x4000, s92
s_xor_b32 s93, s92, 0x4800
s_sub_u32 s93, s93, s44
s_and_b32 s24, s17, s91
s_cbranch_scc0 L_g_h1
s_barrier
L_g_h1:
v_pk_mul_f32 v[20:21], v[160:161], s[94:95] op_sel_hi:[1,0]
v_pk_mul_f32 v[22:23], v[162:163], s[94:95] op_sel_hi:[1,0]
v_cvt_pk_bf16_f32 v32, v20, v21
v_cvt_pk_bf16_f32 v33, v22, v23
v_pk_mul_f32 v[20:21], v[192:193], s[94:95] op_sel_hi:[1,0]
v_pk_mul_f32 v[22:23], v[194:195], s[94:95] op_sel_hi:[1,0]
v_cvt_pk_bf16_f32 v34, v20, v21
v_cvt_pk_bf16_f32 v35, v22, v23
s_mov_b32 s60, s62
s_mov_b32 s29, s62
buffer_store_dwordx4 v[32:35], v13, s[8:11], s29 offen sc1
v_pk_mul_f32 v[24:25], v[164:165], s[94:95] op_sel_hi:[1,0]
v_pk_mul_f32 v[26:27], v[166:167], s[94:95] op_sel_hi:[1,0]
v_cvt_pk_bf16_f32 v36, v24, v25
v_cvt_pk_bf16_f32 v37, v26, v27
v_pk_mul_f32 v[24:25], v[196:197], s[94:95] op_sel_hi:[1,0]
v_pk_mul_f32 v[26:27], v[198:199], s[94:95] op_sel_hi:[1,0]
v_cvt_pk_bf16_f32 v38, v24, v25
v_cvt_pk_bf16_f32 v39, v26, v27
s_add_u32 s29, s29, s44
buffer_store_dwordx4 v[36:39], v13, s[8:11], s29 offen sc1
v_pk_mul_f32 v[20:21], v[168:169], s[94:95] op_sel_hi:[1,0]
v_pk_mul_f32 v[22:23], v[170:171], s[94:95] op_sel_hi:[1,0]
v_cvt_pk_bf16_f32 v40, v20, v21
v_cvt_pk_bf16_f32 v41, v22, v23
v_pk_mul_f32 v[20:21], v[200:201], s[94:95] op_sel_hi:[1,0]
v_pk_mul_f32 v[22:23], v[202:203], s[94:95] op_sel_hi:[1,0]
v_cvt_pk_bf16_f32 v42, v20, v21
v_cvt_pk_bf16_f32 v43, v22, v23
s_add_u32 s29, s29, s93
buffer_store_dwordx4 v[40:43], v13, s[8:11], s29 offen sc1
v_pk_mul_f32 v[24:25], v[172:173], s[94:95] op_sel_hi:[1,0]
v_pk_mul_f32 v[26:27], v[174:175], s[94:95] op_sel_hi:[1,0]
v_cvt_pk_bf16_f32 v44, v24, v25
v_cvt_pk_bf16_f32 v45, v26, v27
v_pk_mul_f32 v[24:25], v[204:205], s[94:95] op_sel_hi:[1,0]
v_pk_mul_f32 v[26:27], v[206:207], s[94:95] op_sel_hi:[1,0]
v_cvt_pk_bf16_f32 v46, v24, v25
v_cvt_pk_bf16_f32 v47, v26, v27
s_add_u32 s29, s29, s44
buffer_store_dwordx4 v[44:47], v13, s[8:11], s29 offen sc1
v_pk_mul_f32 v[20:21], v[176:177], s[94:95] op_sel_hi:[1,0]
v_pk_mul_f32 v[22:23], v[178:179], s[94:95] op_sel_hi:[1,0]
v_cvt_pk_bf16_f32 v48, v20, v21
v_cvt_pk_bf16_f32 v49, v22, v23
v_pk_mul_f32 v[20:21], v[208:209], s[94:95] op_sel_hi:[1,0]
v_pk_mul_f32 v[22:23], v[210:211], s[94:95] op_sel_hi:[1,0]
v_cvt_pk_bf16_f32 v50, v20, v21
v_cvt_pk_bf16_f32 v51, v22, v23
s_add_u32 s29, s29, s93
buffer_store_dwordx4 v[48:51], v13, s[8:11], s29 offen sc1
v_pk_mul_f32 v[24:25], v[180:181], s[94:95] op_sel_hi:[1,0]
v_pk_mul_f32 v[26:27], v[182:183], s[94:95] op_sel_hi:[1,0]
v_cvt_pk_bf16_f32 v52, v24, v25
v_cvt_pk_bf16_f32 v53, v26, v27
v_pk_mul_f32 v[24:25], v[212:213], s[94:95] op_sel_hi:[1,0]
v_pk_mul_f32 v[26:27], v[214:215], s[94:95] op_sel_hi:[1,0]
v_cvt_pk_bf16_f32 v54, v24, v25
v_cvt_pk_bf16_f32 v55, v26, v27
s_add_u32 s29, s29, s44
buffer_store_dwordx4 v[52:55], v13, s[8:11], s29 offen sc1
v_pk_mul_f32 v[20:21], v[184:185], s[94:95] op_sel_hi:[1,0]
v_pk_mul_f32 v[22:23], v[186:187], s[94:95] op_sel_hi:[1,0]
v_cvt_pk_bf16_f32 v56, v20, v21
v_cvt_pk_bf16_f32 v57, v22, v23
v_pk_mul_f32 v[20:21], v[216:217], s[94:95] op_sel_hi:[1,0]
v_pk_mul_f32 v[22:23], v[218:219], s[94:95] op_sel_hi:[1,0]
v_cvt_pk_bf16_f32 v58, v20, v21
v_cvt_pk_bf16_f32 v59, v22, v23
s_add_u32 s29, s29, s93
buffer_store_dwordx4 v[56:59], v13, s[8:11], s29 offen sc1
v_pk_mul_f32 v[24:25], v[188:189], s[94:95] op_sel_hi:[1,0]
v_pk_mul_f32 v[26:27], v[190:191], s[94:95] op_sel_hi:[1,0]
v_cvt_pk_bf16_f32 v60, v24, v25
v_cvt_pk_bf16_f32 v61, v26, v27
v_pk_mul_f32 v[24:25], v[220:221], s[94:95] op_sel_hi:[1,0]
v_pk_mul_f32 v[26:27], v[222:223], s[94:95] op_sel_hi:[1,0]
v_cvt_pk_bf16_f32 v62, v24, v25
v_cvt_pk_bf16_f32 v63, v26, v27
s_add_u32 s29, s29, s44
buffer_store_dwordx4 v[60:63], v13, s[8:11], s29 offen sc1
v_pk_mul_f32 v[20:21], v[224:225], s[94:95] op_sel_hi:[1,0]
v_pk_mul_f32 v[22:23], v[226:227], s[94:95] op_sel_hi:[1,0]
v_cvt_pk_bf16_f32 v64, v20, v21
v_cvt_pk_bf16_f32 v65, v22, v23
v_accvgpr_read_b32 v20, a0
v_accvgpr_read_b32 v21, a1
v_accvgpr_read_b32 v22, a2
v_accvgpr_read_b32 v23, a3
v_pk_mul_f32 v[20:21], v[20:21], s[94:95] op_sel_hi:[1,0]
v_pk_mul_f32 v[22:23], v[22:23], s[94:95] op_sel_hi:[1,0]
v_cvt_pk_bf16_f32 v66, v20, v21
v_cvt_pk_bf16_f32 v67, v22, v23
s_add_u32 s60, s60, s92
s_mov_b32 s29, s60
buffer_store_dwordx4 v[64:67], v13, s[8:11], s29 offen sc1
v_pk_mul_f32 v[24:25], v[228:229], s[94:95] op_sel_hi:[1,0]
v_pk_mul_f32 v[26:27], v[230:231], s[94:95] op_sel_hi:[1,0]
v_cvt_pk_bf16_f32 v68, v24, v25
v_cvt_pk_bf16_f32 v69, v26, v27
v_accvgpr_read_b32 v24, a4
v_accvgpr_read_b32 v25, a5
v_accvgpr_read_b32 v26, a6
v_accvgpr_read_b32 v27, a7
v_pk_mul_f32 v[24:25], v[24:25], s[94:95] op_sel_hi:[1,0]
v_pk_mul_f32 v[26:27], v[26:27], s[94:95] op_sel_hi:[1,0]
v_cvt_pk_bf16_f32 v70, v24, v25
v_cvt_pk_bf16_f32 v71, v26, v27
s_add_u32 s29, s29, s44
buffer_store_dwordx4 v[68:71], v13, s[8:11], s29 offen sc1
v_pk_mul_f32 v[20:21], v[232:233], s[94:95] op_sel_hi:[1,0]
v_pk_mul_f32 v[22:23], v[234:235], s[94:95] op_sel_hi:[1,0]
v_cvt_pk_bf16_f32 v72, v20, v21
v_cvt_pk_bf16_f32 v73, v22, v23
v_accvgpr_read_b32 v20, a8
v_accvgpr_read_b32 v21, a9
v_accvgpr_read_b32 v22, a10
v_accvgpr_read_b32 v23, a11
v_pk_mul_f32 v[20:21], v[20:21], s[94:95] op_sel_hi:[1,0]
v_pk_mul_f32 v[22:23], v[22:23], s[94:95] op_sel_hi:[1,0]
v_cvt_pk_bf16_f32 v74, v20, v21
v_cvt_pk_bf16_f32 v75, v22, v23
s_add_u32 s29, s29, s93
buffer_store_dwordx4 v[72:75], v13, s[8:11], s29 offen sc1
v_pk_mul_f32 v[24:25], v[236:237], s[94:95] op_sel_hi:[1,0]
v_pk_mul_f32 v[26:27], v[238:239], s[94:95] op_sel_hi:[1,0]
v_cvt_pk_bf16_f32 v76, v24, v25
v_cvt_pk_bf16_f32 v77, v26, v27
v_accvgpr_read_b32 v24, a12
v_accvgpr_read_b32 v25, a13
v_accvgpr_read_b32 v26, a14
v_accvgpr_read_b32 v27, a15
v_pk_mul_f32 v[24:25], v[24:25], s[94:95] op_sel_hi:[1,0]
v_pk_mul_f32 v[26:27], v[26:27], s[94:95] op_sel_hi:[1,0]
v_cvt_pk_bf16_f32 v78, v24, v25
v_cvt_pk_bf16_f32 v79, v26, v27
s_add_u32 s29, s29, s44
buffer_store_dwordx4 v[76:79], v13, s[8:11], s29 offen sc1
v_pk_mul_f32 v[20:21], v[240:241], s[94:95] op_sel_hi:[1,0]
v_pk_mul_f32 v[22:23], v[242:243], s[94:95] op_sel_hi:[1,0]
v_cvt_pk_bf16_f32 v80, v20, v21
v_cvt_pk_bf16_f32 v81, v22, v23
v_accvgpr_read_b32 v20, a16
v_accvgpr_read_b32 v21, a17
v_accvgpr_read_b32 v22, a18
v_accvgpr_read_b32 v23, a19
v_pk_mul_f32 v[20:21], v[20:21], s[94:95] op_sel_hi:[1,0]
v_pk_mul_f32 v[22:23], v[22:23], s[94:95] op_sel_hi:[1,0]
v_cvt_pk_bf16_f32 v82, v20, v21
v_cvt_pk_bf16_f32 v83, v22, v23
s_add_u32 s29, s29, s93
buffer_store_dwordx4 v[80:83], v13, s[8:11], s29 offen sc1
v_pk_mul_f32 v[24:25], v[244:245], s[94:95] op_sel_hi:[1,0]
v_pk_mul_f32 v[26:27], v[246:247], s[94:95] op_sel_hi:[1,0]
v_cvt_pk_bf16_f32 v84, v24, v25
v_cvt_pk_bf16_f32 v85, v26, v27
v_accvgpr_read_b32 v24, a20
v_accvgpr_read_b32 v25, a21
v_accvgpr_read_b32 v26, a22
v_accvgpr_read_b32 v27, a23
v_pk_mul_f32 v[24:25], v[24:25], s[94:95] op_sel_hi:[1,0]
v_pk_mul_f32 v[26:27], v[26:27], s[94:95] op_sel_hi:[1,0]
v_cvt_pk_bf16_f32 v86, v24, v25
v_cvt_pk_bf16_f32 v87, v26, v27
s_add_u32 s29, s29, s44
buffer_store_dwordx4 v[84:87], v13, s[8:11], s29 offen sc1
v_pk_mul_f32 v[20:21], v[248:249], s[94:95] op_sel_hi:[1,0]
v_pk_mul_f32 v[22:23], v[250:251], s[94:95] op_sel_hi:[1,0]
v_cvt_pk_bf16_f32 v88, v20, v21
v_cvt_pk_bf16_f32 v89, v22, v23
v_accvgpr_read_b32 v20, a24
v_accvgpr_read_b32 v21, a25
v_accvgpr_read_b32 v22, a26
v_accvgpr_read_b32 v23, a27
v_pk_mul_f32 v[20:21], v[20:21], s[94:95] op_sel_hi:[1,0]
v_pk_mul_f32 v[22:23], v[22:23], s[94:95] op_sel_hi:[1,0]
v_cvt_pk_bf16_f32 v90, v20, v21
v_cvt_pk_bf16_f32 v91, v22, v23
s_add_u32 s29, s29, s93
buffer_store_dwordx4 v[88:91], v13, s[8:11], s29 offen sc1
v_pk_mul_f32 v[24:25], v[252:253], s[94:95] op_sel_hi:[1,0]
v_pk_mul_f32 v[26:27], v[254:255], s[94:95] op_sel_hi:[1,0]
v_cvt_pk_bf16_f32 v92, v24, v25
v_cvt_pk_bf16_f32 v93, v26, v27
v_accvgpr_read_b32 v24, a28
v_accvgpr_read_b32 v25, a29
v_accvgpr_read_b32 v26, a30
v_accvgpr_read_b32 v27, a31
v_pk_mul_f32 v[24:25], v[24:25], s[94:95] op_sel_hi:[1,0]
v_pk_mul_f32 v[26:27], v[26:27], s[94:95] op_sel_hi:[1,0]
v_cvt_pk_bf16_f32 v94, v24, v25
v_cvt_pk_bf16_f32 v95, v26, v27
s_add_u32 s29, s29, s44
buffer_store_dwordx4 v[92:95], v13, s[8:11], s29 offen sc1
v_accvgpr_read_b32 v20, a32
v_accvgpr_read_b32 v21, a33
v_accvgpr_read_b32 v22, a34
v_accvgpr_read_b32 v23, a35
v_pk_mul_f32 v[20:21], v[20:21], s[94:95] op_sel_hi:[1,0]
v_pk_mul_f32 v[22:23], v[22:23], s[94:95] op_sel_hi:[1,0]
v_cvt_pk_bf16_f32 v96, v20, v21
v_cvt_pk_bf16_f32 v97, v22, v23
v_accvgpr_read_b32 v20, a64
v_accvgpr_read_b32 v21, a65
v_accvgpr_read_b32 v22, a66
v_accvgpr_read_b32 v23, a67
v_pk_mul_f32 v[20:21], v[20:21], s[94:95] op_sel_hi:[1,0]
v_pk_mul_f32 v[22:23], v[22:23], s[94:95] op_sel_hi:[1,0]
v_cvt_pk_bf16_f32 v98, v20, v21
v_cvt_pk_bf16_f32 v99, v22, v23
s_add_u32 s60, s60, s92
s_mov_b32 s29, s60
buffer_store_dwordx4 v[96:99], v13, s[8:11], s29 offen sc1
v_accvgpr_read_b32 v24, a36
v_accvgpr_read_b32 v25, a37
v_accvgpr_read_b32 v26, a38
v_accvgpr_read_b32 v27, a39
v_pk_mul_f32 v[24:25], v[24:25], s[94:95] op_sel_hi:[1,0]
v_pk_mul_f32 v[26:27], v[26:27], s[94:95] op_sel_hi:[1,0]
v_cvt_pk_bf16_f32 v100, v24, v25
v_cvt_pk_bf16_f32 v101, v26, v27
v_accvgpr_read_b32 v24, a68
v_accvgpr_read_b32 v25, a69
v_accvgpr_read_b32 v26, a70
v_accvgpr_read_b32 v27, a71
v_pk_mul_f32 v[24:25], v[24:25], s[94:95] op_sel_hi:[1,0]
v_pk_mul_f32 v[26:27], v[26:27], s[94:95] op_sel_hi:[1,0]
v_cvt_pk_bf16_f32 v102, v24, v25
v_cvt_pk_bf16_f32 v103, v26, v27
s_add_u32 s29, s29, s44
buffer_store_dwordx4 v[100:103], v13, s[8:11], s29 offen sc1
v_accvgpr_read_b32 v20, a40
v_accvgpr_read_b32 v21, a41
v_accvgpr_read_b32 v22, a42
v_accvgpr_read_b32 v23, a43
v_pk_mul_f32 v[20:21], v[20:21], s[94:95] op_sel_hi:[1,0]
v_pk_mul_f32 v[22:23], v[22:23], s[94:95] op_sel_hi:[1,0]
v_cvt_pk_bf16_f32 v104, v20, v21
v_cvt_pk_bf16_f32 v105, v22, v23
v_accvgpr_read_b32 v20, a72
v_accvgpr_read_b32 v21, a73
v_accvgpr_read_b32 v22, a74
v_accvgpr_read_b32 v23, a75
v_pk_mul_f32 v[20:21], v[20:21], s[94:95] op_sel_hi:[1,0]
v_pk_mul_f32 v[22:23], v[22:23], s[94:95] op_sel_hi:[1,0]
v_cvt_pk_bf16_f32 v106, v20, v21
v_cvt_pk_bf16_f32 v107, v22, v23
s_add_u32 s29, s29, s93
buffer_store_dwordx4 v[104:107], v13, s[8:11], s29 offen sc1
v_accvgpr_read_b32 v24, a44
v_accvgpr_read_b32 v25, a45
v_accvgpr_read_b32 v26, a46
v_accvgpr_read_b32 v27, a47
v_pk_mul_f32 v[24:25], v[24:25], s[94:95] op_sel_hi:[1,0]
v_pk_mul_f32 v[26:27], v[26:27], s[94:95] op_sel_hi:[1,0]
v_cvt_pk_bf16_f32 v108, v24, v25
v_cvt_pk_bf16_f32 v109, v26, v27
v_accvgpr_read_b32 v24, a76
v_accvgpr_read_b32 v25, a77
v_accvgpr_read_b32 v26, a78
v_accvgpr_read_b32 v27, a79
v_pk_mul_f32 v[24:25], v[24:25], s[94:95] op_sel_hi:[1,0]
v_pk_mul_f32 v[26:27], v[26:27], s[94:95] op_sel_hi:[1,0]
v_cvt_pk_bf16_f32 v110, v24, v25
v_cvt_pk_bf16_f32 v111, v26, v27
s_add_u32 s29, s29, s44
buffer_store_dwordx4 v[108:111], v13, s[8:11], s29 offen sc1
v_accvgpr_read_b32 v20, a48
v_accvgpr_read_b32 v21, a49
v_accvgpr_read_b32 v22, a50
v_accvgpr_read_b32 v23, a51
v_pk_mul_f32 v[20:21], v[20:21], s[94:95] op_sel_hi:[1,0]
v_pk_mul_f32 v[22:23], v[22:23], s[94:95] op_sel_hi:[1,0]
v_cvt_pk_bf16_f32 v112, v20, v21
v_cvt_pk_bf16_f32 v113, v22, v23
v_accvgpr_read_b32 v20, a80
v_accvgpr_read_b32 v21, a81
v_accvgpr_read_b32 v22, a82
v_accvgpr_read_b32 v23, a83
v_pk_mul_f32 v[20:21], v[20:21], s[94:95] op_sel_hi:[1,0]
v_pk_mul_f32 v[22:23], v[22:23], s[94:95] op_sel_hi:[1,0]
v_cvt_pk_bf16_f32 v114, v20, v21
v_cvt_pk_bf16_f32 v115, v22, v23
s_add_u32 s29, s29, s93
buffer_store_dwordx4 v[112:115], v13, s[8:11], s29 offen sc1
v_accvgpr_read_b32 v24, a52
v_accvgpr_read_b32 v25, a53
v_accvgpr_read_b32 v26, a54
v_accvgpr_read_b32 v27, a55
v_pk_mul_f32 v[24:25], v[24:25], s[94:95] op_sel_hi:[1,0]
v_pk_mul_f32 v[26:27], v[26:27], s[94:95] op_sel_hi:[1,0]
v_cvt_pk_bf16_f32 v116, v24, v25
v_cvt_pk_bf16_f32 v117, v26, v27
v_accvgpr_read_b32 v24, a84
v_accvgpr_read_b32 v25, a85
v_accvgpr_read_b32 v26, a86
v_accvgpr_read_b32 v27, a87
v_pk_mul_f32 v[24:25], v[24:25], s[94:95] op_sel_hi:[1,0]
v_pk_mul_f32 v[26:27], v[26:27], s[94:95] op_sel_hi:[1,0]
v_cvt_pk_bf16_f32 v118, v24, v25
v_cvt_pk_bf16_f32 v119, v26, v27
s_add_u32 s29, s29, s44
buffer_store_dwordx4 v[116:119], v13, s[8:11], s29 offen sc1
v_accvgpr_read_b32 v20, a56
v_accvgpr_read_b32 v21, a57
v_accvgpr_read_b32 v22, a58
v_accvgpr_read_b32 v23, a59
v_pk_mul_f32 v[20:21], v[20:21], s[94:95] op_sel_hi:[1,0]
v_pk_mul_f32 v[22:23], v[22:23], s[94:95] op_sel_hi:[1,0]
v_cvt_pk_bf16_f32 v120, v20, v21
v_cvt_pk_bf16_f32 v121, v22, v23
v_accvgpr_read_b32 v20, a88
v_accvgpr_read_b32 v21, a89
v_accvgpr_read_b32 v22, a90
v_accvgpr_read_b32 v23, a91
v_pk_mul_f32 v[20:21], v[20:21], s[94:95] op_sel_hi:[1,0]
v_pk_mul_f32 v[22:23], v[22:23], s[94:95] op_sel_hi:[1,0]
v_cvt_pk_bf16_f32 v122, v20, v21
v_cvt_pk_bf16_f32 v123, v22, v23
s_add_u32 s29, s29, s93
buffer_store_dwordx4 v[120:123], v13, s[8:11], s29 offen sc1
v_accvgpr_read_b32 v24, a60
v_accvgpr_read_b32 v25, a61
v_accvgpr_read_b32 v26, a62
v_accvgpr_read_b32 v27, a63
v_pk_mul_f32 v[24:25], v[24:25], s[94:95] op_sel_hi:[1,0]
v_pk_mul_f32 v[26:27], v[26:27], s[94:95] op_sel_hi:[1,0]
v_cvt_pk_bf16_f32 v124, v24, v25
v_cvt_pk_bf16_f32 v125, v26, v27
v_accvgpr_read_b32 v24, a92
v_accvgpr_read_b32 v25, a93
v_accvgpr_read_b32 v26, a94
v_accvgpr_read_b32 v27, a95
v_pk_mul_f32 v[24:25], v[24:25], s[94:95] op_sel_hi:[1,0]
v_pk_mul_f32 v[26:27], v[26:27], s[94:95] op_sel_hi:[1,0]
v_cvt_pk_bf16_f32 v126, v24, v25
v_cvt_pk_bf16_f32 v127, v26, v27
s_add_u32 s29, s29, s44
buffer_store_dwordx4 v[124:127], v13, s[8:11], s29 offen sc1
v_accvgpr_read_b32 v20, a96
v_accvgpr_read_b32 v21, a97
v_accvgpr_read_b32 v22, a98
v_accvgpr_read_b32 v23, a99
v_pk_mul_f32 v[20:21], v[20:21], s[94:95] op_sel_hi:[1,0]
v_pk_mul_f32 v[22:23], v[22:23], s[94:95] op_sel_hi:[1,0]
v_cvt_pk_bf16_f32 v128, v20, v21
v_cvt_pk_bf16_f32 v129, v22, v23
v_accvgpr_read_b32 v20, a128
v_accvgpr_read_b32 v21, a129
v_accvgpr_read_b32 v22, a130
v_accvgpr_read_b32 v23, a131
v_pk_mul_f32 v[20:21], v[20:21], s[94:95] op_sel_hi:[1,0]
v_pk_mul_f32 v[22:23], v[22:23], s[94:95] op_sel_hi:[1,0]
v_cvt_pk_bf16_f32 v130, v20, v21
v_cvt_pk_bf16_f32 v131, v22, v23
s_add_u32 s60, s60, s92
s_mov_b32 s29, s60
buffer_store_dwordx4 v[128:131], v13, s[8:11], s29 offen sc1
v_accvgpr_read_b32 v24, a100
v_accvgpr_read_b32 v25, a101
v_accvgpr_read_b32 v26, a102
v_accvgpr_read_b32 v27, a103
v_pk_mul_f32 v[24:25], v[24:25], s[94:95] op_sel_hi:[1,0]
v_pk_mul_f32 v[26:27], v[26:27], s[94:95] op_sel_hi:[1,0]
v_cvt_pk_bf16_f32 v132, v24, v25
v_cvt_pk_bf16_f32 v133, v26, v27
v_accvgpr_read_b32 v24, a132
v_accvgpr_read_b32 v25, a133
v_accvgpr_read_b32 v26, a134
v_accvgpr_read_b32 v27, a135
v_pk_mul_f32 v[24:25], v[24:25], s[94:95] op_sel_hi:[1,0]
v_pk_mul_f32 v[26:27], v[26:27], s[94:95] op_sel_hi:[1,0]
v_cvt_pk_bf16_f32 v134, v24, v25
v_cvt_pk_bf16_f32 v135, v26, v27
s_add_u32 s29, s29, s44
buffer_store_dwordx4 v[132:135], v13, s[8:11], s29 offen sc1
v_accvgpr_read_b32 v20, a104
v_accvgpr_read_b32 v21, a105
v_accvgpr_read_b32 v22, a106
v_accvgpr_read_b32 v23, a107
v_pk_mul_f32 v[20:21], v[20:21], s[94:95] op_sel_hi:[1,0]
v_pk_mul_f32 v[22:23], v[22:23], s[94:95] op_sel_hi:[1,0]
v_cvt_pk_bf16_f32 v136, v20, v21
v_cvt_pk_bf16_f32 v137, v22, v23
v_accvgpr_read_b32 v20, a136
v_accvgpr_read_b32 v21, a137
v_accvgpr_read_b32 v22, a138
v_accvgpr_read_b32 v23, a139
v_pk_mul_f32 v[20:21], v[20:21], s[94:95] op_sel_hi:[1,0]
v_pk_mul_f32 v[22:23], v[22:23], s[94:95] op_sel_hi:[1,0]
v_cvt_pk_bf16_f32 v138, v20, v21
v_cvt_pk_bf16_f32 v139, v22, v23
s_add_u32 s29, s29, s93
buffer_store_dwordx4 v[136:139], v13, s[8:11], s29 offen sc1
v_accvgpr_read_b32 v24, a108
v_accvgpr_read_b32 v25, a109
v_accvgpr_read_b32 v26, a110
v_accvgpr_read_b32 v27, a111
v_pk_mul_f32 v[24:25], v[24:25], s[94:95] op_sel_hi:[1,0]
v_pk_mul_f32 v[26:27], v[26:27], s[94:95] op_sel_hi:[1,0]
v_cvt_pk_bf16_f32 v140, v24, v25
v_cvt_pk_bf16_f32 v141, v26, v27
v_accvgpr_read_b32 v24, a140
v_accvgpr_read_b32 v25, a141
v_accvgpr_read_b32 v26, a142
v_accvgpr_read_b32 v27, a143
v_pk_mul_f32 v[24:25], v[24:25], s[94:95] op_sel_hi:[1,0]
v_pk_mul_f32 v[26:27], v[26:27], s[94:95] op_sel_hi:[1,0]
v_cvt_pk_bf16_f32 v142, v24, v25
v_cvt_pk_bf16_f32 v143, v26, v27
s_add_u32 s29, s29, s44
buffer_store_dwordx4 v[140:143], v13, s[8:11], s29 offen sc1
v_accvgpr_read_b32 v20, a112
v_accvgpr_read_b32 v21, a113
v_accvgpr_read_b32 v22, a114
v_accvgpr_read_b32 v23, a115
v_pk_mul_f32 v[20:21], v[20:21], s[94:95] op_sel_hi:[1,0]
v_pk_mul_f32 v[22:23], v[22:23], s[94:95] op_sel_hi:[1,0]
v_cvt_pk_bf16_f32 v144, v20, v21
v_cvt_pk_bf16_f32 v145, v22, v23
v_accvgpr_read_b32 v20, a144
v_accvgpr_read_b32 v21, a145
v_accvgpr_read_b32 v22, a146
v_accvgpr_read_b32 v23, a147
v_pk_mul_f32 v[20:21], v[20:21], s[94:95] op_sel_hi:[1,0]
v_pk_mul_f32 v[22:23], v[22:23], s[94:95] op_sel_hi:[1,0]
v_cvt_pk_bf16_f32 v146, v20, v21
v_cvt_pk_bf16_f32 v147, v22, v23
s_add_u32 s29, s29, s93
buffer_store_dwordx4 v[144:147], v13, s[8:11], s29 offen sc1
v_accvgpr_read_b32 v24, a116
v_accvgpr_read_b32 v25, a117
v_accvgpr_read_b32 v26, a118
v_accvgpr_read_b32 v27, a119
v_pk_mul_f32 v[24:25], v[24:25], s[94:95] op_sel_hi:[1,0]
v_pk_mul_f32 v[26:27], v[26:27], s[94:95] op_sel_hi:[1,0]
v_cvt_pk_bf16_f32 v148, v24, v25
v_cvt_pk_bf16_f32 v149, v26, v27
v_accvgpr_read_b32 v24, a148
v_accvgpr_read_b32 v25, a149
v_accvgpr_read_b32 v26, a150
v_accvgpr_read_b32 v27, a151
v_pk_mul_f32 v[24:25], v[24:25], s[94:95] op_sel_hi:[1,0]
v_pk_mul_f32 v[26:27], v[26:27], s[94:95] op_sel_hi:[1,0]
v_cvt_pk_bf16_f32 v150, v24, v25
v_cvt_pk_bf16_f32 v151, v26, v27
s_add_u32 s29, s29, s44
buffer_store_dwordx4 v[148:151], v13, s[8:11], s29 offen sc1
v_accvgpr_read_b32 v20, a120
v_accvgpr_read_b32 v21, a121
v_accvgpr_read_b32 v22, a122
v_accvgpr_read_b32 v23, a123
v_pk_mul_f32 v[20:21], v[20:21], s[94:95] op_sel_hi:[1,0]
v_pk_mul_f32 v[22:23], v[22:23], s[94:95] op_sel_hi:[1,0]
v_cvt_pk_bf16_f32 v152, v20, v21
v_cvt_pk_bf16_f32 v153, v22, v23
v_accvgpr_read_b32 v20, a152
v_accvgpr_read_b32 v21, a153
v_accvgpr_read_b32 v22, a154
v_accvgpr_read_b32 v23, a155
v_pk_mul_f32 v[20:21], v[20:21], s[94:95] op_sel_hi:[1,0]
v_pk_mul_f32 v[22:23], v[22:23], s[94:95] op_sel_hi:[1,0]
v_cvt_pk_bf16_f32 v154, v20, v21
v_cvt_pk_bf16_f32 v155, v22, v23
s_add_u32 s29, s29, s93
buffer_store_dwordx4 v[152:155], v13, s[8:11], s29 offen sc1
v_accvgpr_read_b32 v24, a124
v_accvgpr_read_b32 v25, a125
v_accvgpr_read_b32 v26, a126
v_accvgpr_read_b32 v27, a127
v_pk_mul_f32 v[24:25], v[24:25], s[94:95] op_sel_hi:[1,0]
v_pk_mul_f32 v[26:27], v[26:27], s[94:95] op_sel_hi:[1,0]
v_cvt_pk_bf16_f32 v156, v24, v25
v_cvt_pk_bf16_f32 v157, v26, v27
v_accvgpr_read_b32 v24, a156
v_accvgpr_read_b32 v25, a157
v_accvgpr_read_b32 v26, a158
v_accvgpr_read_b32 v27, a159
v_pk_mul_f32 v[24:25], v[24:25], s[94:95] op_sel_hi:[1,0]
v_pk_mul_f32 v[26:27], v[26:27], s[94:95] op_sel_hi:[1,0]
v_cvt_pk_bf16_f32 v158, v24, v25
v_cvt_pk_bf16_f32 v159, v26, v27
s_add_u32 s29, s29, s44
buffer_store_dwordx4 v[156:159], v13, s[8:11], s29 offen sc1
v_mov_b32 v20, 128
s_mov_b32 s28, 0
L_poll_10:
buffer_load_dword v21, v20, s[56:59], 0 offen sc1
s_add_u32 s28, s28, 1
s_cmp_gt_u32 s28, 40000
s_cbranch_scc1 L_end
s_waitcnt vmcnt(0)
v_cmp_ne_u32 vcc, 8, v21
s_cbranch_vccz L_pd_11
s_sleep 1
s_branch L_poll_10
L_pd_11:
s_andn2_b32 s24, s91, s17
s_cbranch_scc0 L_g_h2
s_barrier
s_add_u32 s60, s63, 32
v_mov_b32 v16, 0
v_mov_b32 v17, 1
s_cmp_eq_u32 s17, 0
s_cselect_b32 s29, s60, 536870912
s_mov_b64 exec, 1
buffer_store_dword v17, v16, s[8:11], s29 offen sc1
s_mov_b64 exec, -1
L_g_h2:
s_waitcnt vmcnt(0) lgkmcnt(0)
s_barrier
v_mov_b32 v16, 0
v_mov_b32 v17, 1
s_cmp_eq_u32 s17, 0
s_cselect_b32 s29, s63, 536870912
s_mov_b64 exec, 1
buffer_store_dword v17, v16, s[8:11], s29 offen sc1
s_mov_b64 exec, -1
s_mov_b32 s62, 536870912
s_mov_b32 s63, 536870912
s_cmp_lt_u32 s35, s45
s_cbranch_scc1 L_g_go
s_cmp_eq_u32 s3, 1
s_cbranch_scc1 L_part
s_cmp_eq_u32 s61, 1
s_cbranch_scc1 L_bdie
s_sub_u32 s24, s3, 4
s_lshl_b32 s24, s24, 3
s_lshr_b32 s42, s16, 2
s_add_u32 s42, s42, s24
s_and_b32 s62, s16, 3
s_mov_b32 s40, 0x3e0293ee
s_mov_b32 s50, 0xf149f2ca
s_mov_b32 s51, 0x41a00000
v_and_b32 v20, 7, v0
v_lshlrev_b32 v20, 2, v20
v_bfe_u32 v21, v0, 3, 1
s_lshl_b32 s25, s42, 7
s_add_u32 s25, s25, 111165440
s_lshr_b32 s24, s42, 1
s_lshl_b32 s24, s24, 7
s_add_u32 s24, s24, 111173632
s_sub_u32 s24, s24, s25
v_mad_u32_u24 v20, v21, s24, v20
s_mov_b32 s28, 0
L_poll_12:
buffer_load_dword v21, v20, s[8:11], s25 offen sc1
s_add_u32 s28, s28, 1
s_cmp_gt_u32 s28, 40000
s_cbranch_scc1 L_end
s_waitcnt vmcnt(0)
v_cmp_ne_u32 vcc, 1, v21
s_cbranch_vccz L_pd_13
s_sleep 1
s_branch L_poll_12
L_pd_13:
s_sub_u32 s41, 7, s62
s_mov_b32 s60, 0
L_aat:
v_and_b32 v5, 31, v0
v_bfe_u32 v26, v0, 5, 1
v_lshlrev_b32 v27, 2, v26
v_sub_u32 v5, v5, v27
v_bfe_u32 v27, v0, 4, 1
v_lshlrev_b32 v6, 17, v27
v_lshl_add_u32 v6, v26, 8, v6
v_and_b32 v27, 15, v0
v_lshl_add_u32 v6, v27, 4, v6
v_and_b32 v2, 63, v0
v_lshlrev_b32 v2, 4, v2
s_lshl_b32 s24, s17, 13
v_add_u32 v1, s24, v2
v_add_u32 v3, 32768, v2
v_mov_b32 v4, v2
s_lshl_b32 s46, s42, 20
s_add_u32 s46, s46, 0
s_mov_b32 s47, s24
s_lshl_b32 s44, s41, 2
s_add_u32 s45, s44, 4
s_add_u32 s44, s44, s17
s_mov_b32 s43, 0
s_mov_b32 s48, 0
s_mov_b32 s54, s50
s_mov_b32 s55, s50
s_barrier
s_lshr_b32 s26, s42, 1
s_lshl_b32 s26, s26, 6
s_lshl_b32 s27, s44, 1
s_add_u32 s26, s26, s27
s_lshl_b32 s26, s26, 1
s_and_b32 s27, s42, 1
s_add_u32 s26, s26, s27
s_lshl_b32 s26, s26, 13
s_add_u32 s26, s26, 117440512
s_add_u32 s27, s26, 0
buffer_load_dwordx4 a[0:3], v2, s[8:11], s27 offen offset:0 sc1
buffer_load_dwordx4 a[4:7], v2, s[8:11], s27 offen offset:1024 sc1
buffer_load_dwordx4 a[8:11], v2, s[8:11], s27 offen offset:2048 sc1
buffer_load_dwordx4 a[12:15], v2, s[8:11], s27 offen offset:3072 sc1
s_add_u32 s27, s26, 4096
buffer_load_dwordx4 a[16:19], v2, s[8:11], s27 offen offset:0 sc1
buffer_load_dwordx4 a[20:23], v2, s[8:11], s27 offen offset:1024 sc1
buffer_load_dwordx4 a[24:27], v2, s[8:11], s27 offen offset:2048 sc1
buffer_load_dwordx4 a[28:31], v2, s[8:11], s27 offen offset:3072 sc1
s_add_u32 s27, s26, 16384
buffer_load_dwordx4 a[32:35], v2, s[8:11], s27 offen offset:0 sc1
buffer_load_dwordx4 a[36:39], v2, s[8:11], s27 offen offset:1024 sc1
buffer_load_dwordx4 a[40:43], v2, s[8:11], s27 offen offset:2048 sc1
buffer_load_dwordx4 a[44:47], v2, s[8:11], s27 offen offset:3072 sc1
s_add_u32 s27, s26, 20480
buffer_load_dwordx4 a[48:51], v2, s[8:11], s27 offen offset:0 sc1
buffer_load_dwordx4 a[52:55], v2, s[8:11], s27 offen offset:1024 sc1
buffer_load_dwordx4 a[56:59], v2, s[8:11], s27 offen offset:2048 sc1
buffer_load_dwordx4 a[60:63], v2, s[8:11], s27 offen offset:3072 sc1
s_mov_b32 m0, s47
s_add_u32 s24, s46, 4096
buffer_load_dwordx4 v1, s[8:11], s46 offen offset:0 sc1 lds
buffer_load_dwordx4 v1, s[8:11], s46 offen offset:1024 sc1 lds
buffer_load_dwordx4 v1, s[8:11], s46 offen offset:2048 sc1 lds
buffer_load_dwordx4 v1, s[8:11], s46 offen offset:3072 sc1 lds
s_add_u32 m0, s47, 4096
s_nop 0
buffer_load_dwordx4 v1, s[8:11], s24 offen offset:0 sc1 lds
buffer_load_dwordx4 v1, s[8:11], s24 offen offset:1024 sc1 lds
buffer_load_dwordx4 v1, s[8:11], s24 offen offset:2048 sc1 lds
buffer_load_dwordx4 v1, s[8:11], s24 offen offset:3072 sc1 lds
s_add_u32 s46, s46, 32768
s_add_u32 s47, s47, 32768
s_and_b32 s47, s47, 131071
s_mov_b32 m0, s47
s_add_u32 s24, s46, 4096
buffer_load_dwordx4 v1, s[8:11], s46 offen offset:0 sc1 lds
buffer_load_dwordx4 v1, s[8:11], s46 offen offset:1024 sc1 lds
buffer_load_dwordx4 v1, s[8:11], s46 offen offset:2048 sc1 lds
buffer_load_dwordx4 v1, s[8:11], s46 offen offset:3072 sc1 lds
s_add_u32 m0, s47, 4096
s_nop 0
buffer_load_dwordx4 v1, s[8:11], s24 offen offset:0 sc1 lds
buffer_load_dwordx4 v1, s[8:11], s24 offen offset:1024 sc1 lds
buffer_load_dwordx4 v1, s[8:11], s24 offen offset:2048 sc1 lds
buffer_load_dwordx4 v1, s[8:11], s24 offen offset:3072 sc1 lds
s_add_u32 s46, s46, 32768
s_add_u32 s47, s47, 32768
s_and_b32 s47, s47, 131071
s_mov_b32 m0, s47
s_add_u32 s24, s46, 4096
buffer_load_dwordx4 v1, s[8:11], s46 offen offset:0 sc1 lds
buffer_load_dwordx4 v1, s[8:11], s46 offen offset:1024 sc1 lds
buffer_load_dwordx4 v1, s[8:11], s46 offen offset:2048 sc1 lds
buffer_load_dwordx4 v1, s[8:11], s46 offen offset:3072 sc1 lds
s_add_u32 m0, s47, 4096
s_nop 0
buffer_load_dwordx4 v1, s[8:11], s24 offen offset:0 sc1 lds
buffer_load_dwordx4 v1, s[8:11], s24 offen offset:1024 sc1 lds
buffer_load_dwordx4 v1, s[8:11], s24 offen offset:2048 sc1 lds
buffer_load_dwordx4 v1, s[8:11], s24 offen offset:3072 sc1 lds
s_add_u32 s46, s46, 32768
s_add_u32 s47, s47, 32768
s_and_b32 s47, s47, 131071
v_accvgpr_write_b32 a96, 0
v_accvgpr_write_b32 a97, 0
v_accvgpr_write_b32 a98, 0
v_accvgpr_write_b32 a99, 0
v_accvgpr_write_b32 a100, 0
v_accvgpr_write_b32 a101, 0
v_accvgpr_write_b32 a102, 0
v_accvgpr_write_b32 a103, 0
v_accvgpr_write_b32 a104, 0
v_accvgpr_write_b32 a105, 0
v_accvgpr_write_b32 a106, 0
v_accvgpr_write_b32 a107, 0
v_accvgpr_write_b32 a108, 0
v_accvgpr_write_b32 a109, 0
v_accvgpr_write_b32 a110, 0
v_accvgpr_write_b32 a111, 0
v_accvgpr_write_b32 a112, 0
v_accvgpr_write_b32 a113, 0
v_accvgpr_write_b32 a114, 0
v_accvgpr_write_b32 a115, 0
v_accvgpr_write_b32 a116, 0
v_accvgpr_write_b32 a117, 0
v_accvgpr_write_b32 a118, 0
v_accvgpr_write_b32 a119, 0
v_accvgpr_write_b32 a120, 0
v_accvgpr_write_b32 a121, 0
v_accvgpr_write_b32 a122, 0
v_accvgpr_write_b32 a123, 0
v_accvgpr_write_b32 a124, 0
v_accvgpr_write_b32 a125, 0
v_accvgpr_write_b32 a126, 0
v_accvgpr_write_b32 a127, 0
v_accvgpr_write_b32 a128, 0
v_accvgpr_write_b32 a129, 0
v_accvgpr_write_b32 a130, 0
v_accvgpr_write_b32 a131, 0
v_accvgpr_write_b32 a132, 0
v_accvgpr_write_b32 a133, 0
v_accvgpr_write_b32 a134, 0
v_accvgpr_write_b32 a135, 0
v_accvgpr_write_b32 a136, 0
v_accvgpr_write_b32 a137, 0
v_accvgpr_write_b32 a138, 0
v_accvgpr_write_b32 a139, 0
v_accvgpr_write_b32 a140, 0
v_accvgpr_write_b32 a141, 0
v_accvgpr_write_b32 a142, 0
v_accvgpr_write_b32 a143, 0
v_accvgpr_write_b32 a144, 0
v_accvgpr_write_b32 a145, 0
v_accvgpr_write_b32 a146, 0
v_accvgpr_write_b32 a147, 0
v_accvgpr_write_b32 a148, 0
v_accvgpr_write_b32 a149, 0
v_accvgpr_write_b32 a150, 0
v_accvgpr_write_b32 a151, 0
v_accvgpr_write_b32 a152, 0
v_accvgpr_write_b32 a153, 0
v_accvgpr_write_b32 a154, 0
v_accvgpr_write_b32 a155, 0
v_accvgpr_write_b32 a156, 0
v_accvgpr_write_b32 a157, 0
v_accvgpr_write_b32 a158, 0
v_accvgpr_write_b32 a159, 0
v_accvgpr_write_b32 a160, 0
v_accvgpr_write_b32 a161, 0
v_accvgpr_write_b32 a162, 0
v_accvgpr_write_b32 a163, 0
v_accvgpr_write_b32 a164, 0
v_accvgpr_write_b32 a165, 0
v_accvgpr_write_b32 a166, 0
v_accvgpr_write_b32 a167, 0
v_accvgpr_write_b32 a168, 0
v_accvgpr_write_b32 a169, 0
v_accvgpr_write_b32 a170, 0
v_accvgpr_write_b32 a171, 0
v_accvgpr_write_b32 a172, 0
v_accvgpr_write_b32 a173, 0
v_accvgpr_write_b32 a174, 0
v_accvgpr_write_b32 a175, 0
v_accvgpr_write_b32 a176, 0
v_accvgpr_write_b32 a177, 0
v_accvgpr_write_b32 a178, 0
v_accvgpr_write_b32 a179, 0
v_accvgpr_write_b32 a180, 0
v_accvgpr_write_b32 a181, 0
v_accvgpr_write_b32 a182, 0
v_accvgpr_write_b32 a183, 0
v_accvgpr_write_b32 a184, 0
v_accvgpr_write_b32 a185, 0
v_accvgpr_write_b32 a186, 0
v_accvgpr_write_b32 a187, 0
v_accvgpr_write_b32 a188, 0
v_accvgpr_write_b32 a189, 0
v_accvgpr_write_b32 a190, 0
v_accvgpr_write_b32 a191, 0
v_accvgpr_write_b32 a192, 0
v_accvgpr_write_b32 a193, 0
v_accvgpr_write_b32 a194, 0
v_accvgpr_write_b32 a195, 0
v_accvgpr_write_b32 a196, 0
v_accvgpr_write_b32 a197, 0
v_accvgpr_write_b32 a198, 0
v_accvgpr_write_b32 a199, 0
v_accvgpr_write_b32 a200, 0
v_accvgpr_write_b32 a201, 0
v_accvgpr_write_b32 a202, 0
v_accvgpr_write_b32 a203, 0
v_accvgpr_write_b32 a204, 0
v_accvgpr_write_b32 a205, 0
v_accvgpr_write_b32 a206, 0
v_accvgpr_write_b32 a207, 0
v_accvgpr_write_b32 a208, 0
v_accvgpr_write_b32 a209, 0
v_accvgpr_write_b32 a210, 0
v_accvgpr_write_b32 a211, 0
v_accvgpr_write_b32 a212, 0
v_accvgpr_write_b32 a213, 0
v_accvgpr_write_b32 a214, 0
v_accvgpr_write_b32 a215, 0
v_accvgpr_write_b32 a216, 0
v_accvgpr_write_b32 a217, 0
v_accvgpr_write_b32 a218, 0
v_accvgpr_write_b32 a219, 0
v_accvgpr_write_b32 a220, 0
v_accvgpr_write_b32 a221, 0
v_accvgpr_write_b32 a222, 0
v_accvgpr_write_b32 a223, 0
v_mov_b64 v[112:113], 0
v_mov_b64 v[114:115], 0
v_mov_b64 v[116:117], 0
v_mov_b64 v[118:119], 0
v_mov_b64 v[120:121], 0
v_mov_b64 v[122:123], 0
v_mov_b64 v[124:125], 0
v_mov_b64 v[126:127], 0
v_mov_b64 v[128:129], 0
v_mov_b64 v[130:131], 0
v_mov_b64 v[132:133], 0
v_mov_b64 v[134:135], 0
v_mov_b64 v[136:137], 0
v_mov_b64 v[138:139], 0
v_mov_b64 v[140:141], 0
v_mov_b64 v[142:143], 0
v_mov_b64 v[144:145], 0
v_mov_b64 v[146:147], 0
v_mov_b64 v[148:149], 0
v_mov_b64 v[150:151], 0
v_mov_b64 v[152:153], 0
v_mov_b64 v[154:155], 0
v_mov_b64 v[156:157], 0
v_mov_b64 v[158:159], 0
v_mov_b64 v[22:23], 0
s_waitcnt vmcnt(16)
s_barrier
ds_read_b128 a[64:67], v2 offset:0
ds_read_b128 a[68:71], v2 offset:1024
ds_read_b128 a[72:75], v2 offset:2048
ds_read_b128 a[76:79], v2 offset:3072
s_waitcnt lgkmcnt(3)
v_mfma_f32_32x32x16_bf16 v[32:47], a[64:67], a[0:3], v[128:143]
ds_read_b128 a[80:83], v2 offset:4096
v_mfma_f32_32x32x16_bf16 v[48:63], a[64:67], a[32:35], v[144:159]
s_waitcnt lgkmcnt(3)
v_mfma_f32_32x32x16_bf16 v[32:47], a[68:71], a[4:7], v[32:47]
ds_read_b128 a[84:87], v2 offset:5120
v_mfma_f32_32x32x16_bf16 v[48:63], a[68:71], a[36:39], v[48:63]
s_waitcnt lgkmcnt(3)
v_mfma_f32_32x32x16_bf16 v[32:47], a[72:75], a[8:11], v[32:47]
ds_read_b128 a[88:91], v2 offset:6144
v_mfma_f32_32x32x16_bf16 v[48:63], a[72:75], a[40:43], v[48:63]
s_waitcnt lgkmcnt(3)
v_mfma_f32_32x32x16_bf16 v[32:47], a[76:79], a[12:15], v[32:47]
ds_read_b128 a[92:95], v2 offset:7168
v_mfma_f32_32x32x16_bf16 v[48:63], a[76:79], a[44:47], v[48:63]
s_waitcnt lgkmcnt(3)
v_mfma_f32_32x32x16_bf16 v[32:47], a[80:83], a[16:19], v[32:47]
ds_read_b128 a[64:67], v4 offset:24576
v_mfma_f32_32x32x16_bf16 v[48:63], a[80:83], a[48:51], v[48:63]
s_waitcnt lgkmcnt(3)
v_mfma_f32_32x32x16_bf16 v[32:47], a[84:87], a[20:23], v[32:47]
ds_read_b128 a[68:71], v4 offset:25600
v_mfma_f32_32x32x16_bf16 v[48:63], a[84:87], a[52:55], v[48:63]
s_waitcnt lgkmcnt(3)
v_mfma_f32_32x32x16_bf16 v[32:47], a[88:91], a[24:27], v[32:47]
ds_read_b128 a[72:75], v4 offset:26624
v_mfma_f32_32x32x16_bf16 v[48:63], a[88:91], a[56:59], v[48:63]
s_waitcnt lgkmcnt(3)
v_mfma_f32_32x32x16_bf16 v[32:47], a[92:95], a[28:31], v[32:47]
ds_read_b128 a[76:79], v4 offset:27648
v_mfma_f32_32x32x16_bf16 v[48:63], a[92:95], a[60:63], v[48:63]
s_waitcnt lgkmcnt(3)
s_cmp_eq_u32 s44, 0
s_cbranch_scc1 L_at_last
.p2align 3
L_at_loop:
v_mfma_f32_32x32x16_bf16 a[96:111], a[64:67], v[112:115], a[96:111]
ds_read_b128 a[80:83], v4 offset:28672
v_mfma_f32_32x32x16_bf16 a[112:127], a[64:67], v[120:123], a[112:127]
s_waitcnt lgkmcnt(3)
s_add_u32 s24, s43, 3
v_mfma_f32_32x32x16_bf16 a[96:111], a[68:71], v[116:119], a[96:111]
ds_read_b128 a[84:87], v4 offset:29696
v_max3_f32 v26, v32, v33, v34
v_max3_f32 v26, v26, v35, v36
v_max3_f32 v26, v26, v37, v38
v_max3_f32 v26, v26, v39, v40
v_mfma_f32_32x32x16_bf16 a[112:127], a[68:71], v[124:127], a[112:127]
s_waitcnt lgkmcnt(3)
s_cmp_lt_u32 s24, s45
s_cselect_b32 s46, s46, 536870912
v_max3_f32 v26, v26, v41, v42
v_max3_f32 v26, v26, v43, v44
v_max3_f32 v26, v26, v45, v46
v_max3_f32 v26, v26, v47, v48
v_max3_f32 v26, v26, v49, v50
v_mfma_f32_32x32x16_bf16 a[128:143], a[72:75], v[112:115], a[128:143]
ds_read_b128 a[88:91], v4 offset:30720
v_max3_f32 v26, v26, v51, v52
v_max3_f32 v26, v26, v53, v54
v_max3_f32 v26, v26, v55, v56
v_max3_f32 v26, v26, v57, v58
v_mfma_f32_32x32x16_bf16 a[144:159], a[72:75], v[120:123], a[144:159]
s_waitcnt lgkmcnt(3)
v_max3_f32 v26, v26, v59, v60
v_max3_f32 v26, v26, v61, v62
v_max_f32 v26, v26, v63
v_cmp_lt_f32 vcc, s54, v26
v_mfma_f32_32x32x16_bf16 a[128:143], a[76:79], v[116:119], a[128:143]
ds_read_b128 a[92:95], v4 offset:31744
s_cbranch_vccnz L_at_upa
L_at_upra:
v_exp_f32 v32, v32
v_exp_f32 v33, v33
v_mfma_f32_32x32x16_bf16 a[144:159], a[76:79], v[124:127], a[144:159]
s_waitcnt lgkmcnt(3)
v_exp_f32 v34, v34
v_add_f32 v22, v22, v32
v_add_f32 v22, v22, v33
v_mfma_f32_32x32x16_bf16 a[160:175], a[80:83], v[112:115], a[160:175]
ds_read_b128 a[64:67], v2 offset:16384
v_exp_f32 v35, v35
v_cvt_pk_bf16_f32 v96, v32, v33
v_exp_f32 v36, v36
v_mfma_f32_32x32x16_bf16 a[176:191], a[80:83], v[120:123], a[176:191]
s_waitcnt lgkmcnt(3)
v_add_f32 v22, v22, v34
v_add_f32 v22, v22, v35
v_exp_f32 v37, v37
v_mfma_f32_32x32x16_bf16 a[160:175], a[84:87], v[116:119], a[160:175]
ds_read_b128 a[68:71], v2 offset:17408
v_cvt_pk_bf16_f32 v97, v34, v35
v_exp_f32 v38, v38
v_add_f32 v22, v22, v36
v_add_f32 v22, v22, v37
v_mfma_f32_32x32x16_bf16 a[176:191], a[84:87], v[124:127], a[176:191]
s_waitcnt lgkmcnt(3)
v_exp_f32 v39, v39
v_cvt_pk_bf16_f32 v98, v36, v37
v_mfma_f32_32x32x16_bf16 a[192:207], a[88:91], v[112:115], a[192:207]
ds_read_b128 a[72:75], v2 offset:18432
v_exp_f32 v40, v40
v_add_f32 v22, v22, v38
v_add_f32 v22, v22, v39
v_exp_f32 v41, v41
v_mfma_f32_32x32x16_bf16 a[208:223], a[88:91], v[120:123], a[208:223]
s_waitcnt lgkmcnt(3)
v_cvt_pk_bf16_f32 v99, v38, v39
v_exp_f32 v42, v42
v_mfma_f32_32x32x16_bf16 a[192:207], a[92:95], v[116:119], a[192:207]
ds_read_b128 a[76:79], v2 offset:19456
v_add_f32 v22, v22, v40
v_add_f32 v22, v22, v41
v_exp_f32 v43, v43
v_cvt_pk_bf16_f32 v100, v40, v41
v_mfma_f32_32x32x16_bf16 a[208:223], a[92:95], v[124:127], a[208:223]
s_waitcnt lgkmcnt(3)
s_cmp_eq_u32 s48, 0
s_cbranch_scc0 L_at_rsa
L_at_rsra:
v_exp_f32 v44, v44
v_add_f32 v22, v22, v42
v_add_f32 v22, v22, v43
v_mfma_f32_32x32x16_bf16 v[64:79], a[64:67], a[0:3], v[128:143]
ds_read_b128 a[80:83], v2 offset:20480
v_exp_f32 v45, v45
v_cvt_pk_bf16_f32 v101, v42, v43
v_exp_f32 v46, v46
v_mfma_f32_32x32x16_bf16 v[80:95], a[64:67], a[32:35], v[144:159]
s_waitcnt lgkmcnt(3)
v_add_f32 v22, v22, v44
v_add_f32 v22, v22, v45
v_exp_f32 v47, v47
v_mfma_f32_32x32x16_bf16 v[64:79], a[68:71], a[4:7], v[64:79]
ds_read_b128 a[84:87], v2 offset:21504
v_cvt_pk_bf16_f32 v102, v44, v45
v_exp_f32 v48, v48
v_add_f32 v22, v22, v46
v_mfma_f32_32x32x16_bf16 v[80:95], a[68:71], a[36:39], v[80:95]
s_waitcnt lgkmcnt(3)
v_add_f32 v22, v22, v47
v_exp_f32 v49, v49
v_cvt_pk_bf16_f32 v103, v46, v47
v_mfma_f32_32x32x16_bf16 v[64:79], a[72:75], a[8:11], v[64:79]
ds_read_b128 a[88:91], v2 offset:22528
v_exp_f32 v50, v50
v_add_f32 v23, v23, v48
v_add_f32 v23, v23, v49
v_mfma_f32_32x32x16_bf16 v[80:95], a[72:75], a[40:43], v[80:95]
s_waitcnt lgkmcnt(3)
v_exp_f32 v51, v51
v_cvt_pk_bf16_f32 v104, v48, v49
v_exp_f32 v52, v52
v_mfma_f32_32x32x16_bf16 v[64:79], a[76:79], a[12:15], v[64:79]
ds_read_b128 a[92:95], v2 offset:23552
v_add_f32 v23, v23, v50
v_add_f32 v23, v23, v51
v_exp_f32 v53, v53
v_mfma_f32_32x32x16_bf16 v[80:95], a[76:79], a[44:47], v[80:95]
s_waitcnt lgkmcnt(3)
v_cvt_pk_bf16_f32 v105, v50, v51
v_exp_f32 v54, v54
v_add_f32 v23, v23, v52
v_add_f32 v23, v23, v53
v_mfma_f32_32x32x16_bf16 v[64:79], a[80:83], a[16:19], v[64:79]
ds_read_b128 a[64:67], v2 offset:8192
v_exp_f32 v55, v55
v_cvt_pk_bf16_f32 v106, v52, v53
v_mfma_f32_32x32x16_bf16 v[80:95], a[80:83], a[48:51], v[80:95]
s_waitcnt lgkmcnt(3)
v_exp_f32 v56, v56
v_add_f32 v23, v23, v54
v_add_f32 v23, v23, v55
v_exp_f32 v57, v57
v_mfma_f32_32x32x16_bf16 v[64:79], a[84:87], a[20:23], v[64:79]
ds_read_b128 a[68:71], v2 offset:9216
v_cvt_pk_bf16_f32 v107, v54, v55
v_exp_f32 v58, v58
v_mfma_f32_32x32x16_bf16 v[80:95], a[84:87], a[52:55], v[80:95]
s_waitcnt lgkmcnt(3)
v_add_f32 v23, v23, v56
v_add_f32 v23, v23, v57
v_exp_f32 v59, v59
v_cvt_pk_bf16_f32 v108, v56, v57
v_mfma_f32_32x32x16_bf16 v[64:79], a[88:91], a[24:27], v[64:79]
ds_read_b128 a[72:75], v2 offset:10240
v_exp_f32 v60, v60
v_add_f32 v23, v23, v58
v_add_f32 v23, v23, v59
v_mfma_f32_32x32x16_bf16 v[80:95], a[88:91], a[56:59], v[80:95]
s_waitcnt lgkmcnt(3)
v_exp_f32 v61, v61
v_cvt_pk_bf16_f32 v109, v58, v59
v_exp_f32 v62, v62
v_mfma_f32_32x32x16_bf16 v[64:79], a[92:95], a[28:31], v[64:79]
ds_read_b128 a[76:79], v2 offset:11264
v_add_f32 v23, v23, v60
v_add_f32 v23, v23, v61
v_exp_f32 v63, v63
v_mfma_f32_32x32x16_bf16 v[80:95], a[92:95], a[60:63], v[80:95]
s_waitcnt lgkmcnt(3)
v_cvt_pk_bf16_f32 v110, v60, v61
v_add_f32 v23, v23, v62
v_add_f32 v23, v23, v63
v_cvt_pk_bf16_f32 v111, v62, v63
s_waitcnt vmcnt(8)
s_barrier
v_mfma_f32_32x32x16_bf16 a[96:111], a[64:67], v[96:99], a[96:111]
ds_read_b128 a[80:83], v2 offset:12288
v_mfma_f32_32x32x16_bf16 a[112:127], a[64:67], v[104:107], a[112:127]
s_waitcnt lgkmcnt(3)
s_mov_b32 m0, s47
v_mfma_f32_32x32x16_bf16 a[96:111], a[68:71], v[100:103], a[96:111]
ds_read_b128 a[84:87], v2 offset:13312
v_max3_f32 v26, v64, v65, v66
v_max3_f32 v26, v26, v67, v68
v_max3_f32 v26, v26, v69, v70
v_max3_f32 v26, v26, v71, v72
v_mfma_f32_32x32x16_bf16 a[112:127], a[68:71], v[108:111], a[112:127]
s_waitcnt lgkmcnt(3)
s_add_u32 s24, s46, 4096
v_max3_f32 v26, v26, v73, v74
v_max3_f32 v26, v26, v75, v76
v_max3_f32 v26, v26, v77, v78
v_max3_f32 v26, v26, v79, v80
v_max3_f32 v26, v26, v81, v82
v_mfma_f32_32x32x16_bf16 a[128:143], a[72:75], v[96:99], a[128:143]
ds_read_b128 a[88:91], v2 offset:14336
v_max3_f32 v26, v26, v83, v84
v_max3_f32 v26, v26, v85, v86
v_max3_f32 v26, v26, v87, v88
v_max3_f32 v26, v26, v89, v90
v_mfma_f32_32x32x16_bf16 a[144:159], a[72:75], v[104:107], a[144:159]
s_waitcnt lgkmcnt(3)
buffer_load_dwordx4 v1, s[8:11], s46 offen offset:0 sc1 lds
v_max3_f32 v26, v26, v91, v92
v_max3_f32 v26, v26, v93, v94
v_max_f32 v26, v26, v95
v_cmp_lt_f32 vcc, s54, v26
v_mfma_f32_32x32x16_bf16 a[128:143], a[76:79], v[100:103], a[128:143]
ds_read_b128 a[92:95], v2 offset:15360
s_cbranch_vccnz L_at_upb
L_at_uprb:
v_exp_f32 v64, v64
v_exp_f32 v65, v65
v_mfma_f32_32x32x16_bf16 a[144:159], a[76:79], v[108:111], a[144:159]
s_waitcnt lgkmcnt(3)
buffer_load_dwordx4 v1, s[8:11], s46 offen offset:1024 sc1 lds
v_exp_f32 v66, v66
v_add_f32 v22, v22, v64
v_add_f32 v22, v22, v65
v_mfma_f32_32x32x16_bf16 a[160:175], a[80:83], v[96:99], a[160:175]
ds_read_b128 a[64:67], v3 offset:0
v_exp_f32 v67, v67
v_cvt_pk_bf16_f32 v112, v64, v65
v_exp_f32 v68, v68
v_mfma_f32_32x32x16_bf16 a[176:191], a[80:83], v[104:107], a[176:191]
s_waitcnt lgkmcnt(3)
buffer_load_dwordx4 v1, s[8:11], s46 offen offset:2048 sc1 lds
v_add_f32 v22, v22, v66
v_add_f32 v22, v22, v67
v_exp_f32 v69, v69
v_cvt_pk_bf16_f32 v113, v66, v67
v_mfma_f32_32x32x16_bf16 a[160:175], a[84:87], v[100:103], a[160:175]
ds_read_b128 a[68:71], v3 offset:1024
v_exp_f32 v70, v70
v_add_f32 v22, v22, v68
v_add_f32 v22, v22, v69
v_mfma_f32_32x32x16_bf16 a[176:191], a[84:87], v[108:111], a[176:191]
s_waitcnt lgkmcnt(3)
buffer_load_dwordx4 v1, s[8:11], s46 offen offset:3072 sc1 lds
v_exp_f32 v71, v71
v_cvt_pk_bf16_f32 v114, v68, v69
v_exp_f32 v72, v72
v_mfma_f32_32x32x16_bf16 a[192:207], a[88:91], v[96:99], a[192:207]
ds_read_b128 a[72:75], v3 offset:2048
v_add_f32 v22, v22, v70
v_add_f32 v22, v22, v71
v_exp_f32 v73, v73
v_mfma_f32_32x32x16_bf16 a[208:223], a[88:91], v[104:107], a[208:223]
s_waitcnt lgkmcnt(3)
s_add_u32 m0, s47, 4096
v_cvt_pk_bf16_f32 v115, v70, v71
v_exp_f32 v74, v74
v_add_f32 v22, v22, v72
v_add_f32 v22, v22, v73
v_mfma_f32_32x32x16_bf16 a[192:207], a[92:95], v[100:103], a[192:207]
ds_read_b128 a[76:79], v3 offset:3072
v_exp_f32 v75, v75
v_cvt_pk_bf16_f32 v116, v72, v73
v_exp_f32 v76, v76
v_mfma_f32_32x32x16_bf16 a[208:223], a[92:95], v[108:111], a[208:223]
s_waitcnt lgkmcnt(3)
buffer_load_dwordx4 v1, s[8:11], s24 offen offset:0 sc1 lds
s_cmp_eq_u32 s48, 0
s_cbranch_scc0 L_at_rsb
L_at_rsrb:
v_add_f32 v22, v22, v74
v_add_f32 v22, v22, v75
v_exp_f32 v77, v77
v_mfma_f32_32x32x16_bf16 v[32:47], a[64:67], a[0:3], v[128:143]
ds_read_b128 a[80:83], v3 offset:4096
v_cvt_pk_bf16_f32 v117, v74, v75
v_exp_f32 v78, v78
v_add_f32 v22, v22, v76
v_mfma_f32_32x32x16_bf16 v[48:63], a[64:67], a[32:35], v[144:159]
s_waitcnt lgkmcnt(3)
buffer_load_dwordx4 v1, s[8:11], s24 offen offset:1024 sc1 lds
v_add_f32 v22, v22, v77
v_exp_f32 v79, v79
v_cvt_pk_bf16_f32 v118, v76, v77
v_mfma_f32_32x32x16_bf16 v[32:47], a[68:71], a[4:7], v[32:47]
ds_read_b128 a[84:87], v3 offset:5120
v_exp_f32 v80, v80
v_add_f32 v22, v22, v78
v_add_f32 v22, v22, v79
v_exp_f32 v81, v81
v_mfma_f32_32x32x16_bf16 v[48:63], a[68:71], a[36:39], v[48:63]
s_waitcnt lgkmcnt(3)
buffer_load_dwordx4 v1, s[8:11], s24 offen offset:2048 sc1 lds
v_cvt_pk_bf16_f32 v119, v78, v79
v_exp_f32 v82, v82
v_mfma_f32_32x32x16_bf16 v[32:47], a[72:75], a[8:11], v[32:47]
ds_read_b128 a[88:91], v3 offset:6144
v_add_f32 v23, v23, v80
v_add_f32 v23, v23, v81
v_exp_f32 v83, v83
v_cvt_pk_bf16_f32 v120, v80, v81
v_mfma_f32_32x32x16_bf16 v[48:63], a[72:75], a[40:43], v[48:63]
s_waitcnt lgkmcnt(3)
buffer_load_dwordx4 v1, s[8:11], s24 offen offset:3072 sc1 lds
v_exp_f32 v84, v84
v_add_f32 v23, v23, v82
v_add_f32 v23, v23, v83
v_mfma_f32_32x32x16_bf16 v[32:47], a[76:79], a[12:15], v[32:47]
ds_read_b128 a[92:95], v3 offset:7168
v_exp_f32 v85, v85
v_cvt_pk_bf16_f32 v121, v82, v83
v_exp_f32 v86, v86
v_mfma_f32_32x32x16_bf16 v[48:63], a[76:79], a[44:47], v[48:63]
s_waitcnt lgkmcnt(3)
s_add_u32 s46, s46, 32768
v_add_f32 v23, v23, v84
v_add_f32 v23, v23, v85
v_exp_f32 v87, v87
v_mfma_f32_32x32x16_bf16 v[32:47], a[80:83], a[16:19], v[32:47]
ds_read_b128 a[64:67], v2 offset:24576
v_cvt_pk_bf16_f32 v122, v84, v85
v_exp_f32 v88, v88
v_add_f32 v23, v23, v86
v_add_f32 v23, v23, v87
v_mfma_f32_32x32x16_bf16 v[48:63], a[80:83], a[48:51], v[48:63]
s_waitcnt lgkmcnt(3)
s_add_u32 s47, s47, 32768
v_exp_f32 v89, v89
v_cvt_pk_bf16_f32 v123, v86, v87
v_exp_f32 v90, v90
v_mfma_f32_32x32x16_bf16 v[32:47], a[84:87], a[20:23], v[32:47]
ds_read_b128 a[68:71], v2 offset:25600
v_add_f32 v23, v23, v88
v_add_f32 v23, v23, v89
v_exp_f32 v91, v91
v_mfma_f32_32x32x16_bf16 v[48:63], a[84:87], a[52:55], v[48:63]
s_waitcnt lgkmcnt(3)
s_and_b32 s47, s47, 131071
v_cvt_pk_bf16_f32 v124, v88, v89
v_exp_f32 v92, v92
v_add_f32 v23, v23, v90
v_mfma_f32_32x32x16_bf16 v[32:47], a[88:91], a[24:27], v[32:47]
ds_read_b128 a[72:75], v2 offset:26624
v_add_f32 v23, v23, v91
v_exp_f32 v93, v93
v_cvt_pk_bf16_f32 v125, v90, v91
v_mfma_f32_32x32x16_bf16 v[48:63], a[88:91], a[56:59], v[48:63]
s_waitcnt lgkmcnt(3)
s_add_u32 s43, s43, 1
v_exp_f32 v94, v94
v_add_f32 v23, v23, v92
v_add_f32 v23, v23, v93
v_exp_f32 v95, v95
v_mfma_f32_32x32x16_bf16 v[32:47], a[92:95], a[28:31], v[32:47]
ds_read_b128 a[76:79], v2 offset:27648
v_cvt_pk_bf16_f32 v126, v92, v93
v_add_f32 v23, v23, v94
v_add_f32 v23, v23, v95
v_cvt_pk_bf16_f32 v127, v94, v95
v_mfma_f32_32x32x16_bf16 v[48:63], a[92:95], a[60:63], v[48:63]
s_waitcnt lgkmcnt(3)
s_cmp_lt_u32 s43, s44
v_mov_b32 v4, v2
v_mov_b32 v2, v3
v_add_u32 v3, 32768, v3
v_and_b32 v3, 131071, v3
s_cbranch_scc1 L_at_loop
L_at_last:
v_mfma_f32_32x32x16_bf16 a[96:111], a[64:67], v[112:115], a[96:111]
ds_read_b128 a[80:83], v4 offset:28672
v_mfma_f32_32x32x16_bf16 a[112:127], a[64:67], v[120:123], a[112:127]
s_waitcnt lgkmcnt(3)
s_add_u32 s24, s43, 3
v_mfma_f32_32x32x16_bf16 a[96:111], a[68:71], v[116:119], a[96:111]
ds_read_b128 a[84:87], v4 offset:29696
v_mov_b32 v31, s50
v_cmp_le_i32 vcc, 0, v5
s_nop 1
v_cndmask_b32 v32, v31, v32, vcc
v_cmp_le_i32 vcc, 1, v5
v_mfma_f32_32x32x16_bf16 a[112:127], a[68:71], v[124:127], a[112:127]
s_waitcnt lgkmcnt(3)
s_cmp_lt_u32 s24, s45
s_cselect_b32 s46, s46, 536870912
v_cndmask_b32 v33, v31, v33, vcc
v_cmp_le_i32 vcc, 2, v5
s_nop 1
v_cndmask_b32 v34, v31, v34, vcc
v_cmp_le_i32 vcc, 3, v5
v_mfma_f32_32x32x16_bf16 a[128:143], a[72:75], v[112:115], a[128:143]
ds_read_b128 a[88:91], v4 offset:30720
v_cndmask_b32 v35, v31, v35, vcc
v_cmp_le_i32 vcc, 8, v5
s_nop 1
v_cndmask_b32 v36, v31, v36, vcc
v_cmp_le_i32 vcc, 9, v5
s_nop 1
v_cndmask_b32 v37, v31, v37, vcc
v_mfma_f32_32x32x16_bf16 a[144:159], a[72:75], v[120:123], a[144:159]
s_waitcnt lgkmcnt(3)
v_cmp_le_i32 vcc, 10, v5
s_nop 1
v_cndmask_b32 v38, v31, v38, vcc
v_cmp_le_i32 vcc, 11, v5
s_nop 1
v_cndmask_b32 v39, v31, v39, vcc
v_mfma_f32_32x32x16_bf16 a[128:143], a[76:79], v[116:119], a[128:143]
ds_read_b128 a[92:95], v4 offset:31744
v_cmp_le_i32 vcc, 16, v5
s_nop 1
v_cndmask_b32 v40, v31, v40, vcc
v_cmp_le_i32 vcc, 17, v5
s_nop 1
v_cndmask_b32 v41, v31, v41, vcc
v_mfma_f32_32x32x16_bf16 a[144:159], a[76:79], v[124:127], a[144:159]
s_waitcnt lgkmcnt(3)
v_cmp_le_i32 vcc, 18, v5
s_nop 1
v_cndmask_b32 v42, v31, v42, vcc
v_cmp_le_i32 vcc, 19, v5
s_nop 1
v_cndmask_b32 v43, v31, v43, vcc
v_mfma_f32_32x32x16_bf16 a[160:175], a[80:83], v[112:115], a[160:175]
ds_read_b128 a[64:67], v2 offset:16384
v_cmp_le_i32 vcc, 24, v5
s_nop 1
v_cndmask_b32 v44, v31, v44, vcc
v_cmp_le_i32 vcc, 25, v5
s_nop 1
v_cndmask_b32 v45, v31, v45, vcc
v_mfma_f32_32x32x16_bf16 a[176:191], a[80:83], v[120:123], a[176:191]
s_waitcnt lgkmcnt(3)
v_cmp_le_i32 vcc, 26, v5
s_nop 1
v_cndmask_b32 v46, v31, v46, vcc
v_cmp_le_i32 vcc, 27, v5
s_nop 1
v_cndmask_b32 v47, v31, v47, vcc
v_mfma_f32_32x32x16_bf16 a[160:175], a[84:87], v[116:119], a[160:175]
ds_read_b128 a[68:71], v2 offset:17408
v_max3_f32 v26, v32, v33, v34
v_max3_f32 v26, v26, v35, v36
v_max3_f32 v26, v26, v37, v38
v_max3_f32 v26, v26, v39, v40
v_max3_f32 v26, v26, v41, v42
v_mfma_f32_32x32x16_bf16 a[176:191], a[84:87], v[124:127], a[176:191]
s_waitcnt lgkmcnt(3)
v_max3_f32 v26, v26, v43, v44
v_max3_f32 v26, v26, v45, v46
v_max3_f32 v26, v26, v47, v48
v_max3_f32 v26, v26, v49, v50
v_mfma_f32_32x32x16_bf16 a[192:207], a[88:91], v[112:115], a[192:207]
ds_read_b128 a[72:75], v2 offset:18432
v_max3_f32 v26, v26, v51, v52
v_max3_f32 v26, v26, v53, v54
v_max3_f32 v26, v26, v55, v56
v_max3_f32 v26, v26, v57, v58
v_mfma_f32_32x32x16_bf16 a[208:223], a[88:91], v[120:123], a[208:223]
s_waitcnt lgkmcnt(3)
v_max3_f32 v26, v26, v59, v60
v_max3_f32 v26, v26, v61, v62
v_max_f32 v26, v26, v63
v_cmp_lt_f32 vcc, s54, v26
v_mfma_f32_32x32x16_bf16 a[192:207], a[92:95], v[116:119], a[192:207]
ds_read_b128 a[76:79], v2 offset:19456
s_cbranch_vccnz L_at_upc
L_at_uprc:
v_exp_f32 v32, v32
v_exp_f32 v33, v33
v_exp_f32 v34, v34
v_mfma_f32_32x32x16_bf16 a[208:223], a[92:95], v[124:127], a[208:223]
s_waitcnt lgkmcnt(3)
s_cmp_eq_u32 s48, 0
s_cbranch_scc0 L_at_rsc
L_at_rsrc:
v_add_f32 v22, v22, v32
v_add_f32 v22, v22, v33
v_exp_f32 v35, v35
v_cvt_pk_bf16_f32 v96, v32, v33
v_exp_f32 v36, v36
v_mfma_f32_32x32x16_bf16 v[64:79], a[64:67], a[0:3], v[128:143]
ds_read_b128 a[80:83], v2 offset:20480
v_add_f32 v22, v22, v34
v_add_f32 v22, v22, v35
v_exp_f32 v37, v37
v_cvt_pk_bf16_f32 v97, v34, v35
v_mfma_f32_32x32x16_bf16 v[80:95], a[64:67], a[32:35], v[144:159]
s_waitcnt lgkmcnt(3)
v_exp_f32 v38, v38
v_add_f32 v22, v22, v36
v_add_f32 v22, v22, v37
v_exp_f32 v39, v39
v_cvt_pk_bf16_f32 v98, v36, v37
v_mfma_f32_32x32x16_bf16 v[64:79], a[68:71], a[4:7], v[64:79]
ds_read_b128 a[84:87], v2 offset:21504
v_exp_f32 v40, v40
v_add_f32 v22, v22, v38
v_add_f32 v22, v22, v39
v_exp_f32 v41, v41
v_mfma_f32_32x32x16_bf16 v[80:95], a[68:71], a[36:39], v[80:95]
s_waitcnt lgkmcnt(3)
v_cvt_pk_bf16_f32 v99, v38, v39
v_exp_f32 v42, v42
v_add_f32 v22, v22, v40
v_add_f32 v22, v22, v41
v_exp_f32 v43, v43
v_mfma_f32_32x32x16_bf16 v[64:79], a[72:75], a[8:11], v[64:79]
ds_read_b128 a[88:91], v2 offset:22528
v_cvt_pk_bf16_f32 v100, v40, v41
v_exp_f32 v44, v44
v_add_f32 v22, v22, v42
v_add_f32 v22, v22, v43
v_mfma_f32_32x32x16_bf16 v[80:95], a[72:75], a[40:43], v[80:95]
s_waitcnt lgkmcnt(3)
v_exp_f32 v45, v45
v_cvt_pk_bf16_f32 v101, v42, v43
v_exp_f32 v46, v46
v_add_f32 v22, v22, v44
v_add_f32 v22, v22, v45
v_mfma_f32_32x32x16_bf16 v[64:79], a[76:79], a[12:15], v[64:79]
ds_read_b128 a[92:95], v2 offset:23552
v_exp_f32 v47, v47
v_cvt_pk_bf16_f32 v102, v44, v45
v_exp_f32 v48, v48
v_add_f32 v22, v22, v46
v_mfma_f32_32x32x16_bf16 v[80:95], a[76:79], a[44:47], v[80:95]
s_waitcnt lgkmcnt(3)
v_add_f32 v22, v22, v47
v_exp_f32 v49, v49
v_cvt_pk_bf16_f32 v103, v46, v47
v_exp_f32 v50, v50
v_mfma_f32_32x32x16_bf16 v[64:79], a[80:83], a[16:19], v[64:79]
ds_read_b128 a[64:67], v2 offset:8192
v_add_f32 v23, v23, v48
v_add_f32 v23, v23, v49
v_exp_f32 v51, v51
v_cvt_pk_bf16_f32 v104, v48, v49
v_exp_f32 v52, v52
v_mfma_f32_32x32x16_bf16 v[80:95], a[80:83], a[48:51], v[80:95]
s_waitcnt lgkmcnt(3)
v_add_f32 v23, v23, v50
v_add_f32 v23, v23, v51
v_exp_f32 v53, v53
v_cvt_pk_bf16_f32 v105, v50, v51
v_mfma_f32_32x32x16_bf16 v[64:79], a[84:87], a[20:23], v[64:79]
ds_read_b128 a[68:71], v2 offset:9216
v_exp_f32 v54, v54
v_add_f32 v23, v23, v52
v_add_f32 v23, v23, v53
v_exp_f32 v55, v55
v_cvt_pk_bf16_f32 v106, v52, v53
v_mfma_f32_32x32x16_bf16 v[80:95], a[84:87], a[52:55], v[80:95]
s_waitcnt lgkmcnt(3)
v_exp_f32 v56, v56
v_add_f32 v23, v23, v54
v_add_f32 v23, v23, v55
v_exp_f32 v57, v57
v_mfma_f32_32x32x16_bf16 v[64:79], a[88:91], a[24:27], v[64:79]
ds_read_b128 a[72:75], v2 offset:10240
v_cvt_pk_bf16_f32 v107, v54, v55
v_exp_f32 v58, v58
v_add_f32 v23, v23, v56
v_add_f32 v23, v23, v57
v_exp_f32 v59, v59
v_mfma_f32_32x32x16_bf16 v[80:95], a[88:91], a[56:59], v[80:95]
s_waitcnt lgkmcnt(3)
v_cvt_pk_bf16_f32 v108, v56, v57
v_exp_f32 v60, v60
v_add_f32 v23, v23, v58
v_add_f32 v23, v23, v59
v_mfma_f32_32x32x16_bf16 v[64:79], a[92:95], a[28:31], v[64:79]
ds_read_b128 a[76:79], v2 offset:11264
v_exp_f32 v61, v61
v_cvt_pk_bf16_f32 v109, v58, v59
v_exp_f32 v62, v62
v_add_f32 v23, v23, v60
v_add_f32 v23, v23, v61
v_mfma_f32_32x32x16_bf16 v[80:95], a[92:95], a[60:63], v[80:95]
s_waitcnt lgkmcnt(3)
v_exp_f32 v63, v63
v_cvt_pk_bf16_f32 v110, v60, v61
v_add_f32 v23, v23, v62
v_add_f32 v23, v23, v63
v_cvt_pk_bf16_f32 v111, v62, v63
s_waitcnt vmcnt(8)
s_barrier
v_mfma_f32_32x32x16_bf16 a[96:111], a[64:67], v[96:99], a[96:111]
ds_read_b128 a[80:83], v2 offset:12288
s_mov_b32 m0, s47
v_mfma_f32_32x32x16_bf16 a[112:127], a[64:67], v[104:107], a[112:127]
s_waitcnt lgkmcnt(3)
s_add_u32 s24, s46, 4096
v_mfma_f32_32x32x16_bf16 a[96:111], a[68:71], v[100:103], a[96:111]
ds_read_b128 a[84:87], v2 offset:13312
buffer_load_dwordx4 v1, s[8:11], s46 offen offset:0 sc1 lds
v_mov_b32 v31, s50
v_cmp_le_i32 vcc, 0, v5
s_nop 1
v_cndmask_b32 v80, v31, v80, vcc
v_cmp_le_i32 vcc, 1, v5
s_nop 1
v_cndmask_b32 v81, v31, v81, vcc
v_cmp_le_i32 vcc, 2, v5
v_mfma_f32_32x32x16_bf16 a[112:127], a[68:71], v[108:111], a[112:127]
s_waitcnt lgkmcnt(3)
buffer_load_dwordx4 v1, s[8:11], s46 offen offset:1024 sc1 lds
v_cndmask_b32 v82, v31, v82, vcc
v_cmp_le_i32 vcc, 3, v5
s_nop 1
v_cndmask_b32 v83, v31, v83, vcc
v_cmp_le_i32 vcc, 8, v5
s_nop 1
v_cndmask_b32 v84, v31, v84, vcc
v_mfma_f32_32x32x16_bf16 a[128:143], a[72:75], v[96:99], a[128:143]
ds_read_b128 a[88:91], v2 offset:14336
buffer_load_dwordx4 v1, s[8:11], s46 offen offset:2048 sc1 lds
v_cmp_le_i32 vcc, 9, v5
s_nop 1
v_cndmask_b32 v85, v31, v85, vcc
v_cmp_le_i32 vcc, 10, v5
s_nop 1
v_cndmask_b32 v86, v31, v86, vcc
v_cmp_le_i32 vcc, 11, v5
s_nop 1
v_cndmask_b32 v87, v31, v87, vcc
v_mfma_f32_32x32x16_bf16 a[144:159], a[72:75], v[104:107], a[144:159]
s_waitcnt lgkmcnt(3)
buffer_load_dwordx4 v1, s[8:11], s46 offen offset:3072 sc1 lds
v_cmp_le_i32 vcc, 16, v5
s_nop 1
v_cndmask_b32 v88, v31, v88, vcc
v_cmp_le_i32 vcc, 17, v5
s_nop 1
v_cndmask_b32 v89, v31, v89, vcc
v_cmp_le_i32 vcc, 18, v5
v_mfma_f32_32x32x16_bf16 a[128:143], a[76:79], v[100:103], a[128:143]
ds_read_b128 a[92:95], v2 offset:15360
s_add_u32 m0, s47, 4096
v_cndmask_b32 v90, v31, v90, vcc
v_cmp_le_i32 vcc, 19, v5
s_nop 1
v_cndmask_b32 v91, v31, v91, vcc
v_cmp_le_i32 vcc, 24, v5
s_nop 1
v_cndmask_b32 v92, v31, v92, vcc
v_cmp_le_i32 vcc, 25, v5
v_mfma_f32_32x32x16_bf16 a[144:159], a[76:79], v[108:111], a[144:159]
s_waitcnt lgkmcnt(3)
buffer_load_dwordx4 v1, s[8:11], s24 offen offset:0 sc1 lds
v_cndmask_b32 v93, v31, v93, vcc
v_cmp_le_i32 vcc, 26, v5
s_nop 1
v_cndmask_b32 v94, v31, v94, vcc
v_cmp_le_i32 vcc, 27, v5
s_nop 1
v_cndmask_b32 v95, v31, v95, vcc
v_mfma_f32_32x32x16_bf16 a[160:175], a[80:83], v[96:99], a[160:175]
ds_read_b128 a[64:67], v2 offset:24576
buffer_load_dwordx4 v1, s[8:11], s24 offen offset:1024 sc1 lds
v_mov_b32 v64, v31
v_mov_b32 v65, v31
v_mov_b32 v66, v31
v_mov_b32 v67, v31
v_mov_b32 v68, v31
v_mov_b32 v69, v31
v_mfma_f32_32x32x16_bf16 a[176:191], a[80:83], v[104:107], a[176:191]
s_waitcnt lgkmcnt(3)
buffer_load_dwordx4 v1, s[8:11], s24 offen offset:2048 sc1 lds
v_mov_b32 v70, v31
v_mov_b32 v71, v31
v_mov_b32 v72, v31
v_mov_b32 v73, v31
v_mov_b32 v74, v31
v_mfma_f32_32x32x16_bf16 a[160:175], a[84:87], v[100:103], a[160:175]
ds_read_b128 a[68:71], v2 offset:25600
buffer_load_dwordx4 v1, s[8:11], s24 offen offset:3072 sc1 lds
v_mov_b32 v75, v31
v_mov_b32 v76, v31
v_mov_b32 v77, v31
v_mov_b32 v78, v31
v_mov_b32 v79, v31
v_max3_f32 v26, v64, v65, v66
v_mfma_f32_32x32x16_bf16 a[176:191], a[84:87], v[108:111], a[176:191]
s_waitcnt lgkmcnt(3)
s_add_u32 s46, s46, 32768
v_max3_f32 v26, v26, v67, v68
v_max3_f32 v26, v26, v69, v70
v_max3_f32 v26, v26, v71, v72
v_max3_f32 v26, v26, v73, v74
v_max3_f32 v26, v26, v75, v76
v_mfma_f32_32x32x16_bf16 a[192:207], a[88:91], v[96:99], a[192:207]
ds_read_b128 a[72:75], v2 offset:26624
s_add_u32 s47, s47, 32768
v_max3_f32 v26, v26, v77, v78
v_max3_f32 v26, v26, v79, v80
v_max3_f32 v26, v26, v81, v82
v_max3_f32 v26, v26, v83, v84
v_max3_f32 v26, v26, v85, v86
v_max3_f32 v26, v26, v87, v88
v_mfma_f32_32x32x16_bf16 a[208:223], a[88:91], v[104:107], a[208:223]
s_waitcnt lgkmcnt(3)
s_and_b32 s47, s47, 131071
v_max3_f32 v26, v26, v89, v90
v_max3_f32 v26, v26, v91, v92
v_max3_f32 v26, v26, v93, v94
v_max_f32 v26, v26, v95
v_cmp_lt_f32 vcc, s54, v26
v_mfma_f32_32x32x16_bf16 a[192:207], a[92:95], v[100:103], a[192:207]
ds_read_b128 a[76:79], v2 offset:27648
s_cbranch_vccnz L_at_upd
L_at_uprd:
v_exp_f32 v64, v64
v_exp_f32 v65, v65
v_exp_f32 v66, v66
v_add_f32 v22, v22, v64
v_add_f32 v22, v22, v65
v_exp_f32 v67, v67
v_cvt_pk_bf16_f32 v112, v64, v65
v_exp_f32 v68, v68
v_add_f32 v22, v22, v66
v_add_f32 v22, v22, v67
v_exp_f32 v69, v69
v_cvt_pk_bf16_f32 v113, v66, v67
v_exp_f32 v70, v70
v_add_f32 v22, v22, v68
v_add_f32 v22, v22, v69
v_exp_f32 v71, v71
v_cvt_pk_bf16_f32 v114, v68, v69
v_exp_f32 v72, v72
v_add_f32 v22, v22, v70
v_add_f32 v22, v22, v71
v_exp_f32 v73, v73
v_cvt_pk_bf16_f32 v115, v70, v71
v_exp_f32 v74, v74
v_add_f32 v22, v22, v72
v_add_f32 v22, v22, v73
v_exp_f32 v75, v75
v_cvt_pk_bf16_f32 v116, v72, v73
v_exp_f32 v76, v76
v_add_f32 v22, v22, v74
v_add_f32 v22, v22, v75
v_exp_f32 v77, v77
v_cvt_pk_bf16_f32 v117, v74, v75
v_exp_f32 v78, v78
v_add_f32 v22, v22, v76
v_add_f32 v22, v22, v77
v_exp_f32 v79, v79
v_cvt_pk_bf16_f32 v118, v76, v77
v_exp_f32 v80, v80
v_add_f32 v22, v22, v78
v_mfma_f32_32x32x16_bf16 a[208:223], a[92:95], v[108:111], a[208:223]
s_waitcnt lgkmcnt(3)
s_cmp_eq_u32 s48, 0
s_cbranch_scc0 L_at_rsd
L_at_rsrd:
v_add_f32 v22, v22, v79
v_exp_f32 v81, v81
v_cvt_pk_bf16_f32 v119, v78, v79
v_exp_f32 v82, v82
v_add_f32 v23, v23, v80
v_add_f32 v23, v23, v81
v_exp_f32 v83, v83
v_cvt_pk_bf16_f32 v120, v80, v81
v_exp_f32 v84, v84
v_add_f32 v23, v23, v82
v_add_f32 v23, v23, v83
v_exp_f32 v85, v85
v_cvt_pk_bf16_f32 v121, v82, v83
v_exp_f32 v86, v86
v_add_f32 v23, v23, v84
v_add_f32 v23, v23, v85
v_exp_f32 v87, v87
v_cvt_pk_bf16_f32 v122, v84, v85
v_exp_f32 v88, v88
v_add_f32 v23, v23, v86
v_add_f32 v23, v23, v87
v_exp_f32 v89, v89
v_cvt_pk_bf16_f32 v123, v86, v87
v_exp_f32 v90, v90
v_add_f32 v23, v23, v88
v_add_f32 v23, v23, v89
v_exp_f32 v91, v91
v_cvt_pk_bf16_f32 v124, v88, v89
v_exp_f32 v92, v92
v_add_f32 v23, v23, v90
v_add_f32 v23, v23, v91
v_exp_f32 v93, v93
v_cvt_pk_bf16_f32 v125, v90, v91
v_exp_f32 v94, v94
v_add_f32 v23, v23, v92
v_add_f32 v23, v23, v93
v_exp_f32 v95, v95
v_cvt_pk_bf16_f32 v126, v92, v93
v_add_f32 v23, v23, v94
v_add_f32 v23, v23, v95
v_cvt_pk_bf16_f32 v127, v94, v95
v_mfma_f32_32x32x16_bf16 a[96:111], a[64:67], v[112:115], a[96:111]
ds_read_b128 a[80:83], v2 offset:28672
v_mfma_f32_32x32x16_bf16 a[112:127], a[64:67], v[120:123], a[112:127]
s_waitcnt lgkmcnt(3)
v_mfma_f32_32x32x16_bf16 a[96:111], a[68:71], v[116:119], a[96:111]
ds_read_b128 a[84:87], v2 offset:29696
v_mfma_f32_32x32x16_bf16 a[112:127], a[68:71], v[124:127], a[112:127]
s_waitcnt lgkmcnt(3)
v_mfma_f32_32x32x16_bf16 a[128:143], a[72:75], v[112:115], a[128:143]
ds_read_b128 a[88:91], v2 offset:30720
v_mfma_f32_32x32x16_bf16 a[144:159], a[72:75], v[120:123], a[144:159]
s_waitcnt lgkmcnt(3)
v_mfma_f32_32x32x16_bf16 a[128:143], a[76:79], v[116:119], a[128:143]
ds_read_b128 a[92:95], v2 offset:31744
v_mfma_f32_32x32x16_bf16 a[144:159], a[76:79], v[124:127], a[144:159]
s_waitcnt lgkmcnt(3)
v_mfma_f32_32x32x16_bf16 a[160:175], a[80:83], v[112:115], a[160:175]
v_mfma_f32_32x32x16_bf16 a[176:191], a[80:83], v[120:123], a[176:191]
s_waitcnt lgkmcnt(2)
v_mfma_f32_32x32x16_bf16 a[160:175], a[84:87], v[116:119], a[160:175]
v_mfma_f32_32x32x16_bf16 a[176:191], a[84:87], v[124:127], a[176:191]
s_waitcnt lgkmcnt(1)
v_mfma_f32_32x32x16_bf16 a[192:207], a[88:91], v[112:115], a[192:207]
v_mfma_f32_32x32x16_bf16 a[208:223], a[88:91], v[120:123], a[208:223]
s_waitcnt lgkmcnt(0)
v_mfma_f32_32x32x16_bf16 a[192:207], a[92:95], v[116:119], a[192:207]
v_mfma_f32_32x32x16_bf16 a[208:223], a[92:95], v[124:127], a[208:223]
s_lshl_b32 s26, s44, 19
s_lshl_b32 s27, s42, 12
s_add_u32 s26, s26, s27
s_add_u32 s26, s26, 67108864
s_add_u32 s27, s26, 262144
L_at_idle:
s_add_u32 s43, s43, 1
s_cmp_ge_u32 s43, s45
s_cbranch_scc1 L_at_fin
s_waitcnt vmcnt(0)
s_barrier
s_branch L_at_idle
L_at_upa:
v_max3_f32 v26, v32, v33, v34
v_max3_f32 v26, v26, v35, v36
v_max3_f32 v26, v26, v37, v38
v_max3_f32 v26, v26, v39, v40
v_max3_f32 v26, v26, v41, v42
v_max3_f32 v26, v26, v43, v44
v_max3_f32 v26, v26, v45, v46
v_max_f32 v26, v26, v47
v_mov_b32 v27, v26
s_nop 1
v_permlane32_swap_b32 v27, v26
v_max3_f32 v26, v26, v27, s55
v_exp_f32 v24, -v26
v_sub_f32 v32, v32, v26
v_sub_f32 v128, v128, v26
v_sub_f32 v33, v33, v26
v_sub_f32 v129, v129, v26
v_sub_f32 v34, v34, v26
v_sub_f32 v130, v130, v26
v_sub_f32 v35, v35, v26
v_sub_f32 v131, v131, v26
v_sub_f32 v36, v36, v26
v_sub_f32 v132, v132, v26
v_sub_f32 v37, v37, v26
v_sub_f32 v133, v133, v26
v_sub_f32 v38, v38, v26
v_sub_f32 v134, v134, v26
v_sub_f32 v39, v39, v26
v_sub_f32 v135, v135, v26
v_sub_f32 v40, v40, v26
v_sub_f32 v136, v136, v26
v_sub_f32 v41, v41, v26
v_sub_f32 v137, v137, v26
v_sub_f32 v42, v42, v26
v_sub_f32 v138, v138, v26
v_sub_f32 v43, v43, v26
v_sub_f32 v139, v139, v26
v_sub_f32 v44, v44, v26
v_sub_f32 v140, v140, v26
v_sub_f32 v45, v45, v26
v_sub_f32 v141, v141, v26
v_sub_f32 v46, v46, v26
v_sub_f32 v142, v142, v26
v_sub_f32 v47, v47, v26
v_sub_f32 v143, v143, v26
v_min_f32 v24, 1.0, v24
v_mul_f32 v22, v22, v24
v_max3_f32 v26, v48, v49, v50
v_max3_f32 v26, v26, v51, v52
v_max3_f32 v26, v26, v53, v54
v_max3_f32 v26, v26, v55, v56
v_max3_f32 v26, v26, v57, v58
v_max3_f32 v26, v26, v59, v60
v_max3_f32 v26, v26, v61, v62
v_max_f32 v26, v26, v63
v_mov_b32 v27, v26
s_nop 1
v_permlane32_swap_b32 v27, v26
v_max3_f32 v26, v26, v27, s55
v_exp_f32 v25, -v26
v_sub_f32 v48, v48, v26
v_sub_f32 v144, v144, v26
v_sub_f32 v49, v49, v26
v_sub_f32 v145, v145, v26
v_sub_f32 v50, v50, v26
v_sub_f32 v146, v146, v26
v_sub_f32 v51, v51, v26
v_sub_f32 v147, v147, v26
v_sub_f32 v52, v52, v26
v_sub_f32 v148, v148, v26
v_sub_f32 v53, v53, v26
v_sub_f32 v149, v149, v26
v_sub_f32 v54, v54, v26
v_sub_f32 v150, v150, v26
v_sub_f32 v55, v55, v26
v_sub_f32 v151, v151, v26
v_sub_f32 v56, v56, v26
v_sub_f32 v152, v152, v26
v_sub_f32 v57, v57, v26
v_sub_f32 v153, v153, v26
v_sub_f32 v58, v58, v26
v_sub_f32 v154, v154, v26
v_sub_f32 v59, v59, v26
v_sub_f32 v155, v155, v26
v_sub_f32 v60, v60, v26
v_sub_f32 v156, v156, v26
v_sub_f32 v61, v61, v26
v_sub_f32 v157, v157, v26
v_sub_f32 v62, v62, v26
v_sub_f32 v158, v158, v26
v_sub_f32 v63, v63, v26
v_sub_f32 v159, v159, v26
v_min_f32 v25, 1.0, v25
v_mul_f32 v23, v23, v25
s_cmp_eq_u32 s55, 0
s_cselect_b32 s48, 1, 0
s_mov_b32 s55, 0
s_mov_b32 s54, s51
s_branch L_at_upra
L_at_rsa:
s_mov_b32 s52, 0
s_branch L_at_rescale
L_at_upb:
v_max3_f32 v26, v64, v65, v66
v_max3_f32 v26, v26, v67, v68
v_max3_f32 v26, v26, v69, v70
v_max3_f32 v26, v26, v71, v72
v_max3_f32 v26, v26, v73, v74
v_max3_f32 v26, v26, v75, v76
v_max3_f32 v26, v26, v77, v78
v_max_f32 v26, v26, v79
v_mov_b32 v27, v26
s_nop 1
v_permlane32_swap_b32 v27, v26
v_max3_f32 v26, v26, v27, s55
v_exp_f32 v24, -v26
v_sub_f32 v64, v64, v26
v_sub_f32 v128, v128, v26
v_sub_f32 v65, v65, v26
v_sub_f32 v129, v129, v26
v_sub_f32 v66, v66, v26
v_sub_f32 v130, v130, v26
v_sub_f32 v67, v67, v26
v_sub_f32 v131, v131, v26
v_sub_f32 v68, v68, v26
v_sub_f32 v132, v132, v26
v_sub_f32 v69, v69, v26
v_sub_f32 v133, v133, v26
v_sub_f32 v70, v70, v26
v_sub_f32 v134, v134, v26
v_sub_f32 v71, v71, v26
v_sub_f32 v135, v135, v26
v_sub_f32 v72, v72, v26
v_sub_f32 v136, v136, v26
v_sub_f32 v73, v73, v26
v_sub_f32 v137, v137, v26
v_sub_f32 v74, v74, v26
v_sub_f32 v138, v138, v26
v_sub_f32 v75, v75, v26
v_sub_f32 v139, v139, v26
v_sub_f32 v76, v76, v26
v_sub_f32 v140, v140, v26
v_sub_f32 v77, v77, v26
v_sub_f32 v141, v141, v26
v_sub_f32 v78, v78, v26
v_sub_f32 v142, v142, v26
v_sub_f32 v79, v79, v26
v_sub_f32 v143, v143, v26
v_min_f32 v24, 1.0, v24
v_mul_f32 v22, v22, v24
v_max3_f32 v26, v80, v81, v82
v_max3_f32 v26, v26, v83, v84
v_max3_f32 v26, v26, v85, v86
v_max3_f32 v26, v26, v87, v88
v_max3_f32 v26, v26, v89, v90
v_max3_f32 v26, v26, v91, v92
v_max3_f32 v26, v26, v93, v94
v_max_f32 v26, v26, v95
v_mov_b32 v27, v26
s_nop 1
v_permlane32_swap_b32 v27, v26
v_max3_f32 v26, v26, v27, s55
v_exp_f32 v25, -v26
v_sub_f32 v80, v80, v26
v_sub_f32 v144, v144, v26
v_sub_f32 v81, v81, v26
v_sub_f32 v145, v145, v26
v_sub_f32 v82, v82, v26
v_sub_f32 v146, v146, v26
v_sub_f32 v83, v83, v26
v_sub_f32 v147, v147, v26
v_sub_f32 v84, v84, v26
v_sub_f32 v148, v148, v26
v_sub_f32 v85, v85, v26
v_sub_f32 v149, v149, v26
v_sub_f32 v86, v86, v26
v_sub_f32 v150, v150, v26
v_sub_f32 v87, v87, v26
v_sub_f32 v151, v151, v26
v_sub_f32 v88, v88, v26
v_sub_f32 v152, v152, v26
v_sub_f32 v89, v89, v26
v_sub_f32 v153, v153, v26
v_sub_f32 v90, v90, v26
v_sub_f32 v154, v154, v26
v_sub_f32 v91, v91, v26
v_sub_f32 v155, v155, v26
v_sub_f32 v92, v92, v26
v_sub_f32 v156, v156, v26
v_sub_f32 v93, v93, v26
v_sub_f32 v157, v157, v26
v_sub_f32 v94, v94, v26
v_sub_f32 v158, v158, v26
v_sub_f32 v95, v95, v26
v_sub_f32 v159, v159, v26
v_min_f32 v25, 1.0, v25
v_mul_f32 v23, v23, v25
s_cmp_eq_u32 s55, 0
s_cselect_b32 s48, 1, 0
s_mov_b32 s55, 0
s_mov_b32 s54, s51
s_branch L_at_uprb
L_at_rsb:
s_mov_b32 s52, 1
s_branch L_at_rescale
L_at_upc:
v_max3_f32 v26, v32, v33, v34
v_max3_f32 v26, v26, v35, v36
v_max3_f32 v26, v26, v37, v38
v_max3_f32 v26, v26, v39, v40
v_max3_f32 v26, v26, v41, v42
v_max3_f32 v26, v26, v43, v44
v_max3_f32 v26, v26, v45, v46
v_max_f32 v26, v26, v47
v_mov_b32 v27, v26
s_nop 1
v_permlane32_swap_b32 v27, v26
v_max3_f32 v26, v26, v27, s55
v_exp_f32 v24, -v26
v_sub_f32 v32, v32, v26
v_sub_f32 v128, v128, v26
v_sub_f32 v33, v33, v26
v_sub_f32 v129, v129, v26
v_sub_f32 v34, v34, v26
v_sub_f32 v130, v130, v26
v_sub_f32 v35, v35, v26
v_sub_f32 v131, v131, v26
v_sub_f32 v36, v36, v26
v_sub_f32 v132, v132, v26
v_sub_f32 v37, v37, v26
v_sub_f32 v133, v133, v26
v_sub_f32 v38, v38, v26
v_sub_f32 v134, v134, v26
v_sub_f32 v39, v39, v26
v_sub_f32 v135, v135, v26
v_sub_f32 v40, v40, v26
v_sub_f32 v136, v136, v26
v_sub_f32 v41, v41, v26
v_sub_f32 v137, v137, v26
v_sub_f32 v42, v42, v26
v_sub_f32 v138, v138, v26
v_sub_f32 v43, v43, v26
v_sub_f32 v139, v139, v26
v_sub_f32 v44, v44, v26
v_sub_f32 v140, v140, v26
v_sub_f32 v45, v45, v26
v_sub_f32 v141, v141, v26
v_sub_f32 v46, v46, v26
v_sub_f32 v142, v142, v26
v_sub_f32 v47, v47, v26
v_sub_f32 v143, v143, v26
v_min_f32 v24, 1.0, v24
v_mul_f32 v22, v22, v24
v_max3_f32 v26, v48, v49, v50
v_max3_f32 v26, v26, v51, v52
v_max3_f32 v26, v26, v53, v54
v_max3_f32 v26, v26, v55, v56
v_max3_f32 v26, v26, v57, v58
v_max3_f32 v26, v26, v59, v60
v_max3_f32 v26, v26, v61, v62
v_max_f32 v26, v26, v63
v_mov_b32 v27, v26
s_nop 1
v_permlane32_swap_b32 v27, v26
v_max3_f32 v26, v26, v27, s55
v_exp_f32 v25, -v26
v_sub_f32 v48, v48, v26
v_sub_f32 v144, v144, v26
v_sub_f32 v49, v49, v26
v_sub_f32 v145, v145, v26
v_sub_f32 v50, v50, v26
v_sub_f32 v146, v146, v26
v_sub_f32 v51, v51, v26
v_sub_f32 v147, v147, v26
v_sub_f32 v52, v52, v26
v_sub_f32 v148, v148, v26
v_sub_f32 v53, v53, v26
v_sub_f32 v149, v149, v26
v_sub_f32 v54, v54, v26
v_sub_f32 v150, v150, v26
v_sub_f32 v55, v55, v26
v_sub_f32 v151, v151, v26
v_sub_f32 v56, v56, v26
v_sub_f32 v152, v152, v26
v_sub_f32 v57, v57, v26
v_sub_f32 v153, v153, v26
v_sub_f32 v58, v58, v26
v_sub_f32 v154, v154, v26
v_sub_f32 v59, v59, v26
v_sub_f32 v155, v155, v26
v_sub_f32 v60, v60, v26
v_sub_f32 v156, v156, v26
v_sub_f32 v61, v61, v26
v_sub_f32 v157, v157, v26
v_sub_f32 v62, v62, v26
v_sub_f32 v158, v158, v26
v_sub_f32 v63, v63, v26
v_sub_f32 v159, v159, v26
v_min_f32 v25, 1.0, v25
v_mul_f32 v23, v23, v25
s_cmp_eq_u32 s55, 0
s_cselect_b32 s48, 1, 0
s_mov_b32 s55, 0
s_mov_b32 s54, s51
s_branch L_at_uprc
L_at_rsc:
s_mov_b32 s52, 2
s_branch L_at_rescale
L_at_upd:
v_max3_f32 v26, v64, v65, v66
v_max3_f32 v26, v26, v67, v68
v_max3_f32 v26, v26, v69, v70
v_max3_f32 v26, v26, v71, v72
v_max3_f32 v26, v26, v73, v74
v_max3_f32 v26, v26, v75, v76
v_max3_f32 v26, v26, v77, v78
v_max_f32 v26, v26, v79
v_mov_b32 v27, v26
s_nop 1
v_permlane32_swap_b32 v27, v26
v_max3_f32 v26, v26, v27, s55
v_exp_f32 v24, -v26
v_sub_f32 v64, v64, v26
v_sub_f32 v128, v128, v26
v_sub_f32 v65, v65, v26
v_sub_f32 v129, v129, v26
v_sub_f32 v66, v66, v26
v_sub_f32 v130, v130, v26
v_sub_f32 v67, v67, v26
v_sub_f32 v131, v131, v26
v_sub_f32 v68, v68, v26
v_sub_f32 v132, v132, v26
v_sub_f32 v69, v69, v26
v_sub_f32 v133, v133, v26
v_sub_f32 v70, v70, v26
v_sub_f32 v134, v134, v26
v_sub_f32 v71, v71, v26
v_sub_f32 v135, v135, v26
v_sub_f32 v72, v72, v26
v_sub_f32 v136, v136, v26
v_sub_f32 v73, v73, v26
v_sub_f32 v137, v137, v26
v_sub_f32 v74, v74, v26
v_sub_f32 v138, v138, v26
v_sub_f32 v75, v75, v26
v_sub_f32 v139, v139, v26
v_sub_f32 v76, v76, v26
v_sub_f32 v140, v140, v26
v_sub_f32 v77, v77, v26
v_sub_f32 v141, v141, v26
v_sub_f32 v78, v78, v26
v_sub_f32 v142, v142, v26
v_sub_f32 v79, v79, v26
v_sub_f32 v143, v143, v26
v_min_f32 v24, 1.0, v24
v_mul_f32 v22, v22, v24
v_max3_f32 v26, v80, v81, v82
v_max3_f32 v26, v26, v83, v84
v_max3_f32 v26, v26, v85, v86
v_max3_f32 v26, v26, v87, v88
v_max3_f32 v26, v26, v89, v90
v_max3_f32 v26, v26, v91, v92
v_max3_f32 v26, v26, v93, v94
v_max_f32 v26, v26, v95
v_mov_b32 v27, v26
s_nop 1
v_permlane32_swap_b32 v27, v26
v_max3_f32 v26, v26, v27, s55
v_exp_f32 v25, -v26
v_sub_f32 v80, v80, v26
v_sub_f32 v144, v144, v26
v_sub_f32 v81, v81, v26
v_sub_f32 v145, v145, v26
v_sub_f32 v82, v82, v26
v_sub_f32 v146, v146, v26
v_sub_f32 v83, v83, v26
v_sub_f32 v147, v147, v26
v_sub_f32 v84, v84, v26
v_sub_f32 v148, v148, v26
v_sub_f32 v85, v85, v26
v_sub_f32 v149, v149, v26
v_sub_f32 v86, v86, v26
v_sub_f32 v150, v150, v26
v_sub_f32 v87, v87, v26
v_sub_f32 v151, v151, v26
v_sub_f32 v88, v88, v26
v_sub_f32 v152, v152, v26
v_sub_f32 v89, v89, v26
v_sub_f32 v153, v153, v26
v_sub_f32 v90, v90, v26
v_sub_f32 v154, v154, v26
v_sub_f32 v91, v91, v26
v_sub_f32 v155, v155, v26
v_sub_f32 v92, v92, v26
v_sub_f32 v156, v156, v26
v_sub_f32 v93, v93, v26
v_sub_f32 v157, v157, v26
v_sub_f32 v94, v94, v26
v_sub_f32 v158, v158, v26
v_sub_f32 v95, v95, v26
v_sub_f32 v159, v159, v26
v_min_f32 v25, 1.0, v25
v_mul_f32 v23, v23, v25
s_cmp_eq_u32 s55, 0
s_cselect_b32 s48, 1, 0
s_mov_b32 s55, 0
s_mov_b32 s54, s51
s_branch L_at_uprd
L_at_rsd:
s_mov_b32 s52, 3
s_branch L_at_rescale
L_at_rescale:
s_nop 7
s_nop 3
v_accvgpr_read_b32 v160, a96
v_accvgpr_read_b32 v161, a97
v_accvgpr_read_b32 v162, a98
v_accvgpr_read_b32 v163, a99
v_accvgpr_read_b32 v164, a100
v_accvgpr_read_b32 v165, a101
v_accvgpr_read_b32 v166, a102
v_accvgpr_read_b32 v167, a103
v_mul_f32 v160, v160, v24
v_mul_f32 v161, v161, v24
v_mul_f32 v162, v162, v24
v_mul_f32 v163, v163, v24
v_mul_f32 v164, v164, v24
v_mul_f32 v165, v165, v24
v_mul_f32 v166, v166, v24
v_mul_f32 v167, v167, v24
v_accvgpr_write_b32 a96, v160
v_accvgpr_write_b32 a97, v161
v_accvgpr_write_b32 a98, v162
v_accvgpr_write_b32 a99, v163
v_accvgpr_write_b32 a100, v164
v_accvgpr_write_b32 a101, v165
v_accvgpr_write_b32 a102, v166
v_accvgpr_write_b32 a103, v167
v_accvgpr_read_b32 v160, a104
v_accvgpr_read_b32 v161, a105
v_accvgpr_read_b32 v162, a106
v_accvgpr_read_b32 v163, a107
v_accvgpr_read_b32 v164, a108
v_accvgpr_read_b32 v165, a109
v_accvgpr_read_b32 v166, a110
v_accvgpr_read_b32 v167, a111
v_mul_f32 v160, v160, v24
v_mul_f32 v161, v161, v24
v_mul_f32 v162, v162, v24
v_mul_f32 v163, v163, v24
v_mul_f32 v164, v164, v24
v_mul_f32 v165, v165, v24
v_mul_f32 v166, v166, v24
v_mul_f32 v167, v167, v24
v_accvgpr_write_b32 a104, v160
v_accvgpr_write_b32 a105, v161
v_accvgpr_write_b32 a106, v162
v_accvgpr_write_b32 a107, v163
v_accvgpr_write_b32 a108, v164
v_accvgpr_write_b32 a109, v165
v_accvgpr_write_b32 a110, v166
v_accvgpr_write_b32 a111, v167
v_accvgpr_read_b32 v160, a112
v_accvgpr_read_b32 v161, a113
v_accvgpr_read_b32 v162, a114
v_accvgpr_read_b32 v163, a115
v_accvgpr_read_b32 v164, a116
v_accvgpr_read_b32 v165, a117
v_accvgpr_read_b32 v166, a118
v_accvgpr_read_b32 v167, a119
v_mul_f32 v160, v160, v25
v_mul_f32 v161, v161, v25
v_mul_f32 v162, v162, v25
v_mul_f32 v163, v163, v25
v_mul_f32 v164, v164, v25
v_mul_f32 v165, v165, v25
v_mul_f32 v166, v166, v25
v_mul_f32 v167, v167, v25
v_accvgpr_write_b32 a112, v160
v_accvgpr_write_b32 a113, v161
v_accvgpr_write_b32 a114, v162
v_accvgpr_write_b32 a115, v163
v_accvgpr_write_b32 a116, v164
v_accvgpr_write_b32 a117, v165
v_accvgpr_write_b32 a118, v166
v_accvgpr_write_b32 a119, v167
v_accvgpr_read_b32 v160, a120
v_accvgpr_read_b32 v161, a121
v_accvgpr_read_b32 v162, a122
v_accvgpr_read_b32 v163, a123
v_accvgpr_read_b32 v164, a124
v_accvgpr_read_b32 v165, a125
v_accvgpr_read_b32 v166, a126
v_accvgpr_read_b32 v167, a127
v_mul_f32 v160, v160, v25
v_mul_f32 v161, v161, v25
v_mul_f32 v162, v162, v25
v_mul_f32 v163, v163, v25
v_mul_f32 v164, v164, v25
v_mul_f32 v165, v165, v25
v_mul_f32 v166, v166, v25
v_mul_f32 v167, v167, v25
v_accvgpr_write_b32 a120, v160
v_accvgpr_write_b32 a121, v161
v_accvgpr_write_b32 a122, v162
v_accvgpr_write_b32 a123, v163
v_accvgpr_write_b32 a124, v164
v_accvgpr_write_b32 a125, v165
v_accvgpr_write_b32 a126, v166
v_accvgpr_write_b32 a127, v167
v_accvgpr_read_b32 v160, a128
v_accvgpr_read_b32 v161, a129
v_accvgpr_read_b32 v162, a130
v_accvgpr_read_b32 v163, a131
v_accvgpr_read_b32 v164, a132
v_accvgpr_read_b32 v165, a133
v_accvgpr_read_b32 v166, a134
v_accvgpr_read_b32 v167, a135
v_mul_f32 v160, v160, v24
v_mul_f32 v161, v161, v24
v_mul_f32 v162, v162, v24
v_mul_f32 v163, v163, v24
v_mul_f32 v164, v164, v24
v_mul_f32 v165, v165, v24
v_mul_f32 v166, v166, v24
v_mul_f32 v167, v167, v24
v_accvgpr_write_b32 a128, v160
v_accvgpr_write_b32 a129, v161
v_accvgpr_write_b32 a130, v162
v_accvgpr_write_b32 a131, v163
v_accvgpr_write_b32 a132, v164
v_accvgpr_write_b32 a133, v165
v_accvgpr_write_b32 a134, v166
v_accvgpr_write_b32 a135, v167
v_accvgpr_read_b32 v160, a136
v_accvgpr_read_b32 v161, a137
v_accvgpr_read_b32 v162, a138
v_accvgpr_read_b32 v163, a139
v_accvgpr_read_b32 v164, a140
v_accvgpr_read_b32 v165, a141
v_accvgpr_read_b32 v166, a142
v_accvgpr_read_b32 v167, a143
v_mul_f32 v160, v160, v24
v_mul_f32 v161, v161, v24
v_mul_f32 v162, v162, v24
v_mul_f32 v163, v163, v24
v_mul_f32 v164, v164, v24
v_mul_f32 v165, v165, v24
v_mul_f32 v166, v166, v24
v_mul_f32 v167, v167, v24
v_accvgpr_write_b32 a136, v160
v_accvgpr_write_b32 a137, v161
v_accvgpr_write_b32 a138, v162
v_accvgpr_write_b32 a139, v163
v_accvgpr_write_b32 a140, v164
v_accvgpr_write_b32 a141, v165
v_accvgpr_write_b32 a142, v166
v_accvgpr_write_b32 a143, v167
v_accvgpr_read_b32 v160, a144
v_accvgpr_read_b32 v161, a145
v_accvgpr_read_b32 v162, a146
v_accvgpr_read_b32 v163, a147
v_accvgpr_read_b32 v164, a148
v_accvgpr_read_b32 v165, a149
v_accvgpr_read_b32 v166, a150
v_accvgpr_read_b32 v167, a151
v_mul_f32 v160, v160, v25
v_mul_f32 v161, v161, v25
v_mul_f32 v162, v162, v25
v_mul_f32 v163, v163, v25
v_mul_f32 v164, v164, v25
v_mul_f32 v165, v165, v25
v_mul_f32 v166, v166, v25
v_mul_f32 v167, v167, v25
v_accvgpr_write_b32 a144, v160
v_accvgpr_write_b32 a145, v161
v_accvgpr_write_b32 a146, v162
v_accvgpr_write_b32 a147, v163
v_accvgpr_write_b32 a148, v164
v_accvgpr_write_b32 a149, v165
v_accvgpr_write_b32 a150, v166
v_accvgpr_write_b32 a151, v167
v_accvgpr_read_b32 v160, a152
v_accvgpr_read_b32 v161, a153
v_accvgpr_read_b32 v162, a154
v_accvgpr_read_b32 v163, a155
v_accvgpr_read_b32 v164, a156
v_accvgpr_read_b32 v165, a157
v_accvgpr_read_b32 v166, a158
v_accvgpr_read_b32 v167, a159
v_mul_f32 v160, v160, v25
v_mul_f32 v161, v161, v25
v_mul_f32 v162, v162, v25
v_mul_f32 v163, v163, v25
v_mul_f32 v164, v164, v25
v_mul_f32 v165, v165, v25
v_mul_f32 v166, v166, v25
v_mul_f32 v167, v167, v25
v_accvgpr_write_b32 a152, v160
v_accvgpr_write_b32 a153, v161
v_accvgpr_write_b32 a154, v162
v_accvgpr_write_b32 a155, v163
v_accvgpr_write_b32 a156, v164
v_accvgpr_write_b32 a157, v165
v_accvgpr_write_b32 a158, v166
v_accvgpr_write_b32 a159, v167
v_accvgpr_read_b32 v160, a160
v_accvgpr_read_b32 v161, a161
v_accvgpr_read_b32 v162, a162
v_accvgpr_read_b32 v163, a163
v_accvgpr_read_b32 v164, a164
v_accvgpr_read_b32 v165, a165
v_accvgpr_read_b32 v166, a166
v_accvgpr_read_b32 v167, a167
v_mul_f32 v160, v160, v24
v_mul_f32 v161, v161, v24
v_mul_f32 v162, v162, v24
v_mul_f32 v163, v163, v24
v_mul_f32 v164, v164, v24
v_mul_f32 v165, v165, v24
v_mul_f32 v166, v166, v24
v_mul_f32 v167, v167, v24
v_accvgpr_write_b32 a160, v160
v_accvgpr_write_b32 a161, v161
v_accvgpr_write_b32 a162, v162
v_accvgpr_write_b32 a163, v163
v_accvgpr_write_b32 a164, v164
v_accvgpr_write_b32 a165, v165
v_accvgpr_write_b32 a166, v166
v_accvgpr_write_b32 a167, v167
v_accvgpr_read_b32 v160, a168
v_accvgpr_read_b32 v161, a169
v_accvgpr_read_b32 v162, a170
v_accvgpr_read_b32 v163, a171
v_accvgpr_read_b32 v164, a172
v_accvgpr_read_b32 v165, a173
v_accvgpr_read_b32 v166, a174
v_accvgpr_read_b32 v167, a175
v_mul_f32 v160, v160, v24
v_mul_f32 v161, v161, v24
v_mul_f32 v162, v162, v24
v_mul_f32 v163, v163, v24
v_mul_f32 v164, v164, v24
v_mul_f32 v165, v165, v24
v_mul_f32 v166, v166, v24
v_mul_f32 v167, v167, v24
v_accvgpr_write_b32 a168, v160
v_accvgpr_write_b32 a169, v161
v_accvgpr_write_b32 a170, v162
v_accvgpr_write_b32 a171, v163
v_accvgpr_write_b32 a172, v164
v_accvgpr_write_b32 a173, v165
v_accvgpr_write_b32 a174, v166
v_accvgpr_write_b32 a175, v167
v_accvgpr_read_b32 v160, a176
v_accvgpr_read_b32 v161, a177
v_accvgpr_read_b32 v162, a178
v_accvgpr_read_b32 v163, a179
v_accvgpr_read_b32 v164, a180
v_accvgpr_read_b32 v165, a181
v_accvgpr_read_b32 v166, a182
v_accvgpr_read_b32 v167, a183
v_mul_f32 v160, v160, v25
v_mul_f32 v161, v161, v25
v_mul_f32 v162, v162, v25
v_mul_f32 v163, v163, v25
v_mul_f32 v164, v164, v25
v_mul_f32 v165, v165, v25
v_mul_f32 v166, v166, v25
v_mul_f32 v167, v167, v25
v_accvgpr_write_b32 a176, v160
v_accvgpr_write_b32 a177, v161
v_accvgpr_write_b32 a178, v162
v_accvgpr_write_b32 a179, v163
v_accvgpr_write_b32 a180, v164
v_accvgpr_write_b32 a181, v165
v_accvgpr_write_b32 a182, v166
v_accvgpr_write_b32 a183, v167
v_accvgpr_read_b32 v160, a184
v_accvgpr_read_b32 v161, a185
v_accvgpr_read_b32 v162, a186
v_accvgpr_read_b32 v163, a187
v_accvgpr_read_b32 v164, a188
v_accvgpr_read_b32 v165, a189
v_accvgpr_read_b32 v166, a190
v_accvgpr_read_b32 v167, a191
v_mul_f32 v160, v160, v25
v_mul_f32 v161, v161, v25
v_mul_f32 v162, v162, v25
v_mul_f32 v163, v163, v25
v_mul_f32 v164, v164, v25
v_mul_f32 v165, v165, v25
v_mul_f32 v166, v166, v25
v_mul_f32 v167, v167, v25
v_accvgpr_write_b32 a184, v160
v_accvgpr_write_b32 a185, v161
v_accvgpr_write_b32 a186, v162
v_accvgpr_write_b32 a187, v163
v_accvgpr_write_b32 a188, v164
v_accvgpr_write_b32 a189, v165
v_accvgpr_write_b32 a190, v166
v_accvgpr_write_b32 a191, v167
v_accvgpr_read_b32 v160, a192
v_accvgpr_read_b32 v161, a193
v_accvgpr_read_b32 v162, a194
v_accvgpr_read_b32 v163, a195
v_accvgpr_read_b32 v164, a196
v_accvgpr_read_b32 v165, a197
v_accvgpr_read_b32 v166, a198
v_accvgpr_read_b32 v167, a199
v_mul_f32 v160, v160, v24
v_mul_f32 v161, v161, v24
v_mul_f32 v162, v162, v24
v_mul_f32 v163, v163, v24
v_mul_f32 v164, v164, v24
v_mul_f32 v165, v165, v24
v_mul_f32 v166, v166, v24
v_mul_f32 v167, v167, v24
v_accvgpr_write_b32 a192, v160
v_accvgpr_write_b32 a193, v161
v_accvgpr_write_b32 a194, v162
v_accvgpr_write_b32 a195, v163
v_accvgpr_write_b32 a196, v164
v_accvgpr_write_b32 a197, v165
v_accvgpr_write_b32 a198, v166
v_accvgpr_write_b32 a199, v167
v_accvgpr_read_b32 v160, a200
v_accvgpr_read_b32 v161, a201
v_accvgpr_read_b32 v162, a202
v_accvgpr_read_b32 v163, a203
v_accvgpr_read_b32 v164, a204
v_accvgpr_read_b32 v165, a205
v_accvgpr_read_b32 v166, a206
v_accvgpr_read_b32 v167, a207
v_mul_f32 v160, v160, v24
v_mul_f32 v161, v161, v24
v_mul_f32 v162, v162, v24
v_mul_f32 v163, v163, v24
v_mul_f32 v164, v164, v24
v_mul_f32 v165, v165, v24
v_mul_f32 v166, v166, v24
v_mul_f32 v167, v167, v24
v_accvgpr_write_b32 a200, v160
v_accvgpr_write_b32 a201, v161
v_accvgpr_write_b32 a202, v162
v_accvgpr_write_b32 a203, v163
v_accvgpr_write_b32 a204, v164
v_accvgpr_write_b32 a205, v165
v_accvgpr_write_b32 a206, v166
v_accvgpr_write_b32 a207, v167
v_accvgpr_read_b32 v160, a208
v_accvgpr_read_b32 v161, a209
v_accvgpr_read_b32 v162, a210
v_accvgpr_read_b32 v163, a211
v_accvgpr_read_b32 v164, a212
v_accvgpr_read_b32 v165, a213
v_accvgpr_read_b32 v166, a214
v_accvgpr_read_b32 v167, a215
v_mul_f32 v160, v160, v25
v_mul_f32 v161, v161, v25
v_mul_f32 v162, v162, v25
v_mul_f32 v163, v163, v25
v_mul_f32 v164, v164, v25
v_mul_f32 v165, v165, v25
v_mul_f32 v166, v166, v25
v_mul_f32 v167, v167, v25
v_accvgpr_write_b32 a208, v160
v_accvgpr_write_b32 a209, v161
v_accvgpr_write_b32 a210, v162
v_accvgpr_write_b32 a211, v163
v_accvgpr_write_b32 a212, v164
v_accvgpr_write_b32 a213, v165
v_accvgpr_write_b32 a214, v166
v_accvgpr_write_b32 a215, v167
v_accvgpr_read_b32 v160, a216
v_accvgpr_read_b32 v161, a217
v_accvgpr_read_b32 v162, a218
v_accvgpr_read_b32 v163, a219
v_accvgpr_read_b32 v164, a220
v_accvgpr_read_b32 v165, a221
v_accvgpr_read_b32 v166, a222
v_accvgpr_read_b32 v167, a223
v_mul_f32 v160, v160, v25
v_mul_f32 v161, v161, v25
v_mul_f32 v162, v162, v25
v_mul_f32 v163, v163, v25
v_mul_f32 v164, v164, v25
v_mul_f32 v165, v165, v25
v_mul_f32 v166, v166, v25
v_mul_f32 v167, v167, v25
v_accvgpr_write_b32 a216, v160
v_accvgpr_write_b32 a217, v161
v_accvgpr_write_b32 a218, v162
v_accvgpr_write_b32 a219, v163
v_accvgpr_write_b32 a220, v164
v_accvgpr_write_b32 a221, v165
v_accvgpr_write_b32 a222, v166
v_accvgpr_write_b32 a223, v167
s_mov_b32 s48, 0
s_cmp_eq_u32 s52, 0
s_cbranch_scc1 L_at_rsra
s_cmp_eq_u32 s52, 1
s_cbranch_scc1 L_at_rsrb
s_cmp_eq_u32 s52, 2
s_cbranch_scc1 L_at_rsrc
s_branch L_at_rsrd
L_at_fin:
v_accvgpr_read_b32 v128, a96
v_accvgpr_read_b32 v129, a97
v_accvgpr_read_b32 v130, a98
v_accvgpr_read_b32 v131, a99
v_accvgpr_read_b32 v132, a100
v_accvgpr_read_b32 v133, a101
v_accvgpr_read_b32 v134, a102
v_accvgpr_read_b32 v135, a103
v_accvgpr_read_b32 v136, a104
v_accvgpr_read_b32 v137, a105
v_accvgpr_read_b32 v138, a106
v_accvgpr_read_b32 v139, a107
v_accvgpr_read_b32 v140, a108
v_accvgpr_read_b32 v141, a109
v_accvgpr_read_b32 v142, a110
v_accvgpr_read_b32 v143, a111
v_accvgpr_read_b32 v144, a112
v_accvgpr_read_b32 v145, a113
v_accvgpr_read_b32 v146, a114
v_accvgpr_read_b32 v147, a115
v_accvgpr_read_b32 v148, a116
v_accvgpr_read_b32 v149, a117
v_accvgpr_read_b32 v150, a118
v_accvgpr_read_b32 v151, a119
v_accvgpr_read_b32 v152, a120
v_accvgpr_read_b32 v153, a121
v_accvgpr_read_b32 v154, a122
v_accvgpr_read_b32 v155, a123
v_accvgpr_read_b32 v156, a124
v_accvgpr_read_b32 v157, a125
v_accvgpr_read_b32 v158, a126
v_accvgpr_read_b32 v159, a127
v_accvgpr_read_b32 v160, a128
v_accvgpr_read_b32 v161, a129
v_accvgpr_read_b32 v162, a130
v_accvgpr_read_b32 v163, a131
v_accvgpr_read_b32 v164, a132
v_accvgpr_read_b32 v165, a133
v_accvgpr_read_b32 v166, a134
v_accvgpr_read_b32 v167, a135
v_accvgpr_read_b32 v168, a136
v_accvgpr_read_b32 v169, a137
v_accvgpr_read_b32 v170, a138
v_accvgpr_read_b32 v171, a139
v_accvgpr_read_b32 v172, a140
v_accvgpr_read_b32 v173, a141
v_accvgpr_read_b32 v174, a142
v_accvgpr_read_b32 v175, a143
v_accvgpr_read_b32 v176, a144
v_accvgpr_read_b32 v177, a145
v_accvgpr_read_b32 v178, a146
v_accvgpr_read_b32 v179, a147
v_accvgpr_read_b32 v180, a148
v_accvgpr_read_b32 v181, a149
v_accvgpr_read_b32 v182, a150
v_accvgpr_read_b32 v183, a151
v_accvgpr_read_b32 v184, a152
v_accvgpr_read_b32 v185, a153
v_accvgpr_read_b32 v186, a154
v_accvgpr_read_b32 v187, a155
v_accvgpr_read_b32 v188, a156
v_accvgpr_read_b32 v189, a157
v_accvgpr_read_b32 v190, a158
v_accvgpr_read_b32 v191, a159
v_accvgpr_read_b32 v192, a160
v_accvgpr_read_b32 v193, a161
v_accvgpr_read_b32 v194, a162
v_accvgpr_read_b32 v195, a163
v_accvgpr_read_b32 v196, a164
v_accvgpr_read_b32 v197, a165
v_accvgpr_read_b32 v198, a166
v_accvgpr_read_b32 v199, a167
v_accvgpr_read_b32 v200, a168
v_accvgpr_read_b32 v201, a169
v_accvgpr_read_b32 v202, a170
v_accvgpr_read_b32 v203, a171
v_accvgpr_read_b32 v204, a172
v_accvgpr_read_b32 v205, a173
v_accvgpr_read_b32 v206, a174
v_accvgpr_read_b32 v207, a175
v_accvgpr_read_b32 v208, a176
v_accvgpr_read_b32 v209, a177
v_accvgpr_read_b32 v210, a178
v_accvgpr_read_b32 v211, a179
v_accvgpr_read_b32 v212, a180
v_accvgpr_read_b32 v213, a181
v_accvgpr_read_b32 v214, a182
v_accvgpr_read_b32 v215, a183
v_accvgpr_read_b32 v216, a184
v_accvgpr_read_b32 v217, a185
v_accvgpr_read_b32 v218, a186
v_accvgpr_read_b32 v219, a187
v_accvgpr_read_b32 v220, a188
v_accvgpr_read_b32 v221, a189
v_accvgpr_read_b32 v222, a190
v_accvgpr_read_b32 v223, a191
v_accvgpr_read_b32 v224, a192
v_accvgpr_read_b32 v225, a193
v_accvgpr_read_b32 v226, a194
v_accvgpr_read_b32 v227, a195
v_accvgpr_read_b32 v228, a196
v_accvgpr_read_b32 v229, a197
v_accvgpr_read_b32 v230, a198
v_accvgpr_read_b32 v231, a199
v_accvgpr_read_b32 v232, a200
v_accvgpr_read_b32 v233, a201
v_accvgpr_read_b32 v234, a202
v_accvgpr_read_b32 v235, a203
v_accvgpr_read_b32 v236, a204
v_accvgpr_read_b32 v237, a205
v_accvgpr_read_b32 v238, a206
v_accvgpr_read_b32 v239, a207
v_accvgpr_read_b32 v240, a208
v_accvgpr_read_b32 v241, a209
v_accvgpr_read_b32 v242, a210
v_accvgpr_read_b32 v243, a211
v_accvgpr_read_b32 v244, a212
v_accvgpr_read_b32 v245, a213
v_accvgpr_read_b32 v246, a214
v_accvgpr_read_b32 v247, a215
v_accvgpr_read_b32 v248, a216
v_accvgpr_read_b32 v249, a217
v_accvgpr_read_b32 v250, a218
v_accvgpr_read_b32 v251, a219
v_accvgpr_read_b32 v252, a220
v_accvgpr_read_b32 v253, a221
v_accvgpr_read_b32 v254, a222
v_accvgpr_read_b32 v255, a223
v_mov_b32 v26, v22
s_nop 1
v_permlane32_swap_b32 v26, v22
v_add_f32 v26, v26, v22
v_rcp_f32 v26, v26
s_nop 0
v_pk_mul_f32 v[128:129], v[128:129], v[26:27] op_sel_hi:[1,0]
v_pk_mul_f32 v[130:131], v[130:131], v[26:27] op_sel_hi:[1,0]
v_pk_mul_f32 v[132:133], v[132:133], v[26:27] op_sel_hi:[1,0]
v_pk_mul_f32 v[134:135], v[134:135], v[26:27] op_sel_hi:[1,0]
v_pk_mul_f32 v[136:137], v[136:137], v[26:27] op_sel_hi:[1,0]
v_pk_mul_f32 v[138:139], v[138:139], v[26:27] op_sel_hi:[1,0]
v_pk_mul_f32 v[140:141], v[140:141], v[26:27] op_sel_hi:[1,0]
v_pk_mul_f32 v[142:143], v[142:143], v[26:27] op_sel_hi:[1,0]
v_cvt_pk_bf16_f32 v128, v128, v129
v_cvt_pk_bf16_f32 v129, v130, v131
v_cvt_pk_bf16_f32 v130, v132, v133
v_cvt_pk_bf16_f32 v131, v134, v135
buffer_store_dwordx4 v[128:131], v6, s[8:11], s26 offen offset:0 sc1
v_cvt_pk_bf16_f32 v136, v136, v137
v_cvt_pk_bf16_f32 v137, v138, v139
v_cvt_pk_bf16_f32 v138, v140, v141
v_cvt_pk_bf16_f32 v139, v142, v143
buffer_store_dwordx4 v[136:139], v6, s[8:11], s26 offen offset:512 sc1
v_pk_mul_f32 v[160:161], v[160:161], v[26:27] op_sel_hi:[1,0]
v_pk_mul_f32 v[162:163], v[162:163], v[26:27] op_sel_hi:[1,0]
v_pk_mul_f32 v[164:165], v[164:165], v[26:27] op_sel_hi:[1,0]
v_pk_mul_f32 v[166:167], v[166:167], v[26:27] op_sel_hi:[1,0]
v_pk_mul_f32 v[168:169], v[168:169], v[26:27] op_sel_hi:[1,0]
v_pk_mul_f32 v[170:171], v[170:171], v[26:27] op_sel_hi:[1,0]
v_pk_mul_f32 v[172:173], v[172:173], v[26:27] op_sel_hi:[1,0]
v_pk_mul_f32 v[174:175], v[174:175], v[26:27] op_sel_hi:[1,0]
v_cvt_pk_bf16_f32 v160, v160, v161
v_cvt_pk_bf16_f32 v161, v162, v163
v_cvt_pk_bf16_f32 v162, v164, v165
v_cvt_pk_bf16_f32 v163, v166, v167
buffer_store_dwordx4 v[160:163], v6, s[8:11], s26 offen offset:1024 sc1
v_cvt_pk_bf16_f32 v168, v168, v169
v_cvt_pk_bf16_f32 v169, v170, v171
v_cvt_pk_bf16_f32 v170, v172, v173
v_cvt_pk_bf16_f32 v171, v174, v175
buffer_store_dwordx4 v[168:171], v6, s[8:11], s26 offen offset:1536 sc1
v_pk_mul_f32 v[192:193], v[192:193], v[26:27] op_sel_hi:[1,0]
v_pk_mul_f32 v[194:195], v[194:195], v[26:27] op_sel_hi:[1,0]
v_pk_mul_f32 v[196:197], v[196:197], v[26:27] op_sel_hi:[1,0]
v_pk_mul_f32 v[198:199], v[198:199], v[26:27] op_sel_hi:[1,0]
v_pk_mul_f32 v[200:201], v[200:201], v[26:27] op_sel_hi:[1,0]
v_pk_mul_f32 v[202:203], v[202:203], v[26:27] op_sel_hi:[1,0]
v_pk_mul_f32 v[204:205], v[204:205], v[26:27] op_sel_hi:[1,0]
v_pk_mul_f32 v[206:207], v[206:207], v[26:27] op_sel_hi:[1,0]
v_cvt_pk_bf16_f32 v192, v192, v193
v_cvt_pk_bf16_f32 v193, v194, v195
v_cvt_pk_bf16_f32 v194, v196, v197
v_cvt_pk_bf16_f32 v195, v198, v199
buffer_store_dwordx4 v[192:195], v6, s[8:11], s26 offen offset:2048 sc1
v_cvt_pk_bf16_f32 v200, v200, v201
v_cvt_pk_bf16_f32 v201, v202, v203
v_cvt_pk_bf16_f32 v202, v204, v205
v_cvt_pk_bf16_f32 v203, v206, v207
buffer_store_dwordx4 v[200:203], v6, s[8:11], s26 offen offset:2560 sc1
v_pk_mul_f32 v[224:225], v[224:225], v[26:27] op_sel_hi:[1,0]
v_pk_mul_f32 v[226:227], v[226:227], v[26:27] op_sel_hi:[1,0]
v_pk_mul_f32 v[228:229], v[228:229], v[26:27] op_sel_hi:[1,0]
v_pk_mul_f32 v[230:231], v[230:231], v[26:27] op_sel_hi:[1,0]
v_pk_mul_f32 v[232:233], v[232:233], v[26:27] op_sel_hi:[1,0]
v_pk_mul_f32 v[234:235], v[234:235], v[26:27] op_sel_hi:[1,0]
v_pk_mul_f32 v[236:237], v[236:237], v[26:27] op_sel_hi:[1,0]
v_pk_mul_f32 v[238:239], v[238:239], v[26:27] op_sel_hi:[1,0]
v_cvt_pk_bf16_f32 v224, v224, v225
v_cvt_pk_bf16_f32 v225, v226, v227
v_cvt_pk_bf16_f32 v226, v228, v229
v_cvt_pk_bf16_f32 v227, v230, v231
buffer_store_dwordx4 v[224:227], v6, s[8:11], s26 offen offset:3072 sc1
v_cvt_pk_bf16_f32 v232, v232, v233
v_cvt_pk_bf16_f32 v233, v234, v235
v_cvt_pk_bf16_f32 v234, v236, v237
v_cvt_pk_bf16_f32 v235, v238, v239
buffer_store_dwordx4 v[232:235], v6, s[8:11], s26 offen offset:3584 sc1
v_mov_b32 v26, v23
s_nop 1
v_permlane32_swap_b32 v26, v23
v_add_f32 v26, v26, v23
v_rcp_f32 v26, v26
s_nop 0
v_pk_mul_f32 v[144:145], v[144:145], v[26:27] op_sel_hi:[1,0]
v_pk_mul_f32 v[146:147], v[146:147], v[26:27] op_sel_hi:[1,0]
v_pk_mul_f32 v[148:149], v[148:149], v[26:27] op_sel_hi:[1,0]
v_pk_mul_f32 v[150:151], v[150:151], v[26:27] op_sel_hi:[1,0]
v_pk_mul_f32 v[152:153], v[152:153], v[26:27] op_sel_hi:[1,0]
v_pk_mul_f32 v[154:155], v[154:155], v[26:27] op_sel_hi:[1,0]
v_pk_mul_f32 v[156:157], v[156:157], v[26:27] op_sel_hi:[1,0]
v_pk_mul_f32 v[158:159], v[158:159], v[26:27] op_sel_hi:[1,0]
v_cvt_pk_bf16_f32 v144, v144, v145
v_cvt_pk_bf16_f32 v145, v146, v147
v_cvt_pk_bf16_f32 v146, v148, v149
v_cvt_pk_bf16_f32 v147, v150, v151
buffer_store_dwordx4 v[144:147], v6, s[8:11], s27 offen offset:0 sc1
v_cvt_pk_bf16_f32 v152, v152, v153
v_cvt_pk_bf16_f32 v153, v154, v155
v_cvt_pk_bf16_f32 v154, v156, v157
v_cvt_pk_bf16_f32 v155, v158, v159
buffer_store_dwordx4 v[152:155], v6, s[8:11], s27 offen offset:512 sc1
v_pk_mul_f32 v[176:177], v[176:177], v[26:27] op_sel_hi:[1,0]
v_pk_mul_f32 v[178:179], v[178:179], v[26:27] op_sel_hi:[1,0]
v_pk_mul_f32 v[180:181], v[180:181], v[26:27] op_sel_hi:[1,0]
v_pk_mul_f32 v[182:183], v[182:183], v[26:27] op_sel_hi:[1,0]
v_pk_mul_f32 v[184:185], v[184:185], v[26:27] op_sel_hi:[1,0]
v_pk_mul_f32 v[186:187], v[186:187], v[26:27] op_sel_hi:[1,0]
v_pk_mul_f32 v[188:189], v[188:189], v[26:27] op_sel_hi:[1,0]
v_pk_mul_f32 v[190:191], v[190:191], v[26:27] op_sel_hi:[1,0]
v_cvt_pk_bf16_f32 v176, v176, v177
v_cvt_pk_bf16_f32 v177, v178, v179
v_cvt_pk_bf16_f32 v178, v180, v181
v_cvt_pk_bf16_f32 v179, v182, v183
buffer_store_dwordx4 v[176:179], v6, s[8:11], s27 offen offset:1024 sc1
v_cvt_pk_bf16_f32 v184, v184, v185
v_cvt_pk_bf16_f32 v185, v186, v187
v_cvt_pk_bf16_f32 v186, v188, v189
v_cvt_pk_bf16_f32 v187, v190, v191
buffer_store_dwordx4 v[184:187], v6, s[8:11], s27 offen offset:1536 sc1
v_pk_mul_f32 v[208:209], v[208:209], v[26:27] op_sel_hi:[1,0]
v_pk_mul_f32 v[210:211], v[210:211], v[26:27] op_sel_hi:[1,0]
v_pk_mul_f32 v[212:213], v[212:213], v[26:27] op_sel_hi:[1,0]
v_pk_mul_f32 v[214:215], v[214:215], v[26:27] op_sel_hi:[1,0]
v_pk_mul_f32 v[216:217], v[216:217], v[26:27] op_sel_hi:[1,0]
v_pk_mul_f32 v[218:219], v[218:219], v[26:27] op_sel_hi:[1,0]
v_pk_mul_f32 v[220:221], v[220:221], v[26:27] op_sel_hi:[1,0]
v_pk_mul_f32 v[222:223], v[222:223], v[26:27] op_sel_hi:[1,0]
v_cvt_pk_bf16_f32 v208, v208, v209
v_cvt_pk_bf16_f32 v209, v210, v211
v_cvt_pk_bf16_f32 v210, v212, v213
v_cvt_pk_bf16_f32 v211, v214, v215
buffer_store_dwordx4 v[208:211], v6, s[8:11], s27 offen offset:2048 sc1
v_cvt_pk_bf16_f32 v216, v216, v217
v_cvt_pk_bf16_f32 v217, v218, v219
v_cvt_pk_bf16_f32 v218, v220, v221
v_cvt_pk_bf16_f32 v219, v222, v223
buffer_store_dwordx4 v[216:219], v6, s[8:11], s27 offen offset:2560 sc1
v_pk_mul_f32 v[240:241], v[240:241], v[26:27] op_sel_hi:[1,0]
v_pk_mul_f32 v[242:243], v[242:243], v[26:27] op_sel_hi:[1,0]
v_pk_mul_f32 v[244:245], v[244:245], v[26:27] op_sel_hi:[1,0]
v_pk_mul_f32 v[246:247], v[246:247], v[26:27] op_sel_hi:[1,0]
v_pk_mul_f32 v[248:249], v[248:249], v[26:27] op_sel_hi:[1,0]
v_pk_mul_f32 v[250:251], v[250:251], v[26:27] op_sel_hi:[1,0]
v_pk_mul_f32 v[252:253], v[252:253], v[26:27] op_sel_hi:[1,0]
v_pk_mul_f32 v[254:255], v[254:255], v[26:27] op_sel_hi:[1,0]
v_cvt_pk_bf16_f32 v240, v240, v241
v_cvt_pk_bf16_f32 v241, v242, v243
v_cvt_pk_bf16_f32 v242, v244, v245
v_cvt_pk_bf16_f32 v243, v246, v247
buffer_store_dwordx4 v[240:243], v6, s[8:11], s27 offen offset:3072 sc1
v_cvt_pk_bf16_f32 v248, v248, v249
v_cvt_pk_bf16_f32 v249, v250, v251
v_cvt_pk_bf16_f32 v250, v252, v253
v_cvt_pk_bf16_f32 v251, v254, v255
buffer_store_dwordx4 v[248:251], v6, s[8:11], s27 offen offset:3584 sc1
s_lshl_b32 s61, s41, 5
s_add_u32 s61, s61, s42
s_lshl_b32 s61, s61, 2
s_add_u32 s61, s61, 111169536
s_waitcnt vmcnt(0)
s_barrier
s_cmp_lg_u32 s17, 0
s_cbranch_scc1 L_sf_14
v_mov_b32 v20, 0
v_mov_b32 v21, 1
s_mov_b64 exec, 1
buffer_store_dword v21, v20, s[8:11], s61 offen sc1
s_mov_b64 exec, -1
L_sf_14:
s_mov_b32 s41, s62
s_add_u32 s60, s60, 1
s_cmp_lt_u32 s60, 2
s_cbranch_scc1 L_aat
s_load_dwordx2 s[4:5], s[0:1], 40
s_waitcnt lgkmcnt(0)
s_mov_b32 s20, s4
s_and_b32 s21, s5, 0xffff
s_mov_b32 s22, 4718592
s_mov_b32 s23, 0x20000
s_sub_u32 s25, s3, 4
s_mul_i32 s24, s25, 27
s_add_u32 s24, s24, s16
s_mul_i32 s26, s25, 5
s_add_u32 s26, s26, s16
s_add_u32 s26, s26, 81
s_cmp_ge_u32 s16, 27
s_cselect_b32 s24, s26, s24
s_cmp_ge_u32 s24, 126
s_cbranch_scc1 L_done
s_mul_i32 s25, s24, 57
s_lshr_b32 s25, s25, 9
s_mul_i32 s26, s25, 9
s_sub_u32 s40, s24, s26
s_and_b32 s51, s25, 1
s_add_u32 s51, s51, 64
s_lshr_b32 s25, s25, 1
s_cmp_eq_u32 s25, 0
s_cselect_b32 s42, 0x20408125, s42
s_cselect_b32 s43, 0x2040810, s43
s_cmp_eq_u32 s25, 1
s_cselect_b32 s42, 0x4081024a, s42
s_cselect_b32 s43, 0x4081020, s43
s_cmp_eq_u32 s25, 2
s_cselect_b32 s42, 0x81020490, s42
s_cselect_b32 s43, 0x8102040, s43
s_cmp_eq_u32 s25, 3
s_cselect_b32 s42, 0x2040800, s42
s_cselect_b32 s43, 0x10204081, s43
s_cmp_eq_u32 s25, 4
s_cselect_b32 s42, 0x4081000, s42
s_cselect_b32 s43, 0x20408102, s43
s_cmp_eq_u32 s25, 5
s_cselect_b32 s42, 0x8102000, s42
s_cselect_b32 s43, 0x40810204, s43
s_cmp_eq_u32 s25, 6
s_cselect_b32 s42, 0x10204000, s42
s_cselect_b32 s43, 0x81020408, s43
s_mov_b32 s44, 67108864
s_mov_b32 s45, 111169536
s_mov_b32 s46, 4
s_mov_b32 s47, 0
s_branch L_op
L_bdie:
s_mov_b32 s4, 0x557f8000
s_mov_b32 s5, 0x55555555
s_cmp_eq_u32 s3, 2
s_cbranch_scc1 L_cr0
s_mov_b32 s4, 0xaa800000
s_mov_b32 s5, 0xaaaaaaaa
s_branch L_cr0
s_and_b32 s27, s3, 1
s_lshr_b32 s26, s16, 2
s_lshl_b32 s26, s26, 1
s_and_b32 s24, s16, 1
s_add_u32 s26, s26, s24
s_mov_b32 s4, 0x557f8000
s_mov_b32 s5, 0x55555555
s_bitcmp1_b32 s16, 1
s_cbranch_scc1 L_crew
s_mov_b32 s4, 0xaa800000
s_mov_b32 s5, 0xaaaaaaaa
s_branch L_crew
L_part:
s_mov_b32 s4, 0x7fff
s_mov_b32 s5, 0x0
L_cr0:
s_and_b32 s27, s16, 1
s_lshr_b32 s26, s16, 1
L_crew:
s_cmp_eq_u64 s[4:5], 0
s_cbranch_scc1 L_done
s_cmp_lt_u32 s26, 9
s_cbranch_scc1 L_bo
s_mov_b64 s[52:53], s[4:5]
s_sub_u32 s41, s26, 9
s_lshl_b32 s41, s41, 1
s_add_u32 s41, s41, s27
s_mul_i32 s24, s17, 14
s_add_u32 s41, s41, s24
s_mov_b32 s40, 0x3e0293ee
s_mov_b32 s50, 0xf149f2ca
s_mov_b32 s51, 0x41a00000
v_and_b32 v5, 31, v0
v_bfe_u32 v26, v0, 5, 1
v_lshlrev_b32 v27, 2, v26
v_sub_u32 v5, v5, v27
v_bfe_u32 v27, v0, 4, 1
v_lshlrev_b32 v6, 17, v27
v_lshl_add_u32 v6, v26, 8, v6
v_and_b32 v27, 15, v0
v_lshl_add_u32 v6, v27, 4, v6
v_and_b32 v1, 63, v0
v_min_u32 v17, 47, v1
v_lshlrev_b32 v1, 4, v1
v_bfe_u32 v26, v0, 5, 1
v_and_b32 v27, 7, v0
v_xor_b32 v27, v27, v26
v_lshlrev_b32 v27, 4, v27
v_lshl_add_u32 v2, v26, 7, v27
v_xor_b32 v7, 64, v2
v_and_b32 v27, 31, v0
v_lshlrev_b32 v27, 2, v27
v_lshl_add_u32 v3, v26, 8, v27
v_mov_b32 v4, 0
v_lshlrev_b32 v17, 7, v17
v_mul_u32_u24 v26, 24576, v26
v_add_u32 v17, v17, v26
v_add_u32 v17, 111149056, v17
v_bfe_u32 v26, v0, 1, 2
v_and_b32 v27, 1, v0
v_lshl_add_u32 v26, v27, 4, v26
v_bfe_u32 v27, v0, 4, 1
v_lshl_add_u32 v26, v27, 2, v26
v_and_or_b32 v26, v0, 40, v26
v_lshlrev_b32 v16, 4, v26
v_mov_b32 v31, s50
s_mov_b32 s49, 0
s_mov_b32 s45, -1
v_cmp_le_i32 s[64:65], 0, v5
v_cmp_le_i32 s[66:67], 1, v5
v_cmp_le_i32 s[68:69], 2, v5
v_cmp_le_i32 s[70:71], 3, v5
v_cmp_le_i32 s[72:73], 8, v5
v_cmp_le_i32 s[74:75], 9, v5
v_cmp_le_i32 s[76:77], 10, v5
v_cmp_le_i32 s[78:79], 11, v5
v_cmp_le_i32 s[80:81], 16, v5
v_cmp_le_i32 s[82:83], 17, v5
v_cmp_le_i32 s[84:85], 18, v5
v_cmp_le_i32 s[86:87], 19, v5
v_cmp_le_i32 s[88:89], 24, v5
v_cmp_le_i32 s[90:91], 25, v5
v_cmp_le_i32 s[92:93], 26, v5
v_cmp_le_i32 s[94:95], 27, v5
L_nb_16:
s_ff1_i32_b64 s47, s[52:53]
s_cmp_lt_u32 s41, 32
s_cbranch_scc1 L_nb_17
s_bitset0_b64 s[52:53], s47
s_sub_u32 s41, s41, 32
s_branch L_nb_16
L_nb_17:
s_lshl_b32 s47, s47, 5
s_add_u32 s47, s47, s41
s_add_u32 s41, s41, 56
s_and_b32 s24, s47, 31
s_lshr_b32 s25, s47, 5
s_lshl_b32 s46, s24, 6
s_add_u32 s46, s46, s25
s_lshl_b32 s46, s46, 14
s_add_u32 s46, s46, 33554432
s_lshr_b32 s44, s24, 1
s_lshl_b32 s44, s44, 6
s_add_u32 s44, s44, s25
s_lshl_b32 s44, s44, 1
s_and_b32 s24, s24, 1
s_add_u32 s44, s44, s24
s_lshl_b32 s44, s44, 13
s_add_u32 s44, s44, 134217728
s_cmp_ge_u32 s47, 2048
s_cselect_b32 s44, 536870912, s44
s_cselect_b32 s46, 536870912, s46
s_cbranch_scc1 L_nb_15
s_lshr_b32 s25, s47, 8
s_lshl_b32 s25, s25, 2
s_cmp_eq_u32 s25, s45
s_cbranch_scc1 L_nb_15
s_mov_b32 s45, s25
s_mov_b32 s28, 0
L_poll_18:
buffer_load_dword v26, v17, s[8:11], s45 offen sc1
s_add_u32 s28, s28, 1
s_cmp_gt_u32 s28, 40000
s_cbranch_scc1 L_end
s_waitcnt vmcnt(0)
v_cmp_ne_u32 vcc, 1, v26
s_cbranch_vccz L_pd_19
s_sleep 8
s_cmp_lt_u32 s28, 32
s_cbranch_scc1 L_poll_18
s_sleep 32
s_branch L_poll_18
L_pd_19:
L_nb_15:
s_cmp_ge_u32 s47, 2048
s_cbranch_scc1 L_bt_x
s_add_u32 s25, s44, 0
buffer_load_dwordx4 a[0:3], v1, s[8:11], s25 offen offset:0 sc1
buffer_load_dwordx4 a[4:7], v1, s[8:11], s25 offen offset:1024 sc1
buffer_load_dwordx4 a[8:11], v1, s[8:11], s25 offen offset:2048 sc1
buffer_load_dwordx4 a[12:15], v1, s[8:11], s25 offen offset:3072 sc1
s_add_u32 s25, s44, 4096
buffer_load_dwordx4 a[16:19], v1, s[8:11], s25 offen offset:0 sc1
buffer_load_dwordx4 a[20:23], v1, s[8:11], s25 offen offset:1024 sc1
buffer_load_dwordx4 a[24:27], v1, s[8:11], s25 offen offset:2048 sc1
buffer_load_dwordx4 a[28:31], v1, s[8:11], s25 offen offset:3072 sc1
s_add_u32 s25, s46, 0
buffer_load_dwordx4 a[32:35], v1, s[8:11], s25 offen offset:0 sc1
buffer_load_dwordx4 a[36:39], v1, s[8:11], s25 offen offset:1024 sc1
buffer_load_dwordx4 a[40:43], v1, s[8:11], s25 offen offset:2048 sc1
buffer_load_dwordx4 a[44:47], v1, s[8:11], s25 offen offset:3072 sc1
s_add_u32 s25, s46, 4096
buffer_load_dwordx4 a[48:51], v1, s[8:11], s25 offen offset:0 sc1
buffer_load_dwordx4 a[52:55], v1, s[8:11], s25 offen offset:1024 sc1
buffer_load_dwordx4 a[56:59], v1, s[8:11], s25 offen offset:2048 sc1
buffer_load_dwordx4 a[60:63], v1, s[8:11], s25 offen offset:3072 sc1
s_add_u32 s25, s46, 8192
buffer_load_dwordx4 a[64:67], v16, s[8:11], s25 offen offset:0 sc1
buffer_load_dwordx4 a[68:71], v16, s[8:11], s25 offen offset:1024 sc1
buffer_load_dwordx4 a[72:75], v16, s[8:11], s25 offen offset:2048 sc1
buffer_load_dwordx4 a[76:79], v16, s[8:11], s25 offen offset:3072 sc1
s_add_u32 s25, s46, 12288
buffer_load_dwordx4 a[80:83], v16, s[8:11], s25 offen offset:0 sc1
buffer_load_dwordx4 a[84:87], v16, s[8:11], s25 offen offset:1024 sc1
buffer_load_dwordx4 a[88:91], v16, s[8:11], s25 offen offset:2048 sc1
buffer_load_dwordx4 a[92:95], v16, s[8:11], s25 offen offset:3072 sc1
s_waitcnt vmcnt(0)
s_mov_b32 s54, 536870912
L_bt:
s_waitcnt vmcnt(8)
v_mfma_f32_32x32x16_bf16 v[32:47], a[32:35], a[0:3], 0
v_mfma_f32_32x32x16_bf16 v[32:47], a[36:39], a[4:7], v[32:47]
v_mfma_f32_32x32x16_bf16 v[32:47], a[40:43], a[8:11], v[32:47]
v_mfma_f32_32x32x16_bf16 v[32:47], a[44:47], a[12:15], v[32:47]
v_mfma_f32_32x32x16_bf16 v[32:47], a[48:51], a[16:19], v[32:47]
v_mfma_f32_32x32x16_bf16 v[32:47], a[52:55], a[20:23], v[32:47]
v_mfma_f32_32x32x16_bf16 v[32:47], a[56:59], a[24:27], v[32:47]
v_mfma_f32_32x32x16_bf16 v[32:47], a[60:63], a[28:31], v[32:47]
s_and_b32 s42, s47, 31
s_lshr_b32 s43, s47, 5
s_lshl_b32 s26, s47, 12
s_add_u32 s26, s26, 100663296
s_nop 7
v_cndmask_b32 v32, v31, v32, s[64:65]
v_cndmask_b32 v33, v31, v33, s[66:67]
v_cndmask_b32 v34, v31, v34, s[68:69]
v_cndmask_b32 v35, v31, v35, s[70:71]
v_cndmask_b32 v36, v31, v36, s[72:73]
v_cndmask_b32 v37, v31, v37, s[74:75]
v_cndmask_b32 v38, v31, v38, s[76:77]
v_cndmask_b32 v39, v31, v39, s[78:79]
v_cndmask_b32 v40, v31, v40, s[80:81]
v_cndmask_b32 v41, v31, v41, s[82:83]
v_cndmask_b32 v42, v31, v42, s[84:85]
v_cndmask_b32 v43, v31, v43, s[86:87]
v_cndmask_b32 v44, v31, v44, s[88:89]
v_cndmask_b32 v45, v31, v45, s[90:91]
v_cndmask_b32 v46, v31, v46, s[92:93]
v_cndmask_b32 v47, v31, v47, s[94:95]
v_max3_f32 v20, v32, v33, v34
v_max3_f32 v20, v20, v35, v36
v_max3_f32 v20, v20, v37, v38
v_max3_f32 v20, v20, v39, v40
v_max3_f32 v20, v20, v41, v42
v_max3_f32 v20, v20, v43, v44
v_max3_f32 v20, v20, v45, v46
v_max_f32 v20, v20, v47
s_cmp_lt_u32 s43, s49
s_cbranch_scc1 L_kn_20
v_mov_b32 v26, 1
s_waitcnt vmcnt(0)
s_mov_b64 exec, 1
buffer_store_dword v26, v4, s[8:11], s54 offen
s_mov_b64 exec, -1
L_nb_23:
s_ff1_i32_b64 s48, s[52:53]
s_cmp_lt_u32 s41, 32
s_cbranch_scc1 L_nb_24
s_bitset0_b64 s[52:53], s48
s_sub_u32 s41, s41, 32
s_branch L_nb_23
L_nb_24:
s_lshl_b32 s48, s48, 5
s_add_u32 s48, s48, s41
s_add_u32 s41, s41, 56
s_and_b32 s24, s48, 31
s_lshr_b32 s25, s48, 5
s_lshl_b32 s46, s24, 6
s_add_u32 s46, s46, s25
s_lshl_b32 s46, s46, 14
s_add_u32 s46, s46, 33554432
s_lshr_b32 s44, s24, 1
s_lshl_b32 s44, s44, 6
s_add_u32 s44, s44, s25
s_lshl_b32 s44, s44, 1
s_and_b32 s24, s24, 1
s_add_u32 s44, s44, s24
s_lshl_b32 s44, s44, 13
s_add_u32 s44, s44, 134217728
s_cmp_ge_u32 s48, 2048
s_cselect_b32 s44, 536870912, s44
s_cselect_b32 s46, 536870912, s46
s_cbranch_scc1 L_nb_22
s_lshr_b32 s25, s48, 8
s_lshl_b32 s25, s25, 2
s_cmp_eq_u32 s25, s45
s_cbranch_scc1 L_nb_22
s_mov_b32 s45, s25
s_mov_b32 s28, 0
L_poll_25:
buffer_load_dword v26, v17, s[8:11], s45 offen sc1
s_add_u32 s28, s28, 1
s_cmp_gt_u32 s28, 40000
s_cbranch_scc1 L_end
s_waitcnt vmcnt(0)
v_cmp_ne_u32 vcc, 1, v26
s_cbranch_vccz L_pd_26
s_sleep 8
s_cmp_lt_u32 s28, 32
s_cbranch_scc1 L_poll_25
s_sleep 32
s_branch L_poll_25
L_pd_26:
L_nb_22:
s_add_u32 s25, s44, 0
buffer_load_dwordx4 a[96:99], v1, s[8:11], s25 offen offset:0 sc1
buffer_load_dwordx4 a[100:103], v1, s[8:11], s25 offen offset:1024 sc1
buffer_load_dwordx4 a[104:107], v1, s[8:11], s25 offen offset:2048 sc1
buffer_load_dwordx4 a[108:111], v1, s[8:11], s25 offen offset:3072 sc1
s_add_u32 s25, s44, 4096
buffer_load_dwordx4 a[112:115], v1, s[8:11], s25 offen offset:0 sc1
buffer_load_dwordx4 a[116:119], v1, s[8:11], s25 offen offset:1024 sc1
buffer_load_dwordx4 a[120:123], v1, s[8:11], s25 offen offset:2048 sc1
buffer_load_dwordx4 a[124:127], v1, s[8:11], s25 offen offset:3072 sc1
s_add_u32 s25, s46, 0
buffer_load_dwordx4 a[128:131], v1, s[8:11], s25 offen offset:0 sc1
buffer_load_dwordx4 a[132:135], v1, s[8:11], s25 offen offset:1024 sc1
buffer_load_dwordx4 a[136:139], v1, s[8:11], s25 offen offset:2048 sc1
buffer_load_dwordx4 a[140:143], v1, s[8:11], s25 offen offset:3072 sc1
s_add_u32 s25, s46, 4096
buffer_load_dwordx4 a[144:147], v1, s[8:11], s25 offen offset:0 sc1
buffer_load_dwordx4 a[148:151], v1, s[8:11], s25 offen offset:1024 sc1
buffer_load_dwordx4 a[152:155], v1, s[8:11], s25 offen offset:2048 sc1
buffer_load_dwordx4 a[156:159], v1, s[8:11], s25 offen offset:3072 sc1
s_add_u32 s25, s46, 8192
buffer_load_dwordx4 a[160:163], v16, s[8:11], s25 offen offset:0 sc1
buffer_load_dwordx4 a[164:167], v16, s[8:11], s25 offen offset:1024 sc1
buffer_load_dwordx4 a[168:171], v16, s[8:11], s25 offen offset:2048 sc1
buffer_load_dwordx4 a[172:175], v16, s[8:11], s25 offen offset:3072 sc1
s_add_u32 s25, s46, 12288
buffer_load_dwordx4 a[176:179], v16, s[8:11], s25 offen offset:0 sc1
buffer_load_dwordx4 a[180:183], v16, s[8:11], s25 offen offset:1024 sc1
buffer_load_dwordx4 a[184:187], v16, s[8:11], s25 offen offset:2048 sc1
buffer_load_dwordx4 a[188:191], v16, s[8:11], s25 offen offset:3072 sc1
s_lshl_b32 s25, s42, 7
s_add_u32 s25, s25, 111153152
s_mov_b32 s28, 0
L_poll_27:
buffer_load_dword v26, v4, s[8:11], s25 offen sc1
s_add_u32 s28, s28, 1
s_cmp_gt_u32 s28, 40000
s_cbranch_scc1 L_end
s_waitcnt vmcnt(0)
v_cmp_ge_u32 vcc, s43, v26
s_cbranch_vccz L_pd_28
s_sleep 1
s_cmp_lt_u32 s28, 32
s_cbranch_scc1 L_poll_27
s_sleep 32
s_branch L_poll_27
L_pd_28:
buffer_load_dwordx4 v[96:99], v2, s[8:11], s26 offen offset:0 sc1
buffer_load_dwordx4 v[100:103], v7, s[8:11], s26 offen offset:256 sc1
buffer_load_dwordx4 v[104:107], v2, s[8:11], s26 offen offset:512 sc1
buffer_load_dwordx4 v[108:111], v7, s[8:11], s26 offen offset:768 sc1
buffer_load_dwordx4 v[112:115], v2, s[8:11], s26 offen offset:1024 sc1
buffer_load_dwordx4 v[116:119], v7, s[8:11], s26 offen offset:1280 sc1
buffer_load_dwordx4 v[120:123], v2, s[8:11], s26 offen offset:1536 sc1
buffer_load_dwordx4 v[124:127], v7, s[8:11], s26 offen offset:1792 sc1
buffer_load_dword v8, v3, s[8:11], s26 offen offset:2048 sc1
buffer_load_dword v9, v3, s[8:11], s26 offen offset:2176 sc1
buffer_load_dword v10, v3, s[8:11], s26 offen offset:2560 sc1
buffer_load_dword v11, v3, s[8:11], s26 offen offset:2688 sc1
buffer_load_dword v12, v3, s[8:11], s26 offen offset:3072 sc1
buffer_load_dword v13, v3, s[8:11], s26 offen offset:3200 sc1
buffer_load_dword v14, v3, s[8:11], s26 offen offset:3584 sc1
buffer_load_dword v15, v3, s[8:11], s26 offen offset:3712 sc1
v_readfirstlane_b32 s49, v26
s_nop 0
s_min_u32 s49, s49, 63
s_sub_u32 s49, s49, 1
s_waitcnt vmcnt(15)
v_mfma_f32_32x32x16_bf16 v[64:79], v[96:99], a[0:3], 0
s_waitcnt vmcnt(14)
v_mfma_f32_32x32x16_bf16 v[64:79], v[100:103], a[4:7], v[64:79]
s_waitcnt vmcnt(13)
v_mfma_f32_32x32x16_bf16 v[64:79], v[104:107], a[8:11], v[64:79]
s_waitcnt vmcnt(12)
v_mfma_f32_32x32x16_bf16 v[64:79], v[108:111], a[12:15], v[64:79]
s_waitcnt vmcnt(11)
v_mfma_f32_32x32x16_bf16 v[64:79], v[112:115], a[16:19], v[64:79]
s_waitcnt vmcnt(10)
v_mfma_f32_32x32x16_bf16 v[64:79], v[116:119], a[20:23], v[64:79]
s_waitcnt vmcnt(9)
v_mfma_f32_32x32x16_bf16 v[64:79], v[120:123], a[24:27], v[64:79]
s_waitcnt vmcnt(8)
v_mfma_f32_32x32x16_bf16 v[64:79], v[124:127], a[28:31], v[64:79]
s_waitcnt vmcnt(0)
s_branch L_kj_21
L_kn_20:
buffer_load_dwordx4 v[96:99], v2, s[8:11], s26 offen offset:0 sc1
buffer_load_dwordx4 v[100:103], v7, s[8:11], s26 offen offset:256 sc1
buffer_load_dwordx4 v[104:107], v2, s[8:11], s26 offen offset:512 sc1
buffer_load_dwordx4 v[108:111], v7, s[8:11], s26 offen offset:768 sc1
buffer_load_dwordx4 v[112:115], v2, s[8:11], s26 offen offset:1024 sc1
buffer_load_dwordx4 v[116:119], v7, s[8:11], s26 offen offset:1280 sc1
buffer_load_dwordx4 v[120:123], v2, s[8:11], s26 offen offset:1536 sc1
buffer_load_dwordx4 v[124:127], v7, s[8:11], s26 offen offset:1792 sc1
buffer_load_dword v8, v3, s[8:11], s26 offen offset:2048 sc1
buffer_load_dword v9, v3, s[8:11], s26 offen offset:2176 sc1
buffer_load_dword v10, v3, s[8:11], s26 offen offset:2560 sc1
buffer_load_dword v11, v3, s[8:11], s26 offen offset:2688 sc1
buffer_load_dword v12, v3, s[8:11], s26 offen offset:3072 sc1
buffer_load_dword v13, v3, s[8:11], s26 offen offset:3200 sc1
buffer_load_dword v14, v3, s[8:11], s26 offen offset:3584 sc1
buffer_load_dword v15, v3, s[8:11], s26 offen offset:3712 sc1
v_mov_b32 v26, 1
s_waitcnt vmcnt(16)
s_mov_b64 exec, 1
buffer_store_dword v26, v4, s[8:11], s54 offen
s_mov_b64 exec, -1
L_nb_30:
s_ff1_i32_b64 s48, s[52:53]
s_cmp_lt_u32 s41, 32
s_cbranch_scc1 L_nb_31
s_bitset0_b64 s[52:53], s48
s_sub_u32 s41, s41, 32
s_branch L_nb_30
L_nb_31:
s_lshl_b32 s48, s48, 5
s_add_u32 s48, s48, s41
s_add_u32 s41, s41, 56
s_and_b32 s24, s48, 31
s_lshr_b32 s25, s48, 5
s_lshl_b32 s46, s24, 6
s_add_u32 s46, s46, s25
s_lshl_b32 s46, s46, 14
s_add_u32 s46, s46, 33554432
s_lshr_b32 s44, s24, 1
s_lshl_b32 s44, s44, 6
s_add_u32 s44, s44, s25
s_lshl_b32 s44, s44, 1
s_and_b32 s24, s24, 1
s_add_u32 s44, s44, s24
s_lshl_b32 s44, s44, 13
s_add_u32 s44, s44, 134217728
s_cmp_ge_u32 s48, 2048
s_cselect_b32 s44, 536870912, s44
s_cselect_b32 s46, 536870912, s46
s_cbranch_scc1 L_nb_29
s_lshr_b32 s25, s48, 8
s_lshl_b32 s25, s25, 2
s_cmp_eq_u32 s25, s45
s_cbranch_scc1 L_nb_29
s_mov_b32 s45, s25
s_mov_b32 s28, 0
L_poll_32:
buffer_load_dword v26, v17, s[8:11], s45 offen sc1
s_add_u32 s28, s28, 1
s_cmp_gt_u32 s28, 40000
s_cbranch_scc1 L_end
s_waitcnt vmcnt(0)
v_cmp_ne_u32 vcc, 1, v26
s_cbranch_vccz L_pd_33
s_sleep 8
s_cmp_lt_u32 s28, 32
s_cbranch_scc1 L_poll_32
s_sleep 32
s_branch L_poll_32
L_pd_33:
L_nb_29:
s_add_u32 s25, s44, 0
buffer_load_dwordx4 a[96:99], v1, s[8:11], s25 offen offset:0 sc1
buffer_load_dwordx4 a[100:103], v1, s[8:11], s25 offen offset:1024 sc1
buffer_load_dwordx4 a[104:107], v1, s[8:11], s25 offen offset:2048 sc1
buffer_load_dwordx4 a[108:111], v1, s[8:11], s25 offen offset:3072 sc1
s_add_u32 s25, s44, 4096
buffer_load_dwordx4 a[112:115], v1, s[8:11], s25 offen offset:0 sc1
buffer_load_dwordx4 a[116:119], v1, s[8:11], s25 offen offset:1024 sc1
buffer_load_dwordx4 a[120:123], v1, s[8:11], s25 offen offset:2048 sc1
buffer_load_dwordx4 a[124:127], v1, s[8:11], s25 offen offset:3072 sc1
s_waitcnt vmcnt(24)
v_mfma_f32_32x32x16_bf16 v[64:79], v[96:99], a[0:3], 0
s_add_u32 s25, s46, 0
buffer_load_dwordx4 a[128:131], v1, s[8:11], s25 offen offset:0 sc1
buffer_load_dwordx4 a[132:135], v1, s[8:11], s25 offen offset:1024 sc1
s_waitcnt vmcnt(25)
v_mfma_f32_32x32x16_bf16 v[64:79], v[100:103], a[4:7], v[64:79]
buffer_load_dwordx4 a[136:139], v1, s[8:11], s25 offen offset:2048 sc1
buffer_load_dwordx4 a[140:143], v1, s[8:11], s25 offen offset:3072 sc1
s_waitcnt vmcnt(26)
v_mfma_f32_32x32x16_bf16 v[64:79], v[104:107], a[8:11], v[64:79]
s_add_u32 s25, s46, 4096
buffer_load_dwordx4 a[144:147], v1, s[8:11], s25 offen offset:0 sc1
buffer_load_dwordx4 a[148:151], v1, s[8:11], s25 offen offset:1024 sc1
s_waitcnt vmcnt(27)
v_mfma_f32_32x32x16_bf16 v[64:79], v[108:111], a[12:15], v[64:79]
buffer_load_dwordx4 a[152:155], v1, s[8:11], s25 offen offset:2048 sc1
buffer_load_dwordx4 a[156:159], v1, s[8:11], s25 offen offset:3072 sc1
s_waitcnt vmcnt(28)
v_mfma_f32_32x32x16_bf16 v[64:79], v[112:115], a[16:19], v[64:79]
s_add_u32 s25, s46, 8192
buffer_load_dwordx4 a[160:163], v16, s[8:11], s25 offen offset:0 sc1
buffer_load_dwordx4 a[164:167], v16, s[8:11], s25 offen offset:1024 sc1
s_waitcnt vmcnt(29)
v_mfma_f32_32x32x16_bf16 v[64:79], v[116:119], a[20:23], v[64:79]
buffer_load_dwordx4 a[168:171], v16, s[8:11], s25 offen offset:2048 sc1
buffer_load_dwordx4 a[172:175], v16, s[8:11], s25 offen offset:3072 sc1
s_waitcnt vmcnt(30)
v_mfma_f32_32x32x16_bf16 v[64:79], v[120:123], a[24:27], v[64:79]
s_add_u32 s25, s46, 12288
buffer_load_dwordx4 a[176:179], v16, s[8:11], s25 offen offset:0 sc1
buffer_load_dwordx4 a[180:183], v16, s[8:11], s25 offen offset:1024 sc1
s_waitcnt vmcnt(31)
v_mfma_f32_32x32x16_bf16 v[64:79], v[124:127], a[28:31], v[64:79]
buffer_load_dwordx4 a[184:187], v16, s[8:11], s25 offen offset:2048 sc1
buffer_load_dwordx4 a[188:191], v16, s[8:11], s25 offen offset:3072 sc1
s_waitcnt vmcnt(25)
L_kj_21:
s_nop 9
v_max3_f32 v20, v20, v64, v65
v_max3_f32 v20, v20, v66, v67
v_mov_b32 v26, v20
s_nop 1
v_permlane32_swap_b32 v26, v20
v_max_f32 v20, v20, v26
v_mul_f32 v20, s40, v20
v_pk_fma_f32 v[64:65], v[64:65], s[40:41], v[20:21] op_sel_hi:[1,0,0] neg_lo:[0,0,1] neg_hi:[0,0,1]
v_pk_fma_f32 v[66:67], v[66:67], s[40:41], v[20:21] op_sel_hi:[1,0,0] neg_lo:[0,0,1] neg_hi:[0,0,1]
v_pk_fma_f32 v[32:33], v[32:33], s[40:41], v[20:21] op_sel_hi:[1,0,0] neg_lo:[0,0,1] neg_hi:[0,0,1]
v_pk_fma_f32 v[34:35], v[34:35], s[40:41], v[20:21] op_sel_hi:[1,0,0] neg_lo:[0,0,1] neg_hi:[0,0,1]
v_pk_fma_f32 v[36:37], v[36:37], s[40:41], v[20:21] op_sel_hi:[1,0,0] neg_lo:[0,0,1] neg_hi:[0,0,1]
v_pk_fma_f32 v[38:39], v[38:39], s[40:41], v[20:21] op_sel_hi:[1,0,0] neg_lo:[0,0,1] neg_hi:[0,0,1]
v_pk_fma_f32 v[40:41], v[40:41], s[40:41], v[20:21] op_sel_hi:[1,0,0] neg_lo:[0,0,1] neg_hi:[0,0,1]
v_pk_fma_f32 v[42:43], v[42:43], s[40:41], v[20:21] op_sel_hi:[1,0,0] neg_lo:[0,0,1] neg_hi:[0,0,1]
v_pk_fma_f32 v[44:45], v[44:45], s[40:41], v[20:21] op_sel_hi:[1,0,0] neg_lo:[0,0,1] neg_hi:[0,0,1]
v_pk_fma_f32 v[46:47], v[46:47], s[40:41], v[20:21] op_sel_hi:[1,0,0] neg_lo:[0,0,1] neg_hi:[0,0,1]
v_exp_f32 v64, v64
v_exp_f32 v65, v65
v_exp_f32 v66, v66
v_exp_f32 v67, v67
v_exp_f32 v32, v32
v_exp_f32 v33, v33
v_cvt_pk_bf16_f32 v88, v64, v65
v_cvt_pk_bf16_f32 v89, v66, v67
s_nop 1
v_mfma_f32_32x32x8_bf16 v[128:143], v[8:9], v[88:89], 0
v_exp_f32 v34, v34
v_exp_f32 v35, v35
v_exp_f32 v36, v36
v_mfma_f32_32x32x8_bf16 v[160:175], v[10:11], v[88:89], 0
v_exp_f32 v37, v37
v_exp_f32 v38, v38
v_mfma_f32_32x32x8_bf16 v[192:207], v[12:13], v[88:89], 0
v_exp_f32 v39, v39
v_exp_f32 v40, v40
v_exp_f32 v41, v41
v_mfma_f32_32x32x8_bf16 v[224:239], v[14:15], v[88:89], 0
v_cvt_pk_bf16_f32 v80, v32, v33
v_cvt_pk_bf16_f32 v81, v34, v35
v_cvt_pk_bf16_f32 v82, v36, v37
v_cvt_pk_bf16_f32 v83, v38, v39
s_nop 1
v_mfma_f32_32x32x16_bf16 v[128:143], a[64:67], v[80:83], v[128:143]
v_exp_f32 v42, v42
v_exp_f32 v43, v43
v_exp_f32 v44, v44
v_mfma_f32_32x32x16_bf16 v[160:175], a[72:75], v[80:83], v[160:175]
v_exp_f32 v45, v45
v_exp_f32 v46, v46
v_mfma_f32_32x32x16_bf16 v[192:207], a[80:83], v[80:83], v[192:207]
v_exp_f32 v47, v47
v_add_f32 v22, v64, v65
v_add_f32 v22, v22, v66
v_add_f32 v22, v22, v67
v_add_f32 v22, v22, v32
v_mfma_f32_32x32x16_bf16 v[224:239], a[88:91], v[80:83], v[224:239]
v_add_f32 v22, v22, v33
v_cvt_pk_bf16_f32 v84, v40, v41
v_cvt_pk_bf16_f32 v85, v42, v43
v_cvt_pk_bf16_f32 v86, v44, v45
v_cvt_pk_bf16_f32 v87, v46, v47
s_nop 1
v_mfma_f32_32x32x16_bf16 v[128:143], a[68:71], v[84:87], v[128:143]
v_add_f32 v22, v22, v34
v_add_f32 v22, v22, v35
v_add_f32 v22, v22, v36
v_add_f32 v22, v22, v37
v_add_f32 v22, v22, v38
v_mfma_f32_32x32x16_bf16 v[160:175], a[76:79], v[84:87], v[160:175]
v_add_f32 v22, v22, v39
v_add_f32 v22, v22, v40
v_add_f32 v22, v22, v41
v_add_f32 v22, v22, v42
v_mfma_f32_32x32x16_bf16 v[192:207], a[84:87], v[84:87], v[192:207]
v_add_f32 v22, v22, v43
v_add_f32 v22, v22, v44
v_add_f32 v22, v22, v45
v_add_f32 v22, v22, v46
v_add_f32 v22, v22, v47
v_mfma_f32_32x32x16_bf16 v[224:239], a[92:95], v[84:87], v[224:239]
s_lshl_b32 s26, s43, 18
s_lshl_b32 s27, s42, 12
s_add_u32 s26, s26, s27
s_add_u32 s26, s26, 83886080
v_mov_b32 v26, v22
s_nop 1
v_permlane32_swap_b32 v26, v22
v_add_f32 v26, v26, v22
v_rcp_f32 v26, v26
s_nop 0
v_pk_mul_f32 v[128:129], v[128:129], v[26:27] op_sel_hi:[1,0]
v_pk_mul_f32 v[130:131], v[130:131], v[26:27] op_sel_hi:[1,0]
v_pk_mul_f32 v[132:133], v[132:133], v[26:27] op_sel_hi:[1,0]
v_pk_mul_f32 v[134:135], v[134:135], v[26:27] op_sel_hi:[1,0]
v_pk_mul_f32 v[136:137], v[136:137], v[26:27] op_sel_hi:[1,0]
v_pk_mul_f32 v[138:139], v[138:139], v[26:27] op_sel_hi:[1,0]
v_pk_mul_f32 v[140:141], v[140:141], v[26:27] op_sel_hi:[1,0]
v_pk_mul_f32 v[142:143], v[142:143], v[26:27] op_sel_hi:[1,0]
v_cvt_pk_bf16_f32 v128, v128, v129
v_cvt_pk_bf16_f32 v129, v130, v131
v_cvt_pk_bf16_f32 v130, v132, v133
v_cvt_pk_bf16_f32 v131, v134, v135
buffer_store_dwordx4 v[128:131], v6, s[8:11], s26 offen offset:0
v_cvt_pk_bf16_f32 v136, v136, v137
v_cvt_pk_bf16_f32 v137, v138, v139
v_cvt_pk_bf16_f32 v138, v140, v141
v_cvt_pk_bf16_f32 v139, v142, v143
buffer_store_dwordx4 v[136:139], v6, s[8:11], s26 offen offset:512
v_pk_mul_f32 v[160:161], v[160:161], v[26:27] op_sel_hi:[1,0]
v_pk_mul_f32 v[162:163], v[162:163], v[26:27] op_sel_hi:[1,0]
v_pk_mul_f32 v[164:165], v[164:165], v[26:27] op_sel_hi:[1,0]
v_pk_mul_f32 v[166:167], v[166:167], v[26:27] op_sel_hi:[1,0]
v_pk_mul_f32 v[168:169], v[168:169], v[26:27] op_sel_hi:[1,0]
v_pk_mul_f32 v[170:171], v[170:171], v[26:27] op_sel_hi:[1,0]
v_pk_mul_f32 v[172:173], v[172:173], v[26:27] op_sel_hi:[1,0]
v_pk_mul_f32 v[174:175], v[174:175], v[26:27] op_sel_hi:[1,0]
v_cvt_pk_bf16_f32 v160, v160, v161
v_cvt_pk_bf16_f32 v161, v162, v163
v_cvt_pk_bf16_f32 v162, v164, v165
v_cvt_pk_bf16_f32 v163, v166, v167
buffer_store_dwordx4 v[160:163], v6, s[8:11], s26 offen offset:1024
v_cvt_pk_bf16_f32 v168, v168, v169
v_cvt_pk_bf16_f32 v169, v170, v171
v_cvt_pk_bf16_f32 v170, v172, v173
v_cvt_pk_bf16_f32 v171, v174, v175
buffer_store_dwordx4 v[168:171], v6, s[8:11], s26 offen offset:1536
v_pk_mul_f32 v[192:193], v[192:193], v[26:27] op_sel_hi:[1,0]
v_pk_mul_f32 v[194:195], v[194:195], v[26:27] op_sel_hi:[1,0]
v_pk_mul_f32 v[196:197], v[196:197], v[26:27] op_sel_hi:[1,0]
v_pk_mul_f32 v[198:199], v[198:199], v[26:27] op_sel_hi:[1,0]
v_pk_mul_f32 v[200:201], v[200:201], v[26:27] op_sel_hi:[1,0]
v_pk_mul_f32 v[202:203], v[202:203], v[26:27] op_sel_hi:[1,0]
v_pk_mul_f32 v[204:205], v[204:205], v[26:27] op_sel_hi:[1,0]
v_pk_mul_f32 v[206:207], v[206:207], v[26:27] op_sel_hi:[1,0]
v_cvt_pk_bf16_f32 v192, v192, v193
v_cvt_pk_bf16_f32 v193, v194, v195
v_cvt_pk_bf16_f32 v194, v196, v197
v_cvt_pk_bf16_f32 v195, v198, v199
buffer_store_dwordx4 v[192:195], v6, s[8:11], s26 offen offset:2048
v_cvt_pk_bf16_f32 v200, v200, v201
v_cvt_pk_bf16_f32 v201, v202, v203
v_cvt_pk_bf16_f32 v202, v204, v205
v_cvt_pk_bf16_f32 v203, v206, v207
buffer_store_dwordx4 v[200:203], v6, s[8:11], s26 offen offset:2560
v_pk_mul_f32 v[224:225], v[224:225], v[26:27] op_sel_hi:[1,0]
v_pk_mul_f32 v[226:227], v[226:227], v[26:27] op_sel_hi:[1,0]
v_pk_mul_f32 v[228:229], v[228:229], v[26:27] op_sel_hi:[1,0]
v_pk_mul_f32 v[230:231], v[230:231], v[26:27] op_sel_hi:[1,0]
v_pk_mul_f32 v[232:233], v[232:233], v[26:27] op_sel_hi:[1,0]
v_pk_mul_f32 v[234:235], v[234:235], v[26:27] op_sel_hi:[1,0]
v_pk_mul_f32 v[236:237], v[236:237], v[26:27] op_sel_hi:[1,0]
v_pk_mul_f32 v[238:239], v[238:239], v[26:27] op_sel_hi:[1,0]
v_cvt_pk_bf16_f32 v224, v224, v225
v_cvt_pk_bf16_f32 v225, v226, v227
v_cvt_pk_bf16_f32 v226, v228, v229
v_cvt_pk_bf16_f32 v227, v230, v231
buffer_store_dwordx4 v[224:227], v6, s[8:11], s26 offen offset:3072
v_cvt_pk_bf16_f32 v232, v232, v233
v_cvt_pk_bf16_f32 v233, v234, v235
v_cvt_pk_bf16_f32 v234, v236, v237
v_cvt_pk_bf16_f32 v235, v238, v239
buffer_store_dwordx4 v[232:235], v6, s[8:11], s26 offen offset:3584
s_lshl_b32 s54, s47, 2
s_add_u32 s54, s54, 111157248
s_mov_b32 s47, s48
s_cmp_lt_u32 s47, 2048
s_cbranch_scc0 L_bt_f
s_waitcnt vmcnt(8)
v_mfma_f32_32x32x16_bf16 v[32:47], a[128:131], a[96:99], 0
v_mfma_f32_32x32x16_bf16 v[32:47], a[132:135], a[100:103], v[32:47]
v_mfma_f32_32x32x16_bf16 v[32:47], a[136:139], a[104:107], v[32:47]
v_mfma_f32_32x32x16_bf16 v[32:47], a[140:143], a[108:111], v[32:47]
v_mfma_f32_32x32x16_bf16 v[32:47], a[144:147], a[112:115], v[32:47]
v_mfma_f32_32x32x16_bf16 v[32:47], a[148:151], a[116:119], v[32:47]
v_mfma_f32_32x32x16_bf16 v[32:47], a[152:155], a[120:123], v[32:47]
v_mfma_f32_32x32x16_bf16 v[32:47], a[156:159], a[124:127], v[32:47]
s_and_b32 s42, s47, 31
s_lshr_b32 s43, s47, 5
s_lshl_b32 s26, s47, 12
s_add_u32 s26, s26, 100663296
s_nop 7
v_cndmask_b32 v32, v31, v32, s[64:65]
v_cndmask_b32 v33, v31, v33, s[66:67]
v_cndmask_b32 v34, v31, v34, s[68:69]
v_cndmask_b32 v35, v31, v35, s[70:71]
v_cndmask_b32 v36, v31, v36, s[72:73]
v_cndmask_b32 v37, v31, v37, s[74:75]
v_cndmask_b32 v38, v31, v38, s[76:77]
v_cndmask_b32 v39, v31, v39, s[78:79]
v_cndmask_b32 v40, v31, v40, s[80:81]
v_cndmask_b32 v41, v31, v41, s[82:83]
v_cndmask_b32 v42, v31, v42, s[84:85]
v_cndmask_b32 v43, v31, v43, s[86:87]
v_cndmask_b32 v44, v31, v44, s[88:89]
v_cndmask_b32 v45, v31, v45, s[90:91]
v_cndmask_b32 v46, v31, v46, s[92:93]
v_cndmask_b32 v47, v31, v47, s[94:95]
v_max3_f32 v20, v32, v33, v34
v_max3_f32 v20, v20, v35, v36
v_max3_f32 v20, v20, v37, v38
v_max3_f32 v20, v20, v39, v40
v_max3_f32 v20, v20, v41, v42
v_max3_f32 v20, v20, v43, v44
v_max3_f32 v20, v20, v45, v46
v_max_f32 v20, v20, v47
s_cmp_lt_u32 s43, s49
s_cbranch_scc1 L_kn_34
v_mov_b32 v26, 1
s_waitcnt vmcnt(0)
s_mov_b64 exec, 1
buffer_store_dword v26, v4, s[8:11], s54 offen
s_mov_b64 exec, -1
L_nb_37:
s_ff1_i32_b64 s48, s[52:53]
s_cmp_lt_u32 s41, 32
s_cbranch_scc1 L_nb_38
s_bitset0_b64 s[52:53], s48
s_sub_u32 s41, s41, 32
s_branch L_nb_37
L_nb_38:
s_lshl_b32 s48, s48, 5
s_add_u32 s48, s48, s41
s_add_u32 s41, s41, 56
s_and_b32 s24, s48, 31
s_lshr_b32 s25, s48, 5
s_lshl_b32 s46, s24, 6
s_add_u32 s46, s46, s25
s_lshl_b32 s46, s46, 14
s_add_u32 s46, s46, 33554432
s_lshr_b32 s44, s24, 1
s_lshl_b32 s44, s44, 6
s_add_u32 s44, s44, s25
s_lshl_b32 s44, s44, 1
s_and_b32 s24, s24, 1
s_add_u32 s44, s44, s24
s_lshl_b32 s44, s44, 13
s_add_u32 s44, s44, 134217728
s_cmp_ge_u32 s48, 2048
s_cselect_b32 s44, 536870912, s44
s_cselect_b32 s46, 536870912, s46
s_cbranch_scc1 L_nb_36
s_lshr_b32 s25, s48, 8
s_lshl_b32 s25, s25, 2
s_cmp_eq_u32 s25, s45
s_cbranch_scc1 L_nb_36
s_mov_b32 s45, s25
s_mov_b32 s28, 0
L_poll_39:
buffer_load_dword v26, v17, s[8:11], s45 offen sc1
s_add_u32 s28, s28, 1
s_cmp_gt_u32 s28, 40000
s_cbranch_scc1 L_end
s_waitcnt vmcnt(0)
v_cmp_ne_u32 vcc, 1, v26
s_cbranch_vccz L_pd_40
s_sleep 8
s_cmp_lt_u32 s28, 32
s_cbranch_scc1 L_poll_39
s_sleep 32
s_branch L_poll_39
L_pd_40:
L_nb_36:
s_add_u32 s25, s44, 0
buffer_load_dwordx4 a[0:3], v1, s[8:11], s25 offen offset:0 sc1
buffer_load_dwordx4 a[4:7], v1, s[8:11], s25 offen offset:1024 sc1
buffer_load_dwordx4 a[8:11], v1, s[8:11], s25 offen offset:2048 sc1
buffer_load_dwordx4 a[12:15], v1, s[8:11], s25 offen offset:3072 sc1
s_add_u32 s25, s44, 4096
buffer_load_dwordx4 a[16:19], v1, s[8:11], s25 offen offset:0 sc1
buffer_load_dwordx4 a[20:23], v1, s[8:11], s25 offen offset:1024 sc1
buffer_load_dwordx4 a[24:27], v1, s[8:11], s25 offen offset:2048 sc1
buffer_load_dwordx4 a[28:31], v1, s[8:11], s25 offen offset:3072 sc1
s_add_u32 s25, s46, 0
buffer_load_dwordx4 a[32:35], v1, s[8:11], s25 offen offset:0 sc1
buffer_load_dwordx4 a[36:39], v1, s[8:11], s25 offen offset:1024 sc1
buffer_load_dwordx4 a[40:43], v1, s[8:11], s25 offen offset:2048 sc1
buffer_load_dwordx4 a[44:47], v1, s[8:11], s25 offen offset:3072 sc1
s_add_u32 s25, s46, 4096
buffer_load_dwordx4 a[48:51], v1, s[8:11], s25 offen offset:0 sc1
buffer_load_dwordx4 a[52:55], v1, s[8:11], s25 offen offset:1024 sc1
buffer_load_dwordx4 a[56:59], v1, s[8:11], s25 offen offset:2048 sc1
buffer_load_dwordx4 a[60:63], v1, s[8:11], s25 offen offset:3072 sc1
s_add_u32 s25, s46, 8192
buffer_load_dwordx4 a[64:67], v16, s[8:11], s25 offen offset:0 sc1
buffer_load_dwordx4 a[68:71], v16, s[8:11], s25 offen offset:1024 sc1
buffer_load_dwordx4 a[72:75], v16, s[8:11], s25 offen offset:2048 sc1
buffer_load_dwordx4 a[76:79], v16, s[8:11], s25 offen offset:3072 sc1
s_add_u32 s25, s46, 12288
buffer_load_dwordx4 a[80:83], v16, s[8:11], s25 offen offset:0 sc1
buffer_load_dwordx4 a[84:87], v16, s[8:11], s25 offen offset:1024 sc1
buffer_load_dwordx4 a[88:91], v16, s[8:11], s25 offen offset:2048 sc1
buffer_load_dwordx4 a[92:95], v16, s[8:11], s25 offen offset:3072 sc1
s_lshl_b32 s25, s42, 7
s_add_u32 s25, s25, 111153152
s_mov_b32 s28, 0
L_poll_41:
buffer_load_dword v26, v4, s[8:11], s25 offen sc1
s_add_u32 s28, s28, 1
s_cmp_gt_u32 s28, 40000
s_cbranch_scc1 L_end
s_waitcnt vmcnt(0)
v_cmp_ge_u32 vcc, s43, v26
s_cbranch_vccz L_pd_42
s_sleep 1
s_cmp_lt_u32 s28, 32
s_cbranch_scc1 L_poll_41
s_sleep 32
s_branch L_poll_41
L_pd_42:
buffer_load_dwordx4 v[96:99], v2, s[8:11], s26 offen offset:0 sc1
buffer_load_dwordx4 v[100:103], v7, s[8:11], s26 offen offset:256 sc1
buffer_load_dwordx4 v[104:107], v2, s[8:11], s26 offen offset:512 sc1
buffer_load_dwordx4 v[108:111], v7, s[8:11], s26 offen offset:768 sc1
buffer_load_dwordx4 v[112:115], v2, s[8:11], s26 offen offset:1024 sc1
buffer_load_dwordx4 v[116:119], v7, s[8:11], s26 offen offset:1280 sc1
buffer_load_dwordx4 v[120:123], v2, s[8:11], s26 offen offset:1536 sc1
buffer_load_dwordx4 v[124:127], v7, s[8:11], s26 offen offset:1792 sc1
buffer_load_dword v8, v3, s[8:11], s26 offen offset:2048 sc1
buffer_load_dword v9, v3, s[8:11], s26 offen offset:2176 sc1
buffer_load_dword v10, v3, s[8:11], s26 offen offset:2560 sc1
buffer_load_dword v11, v3, s[8:11], s26 offen offset:2688 sc1
buffer_load_dword v12, v3, s[8:11], s26 offen offset:3072 sc1
buffer_load_dword v13, v3, s[8:11], s26 offen offset:3200 sc1
buffer_load_dword v14, v3, s[8:11], s26 offen offset:3584 sc1
buffer_load_dword v15, v3, s[8:11], s26 offen offset:3712 sc1
v_readfirstlane_b32 s49, v26
s_nop 0
s_min_u32 s49, s49, 63
s_sub_u32 s49, s49, 1
s_waitcnt vmcnt(15)
v_mfma_f32_32x32x16_bf16 v[64:79], v[96:99], a[96:99], 0
s_waitcnt vmcnt(14)
v_mfma_f32_32x32x16_bf16 v[64:79], v[100:103], a[100:103], v[64:79]
s_waitcnt vmcnt(13)
v_mfma_f32_32x32x16_bf16 v[64:79], v[104:107], a[104:107], v[64:79]
s_waitcnt vmcnt(12)
v_mfma_f32_32x32x16_bf16 v[64:79], v[108:111], a[108:111], v[64:79]
s_waitcnt vmcnt(11)
v_mfma_f32_32x32x16_bf16 v[64:79], v[112:115], a[112:115], v[64:79]
s_waitcnt vmcnt(10)
v_mfma_f32_32x32x16_bf16 v[64:79], v[116:119], a[116:119], v[64:79]
s_waitcnt vmcnt(9)
v_mfma_f32_32x32x16_bf16 v[64:79], v[120:123], a[120:123], v[64:79]
s_waitcnt vmcnt(8)
v_mfma_f32_32x32x16_bf16 v[64:79], v[124:127], a[124:127], v[64:79]
s_waitcnt vmcnt(0)
s_branch L_kj_35
L_kn_34:
buffer_load_dwordx4 v[96:99], v2, s[8:11], s26 offen offset:0 sc1
buffer_load_dwordx4 v[100:103], v7, s[8:11], s26 offen offset:256 sc1
buffer_load_dwordx4 v[104:107], v2, s[8:11], s26 offen offset:512 sc1
buffer_load_dwordx4 v[108:111], v7, s[8:11], s26 offen offset:768 sc1
buffer_load_dwordx4 v[112:115], v2, s[8:11], s26 offen offset:1024 sc1
buffer_load_dwordx4 v[116:119], v7, s[8:11], s26 offen offset:1280 sc1
buffer_load_dwordx4 v[120:123], v2, s[8:11], s26 offen offset:1536 sc1
buffer_load_dwordx4 v[124:127], v7, s[8:11], s26 offen offset:1792 sc1
buffer_load_dword v8, v3, s[8:11], s26 offen offset:2048 sc1
buffer_load_dword v9, v3, s[8:11], s26 offen offset:2176 sc1
buffer_load_dword v10, v3, s[8:11], s26 offen offset:2560 sc1
buffer_load_dword v11, v3, s[8:11], s26 offen offset:2688 sc1
buffer_load_dword v12, v3, s[8:11], s26 offen offset:3072 sc1
buffer_load_dword v13, v3, s[8:11], s26 offen offset:3200 sc1
buffer_load_dword v14, v3, s[8:11], s26 offen offset:3584 sc1
buffer_load_dword v15, v3, s[8:11], s26 offen offset:3712 sc1
v_mov_b32 v26, 1
s_waitcnt vmcnt(16)
s_mov_b64 exec, 1
buffer_store_dword v26, v4, s[8:11], s54 offen
s_mov_b64 exec, -1
L_nb_44:
s_ff1_i32_b64 s48, s[52:53]
s_cmp_lt_u32 s41, 32
s_cbranch_scc1 L_nb_45
s_bitset0_b64 s[52:53], s48
s_sub_u32 s41, s41, 32
s_branch L_nb_44
L_nb_45:
s_lshl_b32 s48, s48, 5
s_add_u32 s48, s48, s41
s_add_u32 s41, s41, 56
s_and_b32 s24, s48, 31
s_lshr_b32 s25, s48, 5
s_lshl_b32 s46, s24, 6
s_add_u32 s46, s46, s25
s_lshl_b32 s46, s46, 14
s_add_u32 s46, s46, 33554432
s_lshr_b32 s44, s24, 1
s_lshl_b32 s44, s44, 6
s_add_u32 s44, s44, s25
s_lshl_b32 s44, s44, 1
s_and_b32 s24, s24, 1
s_add_u32 s44, s44, s24
s_lshl_b32 s44, s44, 13
s_add_u32 s44, s44, 134217728
s_cmp_ge_u32 s48, 2048
s_cselect_b32 s44, 536870912, s44
s_cselect_b32 s46, 536870912, s46
s_cbranch_scc1 L_nb_43
s_lshr_b32 s25, s48, 8
s_lshl_b32 s25, s25, 2
s_cmp_eq_u32 s25, s45
s_cbranch_scc1 L_nb_43
s_mov_b32 s45, s25
s_mov_b32 s28, 0
L_poll_46:
buffer_load_dword v26, v17, s[8:11], s45 offen sc1
s_add_u32 s28, s28, 1
s_cmp_gt_u32 s28, 40000
s_cbranch_scc1 L_end
s_waitcnt vmcnt(0)
v_cmp_ne_u32 vcc, 1, v26
s_cbranch_vccz L_pd_47
s_sleep 8
s_cmp_lt_u32 s28, 32
s_cbranch_scc1 L_poll_46
s_sleep 32
s_branch L_poll_46
L_pd_47:
L_nb_43:
s_add_u32 s25, s44, 0
buffer_load_dwordx4 a[0:3], v1, s[8:11], s25 offen offset:0 sc1
buffer_load_dwordx4 a[4:7], v1, s[8:11], s25 offen offset:1024 sc1
buffer_load_dwordx4 a[8:11], v1, s[8:11], s25 offen offset:2048 sc1
buffer_load_dwordx4 a[12:15], v1, s[8:11], s25 offen offset:3072 sc1
s_add_u32 s25, s44, 4096
buffer_load_dwordx4 a[16:19], v1, s[8:11], s25 offen offset:0 sc1
buffer_load_dwordx4 a[20:23], v1, s[8:11], s25 offen offset:1024 sc1
buffer_load_dwordx4 a[24:27], v1, s[8:11], s25 offen offset:2048 sc1
buffer_load_dwordx4 a[28:31], v1, s[8:11], s25 offen offset:3072 sc1
s_waitcnt vmcnt(24)
v_mfma_f32_32x32x16_bf16 v[64:79], v[96:99], a[96:99], 0
s_add_u32 s25, s46, 0
buffer_load_dwordx4 a[32:35], v1, s[8:11], s25 offen offset:0 sc1
buffer_load_dwordx4 a[36:39], v1, s[8:11], s25 offen offset:1024 sc1
s_waitcnt vmcnt(25)
v_mfma_f32_32x32x16_bf16 v[64:79], v[100:103], a[100:103], v[64:79]
buffer_load_dwordx4 a[40:43], v1, s[8:11], s25 offen offset:2048 sc1
buffer_load_dwordx4 a[44:47], v1, s[8:11], s25 offen offset:3072 sc1
s_waitcnt vmcnt(26)
v_mfma_f32_32x32x16_bf16 v[64:79], v[104:107], a[104:107], v[64:79]
s_add_u32 s25, s46, 4096
buffer_load_dwordx4 a[48:51], v1, s[8:11], s25 offen offset:0 sc1
buffer_load_dwordx4 a[52:55], v1, s[8:11], s25 offen offset:1024 sc1
s_waitcnt vmcnt(27)
v_mfma_f32_32x32x16_bf16 v[64:79], v[108:111], a[108:111], v[64:79]
buffer_load_dwordx4 a[56:59], v1, s[8:11], s25 offen offset:2048 sc1
buffer_load_dwordx4 a[60:63], v1, s[8:11], s25 offen offset:3072 sc1
s_waitcnt vmcnt(28)
v_mfma_f32_32x32x16_bf16 v[64:79], v[112:115], a[112:115], v[64:79]
s_add_u32 s25, s46, 8192
buffer_load_dwordx4 a[64:67], v16, s[8:11], s25 offen offset:0 sc1
buffer_load_dwordx4 a[68:71], v16, s[8:11], s25 offen offset:1024 sc1
s_waitcnt vmcnt(29)
v_mfma_f32_32x32x16_bf16 v[64:79], v[116:119], a[116:119], v[64:79]
buffer_load_dwordx4 a[72:75], v16, s[8:11], s25 offen offset:2048 sc1
buffer_load_dwordx4 a[76:79], v16, s[8:11], s25 offen offset:3072 sc1
s_waitcnt vmcnt(30)
v_mfma_f32_32x32x16_bf16 v[64:79], v[120:123], a[120:123], v[64:79]
s_add_u32 s25, s46, 12288
buffer_load_dwordx4 a[80:83], v16, s[8:11], s25 offen offset:0 sc1
buffer_load_dwordx4 a[84:87], v16, s[8:11], s25 offen offset:1024 sc1
s_waitcnt vmcnt(31)
v_mfma_f32_32x32x16_bf16 v[64:79], v[124:127], a[124:127], v[64:79]
buffer_load_dwordx4 a[88:91], v16, s[8:11], s25 offen offset:2048 sc1
buffer_load_dwordx4 a[92:95], v16, s[8:11], s25 offen offset:3072 sc1
s_waitcnt vmcnt(25)
L_kj_35:
s_nop 9
v_max3_f32 v20, v20, v64, v65
v_max3_f32 v20, v20, v66, v67
v_mov_b32 v26, v20
s_nop 1
v_permlane32_swap_b32 v26, v20
v_max_f32 v20, v20, v26
v_mul_f32 v20, s40, v20
v_pk_fma_f32 v[64:65], v[64:65], s[40:41], v[20:21] op_sel_hi:[1,0,0] neg_lo:[0,0,1] neg_hi:[0,0,1]
v_pk_fma_f32 v[66:67], v[66:67], s[40:41], v[20:21] op_sel_hi:[1,0,0] neg_lo:[0,0,1] neg_hi:[0,0,1]
v_pk_fma_f32 v[32:33], v[32:33], s[40:41], v[20:21] op_sel_hi:[1,0,0] neg_lo:[0,0,1] neg_hi:[0,0,1]
v_pk_fma_f32 v[34:35], v[34:35], s[40:41], v[20:21] op_sel_hi:[1,0,0] neg_lo:[0,0,1] neg_hi:[0,0,1]
v_pk_fma_f32 v[36:37], v[36:37], s[40:41], v[20:21] op_sel_hi:[1,0,0] neg_lo:[0,0,1] neg_hi:[0,0,1]
v_pk_fma_f32 v[38:39], v[38:39], s[40:41], v[20:21] op_sel_hi:[1,0,0] neg_lo:[0,0,1] neg_hi:[0,0,1]
v_pk_fma_f32 v[40:41], v[40:41], s[40:41], v[20:21] op_sel_hi:[1,0,0] neg_lo:[0,0,1] neg_hi:[0,0,1]
v_pk_fma_f32 v[42:43], v[42:43], s[40:41], v[20:21] op_sel_hi:[1,0,0] neg_lo:[0,0,1] neg_hi:[0,0,1]
v_pk_fma_f32 v[44:45], v[44:45], s[40:41], v[20:21] op_sel_hi:[1,0,0] neg_lo:[0,0,1] neg_hi:[0,0,1]
v_pk_fma_f32 v[46:47], v[46:47], s[40:41], v[20:21] op_sel_hi:[1,0,0] neg_lo:[0,0,1] neg_hi:[0,0,1]
v_exp_f32 v64, v64
v_exp_f32 v65, v65
v_exp_f32 v66, v66
v_exp_f32 v67, v67
v_exp_f32 v32, v32
v_exp_f32 v33, v33
v_cvt_pk_bf16_f32 v88, v64, v65
v_cvt_pk_bf16_f32 v89, v66, v67
s_nop 1
v_mfma_f32_32x32x8_bf16 v[128:143], v[8:9], v[88:89], 0
v_exp_f32 v34, v34
v_exp_f32 v35, v35
v_exp_f32 v36, v36
v_mfma_f32_32x32x8_bf16 v[160:175], v[10:11], v[88:89], 0
v_exp_f32 v37, v37
v_exp_f32 v38, v38
v_mfma_f32_32x32x8_bf16 v[192:207], v[12:13], v[88:89], 0
v_exp_f32 v39, v39
v_exp_f32 v40, v40
v_exp_f32 v41, v41
v_mfma_f32_32x32x8_bf16 v[224:239], v[14:15], v[88:89], 0
v_cvt_pk_bf16_f32 v80, v32, v33
v_cvt_pk_bf16_f32 v81, v34, v35
v_cvt_pk_bf16_f32 v82, v36, v37
v_cvt_pk_bf16_f32 v83, v38, v39
s_nop 1
v_mfma_f32_32x32x16_bf16 v[128:143], a[160:163], v[80:83], v[128:143]
v_exp_f32 v42, v42
v_exp_f32 v43, v43
v_exp_f32 v44, v44
v_mfma_f32_32x32x16_bf16 v[160:175], a[168:171], v[80:83], v[160:175]
v_exp_f32 v45, v45
v_exp_f32 v46, v46
v_mfma_f32_32x32x16_bf16 v[192:207], a[176:179], v[80:83], v[192:207]
v_exp_f32 v47, v47
v_add_f32 v22, v64, v65
v_add_f32 v22, v22, v66
v_add_f32 v22, v22, v67
v_add_f32 v22, v22, v32
v_mfma_f32_32x32x16_bf16 v[224:239], a[184:187], v[80:83], v[224:239]
v_add_f32 v22, v22, v33
v_cvt_pk_bf16_f32 v84, v40, v41
v_cvt_pk_bf16_f32 v85, v42, v43
v_cvt_pk_bf16_f32 v86, v44, v45
v_cvt_pk_bf16_f32 v87, v46, v47
s_nop 1
v_mfma_f32_32x32x16_bf16 v[128:143], a[164:167], v[84:87], v[128:143]
v_add_f32 v22, v22, v34
v_add_f32 v22, v22, v35
v_add_f32 v22, v22, v36
v_add_f32 v22, v22, v37
v_add_f32 v22, v22, v38
v_mfma_f32_32x32x16_bf16 v[160:175], a[172:175], v[84:87], v[160:175]
v_add_f32 v22, v22, v39
v_add_f32 v22, v22, v40
v_add_f32 v22, v22, v41
v_add_f32 v22, v22, v42
v_mfma_f32_32x32x16_bf16 v[192:207], a[180:183], v[84:87], v[192:207]
v_add_f32 v22, v22, v43
v_add_f32 v22, v22, v44
v_add_f32 v22, v22, v45
v_add_f32 v22, v22, v46
v_add_f32 v22, v22, v47
v_mfma_f32_32x32x16_bf16 v[224:239], a[188:191], v[84:87], v[224:239]
s_lshl_b32 s26, s43, 18
s_lshl_b32 s27, s42, 12
s_add_u32 s26, s26, s27
s_add_u32 s26, s26, 83886080
v_mov_b32 v26, v22
s_nop 1
v_permlane32_swap_b32 v26, v22
v_add_f32 v26, v26, v22
v_rcp_f32 v26, v26
s_nop 0
v_pk_mul_f32 v[128:129], v[128:129], v[26:27] op_sel_hi:[1,0]
v_pk_mul_f32 v[130:131], v[130:131], v[26:27] op_sel_hi:[1,0]
v_pk_mul_f32 v[132:133], v[132:133], v[26:27] op_sel_hi:[1,0]
v_pk_mul_f32 v[134:135], v[134:135], v[26:27] op_sel_hi:[1,0]
v_pk_mul_f32 v[136:137], v[136:137], v[26:27] op_sel_hi:[1,0]
v_pk_mul_f32 v[138:139], v[138:139], v[26:27] op_sel_hi:[1,0]
v_pk_mul_f32 v[140:141], v[140:141], v[26:27] op_sel_hi:[1,0]
v_pk_mul_f32 v[142:143], v[142:143], v[26:27] op_sel_hi:[1,0]
v_cvt_pk_bf16_f32 v128, v128, v129
v_cvt_pk_bf16_f32 v129, v130, v131
v_cvt_pk_bf16_f32 v130, v132, v133
v_cvt_pk_bf16_f32 v131, v134, v135
buffer_store_dwordx4 v[128:131], v6, s[8:11], s26 offen offset:0
v_cvt_pk_bf16_f32 v136, v136, v137
v_cvt_pk_bf16_f32 v137, v138, v139
v_cvt_pk_bf16_f32 v138, v140, v141
v_cvt_pk_bf16_f32 v139, v142, v143
buffer_store_dwordx4 v[136:139], v6, s[8:11], s26 offen offset:512
v_pk_mul_f32 v[160:161], v[160:161], v[26:27] op_sel_hi:[1,0]
v_pk_mul_f32 v[162:163], v[162:163], v[26:27] op_sel_hi:[1,0]
v_pk_mul_f32 v[164:165], v[164:165], v[26:27] op_sel_hi:[1,0]
v_pk_mul_f32 v[166:167], v[166:167], v[26:27] op_sel_hi:[1,0]
v_pk_mul_f32 v[168:169], v[168:169], v[26:27] op_sel_hi:[1,0]
v_pk_mul_f32 v[170:171], v[170:171], v[26:27] op_sel_hi:[1,0]
v_pk_mul_f32 v[172:173], v[172:173], v[26:27] op_sel_hi:[1,0]
v_pk_mul_f32 v[174:175], v[174:175], v[26:27] op_sel_hi:[1,0]
v_cvt_pk_bf16_f32 v160, v160, v161
v_cvt_pk_bf16_f32 v161, v162, v163
v_cvt_pk_bf16_f32 v162, v164, v165
v_cvt_pk_bf16_f32 v163, v166, v167
buffer_store_dwordx4 v[160:163], v6, s[8:11], s26 offen offset:1024
v_cvt_pk_bf16_f32 v168, v168, v169
v_cvt_pk_bf16_f32 v169, v170, v171
v_cvt_pk_bf16_f32 v170, v172, v173
v_cvt_pk_bf16_f32 v171, v174, v175
buffer_store_dwordx4 v[168:171], v6, s[8:11], s26 offen offset:1536
v_pk_mul_f32 v[192:193], v[192:193], v[26:27] op_sel_hi:[1,0]
v_pk_mul_f32 v[194:195], v[194:195], v[26:27] op_sel_hi:[1,0]
v_pk_mul_f32 v[196:197], v[196:197], v[26:27] op_sel_hi:[1,0]
v_pk_mul_f32 v[198:199], v[198:199], v[26:27] op_sel_hi:[1,0]
v_pk_mul_f32 v[200:201], v[200:201], v[26:27] op_sel_hi:[1,0]
v_pk_mul_f32 v[202:203], v[202:203], v[26:27] op_sel_hi:[1,0]
v_pk_mul_f32 v[204:205], v[204:205], v[26:27] op_sel_hi:[1,0]
v_pk_mul_f32 v[206:207], v[206:207], v[26:27] op_sel_hi:[1,0]
v_cvt_pk_bf16_f32 v192, v192, v193
v_cvt_pk_bf16_f32 v193, v194, v195
v_cvt_pk_bf16_f32 v194, v196, v197
v_cvt_pk_bf16_f32 v195, v198, v199
buffer_store_dwordx4 v[192:195], v6, s[8:11], s26 offen offset:2048
v_cvt_pk_bf16_f32 v200, v200, v201
v_cvt_pk_bf16_f32 v201, v202, v203
v_cvt_pk_bf16_f32 v202, v204, v205
v_cvt_pk_bf16_f32 v203, v206, v207
buffer_store_dwordx4 v[200:203], v6, s[8:11], s26 offen offset:2560
v_pk_mul_f32 v[224:225], v[224:225], v[26:27] op_sel_hi:[1,0]
v_pk_mul_f32 v[226:227], v[226:227], v[26:27] op_sel_hi:[1,0]
v_pk_mul_f32 v[228:229], v[228:229], v[26:27] op_sel_hi:[1,0]
v_pk_mul_f32 v[230:231], v[230:231], v[26:27] op_sel_hi:[1,0]
v_pk_mul_f32 v[232:233], v[232:233], v[26:27] op_sel_hi:[1,0]
v_pk_mul_f32 v[234:235], v[234:235], v[26:27] op_sel_hi:[1,0]
v_pk_mul_f32 v[236:237], v[236:237], v[26:27] op_sel_hi:[1,0]
v_pk_mul_f32 v[238:239], v[238:239], v[26:27] op_sel_hi:[1,0]
v_cvt_pk_bf16_f32 v224, v224, v225
v_cvt_pk_bf16_f32 v225, v226, v227
v_cvt_pk_bf16_f32 v226, v228, v229
v_cvt_pk_bf16_f32 v227, v230, v231
buffer_store_dwordx4 v[224:227], v6, s[8:11], s26 offen offset:3072
v_cvt_pk_bf16_f32 v232, v232, v233
v_cvt_pk_bf16_f32 v233, v234, v235
v_cvt_pk_bf16_f32 v234, v236, v237
v_cvt_pk_bf16_f32 v235, v238, v239
buffer_store_dwordx4 v[232:235], v6, s[8:11], s26 offen offset:3584
s_lshl_b32 s54, s47, 2
s_add_u32 s54, s54, 111157248
s_mov_b32 s47, s48
s_cmp_lt_u32 s47, 2048
s_cbranch_scc1 L_bt
L_bt_f:
v_mov_b32 v26, 1
s_waitcnt vmcnt(0)
s_mov_b64 exec, 1
buffer_store_dword v26, v4, s[8:11], s54 offen
s_mov_b64 exec, -1
L_bt_x:
s_branch L_done
L_bo:
s_mov_b64 s[42:43], s[4:5]
s_mov_b32 s51, s27
s_mov_b32 s40, s26
s_mov_b32 s44, 83886080
s_mov_b32 s45, 111157248
s_mov_b32 s46, 1
s_mov_b32 s47, 1152
s_load_dwordx2 s[4:5], s[0:1], 88
s_waitcnt lgkmcnt(0)
s_mov_b32 s20, s4
s_and_b32 s21, s5, 0xffff
s_mov_b32 s22, 4718592
s_mov_b32 s23, 0x20000
L_op:
s_load_dwordx2 s[4:5], s[0:1], 104
s_waitcnt lgkmcnt(0)
s_mov_b32 s12, s4
s_and_b32 s13, s5, 0xffff
s_mov_b32 s14, 4718592
s_mov_b32 s15, 0x20000
v_and_b32 v1, 63, v0
v_lshlrev_b32 v1, 4, v1
v_bfe_u32 v12, v0, 3, 3
v_mul_u32_u24 v12, 1152, v12
v_bfe_u32 v13, v0, 4, 2
v_lshlrev_b32 v13, 1, v13
v_and_b32 v14, 7, v0
v_xor_b32 v13, v13, v14
v_lshl_add_u32 v12, v13, 4, v12
s_mul_i32 s24, s17, 1179648
s_lshl_b32 s25, s40, 7
s_add_u32 s24, s24, s25
v_add_u32 v2, s24, v12
s_lshl_b32 s26, s17, 15
v_bfe_u32 v12, v0, 2, 3
v_lshlrev_b32 v12, 7, v12
v_bfe_u32 v13, v0, 5, 1
v_lshl_add_u32 v12, v13, 11, v12
v_bfe_u32 v13, v0, 3, 2
v_lshl_add_u32 v12, v13, 5, v12
v_and_b32 v13, 3, v0
v_lshl_add_u32 v12, v13, 3, v12
v_add_u32 v8, s26, v12
v_xor_b32 v9, 32, v8
v_xor_b32 v10, 64, v8
v_xor_b32 v11, 96, v8
s_add_u32 s24, s40, 0
s_and_b32 s24, s24, 7
s_lshl_b32 s30, s24, 12
s_add_u32 s24, s40, 1
s_and_b32 s24, s24, 7
s_lshl_b32 s31, s24, 12
s_add_u32 s24, s40, 2
s_and_b32 s24, s24, 7
s_lshl_b32 s32, s24, 12
s_add_u32 s24, s40, 3
s_and_b32 s24, s24, 7
s_lshl_b32 s33, s24, 12
s_add_u32 s24, s40, 4
s_and_b32 s24, s24, 7
s_lshl_b32 s34, s24, 12
s_add_u32 s24, s40, 5
s_and_b32 s24, s24, 7
s_lshl_b32 s35, s24, 12
s_add_u32 s24, s40, 6
s_and_b32 s24, s24, 7
s_lshl_b32 s36, s24, 12
s_add_u32 s24, s40, 7
s_and_b32 s24, s24, 7
s_lshl_b32 s37, s24, 12
s_mul_i32 s25, s30, 36
s_add_u32 m0, s26, 0
s_add_u32 s24, s25, 0
buffer_load_dwordx4 v2, s[20:23], s24 offen lds
s_add_u32 m0, s26, 1024
s_add_u32 s24, s25, 9216
buffer_load_dwordx4 v2, s[20:23], s24 offen lds
s_add_u32 m0, s26, 2048
s_add_u32 s24, s25, 18432
buffer_load_dwordx4 v2, s[20:23], s24 offen lds
s_add_u32 m0, s26, 3072
s_add_u32 s24, s25, 27648
buffer_load_dwordx4 v2, s[20:23], s24 offen lds
s_mul_i32 s25, s30, 36
s_add_u32 m0, s26, 4096
s_add_u32 s24, s25, 36864
buffer_load_dwordx4 v2, s[20:23], s24 offen lds
s_add_u32 m0, s26, 5120
s_add_u32 s24, s25, 46080
buffer_load_dwordx4 v2, s[20:23], s24 offen lds
s_add_u32 m0, s26, 6144
s_add_u32 s24, s25, 55296
buffer_load_dwordx4 v2, s[20:23], s24 offen lds
s_add_u32 m0, s26, 7168
s_add_u32 s24, s25, 64512
buffer_load_dwordx4 v2, s[20:23], s24 offen lds
s_mul_i32 s25, s30, 36
s_add_u32 m0, s26, 8192
s_add_u32 s24, s25, 73728
buffer_load_dwordx4 v2, s[20:23], s24 offen lds
s_add_u32 m0, s26, 9216
s_add_u32 s24, s25, 82944
buffer_load_dwordx4 v2, s[20:23], s24 offen lds
s_add_u32 m0, s26, 10240
s_add_u32 s24, s25, 92160
buffer_load_dwordx4 v2, s[20:23], s24 offen lds
s_add_u32 m0, s26, 11264
s_add_u32 s24, s25, 101376
buffer_load_dwordx4 v2, s[20:23], s24 offen lds
s_mul_i32 s25, s31, 36
s_add_u32 m0, s26, 12288
s_add_u32 s24, s25, 0
buffer_load_dwordx4 v2, s[20:23], s24 offen lds
s_add_u32 m0, s26, 13312
s_add_u32 s24, s25, 9216
buffer_load_dwordx4 v2, s[20:23], s24 offen lds
s_add_u32 m0, s26, 14336
s_add_u32 s24, s25, 18432
buffer_load_dwordx4 v2, s[20:23], s24 offen lds
s_add_u32 m0, s26, 15360
s_add_u32 s24, s25, 27648
buffer_load_dwordx4 v2, s[20:23], s24 offen lds
s_mul_i32 s25, s31, 36
s_add_u32 m0, s26, 16384
s_add_u32 s24, s25, 36864
buffer_load_dwordx4 v2, s[20:23], s24 offen lds
s_add_u32 m0, s26, 17408
s_add_u32 s24, s25, 46080
buffer_load_dwordx4 v2, s[20:23], s24 offen lds
s_add_u32 m0, s26, 18432
s_add_u32 s24, s25, 55296
buffer_load_dwordx4 v2, s[20:23], s24 offen lds
s_add_u32 m0, s26, 19456
s_add_u32 s24, s25, 64512
buffer_load_dwordx4 v2, s[20:23], s24 offen lds
s_mul_i32 s25, s31, 36
s_add_u32 m0, s26, 20480
s_add_u32 s24, s25, 73728
buffer_load_dwordx4 v2, s[20:23], s24 offen lds
s_add_u32 m0, s26, 21504
s_add_u32 s24, s25, 82944
buffer_load_dwordx4 v2, s[20:23], s24 offen lds
s_add_u32 m0, s26, 22528
s_add_u32 s24, s25, 92160
buffer_load_dwordx4 v2, s[20:23], s24 offen lds
s_add_u32 m0, s26, 23552
s_add_u32 s24, s25, 101376
buffer_load_dwordx4 v2, s[20:23], s24 offen lds
s_mul_i32 s25, s32, 36
s_add_u32 m0, s26, 24576
s_add_u32 s24, s25, 0
buffer_load_dwordx4 v2, s[20:23], s24 offen lds
s_add_u32 m0, s26, 25600
s_add_u32 s24, s25, 9216
buffer_load_dwordx4 v2, s[20:23], s24 offen lds
s_add_u32 m0, s26, 26624
s_add_u32 s24, s25, 18432
buffer_load_dwordx4 v2, s[20:23], s24 offen lds
s_add_u32 m0, s26, 27648
s_add_u32 s24, s25, 27648
buffer_load_dwordx4 v2, s[20:23], s24 offen lds
s_mul_i32 s25, s32, 36
s_add_u32 m0, s26, 28672
s_add_u32 s24, s25, 36864
buffer_load_dwordx4 v2, s[20:23], s24 offen lds
s_add_u32 m0, s26, 29696
s_add_u32 s24, s25, 46080
buffer_load_dwordx4 v2, s[20:23], s24 offen lds
s_add_u32 m0, s26, 30720
s_add_u32 s24, s25, 55296
buffer_load_dwordx4 v2, s[20:23], s24 offen lds
s_add_u32 m0, s26, 31744
s_add_u32 s24, s25, 64512
buffer_load_dwordx4 v2, s[20:23], s24 offen lds
s_waitcnt vmcnt(28)
ds_read_b64_tr_b16 v[128:129], v8 offset:0
ds_read_b64_tr_b16 v[130:131], v8 offset:1024
ds_read_b64_tr_b16 v[132:133], v9 offset:0
ds_read_b64_tr_b16 v[134:135], v9 offset:1024
ds_read_b64_tr_b16 v[136:137], v10 offset:0
ds_read_b64_tr_b16 v[138:139], v10 offset:1024
ds_read_b64_tr_b16 v[140:141], v11 offset:0
ds_read_b64_tr_b16 v[142:143], v11 offset:1024
s_waitcnt lgkmcnt(0)
s_mul_i32 s25, s32, 36
s_add_u32 m0, s26, 0
s_add_u32 s24, s25, 73728
buffer_load_dwordx4 v2, s[20:23], s24 offen lds
s_add_u32 m0, s26, 1024
s_add_u32 s24, s25, 82944
buffer_load_dwordx4 v2, s[20:23], s24 offen lds
s_add_u32 m0, s26, 2048
s_add_u32 s24, s25, 92160
buffer_load_dwordx4 v2, s[20:23], s24 offen lds
s_add_u32 m0, s26, 3072
s_add_u32 s24, s25, 101376
buffer_load_dwordx4 v2, s[20:23], s24 offen lds
s_waitcnt vmcnt(28)
ds_read_b64_tr_b16 v[144:145], v8 offset:4096
ds_read_b64_tr_b16 v[146:147], v8 offset:5120
ds_read_b64_tr_b16 v[148:149], v9 offset:4096
ds_read_b64_tr_b16 v[150:151], v9 offset:5120
ds_read_b64_tr_b16 v[152:153], v10 offset:4096
ds_read_b64_tr_b16 v[154:155], v10 offset:5120
ds_read_b64_tr_b16 v[156:157], v11 offset:4096
ds_read_b64_tr_b16 v[158:159], v11 offset:5120
s_waitcnt lgkmcnt(0)
s_mul_i32 s25, s33, 36
s_add_u32 m0, s26, 4096
s_add_u32 s24, s25, 0
buffer_load_dwordx4 v2, s[20:23], s24 offen lds
s_add_u32 m0, s26, 5120
s_add_u32 s24, s25, 9216
buffer_load_dwordx4 v2, s[20:23], s24 offen lds
s_add_u32 m0, s26, 6144
s_add_u32 s24, s25, 18432
buffer_load_dwordx4 v2, s[20:23], s24 offen lds
s_add_u32 m0, s26, 7168
s_add_u32 s24, s25, 27648
buffer_load_dwordx4 v2, s[20:23], s24 offen lds
s_waitcnt vmcnt(28)
ds_read_b64_tr_b16 v[160:161], v8 offset:8192
ds_read_b64_tr_b16 v[162:163], v8 offset:9216
ds_read_b64_tr_b16 v[164:165], v9 offset:8192
ds_read_b64_tr_b16 v[166:167], v9 offset:9216
ds_read_b64_tr_b16 v[168:169], v10 offset:8192
ds_read_b64_tr_b16 v[170:171], v10 offset:9216
ds_read_b64_tr_b16 v[172:173], v11 offset:8192
ds_read_b64_tr_b16 v[174:175], v11 offset:9216
s_waitcnt lgkmcnt(0)
s_mul_i32 s25, s33, 36
s_add_u32 m0, s26, 8192
s_add_u32 s24, s25, 36864
buffer_load_dwordx4 v2, s[20:23], s24 offen lds
s_add_u32 m0, s26, 9216
s_add_u32 s24, s25, 46080
buffer_load_dwordx4 v2, s[20:23], s24 offen lds
s_add_u32 m0, s26, 10240
s_add_u32 s24, s25, 55296
buffer_load_dwordx4 v2, s[20:23], s24 offen lds
s_add_u32 m0, s26, 11264
s_add_u32 s24, s25, 64512
buffer_load_dwordx4 v2, s[20:23], s24 offen lds
s_waitcnt vmcnt(28)
ds_read_b64_tr_b16 v[176:177], v8 offset:12288
ds_read_b64_tr_b16 v[178:179], v8 offset:13312
ds_read_b64_tr_b16 v[180:181], v9 offset:12288
ds_read_b64_tr_b16 v[182:183], v9 offset:13312
ds_read_b64_tr_b16 v[184:185], v10 offset:12288
ds_read_b64_tr_b16 v[186:187], v10 offset:13312
ds_read_b64_tr_b16 v[188:189], v11 offset:12288
ds_read_b64_tr_b16 v[190:191], v11 offset:13312
s_waitcnt lgkmcnt(0)
s_mul_i32 s25, s33, 36
s_add_u32 m0, s26, 12288
s_add_u32 s24, s25, 73728
buffer_load_dwordx4 v2, s[20:23], s24 offen lds
s_add_u32 m0, s26, 13312
s_add_u32 s24, s25, 82944
buffer_load_dwordx4 v2, s[20:23], s24 offen lds
s_add_u32 m0, s26, 14336
s_add_u32 s24, s25, 92160
buffer_load_dwordx4 v2, s[20:23], s24 offen lds
s_add_u32 m0, s26, 15360
s_add_u32 s24, s25, 101376
buffer_load_dwordx4 v2, s[20:23], s24 offen lds
s_waitcnt vmcnt(28)
ds_read_b64_tr_b16 v[192:193], v8 offset:16384
ds_read_b64_tr_b16 v[194:195], v8 offset:17408
ds_read_b64_tr_b16 v[196:197], v9 offset:16384
ds_read_b64_tr_b16 v[198:199], v9 offset:17408
ds_read_b64_tr_b16 v[200:201], v10 offset:16384
ds_read_b64_tr_b16 v[202:203], v10 offset:17408
ds_read_b64_tr_b16 v[204:205], v11 offset:16384
ds_read_b64_tr_b16 v[206:207], v11 offset:17408
s_waitcnt lgkmcnt(0)
s_mul_i32 s25, s34, 36
s_add_u32 m0, s26, 16384
s_add_u32 s24, s25, 0
buffer_load_dwordx4 v2, s[20:23], s24 offen lds
s_add_u32 m0, s26, 17408
s_add_u32 s24, s25, 9216
buffer_load_dwordx4 v2, s[20:23], s24 offen lds
s_add_u32 m0, s26, 18432
s_add_u32 s24, s25, 18432
buffer_load_dwordx4 v2, s[20:23], s24 offen lds
s_add_u32 m0, s26, 19456
s_add_u32 s24, s25, 27648
buffer_load_dwordx4 v2, s[20:23], s24 offen lds
s_waitcnt vmcnt(28)
ds_read_b64_tr_b16 v[208:209], v8 offset:20480
ds_read_b64_tr_b16 v[210:211], v8 offset:21504
ds_read_b64_tr_b16 v[212:213], v9 offset:20480
ds_read_b64_tr_b16 v[214:215], v9 offset:21504
ds_read_b64_tr_b16 v[216:217], v10 offset:20480
ds_read_b64_tr_b16 v[218:219], v10 offset:21504
ds_read_b64_tr_b16 v[220:221], v11 offset:20480
ds_read_b64_tr_b16 v[222:223], v11 offset:21504
s_waitcnt lgkmcnt(0)
s_mul_i32 s25, s34, 36
s_add_u32 m0, s26, 20480
s_add_u32 s24, s25, 36864
buffer_load_dwordx4 v2, s[20:23], s24 offen lds
s_add_u32 m0, s26, 21504
s_add_u32 s24, s25, 46080
buffer_load_dwordx4 v2, s[20:23], s24 offen lds
s_add_u32 m0, s26, 22528
s_add_u32 s24, s25, 55296
buffer_load_dwordx4 v2, s[20:23], s24 offen lds
s_add_u32 m0, s26, 23552
s_add_u32 s24, s25, 64512
buffer_load_dwordx4 v2, s[20:23], s24 offen lds
s_waitcnt vmcnt(28)
ds_read_b64_tr_b16 v[224:225], v8 offset:24576
ds_read_b64_tr_b16 v[226:227], v8 offset:25600
ds_read_b64_tr_b16 v[228:229], v9 offset:24576
ds_read_b64_tr_b16 v[230:231], v9 offset:25600
ds_read_b64_tr_b16 v[232:233], v10 offset:24576
ds_read_b64_tr_b16 v[234:235], v10 offset:25600
ds_read_b64_tr_b16 v[236:237], v11 offset:24576
ds_read_b64_tr_b16 v[238:239], v11 offset:25600
s_waitcnt lgkmcnt(0)
s_mul_i32 s25, s34, 36
s_add_u32 m0, s26, 24576
s_add_u32 s24, s25, 73728
buffer_load_dwordx4 v2, s[20:23], s24 offen lds
s_add_u32 m0, s26, 25600
s_add_u32 s24, s25, 82944
buffer_load_dwordx4 v2, s[20:23], s24 offen lds
s_add_u32 m0, s26, 26624
s_add_u32 s24, s25, 92160
buffer_load_dwordx4 v2, s[20:23], s24 offen lds
s_add_u32 m0, s26, 27648
s_add_u32 s24, s25, 101376
buffer_load_dwordx4 v2, s[20:23], s24 offen lds
s_waitcnt vmcnt(28)
ds_read_b64_tr_b16 v[240:241], v8 offset:28672
ds_read_b64_tr_b16 v[242:243], v8 offset:29696
ds_read_b64_tr_b16 v[244:245], v9 offset:28672
ds_read_b64_tr_b16 v[246:247], v9 offset:29696
ds_read_b64_tr_b16 v[248:249], v10 offset:28672
ds_read_b64_tr_b16 v[250:251], v10 offset:29696
ds_read_b64_tr_b16 v[252:253], v11 offset:28672
ds_read_b64_tr_b16 v[254:255], v11 offset:29696
s_waitcnt lgkmcnt(0)
s_mul_i32 s25, s35, 36
s_add_u32 m0, s26, 28672
s_add_u32 s24, s25, 0
buffer_load_dwordx4 v2, s[20:23], s24 offen lds
s_add_u32 m0, s26, 29696
s_add_u32 s24, s25, 9216
buffer_load_dwordx4 v2, s[20:23], s24 offen lds
s_add_u32 m0, s26, 30720
s_add_u32 s24, s25, 18432
buffer_load_dwordx4 v2, s[20:23], s24 offen lds
s_add_u32 m0, s26, 31744
s_add_u32 s24, s25, 27648
buffer_load_dwordx4 v2, s[20:23], s24 offen lds
s_waitcnt vmcnt(28)
ds_read_b64_tr_b16 a[0:1], v8 offset:0
ds_read_b64_tr_b16 a[2:3], v8 offset:1024
ds_read_b64_tr_b16 a[4:5], v9 offset:0
ds_read_b64_tr_b16 a[6:7], v9 offset:1024
ds_read_b64_tr_b16 a[8:9], v10 offset:0
ds_read_b64_tr_b16 a[10:11], v10 offset:1024
ds_read_b64_tr_b16 a[12:13], v11 offset:0
ds_read_b64_tr_b16 a[14:15], v11 offset:1024
s_waitcnt lgkmcnt(0)
s_mul_i32 s25, s35, 36
s_add_u32 m0, s26, 0
s_add_u32 s24, s25, 36864
buffer_load_dwordx4 v2, s[20:23], s24 offen lds
s_add_u32 m0, s26, 1024
s_add_u32 s24, s25, 46080
buffer_load_dwordx4 v2, s[20:23], s24 offen lds
s_add_u32 m0, s26, 2048
s_add_u32 s24, s25, 55296
buffer_load_dwordx4 v2, s[20:23], s24 offen lds
s_add_u32 m0, s26, 3072
s_add_u32 s24, s25, 64512
buffer_load_dwordx4 v2, s[20:23], s24 offen lds
s_waitcnt vmcnt(28)
ds_read_b64_tr_b16 a[16:17], v8 offset:4096
ds_read_b64_tr_b16 a[18:19], v8 offset:5120
ds_read_b64_tr_b16 a[20:21], v9 offset:4096
ds_read_b64_tr_b16 a[22:23], v9 offset:5120
ds_read_b64_tr_b16 a[24:25], v10 offset:4096
ds_read_b64_tr_b16 a[26:27], v10 offset:5120
ds_read_b64_tr_b16 a[28:29], v11 offset:4096
ds_read_b64_tr_b16 a[30:31], v11 offset:5120
s_waitcnt lgkmcnt(0)
s_mul_i32 s25, s35, 36
s_add_u32 m0, s26, 4096
s_add_u32 s24, s25, 73728
buffer_load_dwordx4 v2, s[20:23], s24 offen lds
s_add_u32 m0, s26, 5120
s_add_u32 s24, s25, 82944
buffer_load_dwordx4 v2, s[20:23], s24 offen lds
s_add_u32 m0, s26, 6144
s_add_u32 s24, s25, 92160
buffer_load_dwordx4 v2, s[20:23], s24 offen lds
s_add_u32 m0, s26, 7168
s_add_u32 s24, s25, 101376
buffer_load_dwordx4 v2, s[20:23], s24 offen lds
s_waitcnt vmcnt(28)
ds_read_b64_tr_b16 a[32:33], v8 offset:8192
ds_read_b64_tr_b16 a[34:35], v8 offset:9216
ds_read_b64_tr_b16 a[36:37], v9 offset:8192
ds_read_b64_tr_b16 a[38:39], v9 offset:9216
ds_read_b64_tr_b16 a[40:41], v10 offset:8192
ds_read_b64_tr_b16 a[42:43], v10 offset:9216
ds_read_b64_tr_b16 a[44:45], v11 offset:8192
ds_read_b64_tr_b16 a[46:47], v11 offset:9216
s_waitcnt lgkmcnt(0)
s_mul_i32 s25, s36, 36
s_add_u32 m0, s26, 8192
s_add_u32 s24, s25, 0
buffer_load_dwordx4 v2, s[20:23], s24 offen lds
s_add_u32 m0, s26, 9216
s_add_u32 s24, s25, 9216
buffer_load_dwordx4 v2, s[20:23], s24 offen lds
s_add_u32 m0, s26, 10240
s_add_u32 s24, s25, 18432
buffer_load_dwordx4 v2, s[20:23], s24 offen lds
s_add_u32 m0, s26, 11264
s_add_u32 s24, s25, 27648
buffer_load_dwordx4 v2, s[20:23], s24 offen lds
s_waitcnt vmcnt(28)
ds_read_b64_tr_b16 a[48:49], v8 offset:12288
ds_read_b64_tr_b16 a[50:51], v8 offset:13312
ds_read_b64_tr_b16 a[52:53], v9 offset:12288
ds_read_b64_tr_b16 a[54:55], v9 offset:13312
ds_read_b64_tr_b16 a[56:57], v10 offset:12288
ds_read_b64_tr_b16 a[58:59], v10 offset:13312
ds_read_b64_tr_b16 a[60:61], v11 offset:12288
ds_read_b64_tr_b16 a[62:63], v11 offset:13312
s_waitcnt lgkmcnt(0)
s_mul_i32 s25, s36, 36
s_add_u32 m0, s26, 12288
s_add_u32 s24, s25, 36864
buffer_load_dwordx4 v2, s[20:23], s24 offen lds
s_add_u32 m0, s26, 13312
s_add_u32 s24, s25, 46080
buffer_load_dwordx4 v2, s[20:23], s24 offen lds
s_add_u32 m0, s26, 14336
s_add_u32 s24, s25, 55296
buffer_load_dwordx4 v2, s[20:23], s24 offen lds
s_add_u32 m0, s26, 15360
s_add_u32 s24, s25, 64512
buffer_load_dwordx4 v2, s[20:23], s24 offen lds
s_waitcnt vmcnt(28)
ds_read_b64_tr_b16 a[64:65], v8 offset:16384
ds_read_b64_tr_b16 a[66:67], v8 offset:17408
ds_read_b64_tr_b16 a[68:69], v9 offset:16384
ds_read_b64_tr_b16 a[70:71], v9 offset:17408
ds_read_b64_tr_b16 a[72:73], v10 offset:16384
ds_read_b64_tr_b16 a[74:75], v10 offset:17408
ds_read_b64_tr_b16 a[76:77], v11 offset:16384
ds_read_b64_tr_b16 a[78:79], v11 offset:17408
s_waitcnt lgkmcnt(0)
s_mul_i32 s25, s36, 36
s_add_u32 m0, s26, 16384
s_add_u32 s24, s25, 73728
buffer_load_dwordx4 v2, s[20:23], s24 offen lds
s_add_u32 m0, s26, 17408
s_add_u32 s24, s25, 82944
buffer_load_dwordx4 v2, s[20:23], s24 offen lds
s_add_u32 m0, s26, 18432
s_add_u32 s24, s25, 92160
buffer_load_dwordx4 v2, s[20:23], s24 offen lds
s_add_u32 m0, s26, 19456
s_add_u32 s24, s25, 101376
buffer_load_dwordx4 v2, s[20:23], s24 offen lds
s_waitcnt vmcnt(28)
ds_read_b64_tr_b16 a[80:81], v8 offset:20480
ds_read_b64_tr_b16 a[82:83], v8 offset:21504
ds_read_b64_tr_b16 a[84:85], v9 offset:20480
ds_read_b64_tr_b16 a[86:87], v9 offset:21504
ds_read_b64_tr_b16 a[88:89], v10 offset:20480
ds_read_b64_tr_b16 a[90:91], v10 offset:21504
ds_read_b64_tr_b16 a[92:93], v11 offset:20480
ds_read_b64_tr_b16 a[94:95], v11 offset:21504
s_waitcnt lgkmcnt(0)
s_mul_i32 s25, s37, 36
s_add_u32 m0, s26, 20480
s_add_u32 s24, s25, 0
buffer_load_dwordx4 v2, s[20:23], s24 offen lds
s_add_u32 m0, s26, 21504
s_add_u32 s24, s25, 9216
buffer_load_dwordx4 v2, s[20:23], s24 offen lds
s_add_u32 m0, s26, 22528
s_add_u32 s24, s25, 18432
buffer_load_dwordx4 v2, s[20:23], s24 offen lds
s_add_u32 m0, s26, 23552
s_add_u32 s24, s25, 27648
buffer_load_dwordx4 v2, s[20:23], s24 offen lds
s_waitcnt vmcnt(28)
ds_read_b64_tr_b16 a[96:97], v8 offset:24576
ds_read_b64_tr_b16 a[98:99], v8 offset:25600
ds_read_b64_tr_b16 a[100:101], v9 offset:24576
ds_read_b64_tr_b16 a[102:103], v9 offset:25600
ds_read_b64_tr_b16 a[104:105], v10 offset:24576
ds_read_b64_tr_b16 a[106:107], v10 offset:25600
ds_read_b64_tr_b16 a[108:109], v11 offset:24576
ds_read_b64_tr_b16 a[110:111], v11 offset:25600
s_waitcnt lgkmcnt(0)
s_mul_i32 s25, s37, 36
s_add_u32 m0, s26, 24576
s_add_u32 s24, s25, 36864
buffer_load_dwordx4 v2, s[20:23], s24 offen lds
s_add_u32 m0, s26, 25600
s_add_u32 s24, s25, 46080
buffer_load_dwordx4 v2, s[20:23], s24 offen lds
s_add_u32 m0, s26, 26624
s_add_u32 s24, s25, 55296
buffer_load_dwordx4 v2, s[20:23], s24 offen lds
s_add_u32 m0, s26, 27648
s_add_u32 s24, s25, 64512
buffer_load_dwordx4 v2, s[20:23], s24 offen lds
s_waitcnt vmcnt(28)
ds_read_b64_tr_b16 a[112:113], v8 offset:28672
ds_read_b64_tr_b16 a[114:115], v8 offset:29696
ds_read_b64_tr_b16 a[116:117], v9 offset:28672
ds_read_b64_tr_b16 a[118:119], v9 offset:29696
ds_read_b64_tr_b16 a[120:121], v10 offset:28672
ds_read_b64_tr_b16 a[122:123], v10 offset:29696
ds_read_b64_tr_b16 a[124:125], v11 offset:28672
ds_read_b64_tr_b16 a[126:127], v11 offset:29696
s_waitcnt lgkmcnt(0)
s_mul_i32 s25, s37, 36
s_add_u32 m0, s26, 28672
s_add_u32 s24, s25, 73728
buffer_load_dwordx4 v2, s[20:23], s24 offen lds
s_add_u32 m0, s26, 29696
s_add_u32 s24, s25, 82944
buffer_load_dwordx4 v2, s[20:23], s24 offen lds
s_add_u32 m0, s26, 30720
s_add_u32 s24, s25, 92160
buffer_load_dwordx4 v2, s[20:23], s24 offen lds
s_add_u32 m0, s26, 31744
s_add_u32 s24, s25, 101376
buffer_load_dwordx4 v2, s[20:23], s24 offen lds
s_waitcnt vmcnt(28)
ds_read_b64_tr_b16 a[128:129], v8 offset:0
ds_read_b64_tr_b16 a[130:131], v8 offset:1024
ds_read_b64_tr_b16 a[132:133], v9 offset:0
ds_read_b64_tr_b16 a[134:135], v9 offset:1024
ds_read_b64_tr_b16 a[136:137], v10 offset:0
ds_read_b64_tr_b16 a[138:139], v10 offset:1024
ds_read_b64_tr_b16 a[140:141], v11 offset:0
ds_read_b64_tr_b16 a[142:143], v11 offset:1024
s_waitcnt lgkmcnt(0)
s_mul_i32 s25, s30, 36
s_add_u32 m0, s26, 0
s_add_u32 s24, s25, 110592
buffer_load_dwordx4 v2, s[20:23], s24 offen lds
s_add_u32 m0, s26, 1024
s_add_u32 s24, s25, 119808
buffer_load_dwordx4 v2, s[20:23], s24 offen lds
s_add_u32 m0, s26, 2048
s_add_u32 s24, s25, 129024
buffer_load_dwordx4 v2, s[20:23], s24 offen lds
s_add_u32 m0, s26, 3072
s_add_u32 s24, s25, 138240
buffer_load_dwordx4 v2, s[20:23], s24 offen lds
s_waitcnt vmcnt(28)
ds_read_b64_tr_b16 a[144:145], v8 offset:4096
ds_read_b64_tr_b16 a[146:147], v8 offset:5120
ds_read_b64_tr_b16 a[148:149], v9 offset:4096
ds_read_b64_tr_b16 a[150:151], v9 offset:5120
ds_read_b64_tr_b16 a[152:153], v10 offset:4096
ds_read_b64_tr_b16 a[154:155], v10 offset:5120
ds_read_b64_tr_b16 a[156:157], v11 offset:4096
ds_read_b64_tr_b16 a[158:159], v11 offset:5120
s_waitcnt lgkmcnt(0)
s_mul_i32 s25, s31, 36
s_add_u32 m0, s26, 4096
s_add_u32 s24, s25, 110592
buffer_load_dwordx4 v2, s[20:23], s24 offen lds
s_add_u32 m0, s26, 5120
s_add_u32 s24, s25, 119808
buffer_load_dwordx4 v2, s[20:23], s24 offen lds
s_add_u32 m0, s26, 6144
s_add_u32 s24, s25, 129024
buffer_load_dwordx4 v2, s[20:23], s24 offen lds
s_add_u32 m0, s26, 7168
s_add_u32 s24, s25, 138240
buffer_load_dwordx4 v2, s[20:23], s24 offen lds
s_waitcnt vmcnt(28)
ds_read_b64_tr_b16 a[160:161], v8 offset:8192
ds_read_b64_tr_b16 a[162:163], v8 offset:9216
ds_read_b64_tr_b16 a[164:165], v9 offset:8192
ds_read_b64_tr_b16 a[166:167], v9 offset:9216
ds_read_b64_tr_b16 a[168:169], v10 offset:8192
ds_read_b64_tr_b16 a[170:171], v10 offset:9216
ds_read_b64_tr_b16 a[172:173], v11 offset:8192
ds_read_b64_tr_b16 a[174:175], v11 offset:9216
s_waitcnt lgkmcnt(0)
s_mul_i32 s25, s32, 36
s_add_u32 m0, s26, 8192
s_add_u32 s24, s25, 110592
buffer_load_dwordx4 v2, s[20:23], s24 offen lds
s_add_u32 m0, s26, 9216
s_add_u32 s24, s25, 119808
buffer_load_dwordx4 v2, s[20:23], s24 offen lds
s_add_u32 m0, s26, 10240
s_add_u32 s24, s25, 129024
buffer_load_dwordx4 v2, s[20:23], s24 offen lds
s_add_u32 m0, s26, 11264
s_add_u32 s24, s25, 138240
buffer_load_dwordx4 v2, s[20:23], s24 offen lds
s_waitcnt vmcnt(28)
ds_read_b64_tr_b16 a[176:177], v8 offset:12288
ds_read_b64_tr_b16 a[178:179], v8 offset:13312
ds_read_b64_tr_b16 a[180:181], v9 offset:12288
ds_read_b64_tr_b16 a[182:183], v9 offset:13312
ds_read_b64_tr_b16 a[184:185], v10 offset:12288
ds_read_b64_tr_b16 a[186:187], v10 offset:13312
ds_read_b64_tr_b16 a[188:189], v11 offset:12288
ds_read_b64_tr_b16 a[190:191], v11 offset:13312
s_waitcnt lgkmcnt(0)
s_mul_i32 s25, s33, 36
s_add_u32 m0, s26, 12288
s_add_u32 s24, s25, 110592
buffer_load_dwordx4 v2, s[20:23], s24 offen lds
s_add_u32 m0, s26, 13312
s_add_u32 s24, s25, 119808
buffer_load_dwordx4 v2, s[20:23], s24 offen lds
s_add_u32 m0, s26, 14336
s_add_u32 s24, s25, 129024
buffer_load_dwordx4 v2, s[20:23], s24 offen lds
s_add_u32 m0, s26, 15360
s_add_u32 s24, s25, 138240
buffer_load_dwordx4 v2, s[20:23], s24 offen lds
s_waitcnt vmcnt(28)
ds_read_b64_tr_b16 a[192:193], v8 offset:16384
ds_read_b64_tr_b16 a[194:195], v8 offset:17408
ds_read_b64_tr_b16 a[196:197], v9 offset:16384
ds_read_b64_tr_b16 a[198:199], v9 offset:17408
ds_read_b64_tr_b16 a[200:201], v10 offset:16384
ds_read_b64_tr_b16 a[202:203], v10 offset:17408
ds_read_b64_tr_b16 a[204:205], v11 offset:16384
ds_read_b64_tr_b16 a[206:207], v11 offset:17408
s_waitcnt lgkmcnt(0)
s_mul_i32 s25, s34, 36
s_add_u32 m0, s26, 16384
s_add_u32 s24, s25, 110592
buffer_load_dwordx4 v2, s[20:23], s24 offen lds
s_add_u32 m0, s26, 17408
s_add_u32 s24, s25, 119808
buffer_load_dwordx4 v2, s[20:23], s24 offen lds
s_add_u32 m0, s26, 18432
s_add_u32 s24, s25, 129024
buffer_load_dwordx4 v2, s[20:23], s24 offen lds
s_add_u32 m0, s26, 19456
s_add_u32 s24, s25, 138240
buffer_load_dwordx4 v2, s[20:23], s24 offen lds
s_waitcnt vmcnt(28)
ds_read_b64_tr_b16 a[208:209], v8 offset:20480
ds_read_b64_tr_b16 a[210:211], v8 offset:21504
ds_read_b64_tr_b16 a[212:213], v9 offset:20480
ds_read_b64_tr_b16 a[214:215], v9 offset:21504
ds_read_b64_tr_b16 a[216:217], v10 offset:20480
ds_read_b64_tr_b16 a[218:219], v10 offset:21504
ds_read_b64_tr_b16 a[220:221], v11 offset:20480
ds_read_b64_tr_b16 a[222:223], v11 offset:21504
s_waitcnt lgkmcnt(0)
s_mul_i32 s25, s35, 36
s_add_u32 m0, s26, 20480
s_add_u32 s24, s25, 110592
buffer_load_dwordx4 v2, s[20:23], s24 offen lds
s_add_u32 m0, s26, 21504
s_add_u32 s24, s25, 119808
buffer_load_dwordx4 v2, s[20:23], s24 offen lds
s_add_u32 m0, s26, 22528
s_add_u32 s24, s25, 129024
buffer_load_dwordx4 v2, s[20:23], s24 offen lds
s_add_u32 m0, s26, 23552
s_add_u32 s24, s25, 138240
buffer_load_dwordx4 v2, s[20:23], s24 offen lds
s_waitcnt vmcnt(28)
ds_read_b64_tr_b16 a[224:225], v8 offset:24576
ds_read_b64_tr_b16 a[226:227], v8 offset:25600
ds_read_b64_tr_b16 a[228:229], v9 offset:24576
ds_read_b64_tr_b16 a[230:231], v9 offset:25600
ds_read_b64_tr_b16 a[232:233], v10 offset:24576
ds_read_b64_tr_b16 a[234:235], v10 offset:25600
ds_read_b64_tr_b16 a[236:237], v11 offset:24576
ds_read_b64_tr_b16 a[238:239], v11 offset:25600
s_waitcnt lgkmcnt(0)
s_mul_i32 s25, s36, 36
s_add_u32 m0, s26, 24576
s_add_u32 s24, s25, 110592
buffer_load_dwordx4 v2, s[20:23], s24 offen lds
s_add_u32 m0, s26, 25600
s_add_u32 s24, s25, 119808
buffer_load_dwordx4 v2, s[20:23], s24 offen lds
s_add_u32 m0, s26, 26624
s_add_u32 s24, s25, 129024
buffer_load_dwordx4 v2, s[20:23], s24 offen lds
s_add_u32 m0, s26, 27648
s_add_u32 s24, s25, 138240
buffer_load_dwordx4 v2, s[20:23], s24 offen lds
s_waitcnt vmcnt(28)
ds_read_b64_tr_b16 a[240:241], v8 offset:28672
ds_read_b64_tr_b16 a[242:243], v8 offset:29696
ds_read_b64_tr_b16 a[244:245], v9 offset:28672
ds_read_b64_tr_b16 a[246:247], v9 offset:29696
ds_read_b64_tr_b16 a[248:249], v10 offset:28672
ds_read_b64_tr_b16 a[250:251], v10 offset:29696
ds_read_b64_tr_b16 a[252:253], v11 offset:28672
ds_read_b64_tr_b16 a[254:255], v11 offset:29696
s_waitcnt lgkmcnt(0)
s_mul_i32 s25, s37, 36
s_add_u32 m0, s26, 28672
s_add_u32 s24, s25, 110592
buffer_load_dwordx4 v2, s[20:23], s24 offen lds
s_add_u32 m0, s26, 29696
s_add_u32 s24, s25, 119808
buffer_load_dwordx4 v2, s[20:23], s24 offen lds
s_add_u32 m0, s26, 30720
s_add_u32 s24, s25, 129024
buffer_load_dwordx4 v2, s[20:23], s24 offen lds
s_add_u32 m0, s26, 31744
s_add_u32 s24, s25, 138240
buffer_load_dwordx4 v2, s[20:23], s24 offen lds
s_waitcnt vmcnt(0)
v_and_b32 v12, 15, v0
v_mul_u32_u24 v12, 2304, v12
v_lshrrev_b32 v13, 4, v0
v_lshl_add_u32 v12, v13, 3, v12
s_lshl_b32 s24, s40, 7
s_add_u32 s24, s24, s47
v_add_u32 v4, s24, v12
v_and_b32 v5, 7, v0
v_lshlrev_b32 v5, 2, v5
s_lshl_b32 s24, s17, 5
v_add_u32 v5, s24, v5
v_lshlrev_b32 v3, 4, v0
v_add_u32 v3, 131072, v3
s_lshl_b32 s24, s17, 12
s_add_u32 s24, s24, 131072
v_add_u32 v7, s24, v1
s_lshl_b32 s24, s17, 15
s_add_u32 s44, s44, s24
s_ff1_i32_b64 s41, s[42:43]
s_bitset0_b64 s[42:43], s41
s_lshl_b32 s41, s41, 1
s_add_u32 s41, s41, s51
s_and_b32 s41, s41, 127
L_opl_w:
s_lshr_b32 s25, s41, s46
s_lshl_b32 s25, s25, 7
s_add_u32 s25, s25, s45
s_mov_b32 s28, 0
L_poll_48:
buffer_load_dword v6, v5, s[8:11], s25 offen sc1
s_add_u32 s28, s28, 1
s_cmp_gt_u32 s28, 40000
s_cbranch_scc1 L_end
s_waitcnt vmcnt(0)
v_cmp_ne_u32 vcc, 1, v6
s_cbranch_vccz L_pd_49
s_sleep 1
s_cmp_lt_u32 s28, 32
s_cbranch_scc1 L_poll_48
s_sleep 32
s_branch L_poll_48
L_pd_49:
s_lshl_b32 s48, s41, 17
s_add_u32 s48, s48, s44
s_add_u32 s24, s48, s30
buffer_load_dwordx4 v[16:19], v1, s[8:11], s24 offen offset:0 sc1
buffer_load_dwordx4 v[20:23], v1, s[8:11], s24 offen offset:1024 sc1
buffer_load_dwordx4 v[24:27], v1, s[8:11], s24 offen offset:2048 sc1
buffer_load_dwordx4 v[28:31], v1, s[8:11], s24 offen offset:3072 sc1
s_add_u32 s24, s48, s31
buffer_load_dwordx4 v[32:35], v1, s[8:11], s24 offen offset:0 sc1
buffer_load_dwordx4 v[36:39], v1, s[8:11], s24 offen offset:1024 sc1
buffer_load_dwordx4 v[40:43], v1, s[8:11], s24 offen offset:2048 sc1
buffer_load_dwordx4 v[44:47], v1, s[8:11], s24 offen offset:3072 sc1
s_add_u32 s24, s48, s32
buffer_load_dwordx4 v[48:51], v1, s[8:11], s24 offen offset:0 sc1
buffer_load_dwordx4 v[52:55], v1, s[8:11], s24 offen offset:1024 sc1
buffer_load_dwordx4 v[56:59], v1, s[8:11], s24 offen offset:2048 sc1
buffer_load_dwordx4 v[60:63], v1, s[8:11], s24 offen offset:3072 sc1
s_add_u32 s24, s48, s33
buffer_load_dwordx4 v[64:67], v1, s[8:11], s24 offen offset:0 sc1
buffer_load_dwordx4 v[68:71], v1, s[8:11], s24 offen offset:1024 sc1
buffer_load_dwordx4 v[72:75], v1, s[8:11], s24 offen offset:2048 sc1
buffer_load_dwordx4 v[76:79], v1, s[8:11], s24 offen offset:3072 sc1
s_waitcnt vmcnt(15)
v_mfma_f32_16x16x32_bf16 v[80:83], v[128:131], v[16:19], 0
s_cmp_lg_u64 s[42:43], 0
s_cselect_b32 s52, 1, 0
ds_read_b64_tr_b16 v[112:113], v8 offset:0
v_mfma_f32_16x16x32_bf16 v[84:87], v[132:135], v[16:19], 0
s_ff1_i32_b64 s27, s[42:43]
ds_read_b64_tr_b16 v[114:115], v8 offset:1024
v_mfma_f32_16x16x32_bf16 v[88:91], v[136:139], v[16:19], 0
s_bitset0_b64 s[42:43], s27
s_add_u32 s24, s48, s34
ds_read_b64_tr_b16 v[116:117], v9 offset:0
v_mfma_f32_16x16x32_bf16 v[92:95], v[140:143], v[16:19], 0
s_lshl_b32 s27, s27, 1
ds_read_b64_tr_b16 v[118:119], v9 offset:1024
buffer_load_dwordx4 v[16:19], v1, s[8:11], s24 offen offset:0 sc1
s_waitcnt vmcnt(15)
v_mfma_f32_16x16x32_bf16 v[80:83], v[144:147], v[20:23], v[80:83]
s_add_u32 s27, s27, s51
ds_read_b64_tr_b16 v[120:121], v10 offset:0
v_mfma_f32_16x16x32_bf16 v[84:87], v[148:151], v[20:23], v[84:87]
s_and_b32 s27, s27, 127
ds_read_b64_tr_b16 v[122:123], v10 offset:1024
v_mfma_f32_16x16x32_bf16 v[88:91], v[152:155], v[20:23], v[88:91]
s_lshr_b32 s25, s27, s46
ds_read_b64_tr_b16 v[124:125], v11 offset:0
v_mfma_f32_16x16x32_bf16 v[92:95], v[156:159], v[20:23], v[92:95]
s_lshl_b32 s25, s25, 7
ds_read_b64_tr_b16 v[126:127], v11 offset:1024
buffer_load_dwordx4 v[20:23], v1, s[8:11], s24 offen offset:1024 sc1
s_waitcnt vmcnt(15)
v_mfma_f32_16x16x32_bf16 v[80:83], v[160:163], v[24:27], v[80:83]
s_add_u32 s25, s25, s45
v_mfma_f32_16x16x32_bf16 v[84:87], v[164:167], v[24:27], v[84:87]
s_lshl_b32 s49, s27, 17
v_mfma_f32_16x16x32_bf16 v[88:91], v[168:171], v[24:27], v[88:91]
s_add_u32 s49, s49, s44
v_mfma_f32_16x16x32_bf16 v[92:95], v[172:175], v[24:27], v[92:95]
buffer_load_dwordx4 v[24:27], v1, s[8:11], s24 offen offset:2048 sc1
buffer_load_dword v6, v5, s[8:11], s25 offen sc1
s_waitcnt vmcnt(16) lgkmcnt(0)
v_mfma_f32_16x16x32_bf16 v[80:83], v[112:115], v[28:31], v[80:83]
v_mfma_f32_16x16x32_bf16 v[84:87], v[116:119], v[28:31], v[84:87]
v_mfma_f32_16x16x32_bf16 v[88:91], v[120:123], v[28:31], v[88:91]
v_mfma_f32_16x16x32_bf16 v[92:95], v[124:127], v[28:31], v[92:95]
buffer_load_dwordx4 v[28:31], v1, s[8:11], s24 offen offset:3072 sc1
s_waitcnt vmcnt(16)
v_mfma_f32_16x16x32_bf16 v[80:83], v[176:179], v[32:35], v[80:83]
ds_read_b64_tr_b16 v[112:113], v8 offset:4096
v_mfma_f32_16x16x32_bf16 v[84:87], v[180:183], v[32:35], v[84:87]
ds_read_b64_tr_b16 v[114:115], v8 offset:5120
v_mfma_f32_16x16x32_bf16 v[88:91], v[184:187], v[32:35], v[88:91]
s_add_u32 s24, s48, s35
ds_read_b64_tr_b16 v[116:117], v9 offset:4096
v_mfma_f32_16x16x32_bf16 v[92:95], v[188:191], v[32:35], v[92:95]
ds_read_b64_tr_b16 v[118:119], v9 offset:5120
buffer_load_dwordx4 v[32:35], v1, s[8:11], s24 offen offset:0 sc1
s_waitcnt vmcnt(16)
v_mfma_f32_16x16x32_bf16 v[80:83], v[192:195], v[36:39], v[80:83]
ds_read_b64_tr_b16 v[120:121], v10 offset:4096
v_mfma_f32_16x16x32_bf16 v[84:87], v[196:199], v[36:39], v[84:87]
ds_read_b64_tr_b16 v[122:123], v10 offset:5120
v_mfma_f32_16x16x32_bf16 v[88:91], v[200:203], v[36:39], v[88:91]
ds_read_b64_tr_b16 v[124:125], v11 offset:4096
v_mfma_f32_16x16x32_bf16 v[92:95], v[204:207], v[36:39], v[92:95]
ds_read_b64_tr_b16 v[126:127], v11 offset:5120
buffer_load_dwordx4 v[36:39], v1, s[8:11], s24 offen offset:1024 sc1
s_waitcnt vmcnt(16)
v_mfma_f32_16x16x32_bf16 v[80:83], v[208:211], v[40:43], v[80:83]
v_mfma_f32_16x16x32_bf16 v[84:87], v[212:215], v[40:43], v[84:87]
v_mfma_f32_16x16x32_bf16 v[88:91], v[216:219], v[40:43], v[88:91]
v_mfma_f32_16x16x32_bf16 v[92:95], v[220:223], v[40:43], v[92:95]
buffer_load_dwordx4 v[40:43], v1, s[8:11], s24 offen offset:2048 sc1
s_waitcnt vmcnt(16) lgkmcnt(0)
v_mfma_f32_16x16x32_bf16 v[80:83], v[112:115], v[44:47], v[80:83]
v_mfma_f32_16x16x32_bf16 v[84:87], v[116:119], v[44:47], v[84:87]
v_mfma_f32_16x16x32_bf16 v[88:91], v[120:123], v[44:47], v[88:91]
v_mfma_f32_16x16x32_bf16 v[92:95], v[124:127], v[44:47], v[92:95]
buffer_load_dwordx4 v[44:47], v1, s[8:11], s24 offen offset:3072 sc1
s_waitcnt vmcnt(16)
v_mfma_f32_16x16x32_bf16 v[80:83], v[224:227], v[48:51], v[80:83]
ds_read_b64_tr_b16 v[112:113], v8 offset:8192
v_mfma_f32_16x16x32_bf16 v[84:87], v[228:231], v[48:51], v[84:87]
ds_read_b64_tr_b16 v[114:115], v8 offset:9216
v_mfma_f32_16x16x32_bf16 v[88:91], v[232:235], v[48:51], v[88:91]
s_add_u32 s24, s48, s36
ds_read_b64_tr_b16 v[116:117], v9 offset:8192
v_mfma_f32_16x16x32_bf16 v[92:95], v[236:239], v[48:51], v[92:95]
ds_read_b64_tr_b16 v[118:119], v9 offset:9216
buffer_load_dwordx4 v[48:51], v1, s[8:11], s24 offen offset:0 sc1
s_waitcnt vmcnt(16)
v_mfma_f32_16x16x32_bf16 v[80:83], v[240:243], v[52:55], v[80:83]
ds_read_b64_tr_b16 v[120:121], v10 offset:8192
v_mfma_f32_16x16x32_bf16 v[84:87], v[244:247], v[52:55], v[84:87]
ds_read_b64_tr_b16 v[122:123], v10 offset:9216
v_mfma_f32_16x16x32_bf16 v[88:91], v[248:251], v[52:55], v[88:91]
ds_read_b64_tr_b16 v[124:125], v11 offset:8192
v_mfma_f32_16x16x32_bf16 v[92:95], v[252:255], v[52:55], v[92:95]
ds_read_b64_tr_b16 v[126:127], v11 offset:9216
buffer_load_dwordx4 v[52:55], v1, s[8:11], s24 offen offset:1024 sc1
s_waitcnt vmcnt(16)
v_mfma_f32_16x16x32_bf16 v[80:83], a[0:3], v[56:59], v[80:83]
v_mfma_f32_16x16x32_bf16 v[84:87], a[4:7], v[56:59], v[84:87]
v_mfma_f32_16x16x32_bf16 v[88:91], a[8:11], v[56:59], v[88:91]
v_mfma_f32_16x16x32_bf16 v[92:95], a[12:15], v[56:59], v[92:95]
buffer_load_dwordx4 v[56:59], v1, s[8:11], s24 offen offset:2048 sc1
s_waitcnt vmcnt(16) lgkmcnt(0)
v_mfma_f32_16x16x32_bf16 v[80:83], v[112:115], v[60:63], v[80:83]
v_mfma_f32_16x16x32_bf16 v[84:87], v[116:119], v[60:63], v[84:87]
v_mfma_f32_16x16x32_bf16 v[88:91], v[120:123], v[60:63], v[88:91]
v_mfma_f32_16x16x32_bf16 v[92:95], v[124:127], v[60:63], v[92:95]
buffer_load_dwordx4 v[60:63], v1, s[8:11], s24 offen offset:3072 sc1
s_waitcnt vmcnt(16)
v_mfma_f32_16x16x32_bf16 v[80:83], a[16:19], v[64:67], v[80:83]
ds_read_b64_tr_b16 v[112:113], v8 offset:12288
v_mfma_f32_16x16x32_bf16 v[84:87], a[20:23], v[64:67], v[84:87]
ds_read_b64_tr_b16 v[114:115], v8 offset:13312
v_mfma_f32_16x16x32_bf16 v[88:91], a[24:27], v[64:67], v[88:91]
s_add_u32 s24, s48, s37
ds_read_b64_tr_b16 v[116:117], v9 offset:12288
v_mfma_f32_16x16x32_bf16 v[92:95], a[28:31], v[64:67], v[92:95]
ds_read_b64_tr_b16 v[118:119], v9 offset:13312
buffer_load_dwordx4 v[64:67], v1, s[8:11], s24 offen offset:0 sc1
s_waitcnt vmcnt(16)
v_mfma_f32_16x16x32_bf16 v[80:83], a[32:35], v[68:71], v[80:83]
ds_read_b64_tr_b16 v[120:121], v10 offset:12288
v_mfma_f32_16x16x32_bf16 v[84:87], a[36:39], v[68:71], v[84:87]
ds_read_b64_tr_b16 v[122:123], v10 offset:13312
v_mfma_f32_16x16x32_bf16 v[88:91], a[40:43], v[68:71], v[88:91]
ds_read_b64_tr_b16 v[124:125], v11 offset:12288
v_mfma_f32_16x16x32_bf16 v[92:95], a[44:47], v[68:71], v[92:95]
ds_read_b64_tr_b16 v[126:127], v11 offset:13312
buffer_load_dwordx4 v[68:71], v1, s[8:11], s24 offen offset:1024 sc1
buffer_load_dword v6, v5, s[8:11], s25 offen sc1
s_branch L_opl_t0
L_opl_r0:
s_waitcnt vmcnt(15)
v_mfma_f32_16x16x32_bf16 v[80:83], v[128:131], v[16:19], 0
s_cmp_lg_u64 s[42:43], 0
s_cselect_b32 s52, 1, 0
ds_read_b64_tr_b16 v[112:113], v8 offset:0
v_mfma_f32_16x16x32_bf16 v[84:87], v[132:135], v[16:19], 0
s_ff1_i32_b64 s27, s[42:43]
ds_read_b64_tr_b16 v[114:115], v8 offset:1024
v_mfma_f32_16x16x32_bf16 v[88:91], v[136:139], v[16:19], 0
s_bitset0_b64 s[42:43], s27
s_add_u32 s24, s48, s34
ds_read_b64_tr_b16 v[116:117], v9 offset:0
v_mfma_f32_16x16x32_bf16 v[92:95], v[140:143], v[16:19], 0
s_lshl_b32 s27, s27, 1
ds_read_b64_tr_b16 v[118:119], v9 offset:1024
buffer_load_dwordx4 v[16:19], v1, s[8:11], s24 offen offset:0 sc1
s_waitcnt vmcnt(15)
v_mfma_f32_16x16x32_bf16 v[80:83], v[144:147], v[20:23], v[80:83]
s_add_u32 s27, s27, s51
ds_read_b64_tr_b16 v[120:121], v10 offset:0
v_mfma_f32_16x16x32_bf16 v[84:87], v[148:151], v[20:23], v[84:87]
s_and_b32 s27, s27, 127
ds_read_b64_tr_b16 v[122:123], v10 offset:1024
v_mfma_f32_16x16x32_bf16 v[88:91], v[152:155], v[20:23], v[88:91]
s_lshr_b32 s25, s27, s46
ds_read_b64_tr_b16 v[124:125], v11 offset:0
v_mfma_f32_16x16x32_bf16 v[92:95], v[156:159], v[20:23], v[92:95]
s_lshl_b32 s25, s25, 7
ds_read_b64_tr_b16 v[126:127], v11 offset:1024
buffer_load_dwordx4 v[20:23], v1, s[8:11], s24 offen offset:1024 sc1
s_waitcnt vmcnt(15)
v_mfma_f32_16x16x32_bf16 v[80:83], v[160:163], v[24:27], v[80:83]
s_add_u32 s25, s25, s45
v_mfma_f32_16x16x32_bf16 v[84:87], v[164:167], v[24:27], v[84:87]
s_lshl_b32 s49, s27, 17
v_mfma_f32_16x16x32_bf16 v[88:91], v[168:171], v[24:27], v[88:91]
s_add_u32 s49, s49, s44
v_mfma_f32_16x16x32_bf16 v[92:95], v[172:175], v[24:27], v[92:95]
buffer_load_dwordx4 v[24:27], v1, s[8:11], s24 offen offset:2048 sc1
buffer_load_dword v6, v5, s[8:11], s25 offen sc1
s_waitcnt vmcnt(16) lgkmcnt(0)
v_mfma_f32_16x16x32_bf16 v[80:83], v[112:115], v[28:31], v[80:83]
ds_write_b128 v3, v[96:99] offset:0
v_mfma_f32_16x16x32_bf16 v[84:87], v[116:119], v[28:31], v[84:87]
ds_write_b128 v3, v[100:103] offset:4096
v_mfma_f32_16x16x32_bf16 v[88:91], v[120:123], v[28:31], v[88:91]
ds_write_b128 v3, v[104:107] offset:8192
v_mfma_f32_16x16x32_bf16 v[92:95], v[124:127], v[28:31], v[92:95]
ds_write_b128 v3, v[108:111] offset:12288
buffer_load_dwordx4 v[28:31], v1, s[8:11], s24 offen offset:3072 sc1
s_waitcnt vmcnt(16)
v_mfma_f32_16x16x32_bf16 v[80:83], v[176:179], v[32:35], v[80:83]
ds_read_b64_tr_b16 v[112:113], v8 offset:4096
v_mfma_f32_16x16x32_bf16 v[84:87], v[180:183], v[32:35], v[84:87]
ds_read_b64_tr_b16 v[114:115], v8 offset:5120
v_mfma_f32_16x16x32_bf16 v[88:91], v[184:187], v[32:35], v[88:91]
s_add_u32 s24, s48, s35
ds_read_b64_tr_b16 v[116:117], v9 offset:4096
v_mfma_f32_16x16x32_bf16 v[92:95], v[188:191], v[32:35], v[92:95]
ds_read_b64_tr_b16 v[118:119], v9 offset:5120
buffer_load_dwordx4 v[32:35], v1, s[8:11], s24 offen offset:0 sc1
s_waitcnt vmcnt(16)
v_mfma_f32_16x16x32_bf16 v[80:83], v[192:195], v[36:39], v[80:83]
ds_read_b64_tr_b16 v[120:121], v10 offset:4096
v_mfma_f32_16x16x32_bf16 v[84:87], v[196:199], v[36:39], v[84:87]
ds_read_b64_tr_b16 v[122:123], v10 offset:5120
v_mfma_f32_16x16x32_bf16 v[88:91], v[200:203], v[36:39], v[88:91]
ds_read_b64_tr_b16 v[124:125], v11 offset:4096
v_mfma_f32_16x16x32_bf16 v[92:95], v[204:207], v[36:39], v[92:95]
ds_read_b64_tr_b16 v[126:127], v11 offset:5120
buffer_load_dwordx4 v[36:39], v1, s[8:11], s24 offen offset:1024 sc1
s_waitcnt vmcnt(16)
v_mfma_f32_16x16x32_bf16 v[80:83], v[208:211], v[40:43], v[80:83]
v_mfma_f32_16x16x32_bf16 v[84:87], v[212:215], v[40:43], v[84:87]
v_mfma_f32_16x16x32_bf16 v[88:91], v[216:219], v[40:43], v[88:91]
v_mfma_f32_16x16x32_bf16 v[92:95], v[220:223], v[40:43], v[92:95]
buffer_load_dwordx4 v[40:43], v1, s[8:11], s24 offen offset:2048 sc1
s_waitcnt vmcnt(16) lgkmcnt(0)
s_barrier
v_mfma_f32_16x16x32_bf16 v[80:83], v[112:115], v[44:47], v[80:83]
ds_read_b128 v[96:99], v7 offset:0
v_mfma_f32_16x16x32_bf16 v[84:87], v[116:119], v[44:47], v[84:87]
ds_read_b128 v[100:103], v7 offset:1024
v_mfma_f32_16x16x32_bf16 v[88:91], v[120:123], v[44:47], v[88:91]
ds_read_b128 v[104:107], v7 offset:2048
v_mfma_f32_16x16x32_bf16 v[92:95], v[124:127], v[44:47], v[92:95]
ds_read_b128 v[108:111], v7 offset:3072
buffer_load_dwordx4 v[44:47], v1, s[8:11], s24 offen offset:3072 sc1
s_waitcnt vmcnt(16)
v_mfma_f32_16x16x32_bf16 v[80:83], v[224:227], v[48:51], v[80:83]
ds_read_b64_tr_b16 v[112:113], v8 offset:8192
v_mfma_f32_16x16x32_bf16 v[84:87], v[228:231], v[48:51], v[84:87]
ds_read_b64_tr_b16 v[114:115], v8 offset:9216
v_mfma_f32_16x16x32_bf16 v[88:91], v[232:235], v[48:51], v[88:91]
s_add_u32 s24, s48, s36
ds_read_b64_tr_b16 v[116:117], v9 offset:8192
v_mfma_f32_16x16x32_bf16 v[92:95], v[236:239], v[48:51], v[92:95]
ds_read_b64_tr_b16 v[118:119], v9 offset:9216
buffer_load_dwordx4 v[48:51], v1, s[8:11], s24 offen offset:0 sc1
s_waitcnt vmcnt(16)
v_mfma_f32_16x16x32_bf16 v[80:83], v[240:243], v[52:55], v[80:83]
ds_read_b64_tr_b16 v[120:121], v10 offset:8192
v_mfma_f32_16x16x32_bf16 v[84:87], v[244:247], v[52:55], v[84:87]
ds_read_b64_tr_b16 v[122:123], v10 offset:9216
v_mfma_f32_16x16x32_bf16 v[88:91], v[248:251], v[52:55], v[88:91]
ds_read_b64_tr_b16 v[124:125], v11 offset:8192
v_mfma_f32_16x16x32_bf16 v[92:95], v[252:255], v[52:55], v[92:95]
ds_read_b64_tr_b16 v[126:127], v11 offset:9216
buffer_load_dwordx4 v[52:55], v1, s[8:11], s24 offen offset:1024 sc1
s_waitcnt vmcnt(16)
v_mfma_f32_16x16x32_bf16 v[80:83], a[0:3], v[56:59], v[80:83]
v_mfma_f32_16x16x32_bf16 v[84:87], a[4:7], v[56:59], v[84:87]
v_mfma_f32_16x16x32_bf16 v[88:91], a[8:11], v[56:59], v[88:91]
v_mfma_f32_16x16x32_bf16 v[92:95], a[12:15], v[56:59], v[92:95]
buffer_load_dwordx4 v[56:59], v1, s[8:11], s24 offen offset:2048 sc1
s_waitcnt vmcnt(16) lgkmcnt(0)
v_mfma_f32_16x16x32_bf16 v[80:83], v[112:115], v[60:63], v[80:83]
v_add_f32 v96, v96, v100
v_add_f32 v97, v97, v101
v_mfma_f32_16x16x32_bf16 v[84:87], v[116:119], v[60:63], v[84:87]
v_add_f32 v98, v98, v102
v_add_f32 v99, v99, v103
v_mfma_f32_16x16x32_bf16 v[88:91], v[120:123], v[60:63], v[88:91]
v_add_f32 v96, v96, v104
v_add_f32 v97, v97, v105
v_mfma_f32_16x16x32_bf16 v[92:95], v[124:127], v[60:63], v[92:95]
v_add_f32 v98, v98, v106
v_add_f32 v99, v99, v107
buffer_load_dwordx4 v[60:63], v1, s[8:11], s24 offen offset:3072 sc1
s_waitcnt vmcnt(16)
v_mfma_f32_16x16x32_bf16 v[80:83], a[16:19], v[64:67], v[80:83]
ds_read_b64_tr_b16 v[112:113], v8 offset:12288
v_add_f32 v96, v96, v108
v_mfma_f32_16x16x32_bf16 v[84:87], a[20:23], v[64:67], v[84:87]
ds_read_b64_tr_b16 v[114:115], v8 offset:13312
v_add_f32 v97, v97, v109
v_mfma_f32_16x16x32_bf16 v[88:91], a[24:27], v[64:67], v[88:91]
s_add_u32 s24, s48, s37
ds_read_b64_tr_b16 v[116:117], v9 offset:12288
v_add_f32 v98, v98, v110
v_mfma_f32_16x16x32_bf16 v[92:95], a[28:31], v[64:67], v[92:95]
ds_read_b64_tr_b16 v[118:119], v9 offset:13312
v_add_f32 v99, v99, v111
buffer_load_dwordx4 v[64:67], v1, s[8:11], s24 offen offset:0 sc1
s_waitcnt vmcnt(16)
v_mfma_f32_16x16x32_bf16 v[80:83], a[32:35], v[68:71], v[80:83]
ds_read_b64_tr_b16 v[120:121], v10 offset:12288
v_cvt_pk_bf16_f32 v12, v96, v97
v_mfma_f32_16x16x32_bf16 v[84:87], a[36:39], v[68:71], v[84:87]
ds_read_b64_tr_b16 v[122:123], v10 offset:13312
v_cvt_pk_bf16_f32 v13, v98, v99
v_mfma_f32_16x16x32_bf16 v[88:91], a[40:43], v[68:71], v[88:91]
ds_read_b64_tr_b16 v[124:125], v11 offset:12288
v_xor_b32 v3, 16384, v3
v_mfma_f32_16x16x32_bf16 v[92:95], a[44:47], v[68:71], v[92:95]
ds_read_b64_tr_b16 v[126:127], v11 offset:13312
v_xor_b32 v7, 16384, v7
buffer_load_dwordx4 v[68:71], v1, s[8:11], s24 offen offset:1024 sc1
buffer_store_dwordx2 v[12:13], v4, s[12:15], s53 offen
L_opl_t0:
s_waitcnt vmcnt(17)
v_mfma_f32_16x16x32_bf16 v[80:83], a[48:51], v[72:75], v[80:83]
v_mfma_f32_16x16x32_bf16 v[84:87], a[52:55], v[72:75], v[84:87]
v_mfma_f32_16x16x32_bf16 v[88:91], a[56:59], v[72:75], v[88:91]
v_mfma_f32_16x16x32_bf16 v[92:95], a[60:63], v[72:75], v[92:95]
buffer_load_dwordx4 v[72:75], v1, s[8:11], s24 offen offset:2048 sc1
s_waitcnt vmcnt(17) lgkmcnt(0)
v_mfma_f32_16x16x32_bf16 v[80:83], v[112:115], v[76:79], v[80:83]
s_waitcnt vmcnt(13)
v_cmp_ne_u32 vcc, 1, v6
v_mfma_f32_16x16x32_bf16 v[84:87], v[116:119], v[76:79], v[84:87]
v_mfma_f32_16x16x32_bf16 v[88:91], v[120:123], v[76:79], v[88:91]
s_cmp_eq_u64 vcc, 0
s_cselect_b32 s50, s52, 0
v_mfma_f32_16x16x32_bf16 v[92:95], v[124:127], v[76:79], v[92:95]
buffer_load_dwordx4 v[76:79], v1, s[8:11], s24 offen offset:3072 sc1
s_waitcnt vmcnt(17)
v_mfma_f32_16x16x32_bf16 v[80:83], a[64:67], v[16:19], v[80:83]
s_cmp_eq_u32 s50, 1
s_cselect_b32 s49, s49, 536870912
ds_read_b64_tr_b16 v[112:113], v8 offset:16384
v_mfma_f32_16x16x32_bf16 v[84:87], a[68:71], v[16:19], v[84:87]
ds_read_b64_tr_b16 v[114:115], v8 offset:17408
v_mfma_f32_16x16x32_bf16 v[88:91], a[72:75], v[16:19], v[88:91]
s_add_u32 s24, s49, s30
ds_read_b64_tr_b16 v[116:117], v9 offset:16384
v_mfma_f32_16x16x32_bf16 v[92:95], a[76:79], v[16:19], v[92:95]
ds_read_b64_tr_b16 v[118:119], v9 offset:17408
buffer_load_dwordx4 v[16:19], v1, s[8:11], s24 offen offset:0 sc1
s_waitcnt vmcnt(17)
v_mfma_f32_16x16x32_bf16 v[80:83], a[80:83], v[20:23], v[80:83]
ds_read_b64_tr_b16 v[120:121], v10 offset:16384
v_mfma_f32_16x16x32_bf16 v[84:87], a[84:87], v[20:23], v[84:87]
ds_read_b64_tr_b16 v[122:123], v10 offset:17408
v_mfma_f32_16x16x32_bf16 v[88:91], a[88:91], v[20:23], v[88:91]
ds_read_b64_tr_b16 v[124:125], v11 offset:16384
v_mfma_f32_16x16x32_bf16 v[92:95], a[92:95], v[20:23], v[92:95]
ds_read_b64_tr_b16 v[126:127], v11 offset:17408
buffer_load_dwordx4 v[20:23], v1, s[8:11], s24 offen offset:1024 sc1
s_waitcnt vmcnt(17)
v_mfma_f32_16x16x32_bf16 v[80:83], a[96:99], v[24:27], v[80:83]
v_mfma_f32_16x16x32_bf16 v[84:87], a[100:103], v[24:27], v[84:87]
v_mfma_f32_16x16x32_bf16 v[88:91], a[104:107], v[24:27], v[88:91]
v_mfma_f32_16x16x32_bf16 v[92:95], a[108:111], v[24:27], v[92:95]
buffer_load_dwordx4 v[24:27], v1, s[8:11], s24 offen offset:2048 sc1
s_waitcnt vmcnt(16) lgkmcnt(0)
v_mfma_f32_16x16x32_bf16 v[80:83], v[112:115], v[28:31], v[80:83]
v_mfma_f32_16x16x32_bf16 v[84:87], v[116:119], v[28:31], v[84:87]
v_mfma_f32_16x16x32_bf16 v[88:91], v[120:123], v[28:31], v[88:91]
v_mfma_f32_16x16x32_bf16 v[92:95], v[124:127], v[28:31], v[92:95]
buffer_load_dwordx4 v[28:31], v1, s[8:11], s24 offen offset:3072 sc1
s_waitcnt vmcnt(16)
v_mfma_f32_16x16x32_bf16 v[80:83], a[112:115], v[32:35], v[80:83]
ds_read_b64_tr_b16 v[112:113], v8 offset:20480
v_mfma_f32_16x16x32_bf16 v[84:87], a[116:119], v[32:35], v[84:87]
ds_read_b64_tr_b16 v[114:115], v8 offset:21504
v_mfma_f32_16x16x32_bf16 v[88:91], a[120:123], v[32:35], v[88:91]
s_add_u32 s24, s49, s31
ds_read_b64_tr_b16 v[116:117], v9 offset:20480
v_mfma_f32_16x16x32_bf16 v[92:95], a[124:127], v[32:35], v[92:95]
ds_read_b64_tr_b16 v[118:119], v9 offset:21504
buffer_load_dwordx4 v[32:35], v1, s[8:11], s24 offen offset:0 sc1
s_waitcnt vmcnt(16)
v_mfma_f32_16x16x32_bf16 v[80:83], a[128:131], v[36:39], v[80:83]
ds_read_b64_tr_b16 v[120:121], v10 offset:20480
v_mfma_f32_16x16x32_bf16 v[84:87], a[132:135], v[36:39], v[84:87]
ds_read_b64_tr_b16 v[122:123], v10 offset:21504
v_mfma_f32_16x16x32_bf16 v[88:91], a[136:139], v[36:39], v[88:91]
ds_read_b64_tr_b16 v[124:125], v11 offset:20480
v_mfma_f32_16x16x32_bf16 v[92:95], a[140:143], v[36:39], v[92:95]
ds_read_b64_tr_b16 v[126:127], v11 offset:21504
buffer_load_dwordx4 v[36:39], v1, s[8:11], s24 offen offset:1024 sc1
s_waitcnt vmcnt(16)
v_mfma_f32_16x16x32_bf16 v[80:83], a[144:147], v[40:43], v[80:83]
v_mfma_f32_16x16x32_bf16 v[84:87], a[148:151], v[40:43], v[84:87]
v_mfma_f32_16x16x32_bf16 v[88:91], a[152:155], v[40:43], v[88:91]
v_mfma_f32_16x16x32_bf16 v[92:95], a[156:159], v[40:43], v[92:95]
buffer_load_dwordx4 v[40:43], v1, s[8:11], s24 offen offset:2048 sc1
s_waitcnt vmcnt(16) lgkmcnt(0)
v_mfma_f32_16x16x32_bf16 v[80:83], v[112:115], v[44:47], v[80:83]
v_mfma_f32_16x16x32_bf16 v[84:87], v[116:119], v[44:47], v[84:87]
v_mfma_f32_16x16x32_bf16 v[88:91], v[120:123], v[44:47], v[88:91]
v_mfma_f32_16x16x32_bf16 v[92:95], v[124:127], v[44:47], v[92:95]
buffer_load_dwordx4 v[44:47], v1, s[8:11], s24 offen offset:3072 sc1
s_waitcnt vmcnt(16)
v_mfma_f32_16x16x32_bf16 v[80:83], a[160:163], v[48:51], v[80:83]
ds_read_b64_tr_b16 v[112:113], v8 offset:24576
v_mfma_f32_16x16x32_bf16 v[84:87], a[164:167], v[48:51], v[84:87]
ds_read_b64_tr_b16 v[114:115], v8 offset:25600
v_mfma_f32_16x16x32_bf16 v[88:91], a[168:171], v[48:51], v[88:91]
s_add_u32 s24, s49, s32
ds_read_b64_tr_b16 v[116:117], v9 offset:24576
v_mfma_f32_16x16x32_bf16 v[92:95], a[172:175], v[48:51], v[92:95]
ds_read_b64_tr_b16 v[118:119], v9 offset:25600
buffer_load_dwordx4 v[48:51], v1, s[8:11], s24 offen offset:0 sc1
s_waitcnt vmcnt(16)
v_mfma_f32_16x16x32_bf16 v[80:83], a[176:179], v[52:55], v[80:83]
ds_read_b64_tr_b16 v[120:121], v10 offset:24576
v_mfma_f32_16x16x32_bf16 v[84:87], a[180:183], v[52:55], v[84:87]
ds_read_b64_tr_b16 v[122:123], v10 offset:25600
v_mfma_f32_16x16x32_bf16 v[88:91], a[184:187], v[52:55], v[88:91]
ds_read_b64_tr_b16 v[124:125], v11 offset:24576
v_mfma_f32_16x16x32_bf16 v[92:95], a[188:191], v[52:55], v[92:95]
ds_read_b64_tr_b16 v[126:127], v11 offset:25600
buffer_load_dwordx4 v[52:55], v1, s[8:11], s24 offen offset:1024 sc1
s_waitcnt vmcnt(16)
v_mfma_f32_16x16x32_bf16 v[80:83], a[192:195], v[56:59], v[80:83]
v_mfma_f32_16x16x32_bf16 v[84:87], a[196:199], v[56:59], v[84:87]
v_mfma_f32_16x16x32_bf16 v[88:91], a[200:203], v[56:59], v[88:91]
v_mfma_f32_16x16x32_bf16 v[92:95], a[204:207], v[56:59], v[92:95]
buffer_load_dwordx4 v[56:59], v1, s[8:11], s24 offen offset:2048 sc1
s_waitcnt vmcnt(16) lgkmcnt(0)
v_mfma_f32_16x16x32_bf16 v[80:83], v[112:115], v[60:63], v[80:83]
v_mfma_f32_16x16x32_bf16 v[84:87], v[116:119], v[60:63], v[84:87]
v_mfma_f32_16x16x32_bf16 v[88:91], v[120:123], v[60:63], v[88:91]
v_mfma_f32_16x16x32_bf16 v[92:95], v[124:127], v[60:63], v[92:95]
buffer_load_dwordx4 v[60:63], v1, s[8:11], s24 offen offset:3072 sc1
s_waitcnt vmcnt(16)
v_mfma_f32_16x16x32_bf16 v[80:83], a[208:211], v[64:67], v[80:83]
ds_read_b64_tr_b16 v[112:113], v8 offset:28672
v_mfma_f32_16x16x32_bf16 v[84:87], a[212:215], v[64:67], v[84:87]
ds_read_b64_tr_b16 v[114:115], v8 offset:29696
v_mfma_f32_16x16x32_bf16 v[88:91], a[216:219], v[64:67], v[88:91]
s_add_u32 s24, s49, s33
ds_read_b64_tr_b16 v[116:117], v9 offset:28672
v_mfma_f32_16x16x32_bf16 v[92:95], a[220:223], v[64:67], v[92:95]
ds_read_b64_tr_b16 v[118:119], v9 offset:29696
buffer_load_dwordx4 v[64:67], v1, s[8:11], s24 offen offset:0 sc1
s_waitcnt vmcnt(16)
v_mfma_f32_16x16x32_bf16 v[80:83], a[224:227], v[68:71], v[80:83]
ds_read_b64_tr_b16 v[120:121], v10 offset:28672
v_mfma_f32_16x16x32_bf16 v[84:87], a[228:231], v[68:71], v[84:87]
ds_read_b64_tr_b16 v[122:123], v10 offset:29696
v_mfma_f32_16x16x32_bf16 v[88:91], a[232:235], v[68:71], v[88:91]
ds_read_b64_tr_b16 v[124:125], v11 offset:28672
v_mfma_f32_16x16x32_bf16 v[92:95], a[236:239], v[68:71], v[92:95]
ds_read_b64_tr_b16 v[126:127], v11 offset:29696
buffer_load_dwordx4 v[68:71], v1, s[8:11], s24 offen offset:1024 sc1
s_waitcnt vmcnt(15)
v_mfma_f32_16x16x32_bf16 v[80:83], a[240:243], v[72:75], v[80:83]
v_mfma_f32_16x16x32_bf16 v[84:87], a[244:247], v[72:75], v[84:87]
v_mfma_f32_16x16x32_bf16 v[88:91], a[248:251], v[72:75], v[88:91]
v_mfma_f32_16x16x32_bf16 v[92:95], a[252:255], v[72:75], v[92:95]
buffer_load_dwordx4 v[72:75], v1, s[8:11], s24 offen offset:2048 sc1
s_waitcnt vmcnt(15) lgkmcnt(0)
v_mfma_f32_16x16x32_bf16 v[80:83], v[112:115], v[76:79], v[80:83]
v_mfma_f32_16x16x32_bf16 v[84:87], v[116:119], v[76:79], v[84:87]
v_mfma_f32_16x16x32_bf16 v[88:91], v[120:123], v[76:79], v[88:91]
v_mfma_f32_16x16x32_bf16 v[92:95], v[124:127], v[76:79], v[92:95]
buffer_load_dwordx4 v[76:79], v1, s[8:11], s24 offen offset:3072 sc1
s_mul_i32 s53, s41, 36864
s_mov_b32 s41, s27
s_mov_b32 s48, s49
s_cmp_eq_u32 s50, 0
s_cbranch_scc1 L_opl_c0
L_opl_r1:
s_waitcnt vmcnt(15)
v_mfma_f32_16x16x32_bf16 v[96:99], v[128:131], v[16:19], 0
s_cmp_lg_u64 s[42:43], 0
s_cselect_b32 s52, 1, 0
ds_read_b64_tr_b16 v[112:113], v8 offset:0
v_mfma_f32_16x16x32_bf16 v[100:103], v[132:135], v[16:19], 0
s_ff1_i32_b64 s27, s[42:43]
ds_read_b64_tr_b16 v[114:115], v8 offset:1024
v_mfma_f32_16x16x32_bf16 v[104:107], v[136:139], v[16:19], 0
s_bitset0_b64 s[42:43], s27
s_add_u32 s24, s48, s34
ds_read_b64_tr_b16 v[116:117], v9 offset:0
v_mfma_f32_16x16x32_bf16 v[108:111], v[140:143], v[16:19], 0
s_lshl_b32 s27, s27, 1
ds_read_b64_tr_b16 v[118:119], v9 offset:1024
buffer_load_dwordx4 v[16:19], v1, s[8:11], s24 offen offset:0 sc1
s_waitcnt vmcnt(15)
v_mfma_f32_16x16x32_bf16 v[96:99], v[144:147], v[20:23], v[96:99]
s_add_u32 s27, s27, s51
ds_read_b64_tr_b16 v[120:121], v10 offset:0
v_mfma_f32_16x16x32_bf16 v[100:103], v[148:151], v[20:23], v[100:103]
s_and_b32 s27, s27, 127
ds_read_b64_tr_b16 v[122:123], v10 offset:1024
v_mfma_f32_16x16x32_bf16 v[104:107], v[152:155], v[20:23], v[104:107]
s_lshr_b32 s25, s27, s46
ds_read_b64_tr_b16 v[124:125], v11 offset:0
v_mfma_f32_16x16x32_bf16 v[108:111], v[156:159], v[20:23], v[108:111]
s_lshl_b32 s25, s25, 7
ds_read_b64_tr_b16 v[126:127], v11 offset:1024
buffer_load_dwordx4 v[20:23], v1, s[8:11], s24 offen offset:1024 sc1
s_waitcnt vmcnt(15)
v_mfma_f32_16x16x32_bf16 v[96:99], v[160:163], v[24:27], v[96:99]
s_add_u32 s25, s25, s45
v_mfma_f32_16x16x32_bf16 v[100:103], v[164:167], v[24:27], v[100:103]
s_lshl_b32 s49, s27, 17
v_mfma_f32_16x16x32_bf16 v[104:107], v[168:171], v[24:27], v[104:107]
s_add_u32 s49, s49, s44
v_mfma_f32_16x16x32_bf16 v[108:111], v[172:175], v[24:27], v[108:111]
buffer_load_dwordx4 v[24:27], v1, s[8:11], s24 offen offset:2048 sc1
buffer_load_dword v6, v5, s[8:11], s25 offen sc1
s_waitcnt vmcnt(16) lgkmcnt(0)
v_mfma_f32_16x16x32_bf16 v[96:99], v[112:115], v[28:31], v[96:99]
ds_write_b128 v3, v[80:83] offset:0
v_mfma_f32_16x16x32_bf16 v[100:103], v[116:119], v[28:31], v[100:103]
ds_write_b128 v3, v[84:87] offset:4096
v_mfma_f32_16x16x32_bf16 v[104:107], v[120:123], v[28:31], v[104:107]
ds_write_b128 v3, v[88:91] offset:8192
v_mfma_f32_16x16x32_bf16 v[108:111], v[124:127], v[28:31], v[108:111]
ds_write_b128 v3, v[92:95] offset:12288
buffer_load_dwordx4 v[28:31], v1, s[8:11], s24 offen offset:3072 sc1
s_waitcnt vmcnt(16)
v_mfma_f32_16x16x32_bf16 v[96:99], v[176:179], v[32:35], v[96:99]
ds_read_b64_tr_b16 v[112:113], v8 offset:4096
v_mfma_f32_16x16x32_bf16 v[100:103], v[180:183], v[32:35], v[100:103]
ds_read_b64_tr_b16 v[114:115], v8 offset:5120
v_mfma_f32_16x16x32_bf16 v[104:107], v[184:187], v[32:35], v[104:107]
s_add_u32 s24, s48, s35
ds_read_b64_tr_b16 v[116:117], v9 offset:4096
v_mfma_f32_16x16x32_bf16 v[108:111], v[188:191], v[32:35], v[108:111]
ds_read_b64_tr_b16 v[118:119], v9 offset:5120
buffer_load_dwordx4 v[32:35], v1, s[8:11], s24 offen offset:0 sc1
s_waitcnt vmcnt(16)
v_mfma_f32_16x16x32_bf16 v[96:99], v[192:195], v[36:39], v[96:99]
ds_read_b64_tr_b16 v[120:121], v10 offset:4096
v_mfma_f32_16x16x32_bf16 v[100:103], v[196:199], v[36:39], v[100:103]
ds_read_b64_tr_b16 v[122:123], v10 offset:5120
v_mfma_f32_16x16x32_bf16 v[104:107], v[200:203], v[36:39], v[104:107]
ds_read_b64_tr_b16 v[124:125], v11 offset:4096
v_mfma_f32_16x16x32_bf16 v[108:111], v[204:207], v[36:39], v[108:111]
ds_read_b64_tr_b16 v[126:127], v11 offset:5120
buffer_load_dwordx4 v[36:39], v1, s[8:11], s24 offen offset:1024 sc1
s_waitcnt vmcnt(16)
v_mfma_f32_16x16x32_bf16 v[96:99], v[208:211], v[40:43], v[96:99]
v_mfma_f32_16x16x32_bf16 v[100:103], v[212:215], v[40:43], v[100:103]
v_mfma_f32_16x16x32_bf16 v[104:107], v[216:219], v[40:43], v[104:107]
v_mfma_f32_16x16x32_bf16 v[108:111], v[220:223], v[40:43], v[108:111]
buffer_load_dwordx4 v[40:43], v1, s[8:11], s24 offen offset:2048 sc1
s_waitcnt vmcnt(16) lgkmcnt(0)
s_barrier
v_mfma_f32_16x16x32_bf16 v[96:99], v[112:115], v[44:47], v[96:99]
ds_read_b128 v[80:83], v7 offset:0
v_mfma_f32_16x16x32_bf16 v[100:103], v[116:119], v[44:47], v[100:103]
ds_read_b128 v[84:87], v7 offset:1024
v_mfma_f32_16x16x32_bf16 v[104:107], v[120:123], v[44:47], v[104:107]
ds_read_b128 v[88:91], v7 offset:2048
v_mfma_f32_16x16x32_bf16 v[108:111], v[124:127], v[44:47], v[108:111]
ds_read_b128 v[92:95], v7 offset:3072
buffer_load_dwordx4 v[44:47], v1, s[8:11], s24 offen offset:3072 sc1
s_waitcnt vmcnt(16)
v_mfma_f32_16x16x32_bf16 v[96:99], v[224:227], v[48:51], v[96:99]
ds_read_b64_tr_b16 v[112:113], v8 offset:8192
v_mfma_f32_16x16x32_bf16 v[100:103], v[228:231], v[48:51], v[100:103]
ds_read_b64_tr_b16 v[114:115], v8 offset:9216
v_mfma_f32_16x16x32_bf16 v[104:107], v[232:235], v[48:51], v[104:107]
s_add_u32 s24, s48, s36
ds_read_b64_tr_b16 v[116:117], v9 offset:8192
v_mfma_f32_16x16x32_bf16 v[108:111], v[236:239], v[48:51], v[108:111]
ds_read_b64_tr_b16 v[118:119], v9 offset:9216
buffer_load_dwordx4 v[48:51], v1, s[8:11], s24 offen offset:0 sc1
s_waitcnt vmcnt(16)
v_mfma_f32_16x16x32_bf16 v[96:99], v[240:243], v[52:55], v[96:99]
ds_read_b64_tr_b16 v[120:121], v10 offset:8192
v_mfma_f32_16x16x32_bf16 v[100:103], v[244:247], v[52:55], v[100:103]
ds_read_b64_tr_b16 v[122:123], v10 offset:9216
v_mfma_f32_16x16x32_bf16 v[104:107], v[248:251], v[52:55], v[104:107]
ds_read_b64_tr_b16 v[124:125], v11 offset:8192
v_mfma_f32_16x16x32_bf16 v[108:111], v[252:255], v[52:55], v[108:111]
ds_read_b64_tr_b16 v[126:127], v11 offset:9216
buffer_load_dwordx4 v[52:55], v1, s[8:11], s24 offen offset:1024 sc1
s_waitcnt vmcnt(16)
v_mfma_f32_16x16x32_bf16 v[96:99], a[0:3], v[56:59], v[96:99]
v_mfma_f32_16x16x32_bf16 v[100:103], a[4:7], v[56:59], v[100:103]
v_mfma_f32_16x16x32_bf16 v[104:107], a[8:11], v[56:59], v[104:107]
v_mfma_f32_16x16x32_bf16 v[108:111], a[12:15], v[56:59], v[108:111]
buffer_load_dwordx4 v[56:59], v1, s[8:11], s24 offen offset:2048 sc1
s_waitcnt vmcnt(16) lgkmcnt(0)
v_mfma_f32_16x16x32_bf16 v[96:99], v[112:115], v[60:63], v[96:99]
v_add_f32 v80, v80, v84
v_add_f32 v81, v81, v85
v_mfma_f32_16x16x32_bf16 v[100:103], v[116:119], v[60:63], v[100:103]
v_add_f32 v82, v82, v86
v_add_f32 v83, v83, v87
v_mfma_f32_16x16x32_bf16 v[104:107], v[120:123], v[60:63], v[104:107]
v_add_f32 v80, v80, v88
v_add_f32 v81, v81, v89
v_mfma_f32_16x16x32_bf16 v[108:111], v[124:127], v[60:63], v[108:111]
v_add_f32 v82, v82, v90
v_add_f32 v83, v83, v91
buffer_load_dwordx4 v[60:63], v1, s[8:11], s24 offen offset:3072 sc1
s_waitcnt vmcnt(16)
v_mfma_f32_16x16x32_bf16 v[96:99], a[16:19], v[64:67], v[96:99]
ds_read_b64_tr_b16 v[112:113], v8 offset:12288
v_add_f32 v80, v80, v92
v_mfma_f32_16x16x32_bf16 v[100:103], a[20:23], v[64:67], v[100:103]
ds_read_b64_tr_b16 v[114:115], v8 offset:13312
v_add_f32 v81, v81, v93
v_mfma_f32_16x16x32_bf16 v[104:107], a[24:27], v[64:67], v[104:107]
s_add_u32 s24, s48, s37
ds_read_b64_tr_b16 v[116:117], v9 offset:12288
v_add_f32 v82, v82, v94
v_mfma_f32_16x16x32_bf16 v[108:111], a[28:31], v[64:67], v[108:111]
ds_read_b64_tr_b16 v[118:119], v9 offset:13312
v_add_f32 v83, v83, v95
buffer_load_dwordx4 v[64:67], v1, s[8:11], s24 offen offset:0 sc1
s_waitcnt vmcnt(16)
v_mfma_f32_16x16x32_bf16 v[96:99], a[32:35], v[68:71], v[96:99]
ds_read_b64_tr_b16 v[120:121], v10 offset:12288
v_cvt_pk_bf16_f32 v12, v80, v81
v_mfma_f32_16x16x32_bf16 v[100:103], a[36:39], v[68:71], v[100:103]
ds_read_b64_tr_b16 v[122:123], v10 offset:13312
v_cvt_pk_bf16_f32 v13, v82, v83
v_mfma_f32_16x16x32_bf16 v[104:107], a[40:43], v[68:71], v[104:107]
ds_read_b64_tr_b16 v[124:125], v11 offset:12288
v_xor_b32 v3, 16384, v3
v_mfma_f32_16x16x32_bf16 v[108:111], a[44:47], v[68:71], v[108:111]
ds_read_b64_tr_b16 v[126:127], v11 offset:13312
v_xor_b32 v7, 16384, v7
buffer_load_dwordx4 v[68:71], v1, s[8:11], s24 offen offset:1024 sc1
buffer_store_dwordx2 v[12:13], v4, s[12:15], s53 offen
L_opl_t1:
s_waitcnt vmcnt(17)
v_mfma_f32_16x16x32_bf16 v[96:99], a[48:51], v[72:75], v[96:99]
v_mfma_f32_16x16x32_bf16 v[100:103], a[52:55], v[72:75], v[100:103]
v_mfma_f32_16x16x32_bf16 v[104:107], a[56:59], v[72:75], v[104:107]
v_mfma_f32_16x16x32_bf16 v[108:111], a[60:63], v[72:75], v[108:111]
buffer_load_dwordx4 v[72:75], v1, s[8:11], s24 offen offset:2048 sc1
s_waitcnt vmcnt(17) lgkmcnt(0)
v_mfma_f32_16x16x32_bf16 v[96:99], v[112:115], v[76:79], v[96:99]
s_waitcnt vmcnt(13)
v_cmp_ne_u32 vcc, 1, v6
v_mfma_f32_16x16x32_bf16 v[100:103], v[116:119], v[76:79], v[100:103]
v_mfma_f32_16x16x32_bf16 v[104:107], v[120:123], v[76:79], v[104:107]
s_cmp_eq_u64 vcc, 0
s_cselect_b32 s50, s52, 0
v_mfma_f32_16x16x32_bf16 v[108:111], v[124:127], v[76:79], v[108:111]
buffer_load_dwordx4 v[76:79], v1, s[8:11], s24 offen offset:3072 sc1
s_waitcnt vmcnt(17)
v_mfma_f32_16x16x32_bf16 v[96:99], a[64:67], v[16:19], v[96:99]
s_cmp_eq_u32 s50, 1
s_cselect_b32 s49, s49, 536870912
ds_read_b64_tr_b16 v[112:113], v8 offset:16384
v_mfma_f32_16x16x32_bf16 v[100:103], a[68:71], v[16:19], v[100:103]
ds_read_b64_tr_b16 v[114:115], v8 offset:17408
v_mfma_f32_16x16x32_bf16 v[104:107], a[72:75], v[16:19], v[104:107]
s_add_u32 s24, s49, s30
ds_read_b64_tr_b16 v[116:117], v9 offset:16384
v_mfma_f32_16x16x32_bf16 v[108:111], a[76:79], v[16:19], v[108:111]
ds_read_b64_tr_b16 v[118:119], v9 offset:17408
buffer_load_dwordx4 v[16:19], v1, s[8:11], s24 offen offset:0 sc1
s_waitcnt vmcnt(17)
v_mfma_f32_16x16x32_bf16 v[96:99], a[80:83], v[20:23], v[96:99]
ds_read_b64_tr_b16 v[120:121], v10 offset:16384
v_mfma_f32_16x16x32_bf16 v[100:103], a[84:87], v[20:23], v[100:103]
ds_read_b64_tr_b16 v[122:123], v10 offset:17408
v_mfma_f32_16x16x32_bf16 v[104:107], a[88:91], v[20:23], v[104:107]
ds_read_b64_tr_b16 v[124:125], v11 offset:16384
v_mfma_f32_16x16x32_bf16 v[108:111], a[92:95], v[20:23], v[108:111]
ds_read_b64_tr_b16 v[126:127], v11 offset:17408
buffer_load_dwordx4 v[20:23], v1, s[8:11], s24 offen offset:1024 sc1
s_waitcnt vmcnt(17)
v_mfma_f32_16x16x32_bf16 v[96:99], a[96:99], v[24:27], v[96:99]
v_mfma_f32_16x16x32_bf16 v[100:103], a[100:103], v[24:27], v[100:103]
v_mfma_f32_16x16x32_bf16 v[104:107], a[104:107], v[24:27], v[104:107]
v_mfma_f32_16x16x32_bf16 v[108:111], a[108:111], v[24:27], v[108:111]
buffer_load_dwordx4 v[24:27], v1, s[8:11], s24 offen offset:2048 sc1
s_waitcnt vmcnt(16) lgkmcnt(0)
v_mfma_f32_16x16x32_bf16 v[96:99], v[112:115], v[28:31], v[96:99]
v_mfma_f32_16x16x32_bf16 v[100:103], v[116:119], v[28:31], v[100:103]
v_mfma_f32_16x16x32_bf16 v[104:107], v[120:123], v[28:31], v[104:107]
v_mfma_f32_16x16x32_bf16 v[108:111], v[124:127], v[28:31], v[108:111]
buffer_load_dwordx4 v[28:31], v1, s[8:11], s24 offen offset:3072 sc1
s_waitcnt vmcnt(16)
v_mfma_f32_16x16x32_bf16 v[96:99], a[112:115], v[32:35], v[96:99]
ds_read_b64_tr_b16 v[112:113], v8 offset:20480
v_mfma_f32_16x16x32_bf16 v[100:103], a[116:119], v[32:35], v[100:103]
ds_read_b64_tr_b16 v[114:115], v8 offset:21504
v_mfma_f32_16x16x32_bf16 v[104:107], a[120:123], v[32:35], v[104:107]
s_add_u32 s24, s49, s31
ds_read_b64_tr_b16 v[116:117], v9 offset:20480
v_mfma_f32_16x16x32_bf16 v[108:111], a[124:127], v[32:35], v[108:111]
ds_read_b64_tr_b16 v[118:119], v9 offset:21504
buffer_load_dwordx4 v[32:35], v1, s[8:11], s24 offen offset:0 sc1
s_waitcnt vmcnt(16)
v_mfma_f32_16x16x32_bf16 v[96:99], a[128:131], v[36:39], v[96:99]
ds_read_b64_tr_b16 v[120:121], v10 offset:20480
v_mfma_f32_16x16x32_bf16 v[100:103], a[132:135], v[36:39], v[100:103]
ds_read_b64_tr_b16 v[122:123], v10 offset:21504
v_mfma_f32_16x16x32_bf16 v[104:107], a[136:139], v[36:39], v[104:107]
ds_read_b64_tr_b16 v[124:125], v11 offset:20480
v_mfma_f32_16x16x32_bf16 v[108:111], a[140:143], v[36:39], v[108:111]
ds_read_b64_tr_b16 v[126:127], v11 offset:21504
buffer_load_dwordx4 v[36:39], v1, s[8:11], s24 offen offset:1024 sc1
s_waitcnt vmcnt(16)
v_mfma_f32_16x16x32_bf16 v[96:99], a[144:147], v[40:43], v[96:99]
v_mfma_f32_16x16x32_bf16 v[100:103], a[148:151], v[40:43], v[100:103]
v_mfma_f32_16x16x32_bf16 v[104:107], a[152:155], v[40:43], v[104:107]
v_mfma_f32_16x16x32_bf16 v[108:111], a[156:159], v[40:43], v[108:111]
buffer_load_dwordx4 v[40:43], v1, s[8:11], s24 offen offset:2048 sc1
s_waitcnt vmcnt(16) lgkmcnt(0)
v_mfma_f32_16x16x32_bf16 v[96:99], v[112:115], v[44:47], v[96:99]
v_mfma_f32_16x16x32_bf16 v[100:103], v[116:119], v[44:47], v[100:103]
v_mfma_f32_16x16x32_bf16 v[104:107], v[120:123], v[44:47], v[104:107]
v_mfma_f32_16x16x32_bf16 v[108:111], v[124:127], v[44:47], v[108:111]
buffer_load_dwordx4 v[44:47], v1, s[8:11], s24 offen offset:3072 sc1
s_waitcnt vmcnt(16)
v_mfma_f32_16x16x32_bf16 v[96:99], a[160:163], v[48:51], v[96:99]
ds_read_b64_tr_b16 v[112:113], v8 offset:24576
v_mfma_f32_16x16x32_bf16 v[100:103], a[164:167], v[48:51], v[100:103]
ds_read_b64_tr_b16 v[114:115], v8 offset:25600
v_mfma_f32_16x16x32_bf16 v[104:107], a[168:171], v[48:51], v[104:107]
s_add_u32 s24, s49, s32
ds_read_b64_tr_b16 v[116:117], v9 offset:24576
v_mfma_f32_16x16x32_bf16 v[108:111], a[172:175], v[48:51], v[108:111]
ds_read_b64_tr_b16 v[118:119], v9 offset:25600
buffer_load_dwordx4 v[48:51], v1, s[8:11], s24 offen offset:0 sc1
s_waitcnt vmcnt(16)
v_mfma_f32_16x16x32_bf16 v[96:99], a[176:179], v[52:55], v[96:99]
ds_read_b64_tr_b16 v[120:121], v10 offset:24576
v_mfma_f32_16x16x32_bf16 v[100:103], a[180:183], v[52:55], v[100:103]
ds_read_b64_tr_b16 v[122:123], v10 offset:25600
v_mfma_f32_16x16x32_bf16 v[104:107], a[184:187], v[52:55], v[104:107]
ds_read_b64_tr_b16 v[124:125], v11 offset:24576
v_mfma_f32_16x16x32_bf16 v[108:111], a[188:191], v[52:55], v[108:111]
ds_read_b64_tr_b16 v[126:127], v11 offset:25600
buffer_load_dwordx4 v[52:55], v1, s[8:11], s24 offen offset:1024 sc1
s_waitcnt vmcnt(16)
v_mfma_f32_16x16x32_bf16 v[96:99], a[192:195], v[56:59], v[96:99]
v_mfma_f32_16x16x32_bf16 v[100:103], a[196:199], v[56:59], v[100:103]
v_mfma_f32_16x16x32_bf16 v[104:107], a[200:203], v[56:59], v[104:107]
v_mfma_f32_16x16x32_bf16 v[108:111], a[204:207], v[56:59], v[108:111]
buffer_load_dwordx4 v[56:59], v1, s[8:11], s24 offen offset:2048 sc1
s_waitcnt vmcnt(16) lgkmcnt(0)
v_mfma_f32_16x16x32_bf16 v[96:99], v[112:115], v[60:63], v[96:99]
v_mfma_f32_16x16x32_bf16 v[100:103], v[116:119], v[60:63], v[100:103]
v_mfma_f32_16x16x32_bf16 v[104:107], v[120:123], v[60:63], v[104:107]
v_mfma_f32_16x16x32_bf16 v[108:111], v[124:127], v[60:63], v[108:111]
buffer_load_dwordx4 v[60:63], v1, s[8:11], s24 offen offset:3072 sc1
s_waitcnt vmcnt(16)
v_mfma_f32_16x16x32_bf16 v[96:99], a[208:211], v[64:67], v[96:99]
ds_read_b64_tr_b16 v[112:113], v8 offset:28672
v_mfma_f32_16x16x32_bf16 v[100:103], a[212:215], v[64:67], v[100:103]
ds_read_b64_tr_b16 v[114:115], v8 offset:29696
v_mfma_f32_16x16x32_bf16 v[104:107], a[216:219], v[64:67], v[104:107]
s_add_u32 s24, s49, s33
ds_read_b64_tr_b16 v[116:117], v9 offset:28672
v_mfma_f32_16x16x32_bf16 v[108:111], a[220:223], v[64:67], v[108:111]
ds_read_b64_tr_b16 v[118:119], v9 offset:29696
buffer_load_dwordx4 v[64:67], v1, s[8:11], s24 offen offset:0 sc1
s_waitcnt vmcnt(16)
v_mfma_f32_16x16x32_bf16 v[96:99], a[224:227], v[68:71], v[96:99]
ds_read_b64_tr_b16 v[120:121], v10 offset:28672
v_mfma_f32_16x16x32_bf16 v[100:103], a[228:231], v[68:71], v[100:103]
ds_read_b64_tr_b16 v[122:123], v10 offset:29696
v_mfma_f32_16x16x32_bf16 v[104:107], a[232:235], v[68:71], v[104:107]
ds_read_b64_tr_b16 v[124:125], v11 offset:28672
v_mfma_f32_16x16x32_bf16 v[108:111], a[236:239], v[68:71], v[108:111]
ds_read_b64_tr_b16 v[126:127], v11 offset:29696
buffer_load_dwordx4 v[68:71], v1, s[8:11], s24 offen offset:1024 sc1
s_waitcnt vmcnt(15)
v_mfma_f32_16x16x32_bf16 v[96:99], a[240:243], v[72:75], v[96:99]
v_mfma_f32_16x16x32_bf16 v[100:103], a[244:247], v[72:75], v[100:103]
v_mfma_f32_16x16x32_bf16 v[104:107], a[248:251], v[72:75], v[104:107]
v_mfma_f32_16x16x32_bf16 v[108:111], a[252:255], v[72:75], v[108:111]
buffer_load_dwordx4 v[72:75], v1, s[8:11], s24 offen offset:2048 sc1
s_waitcnt vmcnt(15) lgkmcnt(0)
v_mfma_f32_16x16x32_bf16 v[96:99], v[112:115], v[76:79], v[96:99]
v_mfma_f32_16x16x32_bf16 v[100:103], v[116:119], v[76:79], v[100:103]
v_mfma_f32_16x16x32_bf16 v[104:107], v[120:123], v[76:79], v[104:107]
v_mfma_f32_16x16x32_bf16 v[108:111], v[124:127], v[76:79], v[108:111]
buffer_load_dwordx4 v[76:79], v1, s[8:11], s24 offen offset:3072 sc1
s_mul_i32 s53, s41, 36864
s_mov_b32 s41, s27
s_mov_b32 s48, s49
s_cmp_eq_u32 s50, 0
s_cbranch_scc0 L_opl_r0
L_opl_c1:
ds_write_b128 v3, v[96:99] offset:0
ds_write_b128 v3, v[100:103] offset:4096
ds_write_b128 v3, v[104:107] offset:8192
ds_write_b128 v3, v[108:111] offset:12288
s_waitcnt lgkmcnt(0)
s_barrier
ds_read_b128 v[96:99], v7 offset:0
ds_read_b128 v[100:103], v7 offset:1024
ds_read_b128 v[104:107], v7 offset:2048
ds_read_b128 v[108:111], v7 offset:3072
s_waitcnt lgkmcnt(2)
v_pk_add_f32 v[96:97], v[96:97], v[100:101]
v_pk_add_f32 v[98:99], v[98:99], v[102:103]
s_waitcnt lgkmcnt(1)
v_pk_add_f32 v[96:97], v[96:97], v[104:105]
v_pk_add_f32 v[98:99], v[98:99], v[106:107]
s_waitcnt lgkmcnt(0)
v_pk_add_f32 v[96:97], v[96:97], v[108:109]
v_pk_add_f32 v[98:99], v[98:99], v[110:111]
v_cvt_pk_bf16_f32 v12, v96, v97
v_cvt_pk_bf16_f32 v13, v98, v99
buffer_store_dwordx2 v[12:13], v4, s[12:15], s53 offen
v_xor_b32 v3, 16384, v3
v_xor_b32 v7, 16384, v7
s_cmp_lg_u32 s52, 0
s_cbranch_scc1 L_opl_w
s_branch L_opl_x
L_opl_c0:
ds_write_b128 v3, v[80:83] offset:0
ds_write_b128 v3, v[84:87] offset:4096
ds_write_b128 v3, v[88:91] offset:8192
ds_write_b128 v3, v[92:95] offset:12288
s_waitcnt lgkmcnt(0)
s_barrier
ds_read_b128 v[80:83], v7 offset:0
ds_read_b128 v[84:87], v7 offset:1024
ds_read_b128 v[88:91], v7 offset:2048
ds_read_b128 v[92:95], v7 offset:3072
s_waitcnt lgkmcnt(2)
v_pk_add_f32 v[80:81], v[80:81], v[84:85]
v_pk_add_f32 v[82:83], v[82:83], v[86:87]
s_waitcnt lgkmcnt(1)
v_pk_add_f32 v[80:81], v[80:81], v[88:89]
v_pk_add_f32 v[82:83], v[82:83], v[90:91]
s_waitcnt lgkmcnt(0)
v_pk_add_f32 v[80:81], v[80:81], v[92:93]
v_pk_add_f32 v[82:83], v[82:83], v[94:95]
v_cvt_pk_bf16_f32 v12, v80, v81
v_cvt_pk_bf16_f32 v13, v82, v83
buffer_store_dwordx2 v[12:13], v4, s[12:15], s53 offen
v_xor_b32 v3, 16384, v3
v_xor_b32 v7, 16384, v7
s_cmp_lg_u32 s52, 0
s_cbranch_scc1 L_opl_w
L_opl_x:
s_branch L_done
L_team:
v_mov_b32 v12, v0
v_and_b32 v13, 15, v0
v_bfe_u32 v14, v0, 4, 2
v_lshlrev_b32 v1, 4, v12
v_and_b32 v2, 0x3f0, v1
s_mul_i32 s20, s17, 34816
s_add_u32 s20, s20, 24576
v_add_u32 v2, s20, v2
v_and_b32 v15, 1, v12
v_mul_u32_u24 v0, 0xaaaa, v15
v_add_u32 v0, 0xffff4444, v0
v_lshrrev_b32 v18, 2, v13
v_lshl_add_u32 v18, v18, 1, v15
v_bfe_u32 v19, v13, 1, 1
v_lshrrev_b32 v16, 5, v12
v_lshlrev_b32 v16, 8, v16
v_lshl_add_u32 v16, v18, 5, v16
v_and_b32 v17, 1, v14
v_lshl_add_u32 v16, v17, 4, v16
v_and_b32 v17, 0x7f, v16
v_xor_b32 v17, 16, v17
v_add_u32 v16, 4224, v16
v_add_u32 v17, 6272, v17
v_cmp_eq_u32 vcc, 1, v19
s_nop 1
v_cndmask_b32 v7, v17, v16, vcc
v_and_b32 v16, 1, v14
v_xor_b32 v16, v18, v16
v_and_b32 v17, 2, v14
v_lshlrev_b32 v17, 1, v17
v_xor_b32 v16, v16, v17
v_lshlrev_b32 v16, 4, v16
v_lshl_add_u32 v16, v14, 7, v16
v_mul_u32_u24 v17, 2176, v19
v_add_u32 v16, v16, v17
v_add_u32 v5, 0, v16
v_bfe_u32 v20, v13, 3, 1
v_bfe_u32 v21, v13, 1, 1
v_lshlrev_b32 v16, 1, v14
v_xor_b32 v16, v16, v21
v_lshlrev_b32 v17, 2, v20
v_xor_b32 v16, v16, v17
v_lshlrev_b32 v16, 4, v16
v_lshl_add_u32 v16, v20, 8, v16
v_lshl_add_u32 v16, v21, 7, v16
v_bfe_u32 v17, v13, 2, 1
v_lshl_add_u32 v16, v17, 3, v16
v_lshl_add_u32 v16, v15, 2, v16
s_lshl_b32 s20, s17, 9
s_add_u32 s20, s20, 0
v_add_u32 v4, s20, v16
v_xor_b32 v3, 16, v4
v_lshrrev_b32 v16, 4, v12
v_xor_b32 v17, s16, v16
v_lshlrev_b32 v16, 12, v16
v_lshl_add_u32 v16, v17, 7, v16
v_lshl_add_u32 v9, v13, 3, v16
s_lshr_b32 s20, s17, 1
s_lshl_b32 s20, s20, 2
v_add_u32 v16, s20, v14
v_xor_b32 v17, s16, v16
v_lshlrev_b32 v16, 12, v16
v_lshl_add_u32 v16, v17, 7, v16
v_lshl_add_u32 v16, v13, 2, v16
s_and_b32 s20, s17, 1
s_lshl_b32 s20, s20, 6
s_add_u32 s20, s20, 262144
v_add_u32 v10, s20, v16
v_bfe_u32 v16, v13, 2, 1
v_lshlrev_b32 v16, 5, v16
v_and_b32 v17, 1, v14
v_lshl_add_u32 v16, v17, 8, v16
v_lshrrev_b32 v17, 1, v14
v_lshl_add_u32 v16, v17, 4, v16
v_and_b32 v17, 3, v13
v_lshl_add_u32 v11, v17, 2, v16
v_lshlrev_b32 v6, 7, v12
v_lshlrev_b32 v8, 2, v12
s_mov_b32 s36, 0x11111111
s_mov_b32 s37, 0x11111111
s_mov_b32 s38, 0x22222222
s_mov_b32 s39, 0x22222222
s_mov_b32 s40, 0x44444444
s_mov_b32 s41, 0x44444444
s_mov_b32 s42, 0x88888888
s_mov_b32 s43, 0x88888888
s_mov_b32 s44, 0xf0f0f0f0
s_mov_b32 s45, 0xf0f0f0f0
s_mov_b32 s18, 0x3e0293ee
s_lshl_b32 s20, s17, 5
s_add_u32 s20, s20, s16
s_cmp_lt_u32 s20, 72
s_cselect_b32 s48, 1, 0
s_lshl_b32 s23, s20, 12
s_lshl_b32 s21, s17, 10
s_sub_u32 s23, s23, s21
s_lshr_b32 s24, s20, 2
s_lshl_b32 s24, s24, 9
s_and_b32 s21, s20, 3
s_lshl_b32 s21, s21, 6
s_add_u32 s24, s24, s21
s_add_u32 s24, s24, 110100480
s_cmp_lt_u32 s20, 72
s_cselect_b32 s24, s24, 536870912
s_lshl_b32 s25, s16, 12
s_add_u32 s26, s25, 131072
s_add_u32 s27, s25, 262144
s_cmp_lt_u32 s16, 8
s_cselect_b32 s27, s27, 536870912
s_mov_b32 s28, 109051904
s_mov_b32 s29, 109346816
s_lshl_b32 s30, s16, 20
s_add_u32 s30, s30, 33554432
s_lshl_b32 s31, s16, 12
s_add_u32 s31, s31, 100663296
s_add_u32 s35, s24, 32768
s_mov_b32 s53, 0x3f803f80
s_mov_b32 s86, 0x33333333
s_mov_b32 s87, 0x33333333
s_lshl_b32 s84, s17, 13
s_sub_u32 s84, s20, s84
s_add_u32 s84, s84, 110886912
s_cmp_lt_u32 s20, 72
s_cselect_b32 s84, s84, 536870912
s_and_b32 s21, s16, 3
s_lshl_b32 s21, s21, 7
s_add_u32 s21, s21, 110886144
s_cmp_eq_u32 s17, 3
s_cselect_b32 s84, s21, s84
s_lshl_b32 s82, s16, 7
s_add_u32 s83, s82, 111152384
s_add_u32 s82, s82, 111148288
s_mov_b32 s19, 0
v_mov_b32 v64, -1
v_mov_b32 v65, -1
v_mov_b32 v66, -1
v_mov_b32 v67, -1
s_add_u32 s20, s28, s25
buffer_store_dwordx4 v[64:67], v1, s[8:11], s20 offen
s_add_u32 s20, s28, s26
buffer_store_dwordx4 v[64:67], v1, s[8:11], s20 offen
s_add_u32 s20, s28, s27
buffer_store_dwordx4 v[64:67], v1, s[8:11], s20 offen
s_add_u32 s20, s29, s25
buffer_store_dwordx4 v[64:67], v1, s[8:11], s20 offen
s_add_u32 s20, s29, s26
buffer_store_dwordx4 v[64:67], v1, s[8:11], s20 offen
s_add_u32 s20, s29, s27
buffer_store_dwordx4 v[64:67], v1, s[8:11], s20 offen
s_add_u32 s20, s24, 16384
buffer_store_dword v64, v11, s[8:11], s20 offen
s_cmp_eq_u32 s17, 3
s_cselect_b32 s20, 536870912, s84
s_mov_b64 exec, 15
buffer_store_byte v64, v6, s[8:11], s20 offen
s_mov_b64 exec, -1
v_lshrrev_b32 v0, 4, v1
s_waitcnt vmcnt(0)
s_barrier
s_cmp_eq_u32 s17, 0
s_cbranch_scc0 L_tw
s_mov_b64 exec, 1
v_mov_b32 v1, 1
v_mov_b32 v2, 64
buffer_atomic_add v1, v2, s[56:59], 0 offen
s_mov_b64 exec, -1
L_tw:
s_mov_b32 s46, 0x05040100
s_mov_b32 s47, 0x07060302
v_and_b32 v3, 63, v0
v_lshlrev_b32 v3, 4, v3
s_mul_i32 s20, s17, 34816
s_add_u32 s20, s20, 24576
v_add_u32 v3, s20, v3
v_bfe_u32 v64, v0, 5, 1
v_bfe_u32 v65, v0, 4, 1
v_and_b32 v66, 15, v0
v_lshlrev_b32 v1, 17, v64
v_lshl_add_u32 v1, v65, 14, v1
v_lshl_add_u32 v1, v66, 2, v1
s_lshl_b32 s20, s16, 8
s_lshl_b32 s21, s17, 6
s_add_u32 s20, s20, s21
v_add_u32 v1, s20, v1
v_lshlrev_b32 v2, 4, v64
v_lshl_add_u32 v2, v65, 2, v2
v_mul_u32_u24 v2, 1152, v2
s_mul_i32 s20, s16, 147456
v_add_u32 v2, s20, v2
v_and_b32 v4, 15, v0
s_lshl_b32 s20, s17, 4
v_add_u32 v4, s20, v4
v_lshlrev_b32 v4, 1, v4
v_add_u32 v2, v2, v4
v_add_u32 v4, v2, v4
s_load_dwordx8 s[88:95], s[0:1], 64
s_waitcnt lgkmcnt(0)
s_barrier
s_mov_b32 s12, s90
s_and_b32 s13, s91, 0xffff
s_mov_b32 s14, 4718592
s_mov_b32 s15, 0x20000
s_mov_b32 s20, 0
buffer_load_dword v6, v1, s[12:15], s20 offen
s_mov_b32 s21, 32768
buffer_load_dword v7, v1, s[12:15], s21 offen
s_mov_b32 s20, 65536
buffer_load_dword v8, v1, s[12:15], s20 offen
s_mov_b32 s21, 98304
buffer_load_dword v9, v1, s[12:15], s21 offen
s_mov_b32 s20, 8192
buffer_load_dword v10, v1, s[12:15], s20 offen
s_mov_b32 s21, 40960
buffer_load_dword v11, v1, s[12:15], s21 offen
s_mov_b32 s20, 73728
buffer_load_dword v12, v1, s[12:15], s20 offen
s_mov_b32 s21, 106496
buffer_load_dword v13, v1, s[12:15], s21 offen
s_barrier
s_mov_b32 s20, 262144
buffer_load_dword v14, v1, s[12:15], s20 offen
s_mov_b32 s21, 294912
buffer_load_dword v15, v1, s[12:15], s21 offen
s_mov_b32 s20, 327680
buffer_load_dword v16, v1, s[12:15], s20 offen
s_mov_b32 s21, 360448
buffer_load_dword v17, v1, s[12:15], s21 offen
s_mov_b32 s20, 270336
buffer_load_dword v18, v1, s[12:15], s20 offen
s_mov_b32 s21, 303104
buffer_load_dword v19, v1, s[12:15], s21 offen
s_mov_b32 s20, 335872
buffer_load_dword v20, v1, s[12:15], s20 offen
s_mov_b32 s21, 368640
buffer_load_dword v21, v1, s[12:15], s21 offen
s_barrier
s_mov_b32 s12, s92
s_and_b32 s13, s93, 0xffff
s_mov_b32 s14, 4718592
s_mov_b32 s15, 0x20000
s_mov_b32 s20, 0
buffer_load_dword v22, v1, s[12:15], s20 offen
s_mov_b32 s21, 32768
buffer_load_dword v23, v1, s[12:15], s21 offen
s_mov_b32 s20, 65536
buffer_load_dword v24, v1, s[12:15], s20 offen
s_mov_b32 s21, 98304
buffer_load_dword v25, v1, s[12:15], s21 offen
s_mov_b32 s20, 8192
buffer_load_dword v26, v1, s[12:15], s20 offen
s_mov_b32 s21, 40960
buffer_load_dword v27, v1, s[12:15], s21 offen
s_mov_b32 s20, 73728
buffer_load_dword v28, v1, s[12:15], s20 offen
s_mov_b32 s21, 106496
buffer_load_dword v29, v1, s[12:15], s21 offen
s_barrier
s_mov_b32 s20, 262144
buffer_load_dword v30, v1, s[12:15], s20 offen
s_mov_b32 s21, 294912
buffer_load_dword v31, v1, s[12:15], s21 offen
s_mov_b32 s20, 327680
buffer_load_dword v32, v1, s[12:15], s20 offen
s_mov_b32 s21, 360448
buffer_load_dword v33, v1, s[12:15], s21 offen
s_mov_b32 s20, 270336
buffer_load_dword v34, v1, s[12:15], s20 offen
s_mov_b32 s21, 303104
buffer_load_dword v35, v1, s[12:15], s21 offen
s_mov_b32 s20, 335872
buffer_load_dword v36, v1, s[12:15], s20 offen
s_mov_b32 s21, 368640
buffer_load_dword v37, v1, s[12:15], s21 offen
s_barrier
s_mov_b32 s12, s90
s_and_b32 s13, s91, 0xffff
s_mov_b32 s14, 4718592
s_mov_b32 s15, 0x20000
s_mov_b32 s20, 524288
buffer_load_dword v38, v1, s[12:15], s20 offen
s_mov_b32 s21, 557056
buffer_load_dword v39, v1, s[12:15], s21 offen
s_mov_b32 s20, 589824
buffer_load_dword v40, v1, s[12:15], s20 offen
s_mov_b32 s21, 622592
buffer_load_dword v41, v1, s[12:15], s21 offen
s_mov_b32 s20, 532480
buffer_load_dword v42, v1, s[12:15], s20 offen
s_mov_b32 s21, 565248
buffer_load_dword v43, v1, s[12:15], s21 offen
s_mov_b32 s20, 598016
buffer_load_dword v44, v1, s[12:15], s20 offen
s_mov_b32 s21, 630784
buffer_load_dword v45, v1, s[12:15], s21 offen
s_barrier
s_mov_b32 s20, 786432
buffer_load_dword v46, v1, s[12:15], s20 offen
s_mov_b32 s21, 819200
buffer_load_dword v47, v1, s[12:15], s21 offen
s_mov_b32 s20, 851968
buffer_load_dword v48, v1, s[12:15], s20 offen
s_mov_b32 s21, 884736
buffer_load_dword v49, v1, s[12:15], s21 offen
s_mov_b32 s20, 794624
buffer_load_dword v50, v1, s[12:15], s20 offen
s_mov_b32 s21, 827392
buffer_load_dword v51, v1, s[12:15], s21 offen
s_mov_b32 s20, 860160
buffer_load_dword v52, v1, s[12:15], s20 offen
s_mov_b32 s21, 892928
buffer_load_dword v53, v1, s[12:15], s21 offen
s_barrier
s_mov_b32 s12, s92
s_and_b32 s13, s93, 0xffff
s_mov_b32 s14, 4718592
s_mov_b32 s15, 0x20000
s_mov_b32 s20, 524288
buffer_load_dword v54, v1, s[12:15], s20 offen
s_mov_b32 s21, 557056
buffer_load_dword v55, v1, s[12:15], s21 offen
s_mov_b32 s20, 589824
buffer_load_dword v56, v1, s[12:15], s20 offen
s_mov_b32 s21, 622592
buffer_load_dword v57, v1, s[12:15], s21 offen
s_mov_b32 s20, 532480
buffer_load_dword v58, v1, s[12:15], s20 offen
s_mov_b32 s21, 565248
buffer_load_dword v59, v1, s[12:15], s21 offen
s_mov_b32 s20, 598016
buffer_load_dword v60, v1, s[12:15], s20 offen
s_mov_b32 s21, 630784
buffer_load_dword v61, v1, s[12:15], s21 offen
s_waitcnt vmcnt(54)
v_perm_b32 v88, v7, v6, s46
v_perm_b32 v68, v7, v6, s47
s_barrier
s_mov_b32 s20, 786432
buffer_load_dword v6, v1, s[12:15], s20 offen
s_mov_b32 s21, 819200
buffer_load_dword v7, v1, s[12:15], s21 offen
s_waitcnt vmcnt(54)
v_perm_b32 v89, v9, v8, s46
v_perm_b32 v69, v9, v8, s47
s_mov_b32 s20, 851968
buffer_load_dword v8, v1, s[12:15], s20 offen
s_mov_b32 s21, 884736
buffer_load_dword v9, v1, s[12:15], s21 offen
s_waitcnt vmcnt(54)
v_perm_b32 v90, v11, v10, s46
v_perm_b32 v70, v11, v10, s47
s_mov_b32 s20, 794624
buffer_load_dword v10, v1, s[12:15], s20 offen
s_mov_b32 s21, 827392
buffer_load_dword v11, v1, s[12:15], s21 offen
s_waitcnt vmcnt(54)
v_perm_b32 v91, v13, v12, s46
v_perm_b32 v71, v13, v12, s47
ds_write_b128 v3, v[68:71] offset:0
s_waitcnt lgkmcnt(0)
s_mov_b32 s20, 860160
buffer_load_dword v12, v1, s[12:15], s20 offen
s_mov_b32 s21, 892928
buffer_load_dword v13, v1, s[12:15], s21 offen
s_waitcnt vmcnt(54)
v_perm_b32 v92, v15, v14, s46
v_perm_b32 v68, v15, v14, s47
s_barrier
s_mov_b32 s12, s90
s_and_b32 s13, s91, 0xffff
s_mov_b32 s14, 4718592
s_mov_b32 s15, 0x20000
s_mov_b32 s20, 1048576
buffer_load_dword v14, v1, s[12:15], s20 offen
s_mov_b32 s21, 1081344
buffer_load_dword v15, v1, s[12:15], s21 offen
s_waitcnt vmcnt(54)
v_perm_b32 v93, v17, v16, s46
v_perm_b32 v69, v17, v16, s47
s_mov_b32 s20, 1114112
buffer_load_dword v16, v1, s[12:15], s20 offen
s_mov_b32 s21, 1146880
buffer_load_dword v17, v1, s[12:15], s21 offen
s_waitcnt vmcnt(54)
v_perm_b32 v94, v19, v18, s46
v_perm_b32 v70, v19, v18, s47
s_mov_b32 s20, 1056768
buffer_load_dword v18, v1, s[12:15], s20 offen
s_mov_b32 s21, 1089536
buffer_load_dword v19, v1, s[12:15], s21 offen
s_waitcnt vmcnt(54)
v_perm_b32 v95, v21, v20, s46
v_perm_b32 v71, v21, v20, s47
ds_write_b128 v3, v[68:71] offset:1024
s_waitcnt lgkmcnt(0)
s_mov_b32 s20, 1122304
buffer_load_dword v20, v1, s[12:15], s20 offen
s_mov_b32 s21, 1155072
buffer_load_dword v21, v1, s[12:15], s21 offen
s_waitcnt vmcnt(54)
v_perm_b32 v64, v23, v22, s46
v_accvgpr_write_b32 a32, v64
v_perm_b32 v68, v23, v22, s47
v_accvgpr_write_b32 a40, v68
s_barrier
s_mov_b32 s20, 1310720
buffer_load_dword v22, v1, s[12:15], s20 offen
s_mov_b32 s21, 1343488
buffer_load_dword v23, v1, s[12:15], s21 offen
s_waitcnt vmcnt(54)
v_perm_b32 v65, v25, v24, s46
v_accvgpr_write_b32 a33, v65
v_perm_b32 v69, v25, v24, s47
v_accvgpr_write_b32 a41, v69
s_mov_b32 s20, 1376256
buffer_load_dword v24, v1, s[12:15], s20 offen
s_mov_b32 s21, 1409024
buffer_load_dword v25, v1, s[12:15], s21 offen
s_waitcnt vmcnt(54)
v_perm_b32 v66, v27, v26, s46
v_accvgpr_write_b32 a34, v66
v_perm_b32 v70, v27, v26, s47
v_accvgpr_write_b32 a42, v70
s_mov_b32 s20, 1318912
buffer_load_dword v26, v1, s[12:15], s20 offen
s_mov_b32 s21, 1351680
buffer_load_dword v27, v1, s[12:15], s21 offen
s_waitcnt vmcnt(54)
v_perm_b32 v67, v29, v28, s46
v_accvgpr_write_b32 a35, v67
v_perm_b32 v71, v29, v28, s47
v_accvgpr_write_b32 a43, v71
s_mov_b32 s20, 1384448
buffer_load_dword v28, v1, s[12:15], s20 offen
s_mov_b32 s21, 1417216
buffer_load_dword v29, v1, s[12:15], s21 offen
s_waitcnt vmcnt(54)
v_perm_b32 v64, v31, v30, s46
v_accvgpr_write_b32 a36, v64
v_perm_b32 v68, v31, v30, s47
v_accvgpr_write_b32 a44, v68
s_barrier
s_mov_b32 s12, s92
s_and_b32 s13, s93, 0xffff
s_mov_b32 s14, 4718592
s_mov_b32 s15, 0x20000
s_mov_b32 s20, 1048576
buffer_load_dword v30, v1, s[12:15], s20 offen
s_mov_b32 s21, 1081344
buffer_load_dword v31, v1, s[12:15], s21 offen
s_waitcnt vmcnt(54)
v_perm_b32 v65, v33, v32, s46
v_accvgpr_write_b32 a37, v65
v_perm_b32 v69, v33, v32, s47
v_accvgpr_write_b32 a45, v69
s_mov_b32 s20, 1114112
buffer_load_dword v32, v1, s[12:15], s20 offen
s_mov_b32 s21, 1146880
buffer_load_dword v33, v1, s[12:15], s21 offen
s_waitcnt vmcnt(54)
v_perm_b32 v66, v35, v34, s46
v_accvgpr_write_b32 a38, v66
v_perm_b32 v70, v35, v34, s47
v_accvgpr_write_b32 a46, v70
s_mov_b32 s20, 1056768
buffer_load_dword v34, v1, s[12:15], s20 offen
s_mov_b32 s21, 1089536
buffer_load_dword v35, v1, s[12:15], s21 offen
s_waitcnt vmcnt(54)
v_perm_b32 v67, v37, v36, s46
v_accvgpr_write_b32 a39, v67
v_perm_b32 v71, v37, v36, s47
v_accvgpr_write_b32 a47, v71
s_mov_b32 s20, 1122304
buffer_load_dword v36, v1, s[12:15], s20 offen
s_mov_b32 s21, 1155072
buffer_load_dword v37, v1, s[12:15], s21 offen
s_waitcnt vmcnt(54)
v_perm_b32 v112, v39, v38, s46
v_perm_b32 v68, v39, v38, s47
s_barrier
s_mov_b32 s20, 1310720
buffer_load_dword v38, v1, s[12:15], s20 offen
s_mov_b32 s21, 1343488
buffer_load_dword v39, v1, s[12:15], s21 offen
s_waitcnt vmcnt(54)
v_perm_b32 v113, v41, v40, s46
v_perm_b32 v69, v41, v40, s47
s_mov_b32 s20, 1376256
buffer_load_dword v40, v1, s[12:15], s20 offen
s_mov_b32 s21, 1409024
buffer_load_dword v41, v1, s[12:15], s21 offen
s_waitcnt vmcnt(54)
v_perm_b32 v114, v43, v42, s46
v_perm_b32 v70, v43, v42, s47
s_mov_b32 s20, 1318912
buffer_load_dword v42, v1, s[12:15], s20 offen
s_mov_b32 s21, 1351680
buffer_load_dword v43, v1, s[12:15], s21 offen
s_waitcnt vmcnt(54)
v_perm_b32 v115, v45, v44, s46
v_perm_b32 v71, v45, v44, s47
ds_write_b128 v3, v[68:71] offset:2048
s_waitcnt lgkmcnt(0)
s_mov_b32 s20, 1384448
buffer_load_dword v44, v1, s[12:15], s20 offen
s_mov_b32 s21, 1417216
buffer_load_dword v45, v1, s[12:15], s21 offen
s_waitcnt vmcnt(54)
v_perm_b32 v116, v47, v46, s46
v_perm_b32 v68, v47, v46, s47
s_barrier
s_mov_b32 s12, s90
s_and_b32 s13, s91, 0xffff
s_mov_b32 s14, 4718592
s_mov_b32 s15, 0x20000
s_mov_b32 s20, 1572864
buffer_load_dword v46, v1, s[12:15], s20 offen
s_mov_b32 s21, 1605632
buffer_load_dword v47, v1, s[12:15], s21 offen
s_waitcnt vmcnt(54)
v_perm_b32 v117, v49, v48, s46
v_perm_b32 v69, v49, v48, s47
s_mov_b32 s20, 1638400
buffer_load_dword v48, v1, s[12:15], s20 offen
s_mov_b32 s21, 1671168
buffer_load_dword v49, v1, s[12:15], s21 offen
s_waitcnt vmcnt(54)
v_perm_b32 v118, v51, v50, s46
v_perm_b32 v70, v51, v50, s47
s_mov_b32 s20, 1581056
buffer_load_dword v50, v1, s[12:15], s20 offen
s_mov_b32 s21, 1613824
buffer_load_dword v51, v1, s[12:15], s21 offen
s_waitcnt vmcnt(54)
v_perm_b32 v119, v53, v52, s46
v_perm_b32 v71, v53, v52, s47
ds_write_b128 v3, v[68:71] offset:3072
s_waitcnt lgkmcnt(0)
s_mov_b32 s20, 1646592
buffer_load_dword v52, v1, s[12:15], s20 offen
s_mov_b32 s21, 1679360
buffer_load_dword v53, v1, s[12:15], s21 offen
s_waitcnt vmcnt(54)
v_perm_b32 v64, v55, v54, s46
v_accvgpr_write_b32 a48, v64
v_perm_b32 v68, v55, v54, s47
v_accvgpr_write_b32 a56, v68
s_barrier
s_mov_b32 s20, 1835008
buffer_load_dword v54, v1, s[12:15], s20 offen
s_mov_b32 s21, 1867776
buffer_load_dword v55, v1, s[12:15], s21 offen
s_waitcnt vmcnt(54)
v_perm_b32 v65, v57, v56, s46
v_accvgpr_write_b32 a49, v65
v_perm_b32 v69, v57, v56, s47
v_accvgpr_write_b32 a57, v69
s_mov_b32 s20, 1900544
buffer_load_dword v56, v1, s[12:15], s20 offen
s_mov_b32 s21, 1933312
buffer_load_dword v57, v1, s[12:15], s21 offen
s_waitcnt vmcnt(54)
v_perm_b32 v66, v59, v58, s46
v_accvgpr_write_b32 a50, v66
v_perm_b32 v70, v59, v58, s47
v_accvgpr_write_b32 a58, v70
s_mov_b32 s20, 1843200
buffer_load_dword v58, v1, s[12:15], s20 offen
s_mov_b32 s21, 1875968
buffer_load_dword v59, v1, s[12:15], s21 offen
s_waitcnt vmcnt(54)
v_perm_b32 v67, v61, v60, s46
v_accvgpr_write_b32 a51, v67
v_perm_b32 v71, v61, v60, s47
v_accvgpr_write_b32 a59, v71
s_mov_b32 s20, 1908736
buffer_load_dword v60, v1, s[12:15], s20 offen
s_mov_b32 s21, 1941504
buffer_load_dword v61, v1, s[12:15], s21 offen
s_waitcnt vmcnt(54)
v_perm_b32 v64, v7, v6, s46
v_accvgpr_write_b32 a52, v64
v_perm_b32 v68, v7, v6, s47
v_accvgpr_write_b32 a60, v68
s_barrier
s_mov_b32 s12, s92
s_and_b32 s13, s93, 0xffff
s_mov_b32 s14, 4718592
s_mov_b32 s15, 0x20000
s_mov_b32 s20, 1572864
buffer_load_dword v6, v1, s[12:15], s20 offen
s_mov_b32 s21, 1605632
buffer_load_dword v7, v1, s[12:15], s21 offen
s_waitcnt vmcnt(54)
v_perm_b32 v65, v9, v8, s46
v_accvgpr_write_b32 a53, v65
v_perm_b32 v69, v9, v8, s47
v_accvgpr_write_b32 a61, v69
s_mov_b32 s20, 1638400
buffer_load_dword v8, v1, s[12:15], s20 offen
s_mov_b32 s21, 1671168
buffer_load_dword v9, v1, s[12:15], s21 offen
s_waitcnt vmcnt(54)
v_perm_b32 v66, v11, v10, s46
v_accvgpr_write_b32 a54, v66
v_perm_b32 v70, v11, v10, s47
v_accvgpr_write_b32 a62, v70
s_mov_b32 s20, 1581056
buffer_load_dword v10, v1, s[12:15], s20 offen
s_mov_b32 s21, 1613824
buffer_load_dword v11, v1, s[12:15], s21 offen
s_waitcnt vmcnt(54)
v_perm_b32 v67, v13, v12, s46
v_accvgpr_write_b32 a55, v67
v_perm_b32 v71, v13, v12, s47
v_accvgpr_write_b32 a63, v71
s_mov_b32 s20, 1646592
buffer_load_dword v12, v1, s[12:15], s20 offen
s_mov_b32 s21, 1679360
buffer_load_dword v13, v1, s[12:15], s21 offen
s_waitcnt vmcnt(54)
v_perm_b32 v136, v15, v14, s46
v_perm_b32 v68, v15, v14, s47
s_barrier
s_mov_b32 s20, 1835008
buffer_load_dword v14, v1, s[12:15], s20 offen
s_mov_b32 s21, 1867776
buffer_load_dword v15, v1, s[12:15], s21 offen
s_waitcnt vmcnt(54)
v_perm_b32 v137, v17, v16, s46
v_perm_b32 v69, v17, v16, s47
s_mov_b32 s20, 1900544
buffer_load_dword v16, v1, s[12:15], s20 offen
s_mov_b32 s21, 1933312
buffer_load_dword v17, v1, s[12:15], s21 offen
s_waitcnt vmcnt(54)
v_perm_b32 v138, v19, v18, s46
v_perm_b32 v70, v19, v18, s47
s_mov_b32 s20, 1843200
buffer_load_dword v18, v1, s[12:15], s20 offen
s_mov_b32 s21, 1875968
buffer_load_dword v19, v1, s[12:15], s21 offen
s_waitcnt vmcnt(54)
v_perm_b32 v139, v21, v20, s46
v_perm_b32 v71, v21, v20, s47
ds_write_b128 v3, v[68:71] offset:4096
s_waitcnt lgkmcnt(0)
s_mov_b32 s20, 1908736
buffer_load_dword v20, v1, s[12:15], s20 offen
s_mov_b32 s21, 1941504
buffer_load_dword v21, v1, s[12:15], s21 offen
s_waitcnt vmcnt(54)
v_perm_b32 v140, v23, v22, s46
v_perm_b32 v68, v23, v22, s47
s_barrier
s_mov_b32 s12, s90
s_and_b32 s13, s91, 0xffff
s_mov_b32 s14, 4718592
s_mov_b32 s15, 0x20000
s_mov_b32 s20, 2097152
buffer_load_dword v22, v1, s[12:15], s20 offen
s_mov_b32 s21, 2129920
buffer_load_dword v23, v1, s[12:15], s21 offen
s_waitcnt vmcnt(54)
v_perm_b32 v141, v25, v24, s46
v_perm_b32 v69, v25, v24, s47
s_mov_b32 s20, 2162688
buffer_load_dword v24, v1, s[12:15], s20 offen
s_mov_b32 s21, 2195456
buffer_load_dword v25, v1, s[12:15], s21 offen
s_waitcnt vmcnt(54)
v_perm_b32 v142, v27, v26, s46
v_perm_b32 v70, v27, v26, s47
s_mov_b32 s20, 2105344
buffer_load_dword v26, v1, s[12:15], s20 offen
s_mov_b32 s21, 2138112
buffer_load_dword v27, v1, s[12:15], s21 offen
s_waitcnt vmcnt(54)
v_perm_b32 v143, v29, v28, s46
v_perm_b32 v71, v29, v28, s47
ds_write_b128 v3, v[68:71] offset:5120
s_waitcnt lgkmcnt(0)
s_mov_b32 s20, 2170880
buffer_load_dword v28, v1, s[12:15], s20 offen
s_mov_b32 s21, 2203648
buffer_load_dword v29, v1, s[12:15], s21 offen
s_waitcnt vmcnt(54)
v_perm_b32 v64, v31, v30, s46
v_accvgpr_write_b32 a64, v64
v_perm_b32 v68, v31, v30, s47
v_accvgpr_write_b32 a72, v68
s_barrier
s_mov_b32 s20, 2359296
buffer_load_dword v30, v1, s[12:15], s20 offen
s_mov_b32 s21, 2392064
buffer_load_dword v31, v1, s[12:15], s21 offen
s_waitcnt vmcnt(54)
v_perm_b32 v65, v33, v32, s46
v_accvgpr_write_b32 a65, v65
v_perm_b32 v69, v33, v32, s47
v_accvgpr_write_b32 a73, v69
s_mov_b32 s20, 2424832
buffer_load_dword v32, v1, s[12:15], s20 offen
s_mov_b32 s21, 2457600
buffer_load_dword v33, v1, s[12:15], s21 offen
s_waitcnt vmcnt(54)
v_perm_b32 v66, v35, v34, s46
v_accvgpr_write_b32 a66, v66
v_perm_b32 v70, v35, v34, s47
v_accvgpr_write_b32 a74, v70
s_mov_b32 s20, 2367488
buffer_load_dword v34, v1, s[12:15], s20 offen
s_mov_b32 s21, 2400256
buffer_load_dword v35, v1, s[12:15], s21 offen
s_waitcnt vmcnt(54)
v_perm_b32 v67, v37, v36, s46
v_accvgpr_write_b32 a67, v67
v_perm_b32 v71, v37, v36, s47
v_accvgpr_write_b32 a75, v71
s_mov_b32 s20, 2433024
buffer_load_dword v36, v1, s[12:15], s20 offen
s_mov_b32 s21, 2465792
buffer_load_dword v37, v1, s[12:15], s21 offen
s_waitcnt vmcnt(54)
v_perm_b32 v64, v39, v38, s46
v_accvgpr_write_b32 a68, v64
v_perm_b32 v68, v39, v38, s47
v_accvgpr_write_b32 a76, v68
s_barrier
s_mov_b32 s12, s92
s_and_b32 s13, s93, 0xffff
s_mov_b32 s14, 4718592
s_mov_b32 s15, 0x20000
s_mov_b32 s20, 2097152
buffer_load_dword v38, v1, s[12:15], s20 offen
s_mov_b32 s21, 2129920
buffer_load_dword v39, v1, s[12:15], s21 offen
s_waitcnt vmcnt(54)
v_perm_b32 v65, v41, v40, s46
v_accvgpr_write_b32 a69, v65
v_perm_b32 v69, v41, v40, s47
v_accvgpr_write_b32 a77, v69
s_mov_b32 s20, 2162688
buffer_load_dword v40, v1, s[12:15], s20 offen
s_mov_b32 s21, 2195456
buffer_load_dword v41, v1, s[12:15], s21 offen
s_waitcnt vmcnt(54)
v_perm_b32 v66, v43, v42, s46
v_accvgpr_write_b32 a70, v66
v_perm_b32 v70, v43, v42, s47
v_accvgpr_write_b32 a78, v70
s_mov_b32 s20, 2105344
buffer_load_dword v42, v1, s[12:15], s20 offen
s_mov_b32 s21, 2138112
buffer_load_dword v43, v1, s[12:15], s21 offen
s_waitcnt vmcnt(54)
v_perm_b32 v67, v45, v44, s46
v_accvgpr_write_b32 a71, v67
v_perm_b32 v71, v45, v44, s47
v_accvgpr_write_b32 a79, v71
s_mov_b32 s20, 2170880
buffer_load_dword v44, v1, s[12:15], s20 offen
s_mov_b32 s21, 2203648
buffer_load_dword v45, v1, s[12:15], s21 offen
s_waitcnt vmcnt(54)
v_perm_b32 v160, v47, v46, s46
v_perm_b32 v68, v47, v46, s47
s_barrier
s_mov_b32 s20, 2359296
buffer_load_dword v46, v1, s[12:15], s20 offen
s_mov_b32 s21, 2392064
buffer_load_dword v47, v1, s[12:15], s21 offen
s_waitcnt vmcnt(54)
v_perm_b32 v161, v49, v48, s46
v_perm_b32 v69, v49, v48, s47
s_mov_b32 s20, 2424832
buffer_load_dword v48, v1, s[12:15], s20 offen
s_mov_b32 s21, 2457600
buffer_load_dword v49, v1, s[12:15], s21 offen
s_waitcnt vmcnt(54)
v_perm_b32 v162, v51, v50, s46
v_perm_b32 v70, v51, v50, s47
s_mov_b32 s20, 2367488
buffer_load_dword v50, v1, s[12:15], s20 offen
s_mov_b32 s21, 2400256
buffer_load_dword v51, v1, s[12:15], s21 offen
s_waitcnt vmcnt(54)
v_perm_b32 v163, v53, v52, s46
v_perm_b32 v71, v53, v52, s47
ds_write_b128 v3, v[68:71] offset:6144
s_waitcnt lgkmcnt(0)
s_mov_b32 s20, 2433024
buffer_load_dword v52, v1, s[12:15], s20 offen
s_mov_b32 s21, 2465792
buffer_load_dword v53, v1, s[12:15], s21 offen
s_waitcnt vmcnt(54)
v_perm_b32 v164, v55, v54, s46
v_perm_b32 v68, v55, v54, s47
s_barrier
s_mov_b32 s12, s90
s_and_b32 s13, s91, 0xffff
s_mov_b32 s14, 4718592
s_mov_b32 s15, 0x20000
s_mov_b32 s20, 2621440
buffer_load_dword v54, v1, s[12:15], s20 offen
s_mov_b32 s21, 2654208
buffer_load_dword v55, v1, s[12:15], s21 offen
s_waitcnt vmcnt(54)
v_perm_b32 v165, v57, v56, s46
v_perm_b32 v69, v57, v56, s47
s_mov_b32 s20, 2686976
buffer_load_dword v56, v1, s[12:15], s20 offen
s_mov_b32 s21, 2719744
buffer_load_dword v57, v1, s[12:15], s21 offen
s_waitcnt vmcnt(54)
v_perm_b32 v166, v59, v58, s46
v_perm_b32 v70, v59, v58, s47
s_mov_b32 s20, 2629632
buffer_load_dword v58, v1, s[12:15], s20 offen
s_mov_b32 s21, 2662400
buffer_load_dword v59, v1, s[12:15], s21 offen
s_waitcnt vmcnt(54)
v_perm_b32 v167, v61, v60, s46
v_perm_b32 v71, v61, v60, s47
ds_write_b128 v3, v[68:71] offset:7168
s_waitcnt lgkmcnt(0)
s_mov_b32 s20, 2695168
buffer_load_dword v60, v1, s[12:15], s20 offen
s_mov_b32 s21, 2727936
buffer_load_dword v61, v1, s[12:15], s21 offen
s_waitcnt vmcnt(54)
v_perm_b32 v64, v7, v6, s46
v_accvgpr_write_b32 a80, v64
v_perm_b32 v68, v7, v6, s47
v_accvgpr_write_b32 a88, v68
s_barrier
s_mov_b32 s20, 2883584
buffer_load_dword v6, v1, s[12:15], s20 offen
s_mov_b32 s21, 2916352
buffer_load_dword v7, v1, s[12:15], s21 offen
s_waitcnt vmcnt(54)
v_perm_b32 v65, v9, v8, s46
v_accvgpr_write_b32 a81, v65
v_perm_b32 v69, v9, v8, s47
v_accvgpr_write_b32 a89, v69
s_mov_b32 s20, 2949120
buffer_load_dword v8, v1, s[12:15], s20 offen
s_mov_b32 s21, 2981888
buffer_load_dword v9, v1, s[12:15], s21 offen
s_waitcnt vmcnt(54)
v_perm_b32 v66, v11, v10, s46
v_accvgpr_write_b32 a82, v66
v_perm_b32 v70, v11, v10, s47
v_accvgpr_write_b32 a90, v70
s_mov_b32 s20, 2891776
buffer_load_dword v10, v1, s[12:15], s20 offen
s_mov_b32 s21, 2924544
buffer_load_dword v11, v1, s[12:15], s21 offen
s_waitcnt vmcnt(54)
v_perm_b32 v67, v13, v12, s46
v_accvgpr_write_b32 a83, v67
v_perm_b32 v71, v13, v12, s47
v_accvgpr_write_b32 a91, v71
s_mov_b32 s20, 2957312
buffer_load_dword v12, v1, s[12:15], s20 offen
s_mov_b32 s21, 2990080
buffer_load_dword v13, v1, s[12:15], s21 offen
s_waitcnt vmcnt(54)
v_perm_b32 v64, v15, v14, s46
v_accvgpr_write_b32 a84, v64
v_perm_b32 v68, v15, v14, s47
v_accvgpr_write_b32 a92, v68
s_barrier
s_mov_b32 s12, s92
s_and_b32 s13, s93, 0xffff
s_mov_b32 s14, 4718592
s_mov_b32 s15, 0x20000
s_mov_b32 s20, 2621440
buffer_load_dword v14, v1, s[12:15], s20 offen
s_mov_b32 s21, 2654208
buffer_load_dword v15, v1, s[12:15], s21 offen
s_waitcnt vmcnt(54)
v_perm_b32 v65, v17, v16, s46
v_accvgpr_write_b32 a85, v65
v_perm_b32 v69, v17, v16, s47
v_accvgpr_write_b32 a93, v69
s_mov_b32 s20, 2686976
buffer_load_dword v16, v1, s[12:15], s20 offen
s_mov_b32 s21, 2719744
buffer_load_dword v17, v1, s[12:15], s21 offen
s_waitcnt vmcnt(54)
v_perm_b32 v66, v19, v18, s46
v_accvgpr_write_b32 a86, v66
v_perm_b32 v70, v19, v18, s47
v_accvgpr_write_b32 a94, v70
s_mov_b32 s20, 2629632
buffer_load_dword v18, v1, s[12:15], s20 offen
s_mov_b32 s21, 2662400
buffer_load_dword v19, v1, s[12:15], s21 offen
s_waitcnt vmcnt(54)
v_perm_b32 v67, v21, v20, s46
v_accvgpr_write_b32 a87, v67
v_perm_b32 v71, v21, v20, s47
v_accvgpr_write_b32 a95, v71
s_mov_b32 s20, 2695168
buffer_load_dword v20, v1, s[12:15], s20 offen
s_mov_b32 s21, 2727936
buffer_load_dword v21, v1, s[12:15], s21 offen
s_waitcnt vmcnt(54)
v_perm_b32 v184, v23, v22, s46
v_perm_b32 v68, v23, v22, s47
s_barrier
s_mov_b32 s20, 2883584
buffer_load_dword v22, v1, s[12:15], s20 offen
s_mov_b32 s21, 2916352
buffer_load_dword v23, v1, s[12:15], s21 offen
s_waitcnt vmcnt(54)
v_perm_b32 v185, v25, v24, s46
v_perm_b32 v69, v25, v24, s47
s_mov_b32 s20, 2949120
buffer_load_dword v24, v1, s[12:15], s20 offen
s_mov_b32 s21, 2981888
buffer_load_dword v25, v1, s[12:15], s21 offen
s_waitcnt vmcnt(54)
v_perm_b32 v186, v27, v26, s46
v_perm_b32 v70, v27, v26, s47
s_mov_b32 s20, 2891776
buffer_load_dword v26, v1, s[12:15], s20 offen
s_mov_b32 s21, 2924544
buffer_load_dword v27, v1, s[12:15], s21 offen
s_waitcnt vmcnt(54)
v_perm_b32 v187, v29, v28, s46
v_perm_b32 v71, v29, v28, s47
ds_write_b128 v3, v[68:71] offset:8192
s_waitcnt lgkmcnt(0)
s_mov_b32 s20, 2957312
buffer_load_dword v28, v1, s[12:15], s20 offen
s_mov_b32 s21, 2990080
buffer_load_dword v29, v1, s[12:15], s21 offen
s_waitcnt vmcnt(54)
v_perm_b32 v188, v31, v30, s46
v_perm_b32 v68, v31, v30, s47
s_barrier
s_mov_b32 s12, s90
s_and_b32 s13, s91, 0xffff
s_mov_b32 s14, 4718592
s_mov_b32 s15, 0x20000
s_mov_b32 s20, 3145728
buffer_load_dword v30, v1, s[12:15], s20 offen
s_mov_b32 s21, 3178496
buffer_load_dword v31, v1, s[12:15], s21 offen
s_waitcnt vmcnt(54)
v_perm_b32 v189, v33, v32, s46
v_perm_b32 v69, v33, v32, s47
s_mov_b32 s20, 3211264
buffer_load_dword v32, v1, s[12:15], s20 offen
s_mov_b32 s21, 3244032
buffer_load_dword v33, v1, s[12:15], s21 offen
s_waitcnt vmcnt(54)
v_perm_b32 v190, v35, v34, s46
v_perm_b32 v70, v35, v34, s47
s_mov_b32 s20, 3153920
buffer_load_dword v34, v1, s[12:15], s20 offen
s_mov_b32 s21, 3186688
buffer_load_dword v35, v1, s[12:15], s21 offen
s_waitcnt vmcnt(54)
v_perm_b32 v191, v37, v36, s46
v_perm_b32 v71, v37, v36, s47
ds_write_b128 v3, v[68:71] offset:9216
s_waitcnt lgkmcnt(0)
s_mov_b32 s20, 3219456
buffer_load_dword v36, v1, s[12:15], s20 offen
s_mov_b32 s21, 3252224
buffer_load_dword v37, v1, s[12:15], s21 offen
s_waitcnt vmcnt(54)
v_perm_b32 v64, v39, v38, s46
v_accvgpr_write_b32 a96, v64
v_perm_b32 v68, v39, v38, s47
v_accvgpr_write_b32 a104, v68
s_barrier
s_mov_b32 s20, 3407872
buffer_load_dword v38, v1, s[12:15], s20 offen
s_mov_b32 s21, 3440640
buffer_load_dword v39, v1, s[12:15], s21 offen
s_waitcnt vmcnt(54)
v_perm_b32 v65, v41, v40, s46
v_accvgpr_write_b32 a97, v65
v_perm_b32 v69, v41, v40, s47
v_accvgpr_write_b32 a105, v69
s_mov_b32 s20, 3473408
buffer_load_dword v40, v1, s[12:15], s20 offen
s_mov_b32 s21, 3506176
buffer_load_dword v41, v1, s[12:15], s21 offen
s_waitcnt vmcnt(54)
v_perm_b32 v66, v43, v42, s46
v_accvgpr_write_b32 a98, v66
v_perm_b32 v70, v43, v42, s47
v_accvgpr_write_b32 a106, v70
s_mov_b32 s20, 3416064
buffer_load_dword v42, v1, s[12:15], s20 offen
s_mov_b32 s21, 3448832
buffer_load_dword v43, v1, s[12:15], s21 offen
s_waitcnt vmcnt(54)
v_perm_b32 v67, v45, v44, s46
v_accvgpr_write_b32 a99, v67
v_perm_b32 v71, v45, v44, s47
v_accvgpr_write_b32 a107, v71
s_mov_b32 s20, 3481600
buffer_load_dword v44, v1, s[12:15], s20 offen
s_mov_b32 s21, 3514368
buffer_load_dword v45, v1, s[12:15], s21 offen
s_waitcnt vmcnt(54)
v_perm_b32 v64, v47, v46, s46
v_accvgpr_write_b32 a100, v64
v_perm_b32 v68, v47, v46, s47
v_accvgpr_write_b32 a108, v68
s_barrier
s_mov_b32 s12, s92
s_and_b32 s13, s93, 0xffff
s_mov_b32 s14, 4718592
s_mov_b32 s15, 0x20000
s_mov_b32 s20, 3145728
buffer_load_dword v46, v1, s[12:15], s20 offen
s_mov_b32 s21, 3178496
buffer_load_dword v47, v1, s[12:15], s21 offen
s_waitcnt vmcnt(54)
v_perm_b32 v65, v49, v48, s46
v_accvgpr_write_b32 a101, v65
v_perm_b32 v69, v49, v48, s47
v_accvgpr_write_b32 a109, v69
s_mov_b32 s20, 3211264
buffer_load_dword v48, v1, s[12:15], s20 offen
s_mov_b32 s21, 3244032
buffer_load_dword v49, v1, s[12:15], s21 offen
s_waitcnt vmcnt(54)
v_perm_b32 v66, v51, v50, s46
v_accvgpr_write_b32 a102, v66
v_perm_b32 v70, v51, v50, s47
v_accvgpr_write_b32 a110, v70
s_mov_b32 s20, 3153920
buffer_load_dword v50, v1, s[12:15], s20 offen
s_mov_b32 s21, 3186688
buffer_load_dword v51, v1, s[12:15], s21 offen
s_waitcnt vmcnt(54)
v_perm_b32 v67, v53, v52, s46
v_accvgpr_write_b32 a103, v67
v_perm_b32 v71, v53, v52, s47
v_accvgpr_write_b32 a111, v71
s_mov_b32 s20, 3219456
buffer_load_dword v52, v1, s[12:15], s20 offen
s_mov_b32 s21, 3252224
buffer_load_dword v53, v1, s[12:15], s21 offen
s_waitcnt vmcnt(54)
v_perm_b32 v208, v55, v54, s46
v_perm_b32 v68, v55, v54, s47
s_barrier
s_mov_b32 s20, 3407872
buffer_load_dword v54, v1, s[12:15], s20 offen
s_mov_b32 s21, 3440640
buffer_load_dword v55, v1, s[12:15], s21 offen
s_waitcnt vmcnt(54)
v_perm_b32 v209, v57, v56, s46
v_perm_b32 v69, v57, v56, s47
s_mov_b32 s20, 3473408
buffer_load_dword v56, v1, s[12:15], s20 offen
s_mov_b32 s21, 3506176
buffer_load_dword v57, v1, s[12:15], s21 offen
s_waitcnt vmcnt(54)
v_perm_b32 v210, v59, v58, s46
v_perm_b32 v70, v59, v58, s47
s_mov_b32 s20, 3416064
buffer_load_dword v58, v1, s[12:15], s20 offen
s_mov_b32 s21, 3448832
buffer_load_dword v59, v1, s[12:15], s21 offen
s_waitcnt vmcnt(54)
v_perm_b32 v211, v61, v60, s46
v_perm_b32 v71, v61, v60, s47
ds_write_b128 v3, v[68:71] offset:10240
s_waitcnt lgkmcnt(0)
s_mov_b32 s20, 3481600
buffer_load_dword v60, v1, s[12:15], s20 offen
s_mov_b32 s21, 3514368
buffer_load_dword v61, v1, s[12:15], s21 offen
s_waitcnt vmcnt(54)
v_perm_b32 v212, v7, v6, s46
v_perm_b32 v68, v7, v6, s47
s_barrier
s_mov_b32 s12, s90
s_and_b32 s13, s91, 0xffff
s_mov_b32 s14, 4718592
s_mov_b32 s15, 0x20000
s_mov_b32 s20, 3670016
buffer_load_dword v6, v1, s[12:15], s20 offen
s_mov_b32 s21, 3702784
buffer_load_dword v7, v1, s[12:15], s21 offen
s_waitcnt vmcnt(54)
v_perm_b32 v213, v9, v8, s46
v_perm_b32 v69, v9, v8, s47
s_mov_b32 s20, 3735552
buffer_load_dword v8, v1, s[12:15], s20 offen
s_mov_b32 s21, 3768320
buffer_load_dword v9, v1, s[12:15], s21 offen
s_waitcnt vmcnt(54)
v_perm_b32 v214, v11, v10, s46
v_perm_b32 v70, v11, v10, s47
s_mov_b32 s20, 3678208
buffer_load_dword v10, v1, s[12:15], s20 offen
s_mov_b32 s21, 3710976
buffer_load_dword v11, v1, s[12:15], s21 offen
s_waitcnt vmcnt(54)
v_perm_b32 v215, v13, v12, s46
v_perm_b32 v71, v13, v12, s47
ds_write_b128 v3, v[68:71] offset:11264
s_waitcnt lgkmcnt(0)
s_mov_b32 s20, 3743744
buffer_load_dword v12, v1, s[12:15], s20 offen
s_mov_b32 s21, 3776512
buffer_load_dword v13, v1, s[12:15], s21 offen
s_waitcnt vmcnt(54)
v_perm_b32 v64, v15, v14, s46
v_accvgpr_write_b32 a112, v64
v_perm_b32 v68, v15, v14, s47
v_accvgpr_write_b32 a120, v68
s_barrier
s_mov_b32 s20, 3932160
buffer_load_dword v14, v1, s[12:15], s20 offen
s_mov_b32 s21, 3964928
buffer_load_dword v15, v1, s[12:15], s21 offen
s_waitcnt vmcnt(54)
v_perm_b32 v65, v17, v16, s46
v_accvgpr_write_b32 a113, v65
v_perm_b32 v69, v17, v16, s47
v_accvgpr_write_b32 a121, v69
s_mov_b32 s20, 3997696
buffer_load_dword v16, v1, s[12:15], s20 offen
s_mov_b32 s21, 4030464
buffer_load_dword v17, v1, s[12:15], s21 offen
s_waitcnt vmcnt(54)
v_perm_b32 v66, v19, v18, s46
v_accvgpr_write_b32 a114, v66
v_perm_b32 v70, v19, v18, s47
v_accvgpr_write_b32 a122, v70
s_mov_b32 s20, 3940352
buffer_load_dword v18, v1, s[12:15], s20 offen
s_mov_b32 s21, 3973120
buffer_load_dword v19, v1, s[12:15], s21 offen
s_waitcnt vmcnt(54)
v_perm_b32 v67, v21, v20, s46
v_accvgpr_write_b32 a115, v67
v_perm_b32 v71, v21, v20, s47
v_accvgpr_write_b32 a123, v71
s_mov_b32 s20, 4005888
buffer_load_dword v20, v1, s[12:15], s20 offen
s_mov_b32 s21, 4038656
buffer_load_dword v21, v1, s[12:15], s21 offen
s_waitcnt vmcnt(54)
v_perm_b32 v64, v23, v22, s46
v_accvgpr_write_b32 a116, v64
v_perm_b32 v68, v23, v22, s47
v_accvgpr_write_b32 a124, v68
s_barrier
s_mov_b32 s12, s92
s_and_b32 s13, s93, 0xffff
s_mov_b32 s14, 4718592
s_mov_b32 s15, 0x20000
s_mov_b32 s20, 3670016
buffer_load_dword v22, v1, s[12:15], s20 offen
s_mov_b32 s21, 3702784
buffer_load_dword v23, v1, s[12:15], s21 offen
s_waitcnt vmcnt(54)
v_perm_b32 v65, v25, v24, s46
v_accvgpr_write_b32 a117, v65
v_perm_b32 v69, v25, v24, s47
v_accvgpr_write_b32 a125, v69
s_mov_b32 s20, 3735552
buffer_load_dword v24, v1, s[12:15], s20 offen
s_mov_b32 s21, 3768320
buffer_load_dword v25, v1, s[12:15], s21 offen
s_waitcnt vmcnt(54)
v_perm_b32 v66, v27, v26, s46
v_accvgpr_write_b32 a118, v66
v_perm_b32 v70, v27, v26, s47
v_accvgpr_write_b32 a126, v70
s_mov_b32 s20, 3678208
buffer_load_dword v26, v1, s[12:15], s20 offen
s_mov_b32 s21, 3710976
buffer_load_dword v27, v1, s[12:15], s21 offen
s_waitcnt vmcnt(54)
v_perm_b32 v67, v29, v28, s46
v_accvgpr_write_b32 a119, v67
v_perm_b32 v71, v29, v28, s47
v_accvgpr_write_b32 a127, v71
s_mov_b32 s20, 3743744
buffer_load_dword v28, v1, s[12:15], s20 offen
s_mov_b32 s21, 3776512
buffer_load_dword v29, v1, s[12:15], s21 offen
s_waitcnt vmcnt(54)
v_perm_b32 v232, v31, v30, s46
v_perm_b32 v68, v31, v30, s47
s_barrier
s_mov_b32 s20, 3932160
buffer_load_dword v30, v1, s[12:15], s20 offen
s_mov_b32 s21, 3964928
buffer_load_dword v31, v1, s[12:15], s21 offen
s_waitcnt vmcnt(54)
v_perm_b32 v233, v33, v32, s46
v_perm_b32 v69, v33, v32, s47
s_mov_b32 s20, 3997696
buffer_load_dword v32, v1, s[12:15], s20 offen
s_mov_b32 s21, 4030464
buffer_load_dword v33, v1, s[12:15], s21 offen
s_waitcnt vmcnt(54)
v_perm_b32 v234, v35, v34, s46
v_perm_b32 v70, v35, v34, s47
s_mov_b32 s20, 3940352
buffer_load_dword v34, v1, s[12:15], s20 offen
s_mov_b32 s21, 3973120
buffer_load_dword v35, v1, s[12:15], s21 offen
s_waitcnt vmcnt(54)
v_perm_b32 v235, v37, v36, s46
v_perm_b32 v71, v37, v36, s47
ds_write_b128 v3, v[68:71] offset:12288
s_waitcnt lgkmcnt(0)
s_mov_b32 s20, 4005888
buffer_load_dword v36, v1, s[12:15], s20 offen
s_mov_b32 s21, 4038656
buffer_load_dword v37, v1, s[12:15], s21 offen
s_waitcnt vmcnt(54)
v_perm_b32 v236, v39, v38, s46
v_perm_b32 v68, v39, v38, s47
s_barrier
s_mov_b32 s12, s90
s_and_b32 s13, s91, 0xffff
s_mov_b32 s14, 4718592
s_mov_b32 s15, 0x20000
s_mov_b32 s20, 4194304
buffer_load_dword v38, v1, s[12:15], s20 offen
s_mov_b32 s21, 4227072
buffer_load_dword v39, v1, s[12:15], s21 offen
s_waitcnt vmcnt(54)
v_perm_b32 v237, v41, v40, s46
v_perm_b32 v69, v41, v40, s47
s_mov_b32 s20, 4259840
buffer_load_dword v40, v1, s[12:15], s20 offen
s_mov_b32 s21, 4292608
buffer_load_dword v41, v1, s[12:15], s21 offen
s_waitcnt vmcnt(54)
v_perm_b32 v238, v43, v42, s46
v_perm_b32 v70, v43, v42, s47
s_mov_b32 s20, 4202496
buffer_load_dword v42, v1, s[12:15], s20 offen
s_mov_b32 s21, 4235264
buffer_load_dword v43, v1, s[12:15], s21 offen
s_waitcnt vmcnt(54)
v_perm_b32 v239, v45, v44, s46
v_perm_b32 v71, v45, v44, s47
ds_write_b128 v3, v[68:71] offset:13312
s_waitcnt lgkmcnt(0)
s_mov_b32 s20, 4268032
buffer_load_dword v44, v1, s[12:15], s20 offen
s_mov_b32 s21, 4300800
buffer_load_dword v45, v1, s[12:15], s21 offen
s_waitcnt vmcnt(54)
v_perm_b32 v64, v47, v46, s46
v_accvgpr_write_b32 a128, v64
v_perm_b32 v68, v47, v46, s47
v_accvgpr_write_b32 a136, v68
s_barrier
s_mov_b32 s20, 4456448
buffer_load_dword v46, v1, s[12:15], s20 offen
s_mov_b32 s21, 4489216
buffer_load_dword v47, v1, s[12:15], s21 offen
s_waitcnt vmcnt(54)
v_perm_b32 v65, v49, v48, s46
v_accvgpr_write_b32 a129, v65
v_perm_b32 v69, v49, v48, s47
v_accvgpr_write_b32 a137, v69
s_mov_b32 s20, 4521984
buffer_load_dword v48, v1, s[12:15], s20 offen
s_mov_b32 s21, 4554752
buffer_load_dword v49, v1, s[12:15], s21 offen
s_waitcnt vmcnt(54)
v_perm_b32 v66, v51, v50, s46
v_accvgpr_write_b32 a130, v66
v_perm_b32 v70, v51, v50, s47
v_accvgpr_write_b32 a138, v70
s_mov_b32 s20, 4464640
buffer_load_dword v50, v1, s[12:15], s20 offen
s_mov_b32 s21, 4497408
buffer_load_dword v51, v1, s[12:15], s21 offen
s_waitcnt vmcnt(54)
v_perm_b32 v67, v53, v52, s46
v_accvgpr_write_b32 a131, v67
v_perm_b32 v71, v53, v52, s47
v_accvgpr_write_b32 a139, v71
s_mov_b32 s20, 4530176
buffer_load_dword v52, v1, s[12:15], s20 offen
s_mov_b32 s21, 4562944
buffer_load_dword v53, v1, s[12:15], s21 offen
s_waitcnt vmcnt(54)
v_perm_b32 v64, v55, v54, s46
v_accvgpr_write_b32 a132, v64
v_perm_b32 v68, v55, v54, s47
v_accvgpr_write_b32 a140, v68
s_barrier
s_mov_b32 s12, s92
s_and_b32 s13, s93, 0xffff
s_mov_b32 s14, 4718592
s_mov_b32 s15, 0x20000
s_mov_b32 s20, 4194304
buffer_load_dword v54, v1, s[12:15], s20 offen
s_mov_b32 s21, 4227072
buffer_load_dword v55, v1, s[12:15], s21 offen
s_waitcnt vmcnt(54)
v_perm_b32 v65, v57, v56, s46
v_accvgpr_write_b32 a133, v65
v_perm_b32 v69, v57, v56, s47
v_accvgpr_write_b32 a141, v69
s_mov_b32 s20, 4259840
buffer_load_dword v56, v1, s[12:15], s20 offen
s_mov_b32 s21, 4292608
buffer_load_dword v57, v1, s[12:15], s21 offen
s_waitcnt vmcnt(54)
v_perm_b32 v66, v59, v58, s46
v_accvgpr_write_b32 a134, v66
v_perm_b32 v70, v59, v58, s47
v_accvgpr_write_b32 a142, v70
s_mov_b32 s20, 4202496
buffer_load_dword v58, v1, s[12:15], s20 offen
s_mov_b32 s21, 4235264
buffer_load_dword v59, v1, s[12:15], s21 offen
s_waitcnt vmcnt(54)
v_perm_b32 v67, v61, v60, s46
v_accvgpr_write_b32 a135, v67
v_perm_b32 v71, v61, v60, s47
v_accvgpr_write_b32 a143, v71
s_mov_b32 s20, 4268032
buffer_load_dword v60, v1, s[12:15], s20 offen
s_mov_b32 s21, 4300800
buffer_load_dword v61, v1, s[12:15], s21 offen
s_waitcnt vmcnt(54)
v_perm_b32 v64, v7, v6, s46
v_accvgpr_write_b32 a0, v64
v_perm_b32 v68, v7, v6, s47
s_barrier
s_mov_b32 s20, 4456448
buffer_load_dword v6, v1, s[12:15], s20 offen
s_mov_b32 s21, 4489216
buffer_load_dword v7, v1, s[12:15], s21 offen
s_waitcnt vmcnt(54)
v_perm_b32 v65, v9, v8, s46
v_accvgpr_write_b32 a1, v65
v_perm_b32 v69, v9, v8, s47
s_mov_b32 s20, 4521984
buffer_load_dword v8, v1, s[12:15], s20 offen
s_mov_b32 s21, 4554752
buffer_load_dword v9, v1, s[12:15], s21 offen
s_waitcnt vmcnt(54)
v_perm_b32 v66, v11, v10, s46
v_accvgpr_write_b32 a2, v66
v_perm_b32 v70, v11, v10, s47
s_mov_b32 s20, 4464640
buffer_load_dword v10, v1, s[12:15], s20 offen
s_mov_b32 s21, 4497408
buffer_load_dword v11, v1, s[12:15], s21 offen
s_waitcnt vmcnt(54)
v_perm_b32 v67, v13, v12, s46
v_accvgpr_write_b32 a3, v67
v_perm_b32 v71, v13, v12, s47
ds_write_b128 v3, v[68:71] offset:14336
s_waitcnt lgkmcnt(0)
s_mov_b32 s20, 4530176
buffer_load_dword v12, v1, s[12:15], s20 offen
s_mov_b32 s21, 4562944
buffer_load_dword v13, v1, s[12:15], s21 offen
s_waitcnt vmcnt(54)
v_perm_b32 v64, v15, v14, s46
v_accvgpr_write_b32 a4, v64
v_perm_b32 v68, v15, v14, s47
s_barrier
s_mov_b32 s12, s94
s_and_b32 s13, s95, 0xffff
s_mov_b32 s14, 4718592
s_mov_b32 s15, 0x20000
s_mov_b32 s20, 0
buffer_load_dword v14, v4, s[12:15], s20 offen
s_mov_b32 s21, 1152
buffer_load_dword v15, v4, s[12:15], s21 offen
s_waitcnt vmcnt(54)
v_perm_b32 v65, v17, v16, s46
v_accvgpr_write_b32 a5, v65
v_perm_b32 v69, v17, v16, s47
s_mov_b32 s20, 9216
buffer_load_dword v16, v4, s[12:15], s20 offen
s_mov_b32 s21, 10368
buffer_load_dword v17, v4, s[12:15], s21 offen
s_waitcnt vmcnt(54)
v_perm_b32 v66, v19, v18, s46
v_accvgpr_write_b32 a6, v66
v_perm_b32 v70, v19, v18, s47
s_mov_b32 s20, 2304
buffer_load_dword v18, v4, s[12:15], s20 offen
s_mov_b32 s21, 3456
buffer_load_dword v19, v4, s[12:15], s21 offen
s_waitcnt vmcnt(54)
v_perm_b32 v67, v21, v20, s46
v_accvgpr_write_b32 a7, v67
v_perm_b32 v71, v21, v20, s47
ds_write_b128 v3, v[68:71] offset:15360
s_waitcnt lgkmcnt(0)
s_mov_b32 s20, 11520
buffer_load_dword v20, v4, s[12:15], s20 offen
s_mov_b32 s21, 12672
buffer_load_dword v21, v4, s[12:15], s21 offen
s_waitcnt vmcnt(54)
v_perm_b32 v64, v23, v22, s46
v_accvgpr_write_b32 a144, v64
v_perm_b32 v68, v23, v22, s47
v_accvgpr_write_b32 a152, v68
s_barrier
s_mov_b32 s20, 36864
buffer_load_dword v22, v4, s[12:15], s20 offen
s_mov_b32 s21, 38016
buffer_load_dword v23, v4, s[12:15], s21 offen
s_waitcnt vmcnt(54)
v_perm_b32 v65, v25, v24, s46
v_accvgpr_write_b32 a145, v65
v_perm_b32 v69, v25, v24, s47
v_accvgpr_write_b32 a153, v69
s_mov_b32 s20, 46080
buffer_load_dword v24, v4, s[12:15], s20 offen
s_mov_b32 s21, 47232
buffer_load_dword v25, v4, s[12:15], s21 offen
s_waitcnt vmcnt(54)
v_perm_b32 v66, v27, v26, s46
v_accvgpr_write_b32 a146, v66
v_perm_b32 v70, v27, v26, s47
v_accvgpr_write_b32 a154, v70
s_mov_b32 s20, 39168
buffer_load_dword v26, v4, s[12:15], s20 offen
s_mov_b32 s21, 40320
buffer_load_dword v27, v4, s[12:15], s21 offen
s_waitcnt vmcnt(54)
v_perm_b32 v67, v29, v28, s46
v_accvgpr_write_b32 a147, v67
v_perm_b32 v71, v29, v28, s47
v_accvgpr_write_b32 a155, v71
s_mov_b32 s20, 48384
buffer_load_dword v28, v4, s[12:15], s20 offen
s_mov_b32 s21, 49536
buffer_load_dword v29, v4, s[12:15], s21 offen
s_waitcnt vmcnt(54)
v_perm_b32 v64, v31, v30, s46
v_accvgpr_write_b32 a148, v64
v_perm_b32 v68, v31, v30, s47
v_accvgpr_write_b32 a156, v68
s_barrier
s_mov_b32 s20, 73728
buffer_load_dword v30, v4, s[12:15], s20 offen
s_mov_b32 s21, 74880
buffer_load_dword v31, v4, s[12:15], s21 offen
s_waitcnt vmcnt(54)
v_perm_b32 v65, v33, v32, s46
v_accvgpr_write_b32 a149, v65
v_perm_b32 v69, v33, v32, s47
v_accvgpr_write_b32 a157, v69
s_mov_b32 s20, 82944
buffer_load_dword v32, v4, s[12:15], s20 offen
s_mov_b32 s21, 84096
buffer_load_dword v33, v4, s[12:15], s21 offen
s_waitcnt vmcnt(54)
v_perm_b32 v66, v35, v34, s46
v_accvgpr_write_b32 a150, v66
v_perm_b32 v70, v35, v34, s47
v_accvgpr_write_b32 a158, v70
s_mov_b32 s20, 76032
buffer_load_dword v34, v4, s[12:15], s20 offen
s_mov_b32 s21, 77184
buffer_load_dword v35, v4, s[12:15], s21 offen
s_waitcnt vmcnt(54)
v_perm_b32 v67, v37, v36, s46
v_accvgpr_write_b32 a151, v67
v_perm_b32 v71, v37, v36, s47
v_accvgpr_write_b32 a159, v71
s_mov_b32 s20, 85248
buffer_load_dword v36, v4, s[12:15], s20 offen
s_mov_b32 s21, 86400
buffer_load_dword v37, v4, s[12:15], s21 offen
s_waitcnt vmcnt(54)
v_perm_b32 v64, v39, v38, s46
v_accvgpr_write_b32 a24, v64
v_perm_b32 v68, v39, v38, s47
s_barrier
s_mov_b32 s20, 110592
buffer_load_dword v38, v4, s[12:15], s20 offen
s_mov_b32 s21, 111744
buffer_load_dword v39, v4, s[12:15], s21 offen
s_waitcnt vmcnt(54)
v_perm_b32 v65, v41, v40, s46
v_accvgpr_write_b32 a25, v65
v_perm_b32 v69, v41, v40, s47
s_mov_b32 s20, 119808
buffer_load_dword v40, v4, s[12:15], s20 offen
s_mov_b32 s21, 120960
buffer_load_dword v41, v4, s[12:15], s21 offen
s_waitcnt vmcnt(54)
v_perm_b32 v66, v43, v42, s46
v_accvgpr_write_b32 a26, v66
v_perm_b32 v70, v43, v42, s47
s_mov_b32 s20, 112896
buffer_load_dword v42, v4, s[12:15], s20 offen
s_mov_b32 s21, 114048
buffer_load_dword v43, v4, s[12:15], s21 offen
s_waitcnt vmcnt(54)
v_perm_b32 v67, v45, v44, s46
v_accvgpr_write_b32 a27, v67
v_perm_b32 v71, v45, v44, s47
ds_write_b128 v3, v[68:71] offset:16384
s_waitcnt lgkmcnt(0)
s_mov_b32 s20, 122112
buffer_load_dword v44, v4, s[12:15], s20 offen
s_mov_b32 s21, 123264
buffer_load_dword v45, v4, s[12:15], s21 offen
s_waitcnt vmcnt(54)
v_perm_b32 v64, v47, v46, s46
v_accvgpr_write_b32 a28, v64
v_perm_b32 v68, v47, v46, s47
s_barrier
s_mov_b32 s20, 256
buffer_load_dword v46, v4, s[12:15], s20 offen
s_mov_b32 s21, 1408
buffer_load_dword v47, v4, s[12:15], s21 offen
s_waitcnt vmcnt(54)
v_perm_b32 v65, v49, v48, s46
v_accvgpr_write_b32 a29, v65
v_perm_b32 v69, v49, v48, s47
s_mov_b32 s20, 9472
buffer_load_dword v48, v4, s[12:15], s20 offen
s_mov_b32 s21, 10624
buffer_load_dword v49, v4, s[12:15], s21 offen
s_waitcnt vmcnt(54)
v_perm_b32 v66, v51, v50, s46
v_accvgpr_write_b32 a30, v66
v_perm_b32 v70, v51, v50, s47
s_mov_b32 s20, 2560
buffer_load_dword v50, v4, s[12:15], s20 offen
s_mov_b32 s21, 3712
buffer_load_dword v51, v4, s[12:15], s21 offen
s_waitcnt vmcnt(54)
v_perm_b32 v67, v53, v52, s46
v_accvgpr_write_b32 a31, v67
v_perm_b32 v71, v53, v52, s47
ds_write_b128 v3, v[68:71] offset:17408
s_waitcnt lgkmcnt(0)
s_mov_b32 s20, 11776
buffer_load_dword v52, v4, s[12:15], s20 offen
s_mov_b32 s21, 12928
buffer_load_dword v53, v4, s[12:15], s21 offen
s_waitcnt vmcnt(54)
v_perm_b32 v64, v55, v54, s46
v_accvgpr_write_b32 a160, v64
v_perm_b32 v68, v55, v54, s47
v_accvgpr_write_b32 a168, v68
s_barrier
s_mov_b32 s20, 37120
buffer_load_dword v54, v4, s[12:15], s20 offen
s_mov_b32 s21, 38272
buffer_load_dword v55, v4, s[12:15], s21 offen
s_waitcnt vmcnt(54)
v_perm_b32 v65, v57, v56, s46
v_accvgpr_write_b32 a161, v65
v_perm_b32 v69, v57, v56, s47
v_accvgpr_write_b32 a169, v69
s_mov_b32 s20, 46336
buffer_load_dword v56, v4, s[12:15], s20 offen
s_mov_b32 s21, 47488
buffer_load_dword v57, v4, s[12:15], s21 offen
s_waitcnt vmcnt(54)
v_perm_b32 v66, v59, v58, s46
v_accvgpr_write_b32 a162, v66
v_perm_b32 v70, v59, v58, s47
v_accvgpr_write_b32 a170, v70
s_mov_b32 s20, 39424
buffer_load_dword v58, v4, s[12:15], s20 offen
s_mov_b32 s21, 40576
buffer_load_dword v59, v4, s[12:15], s21 offen
s_waitcnt vmcnt(54)
v_perm_b32 v67, v61, v60, s46
v_accvgpr_write_b32 a163, v67
v_perm_b32 v71, v61, v60, s47
v_accvgpr_write_b32 a171, v71
s_mov_b32 s20, 48640
buffer_load_dword v60, v4, s[12:15], s20 offen
s_mov_b32 s21, 49792
buffer_load_dword v61, v4, s[12:15], s21 offen
s_waitcnt vmcnt(54)
v_perm_b32 v64, v7, v6, s46
v_accvgpr_write_b32 a164, v64
v_perm_b32 v68, v7, v6, s47
v_accvgpr_write_b32 a172, v68
s_barrier
s_mov_b32 s20, 73984
buffer_load_dword v6, v4, s[12:15], s20 offen
s_mov_b32 s21, 75136
buffer_load_dword v7, v4, s[12:15], s21 offen
s_waitcnt vmcnt(54)
v_perm_b32 v65, v9, v8, s46
v_accvgpr_write_b32 a165, v65
v_perm_b32 v69, v9, v8, s47
v_accvgpr_write_b32 a173, v69
s_mov_b32 s20, 83200
buffer_load_dword v8, v4, s[12:15], s20 offen
s_mov_b32 s21, 84352
buffer_load_dword v9, v4, s[12:15], s21 offen
s_waitcnt vmcnt(54)
v_perm_b32 v66, v11, v10, s46
v_accvgpr_write_b32 a166, v66
v_perm_b32 v70, v11, v10, s47
v_accvgpr_write_b32 a174, v70
s_mov_b32 s20, 76288
buffer_load_dword v10, v4, s[12:15], s20 offen
s_mov_b32 s21, 77440
buffer_load_dword v11, v4, s[12:15], s21 offen
s_waitcnt vmcnt(54)
v_perm_b32 v67, v13, v12, s46
v_accvgpr_write_b32 a167, v67
v_perm_b32 v71, v13, v12, s47
v_accvgpr_write_b32 a175, v71
s_mov_b32 s20, 85504
buffer_load_dword v12, v4, s[12:15], s20 offen
s_mov_b32 s21, 86656
buffer_load_dword v13, v4, s[12:15], s21 offen
s_waitcnt vmcnt(54)
v_perm_b32 v64, v15, v14, s46
v_accvgpr_write_b32 a176, v64
v_perm_b32 v68, v15, v14, s47
v_accvgpr_write_b32 a184, v68
s_barrier
s_mov_b32 s20, 110848
buffer_load_dword v14, v4, s[12:15], s20 offen
s_mov_b32 s21, 112000
buffer_load_dword v15, v4, s[12:15], s21 offen
s_waitcnt vmcnt(54)
v_perm_b32 v65, v17, v16, s46
v_accvgpr_write_b32 a177, v65
v_perm_b32 v69, v17, v16, s47
v_accvgpr_write_b32 a185, v69
s_mov_b32 s20, 120064
buffer_load_dword v16, v4, s[12:15], s20 offen
s_mov_b32 s21, 121216
buffer_load_dword v17, v4, s[12:15], s21 offen
s_waitcnt vmcnt(54)
v_perm_b32 v66, v19, v18, s46
v_accvgpr_write_b32 a178, v66
v_perm_b32 v70, v19, v18, s47
v_accvgpr_write_b32 a186, v70
s_mov_b32 s20, 113152
buffer_load_dword v18, v4, s[12:15], s20 offen
s_mov_b32 s21, 114304
buffer_load_dword v19, v4, s[12:15], s21 offen
s_waitcnt vmcnt(54)
v_perm_b32 v67, v21, v20, s46
v_accvgpr_write_b32 a179, v67
v_perm_b32 v71, v21, v20, s47
v_accvgpr_write_b32 a187, v71
s_mov_b32 s20, 122368
buffer_load_dword v20, v4, s[12:15], s20 offen
s_mov_b32 s21, 123520
buffer_load_dword v21, v4, s[12:15], s21 offen
s_waitcnt vmcnt(54)
v_perm_b32 v64, v23, v22, s46
v_accvgpr_write_b32 a180, v64
v_perm_b32 v68, v23, v22, s47
v_accvgpr_write_b32 a188, v68
s_barrier
s_mov_b32 s20, 512
buffer_load_dword v22, v4, s[12:15], s20 offen
s_mov_b32 s21, 1664
buffer_load_dword v23, v4, s[12:15], s21 offen
s_waitcnt vmcnt(54)
v_perm_b32 v65, v25, v24, s46
v_accvgpr_write_b32 a181, v65
v_perm_b32 v69, v25, v24, s47
v_accvgpr_write_b32 a189, v69
s_mov_b32 s20, 9728
buffer_load_dword v24, v4, s[12:15], s20 offen
s_mov_b32 s21, 10880
buffer_load_dword v25, v4, s[12:15], s21 offen
s_waitcnt vmcnt(54)
v_perm_b32 v66, v27, v26, s46
v_accvgpr_write_b32 a182, v66
v_perm_b32 v70, v27, v26, s47
v_accvgpr_write_b32 a190, v70
s_mov_b32 s20, 2816
buffer_load_dword v26, v4, s[12:15], s20 offen
s_mov_b32 s21, 3968
buffer_load_dword v27, v4, s[12:15], s21 offen
s_waitcnt vmcnt(54)
v_perm_b32 v67, v29, v28, s46
v_accvgpr_write_b32 a183, v67
v_perm_b32 v71, v29, v28, s47
v_accvgpr_write_b32 a191, v71
s_mov_b32 s20, 12032
buffer_load_dword v28, v4, s[12:15], s20 offen
s_mov_b32 s21, 13184
buffer_load_dword v29, v4, s[12:15], s21 offen
s_waitcnt vmcnt(54)
v_perm_b32 v64, v31, v30, s46
v_perm_b32 v68, v31, v30, s47
s_barrier
s_mov_b32 s20, 37376
buffer_load_dword v30, v4, s[12:15], s20 offen
s_mov_b32 s21, 38528
buffer_load_dword v31, v4, s[12:15], s21 offen
s_waitcnt vmcnt(54)
v_perm_b32 v65, v33, v32, s46
v_perm_b32 v69, v33, v32, s47
s_mov_b32 s20, 46592
buffer_load_dword v32, v4, s[12:15], s20 offen
s_mov_b32 s21, 47744
buffer_load_dword v33, v4, s[12:15], s21 offen
s_waitcnt vmcnt(54)
v_perm_b32 v66, v35, v34, s46
v_perm_b32 v70, v35, v34, s47
s_mov_b32 s20, 39680
buffer_load_dword v34, v4, s[12:15], s20 offen
s_mov_b32 s21, 40832
buffer_load_dword v35, v4, s[12:15], s21 offen
s_waitcnt vmcnt(54)
v_perm_b32 v67, v37, v36, s46
ds_write_b128 v3, v[64:67] offset:20480
s_waitcnt lgkmcnt(0)
v_perm_b32 v71, v37, v36, s47
ds_write_b128 v3, v[68:71] offset:22528
s_waitcnt lgkmcnt(0)
s_mov_b32 s20, 48896
buffer_load_dword v36, v4, s[12:15], s20 offen
s_mov_b32 s21, 50048
buffer_load_dword v37, v4, s[12:15], s21 offen
s_waitcnt vmcnt(54)
v_perm_b32 v64, v39, v38, s46
v_perm_b32 v68, v39, v38, s47
s_barrier
s_mov_b32 s20, 74240
buffer_load_dword v38, v4, s[12:15], s20 offen
s_mov_b32 s21, 75392
buffer_load_dword v39, v4, s[12:15], s21 offen
s_waitcnt vmcnt(54)
v_perm_b32 v65, v41, v40, s46
v_perm_b32 v69, v41, v40, s47
s_mov_b32 s20, 83456
buffer_load_dword v40, v4, s[12:15], s20 offen
s_mov_b32 s21, 84608
buffer_load_dword v41, v4, s[12:15], s21 offen
s_waitcnt vmcnt(54)
v_perm_b32 v66, v43, v42, s46
v_perm_b32 v70, v43, v42, s47
s_mov_b32 s20, 76544
buffer_load_dword v42, v4, s[12:15], s20 offen
s_mov_b32 s21, 77696
buffer_load_dword v43, v4, s[12:15], s21 offen
s_waitcnt vmcnt(54)
v_perm_b32 v67, v45, v44, s46
ds_write_b128 v3, v[64:67] offset:21504
s_waitcnt lgkmcnt(0)
v_perm_b32 v71, v45, v44, s47
ds_write_b128 v3, v[68:71] offset:23552
s_waitcnt lgkmcnt(0)
s_mov_b32 s20, 85760
buffer_load_dword v44, v4, s[12:15], s20 offen
s_mov_b32 s21, 86912
buffer_load_dword v45, v4, s[12:15], s21 offen
s_waitcnt vmcnt(54)
v_perm_b32 v64, v47, v46, s46
v_accvgpr_write_b32 a192, v64
v_perm_b32 v68, v47, v46, s47
v_accvgpr_write_b32 a200, v68
s_barrier
s_mov_b32 s20, 111104
buffer_load_dword v46, v4, s[12:15], s20 offen
s_mov_b32 s21, 112256
buffer_load_dword v47, v4, s[12:15], s21 offen
s_waitcnt vmcnt(54)
v_perm_b32 v65, v49, v48, s46
v_accvgpr_write_b32 a193, v65
v_perm_b32 v69, v49, v48, s47
v_accvgpr_write_b32 a201, v69
s_mov_b32 s20, 120320
buffer_load_dword v48, v4, s[12:15], s20 offen
s_mov_b32 s21, 121472
buffer_load_dword v49, v4, s[12:15], s21 offen
s_waitcnt vmcnt(54)
v_perm_b32 v66, v51, v50, s46
v_accvgpr_write_b32 a194, v66
v_perm_b32 v70, v51, v50, s47
v_accvgpr_write_b32 a202, v70
s_mov_b32 s20, 113408
buffer_load_dword v50, v4, s[12:15], s20 offen
s_mov_b32 s21, 114560
buffer_load_dword v51, v4, s[12:15], s21 offen
s_waitcnt vmcnt(54)
v_perm_b32 v67, v53, v52, s46
v_accvgpr_write_b32 a195, v67
v_perm_b32 v71, v53, v52, s47
v_accvgpr_write_b32 a203, v71
s_mov_b32 s20, 122624
buffer_load_dword v52, v4, s[12:15], s20 offen
s_mov_b32 s21, 123776
buffer_load_dword v53, v4, s[12:15], s21 offen
s_waitcnt vmcnt(54)
v_perm_b32 v64, v55, v54, s46
v_accvgpr_write_b32 a196, v64
v_perm_b32 v68, v55, v54, s47
v_accvgpr_write_b32 a204, v68
s_barrier
s_mov_b32 s20, 768
buffer_load_dword v54, v4, s[12:15], s20 offen
s_mov_b32 s21, 1920
buffer_load_dword v55, v4, s[12:15], s21 offen
s_waitcnt vmcnt(54)
v_perm_b32 v65, v57, v56, s46
v_accvgpr_write_b32 a197, v65
v_perm_b32 v69, v57, v56, s47
v_accvgpr_write_b32 a205, v69
s_mov_b32 s20, 9984
buffer_load_dword v56, v4, s[12:15], s20 offen
s_mov_b32 s21, 11136
buffer_load_dword v57, v4, s[12:15], s21 offen
s_waitcnt vmcnt(54)
v_perm_b32 v66, v59, v58, s46
v_accvgpr_write_b32 a198, v66
v_perm_b32 v70, v59, v58, s47
v_accvgpr_write_b32 a206, v70
s_mov_b32 s20, 3072
buffer_load_dword v58, v4, s[12:15], s20 offen
s_mov_b32 s21, 4224
buffer_load_dword v59, v4, s[12:15], s21 offen
s_waitcnt vmcnt(54)
v_perm_b32 v67, v61, v60, s46
v_accvgpr_write_b32 a199, v67
v_perm_b32 v71, v61, v60, s47
v_accvgpr_write_b32 a207, v71
s_mov_b32 s20, 12288
buffer_load_dword v60, v4, s[12:15], s20 offen
s_mov_b32 s21, 13440
buffer_load_dword v61, v4, s[12:15], s21 offen
s_waitcnt vmcnt(54)
v_perm_b32 v64, v7, v6, s46
v_perm_b32 v68, v7, v6, s47
s_barrier
s_mov_b32 s20, 37632
buffer_load_dword v6, v4, s[12:15], s20 offen
s_mov_b32 s21, 38784
buffer_load_dword v7, v4, s[12:15], s21 offen
s_waitcnt vmcnt(54)
v_perm_b32 v65, v9, v8, s46
v_perm_b32 v69, v9, v8, s47
s_mov_b32 s20, 46848
buffer_load_dword v8, v4, s[12:15], s20 offen
s_mov_b32 s21, 48000
buffer_load_dword v9, v4, s[12:15], s21 offen
s_waitcnt vmcnt(54)
v_perm_b32 v66, v11, v10, s46
v_perm_b32 v70, v11, v10, s47
s_mov_b32 s20, 39936
buffer_load_dword v10, v4, s[12:15], s20 offen
s_mov_b32 s21, 41088
buffer_load_dword v11, v4, s[12:15], s21 offen
s_waitcnt vmcnt(54)
v_perm_b32 v67, v13, v12, s46
ds_write_b128 v3, v[64:67] offset:24576
s_waitcnt lgkmcnt(0)
v_perm_b32 v71, v13, v12, s47
ds_write_b128 v3, v[68:71] offset:26624
s_waitcnt lgkmcnt(0)
s_mov_b32 s20, 49152
buffer_load_dword v12, v4, s[12:15], s20 offen
s_mov_b32 s21, 50304
buffer_load_dword v13, v4, s[12:15], s21 offen
s_waitcnt vmcnt(54)
v_perm_b32 v64, v15, v14, s46
v_perm_b32 v68, v15, v14, s47
s_barrier
s_mov_b32 s20, 74496
buffer_load_dword v14, v4, s[12:15], s20 offen
s_mov_b32 s21, 75648
buffer_load_dword v15, v4, s[12:15], s21 offen
s_waitcnt vmcnt(54)
v_perm_b32 v65, v17, v16, s46
v_perm_b32 v69, v17, v16, s47
s_mov_b32 s20, 83712
buffer_load_dword v16, v4, s[12:15], s20 offen
s_mov_b32 s21, 84864
buffer_load_dword v17, v4, s[12:15], s21 offen
s_waitcnt vmcnt(54)
v_perm_b32 v66, v19, v18, s46
v_perm_b32 v70, v19, v18, s47
s_mov_b32 s20, 76800
buffer_load_dword v18, v4, s[12:15], s20 offen
s_mov_b32 s21, 77952
buffer_load_dword v19, v4, s[12:15], s21 offen
s_waitcnt vmcnt(54)
v_perm_b32 v67, v21, v20, s46
ds_write_b128 v3, v[64:67] offset:25600
s_waitcnt lgkmcnt(0)
v_perm_b32 v71, v21, v20, s47
ds_write_b128 v3, v[68:71] offset:27648
s_waitcnt lgkmcnt(0)
s_mov_b32 s20, 86016
buffer_load_dword v20, v4, s[12:15], s20 offen
s_mov_b32 s21, 87168
buffer_load_dword v21, v4, s[12:15], s21 offen
s_waitcnt vmcnt(54)
v_perm_b32 v64, v23, v22, s46
v_accvgpr_write_b32 a208, v64
v_perm_b32 v68, v23, v22, s47
v_accvgpr_write_b32 a216, v68
s_barrier
s_mov_b32 s20, 111360
buffer_load_dword v22, v4, s[12:15], s20 offen
s_mov_b32 s21, 112512
buffer_load_dword v23, v4, s[12:15], s21 offen
s_waitcnt vmcnt(54)
v_perm_b32 v65, v25, v24, s46
v_accvgpr_write_b32 a209, v65
v_perm_b32 v69, v25, v24, s47
v_accvgpr_write_b32 a217, v69
s_mov_b32 s20, 120576
buffer_load_dword v24, v4, s[12:15], s20 offen
s_mov_b32 s21, 121728
buffer_load_dword v25, v4, s[12:15], s21 offen
s_waitcnt vmcnt(54)
v_perm_b32 v66, v27, v26, s46
v_accvgpr_write_b32 a210, v66
v_perm_b32 v70, v27, v26, s47
v_accvgpr_write_b32 a218, v70
s_mov_b32 s20, 113664
buffer_load_dword v26, v4, s[12:15], s20 offen
s_mov_b32 s21, 114816
buffer_load_dword v27, v4, s[12:15], s21 offen
s_waitcnt vmcnt(54)
v_perm_b32 v67, v29, v28, s46
v_accvgpr_write_b32 a211, v67
v_perm_b32 v71, v29, v28, s47
v_accvgpr_write_b32 a219, v71
s_mov_b32 s20, 122880
buffer_load_dword v28, v4, s[12:15], s20 offen
s_mov_b32 s21, 124032
buffer_load_dword v29, v4, s[12:15], s21 offen
s_waitcnt vmcnt(54)
v_perm_b32 v64, v31, v30, s46
v_accvgpr_write_b32 a212, v64
v_perm_b32 v68, v31, v30, s47
v_accvgpr_write_b32 a220, v68
s_barrier
s_mov_b32 s20, 1024
buffer_load_ushort v30, v2, s[12:15], s20 offen
s_mov_b32 s21, 2176
buffer_load_ushort v31, v2, s[12:15], s21 offen
s_waitcnt vmcnt(54)
v_perm_b32 v65, v33, v32, s46
v_accvgpr_write_b32 a213, v65
v_perm_b32 v69, v33, v32, s47
v_accvgpr_write_b32 a221, v69
s_mov_b32 s20, 10240
buffer_load_ushort v32, v2, s[12:15], s20 offen
s_mov_b32 s21, 11392
buffer_load_ushort v33, v2, s[12:15], s21 offen
s_waitcnt vmcnt(54)
v_perm_b32 v66, v35, v34, s46
v_accvgpr_write_b32 a214, v66
v_perm_b32 v70, v35, v34, s47
v_accvgpr_write_b32 a222, v70
s_mov_b32 s20, 3328
buffer_load_ushort v34, v2, s[12:15], s20 offen
s_mov_b32 s21, 4480
buffer_load_ushort v35, v2, s[12:15], s21 offen
s_waitcnt vmcnt(54)
v_perm_b32 v67, v37, v36, s46
v_accvgpr_write_b32 a215, v67
v_perm_b32 v71, v37, v36, s47
v_accvgpr_write_b32 a223, v71
s_mov_b32 s20, 12544
buffer_load_ushort v36, v2, s[12:15], s20 offen
s_mov_b32 s21, 13696
buffer_load_ushort v37, v2, s[12:15], s21 offen
s_waitcnt vmcnt(54)
v_perm_b32 v64, v39, v38, s46
v_perm_b32 v68, v39, v38, s47
s_barrier
s_mov_b32 s20, 37888
buffer_load_ushort v38, v2, s[12:15], s20 offen
s_mov_b32 s21, 39040
buffer_load_ushort v39, v2, s[12:15], s21 offen
s_waitcnt vmcnt(54)
v_perm_b32 v65, v41, v40, s46
v_perm_b32 v69, v41, v40, s47
s_mov_b32 s20, 47104
buffer_load_ushort v40, v2, s[12:15], s20 offen
s_mov_b32 s21, 48256
buffer_load_ushort v41, v2, s[12:15], s21 offen
s_waitcnt vmcnt(54)
v_perm_b32 v66, v43, v42, s46
v_perm_b32 v70, v43, v42, s47
s_mov_b32 s20, 40192
buffer_load_ushort v42, v2, s[12:15], s20 offen
s_mov_b32 s21, 41344
buffer_load_ushort v43, v2, s[12:15], s21 offen
s_waitcnt vmcnt(54)
v_perm_b32 v67, v45, v44, s46
ds_write_b128 v3, v[64:67] offset:28672
s_waitcnt lgkmcnt(0)
v_perm_b32 v71, v45, v44, s47
ds_write_b128 v3, v[68:71] offset:30720
s_waitcnt lgkmcnt(0)
s_mov_b32 s20, 49408
buffer_load_ushort v44, v2, s[12:15], s20 offen
s_mov_b32 s21, 50560
buffer_load_ushort v45, v2, s[12:15], s21 offen
s_waitcnt vmcnt(54)
v_perm_b32 v64, v47, v46, s46
v_perm_b32 v68, v47, v46, s47
s_barrier
s_mov_b32 s20, 74752
buffer_load_ushort v46, v2, s[12:15], s20 offen
s_mov_b32 s21, 75904
buffer_load_ushort v47, v2, s[12:15], s21 offen
s_waitcnt vmcnt(54)
v_perm_b32 v65, v49, v48, s46
v_perm_b32 v69, v49, v48, s47
s_mov_b32 s20, 83968
buffer_load_ushort v48, v2, s[12:15], s20 offen
s_mov_b32 s21, 85120
buffer_load_ushort v49, v2, s[12:15], s21 offen
s_waitcnt vmcnt(54)
v_perm_b32 v66, v51, v50, s46
v_perm_b32 v70, v51, v50, s47
s_mov_b32 s20, 77056
buffer_load_ushort v50, v2, s[12:15], s20 offen
s_mov_b32 s21, 78208
buffer_load_ushort v51, v2, s[12:15], s21 offen
s_waitcnt vmcnt(54)
v_perm_b32 v67, v53, v52, s46
ds_write_b128 v3, v[64:67] offset:29696
s_waitcnt lgkmcnt(0)
v_perm_b32 v71, v53, v52, s47
ds_write_b128 v3, v[68:71] offset:31744
s_waitcnt lgkmcnt(0)
s_mov_b32 s20, 86272
buffer_load_ushort v52, v2, s[12:15], s20 offen
s_mov_b32 s21, 87424
buffer_load_ushort v53, v2, s[12:15], s21 offen
s_waitcnt vmcnt(54)
v_perm_b32 v64, v55, v54, s46
v_accvgpr_write_b32 a224, v64
v_perm_b32 v68, v55, v54, s47
v_accvgpr_write_b32 a232, v68
s_barrier
s_mov_b32 s20, 111616
buffer_load_ushort v54, v2, s[12:15], s20 offen
s_mov_b32 s21, 112768
buffer_load_ushort v55, v2, s[12:15], s21 offen
s_waitcnt vmcnt(54)
v_perm_b32 v65, v57, v56, s46
v_accvgpr_write_b32 a225, v65
v_perm_b32 v69, v57, v56, s47
v_accvgpr_write_b32 a233, v69
s_mov_b32 s20, 120832
buffer_load_ushort v56, v2, s[12:15], s20 offen
s_mov_b32 s21, 121984
buffer_load_ushort v57, v2, s[12:15], s21 offen
s_waitcnt vmcnt(54)
v_perm_b32 v66, v59, v58, s46
v_accvgpr_write_b32 a226, v66
v_perm_b32 v70, v59, v58, s47
v_accvgpr_write_b32 a234, v70
s_mov_b32 s20, 113920
buffer_load_ushort v58, v2, s[12:15], s20 offen
s_mov_b32 s21, 115072
buffer_load_ushort v59, v2, s[12:15], s21 offen
s_waitcnt vmcnt(54)
v_perm_b32 v67, v61, v60, s46
v_accvgpr_write_b32 a227, v67
v_perm_b32 v71, v61, v60, s47
v_accvgpr_write_b32 a235, v71
s_mov_b32 s20, 123136
buffer_load_ushort v60, v2, s[12:15], s20 offen
s_mov_b32 s21, 124288
buffer_load_ushort v61, v2, s[12:15], s21 offen
s_waitcnt vmcnt(54)
v_perm_b32 v64, v7, v6, s46
v_accvgpr_write_b32 a228, v64
v_perm_b32 v68, v7, v6, s47
v_accvgpr_write_b32 a236, v68
s_barrier
s_mov_b32 s12, s88
s_and_b32 s13, s89, 0xffff
s_mov_b32 s14, 4718592
s_mov_b32 s15, 0x20000
s_mov_b32 s20, 0
buffer_load_dword v6, v1, s[12:15], s20 offen
s_mov_b32 s21, 32768
buffer_load_dword v7, v1, s[12:15], s21 offen
s_waitcnt vmcnt(54)
v_perm_b32 v65, v9, v8, s46
v_accvgpr_write_b32 a229, v65
v_perm_b32 v69, v9, v8, s47
v_accvgpr_write_b32 a237, v69
s_mov_b32 s20, 65536
buffer_load_dword v8, v1, s[12:15], s20 offen
s_mov_b32 s21, 98304
buffer_load_dword v9, v1, s[12:15], s21 offen
s_waitcnt vmcnt(54)
v_perm_b32 v66, v11, v10, s46
v_accvgpr_write_b32 a230, v66
v_perm_b32 v70, v11, v10, s47
v_accvgpr_write_b32 a238, v70
s_mov_b32 s20, 8192
buffer_load_dword v10, v1, s[12:15], s20 offen
s_mov_b32 s21, 40960
buffer_load_dword v11, v1, s[12:15], s21 offen
s_waitcnt vmcnt(54)
v_perm_b32 v67, v13, v12, s46
v_accvgpr_write_b32 a231, v67
v_perm_b32 v71, v13, v12, s47
v_accvgpr_write_b32 a239, v71
s_mov_b32 s20, 73728
buffer_load_dword v12, v1, s[12:15], s20 offen
s_mov_b32 s21, 106496
buffer_load_dword v13, v1, s[12:15], s21 offen
s_waitcnt vmcnt(54)
v_perm_b32 v64, v15, v14, s46
v_perm_b32 v68, v15, v14, s47
v_accvgpr_write_b32 a240, v68
s_barrier
s_mov_b32 s20, 262144
buffer_load_dword v14, v1, s[12:15], s20 offen
s_mov_b32 s21, 294912
buffer_load_dword v15, v1, s[12:15], s21 offen
s_waitcnt vmcnt(54)
v_perm_b32 v65, v17, v16, s46
v_perm_b32 v69, v17, v16, s47
v_accvgpr_write_b32 a241, v69
s_mov_b32 s20, 327680
buffer_load_dword v16, v1, s[12:15], s20 offen
s_mov_b32 s21, 360448
buffer_load_dword v17, v1, s[12:15], s21 offen
s_waitcnt vmcnt(54)
v_perm_b32 v66, v19, v18, s46
v_perm_b32 v70, v19, v18, s47
v_accvgpr_write_b32 a242, v70
s_mov_b32 s20, 270336
buffer_load_dword v18, v1, s[12:15], s20 offen
s_mov_b32 s21, 303104
buffer_load_dword v19, v1, s[12:15], s21 offen
s_waitcnt vmcnt(54)
v_perm_b32 v67, v21, v20, s46
ds_write_b128 v3, v[64:67] offset:32768
s_waitcnt lgkmcnt(0)
v_perm_b32 v71, v21, v20, s47
v_accvgpr_write_b32 a243, v71
s_mov_b32 s20, 335872
buffer_load_dword v20, v1, s[12:15], s20 offen
s_mov_b32 s21, 368640
buffer_load_dword v21, v1, s[12:15], s21 offen
s_waitcnt vmcnt(54)
v_perm_b32 v64, v23, v22, s46
v_perm_b32 v68, v23, v22, s47
v_accvgpr_write_b32 a244, v68
s_barrier
s_mov_b32 s20, 524288
buffer_load_dword v22, v1, s[12:15], s20 offen
s_mov_b32 s21, 557056
buffer_load_dword v23, v1, s[12:15], s21 offen
s_waitcnt vmcnt(54)
v_perm_b32 v65, v25, v24, s46
v_perm_b32 v69, v25, v24, s47
v_accvgpr_write_b32 a245, v69
s_mov_b32 s20, 589824
buffer_load_dword v24, v1, s[12:15], s20 offen
s_mov_b32 s21, 622592
buffer_load_dword v25, v1, s[12:15], s21 offen
s_waitcnt vmcnt(54)
v_perm_b32 v66, v27, v26, s46
v_perm_b32 v70, v27, v26, s47
v_accvgpr_write_b32 a246, v70
s_mov_b32 s20, 532480
buffer_load_dword v26, v1, s[12:15], s20 offen
s_mov_b32 s21, 565248
buffer_load_dword v27, v1, s[12:15], s21 offen
s_waitcnt vmcnt(54)
v_perm_b32 v67, v29, v28, s46
ds_write_b128 v3, v[64:67] offset:33792
s_waitcnt lgkmcnt(0)
v_perm_b32 v71, v29, v28, s47
v_accvgpr_write_b32 a247, v71
s_mov_b32 s20, 598016
buffer_load_dword v28, v1, s[12:15], s20 offen
s_mov_b32 s21, 630784
buffer_load_dword v29, v1, s[12:15], s21 offen
s_waitcnt vmcnt(54)
v_perm_b32 v64, v31, v30, s46
v_accvgpr_write_b32 a248, v64
s_barrier
s_mov_b32 s20, 786432
buffer_load_dword v30, v1, s[12:15], s20 offen
s_mov_b32 s21, 819200
buffer_load_dword v31, v1, s[12:15], s21 offen
s_waitcnt vmcnt(54)
v_perm_b32 v65, v33, v32, s46
v_accvgpr_write_b32 a249, v65
s_mov_b32 s20, 851968
buffer_load_dword v32, v1, s[12:15], s20 offen
s_mov_b32 s21, 884736
buffer_load_dword v33, v1, s[12:15], s21 offen
s_waitcnt vmcnt(54)
v_perm_b32 v66, v35, v34, s46
v_accvgpr_write_b32 a250, v66
s_mov_b32 s20, 794624
buffer_load_dword v34, v1, s[12:15], s20 offen
s_mov_b32 s21, 827392
buffer_load_dword v35, v1, s[12:15], s21 offen
s_waitcnt vmcnt(54)
v_perm_b32 v67, v37, v36, s46
v_accvgpr_write_b32 a251, v67
s_mov_b32 s20, 860160
buffer_load_dword v36, v1, s[12:15], s20 offen
s_mov_b32 s21, 892928
buffer_load_dword v37, v1, s[12:15], s21 offen
s_waitcnt vmcnt(54)
v_perm_b32 v64, v39, v38, s46
v_accvgpr_write_b32 a252, v64
s_barrier
s_mov_b32 s20, 1048576
buffer_load_dword v38, v1, s[12:15], s20 offen
s_mov_b32 s21, 1081344
buffer_load_dword v39, v1, s[12:15], s21 offen
s_waitcnt vmcnt(54)
v_perm_b32 v65, v41, v40, s46
v_accvgpr_write_b32 a253, v65
s_mov_b32 s20, 1114112
buffer_load_dword v40, v1, s[12:15], s20 offen
s_mov_b32 s21, 1146880
buffer_load_dword v41, v1, s[12:15], s21 offen
s_waitcnt vmcnt(54)
v_perm_b32 v66, v43, v42, s46
v_accvgpr_write_b32 a254, v66
s_mov_b32 s20, 1056768
buffer_load_dword v42, v1, s[12:15], s20 offen
s_mov_b32 s21, 1089536
buffer_load_dword v43, v1, s[12:15], s21 offen
s_waitcnt vmcnt(54)
v_perm_b32 v67, v45, v44, s46
v_accvgpr_write_b32 a255, v67
s_mov_b32 s20, 1122304
buffer_load_dword v44, v1, s[12:15], s20 offen
s_mov_b32 s21, 1155072
buffer_load_dword v45, v1, s[12:15], s21 offen
s_waitcnt vmcnt(54)
v_perm_b32 v64, v47, v46, s46
s_barrier
s_mov_b32 s20, 1310720
buffer_load_dword v46, v1, s[12:15], s20 offen
s_mov_b32 s21, 1343488
buffer_load_dword v47, v1, s[12:15], s21 offen
s_waitcnt vmcnt(54)
v_perm_b32 v65, v49, v48, s46
s_mov_b32 s20, 1376256
buffer_load_dword v48, v1, s[12:15], s20 offen
s_mov_b32 s21, 1409024
buffer_load_dword v49, v1, s[12:15], s21 offen
s_waitcnt vmcnt(54)
v_perm_b32 v66, v51, v50, s46
s_mov_b32 s20, 1318912
buffer_load_dword v50, v1, s[12:15], s20 offen
s_mov_b32 s21, 1351680
buffer_load_dword v51, v1, s[12:15], s21 offen
s_waitcnt vmcnt(54)
v_perm_b32 v67, v53, v52, s46
ds_write_b128 v3, v[64:67] offset:18432
s_waitcnt lgkmcnt(0)
s_mov_b32 s20, 1384448
buffer_load_dword v52, v1, s[12:15], s20 offen
s_mov_b32 s21, 1417216
buffer_load_dword v53, v1, s[12:15], s21 offen
s_waitcnt vmcnt(54)
v_perm_b32 v64, v55, v54, s46
s_barrier
s_mov_b32 s20, 1572864
buffer_load_dword v54, v1, s[12:15], s20 offen
s_mov_b32 s21, 1605632
buffer_load_dword v55, v1, s[12:15], s21 offen
s_waitcnt vmcnt(54)
v_perm_b32 v65, v57, v56, s46
s_mov_b32 s20, 1638400
buffer_load_dword v56, v1, s[12:15], s20 offen
s_mov_b32 s21, 1671168
buffer_load_dword v57, v1, s[12:15], s21 offen
s_waitcnt vmcnt(54)
v_perm_b32 v66, v59, v58, s46
s_mov_b32 s20, 1581056
buffer_load_dword v58, v1, s[12:15], s20 offen
s_mov_b32 s21, 1613824
buffer_load_dword v59, v1, s[12:15], s21 offen
s_waitcnt vmcnt(54)
v_perm_b32 v67, v61, v60, s46
ds_write_b128 v3, v[64:67] offset:19456
s_waitcnt lgkmcnt(0)
s_mov_b32 s20, 1646592
buffer_load_dword v60, v1, s[12:15], s20 offen
s_mov_b32 s21, 1679360
buffer_load_dword v61, v1, s[12:15], s21 offen
s_waitcnt vmcnt(54)
v_perm_b32 v72, v7, v6, s46
v_perm_b32 v80, v7, v6, s47
s_barrier
s_mov_b32 s20, 1835008
buffer_load_dword v6, v1, s[12:15], s20 offen
s_mov_b32 s21, 1867776
buffer_load_dword v7, v1, s[12:15], s21 offen
s_waitcnt vmcnt(54)
v_perm_b32 v73, v9, v8, s46
v_perm_b32 v81, v9, v8, s47
s_mov_b32 s20, 1900544
buffer_load_dword v8, v1, s[12:15], s20 offen
s_mov_b32 s21, 1933312
buffer_load_dword v9, v1, s[12:15], s21 offen
s_waitcnt vmcnt(54)
v_perm_b32 v74, v11, v10, s46
v_perm_b32 v82, v11, v10, s47
s_mov_b32 s20, 1843200
buffer_load_dword v10, v1, s[12:15], s20 offen
s_mov_b32 s21, 1875968
buffer_load_dword v11, v1, s[12:15], s21 offen
s_waitcnt vmcnt(54)
v_perm_b32 v75, v13, v12, s46
v_perm_b32 v83, v13, v12, s47
s_mov_b32 s20, 1908736
buffer_load_dword v12, v1, s[12:15], s20 offen
s_mov_b32 s21, 1941504
buffer_load_dword v13, v1, s[12:15], s21 offen
s_waitcnt vmcnt(54)
v_perm_b32 v76, v15, v14, s46
v_perm_b32 v84, v15, v14, s47
s_barrier
s_mov_b32 s20, 2097152
buffer_load_dword v14, v1, s[12:15], s20 offen
s_mov_b32 s21, 2129920
buffer_load_dword v15, v1, s[12:15], s21 offen
s_waitcnt vmcnt(54)
v_perm_b32 v77, v17, v16, s46
v_perm_b32 v85, v17, v16, s47
s_mov_b32 s20, 2162688
buffer_load_dword v16, v1, s[12:15], s20 offen
s_mov_b32 s21, 2195456
buffer_load_dword v17, v1, s[12:15], s21 offen
s_waitcnt vmcnt(54)
v_perm_b32 v78, v19, v18, s46
v_perm_b32 v86, v19, v18, s47
s_mov_b32 s20, 2105344
buffer_load_dword v18, v1, s[12:15], s20 offen
s_mov_b32 s21, 2138112
buffer_load_dword v19, v1, s[12:15], s21 offen
s_waitcnt vmcnt(54)
v_perm_b32 v79, v21, v20, s46
v_perm_b32 v87, v21, v20, s47
s_mov_b32 s20, 2170880
buffer_load_dword v20, v1, s[12:15], s20 offen
s_mov_b32 s21, 2203648
buffer_load_dword v21, v1, s[12:15], s21 offen
s_waitcnt vmcnt(54)
v_perm_b32 v96, v23, v22, s46
v_perm_b32 v104, v23, v22, s47
s_barrier
s_mov_b32 s20, 2359296
buffer_load_dword v22, v1, s[12:15], s20 offen
s_mov_b32 s21, 2392064
buffer_load_dword v23, v1, s[12:15], s21 offen
s_waitcnt vmcnt(54)
v_perm_b32 v97, v25, v24, s46
v_perm_b32 v105, v25, v24, s47
s_mov_b32 s20, 2424832
buffer_load_dword v24, v1, s[12:15], s20 offen
s_mov_b32 s21, 2457600
buffer_load_dword v25, v1, s[12:15], s21 offen
s_waitcnt vmcnt(54)
v_perm_b32 v98, v27, v26, s46
v_perm_b32 v106, v27, v26, s47
s_mov_b32 s20, 2367488
buffer_load_dword v26, v1, s[12:15], s20 offen
s_mov_b32 s21, 2400256
buffer_load_dword v27, v1, s[12:15], s21 offen
s_waitcnt vmcnt(54)
v_perm_b32 v99, v29, v28, s46
v_perm_b32 v107, v29, v28, s47
s_mov_b32 s20, 2433024
buffer_load_dword v28, v1, s[12:15], s20 offen
s_mov_b32 s21, 2465792
buffer_load_dword v29, v1, s[12:15], s21 offen
s_waitcnt vmcnt(54)
v_perm_b32 v100, v31, v30, s46
v_perm_b32 v108, v31, v30, s47
s_barrier
s_mov_b32 s20, 2621440
buffer_load_dword v30, v1, s[12:15], s20 offen
s_mov_b32 s21, 2654208
buffer_load_dword v31, v1, s[12:15], s21 offen
s_waitcnt vmcnt(54)
v_perm_b32 v101, v33, v32, s46
v_perm_b32 v109, v33, v32, s47
s_mov_b32 s20, 2686976
buffer_load_dword v32, v1, s[12:15], s20 offen
s_mov_b32 s21, 2719744
buffer_load_dword v33, v1, s[12:15], s21 offen
s_waitcnt vmcnt(54)
v_perm_b32 v102, v35, v34, s46
v_perm_b32 v110, v35, v34, s47
s_mov_b32 s20, 2629632
buffer_load_dword v34, v1, s[12:15], s20 offen
s_mov_b32 s21, 2662400
buffer_load_dword v35, v1, s[12:15], s21 offen
s_waitcnt vmcnt(54)
v_perm_b32 v103, v37, v36, s46
v_perm_b32 v111, v37, v36, s47
s_mov_b32 s20, 2695168
buffer_load_dword v36, v1, s[12:15], s20 offen
s_mov_b32 s21, 2727936
buffer_load_dword v37, v1, s[12:15], s21 offen
s_waitcnt vmcnt(54)
v_perm_b32 v120, v39, v38, s46
v_perm_b32 v128, v39, v38, s47
s_barrier
s_mov_b32 s20, 2883584
buffer_load_dword v38, v1, s[12:15], s20 offen
s_mov_b32 s21, 2916352
buffer_load_dword v39, v1, s[12:15], s21 offen
s_waitcnt vmcnt(54)
v_perm_b32 v121, v41, v40, s46
v_perm_b32 v129, v41, v40, s47
s_mov_b32 s20, 2949120
buffer_load_dword v40, v1, s[12:15], s20 offen
s_mov_b32 s21, 2981888
buffer_load_dword v41, v1, s[12:15], s21 offen
s_waitcnt vmcnt(54)
v_perm_b32 v122, v43, v42, s46
v_perm_b32 v130, v43, v42, s47
s_mov_b32 s20, 2891776
buffer_load_dword v42, v1, s[12:15], s20 offen
s_mov_b32 s21, 2924544
buffer_load_dword v43, v1, s[12:15], s21 offen
s_waitcnt vmcnt(54)
v_perm_b32 v123, v45, v44, s46
v_perm_b32 v131, v45, v44, s47
s_mov_b32 s20, 2957312
buffer_load_dword v44, v1, s[12:15], s20 offen
s_mov_b32 s21, 2990080
buffer_load_dword v45, v1, s[12:15], s21 offen
s_waitcnt vmcnt(54)
v_perm_b32 v124, v47, v46, s46
v_perm_b32 v132, v47, v46, s47
s_barrier
s_mov_b32 s20, 3145728
buffer_load_dword v46, v1, s[12:15], s20 offen
s_mov_b32 s21, 3178496
buffer_load_dword v47, v1, s[12:15], s21 offen
s_waitcnt vmcnt(54)
v_perm_b32 v125, v49, v48, s46
v_perm_b32 v133, v49, v48, s47
s_mov_b32 s20, 3211264
buffer_load_dword v48, v1, s[12:15], s20 offen
s_mov_b32 s21, 3244032
buffer_load_dword v49, v1, s[12:15], s21 offen
s_waitcnt vmcnt(54)
v_perm_b32 v126, v51, v50, s46
v_perm_b32 v134, v51, v50, s47
s_mov_b32 s20, 3153920
buffer_load_dword v50, v1, s[12:15], s20 offen
s_mov_b32 s21, 3186688
buffer_load_dword v51, v1, s[12:15], s21 offen
s_waitcnt vmcnt(54)
v_perm_b32 v127, v53, v52, s46
v_perm_b32 v135, v53, v52, s47
s_mov_b32 s20, 3219456
buffer_load_dword v52, v1, s[12:15], s20 offen
s_mov_b32 s21, 3252224
buffer_load_dword v53, v1, s[12:15], s21 offen
s_waitcnt vmcnt(54)
v_perm_b32 v144, v55, v54, s46
v_perm_b32 v152, v55, v54, s47
s_barrier
s_mov_b32 s20, 3407872
buffer_load_dword v54, v1, s[12:15], s20 offen
s_mov_b32 s21, 3440640
buffer_load_dword v55, v1, s[12:15], s21 offen
s_waitcnt vmcnt(54)
v_perm_b32 v145, v57, v56, s46
v_perm_b32 v153, v57, v56, s47
s_mov_b32 s20, 3473408
buffer_load_dword v56, v1, s[12:15], s20 offen
s_mov_b32 s21, 3506176
buffer_load_dword v57, v1, s[12:15], s21 offen
s_waitcnt vmcnt(54)
v_perm_b32 v146, v59, v58, s46
v_perm_b32 v154, v59, v58, s47
s_mov_b32 s20, 3416064
buffer_load_dword v58, v1, s[12:15], s20 offen
s_mov_b32 s21, 3448832
buffer_load_dword v59, v1, s[12:15], s21 offen
s_waitcnt vmcnt(54)
v_perm_b32 v147, v61, v60, s46
v_perm_b32 v155, v61, v60, s47
s_mov_b32 s20, 3481600
buffer_load_dword v60, v1, s[12:15], s20 offen
s_mov_b32 s21, 3514368
buffer_load_dword v61, v1, s[12:15], s21 offen
s_waitcnt vmcnt(54)
v_perm_b32 v148, v7, v6, s46
v_perm_b32 v156, v7, v6, s47
s_barrier
s_mov_b32 s20, 3670016
buffer_load_dword v6, v1, s[12:15], s20 offen
s_mov_b32 s21, 3702784
buffer_load_dword v7, v1, s[12:15], s21 offen
s_waitcnt vmcnt(54)
v_perm_b32 v149, v9, v8, s46
v_perm_b32 v157, v9, v8, s47
s_mov_b32 s20, 3735552
buffer_load_dword v8, v1, s[12:15], s20 offen
s_mov_b32 s21, 3768320
buffer_load_dword v9, v1, s[12:15], s21 offen
s_waitcnt vmcnt(54)
v_perm_b32 v150, v11, v10, s46
v_perm_b32 v158, v11, v10, s47
s_mov_b32 s20, 3678208
buffer_load_dword v10, v1, s[12:15], s20 offen
s_mov_b32 s21, 3710976
buffer_load_dword v11, v1, s[12:15], s21 offen
s_waitcnt vmcnt(54)
v_perm_b32 v151, v13, v12, s46
v_perm_b32 v159, v13, v12, s47
s_mov_b32 s20, 3743744
buffer_load_dword v12, v1, s[12:15], s20 offen
s_mov_b32 s21, 3776512
buffer_load_dword v13, v1, s[12:15], s21 offen
s_waitcnt vmcnt(54)
v_perm_b32 v168, v15, v14, s46
v_perm_b32 v176, v15, v14, s47
s_barrier
s_mov_b32 s20, 3932160
buffer_load_dword v14, v1, s[12:15], s20 offen
s_mov_b32 s21, 3964928
buffer_load_dword v15, v1, s[12:15], s21 offen
s_waitcnt vmcnt(54)
v_perm_b32 v169, v17, v16, s46
v_perm_b32 v177, v17, v16, s47
s_mov_b32 s20, 3997696
buffer_load_dword v16, v1, s[12:15], s20 offen
s_mov_b32 s21, 4030464
buffer_load_dword v17, v1, s[12:15], s21 offen
s_waitcnt vmcnt(54)
v_perm_b32 v170, v19, v18, s46
v_perm_b32 v178, v19, v18, s47
s_mov_b32 s20, 3940352
buffer_load_dword v18, v1, s[12:15], s20 offen
s_mov_b32 s21, 3973120
buffer_load_dword v19, v1, s[12:15], s21 offen
s_waitcnt vmcnt(54)
v_perm_b32 v171, v21, v20, s46
v_perm_b32 v179, v21, v20, s47
s_mov_b32 s20, 4005888
buffer_load_dword v20, v1, s[12:15], s20 offen
s_mov_b32 s21, 4038656
buffer_load_dword v21, v1, s[12:15], s21 offen
s_waitcnt vmcnt(54)
v_perm_b32 v172, v23, v22, s46
v_perm_b32 v180, v23, v22, s47
s_barrier
s_mov_b32 s20, 4194304
buffer_load_dword v22, v1, s[12:15], s20 offen
s_mov_b32 s21, 4227072
buffer_load_dword v23, v1, s[12:15], s21 offen
s_waitcnt vmcnt(54)
v_perm_b32 v173, v25, v24, s46
v_perm_b32 v181, v25, v24, s47
s_mov_b32 s20, 4259840
buffer_load_dword v24, v1, s[12:15], s20 offen
s_mov_b32 s21, 4292608
buffer_load_dword v25, v1, s[12:15], s21 offen
s_waitcnt vmcnt(54)
v_perm_b32 v174, v27, v26, s46
v_perm_b32 v182, v27, v26, s47
s_mov_b32 s20, 4202496
buffer_load_dword v26, v1, s[12:15], s20 offen
s_mov_b32 s21, 4235264
buffer_load_dword v27, v1, s[12:15], s21 offen
s_waitcnt vmcnt(54)
v_perm_b32 v175, v29, v28, s46
v_perm_b32 v183, v29, v28, s47
s_mov_b32 s20, 4268032
buffer_load_dword v28, v1, s[12:15], s20 offen
s_mov_b32 s21, 4300800
buffer_load_dword v29, v1, s[12:15], s21 offen
s_waitcnt vmcnt(54)
v_perm_b32 v192, v31, v30, s46
v_perm_b32 v200, v31, v30, s47
s_barrier
s_mov_b32 s20, 4456448
buffer_load_dword v30, v1, s[12:15], s20 offen
s_mov_b32 s21, 4489216
buffer_load_dword v31, v1, s[12:15], s21 offen
s_waitcnt vmcnt(54)
v_perm_b32 v193, v33, v32, s46
v_perm_b32 v201, v33, v32, s47
s_mov_b32 s20, 4521984
buffer_load_dword v32, v1, s[12:15], s20 offen
s_mov_b32 s21, 4554752
buffer_load_dword v33, v1, s[12:15], s21 offen
s_waitcnt vmcnt(54)
v_perm_b32 v194, v35, v34, s46
v_perm_b32 v202, v35, v34, s47
s_mov_b32 s20, 4464640
buffer_load_dword v34, v1, s[12:15], s20 offen
s_mov_b32 s21, 4497408
buffer_load_dword v35, v1, s[12:15], s21 offen
s_waitcnt vmcnt(54)
v_perm_b32 v195, v37, v36, s46
v_perm_b32 v203, v37, v36, s47
s_mov_b32 s20, 4530176
buffer_load_dword v36, v1, s[12:15], s20 offen
s_mov_b32 s21, 4562944
buffer_load_dword v37, v1, s[12:15], s21 offen
s_waitcnt vmcnt(54)
v_perm_b32 v196, v39, v38, s46
v_perm_b32 v204, v39, v38, s47
s_waitcnt vmcnt(52)
v_perm_b32 v197, v41, v40, s46
v_perm_b32 v205, v41, v40, s47
s_waitcnt vmcnt(50)
v_perm_b32 v198, v43, v42, s46
v_perm_b32 v206, v43, v42, s47
s_waitcnt vmcnt(48)
v_perm_b32 v199, v45, v44, s46
v_perm_b32 v207, v45, v44, s47
s_waitcnt vmcnt(46)
v_perm_b32 v216, v47, v46, s46
v_perm_b32 v224, v47, v46, s47
s_waitcnt vmcnt(44)
v_perm_b32 v217, v49, v48, s46
v_perm_b32 v225, v49, v48, s47
s_waitcnt vmcnt(42)
v_perm_b32 v218, v51, v50, s46
v_perm_b32 v226, v51, v50, s47
s_waitcnt vmcnt(40)
v_perm_b32 v219, v53, v52, s46
v_perm_b32 v227, v53, v52, s47
s_waitcnt vmcnt(38)
v_perm_b32 v220, v55, v54, s46
v_perm_b32 v228, v55, v54, s47
s_waitcnt vmcnt(36)
v_perm_b32 v221, v57, v56, s46
v_perm_b32 v229, v57, v56, s47
s_waitcnt vmcnt(34)
v_perm_b32 v222, v59, v58, s46
v_perm_b32 v230, v59, v58, s47
s_waitcnt vmcnt(32)
v_perm_b32 v223, v61, v60, s46
v_perm_b32 v231, v61, v60, s47
s_waitcnt vmcnt(30)
v_perm_b32 v240, v7, v6, s46
v_perm_b32 v248, v7, v6, s47
s_waitcnt vmcnt(28)
v_perm_b32 v241, v9, v8, s46
v_perm_b32 v249, v9, v8, s47
s_waitcnt vmcnt(26)
v_perm_b32 v242, v11, v10, s46
v_perm_b32 v250, v11, v10, s47
s_waitcnt vmcnt(24)
v_perm_b32 v243, v13, v12, s46
v_perm_b32 v251, v13, v12, s47
s_waitcnt vmcnt(22)
v_perm_b32 v244, v15, v14, s46
v_perm_b32 v252, v15, v14, s47
s_waitcnt vmcnt(20)
v_perm_b32 v245, v17, v16, s46
v_perm_b32 v253, v17, v16, s47
s_waitcnt vmcnt(18)
v_perm_b32 v246, v19, v18, s46
v_perm_b32 v254, v19, v18, s47
s_waitcnt vmcnt(16)
v_perm_b32 v247, v21, v20, s46
v_perm_b32 v255, v21, v20, s47
s_waitcnt vmcnt(14)
v_perm_b32 v64, v23, v22, s46
v_accvgpr_write_b32 a8, v64
v_perm_b32 v68, v23, v22, s47
v_accvgpr_write_b32 a16, v68
s_waitcnt vmcnt(12)
v_perm_b32 v65, v25, v24, s46
v_accvgpr_write_b32 a9, v65
v_perm_b32 v69, v25, v24, s47
v_accvgpr_write_b32 a17, v69
s_waitcnt vmcnt(10)
v_perm_b32 v66, v27, v26, s46
v_accvgpr_write_b32 a10, v66
v_perm_b32 v70, v27, v26, s47
v_accvgpr_write_b32 a18, v70
s_waitcnt vmcnt(8)
v_perm_b32 v67, v29, v28, s46
v_accvgpr_write_b32 a11, v67
v_perm_b32 v71, v29, v28, s47
v_accvgpr_write_b32 a19, v71
s_waitcnt vmcnt(6)
v_perm_b32 v64, v31, v30, s46
v_accvgpr_write_b32 a12, v64
v_perm_b32 v68, v31, v30, s47
v_accvgpr_write_b32 a20, v68
s_waitcnt vmcnt(4)
v_perm_b32 v65, v33, v32, s46
v_accvgpr_write_b32 a13, v65
v_perm_b32 v69, v33, v32, s47
v_accvgpr_write_b32 a21, v69
s_waitcnt vmcnt(2)
v_perm_b32 v66, v35, v34, s46
v_accvgpr_write_b32 a14, v66
v_perm_b32 v70, v35, v34, s47
v_accvgpr_write_b32 a22, v70
s_waitcnt vmcnt(0)
v_perm_b32 v67, v37, v36, s46
v_accvgpr_write_b32 a15, v67
v_perm_b32 v71, v37, v36, s47
v_accvgpr_write_b32 a23, v71
v_mov_b32 v12, v0
v_and_b32 v13, 15, v0
v_bfe_u32 v14, v0, 4, 2
v_lshlrev_b32 v1, 4, v12
v_and_b32 v2, 0x3f0, v1
s_mul_i32 s20, s17, 34816
s_add_u32 s20, s20, 24576
v_add_u32 v2, s20, v2
v_and_b32 v15, 1, v12
v_mul_u32_u24 v0, 0xaaaa, v15
v_add_u32 v0, 0xffff4444, v0
v_lshrrev_b32 v18, 2, v13
v_lshl_add_u32 v18, v18, 1, v15
v_bfe_u32 v19, v13, 1, 1
v_lshrrev_b32 v16, 5, v12
v_lshlrev_b32 v16, 8, v16
v_lshl_add_u32 v16, v18, 5, v16
v_and_b32 v17, 1, v14
v_lshl_add_u32 v16, v17, 4, v16
v_and_b32 v17, 0x7f, v16
v_xor_b32 v17, 16, v17
v_add_u32 v16, 4224, v16
v_add_u32 v17, 6272, v17
v_cmp_eq_u32 vcc, 1, v19
s_nop 1
v_cndmask_b32 v7, v17, v16, vcc
v_and_b32 v16, 1, v14
v_xor_b32 v16, v18, v16
v_and_b32 v17, 2, v14
v_lshlrev_b32 v17, 1, v17
v_xor_b32 v16, v16, v17
v_lshlrev_b32 v16, 4, v16
v_lshl_add_u32 v16, v14, 7, v16
v_mul_u32_u24 v17, 2176, v19
v_add_u32 v16, v16, v17
v_add_u32 v5, 0, v16
v_bfe_u32 v20, v13, 3, 1
v_bfe_u32 v21, v13, 1, 1
v_lshlrev_b32 v16, 1, v14
v_xor_b32 v16, v16, v21
v_lshlrev_b32 v17, 2, v20
v_xor_b32 v16, v16, v17
v_lshlrev_b32 v16, 4, v16
v_lshl_add_u32 v16, v20, 8, v16
v_lshl_add_u32 v16, v21, 7, v16
v_bfe_u32 v17, v13, 2, 1
v_lshl_add_u32 v16, v17, 3, v16
v_lshl_add_u32 v16, v15, 2, v16
s_lshl_b32 s20, s17, 9
s_add_u32 s20, s20, 0
v_add_u32 v4, s20, v16
v_xor_b32 v3, 16, v4
v_lshrrev_b32 v16, 4, v12
v_xor_b32 v17, s16, v16
v_lshlrev_b32 v16, 12, v16
v_lshl_add_u32 v16, v17, 7, v16
v_lshl_add_u32 v9, v13, 3, v16
s_lshr_b32 s20, s17, 1
s_lshl_b32 s20, s20, 2
v_add_u32 v16, s20, v14
v_xor_b32 v17, s16, v16
v_lshlrev_b32 v16, 12, v16
v_lshl_add_u32 v16, v17, 7, v16
v_lshl_add_u32 v16, v13, 2, v16
s_and_b32 s20, s17, 1
s_lshl_b32 s20, s20, 6
s_add_u32 s20, s20, 262144
v_add_u32 v10, s20, v16
v_bfe_u32 v16, v13, 2, 1
v_lshlrev_b32 v16, 5, v16
v_and_b32 v17, 1, v14
v_lshl_add_u32 v16, v17, 8, v16
v_lshrrev_b32 v17, 1, v14
v_lshl_add_u32 v16, v17, 4, v16
v_and_b32 v17, 3, v13
v_lshl_add_u32 v11, v17, 2, v16
v_lshlrev_b32 v6, 7, v12
v_lshlrev_b32 v8, 2, v12
s_mov_b32 s36, 0x11111111
s_mov_b32 s37, 0x11111111
s_mov_b32 s38, 0x22222222
s_mov_b32 s39, 0x22222222
s_mov_b32 s40, 0x44444444
s_mov_b32 s41, 0x44444444
s_mov_b32 s42, 0x88888888
s_mov_b32 s43, 0x88888888
s_mov_b32 s44, 0xf0f0f0f0
s_mov_b32 s45, 0xf0f0f0f0
s_mov_b32 s18, 0x3e0293ee
s_lshl_b32 s20, s17, 5
s_add_u32 s20, s20, s16
s_cmp_lt_u32 s20, 72
s_cselect_b32 s48, 1, 0
s_lshl_b32 s23, s20, 12
s_lshl_b32 s21, s17, 10
s_sub_u32 s23, s23, s21
s_lshr_b32 s24, s20, 2
s_lshl_b32 s24, s24, 9
s_and_b32 s21, s20, 3
s_lshl_b32 s21, s21, 6
s_add_u32 s24, s24, s21
s_add_u32 s24, s24, 110100480
s_cmp_lt_u32 s20, 72
s_cselect_b32 s24, s24, 536870912
s_lshl_b32 s25, s16, 12
s_add_u32 s26, s25, 131072
s_add_u32 s27, s25, 262144
s_cmp_lt_u32 s16, 8
s_cselect_b32 s27, s27, 536870912
s_mov_b32 s28, 109051904
s_mov_b32 s29, 109346816
s_lshl_b32 s30, s16, 20
s_add_u32 s30, s30, 33554432
s_lshl_b32 s31, s16, 12
s_add_u32 s31, s31, 100663296
s_add_u32 s35, s24, 32768
s_mov_b32 s53, 0x3f803f80
s_mov_b32 s86, 0x33333333
s_mov_b32 s87, 0x33333333
s_lshl_b32 s84, s17, 13
s_sub_u32 s84, s20, s84
s_add_u32 s84, s84, 110886912
s_cmp_lt_u32 s20, 72
s_cselect_b32 s84, s84, 536870912
s_and_b32 s21, s16, 3
s_lshl_b32 s21, s21, 7
s_add_u32 s21, s21, 110886144
s_cmp_eq_u32 s17, 3
s_cselect_b32 s84, s21, s84
s_lshl_b32 s82, s16, 7
s_add_u32 s83, s82, 111152384
s_add_u32 s82, s82, 111148288
s_mov_b32 s19, 0
s_getpc_b64 s[4:5]
L_pc2:
s_mov_b32 s12, s4
s_and_b32 s13, s5, 0xffff
s_mov_b32 s14, L_end-L_pc2
s_mov_b32 s15, 0x20000
buffer_load_dword v40, v6, s[12:15], 0 offen
s_mul_i32 s20, s16, 18432
s_add_u32 s20, s20, 109051904
s_lshl_b32 s21, s16, 11
s_add_u32 s21, s21, 110075904
s_cmp_eq_u32 s17, 3
s_cselect_b32 s20, s21, s20
buffer_load_dword v41, v6, s[8:11], s20 offen sc1
s_load_dwordx2 s[50:51], s[0:1], 56
s_waitcnt lgkmcnt(0)
s_mov_b32 s12, s50
s_and_b32 s13, s51, 0xffff
s_mov_b32 s14, 9216
s_mov_b32 s15, 0x20000
v_bfe_u32 v64, v1, 5, 3
v_mul_u32_u24 v64, 1152, v64
v_lshrrev_b32 v65, 8, v1
v_lshl_add_u32 v64, v65, 5, v64
v_and_b32 v65, 16, v1
v_add_u32 v64, v64, v65
buffer_load_dwordx4 v[24:27], v64, s[12:15], 0 offen offset:0
buffer_load_dwordx4 v[28:31], v64, s[12:15], 0 offen offset:512
buffer_load_dwordx4 v[32:35], v64, s[12:15], 0 offen offset:1024
s_waitcnt vmcnt(0)
v_perm_b32 v12, v26, v24, s46
v_perm_b32 v13, v26, v24, s47
v_perm_b32 v14, v27, v25, s46
v_perm_b32 v15, v27, v25, s47
v_min_u32 v12, 0xfffeffff, v12
v_min_u32 v13, 0xfffeffff, v13
v_min_u32 v14, 0xfffeffff, v14
v_min_u32 v15, 0xfffeffff, v15
v_perm_b32 v16, v30, v28, s46
v_perm_b32 v17, v30, v28, s47
v_perm_b32 v18, v31, v29, s46
v_perm_b32 v19, v31, v29, s47
v_min_u32 v16, 0xfffeffff, v16
v_min_u32 v17, 0xfffeffff, v17
v_min_u32 v18, 0xfffeffff, v18
v_min_u32 v19, 0xfffeffff, v19
v_perm_b32 v20, v34, v32, s46
v_perm_b32 v21, v34, v32, s47
v_perm_b32 v22, v35, v33, s46
v_perm_b32 v23, v35, v33, s47
v_min_u32 v20, 0xfffeffff, v20
v_min_u32 v21, 0xfffeffff, v21
v_min_u32 v22, 0xfffeffff, v22
v_min_u32 v23, 0xfffeffff, v23
s_cmp_lg_u32 s17, 0
s_cbranch_scc1 L_m0_50
ds_write_b128 v1, v[20:23] offset:14848
v_mov_b32 v64, 6528
v_mov_b32 v56, 0
v_mov_b32 v57, 0
v_mov_b32 v58, 0
v_mov_b32 v59, 0
ds_write_b128 v64, v[56:59]
L_m0_50:
s_waitcnt lgkmcnt(0)
s_barrier
ds_read_b32 v20, v8 offset:14848
s_waitcnt lgkmcnt(0)
s_mov_b32 s33, 110100480
s_mov_b32 s6, 110100480
s_mov_b32 s7, 110100480
v_and_b32 v66, 16, v1
v_lshlrev_b32 v64, 2, v66
v_add_u32 v64, 64, v64
v_mul_u32_u24 v66, 3, v66
v_lshrrev_b32 v66, 1, v66
v_sub_u32 v66, 32, v66
s_mov_b32 s22, 0
L_poll_51:
buffer_load_dword v65, v64, s[56:59], 0 offen sc1
s_add_u32 s22, s22, 1
s_cmp_gt_u32 s22, 40000
s_cbranch_scc1 L_end
s_waitcnt vmcnt(0)
v_cmp_ne_u32 vcc, v66, v65
s_cbranch_vccz L_pd_52
s_sleep 1
s_branch L_poll_51
L_pd_52:
v_mov_b32 v64, 0
s_lshl_b32 s21, s16, 7
s_add_u32 s21, s21, 111149088
s_mov_b32 s22, 0
L_poll_53:
buffer_load_dword v65, v64, s[8:11], s21 offen sc1
s_add_u32 s22, s22, 1
s_cmp_gt_u32 s22, 40000
s_cbranch_scc1 L_end
s_waitcnt vmcnt(0)
v_cmp_ne_u32 vcc, 1, v65
s_cbranch_vccz L_pd_54
s_sleep 1
s_branch L_poll_53
L_pd_54:
s_mov_b32 s22, 0
s_cmp_eq_u32 s17, 0
s_cbranch_scc1 L_ent0
s_cmp_eq_u32 s17, 1
s_cbranch_scc1 L_ent1
s_cmp_eq_u32 s17, 2
s_cbranch_scc1 L_ent2
s_cmp_eq_u32 s17, 3
s_cbranch_scc1 L_ent3
s_branch L_end
L_ent0:
s_movk_i32 s4, -64
v_mov_b64 v[24:25], 0
v_mov_b64 v[26:27], 0
v_mov_b64 v[28:29], 0
v_mov_b64 v[30:31], 0
v_and_b32 v69, 0x380, v1
v_add_u32 v69, v69, v1
v_and_b32 v70, 0xf40, v1
v_add_u32 v70, v70, v1
v_bfe_u32 v71, v1, 7, 1
v_mad_i32_i24 v70, v71, s4, v70
v_mov_b64 v[64:65], -1
v_mov_b64 v[66:67], -1
v_xor_b32 v3, 16, v4
ds_read_b128 v[48:51], v2 offset:8192
ds_read_b128 v[52:55], v2 offset:9216
ds_read_b128 v[40:43], v2 offset:0
ds_read_b128 v[44:47], v2 offset:1024
v_mov_b64 v[32:33], 0
v_mov_b64 v[34:35], 0
v_mov_b64 v[36:37], 0
v_mov_b64 v[38:39], 0
v_mov_b64 v[56:57], 0
v_mov_b64 v[58:59], 0
v_mov_b64 v[60:61], 0
v_mov_b64 v[62:63], 0
s_add_u32 s20, s30, 0
s_add_u32 s21, s30, 8192
s_add_u32 s49, s29, s25
s_add_u32 s50, s29, s26
s_add_u32 s51, s29, s27
s_add_u32 s52, s30, 16384
s_mov_b32 m0, 15872
s_nop 0
buffer_load_dwordx4 v69, s[8:11], s20 offen sc1 lds
s_mov_b32 m0, 16768
s_nop 0
buffer_load_dwordx4 v69, s[8:11], s20 offen offset:128 sc1 lds
s_waitcnt vmcnt(0) lgkmcnt(0)
s_branch L_step0
L_gr0:
buffer_load_dwordx4 v[12:15], v1, s[8:11], s33 offen sc1
buffer_load_dword v20, v8, s[8:11], s7 offen sc1
buffer_load_dwordx4 v[16:19], v1, s[8:11], s6 offen sc1
s_add_u32 s22, s22, 1
s_cmp_gt_u32 s22, 40000
s_cbranch_scc1 L_end
buffer_load_dwordx4 v[16:19], v1, s[8:11], s6 offen sc1
v_mov_b64 v[24:25], 0
v_mov_b64 v[26:27], 0
v_mov_b64 v[28:29], 0
v_mov_b64 v[30:31], 0
v_mov_b64 v[32:33], 0
v_mov_b64 v[34:35], 0
v_mov_b64 v[36:37], 0
v_mov_b64 v[38:39], 0
v_mov_b64 v[56:57], 0
v_mov_b64 v[58:59], 0
v_mov_b64 v[60:61], 0
v_mov_b64 v[62:63], 0
s_waitcnt lgkmcnt(0)
s_branch L_step0
.p2align 3
L_gat0:
buffer_load_dwordx4 v[12:15], v1, s[8:11], s33 offen sc1
buffer_load_dword v20, v8, s[8:11], s7 offen sc1
buffer_load_dwordx4 v[16:19], v1, s[8:11], s6 offen sc1
s_add_u32 s20, s30, 0
s_add_u32 s21, s30, 8192
s_add_u32 s49, s29, s25
s_add_u32 s50, s29, s26
s_add_u32 s51, s29, s27
s_add_u32 s52, s30, 16384
s_mov_b32 m0, 15872
s_waitcnt vmcnt(4)
ds_read_b128 v[40:43], v2 offset:0
ds_read_b128 v[44:47], v2 offset:1024
v_mov_b64 v[32:33], 0
v_mov_b64 v[34:35], 0
v_mov_b64 v[36:37], 0
v_mov_b64 v[38:39], 0
v_mov_b64 v[56:57], 0
v_mov_b64 v[58:59], 0
v_mov_b64 v[60:61], 0
v_mov_b64 v[62:63], 0
s_nop 6
buffer_load_dwordx4 v[16:19], v1, s[8:11], s6 offen sc1
s_waitcnt lgkmcnt(0)
L_step0:
s_waitcnt vmcnt(3)
v_smfmac_f32_16x16x64_bf16 v[24:27], v[12:15], v[72:79], v0
ds_write_b128 v1, v[12:15] offset:6656
v_smfmac_f32_16x16x64_bf16 v[28:31], v[12:15], v[80:87], v0
s_waitcnt vmcnt(2)
v_max3_u32 v21, v12, v13, v14
v_max3_u32 v21, v21, v15, v20
v_cmp_le_u32 vcc, 0xffff0000, v21
v_smfmac_f32_16x16x64_bf16 v[32:35], v[12:15], v[88:95], v0
s_cbranch_vccnz L_gr0
s_waitcnt vmcnt(1)
v_max3_u32 v21, v16, v17, v18
v_max_u32 v21, v21, v19
v_cmp_le_u32 vcc, 0xffff0000, v21
ds_write_b32 v8, v20 offset:14848
v_smfmac_f32_16x16x64_bf16 v[56:59], v[12:15], a[32:39], v0
s_cbranch_vccnz L_g3r0
L_g30:
ds_write_b128 v1, v[16:19] offset:10752
v_smfmac_f32_16x16x64_bf16 v[60:63], v[12:15], a[40:47], v0
v_smfmac_f32_16x16x64_bf16 v[36:39], v[12:15], v[40:47], v0
v_smfmac_f32_16x16x64_bf16 v[24:27], v[16:19], v[168:175], v0
v_smfmac_f32_16x16x64_bf16 v[28:31], v[16:19], v[176:183], v0
s_waitcnt lgkmcnt(0)
s_barrier
ds_read_b128 v[20:23], v1 offset:7680
v_smfmac_f32_16x16x64_bf16 v[32:35], v[16:19], v[184:191], v0
ds_read_b128 v[12:15], v1 offset:8704
s_mov_b32 m0, 6272
buffer_store_dword v0, v11, s[8:11], s35 offen
v_smfmac_f32_16x16x64_bf16 v[56:59], v[16:19], a[96:103], v0
ds_read_b128 v[40:43], v2 offset:2048
buffer_store_dwordx4 v[64:67], v1, s[8:11], s49 offen
v_smfmac_f32_16x16x64_bf16 v[60:63], v[16:19], a[104:111], v0
ds_read_b128 v[44:47], v2 offset:3072
v_smfmac_f32_16x16x64_bf16 v[36:39], v[16:19], v[48:55], v0
s_waitcnt vmcnt(2)
ds_read_b128 v[16:19], v1 offset:9728
buffer_store_dwordx4 v[64:67], v1, s[8:11], s50 offen
s_waitcnt lgkmcnt(4)
v_smfmac_f32_16x16x64_bf16 v[24:27], v[20:23], v[96:103], v0
ds_read_b128 v[48:51], v2 offset:4096
v_smfmac_f32_16x16x64_bf16 v[28:31], v[20:23], v[104:111], v0
ds_read_b128 v[52:55], v2 offset:5120
buffer_store_dwordx4 v[64:67], v1, s[8:11], s51 offen
v_smfmac_f32_16x16x64_bf16 v[32:35], v[20:23], v[112:119], v0
s_waitcnt lgkmcnt(3)
v_smfmac_f32_16x16x64_bf16 v[36:39], v[20:23], v[40:47], v0
ds_read_b128 v[20:23], v1 offset:11776
buffer_load_dwordx4 v[64:67], v70, s[8:11], s21 offen sc1
v_smfmac_f32_16x16x64_bf16 v[24:27], v[12:15], v[120:127], v0
ds_read_b128 v[40:43], v2 offset:6144
v_smfmac_f32_16x16x64_bf16 v[28:31], v[12:15], v[128:135], v0
ds_read_b128 v[44:47], v2 offset:7168
buffer_load_dwordx4 v[68:71], v70, s[8:11], s21 offen offset:256 sc1
v_smfmac_f32_16x16x64_bf16 v[32:35], v[12:15], v[136:143], v0
s_waitcnt lgkmcnt(3)
v_smfmac_f32_16x16x64_bf16 v[36:39], v[12:15], v[48:55], v0
ds_read_b128 v[12:15], v1 offset:12800
v_smfmac_f32_16x16x64_bf16 v[24:27], v[16:19], v[144:151], v0
ds_read_b128 v[48:51], v2 offset:10240
v_smfmac_f32_16x16x64_bf16 v[28:31], v[16:19], v[152:159], v0
ds_read_b128 v[52:55], v2 offset:11264
v_smfmac_f32_16x16x64_bf16 v[32:35], v[16:19], v[160:167], v0
s_waitcnt lgkmcnt(3)
buffer_load_dword v6, s[8:11], s52 offen sc1 lds
v_smfmac_f32_16x16x64_bf16 v[36:39], v[16:19], v[40:47], v0
ds_read_b128 v[16:19], v1 offset:13824
v_smfmac_f32_16x16x64_bf16 v[24:27], v[20:23], v[192:199], v0
ds_read_b128 v[40:43], v2 offset:12288
v_smfmac_f32_16x16x64_bf16 v[28:31], v[20:23], v[200:207], v0
ds_read_b128 v[44:47], v2 offset:13312
v_smfmac_f32_16x16x64_bf16 v[32:35], v[20:23], v[208:215], v0
s_waitcnt lgkmcnt(3)
v_smfmac_f32_16x16x64_bf16 v[36:39], v[20:23], v[48:55], v0
ds_read_b128 v[20:23], v1 offset:14848
v_smfmac_f32_16x16x64_bf16 v[24:27], v[12:15], v[216:223], v0
ds_read_b128 v[48:51], v2 offset:14336
v_smfmac_f32_16x16x64_bf16 v[28:31], v[12:15], v[224:231], v0
ds_read_b128 v[52:55], v2 offset:15360
v_smfmac_f32_16x16x64_bf16 v[32:35], v[12:15], v[232:239], v0
s_waitcnt lgkmcnt(3)
v_smfmac_f32_16x16x64_bf16 v[36:39], v[12:15], v[40:47], v0
ds_read_b128 v[12:15], v1 offset:7680
v_smfmac_f32_16x16x64_bf16 v[24:27], v[16:19], v[240:247], v0
ds_read_b128 v[40:43], v2 offset:16384
v_smfmac_f32_16x16x64_bf16 v[28:31], v[16:19], v[248:255], v0
s_waitcnt lgkmcnt(4)
ds_read_b128 v[44:47], v2 offset:17408
v_smfmac_f32_16x16x64_bf16 v[24:27], v[20:23], a[8:15], v0
v_smfmac_f32_16x16x64_bf16 v[28:31], v[20:23], a[16:23], v0
v_smfmac_f32_16x16x64_bf16 v[32:35], v[16:19], a[0:7], v0
s_waitcnt lgkmcnt(3)
v_smfmac_f32_16x16x64_bf16 v[36:39], v[16:19], v[48:55], v0
ds_read_b128 v[16:19], v1 offset:8704
s_nop 2
v_add_f32 v24, v24, v25
v_smfmac_f32_16x16x64_bf16 v[32:35], v[20:23], a[24:31], v0
s_waitcnt lgkmcnt(1)
ds_read_b128 v[48:51], v1 offset:19968
v_add_f32 v26, v26, v27
v_smfmac_f32_16x16x64_bf16 v[36:39], v[20:23], v[40:47], v0
ds_read_b128 v[52:55], v1 offset:22016
v_add_f32 v28, v28, v29
v_smfmac_f32_16x16x64_bf16 v[56:59], v[12:15], a[48:55], v0
ds_read_b128 v[20:23], v1 offset:9728
v_add_f32 v30, v30, v31
v_cvt_pk_bf16_f32 v24, v24, v28
ds_write_b32 v4, v24 offset:2176
v_smfmac_f32_16x16x64_bf16 v[60:63], v[12:15], a[56:63], v0
s_waitcnt lgkmcnt(4)
ds_read_b128 v[12:15], v1 offset:11776
v_cvt_pk_bf16_f32 v26, v26, v30
ds_write_b32 v3, v26 offset:2176
v_add_f32 v32, v32, v33
v_smfmac_f32_16x16x64_bf16 v[56:59], v[16:19], a[64:71], v0
ds_read_b128 v[40:43], v1 offset:15872
v_add_f32 v34, v34, v35
v_add_f32 v36, v36, v37
v_add_f32 v38, v38, v39
v_smfmac_f32_16x16x64_bf16 v[60:63], v[16:19], a[72:79], v0
s_waitcnt lgkmcnt(4)
ds_read_b128 v[16:19], v1 offset:12800
v_cvt_pk_bf16_f32 v32, v32, v36
ds_write_b32 v4, v32 offset:0
v_cvt_pk_bf16_f32 v34, v34, v38
v_smfmac_f32_16x16x64_bf16 v[56:59], v[20:23], a[80:87], v0
ds_read_b128 v[44:47], v1 offset:17920
ds_write_b32 v3, v34 offset:0
v_smfmac_f32_16x16x64_bf16 v[60:63], v[20:23], a[88:95], v0
s_waitcnt lgkmcnt(6)
ds_read_b128 v[20:23], v1 offset:13824
v_smfmac_f32_16x16x64_bf16 v[56:59], v[12:15], a[112:119], v0
v_smfmac_f32_16x16x64_bf16 v[60:63], v[12:15], a[120:127], v0
s_waitcnt lgkmcnt(4)
ds_read_b128 v[12:15], v1 offset:14848
v_smfmac_f32_16x16x64_bf16 v[56:59], v[16:19], a[128:135], v0
v_smfmac_f32_16x16x64_bf16 v[60:63], v[16:19], a[136:143], v0
s_waitcnt lgkmcnt(1)
v_smfmac_f32_16x16x64_bf16 v[56:59], v[20:23], a[144:151], v0
s_barrier
ds_read_b128 v[24:27], v5 offset:0
v_smfmac_f32_16x16x64_bf16 v[60:63], v[20:23], a[152:159], v0
s_waitcnt lgkmcnt(1)
ds_read_b128 v[28:31], v5 offset:512
v_smfmac_f32_16x16x64_bf16 v[56:59], v[12:15], a[160:167], v0
ds_read_b128 v[32:35], v5 offset:1024
v_smfmac_f32_16x16x64_bf16 v[60:63], v[12:15], a[168:175], v0
s_waitcnt lgkmcnt(2)
ds_read_b128 v[36:39], v5 offset:1536
v_mfma_f32_16x16x32_bf16 v[16:19], v[40:43], v[24:27], 0
ds_read_b128 v[40:43], v1 offset:16896
s_mov_b64 exec, s[86:87]
buffer_store_dwordx4 v[24:27], v5, s[8:11], s31 offen offset:0 sc1
s_mov_b64 exec, -1
s_waitcnt lgkmcnt(3)
v_mfma_f32_16x16x32_bf16 v[16:19], v[44:47], v[28:31], v[16:19]
s_waitcnt lgkmcnt(2)
ds_read_b128 v[44:47], v1 offset:18944
v_mfma_f32_16x16x32_bf16 v[16:19], v[48:51], v[32:35], v[16:19]
s_waitcnt lgkmcnt(2)
ds_read_b128 v[48:51], v1 offset:20992
v_mfma_f32_16x16x32_bf16 v[16:19], v[52:55], v[36:39], v[16:19]
ds_read_b128 v[52:55], v1 offset:23040
v_mfma_f32_16x16x32_bf16 v[20:23], v[24:27], v[24:27], 0
v_add_f32 v56, v56, v57
v_add_f32 v58, v58, v59
v_mfma_f32_16x16x32_bf16 v[20:23], v[28:31], v[28:31], v[20:23]
v_add_f32 v60, v60, v61
v_add_f32 v62, v62, v63
v_mfma_f32_16x16x32_bf16 v[20:23], v[32:35], v[32:35], v[20:23]
v_cvt_pk_bf16_f32 v56, v56, v58
v_cvt_pk_bf16_f32 v57, v60, v62
v_mfma_f32_16x16x32_bf16 v[20:23], v[36:39], v[36:39], v[20:23]
s_waitcnt lgkmcnt(3)
v_lshrrev_b32 v58, 1, v1
v_max3_f32 v59, v16, v17, v18
v_mfma_f32_16x16x32_bf16 v[12:15], v[40:43], v[24:27], 0
s_waitcnt lgkmcnt(2)
ds_read_b128 v[40:43], v2 offset:18432
buffer_store_dwordx2 v[56:57], v58, s[8:11], s31 offen offset:2048 sc1
v_mfma_f32_16x16x32_bf16 v[12:15], v[44:47], v[28:31], v[12:15]
s_waitcnt lgkmcnt(2)
ds_read_b128 v[44:47], v2 offset:19456
v_mfma_f32_16x16x32_bf16 v[12:15], v[48:51], v[32:35], v[12:15]
s_waitcnt lgkmcnt(2)
ds_read_b128 v[48:51], v2 offset:20480
v_max3_f32 v59, v59, v19, v20
v_max_f32 v59, v59, v21
v_mfma_f32_16x16x32_bf16 v[12:15], v[52:55], v[36:39], v[12:15]
ds_read_b128 v[52:55], v2 offset:21504
v_mov_b32 v60, s53
s_add_u32 s49, s28, s23
v_mov_b32 v61, s53
s_add_u32 s50, s28, 65536
v_mov_b32 v62, s53
ds_read_b128 v[32:35], v2 offset:22528
v_mov_b32 v63, s53
v_max3_f32 v59, v59, v12, v13
v_max3_f32 v22, v59, v14, v15
v_max3_f32 v59, v59, v14, v15
s_add_u32 s51, s28, 131072
s_add_u32 s52, s28, 196608
v_permlane32_swap_b32 v22, v59
v_max_f32 v23, v59, v22
v_max_f32 v59, v59, v22
v_mov_b32 v22, 0
ds_read_b128 v[36:39], v2 offset:23552
v_permlane16_swap_b32 v23, v59
v_max_f32 v59, v59, v23
v_mul_f32 v58, s18, v59
v_pk_fma_f32 v[20:21], v[20:21], s[18:19], v[58:59] op_sel_hi:[1,0,0] neg_lo:[0,0,1] neg_hi:[0,0,1]
v_pk_fma_f32 v[16:17], v[16:17], s[18:19], v[58:59] op_sel_hi:[1,0,0] neg_lo:[0,0,1] neg_hi:[0,0,1]
v_pk_fma_f32 v[18:19], v[18:19], s[18:19], v[58:59] op_sel_hi:[1,0,0] neg_lo:[0,0,1] neg_hi:[0,0,1]
v_pk_fma_f32 v[12:13], v[12:13], s[18:19], v[58:59] op_sel_hi:[1,0,0] neg_lo:[0,0,1] neg_hi:[0,0,1]
v_pk_fma_f32 v[14:15], v[14:15], s[18:19], v[58:59] op_sel_hi:[1,0,0] neg_lo:[0,0,1] neg_hi:[0,0,1]
v_exp_f32 v20, v20
v_exp_f32 v21, v21
v_exp_f32 v16, v16
v_cvt_pk_bf16_f32 v23, v20, v21
v_cvt_pk_bf16_f32 v20, v20, v21
v_mov_b32 v21, 0
v_exp_f32 v17, v17
v_exp_f32 v18, v18
v_mfma_f32_16x16x16_bf16 v[24:27], v[56:57], v[20:21], 0
v_exp_f32 v19, v19
v_mfma_f32_16x16x16_bf16 v[28:31], v[56:57], v[22:23], 0
v_exp_f32 v12, v12
v_exp_f32 v13, v13
v_cvt_pk_bf16_f32 v16, v16, v17
v_cvt_pk_bf16_f32 v17, v18, v19
v_exp_f32 v14, v14
v_exp_f32 v15, v15
v_cvt_pk_bf16_f32 v18, v12, v13
v_cvt_pk_bf16_f32 v19, v14, v15
v_mfma_f32_16x16x16_bf16 v[12:15], v[60:61], v[20:21], 0
s_waitcnt vmcnt(3)
v_mfma_f32_16x16x32_bf16 v[12:15], v[60:63], v[16:19], v[12:15]
v_mov_b32 v20, 0
v_mov_b32 v23, 0
v_mfma_f32_16x16x32_bf16 v[24:27], v[64:67], v[16:19], v[24:27]
s_nop 1
v_mfma_f32_16x16x32_bf16 v[28:31], v[68:71], v[16:19], v[28:31]
v_mov_b32 v16, 0
v_mov_b32 v17, 0
v_rcp_f32 v12, v12
v_mov_b32 v18, 0
v_mov_b32 v19, 0
v_pk_mul_f32 v[24:25], v[24:25], v[12:13] op_sel_hi:[1,0]
v_pk_mul_f32 v[26:27], v[26:27], v[12:13] op_sel_hi:[1,0]
v_mov_b32 v15, 0
v_pk_mul_f32 v[28:29], v[28:29], v[12:13] op_sel_hi:[1,0]
v_pk_mul_f32 v[30:31], v[30:31], v[12:13] op_sel_hi:[1,0]
v_cvt_pk_bf16_f32 v24, v24, v28
v_cvt_pk_bf16_f32 v25, v25, v29
v_cvt_pk_bf16_f32 v26, v26, v30
v_cvt_pk_bf16_f32 v27, v27, v31
v_mfma_f32_16x16x32_bf16 v[56:59], v[20:23], v[20:23], 0
ds_write_b128 v7, v[24:27]
v_mfma_f32_16x16x32_bf16 v[60:63], v[20:23], v[20:23], 0
v_mov_b32 v12, 0
v_mov_b32 v13, 0
v_mov_b32 v14, 0
v_mov_b32 v3, 6528
v_and_b32 v8, 0x380, v1
v_add_u32 v8, v8, v1
v_mfma_f32_16x16x32_bf16 v[64:67], v[20:23], v[20:23], 0
s_add_u32 s20, s30, 16384
s_mov_b32 m0, 15872
s_cmp_eq_u32 s19, 63
s_cbranch_scc1 L_texit
s_waitcnt lgkmcnt(0)
s_barrier
ds_read_b128 v[24:27], v1 offset:4224
v_mfma_f32_16x16x32_bf16 v[68:71], v[20:23], v[20:23], 0
ds_read_b128 v[28:31], v1 offset:5248
s_nop 2
v_mfma_f32_16x16x32_bf16 v[68:71], v[20:23], v[20:23], 0
s_waitcnt lgkmcnt(1)
v_smfmac_f32_16x16x64_bf16 v[12:15], v[24:27], a[248:255], v0
buffer_load_dwordx4 v8, s[8:11], s20 offen sc1 lds
v_smfmac_f32_16x16x64_bf16 v[16:19], v[24:27], a[176:183], v0
s_mov_b32 m0, 16768
s_waitcnt lgkmcnt(0)
v_smfmac_f32_16x16x64_bf16 v[12:15], v[28:31], v[40:47], v0
ds_read_b128 v[40:43], v2 offset:24576
v_smfmac_f32_16x16x64_bf16 v[16:19], v[28:31], v[48:55], v0
ds_read_b128 v[44:47], v2 offset:25600
buffer_load_dwordx4 v8, s[8:11], s20 offen offset:128 sc1 lds
v_smfmac_f32_16x16x64_bf16 v[20:23], v[24:27], a[184:191], v0
ds_read_b128 v[48:51], v2 offset:26624
s_nop 1
v_add_f32 v12, v12, v13
v_add_f32 v14, v14, v15
v_cvt_pk_bf16_f32 v12, v12, v14
v_smfmac_f32_16x16x64_bf16 v[20:23], v[28:31], v[32:39], v0
ds_read_b128 v[52:55], v2 offset:27648
buffer_store_dword v12, v10, s[8:11], s28 offen
v_add_f32 v16, v16, v17
v_add_f32 v18, v18, v19
v_smfmac_f32_16x16x64_bf16 v[56:59], v[24:27], a[192:199], v0
s_waitcnt lgkmcnt(2)
ds_read_b128 v[32:35], v2 offset:28672
v_cvt_pk_bf16_f32 v16, v16, v18
v_smfmac_f32_16x16x64_bf16 v[56:59], v[28:31], v[40:47], v0
ds_read_b128 v[36:39], v2 offset:29696
v_add_f32 v20, v20, v21
v_add_f32 v22, v22, v23
v_cvt_pk_bf16_f32 v17, v20, v22
v_smfmac_f32_16x16x64_bf16 v[60:63], v[24:27], a[200:207], v0
s_waitcnt lgkmcnt(2)
ds_read_b128 v[12:15], v3
buffer_store_dwordx2 v[16:17], v9, s[8:11], s28 offen
v_smfmac_f32_16x16x64_bf16 v[60:63], v[28:31], v[48:55], v0
ds_read_b128 v[40:43], v2 offset:30720
v_add_f32 v56, v56, v57
v_add_f32 v58, v58, v59
v_cvt_pk_bf16_f32 v56, v56, v58
v_smfmac_f32_16x16x64_bf16 v[64:67], v[24:27], a[208:215], v0
s_waitcnt lgkmcnt(2)
ds_read_b128 v[44:47], v2 offset:31744
v_smfmac_f32_16x16x64_bf16 v[64:67], v[28:31], v[32:39], v0
ds_read_b128 v[20:23], v3
v_add_f32 v60, v60, v61
v_add_f32 v62, v62, v63
v_cvt_pk_bf16_f32 v57, v60, v62
v_smfmac_f32_16x16x64_bf16 v[68:71], v[24:27], a[216:223], v0
s_waitcnt lgkmcnt(1)
ds_read_b128 v[48:51], v2 offset:32768
buffer_store_dwordx2 v[56:57], v9, s[8:11], s50 offen
v_smfmac_f32_16x16x64_bf16 v[68:71], v[28:31], v[40:47], v0
ds_read_b128 v[52:55], v2 offset:33792
v_add_f32 v64, v64, v65
v_add_f32 v66, v66, v67
v_cvt_pk_bf16_f32 v64, v64, v66
v_smfmac_f32_16x16x64_bf16 v[12:15], v[24:27], a[224:231], v0
s_waitcnt lgkmcnt(0)
v_smfmac_f32_16x16x64_bf16 v[12:15], v[28:31], v[48:55], v0
s_nop 0
v_add_f32 v68, v68, v69
v_add_f32 v70, v70, v71
v_cvt_pk_bf16_f32 v65, v68, v70
v_smfmac_f32_16x16x64_bf16 v[20:23], v[24:27], a[232:239], v0
buffer_store_dwordx2 v[64:65], v9, s[8:11], s51 offen
v_smfmac_f32_16x16x64_bf16 v[20:23], v[28:31], a[240:247], v0
s_nop 0
v_add_f32 v12, v12, v13
v_add_f32 v14, v14, v15
v_cvt_pk_bf16_f32 v12, v12, v14
s_nop 3
v_add_f32 v20, v20, v21
v_add_f32 v22, v22, v23
v_cvt_pk_bf16_f32 v13, v20, v22
buffer_store_dwordx2 v[12:13], v9, s[8:11], s52 offen
s_waitcnt vmcnt(2)
L_lt0:
buffer_load_dwordx4 v[32:35], v1, s[8:11], s49 offen offset:0 sc1
buffer_load_dwordx4 v[36:39], v1, s[8:11], s49 offen offset:1024 sc1
buffer_load_dwordx4 v[40:43], v1, s[8:11], s49 offen offset:2048 sc1
buffer_load_dwordx4 v[44:47], v1, s[8:11], s49 offen offset:3072 sc1
s_add_u32 s19, s19, 1
s_mov_b32 s20, s28
s_mov_b32 s28, s29
s_mov_b32 s29, s20
s_and_b32 s20, s19, 3
s_lshl_b32 s20, s20, 14
s_add_u32 s33, s20, 110100480
s_add_u32 s34, s20, s24
s_xor_b32 s20, s20, 32768
s_add_u32 s35, s20, s24
s_add_u32 s30, s30, 16384
s_add_u32 s31, s31, 131072
s_add_u32 s6, s33, 4096
s_add_u32 s7, s33, 8192
s_mov_b32 s22, 0
v_mov_b64 v[24:25], 0
v_mov_b64 v[26:27], 0
v_mov_b64 v[28:29], 0
v_mov_b64 v[30:31], 0
v_and_b32 v70, 0xf40, v1
v_add_u32 v70, v70, v1
v_bfe_u32 v71, v1, 7, 1
v_mad_i32_i24 v70, v71, s4, v70
v_mov_b64 v[64:65], -1
v_mov_b64 v[66:67], -1
v_xor_b32 v3, 16, v4
ds_read_b128 v[48:51], v2 offset:8192
ds_read_b128 v[52:55], v2 offset:9216
v_lshrrev_b32 v8, 2, v1
v_mov_b32 v56, 0x3f80
buffer_load_dwordx4 v[32:35], v1, s[8:11], s49 offen offset:0 sc1
buffer_load_dwordx4 v[36:39], v1, s[8:11], s49 offen offset:1024 sc1
buffer_load_dwordx4 v[40:43], v1, s[8:11], s49 offen offset:2048 sc1
buffer_load_dwordx4 v[44:47], v1, s[8:11], s49 offen offset:3072 sc1
v_cndmask_b32 v56, v56, 1.0, s[44:45]
v_cndmask_b32 v60, 0, v56, s[36:37]
v_cndmask_b32 v61, 0, v56, s[38:39]
v_cndmask_b32 v62, 0, v56, s[40:41]
v_cndmask_b32 v63, 0, v56, s[42:43]
s_waitcnt vmcnt(7)
v_max3_u32 v16, v32, v33, v34
v_max_u32 v16, v16, v35
v_mfma_f32_16x16x32_bf16 v[56:59], v[32:35], v[60:63], 0
s_waitcnt vmcnt(6)
v_max3_u32 v16, v16, v36, v37
v_max3_u32 v16, v16, v38, v39
v_mfma_f32_16x16x32_bf16 v[56:59], v[36:39], v[60:63], v[56:59]
s_waitcnt vmcnt(5)
v_max3_u32 v16, v16, v40, v41
v_max3_u32 v16, v16, v42, v43
v_mfma_f32_16x16x32_bf16 v[56:59], v[40:43], v[60:63], v[56:59]
s_waitcnt vmcnt(4)
v_max3_u32 v16, v16, v44, v45
v_max3_u32 v16, v16, v46, v47
v_mfma_f32_16x16x32_bf16 v[56:59], v[44:47], v[60:63], v[56:59]
v_cmp_le_u32 vcc, 0xffff0000, v16
s_cbranch_vccnz L_red0
L_redb0:
s_nop 5
v_permlane32_swap_b32 v56, v58
v_permlane32_swap_b32 v57, v59
v_pk_add_f32 v[56:57], v[56:57], v[58:59]
v_cvt_pk_bf16_f32 v56, v56, v57
buffer_store_dword v56, v11, s[8:11], s34 offen
s_add_u32 s20, s30, 0
s_add_u32 s21, s30, 8192
s_add_u32 s49, s29, s25
s_add_u32 s50, s29, s26
s_add_u32 s51, s29, s27
s_add_u32 s52, s30, 16384
s_mov_b32 m0, 15872
s_nop 1
s_barrier
s_branch L_gat0
L_red0:
s_waitcnt vmcnt(3)
v_mfma_f32_16x16x32_bf16 v[56:59], v[32:35], v[60:63], 0
v_max3_u32 v16, v32, v33, v34
v_max_u32 v16, v16, v35
s_waitcnt vmcnt(2)
v_mfma_f32_16x16x32_bf16 v[56:59], v[36:39], v[60:63], v[56:59]
v_max3_u32 v16, v16, v36, v37
v_max3_u32 v16, v16, v38, v39
s_waitcnt vmcnt(1)
v_mfma_f32_16x16x32_bf16 v[56:59], v[40:43], v[60:63], v[56:59]
v_max3_u32 v16, v16, v40, v41
v_max3_u32 v16, v16, v42, v43
s_waitcnt vmcnt(0)
v_mfma_f32_16x16x32_bf16 v[56:59], v[44:47], v[60:63], v[56:59]
v_max3_u32 v16, v16, v44, v45
v_max3_u32 v16, v16, v46, v47
v_cmp_le_u32 vcc, 0xffff0000, v16
s_cbranch_vccz L_redb0
L_red0b:
buffer_load_dwordx4 v[32:35], v1, s[8:11], s49 offen offset:0 sc1
buffer_load_dwordx4 v[36:39], v1, s[8:11], s49 offen offset:1024 sc1
buffer_load_dwordx4 v[40:43], v1, s[8:11], s49 offen offset:2048 sc1
buffer_load_dwordx4 v[44:47], v1, s[8:11], s49 offen offset:3072 sc1
s_add_u32 s22, s22, 1
s_cmp_gt_u32 s22, 40000
s_cbranch_scc1 L_end
s_waitcnt vmcnt(3)
v_mfma_f32_16x16x32_bf16 v[56:59], v[32:35], v[60:63], 0
v_max3_u32 v16, v32, v33, v34
v_max_u32 v16, v16, v35
s_waitcnt vmcnt(2)
v_mfma_f32_16x16x32_bf16 v[56:59], v[36:39], v[60:63], v[56:59]
v_max3_u32 v16, v16, v36, v37
v_max3_u32 v16, v16, v38, v39
s_waitcnt vmcnt(1)
v_mfma_f32_16x16x32_bf16 v[56:59], v[40:43], v[60:63], v[56:59]
v_max3_u32 v16, v16, v40, v41
v_max3_u32 v16, v16, v42, v43
s_waitcnt vmcnt(0)
v_mfma_f32_16x16x32_bf16 v[56:59], v[44:47], v[60:63], v[56:59]
v_max3_u32 v16, v16, v44, v45
v_max3_u32 v16, v16, v46, v47
v_cmp_le_u32 vcc, 0xffff0000, v16
s_cbranch_vccz L_redb0
s_branch L_red0b
L_g3r0:
buffer_load_dwordx4 v[16:19], v1, s[8:11], s6 offen sc1
s_add_u32 s22, s22, 1
s_waitcnt vmcnt(1)
v_max3_u32 v21, v16, v17, v18
v_max_u32 v21, v21, v19
v_cmp_le_u32 vcc, 0xffff0000, v21
s_cmp_gt_u32 s22, 40000
s_cbranch_vccz L_g30
s_cbranch_scc0 L_g3r0
s_branch L_end
L_ent1:
s_movk_i32 s4, -64
v_mov_b64 v[24:25], 0
v_mov_b64 v[26:27], 0
v_mov_b64 v[28:29], 0
v_mov_b64 v[30:31], 0
v_and_b32 v69, 0x380, v1
v_add_u32 v69, v69, v1
v_and_b32 v70, 0xf40, v1
v_add_u32 v70, v70, v1
v_bfe_u32 v71, v1, 7, 1
v_mad_i32_i24 v70, v71, s4, v70
v_mov_b64 v[64:65], -1
v_mov_b64 v[66:67], -1
v_xor_b32 v3, 16, v4
ds_read_b128 v[48:51], v2 offset:10240
ds_read_b128 v[52:55], v2 offset:11264
ds_read_b128 v[40:43], v2 offset:2048
ds_read_b128 v[44:47], v2 offset:3072
v_mov_b64 v[32:33], 0
v_mov_b64 v[34:35], 0
v_mov_b64 v[36:37], 0
v_mov_b64 v[38:39], 0
v_mov_b64 v[56:57], 0
v_mov_b64 v[58:59], 0
v_mov_b64 v[60:61], 0
v_mov_b64 v[62:63], 0
s_add_u32 s20, s30, 1024
s_add_u32 s21, s30, 8192
s_add_u32 s49, s29, s25
s_add_u32 s50, s29, s26
s_add_u32 s51, s29, s27
s_add_u32 s52, s30, 16384
s_mov_b32 m0, 17920
s_nop 0
buffer_load_dwordx4 v69, s[8:11], s20 offen sc1 lds
s_mov_b32 m0, 18816
s_nop 0
buffer_load_dwordx4 v69, s[8:11], s20 offen offset:128 sc1 lds
s_waitcnt vmcnt(0) lgkmcnt(0)
s_branch L_step1
L_gr1:
buffer_load_dwordx4 v[12:15], v1, s[8:11], s33 offen sc1
buffer_load_dword v20, v8, s[8:11], s7 offen sc1
buffer_load_dwordx4 v[16:19], v1, s[8:11], s6 offen sc1
s_add_u32 s22, s22, 1
s_cmp_gt_u32 s22, 40000
s_cbranch_scc1 L_end
buffer_load_dwordx4 v[16:19], v1, s[8:11], s6 offen sc1
v_mov_b64 v[24:25], 0
v_mov_b64 v[26:27], 0
v_mov_b64 v[28:29], 0
v_mov_b64 v[30:31], 0
v_mov_b64 v[32:33], 0
v_mov_b64 v[34:35], 0
v_mov_b64 v[36:37], 0
v_mov_b64 v[38:39], 0
v_mov_b64 v[56:57], 0
v_mov_b64 v[58:59], 0
v_mov_b64 v[60:61], 0
v_mov_b64 v[62:63], 0
s_waitcnt lgkmcnt(0)
s_branch L_step1
.p2align 3
L_gat1:
buffer_load_dwordx4 v[12:15], v1, s[8:11], s33 offen sc1
buffer_load_dword v20, v8, s[8:11], s7 offen sc1
buffer_load_dwordx4 v[16:19], v1, s[8:11], s6 offen sc1
s_add_u32 s20, s30, 1024
s_add_u32 s21, s30, 8192
s_add_u32 s49, s29, s25
s_add_u32 s50, s29, s26
s_add_u32 s51, s29, s27
s_add_u32 s52, s30, 16384
s_mov_b32 m0, 17920
s_waitcnt vmcnt(4)
ds_read_b128 v[40:43], v2 offset:2048
ds_read_b128 v[44:47], v2 offset:3072
v_mov_b64 v[32:33], 0
v_mov_b64 v[34:35], 0
v_mov_b64 v[36:37], 0
v_mov_b64 v[38:39], 0
v_mov_b64 v[56:57], 0
v_mov_b64 v[58:59], 0
v_mov_b64 v[60:61], 0
v_mov_b64 v[62:63], 0
s_nop 6
buffer_load_dwordx4 v[16:19], v1, s[8:11], s6 offen sc1
s_waitcnt lgkmcnt(0)
L_step1:
s_waitcnt vmcnt(3)
v_smfmac_f32_16x16x64_bf16 v[24:27], v[12:15], v[96:103], v0
ds_write_b128 v1, v[12:15] offset:6656
v_smfmac_f32_16x16x64_bf16 v[28:31], v[12:15], v[104:111], v0
s_waitcnt vmcnt(2)
v_max3_u32 v21, v12, v13, v14
v_max3_u32 v21, v21, v15, v20
v_cmp_le_u32 vcc, 0xffff0000, v21
v_smfmac_f32_16x16x64_bf16 v[32:35], v[12:15], v[112:119], v0
s_cbranch_vccnz L_gr1
s_waitcnt vmcnt(1)
v_max3_u32 v21, v16, v17, v18
v_max_u32 v21, v21, v19
v_cmp_le_u32 vcc, 0xffff0000, v21
ds_write_b32 v8, v20 offset:14848
v_smfmac_f32_16x16x64_bf16 v[56:59], v[12:15], a[48:55], v0
s_cbranch_vccnz L_g3r1
L_g31:
ds_write_b128 v1, v[16:19] offset:10752
v_smfmac_f32_16x16x64_bf16 v[60:63], v[12:15], a[56:63], v0
v_smfmac_f32_16x16x64_bf16 v[36:39], v[12:15], v[40:47], v0
v_smfmac_f32_16x16x64_bf16 v[24:27], v[16:19], v[192:199], v0
v_smfmac_f32_16x16x64_bf16 v[28:31], v[16:19], v[200:207], v0
s_waitcnt lgkmcnt(0)
s_barrier
ds_read_b128 v[20:23], v1 offset:5632
v_smfmac_f32_16x16x64_bf16 v[32:35], v[16:19], v[208:215], v0
ds_read_b128 v[12:15], v1 offset:7680
s_mov_b32 m0, 6272
buffer_store_dword v0, v11, s[8:11], s35 offen
v_smfmac_f32_16x16x64_bf16 v[56:59], v[16:19], a[112:119], v0
ds_read_b128 v[40:43], v2 offset:0
v_smfmac_f32_16x16x64_bf16 v[60:63], v[16:19], a[120:127], v0
ds_read_b128 v[44:47], v2 offset:1024
buffer_store_dwordx4 v[64:67], v1, s[8:11], s49 offen
v_smfmac_f32_16x16x64_bf16 v[36:39], v[16:19], v[48:55], v0
s_waitcnt vmcnt(2)
ds_read_b128 v[16:19], v1 offset:8704
s_waitcnt lgkmcnt(4)
v_smfmac_f32_16x16x64_bf16 v[24:27], v[20:23], v[72:79], v0
ds_read_b128 v[48:51], v2 offset:4096
buffer_store_dwordx4 v[64:67], v1, s[8:11], s50 offen
v_smfmac_f32_16x16x64_bf16 v[28:31], v[20:23], v[80:87], v0
ds_read_b128 v[52:55], v2 offset:5120
v_smfmac_f32_16x16x64_bf16 v[32:35], v[20:23], v[88:95], v0
s_waitcnt lgkmcnt(3)
buffer_store_dwordx4 v[64:67], v1, s[8:11], s51 offen
v_smfmac_f32_16x16x64_bf16 v[36:39], v[20:23], v[40:47], v0
ds_read_b128 v[20:23], v1 offset:9728
buffer_load_dwordx4 v[64:67], v70, s[8:11], s21 offen sc1
v_smfmac_f32_16x16x64_bf16 v[24:27], v[12:15], v[120:127], v0
ds_read_b128 v[40:43], v2 offset:6144
v_smfmac_f32_16x16x64_bf16 v[28:31], v[12:15], v[128:135], v0
ds_read_b128 v[44:47], v2 offset:7168
buffer_load_dwordx4 v[68:71], v70, s[8:11], s21 offen offset:256 sc1
v_smfmac_f32_16x16x64_bf16 v[32:35], v[12:15], v[136:143], v0
s_waitcnt lgkmcnt(3)
v_smfmac_f32_16x16x64_bf16 v[36:39], v[12:15], v[48:55], v0
ds_read_b128 v[12:15], v1 offset:11776
v_smfmac_f32_16x16x64_bf16 v[24:27], v[16:19], v[144:151], v0
ds_read_b128 v[48:51], v2 offset:8192
v_smfmac_f32_16x16x64_bf16 v[28:31], v[16:19], v[152:159], v0
ds_read_b128 v[52:55], v2 offset:9216
v_smfmac_f32_16x16x64_bf16 v[32:35], v[16:19], v[160:167], v0
s_waitcnt lgkmcnt(3)
buffer_load_dword v6, s[8:11], s52 offen sc1 lds
v_smfmac_f32_16x16x64_bf16 v[36:39], v[16:19], v[40:47], v0
ds_read_b128 v[16:19], v1 offset:12800
v_smfmac_f32_16x16x64_bf16 v[24:27], v[20:23], v[168:175], v0
ds_read_b128 v[40:43], v2 offset:12288
v_smfmac_f32_16x16x64_bf16 v[28:31], v[20:23], v[176:183], v0
ds_read_b128 v[44:47], v2 offset:13312
v_smfmac_f32_16x16x64_bf16 v[32:35], v[20:23], v[184:191], v0
s_waitcnt lgkmcnt(3)
v_smfmac_f32_16x16x64_bf16 v[36:39], v[20:23], v[48:55], v0
ds_read_b128 v[20:23], v1 offset:13824
v_smfmac_f32_16x16x64_bf16 v[24:27], v[12:15], v[216:223], v0
ds_read_b128 v[48:51], v2 offset:14336
v_smfmac_f32_16x16x64_bf16 v[28:31], v[12:15], v[224:231], v0
ds_read_b128 v[52:55], v2 offset:15360
v_smfmac_f32_16x16x64_bf16 v[32:35], v[12:15], v[232:239], v0
s_waitcnt lgkmcnt(3)
v_smfmac_f32_16x16x64_bf16 v[36:39], v[12:15], v[40:47], v0
ds_read_b128 v[12:15], v1 offset:5632
v_smfmac_f32_16x16x64_bf16 v[24:27], v[16:19], v[240:247], v0
ds_read_b128 v[40:43], v2 offset:16384
v_smfmac_f32_16x16x64_bf16 v[28:31], v[16:19], v[248:255], v0
s_waitcnt lgkmcnt(4)
ds_read_b128 v[44:47], v2 offset:17408
v_smfmac_f32_16x16x64_bf16 v[24:27], v[20:23], a[8:15], v0
v_smfmac_f32_16x16x64_bf16 v[28:31], v[20:23], a[16:23], v0
v_smfmac_f32_16x16x64_bf16 v[32:35], v[16:19], a[0:7], v0
s_waitcnt lgkmcnt(3)
v_smfmac_f32_16x16x64_bf16 v[36:39], v[16:19], v[48:55], v0
ds_read_b128 v[16:19], v1 offset:7680
s_nop 2
v_add_f32 v24, v24, v25
v_smfmac_f32_16x16x64_bf16 v[32:35], v[20:23], a[24:31], v0
s_waitcnt lgkmcnt(1)
ds_read_b128 v[48:51], v1 offset:18944
v_add_f32 v26, v26, v27
v_smfmac_f32_16x16x64_bf16 v[36:39], v[20:23], v[40:47], v0
ds_read_b128 v[52:55], v1 offset:20992
v_add_f32 v28, v28, v29
v_smfmac_f32_16x16x64_bf16 v[56:59], v[12:15], a[32:39], v0
ds_read_b128 v[20:23], v1 offset:8704
v_add_f32 v30, v30, v31
v_cvt_pk_bf16_f32 v24, v24, v28
ds_write_b32 v4, v24 offset:2176
v_smfmac_f32_16x16x64_bf16 v[60:63], v[12:15], a[40:47], v0
s_waitcnt lgkmcnt(4)
ds_read_b128 v[12:15], v1 offset:9728
v_cvt_pk_bf16_f32 v26, v26, v30
ds_write_b32 v3, v26 offset:2176
v_add_f32 v32, v32, v33
v_smfmac_f32_16x16x64_bf16 v[56:59], v[16:19], a[64:71], v0
ds_read_b128 v[44:47], v1 offset:16896
v_add_f32 v34, v34, v35
v_add_f32 v36, v36, v37
v_add_f32 v38, v38, v39
v_smfmac_f32_16x16x64_bf16 v[60:63], v[16:19], a[72:79], v0
s_waitcnt lgkmcnt(4)
ds_read_b128 v[16:19], v1 offset:11776
v_cvt_pk_bf16_f32 v32, v32, v36
ds_write_b32 v4, v32 offset:0
v_cvt_pk_bf16_f32 v34, v34, v38
v_smfmac_f32_16x16x64_bf16 v[56:59], v[20:23], a[80:87], v0
ds_read_b128 v[40:43], v1 offset:14848
ds_write_b32 v3, v34 offset:0
v_smfmac_f32_16x16x64_bf16 v[60:63], v[20:23], a[88:95], v0
s_waitcnt lgkmcnt(6)
ds_read_b128 v[20:23], v1 offset:12800
v_smfmac_f32_16x16x64_bf16 v[56:59], v[12:15], a[96:103], v0
v_smfmac_f32_16x16x64_bf16 v[60:63], v[12:15], a[104:111], v0
s_waitcnt lgkmcnt(4)
ds_read_b128 v[12:15], v1 offset:13824
v_smfmac_f32_16x16x64_bf16 v[56:59], v[16:19], a[128:135], v0
v_smfmac_f32_16x16x64_bf16 v[60:63], v[16:19], a[136:143], v0
s_waitcnt lgkmcnt(1)
v_smfmac_f32_16x16x64_bf16 v[56:59], v[20:23], a[144:151], v0
s_barrier
ds_read_b128 v[28:31], v5 offset:512
v_smfmac_f32_16x16x64_bf16 v[60:63], v[20:23], a[152:159], v0
s_waitcnt lgkmcnt(1)
ds_read_b128 v[32:35], v5 offset:1024
v_smfmac_f32_16x16x64_bf16 v[56:59], v[12:15], a[160:167], v0
ds_read_b128 v[36:39], v5 offset:1536
v_smfmac_f32_16x16x64_bf16 v[60:63], v[12:15], a[168:175], v0
s_waitcnt lgkmcnt(2)
ds_read_b128 v[24:27], v5 offset:0
v_mfma_f32_16x16x32_bf16 v[16:19], v[44:47], v[28:31], 0
s_waitcnt lgkmcnt(2)
ds_read_b128 v[44:47], v1 offset:17920
v_mfma_f32_16x16x32_bf16 v[16:19], v[48:51], v[32:35], v[16:19]
ds_read_b128 v[48:51], v1 offset:19968
s_mov_b64 exec, s[86:87]
buffer_store_dwordx4 v[28:31], v5, s[8:11], s31 offen offset:512 sc1
s_mov_b64 exec, -1
s_waitcnt lgkmcnt(3)
v_mfma_f32_16x16x32_bf16 v[16:19], v[52:55], v[36:39], v[16:19]
s_waitcnt lgkmcnt(2)
ds_read_b128 v[52:55], v1 offset:22016
v_mfma_f32_16x16x32_bf16 v[16:19], v[40:43], v[24:27], v[16:19]
ds_read_b128 v[40:43], v1 offset:15872
v_mfma_f32_16x16x32_bf16 v[20:23], v[28:31], v[28:31], 0
v_add_f32 v56, v56, v57
v_add_f32 v58, v58, v59
v_mfma_f32_16x16x32_bf16 v[20:23], v[32:35], v[32:35], v[20:23]
v_add_f32 v60, v60, v61
v_add_f32 v62, v62, v63
v_mfma_f32_16x16x32_bf16 v[20:23], v[36:39], v[36:39], v[20:23]
v_cvt_pk_bf16_f32 v56, v56, v58
v_cvt_pk_bf16_f32 v57, v60, v62
v_mfma_f32_16x16x32_bf16 v[20:23], v[24:27], v[24:27], v[20:23]
s_waitcnt lgkmcnt(3)
v_lshrrev_b32 v58, 1, v1
v_max3_f32 v59, v16, v17, v18
v_mfma_f32_16x16x32_bf16 v[12:15], v[44:47], v[28:31], 0
s_waitcnt lgkmcnt(2)
ds_read_b128 v[44:47], v2 offset:19456
v_mfma_f32_16x16x32_bf16 v[12:15], v[48:51], v[32:35], v[12:15]
s_waitcnt lgkmcnt(2)
ds_read_b128 v[48:51], v2 offset:20480
buffer_store_dwordx2 v[56:57], v58, s[8:11], s31 offen offset:2048 sc1
v_mfma_f32_16x16x32_bf16 v[12:15], v[52:55], v[36:39], v[12:15]
s_waitcnt lgkmcnt(2)
ds_read_b128 v[52:55], v2 offset:21504
v_max3_f32 v59, v59, v19, v20
v_max_f32 v59, v59, v21
v_mfma_f32_16x16x32_bf16 v[12:15], v[40:43], v[24:27], v[12:15]
ds_read_b128 v[40:43], v2 offset:18432
v_mov_b32 v60, s53
s_add_u32 s49, s28, s23
v_mov_b32 v61, s53
s_add_u32 s50, s28, 65536
v_mov_b32 v62, s53
ds_read_b128 v[32:35], v2 offset:22528
v_mov_b32 v63, s53
v_max3_f32 v59, v59, v12, v13
v_max3_f32 v22, v59, v14, v15
v_max3_f32 v59, v59, v14, v15
s_add_u32 s51, s28, 131072
s_add_u32 s52, s28, 196608
v_permlane32_swap_b32 v22, v59
v_max_f32 v23, v59, v22
v_max_f32 v59, v59, v22
v_mov_b32 v22, 0
ds_read_b128 v[36:39], v2 offset:23552
v_permlane16_swap_b32 v23, v59
v_max_f32 v59, v59, v23
v_mul_f32 v58, s18, v59
v_pk_fma_f32 v[20:21], v[20:21], s[18:19], v[58:59] op_sel_hi:[1,0,0] neg_lo:[0,0,1] neg_hi:[0,0,1]
v_pk_fma_f32 v[16:17], v[16:17], s[18:19], v[58:59] op_sel_hi:[1,0,0] neg_lo:[0,0,1] neg_hi:[0,0,1]
v_pk_fma_f32 v[18:19], v[18:19], s[18:19], v[58:59] op_sel_hi:[1,0,0] neg_lo:[0,0,1] neg_hi:[0,0,1]
v_pk_fma_f32 v[12:13], v[12:13], s[18:19], v[58:59] op_sel_hi:[1,0,0] neg_lo:[0,0,1] neg_hi:[0,0,1]
v_pk_fma_f32 v[14:15], v[14:15], s[18:19], v[58:59] op_sel_hi:[1,0,0] neg_lo:[0,0,1] neg_hi:[0,0,1]
v_exp_f32 v20, v20
v_exp_f32 v21, v21
v_exp_f32 v16, v16
v_cvt_pk_bf16_f32 v23, v20, v21
v_cvt_pk_bf16_f32 v20, v20, v21
v_mov_b32 v21, 0
v_exp_f32 v17, v17
v_exp_f32 v18, v18
v_mfma_f32_16x16x16_bf16 v[24:27], v[56:57], v[20:21], 0
v_exp_f32 v19, v19
v_mfma_f32_16x16x16_bf16 v[28:31], v[56:57], v[22:23], 0
v_exp_f32 v12, v12
v_exp_f32 v13, v13
v_cvt_pk_bf16_f32 v16, v16, v17
v_cvt_pk_bf16_f32 v17, v18, v19
v_exp_f32 v14, v14
v_exp_f32 v15, v15
v_cvt_pk_bf16_f32 v18, v12, v13
v_cvt_pk_bf16_f32 v19, v14, v15
v_mfma_f32_16x16x16_bf16 v[12:15], v[60:61], v[20:21], 0
s_waitcnt vmcnt(3)
v_mfma_f32_16x16x32_bf16 v[12:15], v[60:63], v[16:19], v[12:15]
v_mov_b32 v20, 0
v_mov_b32 v23, 0
v_mfma_f32_16x16x32_bf16 v[24:27], v[64:67], v[16:19], v[24:27]
s_nop 1
v_mfma_f32_16x16x32_bf16 v[28:31], v[68:71], v[16:19], v[28:31]
v_mov_b32 v16, 0
v_mov_b32 v17, 0
v_rcp_f32 v12, v12
v_mov_b32 v18, 0
v_mov_b32 v19, 0
v_pk_mul_f32 v[24:25], v[24:25], v[12:13] op_sel_hi:[1,0]
v_pk_mul_f32 v[26:27], v[26:27], v[12:13] op_sel_hi:[1,0]
v_mov_b32 v15, 0
v_pk_mul_f32 v[28:29], v[28:29], v[12:13] op_sel_hi:[1,0]
v_pk_mul_f32 v[30:31], v[30:31], v[12:13] op_sel_hi:[1,0]
v_cvt_pk_bf16_f32 v24, v24, v28
v_cvt_pk_bf16_f32 v25, v25, v29
v_cvt_pk_bf16_f32 v26, v26, v30
v_cvt_pk_bf16_f32 v27, v27, v31
v_mfma_f32_16x16x32_bf16 v[56:59], v[20:23], v[20:23], 0
ds_write_b128 v7, v[24:27]
v_mfma_f32_16x16x32_bf16 v[60:63], v[20:23], v[20:23], 0
v_mov_b32 v12, 0
v_mov_b32 v13, 0
v_mov_b32 v14, 0
v_mov_b32 v3, 6528
v_and_b32 v8, 0x380, v1
v_add_u32 v8, v8, v1
v_mfma_f32_16x16x32_bf16 v[64:67], v[20:23], v[20:23], 0
s_add_u32 s20, s30, 17408
s_mov_b32 m0, 17920
s_cmp_eq_u32 s19, 63
s_cbranch_scc1 L_texit
s_waitcnt lgkmcnt(0)
s_barrier
ds_read_b128 v[24:27], v1 offset:3200
v_mfma_f32_16x16x32_bf16 v[68:71], v[20:23], v[20:23], 0
ds_read_b128 v[28:31], v1 offset:4224
s_nop 2
v_mfma_f32_16x16x32_bf16 v[68:71], v[20:23], v[20:23], 0
s_waitcnt lgkmcnt(1)
v_smfmac_f32_16x16x64_bf16 v[12:15], v[24:27], a[248:255], v0
buffer_load_dwordx4 v8, s[8:11], s20 offen sc1 lds
v_smfmac_f32_16x16x64_bf16 v[16:19], v[24:27], a[176:183], v0
s_mov_b32 m0, 18816
s_waitcnt lgkmcnt(0)
v_smfmac_f32_16x16x64_bf16 v[12:15], v[28:31], v[40:47], v0
ds_read_b128 v[40:43], v2 offset:24576
v_smfmac_f32_16x16x64_bf16 v[16:19], v[28:31], v[48:55], v0
ds_read_b128 v[44:47], v2 offset:25600
buffer_load_dwordx4 v8, s[8:11], s20 offen offset:128 sc1 lds
v_smfmac_f32_16x16x64_bf16 v[20:23], v[24:27], a[184:191], v0
ds_read_b128 v[48:51], v2 offset:26624
s_nop 1
v_add_f32 v12, v12, v13
v_add_f32 v14, v14, v15
v_cvt_pk_bf16_f32 v12, v12, v14
v_smfmac_f32_16x16x64_bf16 v[20:23], v[28:31], v[32:39], v0
ds_read_b128 v[52:55], v2 offset:27648
buffer_store_dword v12, v10, s[8:11], s28 offen
v_add_f32 v16, v16, v17
v_add_f32 v18, v18, v19
v_smfmac_f32_16x16x64_bf16 v[56:59], v[24:27], a[192:199], v0
s_waitcnt lgkmcnt(2)
ds_read_b128 v[32:35], v2 offset:28672
v_cvt_pk_bf16_f32 v16, v16, v18
v_smfmac_f32_16x16x64_bf16 v[56:59], v[28:31], v[40:47], v0
ds_read_b128 v[36:39], v2 offset:29696
v_add_f32 v20, v20, v21
v_add_f32 v22, v22, v23
v_cvt_pk_bf16_f32 v17, v20, v22
v_smfmac_f32_16x16x64_bf16 v[60:63], v[24:27], a[200:207], v0
s_waitcnt lgkmcnt(2)
ds_read_b128 v[12:15], v3
buffer_store_dwordx2 v[16:17], v9, s[8:11], s28 offen
v_smfmac_f32_16x16x64_bf16 v[60:63], v[28:31], v[48:55], v0
ds_read_b128 v[40:43], v2 offset:30720
v_add_f32 v56, v56, v57
v_add_f32 v58, v58, v59
v_cvt_pk_bf16_f32 v56, v56, v58
v_smfmac_f32_16x16x64_bf16 v[64:67], v[24:27], a[208:215], v0
s_waitcnt lgkmcnt(2)
ds_read_b128 v[44:47], v2 offset:31744
v_smfmac_f32_16x16x64_bf16 v[64:67], v[28:31], v[32:39], v0
ds_read_b128 v[20:23], v3
v_add_f32 v60, v60, v61
v_add_f32 v62, v62, v63
v_cvt_pk_bf16_f32 v57, v60, v62
v_smfmac_f32_16x16x64_bf16 v[68:71], v[24:27], a[216:223], v0
s_waitcnt lgkmcnt(1)
ds_read_b128 v[48:51], v2 offset:32768
buffer_store_dwordx2 v[56:57], v9, s[8:11], s50 offen
v_smfmac_f32_16x16x64_bf16 v[68:71], v[28:31], v[40:47], v0
ds_read_b128 v[52:55], v2 offset:33792
v_add_f32 v64, v64, v65
v_add_f32 v66, v66, v67
v_cvt_pk_bf16_f32 v64, v64, v66
v_smfmac_f32_16x16x64_bf16 v[12:15], v[24:27], a[224:231], v0
s_waitcnt lgkmcnt(0)
v_smfmac_f32_16x16x64_bf16 v[12:15], v[28:31], v[48:55], v0
s_nop 0
v_add_f32 v68, v68, v69
v_add_f32 v70, v70, v71
v_cvt_pk_bf16_f32 v65, v68, v70
v_smfmac_f32_16x16x64_bf16 v[20:23], v[24:27], a[232:239], v0
buffer_store_dwordx2 v[64:65], v9, s[8:11], s51 offen
v_smfmac_f32_16x16x64_bf16 v[20:23], v[28:31], a[240:247], v0
s_nop 0
v_add_f32 v12, v12, v13
v_add_f32 v14, v14, v15
v_cvt_pk_bf16_f32 v12, v12, v14
s_nop 3
v_add_f32 v20, v20, v21
v_add_f32 v22, v22, v23
v_cvt_pk_bf16_f32 v13, v20, v22
buffer_store_dwordx2 v[12:13], v9, s[8:11], s52 offen
s_waitcnt vmcnt(0)
L_lt1:
buffer_load_dwordx4 v[32:35], v1, s[8:11], s49 offen offset:0 sc1
buffer_load_dwordx4 v[36:39], v1, s[8:11], s49 offen offset:1024 sc1
buffer_load_dwordx4 v[40:43], v1, s[8:11], s49 offen offset:2048 sc1
buffer_load_dwordx4 v[44:47], v1, s[8:11], s49 offen offset:3072 sc1
s_add_u32 s19, s19, 1
s_mov_b32 s20, s28
s_mov_b32 s28, s29
s_mov_b32 s29, s20
s_and_b32 s20, s19, 3
s_lshl_b32 s20, s20, 14
s_add_u32 s33, s20, 110100480
s_add_u32 s34, s20, s24
s_xor_b32 s20, s20, 32768
s_add_u32 s35, s20, s24
s_add_u32 s30, s30, 16384
s_add_u32 s31, s31, 131072
s_add_u32 s6, s33, 4096
s_add_u32 s7, s33, 8192
s_mov_b32 s22, 0
v_mov_b64 v[24:25], 0
v_mov_b64 v[26:27], 0
v_mov_b64 v[28:29], 0
v_mov_b64 v[30:31], 0
buffer_load_dwordx4 v[32:35], v1, s[8:11], s49 offen offset:0 sc1
buffer_load_dwordx4 v[36:39], v1, s[8:11], s49 offen offset:1024 sc1
buffer_load_dwordx4 v[40:43], v1, s[8:11], s49 offen offset:2048 sc1
buffer_load_dwordx4 v[44:47], v1, s[8:11], s49 offen offset:3072 sc1
v_and_b32 v70, 0xf40, v1
v_add_u32 v70, v70, v1
v_bfe_u32 v71, v1, 7, 1
v_mad_i32_i24 v70, v71, s4, v70
v_mov_b64 v[64:65], -1
v_mov_b64 v[66:67], -1
v_xor_b32 v3, 16, v4
ds_read_b128 v[48:51], v2 offset:10240
ds_read_b128 v[52:55], v2 offset:11264
v_lshrrev_b32 v8, 2, v1
v_mov_b32 v56, 0x3f80
v_cndmask_b32 v56, v56, 1.0, s[44:45]
v_cndmask_b32 v60, 0, v56, s[36:37]
v_cndmask_b32 v61, 0, v56, s[38:39]
v_cndmask_b32 v62, 0, v56, s[40:41]
v_cndmask_b32 v63, 0, v56, s[42:43]
s_waitcnt vmcnt(7)
v_max3_u32 v16, v32, v33, v34
v_max_u32 v16, v16, v35
v_mfma_f32_16x16x32_bf16 v[56:59], v[32:35], v[60:63], 0
s_waitcnt vmcnt(6)
v_max3_u32 v16, v16, v36, v37
v_max3_u32 v16, v16, v38, v39
v_mfma_f32_16x16x32_bf16 v[56:59], v[36:39], v[60:63], v[56:59]
s_waitcnt vmcnt(5)
v_max3_u32 v16, v16, v40, v41
v_max3_u32 v16, v16, v42, v43
v_mfma_f32_16x16x32_bf16 v[56:59], v[40:43], v[60:63], v[56:59]
s_waitcnt vmcnt(4)
v_max3_u32 v16, v16, v44, v45
v_max3_u32 v16, v16, v46, v47
v_mfma_f32_16x16x32_bf16 v[56:59], v[44:47], v[60:63], v[56:59]
v_cmp_le_u32 vcc, 0xffff0000, v16
s_cbranch_vccnz L_red1
L_redb1:
s_nop 5
v_permlane32_swap_b32 v56, v58
v_permlane32_swap_b32 v57, v59
v_pk_add_f32 v[56:57], v[56:57], v[58:59]
v_cvt_pk_bf16_f32 v56, v56, v57
buffer_store_dword v56, v11, s[8:11], s34 offen
s_add_u32 s20, s30, 1024
s_add_u32 s21, s30, 8192
s_add_u32 s49, s29, s25
s_add_u32 s50, s29, s26
s_add_u32 s51, s29, s27
s_add_u32 s52, s30, 16384
s_mov_b32 m0, 17920
s_nop 1
s_barrier
s_branch L_gat1
L_red1:
s_waitcnt vmcnt(3)
v_mfma_f32_16x16x32_bf16 v[56:59], v[32:35], v[60:63], 0
v_max3_u32 v16, v32, v33, v34
v_max_u32 v16, v16, v35
s_waitcnt vmcnt(2)
v_mfma_f32_16x16x32_bf16 v[56:59], v[36:39], v[60:63], v[56:59]
v_max3_u32 v16, v16, v36, v37
v_max3_u32 v16, v16, v38, v39
s_waitcnt vmcnt(1)
v_mfma_f32_16x16x32_bf16 v[56:59], v[40:43], v[60:63], v[56:59]
v_max3_u32 v16, v16, v40, v41
v_max3_u32 v16, v16, v42, v43
s_waitcnt vmcnt(0)
v_mfma_f32_16x16x32_bf16 v[56:59], v[44:47], v[60:63], v[56:59]
v_max3_u32 v16, v16, v44, v45
v_max3_u32 v16, v16, v46, v47
v_cmp_le_u32 vcc, 0xffff0000, v16
s_cbranch_vccz L_redb1
L_red1b:
buffer_load_dwordx4 v[32:35], v1, s[8:11], s49 offen offset:0 sc1
buffer_load_dwordx4 v[36:39], v1, s[8:11], s49 offen offset:1024 sc1
buffer_load_dwordx4 v[40:43], v1, s[8:11], s49 offen offset:2048 sc1
buffer_load_dwordx4 v[44:47], v1, s[8:11], s49 offen offset:3072 sc1
s_add_u32 s22, s22, 1
s_cmp_gt_u32 s22, 40000
s_cbranch_scc1 L_end
s_waitcnt vmcnt(3)
v_mfma_f32_16x16x32_bf16 v[56:59], v[32:35], v[60:63], 0
v_max3_u32 v16, v32, v33, v34
v_max_u32 v16, v16, v35
s_waitcnt vmcnt(2)
v_mfma_f32_16x16x32_bf16 v[56:59], v[36:39], v[60:63], v[56:59]
v_max3_u32 v16, v16, v36, v37
v_max3_u32 v16, v16, v38, v39
s_waitcnt vmcnt(1)
v_mfma_f32_16x16x32_bf16 v[56:59], v[40:43], v[60:63], v[56:59]
v_max3_u32 v16, v16, v40, v41
v_max3_u32 v16, v16, v42, v43
s_waitcnt vmcnt(0)
v_mfma_f32_16x16x32_bf16 v[56:59], v[44:47], v[60:63], v[56:59]
v_max3_u32 v16, v16, v44, v45
v_max3_u32 v16, v16, v46, v47
v_cmp_le_u32 vcc, 0xffff0000, v16
s_cbranch_vccz L_redb1
s_branch L_red1b
L_g3r1:
buffer_load_dwordx4 v[16:19], v1, s[8:11], s6 offen sc1
s_add_u32 s22, s22, 1
s_waitcnt vmcnt(1)
v_max3_u32 v21, v16, v17, v18
v_max_u32 v21, v21, v19
v_cmp_le_u32 vcc, 0xffff0000, v21
s_cmp_gt_u32 s22, 40000
s_cbranch_vccz L_g31
s_cbranch_scc0 L_g3r1
s_branch L_end
L_ent2:
s_movk_i32 s4, -64
v_mov_b64 v[24:25], 0
v_mov_b64 v[26:27], 0
v_mov_b64 v[28:29], 0
v_mov_b64 v[30:31], 0
v_and_b32 v69, 0x380, v1
v_add_u32 v69, v69, v1
v_and_b32 v70, 0xf40, v1
v_add_u32 v70, v70, v1
v_bfe_u32 v71, v1, 7, 1
v_mad_i32_i24 v70, v71, s4, v70
v_mov_b64 v[64:65], -1
v_mov_b64 v[66:67], -1
v_xor_b32 v3, 16, v4
ds_read_b128 v[48:51], v2 offset:12288
ds_read_b128 v[52:55], v2 offset:13312
ds_read_b128 v[40:43], v2 offset:4096
ds_read_b128 v[44:47], v2 offset:5120
v_mov_b64 v[32:33], 0
v_mov_b64 v[34:35], 0
v_mov_b64 v[36:37], 0
v_mov_b64 v[38:39], 0
v_mov_b64 v[56:57], 0
v_mov_b64 v[58:59], 0
v_mov_b64 v[60:61], 0
v_mov_b64 v[62:63], 0
s_add_u32 s20, s30, 2048
s_add_u32 s21, s30, 8192
s_add_u32 s49, s29, s25
s_add_u32 s50, s29, s26
s_add_u32 s51, s29, s27
s_add_u32 s52, s30, 16384
s_mov_b32 m0, 19968
s_nop 0
buffer_load_dwordx4 v69, s[8:11], s20 offen sc1 lds
s_mov_b32 m0, 20864
s_nop 0
buffer_load_dwordx4 v69, s[8:11], s20 offen offset:128 sc1 lds
s_waitcnt vmcnt(0) lgkmcnt(0)
s_branch L_step2
L_gr2:
buffer_load_dwordx4 v[12:15], v1, s[8:11], s33 offen sc1
buffer_load_dword v20, v8, s[8:11], s7 offen sc1
buffer_load_dwordx4 v[16:19], v1, s[8:11], s6 offen sc1
s_add_u32 s22, s22, 1
s_cmp_gt_u32 s22, 40000
s_cbranch_scc1 L_end
buffer_load_dwordx4 v[16:19], v1, s[8:11], s6 offen sc1
v_mov_b64 v[24:25], 0
v_mov_b64 v[26:27], 0
v_mov_b64 v[28:29], 0
v_mov_b64 v[30:31], 0
v_mov_b64 v[32:33], 0
v_mov_b64 v[34:35], 0
v_mov_b64 v[36:37], 0
v_mov_b64 v[38:39], 0
v_mov_b64 v[56:57], 0
v_mov_b64 v[58:59], 0
v_mov_b64 v[60:61], 0
v_mov_b64 v[62:63], 0
s_waitcnt lgkmcnt(0)
s_branch L_step2
.p2align 3
L_gat2:
buffer_load_dwordx4 v[12:15], v1, s[8:11], s33 offen sc1
buffer_load_dword v20, v8, s[8:11], s7 offen sc1
buffer_load_dwordx4 v[16:19], v1, s[8:11], s6 offen sc1
s_add_u32 s20, s30, 2048
s_add_u32 s21, s30, 8192
s_add_u32 s49, s29, s25
s_add_u32 s50, s29, s26
s_add_u32 s51, s29, s27
s_add_u32 s52, s30, 16384
s_mov_b32 m0, 19968
ds_read_b128 v[40:43], v2 offset:4096
ds_read_b128 v[44:47], v2 offset:5120
v_mov_b64 v[32:33], 0
v_mov_b64 v[34:35], 0
v_mov_b64 v[36:37], 0
v_mov_b64 v[38:39], 0
v_mov_b64 v[56:57], 0
v_mov_b64 v[58:59], 0
v_mov_b64 v[60:61], 0
v_mov_b64 v[62:63], 0
s_nop 6
buffer_load_dwordx4 v[16:19], v1, s[8:11], s6 offen sc1
s_waitcnt lgkmcnt(0)
L_step2:
s_waitcnt vmcnt(3)
v_smfmac_f32_16x16x64_bf16 v[24:27], v[12:15], v[120:127], v0
ds_write_b128 v1, v[12:15] offset:6656
v_smfmac_f32_16x16x64_bf16 v[28:31], v[12:15], v[128:135], v0
s_waitcnt vmcnt(2)
v_max3_u32 v21, v12, v13, v14
v_max3_u32 v21, v21, v15, v20
v_cmp_le_u32 vcc, 0xffff0000, v21
v_smfmac_f32_16x16x64_bf16 v[32:35], v[12:15], v[136:143], v0
s_cbranch_vccnz L_gr2
s_waitcnt vmcnt(1)
v_max3_u32 v21, v16, v17, v18
v_max_u32 v21, v21, v19
v_cmp_le_u32 vcc, 0xffff0000, v21
ds_write_b32 v8, v20 offset:14848
v_smfmac_f32_16x16x64_bf16 v[56:59], v[12:15], a[64:71], v0
s_cbranch_vccnz L_g3r2
L_g32:
ds_write_b128 v1, v[16:19] offset:10752
v_smfmac_f32_16x16x64_bf16 v[60:63], v[12:15], a[72:79], v0
v_smfmac_f32_16x16x64_bf16 v[36:39], v[12:15], v[40:47], v0
v_smfmac_f32_16x16x64_bf16 v[24:27], v[16:19], v[216:223], v0
v_smfmac_f32_16x16x64_bf16 v[28:31], v[16:19], v[224:231], v0
s_waitcnt lgkmcnt(0)
s_barrier
ds_read_b128 v[20:23], v1 offset:4608
v_smfmac_f32_16x16x64_bf16 v[32:35], v[16:19], v[232:239], v0
ds_read_b128 v[12:15], v1 offset:5632
s_mov_b32 m0, 6272
buffer_store_dword v0, v11, s[8:11], s35 offen
v_smfmac_f32_16x16x64_bf16 v[56:59], v[16:19], a[128:135], v0
ds_read_b128 v[40:43], v2 offset:0
v_smfmac_f32_16x16x64_bf16 v[60:63], v[16:19], a[136:143], v0
ds_read_b128 v[44:47], v2 offset:1024
buffer_store_dwordx4 v[64:67], v1, s[8:11], s49 offen
v_smfmac_f32_16x16x64_bf16 v[36:39], v[16:19], v[48:55], v0
s_waitcnt vmcnt(2)
ds_read_b128 v[16:19], v1 offset:7680
s_waitcnt lgkmcnt(4)
v_smfmac_f32_16x16x64_bf16 v[24:27], v[20:23], v[72:79], v0
ds_read_b128 v[48:51], v2 offset:2048
buffer_store_dwordx4 v[64:67], v1, s[8:11], s50 offen
v_smfmac_f32_16x16x64_bf16 v[28:31], v[20:23], v[80:87], v0
ds_read_b128 v[52:55], v2 offset:3072
v_smfmac_f32_16x16x64_bf16 v[32:35], v[20:23], v[88:95], v0
s_waitcnt lgkmcnt(3)
buffer_store_dwordx4 v[64:67], v1, s[8:11], s51 offen
v_smfmac_f32_16x16x64_bf16 v[36:39], v[20:23], v[40:47], v0
ds_read_b128 v[20:23], v1 offset:8704
buffer_load_dwordx4 v[64:67], v70, s[8:11], s21 offen sc1
v_smfmac_f32_16x16x64_bf16 v[24:27], v[12:15], v[96:103], v0
ds_read_b128 v[40:43], v2 offset:6144
v_smfmac_f32_16x16x64_bf16 v[28:31], v[12:15], v[104:111], v0
ds_read_b128 v[44:47], v2 offset:7168
buffer_load_dwordx4 v[68:71], v70, s[8:11], s21 offen offset:256 sc1
v_smfmac_f32_16x16x64_bf16 v[32:35], v[12:15], v[112:119], v0
s_waitcnt lgkmcnt(3)
v_smfmac_f32_16x16x64_bf16 v[36:39], v[12:15], v[48:55], v0
ds_read_b128 v[12:15], v1 offset:9728
v_smfmac_f32_16x16x64_bf16 v[24:27], v[16:19], v[144:151], v0
ds_read_b128 v[48:51], v2 offset:8192
v_smfmac_f32_16x16x64_bf16 v[28:31], v[16:19], v[152:159], v0
ds_read_b128 v[52:55], v2 offset:9216
v_smfmac_f32_16x16x64_bf16 v[32:35], v[16:19], v[160:167], v0
s_waitcnt lgkmcnt(3)
v_smfmac_f32_16x16x64_bf16 v[36:39], v[16:19], v[40:47], v0
ds_read_b128 v[16:19], v1 offset:11776
v_smfmac_f32_16x16x64_bf16 v[24:27], v[20:23], v[168:175], v0
ds_read_b128 v[40:43], v2 offset:10240
v_smfmac_f32_16x16x64_bf16 v[28:31], v[20:23], v[176:183], v0
ds_read_b128 v[44:47], v2 offset:11264
v_smfmac_f32_16x16x64_bf16 v[32:35], v[20:23], v[184:191], v0
s_waitcnt lgkmcnt(3)
v_smfmac_f32_16x16x64_bf16 v[36:39], v[20:23], v[48:55], v0
ds_read_b128 v[20:23], v1 offset:12800
v_smfmac_f32_16x16x64_bf16 v[24:27], v[12:15], v[192:199], v0
ds_read_b128 v[48:51], v2 offset:14336
v_smfmac_f32_16x16x64_bf16 v[28:31], v[12:15], v[200:207], v0
ds_read_b128 v[52:55], v2 offset:15360
v_smfmac_f32_16x16x64_bf16 v[32:35], v[12:15], v[208:215], v0
s_waitcnt lgkmcnt(3)
v_smfmac_f32_16x16x64_bf16 v[36:39], v[12:15], v[40:47], v0
ds_read_b128 v[12:15], v1 offset:4608
v_smfmac_f32_16x16x64_bf16 v[24:27], v[16:19], v[240:247], v0
ds_read_b128 v[40:43], v2 offset:16384
v_smfmac_f32_16x16x64_bf16 v[28:31], v[16:19], v[248:255], v0
s_waitcnt lgkmcnt(4)
ds_read_b128 v[44:47], v2 offset:17408
v_smfmac_f32_16x16x64_bf16 v[24:27], v[20:23], a[8:15], v0
v_smfmac_f32_16x16x64_bf16 v[28:31], v[20:23], a[16:23], v0
v_smfmac_f32_16x16x64_bf16 v[32:35], v[16:19], a[0:7], v0
s_waitcnt lgkmcnt(3)
v_smfmac_f32_16x16x64_bf16 v[36:39], v[16:19], v[48:55], v0
ds_read_b128 v[16:19], v1 offset:5632
s_nop 2
v_add_f32 v24, v24, v25
v_smfmac_f32_16x16x64_bf16 v[32:35], v[20:23], a[24:31], v0
s_waitcnt lgkmcnt(1)
ds_read_b128 v[48:51], v1 offset:17920
v_add_f32 v26, v26, v27
v_smfmac_f32_16x16x64_bf16 v[36:39], v[20:23], v[40:47], v0
ds_read_b128 v[52:55], v1 offset:19968
v_add_f32 v28, v28, v29
v_smfmac_f32_16x16x64_bf16 v[56:59], v[12:15], a[32:39], v0
ds_read_b128 v[20:23], v1 offset:7680
v_add_f32 v30, v30, v31
v_cvt_pk_bf16_f32 v24, v24, v28
ds_write_b32 v4, v24 offset:2176
v_smfmac_f32_16x16x64_bf16 v[60:63], v[12:15], a[40:47], v0
s_waitcnt lgkmcnt(4)
ds_read_b128 v[12:15], v1 offset:8704
v_cvt_pk_bf16_f32 v26, v26, v30
ds_write_b32 v3, v26 offset:2176
v_add_f32 v32, v32, v33
v_smfmac_f32_16x16x64_bf16 v[56:59], v[16:19], a[48:55], v0
ds_read_b128 v[40:43], v1 offset:13824
v_add_f32 v34, v34, v35
v_add_f32 v36, v36, v37
v_add_f32 v38, v38, v39
v_smfmac_f32_16x16x64_bf16 v[60:63], v[16:19], a[56:63], v0
s_waitcnt lgkmcnt(4)
ds_read_b128 v[16:19], v1 offset:9728
v_cvt_pk_bf16_f32 v32, v32, v36
ds_write_b32 v4, v32 offset:0
v_cvt_pk_bf16_f32 v34, v34, v38
v_smfmac_f32_16x16x64_bf16 v[56:59], v[20:23], a[80:87], v0
ds_read_b128 v[44:47], v1 offset:15872
ds_write_b32 v3, v34 offset:0
v_smfmac_f32_16x16x64_bf16 v[60:63], v[20:23], a[88:95], v0
s_waitcnt lgkmcnt(6)
ds_read_b128 v[20:23], v1 offset:11776
v_smfmac_f32_16x16x64_bf16 v[56:59], v[12:15], a[96:103], v0
v_smfmac_f32_16x16x64_bf16 v[60:63], v[12:15], a[104:111], v0
s_waitcnt lgkmcnt(4)
ds_read_b128 v[12:15], v1 offset:12800
v_smfmac_f32_16x16x64_bf16 v[56:59], v[16:19], a[112:119], v0
v_smfmac_f32_16x16x64_bf16 v[60:63], v[16:19], a[120:127], v0
s_waitcnt lgkmcnt(1)
v_smfmac_f32_16x16x64_bf16 v[56:59], v[20:23], a[144:151], v0
s_barrier
ds_read_b128 v[32:35], v5 offset:1024
v_smfmac_f32_16x16x64_bf16 v[60:63], v[20:23], a[152:159], v0
s_waitcnt lgkmcnt(1)
ds_read_b128 v[36:39], v5 offset:1536
v_smfmac_f32_16x16x64_bf16 v[56:59], v[12:15], a[160:167], v0
ds_read_b128 v[24:27], v5 offset:0
v_smfmac_f32_16x16x64_bf16 v[60:63], v[12:15], a[168:175], v0
s_waitcnt lgkmcnt(2)
ds_read_b128 v[28:31], v5 offset:512
v_mfma_f32_16x16x32_bf16 v[16:19], v[48:51], v[32:35], 0
s_waitcnt lgkmcnt(2)
ds_read_b128 v[48:51], v1 offset:18944
v_mfma_f32_16x16x32_bf16 v[16:19], v[52:55], v[36:39], v[16:19]
s_waitcnt lgkmcnt(2)
ds_read_b128 v[52:55], v1 offset:20992
v_mfma_f32_16x16x32_bf16 v[16:19], v[40:43], v[24:27], v[16:19]
ds_read_b128 v[40:43], v1 offset:14848
s_mov_b64 exec, s[86:87]
buffer_store_dwordx4 v[32:35], v5, s[8:11], s31 offen offset:1024 sc1
s_mov_b64 exec, -1
s_waitcnt lgkmcnt(3)
v_mfma_f32_16x16x32_bf16 v[16:19], v[44:47], v[28:31], v[16:19]
ds_read_b128 v[44:47], v1 offset:16896
v_mfma_f32_16x16x32_bf16 v[20:23], v[32:35], v[32:35], 0
v_add_f32 v56, v56, v57
v_add_f32 v58, v58, v59
v_mfma_f32_16x16x32_bf16 v[20:23], v[36:39], v[36:39], v[20:23]
v_add_f32 v60, v60, v61
v_add_f32 v62, v62, v63
v_mfma_f32_16x16x32_bf16 v[20:23], v[24:27], v[24:27], v[20:23]
v_cvt_pk_bf16_f32 v56, v56, v58
v_cvt_pk_bf16_f32 v57, v60, v62
v_mfma_f32_16x16x32_bf16 v[20:23], v[28:31], v[28:31], v[20:23]
s_waitcnt lgkmcnt(3)
v_lshrrev_b32 v58, 1, v1
v_max3_f32 v59, v16, v17, v18
v_mfma_f32_16x16x32_bf16 v[12:15], v[48:51], v[32:35], 0
s_waitcnt lgkmcnt(2)
ds_read_b128 v[48:51], v2 offset:20480
v_mfma_f32_16x16x32_bf16 v[12:15], v[52:55], v[36:39], v[12:15]
s_waitcnt lgkmcnt(2)
ds_read_b128 v[52:55], v2 offset:21504
v_mfma_f32_16x16x32_bf16 v[12:15], v[40:43], v[24:27], v[12:15]
s_waitcnt lgkmcnt(2)
ds_read_b128 v[40:43], v2 offset:18432
buffer_store_dwordx2 v[56:57], v58, s[8:11], s31 offen offset:2048 sc1
v_mfma_f32_16x16x32_bf16 v[12:15], v[44:47], v[28:31], v[12:15]
ds_read_b128 v[44:47], v2 offset:19456
v_max3_f32 v59, v59, v19, v20
v_max_f32 v59, v59, v21
v_mov_b32 v60, s53
s_add_u32 s49, s28, s23
v_mov_b32 v61, s53
s_add_u32 s50, s28, 65536
v_mov_b32 v62, s53
ds_read_b128 v[32:35], v2 offset:22528
v_mov_b32 v63, s53
v_max3_f32 v59, v59, v12, v13
v_max3_f32 v22, v59, v14, v15
v_max3_f32 v59, v59, v14, v15
s_add_u32 s51, s28, 131072
s_add_u32 s52, s28, 196608
v_permlane32_swap_b32 v22, v59
v_max_f32 v23, v59, v22
v_max_f32 v59, v59, v22
v_mov_b32 v22, 0
ds_read_b128 v[36:39], v2 offset:23552
v_permlane16_swap_b32 v23, v59
v_max_f32 v59, v59, v23
v_mul_f32 v58, s18, v59
v_pk_fma_f32 v[20:21], v[20:21], s[18:19], v[58:59] op_sel_hi:[1,0,0] neg_lo:[0,0,1] neg_hi:[0,0,1]
v_pk_fma_f32 v[16:17], v[16:17], s[18:19], v[58:59] op_sel_hi:[1,0,0] neg_lo:[0,0,1] neg_hi:[0,0,1]
v_pk_fma_f32 v[18:19], v[18:19], s[18:19], v[58:59] op_sel_hi:[1,0,0] neg_lo:[0,0,1] neg_hi:[0,0,1]
v_pk_fma_f32 v[12:13], v[12:13], s[18:19], v[58:59] op_sel_hi:[1,0,0] neg_lo:[0,0,1] neg_hi:[0,0,1]
v_pk_fma_f32 v[14:15], v[14:15], s[18:19], v[58:59] op_sel_hi:[1,0,0] neg_lo:[0,0,1] neg_hi:[0,0,1]
v_exp_f32 v20, v20
v_exp_f32 v21, v21
v_exp_f32 v16, v16
v_cvt_pk_bf16_f32 v23, v20, v21
v_cvt_pk_bf16_f32 v20, v20, v21
v_mov_b32 v21, 0
v_exp_f32 v17, v17
v_exp_f32 v18, v18
v_mfma_f32_16x16x16_bf16 v[24:27], v[56:57], v[20:21], 0
v_exp_f32 v19, v19
v_mfma_f32_16x16x16_bf16 v[28:31], v[56:57], v[22:23], 0
v_exp_f32 v12, v12
v_exp_f32 v13, v13
v_cvt_pk_bf16_f32 v16, v16, v17
v_cvt_pk_bf16_f32 v17, v18, v19
v_exp_f32 v14, v14
v_exp_f32 v15, v15
v_cvt_pk_bf16_f32 v18, v12, v13
v_cvt_pk_bf16_f32 v19, v14, v15
v_mfma_f32_16x16x16_bf16 v[12:15], v[60:61], v[20:21], 0
s_waitcnt vmcnt(2)
v_mfma_f32_16x16x32_bf16 v[12:15], v[60:63], v[16:19], v[12:15]
v_mov_b32 v20, 0
v_mov_b32 v23, 0
v_mfma_f32_16x16x32_bf16 v[24:27], v[64:67], v[16:19], v[24:27]
s_nop 1
v_mfma_f32_16x16x32_bf16 v[28:31], v[68:71], v[16:19], v[28:31]
v_mov_b32 v16, 0
v_mov_b32 v17, 0
v_rcp_f32 v12, v12
v_mov_b32 v18, 0
v_mov_b32 v19, 0
v_pk_mul_f32 v[24:25], v[24:25], v[12:13] op_sel_hi:[1,0]
v_pk_mul_f32 v[26:27], v[26:27], v[12:13] op_sel_hi:[1,0]
v_mov_b32 v15, 0
v_pk_mul_f32 v[28:29], v[28:29], v[12:13] op_sel_hi:[1,0]
v_pk_mul_f32 v[30:31], v[30:31], v[12:13] op_sel_hi:[1,0]
v_cvt_pk_bf16_f32 v24, v24, v28
v_cvt_pk_bf16_f32 v25, v25, v29
v_cvt_pk_bf16_f32 v26, v26, v30
v_cvt_pk_bf16_f32 v27, v27, v31
v_mfma_f32_16x16x32_bf16 v[56:59], v[20:23], v[20:23], 0
ds_write_b128 v7, v[24:27]
v_mfma_f32_16x16x32_bf16 v[60:63], v[20:23], v[20:23], 0
v_mov_b32 v12, 0
v_mov_b32 v13, 0
v_mov_b32 v14, 0
v_mov_b32 v3, 6528
v_and_b32 v8, 0x380, v1
v_add_u32 v8, v8, v1
v_mfma_f32_16x16x32_bf16 v[64:67], v[20:23], v[20:23], 0
s_add_u32 s20, s30, 18432
s_mov_b32 m0, 19968
s_cmp_eq_u32 s19, 63
s_cbranch_scc1 L_texit
s_waitcnt lgkmcnt(0)
s_barrier
ds_read_b128 v[24:27], v1 offset:2176
v_mfma_f32_16x16x32_bf16 v[68:71], v[20:23], v[20:23], 0
ds_read_b128 v[28:31], v1 offset:3200
s_nop 2
v_mfma_f32_16x16x32_bf16 v[68:71], v[20:23], v[20:23], 0
s_waitcnt lgkmcnt(1)
v_smfmac_f32_16x16x64_bf16 v[12:15], v[24:27], a[248:255], v0
buffer_load_dwordx4 v8, s[8:11], s20 offen sc1 lds
v_smfmac_f32_16x16x64_bf16 v[16:19], v[24:27], a[176:183], v0
s_mov_b32 m0, 20864
s_waitcnt lgkmcnt(0)
v_smfmac_f32_16x16x64_bf16 v[12:15], v[28:31], v[40:47], v0
ds_read_b128 v[40:43], v2 offset:24576
v_smfmac_f32_16x16x64_bf16 v[16:19], v[28:31], v[48:55], v0
ds_read_b128 v[44:47], v2 offset:25600
buffer_load_dwordx4 v8, s[8:11], s20 offen offset:128 sc1 lds
v_smfmac_f32_16x16x64_bf16 v[20:23], v[24:27], a[184:191], v0
ds_read_b128 v[48:51], v2 offset:26624
s_nop 1
v_add_f32 v12, v12, v13
v_add_f32 v14, v14, v15
v_cvt_pk_bf16_f32 v12, v12, v14
v_smfmac_f32_16x16x64_bf16 v[20:23], v[28:31], v[32:39], v0
ds_read_b128 v[52:55], v2 offset:27648
buffer_store_dword v12, v10, s[8:11], s28 offen
v_add_f32 v16, v16, v17
v_add_f32 v18, v18, v19
v_smfmac_f32_16x16x64_bf16 v[56:59], v[24:27], a[192:199], v0
s_waitcnt lgkmcnt(2)
ds_read_b128 v[32:35], v2 offset:28672
v_cvt_pk_bf16_f32 v16, v16, v18
v_smfmac_f32_16x16x64_bf16 v[56:59], v[28:31], v[40:47], v0
ds_read_b128 v[36:39], v2 offset:29696
v_add_f32 v20, v20, v21
v_add_f32 v22, v22, v23
v_cvt_pk_bf16_f32 v17, v20, v22
v_smfmac_f32_16x16x64_bf16 v[60:63], v[24:27], a[200:207], v0
s_waitcnt lgkmcnt(2)
ds_read_b128 v[12:15], v3
buffer_store_dwordx2 v[16:17], v9, s[8:11], s28 offen
v_smfmac_f32_16x16x64_bf16 v[60:63], v[28:31], v[48:55], v0
ds_read_b128 v[40:43], v2 offset:30720
v_add_f32 v56, v56, v57
v_add_f32 v58, v58, v59
v_cvt_pk_bf16_f32 v56, v56, v58
v_smfmac_f32_16x16x64_bf16 v[64:67], v[24:27], a[208:215], v0
s_waitcnt lgkmcnt(2)
ds_read_b128 v[44:47], v2 offset:31744
v_smfmac_f32_16x16x64_bf16 v[64:67], v[28:31], v[32:39], v0
ds_read_b128 v[20:23], v3
v_add_f32 v60, v60, v61
v_add_f32 v62, v62, v63
v_cvt_pk_bf16_f32 v57, v60, v62
v_smfmac_f32_16x16x64_bf16 v[68:71], v[24:27], a[216:223], v0
s_waitcnt lgkmcnt(1)
ds_read_b128 v[48:51], v2 offset:32768
buffer_store_dwordx2 v[56:57], v9, s[8:11], s50 offen
v_smfmac_f32_16x16x64_bf16 v[68:71], v[28:31], v[40:47], v0
ds_read_b128 v[52:55], v2 offset:33792
v_add_f32 v64, v64, v65
v_add_f32 v66, v66, v67
v_cvt_pk_bf16_f32 v64, v64, v66
v_smfmac_f32_16x16x64_bf16 v[12:15], v[24:27], a[224:231], v0
s_waitcnt lgkmcnt(0)
v_smfmac_f32_16x16x64_bf16 v[12:15], v[28:31], v[48:55], v0
s_nop 0
v_add_f32 v68, v68, v69
v_add_f32 v70, v70, v71
v_cvt_pk_bf16_f32 v65, v68, v70
v_smfmac_f32_16x16x64_bf16 v[20:23], v[24:27], a[232:239], v0
buffer_store_dwordx2 v[64:65], v9, s[8:11], s51 offen
v_smfmac_f32_16x16x64_bf16 v[20:23], v[28:31], a[240:247], v0
s_nop 0
v_add_f32 v12, v12, v13
v_add_f32 v14, v14, v15
v_cvt_pk_bf16_f32 v12, v12, v14
s_nop 3
v_add_f32 v20, v20, v21
v_add_f32 v22, v22, v23
v_cvt_pk_bf16_f32 v13, v20, v22
buffer_store_dwordx2 v[12:13], v9, s[8:11], s52 offen
s_cmp_eq_u32 s48, 0
s_cbranch_scc1 L_nojob2
L_lt2:
buffer_load_dwordx4 v[32:35], v1, s[8:11], s49 offen offset:0 sc1
buffer_load_dwordx4 v[36:39], v1, s[8:11], s49 offen offset:1024 sc1
buffer_load_dwordx4 v[40:43], v1, s[8:11], s49 offen offset:2048 sc1
buffer_load_dwordx4 v[44:47], v1, s[8:11], s49 offen offset:3072 sc1
s_add_u32 s19, s19, 1
s_mov_b32 s20, s28
s_mov_b32 s28, s29
s_mov_b32 s29, s20
s_and_b32 s20, s19, 3
s_lshl_b32 s20, s20, 14
s_add_u32 s33, s20, 110100480
s_add_u32 s34, s20, s24
s_xor_b32 s20, s20, 32768
s_add_u32 s35, s20, s24
s_add_u32 s30, s30, 16384
s_add_u32 s31, s31, 131072
s_add_u32 s6, s33, 4096
s_add_u32 s7, s33, 8192
s_mov_b32 s22, 0
v_mov_b64 v[24:25], 0
v_mov_b64 v[26:27], 0
v_mov_b64 v[28:29], 0
v_mov_b64 v[30:31], 0
v_and_b32 v70, 0xf40, v1
v_add_u32 v70, v70, v1
v_bfe_u32 v71, v1, 7, 1
v_mad_i32_i24 v70, v71, s4, v70
v_mov_b64 v[64:65], -1
v_mov_b64 v[66:67], -1
v_xor_b32 v3, 16, v4
ds_read_b128 v[48:51], v2 offset:12288
ds_read_b128 v[52:55], v2 offset:13312
v_lshrrev_b32 v8, 2, v1
v_mov_b32 v56, 0x3f80
v_cndmask_b32 v56, v56, 1.0, s[44:45]
v_cndmask_b32 v60, 0, v56, s[36:37]
v_cndmask_b32 v61, 0, v56, s[38:39]
v_cndmask_b32 v62, 0, v56, s[40:41]
v_cndmask_b32 v63, 0, v56, s[42:43]
s_waitcnt vmcnt(3)
s_nop 0
v_mfma_f32_16x16x32_bf16 v[56:59], v[32:35], v[60:63], 0
v_max3_u32 v16, v32, v33, v34
v_max_u32 v16, v16, v35
s_waitcnt vmcnt(2)
v_mfma_f32_16x16x32_bf16 v[56:59], v[36:39], v[60:63], v[56:59]
v_max3_u32 v16, v16, v36, v37
v_max3_u32 v16, v16, v38, v39
s_waitcnt vmcnt(1)
v_mfma_f32_16x16x32_bf16 v[56:59], v[40:43], v[60:63], v[56:59]
v_max3_u32 v16, v16, v40, v41
v_max3_u32 v16, v16, v42, v43
s_waitcnt vmcnt(0)
v_mfma_f32_16x16x32_bf16 v[56:59], v[44:47], v[60:63], v[56:59]
v_max3_u32 v16, v16, v44, v45
v_max3_u32 v16, v16, v46, v47
v_cmp_le_u32 vcc, 0xffff0000, v16
s_cbranch_vccnz L_red2
L_redb2:
s_nop 3
v_permlane32_swap_b32 v56, v58
v_permlane32_swap_b32 v57, v59
v_pk_add_f32 v[56:57], v[56:57], v[58:59]
v_cvt_pk_bf16_f32 v56, v56, v57
buffer_store_dword v56, v11, s[8:11], s34 offen
s_add_u32 s20, s30, 2048
s_add_u32 s21, s30, 8192
s_add_u32 s49, s29, s25
s_add_u32 s50, s29, s26
s_add_u32 s51, s29, s27
s_add_u32 s52, s30, 16384
s_mov_b32 m0, 19968
s_nop 1
s_barrier
s_branch L_gat2
L_red2:
L_red2b:
buffer_load_dwordx4 v[32:35], v1, s[8:11], s49 offen offset:0 sc1
buffer_load_dwordx4 v[36:39], v1, s[8:11], s49 offen offset:1024 sc1
buffer_load_dwordx4 v[40:43], v1, s[8:11], s49 offen offset:2048 sc1
buffer_load_dwordx4 v[44:47], v1, s[8:11], s49 offen offset:3072 sc1
s_add_u32 s22, s22, 1
s_cmp_gt_u32 s22, 40000
s_cbranch_scc1 L_end
s_waitcnt vmcnt(3)
v_mfma_f32_16x16x32_bf16 v[56:59], v[32:35], v[60:63], 0
v_max3_u32 v16, v32, v33, v34
v_max_u32 v16, v16, v35
s_waitcnt vmcnt(2)
v_mfma_f32_16x16x32_bf16 v[56:59], v[36:39], v[60:63], v[56:59]
v_max3_u32 v16, v16, v36, v37
v_max3_u32 v16, v16, v38, v39
s_waitcnt vmcnt(1)
v_mfma_f32_16x16x32_bf16 v[56:59], v[40:43], v[60:63], v[56:59]
v_max3_u32 v16, v16, v40, v41
v_max3_u32 v16, v16, v42, v43
s_waitcnt vmcnt(0)
v_mfma_f32_16x16x32_bf16 v[56:59], v[44:47], v[60:63], v[56:59]
v_max3_u32 v16, v16, v44, v45
v_max3_u32 v16, v16, v46, v47
v_cmp_le_u32 vcc, 0xffff0000, v16
s_cbranch_vccz L_redb2
s_branch L_red2b
L_g3r2:
buffer_load_dwordx4 v[16:19], v1, s[8:11], s6 offen sc1
s_add_u32 s22, s22, 1
s_waitcnt vmcnt(1)
v_max3_u32 v21, v16, v17, v18
v_max_u32 v21, v21, v19
v_cmp_le_u32 vcc, 0xffff0000, v21
s_cmp_gt_u32 s22, 40000
s_cbranch_vccz L_g32
s_cbranch_scc0 L_g3r2
s_branch L_end
L_nojob2:
s_add_u32 s19, s19, 1
s_mov_b32 s20, s28
s_mov_b32 s28, s29
s_mov_b32 s29, s20
s_and_b32 s20, s19, 3
s_lshl_b32 s20, s20, 14
s_add_u32 s33, s20, 110100480
s_add_u32 s34, s20, s24
s_xor_b32 s20, s20, 32768
s_add_u32 s35, s20, s24
s_add_u32 s30, s30, 16384
s_add_u32 s31, s31, 131072
s_add_u32 s6, s33, 4096
s_add_u32 s7, s33, 8192
s_mov_b32 s22, 0
v_mov_b64 v[24:25], 0
v_mov_b64 v[26:27], 0
v_mov_b64 v[28:29], 0
v_mov_b64 v[30:31], 0
v_and_b32 v70, 0xf40, v1
v_add_u32 v70, v70, v1
v_bfe_u32 v71, v1, 7, 1
v_mad_i32_i24 v70, v71, s4, v70
v_mov_b64 v[64:65], -1
v_mov_b64 v[66:67], -1
v_xor_b32 v3, 16, v4
ds_read_b128 v[48:51], v2 offset:12288
ds_read_b128 v[52:55], v2 offset:13312
v_lshrrev_b32 v8, 2, v1
s_barrier
s_branch L_gat2
L_ent3:
s_movk_i32 s4, -64
v_mov_b64 v[24:25], 0
v_mov_b64 v[26:27], 0
v_mov_b64 v[28:29], 0
v_mov_b64 v[30:31], 0
v_and_b32 v69, 0x380, v1
v_add_u32 v69, v69, v1
v_and_b32 v70, 0xf40, v1
v_add_u32 v70, v70, v1
v_bfe_u32 v71, v1, 7, 1
v_mad_i32_i24 v70, v71, s4, v70
v_mov_b64 v[64:65], -1
v_mov_b64 v[66:67], -1
v_xor_b32 v3, 16, v4
ds_read_b128 v[48:51], v2 offset:14336
ds_read_b128 v[52:55], v2 offset:15360
ds_read_b128 v[40:43], v2 offset:6144
ds_read_b128 v[44:47], v2 offset:7168
v_mov_b64 v[32:33], 0
v_mov_b64 v[34:35], 0
v_mov_b64 v[36:37], 0
v_mov_b64 v[38:39], 0
v_mov_b64 v[56:57], 0
v_mov_b64 v[58:59], 0
v_mov_b64 v[60:61], 0
v_mov_b64 v[62:63], 0
s_add_u32 s20, s30, 3072
s_add_u32 s21, s30, 8192
s_add_u32 s49, s29, s25
s_add_u32 s50, s29, s26
s_add_u32 s51, s29, s27
s_add_u32 s52, s30, 16384
s_mov_b32 m0, 22016
s_nop 0
buffer_load_dwordx4 v69, s[8:11], s20 offen sc1 lds
s_mov_b32 m0, 22912
s_nop 0
buffer_load_dwordx4 v69, s[8:11], s20 offen offset:128 sc1 lds
s_waitcnt vmcnt(0) lgkmcnt(0)
s_branch L_step3
L_gr3:
buffer_load_dwordx4 v[12:15], v1, s[8:11], s33 offen sc1
buffer_load_dword v20, v8, s[8:11], s7 offen sc1
buffer_load_dwordx4 v[16:19], v1, s[8:11], s6 offen sc1
s_add_u32 s22, s22, 1
s_cmp_gt_u32 s22, 40000
s_cbranch_scc1 L_end
buffer_load_dwordx4 v[16:19], v1, s[8:11], s6 offen sc1
v_mov_b64 v[24:25], 0
v_mov_b64 v[26:27], 0
v_mov_b64 v[28:29], 0
v_mov_b64 v[30:31], 0
v_mov_b64 v[32:33], 0
v_mov_b64 v[34:35], 0
v_mov_b64 v[36:37], 0
v_mov_b64 v[38:39], 0
v_mov_b64 v[56:57], 0
v_mov_b64 v[58:59], 0
v_mov_b64 v[60:61], 0
v_mov_b64 v[62:63], 0
s_waitcnt lgkmcnt(0)
s_branch L_step3
.p2align 3
L_gat3:
buffer_load_dwordx4 v[12:15], v1, s[8:11], s33 offen sc1
buffer_load_dword v20, v8, s[8:11], s7 offen sc1
buffer_load_dwordx4 v[16:19], v1, s[8:11], s6 offen sc1
s_add_u32 s20, s30, 3072
s_add_u32 s21, s30, 8192
s_add_u32 s49, s29, s25
s_add_u32 s50, s29, s26
s_add_u32 s51, s29, s27
s_add_u32 s52, s30, 16384
s_mov_b32 m0, 22016
ds_read_b128 v[40:43], v2 offset:6144
ds_read_b128 v[44:47], v2 offset:7168
v_mov_b64 v[32:33], 0
v_mov_b64 v[34:35], 0
v_mov_b64 v[36:37], 0
v_mov_b64 v[38:39], 0
v_mov_b64 v[56:57], 0
v_mov_b64 v[58:59], 0
v_mov_b64 v[60:61], 0
v_mov_b64 v[62:63], 0
s_nop 6
buffer_load_dwordx4 v[16:19], v1, s[8:11], s6 offen sc1
s_waitcnt lgkmcnt(0)
L_step3:
s_waitcnt vmcnt(3)
v_smfmac_f32_16x16x64_bf16 v[24:27], v[12:15], v[144:151], v0
ds_write_b128 v1, v[12:15] offset:6656
v_smfmac_f32_16x16x64_bf16 v[28:31], v[12:15], v[152:159], v0
s_waitcnt vmcnt(2)
v_max3_u32 v21, v12, v13, v14
v_max3_u32 v21, v21, v15, v20
v_cmp_le_u32 vcc, 0xffff0000, v21
v_smfmac_f32_16x16x64_bf16 v[32:35], v[12:15], v[160:167], v0
s_cbranch_vccnz L_gr3
s_waitcnt vmcnt(1)
v_max3_u32 v21, v16, v17, v18
v_max_u32 v21, v21, v19
v_cmp_le_u32 vcc, 0xffff0000, v21
ds_write_b32 v8, v20 offset:14848
v_smfmac_f32_16x16x64_bf16 v[56:59], v[12:15], a[80:87], v0
s_cbranch_vccnz L_g3r3
L_g33:
ds_write_b128 v1, v[16:19] offset:10752
v_smfmac_f32_16x16x64_bf16 v[60:63], v[12:15], a[88:95], v0
v_smfmac_f32_16x16x64_bf16 v[36:39], v[12:15], v[40:47], v0
v_smfmac_f32_16x16x64_bf16 v[24:27], v[16:19], v[240:247], v0
v_smfmac_f32_16x16x64_bf16 v[28:31], v[16:19], v[248:255], v0
s_waitcnt lgkmcnt(0)
s_barrier
ds_read_b128 v[20:23], v1 offset:3584
v_smfmac_f32_16x16x64_bf16 v[32:35], v[16:19], a[0:7], v0
ds_read_b128 v[12:15], v1 offset:4608
s_mov_b32 m0, 6272
v_smfmac_f32_16x16x64_bf16 v[56:59], v[16:19], a[144:151], v0
ds_read_b128 v[40:43], v2 offset:0
v_smfmac_f32_16x16x64_bf16 v[60:63], v[16:19], a[152:159], v0
ds_read_b128 v[44:47], v2 offset:1024
buffer_store_dwordx4 v[64:67], v1, s[8:11], s49 offen
v_smfmac_f32_16x16x64_bf16 v[36:39], v[16:19], v[48:55], v0
s_waitcnt vmcnt(1)
ds_read_b128 v[16:19], v1 offset:5632
s_waitcnt lgkmcnt(4)
v_smfmac_f32_16x16x64_bf16 v[24:27], v[20:23], v[72:79], v0
ds_read_b128 v[48:51], v2 offset:2048
buffer_store_dwordx4 v[64:67], v1, s[8:11], s50 offen
v_smfmac_f32_16x16x64_bf16 v[28:31], v[20:23], v[80:87], v0
ds_read_b128 v[52:55], v2 offset:3072
v_smfmac_f32_16x16x64_bf16 v[32:35], v[20:23], v[88:95], v0
s_waitcnt lgkmcnt(3)
buffer_store_dwordx4 v[64:67], v1, s[8:11], s51 offen
v_smfmac_f32_16x16x64_bf16 v[36:39], v[20:23], v[40:47], v0
ds_read_b128 v[20:23], v1 offset:7680
buffer_load_dwordx4 v[64:67], v70, s[8:11], s21 offen sc1
v_smfmac_f32_16x16x64_bf16 v[24:27], v[12:15], v[96:103], v0
ds_read_b128 v[40:43], v2 offset:4096
v_smfmac_f32_16x16x64_bf16 v[28:31], v[12:15], v[104:111], v0
ds_read_b128 v[44:47], v2 offset:5120
buffer_load_dwordx4 v[68:71], v70, s[8:11], s21 offen offset:256 sc1
v_smfmac_f32_16x16x64_bf16 v[32:35], v[12:15], v[112:119], v0
s_waitcnt lgkmcnt(3)
v_smfmac_f32_16x16x64_bf16 v[36:39], v[12:15], v[48:55], v0
ds_read_b128 v[12:15], v1 offset:8704
v_smfmac_f32_16x16x64_bf16 v[24:27], v[16:19], v[120:127], v0
ds_read_b128 v[48:51], v2 offset:8192
v_mov_b32 v11, s19
v_smfmac_f32_16x16x64_bf16 v[28:31], v[16:19], v[128:135], v0
ds_read_b128 v[52:55], v2 offset:9216
v_smfmac_f32_16x16x64_bf16 v[32:35], v[16:19], v[136:143], v0
s_mov_b64 exec, 1
buffer_store_dword v11, v8, s[8:11], s83 offen sc1
s_mov_b64 exec, -1
s_waitcnt lgkmcnt(3)
v_smfmac_f32_16x16x64_bf16 v[36:39], v[16:19], v[40:47], v0
ds_read_b128 v[16:19], v1 offset:9728
buffer_load_dword v11, v8, s[8:11], s82 offen sc1
v_smfmac_f32_16x16x64_bf16 v[24:27], v[20:23], v[168:175], v0
ds_read_b128 v[40:43], v2 offset:10240
v_smfmac_f32_16x16x64_bf16 v[28:31], v[20:23], v[176:183], v0
ds_read_b128 v[44:47], v2 offset:11264
v_smfmac_f32_16x16x64_bf16 v[32:35], v[20:23], v[184:191], v0
s_waitcnt lgkmcnt(3)
v_smfmac_f32_16x16x64_bf16 v[36:39], v[20:23], v[48:55], v0
ds_read_b128 v[20:23], v1 offset:11776
v_smfmac_f32_16x16x64_bf16 v[24:27], v[12:15], v[192:199], v0
ds_read_b128 v[48:51], v2 offset:12288
v_smfmac_f32_16x16x64_bf16 v[28:31], v[12:15], v[200:207], v0
ds_read_b128 v[52:55], v2 offset:13312
v_smfmac_f32_16x16x64_bf16 v[32:35], v[12:15], v[208:215], v0
s_waitcnt lgkmcnt(3)
v_smfmac_f32_16x16x64_bf16 v[36:39], v[12:15], v[40:47], v0
ds_read_b128 v[12:15], v1 offset:3584
v_smfmac_f32_16x16x64_bf16 v[24:27], v[16:19], v[216:223], v0
ds_read_b128 v[40:43], v2 offset:16384
v_smfmac_f32_16x16x64_bf16 v[28:31], v[16:19], v[224:231], v0
s_waitcnt lgkmcnt(4)
ds_read_b128 v[44:47], v2 offset:17408
v_smfmac_f32_16x16x64_bf16 v[24:27], v[20:23], a[8:15], v0
v_smfmac_f32_16x16x64_bf16 v[28:31], v[20:23], a[16:23], v0
v_smfmac_f32_16x16x64_bf16 v[32:35], v[16:19], v[232:239], v0
s_waitcnt lgkmcnt(3)
v_smfmac_f32_16x16x64_bf16 v[36:39], v[16:19], v[48:55], v0
ds_read_b128 v[16:19], v1 offset:4608
s_nop 2
v_add_f32 v24, v24, v25
v_smfmac_f32_16x16x64_bf16 v[32:35], v[20:23], a[24:31], v0
s_waitcnt lgkmcnt(1)
ds_read_b128 v[52:55], v1 offset:18944
v_add_f32 v26, v26, v27
v_smfmac_f32_16x16x64_bf16 v[36:39], v[20:23], v[40:47], v0
ds_read_b128 v[48:51], v1 offset:16896
v_add_f32 v28, v28, v29
v_smfmac_f32_16x16x64_bf16 v[56:59], v[12:15], a[32:39], v0
ds_read_b128 v[20:23], v1 offset:5632
v_add_f32 v30, v30, v31
v_cvt_pk_bf16_f32 v24, v24, v28
ds_write_b32 v4, v24 offset:2176
v_smfmac_f32_16x16x64_bf16 v[60:63], v[12:15], a[40:47], v0
s_waitcnt lgkmcnt(4)
ds_read_b128 v[12:15], v1 offset:7680
v_cvt_pk_bf16_f32 v26, v26, v30
ds_write_b32 v3, v26 offset:2176
v_add_f32 v32, v32, v33
v_smfmac_f32_16x16x64_bf16 v[56:59], v[16:19], a[48:55], v0
ds_read_b128 v[40:43], v1 offset:12800
v_add_f32 v34, v34, v35
v_add_f32 v36, v36, v37
v_add_f32 v38, v38, v39
v_smfmac_f32_16x16x64_bf16 v[60:63], v[16:19], a[56:63], v0
s_waitcnt lgkmcnt(4)
ds_read_b128 v[16:19], v1 offset:8704
v_cvt_pk_bf16_f32 v32, v32, v36
ds_write_b32 v4, v32 offset:0
v_cvt_pk_bf16_f32 v34, v34, v38
v_smfmac_f32_16x16x64_bf16 v[56:59], v[20:23], a[64:71], v0
ds_read_b128 v[44:47], v1 offset:14848
ds_write_b32 v3, v34 offset:0
v_smfmac_f32_16x16x64_bf16 v[60:63], v[20:23], a[72:79], v0
s_waitcnt lgkmcnt(6)
ds_read_b128 v[20:23], v1 offset:9728
v_smfmac_f32_16x16x64_bf16 v[56:59], v[12:15], a[96:103], v0
v_smfmac_f32_16x16x64_bf16 v[60:63], v[12:15], a[104:111], v0
s_waitcnt lgkmcnt(4)
ds_read_b128 v[12:15], v1 offset:11776
v_smfmac_f32_16x16x64_bf16 v[56:59], v[16:19], a[112:119], v0
v_smfmac_f32_16x16x64_bf16 v[60:63], v[16:19], a[120:127], v0
s_waitcnt lgkmcnt(1)
v_smfmac_f32_16x16x64_bf16 v[56:59], v[20:23], a[128:135], v0
s_barrier
ds_read_b128 v[36:39], v5 offset:1536
v_smfmac_f32_16x16x64_bf16 v[60:63], v[20:23], a[136:143], v0
s_waitcnt lgkmcnt(1)
ds_read_b128 v[24:27], v5 offset:0
v_smfmac_f32_16x16x64_bf16 v[56:59], v[12:15], a[160:167], v0
ds_read_b128 v[28:31], v5 offset:512
v_smfmac_f32_16x16x64_bf16 v[60:63], v[12:15], a[168:175], v0
s_waitcnt lgkmcnt(2)
ds_read_b128 v[32:35], v5 offset:1024
v_mfma_f32_16x16x32_bf16 v[16:19], v[52:55], v[36:39], 0
s_waitcnt lgkmcnt(2)
ds_read_b128 v[52:55], v1 offset:19968
v_mfma_f32_16x16x32_bf16 v[16:19], v[40:43], v[24:27], v[16:19]
s_waitcnt lgkmcnt(2)
ds_read_b128 v[40:43], v1 offset:13824
v_mfma_f32_16x16x32_bf16 v[16:19], v[44:47], v[28:31], v[16:19]
s_waitcnt lgkmcnt(2)
ds_read_b128 v[44:47], v1 offset:15872
v_mfma_f32_16x16x32_bf16 v[16:19], v[48:51], v[32:35], v[16:19]
ds_read_b128 v[48:51], v1 offset:17920
s_mov_b64 exec, s[86:87]
buffer_store_dwordx4 v[36:39], v5, s[8:11], s31 offen offset:1536 sc1
s_mov_b64 exec, -1
v_mfma_f32_16x16x32_bf16 v[20:23], v[36:39], v[36:39], 0
v_add_f32 v56, v56, v57
v_add_f32 v58, v58, v59
v_mfma_f32_16x16x32_bf16 v[20:23], v[24:27], v[24:27], v[20:23]
v_add_f32 v60, v60, v61
v_add_f32 v62, v62, v63
v_mfma_f32_16x16x32_bf16 v[20:23], v[28:31], v[28:31], v[20:23]
v_cvt_pk_bf16_f32 v56, v56, v58
v_cvt_pk_bf16_f32 v57, v60, v62
v_mfma_f32_16x16x32_bf16 v[20:23], v[32:35], v[32:35], v[20:23]
s_waitcnt lgkmcnt(3)
v_lshrrev_b32 v58, 1, v1
v_max3_f32 v59, v16, v17, v18
v_mfma_f32_16x16x32_bf16 v[12:15], v[52:55], v[36:39], 0
s_waitcnt lgkmcnt(2)
ds_read_b128 v[52:55], v2 offset:21504
v_mfma_f32_16x16x32_bf16 v[12:15], v[40:43], v[24:27], v[12:15]
s_waitcnt lgkmcnt(2)
ds_read_b128 v[40:43], v2 offset:18432
v_mfma_f32_16x16x32_bf16 v[12:15], v[44:47], v[28:31], v[12:15]
s_waitcnt lgkmcnt(2)
ds_read_b128 v[44:47], v2 offset:19456
v_max3_f32 v59, v59, v19, v20
v_max_f32 v59, v59, v21
v_mfma_f32_16x16x32_bf16 v[12:15], v[48:51], v[32:35], v[12:15]
ds_read_b128 v[48:51], v2 offset:20480
buffer_store_dwordx2 v[56:57], v58, s[8:11], s31 offen offset:2048 sc1
v_mov_b32 v60, s53
s_add_u32 s49, s28, s23
v_mov_b32 v61, s53
s_add_u32 s50, s28, 65536
v_mov_b32 v62, s53
ds_read_b128 v[32:35], v2 offset:22528
v_mov_b32 v63, s53
v_max3_f32 v59, v59, v12, v13
v_max3_f32 v22, v59, v14, v15
v_max3_f32 v59, v59, v14, v15
s_add_u32 s51, s28, 131072
s_add_u32 s52, s28, 196608
v_permlane32_swap_b32 v22, v59
v_max_f32 v23, v59, v22
v_max_f32 v59, v59, v22
v_mov_b32 v22, 0
ds_read_b128 v[36:39], v2 offset:23552
v_permlane16_swap_b32 v23, v59
v_max_f32 v59, v59, v23
v_mul_f32 v58, s18, v59
v_pk_fma_f32 v[20:21], v[20:21], s[18:19], v[58:59] op_sel_hi:[1,0,0] neg_lo:[0,0,1] neg_hi:[0,0,1]
v_pk_fma_f32 v[16:17], v[16:17], s[18:19], v[58:59] op_sel_hi:[1,0,0] neg_lo:[0,0,1] neg_hi:[0,0,1]
v_pk_fma_f32 v[18:19], v[18:19], s[18:19], v[58:59] op_sel_hi:[1,0,0] neg_lo:[0,0,1] neg_hi:[0,0,1]
v_pk_fma_f32 v[12:13], v[12:13], s[18:19], v[58:59] op_sel_hi:[1,0,0] neg_lo:[0,0,1] neg_hi:[0,0,1]
v_pk_fma_f32 v[14:15], v[14:15], s[18:19], v[58:59] op_sel_hi:[1,0,0] neg_lo:[0,0,1] neg_hi:[0,0,1]
v_exp_f32 v20, v20
v_exp_f32 v21, v21
v_exp_f32 v16, v16
v_cvt_pk_bf16_f32 v23, v20, v21
v_cvt_pk_bf16_f32 v20, v20, v21
v_mov_b32 v21, 0
v_exp_f32 v17, v17
v_exp_f32 v18, v18
v_mfma_f32_16x16x16_bf16 v[24:27], v[56:57], v[20:21], 0
v_exp_f32 v19, v19
v_mfma_f32_16x16x16_bf16 v[28:31], v[56:57], v[22:23], 0
v_exp_f32 v12, v12
v_exp_f32 v13, v13
v_cvt_pk_bf16_f32 v16, v16, v17
v_cvt_pk_bf16_f32 v17, v18, v19
v_exp_f32 v14, v14
v_exp_f32 v15, v15
v_cvt_pk_bf16_f32 v18, v12, v13
v_cvt_pk_bf16_f32 v19, v14, v15
v_mfma_f32_16x16x16_bf16 v[12:15], v[60:61], v[20:21], 0
s_waitcnt vmcnt(4)
v_mfma_f32_16x16x32_bf16 v[12:15], v[60:63], v[16:19], v[12:15]
v_mov_b32 v20, 0
v_mov_b32 v23, 0
v_mfma_f32_16x16x32_bf16 v[24:27], v[64:67], v[16:19], v[24:27]
s_nop 1
v_mfma_f32_16x16x32_bf16 v[28:31], v[68:71], v[16:19], v[28:31]
v_mov_b32 v16, 0
v_mov_b32 v17, 0
v_rcp_f32 v12, v12
v_mov_b32 v18, 0
v_mov_b32 v19, 0
v_pk_mul_f32 v[24:25], v[24:25], v[12:13] op_sel_hi:[1,0]
v_pk_mul_f32 v[26:27], v[26:27], v[12:13] op_sel_hi:[1,0]
v_mov_b32 v15, 0
v_pk_mul_f32 v[28:29], v[28:29], v[12:13] op_sel_hi:[1,0]
v_pk_mul_f32 v[30:31], v[30:31], v[12:13] op_sel_hi:[1,0]
v_cvt_pk_bf16_f32 v24, v24, v28
v_cvt_pk_bf16_f32 v25, v25, v29
v_cvt_pk_bf16_f32 v26, v26, v30
v_cvt_pk_bf16_f32 v27, v27, v31
v_mfma_f32_16x16x32_bf16 v[56:59], v[20:23], v[20:23], 0
ds_write_b128 v7, v[24:27]
v_mfma_f32_16x16x32_bf16 v[60:63], v[20:23], v[20:23], 0
v_mov_b32 v12, 0
v_mov_b32 v13, 0
v_mov_b32 v14, 0
v_mov_b32 v3, 6528
v_and_b32 v8, 0x380, v1
v_add_u32 v8, v8, v1
v_mfma_f32_16x16x32_bf16 v[64:67], v[20:23], v[20:23], 0
s_add_u32 s20, s30, 19456
s_mov_b32 m0, 22016
s_cmp_eq_u32 s19, 63
s_cbranch_scc1 L_texit
s_waitcnt lgkmcnt(0)
s_barrier
ds_read_b128 v[24:27], v1 offset:1152
v_mfma_f32_16x16x32_bf16 v[68:71], v[20:23], v[20:23], 0
ds_read_b128 v[28:31], v1 offset:2176
s_nop 2
v_mfma_f32_16x16x32_bf16 v[68:71], v[20:23], v[20:23], 0
s_waitcnt lgkmcnt(1)
v_smfmac_f32_16x16x64_bf16 v[12:15], v[24:27], a[248:255], v0
buffer_load_dwordx4 v8, s[8:11], s20 offen sc1 lds
v_smfmac_f32_16x16x64_bf16 v[16:19], v[24:27], a[176:183], v0
s_mov_b32 m0, 22912
s_waitcnt lgkmcnt(0)
v_smfmac_f32_16x16x64_bf16 v[12:15], v[28:31], v[40:47], v0
ds_read_b128 v[40:43], v2 offset:24576
v_smfmac_f32_16x16x64_bf16 v[16:19], v[28:31], v[48:55], v0
ds_read_b128 v[44:47], v2 offset:25600
buffer_load_dwordx4 v8, s[8:11], s20 offen offset:128 sc1 lds
v_smfmac_f32_16x16x64_bf16 v[20:23], v[24:27], a[184:191], v0
ds_read_b128 v[48:51], v2 offset:26624
s_nop 1
v_add_f32 v12, v12, v13
v_add_f32 v14, v14, v15
v_cvt_pk_bf16_f32 v12, v12, v14
v_smfmac_f32_16x16x64_bf16 v[20:23], v[28:31], v[32:39], v0
ds_read_b128 v[52:55], v2 offset:27648
buffer_store_dword v12, v10, s[8:11], s28 offen
v_add_f32 v16, v16, v17
v_add_f32 v18, v18, v19
v_smfmac_f32_16x16x64_bf16 v[56:59], v[24:27], a[192:199], v0
s_waitcnt lgkmcnt(2)
ds_read_b128 v[32:35], v2 offset:28672
v_cvt_pk_bf16_f32 v16, v16, v18
v_smfmac_f32_16x16x64_bf16 v[56:59], v[28:31], v[40:47], v0
ds_read_b128 v[36:39], v2 offset:29696
v_add_f32 v20, v20, v21
v_add_f32 v22, v22, v23
v_cvt_pk_bf16_f32 v17, v20, v22
v_smfmac_f32_16x16x64_bf16 v[60:63], v[24:27], a[200:207], v0
s_waitcnt lgkmcnt(2)
ds_read_b128 v[12:15], v3
buffer_store_dwordx2 v[16:17], v9, s[8:11], s28 offen
v_smfmac_f32_16x16x64_bf16 v[60:63], v[28:31], v[48:55], v0
ds_read_b128 v[40:43], v2 offset:30720
v_add_f32 v56, v56, v57
v_add_f32 v58, v58, v59
v_cvt_pk_bf16_f32 v56, v56, v58
v_smfmac_f32_16x16x64_bf16 v[64:67], v[24:27], a[208:215], v0
s_waitcnt lgkmcnt(2)
ds_read_b128 v[44:47], v2 offset:31744
v_smfmac_f32_16x16x64_bf16 v[64:67], v[28:31], v[32:39], v0
ds_read_b128 v[20:23], v3
v_add_f32 v60, v60, v61
v_add_f32 v62, v62, v63
v_cvt_pk_bf16_f32 v57, v60, v62
v_smfmac_f32_16x16x64_bf16 v[68:71], v[24:27], a[216:223], v0
s_waitcnt lgkmcnt(1)
ds_read_b128 v[48:51], v2 offset:32768
buffer_store_dwordx2 v[56:57], v9, s[8:11], s50 offen
v_smfmac_f32_16x16x64_bf16 v[68:71], v[28:31], v[40:47], v0
ds_read_b128 v[52:55], v2 offset:33792
v_add_f32 v64, v64, v65
v_add_f32 v66, v66, v67
v_cvt_pk_bf16_f32 v64, v64, v66
v_smfmac_f32_16x16x64_bf16 v[12:15], v[24:27], a[224:231], v0
s_waitcnt lgkmcnt(0)
v_smfmac_f32_16x16x64_bf16 v[12:15], v[28:31], v[48:55], v0
s_nop 0
v_add_f32 v68, v68, v69
v_add_f32 v70, v70, v71
v_cvt_pk_bf16_f32 v65, v68, v70
v_smfmac_f32_16x16x64_bf16 v[20:23], v[24:27], a[232:239], v0
buffer_store_dwordx2 v[64:65], v9, s[8:11], s51 offen
v_smfmac_f32_16x16x64_bf16 v[20:23], v[28:31], a[240:247], v0
s_nop 0
v_add_f32 v12, v12, v13
v_add_f32 v14, v14, v15
v_cvt_pk_bf16_f32 v12, v12, v14
s_nop 3
v_add_f32 v20, v20, v21
v_add_f32 v22, v22, v23
v_cvt_pk_bf16_f32 v13, v20, v22
buffer_store_dwordx2 v[12:13], v9, s[8:11], s52 offen
s_add_u32 s19, s19, 1
s_mov_b32 s20, s28
s_mov_b32 s28, s29
s_mov_b32 s29, s20
s_and_b32 s20, s19, 3
s_lshl_b32 s20, s20, 14
s_add_u32 s33, s20, 110100480
s_add_u32 s34, s20, s24
s_xor_b32 s20, s20, 32768
s_add_u32 s35, s20, s24
s_add_u32 s30, s30, 16384
s_add_u32 s31, s31, 131072
s_add_u32 s6, s33, 4096
s_add_u32 s7, s33, 8192
s_mov_b32 s22, 0
v_mov_b64 v[24:25], 0
v_mov_b64 v[26:27], 0
v_mov_b64 v[28:29], 0
v_mov_b64 v[30:31], 0
v_and_b32 v70, 0xf40, v1
v_add_u32 v70, v70, v1
v_bfe_u32 v71, v1, 7, 1
v_mad_i32_i24 v70, v71, s4, v70
v_mov_b64 v[64:65], -1
v_mov_b64 v[66:67], -1
v_xor_b32 v3, 16, v4
ds_read_b128 v[48:51], v2 offset:14336
ds_read_b128 v[52:55], v2 offset:15360
v_lshrrev_b32 v8, 2, v1
s_add_u32 s20, s19, 1
s_lshr_b32 s20, s20, 3
s_min_u32 s20, s20, 7
s_cmp_lt_u32 s19, 3
s_cselect_b32 s20, 8, s20
s_waitcnt vmcnt(9)
L_kvw:
v_readlane_b32 s21, v11, s20
s_nop 0
s_cmp_eq_u32 s21, 1
s_cbranch_scc0 L_kvp
s_barrier
s_branch L_gat3
L_g3r3:
buffer_load_dwordx4 v[16:19], v1, s[8:11], s6 offen sc1
s_add_u32 s22, s22, 1
s_waitcnt vmcnt(1)
v_max3_u32 v21, v16, v17, v18
v_max_u32 v21, v21, v19
v_cmp_le_u32 vcc, 0xffff0000, v21
s_cmp_gt_u32 s22, 40000
s_cbranch_vccz L_g33
s_cbranch_scc0 L_g3r3
s_branch L_end
L_kvp:
buffer_load_dword v11, v8, s[8:11], s82 offen sc1
s_add_u32 s22, s22, 1
s_cmp_gt_u32 s22, 40000
s_cbranch_scc1 L_end
s_waitcnt vmcnt(0)
s_branch L_kvw
L_texit:
s_lshl_b32 s61, s16, 7
s_add_u32 s61, s61, 111153152
s_waitcnt vmcnt(0)
s_barrier
s_cmp_lg_u32 s17, 0
s_cbranch_scc1 L_sf_55
v_mov_b32 v20, 0
v_mov_b32 v21, 64
s_mov_b64 exec, 1
buffer_store_dword v21, v20, s[8:11], s61 offen sc1
s_mov_b64 exec, -1
L_sf_55:
L_done:
L_end:
s_endpgm
.section .rodata,"a"
.p2align 6
.amdhsa_kernel concat_heads__compressed_kv_cla__memory_aug_recurrent_mem_tr__prompt_kernel
  .amdhsa_next_free_vgpr 512
  .amdhsa_next_free_sgpr 102
  .amdhsa_accum_offset 256
  .amdhsa_group_segment_fixed_size 0
  .amdhsa_kernarg_size 128
  .amdhsa_user_sgpr_count 2
  .amdhsa_user_sgpr_kernarg_segment_ptr 1
  .amdhsa_system_sgpr_workgroup_id_x 1
.end_amdhsa_kernel
```

```asm
; @launch grid=(256,1,1) block=(256,1,1) lds=163840
.amdgcn_target "amdgcn-amd-amdhsa--gfx950"
.text
.globl concat_heads__compressed_kv_cla__memory_aug_recurrent_mem_tr__prompt_kernel
.p2align 8
.type concat_heads__compressed_kv_cla__memory_aug_recurrent_mem_tr__prompt_kernel,@function
concat_heads__compressed_kv_cla__memory_aug_recurrent_mem_tr__prompt_kernel:
s_cmp_lt_u32 s2, 256
s_cbranch_scc1 L_go
L_end0:
s_endpgm
L_go:
s_getreg_b32 s3, hwreg(HW_REG_XCC_ID)
s_and_b32 s3, s3, 7
s_load_dwordx2 s[4:5], s[0:1], 120
s_load_dwordx2 s[6:7], s[0:1], 112
v_lshrrev_b32 v1, 6, v0
s_nop 0
v_readfirstlane_b32 s17, v1
s_waitcnt lgkmcnt(0)
s_mov_b32 s8, s4
s_and_b32 s9, s5, 0xffff
s_mov_b32 s10, 268435456
s_mov_b32 s11, 0x20000
s_mov_b32 s56, s6
s_and_b32 s57, s7, 0xffff
s_mov_b32 s58, 256
s_mov_b32 s59, 0x20000
s_getpc_b64 s[4:5]
L_pc:
s_mov_b32 s12, s4
s_and_b32 s13, s5, 0xffff
s_mov_b32 s14, L_end-L_pc
s_mov_b32 s15, 0x20000
s_lshr_b32 s25, s2, 3
s_lshl_b32 s25, s25, 7
v_lshlrev_b32 v3, 12, v0
buffer_load_dword v3, v3, s[12:15], s25 offen
s_lshl_b32 s24, s3, 2
s_cmp_eq_u32 s17, 0
s_cbranch_scc0 L_tk
s_mov_b64 exec, 1
v_mov_b32 v1, 1
v_mov_b32 v2, 0
buffer_atomic_add v1, v2, s[56:59], s24 offen sc0
s_waitcnt vmcnt(0)
ds_write_b32 v2, v1
s_waitcnt lgkmcnt(0)
s_mov_b64 exec, -1
L_tk:
s_waitcnt vmcnt(0)
s_barrier
v_mov_b32 v2, 0
ds_read_b32 v1, v2
s_lshr_b32 s3, 0x76350124, s24
s_and_b32 s3, s3, 7
s_waitcnt lgkmcnt(0)
v_readfirstlane_b32 s16, v1
s_barrier
s_cmp_ge_u32 s16, 32
s_cbranch_scc1 L_end0
s_cmp_eq_u32 s3, 0
s_cbranch_scc1 L_team
s_cmp_eq_u32 s3, 1
s_cbranch_scc0 L_np
s_cmp_lt_u32 s16, 24
s_cbranch_scc1 L_np
v_lshlrev_b32 v1, 4, v0
v_mov_b64 v[4:5], 0
v_mov_b64 v[6:7], 0
s_sub_u32 s24, s16, 24
s_lshl_b32 s24, s24, 12
s_add_u32 s24, s24, 111149056
buffer_store_dwordx4 v[4:7], v1, s[8:11], s24 offen sc1
s_waitcnt vmcnt(0)
s_barrier
s_cmp_lg_u32 s17, 0
s_cbranch_scc1 L_np
v_mov_b32 v1, 1
v_mov_b32 v2, 128
s_mov_b64 exec, 1
buffer_atomic_add v1, v2, s[56:59], 0 offen
s_mov_b64 exec, -1
L_np:
s_cmp_lt_u32 s3, 4
s_cselect_b32 s61, 1, 0
s_cbranch_scc1 L_pb
s_load_dwordx2 s[52:53], s[0:1], 8
s_load_dwordx2 s[54:55], s[0:1], 0
s_load_dwordx2 s[6:7], s[0:1], 24
s_load_dwordx2 s[4:5], s[0:1], 32
s_load_dwordx2 s[18:19], s[0:1], 16
s_mov_b32 s45, 3
s_sub_u32 s24, s3, 4
s_lshl_b32 s24, s24, 5
s_add_u32 s24, s24, s16
s_lshr_b32 s89, s24, 2
s_lshr_b32 s90, s24, 3
s_and_b32 s24, s16, 3
s_mul_i32 s88, s24, 0x11
s_and_b32 s24, s16, 7
s_lshl_b32 s24, s24, 8
s_add_u32 s88, s88, s24
s_add_u32 s88, s88, 0x840
s_branch L_pg
L_pb:
s_load_dwordx2 s[52:53], s[0:1], 48
s_load_dwordx2 s[54:55], s[0:1], 48
s_load_dwordx2 s[6:7], s[0:1], 72
s_load_dwordx2 s[4:5], s[0:1], 80
s_load_dwordx2 s[18:19], s[0:1], 64
s_mov_b32 s45, 6
s_sub_u32 s24, s3, 2
s_lshl_b32 s24, s24, 5
s_add_u32 s24, s24, s16
s_lshr_b32 s89, s24, 1
s_lshr_b32 s90, s24, 2
s_mov_b32 s88, 0xe6a431
s_mov_b32 s25, 0xe6c431
s_bitcmp1_b32 s16, 0
s_cselect_b32 s88, 0xf7b582, s88
s_cselect_b32 s25, 0xf7d592, s25
s_bitcmp1_b32 s16, 1
s_cselect_b32 s88, s25, s88
s_cselect_b32 s45, 5, 6
s_add_u32 s45, s3, 3
s_cmp_eq_u32 s3, 1
s_cselect_b32 s45, 1, s45
s_cselect_b32 s88, 0, s88
s_cselect_b32 s89, s16, s89
L_pg:
s_waitcnt lgkmcnt(0)
s_cmp_ge_u32 s17, 2
s_cselect_b64 s[6:7], s[4:5], s[6:7]
s_cmp_eq_u32 s61, 0
s_cselect_b32 s24, 4, 1
s_mov_b32 s14, 884736
s_cselect_b32 s14, 1048576, s14
s_sub_u32 s24, s3, s24
s_lshl_b32 s24, s24, 5
s_add_u32 s24, s24, s16
s_lshl_b32 s24, s24, 13
s_mov_b32 s12, s52
s_and_b32 s13, s53, 0xffff
s_mov_b32 s15, 0x20000
v_lshlrev_b32 v15, 5, v0
buffer_load_dword v15, v15, s[12:15], s24 offen
s_sub_u32 s24, 7, s3
s_mul_i32 s25, s16, 6
s_add_u32 s24, s24, s25
s_cmp_ge_u32 s24, 36
s_cbranch_scc1 L_pf_1
s_load_dwordx2 s[4:5], s[0:1], 88
s_sub_u32 s25, s24, 0
s_mul_i32 s25, s25, 131072
s_add_u32 s25, s25, 0
s_min_u32 s25, s25, 4718592
s_sub_u32 s98, 4718592, s25
s_mov_b32 s100, 0x0
s_branch L_pfd
L_pf_1:
s_cmp_ge_u32 s24, 72
s_cbranch_scc1 L_pf_2
s_load_dwordx2 s[4:5], s[0:1], 64
s_sub_u32 s25, s24, 36
s_mul_i32 s25, s25, 131072
s_add_u32 s25, s25, 0
s_min_u32 s25, s25, 4718592
s_sub_u32 s98, 4718592, s25
s_mov_b32 s100, 0x0
s_branch L_pfd
L_pf_2:
s_cmp_ge_u32 s24, 80
s_cbranch_scc1 L_pf_3
s_load_dwordx2 s[4:5], s[0:1], 8
s_sub_u32 s25, s24, 72
s_mul_i32 s25, s25, 131072
s_add_u32 s25, s25, 1048576
s_min_u32 s25, s25, 2097152
s_sub_u32 s98, 2097152, s25
s_mov_b32 s100, 0xfffe0000
s_branch L_pfd
L_pf_3:
s_cmp_ge_u32 s24, 92
s_cbranch_scc1 L_pf_4
s_load_dwordx2 s[4:5], s[0:1], 48
s_sub_u32 s25, s24, 80
s_mul_i32 s25, s25, 131072
s_add_u32 s25, s25, 786432
s_min_u32 s25, s25, 2359296
s_sub_u32 s98, 2359296, s25
s_mov_b32 s100, 0xfffe0000
s_branch L_pfd
L_pf_4:
s_cmp_ge_u32 s24, 110
s_cbranch_scc1 L_pf_5
s_load_dwordx2 s[4:5], s[0:1], 0
s_sub_u32 s25, s24, 92
s_mul_i32 s25, s25, 131072
s_add_u32 s25, s25, 0
s_min_u32 s25, s25, 2359296
s_sub_u32 s98, 2359296, s25
s_mov_b32 s100, 0xfffe0000
s_branch L_pfd
L_pf_5:
s_cmp_ge_u32 s24, 146
s_cbranch_scc1 L_pf_6
s_load_dwordx2 s[4:5], s[0:1], 16
s_sub_u32 s25, s24, 110
s_mul_i32 s25, s25, 131072
s_add_u32 s25, s25, 0
s_min_u32 s25, s25, 4718592
s_sub_u32 s98, 4718592, s25
s_mov_b32 s100, 0xfffe0000
s_branch L_pfd
L_pf_6:
s_load_dwordx2 s[4:5], s[0:1], 40
s_sub_u32 s25, s24, 146
s_mul_i32 s25, s25, 131072
s_add_u32 s25, s25, 0
s_min_u32 s25, s25, 4718592
s_sub_u32 s98, 4718592, s25
s_mov_b32 s100, 0xfffe0000
s_branch L_pfd
L_pf_7:
L_pfd:
s_min_u32 s98, s98, 131072
s_waitcnt lgkmcnt(0)
s_add_u32 s96, s4, s25
s_addc_u32 s5, s5, 0
s_and_b32 s97, s5, 0xffff
s_mov_b32 s99, 0x20000
s_cmp_eq_u32 s3, 1
s_cselect_b32 s100, 536870912, s100
v_lshlrev_b32 v14, 6, v0
s_cmp_eq_u32 s61, 0
s_cselect_b32 s94, 0x3e0293ee, 1.0
s_cmp_eq_u32 s3, 1
s_cselect_b32 s91, 1, 0
v_bfe_u32 v16, v0, 4, 3
v_bfe_u32 v17, v0, 7, 1
v_lshlrev_b32 v17, 2, v17
v_xor_b32 v16, v16, v17
v_and_b32 v17, 7, v0
v_xor_b32 v16, v16, v17
v_lshlrev_b32 v1, 4, v16
v_bfe_u32 v17, v0, 4, 2
v_lshlrev_b32 v16, 2, v17
v_and_b32 v18, 15, v0
v_xor_b32 v16, v16, v18
v_bfe_u32 v18, v0, 6, 1
v_xor_b32 v16, v16, v18
v_lshlrev_b32 v16, 4, v16
v_lshl_add_u32 v16, v17, 13, v16
v_lshl_add_u32 v2, v18, 16, v16
s_and_b32 s24, s17, 1
s_lshr_b32 s25, s17, 1
s_lshl_b32 s25, s25, 13
s_lshl_b32 s33, s24, 11
s_add_u32 s33, s33, s25
s_lshl_b32 s32, s17, 10
s_add_u32 s32, s32, 65536
v_bfe_u32 v16, v0, 3, 1
v_lshlrev_b32 v16, 11, v16
v_and_b32 v18, 7, v0
v_lshl_add_u32 v16, v18, 7, v16
v_bfe_u32 v18, v0, 1, 3
v_xor_b32 v18, v18, v17
v_lshl_add_u32 v16, v18, 4, v16
s_lshl_b32 s24, s24, 14
s_add_u32 s24, s24, 65536
v_add_u32 v3, s24, v16
v_xor_b32 v4, 64, v3
v_bfe_u32 v18, v0, 2, 2
v_mul_u32_u24 v16, 320, v18
v_lshl_add_u32 v16, v17, 11, v16
v_bfe_u32 v18, v0, 1, 1
v_lshl_add_u32 v16, v18, 5, v16
v_bfe_u32 v18, v0, 4, 1
v_lshl_add_u32 v16, v18, 4, v16
v_and_b32 v18, 1, v0
v_lshl_add_u32 v16, v18, 3, v16
v_add_u32 v5, s25, v16
v_xor_b32 v6, 16, v5
v_xor_b32 v7, 64, v5
v_xor_b32 v8, 80, v5
v_xor_b32 v9, 128, v5
v_xor_b32 v10, 144, v5
v_xor_b32 v11, 192, v5
v_xor_b32 v12, 208, v5
s_mov_b32 s35, 0
s_lshr_b32 s24, s16, 1
s_cmp_eq_u32 s35, 5
s_cselect_b32 s90, s24, s90
s_lshl_b32 s24, s35, 2
s_lshr_b32 s26, s88, s24
s_bfe_u32 s2, s26, 0x10003
s_and_b32 s26, s26, 7
s_or_b32 s40, s2, s61
s_lshr_b32 s24, s17, 1
s_cmp_eq_u32 s2, 0
s_cselect_b32 s41, s24, 0
s_cselect_b32 s27, s89, s90
s_sub_u32 s25, s24, s41
s_and_b32 s51, s41, s61
s_lshl_b32 s51, s51, 1
s_or_b32 s51, s51, s41
s_lshl_b32 s46, s27, s2
s_add_u32 s46, s46, s25
s_lshl_b32 s46, s46, 8
s_lshl_b32 s47, s40, 7
s_add_u32 s47, s47, 1024
s_mul_i32 s101, s26, s47
s_lshl_b32 s101, s101, 8
s_lshl_b32 s42, s27, 3
s_add_u32 s42, s42, s26
s_lshl_b32 s42, s42, 1
s_and_b32 s25, s17, 1
s_add_u32 s42, s42, s25
s_lshl_b32 s42, s42, 3
s_add_u32 s42, s42, s24
s_lshl_b32 s42, s42, 13
s_lshl_b32 s43, s27, 5
s_add_u32 s43, s43, s26
s_lshl_b32 s43, s43, 2
s_lshl_b32 s24, s2, 1
s_add_u32 s24, s24, s61
s_lshl_b32 s24, s24, 2
s_lshr_b32 s25, 0x8720, s24
s_and_b32 s25, s25, 15
s_lshl_b32 s25, s25, 24
s_add_u32 s42, s42, s25
s_lshr_b32 s25, 0x7604, s24
s_and_b32 s25, s25, 15
s_lshl_b32 s25, s25, 12
s_add_u32 s43, s43, s25
s_add_u32 s43, s43, 111149056
s_cmp_lt_u32 s35, s45
s_cselect_b32 s101, s101, 536870912
s_cselect_b32 s46, s46, 536870912
s_cmp_eq_u32 s2, 0
s_cselect_b64 s[4:5], s[52:53], s[54:55]
s_mov_b32 s12, s4
s_and_b32 s13, s5, 0xffff
s_lshl_b32 s14, s47, 11
s_mov_b32 s15, 0x20000
s_mov_b32 s30, s101
v_lshrrev_b32 v16, 3, v0
v_mul_lo_u32 v16, v16, s47
v_and_b32 v1, 0x70, v1
v_add_u32 v1, v1, v16
s_lshl_b32 s34, s47, 5
s_cmp_eq_u32 s2, 0
s_cselect_b64 s[4:5], s[6:7], s[18:19]
s_mov_b32 s20, s4
s_and_b32 s21, s5, 0xffff
s_lshl_b32 s22, s47, 12
s_mov_b32 s23, 0x20000
s_mov_b32 s31, s46
s_mov_b32 s48, s30
s_add_u32 m0, s32, 0
s_nop 0
buffer_load_dwordx4 v1, s[12:15], s48 offen lds
s_add_u32 s48, s48, s34
s_add_u32 m0, s32, 4096
s_nop 0
buffer_load_dwordx4 v1, s[12:15], s48 offen lds
s_add_u32 s48, s48, s34
s_add_u32 m0, s32, 8192
s_nop 0
buffer_load_dwordx4 v1, s[12:15], s48 offen lds
s_add_u32 s48, s48, s34
s_add_u32 m0, s32, 12288
s_nop 0
buffer_load_dwordx4 v1, s[12:15], s48 offen lds
s_add_u32 s48, s48, s34
s_add_u32 m0, s32, 16384
s_nop 0
buffer_load_dwordx4 v1, s[12:15], s48 offen lds
s_add_u32 s48, s48, s34
s_add_u32 m0, s32, 20480
s_nop 0
buffer_load_dwordx4 v1, s[12:15], s48 offen lds
s_add_u32 s48, s48, s34
s_add_u32 m0, s32, 24576
s_nop 0
buffer_load_dwordx4 v1, s[12:15], s48 offen lds
s_add_u32 s48, s48, s34
s_add_u32 m0, s32, 28672
s_nop 0
buffer_load_dwordx4 v1, s[12:15], s48 offen lds
s_add_u32 s30, s30, 128
s_add_u32 s32, s32, 32768
s_sub_u32 s48, s32, 98304
s_cmp_ge_u32 s32, 163840
s_cselect_b32 s32, s48, s32
s_add_u32 s37, s31, 0
s_add_u32 m0, s33, 0
s_nop 0
buffer_load_dwordx4 v2, s[20:23], s37 offen  lds
s_add_u32 s37, s31, 32768
s_add_u32 m0, s33, 1024
s_nop 0
buffer_load_dwordx4 v2, s[20:23], s37 offen  lds
s_add_u32 s37, s31, 131072
s_add_u32 m0, s33, 4096
s_nop 0
buffer_load_dwordx4 v2, s[20:23], s37 offen  lds
s_add_u32 s37, s31, 163840
s_add_u32 m0, s33, 5120
s_nop 0
buffer_load_dwordx4 v2, s[20:23], s37 offen  lds
s_add_u32 s31, s31, 262144
s_add_u32 s33, s33, 16384
s_and_b32 s33, s33, 65535
s_add_u32 s37, s31, 0
s_add_u32 m0, s33, 0
s_nop 0
buffer_load_dwordx4 v2, s[20:23], s37 offen  lds
s_add_u32 s37, s31, 32768
s_add_u32 m0, s33, 1024
s_nop 0
buffer_load_dwordx4 v2, s[20:23], s37 offen  lds
s_add_u32 s37, s31, 131072
s_add_u32 m0, s33, 4096
s_nop 0
buffer_load_dwordx4 v2, s[20:23], s37 offen  lds
s_add_u32 s37, s31, 163840
s_add_u32 m0, s33, 5120
s_nop 0
buffer_load_dwordx4 v2, s[20:23], s37 offen  lds
s_add_u32 s31, s31, 262144
s_add_u32 s33, s33, 16384
s_and_b32 s33, s33, 65535
s_mov_b32 s48, s30
s_add_u32 m0, s32, 0
s_nop 0
buffer_load_dwordx4 v1, s[12:15], s48 offen lds
s_add_u32 s48, s48, s34
s_add_u32 m0, s32, 4096
s_nop 0
buffer_load_dwordx4 v1, s[12:15], s48 offen lds
s_add_u32 s48, s48, s34
s_add_u32 m0, s32, 8192
s_nop 0
buffer_load_dwordx4 v1, s[12:15], s48 offen lds
s_add_u32 s48, s48, s34
s_add_u32 m0, s32, 12288
s_nop 0
buffer_load_dwordx4 v1, s[12:15], s48 offen lds
s_add_u32 s37, s31, 0
s_add_u32 m0, s33, 0
s_nop 0
buffer_load_dwordx4 v2, s[20:23], s37 offen  lds
s_add_u32 s37, s31, 32768
s_add_u32 m0, s33, 1024
s_nop 0
buffer_load_dwordx4 v2, s[20:23], s37 offen  lds
s_add_u32 s37, s31, 131072
s_add_u32 m0, s33, 4096
s_nop 0
buffer_load_dwordx4 v2, s[20:23], s37 offen  lds
s_add_u32 s37, s31, 163840
s_add_u32 m0, s33, 5120
s_nop 0
buffer_load_dwordx4 v2, s[20:23], s37 offen  lds
s_add_u32 s31, s31, 262144
s_add_u32 s33, s33, 16384
s_and_b32 s33, s33, 65535
s_add_u32 s48, s48, s34
s_add_u32 m0, s32, 16384
s_nop 0
buffer_load_dwordx4 v1, s[12:15], s48 offen lds
s_add_u32 s48, s48, s34
s_add_u32 m0, s32, 20480
s_nop 0
buffer_load_dwordx4 v1, s[12:15], s48 offen lds
s_add_u32 s48, s48, s34
s_add_u32 m0, s32, 24576
s_nop 0
buffer_load_dwordx4 v1, s[12:15], s48 offen lds
s_add_u32 s48, s48, s34
s_add_u32 m0, s32, 28672
s_nop 0
buffer_load_dwordx4 v1, s[12:15], s48 offen lds
s_add_u32 s30, s30, 128
s_add_u32 s32, s32, 32768
s_sub_u32 s48, s32, 98304
s_cmp_ge_u32 s32, 163840
s_cselect_b32 s32, s48, s32
s_add_u32 s37, s31, 0
s_add_u32 m0, s33, 0
s_nop 0
buffer_load_dwordx4 v2, s[20:23], s37 offen  lds
s_add_u32 s37, s31, 32768
s_add_u32 m0, s33, 1024
s_nop 0
buffer_load_dwordx4 v2, s[20:23], s37 offen  lds
s_add_u32 s37, s31, 131072
s_add_u32 m0, s33, 4096
s_nop 0
buffer_load_dwordx4 v2, s[20:23], s37 offen  lds
s_add_u32 s37, s31, 163840
s_add_u32 m0, s33, 5120
s_nop 0
buffer_load_dwordx4 v2, s[20:23], s37 offen  lds
s_add_u32 s31, s31, 262144
s_add_u32 s33, s33, 16384
s_and_b32 s33, s33, 65535
s_mov_b32 s48, s30
s_add_u32 m0, s32, 0
s_nop 0
buffer_load_dwordx4 v1, s[12:15], s48 offen lds
s_add_u32 s48, s48, s34
s_add_u32 m0, s32, 4096
s_nop 0
buffer_load_dwordx4 v1, s[12:15], s48 offen lds
s_add_u32 s48, s48, s34
s_add_u32 m0, s32, 8192
s_nop 0
buffer_load_dwordx4 v1, s[12:15], s48 offen lds
s_add_u32 s48, s48, s34
s_add_u32 m0, s32, 12288
s_nop 0
buffer_load_dwordx4 v1, s[12:15], s48 offen lds
s_mov_b32 s62, 536870912
s_mov_b32 s63, 536870912
s_mov_b32 s50, 0
s_waitcnt vmcnt(24)
s_barrier
s_cmp_eq_u32 s41, 0
s_cbranch_scc0 L_g_p1
ds_read_b64_tr_b16 a[160:161], v5 offset:0
ds_read_b64_tr_b16 a[162:163], v5 offset:1024
ds_read_b64_tr_b16 a[164:165], v6 offset:0
ds_read_b64_tr_b16 a[166:167], v6 offset:1024
ds_read_b64_tr_b16 a[168:169], v7 offset:0
ds_read_b64_tr_b16 a[170:171], v7 offset:1024
ds_read_b64_tr_b16 a[172:173], v8 offset:0
ds_read_b64_tr_b16 a[174:175], v8 offset:1024
ds_read_b64_tr_b16 a[176:177], v9 offset:0
ds_read_b64_tr_b16 a[178:179], v9 offset:1024
ds_read_b64_tr_b16 a[180:181], v10 offset:0
ds_read_b64_tr_b16 a[182:183], v10 offset:1024
ds_read_b64_tr_b16 a[184:185], v11 offset:0
ds_read_b64_tr_b16 a[186:187], v11 offset:1024
ds_read_b64_tr_b16 a[188:189], v12 offset:0
ds_read_b64_tr_b16 a[190:191], v12 offset:1024
ds_read_b128 a[192:195], v3 offset:0
ds_read_b128 a[196:199], v4 offset:1024
ds_read_b128 a[200:203], v3 offset:4096
ds_read_b128 a[204:207], v4 offset:5120
ds_read_b128 a[208:211], v3 offset:8192
ds_read_b128 a[212:215], v4 offset:9216
ds_read_b128 a[216:219], v3 offset:12288
ds_read_b128 a[220:223], v4 offset:13312
s_branch L_g_p2
L_g_p1:
ds_read_b128 a[160:163], v3 offset:0
ds_read_b128 a[164:167], v4 offset:1024
ds_read_b128 a[168:171], v3 offset:4096
ds_read_b128 a[172:175], v4 offset:5120
ds_read_b128 a[176:179], v3 offset:8192
ds_read_b128 a[180:183], v4 offset:9216
ds_read_b128 a[184:187], v3 offset:12288
ds_read_b128 a[188:191], v4 offset:13312
ds_read_b64_tr_b16 a[192:193], v5 offset:0
ds_read_b64_tr_b16 a[194:195], v5 offset:1024
ds_read_b64_tr_b16 a[196:197], v6 offset:0
ds_read_b64_tr_b16 a[198:199], v6 offset:1024
ds_read_b64_tr_b16 a[200:201], v7 offset:0
ds_read_b64_tr_b16 a[202:203], v7 offset:1024
ds_read_b64_tr_b16 a[204:205], v8 offset:0
ds_read_b64_tr_b16 a[206:207], v8 offset:1024
ds_read_b64_tr_b16 a[208:209], v9 offset:0
ds_read_b64_tr_b16 a[210:211], v9 offset:1024
ds_read_b64_tr_b16 a[212:213], v10 offset:0
ds_read_b64_tr_b16 a[214:215], v10 offset:1024
ds_read_b64_tr_b16 a[216:217], v11 offset:0
ds_read_b64_tr_b16 a[218:219], v11 offset:1024
ds_read_b64_tr_b16 a[220:221], v12 offset:0
ds_read_b64_tr_b16 a[222:223], v12 offset:1024
L_g_p2:
v_add_u32 v5, 16384, v5
v_and_b32 v5, 65535, v5
v_xor_b32 v6, 16, v5
v_xor_b32 v7, 64, v5
v_xor_b32 v8, 80, v5
v_xor_b32 v9, 128, v5
v_xor_b32 v10, 144, v5
v_xor_b32 v11, 192, v5
v_xor_b32 v12, 208, v5
L_g_tile:
s_cmp_eq_u32 s35, 1
s_cbranch_scc1 L_g_first
L_g_go:
s_cmp_eq_u32 s41, 0
s_cbranch_scc0 L_g_v
.p2align 3
L_g_k:
s_waitcnt vmcnt(16) lgkmcnt(0)
s_barrier
v_mfma_f32_16x16x32_bf16 v[160:163], a[160:163], a[192:195], 0
ds_read_b128 a[224:227], v4 offset:0
v_accvgpr_read_b32 v20, a64
v_accvgpr_read_b32 v21, a65
v_accvgpr_read_b32 v22, a66
v_mfma_f32_16x16x32_bf16 v[164:167], a[160:163], a[196:199], 0
s_add_u32 s37, s31, 0
v_accvgpr_read_b32 v23, a67
v_cvt_pk_bf16_f32 v98, v20, v21
v_cvt_pk_bf16_f32 v99, v22, v23
v_accvgpr_read_b32 v24, a68
v_mfma_f32_16x16x32_bf16 v[168:171], a[160:163], a[200:203], 0
s_add_u32 m0, s33, 0
ds_read_b128 a[228:231], v3 offset:1024
v_accvgpr_read_b32 v25, a69
v_accvgpr_read_b32 v26, a70
v_accvgpr_read_b32 v27, a71
v_mfma_f32_16x16x32_bf16 v[172:175], a[160:163], a[204:207], 0
buffer_load_dwordx4 v2, s[20:23], s37 offen  lds
v_cvt_pk_bf16_f32 v102, v24, v25
v_cvt_pk_bf16_f32 v103, v26, v27
v_accvgpr_read_b32 v20, a72
v_mfma_f32_16x16x32_bf16 v[176:179], a[160:163], a[208:211], 0
ds_read_b128 a[232:235], v4 offset:4096
v_accvgpr_read_b32 v21, a73
v_accvgpr_read_b32 v22, a74
v_accvgpr_read_b32 v23, a75
v_mfma_f32_16x16x32_bf16 v[180:183], a[160:163], a[212:215], 0
v_cvt_pk_bf16_f32 v106, v20, v21
v_cvt_pk_bf16_f32 v107, v22, v23
v_accvgpr_read_b32 v24, a76
v_accvgpr_read_b32 v25, a77
v_mfma_f32_16x16x32_bf16 v[184:187], a[160:163], a[216:219], 0
ds_read_b128 a[236:239], v3 offset:5120
v_accvgpr_read_b32 v26, a78
v_accvgpr_read_b32 v27, a79
v_cvt_pk_bf16_f32 v110, v24, v25
v_mfma_f32_16x16x32_bf16 v[188:191], a[160:163], a[220:223], 0
ds_read_b64_tr_b16 a[160:161], v5 offset:0
v_cvt_pk_bf16_f32 v111, v26, v27
v_accvgpr_read_b32 v20, a80
v_accvgpr_read_b32 v21, a81
v_mfma_f32_16x16x32_bf16 v[192:195], a[164:167], a[192:195], 0
s_add_u32 s37, s31, 32768
ds_read_b64_tr_b16 a[162:163], v5 offset:1024
v_accvgpr_read_b32 v22, a82
v_accvgpr_read_b32 v23, a83
v_cvt_pk_bf16_f32 v114, v20, v21
v_mfma_f32_16x16x32_bf16 v[196:199], a[164:167], a[196:199], 0
s_add_u32 m0, s33, 1024
ds_read_b128 a[240:243], v4 offset:8192
v_add_u32 v5, 16384, v5
v_cvt_pk_bf16_f32 v115, v22, v23
v_accvgpr_read_b32 v24, a84
v_mfma_f32_16x16x32_bf16 v[200:203], a[164:167], a[200:203], 0
buffer_load_dwordx4 v2, s[20:23], s37 offen  lds
v_and_b32 v5, 65535, v5
v_accvgpr_read_b32 v25, a85
v_accvgpr_read_b32 v26, a86
v_mfma_f32_16x16x32_bf16 v[204:207], a[164:167], a[204:207], 0
ds_read_b128 a[244:247], v3 offset:9216
v_accvgpr_read_b32 v27, a87
v_cvt_pk_bf16_f32 v118, v24, v25
v_cvt_pk_bf16_f32 v119, v26, v27
v_mfma_f32_16x16x32_bf16 v[208:211], a[164:167], a[208:211], 0
v_accvgpr_read_b32 v20, a88
v_accvgpr_read_b32 v21, a89
v_accvgpr_read_b32 v22, a90
v_accvgpr_read_b32 v23, a91
v_mfma_f32_16x16x32_bf16 v[212:215], a[164:167], a[212:215], 0
ds_read_b128 a[248:251], v4 offset:12288
v_cvt_pk_bf16_f32 v122, v20, v21
v_cvt_pk_bf16_f32 v123, v22, v23
v_accvgpr_read_b32 v24, a92
v_mfma_f32_16x16x32_bf16 v[216:219], a[164:167], a[216:219], 0
v_accvgpr_read_b32 v25, a93
v_accvgpr_read_b32 v26, a94
v_accvgpr_read_b32 v27, a95
v_cvt_pk_bf16_f32 v126, v24, v25
v_mfma_f32_16x16x32_bf16 v[220:223], a[164:167], a[220:223], 0
s_add_u32 s37, s31, 131072
ds_read_b64_tr_b16 a[164:165], v6 offset:0
v_cvt_pk_bf16_f32 v127, v26, v27
v_accvgpr_read_b32 v20, a96
v_accvgpr_read_b32 v21, a97
v_mfma_f32_16x16x32_bf16 v[224:227], a[168:171], a[192:195], 0
s_add_u32 m0, s33, 4096
ds_read_b64_tr_b16 a[166:167], v6 offset:1024
v_accvgpr_read_b32 v22, a98
v_accvgpr_read_b32 v23, a99
v_cvt_pk_bf16_f32 v128, v20, v21
v_mfma_f32_16x16x32_bf16 v[228:231], a[168:171], a[196:199], 0
buffer_load_dwordx4 v2, s[20:23], s37 offen  lds
v_xor_b32 v6, 16, v5
v_cvt_pk_bf16_f32 v129, v22, v23
v_accvgpr_read_b32 v24, a100
v_mfma_f32_16x16x32_bf16 v[232:235], a[168:171], a[200:203], 0
ds_read_b128 a[252:255], v3 offset:13312
v_accvgpr_read_b32 v25, a101
v_accvgpr_read_b32 v26, a102
v_accvgpr_read_b32 v27, a103
v_mfma_f32_16x16x32_bf16 v[236:239], a[168:171], a[204:207], 0
v_cvt_pk_bf16_f32 v132, v24, v25
v_cvt_pk_bf16_f32 v133, v26, v27
v_accvgpr_read_b32 v20, a104
v_accvgpr_read_b32 v21, a105
v_mfma_f32_16x16x32_bf16 v[240:243], a[168:171], a[208:211], 0
ds_read_b64_tr_b16 v[28:29], v12 offset:0
v_accvgpr_read_b32 v22, a106
v_accvgpr_read_b32 v23, a107
v_cvt_pk_bf16_f32 v136, v20, v21
v_mfma_f32_16x16x32_bf16 v[244:247], a[168:171], a[212:215], 0
v_cvt_pk_bf16_f32 v137, v22, v23
v_accvgpr_read_b32 v24, a108
v_accvgpr_read_b32 v25, a109
v_accvgpr_read_b32 v26, a110
v_mfma_f32_16x16x32_bf16 v[248:251], a[168:171], a[216:219], 0
s_add_u32 s37, s31, 163840
ds_read_b64_tr_b16 v[30:31], v12 offset:1024
v_accvgpr_read_b32 v27, a111
v_cvt_pk_bf16_f32 v140, v24, v25
v_cvt_pk_bf16_f32 v141, v26, v27
v_mfma_f32_16x16x32_bf16 v[252:255], a[168:171], a[220:223], 0
s_add_u32 m0, s33, 5120
ds_read_b64_tr_b16 a[168:169], v7 offset:0
v_accvgpr_read_b32 v20, a112
v_accvgpr_read_b32 v21, a113
v_accvgpr_read_b32 v22, a114
v_mfma_f32_16x16x32_bf16 a[0:3], a[172:175], a[192:195], 0
buffer_load_dwordx4 v2, s[20:23], s37 offen  lds
ds_read_b64_tr_b16 a[170:171], v7 offset:1024
v_accvgpr_read_b32 v23, a115
v_cvt_pk_bf16_f32 v144, v20, v21
v_mfma_f32_16x16x32_bf16 a[4:7], a[172:175], a[196:199], 0
s_add_u32 s31, s31, 262144
v_xor_b32 v7, 64, v5
v_xor_b32 v12, 208, v5
v_cvt_pk_bf16_f32 v145, v22, v23
v_accvgpr_read_b32 v24, a116
v_mfma_f32_16x16x32_bf16 a[8:11], a[172:175], a[200:203], 0
s_add_u32 s33, s33, 16384
v_add_u32 v3, 32768, v3
v_accvgpr_read_b32 v25, a117
v_accvgpr_read_b32 v26, a118
v_accvgpr_read_b32 v27, a119
v_mfma_f32_16x16x32_bf16 a[12:15], a[172:175], a[204:207], 0
s_and_b32 s33, s33, 65535
v_subrev_u32 v19, 98304, v3
v_cvt_pk_bf16_f32 v148, v24, v25
v_cvt_pk_bf16_f32 v149, v26, v27
v_accvgpr_read_b32 v20, a120
v_mfma_f32_16x16x32_bf16 a[16:19], a[172:175], a[208:211], 0
v_cmp_le_u32 vcc, 163840, v3
v_accvgpr_read_b32 v21, a121
v_accvgpr_read_b32 v22, a122
v_accvgpr_read_b32 v23, a123
v_mfma_f32_16x16x32_bf16 a[20:23], a[172:175], a[212:215], 0
s_add_u32 s48, s48, s34
v_cndmask_b32 v3, v3, v19, vcc
v_cvt_pk_bf16_f32 v152, v20, v21
v_cvt_pk_bf16_f32 v153, v22, v23
v_accvgpr_read_b32 v24, a124
v_mfma_f32_16x16x32_bf16 a[24:27], a[172:175], a[216:219], 0
s_add_u32 m0, s32, 16384
v_xor_b32 v4, 64, v3
v_accvgpr_read_b32 v25, a125
v_accvgpr_read_b32 v26, a126
v_accvgpr_read_b32 v27, a127
v_mfma_f32_16x16x32_bf16 a[28:31], a[172:175], a[220:223], 0
buffer_load_dwordx4 v1, s[12:15], s48 offen lds
ds_read_b64_tr_b16 a[172:173], v8 offset:0
v_cvt_pk_bf16_f32 v156, v24, v25
v_cvt_pk_bf16_f32 v157, v26, v27
v_mfma_f32_16x16x32_bf16 a[32:35], a[176:179], a[192:195], 0
ds_read_b64_tr_b16 a[174:175], v8 offset:1024
v_accvgpr_read_b32 v20, a128
v_accvgpr_read_b32 v21, a129
v_accvgpr_read_b32 v22, a130
v_mfma_f32_16x16x32_bf16 a[36:39], a[176:179], a[196:199], 0
v_xor_b32 v8, 80, v5
v_accvgpr_read_b32 v23, a131
v_cvt_pk_bf16_f32 v130, v20, v21
v_cvt_pk_bf16_f32 v131, v22, v23
v_mfma_f32_16x16x32_bf16 a[40:43], a[176:179], a[200:203], 0
v_accvgpr_read_b32 v24, a132
v_accvgpr_read_b32 v25, a133
v_accvgpr_read_b32 v26, a134
v_accvgpr_read_b32 v27, a135
v_mfma_f32_16x16x32_bf16 a[44:47], a[176:179], a[204:207], 0
v_cvt_pk_bf16_f32 v134, v24, v25
v_cvt_pk_bf16_f32 v135, v26, v27
v_accvgpr_read_b32 v20, a136
v_accvgpr_read_b32 v21, a137
v_mfma_f32_16x16x32_bf16 a[48:51], a[176:179], a[208:211], 0
s_add_u32 s48, s48, s34
v_accvgpr_read_b32 v22, a138
v_accvgpr_read_b32 v23, a139
v_cvt_pk_bf16_f32 v138, v20, v21
v_cvt_pk_bf16_f32 v139, v22, v23
s_mov_b32 s38, s62
s_mov_b32 s39, s63
v_mfma_f32_16x16x32_bf16 a[52:55], a[176:179], a[212:215], 0
s_add_u32 m0, s32, 20480
v_accvgpr_read_b32 v24, a140
v_accvgpr_read_b32 v25, a141
v_accvgpr_read_b32 v26, a142
v_accvgpr_read_b32 v27, a143
s_mov_b32 s49, s50
s_mov_b32 s62, s42
v_mfma_f32_16x16x32_bf16 a[56:59], a[176:179], a[216:219], 0
buffer_load_dwordx4 v1, s[12:15], s48 offen lds
v_cvt_pk_bf16_f32 v142, v24, v25
v_cvt_pk_bf16_f32 v143, v26, v27
v_accvgpr_read_b32 v20, a144
s_mov_b32 s63, s43
s_mov_b32 s50, s51
v_mfma_f32_16x16x32_bf16 a[60:63], a[176:179], a[220:223], 0
ds_read_b64_tr_b16 a[176:177], v9 offset:0
v_accvgpr_read_b32 v21, a145
v_accvgpr_read_b32 v22, a146
v_accvgpr_read_b32 v23, a147
s_mov_b32 s36, s40
s_add_u32 s35, s35, 1
v_mfma_f32_16x16x32_bf16 a[64:67], a[180:183], a[192:195], 0
ds_read_b64_tr_b16 a[178:179], v9 offset:1024
v_cvt_pk_bf16_f32 v146, v20, v21
v_cvt_pk_bf16_f32 v147, v22, v23
v_accvgpr_read_b32 v24, a148
v_bfe_u32 v16, v0, 3, 3
v_lshlrev_b32 v16, 4, v16
v_mfma_f32_16x16x32_bf16 a[68:71], a[180:183], a[196:199], 0
v_xor_b32 v9, 128, v5
v_accvgpr_read_b32 v25, a149
v_accvgpr_read_b32 v26, a150
v_accvgpr_read_b32 v27, a151
v_and_or_b32 v16, v0, 7, v16
v_bfe_u32 v17, v0, 4, 2
v_mfma_f32_16x16x32_bf16 a[72:75], a[180:183], a[200:203], 0
v_cvt_pk_bf16_f32 v150, v24, v25
v_cvt_pk_bf16_f32 v151, v26, v27
v_accvgpr_read_b32 v20, a152
v_accvgpr_read_b32 v21, a153
v_lshlrev_b32 v17, 5, v17
v_bfe_u32 v18, v0, 1, 3
v_mfma_f32_16x16x32_bf16 a[76:79], a[180:183], a[204:207], 0
s_add_u32 s48, s48, s34
v_accvgpr_read_b32 v22, a154
v_accvgpr_read_b32 v23, a155
v_cvt_pk_bf16_f32 v154, v20, v21
v_cvt_pk_bf16_f32 v155, v22, v23
v_or_b32 v17, v17, v18
v_and_b32 v18, 1, v0
v_mfma_f32_16x16x32_bf16 a[80:83], a[180:183], a[208:211], 0
s_add_u32 m0, s32, 24576
v_accvgpr_read_b32 v24, a156
v_accvgpr_read_b32 v25, a157
v_accvgpr_read_b32 v26, a158
v_accvgpr_read_b32 v27, a159
v_lshl_or_b32 v17, v18, 4, v17
v_mfma_f32_16x16x32_bf16 a[84:87], a[180:183], a[212:215], 0
buffer_load_dwordx4 v1, s[12:15], s48 offen lds
v_cvt_pk_bf16_f32 v158, v24, v25
v_cvt_pk_bf16_f32 v159, v26, v27
s_bitcmp1_b32 s49, 1
s_cselect_b64 vcc, -1, 0
s_movk_i32 s44, 0x80
v_mfma_f32_16x16x32_bf16 a[88:91], a[180:183], a[216:219], 0
v_cndmask_b32 v16, v16, v17, vcc
v_lshlrev_b32 v13, 4, v16
s_movk_i32 s92, 0x800
s_bitcmp1_b32 s49, 0
s_cselect_b32 s92, 0x4000, s92
s_xor_b32 s93, s92, 0x4800
v_mfma_f32_16x16x32_bf16 a[92:95], a[180:183], a[220:223], 0
ds_read_b64_tr_b16 a[180:181], v10 offset:0
s_sub_u32 s93, s93, s44
v_mfma_f32_16x16x32_bf16 a[96:99], a[184:187], a[192:195], 0
ds_read_b64_tr_b16 a[182:183], v10 offset:1024
v_mfma_f32_16x16x32_bf16 a[100:103], a[184:187], a[196:199], 0
v_xor_b32 v10, 144, v5
v_mfma_f32_16x16x32_bf16 a[104:107], a[184:187], a[200:203], 0
s_add_u32 s48, s48, s34
v_mfma_f32_16x16x32_bf16 a[108:111], a[184:187], a[204:207], 0
s_add_u32 m0, s32, 28672
v_mfma_f32_16x16x32_bf16 a[112:115], a[184:187], a[208:211], 0
buffer_load_dwordx4 v1, s[12:15], s48 offen lds
v_mfma_f32_16x16x32_bf16 a[116:119], a[184:187], a[212:215], 0
s_add_u32 s30, s30, 128
v_mfma_f32_16x16x32_bf16 a[120:123], a[184:187], a[216:219], 0
s_add_u32 s32, s32, 32768
v_mfma_f32_16x16x32_bf16 a[124:127], a[184:187], a[220:223], 0
s_sub_u32 s48, s32, 98304
ds_read_b64_tr_b16 a[184:185], v11 offset:0
v_mfma_f32_16x16x32_bf16 a[128:131], a[188:191], a[192:195], 0
s_cmp_ge_u32 s32, 163840
s_cselect_b32 s32, s48, s32
ds_read_b64_tr_b16 a[186:187], v11 offset:1024
v_mfma_f32_16x16x32_bf16 a[132:135], a[188:191], a[196:199], 0
v_xor_b32 v11, 192, v5
v_mfma_f32_16x16x32_bf16 a[136:139], a[188:191], a[200:203], 0
buffer_load_dword v15, v14, s[96:99], s100 offen
v_mfma_f32_16x16x32_bf16 a[140:143], a[188:191], a[204:207], 0
s_add_u32 s100, s100, 16384
v_mfma_f32_16x16x32_bf16 a[144:147], a[188:191], a[208:211], 0
v_mfma_f32_16x16x32_bf16 a[148:151], a[188:191], a[212:215], 0
v_mfma_f32_16x16x32_bf16 a[152:155], a[188:191], a[216:219], 0
v_mfma_f32_16x16x32_bf16 a[156:159], a[188:191], a[220:223], 0
s_waitcnt vmcnt(17) lgkmcnt(0)
s_barrier
v_mfma_f32_16x16x32_bf16 v[160:163], a[160:163], a[224:227], v[160:163]
ds_read_b128 a[192:195], v3 offset:0
v_mfma_f32_16x16x32_bf16 v[164:167], a[160:163], a[228:231], v[164:167]
s_add_u32 s37, s31, 0
v_mfma_f32_16x16x32_bf16 v[168:171], a[160:163], a[232:235], v[168:171]
s_add_u32 m0, s33, 0
ds_read_b128 a[196:199], v4 offset:1024
v_mfma_f32_16x16x32_bf16 v[172:175], a[160:163], a[236:239], v[172:175]
buffer_load_dwordx4 v2, s[20:23], s37 offen  lds
v_mfma_f32_16x16x32_bf16 v[176:179], a[160:163], a[240:243], v[176:179]
s_mov_b32 s60, s38
ds_read_b128 a[200:203], v3 offset:4096
v_mfma_f32_16x16x32_bf16 v[180:183], a[160:163], a[244:247], v[180:183]
s_mov_b32 s29, s38
v_mfma_f32_16x16x32_bf16 v[184:187], a[160:163], a[248:251], v[184:187]
buffer_store_dwordx4 v[32:35], v13, s[8:11], s29 offen sc1
v_mfma_f32_16x16x32_bf16 v[188:191], a[160:163], a[252:255], v[188:191]
ds_read_b64_tr_b16 a[160:161], v5 offset:0
v_mfma_f32_16x16x32_bf16 v[192:195], a[164:167], a[224:227], v[192:195]
s_add_u32 s37, s31, 32768
ds_read_b64_tr_b16 a[162:163], v5 offset:1024
v_mfma_f32_16x16x32_bf16 v[196:199], a[164:167], a[228:231], v[196:199]
s_add_u32 m0, s33, 1024
ds_read_b128 a[204:207], v4 offset:5120
v_add_u32 v5, 16384, v5
v_mfma_f32_16x16x32_bf16 v[200:203], a[164:167], a[232:235], v[200:203]
buffer_load_dwordx4 v2, s[20:23], s37 offen  lds
v_and_b32 v5, 65535, v5
v_mfma_f32_16x16x32_bf16 v[204:207], a[164:167], a[236:239], v[204:207]
ds_read_b128 a[208:211], v3 offset:8192
v_mfma_f32_16x16x32_bf16 v[208:211], a[164:167], a[240:243], v[208:211]
v_mfma_f32_16x16x32_bf16 v[212:215], a[164:167], a[244:247], v[212:215]
ds_read_b128 a[212:215], v4 offset:9216
v_mfma_f32_16x16x32_bf16 v[216:219], a[164:167], a[248:251], v[216:219]
v_mfma_f32_16x16x32_bf16 v[220:223], a[164:167], a[252:255], v[220:223]
s_add_u32 s37, s31, 131072
ds_read_b64_tr_b16 a[164:165], v6 offset:0
v_mfma_f32_16x16x32_bf16 v[224:227], a[168:171], a[224:227], v[224:227]
s_add_u32 m0, s33, 4096
ds_read_b64_tr_b16 a[166:167], v6 offset:1024
v_mfma_f32_16x16x32_bf16 v[228:231], a[168:171], a[228:231], v[228:231]
buffer_load_dwordx4 v2, s[20:23], s37 offen  lds
v_xor_b32 v6, 16, v5
v_mfma_f32_16x16x32_bf16 v[232:235], a[168:171], a[232:235], v[232:235]
ds_read_b128 a[216:219], v3 offset:12288
v_mfma_f32_16x16x32_bf16 v[236:239], a[168:171], a[236:239], v[236:239]
v_mfma_f32_16x16x32_bf16 v[240:243], a[168:171], a[240:243], v[240:243]
ds_read_b128 a[220:223], v4 offset:13312
v_mfma_f32_16x16x32_bf16 v[244:247], a[168:171], a[244:247], v[244:247]
v_mfma_f32_16x16x32_bf16 v[248:251], a[168:171], a[248:251], v[248:251]
s_add_u32 s37, s31, 163840
ds_read_b64_tr_b16 a[188:189], v12 offset:0
v_mfma_f32_16x16x32_bf16 v[252:255], a[168:171], a[252:255], v[252:255]
s_add_u32 m0, s33, 5120
ds_read_b64_tr_b16 a[168:169], v7 offset:0
v_mfma_f32_16x16x32_bf16 a[0:3], a[172:175], a[224:227], a[0:3]
buffer_load_dwordx4 v2, s[20:23], s37 offen  lds
ds_read_b64_tr_b16 a[170:171], v7 offset:1024
v_mfma_f32_16x16x32_bf16 a[4:7], a[172:175], a[228:231], a[4:7]
s_add_u32 s31, s31, 262144
s_add_u32 s29, s29, s44
v_xor_b32 v7, 64, v5
v_mfma_f32_16x16x32_bf16 a[8:11], a[172:175], a[232:235], a[8:11]
s_add_u32 s33, s33, 16384
ds_read_b64_tr_b16 a[190:191], v12 offset:1024
v_mfma_f32_16x16x32_bf16 a[12:15], a[172:175], a[236:239], a[12:15]
s_and_b32 s33, s33, 65535
buffer_store_dwordx4 v[36:39], v13, s[8:11], s29 offen sc1
v_mfma_f32_16x16x32_bf16 a[16:19], a[172:175], a[240:243], a[16:19]
v_mfma_f32_16x16x32_bf16 a[20:23], a[172:175], a[244:247], a[20:23]
s_mov_b32 s48, s30
v_xor_b32 v12, 208, v5
v_mfma_f32_16x16x32_bf16 a[24:27], a[172:175], a[248:251], a[24:27]
s_add_u32 m0, s32, 0
v_mfma_f32_16x16x32_bf16 a[28:31], a[172:175], a[252:255], a[28:31]
buffer_load_dwordx4 v1, s[12:15], s48 offen lds
ds_read_b64_tr_b16 a[172:173], v8 offset:0
v_mfma_f32_16x16x32_bf16 a[32:35], a[176:179], a[224:227], a[32:35]
ds_read_b64_tr_b16 a[174:175], v8 offset:1024
v_mfma_f32_16x16x32_bf16 a[36:39], a[176:179], a[228:231], a[36:39]
v_xor_b32 v8, 80, v5
v_mfma_f32_16x16x32_bf16 a[40:43], a[176:179], a[232:235], a[40:43]
v_mfma_f32_16x16x32_bf16 a[44:47], a[176:179], a[236:239], a[44:47]
v_mfma_f32_16x16x32_bf16 a[48:51], a[176:179], a[240:243], a[48:51]
s_add_u32 s48, s48, s34
v_mfma_f32_16x16x32_bf16 a[52:55], a[176:179], a[244:247], a[52:55]
s_add_u32 m0, s32, 4096
v_mfma_f32_16x16x32_bf16 a[56:59], a[176:179], a[248:251], a[56:59]
buffer_load_dwordx4 v1, s[12:15], s48 offen lds
v_mfma_f32_16x16x32_bf16 a[60:63], a[176:179], a[252:255], a[60:63]
ds_read_b64_tr_b16 a[176:177], v9 offset:0
v_mfma_f32_16x16x32_bf16 a[64:67], a[180:183], a[224:227], a[64:67]
ds_read_b64_tr_b16 a[178:179], v9 offset:1024
v_mfma_f32_16x16x32_bf16 a[68:71], a[180:183], a[228:231], a[68:71]
v_xor_b32 v9, 128, v5
v_mfma_f32_16x16x32_bf16 a[72:75], a[180:183], a[232:235], a[72:75]
v_mfma_f32_16x16x32_bf16 a[76:79], a[180:183], a[236:239], a[76:79]
s_add_u32 s48, s48, s34
v_mfma_f32_16x16x32_bf16 a[80:83], a[180:183], a[240:243], a[80:83]
s_add_u32 m0, s32, 8192
v_mfma_f32_16x16x32_bf16 a[84:87], a[180:183], a[244:247], a[84:87]
buffer_load_dwordx4 v1, s[12:15], s48 offen lds
v_mfma_f32_16x16x32_bf16 a[88:91], a[180:183], a[248:251], a[88:91]
s_add_u32 s29, s29, s93
v_mfma_f32_16x16x32_bf16 a[92:95], a[180:183], a[252:255], a[92:95]
ds_read_b64_tr_b16 a[180:181], v10 offset:0
v_mfma_f32_16x16x32_bf16 a[96:99], a[184:187], a[224:227], a[96:99]
buffer_store_dwordx4 v[40:43], v13, s[8:11], s29 offen sc1
ds_read_b64_tr_b16 a[182:183], v10 offset:1024
v_mfma_f32_16x16x32_bf16 a[100:103], a[184:187], a[228:231], a[100:103]
v_xor_b32 v10, 144, v5
v_mfma_f32_16x16x32_bf16 a[104:107], a[184:187], a[232:235], a[104:107]
s_add_u32 s48, s48, s34
v_mfma_f32_16x16x32_bf16 a[108:111], a[184:187], a[236:239], a[108:111]
s_add_u32 m0, s32, 12288
v_mfma_f32_16x16x32_bf16 a[112:115], a[184:187], a[240:243], a[112:115]
buffer_load_dwordx4 v1, s[12:15], s48 offen lds
v_mfma_f32_16x16x32_bf16 a[116:119], a[184:187], a[244:247], a[116:119]
v_mfma_f32_16x16x32_bf16 a[120:123], a[184:187], a[248:251], a[120:123]
v_mfma_f32_16x16x32_bf16 a[124:127], a[184:187], a[252:255], a[124:127]
ds_read_b64_tr_b16 a[184:185], v11 offset:0
v_mfma_f32_16x16x32_bf16 a[128:131], v[28:31], a[224:227], a[128:131]
ds_read_b64_tr_b16 a[186:187], v11 offset:1024
v_mfma_f32_16x16x32_bf16 a[132:135], v[28:31], a[228:231], a[132:135]
v_xor_b32 v11, 192, v5
v_mfma_f32_16x16x32_bf16 a[136:139], v[28:31], a[232:235], a[136:139]
buffer_load_dword v15, v14, s[96:99], s100 offen
v_mfma_f32_16x16x32_bf16 a[140:143], v[28:31], a[236:239], a[140:143]
s_add_u32 s100, s100, 16384
v_mfma_f32_16x16x32_bf16 a[144:147], v[28:31], a[240:243], a[144:147]
v_mfma_f32_16x16x32_bf16 a[148:151], v[28:31], a[244:247], a[148:151]
v_mfma_f32_16x16x32_bf16 a[152:155], v[28:31], a[248:251], a[152:155]
v_mfma_f32_16x16x32_bf16 a[156:159], v[28:31], a[252:255], a[156:159]
s_waitcnt vmcnt(21) lgkmcnt(0)
s_barrier
v_mfma_f32_16x16x32_bf16 v[160:163], a[160:163], a[192:195], v[160:163]
ds_read_b128 a[224:227], v4 offset:0
v_mfma_f32_16x16x32_bf16 v[164:167], a[160:163], a[196:199], v[164:167]
s_add_u32 s37, s31, 0
v_mfma_f32_16x16x32_bf16 v[168:171], a[160:163], a[200:203], v[168:171]
s_add_u32 m0, s33, 0
ds_read_b128 a[228:231], v3 offset:1024
v_mfma_f32_16x16x32_bf16 v[172:175], a[160:163], a[204:207], v[172:175]
buffer_load_dwordx4 v2, s[20:23], s37 offen  lds
v_mfma_f32_16x16x32_bf16 v[176:179], a[160:163], a[208:211], v[176:179]
s_add_u32 s29, s29, s44
ds_read_b128 a[232:235], v4 offset:4096
v_mfma_f32_16x16x32_bf16 v[180:183], a[160:163], a[212:215], v[180:183]
v_mfma_f32_16x16x32_bf16 v[184:187], a[160:163], a[216:219], v[184:187]
buffer_store_dwordx4 v[44:47], v13, s[8:11], s29 offen sc1
v_mfma_f32_16x16x32_bf16 v[188:191], a[160:163], a[220:223], v[188:191]
ds_read_b64_tr_b16 a[160:161], v5 offset:0
v_mfma_f32_16x16x32_bf16 v[192:195], a[164:167], a[192:195], v[192:195]
s_add_u32 s37, s31, 32768
ds_read_b64_tr_b16 a[162:163], v5 offset:1024
v_mfma_f32_16x16x32_bf16 v[196:199], a[164:167], a[196:199], v[196:199]
s_add_u32 m0, s33, 1024
ds_read_b128 a[236:239], v3 offset:5120
v_add_u32 v5, 16384, v5
v_mfma_f32_16x16x32_bf16 v[200:203], a[164:167], a[200:203], v[200:203]
buffer_load_dwordx4 v2, s[20:23], s37 offen  lds
v_and_b32 v5, 65535, v5
v_mfma_f32_16x16x32_bf16 v[204:207], a[164:167], a[204:207], v[204:207]
ds_read_b128 a[240:243], v4 offset:8192
v_mfma_f32_16x16x32_bf16 v[208:211], a[164:167], a[208:211], v[208:211]
v_mfma_f32_16x16x32_bf16 v[212:215], a[164:167], a[212:215], v[212:215]
ds_read_b128 a[244:247], v3 offset:9216
v_mfma_f32_16x16x32_bf16 v[216:219], a[164:167], a[216:219], v[216:219]
v_mfma_f32_16x16x32_bf16 v[220:223], a[164:167], a[220:223], v[220:223]
s_add_u32 s37, s31, 131072
ds_read_b64_tr_b16 a[164:165], v6 offset:0
v_mfma_f32_16x16x32_bf16 v[224:227], a[168:171], a[192:195], v[224:227]
s_add_u32 m0, s33, 4096
ds_read_b64_tr_b16 a[166:167], v6 offset:1024
v_mfma_f32_16x16x32_bf16 v[228:231], a[168:171], a[196:199], v[228:231]
buffer_load_dwordx4 v2, s[20:23], s37 offen  lds
v_xor_b32 v6, 16, v5
v_mfma_f32_16x16x32_bf16 v[232:235], a[168:171], a[200:203], v[232:235]
ds_read_b128 a[248:251], v4 offset:12288
v_mfma_f32_16x16x32_bf16 v[236:239], a[168:171], a[204:207], v[236:239]
v_mfma_f32_16x16x32_bf16 v[240:243], a[168:171], a[208:211], v[240:243]
ds_read_b128 a[252:255], v3 offset:13312
v_mfma_f32_16x16x32_bf16 v[244:247], a[168:171], a[212:215], v[244:247]
v_mfma_f32_16x16x32_bf16 v[248:251], a[168:171], a[216:219], v[248:251]
s_add_u32 s37, s31, 163840
ds_read_b64_tr_b16 v[28:29], v12 offset:0
v_mfma_f32_16x16x32_bf16 v[252:255], a[168:171], a[220:223], v[252:255]
s_add_u32 m0, s33, 5120
ds_read_b64_tr_b16 a[168:169], v7 offset:0
v_mfma_f32_16x16x32_bf16 a[0:3], a[172:175], a[192:195], a[0:3]
buffer_load_dwordx4 v2, s[20:23], s37 offen  lds
ds_read_b64_tr_b16 a[170:171], v7 offset:1024
v_mfma_f32_16x16x32_bf16 a[4:7], a[172:175], a[196:199], a[4:7]
s_add_u32 s31, s31, 262144
s_add_u32 s29, s29, s93
v_xor_b32 v7, 64, v5
v_mfma_f32_16x16x32_bf16 a[8:11], a[172:175], a[200:203], a[8:11]
s_add_u32 s33, s33, 16384
ds_read_b64_tr_b16 v[30:31], v12 offset:1024
v_mfma_f32_16x16x32_bf16 a[12:15], a[172:175], a[204:207], a[12:15]
s_and_b32 s33, s33, 65535
buffer_store_dwordx4 v[48:51], v13, s[8:11], s29 offen sc1
v_mfma_f32_16x16x32_bf16 a[16:19], a[172:175], a[208:211], a[16:19]
v_mfma_f32_16x16x32_bf16 a[20:23], a[172:175], a[212:215], a[20:23]
s_add_u32 s48, s48, s34
v_xor_b32 v12, 208, v5
v_mfma_f32_16x16x32_bf16 a[24:27], a[172:175], a[216:219], a[24:27]
s_add_u32 m0, s32, 16384
v_add_u32 v3, 32768, v3
v_mfma_f32_16x16x32_bf16 a[28:31], a[172:175], a[220:223], a[28:31]
buffer_load_dwordx4 v1, s[12:15], s48 offen lds
ds_read_b64_tr_b16 a[172:173], v8 offset:0
v_mfma_f32_16x16x32_bf16 a[32:35], a[176:179], a[192:195], a[32:35]
ds_read_b64_tr_b16 a[174:175], v8 offset:1024
v_subrev_u32 v19, 98304, v3
v_mfma_f32_16x16x32_bf16 a[36:39], a[176:179], a[196:199], a[36:39]
v_xor_b32 v8, 80, v5
v_cmp_le_u32 vcc, 163840, v3
v_mfma_f32_16x16x32_bf16 a[40:43], a[176:179], a[200:203], a[40:43]
s_nop 0
v_cndmask_b32 v3, v3, v19, vcc
v_mfma_f32_16x16x32_bf16 a[44:47], a[176:179], a[204:207], a[44:47]
v_xor_b32 v4, 64, v3
v_mfma_f32_16x16x32_bf16 a[48:51], a[176:179], a[208:211], a[48:51]
s_add_u32 s48, s48, s34
v_mfma_f32_16x16x32_bf16 a[52:55], a[176:179], a[212:215], a[52:55]
s_add_u32 m0, s32, 20480
v_mfma_f32_16x16x32_bf16 a[56:59], a[176:179], a[216:219], a[56:59]
buffer_load_dwordx4 v1, s[12:15], s48 offen lds
v_mfma_f32_16x16x32_bf16 a[60:63], a[176:179], a[220:223], a[60:63]
ds_read_b64_tr_b16 a[176:177], v9 offset:0
v_mfma_f32_16x16x32_bf16 a[64:67], a[180:183], a[192:195], a[64:67]
ds_read_b64_tr_b16 a[178:179], v9 offset:1024
v_mfma_f32_16x16x32_bf16 a[68:71], a[180:183], a[196:199], a[68:71]
v_xor_b32 v9, 128, v5
v_mfma_f32_16x16x32_bf16 a[72:75], a[180:183], a[200:203], a[72:75]
v_mfma_f32_16x16x32_bf16 a[76:79], a[180:183], a[204:207], a[76:79]
s_add_u32 s48, s48, s34
v_mfma_f32_16x16x32_bf16 a[80:83], a[180:183], a[208:211], a[80:83]
s_add_u32 m0, s32, 24576
v_mfma_f32_16x16x32_bf16 a[84:87], a[180:183], a[212:215], a[84:87]
buffer_load_dwordx4 v1, s[12:15], s48 offen lds
v_mfma_f32_16x16x32_bf16 a[88:91], a[180:183], a[216:219], a[88:91]
s_add_u32 s29, s29, s44
v_mfma_f32_16x16x32_bf16 a[92:95], a[180:183], a[220:223], a[92:95]
ds_read_b64_tr_b16 a[180:181], v10 offset:0
v_mfma_f32_16x16x32_bf16 a[96:99], a[184:187], a[192:195], a[96:99]
buffer_store_dwordx4 v[52:55], v13, s[8:11], s29 offen sc1
ds_read_b64_tr_b16 a[182:183], v10 offset:1024
v_mfma_f32_16x16x32_bf16 a[100:103], a[184:187], a[196:199], a[100:103]
v_xor_b32 v10, 144, v5
v_mfma_f32_16x16x32_bf16 a[104:107], a[184:187], a[200:203], a[104:107]
s_add_u32 s48, s48, s34
v_mfma_f32_16x16x32_bf16 a[108:111], a[184:187], a[204:207], a[108:111]
s_add_u32 m0, s32, 28672
v_mfma_f32_16x16x32_bf16 a[112:115], a[184:187], a[208:211], a[112:115]
buffer_load_dwordx4 v1, s[12:15], s48 offen lds
v_mfma_f32_16x16x32_bf16 a[116:119], a[184:187], a[212:215], a[116:119]
s_add_u32 s30, s30, 128
v_mfma_f32_16x16x32_bf16 a[120:123], a[184:187], a[216:219], a[120:123]
s_add_u32 s32, s32, 32768
v_mfma_f32_16x16x32_bf16 a[124:127], a[184:187], a[220:223], a[124:127]
s_sub_u32 s48, s32, 98304
ds_read_b64_tr_b16 a[184:185], v11 offset:0
v_mfma_f32_16x16x32_bf16 a[128:131], a[188:191], a[192:195], a[128:131]
s_cmp_ge_u32 s32, 163840
s_cselect_b32 s32, s48, s32
ds_read_b64_tr_b16 a[186:187], v11 offset:1024
v_mfma_f32_16x16x32_bf16 a[132:135], a[188:191], a[196:199], a[132:135]
v_xor_b32 v11, 192, v5
v_mfma_f32_16x16x32_bf16 a[136:139], a[188:191], a[200:203], a[136:139]
buffer_load_dword v15, v14, s[96:99], s100 offen
v_mfma_f32_16x16x32_bf16 a[140:143], a[188:191], a[204:207], a[140:143]
s_add_u32 s100, s100, 16384
v_mfma_f32_16x16x32_bf16 a[144:147], a[188:191], a[208:211], a[144:147]
v_mfma_f32_16x16x32_bf16 a[148:151], a[188:191], a[212:215], a[148:151]
v_mfma_f32_16x16x32_bf16 a[152:155], a[188:191], a[216:219], a[152:155]
v_mfma_f32_16x16x32_bf16 a[156:159], a[188:191], a[220:223], a[156:159]
s_waitcnt vmcnt(24) lgkmcnt(0)
s_barrier
v_mfma_f32_16x16x32_bf16 v[160:163], a[160:163], a[224:227], v[160:163]
ds_read_b128 a[192:195], v3 offset:0
v_mfma_f32_16x16x32_bf16 v[164:167], a[160:163], a[228:231], v[164:167]
s_add_u32 s37, s31, 0
v_mfma_f32_16x16x32_bf16 v[168:171], a[160:163], a[232:235], v[168:171]
s_add_u32 m0, s33, 0
ds_read_b128 a[196:199], v4 offset:1024
v_mfma_f32_16x16x32_bf16 v[172:175], a[160:163], a[236:239], v[172:175]
buffer_load_dwordx4 v2, s[20:23], s37 offen  lds
v_mfma_f32_16x16x32_bf16 v[176:179], a[160:163], a[240:243], v[176:179]
s_add_u32 s29, s29, s93
ds_read_b128 a[200:203], v3 offset:4096
v_mfma_f32_16x16x32_bf16 v[180:183], a[160:163], a[244:247], v[180:183]
v_mfma_f32_16x16x32_bf16 v[184:187], a[160:163], a[248:251], v[184:187]
buffer_store_dwordx4 v[56:59], v13, s[8:11], s29 offen sc1
v_mfma_f32_16x16x32_bf16 v[188:191], a[160:163], a[252:255], v[188:191]
ds_read_b64_tr_b16 a[160:161], v5 offset:0
v_mfma_f32_16x16x32_bf16 v[192:195], a[164:167], a[224:227], v[192:195]
s_add_u32 s37, s31, 32768
ds_read_b64_tr_b16 a[162:163], v5 offset:1024
v_mfma_f32_16x16x32_bf16 v[196:199], a[164:167], a[228:231], v[196:199]
s_add_u32 m0, s33, 1024
ds_read_b128 a[204:207], v4 offset:5120
v_add_u32 v5, 16384, v5
v_mfma_f32_16x16x32_bf16 v[200:203], a[164:167], a[232:235], v[200:203]
buffer_load_dwordx4 v2, s[20:23], s37 offen  lds
v_and_b32 v5, 65535, v5
v_mfma_f32_16x16x32_bf16 v[204:207], a[164:167], a[236:239], v[204:207]
ds_read_b128 a[208:211], v3 offset:8192
v_mfma_f32_16x16x32_bf16 v[208:211], a[164:167], a[240:243], v[208:211]
v_mfma_f32_16x16x32_bf16 v[212:215], a[164:167], a[244:247], v[212:215]
ds_read_b128 a[212:215], v4 offset:9216
v_mfma_f32_16x16x32_bf16 v[216:219], a[164:167], a[248:251], v[216:219]
v_mfma_f32_16x16x32_bf16 v[220:223], a[164:167], a[252:255], v[220:223]
s_add_u32 s37, s31, 131072
ds_read_b64_tr_b16 a[164:165], v6 offset:0
v_mfma_f32_16x16x32_bf16 v[224:227], a[168:171], a[224:227], v[224:227]
s_add_u32 m0, s33, 4096
ds_read_b64_tr_b16 a[166:167], v6 offset:1024
v_mfma_f32_16x16x32_bf16 v[228:231], a[168:171], a[228:231], v[228:231]
buffer_load_dwordx4 v2, s[20:23], s37 offen  lds
v_xor_b32 v6, 16, v5
v_mfma_f32_16x16x32_bf16 v[232:235], a[168:171], a[232:235], v[232:235]
ds_read_b128 a[216:219], v3 offset:12288
v_mfma_f32_16x16x32_bf16 v[236:239], a[168:171], a[236:239], v[236:239]
v_mfma_f32_16x16x32_bf16 v[240:243], a[168:171], a[240:243], v[240:243]
ds_read_b128 a[220:223], v4 offset:13312
v_mfma_f32_16x16x32_bf16 v[244:247], a[168:171], a[244:247], v[244:247]
v_mfma_f32_16x16x32_bf16 v[248:251], a[168:171], a[248:251], v[248:251]
s_add_u32 s37, s31, 163840
ds_read_b64_tr_b16 a[188:189], v12 offset:0
v_mfma_f32_16x16x32_bf16 v[252:255], a[168:171], a[252:255], v[252:255]
s_add_u32 m0, s33, 5120
ds_read_b64_tr_b16 a[168:169], v7 offset:0
v_mfma_f32_16x16x32_bf16 a[0:3], a[172:175], a[224:227], a[0:3]
buffer_load_dwordx4 v2, s[20:23], s37 offen  lds
ds_read_b64_tr_b16 a[170:171], v7 offset:1024
v_mfma_f32_16x16x32_bf16 a[4:7], a[172:175], a[228:231], a[4:7]
s_add_u32 s31, s31, 262144
s_add_u32 s29, s29, s44
v_xor_b32 v7, 64, v5
v_mfma_f32_16x16x32_bf16 a[8:11], a[172:175], a[232:235], a[8:11]
s_add_u32 s33, s33, 16384
ds_read_b64_tr_b16 a[190:191], v12 offset:1024
v_mfma_f32_16x16x32_bf16 a[12:15], a[172:175], a[236:239], a[12:15]
s_and_b32 s33, s33, 65535
buffer_store_dwordx4 v[60:63], v13, s[8:11], s29 offen sc1
v_mfma_f32_16x16x32_bf16 a[16:19], a[172:175], a[240:243], a[16:19]
v_mfma_f32_16x16x32_bf16 a[20:23], a[172:175], a[244:247], a[20:23]
s_mov_b32 s48, s30
v_xor_b32 v12, 208, v5
v_mfma_f32_16x16x32_bf16 a[24:27], a[172:175], a[248:251], a[24:27]
s_add_u32 m0, s32, 0
v_mfma_f32_16x16x32_bf16 a[28:31], a[172:175], a[252:255], a[28:31]
buffer_load_dwordx4 v1, s[12:15], s48 offen lds
ds_read_b64_tr_b16 a[172:173], v8 offset:0
v_mfma_f32_16x16x32_bf16 a[32:35], a[176:179], a[224:227], a[32:35]
ds_read_b64_tr_b16 a[174:175], v8 offset:1024
v_mfma_f32_16x16x32_bf16 a[36:39], a[176:179], a[228:231], a[36:39]
v_xor_b32 v8, 80, v5
v_mfma_f32_16x16x32_bf16 a[40:43], a[176:179], a[232:235], a[40:43]
v_mfma_f32_16x16x32_bf16 a[44:47], a[176:179], a[236:239], a[44:47]
v_mfma_f32_16x16x32_bf16 a[48:51], a[176:179], a[240:243], a[48:51]
s_add_u32 s48, s48, s34
v_mfma_f32_16x16x32_bf16 a[52:55], a[176:179], a[244:247], a[52:55]
s_add_u32 m0, s32, 4096
v_mfma_f32_16x16x32_bf16 a[56:59], a[176:179], a[248:251], a[56:59]
buffer_load_dwordx4 v1, s[12:15], s48 offen lds
v_mfma_f32_16x16x32_bf16 a[60:63], a[176:179], a[252:255], a[60:63]
ds_read_b64_tr_b16 a[176:177], v9 offset:0
v_mfma_f32_16x16x32_bf16 a[64:67], a[180:183], a[224:227], a[64:67]
ds_read_b64_tr_b16 a[178:179], v9 offset:1024
v_mfma_f32_16x16x32_bf16 a[68:71], a[180:183], a[228:231], a[68:71]
v_xor_b32 v9, 128, v5
v_mfma_f32_16x16x32_bf16 a[72:75], a[180:183], a[232:235], a[72:75]
v_mfma_f32_16x16x32_bf16 a[76:79], a[180:183], a[236:239], a[76:79]
s_add_u32 s48, s48, s34
v_mfma_f32_16x16x32_bf16 a[80:83], a[180:183], a[240:243], a[80:83]
s_add_u32 m0, s32, 8192
v_mfma_f32_16x16x32_bf16 a[84:87], a[180:183], a[244:247], a[84:87]
buffer_load_dwordx4 v1, s[12:15], s48 offen lds
v_mfma_f32_16x16x32_bf16 a[88:91], a[180:183], a[248:251], a[88:91]
v_mfma_f32_16x16x32_bf16 a[92:95], a[180:183], a[252:255], a[92:95]
ds_read_b64_tr_b16 a[180:181], v10 offset:0
v_mfma_f32_16x16x32_bf16 a[96:99], a[184:187], a[224:227], a[96:99]
ds_read_b64_tr_b16 a[182:183], v10 offset:1024
v_mfma_f32_16x16x32_bf16 a[100:103], a[184:187], a[228:231], a[100:103]
v_xor_b32 v10, 144, v5
v_mfma_f32_16x16x32_bf16 a[104:107], a[184:187], a[232:235], a[104:107]
s_add_u32 s48, s48, s34
v_mfma_f32_16x16x32_bf16 a[108:111], a[184:187], a[236:239], a[108:111]
s_add_u32 m0, s32, 12288
v_mfma_f32_16x16x32_bf16 a[112:115], a[184:187], a[240:243], a[112:115]
buffer_load_dwordx4 v1, s[12:15], s48 offen lds
v_mfma_f32_16x16x32_bf16 a[116:119], a[184:187], a[244:247], a[116:119]
v_mfma_f32_16x16x32_bf16 a[120:123], a[184:187], a[248:251], a[120:123]
v_mfma_f32_16x16x32_bf16 a[124:127], a[184:187], a[252:255], a[124:127]
ds_read_b64_tr_b16 a[184:185], v11 offset:0
v_mfma_f32_16x16x32_bf16 a[128:131], v[28:31], a[224:227], a[128:131]
ds_read_b64_tr_b16 a[186:187], v11 offset:1024
v_mfma_f32_16x16x32_bf16 a[132:135], v[28:31], a[228:231], a[132:135]
v_xor_b32 v11, 192, v5
v_mfma_f32_16x16x32_bf16 a[136:139], v[28:31], a[232:235], a[136:139]
buffer_load_dword v15, v14, s[96:99], s100 offen
v_mfma_f32_16x16x32_bf16 a[140:143], v[28:31], a[236:239], a[140:143]
s_add_u32 s100, s100, 16384
v_mfma_f32_16x16x32_bf16 a[144:147], v[28:31], a[240:243], a[144:147]
v_mfma_f32_16x16x32_bf16 a[148:151], v[28:31], a[244:247], a[148:151]
v_mfma_f32_16x16x32_bf16 a[152:155], v[28:31], a[248:251], a[152:155]
v_mfma_f32_16x16x32_bf16 a[156:159], v[28:31], a[252:255], a[156:159]
s_waitcnt vmcnt(23) lgkmcnt(0)
s_barrier
v_mfma_f32_16x16x32_bf16 v[160:163], a[160:163], a[192:195], v[160:163]
ds_read_b128 a[224:227], v4 offset:0
v_mfma_f32_16x16x32_bf16 v[164:167], a[160:163], a[196:199], v[164:167]
s_add_u32 s37, s31, 0
v_mfma_f32_16x16x32_bf16 v[168:171], a[160:163], a[200:203], v[168:171]
s_add_u32 m0, s33, 0
ds_read_b128 a[228:231], v3 offset:1024
v_mfma_f32_16x16x32_bf16 v[172:175], a[160:163], a[204:207], v[172:175]
buffer_load_dwordx4 v2, s[20:23], s37 offen  lds
v_mfma_f32_16x16x32_bf16 v[176:179], a[160:163], a[208:211], v[176:179]
s_add_u32 s60, s60, s92
ds_read_b128 a[232:235], v4 offset:4096
v_mfma_f32_16x16x32_bf16 v[180:183], a[160:163], a[212:215], v[180:183]
s_mov_b32 s29, s60
v_mfma_f32_16x16x32_bf16 v[184:187], a[160:163], a[216:219], v[184:187]
buffer_store_dwordx4 v[64:67], v13, s[8:11], s29 offen sc1
v_mfma_f32_16x16x32_bf16 v[188:191], a[160:163], a[220:223], v[188:191]
ds_read_b64_tr_b16 a[160:161], v5 offset:0
v_mfma_f32_16x16x32_bf16 v[192:195], a[164:167], a[192:195], v[192:195]
s_add_u32 s37, s31, 32768
ds_read_b64_tr_b16 a[162:163], v5 offset:1024
v_mfma_f32_16x16x32_bf16 v[196:199], a[164:167], a[196:199], v[196:199]
s_add_u32 m0, s33, 1024
ds_read_b128 a[236:239], v3 offset:5120
v_add_u32 v5, 16384, v5
v_mfma_f32_16x16x32_bf16 v[200:203], a[164:167], a[200:203], v[200:203]
buffer_load_dwordx4 v2, s[20:23], s37 offen  lds
v_and_b32 v5, 65535, v5
v_mfma_f32_16x16x32_bf16 v[204:207], a[164:167], a[204:207], v[204:207]
ds_read_b128 a[240:243], v4 offset:8192
v_mfma_f32_16x16x32_bf16 v[208:211], a[164:167], a[208:211], v[208:211]
v_mfma_f32_16x16x32_bf16 v[212:215], a[164:167], a[212:215], v[212:215]
ds_read_b128 a[244:247], v3 offset:9216
v_mfma_f32_16x16x32_bf16 v[216:219], a[164:167], a[216:219], v[216:219]
v_mfma_f32_16x16x32_bf16 v[220:223], a[164:167], a[220:223], v[220:223]
s_add_u32 s37, s31, 131072
ds_read_b64_tr_b16 a[164:165], v6 offset:0
v_mfma_f32_16x16x32_bf16 v[224:227], a[168:171], a[192:195], v[224:227]
s_add_u32 m0, s33, 4096
ds_read_b64_tr_b16 a[166:167], v6 offset:1024
v_mfma_f32_16x16x32_bf16 v[228:231], a[168:171], a[196:199], v[228:231]
buffer_load_dwordx4 v2, s[20:23], s37 offen  lds
v_xor_b32 v6, 16, v5
v_mfma_f32_16x16x32_bf16 v[232:235], a[168:171], a[200:203], v[232:235]
ds_read_b128 a[248:251], v4 offset:12288
v_mfma_f32_16x16x32_bf16 v[236:239], a[168:171], a[204:207], v[236:239]
v_mfma_f32_16x16x32_bf16 v[240:243], a[168:171], a[208:211], v[240:243]
ds_read_b128 a[252:255], v3 offset:13312
v_mfma_f32_16x16x32_bf16 v[244:247], a[168:171], a[212:215], v[244:247]
v_mfma_f32_16x16x32_bf16 v[248:251], a[168:171], a[216:219], v[248:251]
s_add_u32 s37, s31, 163840
ds_read_b64_tr_b16 v[28:29], v12 offset:0
v_mfma_f32_16x16x32_bf16 v[252:255], a[168:171], a[220:223], v[252:255]
s_add_u32 m0, s33, 5120
ds_read_b64_tr_b16 a[168:169], v7 offset:0
v_mfma_f32_16x16x32_bf16 a[0:3], a[172:175], a[192:195], a[0:3]
buffer_load_dwordx4 v2, s[20:23], s37 offen  lds
ds_read_b64_tr_b16 a[170:171], v7 offset:1024
v_mfma_f32_16x16x32_bf16 a[4:7], a[172:175], a[196:199], a[4:7]
s_add_u32 s31, s31, 262144
s_add_u32 s29, s29, s44
v_xor_b32 v7, 64, v5
v_mfma_f32_16x16x32_bf16 a[8:11], a[172:175], a[200:203], a[8:11]
s_add_u32 s33, s33, 16384
ds_read_b64_tr_b16 v[30:31], v12 offset:1024
v_mfma_f32_16x16x32_bf16 a[12:15], a[172:175], a[204:207], a[12:15]
s_and_b32 s33, s33, 65535
buffer_store_dwordx4 v[68:71], v13, s[8:11], s29 offen sc1
v_mfma_f32_16x16x32_bf16 a[16:19], a[172:175], a[208:211], a[16:19]
v_mfma_f32_16x16x32_bf16 a[20:23], a[172:175], a[212:215], a[20:23]
s_add_u32 s48, s48, s34
v_xor_b32 v12, 208, v5
v_mfma_f32_16x16x32_bf16 a[24:27], a[172:175], a[216:219], a[24:27]
s_add_u32 m0, s32, 16384
v_add_u32 v3, 32768, v3
v_mfma_f32_16x16x32_bf16 a[28:31], a[172:175], a[220:223], a[28:31]
buffer_load_dwordx4 v1, s[12:15], s48 offen lds
ds_read_b64_tr_b16 a[172:173], v8 offset:0
v_mfma_f32_16x16x32_bf16 a[32:35], a[176:179], a[192:195], a[32:35]
ds_read_b64_tr_b16 a[174:175], v8 offset:1024
v_subrev_u32 v19, 98304, v3
v_mfma_f32_16x16x32_bf16 a[36:39], a[176:179], a[196:199], a[36:39]
v_xor_b32 v8, 80, v5
v_cmp_le_u32 vcc, 163840, v3
v_mfma_f32_16x16x32_bf16 a[40:43], a[176:179], a[200:203], a[40:43]
s_nop 0
v_cndmask_b32 v3, v3, v19, vcc
v_mfma_f32_16x16x32_bf16 a[44:47], a[176:179], a[204:207], a[44:47]
v_xor_b32 v4, 64, v3
v_mfma_f32_16x16x32_bf16 a[48:51], a[176:179], a[208:211], a[48:51]
s_add_u32 s48, s48, s34
v_mfma_f32_16x16x32_bf16 a[52:55], a[176:179], a[212:215], a[52:55]
s_add_u32 m0, s32, 20480
v_mfma_f32_16x16x32_bf16 a[56:59], a[176:179], a[216:219], a[56:59]
buffer_load_dwordx4 v1, s[12:15], s48 offen lds
v_mfma_f32_16x16x32_bf16 a[60:63], a[176:179], a[220:223], a[60:63]
ds_read_b64_tr_b16 a[176:177], v9 offset:0
v_mfma_f32_16x16x32_bf16 a[64:67], a[180:183], a[192:195], a[64:67]
ds_read_b64_tr_b16 a[178:179], v9 offset:1024
v_mfma_f32_16x16x32_bf16 a[68:71], a[180:183], a[196:199], a[68:71]
v_xor_b32 v9, 128, v5
v_mfma_f32_16x16x32_bf16 a[72:75], a[180:183], a[200:203], a[72:75]
v_mfma_f32_16x16x32_bf16 a[76:79], a[180:183], a[204:207], a[76:79]
s_add_u32 s48, s48, s34
v_mfma_f32_16x16x32_bf16 a[80:83], a[180:183], a[208:211], a[80:83]
s_add_u32 m0, s32, 24576
v_mfma_f32_16x16x32_bf16 a[84:87], a[180:183], a[212:215], a[84:87]
buffer_load_dwordx4 v1, s[12:15], s48 offen lds
v_mfma_f32_16x16x32_bf16 a[88:91], a[180:183], a[216:219], a[88:91]
s_add_u32 s29, s29, s93
v_mfma_f32_16x16x32_bf16 a[92:95], a[180:183], a[220:223], a[92:95]
ds_read_b64_tr_b16 a[180:181], v10 offset:0
v_mfma_f32_16x16x32_bf16 a[96:99], a[184:187], a[192:195], a[96:99]
buffer_store_dwordx4 v[72:75], v13, s[8:11], s29 offen sc1
ds_read_b64_tr_b16 a[182:183], v10 offset:1024
v_mfma_f32_16x16x32_bf16 a[100:103], a[184:187], a[196:199], a[100:103]
v_xor_b32 v10, 144, v5
v_mfma_f32_16x16x32_bf16 a[104:107], a[184:187], a[200:203], a[104:107]
s_add_u32 s48, s48, s34
v_mfma_f32_16x16x32_bf16 a[108:111], a[184:187], a[204:207], a[108:111]
s_add_u32 m0, s32, 28672
v_mfma_f32_16x16x32_bf16 a[112:115], a[184:187], a[208:211], a[112:115]
buffer_load_dwordx4 v1, s[12:15], s48 offen lds
v_mfma_f32_16x16x32_bf16 a[116:119], a[184:187], a[212:215], a[116:119]
s_add_u32 s30, s30, 128
v_mfma_f32_16x16x32_bf16 a[120:123], a[184:187], a[216:219], a[120:123]
s_add_u32 s32, s32, 32768
v_mfma_f32_16x16x32_bf16 a[124:127], a[184:187], a[220:223], a[124:127]
s_sub_u32 s48, s32, 98304
ds_read_b64_tr_b16 a[184:185], v11 offset:0
v_mfma_f32_16x16x32_bf16 a[128:131], a[188:191], a[192:195], a[128:131]
s_cmp_ge_u32 s32, 163840
s_cselect_b32 s32, s48, s32
ds_read_b64_tr_b16 a[186:187], v11 offset:1024
v_mfma_f32_16x16x32_bf16 a[132:135], a[188:191], a[196:199], a[132:135]
v_xor_b32 v11, 192, v5
v_mfma_f32_16x16x32_bf16 a[136:139], a[188:191], a[200:203], a[136:139]
buffer_load_dword v15, v14, s[96:99], s100 offen
v_mfma_f32_16x16x32_bf16 a[140:143], a[188:191], a[204:207], a[140:143]
s_add_u32 s100, s100, 16384
v_mfma_f32_16x16x32_bf16 a[144:147], a[188:191], a[208:211], a[144:147]
v_mfma_f32_16x16x32_bf16 a[148:151], a[188:191], a[212:215], a[148:151]
v_mfma_f32_16x16x32_bf16 a[152:155], a[188:191], a[216:219], a[152:155]
v_mfma_f32_16x16x32_bf16 a[156:159], a[188:191], a[220:223], a[156:159]
s_waitcnt vmcnt(23) lgkmcnt(0)
s_barrier
v_mfma_f32_16x16x32_bf16 v[160:163], a[160:163], a[224:227], v[160:163]
ds_read_b128 a[192:195], v3 offset:0
v_mfma_f32_16x16x32_bf16 v[164:167], a[160:163], a[228:231], v[164:167]
s_add_u32 s37, s31, 0
v_mfma_f32_16x16x32_bf16 v[168:171], a[160:163], a[232:235], v[168:171]
s_add_u32 m0, s33, 0
ds_read_b128 a[196:199], v4 offset:1024
v_mfma_f32_16x16x32_bf16 v[172:175], a[160:163], a[236:239], v[172:175]
buffer_load_dwordx4 v2, s[20:23], s37 offen  lds
v_mfma_f32_16x16x32_bf16 v[176:179], a[160:163], a[240:243], v[176:179]
s_add_u32 s29, s29, s44
ds_read_b128 a[200:203], v3 offset:4096
v_mfma_f32_16x16x32_bf16 v[180:183], a[160:163], a[244:247], v[180:183]
v_mfma_f32_16x16x32_bf16 v[184:187], a[160:163], a[248:251], v[184:187]
buffer_store_dwordx4 v[76:79], v13, s[8:11], s29 offen sc1
v_mfma_f32_16x16x32_bf16 v[188:191], a[160:163], a[252:255], v[188:191]
ds_read_b64_tr_b16 a[160:161], v5 offset:0
v_mfma_f32_16x16x32_bf16 v[192:195], a[164:167], a[224:227], v[192:195]
s_add_u32 s37, s31, 32768
ds_read_b64_tr_b16 a[162:163], v5 offset:1024
v_mfma_f32_16x16x32_bf16 v[196:199], a[164:167], a[228:231], v[196:199]
s_add_u32 m0, s33, 1024
ds_read_b128 a[204:207], v4 offset:5120
v_add_u32 v5, 16384, v5
v_mfma_f32_16x16x32_bf16 v[200:203], a[164:167], a[232:235], v[200:203]
buffer_load_dwordx4 v2, s[20:23], s37 offen  lds
v_and_b32 v5, 65535, v5
v_mfma_f32_16x16x32_bf16 v[204:207], a[164:167], a[236:239], v[204:207]
ds_read_b128 a[208:211], v3 offset:8192
v_mfma_f32_16x16x32_bf16 v[208:211], a[164:167], a[240:243], v[208:211]
v_mfma_f32_16x16x32_bf16 v[212:215], a[164:167], a[244:247], v[212:215]
ds_read_b128 a[212:215], v4 offset:9216
v_mfma_f32_16x16x32_bf16 v[216:219], a[164:167], a[248:251], v[216:219]
v_mfma_f32_16x16x32_bf16 v[220:223], a[164:167], a[252:255], v[220:223]
s_add_u32 s37, s31, 131072
ds_read_b64_tr_b16 a[164:165], v6 offset:0
v_mfma_f32_16x16x32_bf16 v[224:227], a[168:171], a[224:227], v[224:227]
s_add_u32 m0, s33, 4096
ds_read_b64_tr_b16 a[166:167], v6 offset:1024
v_mfma_f32_16x16x32_bf16 v[228:231], a[168:171], a[228:231], v[228:231]
buffer_load_dwordx4 v2, s[20:23], s37 offen  lds
v_xor_b32 v6, 16, v5
v_mfma_f32_16x16x32_bf16 v[232:235], a[168:171], a[232:235], v[232:235]
ds_read_b128 a[216:219], v3 offset:12288
v_mfma_f32_16x16x32_bf16 v[236:239], a[168:171], a[236:239], v[236:239]
v_mfma_f32_16x16x32_bf16 v[240:243], a[168:171], a[240:243], v[240:243]
ds_read_b128 a[220:223], v4 offset:13312
v_mfma_f32_16x16x32_bf16 v[244:247], a[168:171], a[244:247], v[244:247]
v_mfma_f32_16x16x32_bf16 v[248:251], a[168:171], a[248:251], v[248:251]
s_add_u32 s37, s31, 163840
ds_read_b64_tr_b16 a[188:189], v12 offset:0
v_mfma_f32_16x16x32_bf16 v[252:255], a[168:171], a[252:255], v[252:255]
s_add_u32 m0, s33, 5120
ds_read_b64_tr_b16 a[168:169], v7 offset:0
v_mfma_f32_16x16x32_bf16 a[0:3], a[172:175], a[224:227], a[0:3]
buffer_load_dwordx4 v2, s[20:23], s37 offen  lds
ds_read_b64_tr_b16 a[170:171], v7 offset:1024
v_mfma_f32_16x16x32_bf16 a[4:7], a[172:175], a[228:231], a[4:7]
s_add_u32 s31, s31, 262144
s_add_u32 s29, s29, s93
v_xor_b32 v7, 64, v5
v_mfma_f32_16x16x32_bf16 a[8:11], a[172:175], a[232:235], a[8:11]
s_add_u32 s33, s33, 16384
ds_read_b64_tr_b16 a[190:191], v12 offset:1024
v_mfma_f32_16x16x32_bf16 a[12:15], a[172:175], a[236:239], a[12:15]
s_and_b32 s33, s33, 65535
buffer_store_dwordx4 v[80:83], v13, s[8:11], s29 offen sc1
v_mfma_f32_16x16x32_bf16 a[16:19], a[172:175], a[240:243], a[16:19]
v_mfma_f32_16x16x32_bf16 a[20:23], a[172:175], a[244:247], a[20:23]
s_mov_b32 s48, s30
v_xor_b32 v12, 208, v5
v_mfma_f32_16x16x32_bf16 a[24:27], a[172:175], a[248:251], a[24:27]
s_add_u32 m0, s32, 0
v_mfma_f32_16x16x32_bf16 a[28:31], a[172:175], a[252:255], a[28:31]
buffer_load_dwordx4 v1, s[12:15], s48 offen lds
ds_read_b64_tr_b16 a[172:173], v8 offset:0
v_mfma_f32_16x16x32_bf16 a[32:35], a[176:179], a[224:227], a[32:35]
ds_read_b64_tr_b16 a[174:175], v8 offset:1024
v_mfma_f32_16x16x32_bf16 a[36:39], a[176:179], a[228:231], a[36:39]
v_xor_b32 v8, 80, v5
v_mfma_f32_16x16x32_bf16 a[40:43], a[176:179], a[232:235], a[40:43]
v_mfma_f32_16x16x32_bf16 a[44:47], a[176:179], a[236:239], a[44:47]
v_mfma_f32_16x16x32_bf16 a[48:51], a[176:179], a[240:243], a[48:51]
s_add_u32 s48, s48, s34
v_mfma_f32_16x16x32_bf16 a[52:55], a[176:179], a[244:247], a[52:55]
s_add_u32 m0, s32, 4096
v_mfma_f32_16x16x32_bf16 a[56:59], a[176:179], a[248:251], a[56:59]
buffer_load_dwordx4 v1, s[12:15], s48 offen lds
v_mfma_f32_16x16x32_bf16 a[60:63], a[176:179], a[252:255], a[60:63]
ds_read_b64_tr_b16 a[176:177], v9 offset:0
v_mfma_f32_16x16x32_bf16 a[64:67], a[180:183], a[224:227], a[64:67]
ds_read_b64_tr_b16 a[178:179], v9 offset:1024
v_mfma_f32_16x16x32_bf16 a[68:71], a[180:183], a[228:231], a[68:71]
v_xor_b32 v9, 128, v5
v_mfma_f32_16x16x32_bf16 a[72:75], a[180:183], a[232:235], a[72:75]
v_mfma_f32_16x16x32_bf16 a[76:79], a[180:183], a[236:239], a[76:79]
s_add_u32 s48, s48, s34
v_mfma_f32_16x16x32_bf16 a[80:83], a[180:183], a[240:243], a[80:83]
s_add_u32 m0, s32, 8192
v_mfma_f32_16x16x32_bf16 a[84:87], a[180:183], a[244:247], a[84:87]
buffer_load_dwordx4 v1, s[12:15], s48 offen lds
v_mfma_f32_16x16x32_bf16 a[88:91], a[180:183], a[248:251], a[88:91]
s_add_u32 s29, s29, s44
v_mfma_f32_16x16x32_bf16 a[92:95], a[180:183], a[252:255], a[92:95]
ds_read_b64_tr_b16 a[180:181], v10 offset:0
v_mfma_f32_16x16x32_bf16 a[96:99], a[184:187], a[224:227], a[96:99]
buffer_store_dwordx4 v[84:87], v13, s[8:11], s29 offen sc1
ds_read_b64_tr_b16 a[182:183], v10 offset:1024
v_mfma_f32_16x16x32_bf16 a[100:103], a[184:187], a[228:231], a[100:103]
v_xor_b32 v10, 144, v5
v_mfma_f32_16x16x32_bf16 a[104:107], a[184:187], a[232:235], a[104:107]
s_add_u32 s48, s48, s34
v_mfma_f32_16x16x32_bf16 a[108:111], a[184:187], a[236:239], a[108:111]
s_add_u32 m0, s32, 12288
v_mfma_f32_16x16x32_bf16 a[112:115], a[184:187], a[240:243], a[112:115]
buffer_load_dwordx4 v1, s[12:15], s48 offen lds
v_mfma_f32_16x16x32_bf16 a[116:119], a[184:187], a[244:247], a[116:119]
v_mfma_f32_16x16x32_bf16 a[120:123], a[184:187], a[248:251], a[120:123]
v_mfma_f32_16x16x32_bf16 a[124:127], a[184:187], a[252:255], a[124:127]
ds_read_b64_tr_b16 a[184:185], v11 offset:0
v_mfma_f32_16x16x32_bf16 a[128:131], v[28:31], a[224:227], a[128:131]
ds_read_b64_tr_b16 a[186:187], v11 offset:1024
v_mfma_f32_16x16x32_bf16 a[132:135], v[28:31], a[228:231], a[132:135]
v_xor_b32 v11, 192, v5
v_mfma_f32_16x16x32_bf16 a[136:139], v[28:31], a[232:235], a[136:139]
buffer_load_dword v15, v14, s[96:99], s100 offen
v_mfma_f32_16x16x32_bf16 a[140:143], v[28:31], a[236:239], a[140:143]
s_add_u32 s100, s100, 16384
v_mfma_f32_16x16x32_bf16 a[144:147], v[28:31], a[240:243], a[144:147]
v_mfma_f32_16x16x32_bf16 a[148:151], v[28:31], a[244:247], a[148:151]
v_mfma_f32_16x16x32_bf16 a[152:155], v[28:31], a[248:251], a[152:155]
v_mfma_f32_16x16x32_bf16 a[156:159], v[28:31], a[252:255], a[156:159]
s_waitcnt vmcnt(24) lgkmcnt(0)
s_barrier
v_mfma_f32_16x16x32_bf16 v[160:163], a[160:163], a[192:195], v[160:163]
ds_read_b128 a[224:227], v4 offset:0
v_mfma_f32_16x16x32_bf16 v[164:167], a[160:163], a[196:199], v[164:167]
s_add_u32 s37, s31, 0
v_mfma_f32_16x16x32_bf16 v[168:171], a[160:163], a[200:203], v[168:171]
s_add_u32 m0, s33, 0
ds_read_b128 a[228:231], v3 offset:1024
v_mfma_f32_16x16x32_bf16 v[172:175], a[160:163], a[204:207], v[172:175]
buffer_load_dwordx4 v2, s[20:23], s37 offen  lds
v_mfma_f32_16x16x32_bf16 v[176:179], a[160:163], a[208:211], v[176:179]
s_add_u32 s29, s29, s93
ds_read_b128 a[232:235], v4 offset:4096
v_mfma_f32_16x16x32_bf16 v[180:183], a[160:163], a[212:215], v[180:183]
v_mfma_f32_16x16x32_bf16 v[184:187], a[160:163], a[216:219], v[184:187]
buffer_store_dwordx4 v[88:91], v13, s[8:11], s29 offen sc1
v_mfma_f32_16x16x32_bf16 v[188:191], a[160:163], a[220:223], v[188:191]
ds_read_b64_tr_b16 a[160:161], v5 offset:0
v_mfma_f32_16x16x32_bf16 v[192:195], a[164:167], a[192:195], v[192:195]
s_add_u32 s37, s31, 32768
ds_read_b64_tr_b16 a[162:163], v5 offset:1024
v_mfma_f32_16x16x32_bf16 v[196:199], a[164:167], a[196:199], v[196:199]
s_add_u32 m0, s33, 1024
ds_read_b128 a[236:239], v3 offset:5120
v_add_u32 v5, 16384, v5
v_mfma_f32_16x16x32_bf16 v[200:203], a[164:167], a[200:203], v[200:203]
buffer_load_dwordx4 v2, s[20:23], s37 offen  lds
v_and_b32 v5, 65535, v5
v_mfma_f32_16x16x32_bf16 v[204:207], a[164:167], a[204:207], v[204:207]
ds_read_b128 a[240:243], v4 offset:8192
v_mfma_f32_16x16x32_bf16 v[208:211], a[164:167], a[208:211], v[208:211]
v_mfma_f32_16x16x32_bf16 v[212:215], a[164:167], a[212:215], v[212:215]
ds_read_b128 a[244:247], v3 offset:9216
v_mfma_f32_16x16x32_bf16 v[216:219], a[164:167], a[216:219], v[216:219]
v_mfma_f32_16x16x32_bf16 v[220:223], a[164:167], a[220:223], v[220:223]
s_add_u32 s37, s31, 131072
ds_read_b64_tr_b16 a[164:165], v6 offset:0
v_mfma_f32_16x16x32_bf16 v[224:227], a[168:171], a[192:195], v[224:227]
s_add_u32 m0, s33, 4096
ds_read_b64_tr_b16 a[166:167], v6 offset:1024
v_mfma_f32_16x16x32_bf16 v[228:231], a[168:171], a[196:199], v[228:231]
buffer_load_dwordx4 v2, s[20:23], s37 offen  lds
v_xor_b32 v6, 16, v5
v_mfma_f32_16x16x32_bf16 v[232:235], a[168:171], a[200:203], v[232:235]
ds_read_b128 a[248:251], v4 offset:12288
v_mfma_f32_16x16x32_bf16 v[236:239], a[168:171], a[204:207], v[236:239]
v_mfma_f32_16x16x32_bf16 v[240:243], a[168:171], a[208:211], v[240:243]
ds_read_b128 a[252:255], v3 offset:13312
v_mfma_f32_16x16x32_bf16 v[244:247], a[168:171], a[212:215], v[244:247]
v_mfma_f32_16x16x32_bf16 v[248:251], a[168:171], a[216:219], v[248:251]
s_add_u32 s37, s31, 163840
ds_read_b64_tr_b16 v[28:29], v12 offset:0
v_mfma_f32_16x16x32_bf16 v[252:255], a[168:171], a[220:223], v[252:255]
s_add_u32 m0, s33, 5120
ds_read_b64_tr_b16 a[168:169], v7 offset:0
v_mfma_f32_16x16x32_bf16 a[0:3], a[172:175], a[192:195], a[0:3]
buffer_load_dwordx4 v2, s[20:23], s37 offen  lds
ds_read_b64_tr_b16 a[170:171], v7 offset:1024
v_mfma_f32_16x16x32_bf16 a[4:7], a[172:175], a[196:199], a[4:7]
s_add_u32 s31, s31, 262144
s_add_u32 s29, s29, s44
v_xor_b32 v7, 64, v5
v_mfma_f32_16x16x32_bf16 a[8:11], a[172:175], a[200:203], a[8:11]
s_add_u32 s33, s33, 16384
ds_read_b64_tr_b16 v[30:31], v12 offset:1024
v_mfma_f32_16x16x32_bf16 a[12:15], a[172:175], a[204:207], a[12:15]
s_and_b32 s33, s33, 65535
buffer_store_dwordx4 v[92:95], v13, s[8:11], s29 offen sc1
v_mfma_f32_16x16x32_bf16 a[16:19], a[172:175], a[208:211], a[16:19]
v_mfma_f32_16x16x32_bf16 a[20:23], a[172:175], a[212:215], a[20:23]
s_add_u32 s48, s48, s34
v_xor_b32 v12, 208, v5
v_mfma_f32_16x16x32_bf16 a[24:27], a[172:175], a[216:219], a[24:27]
s_add_u32 m0, s32, 16384
v_add_u32 v3, 32768, v3
v_mfma_f32_16x16x32_bf16 a[28:31], a[172:175], a[220:223], a[28:31]
buffer_load_dwordx4 v1, s[12:15], s48 offen lds
ds_read_b64_tr_b16 a[172:173], v8 offset:0
v_mfma_f32_16x16x32_bf16 a[32:35], a[176:179], a[192:195], a[32:35]
ds_read_b64_tr_b16 a[174:175], v8 offset:1024
v_subrev_u32 v19, 98304, v3
v_mfma_f32_16x16x32_bf16 a[36:39], a[176:179], a[196:199], a[36:39]
v_xor_b32 v8, 80, v5
v_cmp_le_u32 vcc, 163840, v3
v_mfma_f32_16x16x32_bf16 a[40:43], a[176:179], a[200:203], a[40:43]
s_nop 0
v_cndmask_b32 v3, v3, v19, vcc
v_mfma_f32_16x16x32_bf16 a[44:47], a[176:179], a[204:207], a[44:47]
v_xor_b32 v4, 64, v3
v_mfma_f32_16x16x32_bf16 a[48:51], a[176:179], a[208:211], a[48:51]
s_add_u32 s48, s48, s34
v_mfma_f32_16x16x32_bf16 a[52:55], a[176:179], a[212:215], a[52:55]
s_add_u32 m0, s32, 20480
v_mfma_f32_16x16x32_bf16 a[56:59], a[176:179], a[216:219], a[56:59]
buffer_load_dwordx4 v1, s[12:15], s48 offen lds
v_mfma_f32_16x16x32_bf16 a[60:63], a[176:179], a[220:223], a[60:63]
ds_read_b64_tr_b16 a[176:177], v9 offset:0
v_mfma_f32_16x16x32_bf16 a[64:67], a[180:183], a[192:195], a[64:67]
ds_read_b64_tr_b16 a[178:179], v9 offset:1024
v_mfma_f32_16x16x32_bf16 a[68:71], a[180:183], a[196:199], a[68:71]
v_xor_b32 v9, 128, v5
v_mfma_f32_16x16x32_bf16 a[72:75], a[180:183], a[200:203], a[72:75]
v_mfma_f32_16x16x32_bf16 a[76:79], a[180:183], a[204:207], a[76:79]
s_add_u32 s48, s48, s34
v_mfma_f32_16x16x32_bf16 a[80:83], a[180:183], a[208:211], a[80:83]
s_add_u32 m0, s32, 24576
v_mfma_f32_16x16x32_bf16 a[84:87], a[180:183], a[212:215], a[84:87]
buffer_load_dwordx4 v1, s[12:15], s48 offen lds
v_mfma_f32_16x16x32_bf16 a[88:91], a[180:183], a[216:219], a[88:91]
v_mfma_f32_16x16x32_bf16 a[92:95], a[180:183], a[220:223], a[92:95]
ds_read_b64_tr_b16 a[180:181], v10 offset:0
v_mfma_f32_16x16x32_bf16 a[96:99], a[184:187], a[192:195], a[96:99]
ds_read_b64_tr_b16 a[182:183], v10 offset:1024
v_mfma_f32_16x16x32_bf16 a[100:103], a[184:187], a[196:199], a[100:103]
v_xor_b32 v10, 144, v5
v_mfma_f32_16x16x32_bf16 a[104:107], a[184:187], a[200:203], a[104:107]
s_add_u32 s48, s48, s34
v_mfma_f32_16x16x32_bf16 a[108:111], a[184:187], a[204:207], a[108:111]
s_add_u32 m0, s32, 28672
v_mfma_f32_16x16x32_bf16 a[112:115], a[184:187], a[208:211], a[112:115]
buffer_load_dwordx4 v1, s[12:15], s48 offen lds
v_mfma_f32_16x16x32_bf16 a[116:119], a[184:187], a[212:215], a[116:119]
s_add_u32 s30, s30, 128
v_mfma_f32_16x16x32_bf16 a[120:123], a[184:187], a[216:219], a[120:123]
s_add_u32 s32, s32, 32768
v_mfma_f32_16x16x32_bf16 a[124:127], a[184:187], a[220:223], a[124:127]
s_sub_u32 s48, s32, 98304
ds_read_b64_tr_b16 a[184:185], v11 offset:0
v_mfma_f32_16x16x32_bf16 a[128:131], a[188:191], a[192:195], a[128:131]
s_cmp_ge_u32 s32, 163840
s_cselect_b32 s32, s48, s32
ds_read_b64_tr_b16 a[186:187], v11 offset:1024
v_mfma_f32_16x16x32_bf16 a[132:135], a[188:191], a[196:199], a[132:135]
v_xor_b32 v11, 192, v5
v_mfma_f32_16x16x32_bf16 a[136:139], a[188:191], a[200:203], a[136:139]
buffer_load_dword v15, v14, s[96:99], s100 offen
v_mfma_f32_16x16x32_bf16 a[140:143], a[188:191], a[204:207], a[140:143]
s_add_u32 s100, s100, 16384
v_mfma_f32_16x16x32_bf16 a[144:147], a[188:191], a[208:211], a[144:147]
v_mfma_f32_16x16x32_bf16 a[148:151], a[188:191], a[212:215], a[148:151]
v_mfma_f32_16x16x32_bf16 a[152:155], a[188:191], a[216:219], a[152:155]
v_mfma_f32_16x16x32_bf16 a[156:159], a[188:191], a[220:223], a[156:159]
s_waitcnt vmcnt(23) lgkmcnt(0)
s_barrier
v_mfma_f32_16x16x32_bf16 v[160:163], a[160:163], a[224:227], v[160:163]
ds_read_b128 a[192:195], v3 offset:0
v_mfma_f32_16x16x32_bf16 v[164:167], a[160:163], a[228:231], v[164:167]
s_add_u32 s37, s31, 0
v_mfma_f32_16x16x32_bf16 v[168:171], a[160:163], a[232:235], v[168:171]
s_add_u32 m0, s33, 0
ds_read_b128 a[196:199], v4 offset:1024
v_mfma_f32_16x16x32_bf16 v[172:175], a[160:163], a[236:239], v[172:175]
buffer_load_dwordx4 v2, s[20:23], s37 offen  lds
v_mfma_f32_16x16x32_bf16 v[176:179], a[160:163], a[240:243], v[176:179]
s_add_u32 s60, s60, s92
ds_read_b128 a[200:203], v3 offset:4096
v_mfma_f32_16x16x32_bf16 v[180:183], a[160:163], a[244:247], v[180:183]
s_mov_b32 s29, s60
v_mfma_f32_16x16x32_bf16 v[184:187], a[160:163], a[248:251], v[184:187]
buffer_store_dwordx4 v[96:99], v13, s[8:11], s29 offen sc1
v_mfma_f32_16x16x32_bf16 v[188:191], a[160:163], a[252:255], v[188:191]
ds_read_b64_tr_b16 a[160:161], v5 offset:0
v_mfma_f32_16x16x32_bf16 v[192:195], a[164:167], a[224:227], v[192:195]
s_add_u32 s37, s31, 32768
ds_read_b64_tr_b16 a[162:163], v5 offset:1024
v_mfma_f32_16x16x32_bf16 v[196:199], a[164:167], a[228:231], v[196:199]
s_add_u32 m0, s33, 1024
ds_read_b128 a[204:207], v4 offset:5120
v_add_u32 v5, 16384, v5
v_mfma_f32_16x16x32_bf16 v[200:203], a[164:167], a[232:235], v[200:203]
buffer_load_dwordx4 v2, s[20:23], s37 offen  lds
v_and_b32 v5, 65535, v5
v_mfma_f32_16x16x32_bf16 v[204:207], a[164:167], a[236:239], v[204:207]
ds_read_b128 a[208:211], v3 offset:8192
v_mfma_f32_16x16x32_bf16 v[208:211], a[164:167], a[240:243], v[208:211]
v_mfma_f32_16x16x32_bf16 v[212:215], a[164:167], a[244:247], v[212:215]
ds_read_b128 a[212:215], v4 offset:9216
v_mfma_f32_16x16x32_bf16 v[216:219], a[164:167], a[248:251], v[216:219]
v_mfma_f32_16x16x32_bf16 v[220:223], a[164:167], a[252:255], v[220:223]
s_add_u32 s37, s31, 131072
ds_read_b64_tr_b16 a[164:165], v6 offset:0
v_mfma_f32_16x16x32_bf16 v[224:227], a[168:171], a[224:227], v[224:227]
s_add_u32 m0, s33, 4096
ds_read_b64_tr_b16 a[166:167], v6 offset:1024
v_mfma_f32_16x16x32_bf16 v[228:231], a[168:171], a[228:231], v[228:231]
buffer_load_dwordx4 v2, s[20:23], s37 offen  lds
v_xor_b32 v6, 16, v5
v_mfma_f32_16x16x32_bf16 v[232:235], a[168:171], a[232:235], v[232:235]
ds_read_b128 a[216:219], v3 offset:12288
v_mfma_f32_16x16x32_bf16 v[236:239], a[168:171], a[236:239], v[236:239]
v_mfma_f32_16x16x32_bf16 v[240:243], a[168:171], a[240:243], v[240:243]
ds_read_b128 a[220:223], v4 offset:13312
v_mfma_f32_16x16x32_bf16 v[244:247], a[168:171], a[244:247], v[244:247]
v_mfma_f32_16x16x32_bf16 v[248:251], a[168:171], a[248:251], v[248:251]
s_add_u32 s37, s31, 163840
ds_read_b64_tr_b16 a[188:189], v12 offset:0
v_mfma_f32_16x16x32_bf16 v[252:255], a[168:171], a[252:255], v[252:255]
s_add_u32 m0, s33, 5120
ds_read_b64_tr_b16 a[168:169], v7 offset:0
v_mfma_f32_16x16x32_bf16 a[0:3], a[172:175], a[224:227], a[0:3]
buffer_load_dwordx4 v2, s[20:23], s37 offen  lds
ds_read_b64_tr_b16 a[170:171], v7 offset:1024
v_mfma_f32_16x16x32_bf16 a[4:7], a[172:175], a[228:231], a[4:7]
s_add_u32 s31, s31, 262144
s_add_u32 s29, s29, s44
v_xor_b32 v7, 64, v5
v_mfma_f32_16x16x32_bf16 a[8:11], a[172:175], a[232:235], a[8:11]
s_add_u32 s33, s33, 16384
ds_read_b64_tr_b16 a[190:191], v12 offset:1024
v_mfma_f32_16x16x32_bf16 a[12:15], a[172:175], a[236:239], a[12:15]
s_and_b32 s33, s33, 65535
buffer_store_dwordx4 v[100:103], v13, s[8:11], s29 offen sc1
v_mfma_f32_16x16x32_bf16 a[16:19], a[172:175], a[240:243], a[16:19]
v_mfma_f32_16x16x32_bf16 a[20:23], a[172:175], a[244:247], a[20:23]
s_mov_b32 s48, s30
v_xor_b32 v12, 208, v5
v_mfma_f32_16x16x32_bf16 a[24:27], a[172:175], a[248:251], a[24:27]
s_add_u32 m0, s32, 0
v_mfma_f32_16x16x32_bf16 a[28:31], a[172:175], a[252:255], a[28:31]
buffer_load_dwordx4 v1, s[12:15], s48 offen lds
ds_read_b64_tr_b16 a[172:173], v8 offset:0
v_mfma_f32_16x16x32_bf16 a[32:35], a[176:179], a[224:227], a[32:35]
ds_read_b64_tr_b16 a[174:175], v8 offset:1024
v_mfma_f32_16x16x32_bf16 a[36:39], a[176:179], a[228:231], a[36:39]
v_xor_b32 v8, 80, v5
v_mfma_f32_16x16x32_bf16 a[40:43], a[176:179], a[232:235], a[40:43]
v_mfma_f32_16x16x32_bf16 a[44:47], a[176:179], a[236:239], a[44:47]
v_mfma_f32_16x16x32_bf16 a[48:51], a[176:179], a[240:243], a[48:51]
s_add_u32 s48, s48, s34
v_mfma_f32_16x16x32_bf16 a[52:55], a[176:179], a[244:247], a[52:55]
s_add_u32 m0, s32, 4096
v_mfma_f32_16x16x32_bf16 a[56:59], a[176:179], a[248:251], a[56:59]
buffer_load_dwordx4 v1, s[12:15], s48 offen lds
v_mfma_f32_16x16x32_bf16 a[60:63], a[176:179], a[252:255], a[60:63]
ds_read_b64_tr_b16 a[176:177], v9 offset:0
v_mfma_f32_16x16x32_bf16 a[64:67], a[180:183], a[224:227], a[64:67]
ds_read_b64_tr_b16 a[178:179], v9 offset:1024
v_mfma_f32_16x16x32_bf16 a[68:71], a[180:183], a[228:231], a[68:71]
v_xor_b32 v9, 128, v5
v_mfma_f32_16x16x32_bf16 a[72:75], a[180:183], a[232:235], a[72:75]
v_mfma_f32_16x16x32_bf16 a[76:79], a[180:183], a[236:239], a[76:79]
s_add_u32 s48, s48, s34
v_mfma_f32_16x16x32_bf16 a[80:83], a[180:183], a[240:243], a[80:83]
s_add_u32 m0, s32, 8192
v_mfma_f32_16x16x32_bf16 a[84:87], a[180:183], a[244:247], a[84:87]
buffer_load_dwordx4 v1, s[12:15], s48 offen lds
v_mfma_f32_16x16x32_bf16 a[88:91], a[180:183], a[248:251], a[88:91]
s_add_u32 s29, s29, s93
v_mfma_f32_16x16x32_bf16 a[92:95], a[180:183], a[252:255], a[92:95]
ds_read_b64_tr_b16 a[180:181], v10 offset:0
v_mfma_f32_16x16x32_bf16 a[96:99], a[184:187], a[224:227], a[96:99]
buffer_store_dwordx4 v[104:107], v13, s[8:11], s29 offen sc1
ds_read_b64_tr_b16 a[182:183], v10 offset:1024
v_mfma_f32_16x16x32_bf16 a[100:103], a[184:187], a[228:231], a[100:103]
v_xor_b32 v10, 144, v5
v_mfma_f32_16x16x32_bf16 a[104:107], a[184:187], a[232:235], a[104:107]
s_add_u32 s48, s48, s34
v_mfma_f32_16x16x32_bf16 a[108:111], a[184:187], a[236:239], a[108:111]
s_add_u32 m0, s32, 12288
v_mfma_f32_16x16x32_bf16 a[112:115], a[184:187], a[240:243], a[112:115]
buffer_load_dwordx4 v1, s[12:15], s48 offen lds
v_mfma_f32_16x16x32_bf16 a[116:119], a[184:187], a[244:247], a[116:119]
v_mfma_f32_16x16x32_bf16 a[120:123], a[184:187], a[248:251], a[120:123]
v_mfma_f32_16x16x32_bf16 a[124:127], a[184:187], a[252:255], a[124:127]
ds_read_b64_tr_b16 a[184:185], v11 offset:0
v_mfma_f32_16x16x32_bf16 a[128:131], v[28:31], a[224:227], a[128:131]
ds_read_b64_tr_b16 a[186:187], v11 offset:1024
v_mfma_f32_16x16x32_bf16 a[132:135], v[28:31], a[228:231], a[132:135]
v_xor_b32 v11, 192, v5
v_mfma_f32_16x16x32_bf16 a[136:139], v[28:31], a[232:235], a[136:139]
buffer_load_dword v15, v14, s[96:99], s100 offen
v_mfma_f32_16x16x32_bf16 a[140:143], v[28:31], a[236:239], a[140:143]
s_add_u32 s100, s100, 16384
v_mfma_f32_16x16x32_bf16 a[144:147], v[28:31], a[240:243], a[144:147]
v_mfma_f32_16x16x32_bf16 a[148:151], v[28:31], a[244:247], a[148:151]
v_mfma_f32_16x16x32_bf16 a[152:155], v[28:31], a[248:251], a[152:155]
v_mfma_f32_16x16x32_bf16 a[156:159], v[28:31], a[252:255], a[156:159]
s_waitcnt vmcnt(23) lgkmcnt(0)
s_barrier
v_mfma_f32_16x16x32_bf16 v[160:163], a[160:163], a[192:195], v[160:163]
ds_read_b128 a[224:227], v4 offset:0
v_mfma_f32_16x16x32_bf16 v[164:167], a[160:163], a[196:199], v[164:167]
s_add_u32 s37, s31, 0
v_mfma_f32_16x16x32_bf16 v[168:171], a[160:163], a[200:203], v[168:171]
s_add_u32 m0, s33, 0
ds_read_b128 a[228:231], v3 offset:1024
v_mfma_f32_16x16x32_bf16 v[172:175], a[160:163], a[204:207], v[172:175]
buffer_load_dwordx4 v2, s[20:23], s37 offen  lds
v_mfma_f32_16x16x32_bf16 v[176:179], a[160:163], a[208:211], v[176:179]
s_add_u32 s29, s29, s44
ds_read_b128 a[232:235], v4 offset:4096
v_mfma_f32_16x16x32_bf16 v[180:183], a[160:163], a[212:215], v[180:183]
v_mfma_f32_16x16x32_bf16 v[184:187], a[160:163], a[216:219], v[184:187]
buffer_store_dwordx4 v[108:111], v13, s[8:11], s29 offen sc1
v_mfma_f32_16x16x32_bf16 v[188:191], a[160:163], a[220:223], v[188:191]
ds_read_b64_tr_b16 a[160:161], v5 offset:0
v_mfma_f32_16x16x32_bf16 v[192:195], a[164:167], a[192:195], v[192:195]
s_add_u32 s37, s31, 32768
ds_read_b64_tr_b16 a[162:163], v5 offset:1024
v_mfma_f32_16x16x32_bf16 v[196:199], a[164:167], a[196:199], v[196:199]
s_add_u32 m0, s33, 1024
ds_read_b128 a[236:239], v3 offset:5120
v_add_u32 v5, 16384, v5
v_mfma_f32_16x16x32_bf16 v[200:203], a[164:167], a[200:203], v[200:203]
buffer_load_dwordx4 v2, s[20:23], s37 offen  lds
v_and_b32 v5, 65535, v5
v_mfma_f32_16x16x32_bf16 v[204:207], a[164:167], a[204:207], v[204:207]
ds_read_b128 a[240:243], v4 offset:8192
v_mfma_f32_16x16x32_bf16 v[208:211], a[164:167], a[208:211], v[208:211]
v_mfma_f32_16x16x32_bf16 v[212:215], a[164:167], a[212:215], v[212:215]
ds_read_b128 a[244:247], v3 offset:9216
v_mfma_f32_16x16x32_bf16 v[216:219], a[164:167], a[216:219], v[216:219]
v_mfma_f32_16x16x32_bf16 v[220:223], a[164:167], a[220:223], v[220:223]
s_add_u32 s37, s31, 131072
ds_read_b64_tr_b16 a[164:165], v6 offset:0
v_mfma_f32_16x16x32_bf16 v[224:227], a[168:171], a[192:195], v[224:227]
s_add_u32 m0, s33, 4096
ds_read_b64_tr_b16 a[166:167], v6 offset:1024
v_mfma_f32_16x16x32_bf16 v[228:231], a[168:171], a[196:199], v[228:231]
buffer_load_dwordx4 v2, s[20:23], s37 offen  lds
v_xor_b32 v6, 16, v5
v_mfma_f32_16x16x32_bf16 v[232:235], a[168:171], a[200:203], v[232:235]
ds_read_b128 a[248:251], v4 offset:12288
v_mfma_f32_16x16x32_bf16 v[236:239], a[168:171], a[204:207], v[236:239]
v_mfma_f32_16x16x32_bf16 v[240:243], a[168:171], a[208:211], v[240:243]
ds_read_b128 a[252:255], v3 offset:13312
v_mfma_f32_16x16x32_bf16 v[244:247], a[168:171], a[212:215], v[244:247]
v_mfma_f32_16x16x32_bf16 v[248:251], a[168:171], a[216:219], v[248:251]
s_add_u32 s37, s31, 163840
ds_read_b64_tr_b16 v[28:29], v12 offset:0
v_mfma_f32_16x16x32_bf16 v[252:255], a[168:171], a[220:223], v[252:255]
s_add_u32 m0, s33, 5120
ds_read_b64_tr_b16 a[168:169], v7 offset:0
v_mfma_f32_16x16x32_bf16 a[0:3], a[172:175], a[192:195], a[0:3]
buffer_load_dwordx4 v2, s[20:23], s37 offen  lds
ds_read_b64_tr_b16 a[170:171], v7 offset:1024
v_mfma_f32_16x16x32_bf16 a[4:7], a[172:175], a[196:199], a[4:7]
s_add_u32 s31, s31, 262144
s_add_u32 s29, s29, s93
v_xor_b32 v7, 64, v5
v_mfma_f32_16x16x32_bf16 a[8:11], a[172:175], a[200:203], a[8:11]
s_add_u32 s33, s33, 16384
ds_read_b64_tr_b16 v[30:31], v12 offset:1024
v_mfma_f32_16x16x32_bf16 a[12:15], a[172:175], a[204:207], a[12:15]
s_and_b32 s33, s33, 65535
buffer_store_dwordx4 v[112:115], v13, s[8:11], s29 offen sc1
v_mfma_f32_16x16x32_bf16 a[16:19], a[172:175], a[208:211], a[16:19]
v_mfma_f32_16x16x32_bf16 a[20:23], a[172:175], a[212:215], a[20:23]
s_add_u32 s48, s48, s34
v_xor_b32 v12, 208, v5
v_mfma_f32_16x16x32_bf16 a[24:27], a[172:175], a[216:219], a[24:27]
s_add_u32 m0, s32, 16384
v_add_u32 v3, 32768, v3
v_mfma_f32_16x16x32_bf16 a[28:31], a[172:175], a[220:223], a[28:31]
buffer_load_dwordx4 v1, s[12:15], s48 offen lds
ds_read_b64_tr_b16 a[172:173], v8 offset:0
v_mfma_f32_16x16x32_bf16 a[32:35], a[176:179], a[192:195], a[32:35]
ds_read_b64_tr_b16 a[174:175], v8 offset:1024
v_subrev_u32 v19, 98304, v3
v_mfma_f32_16x16x32_bf16 a[36:39], a[176:179], a[196:199], a[36:39]
v_xor_b32 v8, 80, v5
v_cmp_le_u32 vcc, 163840, v3
v_mfma_f32_16x16x32_bf16 a[40:43], a[176:179], a[200:203], a[40:43]
s_nop 0
v_cndmask_b32 v3, v3, v19, vcc
v_mfma_f32_16x16x32_bf16 a[44:47], a[176:179], a[204:207], a[44:47]
v_xor_b32 v4, 64, v3
v_mfma_f32_16x16x32_bf16 a[48:51], a[176:179], a[208:211], a[48:51]
s_add_u32 s48, s48, s34
v_mfma_f32_16x16x32_bf16 a[52:55], a[176:179], a[212:215], a[52:55]
s_add_u32 m0, s32, 20480
v_mfma_f32_16x16x32_bf16 a[56:59], a[176:179], a[216:219], a[56:59]
buffer_load_dwordx4 v1, s[12:15], s48 offen lds
v_mfma_f32_16x16x32_bf16 a[60:63], a[176:179], a[220:223], a[60:63]
ds_read_b64_tr_b16 a[176:177], v9 offset:0
v_mfma_f32_16x16x32_bf16 a[64:67], a[180:183], a[192:195], a[64:67]
ds_read_b64_tr_b16 a[178:179], v9 offset:1024
v_mfma_f32_16x16x32_bf16 a[68:71], a[180:183], a[196:199], a[68:71]
v_xor_b32 v9, 128, v5
v_mfma_f32_16x16x32_bf16 a[72:75], a[180:183], a[200:203], a[72:75]
v_mfma_f32_16x16x32_bf16 a[76:79], a[180:183], a[204:207], a[76:79]
s_add_u32 s48, s48, s34
v_mfma_f32_16x16x32_bf16 a[80:83], a[180:183], a[208:211], a[80:83]
s_add_u32 m0, s32, 24576
v_mfma_f32_16x16x32_bf16 a[84:87], a[180:183], a[212:215], a[84:87]
buffer_load_dwordx4 v1, s[12:15], s48 offen lds
v_mfma_f32_16x16x32_bf16 a[88:91], a[180:183], a[216:219], a[88:91]
s_add_u32 s29, s29, s44
v_mfma_f32_16x16x32_bf16 a[92:95], a[180:183], a[220:223], a[92:95]
ds_read_b64_tr_b16 a[180:181], v10 offset:0
v_mfma_f32_16x16x32_bf16 a[96:99], a[184:187], a[192:195], a[96:99]
buffer_store_dwordx4 v[116:119], v13, s[8:11], s29 offen sc1
ds_read_b64_tr_b16 a[182:183], v10 offset:1024
v_mfma_f32_16x16x32_bf16 a[100:103], a[184:187], a[196:199], a[100:103]
v_xor_b32 v10, 144, v5
v_mfma_f32_16x16x32_bf16 a[104:107], a[184:187], a[200:203], a[104:107]
s_add_u32 s48, s48, s34
v_mfma_f32_16x16x32_bf16 a[108:111], a[184:187], a[204:207], a[108:111]
s_add_u32 m0, s32, 28672
v_mfma_f32_16x16x32_bf16 a[112:115], a[184:187], a[208:211], a[112:115]
buffer_load_dwordx4 v1, s[12:15], s48 offen lds
v_mfma_f32_16x16x32_bf16 a[116:119], a[184:187], a[212:215], a[116:119]
s_add_u32 s30, s30, 128
v_mfma_f32_16x16x32_bf16 a[120:123], a[184:187], a[216:219], a[120:123]
s_add_u32 s32, s32, 32768
v_mfma_f32_16x16x32_bf16 a[124:127], a[184:187], a[220:223], a[124:127]
s_sub_u32 s48, s32, 98304
ds_read_b64_tr_b16 a[184:185], v11 offset:0
v_mfma_f32_16x16x32_bf16 a[128:131], a[188:191], a[192:195], a[128:131]
s_cmp_ge_u32 s32, 163840
s_cselect_b32 s32, s48, s32
ds_read_b64_tr_b16 a[186:187], v11 offset:1024
v_mfma_f32_16x16x32_bf16 a[132:135], a[188:191], a[196:199], a[132:135]
v_xor_b32 v11, 192, v5
v_mfma_f32_16x16x32_bf16 a[136:139], a[188:191], a[200:203], a[136:139]
buffer_load_dword v15, v14, s[96:99], s100 offen
v_mfma_f32_16x16x32_bf16 a[140:143], a[188:191], a[204:207], a[140:143]
s_add_u32 s100, s100, 16384
v_mfma_f32_16x16x32_bf16 a[144:147], a[188:191], a[208:211], a[144:147]
v_mfma_f32_16x16x32_bf16 a[148:151], a[188:191], a[212:215], a[148:151]
v_mfma_f32_16x16x32_bf16 a[152:155], a[188:191], a[216:219], a[152:155]
v_mfma_f32_16x16x32_bf16 a[156:159], a[188:191], a[220:223], a[156:159]
s_waitcnt vmcnt(24) lgkmcnt(0)
s_barrier
v_mfma_f32_16x16x32_bf16 v[160:163], a[160:163], a[224:227], v[160:163]
ds_read_b128 a[192:195], v3 offset:0
v_mfma_f32_16x16x32_bf16 v[164:167], a[160:163], a[228:231], v[164:167]
s_add_u32 s37, s31, 0
v_mfma_f32_16x16x32_bf16 v[168:171], a[160:163], a[232:235], v[168:171]
s_add_u32 m0, s33, 0
ds_read_b128 a[196:199], v4 offset:1024
v_mfma_f32_16x16x32_bf16 v[172:175], a[160:163], a[236:239], v[172:175]
buffer_load_dwordx4 v2, s[20:23], s37 offen  lds
v_mfma_f32_16x16x32_bf16 v[176:179], a[160:163], a[240:243], v[176:179]
s_add_u32 s29, s29, s93
ds_read_b128 a[200:203], v3 offset:4096
v_mfma_f32_16x16x32_bf16 v[180:183], a[160:163], a[244:247], v[180:183]
v_mfma_f32_16x16x32_bf16 v[184:187], a[160:163], a[248:251], v[184:187]
buffer_store_dwordx4 v[120:123], v13, s[8:11], s29 offen sc1
v_mfma_f32_16x16x32_bf16 v[188:191], a[160:163], a[252:255], v[188:191]
ds_read_b64_tr_b16 a[160:161], v5 offset:0
v_mfma_f32_16x16x32_bf16 v[192:195], a[164:167], a[224:227], v[192:195]
s_add_u32 s37, s31, 32768
ds_read_b64_tr_b16 a[162:163], v5 offset:1024
v_mfma_f32_16x16x32_bf16 v[196:199], a[164:167], a[228:231], v[196:199]
s_add_u32 m0, s33, 1024
ds_read_b128 a[204:207], v4 offset:5120
v_add_u32 v5, 16384, v5
v_mfma_f32_16x16x32_bf16 v[200:203], a[164:167], a[232:235], v[200:203]
buffer_load_dwordx4 v2, s[20:23], s37 offen  lds
v_and_b32 v5, 65535, v5
v_mfma_f32_16x16x32_bf16 v[204:207], a[164:167], a[236:239], v[204:207]
ds_read_b128 a[208:211], v3 offset:8192
v_mfma_f32_16x16x32_bf16 v[208:211], a[164:167], a[240:243], v[208:211]
v_mfma_f32_16x16x32_bf16 v[212:215], a[164:167], a[244:247], v[212:215]
ds_read_b128 a[212:215], v4 offset:9216
v_mfma_f32_16x16x32_bf16 v[216:219], a[164:167], a[248:251], v[216:219]
v_mfma_f32_16x16x32_bf16 v[220:223], a[164:167], a[252:255], v[220:223]
s_add_u32 s37, s31, 131072
ds_read_b64_tr_b16 a[164:165], v6 offset:0
v_mfma_f32_16x16x32_bf16 v[224:227], a[168:171], a[224:227], v[224:227]
s_add_u32 m0, s33, 4096
ds_read_b64_tr_b16 a[166:167], v6 offset:1024
v_mfma_f32_16x16x32_bf16 v[228:231], a[168:171], a[228:231], v[228:231]
buffer_load_dwordx4 v2, s[20:23], s37 offen  lds
v_xor_b32 v6, 16, v5
v_mfma_f32_16x16x32_bf16 v[232:235], a[168:171], a[232:235], v[232:235]
ds_read_b128 a[216:219], v3 offset:12288
v_mfma_f32_16x16x32_bf16 v[236:239], a[168:171], a[236:239], v[236:239]
v_mfma_f32_16x16x32_bf16 v[240:243], a[168:171], a[240:243], v[240:243]
ds_read_b128 a[220:223], v4 offset:13312
v_mfma_f32_16x16x32_bf16 v[244:247], a[168:171], a[244:247], v[244:247]
v_mfma_f32_16x16x32_bf16 v[248:251], a[168:171], a[248:251], v[248:251]
s_add_u32 s37, s31, 163840
ds_read_b64_tr_b16 a[188:189], v12 offset:0
v_mfma_f32_16x16x32_bf16 v[252:255], a[168:171], a[252:255], v[252:255]
s_add_u32 m0, s33, 5120
ds_read_b64_tr_b16 a[168:169], v7 offset:0
v_mfma_f32_16x16x32_bf16 a[0:3], a[172:175], a[224:227], a[0:3]
buffer_load_dwordx4 v2, s[20:23], s37 offen  lds
ds_read_b64_tr_b16 a[170:171], v7 offset:1024
v_mfma_f32_16x16x32_bf16 a[4:7], a[172:175], a[228:231], a[4:7]
s_add_u32 s31, s31, 262144
s_add_u32 s29, s29, s44
v_xor_b32 v7, 64, v5
v_mfma_f32_16x16x32_bf16 a[8:11], a[172:175], a[232:235], a[8:11]
s_add_u32 s33, s33, 16384
ds_read_b64_tr_b16 a[190:191], v12 offset:1024
v_mfma_f32_16x16x32_bf16 a[12:15], a[172:175], a[236:239], a[12:15]
s_and_b32 s33, s33, 65535
buffer_store_dwordx4 v[124:127], v13, s[8:11], s29 offen sc1
v_mfma_f32_16x16x32_bf16 a[16:19], a[172:175], a[240:243], a[16:19]
v_mfma_f32_16x16x32_bf16 a[20:23], a[172:175], a[244:247], a[20:23]
s_mov_b32 s48, s30
v_xor_b32 v12, 208, v5
v_mfma_f32_16x16x32_bf16 a[24:27], a[172:175], a[248:251], a[24:27]
s_add_u32 m0, s32, 0
v_mfma_f32_16x16x32_bf16 a[28:31], a[172:175], a[252:255], a[28:31]
buffer_load_dwordx4 v1, s[12:15], s48 offen lds
ds_read_b64_tr_b16 a[172:173], v8 offset:0
v_mfma_f32_16x16x32_bf16 a[32:35], a[176:179], a[224:227], a[32:35]
ds_read_b64_tr_b16 a[174:175], v8 offset:1024
v_mfma_f32_16x16x32_bf16 a[36:39], a[176:179], a[228:231], a[36:39]
v_xor_b32 v8, 80, v5
v_mfma_f32_16x16x32_bf16 a[40:43], a[176:179], a[232:235], a[40:43]
v_mfma_f32_16x16x32_bf16 a[44:47], a[176:179], a[236:239], a[44:47]
v_mfma_f32_16x16x32_bf16 a[48:51], a[176:179], a[240:243], a[48:51]
s_add_u32 s48, s48, s34
v_mfma_f32_16x16x32_bf16 a[52:55], a[176:179], a[244:247], a[52:55]
s_add_u32 m0, s32, 4096
v_mfma_f32_16x16x32_bf16 a[56:59], a[176:179], a[248:251], a[56:59]
buffer_load_dwordx4 v1, s[12:15], s48 offen lds
v_mfma_f32_16x16x32_bf16 a[60:63], a[176:179], a[252:255], a[60:63]
ds_read_b64_tr_b16 a[176:177], v9 offset:0
v_mfma_f32_16x16x32_bf16 a[64:67], a[180:183], a[224:227], a[64:67]
ds_read_b64_tr_b16 a[178:179], v9 offset:1024
v_mfma_f32_16x16x32_bf16 a[68:71], a[180:183], a[228:231], a[68:71]
v_xor_b32 v9, 128, v5
v_mfma_f32_16x16x32_bf16 a[72:75], a[180:183], a[232:235], a[72:75]
v_mfma_f32_16x16x32_bf16 a[76:79], a[180:183], a[236:239], a[76:79]
s_add_u32 s48, s48, s34
v_mfma_f32_16x16x32_bf16 a[80:83], a[180:183], a[240:243], a[80:83]
s_add_u32 m0, s32, 8192
v_mfma_f32_16x16x32_bf16 a[84:87], a[180:183], a[244:247], a[84:87]
buffer_load_dwordx4 v1, s[12:15], s48 offen lds
v_mfma_f32_16x16x32_bf16 a[88:91], a[180:183], a[248:251], a[88:91]
v_mfma_f32_16x16x32_bf16 a[92:95], a[180:183], a[252:255], a[92:95]
ds_read_b64_tr_b16 a[180:181], v10 offset:0
v_mfma_f32_16x16x32_bf16 a[96:99], a[184:187], a[224:227], a[96:99]
ds_read_b64_tr_b16 a[182:183], v10 offset:1024
v_mfma_f32_16x16x32_bf16 a[100:103], a[184:187], a[228:231], a[100:103]
v_xor_b32 v10, 144, v5
v_mfma_f32_16x16x32_bf16 a[104:107], a[184:187], a[232:235], a[104:107]
s_add_u32 s48, s48, s34
v_mfma_f32_16x16x32_bf16 a[108:111], a[184:187], a[236:239], a[108:111]
s_add_u32 m0, s32, 12288
v_mfma_f32_16x16x32_bf16 a[112:115], a[184:187], a[240:243], a[112:115]
buffer_load_dwordx4 v1, s[12:15], s48 offen lds
v_mfma_f32_16x16x32_bf16 a[116:119], a[184:187], a[244:247], a[116:119]
v_mfma_f32_16x16x32_bf16 a[120:123], a[184:187], a[248:251], a[120:123]
v_mfma_f32_16x16x32_bf16 a[124:127], a[184:187], a[252:255], a[124:127]
ds_read_b64_tr_b16 a[184:185], v11 offset:0
v_mfma_f32_16x16x32_bf16 a[128:131], v[28:31], a[224:227], a[128:131]
ds_read_b64_tr_b16 a[186:187], v11 offset:1024
v_mfma_f32_16x16x32_bf16 a[132:135], v[28:31], a[228:231], a[132:135]
v_xor_b32 v11, 192, v5
v_mfma_f32_16x16x32_bf16 a[136:139], v[28:31], a[232:235], a[136:139]
buffer_load_dword v15, v14, s[96:99], s100 offen
v_mfma_f32_16x16x32_bf16 a[140:143], v[28:31], a[236:239], a[140:143]
s_add_u32 s100, s100, 16384
v_mfma_f32_16x16x32_bf16 a[144:147], v[28:31], a[240:243], a[144:147]
v_mfma_f32_16x16x32_bf16 a[148:151], v[28:31], a[244:247], a[148:151]
v_mfma_f32_16x16x32_bf16 a[152:155], v[28:31], a[248:251], a[152:155]
v_mfma_f32_16x16x32_bf16 a[156:159], v[28:31], a[252:255], a[156:159]
s_cmp_eq_u32 s36, 0
s_cbranch_scc1 L_g_k12
s_waitcnt vmcnt(23) lgkmcnt(0)
s_barrier
v_mfma_f32_16x16x32_bf16 v[160:163], a[160:163], a[192:195], v[160:163]
ds_read_b128 a[224:227], v4 offset:0
v_mfma_f32_16x16x32_bf16 v[164:167], a[160:163], a[196:199], v[164:167]
s_add_u32 s37, s31, 0
v_mfma_f32_16x16x32_bf16 v[168:171], a[160:163], a[200:203], v[168:171]
s_add_u32 m0, s33, 0
ds_read_b128 a[228:231], v3 offset:1024
v_mfma_f32_16x16x32_bf16 v[172:175], a[160:163], a[204:207], v[172:175]
buffer_load_dwordx4 v2, s[20:23], s37 offen  lds
v_mfma_f32_16x16x32_bf16 v[176:179], a[160:163], a[208:211], v[176:179]
ds_read_b128 a[232:235], v4 offset:4096
v_mfma_f32_16x16x32_bf16 v[180:183], a[160:163], a[212:215], v[180:183]
v_mfma_f32_16x16x32_bf16 v[184:187], a[160:163], a[216:219], v[184:187]
ds_read_b128 a[236:239], v3 offset:5120
v_mfma_f32_16x16x32_bf16 v[188:191], a[160:163], a[220:223], v[188:191]
ds_read_b64_tr_b16 a[160:161], v5 offset:0
v_mfma_f32_16x16x32_bf16 v[192:195], a[164:167], a[192:195], v[192:195]
s_add_u32 s37, s31, 32768
ds_read_b64_tr_b16 a[162:163], v5 offset:1024
v_mfma_f32_16x16x32_bf16 v[196:199], a[164:167], a[196:199], v[196:199]
s_add_u32 m0, s33, 1024
ds_read_b128 a[240:243], v4 offset:8192
v_add_u32 v5, 16384, v5
v_mfma_f32_16x16x32_bf16 v[200:203], a[164:167], a[200:203], v[200:203]
buffer_load_dwordx4 v2, s[20:23], s37 offen  lds
v_and_b32 v5, 65535, v5
v_mfma_f32_16x16x32_bf16 v[204:207], a[164:167], a[204:207], v[204:207]
ds_read_b128 a[244:247], v3 offset:9216
v_mfma_f32_16x16x32_bf16 v[208:211], a[164:167], a[208:211], v[208:211]
v_mfma_f32_16x16x32_bf16 v[212:215], a[164:167], a[212:215], v[212:215]
ds_read_b128 a[248:251], v4 offset:12288
v_mfma_f32_16x16x32_bf16 v[216:219], a[164:167], a[216:219], v[216:219]
v_mfma_f32_16x16x32_bf16 v[220:223], a[164:167], a[220:223], v[220:223]
s_add_u32 s37, s31, 131072
ds_read_b64_tr_b16 a[164:165], v6 offset:0
v_mfma_f32_16x16x32_bf16 v[224:227], a[168:171], a[192:195], v[224:227]
s_add_u32 m0, s33, 4096
ds_read_b64_tr_b16 a[166:167], v6 offset:1024
v_mfma_f32_16x16x32_bf16 v[228:231], a[168:171], a[196:199], v[228:231]
buffer_load_dwordx4 v2, s[20:23], s37 offen  lds
v_xor_b32 v6, 16, v5
v_mfma_f32_16x16x32_bf16 v[232:235], a[168:171], a[200:203], v[232:235]
ds_read_b128 a[252:255], v3 offset:13312
v_mfma_f32_16x16x32_bf16 v[236:239], a[168:171], a[204:207], v[236:239]
v_mfma_f32_16x16x32_bf16 v[240:243], a[168:171], a[208:211], v[240:243]
ds_read_b64_tr_b16 v[28:29], v12 offset:0
v_mfma_f32_16x16x32_bf16 v[244:247], a[168:171], a[212:215], v[244:247]
v_mfma_f32_16x16x32_bf16 v[248:251], a[168:171], a[216:219], v[248:251]
s_add_u32 s37, s31, 163840
ds_read_b64_tr_b16 v[30:31], v12 offset:1024
v_mfma_f32_16x16x32_bf16 v[252:255], a[168:171], a[220:223], v[252:255]
s_add_u32 m0, s33, 5120
ds_read_b64_tr_b16 a[168:169], v7 offset:0
v_mfma_f32_16x16x32_bf16 a[0:3], a[172:175], a[192:195], a[0:3]
buffer_load_dwordx4 v2, s[20:23], s37 offen  lds
ds_read_b64_tr_b16 a[170:171], v7 offset:1024
v_mfma_f32_16x16x32_bf16 a[4:7], a[172:175], a[196:199], a[4:7]
s_add_u32 s31, s31, 262144
v_xor_b32 v7, 64, v5
v_xor_b32 v12, 208, v5
v_mfma_f32_16x16x32_bf16 a[8:11], a[172:175], a[200:203], a[8:11]
s_add_u32 s33, s33, 16384
v_add_u32 v3, 32768, v3
v_mfma_f32_16x16x32_bf16 a[12:15], a[172:175], a[204:207], a[12:15]
s_and_b32 s33, s33, 65535
v_subrev_u32 v19, 98304, v3
v_mfma_f32_16x16x32_bf16 a[16:19], a[172:175], a[208:211], a[16:19]
v_cmp_le_u32 vcc, 163840, v3
v_mfma_f32_16x16x32_bf16 a[20:23], a[172:175], a[212:215], a[20:23]
s_add_u32 s48, s48, s34
v_cndmask_b32 v3, v3, v19, vcc
v_mfma_f32_16x16x32_bf16 a[24:27], a[172:175], a[216:219], a[24:27]
s_add_u32 m0, s32, 16384
v_xor_b32 v4, 64, v3
v_mfma_f32_16x16x32_bf16 a[28:31], a[172:175], a[220:223], a[28:31]
buffer_load_dwordx4 v1, s[12:15], s48 offen lds
ds_read_b64_tr_b16 a[172:173], v8 offset:0
v_mfma_f32_16x16x32_bf16 a[32:35], a[176:179], a[192:195], a[32:35]
ds_read_b64_tr_b16 a[174:175], v8 offset:1024
v_mfma_f32_16x16x32_bf16 a[36:39], a[176:179], a[196:199], a[36:39]
v_xor_b32 v8, 80, v5
v_mfma_f32_16x16x32_bf16 a[40:43], a[176:179], a[200:203], a[40:43]
v_mfma_f32_16x16x32_bf16 a[44:47], a[176:179], a[204:207], a[44:47]
v_mfma_f32_16x16x32_bf16 a[48:51], a[176:179], a[208:211], a[48:51]
s_add_u32 s48, s48, s34
v_mfma_f32_16x16x32_bf16 a[52:55], a[176:179], a[212:215], a[52:55]
s_add_u32 m0, s32, 20480
v_mfma_f32_16x16x32_bf16 a[56:59], a[176:179], a[216:219], a[56:59]
buffer_load_dwordx4 v1, s[12:15], s48 offen lds
v_mfma_f32_16x16x32_bf16 a[60:63], a[176:179], a[220:223], a[60:63]
ds_read_b64_tr_b16 a[176:177], v9 offset:0
v_mfma_f32_16x16x32_bf16 a[64:67], a[180:183], a[192:195], a[64:67]
ds_read_b64_tr_b16 a[178:179], v9 offset:1024
v_mfma_f32_16x16x32_bf16 a[68:71], a[180:183], a[196:199], a[68:71]
v_xor_b32 v9, 128, v5
v_mfma_f32_16x16x32_bf16 a[72:75], a[180:183], a[200:203], a[72:75]
v_mfma_f32_16x16x32_bf16 a[76:79], a[180:183], a[204:207], a[76:79]
s_add_u32 s48, s48, s34
v_mfma_f32_16x16x32_bf16 a[80:83], a[180:183], a[208:211], a[80:83]
s_add_u32 m0, s32, 24576
v_mfma_f32_16x16x32_bf16 a[84:87], a[180:183], a[212:215], a[84:87]
buffer_load_dwordx4 v1, s[12:15], s48 offen lds
v_mfma_f32_16x16x32_bf16 a[88:91], a[180:183], a[216:219], a[88:91]
v_mfma_f32_16x16x32_bf16 a[92:95], a[180:183], a[220:223], a[92:95]
ds_read_b64_tr_b16 a[180:181], v10 offset:0
v_mfma_f32_16x16x32_bf16 a[96:99], a[184:187], a[192:195], a[96:99]
ds_read_b64_tr_b16 a[182:183], v10 offset:1024
v_mfma_f32_16x16x32_bf16 a[100:103], a[184:187], a[196:199], a[100:103]
v_xor_b32 v10, 144, v5
v_mfma_f32_16x16x32_bf16 a[104:107], a[184:187], a[200:203], a[104:107]
s_add_u32 s48, s48, s34
v_mfma_f32_16x16x32_bf16 a[108:111], a[184:187], a[204:207], a[108:111]
s_add_u32 m0, s32, 28672
v_mfma_f32_16x16x32_bf16 a[112:115], a[184:187], a[208:211], a[112:115]
buffer_load_dwordx4 v1, s[12:15], s48 offen lds
v_mfma_f32_16x16x32_bf16 a[116:119], a[184:187], a[212:215], a[116:119]
s_add_u32 s30, s30, 128
v_mfma_f32_16x16x32_bf16 a[120:123], a[184:187], a[216:219], a[120:123]
s_add_u32 s32, s32, 32768
v_mfma_f32_16x16x32_bf16 a[124:127], a[184:187], a[220:223], a[124:127]
s_sub_u32 s48, s32, 98304
ds_read_b64_tr_b16 a[184:185], v11 offset:0
v_mfma_f32_16x16x32_bf16 a[128:131], a[188:191], a[192:195], a[128:131]
s_cmp_ge_u32 s32, 163840
s_cselect_b32 s32, s48, s32
ds_read_b64_tr_b16 a[186:187], v11 offset:1024
v_mfma_f32_16x16x32_bf16 a[132:135], a[188:191], a[196:199], a[132:135]
v_xor_b32 v11, 192, v5
v_mfma_f32_16x16x32_bf16 a[136:139], a[188:191], a[200:203], a[136:139]
v_mfma_f32_16x16x32_bf16 a[140:143], a[188:191], a[204:207], a[140:143]
v_mfma_f32_16x16x32_bf16 a[144:147], a[188:191], a[208:211], a[144:147]
v_mfma_f32_16x16x32_bf16 a[148:151], a[188:191], a[212:215], a[148:151]
v_mfma_f32_16x16x32_bf16 a[152:155], a[188:191], a[216:219], a[152:155]
v_mfma_f32_16x16x32_bf16 a[156:159], a[188:191], a[220:223], a[156:159]
s_waitcnt vmcnt(19) lgkmcnt(0)
s_barrier
v_mfma_f32_16x16x32_bf16 v[160:163], a[160:163], a[224:227], v[160:163]
ds_read_b128 a[192:195], v3 offset:0
v_mfma_f32_16x16x32_bf16 v[164:167], a[160:163], a[228:231], v[164:167]
s_add_u32 s37, s31, 0
v_mfma_f32_16x16x32_bf16 v[168:171], a[160:163], a[232:235], v[168:171]
s_add_u32 m0, s33, 0
ds_read_b128 a[196:199], v4 offset:1024
v_mfma_f32_16x16x32_bf16 v[172:175], a[160:163], a[236:239], v[172:175]
buffer_load_dwordx4 v2, s[20:23], s37 offen  lds
v_mfma_f32_16x16x32_bf16 v[176:179], a[160:163], a[240:243], v[176:179]
ds_read_b128 a[200:203], v3 offset:4096
v_mfma_f32_16x16x32_bf16 v[180:183], a[160:163], a[244:247], v[180:183]
v_mfma_f32_16x16x32_bf16 v[184:187], a[160:163], a[248:251], v[184:187]
ds_read_b128 a[204:207], v4 offset:5120
v_mfma_f32_16x16x32_bf16 v[188:191], a[160:163], a[252:255], v[188:191]
ds_read_b64_tr_b16 a[160:161], v5 offset:0
v_mfma_f32_16x16x32_bf16 v[192:195], a[164:167], a[224:227], v[192:195]
s_add_u32 s37, s31, 32768
ds_read_b64_tr_b16 a[162:163], v5 offset:1024
v_mfma_f32_16x16x32_bf16 v[196:199], a[164:167], a[228:231], v[196:199]
s_add_u32 m0, s33, 1024
ds_read_b128 a[208:211], v3 offset:8192
v_add_u32 v5, 16384, v5
v_mfma_f32_16x16x32_bf16 v[200:203], a[164:167], a[232:235], v[200:203]
buffer_load_dwordx4 v2, s[20:23], s37 offen  lds
v_and_b32 v5, 65535, v5
v_mfma_f32_16x16x32_bf16 v[204:207], a[164:167], a[236:239], v[204:207]
ds_read_b128 a[212:215], v4 offset:9216
v_mfma_f32_16x16x32_bf16 v[208:211], a[164:167], a[240:243], v[208:211]
v_mfma_f32_16x16x32_bf16 v[212:215], a[164:167], a[244:247], v[212:215]
ds_read_b128 a[216:219], v3 offset:12288
v_mfma_f32_16x16x32_bf16 v[216:219], a[164:167], a[248:251], v[216:219]
v_mfma_f32_16x16x32_bf16 v[220:223], a[164:167], a[252:255], v[220:223]
s_add_u32 s37, s31, 131072
ds_read_b64_tr_b16 a[164:165], v6 offset:0
v_mfma_f32_16x16x32_bf16 v[224:227], a[168:171], a[224:227], v[224:227]
s_add_u32 m0, s33, 4096
ds_read_b64_tr_b16 a[166:167], v6 offset:1024
v_mfma_f32_16x16x32_bf16 v[228:231], a[168:171], a[228:231], v[228:231]
buffer_load_dwordx4 v2, s[20:23], s37 offen  lds
v_xor_b32 v6, 16, v5
v_mfma_f32_16x16x32_bf16 v[232:235], a[168:171], a[232:235], v[232:235]
ds_read_b128 a[220:223], v4 offset:13312
v_mfma_f32_16x16x32_bf16 v[236:239], a[168:171], a[236:239], v[236:239]
v_mfma_f32_16x16x32_bf16 v[240:243], a[168:171], a[240:243], v[240:243]
ds_read_b64_tr_b16 a[188:189], v12 offset:0
v_mfma_f32_16x16x32_bf16 v[244:247], a[168:171], a[244:247], v[244:247]
v_mfma_f32_16x16x32_bf16 v[248:251], a[168:171], a[248:251], v[248:251]
s_add_u32 s37, s31, 163840
ds_read_b64_tr_b16 a[190:191], v12 offset:1024
v_mfma_f32_16x16x32_bf16 v[252:255], a[168:171], a[252:255], v[252:255]
s_add_u32 m0, s33, 5120
ds_read_b64_tr_b16 a[168:169], v7 offset:0
v_mfma_f32_16x16x32_bf16 a[0:3], a[172:175], a[224:227], a[0:3]
buffer_load_dwordx4 v2, s[20:23], s37 offen  lds
ds_read_b64_tr_b16 a[170:171], v7 offset:1024
v_mfma_f32_16x16x32_bf16 a[4:7], a[172:175], a[228:231], a[4:7]
s_add_u32 s31, s31, 262144
v_xor_b32 v7, 64, v5
v_xor_b32 v12, 208, v5
v_mfma_f32_16x16x32_bf16 a[8:11], a[172:175], a[232:235], a[8:11]
s_add_u32 s33, s33, 16384
v_mfma_f32_16x16x32_bf16 a[12:15], a[172:175], a[236:239], a[12:15]
s_and_b32 s33, s33, 65535
v_mfma_f32_16x16x32_bf16 a[16:19], a[172:175], a[240:243], a[16:19]
v_mfma_f32_16x16x32_bf16 a[20:23], a[172:175], a[244:247], a[20:23]
s_mov_b32 s48, s30
v_mfma_f32_16x16x32_bf16 a[24:27], a[172:175], a[248:251], a[24:27]
s_add_u32 m0, s32, 0
v_mfma_f32_16x16x32_bf16 a[28:31], a[172:175], a[252:255], a[28:31]
buffer_load_dwordx4 v1, s[12:15], s48 offen lds
ds_read_b64_tr_b16 a[172:173], v8 offset:0
v_mfma_f32_16x16x32_bf16 a[32:35], a[176:179], a[224:227], a[32:35]
ds_read_b64_tr_b16 a[174:175], v8 offset:1024
v_mfma_f32_16x16x32_bf16 a[36:39], a[176:179], a[228:231], a[36:39]
v_xor_b32 v8, 80, v5
v_mfma_f32_16x16x32_bf16 a[40:43], a[176:179], a[232:235], a[40:43]
v_mfma_f32_16x16x32_bf16 a[44:47], a[176:179], a[236:239], a[44:47]
v_mfma_f32_16x16x32_bf16 a[48:51], a[176:179], a[240:243], a[48:51]
s_add_u32 s48, s48, s34
v_mfma_f32_16x16x32_bf16 a[52:55], a[176:179], a[244:247], a[52:55]
s_add_u32 m0, s32, 4096
v_mfma_f32_16x16x32_bf16 a[56:59], a[176:179], a[248:251], a[56:59]
buffer_load_dwordx4 v1, s[12:15], s48 offen lds
v_mfma_f32_16x16x32_bf16 a[60:63], a[176:179], a[252:255], a[60:63]
ds_read_b64_tr_b16 a[176:177], v9 offset:0
v_mfma_f32_16x16x32_bf16 a[64:67], a[180:183], a[224:227], a[64:67]
ds_read_b64_tr_b16 a[178:179], v9 offset:1024
v_mfma_f32_16x16x32_bf16 a[68:71], a[180:183], a[228:231], a[68:71]
v_xor_b32 v9, 128, v5
v_mfma_f32_16x16x32_bf16 a[72:75], a[180:183], a[232:235], a[72:75]
v_mfma_f32_16x16x32_bf16 a[76:79], a[180:183], a[236:239], a[76:79]
s_add_u32 s48, s48, s34
v_mfma_f32_16x16x32_bf16 a[80:83], a[180:183], a[240:243], a[80:83]
s_add_u32 m0, s32, 8192
v_mfma_f32_16x16x32_bf16 a[84:87], a[180:183], a[244:247], a[84:87]
buffer_load_dwordx4 v1, s[12:15], s48 offen lds
v_mfma_f32_16x16x32_bf16 a[88:91], a[180:183], a[248:251], a[88:91]
v_mfma_f32_16x16x32_bf16 a[92:95], a[180:183], a[252:255], a[92:95]
ds_read_b64_tr_b16 a[180:181], v10 offset:0
v_mfma_f32_16x16x32_bf16 a[96:99], a[184:187], a[224:227], a[96:99]
ds_read_b64_tr_b16 a[182:183], v10 offset:1024
v_mfma_f32_16x16x32_bf16 a[100:103], a[184:187], a[228:231], a[100:103]
v_xor_b32 v10, 144, v5
v_mfma_f32_16x16x32_bf16 a[104:107], a[184:187], a[232:235], a[104:107]
s_add_u32 s48, s48, s34
v_mfma_f32_16x16x32_bf16 a[108:111], a[184:187], a[236:239], a[108:111]
s_add_u32 m0, s32, 12288
v_mfma_f32_16x16x32_bf16 a[112:115], a[184:187], a[240:243], a[112:115]
buffer_load_dwordx4 v1, s[12:15], s48 offen lds
v_mfma_f32_16x16x32_bf16 a[116:119], a[184:187], a[244:247], a[116:119]
v_mfma_f32_16x16x32_bf16 a[120:123], a[184:187], a[248:251], a[120:123]
v_mfma_f32_16x16x32_bf16 a[124:127], a[184:187], a[252:255], a[124:127]
ds_read_b64_tr_b16 a[184:185], v11 offset:0
v_mfma_f32_16x16x32_bf16 a[128:131], v[28:31], a[224:227], a[128:131]
ds_read_b64_tr_b16 a[186:187], v11 offset:1024
v_mfma_f32_16x16x32_bf16 a[132:135], v[28:31], a[228:231], a[132:135]
v_xor_b32 v11, 192, v5
v_mfma_f32_16x16x32_bf16 a[136:139], v[28:31], a[232:235], a[136:139]
v_mfma_f32_16x16x32_bf16 a[140:143], v[28:31], a[236:239], a[140:143]
v_mfma_f32_16x16x32_bf16 a[144:147], v[28:31], a[240:243], a[144:147]
v_mfma_f32_16x16x32_bf16 a[148:151], v[28:31], a[244:247], a[148:151]
v_mfma_f32_16x16x32_bf16 a[152:155], v[28:31], a[248:251], a[152:155]
v_mfma_f32_16x16x32_bf16 a[156:159], v[28:31], a[252:255], a[156:159]
L_g_k12:
s_waitcnt vmcnt(16) lgkmcnt(0)
s_barrier
v_mfma_f32_16x16x32_bf16 v[160:163], a[160:163], a[192:195], v[160:163]
ds_read_b128 a[224:227], v4 offset:0
s_lshr_b32 s24, s16, 1
v_mfma_f32_16x16x32_bf16 v[164:167], a[160:163], a[196:199], v[164:167]
s_add_u32 s37, s31, 0
s_cmp_eq_u32 s35, 5
s_cselect_b32 s90, s24, s90
v_mfma_f32_16x16x32_bf16 v[168:171], a[160:163], a[200:203], v[168:171]
s_add_u32 m0, s33, 0
ds_read_b128 a[228:231], v3 offset:1024
s_lshl_b32 s24, s35, 2
v_mfma_f32_16x16x32_bf16 v[172:175], a[160:163], a[204:207], v[172:175]
buffer_load_dwordx4 v2, s[20:23], s37 offen  lds
s_lshr_b32 s26, s88, s24
v_mfma_f32_16x16x32_bf16 v[176:179], a[160:163], a[208:211], v[176:179]
s_add_u32 s60, s60, s92
ds_read_b128 a[232:235], v4 offset:4096
s_bfe_u32 s2, s26, 0x10003
v_mfma_f32_16x16x32_bf16 v[180:183], a[160:163], a[212:215], v[180:183]
s_mov_b32 s29, s60
s_and_b32 s26, s26, 7
s_or_b32 s40, s2, s61
v_mfma_f32_16x16x32_bf16 v[184:187], a[160:163], a[216:219], v[184:187]
buffer_store_dwordx4 v[128:131], v13, s[8:11], s29 offen sc1
s_lshr_b32 s24, s17, 1
v_mfma_f32_16x16x32_bf16 v[188:191], a[160:163], a[220:223], v[188:191]
ds_read_b64_tr_b16 a[160:161], v5 offset:0
v_mfma_f32_16x16x32_bf16 v[192:195], a[164:167], a[192:195], v[192:195]
s_add_u32 s37, s31, 32768
ds_read_b64_tr_b16 a[162:163], v5 offset:1024
v_mfma_f32_16x16x32_bf16 v[196:199], a[164:167], a[196:199], v[196:199]
s_add_u32 m0, s33, 1024
ds_read_b128 a[236:239], v3 offset:5120
v_add_u32 v5, 16384, v5
v_mfma_f32_16x16x32_bf16 v[200:203], a[164:167], a[200:203], v[200:203]
buffer_load_dwordx4 v2, s[20:23], s37 offen  lds
v_and_b32 v5, 65535, v5
v_mfma_f32_16x16x32_bf16 v[204:207], a[164:167], a[204:207], v[204:207]
ds_read_b128 a[240:243], v4 offset:8192
v_mfma_f32_16x16x32_bf16 v[208:211], a[164:167], a[208:211], v[208:211]
s_cmp_eq_u32 s2, 0
s_cselect_b32 s41, s24, 0
s_cselect_b32 s27, s89, s90
v_mfma_f32_16x16x32_bf16 v[212:215], a[164:167], a[212:215], v[212:215]
ds_read_b128 a[244:247], v3 offset:9216
s_sub_u32 s25, s24, s41
v_mfma_f32_16x16x32_bf16 v[216:219], a[164:167], a[216:219], v[216:219]
s_and_b32 s51, s41, s61
s_lshl_b32 s51, s51, 1
s_or_b32 s51, s51, s41
v_mfma_f32_16x16x32_bf16 v[220:223], a[164:167], a[220:223], v[220:223]
s_add_u32 s37, s31, 131072
ds_read_b64_tr_b16 a[164:165], v6 offset:0
s_lshl_b32 s46, s27, s2
v_mfma_f32_16x16x32_bf16 v[224:227], a[168:171], a[192:195], v[224:227]
s_add_u32 m0, s33, 4096
ds_read_b64_tr_b16 a[166:167], v6 offset:1024
s_add_u32 s46, s46, s25
v_mfma_f32_16x16x32_bf16 v[228:231], a[168:171], a[196:199], v[228:231]
buffer_load_dwordx4 v2, s[20:23], s37 offen  lds
s_lshl_b32 s46, s46, 8
v_mfma_f32_16x16x32_bf16 v[232:235], a[168:171], a[200:203], v[232:235]
ds_read_b128 a[248:251], v4 offset:12288
s_lshl_b32 s47, s40, 7
v_mfma_f32_16x16x32_bf16 v[236:239], a[168:171], a[204:207], v[236:239]
s_add_u32 s47, s47, 1024
s_mul_i32 s101, s26, s47
s_lshl_b32 s101, s101, 8
v_mfma_f32_16x16x32_bf16 v[240:243], a[168:171], a[208:211], v[240:243]
ds_read_b128 a[252:255], v3 offset:13312
s_lshl_b32 s42, s27, 3
v_mfma_f32_16x16x32_bf16 v[244:247], a[168:171], a[212:215], v[244:247]
s_add_u32 s42, s42, s26
s_lshl_b32 s42, s42, 1
s_and_b32 s25, s17, 1
v_mfma_f32_16x16x32_bf16 v[248:251], a[168:171], a[216:219], v[248:251]
s_add_u32 s37, s31, 163840
ds_read_b64_tr_b16 v[28:29], v12 offset:0
s_add_u32 s42, s42, s25
v_mfma_f32_16x16x32_bf16 v[252:255], a[168:171], a[220:223], v[252:255]
s_add_u32 m0, s33, 5120
ds_read_b64_tr_b16 a[168:169], v7 offset:0
s_lshl_b32 s42, s42, 3
v_mfma_f32_16x16x32_bf16 a[0:3], a[172:175], a[192:195], a[0:3]
buffer_load_dwordx4 v2, s[20:23], s37 offen  lds
ds_read_b64_tr_b16 a[170:171], v7 offset:1024
v_mfma_f32_16x16x32_bf16 a[4:7], a[172:175], a[196:199], a[4:7]
s_add_u32 s31, s31, 262144
s_add_u32 s29, s29, s44
s_add_u32 s42, s42, s24
v_mfma_f32_16x16x32_bf16 a[8:11], a[172:175], a[200:203], a[8:11]
s_add_u32 s33, s33, 16384
ds_read_b64_tr_b16 v[30:31], v12 offset:1024
s_lshl_b32 s42, s42, 13
v_mfma_f32_16x16x32_bf16 a[12:15], a[172:175], a[204:207], a[12:15]
s_and_b32 s33, s33, 65535
buffer_store_dwordx4 v[132:135], v13, s[8:11], s29 offen sc1
s_lshl_b32 s43, s27, 5
v_mfma_f32_16x16x32_bf16 a[16:19], a[172:175], a[208:211], a[16:19]
s_add_u32 s43, s43, s26
s_lshl_b32 s43, s43, 2
s_lshl_b32 s24, s2, 1
v_mfma_f32_16x16x32_bf16 a[20:23], a[172:175], a[212:215], a[20:23]
s_add_u32 s48, s48, s34
s_add_u32 s24, s24, s61
s_lshl_b32 s24, s24, 2
v_mfma_f32_16x16x32_bf16 a[24:27], a[172:175], a[216:219], a[24:27]
s_add_u32 m0, s32, 16384
s_lshr_b32 s25, 0x8720, s24
s_and_b32 s25, s25, 15
v_mfma_f32_16x16x32_bf16 a[28:31], a[172:175], a[220:223], a[28:31]
buffer_load_dwordx4 v1, s[12:15], s48 offen lds
ds_read_b64_tr_b16 a[172:173], v8 offset:0
v_mfma_f32_16x16x32_bf16 a[32:35], a[176:179], a[192:195], a[32:35]
ds_read_b64_tr_b16 a[174:175], v8 offset:1024
s_lshl_b32 s25, s25, 24
v_mfma_f32_16x16x32_bf16 a[36:39], a[176:179], a[196:199], a[36:39]
s_add_u32 s42, s42, s25
s_lshr_b32 s25, 0x7604, s24
s_and_b32 s25, s25, 15
v_mfma_f32_16x16x32_bf16 a[40:43], a[176:179], a[200:203], a[40:43]
s_lshl_b32 s25, s25, 12
s_add_u32 s43, s43, s25
s_add_u32 s43, s43, 111149056
v_mfma_f32_16x16x32_bf16 a[44:47], a[176:179], a[204:207], a[44:47]
s_cmp_lt_u32 s35, s45
s_cselect_b32 s101, s101, 536870912
s_cselect_b32 s46, s46, 536870912
v_mfma_f32_16x16x32_bf16 a[48:51], a[176:179], a[208:211], a[48:51]
s_add_u32 s48, s48, s34
v_xor_b32 v6, 16, v5
v_xor_b32 v7, 64, v5
v_mfma_f32_16x16x32_bf16 a[52:55], a[176:179], a[212:215], a[52:55]
s_add_u32 m0, s32, 20480
v_xor_b32 v8, 80, v5
v_xor_b32 v12, 208, v5
v_mfma_f32_16x16x32_bf16 a[56:59], a[176:179], a[216:219], a[56:59]
buffer_load_dwordx4 v1, s[12:15], s48 offen lds
v_add_u32 v3, 32768, v3
v_mfma_f32_16x16x32_bf16 a[60:63], a[176:179], a[220:223], a[60:63]
ds_read_b64_tr_b16 a[176:177], v9 offset:0
v_subrev_u32 v19, 98304, v3
v_mfma_f32_16x16x32_bf16 a[64:67], a[180:183], a[192:195], a[64:67]
ds_read_b64_tr_b16 a[178:179], v9 offset:1024
v_cmp_le_u32 vcc, 163840, v3
v_mfma_f32_16x16x32_bf16 a[68:71], a[180:183], a[196:199], a[68:71]
v_xor_b32 v9, 128, v5
v_cndmask_b32 v3, v3, v19, vcc
v_mfma_f32_16x16x32_bf16 a[72:75], a[180:183], a[200:203], a[72:75]
v_xor_b32 v4, 64, v3
v_mfma_f32_16x16x32_bf16 a[76:79], a[180:183], a[204:207], a[76:79]
s_add_u32 s48, s48, s34
v_mfma_f32_16x16x32_bf16 a[80:83], a[180:183], a[208:211], a[80:83]
s_add_u32 m0, s32, 24576
v_mfma_f32_16x16x32_bf16 a[84:87], a[180:183], a[212:215], a[84:87]
buffer_load_dwordx4 v1, s[12:15], s48 offen lds
v_mfma_f32_16x16x32_bf16 a[88:91], a[180:183], a[216:219], a[88:91]
s_add_u32 s29, s29, s93
v_mfma_f32_16x16x32_bf16 a[92:95], a[180:183], a[220:223], a[92:95]
ds_read_b64_tr_b16 a[180:181], v10 offset:0
v_mfma_f32_16x16x32_bf16 a[96:99], a[184:187], a[192:195], a[96:99]
buffer_store_dwordx4 v[136:139], v13, s[8:11], s29 offen sc1
ds_read_b64_tr_b16 a[182:183], v10 offset:1024
v_mfma_f32_16x16x32_bf16 a[100:103], a[184:187], a[196:199], a[100:103]
v_xor_b32 v10, 144, v5
v_mfma_f32_16x16x32_bf16 a[104:107], a[184:187], a[200:203], a[104:107]
s_add_u32 s48, s48, s34
v_mfma_f32_16x16x32_bf16 a[108:111], a[184:187], a[204:207], a[108:111]
s_add_u32 m0, s32, 28672
v_mfma_f32_16x16x32_bf16 a[112:115], a[184:187], a[208:211], a[112:115]
buffer_load_dwordx4 v1, s[12:15], s48 offen lds
v_mfma_f32_16x16x32_bf16 a[116:119], a[184:187], a[212:215], a[116:119]
s_add_u32 s30, s30, 128
v_mfma_f32_16x16x32_bf16 a[120:123], a[184:187], a[216:219], a[120:123]
s_add_u32 s32, s32, 32768
v_mfma_f32_16x16x32_bf16 a[124:127], a[184:187], a[220:223], a[124:127]
s_sub_u32 s48, s32, 98304
ds_read_b64_tr_b16 a[184:185], v11 offset:0
v_mfma_f32_16x16x32_bf16 a[128:131], a[188:191], a[192:195], a[128:131]
s_cmp_ge_u32 s32, 163840
s_cselect_b32 s32, s48, s32
ds_read_b64_tr_b16 a[186:187], v11 offset:1024
v_mfma_f32_16x16x32_bf16 a[132:135], a[188:191], a[196:199], a[132:135]
v_xor_b32 v11, 192, v5
v_mfma_f32_16x16x32_bf16 a[136:139], a[188:191], a[200:203], a[136:139]
buffer_load_dword v15, v14, s[96:99], s100 offen
v_mfma_f32_16x16x32_bf16 a[140:143], a[188:191], a[204:207], a[140:143]
s_add_u32 s100, s100, 16384
v_mfma_f32_16x16x32_bf16 a[144:147], a[188:191], a[208:211], a[144:147]
v_mfma_f32_16x16x32_bf16 a[148:151], a[188:191], a[212:215], a[148:151]
v_mfma_f32_16x16x32_bf16 a[152:155], a[188:191], a[216:219], a[152:155]
v_mfma_f32_16x16x32_bf16 a[156:159], a[188:191], a[220:223], a[156:159]
s_waitcnt vmcnt(20) lgkmcnt(0)
s_barrier
v_mfma_f32_16x16x32_bf16 v[160:163], a[160:163], a[224:227], v[160:163]
ds_read_b128 a[192:195], v3 offset:0
v_mfma_f32_16x16x32_bf16 v[164:167], a[160:163], a[228:231], v[164:167]
s_add_u32 s37, s31, 0
s_cmp_eq_u32 s2, 0
s_cselect_b64 s[4:5], s[52:53], s[54:55]
v_mfma_f32_16x16x32_bf16 v[168:171], a[160:163], a[232:235], v[168:171]
s_add_u32 m0, s33, 0
ds_read_b128 a[196:199], v4 offset:1024
s_mov_b32 s12, s4
v_mfma_f32_16x16x32_bf16 v[172:175], a[160:163], a[236:239], v[172:175]
buffer_load_dwordx4 v2, s[20:23], s37 offen  lds
s_and_b32 s13, s5, 0xffff
v_mfma_f32_16x16x32_bf16 v[176:179], a[160:163], a[240:243], v[176:179]
s_add_u32 s29, s29, s44
ds_read_b128 a[200:203], v3 offset:4096
s_lshl_b32 s14, s47, 11
v_mfma_f32_16x16x32_bf16 v[180:183], a[160:163], a[244:247], v[180:183]
s_mov_b32 s15, 0x20000
s_mov_b32 s30, s101
v_lshrrev_b32 v16, 3, v0
v_mfma_f32_16x16x32_bf16 v[184:187], a[160:163], a[248:251], v[184:187]
buffer_store_dwordx4 v[140:143], v13, s[8:11], s29 offen sc1
v_mul_lo_u32 v16, v16, s47
v_mfma_f32_16x16x32_bf16 v[188:191], a[160:163], a[252:255], v[188:191]
ds_read_b64_tr_b16 a[160:161], v5 offset:0
v_and_b32 v1, 0x70, v1
v_mfma_f32_16x16x32_bf16 v[192:195], a[164:167], a[224:227], v[192:195]
s_add_u32 s37, s31, 32768
ds_read_b64_tr_b16 a[162:163], v5 offset:1024
v_add_u32 v1, v1, v16
v_mfma_f32_16x16x32_bf16 v[196:199], a[164:167], a[228:231], v[196:199]
s_add_u32 m0, s33, 1024
ds_read_b128 a[204:207], v4 offset:5120
s_lshl_b32 s34, s47, 5
v_mfma_f32_16x16x32_bf16 v[200:203], a[164:167], a[232:235], v[200:203]
buffer_load_dwordx4 v2, s[20:23], s37 offen  lds
v_add_u32 v5, 16384, v5
v_mfma_f32_16x16x32_bf16 v[204:207], a[164:167], a[236:239], v[204:207]
ds_read_b128 a[208:211], v3 offset:8192
v_and_b32 v5, 65535, v5
v_mfma_f32_16x16x32_bf16 v[208:211], a[164:167], a[240:243], v[208:211]
v_mfma_f32_16x16x32_bf16 v[212:215], a[164:167], a[244:247], v[212:215]
ds_read_b128 a[212:215], v4 offset:9216
v_mfma_f32_16x16x32_bf16 v[216:219], a[164:167], a[248:251], v[216:219]
v_mfma_f32_16x16x32_bf16 v[220:223], a[164:167], a[252:255], v[220:223]
s_add_u32 s37, s31, 131072
ds_read_b64_tr_b16 a[164:165], v6 offset:0
v_mfma_f32_16x16x32_bf16 v[224:227], a[168:171], a[224:227], v[224:227]
s_add_u32 m0, s33, 4096
ds_read_b64_tr_b16 a[166:167], v6 offset:1024
v_mfma_f32_16x16x32_bf16 v[228:231], a[168:171], a[228:231], v[228:231]
buffer_load_dwordx4 v2, s[20:23], s37 offen  lds
v_xor_b32 v6, 16, v5
v_mfma_f32_16x16x32_bf16 v[232:235], a[168:171], a[232:235], v[232:235]
ds_read_b128 a[216:219], v3 offset:12288
v_mfma_f32_16x16x32_bf16 v[236:239], a[168:171], a[236:239], v[236:239]
v_mfma_f32_16x16x32_bf16 v[240:243], a[168:171], a[240:243], v[240:243]
ds_read_b128 a[220:223], v4 offset:13312
v_mfma_f32_16x16x32_bf16 v[244:247], a[168:171], a[244:247], v[244:247]
v_mfma_f32_16x16x32_bf16 v[248:251], a[168:171], a[248:251], v[248:251]
s_add_u32 s37, s31, 163840
ds_read_b64_tr_b16 a[188:189], v12 offset:0
v_mfma_f32_16x16x32_bf16 v[252:255], a[168:171], a[252:255], v[252:255]
s_add_u32 m0, s33, 5120
ds_read_b64_tr_b16 a[168:169], v7 offset:0
v_mfma_f32_16x16x32_bf16 a[0:3], a[172:175], a[224:227], a[0:3]
buffer_load_dwordx4 v2, s[20:23], s37 offen  lds
ds_read_b64_tr_b16 a[170:171], v7 offset:1024
v_mfma_f32_16x16x32_bf16 a[4:7], a[172:175], a[228:231], a[4:7]
s_add_u32 s31, s31, 262144
s_add_u32 s29, s29, s93
v_xor_b32 v7, 64, v5
v_mfma_f32_16x16x32_bf16 a[8:11], a[172:175], a[232:235], a[8:11]
s_add_u32 s33, s33, 16384
ds_read_b64_tr_b16 a[190:191], v12 offset:1024
v_mfma_f32_16x16x32_bf16 a[12:15], a[172:175], a[236:239], a[12:15]
s_and_b32 s33, s33, 65535
buffer_store_dwordx4 v[144:147], v13, s[8:11], s29 offen sc1
v_mfma_f32_16x16x32_bf16 a[16:19], a[172:175], a[240:243], a[16:19]
v_mfma_f32_16x16x32_bf16 a[20:23], a[172:175], a[244:247], a[20:23]
s_mov_b32 s48, s30
v_xor_b32 v12, 208, v5
v_mfma_f32_16x16x32_bf16 a[24:27], a[172:175], a[248:251], a[24:27]
s_add_u32 m0, s32, 0
v_mfma_f32_16x16x32_bf16 a[28:31], a[172:175], a[252:255], a[28:31]
buffer_load_dwordx4 v1, s[12:15], s48 offen lds
ds_read_b64_tr_b16 a[172:173], v8 offset:0
v_mfma_f32_16x16x32_bf16 a[32:35], a[176:179], a[224:227], a[32:35]
ds_read_b64_tr_b16 a[174:175], v8 offset:1024
v_mfma_f32_16x16x32_bf16 a[36:39], a[176:179], a[228:231], a[36:39]
v_xor_b32 v8, 80, v5
v_mfma_f32_16x16x32_bf16 a[40:43], a[176:179], a[232:235], a[40:43]
v_mfma_f32_16x16x32_bf16 a[44:47], a[176:179], a[236:239], a[44:47]
v_mfma_f32_16x16x32_bf16 a[48:51], a[176:179], a[240:243], a[48:51]
s_add_u32 s48, s48, s34
v_mfma_f32_16x16x32_bf16 a[52:55], a[176:179], a[244:247], a[52:55]
s_add_u32 m0, s32, 4096
v_mfma_f32_16x16x32_bf16 a[56:59], a[176:179], a[248:251], a[56:59]
buffer_load_dwordx4 v1, s[12:15], s48 offen lds
v_mfma_f32_16x16x32_bf16 a[60:63], a[176:179], a[252:255], a[60:63]
ds_read_b64_tr_b16 a[176:177], v9 offset:0
v_mfma_f32_16x16x32_bf16 a[64:67], a[180:183], a[224:227], a[64:67]
ds_read_b64_tr_b16 a[178:179], v9 offset:1024
v_mfma_f32_16x16x32_bf16 a[68:71], a[180:183], a[228:231], a[68:71]
v_xor_b32 v9, 128, v5
v_mfma_f32_16x16x32_bf16 a[72:75], a[180:183], a[232:235], a[72:75]
v_mfma_f32_16x16x32_bf16 a[76:79], a[180:183], a[236:239], a[76:79]
s_add_u32 s48, s48, s34
v_mfma_f32_16x16x32_bf16 a[80:83], a[180:183], a[240:243], a[80:83]
s_add_u32 m0, s32, 8192
s_cmp_eq_u32 s2, 0
s_cselect_b64 s[4:5], s[6:7], s[18:19]
v_mfma_f32_16x16x32_bf16 a[84:87], a[180:183], a[244:247], a[84:87]
buffer_load_dwordx4 v1, s[12:15], s48 offen lds
s_mov_b32 s20, s4
v_mfma_f32_16x16x32_bf16 a[88:91], a[180:183], a[248:251], a[88:91]
s_add_u32 s29, s29, s44
s_and_b32 s21, s5, 0xffff
s_lshl_b32 s22, s47, 12
v_mfma_f32_16x16x32_bf16 a[92:95], a[180:183], a[252:255], a[92:95]
ds_read_b64_tr_b16 a[180:181], v10 offset:0
s_mov_b32 s23, 0x20000
v_mfma_f32_16x16x32_bf16 a[96:99], a[184:187], a[224:227], a[96:99]
buffer_store_dwordx4 v[148:151], v13, s[8:11], s29 offen sc1
ds_read_b64_tr_b16 a[182:183], v10 offset:1024
v_mfma_f32_16x16x32_bf16 a[100:103], a[184:187], a[228:231], a[100:103]
s_mov_b32 s31, s46
v_xor_b32 v10, 144, v5
v_mfma_f32_16x16x32_bf16 a[104:107], a[184:187], a[232:235], a[104:107]
s_add_u32 s48, s48, s34
v_mfma_f32_16x16x32_bf16 a[108:111], a[184:187], a[236:239], a[108:111]
s_add_u32 m0, s32, 12288
v_mfma_f32_16x16x32_bf16 a[112:115], a[184:187], a[240:243], a[112:115]
buffer_load_dwordx4 v1, s[12:15], s48 offen lds
v_mfma_f32_16x16x32_bf16 a[116:119], a[184:187], a[244:247], a[116:119]
v_mfma_f32_16x16x32_bf16 a[120:123], a[184:187], a[248:251], a[120:123]
v_mfma_f32_16x16x32_bf16 a[124:127], a[184:187], a[252:255], a[124:127]
ds_read_b64_tr_b16 a[184:185], v11 offset:0
v_mfma_f32_16x16x32_bf16 a[128:131], v[28:31], a[224:227], a[128:131]
ds_read_b64_tr_b16 a[186:187], v11 offset:1024
v_mfma_f32_16x16x32_bf16 a[132:135], v[28:31], a[228:231], a[132:135]
v_xor_b32 v11, 192, v5
v_mfma_f32_16x16x32_bf16 a[136:139], v[28:31], a[232:235], a[136:139]
buffer_load_dword v15, v14, s[96:99], s100 offen
v_mfma_f32_16x16x32_bf16 a[140:143], v[28:31], a[236:239], a[140:143]
s_add_u32 s100, s100, 16384
v_mfma_f32_16x16x32_bf16 a[144:147], v[28:31], a[240:243], a[144:147]
v_mfma_f32_16x16x32_bf16 a[148:151], v[28:31], a[244:247], a[148:151]
v_mfma_f32_16x16x32_bf16 a[152:155], v[28:31], a[248:251], a[152:155]
v_mfma_f32_16x16x32_bf16 a[156:159], v[28:31], a[252:255], a[156:159]
s_waitcnt vmcnt(24) lgkmcnt(0)
s_barrier
v_mfma_f32_16x16x32_bf16 v[160:163], a[160:163], a[192:195], v[160:163]
ds_read_b128 a[224:227], v4 offset:0
v_mfma_f32_16x16x32_bf16 v[164:167], a[160:163], a[196:199], v[164:167]
s_add_u32 s37, s31, 0
v_mfma_f32_16x16x32_bf16 v[168:171], a[160:163], a[200:203], v[168:171]
s_add_u32 m0, s33, 0
ds_read_b128 a[228:231], v3 offset:1024
v_mfma_f32_16x16x32_bf16 v[172:175], a[160:163], a[204:207], v[172:175]
buffer_load_dwordx4 v2, s[20:23], s37 offen  lds
v_mfma_f32_16x16x32_bf16 v[176:179], a[160:163], a[208:211], v[176:179]
s_add_u32 s29, s29, s93
ds_read_b128 a[232:235], v4 offset:4096
v_mfma_f32_16x16x32_bf16 v[180:183], a[160:163], a[212:215], v[180:183]
v_mfma_f32_16x16x32_bf16 v[184:187], a[160:163], a[216:219], v[184:187]
buffer_store_dwordx4 v[152:155], v13, s[8:11], s29 offen sc1
v_mfma_f32_16x16x32_bf16 v[188:191], a[160:163], a[220:223], v[188:191]
ds_read_b64_tr_b16 a[160:161], v5 offset:0
v_mfma_f32_16x16x32_bf16 v[192:195], a[164:167], a[192:195], v[192:195]
s_add_u32 s37, s31, 32768
ds_read_b64_tr_b16 a[162:163], v5 offset:1024
v_mfma_f32_16x16x32_bf16 v[196:199], a[164:167], a[196:199], v[196:199]
s_add_u32 m0, s33, 1024
ds_read_b128 a[236:239], v3 offset:5120
v_add_u32 v5, 16384, v5
v_mfma_f32_16x16x32_bf16 v[200:203], a[164:167], a[200:203], v[200:203]
buffer_load_dwordx4 v2, s[20:23], s37 offen  lds
v_and_b32 v5, 65535, v5
v_mfma_f32_16x16x32_bf16 v[204:207], a[164:167], a[204:207], v[204:207]
ds_read_b128 a[240:243], v4 offset:8192
v_mfma_f32_16x16x32_bf16 v[208:211], a[164:167], a[208:211], v[208:211]
v_mfma_f32_16x16x32_bf16 v[212:215], a[164:167], a[212:215], v[212:215]
ds_read_b128 a[244:247], v3 offset:9216
v_mfma_f32_16x16x32_bf16 v[216:219], a[164:167], a[216:219], v[216:219]
v_mfma_f32_16x16x32_bf16 v[220:223], a[164:167], a[220:223], v[220:223]
s_add_u32 s37, s31, 131072
ds_read_b64_tr_b16 a[164:165], v6 offset:0
v_mfma_f32_16x16x32_bf16 v[224:227], a[168:171], a[192:195], v[224:227]
s_add_u32 m0, s33, 4096
ds_read_b64_tr_b16 a[166:167], v6 offset:1024
v_mfma_f32_16x16x32_bf16 v[228:231], a[168:171], a[196:199], v[228:231]
buffer_load_dwordx4 v2, s[20:23], s37 offen  lds
v_xor_b32 v6, 16, v5
v_mfma_f32_16x16x32_bf16 v[232:235], a[168:171], a[200:203], v[232:235]
ds_read_b128 a[248:251], v4 offset:12288
v_mfma_f32_16x16x32_bf16 v[236:239], a[168:171], a[204:207], v[236:239]
v_mfma_f32_16x16x32_bf16 v[240:243], a[168:171], a[208:211], v[240:243]
ds_read_b128 a[252:255], v3 offset:13312
v_mfma_f32_16x16x32_bf16 v[244:247], a[168:171], a[212:215], v[244:247]
v_mfma_f32_16x16x32_bf16 v[248:251], a[168:171], a[216:219], v[248:251]
s_add_u32 s37, s31, 163840
ds_read_b64_tr_b16 v[28:29], v12 offset:0
v_mfma_f32_16x16x32_bf16 v[252:255], a[168:171], a[220:223], v[252:255]
s_add_u32 m0, s33, 5120
ds_read_b64_tr_b16 a[168:169], v7 offset:0
v_mfma_f32_16x16x32_bf16 a[0:3], a[172:175], a[192:195], a[0:3]
buffer_load_dwordx4 v2, s[20:23], s37 offen  lds
ds_read_b64_tr_b16 a[170:171], v7 offset:1024
v_mfma_f32_16x16x32_bf16 a[4:7], a[172:175], a[196:199], a[4:7]
s_add_u32 s31, s31, 262144
s_add_u32 s29, s29, s44
v_xor_b32 v7, 64, v5
v_mfma_f32_16x16x32_bf16 a[8:11], a[172:175], a[200:203], a[8:11]
s_add_u32 s33, s33, 16384
ds_read_b64_tr_b16 v[30:31], v12 offset:1024
v_mfma_f32_16x16x32_bf16 a[12:15], a[172:175], a[204:207], a[12:15]
s_and_b32 s33, s33, 65535
buffer_store_dwordx4 v[156:159], v13, s[8:11], s29 offen sc1
v_mfma_f32_16x16x32_bf16 a[16:19], a[172:175], a[208:211], a[16:19]
v_mfma_f32_16x16x32_bf16 a[20:23], a[172:175], a[212:215], a[20:23]
s_add_u32 s48, s48, s34
v_xor_b32 v12, 208, v5
v_mfma_f32_16x16x32_bf16 a[24:27], a[172:175], a[216:219], a[24:27]
s_add_u32 m0, s32, 16384
v_add_u32 v3, 32768, v3
v_mfma_f32_16x16x32_bf16 a[28:31], a[172:175], a[220:223], a[28:31]
buffer_load_dwordx4 v1, s[12:15], s48 offen lds
ds_read_b64_tr_b16 a[172:173], v8 offset:0
v_mfma_f32_16x16x32_bf16 a[32:35], a[176:179], a[192:195], a[32:35]
ds_read_b64_tr_b16 a[174:175], v8 offset:1024
v_subrev_u32 v19, 98304, v3
v_mfma_f32_16x16x32_bf16 a[36:39], a[176:179], a[196:199], a[36:39]
v_xor_b32 v8, 80, v5
v_cmp_le_u32 vcc, 163840, v3
v_mfma_f32_16x16x32_bf16 a[40:43], a[176:179], a[200:203], a[40:43]
s_nop 0
v_cndmask_b32 v3, v3, v19, vcc
v_mfma_f32_16x16x32_bf16 a[44:47], a[176:179], a[204:207], a[44:47]
v_xor_b32 v4, 64, v3
v_mfma_f32_16x16x32_bf16 a[48:51], a[176:179], a[208:211], a[48:51]
s_add_u32 s48, s48, s34
v_mfma_f32_16x16x32_bf16 a[52:55], a[176:179], a[212:215], a[52:55]
s_add_u32 m0, s32, 20480
v_mfma_f32_16x16x32_bf16 a[56:59], a[176:179], a[216:219], a[56:59]
buffer_load_dwordx4 v1, s[12:15], s48 offen lds
v_mfma_f32_16x16x32_bf16 a[60:63], a[176:179], a[220:223], a[60:63]
ds_read_b64_tr_b16 a[176:177], v9 offset:0
v_mfma_f32_16x16x32_bf16 a[64:67], a[180:183], a[192:195], a[64:67]
ds_read_b64_tr_b16 a[178:179], v9 offset:1024
v_mfma_f32_16x16x32_bf16 a[68:71], a[180:183], a[196:199], a[68:71]
v_xor_b32 v9, 128, v5
v_mfma_f32_16x16x32_bf16 a[72:75], a[180:183], a[200:203], a[72:75]
v_mfma_f32_16x16x32_bf16 a[76:79], a[180:183], a[204:207], a[76:79]
s_add_u32 s48, s48, s34
v_mfma_f32_16x16x32_bf16 a[80:83], a[180:183], a[208:211], a[80:83]
s_add_u32 m0, s32, 24576
v_mfma_f32_16x16x32_bf16 a[84:87], a[180:183], a[212:215], a[84:87]
buffer_load_dwordx4 v1, s[12:15], s48 offen lds
v_mfma_f32_16x16x32_bf16 a[88:91], a[180:183], a[216:219], a[88:91]
v_mfma_f32_16x16x32_bf16 a[92:95], a[180:183], a[220:223], a[92:95]
ds_read_b64_tr_b16 a[180:181], v10 offset:0
v_mfma_f32_16x16x32_bf16 a[96:99], a[184:187], a[192:195], a[96:99]
ds_read_b64_tr_b16 a[182:183], v10 offset:1024
v_mfma_f32_16x16x32_bf16 a[100:103], a[184:187], a[196:199], a[100:103]
v_xor_b32 v10, 144, v5
v_mfma_f32_16x16x32_bf16 a[104:107], a[184:187], a[200:203], a[104:107]
s_add_u32 s48, s48, s34
v_mfma_f32_16x16x32_bf16 a[108:111], a[184:187], a[204:207], a[108:111]
s_add_u32 m0, s32, 28672
v_mfma_f32_16x16x32_bf16 a[112:115], a[184:187], a[208:211], a[112:115]
buffer_load_dwordx4 v1, s[12:15], s48 offen lds
v_mfma_f32_16x16x32_bf16 a[116:119], a[184:187], a[212:215], a[116:119]
s_add_u32 s30, s30, 128
v_mfma_f32_16x16x32_bf16 a[120:123], a[184:187], a[216:219], a[120:123]
s_add_u32 s32, s32, 32768
v_mfma_f32_16x16x32_bf16 a[124:127], a[184:187], a[220:223], a[124:127]
s_sub_u32 s48, s32, 98304
ds_read_b64_tr_b16 a[184:185], v11 offset:0
v_mfma_f32_16x16x32_bf16 a[128:131], a[188:191], a[192:195], a[128:131]
s_cmp_ge_u32 s32, 163840
s_cselect_b32 s32, s48, s32
ds_read_b64_tr_b16 a[186:187], v11 offset:1024
v_mfma_f32_16x16x32_bf16 a[132:135], a[188:191], a[196:199], a[132:135]
v_xor_b32 v11, 192, v5
v_mfma_f32_16x16x32_bf16 a[136:139], a[188:191], a[200:203], a[136:139]
buffer_load_dword v15, v14, s[96:99], s100 offen
v_mfma_f32_16x16x32_bf16 a[140:143], a[188:191], a[204:207], a[140:143]
s_add_u32 s100, s100, 16384
v_mfma_f32_16x16x32_bf16 a[144:147], a[188:191], a[208:211], a[144:147]
v_mfma_f32_16x16x32_bf16 a[148:151], a[188:191], a[212:215], a[148:151]
v_mfma_f32_16x16x32_bf16 a[152:155], a[188:191], a[216:219], a[152:155]
v_mfma_f32_16x16x32_bf16 a[156:159], a[188:191], a[220:223], a[156:159]
s_waitcnt vmcnt(23) lgkmcnt(0)
s_barrier
v_mfma_f32_16x16x32_bf16 v[160:163], a[160:163], a[224:227], v[160:163]
ds_read_b128 a[192:195], v3 offset:0
v_mfma_f32_16x16x32_bf16 v[164:167], a[160:163], a[228:231], v[164:167]
s_add_u32 s37, s31, 0
v_mfma_f32_16x16x32_bf16 v[168:171], a[160:163], a[232:235], v[168:171]
s_add_u32 m0, s33, 0
ds_read_b128 a[196:199], v4 offset:1024
v_mfma_f32_16x16x32_bf16 v[172:175], a[160:163], a[236:239], v[172:175]
buffer_load_dwordx4 v2, s[20:23], s37 offen  lds
v_mfma_f32_16x16x32_bf16 v[176:179], a[160:163], a[240:243], v[176:179]
ds_read_b128 a[200:203], v3 offset:4096
v_mfma_f32_16x16x32_bf16 v[180:183], a[160:163], a[244:247], v[180:183]
v_mfma_f32_16x16x32_bf16 v[184:187], a[160:163], a[248:251], v[184:187]
ds_read_b128 a[204:207], v4 offset:5120
v_mfma_f32_16x16x32_bf16 v[188:191], a[160:163], a[252:255], v[188:191]
ds_read_b64_tr_b16 a[160:161], v5 offset:0
v_mfma_f32_16x16x32_bf16 v[192:195], a[164:167], a[224:227], v[192:195]
s_add_u32 s37, s31, 32768
ds_read_b64_tr_b16 a[162:163], v5 offset:1024
v_mfma_f32_16x16x32_bf16 v[196:199], a[164:167], a[228:231], v[196:199]
s_add_u32 m0, s33, 1024
ds_read_b128 a[208:211], v3 offset:8192
v_add_u32 v5, 16384, v5
v_mfma_f32_16x16x32_bf16 v[200:203], a[164:167], a[232:235], v[200:203]
buffer_load_dwordx4 v2, s[20:23], s37 offen  lds
v_and_b32 v5, 65535, v5
v_mfma_f32_16x16x32_bf16 v[204:207], a[164:167], a[236:239], v[204:207]
ds_read_b128 a[212:215], v4 offset:9216
v_mfma_f32_16x16x32_bf16 v[208:211], a[164:167], a[240:243], v[208:211]
v_mfma_f32_16x16x32_bf16 v[212:215], a[164:167], a[244:247], v[212:215]
ds_read_b128 a[216:219], v3 offset:12288
v_mfma_f32_16x16x32_bf16 v[216:219], a[164:167], a[248:251], v[216:219]
v_mfma_f32_16x16x32_bf16 v[220:223], a[164:167], a[252:255], v[220:223]
s_add_u32 s37, s31, 131072
ds_read_b64_tr_b16 a[164:165], v6 offset:0
v_mfma_f32_16x16x32_bf16 v[224:227], a[168:171], a[224:227], v[224:227]
s_add_u32 m0, s33, 4096
ds_read_b64_tr_b16 a[166:167], v6 offset:1024
v_mfma_f32_16x16x32_bf16 v[228:231], a[168:171], a[228:231], v[228:231]
buffer_load_dwordx4 v2, s[20:23], s37 offen  lds
v_xor_b32 v6, 16, v5
v_mfma_f32_16x16x32_bf16 v[232:235], a[168:171], a[232:235], v[232:235]
ds_read_b128 a[220:223], v4 offset:13312
v_mfma_f32_16x16x32_bf16 v[236:239], a[168:171], a[236:239], v[236:239]
v_mfma_f32_16x16x32_bf16 v[240:243], a[168:171], a[240:243], v[240:243]
ds_read_b64_tr_b16 a[188:189], v12 offset:0
v_mfma_f32_16x16x32_bf16 v[244:247], a[168:171], a[244:247], v[244:247]
v_mfma_f32_16x16x32_bf16 v[248:251], a[168:171], a[248:251], v[248:251]
s_add_u32 s37, s31, 163840
ds_read_b64_tr_b16 a[190:191], v12 offset:1024
v_mfma_f32_16x16x32_bf16 v[252:255], a[168:171], a[252:255], v[252:255]
s_add_u32 m0, s33, 5120
ds_read_b64_tr_b16 a[168:169], v7 offset:0
v_mfma_f32_16x16x32_bf16 a[0:3], a[172:175], a[224:227], a[0:3]
buffer_load_dwordx4 v2, s[20:23], s37 offen  lds
ds_read_b64_tr_b16 a[170:171], v7 offset:1024
v_mfma_f32_16x16x32_bf16 a[4:7], a[172:175], a[228:231], a[4:7]
s_add_u32 s31, s31, 262144
v_xor_b32 v7, 64, v5
v_xor_b32 v12, 208, v5
v_mfma_f32_16x16x32_bf16 a[8:11], a[172:175], a[232:235], a[8:11]
s_add_u32 s33, s33, 16384
v_mfma_f32_16x16x32_bf16 a[12:15], a[172:175], a[236:239], a[12:15]
s_and_b32 s33, s33, 65535
v_mfma_f32_16x16x32_bf16 a[16:19], a[172:175], a[240:243], a[16:19]
v_mfma_f32_16x16x32_bf16 a[20:23], a[172:175], a[244:247], a[20:23]
s_mov_b32 s48, s30
v_mfma_f32_16x16x32_bf16 a[24:27], a[172:175], a[248:251], a[24:27]
s_add_u32 m0, s32, 0
v_mfma_f32_16x16x32_bf16 a[28:31], a[172:175], a[252:255], a[28:31]
buffer_load_dwordx4 v1, s[12:15], s48 offen lds
ds_read_b64_tr_b16 a[172:173], v8 offset:0
v_mfma_f32_16x16x32_bf16 a[32:35], a[176:179], a[224:227], a[32:35]
ds_read_b64_tr_b16 a[174:175], v8 offset:1024
v_mfma_f32_16x16x32_bf16 a[36:39], a[176:179], a[228:231], a[36:39]
v_xor_b32 v8, 80, v5
v_mfma_f32_16x16x32_bf16 a[40:43], a[176:179], a[232:235], a[40:43]
v_mfma_f32_16x16x32_bf16 a[44:47], a[176:179], a[236:239], a[44:47]
v_mfma_f32_16x16x32_bf16 a[48:51], a[176:179], a[240:243], a[48:51]
s_add_u32 s48, s48, s34
v_mfma_f32_16x16x32_bf16 a[52:55], a[176:179], a[244:247], a[52:55]
s_add_u32 m0, s32, 4096
v_mfma_f32_16x16x32_bf16 a[56:59], a[176:179], a[248:251], a[56:59]
buffer_load_dwordx4 v1, s[12:15], s48 offen lds
v_mfma_f32_16x16x32_bf16 a[60:63], a[176:179], a[252:255], a[60:63]
ds_read_b64_tr_b16 a[176:177], v9 offset:0
v_mfma_f32_16x16x32_bf16 a[64:67], a[180:183], a[224:227], a[64:67]
ds_read_b64_tr_b16 a[178:179], v9 offset:1024
v_mfma_f32_16x16x32_bf16 a[68:71], a[180:183], a[228:231], a[68:71]
v_xor_b32 v9, 128, v5
v_mfma_f32_16x16x32_bf16 a[72:75], a[180:183], a[232:235], a[72:75]
v_mfma_f32_16x16x32_bf16 a[76:79], a[180:183], a[236:239], a[76:79]
s_add_u32 s48, s48, s34
v_mfma_f32_16x16x32_bf16 a[80:83], a[180:183], a[240:243], a[80:83]
s_add_u32 m0, s32, 8192
v_mfma_f32_16x16x32_bf16 a[84:87], a[180:183], a[244:247], a[84:87]
buffer_load_dwordx4 v1, s[12:15], s48 offen lds
v_mfma_f32_16x16x32_bf16 a[88:91], a[180:183], a[248:251], a[88:91]
v_mfma_f32_16x16x32_bf16 a[92:95], a[180:183], a[252:255], a[92:95]
ds_read_b64_tr_b16 a[180:181], v10 offset:0
v_mfma_f32_16x16x32_bf16 a[96:99], a[184:187], a[224:227], a[96:99]
ds_read_b64_tr_b16 a[182:183], v10 offset:1024
v_mfma_f32_16x16x32_bf16 a[100:103], a[184:187], a[228:231], a[100:103]
v_xor_b32 v10, 144, v5
v_mfma_f32_16x16x32_bf16 a[104:107], a[184:187], a[232:235], a[104:107]
s_add_u32 s48, s48, s34
v_mfma_f32_16x16x32_bf16 a[108:111], a[184:187], a[236:239], a[108:111]
s_add_u32 m0, s32, 12288
v_mfma_f32_16x16x32_bf16 a[112:115], a[184:187], a[240:243], a[112:115]
buffer_load_dwordx4 v1, s[12:15], s48 offen lds
v_mfma_f32_16x16x32_bf16 a[116:119], a[184:187], a[244:247], a[116:119]
v_mfma_f32_16x16x32_bf16 a[120:123], a[184:187], a[248:251], a[120:123]
v_mfma_f32_16x16x32_bf16 a[124:127], a[184:187], a[252:255], a[124:127]
ds_read_b64_tr_b16 a[184:185], v11 offset:0
v_mfma_f32_16x16x32_bf16 a[128:131], v[28:31], a[224:227], a[128:131]
ds_read_b64_tr_b16 a[186:187], v11 offset:1024
v_mfma_f32_16x16x32_bf16 a[132:135], v[28:31], a[228:231], a[132:135]
v_xor_b32 v11, 192, v5
v_mfma_f32_16x16x32_bf16 a[136:139], v[28:31], a[232:235], a[136:139]
buffer_load_dword v15, v14, s[96:99], s100 offen
v_mfma_f32_16x16x32_bf16 a[140:143], v[28:31], a[236:239], a[140:143]
s_add_u32 s100, s100, 16384
v_mfma_f32_16x16x32_bf16 a[144:147], v[28:31], a[240:243], a[144:147]
v_mfma_f32_16x16x32_bf16 a[148:151], v[28:31], a[244:247], a[148:151]
v_mfma_f32_16x16x32_bf16 a[152:155], v[28:31], a[248:251], a[152:155]
v_mfma_f32_16x16x32_bf16 a[156:159], v[28:31], a[252:255], a[156:159]
s_waitcnt vmcnt(20) lgkmcnt(0)
s_barrier
v_mfma_f32_16x16x32_bf16 v[160:163], a[160:163], a[192:195], v[160:163]
ds_read_b128 a[224:227], v4 offset:0
v_mfma_f32_16x16x32_bf16 v[164:167], a[160:163], a[196:199], v[164:167]
s_add_u32 s37, s31, 0
v_mfma_f32_16x16x32_bf16 v[168:171], a[160:163], a[200:203], v[168:171]
s_add_u32 m0, s33, 0
ds_read_b128 a[228:231], v3 offset:1024
v_mfma_f32_16x16x32_bf16 v[172:175], a[160:163], a[204:207], v[172:175]
buffer_load_dwordx4 v2, s[20:23], s37 offen  lds
v_mfma_f32_16x16x32_bf16 v[176:179], a[160:163], a[208:211], v[176:179]
ds_read_b128 a[232:235], v4 offset:4096
v_mfma_f32_16x16x32_bf16 v[180:183], a[160:163], a[212:215], v[180:183]
v_mfma_f32_16x16x32_bf16 v[184:187], a[160:163], a[216:219], v[184:187]
ds_read_b128 a[236:239], v3 offset:5120
v_mfma_f32_16x16x32_bf16 v[188:191], a[160:163], a[220:223], v[188:191]
ds_read_b64_tr_b16 a[160:161], v5 offset:0
v_mfma_f32_16x16x32_bf16 v[192:195], a[164:167], a[192:195], v[192:195]
s_add_u32 s37, s31, 32768
ds_read_b64_tr_b16 a[162:163], v5 offset:1024
v_mfma_f32_16x16x32_bf16 v[196:199], a[164:167], a[196:199], v[196:199]
s_add_u32 m0, s33, 1024
ds_read_b128 a[240:243], v4 offset:8192
v_add_u32 v5, 16384, v5
v_mfma_f32_16x16x32_bf16 v[200:203], a[164:167], a[200:203], v[200:203]
buffer_load_dwordx4 v2, s[20:23], s37 offen  lds
v_and_b32 v5, 65535, v5
v_mfma_f32_16x16x32_bf16 v[204:207], a[164:167], a[204:207], v[204:207]
ds_read_b128 a[244:247], v3 offset:9216
v_mfma_f32_16x16x32_bf16 v[208:211], a[164:167], a[208:211], v[208:211]
v_mfma_f32_16x16x32_bf16 v[212:215], a[164:167], a[212:215], v[212:215]
ds_read_b128 a[248:251], v4 offset:12288
v_mfma_f32_16x16x32_bf16 v[216:219], a[164:167], a[216:219], v[216:219]
v_mfma_f32_16x16x32_bf16 v[220:223], a[164:167], a[220:223], v[220:223]
s_add_u32 s37, s31, 131072
ds_read_b64_tr_b16 a[164:165], v6 offset:0
v_mfma_f32_16x16x32_bf16 v[224:227], a[168:171], a[192:195], v[224:227]
s_add_u32 m0, s33, 4096
ds_read_b64_tr_b16 a[166:167], v6 offset:1024
v_mfma_f32_16x16x32_bf16 v[228:231], a[168:171], a[196:199], v[228:231]
buffer_load_dwordx4 v2, s[20:23], s37 offen  lds
v_xor_b32 v6, 16, v5
v_mfma_f32_16x16x32_bf16 v[232:235], a[168:171], a[200:203], v[232:235]
ds_read_b128 a[252:255], v3 offset:13312
v_mfma_f32_16x16x32_bf16 v[236:239], a[168:171], a[204:207], v[236:239]
v_mfma_f32_16x16x32_bf16 v[240:243], a[168:171], a[208:211], v[240:243]
ds_read_b64_tr_b16 v[28:29], v12 offset:0
v_mfma_f32_16x16x32_bf16 v[244:247], a[168:171], a[212:215], v[244:247]
v_mfma_f32_16x16x32_bf16 v[248:251], a[168:171], a[216:219], v[248:251]
s_add_u32 s37, s31, 163840
ds_read_b64_tr_b16 v[30:31], v12 offset:1024
v_mfma_f32_16x16x32_bf16 v[252:255], a[168:171], a[220:223], v[252:255]
s_add_u32 m0, s33, 5120
ds_read_b64_tr_b16 a[168:169], v7 offset:0
v_mfma_f32_16x16x32_bf16 a[0:3], a[172:175], a[192:195], a[0:3]
buffer_load_dwordx4 v2, s[20:23], s37 offen  lds
ds_read_b64_tr_b16 a[170:171], v7 offset:1024
v_mfma_f32_16x16x32_bf16 a[4:7], a[172:175], a[196:199], a[4:7]
s_add_u32 s31, s31, 262144
v_xor_b32 v7, 64, v5
v_xor_b32 v12, 208, v5
v_mfma_f32_16x16x32_bf16 a[8:11], a[172:175], a[200:203], a[8:11]
s_add_u32 s33, s33, 16384
v_add_u32 v3, 32768, v3
v_mfma_f32_16x16x32_bf16 a[12:15], a[172:175], a[204:207], a[12:15]
s_and_b32 s33, s33, 65535
v_subrev_u32 v19, 98304, v3
v_mfma_f32_16x16x32_bf16 a[16:19], a[172:175], a[208:211], a[16:19]
v_cmp_le_u32 vcc, 163840, v3
v_mfma_f32_16x16x32_bf16 a[20:23], a[172:175], a[212:215], a[20:23]
s_add_u32 s48, s48, s34
v_cndmask_b32 v3, v3, v19, vcc
v_mfma_f32_16x16x32_bf16 a[24:27], a[172:175], a[216:219], a[24:27]
s_add_u32 m0, s32, 16384
v_xor_b32 v4, 64, v3
v_mfma_f32_16x16x32_bf16 a[28:31], a[172:175], a[220:223], a[28:31]
buffer_load_dwordx4 v1, s[12:15], s48 offen lds
ds_read_b64_tr_b16 a[172:173], v8 offset:0
v_mfma_f32_16x16x32_bf16 a[32:35], a[176:179], a[192:195], a[32:35]
ds_read_b64_tr_b16 a[174:175], v8 offset:1024
v_mfma_f32_16x16x32_bf16 a[36:39], a[176:179], a[196:199], a[36:39]
v_xor_b32 v8, 80, v5
v_mfma_f32_16x16x32_bf16 a[40:43], a[176:179], a[200:203], a[40:43]
v_mfma_f32_16x16x32_bf16 a[44:47], a[176:179], a[204:207], a[44:47]
v_mfma_f32_16x16x32_bf16 a[48:51], a[176:179], a[208:211], a[48:51]
s_add_u32 s48, s48, s34
v_mfma_f32_16x16x32_bf16 a[52:55], a[176:179], a[212:215], a[52:55]
s_add_u32 m0, s32, 20480
v_mfma_f32_16x16x32_bf16 a[56:59], a[176:179], a[216:219], a[56:59]
buffer_load_dwordx4 v1, s[12:15], s48 offen lds
v_mfma_f32_16x16x32_bf16 a[60:63], a[176:179], a[220:223], a[60:63]
ds_read_b64_tr_b16 a[176:177], v9 offset:0
v_mfma_f32_16x16x32_bf16 a[64:67], a[180:183], a[192:195], a[64:67]
ds_read_b64_tr_b16 a[178:179], v9 offset:1024
v_mfma_f32_16x16x32_bf16 a[68:71], a[180:183], a[196:199], a[68:71]
v_xor_b32 v9, 128, v5
v_mfma_f32_16x16x32_bf16 a[72:75], a[180:183], a[200:203], a[72:75]
v_mfma_f32_16x16x32_bf16 a[76:79], a[180:183], a[204:207], a[76:79]
s_add_u32 s48, s48, s34
v_mfma_f32_16x16x32_bf16 a[80:83], a[180:183], a[208:211], a[80:83]
s_add_u32 m0, s32, 24576
v_mfma_f32_16x16x32_bf16 a[84:87], a[180:183], a[212:215], a[84:87]
buffer_load_dwordx4 v1, s[12:15], s48 offen lds
v_mfma_f32_16x16x32_bf16 a[88:91], a[180:183], a[216:219], a[88:91]
v_mfma_f32_16x16x32_bf16 a[92:95], a[180:183], a[220:223], a[92:95]
ds_read_b64_tr_b16 a[180:181], v10 offset:0
v_mfma_f32_16x16x32_bf16 a[96:99], a[184:187], a[192:195], a[96:99]
ds_read_b64_tr_b16 a[182:183], v10 offset:1024
v_mfma_f32_16x16x32_bf16 a[100:103], a[184:187], a[196:199], a[100:103]
v_xor_b32 v10, 144, v5
v_mfma_f32_16x16x32_bf16 a[104:107], a[184:187], a[200:203], a[104:107]
s_add_u32 s48, s48, s34
v_mfma_f32_16x16x32_bf16 a[108:111], a[184:187], a[204:207], a[108:111]
s_add_u32 m0, s32, 28672
v_mfma_f32_16x16x32_bf16 a[112:115], a[184:187], a[208:211], a[112:115]
buffer_load_dwordx4 v1, s[12:15], s48 offen lds
v_mfma_f32_16x16x32_bf16 a[116:119], a[184:187], a[212:215], a[116:119]
s_add_u32 s30, s30, 128
v_mfma_f32_16x16x32_bf16 a[120:123], a[184:187], a[216:219], a[120:123]
s_add_u32 s32, s32, 32768
v_mfma_f32_16x16x32_bf16 a[124:127], a[184:187], a[220:223], a[124:127]
s_sub_u32 s48, s32, 98304
ds_read_b64_tr_b16 a[184:185], v11 offset:0
v_mfma_f32_16x16x32_bf16 a[128:131], a[188:191], a[192:195], a[128:131]
s_cmp_ge_u32 s32, 163840
s_cselect_b32 s32, s48, s32
ds_read_b64_tr_b16 a[186:187], v11 offset:1024
v_mfma_f32_16x16x32_bf16 a[132:135], a[188:191], a[196:199], a[132:135]
v_xor_b32 v11, 192, v5
v_mfma_f32_16x16x32_bf16 a[136:139], a[188:191], a[200:203], a[136:139]
buffer_load_dword v15, v14, s[96:99], s100 offen
v_mfma_f32_16x16x32_bf16 a[140:143], a[188:191], a[204:207], a[140:143]
s_add_u32 s100, s100, 16384
v_mfma_f32_16x16x32_bf16 a[144:147], a[188:191], a[208:211], a[144:147]
v_mfma_f32_16x16x32_bf16 a[148:151], a[188:191], a[212:215], a[148:151]
v_mfma_f32_16x16x32_bf16 a[152:155], a[188:191], a[216:219], a[152:155]
v_mfma_f32_16x16x32_bf16 a[156:159], a[188:191], a[220:223], a[156:159]
s_cmp_eq_u32 s41, 0
s_cbranch_scc0 L_g_k17v
s_waitcnt vmcnt(18) lgkmcnt(0)
s_barrier
v_mfma_f32_16x16x32_bf16 v[160:163], a[160:163], a[224:227], v[160:163]
ds_read_b128 a[192:195], v3 offset:0
v_mfma_f32_16x16x32_bf16 v[164:167], a[160:163], a[228:231], v[164:167]
s_add_u32 s37, s31, 0
v_mfma_f32_16x16x32_bf16 v[168:171], a[160:163], a[232:235], v[168:171]
s_add_u32 m0, s33, 0
ds_read_b128 a[196:199], v4 offset:1024
v_mfma_f32_16x16x32_bf16 v[172:175], a[160:163], a[236:239], v[172:175]
buffer_load_dwordx4 v2, s[20:23], s37 offen  lds
v_mfma_f32_16x16x32_bf16 v[176:179], a[160:163], a[240:243], v[176:179]
ds_read_b128 a[200:203], v3 offset:4096
v_cvt_pk_bf16_f32 v32, v160, v161
v_cvt_pk_bf16_f32 v33, v162, v163
v_mfma_f32_16x16x32_bf16 v[180:183], a[160:163], a[244:247], v[180:183]
v_cvt_pk_bf16_f32 v36, v164, v165
v_cvt_pk_bf16_f32 v37, v166, v167
v_mfma_f32_16x16x32_bf16 v[184:187], a[160:163], a[248:251], v[184:187]
ds_read_b128 a[204:207], v4 offset:5120
v_cvt_pk_bf16_f32 v40, v168, v169
v_cvt_pk_bf16_f32 v41, v170, v171
v_mfma_f32_16x16x32_bf16 v[188:191], a[160:163], a[252:255], v[188:191]
ds_read_b64_tr_b16 a[160:161], v5 offset:0
v_cvt_pk_bf16_f32 v44, v172, v173
v_cvt_pk_bf16_f32 v45, v174, v175
v_mfma_f32_16x16x32_bf16 v[192:195], a[164:167], a[224:227], v[192:195]
s_add_u32 s37, s31, 32768
ds_read_b64_tr_b16 a[162:163], v5 offset:1024
v_cvt_pk_bf16_f32 v48, v176, v177
v_cvt_pk_bf16_f32 v49, v178, v179
v_mfma_f32_16x16x32_bf16 v[196:199], a[164:167], a[228:231], v[196:199]
s_add_u32 m0, s33, 1024
ds_read_b128 a[208:211], v3 offset:8192
v_add_u32 v5, 16384, v5
v_cvt_pk_bf16_f32 v52, v180, v181
v_cvt_pk_bf16_f32 v53, v182, v183
v_mfma_f32_16x16x32_bf16 v[200:203], a[164:167], a[232:235], v[200:203]
buffer_load_dwordx4 v2, s[20:23], s37 offen  lds
v_and_b32 v5, 65535, v5
v_cvt_pk_bf16_f32 v56, v184, v185
v_cvt_pk_bf16_f32 v57, v186, v187
v_mfma_f32_16x16x32_bf16 v[204:207], a[164:167], a[236:239], v[204:207]
ds_read_b128 a[212:215], v4 offset:9216
v_cvt_pk_bf16_f32 v60, v188, v189
v_cvt_pk_bf16_f32 v61, v190, v191
v_mfma_f32_16x16x32_bf16 v[208:211], a[164:167], a[240:243], v[208:211]
v_cvt_pk_bf16_f32 v34, v192, v193
v_cvt_pk_bf16_f32 v35, v194, v195
v_mfma_f32_16x16x32_bf16 v[212:215], a[164:167], a[244:247], v[212:215]
ds_read_b128 a[216:219], v3 offset:12288
v_cvt_pk_bf16_f32 v38, v196, v197
v_cvt_pk_bf16_f32 v39, v198, v199
v_mfma_f32_16x16x32_bf16 v[216:219], a[164:167], a[248:251], v[216:219]
v_cvt_pk_bf16_f32 v42, v200, v201
v_cvt_pk_bf16_f32 v43, v202, v203
v_mfma_f32_16x16x32_bf16 v[220:223], a[164:167], a[252:255], v[220:223]
s_add_u32 s37, s31, 131072
ds_read_b64_tr_b16 a[164:165], v6 offset:0
v_cvt_pk_bf16_f32 v46, v204, v205
v_cvt_pk_bf16_f32 v47, v206, v207
v_mfma_f32_16x16x32_bf16 v[224:227], a[168:171], a[224:227], v[224:227]
s_add_u32 m0, s33, 4096
ds_read_b64_tr_b16 a[166:167], v6 offset:1024
v_cvt_pk_bf16_f32 v50, v208, v209
v_cvt_pk_bf16_f32 v51, v210, v211
v_mfma_f32_16x16x32_bf16 v[228:231], a[168:171], a[228:231], v[228:231]
buffer_load_dwordx4 v2, s[20:23], s37 offen  lds
v_xor_b32 v6, 16, v5
v_cvt_pk_bf16_f32 v54, v212, v213
v_cvt_pk_bf16_f32 v55, v214, v215
v_mfma_f32_16x16x32_bf16 v[232:235], a[168:171], a[232:235], v[232:235]
ds_read_b128 a[220:223], v4 offset:13312
v_cvt_pk_bf16_f32 v58, v216, v217
v_cvt_pk_bf16_f32 v59, v218, v219
v_mfma_f32_16x16x32_bf16 v[236:239], a[168:171], a[236:239], v[236:239]
v_cvt_pk_bf16_f32 v62, v220, v221
v_cvt_pk_bf16_f32 v63, v222, v223
v_mfma_f32_16x16x32_bf16 v[240:243], a[168:171], a[240:243], v[240:243]
ds_read_b64_tr_b16 a[188:189], v12 offset:0
v_cvt_pk_bf16_f32 v64, v224, v225
v_cvt_pk_bf16_f32 v65, v226, v227
v_mfma_f32_16x16x32_bf16 v[244:247], a[168:171], a[244:247], v[244:247]
v_cvt_pk_bf16_f32 v68, v228, v229
v_cvt_pk_bf16_f32 v69, v230, v231
v_mfma_f32_16x16x32_bf16 v[248:251], a[168:171], a[248:251], v[248:251]
s_add_u32 s37, s31, 163840
ds_read_b64_tr_b16 a[190:191], v12 offset:1024
v_cvt_pk_bf16_f32 v72, v232, v233
v_cvt_pk_bf16_f32 v73, v234, v235
v_mfma_f32_16x16x32_bf16 v[252:255], a[168:171], a[252:255], v[252:255]
s_add_u32 m0, s33, 5120
ds_read_b64_tr_b16 a[168:169], v7 offset:0
v_cvt_pk_bf16_f32 v76, v236, v237
v_cvt_pk_bf16_f32 v77, v238, v239
v_mfma_f32_16x16x32_bf16 a[0:3], a[172:175], a[224:227], a[0:3]
buffer_load_dwordx4 v2, s[20:23], s37 offen  lds
ds_read_b64_tr_b16 a[170:171], v7 offset:1024
v_cvt_pk_bf16_f32 v80, v240, v241
v_cvt_pk_bf16_f32 v81, v242, v243
v_mfma_f32_16x16x32_bf16 a[4:7], a[172:175], a[228:231], a[4:7]
s_add_u32 s31, s31, 262144
v_xor_b32 v7, 64, v5
v_xor_b32 v12, 208, v5
v_cvt_pk_bf16_f32 v84, v244, v245
v_cvt_pk_bf16_f32 v85, v246, v247
v_mfma_f32_16x16x32_bf16 a[8:11], a[172:175], a[232:235], a[8:11]
s_add_u32 s33, s33, 16384
v_cvt_pk_bf16_f32 v88, v248, v249
v_cvt_pk_bf16_f32 v89, v250, v251
v_mfma_f32_16x16x32_bf16 a[12:15], a[172:175], a[236:239], a[12:15]
s_and_b32 s33, s33, 65535
v_cvt_pk_bf16_f32 v92, v252, v253
v_cvt_pk_bf16_f32 v93, v254, v255
v_mfma_f32_16x16x32_bf16 a[16:19], a[172:175], a[240:243], a[16:19]
v_accvgpr_read_b32 v20, a0
v_accvgpr_read_b32 v21, a1
v_accvgpr_read_b32 v22, a2
v_accvgpr_read_b32 v23, a3
v_mfma_f32_16x16x32_bf16 a[20:23], a[172:175], a[244:247], a[20:23]
s_mov_b32 s48, s30
v_cvt_pk_bf16_f32 v66, v20, v21
v_cvt_pk_bf16_f32 v67, v22, v23
v_accvgpr_read_b32 v24, a4
v_accvgpr_read_b32 v25, a5
v_mfma_f32_16x16x32_bf16 a[24:27], a[172:175], a[248:251], a[24:27]
s_add_u32 m0, s32, 0
v_accvgpr_read_b32 v26, a6
v_accvgpr_read_b32 v27, a7
v_cvt_pk_bf16_f32 v70, v24, v25
v_cvt_pk_bf16_f32 v71, v26, v27
v_mfma_f32_16x16x32_bf16 a[28:31], a[172:175], a[252:255], a[28:31]
buffer_load_dwordx4 v1, s[12:15], s48 offen lds
ds_read_b64_tr_b16 a[172:173], v8 offset:0
v_accvgpr_read_b32 v20, a8
v_accvgpr_read_b32 v21, a9
v_mfma_f32_16x16x32_bf16 a[32:35], a[176:179], a[224:227], a[32:35]
ds_read_b64_tr_b16 a[174:175], v8 offset:1024
v_mov_b32 v16, 0
v_accvgpr_read_b32 v22, a10
v_accvgpr_read_b32 v23, a11
v_mfma_f32_16x16x32_bf16 a[36:39], a[176:179], a[228:231], a[36:39]
v_mov_b32 v17, 1
v_xor_b32 v8, 80, v5
v_cvt_pk_bf16_f32 v74, v20, v21
v_cvt_pk_bf16_f32 v75, v22, v23
v_mfma_f32_16x16x32_bf16 a[40:43], a[176:179], a[232:235], a[40:43]
s_cmp_eq_u32 s17, 0
s_cselect_b32 s29, s39, 536870912
v_accvgpr_read_b32 v24, a12
v_accvgpr_read_b32 v25, a13
v_mfma_f32_16x16x32_bf16 a[44:47], a[176:179], a[236:239], a[44:47]
s_mov_b64 exec, 1
buffer_store_dword v17, v16, s[8:11], s29 offen sc1
s_mov_b64 exec, -1
v_accvgpr_read_b32 v26, a14
v_mfma_f32_16x16x32_bf16 a[48:51], a[176:179], a[240:243], a[48:51]
s_add_u32 s48, s48, s34
v_accvgpr_read_b32 v27, a15
v_cvt_pk_bf16_f32 v78, v24, v25
v_cvt_pk_bf16_f32 v79, v26, v27
v_accvgpr_read_b32 v20, a16
v_mfma_f32_16x16x32_bf16 a[52:55], a[176:179], a[244:247], a[52:55]
s_add_u32 m0, s32, 4096
v_accvgpr_read_b32 v21, a17
v_accvgpr_read_b32 v22, a18
v_accvgpr_read_b32 v23, a19
v_cvt_pk_bf16_f32 v82, v20, v21
v_mfma_f32_16x16x32_bf16 a[56:59], a[176:179], a[248:251], a[56:59]
buffer_load_dwordx4 v1, s[12:15], s48 offen lds
v_cvt_pk_bf16_f32 v83, v22, v23
v_accvgpr_read_b32 v24, a20
v_accvgpr_read_b32 v25, a21
v_mfma_f32_16x16x32_bf16 a[60:63], a[176:179], a[252:255], a[60:63]
ds_read_b64_tr_b16 a[176:177], v9 offset:0
v_accvgpr_read_b32 v26, a22
v_accvgpr_read_b32 v27, a23
v_cvt_pk_bf16_f32 v86, v24, v25
v_mfma_f32_16x16x32_bf16 a[64:67], a[180:183], a[224:227], a[64:67]
ds_read_b64_tr_b16 a[178:179], v9 offset:1024
v_cvt_pk_bf16_f32 v87, v26, v27
v_accvgpr_read_b32 v20, a24
v_accvgpr_read_b32 v21, a25
v_mfma_f32_16x16x32_bf16 a[68:71], a[180:183], a[228:231], a[68:71]
v_xor_b32 v9, 128, v5
v_accvgpr_read_b32 v22, a26
v_accvgpr_read_b32 v23, a27
v_cvt_pk_bf16_f32 v90, v20, v21
v_mfma_f32_16x16x32_bf16 a[72:75], a[180:183], a[232:235], a[72:75]
v_cvt_pk_bf16_f32 v91, v22, v23
v_accvgpr_read_b32 v24, a28
v_accvgpr_read_b32 v25, a29
v_accvgpr_read_b32 v26, a30
v_mfma_f32_16x16x32_bf16 a[76:79], a[180:183], a[236:239], a[76:79]
s_add_u32 s48, s48, s34
v_accvgpr_read_b32 v27, a31
v_cvt_pk_bf16_f32 v94, v24, v25
v_cvt_pk_bf16_f32 v95, v26, v27
v_accvgpr_read_b32 v20, a32
v_mfma_f32_16x16x32_bf16 a[80:83], a[180:183], a[240:243], a[80:83]
s_add_u32 m0, s32, 8192
v_accvgpr_read_b32 v21, a33
v_accvgpr_read_b32 v22, a34
v_accvgpr_read_b32 v23, a35
v_cvt_pk_bf16_f32 v96, v20, v21
v_mfma_f32_16x16x32_bf16 a[84:87], a[180:183], a[244:247], a[84:87]
buffer_load_dwordx4 v1, s[12:15], s48 offen lds
v_cvt_pk_bf16_f32 v97, v22, v23
v_accvgpr_read_b32 v24, a36
v_accvgpr_read_b32 v25, a37
v_mfma_f32_16x16x32_bf16 a[88:91], a[180:183], a[248:251], a[88:91]
v_accvgpr_read_b32 v26, a38
v_accvgpr_read_b32 v27, a39
v_cvt_pk_bf16_f32 v100, v24, v25
v_cvt_pk_bf16_f32 v101, v26, v27
v_mfma_f32_16x16x32_bf16 a[92:95], a[180:183], a[252:255], a[92:95]
ds_read_b64_tr_b16 a[180:181], v10 offset:0
v_accvgpr_read_b32 v20, a40
v_accvgpr_read_b32 v21, a41
v_accvgpr_read_b32 v22, a42
v_mfma_f32_16x16x32_bf16 a[96:99], a[184:187], a[224:227], a[96:99]
ds_read_b64_tr_b16 a[182:183], v10 offset:1024
v_accvgpr_read_b32 v23, a43
v_cvt_pk_bf16_f32 v104, v20, v21
v_cvt_pk_bf16_f32 v105, v22, v23
v_mfma_f32_16x16x32_bf16 a[100:103], a[184:187], a[228:231], a[100:103]
v_xor_b32 v10, 144, v5
v_accvgpr_read_b32 v24, a44
v_accvgpr_read_b32 v25, a45
v_accvgpr_read_b32 v26, a46
v_mfma_f32_16x16x32_bf16 a[104:107], a[184:187], a[232:235], a[104:107]
s_add_u32 s48, s48, s34
v_accvgpr_read_b32 v27, a47
v_cvt_pk_bf16_f32 v108, v24, v25
v_cvt_pk_bf16_f32 v109, v26, v27
v_accvgpr_read_b32 v20, a48
v_mfma_f32_16x16x32_bf16 a[108:111], a[184:187], a[236:239], a[108:111]
s_add_u32 m0, s32, 12288
v_accvgpr_read_b32 v21, a49
v_accvgpr_read_b32 v22, a50
v_accvgpr_read_b32 v23, a51
v_cvt_pk_bf16_f32 v112, v20, v21
v_mfma_f32_16x16x32_bf16 a[112:115], a[184:187], a[240:243], a[112:115]
buffer_load_dwordx4 v1, s[12:15], s48 offen lds
v_cvt_pk_bf16_f32 v113, v22, v23
v_accvgpr_read_b32 v24, a52
v_accvgpr_read_b32 v25, a53
v_mfma_f32_16x16x32_bf16 a[116:119], a[184:187], a[244:247], a[116:119]
v_accvgpr_read_b32 v26, a54
v_accvgpr_read_b32 v27, a55
v_cvt_pk_bf16_f32 v116, v24, v25
v_cvt_pk_bf16_f32 v117, v26, v27
v_mfma_f32_16x16x32_bf16 a[120:123], a[184:187], a[248:251], a[120:123]
v_accvgpr_read_b32 v20, a56
v_accvgpr_read_b32 v21, a57
v_accvgpr_read_b32 v22, a58
v_accvgpr_read_b32 v23, a59
v_mfma_f32_16x16x32_bf16 a[124:127], a[184:187], a[252:255], a[124:127]
ds_read_b64_tr_b16 a[184:185], v11 offset:0
v_cvt_pk_bf16_f32 v120, v20, v21
v_cvt_pk_bf16_f32 v121, v22, v23
v_accvgpr_read_b32 v24, a60
v_mfma_f32_16x16x32_bf16 a[128:131], v[28:31], a[224:227], a[128:131]
ds_read_b64_tr_b16 a[186:187], v11 offset:1024
v_accvgpr_read_b32 v25, a61
v_accvgpr_read_b32 v26, a62
v_accvgpr_read_b32 v27, a63
v_mfma_f32_16x16x32_bf16 a[132:135], v[28:31], a[228:231], a[132:135]
v_xor_b32 v11, 192, v5
v_cvt_pk_bf16_f32 v124, v24, v25
v_cvt_pk_bf16_f32 v125, v26, v27
v_mfma_f32_16x16x32_bf16 a[136:139], v[28:31], a[232:235], a[136:139]
buffer_load_dword v15, v14, s[96:99], s100 offen
v_mfma_f32_16x16x32_bf16 a[140:143], v[28:31], a[236:239], a[140:143]
s_add_u32 s100, s100, 16384
v_mfma_f32_16x16x32_bf16 a[144:147], v[28:31], a[240:243], a[144:147]
v_mfma_f32_16x16x32_bf16 a[148:151], v[28:31], a[244:247], a[148:151]
v_mfma_f32_16x16x32_bf16 a[152:155], v[28:31], a[248:251], a[152:155]
v_mfma_f32_16x16x32_bf16 a[156:159], v[28:31], a[252:255], a[156:159]
s_cmp_lt_u32 s35, s45
s_cbranch_scc1 L_g_tile
s_branch L_g_end
L_g_k17v:
s_waitcnt vmcnt(18) lgkmcnt(0)
s_barrier
v_mfma_f32_16x16x32_bf16 v[160:163], a[160:163], a[224:227], v[160:163]
ds_read_b64_tr_b16 a[192:193], v5 offset:0
v_mfma_f32_16x16x32_bf16 v[164:167], a[160:163], a[228:231], v[164:167]
s_add_u32 s37, s31, 0
v_mfma_f32_16x16x32_bf16 v[168:171], a[160:163], a[232:235], v[168:171]
s_add_u32 m0, s33, 0
ds_read_b64_tr_b16 a[194:195], v5 offset:1024
v_mfma_f32_16x16x32_bf16 v[172:175], a[160:163], a[236:239], v[172:175]
buffer_load_dwordx4 v2, s[20:23], s37 offen  lds
v_mfma_f32_16x16x32_bf16 v[176:179], a[160:163], a[240:243], v[176:179]
ds_read_b64_tr_b16 a[196:197], v6 offset:0
v_cvt_pk_bf16_f32 v32, v160, v161
v_cvt_pk_bf16_f32 v33, v162, v163
v_mfma_f32_16x16x32_bf16 v[180:183], a[160:163], a[244:247], v[180:183]
v_cvt_pk_bf16_f32 v36, v164, v165
v_cvt_pk_bf16_f32 v37, v166, v167
v_mfma_f32_16x16x32_bf16 v[184:187], a[160:163], a[248:251], v[184:187]
ds_read_b64_tr_b16 a[198:199], v6 offset:1024
v_cvt_pk_bf16_f32 v40, v168, v169
v_cvt_pk_bf16_f32 v41, v170, v171
v_mfma_f32_16x16x32_bf16 v[188:191], a[160:163], a[252:255], v[188:191]
ds_read_b128 a[160:163], v3 offset:0
v_cvt_pk_bf16_f32 v44, v172, v173
v_cvt_pk_bf16_f32 v45, v174, v175
v_mfma_f32_16x16x32_bf16 v[192:195], a[164:167], a[224:227], v[192:195]
s_add_u32 s37, s31, 32768
ds_read_b64_tr_b16 a[200:201], v7 offset:0
v_cvt_pk_bf16_f32 v48, v176, v177
v_cvt_pk_bf16_f32 v49, v178, v179
v_mfma_f32_16x16x32_bf16 v[196:199], a[164:167], a[228:231], v[196:199]
s_add_u32 m0, s33, 1024
v_cvt_pk_bf16_f32 v52, v180, v181
v_cvt_pk_bf16_f32 v53, v182, v183
v_mfma_f32_16x16x32_bf16 v[200:203], a[164:167], a[232:235], v[200:203]
buffer_load_dwordx4 v2, s[20:23], s37 offen  lds
v_cvt_pk_bf16_f32 v56, v184, v185
v_cvt_pk_bf16_f32 v57, v186, v187
v_mfma_f32_16x16x32_bf16 v[204:207], a[164:167], a[236:239], v[204:207]
ds_read_b64_tr_b16 a[202:203], v7 offset:1024
v_cvt_pk_bf16_f32 v60, v188, v189
v_cvt_pk_bf16_f32 v61, v190, v191
v_mfma_f32_16x16x32_bf16 v[208:211], a[164:167], a[240:243], v[208:211]
v_cvt_pk_bf16_f32 v34, v192, v193
v_cvt_pk_bf16_f32 v35, v194, v195
v_mfma_f32_16x16x32_bf16 v[212:215], a[164:167], a[244:247], v[212:215]
ds_read_b64_tr_b16 a[204:205], v8 offset:0
v_cvt_pk_bf16_f32 v38, v196, v197
v_cvt_pk_bf16_f32 v39, v198, v199
v_mfma_f32_16x16x32_bf16 v[216:219], a[164:167], a[248:251], v[216:219]
v_cvt_pk_bf16_f32 v42, v200, v201
v_cvt_pk_bf16_f32 v43, v202, v203
v_mfma_f32_16x16x32_bf16 v[220:223], a[164:167], a[252:255], v[220:223]
s_add_u32 s37, s31, 131072
ds_read_b128 a[164:167], v4 offset:1024
v_cvt_pk_bf16_f32 v46, v204, v205
v_cvt_pk_bf16_f32 v47, v206, v207
v_mfma_f32_16x16x32_bf16 v[224:227], a[168:171], a[224:227], v[224:227]
s_add_u32 m0, s33, 4096
ds_read_b64_tr_b16 a[206:207], v8 offset:1024
v_cvt_pk_bf16_f32 v50, v208, v209
v_cvt_pk_bf16_f32 v51, v210, v211
v_mfma_f32_16x16x32_bf16 v[228:231], a[168:171], a[228:231], v[228:231]
buffer_load_dwordx4 v2, s[20:23], s37 offen  lds
v_cvt_pk_bf16_f32 v54, v212, v213
v_cvt_pk_bf16_f32 v55, v214, v215
v_mfma_f32_16x16x32_bf16 v[232:235], a[168:171], a[232:235], v[232:235]
ds_read_b64_tr_b16 a[208:209], v9 offset:0
v_cvt_pk_bf16_f32 v58, v216, v217
v_cvt_pk_bf16_f32 v59, v218, v219
v_mfma_f32_16x16x32_bf16 v[236:239], a[168:171], a[236:239], v[236:239]
v_cvt_pk_bf16_f32 v62, v220, v221
v_cvt_pk_bf16_f32 v63, v222, v223
v_mfma_f32_16x16x32_bf16 v[240:243], a[168:171], a[240:243], v[240:243]
ds_read_b64_tr_b16 a[210:211], v9 offset:1024
v_cvt_pk_bf16_f32 v64, v224, v225
v_cvt_pk_bf16_f32 v65, v226, v227
v_mfma_f32_16x16x32_bf16 v[244:247], a[168:171], a[244:247], v[244:247]
v_cvt_pk_bf16_f32 v68, v228, v229
v_cvt_pk_bf16_f32 v69, v230, v231
v_mfma_f32_16x16x32_bf16 v[248:251], a[168:171], a[248:251], v[248:251]
s_add_u32 s37, s31, 163840
ds_read_b64_tr_b16 a[212:213], v10 offset:0
v_cvt_pk_bf16_f32 v72, v232, v233
v_cvt_pk_bf16_f32 v73, v234, v235
v_mfma_f32_16x16x32_bf16 v[252:255], a[168:171], a[252:255], v[252:255]
s_add_u32 m0, s33, 5120
ds_read_b128 a[168:171], v3 offset:4096
v_cvt_pk_bf16_f32 v76, v236, v237
v_cvt_pk_bf16_f32 v77, v238, v239
v_mfma_f32_16x16x32_bf16 a[0:3], a[172:175], a[224:227], a[0:3]
buffer_load_dwordx4 v2, s[20:23], s37 offen  lds
v_cvt_pk_bf16_f32 v80, v240, v241
v_cvt_pk_bf16_f32 v81, v242, v243
v_mfma_f32_16x16x32_bf16 a[4:7], a[172:175], a[228:231], a[4:7]
s_add_u32 s31, s31, 262144
ds_read_b64_tr_b16 a[214:215], v10 offset:1024
v_cvt_pk_bf16_f32 v84, v244, v245
v_cvt_pk_bf16_f32 v85, v246, v247
v_mfma_f32_16x16x32_bf16 a[8:11], a[172:175], a[232:235], a[8:11]
s_add_u32 s33, s33, 16384
v_cvt_pk_bf16_f32 v88, v248, v249
v_cvt_pk_bf16_f32 v89, v250, v251
v_mfma_f32_16x16x32_bf16 a[12:15], a[172:175], a[236:239], a[12:15]
s_and_b32 s33, s33, 65535
ds_read_b64_tr_b16 a[216:217], v11 offset:0
v_cvt_pk_bf16_f32 v92, v252, v253
v_cvt_pk_bf16_f32 v93, v254, v255
v_mfma_f32_16x16x32_bf16 a[16:19], a[172:175], a[240:243], a[16:19]
v_accvgpr_read_b32 v20, a0
v_accvgpr_read_b32 v21, a1
v_accvgpr_read_b32 v22, a2
v_accvgpr_read_b32 v23, a3
v_mfma_f32_16x16x32_bf16 a[20:23], a[172:175], a[244:247], a[20:23]
s_mov_b32 s48, s30
ds_read_b64_tr_b16 a[218:219], v11 offset:1024
v_cvt_pk_bf16_f32 v66, v20, v21
v_cvt_pk_bf16_f32 v67, v22, v23
v_accvgpr_read_b32 v24, a4
v_mfma_f32_16x16x32_bf16 a[24:27], a[172:175], a[248:251], a[24:27]
s_add_u32 m0, s32, 0
v_accvgpr_read_b32 v25, a5
v_accvgpr_read_b32 v26, a6
v_accvgpr_read_b32 v27, a7
v_cvt_pk_bf16_f32 v70, v24, v25
v_mfma_f32_16x16x32_bf16 a[28:31], a[172:175], a[252:255], a[28:31]
buffer_load_dwordx4 v1, s[12:15], s48 offen lds
ds_read_b128 a[172:175], v4 offset:5120
v_cvt_pk_bf16_f32 v71, v26, v27
v_accvgpr_read_b32 v20, a8
v_mfma_f32_16x16x32_bf16 a[32:35], a[176:179], a[224:227], a[32:35]
ds_read_b64_tr_b16 a[220:221], v12 offset:0
v_mov_b32 v16, 0
v_accvgpr_read_b32 v21, a9
v_accvgpr_read_b32 v22, a10
v_mfma_f32_16x16x32_bf16 a[36:39], a[176:179], a[228:231], a[36:39]
v_mov_b32 v17, 1
v_accvgpr_read_b32 v23, a11
v_cvt_pk_bf16_f32 v74, v20, v21
v_cvt_pk_bf16_f32 v75, v22, v23
v_mfma_f32_16x16x32_bf16 a[40:43], a[176:179], a[232:235], a[40:43]
ds_read_b64_tr_b16 a[222:223], v12 offset:1024
v_accvgpr_read_b32 v24, a12
v_accvgpr_read_b32 v25, a13
v_accvgpr_read_b32 v26, a14
v_mfma_f32_16x16x32_bf16 a[44:47], a[176:179], a[236:239], a[44:47]
s_cmp_eq_u32 s17, 0
s_cselect_b32 s29, s39, 536870912
v_accvgpr_read_b32 v27, a15
v_cvt_pk_bf16_f32 v78, v24, v25
v_mfma_f32_16x16x32_bf16 a[48:51], a[176:179], a[240:243], a[48:51]
s_add_u32 s48, s48, s34
ds_read_b128 a[188:191], v4 offset:13312
v_cvt_pk_bf16_f32 v79, v26, v27
v_accvgpr_read_b32 v20, a16
v_accvgpr_read_b32 v21, a17
v_mfma_f32_16x16x32_bf16 a[52:55], a[176:179], a[244:247], a[52:55]
s_add_u32 m0, s32, 4096
v_accvgpr_read_b32 v22, a18
v_accvgpr_read_b32 v23, a19
v_cvt_pk_bf16_f32 v82, v20, v21
v_cvt_pk_bf16_f32 v83, v22, v23
v_mfma_f32_16x16x32_bf16 a[56:59], a[176:179], a[248:251], a[56:59]
buffer_load_dwordx4 v1, s[12:15], s48 offen lds
v_accvgpr_read_b32 v24, a20
v_accvgpr_read_b32 v25, a21
v_accvgpr_read_b32 v26, a22
v_mfma_f32_16x16x32_bf16 a[60:63], a[176:179], a[252:255], a[60:63]
ds_read_b128 a[176:179], v3 offset:8192
v_add_u32 v5, 16384, v5
v_accvgpr_read_b32 v27, a23
v_cvt_pk_bf16_f32 v86, v24, v25
v_mfma_f32_16x16x32_bf16 a[64:67], a[180:183], a[224:227], a[64:67]
s_mov_b64 exec, 1
buffer_store_dword v17, v16, s[8:11], s29 offen sc1
s_mov_b64 exec, -1
v_cvt_pk_bf16_f32 v87, v26, v27
v_mfma_f32_16x16x32_bf16 a[68:71], a[180:183], a[228:231], a[68:71]
v_and_b32 v5, 65535, v5
v_xor_b32 v6, 16, v5
v_accvgpr_read_b32 v20, a24
v_accvgpr_read_b32 v21, a25
v_mfma_f32_16x16x32_bf16 a[72:75], a[180:183], a[232:235], a[72:75]
v_xor_b32 v7, 64, v5
v_xor_b32 v8, 80, v5
v_accvgpr_read_b32 v22, a26
v_accvgpr_read_b32 v23, a27
v_mfma_f32_16x16x32_bf16 a[76:79], a[180:183], a[236:239], a[76:79]
s_add_u32 s48, s48, s34
v_xor_b32 v9, 128, v5
v_xor_b32 v10, 144, v5
v_cvt_pk_bf16_f32 v90, v20, v21
v_cvt_pk_bf16_f32 v91, v22, v23
v_mfma_f32_16x16x32_bf16 a[80:83], a[180:183], a[240:243], a[80:83]
s_add_u32 m0, s32, 8192
v_xor_b32 v11, 192, v5
v_xor_b32 v12, 208, v5
v_accvgpr_read_b32 v24, a28
v_accvgpr_read_b32 v25, a29
v_mfma_f32_16x16x32_bf16 a[84:87], a[180:183], a[244:247], a[84:87]
buffer_load_dwordx4 v1, s[12:15], s48 offen lds
v_accvgpr_read_b32 v26, a30
v_accvgpr_read_b32 v27, a31
v_cvt_pk_bf16_f32 v94, v24, v25
v_mfma_f32_16x16x32_bf16 a[88:91], a[180:183], a[248:251], a[88:91]
v_cvt_pk_bf16_f32 v95, v26, v27
v_accvgpr_read_b32 v20, a32
v_accvgpr_read_b32 v21, a33
v_accvgpr_read_b32 v22, a34
v_mfma_f32_16x16x32_bf16 a[92:95], a[180:183], a[252:255], a[92:95]
ds_read_b128 a[180:183], v4 offset:9216
v_accvgpr_read_b32 v23, a35
v_cvt_pk_bf16_f32 v96, v20, v21
v_cvt_pk_bf16_f32 v97, v22, v23
v_mfma_f32_16x16x32_bf16 a[96:99], a[184:187], a[224:227], a[96:99]
v_accvgpr_read_b32 v24, a36
v_accvgpr_read_b32 v25, a37
v_accvgpr_read_b32 v26, a38
v_accvgpr_read_b32 v27, a39
v_mfma_f32_16x16x32_bf16 a[100:103], a[184:187], a[228:231], a[100:103]
v_cvt_pk_bf16_f32 v100, v24, v25
v_cvt_pk_bf16_f32 v101, v26, v27
v_accvgpr_read_b32 v20, a40
v_accvgpr_read_b32 v21, a41
v_mfma_f32_16x16x32_bf16 a[104:107], a[184:187], a[232:235], a[104:107]
s_add_u32 s48, s48, s34
v_accvgpr_read_b32 v22, a42
v_accvgpr_read_b32 v23, a43
v_cvt_pk_bf16_f32 v104, v20, v21
v_cvt_pk_bf16_f32 v105, v22, v23
v_mfma_f32_16x16x32_bf16 a[108:111], a[184:187], a[236:239], a[108:111]
s_add_u32 m0, s32, 12288
v_accvgpr_read_b32 v24, a44
v_accvgpr_read_b32 v25, a45
v_accvgpr_read_b32 v26, a46
v_accvgpr_read_b32 v27, a47
v_mfma_f32_16x16x32_bf16 a[112:115], a[184:187], a[240:243], a[112:115]
buffer_load_dwordx4 v1, s[12:15], s48 offen lds
v_cvt_pk_bf16_f32 v108, v24, v25
v_cvt_pk_bf16_f32 v109, v26, v27
v_accvgpr_read_b32 v20, a48
v_mfma_f32_16x16x32_bf16 a[116:119], a[184:187], a[244:247], a[116:119]
v_accvgpr_read_b32 v21, a49
v_accvgpr_read_b32 v22, a50
v_accvgpr_read_b32 v23, a51
v_cvt_pk_bf16_f32 v112, v20, v21
v_mfma_f32_16x16x32_bf16 a[120:123], a[184:187], a[248:251], a[120:123]
v_cvt_pk_bf16_f32 v113, v22, v23
v_accvgpr_read_b32 v24, a52
v_accvgpr_read_b32 v25, a53
v_accvgpr_read_b32 v26, a54
v_mfma_f32_16x16x32_bf16 a[124:127], a[184:187], a[252:255], a[124:127]
ds_read_b128 a[184:187], v3 offset:12288
v_accvgpr_read_b32 v27, a55
v_cvt_pk_bf16_f32 v116, v24, v25
v_cvt_pk_bf16_f32 v117, v26, v27
v_mfma_f32_16x16x32_bf16 a[128:131], v[28:31], a[224:227], a[128:131]
v_accvgpr_read_b32 v20, a56
v_accvgpr_read_b32 v21, a57
v_accvgpr_read_b32 v22, a58
v_accvgpr_read_b32 v23, a59
v_mfma_f32_16x16x32_bf16 a[132:135], v[28:31], a[228:231], a[132:135]
v_cvt_pk_bf16_f32 v120, v20, v21
v_cvt_pk_bf16_f32 v121, v22, v23
v_accvgpr_read_b32 v24, a60
v_accvgpr_read_b32 v25, a61
v_mfma_f32_16x16x32_bf16 a[136:139], v[28:31], a[232:235], a[136:139]
buffer_load_dword v15, v14, s[96:99], s100 offen
v_accvgpr_read_b32 v26, a62
v_accvgpr_read_b32 v27, a63
v_cvt_pk_bf16_f32 v124, v24, v25
v_mfma_f32_16x16x32_bf16 a[140:143], v[28:31], a[236:239], a[140:143]
s_add_u32 s100, s100, 16384
v_cvt_pk_bf16_f32 v125, v26, v27
v_mfma_f32_16x16x32_bf16 a[144:147], v[28:31], a[240:243], a[144:147]
v_mfma_f32_16x16x32_bf16 a[148:151], v[28:31], a[244:247], a[148:151]
v_mfma_f32_16x16x32_bf16 a[152:155], v[28:31], a[248:251], a[152:155]
v_mfma_f32_16x16x32_bf16 a[156:159], v[28:31], a[252:255], a[156:159]
s_cmp_lt_u32 s35, s45
s_cbranch_scc1 L_g_tile
s_branch L_g_end
.p2align 3
L_g_v:
s_waitcnt vmcnt(16) lgkmcnt(0)
s_barrier
v_mfma_f32_16x16x32_bf16 v[160:163], a[160:163], a[192:195], 0
ds_read_b64_tr_b16 a[224:225], v5 offset:0
v_accvgpr_read_b32 v20, a64
v_accvgpr_read_b32 v21, a65
v_accvgpr_read_b32 v22, a66
v_mfma_f32_16x16x32_bf16 v[164:167], a[160:163], a[196:199], 0
v_accvgpr_read_b32 v23, a67
v_cvt_pk_bf16_f32 v98, v20, v21
v_cvt_pk_bf16_f32 v99, v22, v23
v_accvgpr_read_b32 v24, a68
v_mfma_f32_16x16x32_bf16 v[168:171], a[160:163], a[200:203], 0
ds_read_b64_tr_b16 a[226:227], v5 offset:1024
v_accvgpr_read_b32 v25, a69
v_accvgpr_read_b32 v26, a70
v_accvgpr_read_b32 v27, a71
v_mfma_f32_16x16x32_bf16 v[172:175], a[160:163], a[204:207], 0
s_add_u32 s37, s31, 0
v_cvt_pk_bf16_f32 v102, v24, v25
v_cvt_pk_bf16_f32 v103, v26, v27
v_accvgpr_read_b32 v20, a72
v_accvgpr_read_b32 v21, a73
v_mfma_f32_16x16x32_bf16 v[176:179], a[160:163], a[208:211], 0
s_add_u32 m0, s33, 0
ds_read_b64_tr_b16 a[228:229], v6 offset:0
v_accvgpr_read_b32 v22, a74
v_accvgpr_read_b32 v23, a75
v_cvt_pk_bf16_f32 v106, v20, v21
v_mfma_f32_16x16x32_bf16 v[180:183], a[160:163], a[212:215], 0
buffer_load_dwordx4 v2, s[20:23], s37 offen  lds
v_cvt_pk_bf16_f32 v107, v22, v23
v_accvgpr_read_b32 v24, a76
v_accvgpr_read_b32 v25, a77
v_mfma_f32_16x16x32_bf16 v[184:187], a[160:163], a[216:219], 0
ds_read_b64_tr_b16 a[230:231], v6 offset:1024
v_accvgpr_read_b32 v26, a78
v_accvgpr_read_b32 v27, a79
v_cvt_pk_bf16_f32 v110, v24, v25
v_mfma_f32_16x16x32_bf16 v[188:191], a[160:163], a[220:223], 0
ds_read_b128 a[160:163], v4 offset:0
v_cvt_pk_bf16_f32 v111, v26, v27
v_accvgpr_read_b32 v20, a80
v_accvgpr_read_b32 v21, a81
v_mfma_f32_16x16x32_bf16 v[192:195], a[164:167], a[192:195], 0
ds_read_b64_tr_b16 a[232:233], v7 offset:0
v_accvgpr_read_b32 v22, a82
v_accvgpr_read_b32 v23, a83
v_cvt_pk_bf16_f32 v114, v20, v21
v_mfma_f32_16x16x32_bf16 v[196:199], a[164:167], a[196:199], 0
v_cvt_pk_bf16_f32 v115, v22, v23
v_accvgpr_read_b32 v24, a84
v_accvgpr_read_b32 v25, a85
v_accvgpr_read_b32 v26, a86
v_mfma_f32_16x16x32_bf16 v[200:203], a[164:167], a[200:203], 0
s_add_u32 s37, s31, 32768
ds_read_b64_tr_b16 a[234:235], v7 offset:1024
v_accvgpr_read_b32 v27, a87
v_cvt_pk_bf16_f32 v118, v24, v25
v_cvt_pk_bf16_f32 v119, v26, v27
v_mfma_f32_16x16x32_bf16 v[204:207], a[164:167], a[204:207], 0
s_add_u32 m0, s33, 1024
v_accvgpr_read_b32 v20, a88
v_accvgpr_read_b32 v21, a89
v_accvgpr_read_b32 v22, a90
v_accvgpr_read_b32 v23, a91
v_mfma_f32_16x16x32_bf16 v[208:211], a[164:167], a[208:211], 0
buffer_load_dwordx4 v2, s[20:23], s37 offen  lds
v_cvt_pk_bf16_f32 v122, v20, v21
v_cvt_pk_bf16_f32 v123, v22, v23
v_accvgpr_read_b32 v24, a92
v_mfma_f32_16x16x32_bf16 v[212:215], a[164:167], a[212:215], 0
ds_read_b64_tr_b16 a[236:237], v8 offset:0
v_accvgpr_read_b32 v25, a93
v_accvgpr_read_b32 v26, a94
v_accvgpr_read_b32 v27, a95
v_mfma_f32_16x16x32_bf16 v[216:219], a[164:167], a[216:219], 0
v_cvt_pk_bf16_f32 v126, v24, v25
v_cvt_pk_bf16_f32 v127, v26, v27
v_accvgpr_read_b32 v20, a96
v_accvgpr_read_b32 v21, a97
v_mfma_f32_16x16x32_bf16 v[220:223], a[164:167], a[220:223], 0
ds_read_b128 a[164:167], v3 offset:1024
v_accvgpr_read_b32 v22, a98
v_accvgpr_read_b32 v23, a99
v_cvt_pk_bf16_f32 v128, v20, v21
v_mfma_f32_16x16x32_bf16 v[224:227], a[168:171], a[192:195], 0
ds_read_b64_tr_b16 a[238:239], v8 offset:1024
v_cvt_pk_bf16_f32 v129, v22, v23
v_accvgpr_read_b32 v24, a100
v_accvgpr_read_b32 v25, a101
v_mfma_f32_16x16x32_bf16 v[228:231], a[168:171], a[196:199], 0
s_add_u32 s37, s31, 131072
v_accvgpr_read_b32 v26, a102
v_accvgpr_read_b32 v27, a103
v_cvt_pk_bf16_f32 v132, v24, v25
v_cvt_pk_bf16_f32 v133, v26, v27
v_mfma_f32_16x16x32_bf16 v[232:235], a[168:171], a[200:203], 0
s_add_u32 m0, s33, 4096
ds_read_b64_tr_b16 a[240:241], v9 offset:0
v_accvgpr_read_b32 v20, a104
v_accvgpr_read_b32 v21, a105
v_accvgpr_read_b32 v22, a106
v_mfma_f32_16x16x32_bf16 v[236:239], a[168:171], a[204:207], 0
buffer_load_dwordx4 v2, s[20:23], s37 offen  lds
v_accvgpr_read_b32 v23, a107
v_cvt_pk_bf16_f32 v136, v20, v21
v_cvt_pk_bf16_f32 v137, v22, v23
v_mfma_f32_16x16x32_bf16 v[240:243], a[168:171], a[208:211], 0
ds_read_b64_tr_b16 a[242:243], v9 offset:1024
v_accvgpr_read_b32 v24, a108
v_accvgpr_read_b32 v25, a109
v_accvgpr_read_b32 v26, a110
v_mfma_f32_16x16x32_bf16 v[244:247], a[168:171], a[212:215], 0
v_accvgpr_read_b32 v27, a111
v_cvt_pk_bf16_f32 v140, v24, v25
v_cvt_pk_bf16_f32 v141, v26, v27
v_accvgpr_read_b32 v20, a112
v_mfma_f32_16x16x32_bf16 v[248:251], a[168:171], a[216:219], 0
ds_read_b64_tr_b16 a[244:245], v10 offset:0
v_accvgpr_read_b32 v21, a113
v_accvgpr_read_b32 v22, a114
v_accvgpr_read_b32 v23, a115
v_mfma_f32_16x16x32_bf16 v[252:255], a[168:171], a[220:223], 0
ds_read_b128 a[168:171], v4 offset:4096
v_cvt_pk_bf16_f32 v144, v20, v21
v_cvt_pk_bf16_f32 v145, v22, v23
v_accvgpr_read_b32 v24, a116
v_mfma_f32_16x16x32_bf16 a[0:3], a[172:175], a[192:195], 0
s_add_u32 s37, s31, 163840
ds_read_b64_tr_b16 a[246:247], v10 offset:1024
v_accvgpr_read_b32 v25, a117
v_accvgpr_read_b32 v26, a118
v_accvgpr_read_b32 v27, a119
v_mfma_f32_16x16x32_bf16 a[4:7], a[172:175], a[196:199], 0
s_add_u32 m0, s33, 5120
v_cvt_pk_bf16_f32 v148, v24, v25
v_cvt_pk_bf16_f32 v149, v26, v27
v_accvgpr_read_b32 v20, a120
v_accvgpr_read_b32 v21, a121
v_mfma_f32_16x16x32_bf16 a[8:11], a[172:175], a[200:203], 0
buffer_load_dwordx4 v2, s[20:23], s37 offen  lds
v_accvgpr_read_b32 v22, a122
v_accvgpr_read_b32 v23, a123
v_cvt_pk_bf16_f32 v152, v20, v21
v_mfma_f32_16x16x32_bf16 a[12:15], a[172:175], a[204:207], 0
s_add_u32 s31, s31, 262144
ds_read_b64_tr_b16 a[248:249], v11 offset:0
v_cvt_pk_bf16_f32 v153, v22, v23
v_accvgpr_read_b32 v24, a124
v_accvgpr_read_b32 v25, a125
v_mfma_f32_16x16x32_bf16 a[16:19], a[172:175], a[208:211], 0
s_add_u32 s33, s33, 16384
v_accvgpr_read_b32 v26, a126
v_accvgpr_read_b32 v27, a127
v_cvt_pk_bf16_f32 v156, v24, v25
v_cvt_pk_bf16_f32 v157, v26, v27
v_mfma_f32_16x16x32_bf16 a[20:23], a[172:175], a[212:215], 0
s_and_b32 s33, s33, 65535
ds_read_b64_tr_b16 a[250:251], v11 offset:1024
v_accvgpr_read_b32 v20, a128
v_accvgpr_read_b32 v21, a129
v_accvgpr_read_b32 v22, a130
v_mfma_f32_16x16x32_bf16 a[24:27], a[172:175], a[216:219], 0
v_accvgpr_read_b32 v23, a131
v_cvt_pk_bf16_f32 v130, v20, v21
v_cvt_pk_bf16_f32 v131, v22, v23
v_accvgpr_read_b32 v24, a132
v_mfma_f32_16x16x32_bf16 a[28:31], a[172:175], a[220:223], 0
s_add_u32 s48, s48, s34
ds_read_b128 a[172:175], v3 offset:5120
v_accvgpr_read_b32 v25, a133
v_accvgpr_read_b32 v26, a134
v_accvgpr_read_b32 v27, a135
v_mfma_f32_16x16x32_bf16 a[32:35], a[176:179], a[192:195], 0
s_add_u32 m0, s32, 16384
ds_read_b64_tr_b16 a[252:253], v12 offset:0
v_cvt_pk_bf16_f32 v134, v24, v25
v_cvt_pk_bf16_f32 v135, v26, v27
v_accvgpr_read_b32 v20, a136
v_mfma_f32_16x16x32_bf16 a[36:39], a[176:179], a[196:199], 0
buffer_load_dwordx4 v1, s[12:15], s48 offen lds
v_accvgpr_read_b32 v21, a137
v_accvgpr_read_b32 v22, a138
v_accvgpr_read_b32 v23, a139
v_mfma_f32_16x16x32_bf16 a[40:43], a[176:179], a[200:203], 0
ds_read_b64_tr_b16 a[254:255], v12 offset:1024
v_cvt_pk_bf16_f32 v138, v20, v21
v_cvt_pk_bf16_f32 v139, v22, v23
v_accvgpr_read_b32 v24, a140
v_mfma_f32_16x16x32_bf16 a[44:47], a[176:179], a[204:207], 0
v_accvgpr_read_b32 v25, a141
v_accvgpr_read_b32 v26, a142
v_accvgpr_read_b32 v27, a143
v_cvt_pk_bf16_f32 v142, v24, v25
v_mfma_f32_16x16x32_bf16 a[48:51], a[176:179], a[208:211], 0
ds_read_b128 v[28:31], v3 offset:13312
v_cvt_pk_bf16_f32 v143, v26, v27
v_accvgpr_read_b32 v20, a144
v_accvgpr_read_b32 v21, a145
s_mov_b32 s38, s62
s_mov_b32 s39, s63
v_mfma_f32_16x16x32_bf16 a[52:55], a[176:179], a[212:215], 0
v_accvgpr_read_b32 v22, a146
v_accvgpr_read_b32 v23, a147
v_cvt_pk_bf16_f32 v146, v20, v21
v_cvt_pk_bf16_f32 v147, v22, v23
s_mov_b32 s49, s50
s_mov_b32 s62, s42
v_mfma_f32_16x16x32_bf16 a[56:59], a[176:179], a[216:219], 0
s_add_u32 s48, s48, s34
v_accvgpr_read_b32 v24, a148
v_accvgpr_read_b32 v25, a149
v_accvgpr_read_b32 v26, a150
v_accvgpr_read_b32 v27, a151
s_mov_b32 s63, s43
s_mov_b32 s50, s51
v_mfma_f32_16x16x32_bf16 a[60:63], a[176:179], a[220:223], 0
s_add_u32 m0, s32, 20480
ds_read_b128 a[176:179], v4 offset:8192
v_add_u32 v5, 16384, v5
v_cvt_pk_bf16_f32 v150, v24, v25
v_cvt_pk_bf16_f32 v151, v26, v27
s_mov_b32 s36, s40
s_add_u32 s35, s35, 1
v_mfma_f32_16x16x32_bf16 a[64:67], a[180:183], a[192:195], 0
buffer_load_dwordx4 v1, s[12:15], s48 offen lds
v_and_b32 v5, 65535, v5
v_accvgpr_read_b32 v20, a152
v_accvgpr_read_b32 v21, a153
v_bfe_u32 v16, v0, 3, 3
v_lshlrev_b32 v16, 4, v16
v_mfma_f32_16x16x32_bf16 a[68:71], a[180:183], a[196:199], 0
v_xor_b32 v6, 16, v5
v_xor_b32 v7, 64, v5
v_accvgpr_read_b32 v22, a154
v_accvgpr_read_b32 v23, a155
v_and_or_b32 v16, v0, 7, v16
v_bfe_u32 v17, v0, 4, 2
v_mfma_f32_16x16x32_bf16 a[72:75], a[180:183], a[200:203], 0
v_xor_b32 v8, 80, v5
v_xor_b32 v9, 128, v5
v_cvt_pk_bf16_f32 v154, v20, v21
v_cvt_pk_bf16_f32 v155, v22, v23
v_lshlrev_b32 v17, 5, v17
v_bfe_u32 v18, v0, 1, 3
v_mfma_f32_16x16x32_bf16 a[76:79], a[180:183], a[204:207], 0
v_xor_b32 v10, 144, v5
v_xor_b32 v11, 192, v5
v_accvgpr_read_b32 v24, a156
v_accvgpr_read_b32 v25, a157
v_or_b32 v17, v17, v18
v_and_b32 v18, 1, v0
v_mfma_f32_16x16x32_bf16 a[80:83], a[180:183], a[208:211], 0
v_xor_b32 v12, 208, v5
v_accvgpr_read_b32 v26, a158
v_accvgpr_read_b32 v27, a159
v_cvt_pk_bf16_f32 v158, v24, v25
v_lshl_or_b32 v17, v18, 4, v17
v_mfma_f32_16x16x32_bf16 a[84:87], a[180:183], a[212:215], 0
s_add_u32 s48, s48, s34
v_cvt_pk_bf16_f32 v159, v26, v27
s_bitcmp1_b32 s49, 1
s_cselect_b64 vcc, -1, 0
s_movk_i32 s44, 0x80
v_cndmask_b32 v16, v16, v17, vcc
v_lshlrev_b32 v13, 4, v16
v_mfma_f32_16x16x32_bf16 a[88:91], a[180:183], a[216:219], 0
s_add_u32 m0, s32, 24576
s_movk_i32 s92, 0x800
s_bitcmp1_b32 s49, 0
s_cselect_b32 s92, 0x4000, s92
s_xor_b32 s93, s92, 0x4800
s_sub_u32 s93, s93, s44
v_mfma_f32_16x16x32_bf16 a[92:95], a[180:183], a[220:223], 0
buffer_load_dwordx4 v1, s[12:15], s48 offen lds
ds_read_b128 a[180:183], v3 offset:9216
v_mfma_f32_16x16x32_bf16 a[96:99], a[184:187], a[192:195], 0
v_mfma_f32_16x16x32_bf16 a[100:103], a[184:187], a[196:199], 0
v_mfma_f32_16x16x32_bf16 a[104:107], a[184:187], a[200:203], 0
v_mfma_f32_16x16x32_bf16 a[108:111], a[184:187], a[204:207], 0
v_mfma_f32_16x16x32_bf16 a[112:115], a[184:187], a[208:211], 0
s_add_u32 s48, s48, s34
v_mfma_f32_16x16x32_bf16 a[116:119], a[184:187], a[212:215], 0
s_add_u32 m0, s32, 28672
v_mfma_f32_16x16x32_bf16 a[120:123], a[184:187], a[216:219], 0
buffer_load_dwordx4 v1, s[12:15], s48 offen lds
v_mfma_f32_16x16x32_bf16 a[124:127], a[184:187], a[220:223], 0
s_add_u32 s30, s30, 128
ds_read_b128 a[184:187], v4 offset:12288
v_mfma_f32_16x16x32_bf16 a[128:131], a[188:191], a[192:195], 0
s_add_u32 s32, s32, 32768
v_add_u32 v3, 32768, v3
v_mfma_f32_16x16x32_bf16 a[132:135], a[188:191], a[196:199], 0
s_sub_u32 s48, s32, 98304
v_subrev_u32 v19, 98304, v3
v_mfma_f32_16x16x32_bf16 a[136:139], a[188:191], a[200:203], 0
s_cmp_ge_u32 s32, 163840
s_cselect_b32 s32, s48, s32
buffer_load_dword v15, v14, s[96:99], s100 offen
v_mfma_f32_16x16x32_bf16 a[140:143], a[188:191], a[204:207], 0
s_add_u32 s100, s100, 16384
v_cmp_le_u32 vcc, 163840, v3
v_mfma_f32_16x16x32_bf16 a[144:147], a[188:191], a[208:211], 0
s_nop 0
v_cndmask_b32 v3, v3, v19, vcc
v_mfma_f32_16x16x32_bf16 a[148:151], a[188:191], a[212:215], 0
v_xor_b32 v4, 64, v3
v_mfma_f32_16x16x32_bf16 a[152:155], a[188:191], a[216:219], 0
v_mfma_f32_16x16x32_bf16 a[156:159], a[188:191], a[220:223], 0
s_waitcnt vmcnt(17) lgkmcnt(0)
s_barrier
v_mfma_f32_16x16x32_bf16 v[160:163], a[160:163], a[224:227], v[160:163]
ds_read_b64_tr_b16 a[192:193], v5 offset:0
v_mfma_f32_16x16x32_bf16 v[164:167], a[160:163], a[228:231], v[164:167]
v_mfma_f32_16x16x32_bf16 v[168:171], a[160:163], a[232:235], v[168:171]
ds_read_b64_tr_b16 a[194:195], v5 offset:1024
v_mfma_f32_16x16x32_bf16 v[172:175], a[160:163], a[236:239], v[172:175]
s_add_u32 s37, s31, 0
v_mfma_f32_16x16x32_bf16 v[176:179], a[160:163], a[240:243], v[176:179]
s_add_u32 m0, s33, 0
ds_read_b64_tr_b16 a[196:197], v6 offset:0
v_mfma_f32_16x16x32_bf16 v[180:183], a[160:163], a[244:247], v[180:183]
buffer_load_dwordx4 v2, s[20:23], s37 offen  lds
v_mfma_f32_16x16x32_bf16 v[184:187], a[160:163], a[248:251], v[184:187]
ds_read_b64_tr_b16 a[198:199], v6 offset:1024
v_mfma_f32_16x16x32_bf16 v[188:191], a[160:163], a[252:255], v[188:191]
ds_read_b128 a[160:163], v3 offset:0
v_mfma_f32_16x16x32_bf16 v[192:195], a[164:167], a[224:227], v[192:195]
ds_read_b64_tr_b16 a[200:201], v7 offset:0
v_mfma_f32_16x16x32_bf16 v[196:199], a[164:167], a[228:231], v[196:199]
v_mfma_f32_16x16x32_bf16 v[200:203], a[164:167], a[232:235], v[200:203]
s_add_u32 s37, s31, 32768
ds_read_b64_tr_b16 a[202:203], v7 offset:1024
v_mfma_f32_16x16x32_bf16 v[204:207], a[164:167], a[236:239], v[204:207]
s_add_u32 m0, s33, 1024
v_mfma_f32_16x16x32_bf16 v[208:211], a[164:167], a[240:243], v[208:211]
buffer_load_dwordx4 v2, s[20:23], s37 offen  lds
v_mfma_f32_16x16x32_bf16 v[212:215], a[164:167], a[244:247], v[212:215]
ds_read_b64_tr_b16 a[204:205], v8 offset:0
v_mfma_f32_16x16x32_bf16 v[216:219], a[164:167], a[248:251], v[216:219]
s_mov_b32 s60, s38
v_mfma_f32_16x16x32_bf16 v[220:223], a[164:167], a[252:255], v[220:223]
s_mov_b32 s29, s38
ds_read_b128 a[164:167], v4 offset:1024
v_mfma_f32_16x16x32_bf16 v[224:227], a[168:171], a[224:227], v[224:227]
buffer_store_dwordx4 v[32:35], v13, s[8:11], s29 offen sc1
v_mfma_f32_16x16x32_bf16 v[228:231], a[168:171], a[228:231], v[228:231]
s_add_u32 s37, s31, 131072
ds_read_b64_tr_b16 a[206:207], v8 offset:1024
v_mfma_f32_16x16x32_bf16 v[232:235], a[168:171], a[232:235], v[232:235]
s_add_u32 m0, s33, 4096
v_mfma_f32_16x16x32_bf16 v[236:239], a[168:171], a[236:239], v[236:239]
buffer_load_dwordx4 v2, s[20:23], s37 offen  lds
v_mfma_f32_16x16x32_bf16 v[240:243], a[168:171], a[240:243], v[240:243]
ds_read_b64_tr_b16 a[208:209], v9 offset:0
v_mfma_f32_16x16x32_bf16 v[244:247], a[168:171], a[244:247], v[244:247]
v_mfma_f32_16x16x32_bf16 v[248:251], a[168:171], a[248:251], v[248:251]
ds_read_b64_tr_b16 a[210:211], v9 offset:1024
v_mfma_f32_16x16x32_bf16 v[252:255], a[168:171], a[252:255], v[252:255]
ds_read_b128 a[168:171], v3 offset:4096
v_mfma_f32_16x16x32_bf16 a[0:3], a[172:175], a[224:227], a[0:3]
s_add_u32 s37, s31, 163840
ds_read_b64_tr_b16 a[212:213], v10 offset:0
v_mfma_f32_16x16x32_bf16 a[4:7], a[172:175], a[228:231], a[4:7]
s_add_u32 m0, s33, 5120
v_mfma_f32_16x16x32_bf16 a[8:11], a[172:175], a[232:235], a[8:11]
buffer_load_dwordx4 v2, s[20:23], s37 offen  lds
v_mfma_f32_16x16x32_bf16 a[12:15], a[172:175], a[236:239], a[12:15]
s_add_u32 s31, s31, 262144
ds_read_b64_tr_b16 a[214:215], v10 offset:1024
v_mfma_f32_16x16x32_bf16 a[16:19], a[172:175], a[240:243], a[16:19]
s_add_u32 s33, s33, 16384
v_mfma_f32_16x16x32_bf16 a[20:23], a[172:175], a[244:247], a[20:23]
s_and_b32 s33, s33, 65535
ds_read_b64_tr_b16 a[216:217], v11 offset:0
v_mfma_f32_16x16x32_bf16 a[24:27], a[172:175], a[248:251], a[24:27]
v_mfma_f32_16x16x32_bf16 a[28:31], a[172:175], a[252:255], a[28:31]
s_mov_b32 s48, s30
ds_read_b128 a[172:175], v4 offset:5120
v_mfma_f32_16x16x32_bf16 a[32:35], a[176:179], a[224:227], a[32:35]
s_add_u32 m0, s32, 0
ds_read_b64_tr_b16 a[218:219], v11 offset:1024
v_mfma_f32_16x16x32_bf16 a[36:39], a[176:179], a[228:231], a[36:39]
buffer_load_dwordx4 v1, s[12:15], s48 offen lds
v_mfma_f32_16x16x32_bf16 a[40:43], a[176:179], a[232:235], a[40:43]
ds_read_b64_tr_b16 a[220:221], v12 offset:0
v_mfma_f32_16x16x32_bf16 a[44:47], a[176:179], a[236:239], a[44:47]
s_add_u32 s29, s29, s44
v_mfma_f32_16x16x32_bf16 a[48:51], a[176:179], a[240:243], a[48:51]
ds_read_b64_tr_b16 a[222:223], v12 offset:1024
v_mfma_f32_16x16x32_bf16 a[52:55], a[176:179], a[244:247], a[52:55]
buffer_store_dwordx4 v[36:39], v13, s[8:11], s29 offen sc1
v_mfma_f32_16x16x32_bf16 a[56:59], a[176:179], a[248:251], a[56:59]
s_add_u32 s48, s48, s34
ds_read_b128 a[188:191], v4 offset:13312
v_mfma_f32_16x16x32_bf16 a[60:63], a[176:179], a[252:255], a[60:63]
s_add_u32 m0, s32, 4096
ds_read_b128 a[176:179], v3 offset:8192
v_mfma_f32_16x16x32_bf16 a[64:67], a[180:183], a[224:227], a[64:67]
buffer_load_dwordx4 v1, s[12:15], s48 offen lds
v_mfma_f32_16x16x32_bf16 a[68:71], a[180:183], a[228:231], a[68:71]
v_add_u32 v5, 16384, v5
v_and_b32 v5, 65535, v5
v_mfma_f32_16x16x32_bf16 a[72:75], a[180:183], a[232:235], a[72:75]
v_xor_b32 v6, 16, v5
v_xor_b32 v7, 64, v5
v_mfma_f32_16x16x32_bf16 a[76:79], a[180:183], a[236:239], a[76:79]
v_xor_b32 v8, 80, v5
v_xor_b32 v9, 128, v5
v_mfma_f32_16x16x32_bf16 a[80:83], a[180:183], a[240:243], a[80:83]
v_xor_b32 v10, 144, v5
v_xor_b32 v11, 192, v5
v_mfma_f32_16x16x32_bf16 a[84:87], a[180:183], a[244:247], a[84:87]
s_add_u32 s48, s48, s34
v_xor_b32 v12, 208, v5
v_mfma_f32_16x16x32_bf16 a[88:91], a[180:183], a[248:251], a[88:91]
s_add_u32 m0, s32, 8192
v_mfma_f32_16x16x32_bf16 a[92:95], a[180:183], a[252:255], a[92:95]
buffer_load_dwordx4 v1, s[12:15], s48 offen lds
ds_read_b128 a[180:183], v4 offset:9216
v_mfma_f32_16x16x32_bf16 a[96:99], a[184:187], a[224:227], a[96:99]
v_mfma_f32_16x16x32_bf16 a[100:103], a[184:187], a[228:231], a[100:103]
v_mfma_f32_16x16x32_bf16 a[104:107], a[184:187], a[232:235], a[104:107]
v_mfma_f32_16x16x32_bf16 a[108:111], a[184:187], a[236:239], a[108:111]
v_mfma_f32_16x16x32_bf16 a[112:115], a[184:187], a[240:243], a[112:115]
s_add_u32 s48, s48, s34
v_mfma_f32_16x16x32_bf16 a[116:119], a[184:187], a[244:247], a[116:119]
s_add_u32 m0, s32, 12288
v_mfma_f32_16x16x32_bf16 a[120:123], a[184:187], a[248:251], a[120:123]
buffer_load_dwordx4 v1, s[12:15], s48 offen lds
v_mfma_f32_16x16x32_bf16 a[124:127], a[184:187], a[252:255], a[124:127]
ds_read_b128 a[184:187], v3 offset:12288
v_mfma_f32_16x16x32_bf16 a[128:131], v[28:31], a[224:227], a[128:131]
s_add_u32 s29, s29, s93
v_mfma_f32_16x16x32_bf16 a[132:135], v[28:31], a[228:231], a[132:135]
v_mfma_f32_16x16x32_bf16 a[136:139], v[28:31], a[232:235], a[136:139]
buffer_store_dwordx4 v[40:43], v13, s[8:11], s29 offen sc1
buffer_load_dword v15, v14, s[96:99], s100 offen
v_mfma_f32_16x16x32_bf16 a[140:143], v[28:31], a[236:239], a[140:143]
s_add_u32 s100, s100, 16384
v_mfma_f32_16x16x32_bf16 a[144:147], v[28:31], a[240:243], a[144:147]
v_mfma_f32_16x16x32_bf16 a[148:151], v[28:31], a[244:247], a[148:151]
v_mfma_f32_16x16x32_bf16 a[152:155], v[28:31], a[248:251], a[152:155]
v_mfma_f32_16x16x32_bf16 a[156:159], v[28:31], a[252:255], a[156:159]
s_waitcnt vmcnt(21) lgkmcnt(0)
s_barrier
v_mfma_f32_16x16x32_bf16 v[160:163], a[160:163], a[192:195], v[160:163]
ds_read_b64_tr_b16 a[224:225], v5 offset:0
v_mfma_f32_16x16x32_bf16 v[164:167], a[160:163], a[196:199], v[164:167]
v_mfma_f32_16x16x32_bf16 v[168:171], a[160:163], a[200:203], v[168:171]
ds_read_b64_tr_b16 a[226:227], v5 offset:1024
v_mfma_f32_16x16x32_bf16 v[172:175], a[160:163], a[204:207], v[172:175]
s_add_u32 s37, s31, 0
v_mfma_f32_16x16x32_bf16 v[176:179], a[160:163], a[208:211], v[176:179]
s_add_u32 m0, s33, 0
ds_read_b64_tr_b16 a[228:229], v6 offset:0
v_mfma_f32_16x16x32_bf16 v[180:183], a[160:163], a[212:215], v[180:183]
buffer_load_dwordx4 v2, s[20:23], s37 offen  lds
v_mfma_f32_16x16x32_bf16 v[184:187], a[160:163], a[216:219], v[184:187]
ds_read_b64_tr_b16 a[230:231], v6 offset:1024
v_mfma_f32_16x16x32_bf16 v[188:191], a[160:163], a[220:223], v[188:191]
ds_read_b128 a[160:163], v4 offset:0
v_mfma_f32_16x16x32_bf16 v[192:195], a[164:167], a[192:195], v[192:195]
ds_read_b64_tr_b16 a[232:233], v7 offset:0
v_mfma_f32_16x16x32_bf16 v[196:199], a[164:167], a[196:199], v[196:199]
v_mfma_f32_16x16x32_bf16 v[200:203], a[164:167], a[200:203], v[200:203]
s_add_u32 s37, s31, 32768
ds_read_b64_tr_b16 a[234:235], v7 offset:1024
v_mfma_f32_16x16x32_bf16 v[204:207], a[164:167], a[204:207], v[204:207]
s_add_u32 m0, s33, 1024
v_mfma_f32_16x16x32_bf16 v[208:211], a[164:167], a[208:211], v[208:211]
buffer_load_dwordx4 v2, s[20:23], s37 offen  lds
v_mfma_f32_16x16x32_bf16 v[212:215], a[164:167], a[212:215], v[212:215]
ds_read_b64_tr_b16 a[236:237], v8 offset:0
v_mfma_f32_16x16x32_bf16 v[216:219], a[164:167], a[216:219], v[216:219]
s_add_u32 s29, s29, s44
v_mfma_f32_16x16x32_bf16 v[220:223], a[164:167], a[220:223], v[220:223]
ds_read_b128 a[164:167], v3 offset:1024
v_mfma_f32_16x16x32_bf16 v[224:227], a[168:171], a[192:195], v[224:227]
buffer_store_dwordx4 v[44:47], v13, s[8:11], s29 offen sc1
v_mfma_f32_16x16x32_bf16 v[228:231], a[168:171], a[196:199], v[228:231]
s_add_u32 s37, s31, 131072
ds_read_b64_tr_b16 a[238:239], v8 offset:1024
v_mfma_f32_16x16x32_bf16 v[232:235], a[168:171], a[200:203], v[232:235]
s_add_u32 m0, s33, 4096
v_mfma_f32_16x16x32_bf16 v[236:239], a[168:171], a[204:207], v[236:239]
buffer_load_dwordx4 v2, s[20:23], s37 offen  lds
v_mfma_f32_16x16x32_bf16 v[240:243], a[168:171], a[208:211], v[240:243]
ds_read_b64_tr_b16 a[240:241], v9 offset:0
v_mfma_f32_16x16x32_bf16 v[244:247], a[168:171], a[212:215], v[244:247]
v_mfma_f32_16x16x32_bf16 v[248:251], a[168:171], a[216:219], v[248:251]
ds_read_b64_tr_b16 a[242:243], v9 offset:1024
v_mfma_f32_16x16x32_bf16 v[252:255], a[168:171], a[220:223], v[252:255]
ds_read_b128 a[168:171], v4 offset:4096
v_mfma_f32_16x16x32_bf16 a[0:3], a[172:175], a[192:195], a[0:3]
s_add_u32 s37, s31, 163840
ds_read_b64_tr_b16 a[244:245], v10 offset:0
v_mfma_f32_16x16x32_bf16 a[4:7], a[172:175], a[196:199], a[4:7]
s_add_u32 m0, s33, 5120
v_mfma_f32_16x16x32_bf16 a[8:11], a[172:175], a[200:203], a[8:11]
buffer_load_dwordx4 v2, s[20:23], s37 offen  lds
v_mfma_f32_16x16x32_bf16 a[12:15], a[172:175], a[204:207], a[12:15]
s_add_u32 s31, s31, 262144
ds_read_b64_tr_b16 a[246:247], v10 offset:1024
v_mfma_f32_16x16x32_bf16 a[16:19], a[172:175], a[208:211], a[16:19]
s_add_u32 s33, s33, 16384
v_mfma_f32_16x16x32_bf16 a[20:23], a[172:175], a[212:215], a[20:23]
s_and_b32 s33, s33, 65535
ds_read_b64_tr_b16 a[248:249], v11 offset:0
v_mfma_f32_16x16x32_bf16 a[24:27], a[172:175], a[216:219], a[24:27]
v_mfma_f32_16x16x32_bf16 a[28:31], a[172:175], a[220:223], a[28:31]
s_add_u32 s48, s48, s34
ds_read_b128 a[172:175], v3 offset:5120
v_mfma_f32_16x16x32_bf16 a[32:35], a[176:179], a[192:195], a[32:35]
s_add_u32 m0, s32, 16384
ds_read_b64_tr_b16 a[250:251], v11 offset:1024
v_mfma_f32_16x16x32_bf16 a[36:39], a[176:179], a[196:199], a[36:39]
buffer_load_dwordx4 v1, s[12:15], s48 offen lds
v_mfma_f32_16x16x32_bf16 a[40:43], a[176:179], a[200:203], a[40:43]
ds_read_b64_tr_b16 a[252:253], v12 offset:0
v_mfma_f32_16x16x32_bf16 a[44:47], a[176:179], a[204:207], a[44:47]
s_add_u32 s29, s29, s93
v_mfma_f32_16x16x32_bf16 a[48:51], a[176:179], a[208:211], a[48:51]
ds_read_b64_tr_b16 a[254:255], v12 offset:1024
v_mfma_f32_16x16x32_bf16 a[52:55], a[176:179], a[212:215], a[52:55]
buffer_store_dwordx4 v[48:51], v13, s[8:11], s29 offen sc1
v_mfma_f32_16x16x32_bf16 a[56:59], a[176:179], a[216:219], a[56:59]
s_add_u32 s48, s48, s34
ds_read_b128 v[28:31], v3 offset:13312
v_mfma_f32_16x16x32_bf16 a[60:63], a[176:179], a[220:223], a[60:63]
s_add_u32 m0, s32, 20480
ds_read_b128 a[176:179], v4 offset:8192
v_mfma_f32_16x16x32_bf16 a[64:67], a[180:183], a[192:195], a[64:67]
buffer_load_dwordx4 v1, s[12:15], s48 offen lds
v_mfma_f32_16x16x32_bf16 a[68:71], a[180:183], a[196:199], a[68:71]
v_add_u32 v5, 16384, v5
v_and_b32 v5, 65535, v5
v_mfma_f32_16x16x32_bf16 a[72:75], a[180:183], a[200:203], a[72:75]
v_xor_b32 v6, 16, v5
v_xor_b32 v7, 64, v5
v_mfma_f32_16x16x32_bf16 a[76:79], a[180:183], a[204:207], a[76:79]
v_xor_b32 v8, 80, v5
v_xor_b32 v9, 128, v5
v_mfma_f32_16x16x32_bf16 a[80:83], a[180:183], a[208:211], a[80:83]
v_xor_b32 v10, 144, v5
v_xor_b32 v11, 192, v5
v_mfma_f32_16x16x32_bf16 a[84:87], a[180:183], a[212:215], a[84:87]
s_add_u32 s48, s48, s34
v_xor_b32 v12, 208, v5
v_mfma_f32_16x16x32_bf16 a[88:91], a[180:183], a[216:219], a[88:91]
s_add_u32 m0, s32, 24576
v_mfma_f32_16x16x32_bf16 a[92:95], a[180:183], a[220:223], a[92:95]
buffer_load_dwordx4 v1, s[12:15], s48 offen lds
ds_read_b128 a[180:183], v3 offset:9216
v_mfma_f32_16x16x32_bf16 a[96:99], a[184:187], a[192:195], a[96:99]
v_mfma_f32_16x16x32_bf16 a[100:103], a[184:187], a[196:199], a[100:103]
v_mfma_f32_16x16x32_bf16 a[104:107], a[184:187], a[200:203], a[104:107]
v_mfma_f32_16x16x32_bf16 a[108:111], a[184:187], a[204:207], a[108:111]
v_mfma_f32_16x16x32_bf16 a[112:115], a[184:187], a[208:211], a[112:115]
s_add_u32 s48, s48, s34
v_mfma_f32_16x16x32_bf16 a[116:119], a[184:187], a[212:215], a[116:119]
s_add_u32 m0, s32, 28672
v_mfma_f32_16x16x32_bf16 a[120:123], a[184:187], a[216:219], a[120:123]
buffer_load_dwordx4 v1, s[12:15], s48 offen lds
v_mfma_f32_16x16x32_bf16 a[124:127], a[184:187], a[220:223], a[124:127]
s_add_u32 s30, s30, 128
ds_read_b128 a[184:187], v4 offset:12288
v_mfma_f32_16x16x32_bf16 a[128:131], a[188:191], a[192:195], a[128:131]
s_add_u32 s32, s32, 32768
s_add_u32 s29, s29, s44
v_add_u32 v3, 32768, v3
v_mfma_f32_16x16x32_bf16 a[132:135], a[188:191], a[196:199], a[132:135]
s_sub_u32 s48, s32, 98304
v_subrev_u32 v19, 98304, v3
v_mfma_f32_16x16x32_bf16 a[136:139], a[188:191], a[200:203], a[136:139]
s_cmp_ge_u32 s32, 163840
s_cselect_b32 s32, s48, s32
buffer_store_dwordx4 v[52:55], v13, s[8:11], s29 offen sc1
buffer_load_dword v15, v14, s[96:99], s100 offen
v_mfma_f32_16x16x32_bf16 a[140:143], a[188:191], a[204:207], a[140:143]
s_add_u32 s100, s100, 16384
v_cmp_le_u32 vcc, 163840, v3
v_mfma_f32_16x16x32_bf16 a[144:147], a[188:191], a[208:211], a[144:147]
s_nop 0
v_cndmask_b32 v3, v3, v19, vcc
v_mfma_f32_16x16x32_bf16 a[148:151], a[188:191], a[212:215], a[148:151]
v_xor_b32 v4, 64, v3
v_mfma_f32_16x16x32_bf16 a[152:155], a[188:191], a[216:219], a[152:155]
v_mfma_f32_16x16x32_bf16 a[156:159], a[188:191], a[220:223], a[156:159]
s_waitcnt vmcnt(24) lgkmcnt(0)
s_barrier
v_mfma_f32_16x16x32_bf16 v[160:163], a[160:163], a[224:227], v[160:163]
ds_read_b64_tr_b16 a[192:193], v5 offset:0
v_mfma_f32_16x16x32_bf16 v[164:167], a[160:163], a[228:231], v[164:167]
v_mfma_f32_16x16x32_bf16 v[168:171], a[160:163], a[232:235], v[168:171]
ds_read_b64_tr_b16 a[194:195], v5 offset:1024
v_mfma_f32_16x16x32_bf16 v[172:175], a[160:163], a[236:239], v[172:175]
s_add_u32 s37, s31, 0
v_mfma_f32_16x16x32_bf16 v[176:179], a[160:163], a[240:243], v[176:179]
s_add_u32 m0, s33, 0
ds_read_b64_tr_b16 a[196:197], v6 offset:0
v_mfma_f32_16x16x32_bf16 v[180:183], a[160:163], a[244:247], v[180:183]
buffer_load_dwordx4 v2, s[20:23], s37 offen  lds
v_mfma_f32_16x16x32_bf16 v[184:187], a[160:163], a[248:251], v[184:187]
ds_read_b64_tr_b16 a[198:199], v6 offset:1024
v_mfma_f32_16x16x32_bf16 v[188:191], a[160:163], a[252:255], v[188:191]
ds_read_b128 a[160:163], v3 offset:0
v_mfma_f32_16x16x32_bf16 v[192:195], a[164:167], a[224:227], v[192:195]
ds_read_b64_tr_b16 a[200:201], v7 offset:0
v_mfma_f32_16x16x32_bf16 v[196:199], a[164:167], a[228:231], v[196:199]
v_mfma_f32_16x16x32_bf16 v[200:203], a[164:167], a[232:235], v[200:203]
s_add_u32 s37, s31, 32768
ds_read_b64_tr_b16 a[202:203], v7 offset:1024
v_mfma_f32_16x16x32_bf16 v[204:207], a[164:167], a[236:239], v[204:207]
s_add_u32 m0, s33, 1024
v_mfma_f32_16x16x32_bf16 v[208:211], a[164:167], a[240:243], v[208:211]
buffer_load_dwordx4 v2, s[20:23], s37 offen  lds
v_mfma_f32_16x16x32_bf16 v[212:215], a[164:167], a[244:247], v[212:215]
ds_read_b64_tr_b16 a[204:205], v8 offset:0
v_mfma_f32_16x16x32_bf16 v[216:219], a[164:167], a[248:251], v[216:219]
s_add_u32 s29, s29, s93
v_mfma_f32_16x16x32_bf16 v[220:223], a[164:167], a[252:255], v[220:223]
ds_read_b128 a[164:167], v4 offset:1024
v_mfma_f32_16x16x32_bf16 v[224:227], a[168:171], a[224:227], v[224:227]
buffer_store_dwordx4 v[56:59], v13, s[8:11], s29 offen sc1
v_mfma_f32_16x16x32_bf16 v[228:231], a[168:171], a[228:231], v[228:231]
s_add_u32 s37, s31, 131072
ds_read_b64_tr_b16 a[206:207], v8 offset:1024
v_mfma_f32_16x16x32_bf16 v[232:235], a[168:171], a[232:235], v[232:235]
s_add_u32 m0, s33, 4096
v_mfma_f32_16x16x32_bf16 v[236:239], a[168:171], a[236:239], v[236:239]
buffer_load_dwordx4 v2, s[20:23], s37 offen  lds
v_mfma_f32_16x16x32_bf16 v[240:243], a[168:171], a[240:243], v[240:243]
ds_read_b64_tr_b16 a[208:209], v9 offset:0
v_mfma_f32_16x16x32_bf16 v[244:247], a[168:171], a[244:247], v[244:247]
v_mfma_f32_16x16x32_bf16 v[248:251], a[168:171], a[248:251], v[248:251]
ds_read_b64_tr_b16 a[210:211], v9 offset:1024
v_mfma_f32_16x16x32_bf16 v[252:255], a[168:171], a[252:255], v[252:255]
ds_read_b128 a[168:171], v3 offset:4096
v_mfma_f32_16x16x32_bf16 a[0:3], a[172:175], a[224:227], a[0:3]
s_add_u32 s37, s31, 163840
ds_read_b64_tr_b16 a[212:213], v10 offset:0
v_mfma_f32_16x16x32_bf16 a[4:7], a[172:175], a[228:231], a[4:7]
s_add_u32 m0, s33, 5120
v_mfma_f32_16x16x32_bf16 a[8:11], a[172:175], a[232:235], a[8:11]
buffer_load_dwordx4 v2, s[20:23], s37 offen  lds
v_mfma_f32_16x16x32_bf16 a[12:15], a[172:175], a[236:239], a[12:15]
s_add_u32 s31, s31, 262144
ds_read_b64_tr_b16 a[214:215], v10 offset:1024
v_mfma_f32_16x16x32_bf16 a[16:19], a[172:175], a[240:243], a[16:19]
s_add_u32 s33, s33, 16384
v_mfma_f32_16x16x32_bf16 a[20:23], a[172:175], a[244:247], a[20:23]
s_and_b32 s33, s33, 65535
ds_read_b64_tr_b16 a[216:217], v11 offset:0
v_mfma_f32_16x16x32_bf16 a[24:27], a[172:175], a[248:251], a[24:27]
v_mfma_f32_16x16x32_bf16 a[28:31], a[172:175], a[252:255], a[28:31]
s_mov_b32 s48, s30
ds_read_b128 a[172:175], v4 offset:5120
v_mfma_f32_16x16x32_bf16 a[32:35], a[176:179], a[224:227], a[32:35]
s_add_u32 m0, s32, 0
ds_read_b64_tr_b16 a[218:219], v11 offset:1024
v_mfma_f32_16x16x32_bf16 a[36:39], a[176:179], a[228:231], a[36:39]
buffer_load_dwordx4 v1, s[12:15], s48 offen lds
v_mfma_f32_16x16x32_bf16 a[40:43], a[176:179], a[232:235], a[40:43]
ds_read_b64_tr_b16 a[220:221], v12 offset:0
v_mfma_f32_16x16x32_bf16 a[44:47], a[176:179], a[236:239], a[44:47]
s_add_u32 s29, s29, s44
v_mfma_f32_16x16x32_bf16 a[48:51], a[176:179], a[240:243], a[48:51]
ds_read_b64_tr_b16 a[222:223], v12 offset:1024
v_mfma_f32_16x16x32_bf16 a[52:55], a[176:179], a[244:247], a[52:55]
buffer_store_dwordx4 v[60:63], v13, s[8:11], s29 offen sc1
v_mfma_f32_16x16x32_bf16 a[56:59], a[176:179], a[248:251], a[56:59]
s_add_u32 s48, s48, s34
ds_read_b128 a[188:191], v4 offset:13312
v_mfma_f32_16x16x32_bf16 a[60:63], a[176:179], a[252:255], a[60:63]
s_add_u32 m0, s32, 4096
ds_read_b128 a[176:179], v3 offset:8192
v_mfma_f32_16x16x32_bf16 a[64:67], a[180:183], a[224:227], a[64:67]
buffer_load_dwordx4 v1, s[12:15], s48 offen lds
v_mfma_f32_16x16x32_bf16 a[68:71], a[180:183], a[228:231], a[68:71]
v_add_u32 v5, 16384, v5
v_and_b32 v5, 65535, v5
v_mfma_f32_16x16x32_bf16 a[72:75], a[180:183], a[232:235], a[72:75]
v_xor_b32 v6, 16, v5
v_xor_b32 v7, 64, v5
v_mfma_f32_16x16x32_bf16 a[76:79], a[180:183], a[236:239], a[76:79]
v_xor_b32 v8, 80, v5
v_xor_b32 v9, 128, v5
v_mfma_f32_16x16x32_bf16 a[80:83], a[180:183], a[240:243], a[80:83]
v_xor_b32 v10, 144, v5
v_xor_b32 v11, 192, v5
v_mfma_f32_16x16x32_bf16 a[84:87], a[180:183], a[244:247], a[84:87]
s_add_u32 s48, s48, s34
v_xor_b32 v12, 208, v5
v_mfma_f32_16x16x32_bf16 a[88:91], a[180:183], a[248:251], a[88:91]
s_add_u32 m0, s32, 8192
v_mfma_f32_16x16x32_bf16 a[92:95], a[180:183], a[252:255], a[92:95]
buffer_load_dwordx4 v1, s[12:15], s48 offen lds
ds_read_b128 a[180:183], v4 offset:9216
v_mfma_f32_16x16x32_bf16 a[96:99], a[184:187], a[224:227], a[96:99]
v_mfma_f32_16x16x32_bf16 a[100:103], a[184:187], a[228:231], a[100:103]
v_mfma_f32_16x16x32_bf16 a[104:107], a[184:187], a[232:235], a[104:107]
v_mfma_f32_16x16x32_bf16 a[108:111], a[184:187], a[236:239], a[108:111]
v_mfma_f32_16x16x32_bf16 a[112:115], a[184:187], a[240:243], a[112:115]
s_add_u32 s48, s48, s34
v_mfma_f32_16x16x32_bf16 a[116:119], a[184:187], a[244:247], a[116:119]
s_add_u32 m0, s32, 12288
v_mfma_f32_16x16x32_bf16 a[120:123], a[184:187], a[248:251], a[120:123]
buffer_load_dwordx4 v1, s[12:15], s48 offen lds
v_mfma_f32_16x16x32_bf16 a[124:127], a[184:187], a[252:255], a[124:127]
ds_read_b128 a[184:187], v3 offset:12288
v_mfma_f32_16x16x32_bf16 a[128:131], v[28:31], a[224:227], a[128:131]
v_mfma_f32_16x16x32_bf16 a[132:135], v[28:31], a[228:231], a[132:135]
v_mfma_f32_16x16x32_bf16 a[136:139], v[28:31], a[232:235], a[136:139]
buffer_load_dword v15, v14, s[96:99], s100 offen
v_mfma_f32_16x16x32_bf16 a[140:143], v[28:31], a[236:239], a[140:143]
s_add_u32 s100, s100, 16384
v_mfma_f32_16x16x32_bf16 a[144:147], v[28:31], a[240:243], a[144:147]
v_mfma_f32_16x16x32_bf16 a[148:151], v[28:31], a[244:247], a[148:151]
v_mfma_f32_16x16x32_bf16 a[152:155], v[28:31], a[248:251], a[152:155]
v_mfma_f32_16x16x32_bf16 a[156:159], v[28:31], a[252:255], a[156:159]
s_waitcnt vmcnt(23) lgkmcnt(0)
s_barrier
v_mfma_f32_16x16x32_bf16 v[160:163], a[160:163], a[192:195], v[160:163]
ds_read_b64_tr_b16 a[224:225], v5 offset:0
v_mfma_f32_16x16x32_bf16 v[164:167], a[160:163], a[196:199], v[164:167]
v_mfma_f32_16x16x32_bf16 v[168:171], a[160:163], a[200:203], v[168:171]
ds_read_b64_tr_b16 a[226:227], v5 offset:1024
v_mfma_f32_16x16x32_bf16 v[172:175], a[160:163], a[204:207], v[172:175]
s_add_u32 s37, s31, 0
v_mfma_f32_16x16x32_bf16 v[176:179], a[160:163], a[208:211], v[176:179]
s_add_u32 m0, s33, 0
ds_read_b64_tr_b16 a[228:229], v6 offset:0
v_mfma_f32_16x16x32_bf16 v[180:183], a[160:163], a[212:215], v[180:183]
buffer_load_dwordx4 v2, s[20:23], s37 offen  lds
v_mfma_f32_16x16x32_bf16 v[184:187], a[160:163], a[216:219], v[184:187]
ds_read_b64_tr_b16 a[230:231], v6 offset:1024
v_mfma_f32_16x16x32_bf16 v[188:191], a[160:163], a[220:223], v[188:191]
ds_read_b128 a[160:163], v4 offset:0
v_mfma_f32_16x16x32_bf16 v[192:195], a[164:167], a[192:195], v[192:195]
ds_read_b64_tr_b16 a[232:233], v7 offset:0
v_mfma_f32_16x16x32_bf16 v[196:199], a[164:167], a[196:199], v[196:199]
v_mfma_f32_16x16x32_bf16 v[200:203], a[164:167], a[200:203], v[200:203]
s_add_u32 s37, s31, 32768
ds_read_b64_tr_b16 a[234:235], v7 offset:1024
v_mfma_f32_16x16x32_bf16 v[204:207], a[164:167], a[204:207], v[204:207]
s_add_u32 m0, s33, 1024
v_mfma_f32_16x16x32_bf16 v[208:211], a[164:167], a[208:211], v[208:211]
buffer_load_dwordx4 v2, s[20:23], s37 offen  lds
v_mfma_f32_16x16x32_bf16 v[212:215], a[164:167], a[212:215], v[212:215]
ds_read_b64_tr_b16 a[236:237], v8 offset:0
v_mfma_f32_16x16x32_bf16 v[216:219], a[164:167], a[216:219], v[216:219]
s_add_u32 s60, s60, s92
v_mfma_f32_16x16x32_bf16 v[220:223], a[164:167], a[220:223], v[220:223]
s_mov_b32 s29, s60
ds_read_b128 a[164:167], v3 offset:1024
v_mfma_f32_16x16x32_bf16 v[224:227], a[168:171], a[192:195], v[224:227]
buffer_store_dwordx4 v[64:67], v13, s[8:11], s29 offen sc1
v_mfma_f32_16x16x32_bf16 v[228:231], a[168:171], a[196:199], v[228:231]
s_add_u32 s37, s31, 131072
ds_read_b64_tr_b16 a[238:239], v8 offset:1024
v_mfma_f32_16x16x32_bf16 v[232:235], a[168:171], a[200:203], v[232:235]
s_add_u32 m0, s33, 4096
v_mfma_f32_16x16x32_bf16 v[236:239], a[168:171], a[204:207], v[236:239]
buffer_load_dwordx4 v2, s[20:23], s37 offen  lds
v_mfma_f32_16x16x32_bf16 v[240:243], a[168:171], a[208:211], v[240:243]
ds_read_b64_tr_b16 a[240:241], v9 offset:0
v_mfma_f32_16x16x32_bf16 v[244:247], a[168:171], a[212:215], v[244:247]
v_mfma_f32_16x16x32_bf16 v[248:251], a[168:171], a[216:219], v[248:251]
ds_read_b64_tr_b16 a[242:243], v9 offset:1024
v_mfma_f32_16x16x32_bf16 v[252:255], a[168:171], a[220:223], v[252:255]
ds_read_b128 a[168:171], v4 offset:4096
v_mfma_f32_16x16x32_bf16 a[0:3], a[172:175], a[192:195], a[0:3]
s_add_u32 s37, s31, 163840
ds_read_b64_tr_b16 a[244:245], v10 offset:0
v_mfma_f32_16x16x32_bf16 a[4:7], a[172:175], a[196:199], a[4:7]
s_add_u32 m0, s33, 5120
v_mfma_f32_16x16x32_bf16 a[8:11], a[172:175], a[200:203], a[8:11]
buffer_load_dwordx4 v2, s[20:23], s37 offen  lds
v_mfma_f32_16x16x32_bf16 a[12:15], a[172:175], a[204:207], a[12:15]
s_add_u32 s31, s31, 262144
ds_read_b64_tr_b16 a[246:247], v10 offset:1024
v_mfma_f32_16x16x32_bf16 a[16:19], a[172:175], a[208:211], a[16:19]
s_add_u32 s33, s33, 16384
v_mfma_f32_16x16x32_bf16 a[20:23], a[172:175], a[212:215], a[20:23]
s_and_b32 s33, s33, 65535
ds_read_b64_tr_b16 a[248:249], v11 offset:0
v_mfma_f32_16x16x32_bf16 a[24:27], a[172:175], a[216:219], a[24:27]
v_mfma_f32_16x16x32_bf16 a[28:31], a[172:175], a[220:223], a[28:31]
s_add_u32 s48, s48, s34
ds_read_b128 a[172:175], v3 offset:5120
v_mfma_f32_16x16x32_bf16 a[32:35], a[176:179], a[192:195], a[32:35]
s_add_u32 m0, s32, 16384
ds_read_b64_tr_b16 a[250:251], v11 offset:1024
v_mfma_f32_16x16x32_bf16 a[36:39], a[176:179], a[196:199], a[36:39]
buffer_load_dwordx4 v1, s[12:15], s48 offen lds
v_mfma_f32_16x16x32_bf16 a[40:43], a[176:179], a[200:203], a[40:43]
ds_read_b64_tr_b16 a[252:253], v12 offset:0
v_mfma_f32_16x16x32_bf16 a[44:47], a[176:179], a[204:207], a[44:47]
s_add_u32 s29, s29, s44
v_mfma_f32_16x16x32_bf16 a[48:51], a[176:179], a[208:211], a[48:51]
ds_read_b64_tr_b16 a[254:255], v12 offset:1024
v_mfma_f32_16x16x32_bf16 a[52:55], a[176:179], a[212:215], a[52:55]
buffer_store_dwordx4 v[68:71], v13, s[8:11], s29 offen sc1
v_mfma_f32_16x16x32_bf16 a[56:59], a[176:179], a[216:219], a[56:59]
s_add_u32 s48, s48, s34
ds_read_b128 v[28:31], v3 offset:13312
v_mfma_f32_16x16x32_bf16 a[60:63], a[176:179], a[220:223], a[60:63]
s_add_u32 m0, s32, 20480
ds_read_b128 a[176:179], v4 offset:8192
v_mfma_f32_16x16x32_bf16 a[64:67], a[180:183], a[192:195], a[64:67]
buffer_load_dwordx4 v1, s[12:15], s48 offen lds
v_mfma_f32_16x16x32_bf16 a[68:71], a[180:183], a[196:199], a[68:71]
v_add_u32 v5, 16384, v5
v_and_b32 v5, 65535, v5
v_mfma_f32_16x16x32_bf16 a[72:75], a[180:183], a[200:203], a[72:75]
v_xor_b32 v6, 16, v5
v_xor_b32 v7, 64, v5
v_mfma_f32_16x16x32_bf16 a[76:79], a[180:183], a[204:207], a[76:79]
v_xor_b32 v8, 80, v5
v_xor_b32 v9, 128, v5
v_mfma_f32_16x16x32_bf16 a[80:83], a[180:183], a[208:211], a[80:83]
v_xor_b32 v10, 144, v5
v_xor_b32 v11, 192, v5
v_mfma_f32_16x16x32_bf16 a[84:87], a[180:183], a[212:215], a[84:87]
s_add_u32 s48, s48, s34
v_xor_b32 v12, 208, v5
v_mfma_f32_16x16x32_bf16 a[88:91], a[180:183], a[216:219], a[88:91]
s_add_u32 m0, s32, 24576
v_mfma_f32_16x16x32_bf16 a[92:95], a[180:183], a[220:223], a[92:95]
buffer_load_dwordx4 v1, s[12:15], s48 offen lds
ds_read_b128 a[180:183], v3 offset:9216
v_mfma_f32_16x16x32_bf16 a[96:99], a[184:187], a[192:195], a[96:99]
v_mfma_f32_16x16x32_bf16 a[100:103], a[184:187], a[196:199], a[100:103]
v_mfma_f32_16x16x32_bf16 a[104:107], a[184:187], a[200:203], a[104:107]
v_mfma_f32_16x16x32_bf16 a[108:111], a[184:187], a[204:207], a[108:111]
v_mfma_f32_16x16x32_bf16 a[112:115], a[184:187], a[208:211], a[112:115]
s_add_u32 s48, s48, s34
v_mfma_f32_16x16x32_bf16 a[116:119], a[184:187], a[212:215], a[116:119]
s_add_u32 m0, s32, 28672
v_mfma_f32_16x16x32_bf16 a[120:123], a[184:187], a[216:219], a[120:123]
buffer_load_dwordx4 v1, s[12:15], s48 offen lds
v_mfma_f32_16x16x32_bf16 a[124:127], a[184:187], a[220:223], a[124:127]
s_add_u32 s30, s30, 128
ds_read_b128 a[184:187], v4 offset:12288
v_mfma_f32_16x16x32_bf16 a[128:131], a[188:191], a[192:195], a[128:131]
s_add_u32 s32, s32, 32768
s_add_u32 s29, s29, s93
v_add_u32 v3, 32768, v3
v_mfma_f32_16x16x32_bf16 a[132:135], a[188:191], a[196:199], a[132:135]
s_sub_u32 s48, s32, 98304
v_subrev_u32 v19, 98304, v3
v_mfma_f32_16x16x32_bf16 a[136:139], a[188:191], a[200:203], a[136:139]
s_cmp_ge_u32 s32, 163840
s_cselect_b32 s32, s48, s32
buffer_store_dwordx4 v[72:75], v13, s[8:11], s29 offen sc1
buffer_load_dword v15, v14, s[96:99], s100 offen
v_mfma_f32_16x16x32_bf16 a[140:143], a[188:191], a[204:207], a[140:143]
s_add_u32 s100, s100, 16384
v_cmp_le_u32 vcc, 163840, v3
v_mfma_f32_16x16x32_bf16 a[144:147], a[188:191], a[208:211], a[144:147]
s_nop 0
v_cndmask_b32 v3, v3, v19, vcc
v_mfma_f32_16x16x32_bf16 a[148:151], a[188:191], a[212:215], a[148:151]
v_xor_b32 v4, 64, v3
v_mfma_f32_16x16x32_bf16 a[152:155], a[188:191], a[216:219], a[152:155]
v_mfma_f32_16x16x32_bf16 a[156:159], a[188:191], a[220:223], a[156:159]
s_waitcnt vmcnt(23) lgkmcnt(0)
s_barrier
v_mfma_f32_16x16x32_bf16 v[160:163], a[160:163], a[224:227], v[160:163]
ds_read_b64_tr_b16 a[192:193], v5 offset:0
v_mfma_f32_16x16x32_bf16 v[164:167], a[160:163], a[228:231], v[164:167]
v_mfma_f32_16x16x32_bf16 v[168:171], a[160:163], a[232:235], v[168:171]
ds_read_b64_tr_b16 a[194:195], v5 offset:1024
v_mfma_f32_16x16x32_bf16 v[172:175], a[160:163], a[236:239], v[172:175]
s_add_u32 s37, s31, 0
v_mfma_f32_16x16x32_bf16 v[176:179], a[160:163], a[240:243], v[176:179]
s_add_u32 m0, s33, 0
ds_read_b64_tr_b16 a[196:197], v6 offset:0
v_mfma_f32_16x16x32_bf16 v[180:183], a[160:163], a[244:247], v[180:183]
buffer_load_dwordx4 v2, s[20:23], s37 offen  lds
v_mfma_f32_16x16x32_bf16 v[184:187], a[160:163], a[248:251], v[184:187]
ds_read_b64_tr_b16 a[198:199], v6 offset:1024
v_mfma_f32_16x16x32_bf16 v[188:191], a[160:163], a[252:255], v[188:191]
ds_read_b128 a[160:163], v3 offset:0
v_mfma_f32_16x16x32_bf16 v[192:195], a[164:167], a[224:227], v[192:195]
ds_read_b64_tr_b16 a[200:201], v7 offset:0
v_mfma_f32_16x16x32_bf16 v[196:199], a[164:167], a[228:231], v[196:199]
v_mfma_f32_16x16x32_bf16 v[200:203], a[164:167], a[232:235], v[200:203]
s_add_u32 s37, s31, 32768
ds_read_b64_tr_b16 a[202:203], v7 offset:1024
v_mfma_f32_16x16x32_bf16 v[204:207], a[164:167], a[236:239], v[204:207]
s_add_u32 m0, s33, 1024
v_mfma_f32_16x16x32_bf16 v[208:211], a[164:167], a[240:243], v[208:211]
buffer_load_dwordx4 v2, s[20:23], s37 offen  lds
v_mfma_f32_16x16x32_bf16 v[212:215], a[164:167], a[244:247], v[212:215]
ds_read_b64_tr_b16 a[204:205], v8 offset:0
v_mfma_f32_16x16x32_bf16 v[216:219], a[164:167], a[248:251], v[216:219]
s_add_u32 s29, s29, s44
v_mfma_f32_16x16x32_bf16 v[220:223], a[164:167], a[252:255], v[220:223]
ds_read_b128 a[164:167], v4 offset:1024
v_mfma_f32_16x16x32_bf16 v[224:227], a[168:171], a[224:227], v[224:227]
buffer_store_dwordx4 v[76:79], v13, s[8:11], s29 offen sc1
v_mfma_f32_16x16x32_bf16 v[228:231], a[168:171], a[228:231], v[228:231]
s_add_u32 s37, s31, 131072
ds_read_b64_tr_b16 a[206:207], v8 offset:1024
v_mfma_f32_16x16x32_bf16 v[232:235], a[168:171], a[232:235], v[232:235]
s_add_u32 m0, s33, 4096
v_mfma_f32_16x16x32_bf16 v[236:239], a[168:171], a[236:239], v[236:239]
buffer_load_dwordx4 v2, s[20:23], s37 offen  lds
v_mfma_f32_16x16x32_bf16 v[240:243], a[168:171], a[240:243], v[240:243]
ds_read_b64_tr_b16 a[208:209], v9 offset:0
v_mfma_f32_16x16x32_bf16 v[244:247], a[168:171], a[244:247], v[244:247]
v_mfma_f32_16x16x32_bf16 v[248:251], a[168:171], a[248:251], v[248:251]
ds_read_b64_tr_b16 a[210:211], v9 offset:1024
v_mfma_f32_16x16x32_bf16 v[252:255], a[168:171], a[252:255], v[252:255]
ds_read_b128 a[168:171], v3 offset:4096
v_mfma_f32_16x16x32_bf16 a[0:3], a[172:175], a[224:227], a[0:3]
s_add_u32 s37, s31, 163840
ds_read_b64_tr_b16 a[212:213], v10 offset:0
v_mfma_f32_16x16x32_bf16 a[4:7], a[172:175], a[228:231], a[4:7]
s_add_u32 m0, s33, 5120
v_mfma_f32_16x16x32_bf16 a[8:11], a[172:175], a[232:235], a[8:11]
buffer_load_dwordx4 v2, s[20:23], s37 offen  lds
v_mfma_f32_16x16x32_bf16 a[12:15], a[172:175], a[236:239], a[12:15]
s_add_u32 s31, s31, 262144
ds_read_b64_tr_b16 a[214:215], v10 offset:1024
v_mfma_f32_16x16x32_bf16 a[16:19], a[172:175], a[240:243], a[16:19]
s_add_u32 s33, s33, 16384
v_mfma_f32_16x16x32_bf16 a[20:23], a[172:175], a[244:247], a[20:23]
s_and_b32 s33, s33, 65535
ds_read_b64_tr_b16 a[216:217], v11 offset:0
v_mfma_f32_16x16x32_bf16 a[24:27], a[172:175], a[248:251], a[24:27]
v_mfma_f32_16x16x32_bf16 a[28:31], a[172:175], a[252:255], a[28:31]
s_mov_b32 s48, s30
ds_read_b128 a[172:175], v4 offset:5120
v_mfma_f32_16x16x32_bf16 a[32:35], a[176:179], a[224:227], a[32:35]
s_add_u32 m0, s32, 0
ds_read_b64_tr_b16 a[218:219], v11 offset:1024
v_mfma_f32_16x16x32_bf16 a[36:39], a[176:179], a[228:231], a[36:39]
buffer_load_dwordx4 v1, s[12:15], s48 offen lds
v_mfma_f32_16x16x32_bf16 a[40:43], a[176:179], a[232:235], a[40:43]
ds_read_b64_tr_b16 a[220:221], v12 offset:0
v_mfma_f32_16x16x32_bf16 a[44:47], a[176:179], a[236:239], a[44:47]
s_add_u32 s29, s29, s93
v_mfma_f32_16x16x32_bf16 a[48:51], a[176:179], a[240:243], a[48:51]
ds_read_b64_tr_b16 a[222:223], v12 offset:1024
v_mfma_f32_16x16x32_bf16 a[52:55], a[176:179], a[244:247], a[52:55]
buffer_store_dwordx4 v[80:83], v13, s[8:11], s29 offen sc1
v_mfma_f32_16x16x32_bf16 a[56:59], a[176:179], a[248:251], a[56:59]
s_add_u32 s48, s48, s34
ds_read_b128 a[188:191], v4 offset:13312
v_mfma_f32_16x16x32_bf16 a[60:63], a[176:179], a[252:255], a[60:63]
s_add_u32 m0, s32, 4096
ds_read_b128 a[176:179], v3 offset:8192
v_mfma_f32_16x16x32_bf16 a[64:67], a[180:183], a[224:227], a[64:67]
buffer_load_dwordx4 v1, s[12:15], s48 offen lds
v_mfma_f32_16x16x32_bf16 a[68:71], a[180:183], a[228:231], a[68:71]
v_add_u32 v5, 16384, v5
v_and_b32 v5, 65535, v5
v_mfma_f32_16x16x32_bf16 a[72:75], a[180:183], a[232:235], a[72:75]
v_xor_b32 v6, 16, v5
v_xor_b32 v7, 64, v5
v_mfma_f32_16x16x32_bf16 a[76:79], a[180:183], a[236:239], a[76:79]
v_xor_b32 v8, 80, v5
v_xor_b32 v9, 128, v5
v_mfma_f32_16x16x32_bf16 a[80:83], a[180:183], a[240:243], a[80:83]
v_xor_b32 v10, 144, v5
v_xor_b32 v11, 192, v5
v_mfma_f32_16x16x32_bf16 a[84:87], a[180:183], a[244:247], a[84:87]
s_add_u32 s48, s48, s34
v_xor_b32 v12, 208, v5
v_mfma_f32_16x16x32_bf16 a[88:91], a[180:183], a[248:251], a[88:91]
s_add_u32 m0, s32, 8192
v_mfma_f32_16x16x32_bf16 a[92:95], a[180:183], a[252:255], a[92:95]
buffer_load_dwordx4 v1, s[12:15], s48 offen lds
ds_read_b128 a[180:183], v4 offset:9216
v_mfma_f32_16x16x32_bf16 a[96:99], a[184:187], a[224:227], a[96:99]
v_mfma_f32_16x16x32_bf16 a[100:103], a[184:187], a[228:231], a[100:103]
v_mfma_f32_16x16x32_bf16 a[104:107], a[184:187], a[232:235], a[104:107]
v_mfma_f32_16x16x32_bf16 a[108:111], a[184:187], a[236:239], a[108:111]
v_mfma_f32_16x16x32_bf16 a[112:115], a[184:187], a[240:243], a[112:115]
s_add_u32 s48, s48, s34
v_mfma_f32_16x16x32_bf16 a[116:119], a[184:187], a[244:247], a[116:119]
s_add_u32 m0, s32, 12288
v_mfma_f32_16x16x32_bf16 a[120:123], a[184:187], a[248:251], a[120:123]
buffer_load_dwordx4 v1, s[12:15], s48 offen lds
v_mfma_f32_16x16x32_bf16 a[124:127], a[184:187], a[252:255], a[124:127]
ds_read_b128 a[184:187], v3 offset:12288
v_mfma_f32_16x16x32_bf16 a[128:131], v[28:31], a[224:227], a[128:131]
s_add_u32 s29, s29, s44
v_mfma_f32_16x16x32_bf16 a[132:135], v[28:31], a[228:231], a[132:135]
v_mfma_f32_16x16x32_bf16 a[136:139], v[28:31], a[232:235], a[136:139]
buffer_store_dwordx4 v[84:87], v13, s[8:11], s29 offen sc1
buffer_load_dword v15, v14, s[96:99], s100 offen
v_mfma_f32_16x16x32_bf16 a[140:143], v[28:31], a[236:239], a[140:143]
s_add_u32 s100, s100, 16384
v_mfma_f32_16x16x32_bf16 a[144:147], v[28:31], a[240:243], a[144:147]
v_mfma_f32_16x16x32_bf16 a[148:151], v[28:31], a[244:247], a[148:151]
v_mfma_f32_16x16x32_bf16 a[152:155], v[28:31], a[248:251], a[152:155]
v_mfma_f32_16x16x32_bf16 a[156:159], v[28:31], a[252:255], a[156:159]
s_waitcnt vmcnt(24) lgkmcnt(0)
s_barrier
v_mfma_f32_16x16x32_bf16 v[160:163], a[160:163], a[192:195], v[160:163]
ds_read_b64_tr_b16 a[224:225], v5 offset:0
v_mfma_f32_16x16x32_bf16 v[164:167], a[160:163], a[196:199], v[164:167]
v_mfma_f32_16x16x32_bf16 v[168:171], a[160:163], a[200:203], v[168:171]
ds_read_b64_tr_b16 a[226:227], v5 offset:1024
v_mfma_f32_16x16x32_bf16 v[172:175], a[160:163], a[204:207], v[172:175]
s_add_u32 s37, s31, 0
v_mfma_f32_16x16x32_bf16 v[176:179], a[160:163], a[208:211], v[176:179]
s_add_u32 m0, s33, 0
ds_read_b64_tr_b16 a[228:229], v6 offset:0
v_mfma_f32_16x16x32_bf16 v[180:183], a[160:163], a[212:215], v[180:183]
buffer_load_dwordx4 v2, s[20:23], s37 offen  lds
v_mfma_f32_16x16x32_bf16 v[184:187], a[160:163], a[216:219], v[184:187]
ds_read_b64_tr_b16 a[230:231], v6 offset:1024
v_mfma_f32_16x16x32_bf16 v[188:191], a[160:163], a[220:223], v[188:191]
ds_read_b128 a[160:163], v4 offset:0
v_mfma_f32_16x16x32_bf16 v[192:195], a[164:167], a[192:195], v[192:195]
ds_read_b64_tr_b16 a[232:233], v7 offset:0
v_mfma_f32_16x16x32_bf16 v[196:199], a[164:167], a[196:199], v[196:199]
v_mfma_f32_16x16x32_bf16 v[200:203], a[164:167], a[200:203], v[200:203]
s_add_u32 s37, s31, 32768
ds_read_b64_tr_b16 a[234:235], v7 offset:1024
v_mfma_f32_16x16x32_bf16 v[204:207], a[164:167], a[204:207], v[204:207]
s_add_u32 m0, s33, 1024
v_mfma_f32_16x16x32_bf16 v[208:211], a[164:167], a[208:211], v[208:211]
buffer_load_dwordx4 v2, s[20:23], s37 offen  lds
v_mfma_f32_16x16x32_bf16 v[212:215], a[164:167], a[212:215], v[212:215]
ds_read_b64_tr_b16 a[236:237], v8 offset:0
v_mfma_f32_16x16x32_bf16 v[216:219], a[164:167], a[216:219], v[216:219]
s_add_u32 s29, s29, s93
v_mfma_f32_16x16x32_bf16 v[220:223], a[164:167], a[220:223], v[220:223]
ds_read_b128 a[164:167], v3 offset:1024
v_mfma_f32_16x16x32_bf16 v[224:227], a[168:171], a[192:195], v[224:227]
buffer_store_dwordx4 v[88:91], v13, s[8:11], s29 offen sc1
v_mfma_f32_16x16x32_bf16 v[228:231], a[168:171], a[196:199], v[228:231]
s_add_u32 s37, s31, 131072
ds_read_b64_tr_b16 a[238:239], v8 offset:1024
v_mfma_f32_16x16x32_bf16 v[232:235], a[168:171], a[200:203], v[232:235]
s_add_u32 m0, s33, 4096
v_mfma_f32_16x16x32_bf16 v[236:239], a[168:171], a[204:207], v[236:239]
buffer_load_dwordx4 v2, s[20:23], s37 offen  lds
v_mfma_f32_16x16x32_bf16 v[240:243], a[168:171], a[208:211], v[240:243]
ds_read_b64_tr_b16 a[240:241], v9 offset:0
v_mfma_f32_16x16x32_bf16 v[244:247], a[168:171], a[212:215], v[244:247]
v_mfma_f32_16x16x32_bf16 v[248:251], a[168:171], a[216:219], v[248:251]
ds_read_b64_tr_b16 a[242:243], v9 offset:1024
v_mfma_f32_16x16x32_bf16 v[252:255], a[168:171], a[220:223], v[252:255]
ds_read_b128 a[168:171], v4 offset:4096
v_mfma_f32_16x16x32_bf16 a[0:3], a[172:175], a[192:195], a[0:3]
s_add_u32 s37, s31, 163840
ds_read_b64_tr_b16 a[244:245], v10 offset:0
v_mfma_f32_16x16x32_bf16 a[4:7], a[172:175], a[196:199], a[4:7]
s_add_u32 m0, s33, 5120
v_mfma_f32_16x16x32_bf16 a[8:11], a[172:175], a[200:203], a[8:11]
buffer_load_dwordx4 v2, s[20:23], s37 offen  lds
v_mfma_f32_16x16x32_bf16 a[12:15], a[172:175], a[204:207], a[12:15]
s_add_u32 s31, s31, 262144
ds_read_b64_tr_b16 a[246:247], v10 offset:1024
v_mfma_f32_16x16x32_bf16 a[16:19], a[172:175], a[208:211], a[16:19]
s_add_u32 s33, s33, 16384
v_mfma_f32_16x16x32_bf16 a[20:23], a[172:175], a[212:215], a[20:23]
s_and_b32 s33, s33, 65535
ds_read_b64_tr_b16 a[248:249], v11 offset:0
v_mfma_f32_16x16x32_bf16 a[24:27], a[172:175], a[216:219], a[24:27]
v_mfma_f32_16x16x32_bf16 a[28:31], a[172:175], a[220:223], a[28:31]
s_add_u32 s48, s48, s34
ds_read_b128 a[172:175], v3 offset:5120
v_mfma_f32_16x16x32_bf16 a[32:35], a[176:179], a[192:195], a[32:35]
s_add_u32 m0, s32, 16384
ds_read_b64_tr_b16 a[250:251], v11 offset:1024
v_mfma_f32_16x16x32_bf16 a[36:39], a[176:179], a[196:199], a[36:39]
buffer_load_dwordx4 v1, s[12:15], s48 offen lds
v_mfma_f32_16x16x32_bf16 a[40:43], a[176:179], a[200:203], a[40:43]
ds_read_b64_tr_b16 a[252:253], v12 offset:0
v_mfma_f32_16x16x32_bf16 a[44:47], a[176:179], a[204:207], a[44:47]
s_add_u32 s29, s29, s44
v_mfma_f32_16x16x32_bf16 a[48:51], a[176:179], a[208:211], a[48:51]
ds_read_b64_tr_b16 a[254:255], v12 offset:1024
v_mfma_f32_16x16x32_bf16 a[52:55], a[176:179], a[212:215], a[52:55]
buffer_store_dwordx4 v[92:95], v13, s[8:11], s29 offen sc1
v_mfma_f32_16x16x32_bf16 a[56:59], a[176:179], a[216:219], a[56:59]
s_add_u32 s48, s48, s34
ds_read_b128 v[28:31], v3 offset:13312
v_mfma_f32_16x16x32_bf16 a[60:63], a[176:179], a[220:223], a[60:63]
s_add_u32 m0, s32, 20480
ds_read_b128 a[176:179], v4 offset:8192
v_mfma_f32_16x16x32_bf16 a[64:67], a[180:183], a[192:195], a[64:67]
buffer_load_dwordx4 v1, s[12:15], s48 offen lds
v_mfma_f32_16x16x32_bf16 a[68:71], a[180:183], a[196:199], a[68:71]
v_add_u32 v5, 16384, v5
v_and_b32 v5, 65535, v5
v_mfma_f32_16x16x32_bf16 a[72:75], a[180:183], a[200:203], a[72:75]
v_xor_b32 v6, 16, v5
v_xor_b32 v7, 64, v5
v_mfma_f32_16x16x32_bf16 a[76:79], a[180:183], a[204:207], a[76:79]
v_xor_b32 v8, 80, v5
v_xor_b32 v9, 128, v5
v_mfma_f32_16x16x32_bf16 a[80:83], a[180:183], a[208:211], a[80:83]
v_xor_b32 v10, 144, v5
v_xor_b32 v11, 192, v5
v_mfma_f32_16x16x32_bf16 a[84:87], a[180:183], a[212:215], a[84:87]
s_add_u32 s48, s48, s34
v_xor_b32 v12, 208, v5
v_mfma_f32_16x16x32_bf16 a[88:91], a[180:183], a[216:219], a[88:91]
s_add_u32 m0, s32, 24576
v_mfma_f32_16x16x32_bf16 a[92:95], a[180:183], a[220:223], a[92:95]
buffer_load_dwordx4 v1, s[12:15], s48 offen lds
ds_read_b128 a[180:183], v3 offset:9216
v_mfma_f32_16x16x32_bf16 a[96:99], a[184:187], a[192:195], a[96:99]
v_mfma_f32_16x16x32_bf16 a[100:103], a[184:187], a[196:199], a[100:103]
v_mfma_f32_16x16x32_bf16 a[104:107], a[184:187], a[200:203], a[104:107]
v_mfma_f32_16x16x32_bf16 a[108:111], a[184:187], a[204:207], a[108:111]
v_mfma_f32_16x16x32_bf16 a[112:115], a[184:187], a[208:211], a[112:115]
s_add_u32 s48, s48, s34
v_mfma_f32_16x16x32_bf16 a[116:119], a[184:187], a[212:215], a[116:119]
s_add_u32 m0, s32, 28672
v_mfma_f32_16x16x32_bf16 a[120:123], a[184:187], a[216:219], a[120:123]
buffer_load_dwordx4 v1, s[12:15], s48 offen lds
v_mfma_f32_16x16x32_bf16 a[124:127], a[184:187], a[220:223], a[124:127]
s_add_u32 s30, s30, 128
ds_read_b128 a[184:187], v4 offset:12288
v_mfma_f32_16x16x32_bf16 a[128:131], a[188:191], a[192:195], a[128:131]
s_add_u32 s32, s32, 32768
v_add_u32 v3, 32768, v3
v_mfma_f32_16x16x32_bf16 a[132:135], a[188:191], a[196:199], a[132:135]
s_sub_u32 s48, s32, 98304
v_subrev_u32 v19, 98304, v3
v_mfma_f32_16x16x32_bf16 a[136:139], a[188:191], a[200:203], a[136:139]
s_cmp_ge_u32 s32, 163840
s_cselect_b32 s32, s48, s32
buffer_load_dword v15, v14, s[96:99], s100 offen
v_mfma_f32_16x16x32_bf16 a[140:143], a[188:191], a[204:207], a[140:143]
s_add_u32 s100, s100, 16384
v_cmp_le_u32 vcc, 163840, v3
v_mfma_f32_16x16x32_bf16 a[144:147], a[188:191], a[208:211], a[144:147]
s_nop 0
v_cndmask_b32 v3, v3, v19, vcc
v_mfma_f32_16x16x32_bf16 a[148:151], a[188:191], a[212:215], a[148:151]
v_xor_b32 v4, 64, v3
v_mfma_f32_16x16x32_bf16 a[152:155], a[188:191], a[216:219], a[152:155]
v_mfma_f32_16x16x32_bf16 a[156:159], a[188:191], a[220:223], a[156:159]
s_waitcnt vmcnt(23) lgkmcnt(0)
s_barrier
v_mfma_f32_16x16x32_bf16 v[160:163], a[160:163], a[224:227], v[160:163]
ds_read_b64_tr_b16 a[192:193], v5 offset:0
v_mfma_f32_16x16x32_bf16 v[164:167], a[160:163], a[228:231], v[164:167]
v_mfma_f32_16x16x32_bf16 v[168:171], a[160:163], a[232:235], v[168:171]
ds_read_b64_tr_b16 a[194:195], v5 offset:1024
v_mfma_f32_16x16x32_bf16 v[172:175], a[160:163], a[236:239], v[172:175]
s_add_u32 s37, s31, 0
v_mfma_f32_16x16x32_bf16 v[176:179], a[160:163], a[240:243], v[176:179]
s_add_u32 m0, s33, 0
ds_read_b64_tr_b16 a[196:197], v6 offset:0
v_mfma_f32_16x16x32_bf16 v[180:183], a[160:163], a[244:247], v[180:183]
buffer_load_dwordx4 v2, s[20:23], s37 offen  lds
v_mfma_f32_16x16x32_bf16 v[184:187], a[160:163], a[248:251], v[184:187]
ds_read_b64_tr_b16 a[198:199], v6 offset:1024
v_mfma_f32_16x16x32_bf16 v[188:191], a[160:163], a[252:255], v[188:191]
ds_read_b128 a[160:163], v3 offset:0
v_mfma_f32_16x16x32_bf16 v[192:195], a[164:167], a[224:227], v[192:195]
ds_read_b64_tr_b16 a[200:201], v7 offset:0
v_mfma_f32_16x16x32_bf16 v[196:199], a[164:167], a[228:231], v[196:199]
v_mfma_f32_16x16x32_bf16 v[200:203], a[164:167], a[232:235], v[200:203]
s_add_u32 s37, s31, 32768
ds_read_b64_tr_b16 a[202:203], v7 offset:1024
v_mfma_f32_16x16x32_bf16 v[204:207], a[164:167], a[236:239], v[204:207]
s_add_u32 m0, s33, 1024
v_mfma_f32_16x16x32_bf16 v[208:211], a[164:167], a[240:243], v[208:211]
buffer_load_dwordx4 v2, s[20:23], s37 offen  lds
v_mfma_f32_16x16x32_bf16 v[212:215], a[164:167], a[244:247], v[212:215]
ds_read_b64_tr_b16 a[204:205], v8 offset:0
v_mfma_f32_16x16x32_bf16 v[216:219], a[164:167], a[248:251], v[216:219]
s_add_u32 s60, s60, s92
v_mfma_f32_16x16x32_bf16 v[220:223], a[164:167], a[252:255], v[220:223]
s_mov_b32 s29, s60
ds_read_b128 a[164:167], v4 offset:1024
v_mfma_f32_16x16x32_bf16 v[224:227], a[168:171], a[224:227], v[224:227]
buffer_store_dwordx4 v[96:99], v13, s[8:11], s29 offen sc1
v_mfma_f32_16x16x32_bf16 v[228:231], a[168:171], a[228:231], v[228:231]
s_add_u32 s37, s31, 131072
ds_read_b64_tr_b16 a[206:207], v8 offset:1024
v_mfma_f32_16x16x32_bf16 v[232:235], a[168:171], a[232:235], v[232:235]
s_add_u32 m0, s33, 4096
v_mfma_f32_16x16x32_bf16 v[236:239], a[168:171], a[236:239], v[236:239]
buffer_load_dwordx4 v2, s[20:23], s37 offen  lds
v_mfma_f32_16x16x32_bf16 v[240:243], a[168:171], a[240:243], v[240:243]
ds_read_b64_tr_b16 a[208:209], v9 offset:0
v_mfma_f32_16x16x32_bf16 v[244:247], a[168:171], a[244:247], v[244:247]
v_mfma_f32_16x16x32_bf16 v[248:251], a[168:171], a[248:251], v[248:251]
ds_read_b64_tr_b16 a[210:211], v9 offset:1024
v_mfma_f32_16x16x32_bf16 v[252:255], a[168:171], a[252:255], v[252:255]
ds_read_b128 a[168:171], v3 offset:4096
v_mfma_f32_16x16x32_bf16 a[0:3], a[172:175], a[224:227], a[0:3]
s_add_u32 s37, s31, 163840
ds_read_b64_tr_b16 a[212:213], v10 offset:0
v_mfma_f32_16x16x32_bf16 a[4:7], a[172:175], a[228:231], a[4:7]
s_add_u32 m0, s33, 5120
v_mfma_f32_16x16x32_bf16 a[8:11], a[172:175], a[232:235], a[8:11]
buffer_load_dwordx4 v2, s[20:23], s37 offen  lds
v_mfma_f32_16x16x32_bf16 a[12:15], a[172:175], a[236:239], a[12:15]
s_add_u32 s31, s31, 262144
ds_read_b64_tr_b16 a[214:215], v10 offset:1024
v_mfma_f32_16x16x32_bf16 a[16:19], a[172:175], a[240:243], a[16:19]
s_add_u32 s33, s33, 16384
v_mfma_f32_16x16x32_bf16 a[20:23], a[172:175], a[244:247], a[20:23]
s_and_b32 s33, s33, 65535
ds_read_b64_tr_b16 a[216:217], v11 offset:0
v_mfma_f32_16x16x32_bf16 a[24:27], a[172:175], a[248:251], a[24:27]
v_mfma_f32_16x16x32_bf16 a[28:31], a[172:175], a[252:255], a[28:31]
s_mov_b32 s48, s30
ds_read_b128 a[172:175], v4 offset:5120
v_mfma_f32_16x16x32_bf16 a[32:35], a[176:179], a[224:227], a[32:35]
s_add_u32 m0, s32, 0
ds_read_b64_tr_b16 a[218:219], v11 offset:1024
v_mfma_f32_16x16x32_bf16 a[36:39], a[176:179], a[228:231], a[36:39]
buffer_load_dwordx4 v1, s[12:15], s48 offen lds
v_mfma_f32_16x16x32_bf16 a[40:43], a[176:179], a[232:235], a[40:43]
ds_read_b64_tr_b16 a[220:221], v12 offset:0
v_mfma_f32_16x16x32_bf16 a[44:47], a[176:179], a[236:239], a[44:47]
s_add_u32 s29, s29, s44
v_mfma_f32_16x16x32_bf16 a[48:51], a[176:179], a[240:243], a[48:51]
ds_read_b64_tr_b16 a[222:223], v12 offset:1024
v_mfma_f32_16x16x32_bf16 a[52:55], a[176:179], a[244:247], a[52:55]
buffer_store_dwordx4 v[100:103], v13, s[8:11], s29 offen sc1
v_mfma_f32_16x16x32_bf16 a[56:59], a[176:179], a[248:251], a[56:59]
s_add_u32 s48, s48, s34
ds_read_b128 a[188:191], v4 offset:13312
v_mfma_f32_16x16x32_bf16 a[60:63], a[176:179], a[252:255], a[60:63]
s_add_u32 m0, s32, 4096
ds_read_b128 a[176:179], v3 offset:8192
v_mfma_f32_16x16x32_bf16 a[64:67], a[180:183], a[224:227], a[64:67]
buffer_load_dwordx4 v1, s[12:15], s48 offen lds
v_mfma_f32_16x16x32_bf16 a[68:71], a[180:183], a[228:231], a[68:71]
v_add_u32 v5, 16384, v5
v_and_b32 v5, 65535, v5
v_mfma_f32_16x16x32_bf16 a[72:75], a[180:183], a[232:235], a[72:75]
v_xor_b32 v6, 16, v5
v_xor_b32 v7, 64, v5
v_mfma_f32_16x16x32_bf16 a[76:79], a[180:183], a[236:239], a[76:79]
v_xor_b32 v8, 80, v5
v_xor_b32 v9, 128, v5
v_mfma_f32_16x16x32_bf16 a[80:83], a[180:183], a[240:243], a[80:83]
v_xor_b32 v10, 144, v5
v_xor_b32 v11, 192, v5
v_mfma_f32_16x16x32_bf16 a[84:87], a[180:183], a[244:247], a[84:87]
s_add_u32 s48, s48, s34
v_xor_b32 v12, 208, v5
v_mfma_f32_16x16x32_bf16 a[88:91], a[180:183], a[248:251], a[88:91]
s_add_u32 m0, s32, 8192
v_mfma_f32_16x16x32_bf16 a[92:95], a[180:183], a[252:255], a[92:95]
buffer_load_dwordx4 v1, s[12:15], s48 offen lds
ds_read_b128 a[180:183], v4 offset:9216
v_mfma_f32_16x16x32_bf16 a[96:99], a[184:187], a[224:227], a[96:99]
v_mfma_f32_16x16x32_bf16 a[100:103], a[184:187], a[228:231], a[100:103]
v_mfma_f32_16x16x32_bf16 a[104:107], a[184:187], a[232:235], a[104:107]
v_mfma_f32_16x16x32_bf16 a[108:111], a[184:187], a[236:239], a[108:111]
v_mfma_f32_16x16x32_bf16 a[112:115], a[184:187], a[240:243], a[112:115]
s_add_u32 s48, s48, s34
v_mfma_f32_16x16x32_bf16 a[116:119], a[184:187], a[244:247], a[116:119]
s_add_u32 m0, s32, 12288
v_mfma_f32_16x16x32_bf16 a[120:123], a[184:187], a[248:251], a[120:123]
buffer_load_dwordx4 v1, s[12:15], s48 offen lds
v_mfma_f32_16x16x32_bf16 a[124:127], a[184:187], a[252:255], a[124:127]
ds_read_b128 a[184:187], v3 offset:12288
v_mfma_f32_16x16x32_bf16 a[128:131], v[28:31], a[224:227], a[128:131]
s_add_u32 s29, s29, s93
v_mfma_f32_16x16x32_bf16 a[132:135], v[28:31], a[228:231], a[132:135]
v_mfma_f32_16x16x32_bf16 a[136:139], v[28:31], a[232:235], a[136:139]
buffer_store_dwordx4 v[104:107], v13, s[8:11], s29 offen sc1
buffer_load_dword v15, v14, s[96:99], s100 offen
v_mfma_f32_16x16x32_bf16 a[140:143], v[28:31], a[236:239], a[140:143]
s_add_u32 s100, s100, 16384
v_mfma_f32_16x16x32_bf16 a[144:147], v[28:31], a[240:243], a[144:147]
v_mfma_f32_16x16x32_bf16 a[148:151], v[28:31], a[244:247], a[148:151]
v_mfma_f32_16x16x32_bf16 a[152:155], v[28:31], a[248:251], a[152:155]
v_mfma_f32_16x16x32_bf16 a[156:159], v[28:31], a[252:255], a[156:159]
s_waitcnt vmcnt(23) lgkmcnt(0)
s_barrier
v_mfma_f32_16x16x32_bf16 v[160:163], a[160:163], a[192:195], v[160:163]
ds_read_b64_tr_b16 a[224:225], v5 offset:0
v_mfma_f32_16x16x32_bf16 v[164:167], a[160:163], a[196:199], v[164:167]
v_mfma_f32_16x16x32_bf16 v[168:171], a[160:163], a[200:203], v[168:171]
ds_read_b64_tr_b16 a[226:227], v5 offset:1024
v_mfma_f32_16x16x32_bf16 v[172:175], a[160:163], a[204:207], v[172:175]
s_add_u32 s37, s31, 0
v_mfma_f32_16x16x32_bf16 v[176:179], a[160:163], a[208:211], v[176:179]
s_add_u32 m0, s33, 0
ds_read_b64_tr_b16 a[228:229], v6 offset:0
v_mfma_f32_16x16x32_bf16 v[180:183], a[160:163], a[212:215], v[180:183]
buffer_load_dwordx4 v2, s[20:23], s37 offen  lds
v_mfma_f32_16x16x32_bf16 v[184:187], a[160:163], a[216:219], v[184:187]
ds_read_b64_tr_b16 a[230:231], v6 offset:1024
v_mfma_f32_16x16x32_bf16 v[188:191], a[160:163], a[220:223], v[188:191]
ds_read_b128 a[160:163], v4 offset:0
v_mfma_f32_16x16x32_bf16 v[192:195], a[164:167], a[192:195], v[192:195]
ds_read_b64_tr_b16 a[232:233], v7 offset:0
v_mfma_f32_16x16x32_bf16 v[196:199], a[164:167], a[196:199], v[196:199]
v_mfma_f32_16x16x32_bf16 v[200:203], a[164:167], a[200:203], v[200:203]
s_add_u32 s37, s31, 32768
ds_read_b64_tr_b16 a[234:235], v7 offset:1024
v_mfma_f32_16x16x32_bf16 v[204:207], a[164:167], a[204:207], v[204:207]
s_add_u32 m0, s33, 1024
v_mfma_f32_16x16x32_bf16 v[208:211], a[164:167], a[208:211], v[208:211]
buffer_load_dwordx4 v2, s[20:23], s37 offen  lds
v_mfma_f32_16x16x32_bf16 v[212:215], a[164:167], a[212:215], v[212:215]
ds_read_b64_tr_b16 a[236:237], v8 offset:0
v_mfma_f32_16x16x32_bf16 v[216:219], a[164:167], a[216:219], v[216:219]
s_add_u32 s29, s29, s44
v_mfma_f32_16x16x32_bf16 v[220:223], a[164:167], a[220:223], v[220:223]
ds_read_b128 a[164:167], v3 offset:1024
v_mfma_f32_16x16x32_bf16 v[224:227], a[168:171], a[192:195], v[224:227]
buffer_store_dwordx4 v[108:111], v13, s[8:11], s29 offen sc1
v_mfma_f32_16x16x32_bf16 v[228:231], a[168:171], a[196:199], v[228:231]
s_add_u32 s37, s31, 131072
ds_read_b64_tr_b16 a[238:239], v8 offset:1024
v_mfma_f32_16x16x32_bf16 v[232:235], a[168:171], a[200:203], v[232:235]
s_add_u32 m0, s33, 4096
v_mfma_f32_16x16x32_bf16 v[236:239], a[168:171], a[204:207], v[236:239]
buffer_load_dwordx4 v2, s[20:23], s37 offen  lds
v_mfma_f32_16x16x32_bf16 v[240:243], a[168:171], a[208:211], v[240:243]
ds_read_b64_tr_b16 a[240:241], v9 offset:0
v_mfma_f32_16x16x32_bf16 v[244:247], a[168:171], a[212:215], v[244:247]
v_mfma_f32_16x16x32_bf16 v[248:251], a[168:171], a[216:219], v[248:251]
ds_read_b64_tr_b16 a[242:243], v9 offset:1024
v_mfma_f32_16x16x32_bf16 v[252:255], a[168:171], a[220:223], v[252:255]
ds_read_b128 a[168:171], v4 offset:4096
v_mfma_f32_16x16x32_bf16 a[0:3], a[172:175], a[192:195], a[0:3]
s_add_u32 s37, s31, 163840
ds_read_b64_tr_b16 a[244:245], v10 offset:0
v_mfma_f32_16x16x32_bf16 a[4:7], a[172:175], a[196:199], a[4:7]
s_add_u32 m0, s33, 5120
v_mfma_f32_16x16x32_bf16 a[8:11], a[172:175], a[200:203], a[8:11]
buffer_load_dwordx4 v2, s[20:23], s37 offen  lds
v_mfma_f32_16x16x32_bf16 a[12:15], a[172:175], a[204:207], a[12:15]
s_add_u32 s31, s31, 262144
ds_read_b64_tr_b16 a[246:247], v10 offset:1024
v_mfma_f32_16x16x32_bf16 a[16:19], a[172:175], a[208:211], a[16:19]
s_add_u32 s33, s33, 16384
v_mfma_f32_16x16x32_bf16 a[20:23], a[172:175], a[212:215], a[20:23]
s_and_b32 s33, s33, 65535
ds_read_b64_tr_b16 a[248:249], v11 offset:0
v_mfma_f32_16x16x32_bf16 a[24:27], a[172:175], a[216:219], a[24:27]
v_mfma_f32_16x16x32_bf16 a[28:31], a[172:175], a[220:223], a[28:31]
s_add_u32 s48, s48, s34
ds_read_b128 a[172:175], v3 offset:5120
v_mfma_f32_16x16x32_bf16 a[32:35], a[176:179], a[192:195], a[32:35]
s_add_u32 m0, s32, 16384
ds_read_b64_tr_b16 a[250:251], v11 offset:1024
v_mfma_f32_16x16x32_bf16 a[36:39], a[176:179], a[196:199], a[36:39]
buffer_load_dwordx4 v1, s[12:15], s48 offen lds
v_mfma_f32_16x16x32_bf16 a[40:43], a[176:179], a[200:203], a[40:43]
ds_read_b64_tr_b16 a[252:253], v12 offset:0
v_mfma_f32_16x16x32_bf16 a[44:47], a[176:179], a[204:207], a[44:47]
s_add_u32 s29, s29, s93
v_mfma_f32_16x16x32_bf16 a[48:51], a[176:179], a[208:211], a[48:51]
ds_read_b64_tr_b16 a[254:255], v12 offset:1024
v_mfma_f32_16x16x32_bf16 a[52:55], a[176:179], a[212:215], a[52:55]
buffer_store_dwordx4 v[112:115], v13, s[8:11], s29 offen sc1
v_mfma_f32_16x16x32_bf16 a[56:59], a[176:179], a[216:219], a[56:59]
s_add_u32 s48, s48, s34
ds_read_b128 v[28:31], v3 offset:13312
v_mfma_f32_16x16x32_bf16 a[60:63], a[176:179], a[220:223], a[60:63]
s_add_u32 m0, s32, 20480
ds_read_b128 a[176:179], v4 offset:8192
v_mfma_f32_16x16x32_bf16 a[64:67], a[180:183], a[192:195], a[64:67]
buffer_load_dwordx4 v1, s[12:15], s48 offen lds
v_mfma_f32_16x16x32_bf16 a[68:71], a[180:183], a[196:199], a[68:71]
v_add_u32 v5, 16384, v5
v_and_b32 v5, 65535, v5
v_mfma_f32_16x16x32_bf16 a[72:75], a[180:183], a[200:203], a[72:75]
v_xor_b32 v6, 16, v5
v_xor_b32 v7, 64, v5
v_mfma_f32_16x16x32_bf16 a[76:79], a[180:183], a[204:207], a[76:79]
v_xor_b32 v8, 80, v5
v_xor_b32 v9, 128, v5
v_mfma_f32_16x16x32_bf16 a[80:83], a[180:183], a[208:211], a[80:83]
v_xor_b32 v10, 144, v5
v_xor_b32 v11, 192, v5
v_mfma_f32_16x16x32_bf16 a[84:87], a[180:183], a[212:215], a[84:87]
s_add_u32 s48, s48, s34
v_xor_b32 v12, 208, v5
v_mfma_f32_16x16x32_bf16 a[88:91], a[180:183], a[216:219], a[88:91]
s_add_u32 m0, s32, 24576
v_mfma_f32_16x16x32_bf16 a[92:95], a[180:183], a[220:223], a[92:95]
buffer_load_dwordx4 v1, s[12:15], s48 offen lds
ds_read_b128 a[180:183], v3 offset:9216
v_mfma_f32_16x16x32_bf16 a[96:99], a[184:187], a[192:195], a[96:99]
v_mfma_f32_16x16x32_bf16 a[100:103], a[184:187], a[196:199], a[100:103]
v_mfma_f32_16x16x32_bf16 a[104:107], a[184:187], a[200:203], a[104:107]
v_mfma_f32_16x16x32_bf16 a[108:111], a[184:187], a[204:207], a[108:111]
v_mfma_f32_16x16x32_bf16 a[112:115], a[184:187], a[208:211], a[112:115]
s_add_u32 s48, s48, s34
v_mfma_f32_16x16x32_bf16 a[116:119], a[184:187], a[212:215], a[116:119]
s_add_u32 m0, s32, 28672
v_mfma_f32_16x16x32_bf16 a[120:123], a[184:187], a[216:219], a[120:123]
buffer_load_dwordx4 v1, s[12:15], s48 offen lds
v_mfma_f32_16x16x32_bf16 a[124:127], a[184:187], a[220:223], a[124:127]
s_add_u32 s30, s30, 128
ds_read_b128 a[184:187], v4 offset:12288
v_mfma_f32_16x16x32_bf16 a[128:131], a[188:191], a[192:195], a[128:131]
s_add_u32 s32, s32, 32768
s_add_u32 s29, s29, s44
v_add_u32 v3, 32768, v3
v_mfma_f32_16x16x32_bf16 a[132:135], a[188:191], a[196:199], a[132:135]
s_sub_u32 s48, s32, 98304
v_subrev_u32 v19, 98304, v3
v_mfma_f32_16x16x32_bf16 a[136:139], a[188:191], a[200:203], a[136:139]
s_cmp_ge_u32 s32, 163840
s_cselect_b32 s32, s48, s32
buffer_store_dwordx4 v[116:119], v13, s[8:11], s29 offen sc1
buffer_load_dword v15, v14, s[96:99], s100 offen
v_mfma_f32_16x16x32_bf16 a[140:143], a[188:191], a[204:207], a[140:143]
s_add_u32 s100, s100, 16384
v_cmp_le_u32 vcc, 163840, v3
v_mfma_f32_16x16x32_bf16 a[144:147], a[188:191], a[208:211], a[144:147]
s_nop 0
v_cndmask_b32 v3, v3, v19, vcc
v_mfma_f32_16x16x32_bf16 a[148:151], a[188:191], a[212:215], a[148:151]
v_xor_b32 v4, 64, v3
v_mfma_f32_16x16x32_bf16 a[152:155], a[188:191], a[216:219], a[152:155]
v_mfma_f32_16x16x32_bf16 a[156:159], a[188:191], a[220:223], a[156:159]
s_waitcnt vmcnt(24) lgkmcnt(0)
s_barrier
v_mfma_f32_16x16x32_bf16 v[160:163], a[160:163], a[224:227], v[160:163]
ds_read_b64_tr_b16 a[192:193], v5 offset:0
v_mfma_f32_16x16x32_bf16 v[164:167], a[160:163], a[228:231], v[164:167]
v_mfma_f32_16x16x32_bf16 v[168:171], a[160:163], a[232:235], v[168:171]
ds_read_b64_tr_b16 a[194:195], v5 offset:1024
v_mfma_f32_16x16x32_bf16 v[172:175], a[160:163], a[236:239], v[172:175]
s_add_u32 s37, s31, 0
v_mfma_f32_16x16x32_bf16 v[176:179], a[160:163], a[240:243], v[176:179]
s_add_u32 m0, s33, 0
ds_read_b64_tr_b16 a[196:197], v6 offset:0
v_mfma_f32_16x16x32_bf16 v[180:183], a[160:163], a[244:247], v[180:183]
buffer_load_dwordx4 v2, s[20:23], s37 offen  lds
v_mfma_f32_16x16x32_bf16 v[184:187], a[160:163], a[248:251], v[184:187]
ds_read_b64_tr_b16 a[198:199], v6 offset:1024
v_mfma_f32_16x16x32_bf16 v[188:191], a[160:163], a[252:255], v[188:191]
ds_read_b128 a[160:163], v3 offset:0
v_mfma_f32_16x16x32_bf16 v[192:195], a[164:167], a[224:227], v[192:195]
ds_read_b64_tr_b16 a[200:201], v7 offset:0
v_mfma_f32_16x16x32_bf16 v[196:199], a[164:167], a[228:231], v[196:199]
v_mfma_f32_16x16x32_bf16 v[200:203], a[164:167], a[232:235], v[200:203]
s_add_u32 s37, s31, 32768
ds_read_b64_tr_b16 a[202:203], v7 offset:1024
v_mfma_f32_16x16x32_bf16 v[204:207], a[164:167], a[236:239], v[204:207]
s_add_u32 m0, s33, 1024
v_mfma_f32_16x16x32_bf16 v[208:211], a[164:167], a[240:243], v[208:211]
buffer_load_dwordx4 v2, s[20:23], s37 offen  lds
v_mfma_f32_16x16x32_bf16 v[212:215], a[164:167], a[244:247], v[212:215]
ds_read_b64_tr_b16 a[204:205], v8 offset:0
v_mfma_f32_16x16x32_bf16 v[216:219], a[164:167], a[248:251], v[216:219]
s_add_u32 s29, s29, s93
v_mfma_f32_16x16x32_bf16 v[220:223], a[164:167], a[252:255], v[220:223]
ds_read_b128 a[164:167], v4 offset:1024
v_mfma_f32_16x16x32_bf16 v[224:227], a[168:171], a[224:227], v[224:227]
buffer_store_dwordx4 v[120:123], v13, s[8:11], s29 offen sc1
v_mfma_f32_16x16x32_bf16 v[228:231], a[168:171], a[228:231], v[228:231]
s_add_u32 s37, s31, 131072
ds_read_b64_tr_b16 a[206:207], v8 offset:1024
v_mfma_f32_16x16x32_bf16 v[232:235], a[168:171], a[232:235], v[232:235]
s_add_u32 m0, s33, 4096
v_mfma_f32_16x16x32_bf16 v[236:239], a[168:171], a[236:239], v[236:239]
buffer_load_dwordx4 v2, s[20:23], s37 offen  lds
v_mfma_f32_16x16x32_bf16 v[240:243], a[168:171], a[240:243], v[240:243]
ds_read_b64_tr_b16 a[208:209], v9 offset:0
v_mfma_f32_16x16x32_bf16 v[244:247], a[168:171], a[244:247], v[244:247]
v_mfma_f32_16x16x32_bf16 v[248:251], a[168:171], a[248:251], v[248:251]
ds_read_b64_tr_b16 a[210:211], v9 offset:1024
v_mfma_f32_16x16x32_bf16 v[252:255], a[168:171], a[252:255], v[252:255]
ds_read_b128 a[168:171], v3 offset:4096
v_mfma_f32_16x16x32_bf16 a[0:3], a[172:175], a[224:227], a[0:3]
s_add_u32 s37, s31, 163840
ds_read_b64_tr_b16 a[212:213], v10 offset:0
v_mfma_f32_16x16x32_bf16 a[4:7], a[172:175], a[228:231], a[4:7]
s_add_u32 m0, s33, 5120
v_mfma_f32_16x16x32_bf16 a[8:11], a[172:175], a[232:235], a[8:11]
buffer_load_dwordx4 v2, s[20:23], s37 offen  lds
v_mfma_f32_16x16x32_bf16 a[12:15], a[172:175], a[236:239], a[12:15]
s_add_u32 s31, s31, 262144
ds_read_b64_tr_b16 a[214:215], v10 offset:1024
v_mfma_f32_16x16x32_bf16 a[16:19], a[172:175], a[240:243], a[16:19]
s_add_u32 s33, s33, 16384
v_mfma_f32_16x16x32_bf16 a[20:23], a[172:175], a[244:247], a[20:23]
s_and_b32 s33, s33, 65535
ds_read_b64_tr_b16 a[216:217], v11 offset:0
v_mfma_f32_16x16x32_bf16 a[24:27], a[172:175], a[248:251], a[24:27]
v_mfma_f32_16x16x32_bf16 a[28:31], a[172:175], a[252:255], a[28:31]
s_mov_b32 s48, s30
ds_read_b128 a[172:175], v4 offset:5120
v_mfma_f32_16x16x32_bf16 a[32:35], a[176:179], a[224:227], a[32:35]
s_add_u32 m0, s32, 0
ds_read_b64_tr_b16 a[218:219], v11 offset:1024
v_mfma_f32_16x16x32_bf16 a[36:39], a[176:179], a[228:231], a[36:39]
buffer_load_dwordx4 v1, s[12:15], s48 offen lds
v_mfma_f32_16x16x32_bf16 a[40:43], a[176:179], a[232:235], a[40:43]
ds_read_b64_tr_b16 a[220:221], v12 offset:0
v_mfma_f32_16x16x32_bf16 a[44:47], a[176:179], a[236:239], a[44:47]
s_add_u32 s29, s29, s44
v_mfma_f32_16x16x32_bf16 a[48:51], a[176:179], a[240:243], a[48:51]
ds_read_b64_tr_b16 a[222:223], v12 offset:1024
v_mfma_f32_16x16x32_bf16 a[52:55], a[176:179], a[244:247], a[52:55]
buffer_store_dwordx4 v[124:127], v13, s[8:11], s29 offen sc1
v_mfma_f32_16x16x32_bf16 a[56:59], a[176:179], a[248:251], a[56:59]
s_add_u32 s48, s48, s34
ds_read_b128 a[188:191], v4 offset:13312
v_mfma_f32_16x16x32_bf16 a[60:63], a[176:179], a[252:255], a[60:63]
s_add_u32 m0, s32, 4096
ds_read_b128 a[176:179], v3 offset:8192
v_mfma_f32_16x16x32_bf16 a[64:67], a[180:183], a[224:227], a[64:67]
buffer_load_dwordx4 v1, s[12:15], s48 offen lds
v_mfma_f32_16x16x32_bf16 a[68:71], a[180:183], a[228:231], a[68:71]
v_add_u32 v5, 16384, v5
v_and_b32 v5, 65535, v5
v_mfma_f32_16x16x32_bf16 a[72:75], a[180:183], a[232:235], a[72:75]
v_xor_b32 v6, 16, v5
v_xor_b32 v7, 64, v5
v_mfma_f32_16x16x32_bf16 a[76:79], a[180:183], a[236:239], a[76:79]
v_xor_b32 v8, 80, v5
v_xor_b32 v9, 128, v5
v_mfma_f32_16x16x32_bf16 a[80:83], a[180:183], a[240:243], a[80:83]
v_xor_b32 v10, 144, v5
v_xor_b32 v11, 192, v5
v_mfma_f32_16x16x32_bf16 a[84:87], a[180:183], a[244:247], a[84:87]
s_add_u32 s48, s48, s34
v_xor_b32 v12, 208, v5
v_mfma_f32_16x16x32_bf16 a[88:91], a[180:183], a[248:251], a[88:91]
s_add_u32 m0, s32, 8192
v_mfma_f32_16x16x32_bf16 a[92:95], a[180:183], a[252:255], a[92:95]
buffer_load_dwordx4 v1, s[12:15], s48 offen lds
ds_read_b128 a[180:183], v4 offset:9216
v_mfma_f32_16x16x32_bf16 a[96:99], a[184:187], a[224:227], a[96:99]
v_mfma_f32_16x16x32_bf16 a[100:103], a[184:187], a[228:231], a[100:103]
v_mfma_f32_16x16x32_bf16 a[104:107], a[184:187], a[232:235], a[104:107]
v_mfma_f32_16x16x32_bf16 a[108:111], a[184:187], a[236:239], a[108:111]
v_mfma_f32_16x16x32_bf16 a[112:115], a[184:187], a[240:243], a[112:115]
s_add_u32 s48, s48, s34
v_mfma_f32_16x16x32_bf16 a[116:119], a[184:187], a[244:247], a[116:119]
s_add_u32 m0, s32, 12288
v_mfma_f32_16x16x32_bf16 a[120:123], a[184:187], a[248:251], a[120:123]
buffer_load_dwordx4 v1, s[12:15], s48 offen lds
v_mfma_f32_16x16x32_bf16 a[124:127], a[184:187], a[252:255], a[124:127]
ds_read_b128 a[184:187], v3 offset:12288
v_mfma_f32_16x16x32_bf16 a[128:131], v[28:31], a[224:227], a[128:131]
v_mfma_f32_16x16x32_bf16 a[132:135], v[28:31], a[228:231], a[132:135]
v_mfma_f32_16x16x32_bf16 a[136:139], v[28:31], a[232:235], a[136:139]
buffer_load_dword v15, v14, s[96:99], s100 offen
v_mfma_f32_16x16x32_bf16 a[140:143], v[28:31], a[236:239], a[140:143]
s_add_u32 s100, s100, 16384
v_mfma_f32_16x16x32_bf16 a[144:147], v[28:31], a[240:243], a[144:147]
v_mfma_f32_16x16x32_bf16 a[148:151], v[28:31], a[244:247], a[148:151]
v_mfma_f32_16x16x32_bf16 a[152:155], v[28:31], a[248:251], a[152:155]
v_mfma_f32_16x16x32_bf16 a[156:159], v[28:31], a[252:255], a[156:159]
s_cmp_eq_u32 s36, 0
s_cbranch_scc1 L_g_v12
s_waitcnt vmcnt(23) lgkmcnt(0)
s_barrier
v_mfma_f32_16x16x32_bf16 v[160:163], a[160:163], a[192:195], v[160:163]
ds_read_b64_tr_b16 a[224:225], v5 offset:0
v_mfma_f32_16x16x32_bf16 v[164:167], a[160:163], a[196:199], v[164:167]
v_mfma_f32_16x16x32_bf16 v[168:171], a[160:163], a[200:203], v[168:171]
ds_read_b64_tr_b16 a[226:227], v5 offset:1024
v_mfma_f32_16x16x32_bf16 v[172:175], a[160:163], a[204:207], v[172:175]
s_add_u32 s37, s31, 0
v_mfma_f32_16x16x32_bf16 v[176:179], a[160:163], a[208:211], v[176:179]
s_add_u32 m0, s33, 0
ds_read_b64_tr_b16 a[228:229], v6 offset:0
v_mfma_f32_16x16x32_bf16 v[180:183], a[160:163], a[212:215], v[180:183]
buffer_load_dwordx4 v2, s[20:23], s37 offen  lds
v_mfma_f32_16x16x32_bf16 v[184:187], a[160:163], a[216:219], v[184:187]
ds_read_b64_tr_b16 a[230:231], v6 offset:1024
v_mfma_f32_16x16x32_bf16 v[188:191], a[160:163], a[220:223], v[188:191]
ds_read_b128 a[160:163], v4 offset:0
v_mfma_f32_16x16x32_bf16 v[192:195], a[164:167], a[192:195], v[192:195]
ds_read_b64_tr_b16 a[232:233], v7 offset:0
v_mfma_f32_16x16x32_bf16 v[196:199], a[164:167], a[196:199], v[196:199]
v_mfma_f32_16x16x32_bf16 v[200:203], a[164:167], a[200:203], v[200:203]
s_add_u32 s37, s31, 32768
ds_read_b64_tr_b16 a[234:235], v7 offset:1024
v_mfma_f32_16x16x32_bf16 v[204:207], a[164:167], a[204:207], v[204:207]
s_add_u32 m0, s33, 1024
v_mfma_f32_16x16x32_bf16 v[208:211], a[164:167], a[208:211], v[208:211]
buffer_load_dwordx4 v2, s[20:23], s37 offen  lds
v_mfma_f32_16x16x32_bf16 v[212:215], a[164:167], a[212:215], v[212:215]
ds_read_b64_tr_b16 a[236:237], v8 offset:0
v_mfma_f32_16x16x32_bf16 v[216:219], a[164:167], a[216:219], v[216:219]
v_mfma_f32_16x16x32_bf16 v[220:223], a[164:167], a[220:223], v[220:223]
ds_read_b128 a[164:167], v3 offset:1024
v_mfma_f32_16x16x32_bf16 v[224:227], a[168:171], a[192:195], v[224:227]
ds_read_b64_tr_b16 a[238:239], v8 offset:1024
v_mfma_f32_16x16x32_bf16 v[228:231], a[168:171], a[196:199], v[228:231]
s_add_u32 s37, s31, 131072
v_mfma_f32_16x16x32_bf16 v[232:235], a[168:171], a[200:203], v[232:235]
s_add_u32 m0, s33, 4096
ds_read_b64_tr_b16 a[240:241], v9 offset:0
v_mfma_f32_16x16x32_bf16 v[236:239], a[168:171], a[204:207], v[236:239]
buffer_load_dwordx4 v2, s[20:23], s37 offen  lds
v_mfma_f32_16x16x32_bf16 v[240:243], a[168:171], a[208:211], v[240:243]
ds_read_b64_tr_b16 a[242:243], v9 offset:1024
v_mfma_f32_16x16x32_bf16 v[244:247], a[168:171], a[212:215], v[244:247]
v_mfma_f32_16x16x32_bf16 v[248:251], a[168:171], a[216:219], v[248:251]
ds_read_b64_tr_b16 a[244:245], v10 offset:0
v_mfma_f32_16x16x32_bf16 v[252:255], a[168:171], a[220:223], v[252:255]
ds_read_b128 a[168:171], v4 offset:4096
v_mfma_f32_16x16x32_bf16 a[0:3], a[172:175], a[192:195], a[0:3]
s_add_u32 s37, s31, 163840
ds_read_b64_tr_b16 a[246:247], v10 offset:1024
v_mfma_f32_16x16x32_bf16 a[4:7], a[172:175], a[196:199], a[4:7]
s_add_u32 m0, s33, 5120
v_mfma_f32_16x16x32_bf16 a[8:11], a[172:175], a[200:203], a[8:11]
buffer_load_dwordx4 v2, s[20:23], s37 offen  lds
v_mfma_f32_16x16x32_bf16 a[12:15], a[172:175], a[204:207], a[12:15]
s_add_u32 s31, s31, 262144
ds_read_b64_tr_b16 a[248:249], v11 offset:0
v_mfma_f32_16x16x32_bf16 a[16:19], a[172:175], a[208:211], a[16:19]
s_add_u32 s33, s33, 16384
v_mfma_f32_16x16x32_bf16 a[20:23], a[172:175], a[212:215], a[20:23]
s_and_b32 s33, s33, 65535
ds_read_b64_tr_b16 a[250:251], v11 offset:1024
v_mfma_f32_16x16x32_bf16 a[24:27], a[172:175], a[216:219], a[24:27]
v_mfma_f32_16x16x32_bf16 a[28:31], a[172:175], a[220:223], a[28:31]
s_add_u32 s48, s48, s34
ds_read_b128 a[172:175], v3 offset:5120
v_mfma_f32_16x16x32_bf16 a[32:35], a[176:179], a[192:195], a[32:35]
s_add_u32 m0, s32, 16384
ds_read_b64_tr_b16 a[252:253], v12 offset:0
v_mfma_f32_16x16x32_bf16 a[36:39], a[176:179], a[196:199], a[36:39]
buffer_load_dwordx4 v1, s[12:15], s48 offen lds
v_mfma_f32_16x16x32_bf16 a[40:43], a[176:179], a[200:203], a[40:43]
ds_read_b64_tr_b16 a[254:255], v12 offset:1024
v_mfma_f32_16x16x32_bf16 a[44:47], a[176:179], a[204:207], a[44:47]
v_mfma_f32_16x16x32_bf16 a[48:51], a[176:179], a[208:211], a[48:51]
ds_read_b128 v[28:31], v3 offset:13312
v_mfma_f32_16x16x32_bf16 a[52:55], a[176:179], a[212:215], a[52:55]
v_mfma_f32_16x16x32_bf16 a[56:59], a[176:179], a[216:219], a[56:59]
s_add_u32 s48, s48, s34
v_mfma_f32_16x16x32_bf16 a[60:63], a[176:179], a[220:223], a[60:63]
s_add_u32 m0, s32, 20480
ds_read_b128 a[176:179], v4 offset:8192
v_add_u32 v5, 16384, v5
v_mfma_f32_16x16x32_bf16 a[64:67], a[180:183], a[192:195], a[64:67]
buffer_load_dwordx4 v1, s[12:15], s48 offen lds
v_and_b32 v5, 65535, v5
v_mfma_f32_16x16x32_bf16 a[68:71], a[180:183], a[196:199], a[68:71]
v_xor_b32 v6, 16, v5
v_xor_b32 v7, 64, v5
v_mfma_f32_16x16x32_bf16 a[72:75], a[180:183], a[200:203], a[72:75]
v_xor_b32 v8, 80, v5
v_xor_b32 v9, 128, v5
v_mfma_f32_16x16x32_bf16 a[76:79], a[180:183], a[204:207], a[76:79]
v_xor_b32 v10, 144, v5
v_xor_b32 v11, 192, v5
v_mfma_f32_16x16x32_bf16 a[80:83], a[180:183], a[208:211], a[80:83]
v_xor_b32 v12, 208, v5
v_mfma_f32_16x16x32_bf16 a[84:87], a[180:183], a[212:215], a[84:87]
s_add_u32 s48, s48, s34
v_mfma_f32_16x16x32_bf16 a[88:91], a[180:183], a[216:219], a[88:91]
s_add_u32 m0, s32, 24576
v_mfma_f32_16x16x32_bf16 a[92:95], a[180:183], a[220:223], a[92:95]
buffer_load_dwordx4 v1, s[12:15], s48 offen lds
ds_read_b128 a[180:183], v3 offset:9216
v_mfma_f32_16x16x32_bf16 a[96:99], a[184:187], a[192:195], a[96:99]
v_mfma_f32_16x16x32_bf16 a[100:103], a[184:187], a[196:199], a[100:103]
v_mfma_f32_16x16x32_bf16 a[104:107], a[184:187], a[200:203], a[104:107]
v_mfma_f32_16x16x32_bf16 a[108:111], a[184:187], a[204:207], a[108:111]
v_mfma_f32_16x16x32_bf16 a[112:115], a[184:187], a[208:211], a[112:115]
s_add_u32 s48, s48, s34
v_mfma_f32_16x16x32_bf16 a[116:119], a[184:187], a[212:215], a[116:119]
s_add_u32 m0, s32, 28672
v_mfma_f32_16x16x32_bf16 a[120:123], a[184:187], a[216:219], a[120:123]
buffer_load_dwordx4 v1, s[12:15], s48 offen lds
v_mfma_f32_16x16x32_bf16 a[124:127], a[184:187], a[220:223], a[124:127]
s_add_u32 s30, s30, 128
ds_read_b128 a[184:187], v4 offset:12288
v_mfma_f32_16x16x32_bf16 a[128:131], a[188:191], a[192:195], a[128:131]
s_add_u32 s32, s32, 32768
v_add_u32 v3, 32768, v3
v_mfma_f32_16x16x32_bf16 a[132:135], a[188:191], a[196:199], a[132:135]
s_sub_u32 s48, s32, 98304
v_subrev_u32 v19, 98304, v3
v_mfma_f32_16x16x32_bf16 a[136:139], a[188:191], a[200:203], a[136:139]
s_cmp_ge_u32 s32, 163840
s_cselect_b32 s32, s48, s32
v_mfma_f32_16x16x32_bf16 a[140:143], a[188:191], a[204:207], a[140:143]
v_cmp_le_u32 vcc, 163840, v3
v_mfma_f32_16x16x32_bf16 a[144:147], a[188:191], a[208:211], a[144:147]
s_nop 0
v_cndmask_b32 v3, v3, v19, vcc
v_mfma_f32_16x16x32_bf16 a[148:151], a[188:191], a[212:215], a[148:151]
v_xor_b32 v4, 64, v3
v_mfma_f32_16x16x32_bf16 a[152:155], a[188:191], a[216:219], a[152:155]
v_mfma_f32_16x16x32_bf16 a[156:159], a[188:191], a[220:223], a[156:159]
s_waitcnt vmcnt(19) lgkmcnt(0)
s_barrier
v_mfma_f32_16x16x32_bf16 v[160:163], a[160:163], a[224:227], v[160:163]
ds_read_b64_tr_b16 a[192:193], v5 offset:0
v_mfma_f32_16x16x32_bf16 v[164:167], a[160:163], a[228:231], v[164:167]
v_mfma_f32_16x16x32_bf16 v[168:171], a[160:163], a[232:235], v[168:171]
ds_read_b64_tr_b16 a[194:195], v5 offset:1024
v_mfma_f32_16x16x32_bf16 v[172:175], a[160:163], a[236:239], v[172:175]
s_add_u32 s37, s31, 0
v_mfma_f32_16x16x32_bf16 v[176:179], a[160:163], a[240:243], v[176:179]
s_add_u32 m0, s33, 0
ds_read_b64_tr_b16 a[196:197], v6 offset:0
v_mfma_f32_16x16x32_bf16 v[180:183], a[160:163], a[244:247], v[180:183]
buffer_load_dwordx4 v2, s[20:23], s37 offen  lds
v_mfma_f32_16x16x32_bf16 v[184:187], a[160:163], a[248:251], v[184:187]
ds_read_b64_tr_b16 a[198:199], v6 offset:1024
v_mfma_f32_16x16x32_bf16 v[188:191], a[160:163], a[252:255], v[188:191]
ds_read_b128 a[160:163], v3 offset:0
v_mfma_f32_16x16x32_bf16 v[192:195], a[164:167], a[224:227], v[192:195]
ds_read_b64_tr_b16 a[200:201], v7 offset:0
v_mfma_f32_16x16x32_bf16 v[196:199], a[164:167], a[228:231], v[196:199]
v_mfma_f32_16x16x32_bf16 v[200:203], a[164:167], a[232:235], v[200:203]
s_add_u32 s37, s31, 32768
ds_read_b64_tr_b16 a[202:203], v7 offset:1024
v_mfma_f32_16x16x32_bf16 v[204:207], a[164:167], a[236:239], v[204:207]
s_add_u32 m0, s33, 1024
v_mfma_f32_16x16x32_bf16 v[208:211], a[164:167], a[240:243], v[208:211]
buffer_load_dwordx4 v2, s[20:23], s37 offen  lds
v_mfma_f32_16x16x32_bf16 v[212:215], a[164:167], a[244:247], v[212:215]
ds_read_b64_tr_b16 a[204:205], v8 offset:0
v_mfma_f32_16x16x32_bf16 v[216:219], a[164:167], a[248:251], v[216:219]
v_mfma_f32_16x16x32_bf16 v[220:223], a[164:167], a[252:255], v[220:223]
ds_read_b128 a[164:167], v4 offset:1024
v_mfma_f32_16x16x32_bf16 v[224:227], a[168:171], a[224:227], v[224:227]
ds_read_b64_tr_b16 a[206:207], v8 offset:1024
v_mfma_f32_16x16x32_bf16 v[228:231], a[168:171], a[228:231], v[228:231]
s_add_u32 s37, s31, 131072
v_mfma_f32_16x16x32_bf16 v[232:235], a[168:171], a[232:235], v[232:235]
s_add_u32 m0, s33, 4096
ds_read_b64_tr_b16 a[208:209], v9 offset:0
v_mfma_f32_16x16x32_bf16 v[236:239], a[168:171], a[236:239], v[236:239]
buffer_load_dwordx4 v2, s[20:23], s37 offen  lds
v_mfma_f32_16x16x32_bf16 v[240:243], a[168:171], a[240:243], v[240:243]
ds_read_b64_tr_b16 a[210:211], v9 offset:1024
v_mfma_f32_16x16x32_bf16 v[244:247], a[168:171], a[244:247], v[244:247]
v_mfma_f32_16x16x32_bf16 v[248:251], a[168:171], a[248:251], v[248:251]
ds_read_b64_tr_b16 a[212:213], v10 offset:0
v_mfma_f32_16x16x32_bf16 v[252:255], a[168:171], a[252:255], v[252:255]
ds_read_b128 a[168:171], v3 offset:4096
v_mfma_f32_16x16x32_bf16 a[0:3], a[172:175], a[224:227], a[0:3]
s_add_u32 s37, s31, 163840
ds_read_b64_tr_b16 a[214:215], v10 offset:1024
v_mfma_f32_16x16x32_bf16 a[4:7], a[172:175], a[228:231], a[4:7]
s_add_u32 m0, s33, 5120
v_mfma_f32_16x16x32_bf16 a[8:11], a[172:175], a[232:235], a[8:11]
buffer_load_dwordx4 v2, s[20:23], s37 offen  lds
v_mfma_f32_16x16x32_bf16 a[12:15], a[172:175], a[236:239], a[12:15]
s_add_u32 s31, s31, 262144
ds_read_b64_tr_b16 a[216:217], v11 offset:0
v_mfma_f32_16x16x32_bf16 a[16:19], a[172:175], a[240:243], a[16:19]
s_add_u32 s33, s33, 16384
v_mfma_f32_16x16x32_bf16 a[20:23], a[172:175], a[244:247], a[20:23]
s_and_b32 s33, s33, 65535
ds_read_b64_tr_b16 a[218:219], v11 offset:1024
v_mfma_f32_16x16x32_bf16 a[24:27], a[172:175], a[248:251], a[24:27]
v_mfma_f32_16x16x32_bf16 a[28:31], a[172:175], a[252:255], a[28:31]
s_mov_b32 s48, s30
ds_read_b128 a[172:175], v4 offset:5120
v_mfma_f32_16x16x32_bf16 a[32:35], a[176:179], a[224:227], a[32:35]
s_add_u32 m0, s32, 0
ds_read_b64_tr_b16 a[220:221], v12 offset:0
v_mfma_f32_16x16x32_bf16 a[36:39], a[176:179], a[228:231], a[36:39]
buffer_load_dwordx4 v1, s[12:15], s48 offen lds
v_mfma_f32_16x16x32_bf16 a[40:43], a[176:179], a[232:235], a[40:43]
ds_read_b64_tr_b16 a[222:223], v12 offset:1024
v_mfma_f32_16x16x32_bf16 a[44:47], a[176:179], a[236:239], a[44:47]
v_mfma_f32_16x16x32_bf16 a[48:51], a[176:179], a[240:243], a[48:51]
ds_read_b128 a[188:191], v4 offset:13312
v_mfma_f32_16x16x32_bf16 a[52:55], a[176:179], a[244:247], a[52:55]
v_mfma_f32_16x16x32_bf16 a[56:59], a[176:179], a[248:251], a[56:59]
s_add_u32 s48, s48, s34
v_mfma_f32_16x16x32_bf16 a[60:63], a[176:179], a[252:255], a[60:63]
s_add_u32 m0, s32, 4096
ds_read_b128 a[176:179], v3 offset:8192
v_add_u32 v5, 16384, v5
v_mfma_f32_16x16x32_bf16 a[64:67], a[180:183], a[224:227], a[64:67]
buffer_load_dwordx4 v1, s[12:15], s48 offen lds
v_and_b32 v5, 65535, v5
v_mfma_f32_16x16x32_bf16 a[68:71], a[180:183], a[228:231], a[68:71]
v_xor_b32 v6, 16, v5
v_xor_b32 v7, 64, v5
v_mfma_f32_16x16x32_bf16 a[72:75], a[180:183], a[232:235], a[72:75]
v_xor_b32 v8, 80, v5
v_xor_b32 v9, 128, v5
v_mfma_f32_16x16x32_bf16 a[76:79], a[180:183], a[236:239], a[76:79]
v_xor_b32 v10, 144, v5
v_xor_b32 v11, 192, v5
v_mfma_f32_16x16x32_bf16 a[80:83], a[180:183], a[240:243], a[80:83]
v_xor_b32 v12, 208, v5
v_mfma_f32_16x16x32_bf16 a[84:87], a[180:183], a[244:247], a[84:87]
s_add_u32 s48, s48, s34
v_mfma_f32_16x16x32_bf16 a[88:91], a[180:183], a[248:251], a[88:91]
s_add_u32 m0, s32, 8192
v_mfma_f32_16x16x32_bf16 a[92:95], a[180:183], a[252:255], a[92:95]
buffer_load_dwordx4 v1, s[12:15], s48 offen lds
ds_read_b128 a[180:183], v4 offset:9216
v_mfma_f32_16x16x32_bf16 a[96:99], a[184:187], a[224:227], a[96:99]
v_mfma_f32_16x16x32_bf16 a[100:103], a[184:187], a[228:231], a[100:103]
v_mfma_f32_16x16x32_bf16 a[104:107], a[184:187], a[232:235], a[104:107]
v_mfma_f32_16x16x32_bf16 a[108:111], a[184:187], a[236:239], a[108:111]
v_mfma_f32_16x16x32_bf16 a[112:115], a[184:187], a[240:243], a[112:115]
s_add_u32 s48, s48, s34
v_mfma_f32_16x16x32_bf16 a[116:119], a[184:187], a[244:247], a[116:119]
s_add_u32 m0, s32, 12288
v_mfma_f32_16x16x32_bf16 a[120:123], a[184:187], a[248:251], a[120:123]
buffer_load_dwordx4 v1, s[12:15], s48 offen lds
v_mfma_f32_16x16x32_bf16 a[124:127], a[184:187], a[252:255], a[124:127]
ds_read_b128 a[184:187], v3 offset:12288
v_mfma_f32_16x16x32_bf16 a[128:131], v[28:31], a[224:227], a[128:131]
v_mfma_f32_16x16x32_bf16 a[132:135], v[28:31], a[228:231], a[132:135]
v_mfma_f32_16x16x32_bf16 a[136:139], v[28:31], a[232:235], a[136:139]
v_mfma_f32_16x16x32_bf16 a[140:143], v[28:31], a[236:239], a[140:143]
v_mfma_f32_16x16x32_bf16 a[144:147], v[28:31], a[240:243], a[144:147]
v_mfma_f32_16x16x32_bf16 a[148:151], v[28:31], a[244:247], a[148:151]
v_mfma_f32_16x16x32_bf16 a[152:155], v[28:31], a[248:251], a[152:155]
v_mfma_f32_16x16x32_bf16 a[156:159], v[28:31], a[252:255], a[156:159]
L_g_v12:
s_waitcnt vmcnt(16) lgkmcnt(0)
s_barrier
v_mfma_f32_16x16x32_bf16 v[160:163], a[160:163], a[192:195], v[160:163]
ds_read_b64_tr_b16 a[224:225], v5 offset:0
s_lshr_b32 s24, s16, 1
v_mfma_f32_16x16x32_bf16 v[164:167], a[160:163], a[196:199], v[164:167]
s_cmp_eq_u32 s35, 5
s_cselect_b32 s90, s24, s90
v_mfma_f32_16x16x32_bf16 v[168:171], a[160:163], a[200:203], v[168:171]
ds_read_b64_tr_b16 a[226:227], v5 offset:1024
s_lshl_b32 s24, s35, 2
v_mfma_f32_16x16x32_bf16 v[172:175], a[160:163], a[204:207], v[172:175]
s_add_u32 s37, s31, 0
s_lshr_b32 s26, s88, s24
s_bfe_u32 s2, s26, 0x10003
v_mfma_f32_16x16x32_bf16 v[176:179], a[160:163], a[208:211], v[176:179]
s_add_u32 m0, s33, 0
ds_read_b64_tr_b16 a[228:229], v6 offset:0
s_and_b32 s26, s26, 7
v_mfma_f32_16x16x32_bf16 v[180:183], a[160:163], a[212:215], v[180:183]
buffer_load_dwordx4 v2, s[20:23], s37 offen  lds
s_or_b32 s40, s2, s61
v_mfma_f32_16x16x32_bf16 v[184:187], a[160:163], a[216:219], v[184:187]
ds_read_b64_tr_b16 a[230:231], v6 offset:1024
s_lshr_b32 s24, s17, 1
v_mfma_f32_16x16x32_bf16 v[188:191], a[160:163], a[220:223], v[188:191]
ds_read_b128 a[160:163], v4 offset:0
v_mfma_f32_16x16x32_bf16 v[192:195], a[164:167], a[192:195], v[192:195]
ds_read_b64_tr_b16 a[232:233], v7 offset:0
v_mfma_f32_16x16x32_bf16 v[196:199], a[164:167], a[196:199], v[196:199]
s_cmp_eq_u32 s2, 0
s_cselect_b32 s41, s24, 0
s_cselect_b32 s27, s89, s90
v_mfma_f32_16x16x32_bf16 v[200:203], a[164:167], a[200:203], v[200:203]
s_add_u32 s37, s31, 32768
ds_read_b64_tr_b16 a[234:235], v7 offset:1024
s_sub_u32 s25, s24, s41
v_mfma_f32_16x16x32_bf16 v[204:207], a[164:167], a[204:207], v[204:207]
s_add_u32 m0, s33, 1024
s_and_b32 s51, s41, s61
s_lshl_b32 s51, s51, 1
v_mfma_f32_16x16x32_bf16 v[208:211], a[164:167], a[208:211], v[208:211]
buffer_load_dwordx4 v2, s[20:23], s37 offen  lds
s_or_b32 s51, s51, s41
v_mfma_f32_16x16x32_bf16 v[212:215], a[164:167], a[212:215], v[212:215]
ds_read_b64_tr_b16 a[236:237], v8 offset:0
s_lshl_b32 s46, s27, s2
v_mfma_f32_16x16x32_bf16 v[216:219], a[164:167], a[216:219], v[216:219]
s_add_u32 s60, s60, s92
s_add_u32 s46, s46, s25
s_lshl_b32 s46, s46, 8
v_mfma_f32_16x16x32_bf16 v[220:223], a[164:167], a[220:223], v[220:223]
s_mov_b32 s29, s60
ds_read_b128 a[164:167], v3 offset:1024
s_lshl_b32 s47, s40, 7
v_mfma_f32_16x16x32_bf16 v[224:227], a[168:171], a[192:195], v[224:227]
buffer_store_dwordx4 v[128:131], v13, s[8:11], s29 offen sc1
s_add_u32 s47, s47, 1024
v_mfma_f32_16x16x32_bf16 v[228:231], a[168:171], a[196:199], v[228:231]
s_add_u32 s37, s31, 131072
ds_read_b64_tr_b16 a[238:239], v8 offset:1024
s_mul_i32 s101, s26, s47
v_mfma_f32_16x16x32_bf16 v[232:235], a[168:171], a[200:203], v[232:235]
s_add_u32 m0, s33, 4096
s_lshl_b32 s101, s101, 8
s_lshl_b32 s42, s27, 3
v_mfma_f32_16x16x32_bf16 v[236:239], a[168:171], a[204:207], v[236:239]
buffer_load_dwordx4 v2, s[20:23], s37 offen  lds
s_add_u32 s42, s42, s26
v_mfma_f32_16x16x32_bf16 v[240:243], a[168:171], a[208:211], v[240:243]
ds_read_b64_tr_b16 a[240:241], v9 offset:0
s_lshl_b32 s42, s42, 1
v_mfma_f32_16x16x32_bf16 v[244:247], a[168:171], a[212:215], v[244:247]
s_and_b32 s25, s17, 1
s_add_u32 s42, s42, s25
s_lshl_b32 s42, s42, 3
v_mfma_f32_16x16x32_bf16 v[248:251], a[168:171], a[216:219], v[248:251]
ds_read_b64_tr_b16 a[242:243], v9 offset:1024
s_add_u32 s42, s42, s24
v_mfma_f32_16x16x32_bf16 v[252:255], a[168:171], a[220:223], v[252:255]
ds_read_b128 a[168:171], v4 offset:4096
s_lshl_b32 s42, s42, 13
v_mfma_f32_16x16x32_bf16 a[0:3], a[172:175], a[192:195], a[0:3]
s_add_u32 s37, s31, 163840
ds_read_b64_tr_b16 a[244:245], v10 offset:0
s_lshl_b32 s43, s27, 5
v_mfma_f32_16x16x32_bf16 a[4:7], a[172:175], a[196:199], a[4:7]
s_add_u32 m0, s33, 5120
s_add_u32 s43, s43, s26
s_lshl_b32 s43, s43, 2
v_mfma_f32_16x16x32_bf16 a[8:11], a[172:175], a[200:203], a[8:11]
buffer_load_dwordx4 v2, s[20:23], s37 offen  lds
s_lshl_b32 s24, s2, 1
v_mfma_f32_16x16x32_bf16 a[12:15], a[172:175], a[204:207], a[12:15]
s_add_u32 s31, s31, 262144
ds_read_b64_tr_b16 a[246:247], v10 offset:1024
s_add_u32 s24, s24, s61
v_mfma_f32_16x16x32_bf16 a[16:19], a[172:175], a[208:211], a[16:19]
s_add_u32 s33, s33, 16384
s_lshl_b32 s24, s24, 2
s_lshr_b32 s25, 0x8720, s24
v_mfma_f32_16x16x32_bf16 a[20:23], a[172:175], a[212:215], a[20:23]
s_and_b32 s33, s33, 65535
ds_read_b64_tr_b16 a[248:249], v11 offset:0
s_and_b32 s25, s25, 15
v_mfma_f32_16x16x32_bf16 a[24:27], a[172:175], a[216:219], a[24:27]
s_lshl_b32 s25, s25, 24
s_add_u32 s42, s42, s25
s_lshr_b32 s25, 0x7604, s24
v_mfma_f32_16x16x32_bf16 a[28:31], a[172:175], a[220:223], a[28:31]
s_add_u32 s48, s48, s34
ds_read_b128 a[172:175], v3 offset:5120
s_and_b32 s25, s25, 15
v_mfma_f32_16x16x32_bf16 a[32:35], a[176:179], a[192:195], a[32:35]
s_add_u32 m0, s32, 16384
ds_read_b64_tr_b16 a[250:251], v11 offset:1024
s_lshl_b32 s25, s25, 12
v_mfma_f32_16x16x32_bf16 a[36:39], a[176:179], a[196:199], a[36:39]
buffer_load_dwordx4 v1, s[12:15], s48 offen lds
s_add_u32 s43, s43, s25
v_mfma_f32_16x16x32_bf16 a[40:43], a[176:179], a[200:203], a[40:43]
ds_read_b64_tr_b16 a[252:253], v12 offset:0
s_add_u32 s43, s43, 111149056
v_mfma_f32_16x16x32_bf16 a[44:47], a[176:179], a[204:207], a[44:47]
s_add_u32 s29, s29, s44
v_mfma_f32_16x16x32_bf16 a[48:51], a[176:179], a[208:211], a[48:51]
ds_read_b64_tr_b16 a[254:255], v12 offset:1024
v_mfma_f32_16x16x32_bf16 a[52:55], a[176:179], a[212:215], a[52:55]
buffer_store_dwordx4 v[132:135], v13, s[8:11], s29 offen sc1
v_mfma_f32_16x16x32_bf16 a[56:59], a[176:179], a[216:219], a[56:59]
s_add_u32 s48, s48, s34
ds_read_b128 v[28:31], v3 offset:13312
v_mfma_f32_16x16x32_bf16 a[60:63], a[176:179], a[220:223], a[60:63]
s_add_u32 m0, s32, 20480
ds_read_b128 a[176:179], v4 offset:8192
v_mfma_f32_16x16x32_bf16 a[64:67], a[180:183], a[192:195], a[64:67]
buffer_load_dwordx4 v1, s[12:15], s48 offen lds
v_mfma_f32_16x16x32_bf16 a[68:71], a[180:183], a[196:199], a[68:71]
s_cmp_lt_u32 s35, s45
s_cselect_b32 s101, s101, 536870912
s_cselect_b32 s46, s46, 536870912
v_mfma_f32_16x16x32_bf16 a[72:75], a[180:183], a[200:203], a[72:75]
v_add_u32 v5, 16384, v5
v_and_b32 v5, 65535, v5
v_mfma_f32_16x16x32_bf16 a[76:79], a[180:183], a[204:207], a[76:79]
v_xor_b32 v6, 16, v5
v_xor_b32 v7, 64, v5
v_mfma_f32_16x16x32_bf16 a[80:83], a[180:183], a[208:211], a[80:83]
v_xor_b32 v8, 80, v5
v_xor_b32 v9, 128, v5
v_mfma_f32_16x16x32_bf16 a[84:87], a[180:183], a[212:215], a[84:87]
s_add_u32 s48, s48, s34
v_xor_b32 v10, 144, v5
v_xor_b32 v11, 192, v5
v_mfma_f32_16x16x32_bf16 a[88:91], a[180:183], a[216:219], a[88:91]
s_add_u32 m0, s32, 24576
v_xor_b32 v12, 208, v5
v_mfma_f32_16x16x32_bf16 a[92:95], a[180:183], a[220:223], a[92:95]
buffer_load_dwordx4 v1, s[12:15], s48 offen lds
ds_read_b128 a[180:183], v3 offset:9216
v_mfma_f32_16x16x32_bf16 a[96:99], a[184:187], a[192:195], a[96:99]
v_mfma_f32_16x16x32_bf16 a[100:103], a[184:187], a[196:199], a[100:103]
v_mfma_f32_16x16x32_bf16 a[104:107], a[184:187], a[200:203], a[104:107]
v_mfma_f32_16x16x32_bf16 a[108:111], a[184:187], a[204:207], a[108:111]
v_mfma_f32_16x16x32_bf16 a[112:115], a[184:187], a[208:211], a[112:115]
s_add_u32 s48, s48, s34
v_mfma_f32_16x16x32_bf16 a[116:119], a[184:187], a[212:215], a[116:119]
s_add_u32 m0, s32, 28672
v_mfma_f32_16x16x32_bf16 a[120:123], a[184:187], a[216:219], a[120:123]
buffer_load_dwordx4 v1, s[12:15], s48 offen lds
v_mfma_f32_16x16x32_bf16 a[124:127], a[184:187], a[220:223], a[124:127]
s_add_u32 s30, s30, 128
ds_read_b128 a[184:187], v4 offset:12288
v_mfma_f32_16x16x32_bf16 a[128:131], a[188:191], a[192:195], a[128:131]
s_add_u32 s32, s32, 32768
s_add_u32 s29, s29, s93
v_add_u32 v3, 32768, v3
v_mfma_f32_16x16x32_bf16 a[132:135], a[188:191], a[196:199], a[132:135]
s_sub_u32 s48, s32, 98304
v_subrev_u32 v19, 98304, v3
v_mfma_f32_16x16x32_bf16 a[136:139], a[188:191], a[200:203], a[136:139]
s_cmp_ge_u32 s32, 163840
s_cselect_b32 s32, s48, s32
buffer_store_dwordx4 v[136:139], v13, s[8:11], s29 offen sc1
buffer_load_dword v15, v14, s[96:99], s100 offen
v_mfma_f32_16x16x32_bf16 a[140:143], a[188:191], a[204:207], a[140:143]
s_add_u32 s100, s100, 16384
v_cmp_le_u32 vcc, 163840, v3
v_mfma_f32_16x16x32_bf16 a[144:147], a[188:191], a[208:211], a[144:147]
s_nop 0
v_cndmask_b32 v3, v3, v19, vcc
v_mfma_f32_16x16x32_bf16 a[148:151], a[188:191], a[212:215], a[148:151]
v_xor_b32 v4, 64, v3
v_mfma_f32_16x16x32_bf16 a[152:155], a[188:191], a[216:219], a[152:155]
v_mfma_f32_16x16x32_bf16 a[156:159], a[188:191], a[220:223], a[156:159]
s_waitcnt vmcnt(20) lgkmcnt(0)
s_barrier
v_mfma_f32_16x16x32_bf16 v[160:163], a[160:163], a[224:227], v[160:163]
ds_read_b64_tr_b16 a[192:193], v5 offset:0
v_mfma_f32_16x16x32_bf16 v[164:167], a[160:163], a[228:231], v[164:167]
s_cmp_eq_u32 s2, 0
s_cselect_b64 s[4:5], s[52:53], s[54:55]
v_mfma_f32_16x16x32_bf16 v[168:171], a[160:163], a[232:235], v[168:171]
ds_read_b64_tr_b16 a[194:195], v5 offset:1024
s_mov_b32 s12, s4
v_mfma_f32_16x16x32_bf16 v[172:175], a[160:163], a[236:239], v[172:175]
s_add_u32 s37, s31, 0
s_and_b32 s13, s5, 0xffff
s_lshl_b32 s14, s47, 11
v_mfma_f32_16x16x32_bf16 v[176:179], a[160:163], a[240:243], v[176:179]
s_add_u32 m0, s33, 0
ds_read_b64_tr_b16 a[196:197], v6 offset:0
s_mov_b32 s15, 0x20000
v_mfma_f32_16x16x32_bf16 v[180:183], a[160:163], a[244:247], v[180:183]
buffer_load_dwordx4 v2, s[20:23], s37 offen  lds
s_mov_b32 s30, s101
v_mfma_f32_16x16x32_bf16 v[184:187], a[160:163], a[248:251], v[184:187]
ds_read_b64_tr_b16 a[198:199], v6 offset:1024
v_lshrrev_b32 v16, 3, v0
v_mfma_f32_16x16x32_bf16 v[188:191], a[160:163], a[252:255], v[188:191]
ds_read_b128 a[160:163], v3 offset:0
v_mul_lo_u32 v16, v16, s47
v_mfma_f32_16x16x32_bf16 v[192:195], a[164:167], a[224:227], v[192:195]
ds_read_b64_tr_b16 a[200:201], v7 offset:0
v_and_b32 v1, 0x70, v1
v_mfma_f32_16x16x32_bf16 v[196:199], a[164:167], a[228:231], v[196:199]
v_add_u32 v1, v1, v16
s_lshl_b32 s34, s47, 5
v_mfma_f32_16x16x32_bf16 v[200:203], a[164:167], a[232:235], v[200:203]
s_add_u32 s37, s31, 32768
ds_read_b64_tr_b16 a[202:203], v7 offset:1024
v_mfma_f32_16x16x32_bf16 v[204:207], a[164:167], a[236:239], v[204:207]
s_add_u32 m0, s33, 1024
v_mfma_f32_16x16x32_bf16 v[208:211], a[164:167], a[240:243], v[208:211]
buffer_load_dwordx4 v2, s[20:23], s37 offen  lds
v_mfma_f32_16x16x32_bf16 v[212:215], a[164:167], a[244:247], v[212:215]
ds_read_b64_tr_b16 a[204:205], v8 offset:0
v_mfma_f32_16x16x32_bf16 v[216:219], a[164:167], a[248:251], v[216:219]
s_add_u32 s29, s29, s44
v_mfma_f32_16x16x32_bf16 v[220:223], a[164:167], a[252:255], v[220:223]
ds_read_b128 a[164:167], v4 offset:1024
v_mfma_f32_16x16x32_bf16 v[224:227], a[168:171], a[224:227], v[224:227]
buffer_store_dwordx4 v[140:143], v13, s[8:11], s29 offen sc1
v_mfma_f32_16x16x32_bf16 v[228:231], a[168:171], a[228:231], v[228:231]
s_add_u32 s37, s31, 131072
ds_read_b64_tr_b16 a[206:207], v8 offset:1024
v_mfma_f32_16x16x32_bf16 v[232:235], a[168:171], a[232:235], v[232:235]
s_add_u32 m0, s33, 4096
v_mfma_f32_16x16x32_bf16 v[236:239], a[168:171], a[236:239], v[236:239]
buffer_load_dwordx4 v2, s[20:23], s37 offen  lds
v_mfma_f32_16x16x32_bf16 v[240:243], a[168:171], a[240:243], v[240:243]
ds_read_b64_tr_b16 a[208:209], v9 offset:0
v_mfma_f32_16x16x32_bf16 v[244:247], a[168:171], a[244:247], v[244:247]
v_mfma_f32_16x16x32_bf16 v[248:251], a[168:171], a[248:251], v[248:251]
ds_read_b64_tr_b16 a[210:211], v9 offset:1024
v_mfma_f32_16x16x32_bf16 v[252:255], a[168:171], a[252:255], v[252:255]
ds_read_b128 a[168:171], v3 offset:4096
v_mfma_f32_16x16x32_bf16 a[0:3], a[172:175], a[224:227], a[0:3]
s_add_u32 s37, s31, 163840
ds_read_b64_tr_b16 a[212:213], v10 offset:0
v_mfma_f32_16x16x32_bf16 a[4:7], a[172:175], a[228:231], a[4:7]
s_add_u32 m0, s33, 5120
v_mfma_f32_16x16x32_bf16 a[8:11], a[172:175], a[232:235], a[8:11]
buffer_load_dwordx4 v2, s[20:23], s37 offen  lds
v_mfma_f32_16x16x32_bf16 a[12:15], a[172:175], a[236:239], a[12:15]
s_add_u32 s31, s31, 262144
ds_read_b64_tr_b16 a[214:215], v10 offset:1024
v_mfma_f32_16x16x32_bf16 a[16:19], a[172:175], a[240:243], a[16:19]
s_add_u32 s33, s33, 16384
v_mfma_f32_16x16x32_bf16 a[20:23], a[172:175], a[244:247], a[20:23]
s_and_b32 s33, s33, 65535
ds_read_b64_tr_b16 a[216:217], v11 offset:0
v_mfma_f32_16x16x32_bf16 a[24:27], a[172:175], a[248:251], a[24:27]
v_mfma_f32_16x16x32_bf16 a[28:31], a[172:175], a[252:255], a[28:31]
s_mov_b32 s48, s30
ds_read_b128 a[172:175], v4 offset:5120
v_mfma_f32_16x16x32_bf16 a[32:35], a[176:179], a[224:227], a[32:35]
s_add_u32 m0, s32, 0
ds_read_b64_tr_b16 a[218:219], v11 offset:1024
v_mfma_f32_16x16x32_bf16 a[36:39], a[176:179], a[228:231], a[36:39]
buffer_load_dwordx4 v1, s[12:15], s48 offen lds
v_mfma_f32_16x16x32_bf16 a[40:43], a[176:179], a[232:235], a[40:43]
ds_read_b64_tr_b16 a[220:221], v12 offset:0
v_mfma_f32_16x16x32_bf16 a[44:47], a[176:179], a[236:239], a[44:47]
s_add_u32 s29, s29, s93
v_mfma_f32_16x16x32_bf16 a[48:51], a[176:179], a[240:243], a[48:51]
ds_read_b64_tr_b16 a[222:223], v12 offset:1024
v_mfma_f32_16x16x32_bf16 a[52:55], a[176:179], a[244:247], a[52:55]
buffer_store_dwordx4 v[144:147], v13, s[8:11], s29 offen sc1
v_mfma_f32_16x16x32_bf16 a[56:59], a[176:179], a[248:251], a[56:59]
s_add_u32 s48, s48, s34
ds_read_b128 a[188:191], v4 offset:13312
v_mfma_f32_16x16x32_bf16 a[60:63], a[176:179], a[252:255], a[60:63]
s_add_u32 m0, s32, 4096
ds_read_b128 a[176:179], v3 offset:8192
v_mfma_f32_16x16x32_bf16 a[64:67], a[180:183], a[224:227], a[64:67]
buffer_load_dwordx4 v1, s[12:15], s48 offen lds
v_mfma_f32_16x16x32_bf16 a[68:71], a[180:183], a[228:231], a[68:71]
v_add_u32 v5, 16384, v5
v_and_b32 v5, 65535, v5
v_mfma_f32_16x16x32_bf16 a[72:75], a[180:183], a[232:235], a[72:75]
v_xor_b32 v6, 16, v5
v_xor_b32 v7, 64, v5
v_mfma_f32_16x16x32_bf16 a[76:79], a[180:183], a[236:239], a[76:79]
v_xor_b32 v8, 80, v5
v_xor_b32 v9, 128, v5
v_mfma_f32_16x16x32_bf16 a[80:83], a[180:183], a[240:243], a[80:83]
s_cmp_eq_u32 s2, 0
s_cselect_b64 s[4:5], s[6:7], s[18:19]
v_mfma_f32_16x16x32_bf16 a[84:87], a[180:183], a[244:247], a[84:87]
s_add_u32 s48, s48, s34
s_mov_b32 s20, s4
s_and_b32 s21, s5, 0xffff
v_mfma_f32_16x16x32_bf16 a[88:91], a[180:183], a[248:251], a[88:91]
s_add_u32 m0, s32, 8192
s_lshl_b32 s22, s47, 12
s_mov_b32 s23, 0x20000
v_mfma_f32_16x16x32_bf16 a[92:95], a[180:183], a[252:255], a[92:95]
buffer_load_dwordx4 v1, s[12:15], s48 offen lds
ds_read_b128 a[180:183], v4 offset:9216
v_mfma_f32_16x16x32_bf16 a[96:99], a[184:187], a[224:227], a[96:99]
s_mov_b32 s31, s46
v_xor_b32 v10, 144, v5
v_xor_b32 v11, 192, v5
v_mfma_f32_16x16x32_bf16 a[100:103], a[184:187], a[228:231], a[100:103]
v_xor_b32 v12, 208, v5
v_mfma_f32_16x16x32_bf16 a[104:107], a[184:187], a[232:235], a[104:107]
v_mfma_f32_16x16x32_bf16 a[108:111], a[184:187], a[236:239], a[108:111]
v_mfma_f32_16x16x32_bf16 a[112:115], a[184:187], a[240:243], a[112:115]
s_add_u32 s48, s48, s34
v_mfma_f32_16x16x32_bf16 a[116:119], a[184:187], a[244:247], a[116:119]
s_add_u32 m0, s32, 12288
v_mfma_f32_16x16x32_bf16 a[120:123], a[184:187], a[248:251], a[120:123]
buffer_load_dwordx4 v1, s[12:15], s48 offen lds
v_mfma_f32_16x16x32_bf16 a[124:127], a[184:187], a[252:255], a[124:127]
ds_read_b128 a[184:187], v3 offset:12288
v_mfma_f32_16x16x32_bf16 a[128:131], v[28:31], a[224:227], a[128:131]
s_add_u32 s29, s29, s44
v_mfma_f32_16x16x32_bf16 a[132:135], v[28:31], a[228:231], a[132:135]
v_mfma_f32_16x16x32_bf16 a[136:139], v[28:31], a[232:235], a[136:139]
buffer_store_dwordx4 v[148:151], v13, s[8:11], s29 offen sc1
buffer_load_dword v15, v14, s[96:99], s100 offen
v_mfma_f32_16x16x32_bf16 a[140:143], v[28:31], a[236:239], a[140:143]
s_add_u32 s100, s100, 16384
v_mfma_f32_16x16x32_bf16 a[144:147], v[28:31], a[240:243], a[144:147]
v_mfma_f32_16x16x32_bf16 a[148:151], v[28:31], a[244:247], a[148:151]
v_mfma_f32_16x16x32_bf16 a[152:155], v[28:31], a[248:251], a[152:155]
v_mfma_f32_16x16x32_bf16 a[156:159], v[28:31], a[252:255], a[156:159]
s_waitcnt vmcnt(24) lgkmcnt(0)
s_barrier
v_mfma_f32_16x16x32_bf16 v[160:163], a[160:163], a[192:195], v[160:163]
ds_read_b64_tr_b16 a[224:225], v5 offset:0
v_mfma_f32_16x16x32_bf16 v[164:167], a[160:163], a[196:199], v[164:167]
v_mfma_f32_16x16x32_bf16 v[168:171], a[160:163], a[200:203], v[168:171]
ds_read_b64_tr_b16 a[226:227], v5 offset:1024
v_mfma_f32_16x16x32_bf16 v[172:175], a[160:163], a[204:207], v[172:175]
s_add_u32 s37, s31, 0
v_mfma_f32_16x16x32_bf16 v[176:179], a[160:163], a[208:211], v[176:179]
s_add_u32 m0, s33, 0
ds_read_b64_tr_b16 a[228:229], v6 offset:0
v_mfma_f32_16x16x32_bf16 v[180:183], a[160:163], a[212:215], v[180:183]
buffer_load_dwordx4 v2, s[20:23], s37 offen  lds
v_mfma_f32_16x16x32_bf16 v[184:187], a[160:163], a[216:219], v[184:187]
ds_read_b64_tr_b16 a[230:231], v6 offset:1024
v_mfma_f32_16x16x32_bf16 v[188:191], a[160:163], a[220:223], v[188:191]
ds_read_b128 a[160:163], v4 offset:0
v_mfma_f32_16x16x32_bf16 v[192:195], a[164:167], a[192:195], v[192:195]
ds_read_b64_tr_b16 a[232:233], v7 offset:0
v_mfma_f32_16x16x32_bf16 v[196:199], a[164:167], a[196:199], v[196:199]
v_mfma_f32_16x16x32_bf16 v[200:203], a[164:167], a[200:203], v[200:203]
s_add_u32 s37, s31, 32768
ds_read_b64_tr_b16 a[234:235], v7 offset:1024
v_mfma_f32_16x16x32_bf16 v[204:207], a[164:167], a[204:207], v[204:207]
s_add_u32 m0, s33, 1024
v_mfma_f32_16x16x32_bf16 v[208:211], a[164:167], a[208:211], v[208:211]
buffer_load_dwordx4 v2, s[20:23], s37 offen  lds
v_mfma_f32_16x16x32_bf16 v[212:215], a[164:167], a[212:215], v[212:215]
ds_read_b64_tr_b16 a[236:237], v8 offset:0
v_mfma_f32_16x16x32_bf16 v[216:219], a[164:167], a[216:219], v[216:219]
s_add_u32 s29, s29, s93
v_mfma_f32_16x16x32_bf16 v[220:223], a[164:167], a[220:223], v[220:223]
ds_read_b128 a[164:167], v3 offset:1024
v_mfma_f32_16x16x32_bf16 v[224:227], a[168:171], a[192:195], v[224:227]
buffer_store_dwordx4 v[152:155], v13, s[8:11], s29 offen sc1
v_mfma_f32_16x16x32_bf16 v[228:231], a[168:171], a[196:199], v[228:231]
s_add_u32 s37, s31, 131072
ds_read_b64_tr_b16 a[238:239], v8 offset:1024
v_mfma_f32_16x16x32_bf16 v[232:235], a[168:171], a[200:203], v[232:235]
s_add_u32 m0, s33, 4096
v_mfma_f32_16x16x32_bf16 v[236:239], a[168:171], a[204:207], v[236:239]
buffer_load_dwordx4 v2, s[20:23], s37 offen  lds
v_mfma_f32_16x16x32_bf16 v[240:243], a[168:171], a[208:211], v[240:243]
ds_read_b64_tr_b16 a[240:241], v9 offset:0
v_mfma_f32_16x16x32_bf16 v[244:247], a[168:171], a[212:215], v[244:247]
v_mfma_f32_16x16x32_bf16 v[248:251], a[168:171], a[216:219], v[248:251]
ds_read_b64_tr_b16 a[242:243], v9 offset:1024
v_mfma_f32_16x16x32_bf16 v[252:255], a[168:171], a[220:223], v[252:255]
ds_read_b128 a[168:171], v4 offset:4096
v_mfma_f32_16x16x32_bf16 a[0:3], a[172:175], a[192:195], a[0:3]
s_add_u32 s37, s31, 163840
ds_read_b64_tr_b16 a[244:245], v10 offset:0
v_mfma_f32_16x16x32_bf16 a[4:7], a[172:175], a[196:199], a[4:7]
s_add_u32 m0, s33, 5120
v_mfma_f32_16x16x32_bf16 a[8:11], a[172:175], a[200:203], a[8:11]
buffer_load_dwordx4 v2, s[20:23], s37 offen  lds
v_mfma_f32_16x16x32_bf16 a[12:15], a[172:175], a[204:207], a[12:15]
s_add_u32 s31, s31, 262144
ds_read_b64_tr_b16 a[246:247], v10 offset:1024
v_mfma_f32_16x16x32_bf16 a[16:19], a[172:175], a[208:211], a[16:19]
s_add_u32 s33, s33, 16384
v_mfma_f32_16x16x32_bf16 a[20:23], a[172:175], a[212:215], a[20:23]
s_and_b32 s33, s33, 65535
ds_read_b64_tr_b16 a[248:249], v11 offset:0
v_mfma_f32_16x16x32_bf16 a[24:27], a[172:175], a[216:219], a[24:27]
v_mfma_f32_16x16x32_bf16 a[28:31], a[172:175], a[220:223], a[28:31]
s_add_u32 s48, s48, s34
ds_read_b128 a[172:175], v3 offset:5120
v_mfma_f32_16x16x32_bf16 a[32:35], a[176:179], a[192:195], a[32:35]
s_add_u32 m0, s32, 16384
ds_read_b64_tr_b16 a[250:251], v11 offset:1024
v_mfma_f32_16x16x32_bf16 a[36:39], a[176:179], a[196:199], a[36:39]
buffer_load_dwordx4 v1, s[12:15], s48 offen lds
v_mfma_f32_16x16x32_bf16 a[40:43], a[176:179], a[200:203], a[40:43]
ds_read_b64_tr_b16 a[252:253], v12 offset:0
v_mfma_f32_16x16x32_bf16 a[44:47], a[176:179], a[204:207], a[44:47]
s_add_u32 s29, s29, s44
v_mfma_f32_16x16x32_bf16 a[48:51], a[176:179], a[208:211], a[48:51]
ds_read_b64_tr_b16 a[254:255], v12 offset:1024
v_mfma_f32_16x16x32_bf16 a[52:55], a[176:179], a[212:215], a[52:55]
buffer_store_dwordx4 v[156:159], v13, s[8:11], s29 offen sc1
v_mfma_f32_16x16x32_bf16 a[56:59], a[176:179], a[216:219], a[56:59]
s_add_u32 s48, s48, s34
ds_read_b128 v[28:31], v3 offset:13312
v_mfma_f32_16x16x32_bf16 a[60:63], a[176:179], a[220:223], a[60:63]
s_add_u32 m0, s32, 20480
ds_read_b128 a[176:179], v4 offset:8192
v_mfma_f32_16x16x32_bf16 a[64:67], a[180:183], a[192:195], a[64:67]
buffer_load_dwordx4 v1, s[12:15], s48 offen lds
v_mfma_f32_16x16x32_bf16 a[68:71], a[180:183], a[196:199], a[68:71]
v_add_u32 v5, 16384, v5
v_and_b32 v5, 65535, v5
v_mfma_f32_16x16x32_bf16 a[72:75], a[180:183], a[200:203], a[72:75]
v_xor_b32 v6, 16, v5
v_xor_b32 v7, 64, v5
v_mfma_f32_16x16x32_bf16 a[76:79], a[180:183], a[204:207], a[76:79]
v_xor_b32 v8, 80, v5
v_xor_b32 v9, 128, v5
v_mfma_f32_16x16x32_bf16 a[80:83], a[180:183], a[208:211], a[80:83]
v_xor_b32 v10, 144, v5
v_xor_b32 v11, 192, v5
v_mfma_f32_16x16x32_bf16 a[84:87], a[180:183], a[212:215], a[84:87]
s_add_u32 s48, s48, s34
v_xor_b32 v12, 208, v5
v_mfma_f32_16x16x32_bf16 a[88:91], a[180:183], a[216:219], a[88:91]
s_add_u32 m0, s32, 24576
v_mfma_f32_16x16x32_bf16 a[92:95], a[180:183], a[220:223], a[92:95]
buffer_load_dwordx4 v1, s[12:15], s48 offen lds
ds_read_b128 a[180:183], v3 offset:9216
v_mfma_f32_16x16x32_bf16 a[96:99], a[184:187], a[192:195], a[96:99]
v_mfma_f32_16x16x32_bf16 a[100:103], a[184:187], a[196:199], a[100:103]
v_mfma_f32_16x16x32_bf16 a[104:107], a[184:187], a[200:203], a[104:107]
v_mfma_f32_16x16x32_bf16 a[108:111], a[184:187], a[204:207], a[108:111]
v_mfma_f32_16x16x32_bf16 a[112:115], a[184:187], a[208:211], a[112:115]
s_add_u32 s48, s48, s34
v_mfma_f32_16x16x32_bf16 a[116:119], a[184:187], a[212:215], a[116:119]
s_add_u32 m0, s32, 28672
v_mfma_f32_16x16x32_bf16 a[120:123], a[184:187], a[216:219], a[120:123]
buffer_load_dwordx4 v1, s[12:15], s48 offen lds
v_mfma_f32_16x16x32_bf16 a[124:127], a[184:187], a[220:223], a[124:127]
s_add_u32 s30, s30, 128
ds_read_b128 a[184:187], v4 offset:12288
v_mfma_f32_16x16x32_bf16 a[128:131], a[188:191], a[192:195], a[128:131]
s_add_u32 s32, s32, 32768
v_add_u32 v3, 32768, v3
v_mfma_f32_16x16x32_bf16 a[132:135], a[188:191], a[196:199], a[132:135]
s_sub_u32 s48, s32, 98304
v_subrev_u32 v19, 98304, v3
v_mfma_f32_16x16x32_bf16 a[136:139], a[188:191], a[200:203], a[136:139]
s_cmp_ge_u32 s32, 163840
s_cselect_b32 s32, s48, s32
buffer_load_dword v15, v14, s[96:99], s100 offen
v_mfma_f32_16x16x32_bf16 a[140:143], a[188:191], a[204:207], a[140:143]
s_add_u32 s100, s100, 16384
v_cmp_le_u32 vcc, 163840, v3
v_mfma_f32_16x16x32_bf16 a[144:147], a[188:191], a[208:211], a[144:147]
s_nop 0
v_cndmask_b32 v3, v3, v19, vcc
v_mfma_f32_16x16x32_bf16 a[148:151], a[188:191], a[212:215], a[148:151]
v_xor_b32 v4, 64, v3
v_mfma_f32_16x16x32_bf16 a[152:155], a[188:191], a[216:219], a[152:155]
v_mfma_f32_16x16x32_bf16 a[156:159], a[188:191], a[220:223], a[156:159]
s_waitcnt vmcnt(23) lgkmcnt(0)
s_barrier
v_mfma_f32_16x16x32_bf16 v[160:163], a[160:163], a[224:227], v[160:163]
ds_read_b64_tr_b16 a[192:193], v5 offset:0
v_mfma_f32_16x16x32_bf16 v[164:167], a[160:163], a[228:231], v[164:167]
v_mfma_f32_16x16x32_bf16 v[168:171], a[160:163], a[232:235], v[168:171]
ds_read_b64_tr_b16 a[194:195], v5 offset:1024
v_mfma_f32_16x16x32_bf16 v[172:175], a[160:163], a[236:239], v[172:175]
s_add_u32 s37, s31, 0
v_mfma_f32_16x16x32_bf16 v[176:179], a[160:163], a[240:243], v[176:179]
s_add_u32 m0, s33, 0
ds_read_b64_tr_b16 a[196:197], v6 offset:0
v_mfma_f32_16x16x32_bf16 v[180:183], a[160:163], a[244:247], v[180:183]
buffer_load_dwordx4 v2, s[20:23], s37 offen  lds
v_mfma_f32_16x16x32_bf16 v[184:187], a[160:163], a[248:251], v[184:187]
ds_read_b64_tr_b16 a[198:199], v6 offset:1024
v_mfma_f32_16x16x32_bf16 v[188:191], a[160:163], a[252:255], v[188:191]
ds_read_b128 a[160:163], v3 offset:0
v_mfma_f32_16x16x32_bf16 v[192:195], a[164:167], a[224:227], v[192:195]
ds_read_b64_tr_b16 a[200:201], v7 offset:0
v_mfma_f32_16x16x32_bf16 v[196:199], a[164:167], a[228:231], v[196:199]
v_mfma_f32_16x16x32_bf16 v[200:203], a[164:167], a[232:235], v[200:203]
s_add_u32 s37, s31, 32768
ds_read_b64_tr_b16 a[202:203], v7 offset:1024
v_mfma_f32_16x16x32_bf16 v[204:207], a[164:167], a[236:239], v[204:207]
s_add_u32 m0, s33, 1024
v_mfma_f32_16x16x32_bf16 v[208:211], a[164:167], a[240:243], v[208:211]
buffer_load_dwordx4 v2, s[20:23], s37 offen  lds
v_mfma_f32_16x16x32_bf16 v[212:215], a[164:167], a[244:247], v[212:215]
ds_read_b64_tr_b16 a[204:205], v8 offset:0
v_mfma_f32_16x16x32_bf16 v[216:219], a[164:167], a[248:251], v[216:219]
v_mfma_f32_16x16x32_bf16 v[220:223], a[164:167], a[252:255], v[220:223]
ds_read_b128 a[164:167], v4 offset:1024
v_mfma_f32_16x16x32_bf16 v[224:227], a[168:171], a[224:227], v[224:227]
ds_read_b64_tr_b16 a[206:207], v8 offset:1024
v_mfma_f32_16x16x32_bf16 v[228:231], a[168:171], a[228:231], v[228:231]
s_add_u32 s37, s31, 131072
v_mfma_f32_16x16x32_bf16 v[232:235], a[168:171], a[232:235], v[232:235]
s_add_u32 m0, s33, 4096
ds_read_b64_tr_b16 a[208:209], v9 offset:0
v_mfma_f32_16x16x32_bf16 v[236:239], a[168:171], a[236:239], v[236:239]
buffer_load_dwordx4 v2, s[20:23], s37 offen  lds
v_mfma_f32_16x16x32_bf16 v[240:243], a[168:171], a[240:243], v[240:243]
ds_read_b64_tr_b16 a[210:211], v9 offset:1024
v_mfma_f32_16x16x32_bf16 v[244:247], a[168:171], a[244:247], v[244:247]
v_mfma_f32_16x16x32_bf16 v[248:251], a[168:171], a[248:251], v[248:251]
ds_read_b64_tr_b16 a[212:213], v10 offset:0
v_mfma_f32_16x16x32_bf16 v[252:255], a[168:171], a[252:255], v[252:255]
ds_read_b128 a[168:171], v3 offset:4096
v_mfma_f32_16x16x32_bf16 a[0:3], a[172:175], a[224:227], a[0:3]
s_add_u32 s37, s31, 163840
ds_read_b64_tr_b16 a[214:215], v10 offset:1024
v_mfma_f32_16x16x32_bf16 a[4:7], a[172:175], a[228:231], a[4:7]
s_add_u32 m0, s33, 5120
v_mfma_f32_16x16x32_bf16 a[8:11], a[172:175], a[232:235], a[8:11]
buffer_load_dwordx4 v2, s[20:23], s37 offen  lds
v_mfma_f32_16x16x32_bf16 a[12:15], a[172:175], a[236:239], a[12:15]
s_add_u32 s31, s31, 262144
ds_read_b64_tr_b16 a[216:217], v11 offset:0
v_mfma_f32_16x16x32_bf16 a[16:19], a[172:175], a[240:243], a[16:19]
s_add_u32 s33, s33, 16384
v_mfma_f32_16x16x32_bf16 a[20:23], a[172:175], a[244:247], a[20:23]
s_and_b32 s33, s33, 65535
ds_read_b64_tr_b16 a[218:219], v11 offset:1024
v_mfma_f32_16x16x32_bf16 a[24:27], a[172:175], a[248:251], a[24:27]
v_mfma_f32_16x16x32_bf16 a[28:31], a[172:175], a[252:255], a[28:31]
s_mov_b32 s48, s30
ds_read_b128 a[172:175], v4 offset:5120
v_mfma_f32_16x16x32_bf16 a[32:35], a[176:179], a[224:227], a[32:35]
s_add_u32 m0, s32, 0
ds_read_b64_tr_b16 a[220:221], v12 offset:0
v_mfma_f32_16x16x32_bf16 a[36:39], a[176:179], a[228:231], a[36:39]
buffer_load_dwordx4 v1, s[12:15], s48 offen lds
v_mfma_f32_16x16x32_bf16 a[40:43], a[176:179], a[232:235], a[40:43]
ds_read_b64_tr_b16 a[222:223], v12 offset:1024
v_mfma_f32_16x16x32_bf16 a[44:47], a[176:179], a[236:239], a[44:47]
v_mfma_f32_16x16x32_bf16 a[48:51], a[176:179], a[240:243], a[48:51]
ds_read_b128 a[188:191], v4 offset:13312
v_mfma_f32_16x16x32_bf16 a[52:55], a[176:179], a[244:247], a[52:55]
v_mfma_f32_16x16x32_bf16 a[56:59], a[176:179], a[248:251], a[56:59]
s_add_u32 s48, s48, s34
v_mfma_f32_16x16x32_bf16 a[60:63], a[176:179], a[252:255], a[60:63]
s_add_u32 m0, s32, 4096
ds_read_b128 a[176:179], v3 offset:8192
v_add_u32 v5, 16384, v5
v_mfma_f32_16x16x32_bf16 a[64:67], a[180:183], a[224:227], a[64:67]
buffer_load_dwordx4 v1, s[12:15], s48 offen lds
v_and_b32 v5, 65535, v5
v_mfma_f32_16x16x32_bf16 a[68:71], a[180:183], a[228:231], a[68:71]
v_xor_b32 v6, 16, v5
v_xor_b32 v7, 64, v5
v_mfma_f32_16x16x32_bf16 a[72:75], a[180:183], a[232:235], a[72:75]
v_xor_b32 v8, 80, v5
v_xor_b32 v9, 128, v5
v_mfma_f32_16x16x32_bf16 a[76:79], a[180:183], a[236:239], a[76:79]
v_xor_b32 v10, 144, v5
v_xor_b32 v11, 192, v5
v_mfma_f32_16x16x32_bf16 a[80:83], a[180:183], a[240:243], a[80:83]
v_xor_b32 v12, 208, v5
v_mfma_f32_16x16x32_bf16 a[84:87], a[180:183], a[244:247], a[84:87]
s_add_u32 s48, s48, s34
v_mfma_f32_16x16x32_bf16 a[88:91], a[180:183], a[248:251], a[88:91]
s_add_u32 m0, s32, 8192
v_mfma_f32_16x16x32_bf16 a[92:95], a[180:183], a[252:255], a[92:95]
buffer_load_dwordx4 v1, s[12:15], s48 offen lds
ds_read_b128 a[180:183], v4 offset:9216
v_mfma_f32_16x16x32_bf16 a[96:99], a[184:187], a[224:227], a[96:99]
v_mfma_f32_16x16x32_bf16 a[100:103], a[184:187], a[228:231], a[100:103]
v_mfma_f32_16x16x32_bf16 a[104:107], a[184:187], a[232:235], a[104:107]
v_mfma_f32_16x16x32_bf16 a[108:111], a[184:187], a[236:239], a[108:111]
v_mfma_f32_16x16x32_bf16 a[112:115], a[184:187], a[240:243], a[112:115]
s_add_u32 s48, s48, s34
v_mfma_f32_16x16x32_bf16 a[116:119], a[184:187], a[244:247], a[116:119]
s_add_u32 m0, s32, 12288
v_mfma_f32_16x16x32_bf16 a[120:123], a[184:187], a[248:251], a[120:123]
buffer_load_dwordx4 v1, s[12:15], s48 offen lds
v_mfma_f32_16x16x32_bf16 a[124:127], a[184:187], a[252:255], a[124:127]
ds_read_b128 a[184:187], v3 offset:12288
v_mfma_f32_16x16x32_bf16 a[128:131], v[28:31], a[224:227], a[128:131]
v_mfma_f32_16x16x32_bf16 a[132:135], v[28:31], a[228:231], a[132:135]
v_mfma_f32_16x16x32_bf16 a[136:139], v[28:31], a[232:235], a[136:139]
buffer_load_dword v15, v14, s[96:99], s100 offen
v_mfma_f32_16x16x32_bf16 a[140:143], v[28:31], a[236:239], a[140:143]
s_add_u32 s100, s100, 16384
v_mfma_f32_16x16x32_bf16 a[144:147], v[28:31], a[240:243], a[144:147]
v_mfma_f32_16x16x32_bf16 a[148:151], v[28:31], a[244:247], a[148:151]
v_mfma_f32_16x16x32_bf16 a[152:155], v[28:31], a[248:251], a[152:155]
v_mfma_f32_16x16x32_bf16 a[156:159], v[28:31], a[252:255], a[156:159]
s_waitcnt vmcnt(20) lgkmcnt(0)
s_barrier
v_mfma_f32_16x16x32_bf16 v[160:163], a[160:163], a[192:195], v[160:163]
ds_read_b64_tr_b16 a[224:225], v5 offset:0
v_mfma_f32_16x16x32_bf16 v[164:167], a[160:163], a[196:199], v[164:167]
v_mfma_f32_16x16x32_bf16 v[168:171], a[160:163], a[200:203], v[168:171]
ds_read_b64_tr_b16 a[226:227], v5 offset:1024
v_mfma_f32_16x16x32_bf16 v[172:175], a[160:163], a[204:207], v[172:175]
s_add_u32 s37, s31, 0
v_mfma_f32_16x16x32_bf16 v[176:179], a[160:163], a[208:211], v[176:179]
s_add_u32 m0, s33, 0
ds_read_b64_tr_b16 a[228:229], v6 offset:0
v_mfma_f32_16x16x32_bf16 v[180:183], a[160:163], a[212:215], v[180:183]
buffer_load_dwordx4 v2, s[20:23], s37 offen  lds
v_mfma_f32_16x16x32_bf16 v[184:187], a[160:163], a[216:219], v[184:187]
ds_read_b64_tr_b16 a[230:231], v6 offset:1024
v_mfma_f32_16x16x32_bf16 v[188:191], a[160:163], a[220:223], v[188:191]
ds_read_b128 a[160:163], v4 offset:0
v_mfma_f32_16x16x32_bf16 v[192:195], a[164:167], a[192:195], v[192:195]
ds_read_b64_tr_b16 a[232:233], v7 offset:0
v_mfma_f32_16x16x32_bf16 v[196:199], a[164:167], a[196:199], v[196:199]
v_mfma_f32_16x16x32_bf16 v[200:203], a[164:167], a[200:203], v[200:203]
s_add_u32 s37, s31, 32768
ds_read_b64_tr_b16 a[234:235], v7 offset:1024
v_mfma_f32_16x16x32_bf16 v[204:207], a[164:167], a[204:207], v[204:207]
s_add_u32 m0, s33, 1024
v_mfma_f32_16x16x32_bf16 v[208:211], a[164:167], a[208:211], v[208:211]
buffer_load_dwordx4 v2, s[20:23], s37 offen  lds
v_mfma_f32_16x16x32_bf16 v[212:215], a[164:167], a[212:215], v[212:215]
ds_read_b64_tr_b16 a[236:237], v8 offset:0
v_mfma_f32_16x16x32_bf16 v[216:219], a[164:167], a[216:219], v[216:219]
v_mfma_f32_16x16x32_bf16 v[220:223], a[164:167], a[220:223], v[220:223]
ds_read_b128 a[164:167], v3 offset:1024
v_mfma_f32_16x16x32_bf16 v[224:227], a[168:171], a[192:195], v[224:227]
ds_read_b64_tr_b16 a[238:239], v8 offset:1024
v_mfma_f32_16x16x32_bf16 v[228:231], a[168:171], a[196:199], v[228:231]
s_add_u32 s37, s31, 131072
v_mfma_f32_16x16x32_bf16 v[232:235], a[168:171], a[200:203], v[232:235]
s_add_u32 m0, s33, 4096
ds_read_b64_tr_b16 a[240:241], v9 offset:0
v_mfma_f32_16x16x32_bf16 v[236:239], a[168:171], a[204:207], v[236:239]
buffer_load_dwordx4 v2, s[20:23], s37 offen  lds
v_mfma_f32_16x16x32_bf16 v[240:243], a[168:171], a[208:211], v[240:243]
ds_read_b64_tr_b16 a[242:243], v9 offset:1024
v_mfma_f32_16x16x32_bf16 v[244:247], a[168:171], a[212:215], v[244:247]
v_mfma_f32_16x16x32_bf16 v[248:251], a[168:171], a[216:219], v[248:251]
ds_read_b64_tr_b16 a[244:245], v10 offset:0
v_mfma_f32_16x16x32_bf16 v[252:255], a[168:171], a[220:223], v[252:255]
ds_read_b128 a[168:171], v4 offset:4096
v_mfma_f32_16x16x32_bf16 a[0:3], a[172:175], a[192:195], a[0:3]
s_add_u32 s37, s31, 163840
ds_read_b64_tr_b16 a[246:247], v10 offset:1024
v_mfma_f32_16x16x32_bf16 a[4:7], a[172:175], a[196:199], a[4:7]
s_add_u32 m0, s33, 5120
v_mfma_f32_16x16x32_bf16 a[8:11], a[172:175], a[200:203], a[8:11]
buffer_load_dwordx4 v2, s[20:23], s37 offen  lds
v_mfma_f32_16x16x32_bf16 a[12:15], a[172:175], a[204:207], a[12:15]
s_add_u32 s31, s31, 262144
ds_read_b64_tr_b16 a[248:249], v11 offset:0
v_mfma_f32_16x16x32_bf16 a[16:19], a[172:175], a[208:211], a[16:19]
s_add_u32 s33, s33, 16384
v_mfma_f32_16x16x32_bf16 a[20:23], a[172:175], a[212:215], a[20:23]
s_and_b32 s33, s33, 65535
ds_read_b64_tr_b16 a[250:251], v11 offset:1024
v_mfma_f32_16x16x32_bf16 a[24:27], a[172:175], a[216:219], a[24:27]
v_mfma_f32_16x16x32_bf16 a[28:31], a[172:175], a[220:223], a[28:31]
s_add_u32 s48, s48, s34
ds_read_b128 a[172:175], v3 offset:5120
v_mfma_f32_16x16x32_bf16 a[32:35], a[176:179], a[192:195], a[32:35]
s_add_u32 m0, s32, 16384
ds_read_b64_tr_b16 a[252:253], v12 offset:0
v_mfma_f32_16x16x32_bf16 a[36:39], a[176:179], a[196:199], a[36:39]
buffer_load_dwordx4 v1, s[12:15], s48 offen lds
v_mfma_f32_16x16x32_bf16 a[40:43], a[176:179], a[200:203], a[40:43]
ds_read_b64_tr_b16 a[254:255], v12 offset:1024
v_mfma_f32_16x16x32_bf16 a[44:47], a[176:179], a[204:207], a[44:47]
v_mfma_f32_16x16x32_bf16 a[48:51], a[176:179], a[208:211], a[48:51]
ds_read_b128 v[28:31], v3 offset:13312
v_mfma_f32_16x16x32_bf16 a[52:55], a[176:179], a[212:215], a[52:55]
v_mfma_f32_16x16x32_bf16 a[56:59], a[176:179], a[216:219], a[56:59]
s_add_u32 s48, s48, s34
v_mfma_f32_16x16x32_bf16 a[60:63], a[176:179], a[220:223], a[60:63]
s_add_u32 m0, s32, 20480
ds_read_b128 a[176:179], v4 offset:8192
v_add_u32 v5, 16384, v5
v_mfma_f32_16x16x32_bf16 a[64:67], a[180:183], a[192:195], a[64:67]
buffer_load_dwordx4 v1, s[12:15], s48 offen lds
v_and_b32 v5, 65535, v5
v_mfma_f32_16x16x32_bf16 a[68:71], a[180:183], a[196:199], a[68:71]
v_xor_b32 v6, 16, v5
v_xor_b32 v7, 64, v5
v_mfma_f32_16x16x32_bf16 a[72:75], a[180:183], a[200:203], a[72:75]
v_xor_b32 v8, 80, v5
v_xor_b32 v9, 128, v5
v_mfma_f32_16x16x32_bf16 a[76:79], a[180:183], a[204:207], a[76:79]
v_xor_b32 v10, 144, v5
v_xor_b32 v11, 192, v5
v_mfma_f32_16x16x32_bf16 a[80:83], a[180:183], a[208:211], a[80:83]
v_xor_b32 v12, 208, v5
v_mfma_f32_16x16x32_bf16 a[84:87], a[180:183], a[212:215], a[84:87]
s_add_u32 s48, s48, s34
v_mfma_f32_16x16x32_bf16 a[88:91], a[180:183], a[216:219], a[88:91]
s_add_u32 m0, s32, 24576
v_mfma_f32_16x16x32_bf16 a[92:95], a[180:183], a[220:223], a[92:95]
buffer_load_dwordx4 v1, s[12:15], s48 offen lds
ds_read_b128 a[180:183], v3 offset:9216
v_mfma_f32_16x16x32_bf16 a[96:99], a[184:187], a[192:195], a[96:99]
v_mfma_f32_16x16x32_bf16 a[100:103], a[184:187], a[196:199], a[100:103]
v_mfma_f32_16x16x32_bf16 a[104:107], a[184:187], a[200:203], a[104:107]
v_mfma_f32_16x16x32_bf16 a[108:111], a[184:187], a[204:207], a[108:111]
v_mfma_f32_16x16x32_bf16 a[112:115], a[184:187], a[208:211], a[112:115]
s_add_u32 s48, s48, s34
v_mfma_f32_16x16x32_bf16 a[116:119], a[184:187], a[212:215], a[116:119]
s_add_u32 m0, s32, 28672
v_mfma_f32_16x16x32_bf16 a[120:123], a[184:187], a[216:219], a[120:123]
buffer_load_dwordx4 v1, s[12:15], s48 offen lds
v_mfma_f32_16x16x32_bf16 a[124:127], a[184:187], a[220:223], a[124:127]
s_add_u32 s30, s30, 128
ds_read_b128 a[184:187], v4 offset:12288
v_mfma_f32_16x16x32_bf16 a[128:131], a[188:191], a[192:195], a[128:131]
s_add_u32 s32, s32, 32768
v_add_u32 v3, 32768, v3
v_mfma_f32_16x16x32_bf16 a[132:135], a[188:191], a[196:199], a[132:135]
s_sub_u32 s48, s32, 98304
v_subrev_u32 v19, 98304, v3
v_mfma_f32_16x16x32_bf16 a[136:139], a[188:191], a[200:203], a[136:139]
s_cmp_ge_u32 s32, 163840
s_cselect_b32 s32, s48, s32
buffer_load_dword v15, v14, s[96:99], s100 offen
v_mfma_f32_16x16x32_bf16 a[140:143], a[188:191], a[204:207], a[140:143]
s_add_u32 s100, s100, 16384
v_cmp_le_u32 vcc, 163840, v3
v_mfma_f32_16x16x32_bf16 a[144:147], a[188:191], a[208:211], a[144:147]
s_nop 0
v_cndmask_b32 v3, v3, v19, vcc
v_mfma_f32_16x16x32_bf16 a[148:151], a[188:191], a[212:215], a[148:151]
v_xor_b32 v4, 64, v3
v_mfma_f32_16x16x32_bf16 a[152:155], a[188:191], a[216:219], a[152:155]
v_mfma_f32_16x16x32_bf16 a[156:159], a[188:191], a[220:223], a[156:159]
s_cmp_eq_u32 s41, 0
s_cbranch_scc0 L_g_v17v
s_waitcnt vmcnt(18) lgkmcnt(0)
s_barrier
v_mfma_f32_16x16x32_bf16 v[160:163], a[160:163], a[224:227], v[160:163]
ds_read_b128 a[192:195], v3 offset:0
v_mfma_f32_16x16x32_bf16 v[164:167], a[160:163], a[228:231], v[164:167]
v_mfma_f32_16x16x32_bf16 v[168:171], a[160:163], a[232:235], v[168:171]
ds_read_b128 a[196:199], v4 offset:1024
v_mfma_f32_16x16x32_bf16 v[172:175], a[160:163], a[236:239], v[172:175]
s_add_u32 s37, s31, 0
v_mfma_f32_16x16x32_bf16 v[176:179], a[160:163], a[240:243], v[176:179]
s_add_u32 m0, s33, 0
ds_read_b128 a[200:203], v3 offset:4096
v_cvt_pk_bf16_f32 v32, v160, v161
v_cvt_pk_bf16_f32 v33, v162, v163
v_mfma_f32_16x16x32_bf16 v[180:183], a[160:163], a[244:247], v[180:183]
buffer_load_dwordx4 v2, s[20:23], s37 offen  lds
v_cvt_pk_bf16_f32 v36, v164, v165
v_cvt_pk_bf16_f32 v37, v166, v167
v_mfma_f32_16x16x32_bf16 v[184:187], a[160:163], a[248:251], v[184:187]
ds_read_b128 a[204:207], v4 offset:5120
v_cvt_pk_bf16_f32 v40, v168, v169
v_cvt_pk_bf16_f32 v41, v170, v171
v_mfma_f32_16x16x32_bf16 v[188:191], a[160:163], a[252:255], v[188:191]
ds_read_b64_tr_b16 a[160:161], v5 offset:0
v_cvt_pk_bf16_f32 v44, v172, v173
v_cvt_pk_bf16_f32 v45, v174, v175
v_mfma_f32_16x16x32_bf16 v[192:195], a[164:167], a[224:227], v[192:195]
ds_read_b64_tr_b16 a[162:163], v5 offset:1024
v_cvt_pk_bf16_f32 v48, v176, v177
v_cvt_pk_bf16_f32 v49, v178, v179
v_mfma_f32_16x16x32_bf16 v[196:199], a[164:167], a[228:231], v[196:199]
ds_read_b128 a[208:211], v3 offset:8192
v_add_u32 v5, 16384, v5
v_cvt_pk_bf16_f32 v52, v180, v181
v_cvt_pk_bf16_f32 v53, v182, v183
v_mfma_f32_16x16x32_bf16 v[200:203], a[164:167], a[232:235], v[200:203]
s_add_u32 s37, s31, 32768
v_and_b32 v5, 65535, v5
v_cvt_pk_bf16_f32 v56, v184, v185
v_cvt_pk_bf16_f32 v57, v186, v187
v_mfma_f32_16x16x32_bf16 v[204:207], a[164:167], a[236:239], v[204:207]
s_add_u32 m0, s33, 1024
ds_read_b128 a[212:215], v4 offset:9216
v_cvt_pk_bf16_f32 v60, v188, v189
v_cvt_pk_bf16_f32 v61, v190, v191
v_mfma_f32_16x16x32_bf16 v[208:211], a[164:167], a[240:243], v[208:211]
buffer_load_dwordx4 v2, s[20:23], s37 offen  lds
v_cvt_pk_bf16_f32 v34, v192, v193
v_cvt_pk_bf16_f32 v35, v194, v195
v_mfma_f32_16x16x32_bf16 v[212:215], a[164:167], a[244:247], v[212:215]
ds_read_b128 a[216:219], v3 offset:12288
v_cvt_pk_bf16_f32 v38, v196, v197
v_cvt_pk_bf16_f32 v39, v198, v199
v_mfma_f32_16x16x32_bf16 v[216:219], a[164:167], a[248:251], v[216:219]
v_cvt_pk_bf16_f32 v42, v200, v201
v_cvt_pk_bf16_f32 v43, v202, v203
v_mfma_f32_16x16x32_bf16 v[220:223], a[164:167], a[252:255], v[220:223]
ds_read_b64_tr_b16 a[164:165], v6 offset:0
v_cvt_pk_bf16_f32 v46, v204, v205
v_cvt_pk_bf16_f32 v47, v206, v207
v_mfma_f32_16x16x32_bf16 v[224:227], a[168:171], a[224:227], v[224:227]
ds_read_b64_tr_b16 a[166:167], v6 offset:1024
v_cvt_pk_bf16_f32 v50, v208, v209
v_cvt_pk_bf16_f32 v51, v210, v211
v_mfma_f32_16x16x32_bf16 v[228:231], a[168:171], a[228:231], v[228:231]
s_add_u32 s37, s31, 131072
ds_read_b128 a[220:223], v4 offset:13312
v_xor_b32 v6, 16, v5
v_cvt_pk_bf16_f32 v54, v212, v213
v_cvt_pk_bf16_f32 v55, v214, v215
v_mfma_f32_16x16x32_bf16 v[232:235], a[168:171], a[232:235], v[232:235]
s_add_u32 m0, s33, 4096
v_cvt_pk_bf16_f32 v58, v216, v217
v_cvt_pk_bf16_f32 v59, v218, v219
v_mfma_f32_16x16x32_bf16 v[236:239], a[168:171], a[236:239], v[236:239]
buffer_load_dwordx4 v2, s[20:23], s37 offen  lds
v_cvt_pk_bf16_f32 v62, v220, v221
v_cvt_pk_bf16_f32 v63, v222, v223
v_mfma_f32_16x16x32_bf16 v[240:243], a[168:171], a[240:243], v[240:243]
ds_read_b64_tr_b16 a[188:189], v12 offset:0
v_cvt_pk_bf16_f32 v64, v224, v225
v_cvt_pk_bf16_f32 v65, v226, v227
v_mfma_f32_16x16x32_bf16 v[244:247], a[168:171], a[244:247], v[244:247]
v_cvt_pk_bf16_f32 v68, v228, v229
v_cvt_pk_bf16_f32 v69, v230, v231
v_mfma_f32_16x16x32_bf16 v[248:251], a[168:171], a[248:251], v[248:251]
ds_read_b64_tr_b16 a[190:191], v12 offset:1024
v_cvt_pk_bf16_f32 v72, v232, v233
v_cvt_pk_bf16_f32 v73, v234, v235
v_mfma_f32_16x16x32_bf16 v[252:255], a[168:171], a[252:255], v[252:255]
ds_read_b64_tr_b16 a[168:169], v7 offset:0
v_cvt_pk_bf16_f32 v76, v236, v237
v_cvt_pk_bf16_f32 v77, v238, v239
v_mfma_f32_16x16x32_bf16 a[0:3], a[172:175], a[224:227], a[0:3]
s_add_u32 s37, s31, 163840
ds_read_b64_tr_b16 a[170:171], v7 offset:1024
v_cvt_pk_bf16_f32 v80, v240, v241
v_cvt_pk_bf16_f32 v81, v242, v243
v_mfma_f32_16x16x32_bf16 a[4:7], a[172:175], a[228:231], a[4:7]
s_add_u32 m0, s33, 5120
v_xor_b32 v7, 64, v5
v_xor_b32 v12, 208, v5
v_cvt_pk_bf16_f32 v84, v244, v245
v_cvt_pk_bf16_f32 v85, v246, v247
v_mfma_f32_16x16x32_bf16 a[8:11], a[172:175], a[232:235], a[8:11]
buffer_load_dwordx4 v2, s[20:23], s37 offen  lds
v_cvt_pk_bf16_f32 v88, v248, v249
v_cvt_pk_bf16_f32 v89, v250, v251
v_mfma_f32_16x16x32_bf16 a[12:15], a[172:175], a[236:239], a[12:15]
s_add_u32 s31, s31, 262144
v_cvt_pk_bf16_f32 v92, v252, v253
v_cvt_pk_bf16_f32 v93, v254, v255
v_mfma_f32_16x16x32_bf16 a[16:19], a[172:175], a[240:243], a[16:19]
s_add_u32 s33, s33, 16384
v_accvgpr_read_b32 v20, a0
v_accvgpr_read_b32 v21, a1
v_accvgpr_read_b32 v22, a2
v_accvgpr_read_b32 v23, a3
v_mfma_f32_16x16x32_bf16 a[20:23], a[172:175], a[244:247], a[20:23]
s_and_b32 s33, s33, 65535
v_cvt_pk_bf16_f32 v66, v20, v21
v_cvt_pk_bf16_f32 v67, v22, v23
v_accvgpr_read_b32 v24, a4
v_accvgpr_read_b32 v25, a5
v_mfma_f32_16x16x32_bf16 a[24:27], a[172:175], a[248:251], a[24:27]
v_accvgpr_read_b32 v26, a6
v_accvgpr_read_b32 v27, a7
v_cvt_pk_bf16_f32 v70, v24, v25
v_cvt_pk_bf16_f32 v71, v26, v27
v_mfma_f32_16x16x32_bf16 a[28:31], a[172:175], a[252:255], a[28:31]
s_mov_b32 s48, s30
ds_read_b64_tr_b16 a[172:173], v8 offset:0
v_accvgpr_read_b32 v20, a8
v_accvgpr_read_b32 v21, a9
v_accvgpr_read_b32 v22, a10
v_mfma_f32_16x16x32_bf16 a[32:35], a[176:179], a[224:227], a[32:35]
s_add_u32 m0, s32, 0
ds_read_b64_tr_b16 a[174:175], v8 offset:1024
v_mov_b32 v16, 0
v_accvgpr_read_b32 v23, a11
v_cvt_pk_bf16_f32 v74, v20, v21
v_mfma_f32_16x16x32_bf16 a[36:39], a[176:179], a[228:231], a[36:39]
buffer_load_dwordx4 v1, s[12:15], s48 offen lds
v_mov_b32 v17, 1
v_cvt_pk_bf16_f32 v75, v22, v23
v_accvgpr_read_b32 v24, a12
v_mfma_f32_16x16x32_bf16 a[40:43], a[176:179], a[232:235], a[40:43]
s_cmp_eq_u32 s17, 0
s_cselect_b32 s29, s39, 536870912
v_accvgpr_read_b32 v25, a13
v_accvgpr_read_b32 v26, a14
v_mfma_f32_16x16x32_bf16 a[44:47], a[176:179], a[236:239], a[44:47]
s_mov_b64 exec, 1
buffer_store_dword v17, v16, s[8:11], s29 offen sc1
s_mov_b64 exec, -1
v_accvgpr_read_b32 v27, a15
v_mfma_f32_16x16x32_bf16 a[48:51], a[176:179], a[240:243], a[48:51]
v_xor_b32 v8, 80, v5
v_cvt_pk_bf16_f32 v78, v24, v25
v_cvt_pk_bf16_f32 v79, v26, v27
v_accvgpr_read_b32 v20, a16
v_mfma_f32_16x16x32_bf16 a[52:55], a[176:179], a[244:247], a[52:55]
v_accvgpr_read_b32 v21, a17
v_accvgpr_read_b32 v22, a18
v_accvgpr_read_b32 v23, a19
v_cvt_pk_bf16_f32 v82, v20, v21
v_mfma_f32_16x16x32_bf16 a[56:59], a[176:179], a[248:251], a[56:59]
s_add_u32 s48, s48, s34
v_cvt_pk_bf16_f32 v83, v22, v23
v_accvgpr_read_b32 v24, a20
v_accvgpr_read_b32 v25, a21
v_accvgpr_read_b32 v26, a22
v_mfma_f32_16x16x32_bf16 a[60:63], a[176:179], a[252:255], a[60:63]
s_add_u32 m0, s32, 4096
ds_read_b64_tr_b16 a[176:177], v9 offset:0
v_accvgpr_read_b32 v27, a23
v_cvt_pk_bf16_f32 v86, v24, v25
v_cvt_pk_bf16_f32 v87, v26, v27
v_mfma_f32_16x16x32_bf16 a[64:67], a[180:183], a[224:227], a[64:67]
buffer_load_dwordx4 v1, s[12:15], s48 offen lds
ds_read_b64_tr_b16 a[178:179], v9 offset:1024
v_accvgpr_read_b32 v20, a24
v_accvgpr_read_b32 v21, a25
v_mfma_f32_16x16x32_bf16 a[68:71], a[180:183], a[228:231], a[68:71]
v_xor_b32 v9, 128, v5
v_accvgpr_read_b32 v22, a26
v_accvgpr_read_b32 v23, a27
v_cvt_pk_bf16_f32 v90, v20, v21
v_mfma_f32_16x16x32_bf16 a[72:75], a[180:183], a[232:235], a[72:75]
v_cvt_pk_bf16_f32 v91, v22, v23
v_accvgpr_read_b32 v24, a28
v_accvgpr_read_b32 v25, a29
v_accvgpr_read_b32 v26, a30
v_mfma_f32_16x16x32_bf16 a[76:79], a[180:183], a[236:239], a[76:79]
v_accvgpr_read_b32 v27, a31
v_cvt_pk_bf16_f32 v94, v24, v25
v_cvt_pk_bf16_f32 v95, v26, v27
v_accvgpr_read_b32 v20, a32
v_mfma_f32_16x16x32_bf16 a[80:83], a[180:183], a[240:243], a[80:83]
v_accvgpr_read_b32 v21, a33
v_accvgpr_read_b32 v22, a34
v_accvgpr_read_b32 v23, a35
v_cvt_pk_bf16_f32 v96, v20, v21
v_mfma_f32_16x16x32_bf16 a[84:87], a[180:183], a[244:247], a[84:87]
s_add_u32 s48, s48, s34
v_cvt_pk_bf16_f32 v97, v22, v23
v_accvgpr_read_b32 v24, a36
v_accvgpr_read_b32 v25, a37
v_accvgpr_read_b32 v26, a38
v_mfma_f32_16x16x32_bf16 a[88:91], a[180:183], a[248:251], a[88:91]
s_add_u32 m0, s32, 8192
v_accvgpr_read_b32 v27, a39
v_cvt_pk_bf16_f32 v100, v24, v25
v_cvt_pk_bf16_f32 v101, v26, v27
v_accvgpr_read_b32 v20, a40
v_mfma_f32_16x16x32_bf16 a[92:95], a[180:183], a[252:255], a[92:95]
buffer_load_dwordx4 v1, s[12:15], s48 offen lds
ds_read_b64_tr_b16 a[180:181], v10 offset:0
v_accvgpr_read_b32 v21, a41
v_accvgpr_read_b32 v22, a42
v_mfma_f32_16x16x32_bf16 a[96:99], a[184:187], a[224:227], a[96:99]
ds_read_b64_tr_b16 a[182:183], v10 offset:1024
v_accvgpr_read_b32 v23, a43
v_cvt_pk_bf16_f32 v104, v20, v21
v_cvt_pk_bf16_f32 v105, v22, v23
v_mfma_f32_16x16x32_bf16 a[100:103], a[184:187], a[228:231], a[100:103]
v_xor_b32 v10, 144, v5
v_accvgpr_read_b32 v24, a44
v_accvgpr_read_b32 v25, a45
v_accvgpr_read_b32 v26, a46
v_mfma_f32_16x16x32_bf16 a[104:107], a[184:187], a[232:235], a[104:107]
v_accvgpr_read_b32 v27, a47
v_cvt_pk_bf16_f32 v108, v24, v25
v_cvt_pk_bf16_f32 v109, v26, v27
v_accvgpr_read_b32 v20, a48
v_mfma_f32_16x16x32_bf16 a[108:111], a[184:187], a[236:239], a[108:111]
v_accvgpr_read_b32 v21, a49
v_accvgpr_read_b32 v22, a50
v_accvgpr_read_b32 v23, a51
v_cvt_pk_bf16_f32 v112, v20, v21
v_mfma_f32_16x16x32_bf16 a[112:115], a[184:187], a[240:243], a[112:115]
s_add_u32 s48, s48, s34
v_cvt_pk_bf16_f32 v113, v22, v23
v_accvgpr_read_b32 v24, a52
v_accvgpr_read_b32 v25, a53
v_accvgpr_read_b32 v26, a54
v_mfma_f32_16x16x32_bf16 a[116:119], a[184:187], a[244:247], a[116:119]
s_add_u32 m0, s32, 12288
v_accvgpr_read_b32 v27, a55
v_cvt_pk_bf16_f32 v116, v24, v25
v_cvt_pk_bf16_f32 v117, v26, v27
v_accvgpr_read_b32 v20, a56
v_mfma_f32_16x16x32_bf16 a[120:123], a[184:187], a[248:251], a[120:123]
buffer_load_dwordx4 v1, s[12:15], s48 offen lds
v_accvgpr_read_b32 v21, a57
v_accvgpr_read_b32 v22, a58
v_accvgpr_read_b32 v23, a59
v_mfma_f32_16x16x32_bf16 a[124:127], a[184:187], a[252:255], a[124:127]
ds_read_b64_tr_b16 a[184:185], v11 offset:0
v_cvt_pk_bf16_f32 v120, v20, v21
v_cvt_pk_bf16_f32 v121, v22, v23
v_accvgpr_read_b32 v24, a60
v_mfma_f32_16x16x32_bf16 a[128:131], v[28:31], a[224:227], a[128:131]
ds_read_b64_tr_b16 a[186:187], v11 offset:1024
v_accvgpr_read_b32 v25, a61
v_accvgpr_read_b32 v26, a62
v_accvgpr_read_b32 v27, a63
v_mfma_f32_16x16x32_bf16 a[132:135], v[28:31], a[228:231], a[132:135]
v_xor_b32 v11, 192, v5
v_cvt_pk_bf16_f32 v124, v24, v25
v_cvt_pk_bf16_f32 v125, v26, v27
v_mfma_f32_16x16x32_bf16 a[136:139], v[28:31], a[232:235], a[136:139]
buffer_load_dword v15, v14, s[96:99], s100 offen
v_mfma_f32_16x16x32_bf16 a[140:143], v[28:31], a[236:239], a[140:143]
s_add_u32 s100, s100, 16384
v_mfma_f32_16x16x32_bf16 a[144:147], v[28:31], a[240:243], a[144:147]
v_mfma_f32_16x16x32_bf16 a[148:151], v[28:31], a[244:247], a[148:151]
v_mfma_f32_16x16x32_bf16 a[152:155], v[28:31], a[248:251], a[152:155]
v_mfma_f32_16x16x32_bf16 a[156:159], v[28:31], a[252:255], a[156:159]
s_cmp_lt_u32 s35, s45
s_cbranch_scc1 L_g_tile
s_branch L_g_end
L_g_v17v:
s_waitcnt vmcnt(18) lgkmcnt(0)
s_barrier
v_mfma_f32_16x16x32_bf16 v[160:163], a[160:163], a[224:227], v[160:163]
ds_read_b64_tr_b16 a[192:193], v5 offset:0
v_mfma_f32_16x16x32_bf16 v[164:167], a[160:163], a[228:231], v[164:167]
v_mfma_f32_16x16x32_bf16 v[168:171], a[160:163], a[232:235], v[168:171]
ds_read_b64_tr_b16 a[194:195], v5 offset:1024
v_mfma_f32_16x16x32_bf16 v[172:175], a[160:163], a[236:239], v[172:175]
s_add_u32 s37, s31, 0
v_mfma_f32_16x16x32_bf16 v[176:179], a[160:163], a[240:243], v[176:179]
s_add_u32 m0, s33, 0
ds_read_b64_tr_b16 a[196:197], v6 offset:0
v_cvt_pk_bf16_f32 v32, v160, v161
v_cvt_pk_bf16_f32 v33, v162, v163
v_mfma_f32_16x16x32_bf16 v[180:183], a[160:163], a[244:247], v[180:183]
buffer_load_dwordx4 v2, s[20:23], s37 offen  lds
v_cvt_pk_bf16_f32 v36, v164, v165
v_cvt_pk_bf16_f32 v37, v166, v167
v_mfma_f32_16x16x32_bf16 v[184:187], a[160:163], a[248:251], v[184:187]
ds_read_b64_tr_b16 a[198:199], v6 offset:1024
v_cvt_pk_bf16_f32 v40, v168, v169
v_cvt_pk_bf16_f32 v41, v170, v171
v_mfma_f32_16x16x32_bf16 v[188:191], a[160:163], a[252:255], v[188:191]
ds_read_b128 a[160:163], v3 offset:0
v_cvt_pk_bf16_f32 v44, v172, v173
v_cvt_pk_bf16_f32 v45, v174, v175
v_mfma_f32_16x16x32_bf16 v[192:195], a[164:167], a[224:227], v[192:195]
ds_read_b64_tr_b16 a[200:201], v7 offset:0
v_cvt_pk_bf16_f32 v48, v176, v177
v_cvt_pk_bf16_f32 v49, v178, v179
v_mfma_f32_16x16x32_bf16 v[196:199], a[164:167], a[228:231], v[196:199]
v_cvt_pk_bf16_f32 v52, v180, v181
v_cvt_pk_bf16_f32 v53, v182, v183
v_mfma_f32_16x16x32_bf16 v[200:203], a[164:167], a[232:235], v[200:203]
s_add_u32 s37, s31, 32768
ds_read_b64_tr_b16 a[202:203], v7 offset:1024
v_cvt_pk_bf16_f32 v56, v184, v185
v_cvt_pk_bf16_f32 v57, v186, v187
v_mfma_f32_16x16x32_bf16 v[204:207], a[164:167], a[236:239], v[204:207]
s_add_u32 m0, s33, 1024
v_cvt_pk_bf16_f32 v60, v188, v189
v_cvt_pk_bf16_f32 v61, v190, v191
v_mfma_f32_16x16x32_bf16 v[208:211], a[164:167], a[240:243], v[208:211]
buffer_load_dwordx4 v2, s[20:23], s37 offen  lds
v_cvt_pk_bf16_f32 v34, v192, v193
v_cvt_pk_bf16_f32 v35, v194, v195
v_mfma_f32_16x16x32_bf16 v[212:215], a[164:167], a[244:247], v[212:215]
ds_read_b64_tr_b16 a[204:205], v8 offset:0
v_cvt_pk_bf16_f32 v38, v196, v197
v_cvt_pk_bf16_f32 v39, v198, v199
v_mfma_f32_16x16x32_bf16 v[216:219], a[164:167], a[248:251], v[216:219]
v_cvt_pk_bf16_f32 v42, v200, v201
v_cvt_pk_bf16_f32 v43, v202, v203
v_mfma_f32_16x16x32_bf16 v[220:223], a[164:167], a[252:255], v[220:223]
ds_read_b128 a[164:167], v4 offset:1024
v_cvt_pk_bf16_f32 v46, v204, v205
v_cvt_pk_bf16_f32 v47, v206, v207
v_mfma_f32_16x16x32_bf16 v[224:227], a[168:171], a[224:227], v[224:227]
ds_read_b64_tr_b16 a[206:207], v8 offset:1024
v_cvt_pk_bf16_f32 v50, v208, v209
v_cvt_pk_bf16_f32 v51, v210, v211
v_mfma_f32_16x16x32_bf16 v[228:231], a[168:171], a[228:231], v[228:231]
s_add_u32 s37, s31, 131072
v_cvt_pk_bf16_f32 v54, v212, v213
v_cvt_pk_bf16_f32 v55, v214, v215
v_mfma_f32_16x16x32_bf16 v[232:235], a[168:171], a[232:235], v[232:235]
s_add_u32 m0, s33, 4096
ds_read_b64_tr_b16 a[208:209], v9 offset:0
v_cvt_pk_bf16_f32 v58, v216, v217
v_cvt_pk_bf16_f32 v59, v218, v219
v_mfma_f32_16x16x32_bf16 v[236:239], a[168:171], a[236:239], v[236:239]
buffer_load_dwordx4 v2, s[20:23], s37 offen  lds
v_cvt_pk_bf16_f32 v62, v220, v221
v_cvt_pk_bf16_f32 v63, v222, v223
v_mfma_f32_16x16x32_bf16 v[240:243], a[168:171], a[240:243], v[240:243]
ds_read_b64_tr_b16 a[210:211], v9 offset:1024
v_cvt_pk_bf16_f32 v64, v224, v225
v_cvt_pk_bf16_f32 v65, v226, v227
v_mfma_f32_16x16x32_bf16 v[244:247], a[168:171], a[244:247], v[244:247]
v_cvt_pk_bf16_f32 v68, v228, v229
v_cvt_pk_bf16_f32 v69, v230, v231
v_mfma_f32_16x16x32_bf16 v[248:251], a[168:171], a[248:251], v[248:251]
ds_read_b64_tr_b16 a[212:213], v10 offset:0
v_cvt_pk_bf16_f32 v72, v232, v233
v_cvt_pk_bf16_f32 v73, v234, v235
v_mfma_f32_16x16x32_bf16 v[252:255], a[168:171], a[252:255], v[252:255]
ds_read_b128 a[168:171], v3 offset:4096
v_cvt_pk_bf16_f32 v76, v236, v237
v_cvt_pk_bf16_f32 v77, v238, v239
v_mfma_f32_16x16x32_bf16 a[0:3], a[172:175], a[224:227], a[0:3]
s_add_u32 s37, s31, 163840
ds_read_b64_tr_b16 a[214:215], v10 offset:1024
v_cvt_pk_bf16_f32 v80, v240, v241
v_cvt_pk_bf16_f32 v81, v242, v243
v_mfma_f32_16x16x32_bf16 a[4:7], a[172:175], a[228:231], a[4:7]
s_add_u32 m0, s33, 5120
v_cvt_pk_bf16_f32 v84, v244, v245
v_cvt_pk_bf16_f32 v85, v246, v247
v_mfma_f32_16x16x32_bf16 a[8:11], a[172:175], a[232:235], a[8:11]
buffer_load_dwordx4 v2, s[20:23], s37 offen  lds
v_cvt_pk_bf16_f32 v88, v248, v249
v_cvt_pk_bf16_f32 v89, v250, v251
v_mfma_f32_16x16x32_bf16 a[12:15], a[172:175], a[236:239], a[12:15]
s_add_u32 s31, s31, 262144
ds_read_b64_tr_b16 a[216:217], v11 offset:0
v_cvt_pk_bf16_f32 v92, v252, v253
v_cvt_pk_bf16_f32 v93, v254, v255
v_mfma_f32_16x16x32_bf16 a[16:19], a[172:175], a[240:243], a[16:19]
s_add_u32 s33, s33, 16384
v_accvgpr_read_b32 v20, a0
v_accvgpr_read_b32 v21, a1
v_accvgpr_read_b32 v22, a2
v_accvgpr_read_b32 v23, a3
v_mfma_f32_16x16x32_bf16 a[20:23], a[172:175], a[244:247], a[20:23]
s_and_b32 s33, s33, 65535
ds_read_b64_tr_b16 a[218:219], v11 offset:1024
v_cvt_pk_bf16_f32 v66, v20, v21
v_cvt_pk_bf16_f32 v67, v22, v23
v_accvgpr_read_b32 v24, a4
v_mfma_f32_16x16x32_bf16 a[24:27], a[172:175], a[248:251], a[24:27]
v_accvgpr_read_b32 v25, a5
v_accvgpr_read_b32 v26, a6
v_accvgpr_read_b32 v27, a7
v_cvt_pk_bf16_f32 v70, v24, v25
v_mfma_f32_16x16x32_bf16 a[28:31], a[172:175], a[252:255], a[28:31]
s_mov_b32 s48, s30
ds_read_b128 a[172:175], v4 offset:5120
v_cvt_pk_bf16_f32 v71, v26, v27
v_accvgpr_read_b32 v20, a8
v_accvgpr_read_b32 v21, a9
v_mfma_f32_16x16x32_bf16 a[32:35], a[176:179], a[224:227], a[32:35]
s_add_u32 m0, s32, 0
ds_read_b64_tr_b16 a[220:221], v12 offset:0
v_mov_b32 v16, 0
v_accvgpr_read_b32 v22, a10
v_accvgpr_read_b32 v23, a11
v_mfma_f32_16x16x32_bf16 a[36:39], a[176:179], a[228:231], a[36:39]
buffer_load_dwordx4 v1, s[12:15], s48 offen lds
v_mov_b32 v17, 1
v_cvt_pk_bf16_f32 v74, v20, v21
v_cvt_pk_bf16_f32 v75, v22, v23
v_mfma_f32_16x16x32_bf16 a[40:43], a[176:179], a[232:235], a[40:43]
ds_read_b64_tr_b16 a[222:223], v12 offset:1024
v_accvgpr_read_b32 v24, a12
v_accvgpr_read_b32 v25, a13
v_accvgpr_read_b32 v26, a14
v_mfma_f32_16x16x32_bf16 a[44:47], a[176:179], a[236:239], a[44:47]
s_cmp_eq_u32 s17, 0
s_cselect_b32 s29, s39, 536870912
v_accvgpr_read_b32 v27, a15
v_cvt_pk_bf16_f32 v78, v24, v25
v_mfma_f32_16x16x32_bf16 a[48:51], a[176:179], a[240:243], a[48:51]
ds_read_b128 a[188:191], v4 offset:13312
v_cvt_pk_bf16_f32 v79, v26, v27
v_accvgpr_read_b32 v20, a16
v_accvgpr_read_b32 v21, a17
v_mfma_f32_16x16x32_bf16 a[52:55], a[176:179], a[244:247], a[52:55]
s_mov_b64 exec, 1
buffer_store_dword v17, v16, s[8:11], s29 offen sc1
s_mov_b64 exec, -1
v_accvgpr_read_b32 v22, a18
v_mfma_f32_16x16x32_bf16 a[56:59], a[176:179], a[248:251], a[56:59]
s_add_u32 s48, s48, s34
v_accvgpr_read_b32 v23, a19
v_cvt_pk_bf16_f32 v82, v20, v21
v_cvt_pk_bf16_f32 v83, v22, v23
v_accvgpr_read_b32 v24, a20
v_mfma_f32_16x16x32_bf16 a[60:63], a[176:179], a[252:255], a[60:63]
s_add_u32 m0, s32, 4096
ds_read_b128 a[176:179], v3 offset:8192
v_add_u32 v5, 16384, v5
v_accvgpr_read_b32 v25, a21
v_accvgpr_read_b32 v26, a22
v_mfma_f32_16x16x32_bf16 a[64:67], a[180:183], a[224:227], a[64:67]
buffer_load_dwordx4 v1, s[12:15], s48 offen lds
v_and_b32 v5, 65535, v5
v_accvgpr_read_b32 v27, a23
v_cvt_pk_bf16_f32 v86, v24, v25
v_mfma_f32_16x16x32_bf16 a[68:71], a[180:183], a[228:231], a[68:71]
v_xor_b32 v6, 16, v5
v_xor_b32 v7, 64, v5
v_cvt_pk_bf16_f32 v87, v26, v27
v_accvgpr_read_b32 v20, a24
v_mfma_f32_16x16x32_bf16 a[72:75], a[180:183], a[232:235], a[72:75]
v_xor_b32 v8, 80, v5
v_xor_b32 v9, 128, v5
v_accvgpr_read_b32 v21, a25
v_accvgpr_read_b32 v22, a26
v_mfma_f32_16x16x32_bf16 a[76:79], a[180:183], a[236:239], a[76:79]
v_xor_b32 v10, 144, v5
v_xor_b32 v11, 192, v5
v_accvgpr_read_b32 v23, a27
v_cvt_pk_bf16_f32 v90, v20, v21
v_mfma_f32_16x16x32_bf16 a[80:83], a[180:183], a[240:243], a[80:83]
v_xor_b32 v12, 208, v5
v_cvt_pk_bf16_f32 v91, v22, v23
v_accvgpr_read_b32 v24, a28
v_accvgpr_read_b32 v25, a29
v_mfma_f32_16x16x32_bf16 a[84:87], a[180:183], a[244:247], a[84:87]
s_add_u32 s48, s48, s34
v_accvgpr_read_b32 v26, a30
v_accvgpr_read_b32 v27, a31
v_cvt_pk_bf16_f32 v94, v24, v25
v_cvt_pk_bf16_f32 v95, v26, v27
v_mfma_f32_16x16x32_bf16 a[88:91], a[180:183], a[248:251], a[88:91]
s_add_u32 m0, s32, 8192
v_accvgpr_read_b32 v20, a32
v_accvgpr_read_b32 v21, a33
v_accvgpr_read_b32 v22, a34
v_accvgpr_read_b32 v23, a35
v_mfma_f32_16x16x32_bf16 a[92:95], a[180:183], a[252:255], a[92:95]
buffer_load_dwordx4 v1, s[12:15], s48 offen lds
ds_read_b128 a[180:183], v4 offset:9216
v_cvt_pk_bf16_f32 v96, v20, v21
v_cvt_pk_bf16_f32 v97, v22, v23
v_mfma_f32_16x16x32_bf16 a[96:99], a[184:187], a[224:227], a[96:99]
v_accvgpr_read_b32 v24, a36
v_accvgpr_read_b32 v25, a37
v_accvgpr_read_b32 v26, a38
v_accvgpr_read_b32 v27, a39
v_mfma_f32_16x16x32_bf16 a[100:103], a[184:187], a[228:231], a[100:103]
v_cvt_pk_bf16_f32 v100, v24, v25
v_cvt_pk_bf16_f32 v101, v26, v27
v_accvgpr_read_b32 v20, a40
v_accvgpr_read_b32 v21, a41
v_mfma_f32_16x16x32_bf16 a[104:107], a[184:187], a[232:235], a[104:107]
v_accvgpr_read_b32 v22, a42
v_accvgpr_read_b32 v23, a43
v_cvt_pk_bf16_f32 v104, v20, v21
v_cvt_pk_bf16_f32 v105, v22, v23
v_mfma_f32_16x16x32_bf16 a[108:111], a[184:187], a[236:239], a[108:111]
v_accvgpr_read_b32 v24, a44
v_accvgpr_read_b32 v25, a45
v_accvgpr_read_b32 v26, a46
v_accvgpr_read_b32 v27, a47
v_mfma_f32_16x16x32_bf16 a[112:115], a[184:187], a[240:243], a[112:115]
s_add_u32 s48, s48, s34
v_cvt_pk_bf16_f32 v108, v24, v25
v_cvt_pk_bf16_f32 v109, v26, v27
v_accvgpr_read_b32 v20, a48
v_accvgpr_read_b32 v21, a49
v_mfma_f32_16x16x32_bf16 a[116:119], a[184:187], a[244:247], a[116:119]
s_add_u32 m0, s32, 12288
v_accvgpr_read_b32 v22, a50
v_accvgpr_read_b32 v23, a51
v_cvt_pk_bf16_f32 v112, v20, v21
v_cvt_pk_bf16_f32 v113, v22, v23
v_mfma_f32_16x16x32_bf16 a[120:123], a[184:187], a[248:251], a[120:123]
buffer_load_dwordx4 v1, s[12:15], s48 offen lds
v_accvgpr_read_b32 v24, a52
v_accvgpr_read_b32 v25, a53
v_accvgpr_read_b32 v26, a54
v_mfma_f32_16x16x32_bf16 a[124:127], a[184:187], a[252:255], a[124:127]
ds_read_b128 a[184:187], v3 offset:12288
v_accvgpr_read_b32 v27, a55
v_cvt_pk_bf16_f32 v116, v24, v25
v_cvt_pk_bf16_f32 v117, v26, v27
v_mfma_f32_16x16x32_bf16 a[128:131], v[28:31], a[224:227], a[128:131]
v_accvgpr_read_b32 v20, a56
v_accvgpr_read_b32 v21, a57
v_accvgpr_read_b32 v22, a58
v_accvgpr_read_b32 v23, a59
v_mfma_f32_16x16x32_bf16 a[132:135], v[28:31], a[228:231], a[132:135]
v_cvt_pk_bf16_f32 v120, v20, v21
v_cvt_pk_bf16_f32 v121, v22, v23
v_accvgpr_read_b32 v24, a60
v_accvgpr_read_b32 v25, a61
v_mfma_f32_16x16x32_bf16 a[136:139], v[28:31], a[232:235], a[136:139]
buffer_load_dword v15, v14, s[96:99], s100 offen
v_accvgpr_read_b32 v26, a62
v_accvgpr_read_b32 v27, a63
v_cvt_pk_bf16_f32 v124, v24, v25
v_mfma_f32_16x16x32_bf16 a[140:143], v[28:31], a[236:239], a[140:143]
s_add_u32 s100, s100, 16384
v_cvt_pk_bf16_f32 v125, v26, v27
v_mfma_f32_16x16x32_bf16 a[144:147], v[28:31], a[240:243], a[144:147]
v_mfma_f32_16x16x32_bf16 a[148:151], v[28:31], a[244:247], a[148:151]
v_mfma_f32_16x16x32_bf16 a[152:155], v[28:31], a[248:251], a[152:155]
v_mfma_f32_16x16x32_bf16 a[156:159], v[28:31], a[252:255], a[156:159]
s_cmp_lt_u32 s35, s45
s_cbranch_scc1 L_g_tile
s_branch L_g_end
L_g_first:
s_mov_b32 s100, 536870912
s_cmp_eq_u32 s61, 0
s_cbranch_scc0 L_g_end
v_mov_b32 v20, 128
s_mov_b32 s28, 0
L_poll_8:
buffer_load_dword v21, v20, s[56:59], 0 offen sc1
s_add_u32 s28, s28, 1
s_cmp_gt_u32 s28, 40000
s_cbranch_scc1 L_end
s_waitcnt vmcnt(0)
v_cmp_ne_u32 vcc, 8, v21
s_cbranch_vccz L_pd_9
s_sleep 1
s_branch L_poll_8
L_pd_9:
s_branch L_g_go
L_g_end:
v_bfe_u32 v16, v0, 3, 3
v_lshlrev_b32 v16, 4, v16
v_and_or_b32 v16, v0, 7, v16
v_bfe_u32 v17, v0, 4, 2
v_lshlrev_b32 v17, 5, v17
v_bfe_u32 v18, v0, 1, 3
v_or_b32 v17, v17, v18
v_and_b32 v18, 1, v0
v_lshl_or_b32 v17, v18, 4, v17
s_bitcmp1_b32 s50, 1
s_cselect_b64 vcc, -1, 0
s_movk_i32 s44, 0x80
v_cndmask_b32 v16, v16, v17, vcc
v_lshlrev_b32 v13, 4, v16
s_movk_i32 s92, 0x800
s_bitcmp1_b32 s50, 0
s_cselect_b32 s92, 0x4000, s92
s_xor_b32 s93, s92, 0x4800
s_sub_u32 s93, s93, s44
s_and_b32 s24, s17, s91
s_cbranch_scc0 L_g_h1
s_barrier
L_g_h1:
v_pk_mul_f32 v[20:21], v[160:161], s[94:95] op_sel_hi:[1,0]
v_pk_mul_f32 v[22:23], v[162:163], s[94:95] op_sel_hi:[1,0]
v_cvt_pk_bf16_f32 v32, v20, v21
v_cvt_pk_bf16_f32 v33, v22, v23
v_pk_mul_f32 v[20:21], v[192:193], s[94:95] op_sel_hi:[1,0]
v_pk_mul_f32 v[22:23], v[194:195], s[94:95] op_sel_hi:[1,0]
v_cvt_pk_bf16_f32 v34, v20, v21
v_cvt_pk_bf16_f32 v35, v22, v23
s_mov_b32 s60, s62
s_mov_b32 s29, s62
buffer_store_dwordx4 v[32:35], v13, s[8:11], s29 offen sc1
v_pk_mul_f32 v[24:25], v[164:165], s[94:95] op_sel_hi:[1,0]
v_pk_mul_f32 v[26:27], v[166:167], s[94:95] op_sel_hi:[1,0]
v_cvt_pk_bf16_f32 v36, v24, v25
v_cvt_pk_bf16_f32 v37, v26, v27
v_pk_mul_f32 v[24:25], v[196:197], s[94:95] op_sel_hi:[1,0]
v_pk_mul_f32 v[26:27], v[198:199], s[94:95] op_sel_hi:[1,0]
v_cvt_pk_bf16_f32 v38, v24, v25
v_cvt_pk_bf16_f32 v39, v26, v27
s_add_u32 s29, s29, s44
buffer_store_dwordx4 v[36:39], v13, s[8:11], s29 offen sc1
v_pk_mul_f32 v[20:21], v[168:169], s[94:95] op_sel_hi:[1,0]
v_pk_mul_f32 v[22:23], v[170:171], s[94:95] op_sel_hi:[1,0]
v_cvt_pk_bf16_f32 v40, v20, v21
v_cvt_pk_bf16_f32 v41, v22, v23
v_pk_mul_f32 v[20:21], v[200:201], s[94:95] op_sel_hi:[1,0]
v_pk_mul_f32 v[22:23], v[202:203], s[94:95] op_sel_hi:[1,0]
v_cvt_pk_bf16_f32 v42, v20, v21
v_cvt_pk_bf16_f32 v43, v22, v23
s_add_u32 s29, s29, s93
buffer_store_dwordx4 v[40:43], v13, s[8:11], s29 offen sc1
v_pk_mul_f32 v[24:25], v[172:173], s[94:95] op_sel_hi:[1,0]
v_pk_mul_f32 v[26:27], v[174:175], s[94:95] op_sel_hi:[1,0]
v_cvt_pk_bf16_f32 v44, v24, v25
v_cvt_pk_bf16_f32 v45, v26, v27
v_pk_mul_f32 v[24:25], v[204:205], s[94:95] op_sel_hi:[1,0]
v_pk_mul_f32 v[26:27], v[206:207], s[94:95] op_sel_hi:[1,0]
v_cvt_pk_bf16_f32 v46, v24, v25
v_cvt_pk_bf16_f32 v47, v26, v27
s_add_u32 s29, s29, s44
buffer_store_dwordx4 v[44:47], v13, s[8:11], s29 offen sc1
v_pk_mul_f32 v[20:21], v[176:177], s[94:95] op_sel_hi:[1,0]
v_pk_mul_f32 v[22:23], v[178:179], s[94:95] op_sel_hi:[1,0]
v_cvt_pk_bf16_f32 v48, v20, v21
v_cvt_pk_bf16_f32 v49, v22, v23
v_pk_mul_f32 v[20:21], v[208:209], s[94:95] op_sel_hi:[1,0]
v_pk_mul_f32 v[22:23], v[210:211], s[94:95] op_sel_hi:[1,0]
v_cvt_pk_bf16_f32 v50, v20, v21
v_cvt_pk_bf16_f32 v51, v22, v23
s_add_u32 s29, s29, s93
buffer_store_dwordx4 v[48:51], v13, s[8:11], s29 offen sc1
v_pk_mul_f32 v[24:25], v[180:181], s[94:95] op_sel_hi:[1,0]
v_pk_mul_f32 v[26:27], v[182:183], s[94:95] op_sel_hi:[1,0]
v_cvt_pk_bf16_f32 v52, v24, v25
v_cvt_pk_bf16_f32 v53, v26, v27
v_pk_mul_f32 v[24:25], v[212:213], s[94:95] op_sel_hi:[1,0]
v_pk_mul_f32 v[26:27], v[214:215], s[94:95] op_sel_hi:[1,0]
v_cvt_pk_bf16_f32 v54, v24, v25
v_cvt_pk_bf16_f32 v55, v26, v27
s_add_u32 s29, s29, s44
buffer_store_dwordx4 v[52:55], v13, s[8:11], s29 offen sc1
v_pk_mul_f32 v[20:21], v[184:185], s[94:95] op_sel_hi:[1,0]
v_pk_mul_f32 v[22:23], v[186:187], s[94:95] op_sel_hi:[1,0]
v_cvt_pk_bf16_f32 v56, v20, v21
v_cvt_pk_bf16_f32 v57, v22, v23
v_pk_mul_f32 v[20:21], v[216:217], s[94:95] op_sel_hi:[1,0]
v_pk_mul_f32 v[22:23], v[218:219], s[94:95] op_sel_hi:[1,0]
v_cvt_pk_bf16_f32 v58, v20, v21
v_cvt_pk_bf16_f32 v59, v22, v23
s_add_u32 s29, s29, s93
buffer_store_dwordx4 v[56:59], v13, s[8:11], s29 offen sc1
v_pk_mul_f32 v[24:25], v[188:189], s[94:95] op_sel_hi:[1,0]
v_pk_mul_f32 v[26:27], v[190:191], s[94:95] op_sel_hi:[1,0]
v_cvt_pk_bf16_f32 v60, v24, v25
v_cvt_pk_bf16_f32 v61, v26, v27
v_pk_mul_f32 v[24:25], v[220:221], s[94:95] op_sel_hi:[1,0]
v_pk_mul_f32 v[26:27], v[222:223], s[94:95] op_sel_hi:[1,0]
v_cvt_pk_bf16_f32 v62, v24, v25
v_cvt_pk_bf16_f32 v63, v26, v27
s_add_u32 s29, s29, s44
buffer_store_dwordx4 v[60:63], v13, s[8:11], s29 offen sc1
v_pk_mul_f32 v[20:21], v[224:225], s[94:95] op_sel_hi:[1,0]
v_pk_mul_f32 v[22:23], v[226:227], s[94:95] op_sel_hi:[1,0]
v_cvt_pk_bf16_f32 v64, v20, v21
v_cvt_pk_bf16_f32 v65, v22, v23
v_accvgpr_read_b32 v20, a0
v_accvgpr_read_b32 v21, a1
v_accvgpr_read_b32 v22, a2
v_accvgpr_read_b32 v23, a3
v_pk_mul_f32 v[20:21], v[20:21], s[94:95] op_sel_hi:[1,0]
v_pk_mul_f32 v[22:23], v[22:23], s[94:95] op_sel_hi:[1,0]
v_cvt_pk_bf16_f32 v66, v20, v21
v_cvt_pk_bf16_f32 v67, v22, v23
s_add_u32 s60, s60, s92
s_mov_b32 s29, s60
buffer_store_dwordx4 v[64:67], v13, s[8:11], s29 offen sc1
v_pk_mul_f32 v[24:25], v[228:229], s[94:95] op_sel_hi:[1,0]
v_pk_mul_f32 v[26:27], v[230:231], s[94:95] op_sel_hi:[1,0]
v_cvt_pk_bf16_f32 v68, v24, v25
v_cvt_pk_bf16_f32 v69, v26, v27
v_accvgpr_read_b32 v24, a4
v_accvgpr_read_b32 v25, a5
v_accvgpr_read_b32 v26, a6
v_accvgpr_read_b32 v27, a7
v_pk_mul_f32 v[24:25], v[24:25], s[94:95] op_sel_hi:[1,0]
v_pk_mul_f32 v[26:27], v[26:27], s[94:95] op_sel_hi:[1,0]
v_cvt_pk_bf16_f32 v70, v24, v25
v_cvt_pk_bf16_f32 v71, v26, v27
s_add_u32 s29, s29, s44
buffer_store_dwordx4 v[68:71], v13, s[8:11], s29 offen sc1
v_pk_mul_f32 v[20:21], v[232:233], s[94:95] op_sel_hi:[1,0]
v_pk_mul_f32 v[22:23], v[234:235], s[94:95] op_sel_hi:[1,0]
v_cvt_pk_bf16_f32 v72, v20, v21
v_cvt_pk_bf16_f32 v73, v22, v23
v_accvgpr_read_b32 v20, a8
v_accvgpr_read_b32 v21, a9
v_accvgpr_read_b32 v22, a10
v_accvgpr_read_b32 v23, a11
v_pk_mul_f32 v[20:21], v[20:21], s[94:95] op_sel_hi:[1,0]
v_pk_mul_f32 v[22:23], v[22:23], s[94:95] op_sel_hi:[1,0]
v_cvt_pk_bf16_f32 v74, v20, v21
v_cvt_pk_bf16_f32 v75, v22, v23
s_add_u32 s29, s29, s93
buffer_store_dwordx4 v[72:75], v13, s[8:11], s29 offen sc1
v_pk_mul_f32 v[24:25], v[236:237], s[94:95] op_sel_hi:[1,0]
v_pk_mul_f32 v[26:27], v[238:239], s[94:95] op_sel_hi:[1,0]
v_cvt_pk_bf16_f32 v76, v24, v25
v_cvt_pk_bf16_f32 v77, v26, v27
v_accvgpr_read_b32 v24, a12
v_accvgpr_read_b32 v25, a13
v_accvgpr_read_b32 v26, a14
v_accvgpr_read_b32 v27, a15
v_pk_mul_f32 v[24:25], v[24:25], s[94:95] op_sel_hi:[1,0]
v_pk_mul_f32 v[26:27], v[26:27], s[94:95] op_sel_hi:[1,0]
v_cvt_pk_bf16_f32 v78, v24, v25
v_cvt_pk_bf16_f32 v79, v26, v27
s_add_u32 s29, s29, s44
buffer_store_dwordx4 v[76:79], v13, s[8:11], s29 offen sc1
v_pk_mul_f32 v[20:21], v[240:241], s[94:95] op_sel_hi:[1,0]
v_pk_mul_f32 v[22:23], v[242:243], s[94:95] op_sel_hi:[1,0]
v_cvt_pk_bf16_f32 v80, v20, v21
v_cvt_pk_bf16_f32 v81, v22, v23
v_accvgpr_read_b32 v20, a16
v_accvgpr_read_b32 v21, a17
v_accvgpr_read_b32 v22, a18
v_accvgpr_read_b32 v23, a19
v_pk_mul_f32 v[20:21], v[20:21], s[94:95] op_sel_hi:[1,0]
v_pk_mul_f32 v[22:23], v[22:23], s[94:95] op_sel_hi:[1,0]
v_cvt_pk_bf16_f32 v82, v20, v21
v_cvt_pk_bf16_f32 v83, v22, v23
s_add_u32 s29, s29, s93
buffer_store_dwordx4 v[80:83], v13, s[8:11], s29 offen sc1
v_pk_mul_f32 v[24:25], v[244:245], s[94:95] op_sel_hi:[1,0]
v_pk_mul_f32 v[26:27], v[246:247], s[94:95] op_sel_hi:[1,0]
v_cvt_pk_bf16_f32 v84, v24, v25
v_cvt_pk_bf16_f32 v85, v26, v27
v_accvgpr_read_b32 v24, a20
v_accvgpr_read_b32 v25, a21
v_accvgpr_read_b32 v26, a22
v_accvgpr_read_b32 v27, a23
v_pk_mul_f32 v[24:25], v[24:25], s[94:95] op_sel_hi:[1,0]
v_pk_mul_f32 v[26:27], v[26:27], s[94:95] op_sel_hi:[1,0]
v_cvt_pk_bf16_f32 v86, v24, v25
v_cvt_pk_bf16_f32 v87, v26, v27
s_add_u32 s29, s29, s44
buffer_store_dwordx4 v[84:87], v13, s[8:11], s29 offen sc1
v_pk_mul_f32 v[20:21], v[248:249], s[94:95] op_sel_hi:[1,0]
v_pk_mul_f32 v[22:23], v[250:251], s[94:95] op_sel_hi:[1,0]
v_cvt_pk_bf16_f32 v88, v20, v21
v_cvt_pk_bf16_f32 v89, v22, v23
v_accvgpr_read_b32 v20, a24
v_accvgpr_read_b32 v21, a25
v_accvgpr_read_b32 v22, a26
v_accvgpr_read_b32 v23, a27
v_pk_mul_f32 v[20:21], v[20:21], s[94:95] op_sel_hi:[1,0]
v_pk_mul_f32 v[22:23], v[22:23], s[94:95] op_sel_hi:[1,0]
v_cvt_pk_bf16_f32 v90, v20, v21
v_cvt_pk_bf16_f32 v91, v22, v23
s_add_u32 s29, s29, s93
buffer_store_dwordx4 v[88:91], v13, s[8:11], s29 offen sc1
v_pk_mul_f32 v[24:25], v[252:253], s[94:95] op_sel_hi:[1,0]
v_pk_mul_f32 v[26:27], v[254:255], s[94:95] op_sel_hi:[1,0]
v_cvt_pk_bf16_f32 v92, v24, v25
v_cvt_pk_bf16_f32 v93, v26, v27
v_accvgpr_read_b32 v24, a28
v_accvgpr_read_b32 v25, a29
v_accvgpr_read_b32 v26, a30
v_accvgpr_read_b32 v27, a31
v_pk_mul_f32 v[24:25], v[24:25], s[94:95] op_sel_hi:[1,0]
v_pk_mul_f32 v[26:27], v[26:27], s[94:95] op_sel_hi:[1,0]
v_cvt_pk_bf16_f32 v94, v24, v25
v_cvt_pk_bf16_f32 v95, v26, v27
s_add_u32 s29, s29, s44
buffer_store_dwordx4 v[92:95], v13, s[8:11], s29 offen sc1
v_accvgpr_read_b32 v20, a32
v_accvgpr_read_b32 v21, a33
v_accvgpr_read_b32 v22, a34
v_accvgpr_read_b32 v23, a35
v_pk_mul_f32 v[20:21], v[20:21], s[94:95] op_sel_hi:[1,0]
v_pk_mul_f32 v[22:23], v[22:23], s[94:95] op_sel_hi:[1,0]
v_cvt_pk_bf16_f32 v96, v20, v21
v_cvt_pk_bf16_f32 v97, v22, v23
v_accvgpr_read_b32 v20, a64
v_accvgpr_read_b32 v21, a65
v_accvgpr_read_b32 v22, a66
v_accvgpr_read_b32 v23, a67
v_pk_mul_f32 v[20:21], v[20:21], s[94:95] op_sel_hi:[1,0]
v_pk_mul_f32 v[22:23], v[22:23], s[94:95] op_sel_hi:[1,0]
v_cvt_pk_bf16_f32 v98, v20, v21
v_cvt_pk_bf16_f32 v99, v22, v23
s_add_u32 s60, s60, s92
s_mov_b32 s29, s60
buffer_store_dwordx4 v[96:99], v13, s[8:11], s29 offen sc1
v_accvgpr_read_b32 v24, a36
v_accvgpr_read_b32 v25, a37
v_accvgpr_read_b32 v26, a38
v_accvgpr_read_b32 v27, a39
v_pk_mul_f32 v[24:25], v[24:25], s[94:95] op_sel_hi:[1,0]
v_pk_mul_f32 v[26:27], v[26:27], s[94:95] op_sel_hi:[1,0]
v_cvt_pk_bf16_f32 v100, v24, v25
v_cvt_pk_bf16_f32 v101, v26, v27
v_accvgpr_read_b32 v24, a68
v_accvgpr_read_b32 v25, a69
v_accvgpr_read_b32 v26, a70
v_accvgpr_read_b32 v27, a71
v_pk_mul_f32 v[24:25], v[24:25], s[94:95] op_sel_hi:[1,0]
v_pk_mul_f32 v[26:27], v[26:27], s[94:95] op_sel_hi:[1,0]
v_cvt_pk_bf16_f32 v102, v24, v25
v_cvt_pk_bf16_f32 v103, v26, v27
s_add_u32 s29, s29, s44
buffer_store_dwordx4 v[100:103], v13, s[8:11], s29 offen sc1
v_accvgpr_read_b32 v20, a40
v_accvgpr_read_b32 v21, a41
v_accvgpr_read_b32 v22, a42
v_accvgpr_read_b32 v23, a43
v_pk_mul_f32 v[20:21], v[20:21], s[94:95] op_sel_hi:[1,0]
v_pk_mul_f32 v[22:23], v[22:23], s[94:95] op_sel_hi:[1,0]
v_cvt_pk_bf16_f32 v104, v20, v21
v_cvt_pk_bf16_f32 v105, v22, v23
v_accvgpr_read_b32 v20, a72
v_accvgpr_read_b32 v21, a73
v_accvgpr_read_b32 v22, a74
v_accvgpr_read_b32 v23, a75
v_pk_mul_f32 v[20:21], v[20:21], s[94:95] op_sel_hi:[1,0]
v_pk_mul_f32 v[22:23], v[22:23], s[94:95] op_sel_hi:[1,0]
v_cvt_pk_bf16_f32 v106, v20, v21
v_cvt_pk_bf16_f32 v107, v22, v23
s_add_u32 s29, s29, s93
buffer_store_dwordx4 v[104:107], v13, s[8:11], s29 offen sc1
v_accvgpr_read_b32 v24, a44
v_accvgpr_read_b32 v25, a45
v_accvgpr_read_b32 v26, a46
v_accvgpr_read_b32 v27, a47
v_pk_mul_f32 v[24:25], v[24:25], s[94:95] op_sel_hi:[1,0]
v_pk_mul_f32 v[26:27], v[26:27], s[94:95] op_sel_hi:[1,0]
v_cvt_pk_bf16_f32 v108, v24, v25
v_cvt_pk_bf16_f32 v109, v26, v27
v_accvgpr_read_b32 v24, a76
v_accvgpr_read_b32 v25, a77
v_accvgpr_read_b32 v26, a78
v_accvgpr_read_b32 v27, a79
v_pk_mul_f32 v[24:25], v[24:25], s[94:95] op_sel_hi:[1,0]
v_pk_mul_f32 v[26:27], v[26:27], s[94:95] op_sel_hi:[1,0]
v_cvt_pk_bf16_f32 v110, v24, v25
v_cvt_pk_bf16_f32 v111, v26, v27
s_add_u32 s29, s29, s44
buffer_store_dwordx4 v[108:111], v13, s[8:11], s29 offen sc1
v_accvgpr_read_b32 v20, a48
v_accvgpr_read_b32 v21, a49
v_accvgpr_read_b32 v22, a50
v_accvgpr_read_b32 v23, a51
v_pk_mul_f32 v[20:21], v[20:21], s[94:95] op_sel_hi:[1,0]
v_pk_mul_f32 v[22:23], v[22:23], s[94:95] op_sel_hi:[1,0]
v_cvt_pk_bf16_f32 v112, v20, v21
v_cvt_pk_bf16_f32 v113, v22, v23
v_accvgpr_read_b32 v20, a80
v_accvgpr_read_b32 v21, a81
v_accvgpr_read_b32 v22, a82
v_accvgpr_read_b32 v23, a83
v_pk_mul_f32 v[20:21], v[20:21], s[94:95] op_sel_hi:[1,0]
v_pk_mul_f32 v[22:23], v[22:23], s[94:95] op_sel_hi:[1,0]
v_cvt_pk_bf16_f32 v114, v20, v21
v_cvt_pk_bf16_f32 v115, v22, v23
s_add_u32 s29, s29, s93
buffer_store_dwordx4 v[112:115], v13, s[8:11], s29 offen sc1
v_accvgpr_read_b32 v24, a52
v_accvgpr_read_b32 v25, a53
v_accvgpr_read_b32 v26, a54
v_accvgpr_read_b32 v27, a55
v_pk_mul_f32 v[24:25], v[24:25], s[94:95] op_sel_hi:[1,0]
v_pk_mul_f32 v[26:27], v[26:27], s[94:95] op_sel_hi:[1,0]
v_cvt_pk_bf16_f32 v116, v24, v25
v_cvt_pk_bf16_f32 v117, v26, v27
v_accvgpr_read_b32 v24, a84
v_accvgpr_read_b32 v25, a85
v_accvgpr_read_b32 v26, a86
v_accvgpr_read_b32 v27, a87
v_pk_mul_f32 v[24:25], v[24:25], s[94:95] op_sel_hi:[1,0]
v_pk_mul_f32 v[26:27], v[26:27], s[94:95] op_sel_hi:[1,0]
v_cvt_pk_bf16_f32 v118, v24, v25
v_cvt_pk_bf16_f32 v119, v26, v27
s_add_u32 s29, s29, s44
buffer_store_dwordx4 v[116:119], v13, s[8:11], s29 offen sc1
v_accvgpr_read_b32 v20, a56
v_accvgpr_read_b32 v21, a57
v_accvgpr_read_b32 v22, a58
v_accvgpr_read_b32 v23, a59
v_pk_mul_f32 v[20:21], v[20:21], s[94:95] op_sel_hi:[1,0]
v_pk_mul_f32 v[22:23], v[22:23], s[94:95] op_sel_hi:[1,0]
v_cvt_pk_bf16_f32 v120, v20, v21
v_cvt_pk_bf16_f32 v121, v22, v23
v_accvgpr_read_b32 v20, a88
v_accvgpr_read_b32 v21, a89
v_accvgpr_read_b32 v22, a90
v_accvgpr_read_b32 v23, a91
v_pk_mul_f32 v[20:21], v[20:21], s[94:95] op_sel_hi:[1,0]
v_pk_mul_f32 v[22:23], v[22:23], s[94:95] op_sel_hi:[1,0]
v_cvt_pk_bf16_f32 v122, v20, v21
v_cvt_pk_bf16_f32 v123, v22, v23
s_add_u32 s29, s29, s93
buffer_store_dwordx4 v[120:123], v13, s[8:11], s29 offen sc1
v_accvgpr_read_b32 v24, a60
v_accvgpr_read_b32 v25, a61
v_accvgpr_read_b32 v26, a62
v_accvgpr_read_b32 v27, a63
v_pk_mul_f32 v[24:25], v[24:25], s[94:95] op_sel_hi:[1,0]
v_pk_mul_f32 v[26:27], v[26:27], s[94:95] op_sel_hi:[1,0]
v_cvt_pk_bf16_f32 v124, v24, v25
v_cvt_pk_bf16_f32 v125, v26, v27
v_accvgpr_read_b32 v24, a92
v_accvgpr_read_b32 v25, a93
v_accvgpr_read_b32 v26, a94
v_accvgpr_read_b32 v27, a95
v_pk_mul_f32 v[24:25], v[24:25], s[94:95] op_sel_hi:[1,0]
v_pk_mul_f32 v[26:27], v[26:27], s[94:95] op_sel_hi:[1,0]
v_cvt_pk_bf16_f32 v126, v24, v25
v_cvt_pk_bf16_f32 v127, v26, v27
s_add_u32 s29, s29, s44
buffer_store_dwordx4 v[124:127], v13, s[8:11], s29 offen sc1
v_accvgpr_read_b32 v20, a96
v_accvgpr_read_b32 v21, a97
v_accvgpr_read_b32 v22, a98
v_accvgpr_read_b32 v23, a99
v_pk_mul_f32 v[20:21], v[20:21], s[94:95] op_sel_hi:[1,0]
v_pk_mul_f32 v[22:23], v[22:23], s[94:95] op_sel_hi:[1,0]
v_cvt_pk_bf16_f32 v128, v20, v21
v_cvt_pk_bf16_f32 v129, v22, v23
v_accvgpr_read_b32 v20, a128
v_accvgpr_read_b32 v21, a129
v_accvgpr_read_b32 v22, a130
v_accvgpr_read_b32 v23, a131
v_pk_mul_f32 v[20:21], v[20:21], s[94:95] op_sel_hi:[1,0]
v_pk_mul_f32 v[22:23], v[22:23], s[94:95] op_sel_hi:[1,0]
v_cvt_pk_bf16_f32 v130, v20, v21
v_cvt_pk_bf16_f32 v131, v22, v23
s_add_u32 s60, s60, s92
s_mov_b32 s29, s60
buffer_store_dwordx4 v[128:131], v13, s[8:11], s29 offen sc1
v_accvgpr_read_b32 v24, a100
v_accvgpr_read_b32 v25, a101
v_accvgpr_read_b32 v26, a102
v_accvgpr_read_b32 v27, a103
v_pk_mul_f32 v[24:25], v[24:25], s[94:95] op_sel_hi:[1,0]
v_pk_mul_f32 v[26:27], v[26:27], s[94:95] op_sel_hi:[1,0]
v_cvt_pk_bf16_f32 v132, v24, v25
v_cvt_pk_bf16_f32 v133, v26, v27
v_accvgpr_read_b32 v24, a132
v_accvgpr_read_b32 v25, a133
v_accvgpr_read_b32 v26, a134
v_accvgpr_read_b32 v27, a135
v_pk_mul_f32 v[24:25], v[24:25], s[94:95] op_sel_hi:[1,0]
v_pk_mul_f32 v[26:27], v[26:27], s[94:95] op_sel_hi:[1,0]
v_cvt_pk_bf16_f32 v134, v24, v25
v_cvt_pk_bf16_f32 v135, v26, v27
s_add_u32 s29, s29, s44
buffer_store_dwordx4 v[132:135], v13, s[8:11], s29 offen sc1
v_accvgpr_read_b32 v20, a104
v_accvgpr_read_b32 v21, a105
v_accvgpr_read_b32 v22, a106
v_accvgpr_read_b32 v23, a107
v_pk_mul_f32 v[20:21], v[20:21], s[94:95] op_sel_hi:[1,0]
v_pk_mul_f32 v[22:23], v[22:23], s[94:95] op_sel_hi:[1,0]
v_cvt_pk_bf16_f32 v136, v20, v21
v_cvt_pk_bf16_f32 v137, v22, v23
v_accvgpr_read_b32 v20, a136
v_accvgpr_read_b32 v21, a137
v_accvgpr_read_b32 v22, a138
v_accvgpr_read_b32 v23, a139
v_pk_mul_f32 v[20:21], v[20:21], s[94:95] op_sel_hi:[1,0]
v_pk_mul_f32 v[22:23], v[22:23], s[94:95] op_sel_hi:[1,0]
v_cvt_pk_bf16_f32 v138, v20, v21
v_cvt_pk_bf16_f32 v139, v22, v23
s_add_u32 s29, s29, s93
buffer_store_dwordx4 v[136:139], v13, s[8:11], s29 offen sc1
v_accvgpr_read_b32 v24, a108
v_accvgpr_read_b32 v25, a109
v_accvgpr_read_b32 v26, a110
v_accvgpr_read_b32 v27, a111
v_pk_mul_f32 v[24:25], v[24:25], s[94:95] op_sel_hi:[1,0]
v_pk_mul_f32 v[26:27], v[26:27], s[94:95] op_sel_hi:[1,0]
v_cvt_pk_bf16_f32 v140, v24, v25
v_cvt_pk_bf16_f32 v141, v26, v27
v_accvgpr_read_b32 v24, a140
v_accvgpr_read_b32 v25, a141
v_accvgpr_read_b32 v26, a142
v_accvgpr_read_b32 v27, a143
v_pk_mul_f32 v[24:25], v[24:25], s[94:95] op_sel_hi:[1,0]
v_pk_mul_f32 v[26:27], v[26:27], s[94:95] op_sel_hi:[1,0]
v_cvt_pk_bf16_f32 v142, v24, v25
v_cvt_pk_bf16_f32 v143, v26, v27
s_add_u32 s29, s29, s44
buffer_store_dwordx4 v[140:143], v13, s[8:11], s29 offen sc1
v_accvgpr_read_b32 v20, a112
v_accvgpr_read_b32 v21, a113
v_accvgpr_read_b32 v22, a114
v_accvgpr_read_b32 v23, a115
v_pk_mul_f32 v[20:21], v[20:21], s[94:95] op_sel_hi:[1,0]
v_pk_mul_f32 v[22:23], v[22:23], s[94:95] op_sel_hi:[1,0]
v_cvt_pk_bf16_f32 v144, v20, v21
v_cvt_pk_bf16_f32 v145, v22, v23
v_accvgpr_read_b32 v20, a144
v_accvgpr_read_b32 v21, a145
v_accvgpr_read_b32 v22, a146
v_accvgpr_read_b32 v23, a147
v_pk_mul_f32 v[20:21], v[20:21], s[94:95] op_sel_hi:[1,0]
v_pk_mul_f32 v[22:23], v[22:23], s[94:95] op_sel_hi:[1,0]
v_cvt_pk_bf16_f32 v146, v20, v21
v_cvt_pk_bf16_f32 v147, v22, v23
s_add_u32 s29, s29, s93
buffer_store_dwordx4 v[144:147], v13, s[8:11], s29 offen sc1
v_accvgpr_read_b32 v24, a116
v_accvgpr_read_b32 v25, a117
v_accvgpr_read_b32 v26, a118
v_accvgpr_read_b32 v27, a119
v_pk_mul_f32 v[24:25], v[24:25], s[94:95] op_sel_hi:[1,0]
v_pk_mul_f32 v[26:27], v[26:27], s[94:95] op_sel_hi:[1,0]
v_cvt_pk_bf16_f32 v148, v24, v25
v_cvt_pk_bf16_f32 v149, v26, v27
v_accvgpr_read_b32 v24, a148
v_accvgpr_read_b32 v25, a149
v_accvgpr_read_b32 v26, a150
v_accvgpr_read_b32 v27, a151
v_pk_mul_f32 v[24:25], v[24:25], s[94:95] op_sel_hi:[1,0]
v_pk_mul_f32 v[26:27], v[26:27], s[94:95] op_sel_hi:[1,0]
v_cvt_pk_bf16_f32 v150, v24, v25
v_cvt_pk_bf16_f32 v151, v26, v27
s_add_u32 s29, s29, s44
buffer_store_dwordx4 v[148:151], v13, s[8:11], s29 offen sc1
v_accvgpr_read_b32 v20, a120
v_accvgpr_read_b32 v21, a121
v_accvgpr_read_b32 v22, a122
v_accvgpr_read_b32 v23, a123
v_pk_mul_f32 v[20:21], v[20:21], s[94:95] op_sel_hi:[1,0]
v_pk_mul_f32 v[22:23], v[22:23], s[94:95] op_sel_hi:[1,0]
v_cvt_pk_bf16_f32 v152, v20, v21
v_cvt_pk_bf16_f32 v153, v22, v23
v_accvgpr_read_b32 v20, a152
v_accvgpr_read_b32 v21, a153
v_accvgpr_read_b32 v22, a154
v_accvgpr_read_b32 v23, a155
v_pk_mul_f32 v[20:21], v[20:21], s[94:95] op_sel_hi:[1,0]
v_pk_mul_f32 v[22:23], v[22:23], s[94:95] op_sel_hi:[1,0]
v_cvt_pk_bf16_f32 v154, v20, v21
v_cvt_pk_bf16_f32 v155, v22, v23
s_add_u32 s29, s29, s93
buffer_store_dwordx4 v[152:155], v13, s[8:11], s29 offen sc1
v_accvgpr_read_b32 v24, a124
v_accvgpr_read_b32 v25, a125
v_accvgpr_read_b32 v26, a126
v_accvgpr_read_b32 v27, a127
v_pk_mul_f32 v[24:25], v[24:25], s[94:95] op_sel_hi:[1,0]
v_pk_mul_f32 v[26:27], v[26:27], s[94:95] op_sel_hi:[1,0]
v_cvt_pk_bf16_f32 v156, v24, v25
v_cvt_pk_bf16_f32 v157, v26, v27
v_accvgpr_read_b32 v24, a156
v_accvgpr_read_b32 v25, a157
v_accvgpr_read_b32 v26, a158
v_accvgpr_read_b32 v27, a159
v_pk_mul_f32 v[24:25], v[24:25], s[94:95] op_sel_hi:[1,0]
v_pk_mul_f32 v[26:27], v[26:27], s[94:95] op_sel_hi:[1,0]
v_cvt_pk_bf16_f32 v158, v24, v25
v_cvt_pk_bf16_f32 v159, v26, v27
s_add_u32 s29, s29, s44
buffer_store_dwordx4 v[156:159], v13, s[8:11], s29 offen sc1
v_mov_b32 v20, 128
s_mov_b32 s28, 0
L_poll_10:
buffer_load_dword v21, v20, s[56:59], 0 offen sc1
s_add_u32 s28, s28, 1
s_cmp_gt_u32 s28, 40000
s_cbranch_scc1 L_end
s_waitcnt vmcnt(0)
v_cmp_ne_u32 vcc, 8, v21
s_cbranch_vccz L_pd_11
s_sleep 1
s_branch L_poll_10
L_pd_11:
s_andn2_b32 s24, s91, s17
s_cbranch_scc0 L_g_h2
s_barrier
s_add_u32 s60, s63, 32
v_mov_b32 v16, 0
v_mov_b32 v17, 1
s_cmp_eq_u32 s17, 0
s_cselect_b32 s29, s60, 536870912
s_mov_b64 exec, 1
buffer_store_dword v17, v16, s[8:11], s29 offen sc1
s_mov_b64 exec, -1
L_g_h2:
s_waitcnt vmcnt(0) lgkmcnt(0)
s_barrier
v_mov_b32 v16, 0
v_mov_b32 v17, 1
s_cmp_eq_u32 s17, 0
s_cselect_b32 s29, s63, 536870912
s_mov_b64 exec, 1
buffer_store_dword v17, v16, s[8:11], s29 offen sc1
s_mov_b64 exec, -1
s_mov_b32 s62, 536870912
s_mov_b32 s63, 536870912
s_cmp_lt_u32 s35, s45
s_cbranch_scc1 L_g_go
s_cmp_eq_u32 s3, 1
s_cbranch_scc1 L_part
s_cmp_eq_u32 s61, 1
s_cbranch_scc1 L_bdie
s_sub_u32 s24, s3, 4
s_lshl_b32 s24, s24, 3
s_lshr_b32 s42, s16, 2
s_add_u32 s42, s42, s24
s_and_b32 s62, s16, 3
s_mov_b32 s40, 0x3e0293ee
s_mov_b32 s50, 0xf149f2ca
s_mov_b32 s51, 0x41a00000
v_and_b32 v20, 7, v0
v_lshlrev_b32 v20, 2, v20
v_bfe_u32 v21, v0, 3, 1
s_lshl_b32 s25, s42, 7
s_add_u32 s25, s25, 111165440
s_lshr_b32 s24, s42, 1
s_lshl_b32 s24, s24, 7
s_add_u32 s24, s24, 111173632
s_sub_u32 s24, s24, s25
v_mad_u32_u24 v20, v21, s24, v20
s_mov_b32 s28, 0
L_poll_12:
buffer_load_dword v21, v20, s[8:11], s25 offen sc1
s_add_u32 s28, s28, 1
s_cmp_gt_u32 s28, 40000
s_cbranch_scc1 L_end
s_waitcnt vmcnt(0)
v_cmp_ne_u32 vcc, 1, v21
s_cbranch_vccz L_pd_13
s_sleep 1
s_branch L_poll_12
L_pd_13:
s_sub_u32 s41, 7, s62
s_mov_b32 s63, s62
v_and_b32 v6, 63, v0
v_lshlrev_b32 v6, 4, v6
v_and_b32 v16, 0x380, v6
s_lshl_b32 s24, s17, 13
v_add3_u32 v1, v6, v16, s24
v_and_b32 v16, 0x300, v6
s_and_b32 s24, s17, 1
s_lshl_b32 s24, s24, 8
s_lshr_b32 s25, s17, 1
s_lshl_b32 s25, s25, 14
s_add_u32 s24, s24, s25
v_add3_u32 v7, v6, v16, s24
v_and_b32 v5, 15, v0
s_lshl_b32 s24, s17, 4
v_add_u32 v5, s24, v5
v_bfe_u32 v16, v0, 5, 1
v_lshlrev_b32 v16, 4, v16
v_sub_u32 v5, v5, v16
v_bfe_u32 v16, v0, 4, 1
v_lshlrev_b32 v16, 2, v16
v_sub_u32 v5, v5, v16
v_mov_b32 v8, s50
v_mov_b32 v16, 0x3f803f80
v_accvgpr_write_b32 a240, v16
v_accvgpr_write_b32 a241, v16
v_accvgpr_write_b32 a242, v16
v_accvgpr_write_b32 a243, v16
s_lshl_b32 s47, s17, 13
s_mov_b32 s48, 0
s_mov_b32 s60, 536870912
s_lshl_b32 s46, s42, 20
s_add_u32 s46, s46, 0
s_cmp_lt_u32 s63, 8
s_cselect_b32 s46, s46, 536870912
s_add_u32 s24, s46, 4096
s_add_u32 m0, s47, 0
s_nop 0
buffer_load_dwordx4 v1, s[8:11], s46 offen sc1 lds
buffer_load_dwordx4 v1, s[8:11], s46 offen offset:2048 sc1 lds
s_add_u32 m0, s47, 896
s_nop 0
buffer_load_dwordx4 v1, s[8:11], s46 offen offset:128 sc1 lds
buffer_load_dwordx4 v1, s[8:11], s46 offen offset:2176 sc1 lds
s_add_u32 m0, s47, 4096
s_nop 0
buffer_load_dwordx4 v1, s[8:11], s24 offen sc1 lds
buffer_load_dwordx4 v1, s[8:11], s24 offen offset:2048 sc1 lds
s_add_u32 m0, s47, 4992
s_nop 0
buffer_load_dwordx4 v1, s[8:11], s24 offen offset:128 sc1 lds
buffer_load_dwordx4 v1, s[8:11], s24 offen offset:2176 sc1 lds
s_add_u32 s46, s46, 32768
s_add_u32 s47, s47, 32768
s_and_b32 s47, s47, 131071
s_lshr_b32 s26, s42, 1
s_lshl_b32 s26, s26, 3
s_add_u32 s26, s26, s41
s_lshl_b32 s26, s26, 4
s_and_b32 s27, s42, 1
s_add_u32 s26, s26, s27
s_lshl_b32 s26, s26, 13
s_add_u32 s26, s26, 117440512
s_cmp_lt_u32 s41, 8
s_cselect_b32 s26, s26, 536870912
s_add_u32 s27, s26, 0
buffer_load_dwordx4 v[160:163], v7, s[8:11], s27 offen sc1
buffer_load_dwordx4 v[164:167], v7, s[8:11], s27 offen offset:2048 sc1
s_add_u32 s27, s26, 4096
buffer_load_dwordx4 v[168:171], v7, s[8:11], s27 offen sc1
buffer_load_dwordx4 v[172:175], v7, s[8:11], s27 offen offset:2048 sc1
s_add_u32 s27, s26, 32768
buffer_load_dwordx4 v[176:179], v7, s[8:11], s27 offen sc1
buffer_load_dwordx4 v[180:183], v7, s[8:11], s27 offen offset:2048 sc1
s_add_u32 s27, s26, 36864
buffer_load_dwordx4 v[184:187], v7, s[8:11], s27 offen sc1
buffer_load_dwordx4 v[188:191], v7, s[8:11], s27 offen offset:2048 sc1
s_add_u32 s27, s26, 65536
buffer_load_dwordx4 v[192:195], v7, s[8:11], s27 offen sc1
buffer_load_dwordx4 v[196:199], v7, s[8:11], s27 offen offset:2048 sc1
s_add_u32 s27, s26, 69632
buffer_load_dwordx4 v[200:203], v7, s[8:11], s27 offen sc1
buffer_load_dwordx4 v[204:207], v7, s[8:11], s27 offen offset:2048 sc1
s_add_u32 s27, s26, 98304
buffer_load_dwordx4 v[208:211], v7, s[8:11], s27 offen sc1
buffer_load_dwordx4 v[212:215], v7, s[8:11], s27 offen offset:2048 sc1
s_add_u32 s27, s26, 102400
buffer_load_dwordx4 v[216:219], v7, s[8:11], s27 offen sc1
buffer_load_dwordx4 v[220:223], v7, s[8:11], s27 offen offset:2048 sc1
s_add_u32 s24, s46, 4096
s_add_u32 m0, s47, 0
s_nop 0
buffer_load_dwordx4 v1, s[8:11], s46 offen sc1 lds
buffer_load_dwordx4 v1, s[8:11], s46 offen offset:2048 sc1 lds
s_add_u32 m0, s47, 896
s_nop 0
buffer_load_dwordx4 v1, s[8:11], s46 offen offset:128 sc1 lds
buffer_load_dwordx4 v1, s[8:11], s46 offen offset:2176 sc1 lds
s_add_u32 m0, s47, 4096
s_nop 0
buffer_load_dwordx4 v1, s[8:11], s24 offen sc1 lds
buffer_load_dwordx4 v1, s[8:11], s24 offen offset:2048 sc1 lds
s_add_u32 m0, s47, 4992
s_nop 0
buffer_load_dwordx4 v1, s[8:11], s24 offen offset:128 sc1 lds
buffer_load_dwordx4 v1, s[8:11], s24 offen offset:2176 sc1 lds
s_add_u32 s46, s46, 32768
s_add_u32 s47, s47, 32768
s_and_b32 s47, s47, 131071
s_add_u32 s24, s46, 4096
s_add_u32 m0, s47, 0
s_nop 0
buffer_load_dwordx4 v1, s[8:11], s46 offen sc1 lds
buffer_load_dwordx4 v1, s[8:11], s46 offen offset:2048 sc1 lds
s_add_u32 m0, s47, 896
s_nop 0
buffer_load_dwordx4 v1, s[8:11], s46 offen offset:128 sc1 lds
buffer_load_dwordx4 v1, s[8:11], s46 offen offset:2176 sc1 lds
s_add_u32 m0, s47, 4096
s_nop 0
buffer_load_dwordx4 v1, s[8:11], s24 offen sc1 lds
buffer_load_dwordx4 v1, s[8:11], s24 offen offset:2048 sc1 lds
s_add_u32 m0, s47, 4992
s_nop 0
buffer_load_dwordx4 v1, s[8:11], s24 offen offset:128 sc1 lds
buffer_load_dwordx4 v1, s[8:11], s24 offen offset:2176 sc1 lds
s_add_u32 s46, s46, 32768
s_add_u32 s47, s47, 32768
s_and_b32 s47, s47, 131071
s_waitcnt vmcnt(16)
L_at_item:
s_lshl_b32 s44, s41, 2
s_mov_b32 s43, 0
s_mov_b32 s54, s50
s_mov_b32 s55, s50
v_mov_b32 v2, v6
v_add_u32 v3, 32768, v6
v_mov_b32 v4, v6
s_barrier
ds_read_b128 a[64:67], v2
ds_read_b128 a[68:71], v2 offset:1024
ds_read_b128 a[72:75], v2 offset:2048
v_accvgpr_write_b32 a0, v160
v_accvgpr_write_b32 a1, v161
v_accvgpr_write_b32 a2, v162
v_accvgpr_write_b32 a3, v163
v_accvgpr_write_b32 a4, v164
v_accvgpr_write_b32 a5, v165
v_accvgpr_write_b32 a6, v166
v_accvgpr_write_b32 a7, v167
v_accvgpr_write_b32 a8, v168
v_accvgpr_write_b32 a9, v169
v_accvgpr_write_b32 a10, v170
v_accvgpr_write_b32 a11, v171
v_accvgpr_write_b32 a12, v172
v_accvgpr_write_b32 a13, v173
v_accvgpr_write_b32 a14, v174
v_accvgpr_write_b32 a15, v175
v_accvgpr_write_b32 a16, v176
v_accvgpr_write_b32 a17, v177
v_accvgpr_write_b32 a18, v178
v_accvgpr_write_b32 a19, v179
v_accvgpr_write_b32 a20, v180
v_accvgpr_write_b32 a21, v181
v_accvgpr_write_b32 a22, v182
v_accvgpr_write_b32 a23, v183
v_accvgpr_write_b32 a24, v184
v_accvgpr_write_b32 a25, v185
v_accvgpr_write_b32 a26, v186
v_accvgpr_write_b32 a27, v187
v_accvgpr_write_b32 a28, v188
v_accvgpr_write_b32 a29, v189
v_accvgpr_write_b32 a30, v190
v_accvgpr_write_b32 a31, v191
v_accvgpr_write_b32 a32, v192
v_accvgpr_write_b32 a33, v193
v_accvgpr_write_b32 a34, v194
v_accvgpr_write_b32 a35, v195
v_accvgpr_write_b32 a36, v196
v_accvgpr_write_b32 a37, v197
v_accvgpr_write_b32 a38, v198
v_accvgpr_write_b32 a39, v199
v_accvgpr_write_b32 a40, v200
v_accvgpr_write_b32 a41, v201
v_accvgpr_write_b32 a42, v202
v_accvgpr_write_b32 a43, v203
v_accvgpr_write_b32 a44, v204
v_accvgpr_write_b32 a45, v205
v_accvgpr_write_b32 a46, v206
v_accvgpr_write_b32 a47, v207
v_accvgpr_write_b32 a48, v208
v_accvgpr_write_b32 a49, v209
v_accvgpr_write_b32 a50, v210
v_accvgpr_write_b32 a51, v211
v_accvgpr_write_b32 a52, v212
v_accvgpr_write_b32 a53, v213
v_accvgpr_write_b32 a54, v214
v_accvgpr_write_b32 a55, v215
v_accvgpr_write_b32 a56, v216
v_accvgpr_write_b32 a57, v217
v_accvgpr_write_b32 a58, v218
v_accvgpr_write_b32 a59, v219
v_accvgpr_write_b32 a60, v220
v_accvgpr_write_b32 a61, v221
v_accvgpr_write_b32 a62, v222
v_accvgpr_write_b32 a63, v223
v_mov_b64 v[112:113], 0
v_mov_b64 v[114:115], 0
v_mov_b64 v[116:117], 0
v_mov_b64 v[118:119], 0
v_mov_b64 v[120:121], 0
v_mov_b64 v[122:123], 0
v_mov_b64 v[124:125], 0
v_mov_b64 v[126:127], 0
v_mov_b64 v[128:129], 0
v_mov_b64 v[130:131], 0
v_mov_b64 v[132:133], 0
v_mov_b64 v[134:135], 0
v_mov_b64 v[136:137], 0
v_mov_b64 v[138:139], 0
v_mov_b64 v[140:141], 0
v_mov_b64 v[142:143], 0
s_waitcnt lgkmcnt(2)
v_mfma_f32_16x16x32_bf16 v[32:35], a[64:67], a[0:3], v[128:131]
ds_read_b128 a[76:79], v2 offset:3072
s_lshr_b32 s26, s42, 1
s_lshl_b32 s26, s26, 3
v_accvgpr_write_b32 a96, 0
v_accvgpr_write_b32 a97, 0
v_mfma_f32_16x16x32_bf16 v[40:43], a[64:67], a[16:19], v[132:135]
s_add_u32 s26, s26, s63
v_accvgpr_write_b32 a98, 0
v_accvgpr_write_b32 a99, 0
v_accvgpr_write_b32 a100, 0
v_accvgpr_write_b32 a101, 0
v_accvgpr_write_b32 a102, 0
v_mfma_f32_16x16x32_bf16 v[48:51], a[64:67], a[32:35], v[136:139]
s_lshl_b32 s26, s26, 4
v_accvgpr_write_b32 a103, 0
v_accvgpr_write_b32 a104, 0
v_accvgpr_write_b32 a105, 0
v_accvgpr_write_b32 a106, 0
v_accvgpr_write_b32 a107, 0
v_mfma_f32_16x16x32_bf16 v[56:59], a[64:67], a[48:51], v[140:143]
s_waitcnt lgkmcnt(2)
s_and_b32 s27, s42, 1
v_accvgpr_write_b32 a108, 0
v_accvgpr_write_b32 a109, 0
v_accvgpr_write_b32 a110, 0
v_accvgpr_write_b32 a111, 0
v_accvgpr_write_b32 a112, 0
v_mfma_f32_16x16x32_bf16 v[36:39], a[68:71], a[0:3], v[128:131]
ds_read_b128 a[80:83], v2 offset:4096
s_add_u32 s26, s26, s27
v_accvgpr_write_b32 a113, 0
v_accvgpr_write_b32 a114, 0
v_accvgpr_write_b32 a115, 0
v_mfma_f32_16x16x32_bf16 v[44:47], a[68:71], a[16:19], v[132:135]
s_lshl_b32 s26, s26, 13
v_accvgpr_write_b32 a116, 0
v_accvgpr_write_b32 a117, 0
v_accvgpr_write_b32 a118, 0
v_accvgpr_write_b32 a119, 0
v_accvgpr_write_b32 a120, 0
v_mfma_f32_16x16x32_bf16 v[52:55], a[68:71], a[32:35], v[136:139]
s_add_u32 s26, s26, 117440512
v_accvgpr_write_b32 a121, 0
v_accvgpr_write_b32 a122, 0
v_accvgpr_write_b32 a123, 0
v_accvgpr_write_b32 a124, 0
v_accvgpr_write_b32 a125, 0
v_mfma_f32_16x16x32_bf16 v[60:63], a[68:71], a[48:51], v[140:143]
s_waitcnt lgkmcnt(2)
s_cmp_lt_u32 s63, 8
s_cselect_b32 s26, s26, 536870912
v_accvgpr_write_b32 a126, 0
v_accvgpr_write_b32 a127, 0
v_accvgpr_write_b32 a128, 0
v_accvgpr_write_b32 a129, 0
v_mfma_f32_16x16x32_bf16 v[32:35], a[72:75], a[4:7], v[32:35]
ds_read_b128 a[84:87], v2 offset:5120
s_add_u32 s27, s26, 0
v_accvgpr_write_b32 a130, 0
v_accvgpr_write_b32 a131, 0
v_accvgpr_write_b32 a132, 0
v_mfma_f32_16x16x32_bf16 v[40:43], a[72:75], a[20:23], v[40:43]
buffer_load_dwordx4 v[160:163], v7, s[8:11], s27 offen sc1
v_accvgpr_write_b32 a133, 0
v_accvgpr_write_b32 a134, 0
v_accvgpr_write_b32 a135, 0
v_accvgpr_write_b32 a136, 0
v_accvgpr_write_b32 a137, 0
v_mfma_f32_16x16x32_bf16 v[48:51], a[72:75], a[36:39], v[48:51]
buffer_load_dwordx4 v[164:167], v7, s[8:11], s27 offen offset:2048 sc1
v_accvgpr_write_b32 a138, 0
v_accvgpr_write_b32 a139, 0
v_accvgpr_write_b32 a140, 0
v_accvgpr_write_b32 a141, 0
v_mfma_f32_16x16x32_bf16 v[56:59], a[72:75], a[52:55], v[56:59]
s_waitcnt lgkmcnt(2)
s_add_u32 s27, s26, 4096
v_accvgpr_write_b32 a142, 0
v_accvgpr_write_b32 a143, 0
v_accvgpr_write_b32 a144, 0
v_accvgpr_write_b32 a145, 0
v_accvgpr_write_b32 a146, 0
v_mfma_f32_16x16x32_bf16 v[36:39], a[76:79], a[4:7], v[36:39]
ds_read_b128 a[88:91], v2 offset:6144
buffer_load_dwordx4 v[168:171], v7, s[8:11], s27 offen sc1
v_accvgpr_write_b32 a147, 0
v_accvgpr_write_b32 a148, 0
v_accvgpr_write_b32 a149, 0
v_mfma_f32_16x16x32_bf16 v[44:47], a[76:79], a[20:23], v[44:47]
buffer_load_dwordx4 v[172:175], v7, s[8:11], s27 offen offset:2048 sc1
v_accvgpr_write_b32 a150, 0
v_accvgpr_write_b32 a151, 0
v_accvgpr_write_b32 a152, 0
v_accvgpr_write_b32 a153, 0
v_accvgpr_write_b32 a154, 0
v_mfma_f32_16x16x32_bf16 v[52:55], a[76:79], a[36:39], v[52:55]
s_add_u32 s27, s26, 32768
v_accvgpr_write_b32 a155, 0
v_accvgpr_write_b32 a156, 0
v_accvgpr_write_b32 a157, 0
v_accvgpr_write_b32 a158, 0
v_accvgpr_write_b32 a159, 0
v_mfma_f32_16x16x32_bf16 v[60:63], a[76:79], a[52:55], v[60:63]
s_waitcnt lgkmcnt(2)
buffer_load_dwordx4 v[176:179], v7, s[8:11], s27 offen sc1
v_accvgpr_write_b32 a160, 0
v_accvgpr_write_b32 a161, 0
v_accvgpr_write_b32 a162, 0
v_accvgpr_write_b32 a163, 0
v_accvgpr_write_b32 a164, 0
v_mfma_f32_16x16x32_bf16 v[32:35], a[80:83], a[8:11], v[32:35]
ds_read_b128 a[92:95], v2 offset:7168
buffer_load_dwordx4 v[180:183], v7, s[8:11], s27 offen offset:2048 sc1
v_accvgpr_write_b32 a165, 0
v_accvgpr_write_b32 a166, 0
v_accvgpr_write_b32 a167, 0
v_mfma_f32_16x16x32_bf16 v[40:43], a[80:83], a[24:27], v[40:43]
s_add_u32 s27, s26, 36864
v_accvgpr_write_b32 a168, 0
v_accvgpr_write_b32 a169, 0
v_accvgpr_write_b32 a170, 0
v_accvgpr_write_b32 a171, 0
v_accvgpr_write_b32 a172, 0
v_mfma_f32_16x16x32_bf16 v[48:51], a[80:83], a[40:43], v[48:51]
buffer_load_dwordx4 v[184:187], v7, s[8:11], s27 offen sc1
v_accvgpr_write_b32 a173, 0
v_accvgpr_write_b32 a174, 0
v_accvgpr_write_b32 a175, 0
v_accvgpr_write_b32 a176, 0
v_accvgpr_write_b32 a177, 0
v_mfma_f32_16x16x32_bf16 v[56:59], a[80:83], a[56:59], v[56:59]
s_waitcnt lgkmcnt(2)
buffer_load_dwordx4 v[188:191], v7, s[8:11], s27 offen offset:2048 sc1
v_accvgpr_write_b32 a178, 0
v_accvgpr_write_b32 a179, 0
v_accvgpr_write_b32 a180, 0
v_accvgpr_write_b32 a181, 0
v_mfma_f32_16x16x32_bf16 v[36:39], a[84:87], a[8:11], v[36:39]
ds_read_b128 a[64:67], v4 offset:24576
s_add_u32 s27, s26, 65536
v_accvgpr_write_b32 a182, 0
v_accvgpr_write_b32 a183, 0
v_accvgpr_write_b32 a184, 0
v_accvgpr_write_b32 a185, 0
v_mfma_f32_16x16x32_bf16 v[44:47], a[84:87], a[24:27], v[44:47]
buffer_load_dwordx4 v[192:195], v7, s[8:11], s27 offen sc1
v_accvgpr_write_b32 a186, 0
v_accvgpr_write_b32 a187, 0
v_accvgpr_write_b32 a188, 0
v_accvgpr_write_b32 a189, 0
v_mfma_f32_16x16x32_bf16 v[52:55], a[84:87], a[40:43], v[52:55]
buffer_load_dwordx4 v[196:199], v7, s[8:11], s27 offen offset:2048 sc1
v_accvgpr_write_b32 a190, 0
v_accvgpr_write_b32 a191, 0
v_accvgpr_write_b32 a192, 0
v_accvgpr_write_b32 a193, 0
v_accvgpr_write_b32 a194, 0
v_mfma_f32_16x16x32_bf16 v[60:63], a[84:87], a[56:59], v[60:63]
s_waitcnt lgkmcnt(2)
s_add_u32 s27, s26, 69632
v_accvgpr_write_b32 a195, 0
v_accvgpr_write_b32 a196, 0
v_accvgpr_write_b32 a197, 0
v_accvgpr_write_b32 a198, 0
v_mfma_f32_16x16x32_bf16 v[32:35], a[88:91], a[12:15], v[32:35]
ds_read_b128 a[68:71], v4 offset:25600
buffer_load_dwordx4 v[200:203], v7, s[8:11], s27 offen sc1
v_accvgpr_write_b32 a199, 0
v_accvgpr_write_b32 a200, 0
v_accvgpr_write_b32 a201, 0
v_accvgpr_write_b32 a202, 0
v_mfma_f32_16x16x32_bf16 v[40:43], a[88:91], a[28:31], v[40:43]
buffer_load_dwordx4 v[204:207], v7, s[8:11], s27 offen offset:2048 sc1
v_accvgpr_write_b32 a203, 0
v_accvgpr_write_b32 a204, 0
v_accvgpr_write_b32 a205, 0
v_accvgpr_write_b32 a206, 0
v_accvgpr_write_b32 a207, 0
v_mfma_f32_16x16x32_bf16 v[48:51], a[88:91], a[44:47], v[48:51]
s_add_u32 s27, s26, 98304
v_accvgpr_write_b32 a208, 0
v_accvgpr_write_b32 a209, 0
v_accvgpr_write_b32 a210, 0
v_accvgpr_write_b32 a211, 0
v_accvgpr_write_b32 a212, 0
v_mfma_f32_16x16x32_bf16 v[56:59], a[88:91], a[60:63], v[56:59]
s_waitcnt lgkmcnt(2)
buffer_load_dwordx4 v[208:211], v7, s[8:11], s27 offen sc1
v_accvgpr_write_b32 a213, 0
v_accvgpr_write_b32 a214, 0
v_accvgpr_write_b32 a215, 0
v_accvgpr_write_b32 a216, 0
v_accvgpr_write_b32 a217, 0
v_mfma_f32_16x16x32_bf16 v[36:39], a[92:95], a[12:15], v[36:39]
ds_read_b128 a[72:75], v4 offset:26624
buffer_load_dwordx4 v[212:215], v7, s[8:11], s27 offen offset:2048 sc1
v_accvgpr_write_b32 a218, 0
v_accvgpr_write_b32 a219, 0
v_accvgpr_write_b32 a220, 0
v_mfma_f32_16x16x32_bf16 v[44:47], a[92:95], a[28:31], v[44:47]
s_add_u32 s27, s26, 102400
v_accvgpr_write_b32 a221, 0
v_accvgpr_write_b32 a222, 0
v_accvgpr_write_b32 a223, 0
v_accvgpr_write_b32 a224, 0
v_accvgpr_write_b32 a225, 0
v_mfma_f32_16x16x32_bf16 v[52:55], a[92:95], a[44:47], v[52:55]
buffer_load_dwordx4 v[216:219], v7, s[8:11], s27 offen sc1
v_accvgpr_write_b32 a226, 0
v_accvgpr_write_b32 a227, 0
v_accvgpr_write_b32 a228, 0
v_accvgpr_write_b32 a229, 0
v_accvgpr_write_b32 a230, 0
v_mfma_f32_16x16x32_bf16 v[60:63], a[92:95], a[60:63], v[60:63]
s_waitcnt lgkmcnt(2)
buffer_load_dwordx4 v[220:223], v7, s[8:11], s27 offen offset:2048 sc1
v_accvgpr_write_b32 a231, 0
v_accvgpr_write_b32 a232, 0
v_accvgpr_write_b32 a233, 0
v_accvgpr_write_b32 a234, 0
v_accvgpr_write_b32 a235, 0
v_accvgpr_write_b32 a236, 0
v_accvgpr_write_b32 a237, 0
v_accvgpr_write_b32 a238, 0
v_accvgpr_write_b32 a239, 0
s_cmp_eq_u32 s44, 0
s_cbranch_scc1 L_at_last
.p2align 3
L_at_loop:
v_mfma_f32_16x16x32_bf16 a[224:227], a[240:243], v[112:115], a[224:227]
s_add_u32 s43, s43, 1
v_mfma_f32_16x16x32_bf16 a[228:231], a[240:243], v[116:119], a[228:231]
v_mfma_f32_16x16x32_bf16 a[232:235], a[240:243], v[120:123], a[232:235]
v_mfma_f32_16x16x32_bf16 a[236:239], a[240:243], v[124:127], a[236:239]
v_max3_f32 v16, v32, v33, v34
v_max3_f32 v16, v16, v35, v40
v_mfma_f32_16x16x32_bf16 a[96:99], a[64:67], v[112:115], a[96:99]
ds_read_b128 a[76:79], v4 offset:27648
v_max3_f32 v16, v16, v41, v42
v_mfma_f32_16x16x32_bf16 a[100:103], a[64:67], v[116:119], a[100:103]
v_max3_f32 v16, v16, v43, v48
v_max3_f32 v16, v16, v49, v50
v_mfma_f32_16x16x32_bf16 a[104:107], a[64:67], v[120:123], a[104:107]
v_max3_f32 v16, v16, v51, v56
v_max3_f32 v16, v16, v57, v58
v_mfma_f32_16x16x32_bf16 a[108:111], a[64:67], v[124:127], a[108:111]
s_waitcnt lgkmcnt(2)
v_max3_f32 v16, v16, v59, v36
v_max3_f32 v16, v16, v37, v38
v_mfma_f32_16x16x32_bf16 a[112:115], a[68:71], v[112:115], a[112:115]
ds_read_b128 a[80:83], v4 offset:28672
v_max3_f32 v16, v16, v39, v44
v_mfma_f32_16x16x32_bf16 a[116:119], a[68:71], v[116:119], a[116:119]
v_max3_f32 v16, v16, v45, v46
v_max3_f32 v16, v16, v47, v52
v_mfma_f32_16x16x32_bf16 a[120:123], a[68:71], v[120:123], a[120:123]
v_max3_f32 v16, v16, v53, v54
v_max3_f32 v16, v16, v55, v60
v_mfma_f32_16x16x32_bf16 a[124:127], a[68:71], v[124:127], a[124:127]
s_waitcnt lgkmcnt(2)
v_max3_f32 v16, v16, v61, v62
v_max_f32 v16, v16, v63
v_mfma_f32_16x16x32_bf16 a[128:131], a[72:75], v[112:115], a[128:131]
ds_read_b128 a[84:87], v4 offset:29696
v_cmp_lt_f32 vcc, s54, v16
v_mfma_f32_16x16x32_bf16 a[132:135], a[72:75], v[116:119], a[132:135]
s_cbranch_vccnz L_at_up0
L_at_upr0:
v_mfma_f32_16x16x32_bf16 a[136:139], a[72:75], v[120:123], a[136:139]
v_exp_f32 v32, v32
v_mfma_f32_16x16x32_bf16 a[140:143], a[72:75], v[124:127], a[140:143]
s_waitcnt lgkmcnt(2)
v_exp_f32 v33, v33
v_mfma_f32_16x16x32_bf16 a[144:147], a[76:79], v[112:115], a[144:147]
ds_read_b128 a[88:91], v4 offset:30720
v_cvt_pk_bf16_f32 v96, v32, v33
v_mfma_f32_16x16x32_bf16 a[148:151], a[76:79], v[116:119], a[148:151]
v_exp_f32 v34, v34
v_mfma_f32_16x16x32_bf16 a[152:155], a[76:79], v[120:123], a[152:155]
v_exp_f32 v35, v35
v_mfma_f32_16x16x32_bf16 a[156:159], a[76:79], v[124:127], a[156:159]
s_waitcnt lgkmcnt(2)
v_exp_f32 v36, v36
v_mfma_f32_16x16x32_bf16 a[160:163], a[80:83], v[112:115], a[160:163]
ds_read_b128 a[92:95], v4 offset:31744
v_cvt_pk_bf16_f32 v97, v34, v35
v_mfma_f32_16x16x32_bf16 a[164:167], a[80:83], v[116:119], a[164:167]
v_exp_f32 v37, v37
v_mfma_f32_16x16x32_bf16 a[168:171], a[80:83], v[120:123], a[168:171]
v_exp_f32 v38, v38
v_mfma_f32_16x16x32_bf16 a[172:175], a[80:83], v[124:127], a[172:175]
s_waitcnt lgkmcnt(2)
v_exp_f32 v39, v39
v_mfma_f32_16x16x32_bf16 a[176:179], a[84:87], v[112:115], a[176:179]
ds_read_b128 a[64:67], v2 offset:16384
v_cvt_pk_bf16_f32 v98, v36, v37
v_mfma_f32_16x16x32_bf16 a[180:183], a[84:87], v[116:119], a[180:183]
v_exp_f32 v40, v40
v_mfma_f32_16x16x32_bf16 a[184:187], a[84:87], v[120:123], a[184:187]
v_exp_f32 v41, v41
v_mfma_f32_16x16x32_bf16 a[188:191], a[84:87], v[124:127], a[188:191]
s_waitcnt lgkmcnt(2)
v_exp_f32 v42, v42
v_mfma_f32_16x16x32_bf16 a[192:195], a[88:91], v[112:115], a[192:195]
ds_read_b128 a[68:71], v2 offset:17408
v_cvt_pk_bf16_f32 v99, v38, v39
v_mfma_f32_16x16x32_bf16 a[196:199], a[88:91], v[116:119], a[196:199]
v_exp_f32 v43, v43
v_mfma_f32_16x16x32_bf16 a[200:203], a[88:91], v[120:123], a[200:203]
v_exp_f32 v44, v44
v_mfma_f32_16x16x32_bf16 a[204:207], a[88:91], v[124:127], a[204:207]
s_waitcnt lgkmcnt(2)
v_exp_f32 v45, v45
v_mfma_f32_16x16x32_bf16 a[208:211], a[92:95], v[112:115], a[208:211]
ds_read_b128 a[72:75], v2 offset:18432
v_cvt_pk_bf16_f32 v100, v40, v41
v_mfma_f32_16x16x32_bf16 a[212:215], a[92:95], v[116:119], a[212:215]
v_exp_f32 v46, v46
v_mfma_f32_16x16x32_bf16 a[216:219], a[92:95], v[120:123], a[216:219]
s_cmp_eq_u32 s48, 0
v_exp_f32 v47, v47
v_mfma_f32_16x16x32_bf16 a[220:223], a[92:95], v[124:127], a[220:223]
s_waitcnt lgkmcnt(2)
s_cbranch_scc0 L_at_rs0
L_at_rsr0:
v_mfma_f32_16x16x32_bf16 v[64:67], a[64:67], a[0:3], v[128:131]
ds_read_b128 a[76:79], v2 offset:19456
v_cvt_pk_bf16_f32 v101, v42, v43
v_mfma_f32_16x16x32_bf16 v[72:75], a[64:67], a[16:19], v[132:135]
v_exp_f32 v48, v48
v_mfma_f32_16x16x32_bf16 v[80:83], a[64:67], a[32:35], v[136:139]
v_exp_f32 v49, v49
v_mfma_f32_16x16x32_bf16 v[88:91], a[64:67], a[48:51], v[140:143]
s_waitcnt lgkmcnt(2)
v_exp_f32 v50, v50
v_mfma_f32_16x16x32_bf16 v[68:71], a[68:71], a[0:3], v[128:131]
ds_read_b128 a[80:83], v2 offset:20480
v_cvt_pk_bf16_f32 v102, v44, v45
v_mfma_f32_16x16x32_bf16 v[76:79], a[68:71], a[16:19], v[132:135]
v_exp_f32 v51, v51
v_mfma_f32_16x16x32_bf16 v[84:87], a[68:71], a[32:35], v[136:139]
v_exp_f32 v52, v52
v_mfma_f32_16x16x32_bf16 v[92:95], a[68:71], a[48:51], v[140:143]
s_waitcnt lgkmcnt(2)
v_exp_f32 v53, v53
v_mfma_f32_16x16x32_bf16 v[64:67], a[72:75], a[4:7], v[64:67]
ds_read_b128 a[84:87], v2 offset:21504
v_cvt_pk_bf16_f32 v103, v46, v47
v_mfma_f32_16x16x32_bf16 v[72:75], a[72:75], a[20:23], v[72:75]
v_exp_f32 v54, v54
v_mfma_f32_16x16x32_bf16 v[80:83], a[72:75], a[36:39], v[80:83]
v_exp_f32 v55, v55
v_mfma_f32_16x16x32_bf16 v[88:91], a[72:75], a[52:55], v[88:91]
s_waitcnt lgkmcnt(2)
v_exp_f32 v56, v56
v_mfma_f32_16x16x32_bf16 v[68:71], a[76:79], a[4:7], v[68:71]
ds_read_b128 a[88:91], v2 offset:22528
v_cvt_pk_bf16_f32 v104, v48, v49
v_mfma_f32_16x16x32_bf16 v[76:79], a[76:79], a[20:23], v[76:79]
v_exp_f32 v57, v57
v_mfma_f32_16x16x32_bf16 v[84:87], a[76:79], a[36:39], v[84:87]
v_exp_f32 v58, v58
v_mfma_f32_16x16x32_bf16 v[92:95], a[76:79], a[52:55], v[92:95]
s_waitcnt lgkmcnt(2)
v_exp_f32 v59, v59
v_mfma_f32_16x16x32_bf16 v[64:67], a[80:83], a[8:11], v[64:67]
ds_read_b128 a[92:95], v2 offset:23552
v_cvt_pk_bf16_f32 v105, v50, v51
v_mfma_f32_16x16x32_bf16 v[72:75], a[80:83], a[24:27], v[72:75]
v_exp_f32 v60, v60
v_mfma_f32_16x16x32_bf16 v[80:83], a[80:83], a[40:43], v[80:83]
v_exp_f32 v61, v61
v_mfma_f32_16x16x32_bf16 v[88:91], a[80:83], a[56:59], v[88:91]
s_waitcnt lgkmcnt(2)
v_exp_f32 v62, v62
v_mfma_f32_16x16x32_bf16 v[68:71], a[84:87], a[8:11], v[68:71]
ds_read_b128 a[64:67], v2 offset:8192
v_cvt_pk_bf16_f32 v106, v52, v53
v_mfma_f32_16x16x32_bf16 v[76:79], a[84:87], a[24:27], v[76:79]
v_exp_f32 v63, v63
v_mfma_f32_16x16x32_bf16 v[84:87], a[84:87], a[40:43], v[84:87]
v_cvt_pk_bf16_f32 v107, v54, v55
v_cvt_pk_bf16_f32 v108, v56, v57
v_mfma_f32_16x16x32_bf16 v[92:95], a[84:87], a[56:59], v[92:95]
s_waitcnt lgkmcnt(2)
v_cvt_pk_bf16_f32 v109, v58, v59
v_cvt_pk_bf16_f32 v110, v60, v61
v_mfma_f32_16x16x32_bf16 v[64:67], a[88:91], a[12:15], v[64:67]
ds_read_b128 a[68:71], v2 offset:9216
v_cvt_pk_bf16_f32 v111, v62, v63
v_mfma_f32_16x16x32_bf16 v[72:75], a[88:91], a[28:31], v[72:75]
v_mfma_f32_16x16x32_bf16 v[80:83], a[88:91], a[44:47], v[80:83]
v_mfma_f32_16x16x32_bf16 v[88:91], a[88:91], a[60:63], v[88:91]
s_waitcnt lgkmcnt(2)
v_mfma_f32_16x16x32_bf16 v[68:71], a[92:95], a[12:15], v[68:71]
ds_read_b128 a[72:75], v2 offset:10240
v_mfma_f32_16x16x32_bf16 v[76:79], a[92:95], a[28:31], v[76:79]
v_mfma_f32_16x16x32_bf16 v[84:87], a[92:95], a[44:47], v[84:87]
v_mfma_f32_16x16x32_bf16 v[92:95], a[92:95], a[60:63], v[92:95]
s_waitcnt lgkmcnt(2)
s_waitcnt vmcnt(8)
s_barrier
v_mfma_f32_16x16x32_bf16 a[224:227], a[240:243], v[96:99], a[224:227]
s_add_u32 s24, s46, 4096
s_add_u32 m0, s47, 0
v_mfma_f32_16x16x32_bf16 a[228:231], a[240:243], v[100:103], a[228:231]
buffer_load_dwordx4 v1, s[8:11], s46 offen sc1 lds
v_mfma_f32_16x16x32_bf16 a[232:235], a[240:243], v[104:107], a[232:235]
buffer_load_dwordx4 v1, s[8:11], s46 offen offset:2048 sc1 lds
v_mfma_f32_16x16x32_bf16 a[236:239], a[240:243], v[108:111], a[236:239]
v_max3_f32 v16, v64, v65, v66
v_max3_f32 v16, v16, v67, v72
v_mfma_f32_16x16x32_bf16 a[96:99], a[64:67], v[96:99], a[96:99]
ds_read_b128 a[76:79], v2 offset:11264
v_max3_f32 v16, v16, v73, v74
v_mfma_f32_16x16x32_bf16 a[100:103], a[64:67], v[100:103], a[100:103]
s_add_u32 m0, s47, 896
v_max3_f32 v16, v16, v75, v80
v_max3_f32 v16, v16, v81, v82
v_mfma_f32_16x16x32_bf16 a[104:107], a[64:67], v[104:107], a[104:107]
v_max3_f32 v16, v16, v83, v88
v_max3_f32 v16, v16, v89, v90
v_mfma_f32_16x16x32_bf16 a[108:111], a[64:67], v[108:111], a[108:111]
s_waitcnt lgkmcnt(2)
v_max3_f32 v16, v16, v91, v68
v_max3_f32 v16, v16, v69, v70
v_mfma_f32_16x16x32_bf16 a[112:115], a[68:71], v[96:99], a[112:115]
ds_read_b128 a[80:83], v2 offset:12288
v_max3_f32 v16, v16, v71, v76
v_mfma_f32_16x16x32_bf16 a[116:119], a[68:71], v[100:103], a[116:119]
buffer_load_dwordx4 v1, s[8:11], s46 offen offset:128 sc1 lds
v_max3_f32 v16, v16, v77, v78
v_mfma_f32_16x16x32_bf16 a[120:123], a[68:71], v[104:107], a[120:123]
v_max3_f32 v16, v16, v79, v84
v_max3_f32 v16, v16, v85, v86
v_mfma_f32_16x16x32_bf16 a[124:127], a[68:71], v[108:111], a[124:127]
s_waitcnt lgkmcnt(2)
v_max3_f32 v16, v16, v87, v92
v_max3_f32 v16, v16, v93, v94
v_mfma_f32_16x16x32_bf16 a[128:131], a[72:75], v[96:99], a[128:131]
ds_read_b128 a[84:87], v2 offset:13312
v_max_f32 v16, v16, v95
v_cmp_lt_f32 vcc, s54, v16
v_mfma_f32_16x16x32_bf16 a[132:135], a[72:75], v[100:103], a[132:135]
buffer_load_dwordx4 v1, s[8:11], s46 offen offset:2176 sc1 lds
s_cbranch_vccnz L_at_up1
L_at_upr1:
v_mfma_f32_16x16x32_bf16 a[136:139], a[72:75], v[104:107], a[136:139]
v_exp_f32 v64, v64
v_mfma_f32_16x16x32_bf16 a[140:143], a[72:75], v[108:111], a[140:143]
s_waitcnt lgkmcnt(2)
v_exp_f32 v65, v65
v_mfma_f32_16x16x32_bf16 a[144:147], a[76:79], v[96:99], a[144:147]
ds_read_b128 a[88:91], v2 offset:14336
v_cvt_pk_bf16_f32 v112, v64, v65
v_mfma_f32_16x16x32_bf16 a[148:151], a[76:79], v[100:103], a[148:151]
v_exp_f32 v66, v66
v_mfma_f32_16x16x32_bf16 a[152:155], a[76:79], v[104:107], a[152:155]
s_add_u32 m0, s47, 4096
v_exp_f32 v67, v67
v_mfma_f32_16x16x32_bf16 a[156:159], a[76:79], v[108:111], a[156:159]
s_waitcnt lgkmcnt(2)
v_exp_f32 v68, v68
v_mfma_f32_16x16x32_bf16 a[160:163], a[80:83], v[96:99], a[160:163]
ds_read_b128 a[92:95], v2 offset:15360
v_cvt_pk_bf16_f32 v113, v66, v67
v_mfma_f32_16x16x32_bf16 a[164:167], a[80:83], v[100:103], a[164:167]
v_exp_f32 v69, v69
v_mfma_f32_16x16x32_bf16 a[168:171], a[80:83], v[104:107], a[168:171]
buffer_load_dwordx4 v1, s[8:11], s24 offen sc1 lds
v_cvt_pk_bf16_f32 v114, v68, v69
v_mfma_f32_16x16x32_bf16 a[172:175], a[80:83], v[108:111], a[172:175]
s_waitcnt lgkmcnt(2)
v_exp_f32 v70, v70
v_mfma_f32_16x16x32_bf16 a[176:179], a[84:87], v[96:99], a[176:179]
ds_read_b128 a[64:67], v3
v_mfma_f32_16x16x32_bf16 a[180:183], a[84:87], v[100:103], a[180:183]
v_exp_f32 v71, v71
v_mfma_f32_16x16x32_bf16 a[184:187], a[84:87], v[104:107], a[184:187]
v_exp_f32 v72, v72
v_mfma_f32_16x16x32_bf16 a[188:191], a[84:87], v[108:111], a[188:191]
s_waitcnt lgkmcnt(2)
v_exp_f32 v73, v73
v_mfma_f32_16x16x32_bf16 a[192:195], a[88:91], v[96:99], a[192:195]
ds_read_b128 a[68:71], v3 offset:1024
v_cvt_pk_bf16_f32 v115, v70, v71
v_mfma_f32_16x16x32_bf16 a[196:199], a[88:91], v[100:103], a[196:199]
buffer_load_dwordx4 v1, s[8:11], s24 offen offset:2048 sc1 lds
v_cvt_pk_bf16_f32 v116, v72, v73
v_mfma_f32_16x16x32_bf16 a[200:203], a[88:91], v[104:107], a[200:203]
v_exp_f32 v74, v74
v_mfma_f32_16x16x32_bf16 a[204:207], a[88:91], v[108:111], a[204:207]
s_waitcnt lgkmcnt(2)
v_exp_f32 v75, v75
v_mfma_f32_16x16x32_bf16 a[208:211], a[92:95], v[96:99], a[208:211]
ds_read_b128 a[72:75], v3 offset:2048
v_cvt_pk_bf16_f32 v117, v74, v75
v_mfma_f32_16x16x32_bf16 a[212:215], a[92:95], v[100:103], a[212:215]
s_add_u32 m0, s47, 4992
v_exp_f32 v76, v76
v_mfma_f32_16x16x32_bf16 a[216:219], a[92:95], v[104:107], a[216:219]
s_cmp_eq_u32 s48, 0
v_exp_f32 v77, v77
v_mfma_f32_16x16x32_bf16 a[220:223], a[92:95], v[108:111], a[220:223]
s_waitcnt lgkmcnt(2)
s_cbranch_scc0 L_at_rs1
L_at_rsr1:
v_mfma_f32_16x16x32_bf16 v[32:35], a[64:67], a[0:3], v[128:131]
ds_read_b128 a[76:79], v3 offset:3072
v_cvt_pk_bf16_f32 v118, v76, v77
v_mfma_f32_16x16x32_bf16 v[40:43], a[64:67], a[16:19], v[132:135]
v_exp_f32 v78, v78
v_mfma_f32_16x16x32_bf16 v[48:51], a[64:67], a[32:35], v[136:139]
buffer_load_dwordx4 v1, s[8:11], s24 offen offset:128 sc1 lds
v_mfma_f32_16x16x32_bf16 v[56:59], a[64:67], a[48:51], v[140:143]
s_waitcnt lgkmcnt(2)
v_exp_f32 v79, v79
v_mfma_f32_16x16x32_bf16 v[36:39], a[68:71], a[0:3], v[128:131]
ds_read_b128 a[80:83], v3 offset:4096
v_cvt_pk_bf16_f32 v119, v78, v79
v_mfma_f32_16x16x32_bf16 v[44:47], a[68:71], a[16:19], v[132:135]
v_exp_f32 v80, v80
v_mfma_f32_16x16x32_bf16 v[52:55], a[68:71], a[32:35], v[136:139]
v_exp_f32 v81, v81
v_mfma_f32_16x16x32_bf16 v[60:63], a[68:71], a[48:51], v[140:143]
s_waitcnt lgkmcnt(2)
v_exp_f32 v82, v82
v_mfma_f32_16x16x32_bf16 v[32:35], a[72:75], a[4:7], v[32:35]
ds_read_b128 a[84:87], v3 offset:5120
v_cvt_pk_bf16_f32 v120, v80, v81
v_mfma_f32_16x16x32_bf16 v[40:43], a[72:75], a[20:23], v[40:43]
buffer_load_dwordx4 v1, s[8:11], s24 offen offset:2176 sc1 lds
v_mfma_f32_16x16x32_bf16 v[48:51], a[72:75], a[36:39], v[48:51]
v_exp_f32 v83, v83
v_mfma_f32_16x16x32_bf16 v[56:59], a[72:75], a[52:55], v[56:59]
s_waitcnt lgkmcnt(2)
v_exp_f32 v84, v84
v_mfma_f32_16x16x32_bf16 v[36:39], a[76:79], a[4:7], v[36:39]
ds_read_b128 a[88:91], v3 offset:6144
v_cvt_pk_bf16_f32 v121, v82, v83
v_mfma_f32_16x16x32_bf16 v[44:47], a[76:79], a[20:23], v[44:47]
s_add_u32 s46, s46, 32768
v_exp_f32 v85, v85
v_mfma_f32_16x16x32_bf16 v[52:55], a[76:79], a[36:39], v[52:55]
v_exp_f32 v86, v86
v_mfma_f32_16x16x32_bf16 v[60:63], a[76:79], a[52:55], v[60:63]
s_waitcnt lgkmcnt(2)
v_exp_f32 v87, v87
v_mfma_f32_16x16x32_bf16 v[32:35], a[80:83], a[8:11], v[32:35]
ds_read_b128 a[92:95], v3 offset:7168
v_cvt_pk_bf16_f32 v122, v84, v85
v_mfma_f32_16x16x32_bf16 v[40:43], a[80:83], a[24:27], v[40:43]
v_exp_f32 v88, v88
v_mfma_f32_16x16x32_bf16 v[48:51], a[80:83], a[40:43], v[48:51]
s_add_u32 s47, s47, 32768
v_exp_f32 v89, v89
v_mfma_f32_16x16x32_bf16 v[56:59], a[80:83], a[56:59], v[56:59]
s_waitcnt lgkmcnt(2)
v_exp_f32 v90, v90
v_mfma_f32_16x16x32_bf16 v[36:39], a[84:87], a[8:11], v[36:39]
ds_read_b128 a[64:67], v2 offset:24576
v_cvt_pk_bf16_f32 v123, v86, v87
v_mfma_f32_16x16x32_bf16 v[44:47], a[84:87], a[24:27], v[44:47]
v_exp_f32 v91, v91
v_mfma_f32_16x16x32_bf16 v[52:55], a[84:87], a[40:43], v[52:55]
s_and_b32 s47, s47, 131071
v_exp_f32 v92, v92
v_mfma_f32_16x16x32_bf16 v[60:63], a[84:87], a[56:59], v[60:63]
s_waitcnt lgkmcnt(2)
v_exp_f32 v93, v93
v_mfma_f32_16x16x32_bf16 v[32:35], a[88:91], a[12:15], v[32:35]
ds_read_b128 a[68:71], v2 offset:25600
v_cvt_pk_bf16_f32 v124, v88, v89
v_mfma_f32_16x16x32_bf16 v[40:43], a[88:91], a[28:31], v[40:43]
v_exp_f32 v94, v94
v_mfma_f32_16x16x32_bf16 v[48:51], a[88:91], a[44:47], v[48:51]
v_exp_f32 v95, v95
v_mfma_f32_16x16x32_bf16 v[56:59], a[88:91], a[60:63], v[56:59]
s_waitcnt lgkmcnt(2)
v_cvt_pk_bf16_f32 v125, v90, v91
v_cvt_pk_bf16_f32 v126, v92, v93
v_mfma_f32_16x16x32_bf16 v[36:39], a[92:95], a[12:15], v[36:39]
ds_read_b128 a[72:75], v2 offset:26624
v_cvt_pk_bf16_f32 v127, v94, v95
v_mfma_f32_16x16x32_bf16 v[44:47], a[92:95], a[28:31], v[44:47]
s_cmp_lt_u32 s43, s44
v_mov_b32 v4, v2
v_mov_b32 v2, v3
v_mfma_f32_16x16x32_bf16 v[52:55], a[92:95], a[44:47], v[52:55]
v_add_u32 v3, 32768, v3
v_and_b32 v3, 131071, v3
v_mfma_f32_16x16x32_bf16 v[60:63], a[92:95], a[60:63], v[60:63]
s_waitcnt lgkmcnt(2)
s_cbranch_scc1 L_at_loop
L_at_last:
v_mfma_f32_16x16x32_bf16 a[224:227], a[240:243], v[112:115], a[224:227]
s_lshl_b32 s61, s41, 4
v_mfma_f32_16x16x32_bf16 a[228:231], a[240:243], v[116:119], a[228:231]
v_mfma_f32_16x16x32_bf16 a[232:235], a[240:243], v[120:123], a[232:235]
v_mfma_f32_16x16x32_bf16 a[236:239], a[240:243], v[124:127], a[236:239]
v_cmp_le_i32 s[30:31], 0, v5
v_cmp_le_i32 s[32:33], 1, v5
v_mfma_f32_16x16x32_bf16 a[96:99], a[64:67], v[112:115], a[96:99]
ds_read_b128 a[76:79], v4 offset:27648
v_cmp_le_i32 s[34:35], 2, v5
v_mfma_f32_16x16x32_bf16 a[100:103], a[64:67], v[116:119], a[100:103]
v_cmp_le_i32 s[36:37], 3, v5
v_cndmask_b32 v32, v8, v32, s[30:31]
v_mfma_f32_16x16x32_bf16 a[104:107], a[64:67], v[120:123], a[104:107]
s_add_u32 s61, s61, s17
v_cndmask_b32 v33, v8, v33, s[32:33]
v_cndmask_b32 v34, v8, v34, s[34:35]
v_mfma_f32_16x16x32_bf16 a[108:111], a[64:67], v[124:127], a[108:111]
s_waitcnt lgkmcnt(2)
v_cndmask_b32 v35, v8, v35, s[36:37]
v_cmp_le_i32 s[30:31], 8, v5
v_mfma_f32_16x16x32_bf16 a[112:115], a[68:71], v[112:115], a[112:115]
ds_read_b128 a[80:83], v4 offset:28672
v_cmp_le_i32 s[32:33], 9, v5
v_mfma_f32_16x16x32_bf16 a[116:119], a[68:71], v[116:119], a[116:119]
v_cmp_le_i32 s[34:35], 10, v5
v_cmp_le_i32 s[36:37], 11, v5
v_mfma_f32_16x16x32_bf16 a[120:123], a[68:71], v[120:123], a[120:123]
v_cndmask_b32 v36, v8, v36, s[30:31]
v_cndmask_b32 v37, v8, v37, s[32:33]
v_mfma_f32_16x16x32_bf16 a[124:127], a[68:71], v[124:127], a[124:127]
s_waitcnt lgkmcnt(2)
v_cndmask_b32 v38, v8, v38, s[34:35]
v_cndmask_b32 v39, v8, v39, s[36:37]
v_mfma_f32_16x16x32_bf16 a[128:131], a[72:75], v[112:115], a[128:131]
ds_read_b128 a[84:87], v4 offset:29696
v_max3_f32 v16, v32, v33, v34
v_mfma_f32_16x16x32_bf16 a[132:135], a[72:75], v[116:119], a[132:135]
v_max3_f32 v16, v16, v35, v40
v_max3_f32 v16, v16, v41, v42
v_mfma_f32_16x16x32_bf16 a[136:139], a[72:75], v[120:123], a[136:139]
v_max3_f32 v16, v16, v43, v48
v_max3_f32 v16, v16, v49, v50
v_mfma_f32_16x16x32_bf16 a[140:143], a[72:75], v[124:127], a[140:143]
s_waitcnt lgkmcnt(2)
v_max3_f32 v16, v16, v51, v56
v_max3_f32 v16, v16, v57, v58
v_mfma_f32_16x16x32_bf16 a[144:147], a[76:79], v[112:115], a[144:147]
ds_read_b128 a[88:91], v4 offset:30720
v_max3_f32 v16, v16, v59, v36
v_mfma_f32_16x16x32_bf16 a[148:151], a[76:79], v[116:119], a[148:151]
v_max3_f32 v16, v16, v37, v38
v_max3_f32 v16, v16, v39, v44
v_mfma_f32_16x16x32_bf16 a[152:155], a[76:79], v[120:123], a[152:155]
s_lshl_b32 s61, s61, 5
v_max3_f32 v16, v16, v45, v46
v_max3_f32 v16, v16, v47, v52
v_mfma_f32_16x16x32_bf16 a[156:159], a[76:79], v[124:127], a[156:159]
s_waitcnt lgkmcnt(2)
v_max3_f32 v16, v16, v53, v54
v_max3_f32 v16, v16, v55, v60
v_mfma_f32_16x16x32_bf16 a[160:163], a[80:83], v[112:115], a[160:163]
ds_read_b128 a[92:95], v4 offset:31744
v_max3_f32 v16, v16, v61, v62
v_mfma_f32_16x16x32_bf16 a[164:167], a[80:83], v[116:119], a[164:167]
v_max_f32 v16, v16, v63
v_cmp_lt_f32 vcc, s54, v16
v_mfma_f32_16x16x32_bf16 a[168:171], a[80:83], v[120:123], a[168:171]
s_cbranch_vccnz L_at_up2
L_at_upr2:
v_mfma_f32_16x16x32_bf16 a[172:175], a[80:83], v[124:127], a[172:175]
s_waitcnt lgkmcnt(2)
v_exp_f32 v32, v32
v_mfma_f32_16x16x32_bf16 a[176:179], a[84:87], v[112:115], a[176:179]
ds_read_b128 a[64:67], v2 offset:16384
v_exp_f32 v33, v33
v_mfma_f32_16x16x32_bf16 a[180:183], a[84:87], v[116:119], a[180:183]
v_exp_f32 v34, v34
v_cvt_pk_bf16_f32 v96, v32, v33
v_mfma_f32_16x16x32_bf16 a[184:187], a[84:87], v[120:123], a[184:187]
v_exp_f32 v35, v35
v_mfma_f32_16x16x32_bf16 a[188:191], a[84:87], v[124:127], a[188:191]
s_waitcnt lgkmcnt(2)
v_exp_f32 v36, v36
v_cvt_pk_bf16_f32 v97, v34, v35
v_mfma_f32_16x16x32_bf16 a[192:195], a[88:91], v[112:115], a[192:195]
ds_read_b128 a[68:71], v2 offset:17408
v_mfma_f32_16x16x32_bf16 a[196:199], a[88:91], v[116:119], a[196:199]
s_add_u32 s61, s61, s42
v_exp_f32 v37, v37
v_mfma_f32_16x16x32_bf16 a[200:203], a[88:91], v[120:123], a[200:203]
v_exp_f32 v38, v38
v_cvt_pk_bf16_f32 v98, v36, v37
v_mfma_f32_16x16x32_bf16 a[204:207], a[88:91], v[124:127], a[204:207]
s_waitcnt lgkmcnt(2)
v_exp_f32 v39, v39
v_mfma_f32_16x16x32_bf16 a[208:211], a[92:95], v[112:115], a[208:211]
ds_read_b128 a[72:75], v2 offset:18432
v_cvt_pk_bf16_f32 v99, v38, v39
v_mfma_f32_16x16x32_bf16 a[212:215], a[92:95], v[116:119], a[212:215]
v_exp_f32 v40, v40
v_mfma_f32_16x16x32_bf16 a[216:219], a[92:95], v[120:123], a[216:219]
v_exp_f32 v41, v41
v_mfma_f32_16x16x32_bf16 a[220:223], a[92:95], v[124:127], a[220:223]
s_waitcnt lgkmcnt(2)
s_cmp_eq_u32 s48, 0
s_cbranch_scc0 L_at_rs2
L_at_rsr2:
v_mfma_f32_16x16x32_bf16 v[64:67], a[64:67], a[0:3], v[128:131]
ds_read_b128 a[76:79], v2 offset:19456
v_cvt_pk_bf16_f32 v100, v40, v41
v_mfma_f32_16x16x32_bf16 v[72:75], a[64:67], a[16:19], v[132:135]
v_exp_f32 v42, v42
v_mfma_f32_16x16x32_bf16 v[80:83], a[64:67], a[32:35], v[136:139]
v_exp_f32 v43, v43
v_mfma_f32_16x16x32_bf16 v[88:91], a[64:67], a[48:51], v[140:143]
s_waitcnt lgkmcnt(2)
v_exp_f32 v44, v44
v_mfma_f32_16x16x32_bf16 v[68:71], a[68:71], a[0:3], v[128:131]
ds_read_b128 a[80:83], v2 offset:20480
v_cvt_pk_bf16_f32 v101, v42, v43
v_mfma_f32_16x16x32_bf16 v[76:79], a[68:71], a[16:19], v[132:135]
v_exp_f32 v45, v45
v_mfma_f32_16x16x32_bf16 v[84:87], a[68:71], a[32:35], v[136:139]
s_lshl_b32 s61, s61, 12
v_exp_f32 v46, v46
v_mfma_f32_16x16x32_bf16 v[92:95], a[68:71], a[48:51], v[140:143]
s_waitcnt lgkmcnt(2)
v_exp_f32 v47, v47
v_mfma_f32_16x16x32_bf16 v[64:67], a[72:75], a[4:7], v[64:67]
ds_read_b128 a[84:87], v2 offset:21504
v_cvt_pk_bf16_f32 v102, v44, v45
v_mfma_f32_16x16x32_bf16 v[72:75], a[72:75], a[20:23], v[72:75]
v_exp_f32 v48, v48
v_mfma_f32_16x16x32_bf16 v[80:83], a[72:75], a[36:39], v[80:83]
v_exp_f32 v49, v49
v_mfma_f32_16x16x32_bf16 v[88:91], a[72:75], a[52:55], v[88:91]
s_waitcnt lgkmcnt(2)
v_exp_f32 v50, v50
v_mfma_f32_16x16x32_bf16 v[68:71], a[76:79], a[4:7], v[68:71]
ds_read_b128 a[88:91], v2 offset:22528
v_cvt_pk_bf16_f32 v103, v46, v47
v_mfma_f32_16x16x32_bf16 v[76:79], a[76:79], a[20:23], v[76:79]
v_exp_f32 v51, v51
v_mfma_f32_16x16x32_bf16 v[84:87], a[76:79], a[36:39], v[84:87]
v_exp_f32 v52, v52
v_mfma_f32_16x16x32_bf16 v[92:95], a[76:79], a[52:55], v[92:95]
s_waitcnt lgkmcnt(2)
v_exp_f32 v53, v53
v_mfma_f32_16x16x32_bf16 v[64:67], a[80:83], a[8:11], v[64:67]
ds_read_b128 a[92:95], v2 offset:23552
v_cvt_pk_bf16_f32 v104, v48, v49
v_mfma_f32_16x16x32_bf16 v[72:75], a[80:83], a[24:27], v[72:75]
s_add_u32 s61, s61, 67108864
v_exp_f32 v54, v54
v_mfma_f32_16x16x32_bf16 v[80:83], a[80:83], a[40:43], v[80:83]
v_exp_f32 v55, v55
v_mfma_f32_16x16x32_bf16 v[88:91], a[80:83], a[56:59], v[88:91]
s_waitcnt lgkmcnt(2)
v_exp_f32 v56, v56
v_mfma_f32_16x16x32_bf16 v[68:71], a[84:87], a[8:11], v[68:71]
ds_read_b128 a[64:67], v2 offset:8192
v_cvt_pk_bf16_f32 v105, v50, v51
v_mfma_f32_16x16x32_bf16 v[76:79], a[84:87], a[24:27], v[76:79]
v_exp_f32 v57, v57
v_mfma_f32_16x16x32_bf16 v[84:87], a[84:87], a[40:43], v[84:87]
v_exp_f32 v58, v58
v_mfma_f32_16x16x32_bf16 v[92:95], a[84:87], a[56:59], v[92:95]
s_waitcnt lgkmcnt(2)
v_exp_f32 v59, v59
v_mfma_f32_16x16x32_bf16 v[64:67], a[88:91], a[12:15], v[64:67]
ds_read_b128 a[68:71], v2 offset:9216
v_cvt_pk_bf16_f32 v106, v52, v53
v_mfma_f32_16x16x32_bf16 v[72:75], a[88:91], a[28:31], v[72:75]
v_exp_f32 v60, v60
v_mfma_f32_16x16x32_bf16 v[80:83], a[88:91], a[44:47], v[80:83]
v_exp_f32 v61, v61
v_mfma_f32_16x16x32_bf16 v[88:91], a[88:91], a[60:63], v[88:91]
s_waitcnt lgkmcnt(2)
v_exp_f32 v62, v62
v_mfma_f32_16x16x32_bf16 v[68:71], a[92:95], a[12:15], v[68:71]
ds_read_b128 a[72:75], v2 offset:10240
v_cvt_pk_bf16_f32 v107, v54, v55
v_mfma_f32_16x16x32_bf16 v[76:79], a[92:95], a[28:31], v[76:79]
v_exp_f32 v63, v63
v_mfma_f32_16x16x32_bf16 v[84:87], a[92:95], a[44:47], v[84:87]
v_cvt_pk_bf16_f32 v108, v56, v57
v_cvt_pk_bf16_f32 v109, v58, v59
v_mfma_f32_16x16x32_bf16 v[92:95], a[92:95], a[60:63], v[92:95]
s_waitcnt lgkmcnt(2)
v_cvt_pk_bf16_f32 v110, v60, v61
v_cvt_pk_bf16_f32 v111, v62, v63
s_waitcnt vmcnt(8)
s_barrier
v_mfma_f32_16x16x32_bf16 a[224:227], a[240:243], v[96:99], a[224:227]
s_add_u32 s24, s46, 4096
s_add_u32 m0, s47, 0
v_mfma_f32_16x16x32_bf16 a[228:231], a[240:243], v[100:103], a[228:231]
buffer_load_dwordx4 v1, s[8:11], s46 offen sc1 lds
v_mfma_f32_16x16x32_bf16 a[232:235], a[240:243], v[104:107], a[232:235]
buffer_load_dwordx4 v1, s[8:11], s46 offen offset:2048 sc1 lds
v_mfma_f32_16x16x32_bf16 a[236:239], a[240:243], v[108:111], a[236:239]
v_cmp_le_i32 s[30:31], 32, v5
v_cmp_le_i32 s[32:33], 33, v5
v_mfma_f32_16x16x32_bf16 a[96:99], a[64:67], v[96:99], a[96:99]
ds_read_b128 a[76:79], v2 offset:11264
v_cmp_le_i32 s[34:35], 34, v5
v_mfma_f32_16x16x32_bf16 a[100:103], a[64:67], v[100:103], a[100:103]
s_add_u32 m0, s47, 896
v_cmp_le_i32 s[36:37], 35, v5
v_cndmask_b32 v64, v8, v64, s[30:31]
v_mfma_f32_16x16x32_bf16 a[104:107], a[64:67], v[104:107], a[104:107]
buffer_load_dwordx4 v1, s[8:11], s46 offen offset:128 sc1 lds
v_cndmask_b32 v65, v8, v65, s[32:33]
v_mfma_f32_16x16x32_bf16 a[108:111], a[64:67], v[108:111], a[108:111]
s_waitcnt lgkmcnt(2)
v_cndmask_b32 v66, v8, v66, s[34:35]
v_cndmask_b32 v67, v8, v67, s[36:37]
v_mfma_f32_16x16x32_bf16 a[112:115], a[68:71], v[96:99], a[112:115]
ds_read_b128 a[80:83], v2 offset:12288
v_cmp_le_i32 s[30:31], 40, v5
v_mfma_f32_16x16x32_bf16 a[116:119], a[68:71], v[100:103], a[116:119]
v_cmp_le_i32 s[32:33], 41, v5
v_cmp_le_i32 s[34:35], 42, v5
v_mfma_f32_16x16x32_bf16 a[120:123], a[68:71], v[104:107], a[120:123]
buffer_load_dwordx4 v1, s[8:11], s46 offen offset:2176 sc1 lds
v_cmp_le_i32 s[36:37], 43, v5
v_mfma_f32_16x16x32_bf16 a[124:127], a[68:71], v[108:111], a[124:127]
s_waitcnt lgkmcnt(2)
v_cndmask_b32 v68, v8, v68, s[30:31]
v_cndmask_b32 v69, v8, v69, s[32:33]
v_mfma_f32_16x16x32_bf16 a[128:131], a[72:75], v[96:99], a[128:131]
ds_read_b128 a[84:87], v2 offset:13312
v_cndmask_b32 v70, v8, v70, s[34:35]
v_mfma_f32_16x16x32_bf16 a[132:135], a[72:75], v[100:103], a[132:135]
v_cndmask_b32 v71, v8, v71, s[36:37]
v_max3_f32 v16, v64, v65, v66
v_mfma_f32_16x16x32_bf16 a[136:139], a[72:75], v[104:107], a[136:139]
s_add_u32 m0, s47, 4096
v_max3_f32 v16, v16, v67, v72
v_max3_f32 v16, v16, v73, v74
v_mfma_f32_16x16x32_bf16 a[140:143], a[72:75], v[108:111], a[140:143]
s_waitcnt lgkmcnt(2)
v_max3_f32 v16, v16, v75, v80
v_max3_f32 v16, v16, v81, v82
v_mfma_f32_16x16x32_bf16 a[144:147], a[76:79], v[96:99], a[144:147]
ds_read_b128 a[88:91], v2 offset:14336
v_max3_f32 v16, v16, v83, v88
v_mfma_f32_16x16x32_bf16 a[148:151], a[76:79], v[100:103], a[148:151]
v_max3_f32 v16, v16, v89, v90
v_max3_f32 v16, v16, v91, v68
v_mfma_f32_16x16x32_bf16 a[152:155], a[76:79], v[104:107], a[152:155]
buffer_load_dwordx4 v1, s[8:11], s24 offen sc1 lds
v_max3_f32 v16, v16, v69, v70
v_mfma_f32_16x16x32_bf16 a[156:159], a[76:79], v[108:111], a[156:159]
s_waitcnt lgkmcnt(2)
v_max3_f32 v16, v16, v71, v76
v_max3_f32 v16, v16, v77, v78
v_mfma_f32_16x16x32_bf16 a[160:163], a[80:83], v[96:99], a[160:163]
ds_read_b128 a[92:95], v2 offset:15360
v_max3_f32 v16, v16, v79, v84
v_mfma_f32_16x16x32_bf16 a[164:167], a[80:83], v[100:103], a[164:167]
v_max3_f32 v16, v16, v85, v86
v_max3_f32 v16, v16, v87, v92
v_max3_f32 v16, v16, v93, v94
v_max_f32 v16, v16, v95
v_cmp_lt_f32 vcc, s54, v16
v_mfma_f32_16x16x32_bf16 a[168:171], a[80:83], v[104:107], a[168:171]
buffer_load_dwordx4 v1, s[8:11], s24 offen offset:2048 sc1 lds
s_cbranch_vccnz L_at_up3
L_at_upr3:
v_mfma_f32_16x16x32_bf16 a[172:175], a[80:83], v[108:111], a[172:175]
s_waitcnt lgkmcnt(2)
v_exp_f32 v64, v64
v_mfma_f32_16x16x32_bf16 a[176:179], a[84:87], v[96:99], a[176:179]
ds_read_b128 a[64:67], v3
v_exp_f32 v65, v65
v_mfma_f32_16x16x32_bf16 a[180:183], a[84:87], v[100:103], a[180:183]
v_exp_f32 v66, v66
v_cvt_pk_bf16_f32 v112, v64, v65
v_mfma_f32_16x16x32_bf16 a[184:187], a[84:87], v[104:107], a[184:187]
s_add_u32 m0, s47, 4992
v_exp_f32 v67, v67
v_mfma_f32_16x16x32_bf16 a[188:191], a[84:87], v[108:111], a[188:191]
s_waitcnt lgkmcnt(2)
v_exp_f32 v68, v68
v_cvt_pk_bf16_f32 v113, v66, v67
v_mfma_f32_16x16x32_bf16 a[192:195], a[88:91], v[96:99], a[192:195]
ds_read_b128 a[68:71], v3 offset:1024
v_exp_f32 v69, v69
v_mfma_f32_16x16x32_bf16 a[196:199], a[88:91], v[100:103], a[196:199]
buffer_load_dwordx4 v1, s[8:11], s24 offen offset:128 sc1 lds
v_exp_f32 v70, v70
v_mfma_f32_16x16x32_bf16 a[200:203], a[88:91], v[104:107], a[200:203]
v_exp_f32 v71, v71
v_cvt_pk_bf16_f32 v114, v68, v69
v_mfma_f32_16x16x32_bf16 a[204:207], a[88:91], v[108:111], a[204:207]
s_waitcnt lgkmcnt(2)
v_exp_f32 v72, v72
v_cvt_pk_bf16_f32 v115, v70, v71
v_mfma_f32_16x16x32_bf16 a[208:211], a[92:95], v[96:99], a[208:211]
ds_read_b128 a[72:75], v3 offset:2048
v_exp_f32 v73, v73
v_mfma_f32_16x16x32_bf16 a[212:215], a[92:95], v[100:103], a[212:215]
buffer_load_dwordx4 v1, s[8:11], s24 offen offset:2176 sc1 lds
v_exp_f32 v74, v74
v_mfma_f32_16x16x32_bf16 a[216:219], a[92:95], v[104:107], a[216:219]
v_exp_f32 v75, v75
v_cvt_pk_bf16_f32 v116, v72, v73
v_mfma_f32_16x16x32_bf16 a[220:223], a[92:95], v[108:111], a[220:223]
s_waitcnt lgkmcnt(2)
s_cmp_eq_u32 s48, 0
s_cbranch_scc0 L_at_rs3
L_at_rsr3:
v_cvt_pk_bf16_f32 v117, v74, v75
v_mfma_f32_16x16x32_bf16 v[40:43], a[64:67], a[16:19], v[132:135]
ds_read_b128 a[76:79], v3 offset:3072
v_exp_f32 v76, v76
v_mfma_f32_16x16x32_bf16 v[48:51], a[64:67], a[32:35], v[136:139]
v_exp_f32 v77, v77
v_mfma_f32_16x16x32_bf16 v[56:59], a[64:67], a[48:51], v[140:143]
s_waitcnt lgkmcnt(2)
v_exp_f32 v78, v78
v_cvt_pk_bf16_f32 v118, v76, v77
v_mfma_f32_16x16x32_bf16 v[44:47], a[68:71], a[16:19], v[132:135]
ds_read_b128 a[80:83], v3 offset:4096
v_exp_f32 v79, v79
v_mfma_f32_16x16x32_bf16 v[52:55], a[68:71], a[32:35], v[136:139]
s_add_u32 s46, s46, 32768
v_exp_f32 v80, v80
v_cvt_pk_bf16_f32 v119, v78, v79
v_mfma_f32_16x16x32_bf16 v[60:63], a[68:71], a[48:51], v[140:143]
s_waitcnt lgkmcnt(2)
v_exp_f32 v81, v81
v_mfma_f32_16x16x32_bf16 v[40:43], a[72:75], a[20:23], v[40:43]
ds_read_b128 a[84:87], v3 offset:5120
v_exp_f32 v82, v82
v_mfma_f32_16x16x32_bf16 v[48:51], a[72:75], a[36:39], v[48:51]
v_exp_f32 v83, v83
v_cvt_pk_bf16_f32 v120, v80, v81
v_mfma_f32_16x16x32_bf16 v[56:59], a[72:75], a[52:55], v[56:59]
s_waitcnt lgkmcnt(2)
v_exp_f32 v84, v84
v_cvt_pk_bf16_f32 v121, v82, v83
v_mfma_f32_16x16x32_bf16 v[44:47], a[76:79], a[20:23], v[44:47]
ds_read_b128 a[88:91], v3 offset:6144
v_exp_f32 v85, v85
v_mfma_f32_16x16x32_bf16 v[52:55], a[76:79], a[36:39], v[52:55]
s_add_u32 s47, s47, 32768
v_exp_f32 v86, v86
v_cvt_pk_bf16_f32 v122, v84, v85
v_mfma_f32_16x16x32_bf16 v[60:63], a[76:79], a[52:55], v[60:63]
s_waitcnt lgkmcnt(2)
v_exp_f32 v87, v87
v_mfma_f32_16x16x32_bf16 v[40:43], a[80:83], a[24:27], v[40:43]
ds_read_b128 a[92:95], v3 offset:7168
v_exp_f32 v88, v88
v_mfma_f32_16x16x32_bf16 v[48:51], a[80:83], a[40:43], v[48:51]
v_exp_f32 v89, v89
v_mfma_f32_16x16x32_bf16 v[56:59], a[80:83], a[56:59], v[56:59]
s_waitcnt lgkmcnt(2)
v_exp_f32 v90, v90
v_mfma_f32_16x16x32_bf16 v[44:47], a[84:87], a[24:27], v[44:47]
ds_read_b128 a[64:67], v2 offset:24576
v_cvt_pk_bf16_f32 v123, v86, v87
v_mfma_f32_16x16x32_bf16 v[52:55], a[84:87], a[40:43], v[52:55]
s_and_b32 s47, s47, 131071
v_exp_f32 v91, v91
v_mfma_f32_16x16x32_bf16 v[60:63], a[84:87], a[56:59], v[60:63]
s_waitcnt lgkmcnt(2)
v_exp_f32 v92, v92
v_mfma_f32_16x16x32_bf16 v[40:43], a[88:91], a[28:31], v[40:43]
ds_read_b128 a[68:71], v2 offset:25600
v_cvt_pk_bf16_f32 v124, v88, v89
v_mfma_f32_16x16x32_bf16 v[48:51], a[88:91], a[44:47], v[48:51]
v_exp_f32 v93, v93
v_mfma_f32_16x16x32_bf16 v[56:59], a[88:91], a[60:63], v[56:59]
s_waitcnt lgkmcnt(2)
v_exp_f32 v94, v94
v_mfma_f32_16x16x32_bf16 v[44:47], a[92:95], a[28:31], v[44:47]
ds_read_b128 a[72:75], v2 offset:26624
v_cvt_pk_bf16_f32 v125, v90, v91
v_mfma_f32_16x16x32_bf16 v[52:55], a[92:95], a[44:47], v[52:55]
v_exp_f32 v95, v95
v_mfma_f32_16x16x32_bf16 v[60:63], a[92:95], a[60:63], v[60:63]
s_waitcnt lgkmcnt(2)
v_cvt_pk_bf16_f32 v126, v92, v93
v_cvt_pk_bf16_f32 v127, v94, v95
v_mov_b32 v4, v2
v_mov_b32 v2, v3
v_add_u32 v3, 32768, v3
v_and_b32 v3, 131071, v3
v_mfma_f32_16x16x32_bf16 a[224:227], a[240:243], v[112:115], a[224:227]
s_lshl_b32 s46, s42, 20
v_mfma_f32_16x16x32_bf16 a[228:231], a[240:243], v[116:119], a[228:231]
v_mfma_f32_16x16x32_bf16 a[232:235], a[240:243], v[120:123], a[232:235]
v_mfma_f32_16x16x32_bf16 a[236:239], a[240:243], v[124:127], a[236:239]
v_cmp_le_i32 s[30:31], 0, v5
v_cmp_le_i32 s[32:33], 1, v5
v_mfma_f32_16x16x32_bf16 a[96:99], a[64:67], v[112:115], a[96:99]
ds_read_b128 a[76:79], v4 offset:27648
v_cmp_le_i32 s[34:35], 2, v5
v_mfma_f32_16x16x32_bf16 a[100:103], a[64:67], v[116:119], a[100:103]
v_cmp_le_i32 s[36:37], 3, v5
v_cndmask_b32 v40, v8, v40, s[30:31]
v_mfma_f32_16x16x32_bf16 a[104:107], a[64:67], v[120:123], a[104:107]
v_cndmask_b32 v41, v8, v41, s[32:33]
v_cndmask_b32 v42, v8, v42, s[34:35]
v_mfma_f32_16x16x32_bf16 a[108:111], a[64:67], v[124:127], a[108:111]
s_waitcnt lgkmcnt(2)
v_cndmask_b32 v43, v8, v43, s[36:37]
v_cmp_le_i32 s[30:31], 8, v5
v_mfma_f32_16x16x32_bf16 a[112:115], a[68:71], v[112:115], a[112:115]
ds_read_b128 a[80:83], v4 offset:28672
v_cmp_le_i32 s[32:33], 9, v5
v_mfma_f32_16x16x32_bf16 a[116:119], a[68:71], v[116:119], a[116:119]
v_cmp_le_i32 s[34:35], 10, v5
v_cmp_le_i32 s[36:37], 11, v5
v_mfma_f32_16x16x32_bf16 a[120:123], a[68:71], v[120:123], a[120:123]
v_cndmask_b32 v44, v8, v44, s[30:31]
v_cndmask_b32 v45, v8, v45, s[32:33]
v_mfma_f32_16x16x32_bf16 a[124:127], a[68:71], v[124:127], a[124:127]
s_waitcnt lgkmcnt(2)
v_cndmask_b32 v46, v8, v46, s[34:35]
v_cndmask_b32 v47, v8, v47, s[36:37]
v_mfma_f32_16x16x32_bf16 a[128:131], a[72:75], v[112:115], a[128:131]
ds_read_b128 a[84:87], v4 offset:29696
v_max3_f32 v16, v40, v41, v42
v_mfma_f32_16x16x32_bf16 a[132:135], a[72:75], v[116:119], a[132:135]
s_add_u32 s46, s46, 0
v_max3_f32 v16, v16, v43, v48
v_max3_f32 v16, v16, v49, v50
v_mfma_f32_16x16x32_bf16 a[136:139], a[72:75], v[120:123], a[136:139]
v_max3_f32 v16, v16, v51, v56
v_max3_f32 v16, v16, v57, v58
v_mfma_f32_16x16x32_bf16 a[140:143], a[72:75], v[124:127], a[140:143]
s_waitcnt lgkmcnt(2)
v_max3_f32 v16, v16, v59, v44
v_max3_f32 v16, v16, v45, v46
v_mfma_f32_16x16x32_bf16 a[144:147], a[76:79], v[112:115], a[144:147]
ds_read_b128 a[88:91], v4 offset:30720
v_max3_f32 v16, v16, v47, v52
v_mfma_f32_16x16x32_bf16 a[148:151], a[76:79], v[116:119], a[148:151]
v_max3_f32 v16, v16, v53, v54
v_max3_f32 v16, v16, v55, v60
v_mfma_f32_16x16x32_bf16 a[152:155], a[76:79], v[120:123], a[152:155]
v_max3_f32 v16, v16, v61, v62
v_max_f32 v16, v16, v63
v_mfma_f32_16x16x32_bf16 a[156:159], a[76:79], v[124:127], a[156:159]
s_waitcnt lgkmcnt(2)
v_cmp_lt_f32 vcc, s54, v16
v_mfma_f32_16x16x32_bf16 a[160:163], a[80:83], v[112:115], a[160:163]
ds_read_b128 a[92:95], v4 offset:31744
s_cbranch_vccnz L_at_up4
L_at_upr4:
v_mfma_f32_16x16x32_bf16 a[164:167], a[80:83], v[116:119], a[164:167]
v_exp_f32 v40, v40
v_mfma_f32_16x16x32_bf16 a[168:171], a[80:83], v[120:123], a[168:171]
v_exp_f32 v41, v41
v_mfma_f32_16x16x32_bf16 a[172:175], a[80:83], v[124:127], a[172:175]
s_waitcnt lgkmcnt(2)
v_exp_f32 v42, v42
v_mfma_f32_16x16x32_bf16 a[176:179], a[84:87], v[112:115], a[176:179]
ds_read_b128 a[64:67], v2 offset:16384
v_cvt_pk_bf16_f32 v100, v40, v41
v_mfma_f32_16x16x32_bf16 a[180:183], a[84:87], v[116:119], a[180:183]
v_exp_f32 v43, v43
v_mfma_f32_16x16x32_bf16 a[184:187], a[84:87], v[120:123], a[184:187]
v_exp_f32 v44, v44
v_mfma_f32_16x16x32_bf16 a[188:191], a[84:87], v[124:127], a[188:191]
s_waitcnt lgkmcnt(2)
v_exp_f32 v45, v45
v_mfma_f32_16x16x32_bf16 a[192:195], a[88:91], v[112:115], a[192:195]
ds_read_b128 a[68:71], v2 offset:17408
v_cvt_pk_bf16_f32 v101, v42, v43
v_mfma_f32_16x16x32_bf16 a[196:199], a[88:91], v[116:119], a[196:199]
v_exp_f32 v46, v46
v_mfma_f32_16x16x32_bf16 a[200:203], a[88:91], v[120:123], a[200:203]
s_cmp_lt_u32 s63, 8
s_cselect_b32 s46, s46, 536870912
v_cvt_pk_bf16_f32 v102, v44, v45
v_mfma_f32_16x16x32_bf16 a[204:207], a[88:91], v[124:127], a[204:207]
s_waitcnt lgkmcnt(2)
v_exp_f32 v47, v47
v_mfma_f32_16x16x32_bf16 a[208:211], a[92:95], v[112:115], a[208:211]
ds_read_b128 a[72:75], v2 offset:18432
v_cvt_pk_bf16_f32 v103, v46, v47
v_mfma_f32_16x16x32_bf16 a[212:215], a[92:95], v[116:119], a[212:215]
v_exp_f32 v48, v48
v_mfma_f32_16x16x32_bf16 a[216:219], a[92:95], v[120:123], a[216:219]
v_exp_f32 v49, v49
v_mfma_f32_16x16x32_bf16 a[220:223], a[92:95], v[124:127], a[220:223]
s_waitcnt lgkmcnt(2)
s_cmp_eq_u32 s48, 0
s_cbranch_scc0 L_at_rs4
L_at_rsr4:
v_mfma_f32_16x16x32_bf16 v[72:75], a[64:67], a[16:19], v[132:135]
ds_read_b128 a[76:79], v2 offset:19456
v_cvt_pk_bf16_f32 v104, v48, v49
v_mfma_f32_16x16x32_bf16 v[80:83], a[64:67], a[32:35], v[136:139]
v_exp_f32 v50, v50
v_mfma_f32_16x16x32_bf16 v[88:91], a[64:67], a[48:51], v[140:143]
s_waitcnt lgkmcnt(2)
v_exp_f32 v51, v51
v_mfma_f32_16x16x32_bf16 v[76:79], a[68:71], a[16:19], v[132:135]
ds_read_b128 a[80:83], v2 offset:20480
v_cvt_pk_bf16_f32 v105, v50, v51
v_mfma_f32_16x16x32_bf16 v[84:87], a[68:71], a[32:35], v[136:139]
v_exp_f32 v52, v52
v_mfma_f32_16x16x32_bf16 v[92:95], a[68:71], a[48:51], v[140:143]
s_waitcnt lgkmcnt(2)
v_exp_f32 v53, v53
v_mfma_f32_16x16x32_bf16 v[72:75], a[72:75], a[20:23], v[72:75]
ds_read_b128 a[84:87], v2 offset:21504
v_cvt_pk_bf16_f32 v106, v52, v53
v_mfma_f32_16x16x32_bf16 v[80:83], a[72:75], a[36:39], v[80:83]
v_exp_f32 v54, v54
v_mfma_f32_16x16x32_bf16 v[88:91], a[72:75], a[52:55], v[88:91]
s_waitcnt lgkmcnt(2)
v_exp_f32 v55, v55
v_mfma_f32_16x16x32_bf16 v[76:79], a[76:79], a[20:23], v[76:79]
ds_read_b128 a[88:91], v2 offset:22528
v_cvt_pk_bf16_f32 v107, v54, v55
v_mfma_f32_16x16x32_bf16 v[84:87], a[76:79], a[36:39], v[84:87]
v_exp_f32 v56, v56
v_mfma_f32_16x16x32_bf16 v[92:95], a[76:79], a[52:55], v[92:95]
s_waitcnt lgkmcnt(2)
v_exp_f32 v57, v57
v_mfma_f32_16x16x32_bf16 v[72:75], a[80:83], a[24:27], v[72:75]
ds_read_b128 a[92:95], v2 offset:23552
v_cvt_pk_bf16_f32 v108, v56, v57
v_mfma_f32_16x16x32_bf16 v[80:83], a[80:83], a[40:43], v[80:83]
v_exp_f32 v58, v58
v_mfma_f32_16x16x32_bf16 v[88:91], a[80:83], a[56:59], v[88:91]
s_waitcnt lgkmcnt(2)
v_exp_f32 v59, v59
v_mfma_f32_16x16x32_bf16 v[76:79], a[84:87], a[24:27], v[76:79]
ds_read_b128 a[64:67], v2 offset:8192
v_cvt_pk_bf16_f32 v109, v58, v59
v_mfma_f32_16x16x32_bf16 v[84:87], a[84:87], a[40:43], v[84:87]
v_exp_f32 v60, v60
v_mfma_f32_16x16x32_bf16 v[92:95], a[84:87], a[56:59], v[92:95]
s_waitcnt lgkmcnt(2)
v_exp_f32 v61, v61
v_mfma_f32_16x16x32_bf16 v[72:75], a[88:91], a[28:31], v[72:75]
ds_read_b128 a[68:71], v2 offset:9216
v_cvt_pk_bf16_f32 v110, v60, v61
v_mfma_f32_16x16x32_bf16 v[80:83], a[88:91], a[44:47], v[80:83]
v_exp_f32 v62, v62
v_mfma_f32_16x16x32_bf16 v[88:91], a[88:91], a[60:63], v[88:91]
s_waitcnt lgkmcnt(2)
v_exp_f32 v63, v63
v_mfma_f32_16x16x32_bf16 v[76:79], a[92:95], a[28:31], v[76:79]
ds_read_b128 a[72:75], v2 offset:10240
v_cvt_pk_bf16_f32 v111, v62, v63
v_mfma_f32_16x16x32_bf16 v[84:87], a[92:95], a[44:47], v[84:87]
v_mfma_f32_16x16x32_bf16 v[92:95], a[92:95], a[60:63], v[92:95]
s_waitcnt lgkmcnt(2)
s_waitcnt vmcnt(8)
s_barrier
s_add_u32 s25, s61, 0
v_mov_b32 v19, 1
s_mov_b64 exec, 1
buffer_store_dword v19, v6, s[8:11], s60 offen sc1
s_mov_b64 exec, -1
v_mfma_f32_16x16x32_bf16 a[228:231], a[240:243], v[100:103], a[228:231]
s_add_u32 s24, s46, 4096
v_mfma_f32_16x16x32_bf16 a[232:235], a[240:243], v[104:107], a[232:235]
v_mfma_f32_16x16x32_bf16 a[236:239], a[240:243], v[108:111], a[236:239]
s_add_u32 m0, s47, 0
v_mfma_f32_16x16x32_bf16 a[100:103], a[64:67], v[100:103], a[100:103]
ds_read_b128 a[76:79], v2 offset:11264
v_cmp_le_i32 s[30:31], 32, v5
v_mfma_f32_16x16x32_bf16 a[104:107], a[64:67], v[104:107], a[104:107]
v_cmp_le_i32 s[32:33], 33, v5
v_cmp_le_i32 s[34:35], 34, v5
v_mfma_f32_16x16x32_bf16 a[108:111], a[64:67], v[108:111], a[108:111]
s_waitcnt lgkmcnt(2)
buffer_load_dwordx4 v1, s[8:11], s46 offen sc1 lds
v_cmp_le_i32 s[36:37], 35, v5
v_mfma_f32_16x16x32_bf16 a[116:119], a[68:71], v[100:103], a[116:119]
ds_read_b128 a[80:83], v2 offset:12288
v_cndmask_b32 v72, v8, v72, s[30:31]
v_cndmask_b32 v73, v8, v73, s[32:33]
v_mfma_f32_16x16x32_bf16 a[120:123], a[68:71], v[104:107], a[120:123]
v_cndmask_b32 v74, v8, v74, s[34:35]
v_cndmask_b32 v75, v8, v75, s[36:37]
v_mfma_f32_16x16x32_bf16 a[124:127], a[68:71], v[108:111], a[124:127]
s_waitcnt lgkmcnt(2)
buffer_load_dwordx4 v1, s[8:11], s46 offen offset:2048 sc1 lds
v_cmp_le_i32 s[30:31], 40, v5
v_mfma_f32_16x16x32_bf16 a[132:135], a[72:75], v[100:103], a[132:135]
ds_read_b128 a[84:87], v2 offset:13312
v_cmp_le_i32 s[32:33], 41, v5
v_cmp_le_i32 s[34:35], 42, v5
v_mfma_f32_16x16x32_bf16 a[136:139], a[72:75], v[104:107], a[136:139]
s_add_u32 m0, s47, 896
v_cmp_le_i32 s[36:37], 43, v5
v_cndmask_b32 v76, v8, v76, s[30:31]
v_mfma_f32_16x16x32_bf16 a[140:143], a[72:75], v[108:111], a[140:143]
s_waitcnt lgkmcnt(2)
v_cndmask_b32 v77, v8, v77, s[32:33]
v_cndmask_b32 v78, v8, v78, s[34:35]
v_mfma_f32_16x16x32_bf16 a[148:151], a[76:79], v[100:103], a[148:151]
ds_read_b128 a[88:91], v2 offset:14336
v_cndmask_b32 v79, v8, v79, s[36:37]
v_mfma_f32_16x16x32_bf16 a[152:155], a[76:79], v[104:107], a[152:155]
buffer_load_dwordx4 v1, s[8:11], s46 offen offset:128 sc1 lds
v_max3_f32 v16, v72, v73, v74
v_max3_f32 v16, v16, v75, v80
v_mfma_f32_16x16x32_bf16 a[156:159], a[76:79], v[108:111], a[156:159]
s_waitcnt lgkmcnt(2)
v_max3_f32 v16, v16, v81, v82
v_max3_f32 v16, v16, v83, v88
v_mfma_f32_16x16x32_bf16 a[164:167], a[80:83], v[100:103], a[164:167]
ds_read_b128 a[92:95], v2 offset:15360
v_max3_f32 v16, v16, v89, v90
v_mfma_f32_16x16x32_bf16 a[168:171], a[80:83], v[104:107], a[168:171]
buffer_load_dwordx4 v1, s[8:11], s46 offen offset:2176 sc1 lds
v_max3_f32 v16, v16, v91, v76
v_max3_f32 v16, v16, v77, v78
v_mfma_f32_16x16x32_bf16 a[172:175], a[80:83], v[108:111], a[172:175]
s_waitcnt lgkmcnt(2)
v_max3_f32 v16, v16, v79, v84
v_max3_f32 v16, v16, v85, v86
v_mfma_f32_16x16x32_bf16 a[180:183], a[84:87], v[100:103], a[180:183]
ds_read_b128 a[64:67], v3
s_add_u32 m0, s47, 4096
v_mfma_f32_16x16x32_bf16 a[184:187], a[84:87], v[104:107], a[184:187]
v_max3_f32 v16, v16, v87, v92
v_max3_f32 v16, v16, v93, v94
v_max_f32 v16, v16, v95
v_cmp_lt_f32 vcc, s54, v16
v_mfma_f32_16x16x32_bf16 a[188:191], a[84:87], v[108:111], a[188:191]
s_waitcnt lgkmcnt(2)
s_cbranch_vccnz L_at_up5
L_at_upr5:
v_exp_f32 v72, v72
v_exp_f32 v73, v73
v_exp_f32 v74, v74
v_mfma_f32_16x16x32_bf16 a[196:199], a[88:91], v[100:103], a[196:199]
ds_read_b128 a[68:71], v3 offset:1024
buffer_load_dwordx4 v1, s[8:11], s24 offen sc1 lds
v_exp_f32 v75, v75
v_exp_f32 v76, v76
v_exp_f32 v77, v77
v_mfma_f32_16x16x32_bf16 a[200:203], a[88:91], v[104:107], a[200:203]
v_exp_f32 v78, v78
v_exp_f32 v79, v79
v_exp_f32 v80, v80
v_exp_f32 v81, v81
v_mfma_f32_16x16x32_bf16 a[204:207], a[88:91], v[108:111], a[204:207]
s_waitcnt lgkmcnt(2)
v_exp_f32 v82, v82
v_exp_f32 v83, v83
v_exp_f32 v84, v84
v_exp_f32 v85, v85
v_mfma_f32_16x16x32_bf16 a[212:215], a[92:95], v[100:103], a[212:215]
ds_read_b128 a[72:75], v3 offset:2048
buffer_load_dwordx4 v1, s[8:11], s24 offen offset:2048 sc1 lds
v_exp_f32 v86, v86
v_exp_f32 v87, v87
v_exp_f32 v88, v88
v_mfma_f32_16x16x32_bf16 a[216:219], a[92:95], v[104:107], a[216:219]
v_exp_f32 v89, v89
v_exp_f32 v90, v90
v_exp_f32 v91, v91
v_exp_f32 v92, v92
v_mfma_f32_16x16x32_bf16 a[220:223], a[92:95], v[108:111], a[220:223]
s_waitcnt lgkmcnt(2)
s_add_u32 m0, s47, 4992
s_cmp_eq_u32 s48, 0
s_cbranch_scc0 L_at_rs5
L_at_rsr5:
v_exp_f32 v93, v93
v_exp_f32 v94, v94
v_exp_f32 v95, v95
v_mfma_f32_16x16x32_bf16 v[48:51], a[64:67], a[32:35], v[136:139]
ds_read_b128 a[76:79], v3 offset:3072
v_cvt_pk_bf16_f32 v116, v72, v73
v_cvt_pk_bf16_f32 v117, v74, v75
v_cvt_pk_bf16_f32 v118, v76, v77
v_cvt_pk_bf16_f32 v119, v78, v79
v_cvt_pk_bf16_f32 v120, v80, v81
v_cvt_pk_bf16_f32 v121, v82, v83
v_cvt_pk_bf16_f32 v122, v84, v85
v_mfma_f32_16x16x32_bf16 v[56:59], a[64:67], a[48:51], v[140:143]
s_waitcnt lgkmcnt(2)
v_cvt_pk_bf16_f32 v123, v86, v87
v_cvt_pk_bf16_f32 v124, v88, v89
v_cvt_pk_bf16_f32 v125, v90, v91
v_cvt_pk_bf16_f32 v126, v92, v93
v_cvt_pk_bf16_f32 v127, v94, v95
v_accvgpr_read_b32 v18, a224
v_rcp_f32 v18, v18
v_mfma_f32_16x16x32_bf16 v[52:55], a[68:71], a[32:35], v[136:139]
ds_read_b128 a[80:83], v3 offset:4096
buffer_load_dwordx4 v1, s[8:11], s24 offen offset:128 sc1 lds
v_accvgpr_read_b32 v224, a96
v_accvgpr_read_b32 v225, a97
v_accvgpr_read_b32 v226, a98
v_accvgpr_read_b32 v227, a99
v_accvgpr_read_b32 v228, a112
v_accvgpr_read_b32 v229, a113
v_mfma_f32_16x16x32_bf16 v[60:63], a[68:71], a[48:51], v[140:143]
s_waitcnt lgkmcnt(2)
v_accvgpr_read_b32 v230, a114
v_accvgpr_read_b32 v231, a115
v_mul_f32 v224, v224, v18
v_mul_f32 v225, v225, v18
v_mul_f32 v226, v226, v18
v_mul_f32 v227, v227, v18
v_mul_f32 v228, v228, v18
v_mul_f32 v229, v229, v18
v_mfma_f32_16x16x32_bf16 v[48:51], a[72:75], a[36:39], v[48:51]
ds_read_b128 a[84:87], v3 offset:5120
v_mul_f32 v230, v230, v18
v_mul_f32 v231, v231, v18
v_cvt_pk_bf16_f32 v224, v224, v225
v_cvt_pk_bf16_f32 v225, v226, v227
v_cvt_pk_bf16_f32 v226, v228, v229
v_cvt_pk_bf16_f32 v227, v230, v231
buffer_store_dwordx4 v[224:227], v6, s[8:11], s25 offen sc1
v_mfma_f32_16x16x32_bf16 v[56:59], a[72:75], a[52:55], v[56:59]
s_waitcnt lgkmcnt(2)
buffer_load_dwordx4 v1, s[8:11], s24 offen offset:2176 sc1 lds
v_accvgpr_read_b32 v232, a128
v_accvgpr_read_b32 v233, a129
v_accvgpr_read_b32 v234, a130
v_accvgpr_read_b32 v235, a131
v_accvgpr_read_b32 v236, a144
v_accvgpr_read_b32 v237, a145
v_accvgpr_read_b32 v238, a146
v_mfma_f32_16x16x32_bf16 v[52:55], a[76:79], a[36:39], v[52:55]
ds_read_b128 a[88:91], v3 offset:6144
v_accvgpr_read_b32 v239, a147
v_mul_f32 v232, v232, v18
v_mul_f32 v233, v233, v18
v_mul_f32 v234, v234, v18
v_mul_f32 v235, v235, v18
v_mul_f32 v236, v236, v18
v_mul_f32 v237, v237, v18
v_mfma_f32_16x16x32_bf16 v[60:63], a[76:79], a[52:55], v[60:63]
s_waitcnt lgkmcnt(2)
s_add_u32 s46, s46, 32768
v_mul_f32 v238, v238, v18
v_mul_f32 v239, v239, v18
v_cvt_pk_bf16_f32 v232, v232, v233
v_cvt_pk_bf16_f32 v233, v234, v235
v_cvt_pk_bf16_f32 v234, v236, v237
v_cvt_pk_bf16_f32 v235, v238, v239
buffer_store_dwordx4 v[232:235], v6, s[8:11], s25 offen offset:1024 sc1
v_mfma_f32_16x16x32_bf16 v[48:51], a[80:83], a[40:43], v[48:51]
ds_read_b128 a[92:95], v3 offset:7168
v_accvgpr_read_b32 v240, a160
v_accvgpr_read_b32 v241, a161
v_accvgpr_read_b32 v242, a162
v_accvgpr_read_b32 v243, a163
v_accvgpr_read_b32 v244, a176
v_accvgpr_read_b32 v245, a177
v_mfma_f32_16x16x32_bf16 v[56:59], a[80:83], a[56:59], v[56:59]
s_waitcnt lgkmcnt(2)
v_accvgpr_read_b32 v246, a178
v_accvgpr_read_b32 v247, a179
v_mul_f32 v240, v240, v18
v_mul_f32 v241, v241, v18
v_mul_f32 v242, v242, v18
v_mul_f32 v243, v243, v18
v_mul_f32 v244, v244, v18
v_mfma_f32_16x16x32_bf16 v[52:55], a[84:87], a[40:43], v[52:55]
ds_read_b128 a[64:67], v2 offset:24576
s_add_u32 s47, s47, 32768
v_mul_f32 v245, v245, v18
v_mul_f32 v246, v246, v18
v_mul_f32 v247, v247, v18
v_cvt_pk_bf16_f32 v240, v240, v241
v_cvt_pk_bf16_f32 v241, v242, v243
v_mfma_f32_16x16x32_bf16 v[60:63], a[84:87], a[56:59], v[60:63]
s_waitcnt lgkmcnt(2)
v_cvt_pk_bf16_f32 v242, v244, v245
v_cvt_pk_bf16_f32 v243, v246, v247
buffer_store_dwordx4 v[240:243], v6, s[8:11], s25 offen offset:2048 sc1
v_accvgpr_read_b32 v248, a192
v_mfma_f32_16x16x32_bf16 v[48:51], a[88:91], a[44:47], v[48:51]
ds_read_b128 a[68:71], v2 offset:25600
v_accvgpr_read_b32 v249, a193
v_accvgpr_read_b32 v250, a194
v_accvgpr_read_b32 v251, a195
v_accvgpr_read_b32 v252, a208
v_accvgpr_read_b32 v253, a209
v_accvgpr_read_b32 v254, a210
v_mfma_f32_16x16x32_bf16 v[56:59], a[88:91], a[60:63], v[56:59]
s_waitcnt lgkmcnt(2)
s_and_b32 s47, s47, 131071
v_accvgpr_read_b32 v255, a211
v_mul_f32 v248, v248, v18
v_mul_f32 v249, v249, v18
v_mul_f32 v250, v250, v18
v_mul_f32 v251, v251, v18
v_mul_f32 v252, v252, v18
v_mfma_f32_16x16x32_bf16 v[52:55], a[92:95], a[44:47], v[52:55]
ds_read_b128 a[72:75], v2 offset:26624
v_mul_f32 v253, v253, v18
v_mul_f32 v254, v254, v18
v_mul_f32 v255, v255, v18
v_cvt_pk_bf16_f32 v248, v248, v249
v_cvt_pk_bf16_f32 v249, v250, v251
v_mfma_f32_16x16x32_bf16 v[60:63], a[92:95], a[60:63], v[60:63]
s_waitcnt lgkmcnt(2)
v_cvt_pk_bf16_f32 v250, v252, v253
v_cvt_pk_bf16_f32 v251, v254, v255
buffer_store_dwordx4 v[248:251], v6, s[8:11], s25 offen offset:3072 sc1
v_mov_b32 v4, v2
v_mov_b32 v2, v3
v_add_u32 v3, 32768, v3
v_and_b32 v3, 131071, v3
v_mfma_f32_16x16x32_bf16 a[228:231], a[240:243], v[116:119], a[228:231]
v_mfma_f32_16x16x32_bf16 a[232:235], a[240:243], v[120:123], a[232:235]
v_mfma_f32_16x16x32_bf16 a[236:239], a[240:243], v[124:127], a[236:239]
v_mfma_f32_16x16x32_bf16 a[100:103], a[64:67], v[116:119], a[100:103]
ds_read_b128 a[76:79], v4 offset:27648
v_cmp_le_i32 s[30:31], 0, v5
v_mfma_f32_16x16x32_bf16 a[104:107], a[64:67], v[120:123], a[104:107]
v_cmp_le_i32 s[32:33], 1, v5
v_cmp_le_i32 s[34:35], 2, v5
v_mfma_f32_16x16x32_bf16 a[108:111], a[64:67], v[124:127], a[108:111]
s_waitcnt lgkmcnt(2)
v_cmp_le_i32 s[36:37], 3, v5
v_cndmask_b32 v48, v8, v48, s[30:31]
v_mfma_f32_16x16x32_bf16 a[116:119], a[68:71], v[116:119], a[116:119]
ds_read_b128 a[80:83], v4 offset:28672
v_cndmask_b32 v49, v8, v49, s[32:33]
v_mfma_f32_16x16x32_bf16 a[120:123], a[68:71], v[120:123], a[120:123]
v_cndmask_b32 v50, v8, v50, s[34:35]
v_cndmask_b32 v51, v8, v51, s[36:37]
v_mfma_f32_16x16x32_bf16 a[124:127], a[68:71], v[124:127], a[124:127]
s_waitcnt lgkmcnt(2)
v_cmp_le_i32 s[30:31], 8, v5
v_cmp_le_i32 s[32:33], 9, v5
v_mfma_f32_16x16x32_bf16 a[132:135], a[72:75], v[116:119], a[132:135]
ds_read_b128 a[84:87], v4 offset:29696
v_cmp_le_i32 s[34:35], 10, v5
v_mfma_f32_16x16x32_bf16 a[136:139], a[72:75], v[120:123], a[136:139]
v_cmp_le_i32 s[36:37], 11, v5
v_cndmask_b32 v52, v8, v52, s[30:31]
v_mfma_f32_16x16x32_bf16 a[140:143], a[72:75], v[124:127], a[140:143]
s_waitcnt lgkmcnt(2)
v_cndmask_b32 v53, v8, v53, s[32:33]
v_cndmask_b32 v54, v8, v54, s[34:35]
v_mfma_f32_16x16x32_bf16 a[148:151], a[76:79], v[116:119], a[148:151]
ds_read_b128 a[88:91], v4 offset:30720
v_cndmask_b32 v55, v8, v55, s[36:37]
v_mfma_f32_16x16x32_bf16 a[152:155], a[76:79], v[120:123], a[152:155]
v_max3_f32 v16, v48, v49, v50
v_max3_f32 v16, v16, v51, v56
v_mfma_f32_16x16x32_bf16 a[156:159], a[76:79], v[124:127], a[156:159]
s_waitcnt lgkmcnt(2)
v_max3_f32 v16, v16, v57, v58
v_max3_f32 v16, v16, v59, v52
v_mfma_f32_16x16x32_bf16 a[164:167], a[80:83], v[116:119], a[164:167]
ds_read_b128 a[92:95], v4 offset:31744
v_max3_f32 v16, v16, v53, v54
v_mfma_f32_16x16x32_bf16 a[168:171], a[80:83], v[120:123], a[168:171]
v_max3_f32 v16, v16, v55, v60
v_max3_f32 v16, v16, v61, v62
v_mfma_f32_16x16x32_bf16 a[172:175], a[80:83], v[124:127], a[172:175]
s_waitcnt lgkmcnt(2)
v_max_f32 v16, v16, v63
v_cmp_lt_f32 vcc, s54, v16
v_mfma_f32_16x16x32_bf16 a[180:183], a[84:87], v[116:119], a[180:183]
ds_read_b128 a[64:67], v2 offset:16384
s_cbranch_vccnz L_at_up6
L_at_upr6:
v_mfma_f32_16x16x32_bf16 a[184:187], a[84:87], v[120:123], a[184:187]
v_exp_f32 v48, v48
v_mfma_f32_16x16x32_bf16 a[188:191], a[84:87], v[124:127], a[188:191]
s_waitcnt lgkmcnt(2)
v_exp_f32 v49, v49
v_mfma_f32_16x16x32_bf16 a[196:199], a[88:91], v[116:119], a[196:199]
ds_read_b128 a[68:71], v2 offset:17408
v_exp_f32 v50, v50
v_mfma_f32_16x16x32_bf16 a[200:203], a[88:91], v[120:123], a[200:203]
v_exp_f32 v51, v51
v_cvt_pk_bf16_f32 v104, v48, v49
v_mfma_f32_16x16x32_bf16 a[204:207], a[88:91], v[124:127], a[204:207]
s_waitcnt lgkmcnt(2)
v_exp_f32 v52, v52
v_cvt_pk_bf16_f32 v105, v50, v51
v_mfma_f32_16x16x32_bf16 a[212:215], a[92:95], v[116:119], a[212:215]
ds_read_b128 a[72:75], v2 offset:18432
v_exp_f32 v53, v53
v_mfma_f32_16x16x32_bf16 a[216:219], a[92:95], v[120:123], a[216:219]
v_exp_f32 v54, v54
v_mfma_f32_16x16x32_bf16 a[220:223], a[92:95], v[124:127], a[220:223]
s_waitcnt lgkmcnt(2)
s_cmp_eq_u32 s48, 0
s_cbranch_scc0 L_at_rs6
L_at_rsr6:
v_mfma_f32_16x16x32_bf16 v[80:83], a[64:67], a[32:35], v[136:139]
ds_read_b128 a[76:79], v2 offset:19456
v_cvt_pk_bf16_f32 v106, v52, v53
v_mfma_f32_16x16x32_bf16 v[88:91], a[64:67], a[48:51], v[140:143]
s_waitcnt lgkmcnt(2)
v_exp_f32 v55, v55
v_mfma_f32_16x16x32_bf16 v[84:87], a[68:71], a[32:35], v[136:139]
ds_read_b128 a[80:83], v2 offset:20480
v_cvt_pk_bf16_f32 v107, v54, v55
v_mfma_f32_16x16x32_bf16 v[92:95], a[68:71], a[48:51], v[140:143]
s_waitcnt lgkmcnt(2)
v_exp_f32 v56, v56
v_mfma_f32_16x16x32_bf16 v[80:83], a[72:75], a[36:39], v[80:83]
ds_read_b128 a[84:87], v2 offset:21504
v_mfma_f32_16x16x32_bf16 v[88:91], a[72:75], a[52:55], v[88:91]
s_waitcnt lgkmcnt(2)
v_exp_f32 v57, v57
v_mfma_f32_16x16x32_bf16 v[84:87], a[76:79], a[36:39], v[84:87]
ds_read_b128 a[88:91], v2 offset:22528
v_exp_f32 v58, v58
v_mfma_f32_16x16x32_bf16 v[92:95], a[76:79], a[52:55], v[92:95]
s_waitcnt lgkmcnt(2)
v_exp_f32 v59, v59
v_mfma_f32_16x16x32_bf16 v[80:83], a[80:83], a[40:43], v[80:83]
ds_read_b128 a[92:95], v2 offset:23552
v_cvt_pk_bf16_f32 v108, v56, v57
v_mfma_f32_16x16x32_bf16 v[88:91], a[80:83], a[56:59], v[88:91]
s_waitcnt lgkmcnt(2)
v_exp_f32 v60, v60
v_mfma_f32_16x16x32_bf16 v[84:87], a[84:87], a[40:43], v[84:87]
ds_read_b128 a[64:67], v2 offset:8192
v_cvt_pk_bf16_f32 v109, v58, v59
v_mfma_f32_16x16x32_bf16 v[92:95], a[84:87], a[56:59], v[92:95]
s_waitcnt lgkmcnt(2)
v_exp_f32 v61, v61
v_mfma_f32_16x16x32_bf16 v[80:83], a[88:91], a[44:47], v[80:83]
ds_read_b128 a[68:71], v2 offset:9216
v_cvt_pk_bf16_f32 v110, v60, v61
v_mfma_f32_16x16x32_bf16 v[88:91], a[88:91], a[60:63], v[88:91]
s_waitcnt lgkmcnt(2)
v_exp_f32 v62, v62
v_mfma_f32_16x16x32_bf16 v[84:87], a[92:95], a[44:47], v[84:87]
ds_read_b128 a[72:75], v2 offset:10240
v_mfma_f32_16x16x32_bf16 v[92:95], a[92:95], a[60:63], v[92:95]
s_waitcnt lgkmcnt(2)
v_exp_f32 v63, v63
s_nop 0
v_cvt_pk_bf16_f32 v111, v62, v63
s_waitcnt vmcnt(12)
s_barrier
s_add_u32 s25, s61, 524288
v_mfma_f32_16x16x32_bf16 a[232:235], a[240:243], v[104:107], a[232:235]
s_add_u32 s24, s46, 4096
v_mfma_f32_16x16x32_bf16 a[236:239], a[240:243], v[108:111], a[236:239]
s_add_u32 m0, s47, 0
v_mfma_f32_16x16x32_bf16 a[104:107], a[64:67], v[104:107], a[104:107]
ds_read_b128 a[76:79], v2 offset:11264
v_mfma_f32_16x16x32_bf16 a[108:111], a[64:67], v[108:111], a[108:111]
s_waitcnt lgkmcnt(2)
buffer_load_dwordx4 v1, s[8:11], s46 offen sc1 lds
v_cmp_le_i32 s[30:31], 32, v5
v_cmp_le_i32 s[32:33], 33, v5
v_mfma_f32_16x16x32_bf16 a[120:123], a[68:71], v[104:107], a[120:123]
ds_read_b128 a[80:83], v2 offset:12288
buffer_load_dwordx4 v1, s[8:11], s46 offen offset:2048 sc1 lds
v_cmp_le_i32 s[34:35], 34, v5
v_mfma_f32_16x16x32_bf16 a[124:127], a[68:71], v[108:111], a[124:127]
s_waitcnt lgkmcnt(2)
v_cmp_le_i32 s[36:37], 35, v5
v_cndmask_b32 v80, v8, v80, s[30:31]
v_cndmask_b32 v81, v8, v81, s[32:33]
v_mfma_f32_16x16x32_bf16 a[136:139], a[72:75], v[104:107], a[136:139]
ds_read_b128 a[84:87], v2 offset:13312
s_add_u32 m0, s47, 896
v_cndmask_b32 v82, v8, v82, s[34:35]
v_mfma_f32_16x16x32_bf16 a[140:143], a[72:75], v[108:111], a[140:143]
s_waitcnt lgkmcnt(2)
v_cndmask_b32 v83, v8, v83, s[36:37]
v_cmp_le_i32 s[30:31], 40, v5
v_cmp_le_i32 s[32:33], 41, v5
v_mfma_f32_16x16x32_bf16 a[152:155], a[76:79], v[104:107], a[152:155]
ds_read_b128 a[88:91], v2 offset:14336
buffer_load_dwordx4 v1, s[8:11], s46 offen offset:128 sc1 lds
v_cmp_le_i32 s[34:35], 42, v5
v_mfma_f32_16x16x32_bf16 a[156:159], a[76:79], v[108:111], a[156:159]
s_waitcnt lgkmcnt(2)
buffer_load_dwordx4 v1, s[8:11], s46 offen offset:2176 sc1 lds
v_cmp_le_i32 s[36:37], 43, v5
v_cndmask_b32 v84, v8, v84, s[30:31]
v_mfma_f32_16x16x32_bf16 a[168:171], a[80:83], v[104:107], a[168:171]
ds_read_b128 a[92:95], v2 offset:15360
v_cndmask_b32 v85, v8, v85, s[32:33]
v_cndmask_b32 v86, v8, v86, s[34:35]
v_mfma_f32_16x16x32_bf16 a[172:175], a[80:83], v[108:111], a[172:175]
s_waitcnt lgkmcnt(2)
s_add_u32 m0, s47, 4096
v_cndmask_b32 v87, v8, v87, s[36:37]
v_max3_f32 v16, v80, v81, v82
v_mfma_f32_16x16x32_bf16 a[184:187], a[84:87], v[104:107], a[184:187]
ds_read_b128 a[64:67], v3
v_max3_f32 v16, v16, v83, v88
v_max3_f32 v16, v16, v89, v90
v_mfma_f32_16x16x32_bf16 a[188:191], a[84:87], v[108:111], a[188:191]
s_waitcnt lgkmcnt(2)
buffer_load_dwordx4 v1, s[8:11], s24 offen sc1 lds
v_max3_f32 v16, v16, v91, v84
v_max3_f32 v16, v16, v85, v86
v_mfma_f32_16x16x32_bf16 a[200:203], a[88:91], v[104:107], a[200:203]
ds_read_b128 a[68:71], v3 offset:1024
buffer_load_dwordx4 v1, s[8:11], s24 offen offset:2048 sc1 lds
v_max3_f32 v16, v16, v87, v92
v_mfma_f32_16x16x32_bf16 a[204:207], a[88:91], v[108:111], a[204:207]
s_waitcnt lgkmcnt(2)
v_max3_f32 v16, v16, v93, v94
v_max_f32 v16, v16, v95
v_cmp_lt_f32 vcc, s54, v16
v_mfma_f32_16x16x32_bf16 a[216:219], a[92:95], v[104:107], a[216:219]
ds_read_b128 a[72:75], v3 offset:2048
s_add_u32 m0, s47, 4992
s_cbranch_vccnz L_at_up7
L_at_upr7:
v_exp_f32 v80, v80
v_exp_f32 v81, v81
v_exp_f32 v82, v82
v_exp_f32 v83, v83
v_exp_f32 v84, v84
v_exp_f32 v85, v85
v_exp_f32 v86, v86
v_mfma_f32_16x16x32_bf16 a[220:223], a[92:95], v[108:111], a[220:223]
s_waitcnt lgkmcnt(2)
buffer_load_dwordx4 v1, s[8:11], s24 offen offset:128 sc1 lds
s_cmp_eq_u32 s48, 0
s_cbranch_scc0 L_at_rs7
L_at_rsr7:
v_exp_f32 v87, v87
v_exp_f32 v88, v88
v_exp_f32 v89, v89
v_exp_f32 v90, v90
v_exp_f32 v91, v91
v_exp_f32 v92, v92
v_exp_f32 v93, v93
v_mfma_f32_16x16x32_bf16 v[56:59], a[64:67], a[48:51], v[140:143]
ds_read_b128 a[76:79], v3 offset:3072
s_waitcnt lgkmcnt(2)
v_exp_f32 v94, v94
v_exp_f32 v95, v95
v_cvt_pk_bf16_f32 v120, v80, v81
v_cvt_pk_bf16_f32 v121, v82, v83
v_cvt_pk_bf16_f32 v122, v84, v85
v_cvt_pk_bf16_f32 v123, v86, v87
v_cvt_pk_bf16_f32 v124, v88, v89
v_cvt_pk_bf16_f32 v125, v90, v91
v_cvt_pk_bf16_f32 v126, v92, v93
v_accvgpr_read_b32 v18, a228
v_rcp_f32 v18, v18
v_mfma_f32_16x16x32_bf16 v[60:63], a[68:71], a[48:51], v[140:143]
ds_read_b128 a[80:83], v3 offset:4096
s_waitcnt lgkmcnt(2)
buffer_load_dwordx4 v1, s[8:11], s24 offen offset:2176 sc1 lds
v_cvt_pk_bf16_f32 v127, v94, v95
v_accvgpr_read_b32 v224, a100
v_accvgpr_read_b32 v225, a101
v_accvgpr_read_b32 v226, a102
v_accvgpr_read_b32 v227, a103
v_accvgpr_read_b32 v228, a116
v_accvgpr_read_b32 v229, a117
v_accvgpr_read_b32 v230, a118
v_accvgpr_read_b32 v231, a119
v_mul_f32 v224, v224, v18
v_mul_f32 v225, v225, v18
v_mul_f32 v226, v226, v18
v_mul_f32 v227, v227, v18
v_mul_f32 v228, v228, v18
v_mfma_f32_16x16x32_bf16 v[56:59], a[72:75], a[52:55], v[56:59]
ds_read_b128 a[84:87], v3 offset:5120
s_waitcnt lgkmcnt(2)
v_mul_f32 v229, v229, v18
v_mul_f32 v230, v230, v18
v_mul_f32 v231, v231, v18
v_cvt_pk_bf16_f32 v224, v224, v225
v_cvt_pk_bf16_f32 v225, v226, v227
v_cvt_pk_bf16_f32 v226, v228, v229
v_cvt_pk_bf16_f32 v227, v230, v231
buffer_store_dwordx4 v[224:227], v6, s[8:11], s25 offen sc1
v_accvgpr_read_b32 v232, a132
v_accvgpr_read_b32 v233, a133
v_accvgpr_read_b32 v234, a134
v_mfma_f32_16x16x32_bf16 v[60:63], a[76:79], a[52:55], v[60:63]
ds_read_b128 a[88:91], v3 offset:6144
s_waitcnt lgkmcnt(2)
s_add_u32 s46, s46, 32768
v_accvgpr_read_b32 v235, a135
v_accvgpr_read_b32 v236, a148
v_accvgpr_read_b32 v237, a149
v_accvgpr_read_b32 v238, a150
v_accvgpr_read_b32 v239, a151
v_mul_f32 v232, v232, v18
v_mul_f32 v233, v233, v18
v_mul_f32 v234, v234, v18
v_mul_f32 v235, v235, v18
v_mul_f32 v236, v236, v18
v_mul_f32 v237, v237, v18
v_mul_f32 v238, v238, v18
v_mul_f32 v239, v239, v18
v_cvt_pk_bf16_f32 v232, v232, v233
v_mfma_f32_16x16x32_bf16 v[56:59], a[80:83], a[56:59], v[56:59]
ds_read_b128 a[92:95], v3 offset:7168
s_waitcnt lgkmcnt(2)
s_add_u32 s47, s47, 32768
v_cvt_pk_bf16_f32 v233, v234, v235
v_cvt_pk_bf16_f32 v234, v236, v237
v_cvt_pk_bf16_f32 v235, v238, v239
buffer_store_dwordx4 v[232:235], v6, s[8:11], s25 offen offset:1024 sc1
v_accvgpr_read_b32 v240, a164
v_accvgpr_read_b32 v241, a165
v_accvgpr_read_b32 v242, a166
v_accvgpr_read_b32 v243, a167
v_accvgpr_read_b32 v244, a180
v_accvgpr_read_b32 v245, a181
v_accvgpr_read_b32 v246, a182
v_mfma_f32_16x16x32_bf16 v[60:63], a[84:87], a[56:59], v[60:63]
ds_read_b128 a[64:67], v2 offset:24576
s_waitcnt lgkmcnt(2)
v_accvgpr_read_b32 v247, a183
v_mul_f32 v240, v240, v18
v_mul_f32 v241, v241, v18
v_mul_f32 v242, v242, v18
v_mul_f32 v243, v243, v18
v_mul_f32 v244, v244, v18
v_mul_f32 v245, v245, v18
v_mul_f32 v246, v246, v18
v_mul_f32 v247, v247, v18
v_cvt_pk_bf16_f32 v240, v240, v241
v_cvt_pk_bf16_f32 v241, v242, v243
v_cvt_pk_bf16_f32 v242, v244, v245
v_cvt_pk_bf16_f32 v243, v246, v247
buffer_store_dwordx4 v[240:243], v6, s[8:11], s25 offen offset:2048 sc1
v_mfma_f32_16x16x32_bf16 v[56:59], a[88:91], a[60:63], v[56:59]
ds_read_b128 a[68:71], v2 offset:25600
s_waitcnt lgkmcnt(2)
s_and_b32 s47, s47, 131071
v_accvgpr_read_b32 v248, a196
v_accvgpr_read_b32 v249, a197
v_accvgpr_read_b32 v250, a198
v_accvgpr_read_b32 v251, a199
v_accvgpr_read_b32 v252, a212
v_accvgpr_read_b32 v253, a213
v_accvgpr_read_b32 v254, a214
v_accvgpr_read_b32 v255, a215
v_mul_f32 v248, v248, v18
v_mul_f32 v249, v249, v18
v_mul_f32 v250, v250, v18
v_mul_f32 v251, v251, v18
v_mfma_f32_16x16x32_bf16 v[60:63], a[92:95], a[60:63], v[60:63]
ds_read_b128 a[72:75], v2 offset:26624
s_waitcnt lgkmcnt(2)
v_mul_f32 v252, v252, v18
v_mul_f32 v253, v253, v18
v_mul_f32 v254, v254, v18
v_mul_f32 v255, v255, v18
v_cvt_pk_bf16_f32 v248, v248, v249
v_cvt_pk_bf16_f32 v249, v250, v251
v_cvt_pk_bf16_f32 v250, v252, v253
v_cvt_pk_bf16_f32 v251, v254, v255
buffer_store_dwordx4 v[248:251], v6, s[8:11], s25 offen offset:3072 sc1
v_mov_b32 v4, v2
v_mov_b32 v2, v3
v_add_u32 v3, 32768, v3
v_and_b32 v3, 131071, v3
v_mfma_f32_16x16x32_bf16 a[232:235], a[240:243], v[120:123], a[232:235]
v_mfma_f32_16x16x32_bf16 a[236:239], a[240:243], v[124:127], a[236:239]
v_mfma_f32_16x16x32_bf16 a[104:107], a[64:67], v[120:123], a[104:107]
ds_read_b128 a[76:79], v4 offset:27648
v_mfma_f32_16x16x32_bf16 a[108:111], a[64:67], v[124:127], a[108:111]
s_waitcnt lgkmcnt(2)
v_cmp_le_i32 s[30:31], 0, v5
v_cmp_le_i32 s[32:33], 1, v5
v_mfma_f32_16x16x32_bf16 a[120:123], a[68:71], v[120:123], a[120:123]
ds_read_b128 a[80:83], v4 offset:28672
v_cmp_le_i32 s[34:35], 2, v5
v_mfma_f32_16x16x32_bf16 a[124:127], a[68:71], v[124:127], a[124:127]
s_waitcnt lgkmcnt(2)
v_cmp_le_i32 s[36:37], 3, v5
v_cndmask_b32 v56, v8, v56, s[30:31]
v_mfma_f32_16x16x32_bf16 a[136:139], a[72:75], v[120:123], a[136:139]
ds_read_b128 a[84:87], v4 offset:29696
v_cndmask_b32 v57, v8, v57, s[32:33]
v_mfma_f32_16x16x32_bf16 a[140:143], a[72:75], v[124:127], a[140:143]
s_waitcnt lgkmcnt(2)
v_cndmask_b32 v58, v8, v58, s[34:35]
v_cndmask_b32 v59, v8, v59, s[36:37]
v_mfma_f32_16x16x32_bf16 a[152:155], a[76:79], v[120:123], a[152:155]
ds_read_b128 a[88:91], v4 offset:30720
v_cmp_le_i32 s[30:31], 8, v5
v_mfma_f32_16x16x32_bf16 a[156:159], a[76:79], v[124:127], a[156:159]
s_waitcnt lgkmcnt(2)
v_cmp_le_i32 s[32:33], 9, v5
v_cmp_le_i32 s[34:35], 10, v5
v_mfma_f32_16x16x32_bf16 a[168:171], a[80:83], v[120:123], a[168:171]
ds_read_b128 a[92:95], v4 offset:31744
v_cmp_le_i32 s[36:37], 11, v5
v_mfma_f32_16x16x32_bf16 a[172:175], a[80:83], v[124:127], a[172:175]
s_waitcnt lgkmcnt(2)
v_cndmask_b32 v60, v8, v60, s[30:31]
v_cndmask_b32 v61, v8, v61, s[32:33]
v_mfma_f32_16x16x32_bf16 a[184:187], a[84:87], v[120:123], a[184:187]
ds_read_b128 a[64:67], v2 offset:16384
v_cndmask_b32 v62, v8, v62, s[34:35]
v_mfma_f32_16x16x32_bf16 a[188:191], a[84:87], v[124:127], a[188:191]
s_waitcnt lgkmcnt(2)
v_cndmask_b32 v63, v8, v63, s[36:37]
v_max3_f32 v16, v56, v57, v58
v_mfma_f32_16x16x32_bf16 a[200:203], a[88:91], v[120:123], a[200:203]
ds_read_b128 a[68:71], v2 offset:17408
v_max3_f32 v16, v16, v59, v60
v_max3_f32 v16, v16, v61, v62
v_max_f32 v16, v16, v63
v_cmp_lt_f32 vcc, s54, v16
v_mfma_f32_16x16x32_bf16 a[204:207], a[88:91], v[124:127], a[204:207]
s_waitcnt lgkmcnt(2)
s_cbranch_vccnz L_at_up8
L_at_upr8:
v_exp_f32 v56, v56
v_mfma_f32_16x16x32_bf16 a[216:219], a[92:95], v[120:123], a[216:219]
ds_read_b128 a[72:75], v2 offset:18432
v_exp_f32 v57, v57
v_mfma_f32_16x16x32_bf16 a[220:223], a[92:95], v[124:127], a[220:223]
s_waitcnt lgkmcnt(2)
s_cmp_eq_u32 s48, 0
s_cbranch_scc0 L_at_rs8
L_at_rsr8:
v_exp_f32 v58, v58
v_mfma_f32_16x16x32_bf16 v[88:91], a[64:67], a[48:51], v[140:143]
ds_read_b128 a[76:79], v2 offset:19456
s_waitcnt lgkmcnt(2)
v_exp_f32 v59, v59
v_mfma_f32_16x16x32_bf16 v[92:95], a[68:71], a[48:51], v[140:143]
ds_read_b128 a[80:83], v2 offset:20480
s_waitcnt lgkmcnt(2)
v_exp_f32 v60, v60
v_mfma_f32_16x16x32_bf16 v[88:91], a[72:75], a[52:55], v[88:91]
ds_read_b128 a[84:87], v2 offset:21504
s_waitcnt lgkmcnt(2)
v_exp_f32 v61, v61
v_mfma_f32_16x16x32_bf16 v[92:95], a[76:79], a[52:55], v[92:95]
ds_read_b128 a[88:91], v2 offset:22528
s_waitcnt lgkmcnt(2)
v_exp_f32 v62, v62
v_mfma_f32_16x16x32_bf16 v[88:91], a[80:83], a[56:59], v[88:91]
ds_read_b128 a[92:95], v2 offset:23552
s_waitcnt lgkmcnt(2)
v_exp_f32 v63, v63
v_mfma_f32_16x16x32_bf16 v[92:95], a[84:87], a[56:59], v[92:95]
ds_read_b128 a[64:67], v2 offset:8192
s_waitcnt lgkmcnt(2)
v_cvt_pk_bf16_f32 v108, v56, v57
v_cvt_pk_bf16_f32 v109, v58, v59
v_mfma_f32_16x16x32_bf16 v[88:91], a[88:91], a[60:63], v[88:91]
ds_read_b128 a[68:71], v2 offset:9216
s_waitcnt lgkmcnt(2)
v_cvt_pk_bf16_f32 v110, v60, v61
v_mfma_f32_16x16x32_bf16 v[92:95], a[92:95], a[60:63], v[92:95]
ds_read_b128 a[72:75], v2 offset:10240
s_waitcnt lgkmcnt(2)
v_cvt_pk_bf16_f32 v111, v62, v63
s_barrier
s_add_u32 s25, s61, 1048576
v_mfma_f32_16x16x32_bf16 a[236:239], a[240:243], v[108:111], a[236:239]
s_add_u32 s24, s46, 4096
s_add_u32 m0, s47, 0
v_mfma_f32_16x16x32_bf16 a[108:111], a[64:67], v[108:111], a[108:111]
ds_read_b128 a[76:79], v2 offset:11264
s_waitcnt lgkmcnt(2)
buffer_load_dwordx4 v1, s[8:11], s46 offen sc1 lds
buffer_load_dwordx4 v1, s[8:11], s46 offen offset:2048 sc1 lds
v_mfma_f32_16x16x32_bf16 a[124:127], a[68:71], v[108:111], a[124:127]
ds_read_b128 a[80:83], v2 offset:12288
s_waitcnt lgkmcnt(2)
s_add_u32 m0, s47, 896
s_nop 0
buffer_load_dwordx4 v1, s[8:11], s46 offen offset:128 sc1 lds
v_mfma_f32_16x16x32_bf16 a[140:143], a[72:75], v[108:111], a[140:143]
ds_read_b128 a[84:87], v2 offset:13312
s_waitcnt lgkmcnt(2)
buffer_load_dwordx4 v1, s[8:11], s46 offen offset:2176 sc1 lds
s_add_u32 m0, s47, 4096
v_cmp_le_i32 s[30:31], 32, v5
v_cmp_le_i32 s[32:33], 33, v5
v_cmp_le_i32 s[34:35], 34, v5
v_cmp_le_i32 s[36:37], 35, v5
v_cndmask_b32 v88, v8, v88, s[30:31]
v_mfma_f32_16x16x32_bf16 a[156:159], a[76:79], v[108:111], a[156:159]
ds_read_b128 a[88:91], v2 offset:14336
s_waitcnt lgkmcnt(2)
buffer_load_dwordx4 v1, s[8:11], s24 offen sc1 lds
v_cndmask_b32 v89, v8, v89, s[32:33]
v_cndmask_b32 v90, v8, v90, s[34:35]
v_cndmask_b32 v91, v8, v91, s[36:37]
v_cmp_le_i32 s[30:31], 40, v5
v_cmp_le_i32 s[32:33], 41, v5
v_cmp_le_i32 s[34:35], 42, v5
v_mfma_f32_16x16x32_bf16 a[172:175], a[80:83], v[108:111], a[172:175]
ds_read_b128 a[92:95], v2 offset:15360
s_waitcnt lgkmcnt(2)
buffer_load_dwordx4 v1, s[8:11], s24 offen offset:2048 sc1 lds
s_add_u32 m0, s47, 4992
v_cmp_le_i32 s[36:37], 43, v5
v_cndmask_b32 v92, v8, v92, s[30:31]
v_cndmask_b32 v93, v8, v93, s[32:33]
v_cndmask_b32 v94, v8, v94, s[34:35]
v_cndmask_b32 v95, v8, v95, s[36:37]
v_mfma_f32_16x16x32_bf16 a[188:191], a[84:87], v[108:111], a[188:191]
ds_read_b128 a[64:67], v2 offset:24576
s_waitcnt lgkmcnt(2)
buffer_load_dwordx4 v1, s[8:11], s24 offen offset:128 sc1 lds
buffer_load_dwordx4 v1, s[8:11], s24 offen offset:2176 sc1 lds
v_max3_f32 v16, v88, v89, v90
v_max3_f32 v16, v16, v91, v92
v_max3_f32 v16, v16, v93, v94
v_max_f32 v16, v16, v95
v_cmp_lt_f32 vcc, s54, v16
v_mfma_f32_16x16x32_bf16 a[204:207], a[88:91], v[108:111], a[204:207]
ds_read_b128 a[68:71], v2 offset:25600
s_waitcnt lgkmcnt(2)
s_add_u32 s46, s46, 32768
s_add_u32 s47, s47, 32768
s_cbranch_vccnz L_at_up9
L_at_upr9:
v_exp_f32 v88, v88
v_exp_f32 v89, v89
v_exp_f32 v90, v90
v_exp_f32 v91, v91
v_exp_f32 v92, v92
v_exp_f32 v93, v93
v_exp_f32 v94, v94
v_exp_f32 v95, v95
v_accvgpr_read_b32 v18, a232
v_rcp_f32 v18, v18
v_accvgpr_read_b32 v224, a104
v_accvgpr_read_b32 v225, a105
v_accvgpr_read_b32 v226, a106
v_accvgpr_read_b32 v227, a107
v_accvgpr_read_b32 v228, a120
v_accvgpr_read_b32 v229, a121
v_accvgpr_read_b32 v230, a122
v_accvgpr_read_b32 v231, a123
v_mul_f32 v224, v224, v18
v_mul_f32 v225, v225, v18
v_mul_f32 v226, v226, v18
v_mul_f32 v227, v227, v18
v_mul_f32 v228, v228, v18
v_mul_f32 v229, v229, v18
v_mul_f32 v230, v230, v18
v_mul_f32 v231, v231, v18
v_cvt_pk_bf16_f32 v224, v224, v225
v_cvt_pk_bf16_f32 v225, v226, v227
v_cvt_pk_bf16_f32 v226, v228, v229
v_cvt_pk_bf16_f32 v227, v230, v231
buffer_store_dwordx4 v[224:227], v6, s[8:11], s25 offen sc1
v_accvgpr_read_b32 v232, a136
v_accvgpr_read_b32 v233, a137
v_accvgpr_read_b32 v234, a138
v_accvgpr_read_b32 v235, a139
v_accvgpr_read_b32 v236, a152
v_accvgpr_read_b32 v237, a153
v_accvgpr_read_b32 v238, a154
v_accvgpr_read_b32 v239, a155
v_mul_f32 v232, v232, v18
v_mul_f32 v233, v233, v18
v_mul_f32 v234, v234, v18
v_mul_f32 v235, v235, v18
v_mul_f32 v236, v236, v18
v_mul_f32 v237, v237, v18
v_mul_f32 v238, v238, v18
v_mul_f32 v239, v239, v18
v_cvt_pk_bf16_f32 v232, v232, v233
v_mfma_f32_16x16x32_bf16 a[220:223], a[92:95], v[108:111], a[220:223]
ds_read_b128 a[72:75], v2 offset:26624
s_waitcnt lgkmcnt(2)
s_and_b32 s47, s47, 131071
s_cmp_eq_u32 s48, 0
s_cbranch_scc0 L_at_rs9
L_at_rsr9:
v_cvt_pk_bf16_f32 v124, v88, v89
v_cvt_pk_bf16_f32 v125, v90, v91
v_cvt_pk_bf16_f32 v126, v92, v93
v_cvt_pk_bf16_f32 v127, v94, v95
v_cvt_pk_bf16_f32 v233, v234, v235
v_cvt_pk_bf16_f32 v234, v236, v237
v_cvt_pk_bf16_f32 v235, v238, v239
buffer_store_dwordx4 v[232:235], v6, s[8:11], s25 offen offset:1024 sc1
v_accvgpr_read_b32 v240, a168
v_accvgpr_read_b32 v241, a169
v_accvgpr_read_b32 v242, a170
v_accvgpr_read_b32 v243, a171
v_accvgpr_read_b32 v244, a184
v_accvgpr_read_b32 v245, a185
v_accvgpr_read_b32 v246, a186
v_accvgpr_read_b32 v247, a187
v_mul_f32 v240, v240, v18
v_mul_f32 v241, v241, v18
v_mul_f32 v242, v242, v18
v_mul_f32 v243, v243, v18
v_mul_f32 v244, v244, v18
v_mul_f32 v245, v245, v18
v_mul_f32 v246, v246, v18
v_mul_f32 v247, v247, v18
v_cvt_pk_bf16_f32 v240, v240, v241
v_cvt_pk_bf16_f32 v241, v242, v243
v_cvt_pk_bf16_f32 v242, v244, v245
v_cvt_pk_bf16_f32 v243, v246, v247
buffer_store_dwordx4 v[240:243], v6, s[8:11], s25 offen offset:2048 sc1
v_accvgpr_read_b32 v248, a200
v_accvgpr_read_b32 v249, a201
v_accvgpr_read_b32 v250, a202
v_accvgpr_read_b32 v251, a203
v_accvgpr_read_b32 v252, a216
v_accvgpr_read_b32 v253, a217
v_accvgpr_read_b32 v254, a218
v_accvgpr_read_b32 v255, a219
v_mul_f32 v248, v248, v18
v_mul_f32 v249, v249, v18
v_mul_f32 v250, v250, v18
v_mul_f32 v251, v251, v18
v_mul_f32 v252, v252, v18
v_mul_f32 v253, v253, v18
v_mul_f32 v254, v254, v18
v_mul_f32 v255, v255, v18
v_cvt_pk_bf16_f32 v248, v248, v249
v_cvt_pk_bf16_f32 v249, v250, v251
v_cvt_pk_bf16_f32 v250, v252, v253
v_cvt_pk_bf16_f32 v251, v254, v255
buffer_store_dwordx4 v[248:251], v6, s[8:11], s25 offen offset:3072 sc1
v_mfma_f32_16x16x32_bf16 a[236:239], a[240:243], v[124:127], a[236:239]
v_mfma_f32_16x16x32_bf16 a[108:111], a[64:67], v[124:127], a[108:111]
ds_read_b128 a[76:79], v2 offset:27648
s_waitcnt lgkmcnt(2)
v_mfma_f32_16x16x32_bf16 a[124:127], a[68:71], v[124:127], a[124:127]
ds_read_b128 a[80:83], v2 offset:28672
s_waitcnt lgkmcnt(2)
v_mfma_f32_16x16x32_bf16 a[140:143], a[72:75], v[124:127], a[140:143]
ds_read_b128 a[84:87], v2 offset:29696
s_waitcnt lgkmcnt(2)
v_mfma_f32_16x16x32_bf16 a[156:159], a[76:79], v[124:127], a[156:159]
ds_read_b128 a[88:91], v2 offset:30720
s_waitcnt lgkmcnt(2)
v_mfma_f32_16x16x32_bf16 a[172:175], a[80:83], v[124:127], a[172:175]
ds_read_b128 a[92:95], v2 offset:31744
s_waitcnt lgkmcnt(2)
v_mfma_f32_16x16x32_bf16 a[188:191], a[84:87], v[124:127], a[188:191]
s_waitcnt lgkmcnt(1)
v_mfma_f32_16x16x32_bf16 a[204:207], a[88:91], v[124:127], a[204:207]
s_waitcnt lgkmcnt(0)
v_mfma_f32_16x16x32_bf16 a[220:223], a[92:95], v[124:127], a[220:223]
s_add_u32 s25, s61, 1572864
v_accvgpr_read_b32 v18, a236
v_rcp_f32 v18, v18
v_accvgpr_read_b32 v224, a108
v_accvgpr_read_b32 v225, a109
v_accvgpr_read_b32 v226, a110
v_accvgpr_read_b32 v227, a111
v_accvgpr_read_b32 v228, a124
v_accvgpr_read_b32 v229, a125
v_accvgpr_read_b32 v230, a126
v_accvgpr_read_b32 v231, a127
v_mul_f32 v224, v224, v18
v_mul_f32 v225, v225, v18
v_mul_f32 v226, v226, v18
v_mul_f32 v227, v227, v18
v_mul_f32 v228, v228, v18
v_mul_f32 v229, v229, v18
v_mul_f32 v230, v230, v18
v_mul_f32 v231, v231, v18
v_cvt_pk_bf16_f32 v224, v224, v225
v_cvt_pk_bf16_f32 v225, v226, v227
v_cvt_pk_bf16_f32 v226, v228, v229
v_cvt_pk_bf16_f32 v227, v230, v231
buffer_store_dwordx4 v[224:227], v6, s[8:11], s25 offen sc1
v_accvgpr_read_b32 v232, a140
v_accvgpr_read_b32 v233, a141
v_accvgpr_read_b32 v234, a142
v_accvgpr_read_b32 v235, a143
v_accvgpr_read_b32 v236, a156
v_accvgpr_read_b32 v237, a157
v_accvgpr_read_b32 v238, a158
v_accvgpr_read_b32 v239, a159
v_mul_f32 v232, v232, v18
v_mul_f32 v233, v233, v18
v_mul_f32 v234, v234, v18
v_mul_f32 v235, v235, v18
v_mul_f32 v236, v236, v18
v_mul_f32 v237, v237, v18
v_mul_f32 v238, v238, v18
v_mul_f32 v239, v239, v18
v_cvt_pk_bf16_f32 v232, v232, v233
v_cvt_pk_bf16_f32 v233, v234, v235
v_cvt_pk_bf16_f32 v234, v236, v237
v_cvt_pk_bf16_f32 v235, v238, v239
buffer_store_dwordx4 v[232:235], v6, s[8:11], s25 offen offset:1024 sc1
v_accvgpr_read_b32 v240, a172
v_accvgpr_read_b32 v241, a173
v_accvgpr_read_b32 v242, a174
v_accvgpr_read_b32 v243, a175
v_accvgpr_read_b32 v244, a188
v_accvgpr_read_b32 v245, a189
v_accvgpr_read_b32 v246, a190
v_accvgpr_read_b32 v247, a191
v_mul_f32 v240, v240, v18
v_mul_f32 v241, v241, v18
v_mul_f32 v242, v242, v18
v_mul_f32 v243, v243, v18
v_mul_f32 v244, v244, v18
v_mul_f32 v245, v245, v18
v_mul_f32 v246, v246, v18
v_mul_f32 v247, v247, v18
v_cvt_pk_bf16_f32 v240, v240, v241
v_cvt_pk_bf16_f32 v241, v242, v243
v_cvt_pk_bf16_f32 v242, v244, v245
v_cvt_pk_bf16_f32 v243, v246, v247
buffer_store_dwordx4 v[240:243], v6, s[8:11], s25 offen offset:2048 sc1
v_accvgpr_read_b32 v248, a204
v_accvgpr_read_b32 v249, a205
v_accvgpr_read_b32 v250, a206
v_accvgpr_read_b32 v251, a207
v_accvgpr_read_b32 v252, a220
v_accvgpr_read_b32 v253, a221
v_accvgpr_read_b32 v254, a222
v_accvgpr_read_b32 v255, a223
v_mul_f32 v248, v248, v18
v_mul_f32 v249, v249, v18
v_mul_f32 v250, v250, v18
v_mul_f32 v251, v251, v18
v_mul_f32 v252, v252, v18
v_mul_f32 v253, v253, v18
v_mul_f32 v254, v254, v18
v_mul_f32 v255, v255, v18
v_cvt_pk_bf16_f32 v248, v248, v249
v_cvt_pk_bf16_f32 v249, v250, v251
v_cvt_pk_bf16_f32 v250, v252, v253
v_cvt_pk_bf16_f32 v251, v254, v255
buffer_store_dwordx4 v[248:251], v6, s[8:11], s25 offen offset:3072 sc1
s_lshl_b32 s60, s41, 5
s_add_u32 s60, s60, s42
s_lshl_b32 s60, s60, 2
s_add_u32 s60, s60, 111169536
s_cmp_eq_u32 s17, 0
s_cselect_b32 s60, s60, 536870912
s_mov_b32 s41, s63
s_mov_b32 s63, 8
s_waitcnt vmcnt(28)
s_cmp_lt_u32 s41, 8
s_cbranch_scc1 L_at_item
s_waitcnt vmcnt(0)
s_barrier
v_mov_b32 v19, 1
s_mov_b64 exec, 1
buffer_store_dword v19, v6, s[8:11], s60 offen sc1
s_mov_b64 exec, -1
s_branch L_at_done
L_at_up0:
v_max3_f32 v16, v32, v33, v34
v_max3_f32 v16, v16, v35, v36
v_max3_f32 v16, v16, v37, v38
v_max_f32 v16, v16, v39
v_mov_b32 v17, v16
s_nop 1
v_permlane32_swap_b32 v17, v16
v_max_f32 v16, v16, v17
v_mov_b32 v17, v16
s_nop 1
v_permlane16_swap_b32 v17, v16
v_max3_f32 v16, v16, v17, s55
v_exp_f32 v12, -v16
v_sub_f32 v32, v32, v16
v_sub_f32 v33, v33, v16
v_sub_f32 v34, v34, v16
v_sub_f32 v35, v35, v16
v_sub_f32 v36, v36, v16
v_sub_f32 v37, v37, v16
v_sub_f32 v38, v38, v16
v_sub_f32 v39, v39, v16
v_sub_f32 v128, v128, v16
v_sub_f32 v129, v129, v16
v_sub_f32 v130, v130, v16
v_sub_f32 v131, v131, v16
v_max3_f32 v16, v40, v41, v42
v_max3_f32 v16, v16, v43, v44
v_max3_f32 v16, v16, v45, v46
v_max_f32 v16, v16, v47
v_mov_b32 v17, v16
s_nop 1
v_permlane32_swap_b32 v17, v16
v_max_f32 v16, v16, v17
v_mov_b32 v17, v16
s_nop 1
v_permlane16_swap_b32 v17, v16
v_max3_f32 v16, v16, v17, s55
v_exp_f32 v13, -v16
v_sub_f32 v40, v40, v16
v_sub_f32 v41, v41, v16
v_sub_f32 v42, v42, v16
v_sub_f32 v43, v43, v16
v_sub_f32 v44, v44, v16
v_sub_f32 v45, v45, v16
v_sub_f32 v46, v46, v16
v_sub_f32 v47, v47, v16
v_sub_f32 v132, v132, v16
v_sub_f32 v133, v133, v16
v_sub_f32 v134, v134, v16
v_sub_f32 v135, v135, v16
v_max3_f32 v16, v48, v49, v50
v_max3_f32 v16, v16, v51, v52
v_max3_f32 v16, v16, v53, v54
v_max_f32 v16, v16, v55
v_mov_b32 v17, v16
s_nop 1
v_permlane32_swap_b32 v17, v16
v_max_f32 v16, v16, v17
v_mov_b32 v17, v16
s_nop 1
v_permlane16_swap_b32 v17, v16
v_max3_f32 v16, v16, v17, s55
v_exp_f32 v14, -v16
v_sub_f32 v48, v48, v16
v_sub_f32 v49, v49, v16
v_sub_f32 v50, v50, v16
v_sub_f32 v51, v51, v16
v_sub_f32 v52, v52, v16
v_sub_f32 v53, v53, v16
v_sub_f32 v54, v54, v16
v_sub_f32 v55, v55, v16
v_sub_f32 v136, v136, v16
v_sub_f32 v137, v137, v16
v_sub_f32 v138, v138, v16
v_sub_f32 v139, v139, v16
v_max3_f32 v16, v56, v57, v58
v_max3_f32 v16, v16, v59, v60
v_max3_f32 v16, v16, v61, v62
v_max_f32 v16, v16, v63
v_mov_b32 v17, v16
s_nop 1
v_permlane32_swap_b32 v17, v16
v_max_f32 v16, v16, v17
v_mov_b32 v17, v16
s_nop 1
v_permlane16_swap_b32 v17, v16
v_max3_f32 v16, v16, v17, s55
v_exp_f32 v15, -v16
v_sub_f32 v56, v56, v16
v_sub_f32 v57, v57, v16
v_sub_f32 v58, v58, v16
v_sub_f32 v59, v59, v16
v_sub_f32 v60, v60, v16
v_sub_f32 v61, v61, v16
v_sub_f32 v62, v62, v16
v_sub_f32 v63, v63, v16
v_sub_f32 v140, v140, v16
v_sub_f32 v141, v141, v16
v_sub_f32 v142, v142, v16
v_sub_f32 v143, v143, v16
s_cmp_eq_u32 s55, 0
s_cselect_b32 s48, 1, 0
s_mov_b32 s55, 0
s_mov_b32 s54, s51
s_branch L_at_upr0
L_at_rs0:
s_mov_b32 s52, 0
s_branch L_at_rescale
L_at_up1:
v_max3_f32 v16, v64, v65, v66
v_max3_f32 v16, v16, v67, v68
v_max3_f32 v16, v16, v69, v70
v_max_f32 v16, v16, v71
v_mov_b32 v17, v16
s_nop 1
v_permlane32_swap_b32 v17, v16
v_max_f32 v16, v16, v17
v_mov_b32 v17, v16
s_nop 1
v_permlane16_swap_b32 v17, v16
v_max3_f32 v16, v16, v17, s55
v_exp_f32 v12, -v16
v_sub_f32 v64, v64, v16
v_sub_f32 v65, v65, v16
v_sub_f32 v66, v66, v16
v_sub_f32 v67, v67, v16
v_sub_f32 v68, v68, v16
v_sub_f32 v69, v69, v16
v_sub_f32 v70, v70, v16
v_sub_f32 v71, v71, v16
v_sub_f32 v128, v128, v16
v_sub_f32 v129, v129, v16
v_sub_f32 v130, v130, v16
v_sub_f32 v131, v131, v16
v_max3_f32 v16, v72, v73, v74
v_max3_f32 v16, v16, v75, v76
v_max3_f32 v16, v16, v77, v78
v_max_f32 v16, v16, v79
v_mov_b32 v17, v16
s_nop 1
v_permlane32_swap_b32 v17, v16
v_max_f32 v16, v16, v17
v_mov_b32 v17, v16
s_nop 1
v_permlane16_swap_b32 v17, v16
v_max3_f32 v16, v16, v17, s55
v_exp_f32 v13, -v16
v_sub_f32 v72, v72, v16
v_sub_f32 v73, v73, v16
v_sub_f32 v74, v74, v16
v_sub_f32 v75, v75, v16
v_sub_f32 v76, v76, v16
v_sub_f32 v77, v77, v16
v_sub_f32 v78, v78, v16
v_sub_f32 v79, v79, v16
v_sub_f32 v132, v132, v16
v_sub_f32 v133, v133, v16
v_sub_f32 v134, v134, v16
v_sub_f32 v135, v135, v16
v_max3_f32 v16, v80, v81, v82
v_max3_f32 v16, v16, v83, v84
v_max3_f32 v16, v16, v85, v86
v_max_f32 v16, v16, v87
v_mov_b32 v17, v16
s_nop 1
v_permlane32_swap_b32 v17, v16
v_max_f32 v16, v16, v17
v_mov_b32 v17, v16
s_nop 1
v_permlane16_swap_b32 v17, v16
v_max3_f32 v16, v16, v17, s55
v_exp_f32 v14, -v16
v_sub_f32 v80, v80, v16
v_sub_f32 v81, v81, v16
v_sub_f32 v82, v82, v16
v_sub_f32 v83, v83, v16
v_sub_f32 v84, v84, v16
v_sub_f32 v85, v85, v16
v_sub_f32 v86, v86, v16
v_sub_f32 v87, v87, v16
v_sub_f32 v136, v136, v16
v_sub_f32 v137, v137, v16
v_sub_f32 v138, v138, v16
v_sub_f32 v139, v139, v16
v_max3_f32 v16, v88, v89, v90
v_max3_f32 v16, v16, v91, v92
v_max3_f32 v16, v16, v93, v94
v_max_f32 v16, v16, v95
v_mov_b32 v17, v16
s_nop 1
v_permlane32_swap_b32 v17, v16
v_max_f32 v16, v16, v17
v_mov_b32 v17, v16
s_nop 1
v_permlane16_swap_b32 v17, v16
v_max3_f32 v16, v16, v17, s55
v_exp_f32 v15, -v16
v_sub_f32 v88, v88, v16
v_sub_f32 v89, v89, v16
v_sub_f32 v90, v90, v16
v_sub_f32 v91, v91, v16
v_sub_f32 v92, v92, v16
v_sub_f32 v93, v93, v16
v_sub_f32 v94, v94, v16
v_sub_f32 v95, v95, v16
v_sub_f32 v140, v140, v16
v_sub_f32 v141, v141, v16
v_sub_f32 v142, v142, v16
v_sub_f32 v143, v143, v16
s_cmp_eq_u32 s55, 0
s_cselect_b32 s48, 1, 0
s_mov_b32 s55, 0
s_mov_b32 s54, s51
s_branch L_at_upr1
L_at_rs1:
s_mov_b32 s52, 1
s_branch L_at_rescale
L_at_up2:
v_max3_f32 v16, v32, v33, v34
v_max3_f32 v16, v16, v35, v36
v_max3_f32 v16, v16, v37, v38
v_max_f32 v16, v16, v39
v_mov_b32 v17, v16
s_nop 1
v_permlane32_swap_b32 v17, v16
v_max_f32 v16, v16, v17
v_mov_b32 v17, v16
s_nop 1
v_permlane16_swap_b32 v17, v16
v_max3_f32 v16, v16, v17, s55
v_exp_f32 v12, -v16
v_sub_f32 v32, v32, v16
v_sub_f32 v33, v33, v16
v_sub_f32 v34, v34, v16
v_sub_f32 v35, v35, v16
v_sub_f32 v36, v36, v16
v_sub_f32 v37, v37, v16
v_sub_f32 v38, v38, v16
v_sub_f32 v39, v39, v16
v_sub_f32 v128, v128, v16
v_sub_f32 v129, v129, v16
v_sub_f32 v130, v130, v16
v_sub_f32 v131, v131, v16
v_max3_f32 v16, v40, v41, v42
v_max3_f32 v16, v16, v43, v44
v_max3_f32 v16, v16, v45, v46
v_max_f32 v16, v16, v47
v_mov_b32 v17, v16
s_nop 1
v_permlane32_swap_b32 v17, v16
v_max_f32 v16, v16, v17
v_mov_b32 v17, v16
s_nop 1
v_permlane16_swap_b32 v17, v16
v_max3_f32 v16, v16, v17, s55
v_exp_f32 v13, -v16
v_sub_f32 v40, v40, v16
v_sub_f32 v41, v41, v16
v_sub_f32 v42, v42, v16
v_sub_f32 v43, v43, v16
v_sub_f32 v44, v44, v16
v_sub_f32 v45, v45, v16
v_sub_f32 v46, v46, v16
v_sub_f32 v47, v47, v16
v_sub_f32 v132, v132, v16
v_sub_f32 v133, v133, v16
v_sub_f32 v134, v134, v16
v_sub_f32 v135, v135, v16
v_max3_f32 v16, v48, v49, v50
v_max3_f32 v16, v16, v51, v52
v_max3_f32 v16, v16, v53, v54
v_max_f32 v16, v16, v55
v_mov_b32 v17, v16
s_nop 1
v_permlane32_swap_b32 v17, v16
v_max_f32 v16, v16, v17
v_mov_b32 v17, v16
s_nop 1
v_permlane16_swap_b32 v17, v16
v_max3_f32 v16, v16, v17, s55
v_exp_f32 v14, -v16
v_sub_f32 v48, v48, v16
v_sub_f32 v49, v49, v16
v_sub_f32 v50, v50, v16
v_sub_f32 v51, v51, v16
v_sub_f32 v52, v52, v16
v_sub_f32 v53, v53, v16
v_sub_f32 v54, v54, v16
v_sub_f32 v55, v55, v16
v_sub_f32 v136, v136, v16
v_sub_f32 v137, v137, v16
v_sub_f32 v138, v138, v16
v_sub_f32 v139, v139, v16
v_max3_f32 v16, v56, v57, v58
v_max3_f32 v16, v16, v59, v60
v_max3_f32 v16, v16, v61, v62
v_max_f32 v16, v16, v63
v_mov_b32 v17, v16
s_nop 1
v_permlane32_swap_b32 v17, v16
v_max_f32 v16, v16, v17
v_mov_b32 v17, v16
s_nop 1
v_permlane16_swap_b32 v17, v16
v_max3_f32 v16, v16, v17, s55
v_exp_f32 v15, -v16
v_sub_f32 v56, v56, v16
v_sub_f32 v57, v57, v16
v_sub_f32 v58, v58, v16
v_sub_f32 v59, v59, v16
v_sub_f32 v60, v60, v16
v_sub_f32 v61, v61, v16
v_sub_f32 v62, v62, v16
v_sub_f32 v63, v63, v16
v_sub_f32 v140, v140, v16
v_sub_f32 v141, v141, v16
v_sub_f32 v142, v142, v16
v_sub_f32 v143, v143, v16
s_cmp_eq_u32 s55, 0
s_cselect_b32 s48, 1, 0
s_mov_b32 s55, 0
s_mov_b32 s54, s51
s_branch L_at_upr2
L_at_rs2:
s_mov_b32 s52, 2
s_branch L_at_rescale
L_at_up3:
v_max3_f32 v16, v64, v65, v66
v_max3_f32 v16, v16, v67, v68
v_max3_f32 v16, v16, v69, v70
v_max_f32 v16, v16, v71
v_mov_b32 v17, v16
s_nop 1
v_permlane32_swap_b32 v17, v16
v_max_f32 v16, v16, v17
v_mov_b32 v17, v16
s_nop 1
v_permlane16_swap_b32 v17, v16
v_max3_f32 v16, v16, v17, s55
v_exp_f32 v12, -v16
v_sub_f32 v64, v64, v16
v_sub_f32 v65, v65, v16
v_sub_f32 v66, v66, v16
v_sub_f32 v67, v67, v16
v_sub_f32 v68, v68, v16
v_sub_f32 v69, v69, v16
v_sub_f32 v70, v70, v16
v_sub_f32 v71, v71, v16
v_sub_f32 v128, v128, v16
v_sub_f32 v129, v129, v16
v_sub_f32 v130, v130, v16
v_sub_f32 v131, v131, v16
v_max3_f32 v16, v72, v73, v74
v_max3_f32 v16, v16, v75, v76
v_max3_f32 v16, v16, v77, v78
v_max_f32 v16, v16, v79
v_mov_b32 v17, v16
s_nop 1
v_permlane32_swap_b32 v17, v16
v_max_f32 v16, v16, v17
v_mov_b32 v17, v16
s_nop 1
v_permlane16_swap_b32 v17, v16
v_max3_f32 v16, v16, v17, s55
v_exp_f32 v13, -v16
v_sub_f32 v72, v72, v16
v_sub_f32 v73, v73, v16
v_sub_f32 v74, v74, v16
v_sub_f32 v75, v75, v16
v_sub_f32 v76, v76, v16
v_sub_f32 v77, v77, v16
v_sub_f32 v78, v78, v16
v_sub_f32 v79, v79, v16
v_sub_f32 v132, v132, v16
v_sub_f32 v133, v133, v16
v_sub_f32 v134, v134, v16
v_sub_f32 v135, v135, v16
v_max3_f32 v16, v80, v81, v82
v_max3_f32 v16, v16, v83, v84
v_max3_f32 v16, v16, v85, v86
v_max_f32 v16, v16, v87
v_mov_b32 v17, v16
s_nop 1
v_permlane32_swap_b32 v17, v16
v_max_f32 v16, v16, v17
v_mov_b32 v17, v16
s_nop 1
v_permlane16_swap_b32 v17, v16
v_max3_f32 v16, v16, v17, s55
v_exp_f32 v14, -v16
v_sub_f32 v80, v80, v16
v_sub_f32 v81, v81, v16
v_sub_f32 v82, v82, v16
v_sub_f32 v83, v83, v16
v_sub_f32 v84, v84, v16
v_sub_f32 v85, v85, v16
v_sub_f32 v86, v86, v16
v_sub_f32 v87, v87, v16
v_sub_f32 v136, v136, v16
v_sub_f32 v137, v137, v16
v_sub_f32 v138, v138, v16
v_sub_f32 v139, v139, v16
v_max3_f32 v16, v88, v89, v90
v_max3_f32 v16, v16, v91, v92
v_max3_f32 v16, v16, v93, v94
v_max_f32 v16, v16, v95
v_mov_b32 v17, v16
s_nop 1
v_permlane32_swap_b32 v17, v16
v_max_f32 v16, v16, v17
v_mov_b32 v17, v16
s_nop 1
v_permlane16_swap_b32 v17, v16
v_max3_f32 v16, v16, v17, s55
v_exp_f32 v15, -v16
v_sub_f32 v88, v88, v16
v_sub_f32 v89, v89, v16
v_sub_f32 v90, v90, v16
v_sub_f32 v91, v91, v16
v_sub_f32 v92, v92, v16
v_sub_f32 v93, v93, v16
v_sub_f32 v94, v94, v16
v_sub_f32 v95, v95, v16
v_sub_f32 v140, v140, v16
v_sub_f32 v141, v141, v16
v_sub_f32 v142, v142, v16
v_sub_f32 v143, v143, v16
s_cmp_eq_u32 s55, 0
s_cselect_b32 s48, 1, 0
s_mov_b32 s55, 0
s_mov_b32 s54, s51
s_branch L_at_upr3
L_at_rs3:
s_mov_b32 s52, 3
s_branch L_at_rescale
L_at_up4:
v_mov_b32 v12, 1.0
v_max3_f32 v16, v40, v41, v42
v_max3_f32 v16, v16, v43, v44
v_max3_f32 v16, v16, v45, v46
v_max_f32 v16, v16, v47
v_mov_b32 v17, v16
s_nop 1
v_permlane32_swap_b32 v17, v16
v_max_f32 v16, v16, v17
v_mov_b32 v17, v16
s_nop 1
v_permlane16_swap_b32 v17, v16
v_max3_f32 v16, v16, v17, s55
v_exp_f32 v13, -v16
v_sub_f32 v40, v40, v16
v_sub_f32 v41, v41, v16
v_sub_f32 v42, v42, v16
v_sub_f32 v43, v43, v16
v_sub_f32 v44, v44, v16
v_sub_f32 v45, v45, v16
v_sub_f32 v46, v46, v16
v_sub_f32 v47, v47, v16
v_sub_f32 v132, v132, v16
v_sub_f32 v133, v133, v16
v_sub_f32 v134, v134, v16
v_sub_f32 v135, v135, v16
v_max3_f32 v16, v48, v49, v50
v_max3_f32 v16, v16, v51, v52
v_max3_f32 v16, v16, v53, v54
v_max_f32 v16, v16, v55
v_mov_b32 v17, v16
s_nop 1
v_permlane32_swap_b32 v17, v16
v_max_f32 v16, v16, v17
v_mov_b32 v17, v16
s_nop 1
v_permlane16_swap_b32 v17, v16
v_max3_f32 v16, v16, v17, s55
v_exp_f32 v14, -v16
v_sub_f32 v48, v48, v16
v_sub_f32 v49, v49, v16
v_sub_f32 v50, v50, v16
v_sub_f32 v51, v51, v16
v_sub_f32 v52, v52, v16
v_sub_f32 v53, v53, v16
v_sub_f32 v54, v54, v16
v_sub_f32 v55, v55, v16
v_sub_f32 v136, v136, v16
v_sub_f32 v137, v137, v16
v_sub_f32 v138, v138, v16
v_sub_f32 v139, v139, v16
v_max3_f32 v16, v56, v57, v58
v_max3_f32 v16, v16, v59, v60
v_max3_f32 v16, v16, v61, v62
v_max_f32 v16, v16, v63
v_mov_b32 v17, v16
s_nop 1
v_permlane32_swap_b32 v17, v16
v_max_f32 v16, v16, v17
v_mov_b32 v17, v16
s_nop 1
v_permlane16_swap_b32 v17, v16
v_max3_f32 v16, v16, v17, s55
v_exp_f32 v15, -v16
v_sub_f32 v56, v56, v16
v_sub_f32 v57, v57, v16
v_sub_f32 v58, v58, v16
v_sub_f32 v59, v59, v16
v_sub_f32 v60, v60, v16
v_sub_f32 v61, v61, v16
v_sub_f32 v62, v62, v16
v_sub_f32 v63, v63, v16
v_sub_f32 v140, v140, v16
v_sub_f32 v141, v141, v16
v_sub_f32 v142, v142, v16
v_sub_f32 v143, v143, v16
s_cmp_eq_u32 s55, 0
s_cselect_b32 s48, 1, 0
s_mov_b32 s55, 0
s_mov_b32 s54, s51
s_branch L_at_upr4
L_at_rs4:
s_mov_b32 s52, 4
s_branch L_at_rescale
L_at_up5:
v_mov_b32 v12, 1.0
v_max3_f32 v16, v72, v73, v74
v_max3_f32 v16, v16, v75, v76
v_max3_f32 v16, v16, v77, v78
v_max_f32 v16, v16, v79
v_mov_b32 v17, v16
s_nop 1
v_permlane32_swap_b32 v17, v16
v_max_f32 v16, v16, v17
v_mov_b32 v17, v16
s_nop 1
v_permlane16_swap_b32 v17, v16
v_max3_f32 v16, v16, v17, s55
v_exp_f32 v13, -v16
v_sub_f32 v72, v72, v16
v_sub_f32 v73, v73, v16
v_sub_f32 v74, v74, v16
v_sub_f32 v75, v75, v16
v_sub_f32 v76, v76, v16
v_sub_f32 v77, v77, v16
v_sub_f32 v78, v78, v16
v_sub_f32 v79, v79, v16
v_sub_f32 v132, v132, v16
v_sub_f32 v133, v133, v16
v_sub_f32 v134, v134, v16
v_sub_f32 v135, v135, v16
v_max3_f32 v16, v80, v81, v82
v_max3_f32 v16, v16, v83, v84
v_max3_f32 v16, v16, v85, v86
v_max_f32 v16, v16, v87
v_mov_b32 v17, v16
s_nop 1
v_permlane32_swap_b32 v17, v16
v_max_f32 v16, v16, v17
v_mov_b32 v17, v16
s_nop 1
v_permlane16_swap_b32 v17, v16
v_max3_f32 v16, v16, v17, s55
v_exp_f32 v14, -v16
v_sub_f32 v80, v80, v16
v_sub_f32 v81, v81, v16
v_sub_f32 v82, v82, v16
v_sub_f32 v83, v83, v16
v_sub_f32 v84, v84, v16
v_sub_f32 v85, v85, v16
v_sub_f32 v86, v86, v16
v_sub_f32 v87, v87, v16
v_sub_f32 v136, v136, v16
v_sub_f32 v137, v137, v16
v_sub_f32 v138, v138, v16
v_sub_f32 v139, v139, v16
v_max3_f32 v16, v88, v89, v90
v_max3_f32 v16, v16, v91, v92
v_max3_f32 v16, v16, v93, v94
v_max_f32 v16, v16, v95
v_mov_b32 v17, v16
s_nop 1
v_permlane32_swap_b32 v17, v16
v_max_f32 v16, v16, v17
v_mov_b32 v17, v16
s_nop 1
v_permlane16_swap_b32 v17, v16
v_max3_f32 v16, v16, v17, s55
v_exp_f32 v15, -v16
v_sub_f32 v88, v88, v16
v_sub_f32 v89, v89, v16
v_sub_f32 v90, v90, v16
v_sub_f32 v91, v91, v16
v_sub_f32 v92, v92, v16
v_sub_f32 v93, v93, v16
v_sub_f32 v94, v94, v16
v_sub_f32 v95, v95, v16
v_sub_f32 v140, v140, v16
v_sub_f32 v141, v141, v16
v_sub_f32 v142, v142, v16
v_sub_f32 v143, v143, v16
s_cmp_eq_u32 s55, 0
s_cselect_b32 s48, 1, 0
s_mov_b32 s55, 0
s_mov_b32 s54, s51
s_branch L_at_upr5
L_at_rs5:
s_mov_b32 s52, 5
s_branch L_at_rescale
L_at_up6:
v_mov_b32 v12, 1.0
v_mov_b32 v13, 1.0
v_max3_f32 v16, v48, v49, v50
v_max3_f32 v16, v16, v51, v52
v_max3_f32 v16, v16, v53, v54
v_max_f32 v16, v16, v55
v_mov_b32 v17, v16
s_nop 1
v_permlane32_swap_b32 v17, v16
v_max_f32 v16, v16, v17
v_mov_b32 v17, v16
s_nop 1
v_permlane16_swap_b32 v17, v16
v_max3_f32 v16, v16, v17, s55
v_exp_f32 v14, -v16
v_sub_f32 v48, v48, v16
v_sub_f32 v49, v49, v16
v_sub_f32 v50, v50, v16
v_sub_f32 v51, v51, v16
v_sub_f32 v52, v52, v16
v_sub_f32 v53, v53, v16
v_sub_f32 v54, v54, v16
v_sub_f32 v55, v55, v16
v_sub_f32 v136, v136, v16
v_sub_f32 v137, v137, v16
v_sub_f32 v138, v138, v16
v_sub_f32 v139, v139, v16
v_max3_f32 v16, v56, v57, v58
v_max3_f32 v16, v16, v59, v60
v_max3_f32 v16, v16, v61, v62
v_max_f32 v16, v16, v63
v_mov_b32 v17, v16
s_nop 1
v_permlane32_swap_b32 v17, v16
v_max_f32 v16, v16, v17
v_mov_b32 v17, v16
s_nop 1
v_permlane16_swap_b32 v17, v16
v_max3_f32 v16, v16, v17, s55
v_exp_f32 v15, -v16
v_sub_f32 v56, v56, v16
v_sub_f32 v57, v57, v16
v_sub_f32 v58, v58, v16
v_sub_f32 v59, v59, v16
v_sub_f32 v60, v60, v16
v_sub_f32 v61, v61, v16
v_sub_f32 v62, v62, v16
v_sub_f32 v63, v63, v16
v_sub_f32 v140, v140, v16
v_sub_f32 v141, v141, v16
v_sub_f32 v142, v142, v16
v_sub_f32 v143, v143, v16
s_cmp_eq_u32 s55, 0
s_cselect_b32 s48, 1, 0
s_mov_b32 s55, 0
s_mov_b32 s54, s51
s_branch L_at_upr6
L_at_rs6:
s_mov_b32 s52, 6
s_branch L_at_rescale
L_at_up7:
v_mov_b32 v12, 1.0
v_mov_b32 v13, 1.0
v_max3_f32 v16, v80, v81, v82
v_max3_f32 v16, v16, v83, v84
v_max3_f32 v16, v16, v85, v86
v_max_f32 v16, v16, v87
v_mov_b32 v17, v16
s_nop 1
v_permlane32_swap_b32 v17, v16
v_max_f32 v16, v16, v17
v_mov_b32 v17, v16
s_nop 1
v_permlane16_swap_b32 v17, v16
v_max3_f32 v16, v16, v17, s55
v_exp_f32 v14, -v16
v_sub_f32 v80, v80, v16
v_sub_f32 v81, v81, v16
v_sub_f32 v82, v82, v16
v_sub_f32 v83, v83, v16
v_sub_f32 v84, v84, v16
v_sub_f32 v85, v85, v16
v_sub_f32 v86, v86, v16
v_sub_f32 v87, v87, v16
v_sub_f32 v136, v136, v16
v_sub_f32 v137, v137, v16
v_sub_f32 v138, v138, v16
v_sub_f32 v139, v139, v16
v_max3_f32 v16, v88, v89, v90
v_max3_f32 v16, v16, v91, v92
v_max3_f32 v16, v16, v93, v94
v_max_f32 v16, v16, v95
v_mov_b32 v17, v16
s_nop 1
v_permlane32_swap_b32 v17, v16
v_max_f32 v16, v16, v17
v_mov_b32 v17, v16
s_nop 1
v_permlane16_swap_b32 v17, v16
v_max3_f32 v16, v16, v17, s55
v_exp_f32 v15, -v16
v_sub_f32 v88, v88, v16
v_sub_f32 v89, v89, v16
v_sub_f32 v90, v90, v16
v_sub_f32 v91, v91, v16
v_sub_f32 v92, v92, v16
v_sub_f32 v93, v93, v16
v_sub_f32 v94, v94, v16
v_sub_f32 v95, v95, v16
v_sub_f32 v140, v140, v16
v_sub_f32 v141, v141, v16
v_sub_f32 v142, v142, v16
v_sub_f32 v143, v143, v16
s_cmp_eq_u32 s55, 0
s_cselect_b32 s48, 1, 0
s_mov_b32 s55, 0
s_mov_b32 s54, s51
s_branch L_at_upr7
L_at_rs7:
s_mov_b32 s52, 7
s_branch L_at_rescale
L_at_up8:
v_mov_b32 v12, 1.0
v_mov_b32 v13, 1.0
v_mov_b32 v14, 1.0
v_max3_f32 v16, v56, v57, v58
v_max3_f32 v16, v16, v59, v60
v_max3_f32 v16, v16, v61, v62
v_max_f32 v16, v16, v63
v_mov_b32 v17, v16
s_nop 1
v_permlane32_swap_b32 v17, v16
v_max_f32 v16, v16, v17
v_mov_b32 v17, v16
s_nop 1
v_permlane16_swap_b32 v17, v16
v_max3_f32 v16, v16, v17, s55
v_exp_f32 v15, -v16
v_sub_f32 v56, v56, v16
v_sub_f32 v57, v57, v16
v_sub_f32 v58, v58, v16
v_sub_f32 v59, v59, v16
v_sub_f32 v60, v60, v16
v_sub_f32 v61, v61, v16
v_sub_f32 v62, v62, v16
v_sub_f32 v63, v63, v16
v_sub_f32 v140, v140, v16
v_sub_f32 v141, v141, v16
v_sub_f32 v142, v142, v16
v_sub_f32 v143, v143, v16
s_cmp_eq_u32 s55, 0
s_cselect_b32 s48, 1, 0
s_mov_b32 s55, 0
s_mov_b32 s54, s51
s_branch L_at_upr8
L_at_rs8:
s_mov_b32 s52, 8
s_branch L_at_rescale
L_at_up9:
v_mov_b32 v12, 1.0
v_mov_b32 v13, 1.0
v_mov_b32 v14, 1.0
v_max3_f32 v16, v88, v89, v90
v_max3_f32 v16, v16, v91, v92
v_max3_f32 v16, v16, v93, v94
v_max_f32 v16, v16, v95
v_mov_b32 v17, v16
s_nop 1
v_permlane32_swap_b32 v17, v16
v_max_f32 v16, v16, v17
v_mov_b32 v17, v16
s_nop 1
v_permlane16_swap_b32 v17, v16
v_max3_f32 v16, v16, v17, s55
v_exp_f32 v15, -v16
v_sub_f32 v88, v88, v16
v_sub_f32 v89, v89, v16
v_sub_f32 v90, v90, v16
v_sub_f32 v91, v91, v16
v_sub_f32 v92, v92, v16
v_sub_f32 v93, v93, v16
v_sub_f32 v94, v94, v16
v_sub_f32 v95, v95, v16
v_sub_f32 v140, v140, v16
v_sub_f32 v141, v141, v16
v_sub_f32 v142, v142, v16
v_sub_f32 v143, v143, v16
s_cmp_eq_u32 s55, 0
s_cselect_b32 s48, 1, 0
s_mov_b32 s55, 0
s_mov_b32 s54, s51
s_branch L_at_upr9
L_at_rs9:
s_mov_b32 s52, 9
s_branch L_at_rescale
L_at_rescale:
v_accvgpr_read_b32 v24, a96
v_accvgpr_read_b32 v25, a97
v_accvgpr_read_b32 v26, a98
v_accvgpr_read_b32 v27, a99
v_accvgpr_read_b32 v28, a100
v_accvgpr_read_b32 v29, a101
v_accvgpr_read_b32 v30, a102
v_accvgpr_read_b32 v31, a103
v_mul_f32 v24, v24, v12
v_mul_f32 v25, v25, v12
v_mul_f32 v26, v26, v12
v_mul_f32 v27, v27, v12
v_mul_f32 v28, v28, v13
v_mul_f32 v29, v29, v13
v_mul_f32 v30, v30, v13
v_mul_f32 v31, v31, v13
v_accvgpr_write_b32 a96, v24
v_accvgpr_write_b32 a97, v25
v_accvgpr_write_b32 a98, v26
v_accvgpr_write_b32 a99, v27
v_accvgpr_write_b32 a100, v28
v_accvgpr_write_b32 a101, v29
v_accvgpr_write_b32 a102, v30
v_accvgpr_write_b32 a103, v31
v_accvgpr_read_b32 v24, a104
v_accvgpr_read_b32 v25, a105
v_accvgpr_read_b32 v26, a106
v_accvgpr_read_b32 v27, a107
v_accvgpr_read_b32 v28, a108
v_accvgpr_read_b32 v29, a109
v_accvgpr_read_b32 v30, a110
v_accvgpr_read_b32 v31, a111
v_mul_f32 v24, v24, v14
v_mul_f32 v25, v25, v14
v_mul_f32 v26, v26, v14
v_mul_f32 v27, v27, v14
v_mul_f32 v28, v28, v15
v_mul_f32 v29, v29, v15
v_mul_f32 v30, v30, v15
v_mul_f32 v31, v31, v15
v_accvgpr_write_b32 a104, v24
v_accvgpr_write_b32 a105, v25
v_accvgpr_write_b32 a106, v26
v_accvgpr_write_b32 a107, v27
v_accvgpr_write_b32 a108, v28
v_accvgpr_write_b32 a109, v29
v_accvgpr_write_b32 a110, v30
v_accvgpr_write_b32 a111, v31
v_accvgpr_read_b32 v24, a112
v_accvgpr_read_b32 v25, a113
v_accvgpr_read_b32 v26, a114
v_accvgpr_read_b32 v27, a115
v_accvgpr_read_b32 v28, a116
v_accvgpr_read_b32 v29, a117
v_accvgpr_read_b32 v30, a118
v_accvgpr_read_b32 v31, a119
v_mul_f32 v24, v24, v12
v_mul_f32 v25, v25, v12
v_mul_f32 v26, v26, v12
v_mul_f32 v27, v27, v12
v_mul_f32 v28, v28, v13
v_mul_f32 v29, v29, v13
v_mul_f32 v30, v30, v13
v_mul_f32 v31, v31, v13
v_accvgpr_write_b32 a112, v24
v_accvgpr_write_b32 a113, v25
v_accvgpr_write_b32 a114, v26
v_accvgpr_write_b32 a115, v27
v_accvgpr_write_b32 a116, v28
v_accvgpr_write_b32 a117, v29
v_accvgpr_write_b32 a118, v30
v_accvgpr_write_b32 a119, v31
v_accvgpr_read_b32 v24, a120
v_accvgpr_read_b32 v25, a121
v_accvgpr_read_b32 v26, a122
v_accvgpr_read_b32 v27, a123
v_accvgpr_read_b32 v28, a124
v_accvgpr_read_b32 v29, a125
v_accvgpr_read_b32 v30, a126
v_accvgpr_read_b32 v31, a127
v_mul_f32 v24, v24, v14
v_mul_f32 v25, v25, v14
v_mul_f32 v26, v26, v14
v_mul_f32 v27, v27, v14
v_mul_f32 v28, v28, v15
v_mul_f32 v29, v29, v15
v_mul_f32 v30, v30, v15
v_mul_f32 v31, v31, v15
v_accvgpr_write_b32 a120, v24
v_accvgpr_write_b32 a121, v25
v_accvgpr_write_b32 a122, v26
v_accvgpr_write_b32 a123, v27
v_accvgpr_write_b32 a124, v28
v_accvgpr_write_b32 a125, v29
v_accvgpr_write_b32 a126, v30
v_accvgpr_write_b32 a127, v31
v_accvgpr_read_b32 v24, a128
v_accvgpr_read_b32 v25, a129
v_accvgpr_read_b32 v26, a130
v_accvgpr_read_b32 v27, a131
v_accvgpr_read_b32 v28, a132
v_accvgpr_read_b32 v29, a133
v_accvgpr_read_b32 v30, a134
v_accvgpr_read_b32 v31, a135
v_mul_f32 v24, v24, v12
v_mul_f32 v25, v25, v12
v_mul_f32 v26, v26, v12
v_mul_f32 v27, v27, v12
v_mul_f32 v28, v28, v13
v_mul_f32 v29, v29, v13
v_mul_f32 v30, v30, v13
v_mul_f32 v31, v31, v13
v_accvgpr_write_b32 a128, v24
v_accvgpr_write_b32 a129, v25
v_accvgpr_write_b32 a130, v26
v_accvgpr_write_b32 a131, v27
v_accvgpr_write_b32 a132, v28
v_accvgpr_write_b32 a133, v29
v_accvgpr_write_b32 a134, v30
v_accvgpr_write_b32 a135, v31
v_accvgpr_read_b32 v24, a136
v_accvgpr_read_b32 v25, a137
v_accvgpr_read_b32 v26, a138
v_accvgpr_read_b32 v27, a139
v_accvgpr_read_b32 v28, a140
v_accvgpr_read_b32 v29, a141
v_accvgpr_read_b32 v30, a142
v_accvgpr_read_b32 v31, a143
v_mul_f32 v24, v24, v14
v_mul_f32 v25, v25, v14
v_mul_f32 v26, v26, v14
v_mul_f32 v27, v27, v14
v_mul_f32 v28, v28, v15
v_mul_f32 v29, v29, v15
v_mul_f32 v30, v30, v15
v_mul_f32 v31, v31, v15
v_accvgpr_write_b32 a136, v24
v_accvgpr_write_b32 a137, v25
v_accvgpr_write_b32 a138, v26
v_accvgpr_write_b32 a139, v27
v_accvgpr_write_b32 a140, v28
v_accvgpr_write_b32 a141, v29
v_accvgpr_write_b32 a142, v30
v_accvgpr_write_b32 a143, v31
v_accvgpr_read_b32 v24, a144
v_accvgpr_read_b32 v25, a145
v_accvgpr_read_b32 v26, a146
v_accvgpr_read_b32 v27, a147
v_accvgpr_read_b32 v28, a148
v_accvgpr_read_b32 v29, a149
v_accvgpr_read_b32 v30, a150
v_accvgpr_read_b32 v31, a151
v_mul_f32 v24, v24, v12
v_mul_f32 v25, v25, v12
v_mul_f32 v26, v26, v12
v_mul_f32 v27, v27, v12
v_mul_f32 v28, v28, v13
v_mul_f32 v29, v29, v13
v_mul_f32 v30, v30, v13
v_mul_f32 v31, v31, v13
v_accvgpr_write_b32 a144, v24
v_accvgpr_write_b32 a145, v25
v_accvgpr_write_b32 a146, v26
v_accvgpr_write_b32 a147, v27
v_accvgpr_write_b32 a148, v28
v_accvgpr_write_b32 a149, v29
v_accvgpr_write_b32 a150, v30
v_accvgpr_write_b32 a151, v31
v_accvgpr_read_b32 v24, a152
v_accvgpr_read_b32 v25, a153
v_accvgpr_read_b32 v26, a154
v_accvgpr_read_b32 v27, a155
v_accvgpr_read_b32 v28, a156
v_accvgpr_read_b32 v29, a157
v_accvgpr_read_b32 v30, a158
v_accvgpr_read_b32 v31, a159
v_mul_f32 v24, v24, v14
v_mul_f32 v25, v25, v14
v_mul_f32 v26, v26, v14
v_mul_f32 v27, v27, v14
v_mul_f32 v28, v28, v15
v_mul_f32 v29, v29, v15
v_mul_f32 v30, v30, v15
v_mul_f32 v31, v31, v15
v_accvgpr_write_b32 a152, v24
v_accvgpr_write_b32 a153, v25
v_accvgpr_write_b32 a154, v26
v_accvgpr_write_b32 a155, v27
v_accvgpr_write_b32 a156, v28
v_accvgpr_write_b32 a157, v29
v_accvgpr_write_b32 a158, v30
v_accvgpr_write_b32 a159, v31
v_accvgpr_read_b32 v24, a160
v_accvgpr_read_b32 v25, a161
v_accvgpr_read_b32 v26, a162
v_accvgpr_read_b32 v27, a163
v_accvgpr_read_b32 v28, a164
v_accvgpr_read_b32 v29, a165
v_accvgpr_read_b32 v30, a166
v_accvgpr_read_b32 v31, a167
v_mul_f32 v24, v24, v12
v_mul_f32 v25, v25, v12
v_mul_f32 v26, v26, v12
v_mul_f32 v27, v27, v12
v_mul_f32 v28, v28, v13
v_mul_f32 v29, v29, v13
v_mul_f32 v30, v30, v13
v_mul_f32 v31, v31, v13
v_accvgpr_write_b32 a160, v24
v_accvgpr_write_b32 a161, v25
v_accvgpr_write_b32 a162, v26
v_accvgpr_write_b32 a163, v27
v_accvgpr_write_b32 a164, v28
v_accvgpr_write_b32 a165, v29
v_accvgpr_write_b32 a166, v30
v_accvgpr_write_b32 a167, v31
v_accvgpr_read_b32 v24, a168
v_accvgpr_read_b32 v25, a169
v_accvgpr_read_b32 v26, a170
v_accvgpr_read_b32 v27, a171
v_accvgpr_read_b32 v28, a172
v_accvgpr_read_b32 v29, a173
v_accvgpr_read_b32 v30, a174
v_accvgpr_read_b32 v31, a175
v_mul_f32 v24, v24, v14
v_mul_f32 v25, v25, v14
v_mul_f32 v26, v26, v14
v_mul_f32 v27, v27, v14
v_mul_f32 v28, v28, v15
v_mul_f32 v29, v29, v15
v_mul_f32 v30, v30, v15
v_mul_f32 v31, v31, v15
v_accvgpr_write_b32 a168, v24
v_accvgpr_write_b32 a169, v25
v_accvgpr_write_b32 a170, v26
v_accvgpr_write_b32 a171, v27
v_accvgpr_write_b32 a172, v28
v_accvgpr_write_b32 a173, v29
v_accvgpr_write_b32 a174, v30
v_accvgpr_write_b32 a175, v31
v_accvgpr_read_b32 v24, a176
v_accvgpr_read_b32 v25, a177
v_accvgpr_read_b32 v26, a178
v_accvgpr_read_b32 v27, a179
v_accvgpr_read_b32 v28, a180
v_accvgpr_read_b32 v29, a181
v_accvgpr_read_b32 v30, a182
v_accvgpr_read_b32 v31, a183
v_mul_f32 v24, v24, v12
v_mul_f32 v25, v25, v12
v_mul_f32 v26, v26, v12
v_mul_f32 v27, v27, v12
v_mul_f32 v28, v28, v13
v_mul_f32 v29, v29, v13
v_mul_f32 v30, v30, v13
v_mul_f32 v31, v31, v13
v_accvgpr_write_b32 a176, v24
v_accvgpr_write_b32 a177, v25
v_accvgpr_write_b32 a178, v26
v_accvgpr_write_b32 a179, v27
v_accvgpr_write_b32 a180, v28
v_accvgpr_write_b32 a181, v29
v_accvgpr_write_b32 a182, v30
v_accvgpr_write_b32 a183, v31
v_accvgpr_read_b32 v24, a184
v_accvgpr_read_b32 v25, a185
v_accvgpr_read_b32 v26, a186
v_accvgpr_read_b32 v27, a187
v_accvgpr_read_b32 v28, a188
v_accvgpr_read_b32 v29, a189
v_accvgpr_read_b32 v30, a190
v_accvgpr_read_b32 v31, a191
v_mul_f32 v24, v24, v14
v_mul_f32 v25, v25, v14
v_mul_f32 v26, v26, v14
v_mul_f32 v27, v27, v14
v_mul_f32 v28, v28, v15
v_mul_f32 v29, v29, v15
v_mul_f32 v30, v30, v15
v_mul_f32 v31, v31, v15
v_accvgpr_write_b32 a184, v24
v_accvgpr_write_b32 a185, v25
v_accvgpr_write_b32 a186, v26
v_accvgpr_write_b32 a187, v27
v_accvgpr_write_b32 a188, v28
v_accvgpr_write_b32 a189, v29
v_accvgpr_write_b32 a190, v30
v_accvgpr_write_b32 a191, v31
v_accvgpr_read_b32 v24, a192
v_accvgpr_read_b32 v25, a193
v_accvgpr_read_b32 v26, a194
v_accvgpr_read_b32 v27, a195
v_accvgpr_read_b32 v28, a196
v_accvgpr_read_b32 v29, a197
v_accvgpr_read_b32 v30, a198
v_accvgpr_read_b32 v31, a199
v_mul_f32 v24, v24, v12
v_mul_f32 v25, v25, v12
v_mul_f32 v26, v26, v12
v_mul_f32 v27, v27, v12
v_mul_f32 v28, v28, v13
v_mul_f32 v29, v29, v13
v_mul_f32 v30, v30, v13
v_mul_f32 v31, v31, v13
v_accvgpr_write_b32 a192, v24
v_accvgpr_write_b32 a193, v25
v_accvgpr_write_b32 a194, v26
v_accvgpr_write_b32 a195, v27
v_accvgpr_write_b32 a196, v28
v_accvgpr_write_b32 a197, v29
v_accvgpr_write_b32 a198, v30
v_accvgpr_write_b32 a199, v31
v_accvgpr_read_b32 v24, a200
v_accvgpr_read_b32 v25, a201
v_accvgpr_read_b32 v26, a202
v_accvgpr_read_b32 v27, a203
v_accvgpr_read_b32 v28, a204
v_accvgpr_read_b32 v29, a205
v_accvgpr_read_b32 v30, a206
v_accvgpr_read_b32 v31, a207
v_mul_f32 v24, v24, v14
v_mul_f32 v25, v25, v14
v_mul_f32 v26, v26, v14
v_mul_f32 v27, v27, v14
v_mul_f32 v28, v28, v15
v_mul_f32 v29, v29, v15
v_mul_f32 v30, v30, v15
v_mul_f32 v31, v31, v15
v_accvgpr_write_b32 a200, v24
v_accvgpr_write_b32 a201, v25
v_accvgpr_write_b32 a202, v26
v_accvgpr_write_b32 a203, v27
v_accvgpr_write_b32 a204, v28
v_accvgpr_write_b32 a205, v29
v_accvgpr_write_b32 a206, v30
v_accvgpr_write_b32 a207, v31
v_accvgpr_read_b32 v24, a208
v_accvgpr_read_b32 v25, a209
v_accvgpr_read_b32 v26, a210
v_accvgpr_read_b32 v27, a211
v_accvgpr_read_b32 v28, a212
v_accvgpr_read_b32 v29, a213
v_accvgpr_read_b32 v30, a214
v_accvgpr_read_b32 v31, a215
v_mul_f32 v24, v24, v12
v_mul_f32 v25, v25, v12
v_mul_f32 v26, v26, v12
v_mul_f32 v27, v27, v12
v_mul_f32 v28, v28, v13
v_mul_f32 v29, v29, v13
v_mul_f32 v30, v30, v13
v_mul_f32 v31, v31, v13
v_accvgpr_write_b32 a208, v24
v_accvgpr_write_b32 a209, v25
v_accvgpr_write_b32 a210, v26
v_accvgpr_write_b32 a211, v27
v_accvgpr_write_b32 a212, v28
v_accvgpr_write_b32 a213, v29
v_accvgpr_write_b32 a214, v30
v_accvgpr_write_b32 a215, v31
v_accvgpr_read_b32 v24, a216
v_accvgpr_read_b32 v25, a217
v_accvgpr_read_b32 v26, a218
v_accvgpr_read_b32 v27, a219
v_accvgpr_read_b32 v28, a220
v_accvgpr_read_b32 v29, a221
v_accvgpr_read_b32 v30, a222
v_accvgpr_read_b32 v31, a223
v_mul_f32 v24, v24, v14
v_mul_f32 v25, v25, v14
v_mul_f32 v26, v26, v14
v_mul_f32 v27, v27, v14
v_mul_f32 v28, v28, v15
v_mul_f32 v29, v29, v15
v_mul_f32 v30, v30, v15
v_mul_f32 v31, v31, v15
v_accvgpr_write_b32 a216, v24
v_accvgpr_write_b32 a217, v25
v_accvgpr_write_b32 a218, v26
v_accvgpr_write_b32 a219, v27
v_accvgpr_write_b32 a220, v28
v_accvgpr_write_b32 a221, v29
v_accvgpr_write_b32 a222, v30
v_accvgpr_write_b32 a223, v31
v_accvgpr_read_b32 v24, a224
v_accvgpr_read_b32 v25, a225
v_accvgpr_read_b32 v26, a226
v_accvgpr_read_b32 v27, a227
v_accvgpr_read_b32 v28, a228
v_accvgpr_read_b32 v29, a229
v_accvgpr_read_b32 v30, a230
v_accvgpr_read_b32 v31, a231
v_mul_f32 v24, v24, v12
v_mul_f32 v25, v25, v12
v_mul_f32 v26, v26, v12
v_mul_f32 v27, v27, v12
v_mul_f32 v28, v28, v13
v_mul_f32 v29, v29, v13
v_mul_f32 v30, v30, v13
v_mul_f32 v31, v31, v13
v_accvgpr_write_b32 a224, v24
v_accvgpr_write_b32 a225, v25
v_accvgpr_write_b32 a226, v26
v_accvgpr_write_b32 a227, v27
v_accvgpr_write_b32 a228, v28
v_accvgpr_write_b32 a229, v29
v_accvgpr_write_b32 a230, v30
v_accvgpr_write_b32 a231, v31
v_accvgpr_read_b32 v24, a232
v_accvgpr_read_b32 v25, a233
v_accvgpr_read_b32 v26, a234
v_accvgpr_read_b32 v27, a235
v_accvgpr_read_b32 v28, a236
v_accvgpr_read_b32 v29, a237
v_accvgpr_read_b32 v30, a238
v_accvgpr_read_b32 v31, a239
v_mul_f32 v24, v24, v14
v_mul_f32 v25, v25, v14
v_mul_f32 v26, v26, v14
v_mul_f32 v27, v27, v14
v_mul_f32 v28, v28, v15
v_mul_f32 v29, v29, v15
v_mul_f32 v30, v30, v15
v_mul_f32 v31, v31, v15
v_accvgpr_write_b32 a232, v24
v_accvgpr_write_b32 a233, v25
v_accvgpr_write_b32 a234, v26
v_accvgpr_write_b32 a235, v27
v_accvgpr_write_b32 a236, v28
v_accvgpr_write_b32 a237, v29
v_accvgpr_write_b32 a238, v30
v_accvgpr_write_b32 a239, v31
s_mov_b32 s48, 0
s_cmp_eq_u32 s52, 0
s_cbranch_scc1 L_at_rsr0
s_cmp_eq_u32 s52, 1
s_cbranch_scc1 L_at_rsr1
s_cmp_eq_u32 s52, 2
s_cbranch_scc1 L_at_rsr2
s_cmp_eq_u32 s52, 3
s_cbranch_scc1 L_at_rsr3
s_cmp_eq_u32 s52, 4
s_cbranch_scc1 L_at_rsr4
s_cmp_eq_u32 s52, 5
s_cbranch_scc1 L_at_rsr5
s_cmp_eq_u32 s52, 6
s_cbranch_scc1 L_at_rsr6
s_cmp_eq_u32 s52, 7
s_cbranch_scc1 L_at_rsr7
s_cmp_eq_u32 s52, 8
s_cbranch_scc1 L_at_rsr8
s_branch L_at_rsr9
L_at_done:
s_load_dwordx2 s[4:5], s[0:1], 40
s_waitcnt lgkmcnt(0)
s_mov_b32 s20, s4
s_and_b32 s21, s5, 0xffff
s_mov_b32 s22, 4718592
s_mov_b32 s23, 0x20000
s_sub_u32 s25, s3, 4
s_mul_i32 s24, s25, 27
s_add_u32 s24, s24, s16
s_mul_i32 s26, s25, 5
s_add_u32 s26, s26, s16
s_add_u32 s26, s26, 81
s_cmp_ge_u32 s16, 27
s_cselect_b32 s24, s26, s24
s_cmp_ge_u32 s24, 126
s_cbranch_scc1 L_done
s_mul_i32 s25, s24, 57
s_lshr_b32 s25, s25, 9
s_mul_i32 s26, s25, 9
s_sub_u32 s40, s24, s26
s_and_b32 s51, s25, 1
s_add_u32 s51, s51, 126
s_lshr_b32 s25, s25, 1
s_cmp_eq_u32 s25, 0
s_cselect_b32 s42, 0x20408109, s42
s_cselect_b32 s43, 0x2040810, s43
s_cmp_eq_u32 s25, 1
s_cselect_b32 s42, 0x40810212, s42
s_cselect_b32 s43, 0x4081020, s43
s_cmp_eq_u32 s25, 2
s_cselect_b32 s42, 0x81020424, s42
s_cselect_b32 s43, 0x8102040, s43
s_cmp_eq_u32 s25, 3
s_cselect_b32 s42, 0x2040840, s42
s_cselect_b32 s43, 0x10204081, s43
s_cmp_eq_u32 s25, 4
s_cselect_b32 s42, 0x4081000, s42
s_cselect_b32 s43, 0x20408102, s43
s_cmp_eq_u32 s25, 5
s_cselect_b32 s42, 0x8102000, s42
s_cselect_b32 s43, 0x40810204, s43
s_cmp_eq_u32 s25, 6
s_cselect_b32 s42, 0x10204080, s42
s_cselect_b32 s43, 0x81020408, s43
s_mov_b32 s44, 67108864
s_mov_b32 s45, 111169536
s_mov_b32 s46, 4
s_mov_b32 s47, 0
s_branch L_op
L_bdie:
s_mov_b32 s4, 0x57ff0000
s_mov_b32 s5, 0x55555555
s_cmp_eq_u32 s3, 2
s_cbranch_scc1 L_cr0
s_mov_b32 s4, 0xa8000000
s_mov_b32 s5, 0xaaaaaaaa
s_branch L_cr0
s_and_b32 s27, s3, 1
s_lshr_b32 s26, s16, 2
s_lshl_b32 s26, s26, 1
s_and_b32 s24, s16, 1
s_add_u32 s26, s26, s24
s_mov_b32 s4, 0x57ff0000
s_mov_b32 s5, 0x55555555
s_bitcmp1_b32 s16, 1
s_cbranch_scc1 L_crew
s_mov_b32 s4, 0xa8000000
s_mov_b32 s5, 0xaaaaaaaa
s_branch L_crew
L_part:
s_mov_b32 s4, 0xffff
s_mov_b32 s5, 0x0
L_cr0:
s_and_b32 s27, s16, 1
s_lshr_b32 s26, s16, 1
L_crew:
s_cmp_eq_u64 s[4:5], 0
s_cbranch_scc1 L_done
s_cmp_lt_u32 s26, 9
s_cbranch_scc1 L_bo
s_mov_b64 s[52:53], s[4:5]
s_sub_u32 s41, s26, 9
s_lshl_b32 s41, s41, 1
s_add_u32 s41, s41, s27
s_mul_i32 s24, s17, 14
s_add_u32 s41, s41, s24
s_mov_b32 s40, 0x3e0293ee
s_mov_b32 s50, 0xf149f2ca
s_mov_b32 s51, 0x41a00000
v_and_b32 v5, 31, v0
v_bfe_u32 v26, v0, 5, 1
v_lshlrev_b32 v27, 2, v26
v_sub_u32 v5, v5, v27
v_bfe_u32 v27, v0, 4, 1
v_lshlrev_b32 v6, 17, v27
v_lshl_add_u32 v6, v26, 8, v6
v_and_b32 v27, 15, v0
v_lshl_add_u32 v6, v27, 4, v6
v_and_b32 v1, 63, v0
v_min_u32 v17, 47, v1
v_lshlrev_b32 v1, 4, v1
v_bfe_u32 v26, v0, 5, 1
v_and_b32 v27, 7, v0
v_xor_b32 v27, v27, v26
v_lshlrev_b32 v27, 4, v27
v_lshl_add_u32 v2, v26, 7, v27
v_xor_b32 v7, 64, v2
v_and_b32 v27, 31, v0
v_lshlrev_b32 v27, 2, v27
v_lshl_add_u32 v3, v26, 8, v27
v_mov_b32 v4, 0
v_lshlrev_b32 v17, 7, v17
v_mul_u32_u24 v26, 24576, v26
v_add_u32 v17, v17, v26
v_add_u32 v17, 111149056, v17
v_bfe_u32 v26, v0, 1, 2
v_and_b32 v27, 1, v0
v_lshl_add_u32 v26, v27, 4, v26
v_bfe_u32 v27, v0, 4, 1
v_lshl_add_u32 v26, v27, 2, v26
v_and_or_b32 v26, v0, 40, v26
v_lshlrev_b32 v16, 4, v26
v_mov_b32 v31, s50
s_mov_b32 s49, 0
s_mov_b32 s45, -1
v_cmp_le_i32 s[64:65], 0, v5
v_cmp_le_i32 s[66:67], 1, v5
v_cmp_le_i32 s[68:69], 2, v5
v_cmp_le_i32 s[70:71], 3, v5
v_cmp_le_i32 s[72:73], 8, v5
v_cmp_le_i32 s[74:75], 9, v5
v_cmp_le_i32 s[76:77], 10, v5
v_cmp_le_i32 s[78:79], 11, v5
v_cmp_le_i32 s[80:81], 16, v5
v_cmp_le_i32 s[82:83], 17, v5
v_cmp_le_i32 s[84:85], 18, v5
v_cmp_le_i32 s[86:87], 19, v5
v_cmp_le_i32 s[88:89], 24, v5
v_cmp_le_i32 s[90:91], 25, v5
v_cmp_le_i32 s[92:93], 26, v5
v_cmp_le_i32 s[94:95], 27, v5
L_nb_15:
s_ff1_i32_b64 s47, s[52:53]
s_cmp_lt_u32 s41, 32
s_cbranch_scc1 L_nb_16
s_bitset0_b64 s[52:53], s47
s_sub_u32 s41, s41, 32
s_branch L_nb_15
L_nb_16:
s_lshl_b32 s47, s47, 5
s_add_u32 s47, s47, s41
s_add_u32 s41, s41, 56
s_and_b32 s24, s47, 31
s_lshr_b32 s25, s47, 5
s_lshl_b32 s46, s24, 6
s_add_u32 s46, s46, s25
s_lshl_b32 s46, s46, 14
s_add_u32 s46, s46, 33554432
s_lshr_b32 s44, s24, 1
s_lshl_b32 s44, s44, 6
s_add_u32 s44, s44, s25
s_lshl_b32 s44, s44, 1
s_and_b32 s24, s24, 1
s_add_u32 s44, s44, s24
s_lshl_b32 s44, s44, 13
s_add_u32 s44, s44, 134217728
s_cmp_ge_u32 s47, 2048
s_cselect_b32 s44, 536870912, s44
s_cselect_b32 s46, 536870912, s46
s_cbranch_scc1 L_nb_14
s_lshr_b32 s25, s47, 8
s_lshl_b32 s25, s25, 2
s_cmp_eq_u32 s25, s45
s_cbranch_scc1 L_nb_14
s_mov_b32 s45, s25
s_mov_b32 s28, 0
L_poll_17:
buffer_load_dword v26, v17, s[8:11], s45 offen sc1
s_add_u32 s28, s28, 1
s_cmp_gt_u32 s28, 40000
s_cbranch_scc1 L_end
s_waitcnt vmcnt(0)
v_cmp_ne_u32 vcc, 1, v26
s_cbranch_vccz L_pd_18
s_sleep 8
s_cmp_lt_u32 s28, 32
s_cbranch_scc1 L_poll_17
s_sleep 32
s_branch L_poll_17
L_pd_18:
L_nb_14:
s_cmp_ge_u32 s47, 2048
s_cbranch_scc1 L_bt_x
s_add_u32 s25, s44, 0
buffer_load_dwordx4 a[0:3], v1, s[8:11], s25 offen sc1
buffer_load_dwordx4 a[4:7], v1, s[8:11], s25 offen offset:1024 sc1
buffer_load_dwordx4 a[8:11], v1, s[8:11], s25 offen offset:2048 sc1
buffer_load_dwordx4 a[12:15], v1, s[8:11], s25 offen offset:3072 sc1
s_add_u32 s25, s44, 4096
buffer_load_dwordx4 a[16:19], v1, s[8:11], s25 offen sc1
buffer_load_dwordx4 a[20:23], v1, s[8:11], s25 offen offset:1024 sc1
buffer_load_dwordx4 a[24:27], v1, s[8:11], s25 offen offset:2048 sc1
buffer_load_dwordx4 a[28:31], v1, s[8:11], s25 offen offset:3072 sc1
s_add_u32 s25, s46, 0
buffer_load_dwordx4 a[32:35], v1, s[8:11], s25 offen sc1
buffer_load_dwordx4 a[36:39], v1, s[8:11], s25 offen offset:1024 sc1
buffer_load_dwordx4 a[40:43], v1, s[8:11], s25 offen offset:2048 sc1
buffer_load_dwordx4 a[44:47], v1, s[8:11], s25 offen offset:3072 sc1
s_add_u32 s25, s46, 4096
buffer_load_dwordx4 a[48:51], v1, s[8:11], s25 offen sc1
buffer_load_dwordx4 a[52:55], v1, s[8:11], s25 offen offset:1024 sc1
buffer_load_dwordx4 a[56:59], v1, s[8:11], s25 offen offset:2048 sc1
buffer_load_dwordx4 a[60:63], v1, s[8:11], s25 offen offset:3072 sc1
s_add_u32 s25, s46, 8192
buffer_load_dwordx4 a[64:67], v16, s[8:11], s25 offen sc1
buffer_load_dwordx4 a[68:71], v16, s[8:11], s25 offen offset:1024 sc1
buffer_load_dwordx4 a[72:75], v16, s[8:11], s25 offen offset:2048 sc1
buffer_load_dwordx4 a[76:79], v16, s[8:11], s25 offen offset:3072 sc1
s_add_u32 s25, s46, 12288
buffer_load_dwordx4 a[80:83], v16, s[8:11], s25 offen sc1
buffer_load_dwordx4 a[84:87], v16, s[8:11], s25 offen offset:1024 sc1
buffer_load_dwordx4 a[88:91], v16, s[8:11], s25 offen offset:2048 sc1
buffer_load_dwordx4 a[92:95], v16, s[8:11], s25 offen offset:3072 sc1
s_waitcnt vmcnt(0)
s_mov_b32 s54, 536870912
L_bt:
s_waitcnt vmcnt(8)
v_mfma_f32_32x32x16_bf16 v[32:47], a[32:35], a[0:3], 0
v_mfma_f32_32x32x16_bf16 v[32:47], a[36:39], a[4:7], v[32:47]
v_mfma_f32_32x32x16_bf16 v[32:47], a[40:43], a[8:11], v[32:47]
v_mfma_f32_32x32x16_bf16 v[32:47], a[44:47], a[12:15], v[32:47]
v_mfma_f32_32x32x16_bf16 v[32:47], a[48:51], a[16:19], v[32:47]
v_mfma_f32_32x32x16_bf16 v[32:47], a[52:55], a[20:23], v[32:47]
v_mfma_f32_32x32x16_bf16 v[32:47], a[56:59], a[24:27], v[32:47]
v_mfma_f32_32x32x16_bf16 v[32:47], a[60:63], a[28:31], v[32:47]
s_and_b32 s42, s47, 31
s_lshr_b32 s43, s47, 5
s_lshl_b32 s26, s47, 12
s_add_u32 s26, s26, 100663296
s_nop 7
v_cndmask_b32 v32, v31, v32, s[64:65]
v_cndmask_b32 v33, v31, v33, s[66:67]
v_cndmask_b32 v34, v31, v34, s[68:69]
v_cndmask_b32 v35, v31, v35, s[70:71]
v_cndmask_b32 v36, v31, v36, s[72:73]
v_cndmask_b32 v37, v31, v37, s[74:75]
v_cndmask_b32 v38, v31, v38, s[76:77]
v_cndmask_b32 v39, v31, v39, s[78:79]
v_cndmask_b32 v40, v31, v40, s[80:81]
v_cndmask_b32 v41, v31, v41, s[82:83]
v_cndmask_b32 v42, v31, v42, s[84:85]
v_cndmask_b32 v43, v31, v43, s[86:87]
v_cndmask_b32 v44, v31, v44, s[88:89]
v_cndmask_b32 v45, v31, v45, s[90:91]
v_cndmask_b32 v46, v31, v46, s[92:93]
v_cndmask_b32 v47, v31, v47, s[94:95]
v_max3_f32 v20, v32, v33, v34
v_max3_f32 v20, v20, v35, v36
v_max3_f32 v20, v20, v37, v38
v_max3_f32 v20, v20, v39, v40
v_max3_f32 v20, v20, v41, v42
v_max3_f32 v20, v20, v43, v44
v_max3_f32 v20, v20, v45, v46
v_max_f32 v20, v20, v47
s_cmp_lt_u32 s43, s49
s_cbranch_scc1 L_kn_19
v_mov_b32 v26, 1
s_waitcnt vmcnt(0)
s_mov_b64 exec, 1
buffer_store_dword v26, v4, s[8:11], s54 offen
s_mov_b64 exec, -1
L_nb_22:
s_ff1_i32_b64 s48, s[52:53]
s_cmp_lt_u32 s41, 32
s_cbranch_scc1 L_nb_23
s_bitset0_b64 s[52:53], s48
s_sub_u32 s41, s41, 32
s_branch L_nb_22
L_nb_23:
s_lshl_b32 s48, s48, 5
s_add_u32 s48, s48, s41
s_add_u32 s41, s41, 56
s_and_b32 s24, s48, 31
s_lshr_b32 s25, s48, 5
s_lshl_b32 s46, s24, 6
s_add_u32 s46, s46, s25
s_lshl_b32 s46, s46, 14
s_add_u32 s46, s46, 33554432
s_lshr_b32 s44, s24, 1
s_lshl_b32 s44, s44, 6
s_add_u32 s44, s44, s25
s_lshl_b32 s44, s44, 1
s_and_b32 s24, s24, 1
s_add_u32 s44, s44, s24
s_lshl_b32 s44, s44, 13
s_add_u32 s44, s44, 134217728
s_cmp_ge_u32 s48, 2048
s_cselect_b32 s44, 536870912, s44
s_cselect_b32 s46, 536870912, s46
s_cbranch_scc1 L_nb_21
s_lshr_b32 s25, s48, 8
s_lshl_b32 s25, s25, 2
s_cmp_eq_u32 s25, s45
s_cbranch_scc1 L_nb_21
s_mov_b32 s45, s25
s_mov_b32 s28, 0
L_poll_24:
buffer_load_dword v26, v17, s[8:11], s45 offen sc1
s_add_u32 s28, s28, 1
s_cmp_gt_u32 s28, 40000
s_cbranch_scc1 L_end
s_waitcnt vmcnt(0)
v_cmp_ne_u32 vcc, 1, v26
s_cbranch_vccz L_pd_25
s_sleep 8
s_cmp_lt_u32 s28, 32
s_cbranch_scc1 L_poll_24
s_sleep 32
s_branch L_poll_24
L_pd_25:
L_nb_21:
s_add_u32 s25, s44, 0
buffer_load_dwordx4 a[96:99], v1, s[8:11], s25 offen sc1
buffer_load_dwordx4 a[100:103], v1, s[8:11], s25 offen offset:1024 sc1
buffer_load_dwordx4 a[104:107], v1, s[8:11], s25 offen offset:2048 sc1
buffer_load_dwordx4 a[108:111], v1, s[8:11], s25 offen offset:3072 sc1
s_add_u32 s25, s44, 4096
buffer_load_dwordx4 a[112:115], v1, s[8:11], s25 offen sc1
buffer_load_dwordx4 a[116:119], v1, s[8:11], s25 offen offset:1024 sc1
buffer_load_dwordx4 a[120:123], v1, s[8:11], s25 offen offset:2048 sc1
buffer_load_dwordx4 a[124:127], v1, s[8:11], s25 offen offset:3072 sc1
s_add_u32 s25, s46, 0
buffer_load_dwordx4 a[128:131], v1, s[8:11], s25 offen sc1
buffer_load_dwordx4 a[132:135], v1, s[8:11], s25 offen offset:1024 sc1
buffer_load_dwordx4 a[136:139], v1, s[8:11], s25 offen offset:2048 sc1
buffer_load_dwordx4 a[140:143], v1, s[8:11], s25 offen offset:3072 sc1
s_add_u32 s25, s46, 4096
buffer_load_dwordx4 a[144:147], v1, s[8:11], s25 offen sc1
buffer_load_dwordx4 a[148:151], v1, s[8:11], s25 offen offset:1024 sc1
buffer_load_dwordx4 a[152:155], v1, s[8:11], s25 offen offset:2048 sc1
buffer_load_dwordx4 a[156:159], v1, s[8:11], s25 offen offset:3072 sc1
s_add_u32 s25, s46, 8192
buffer_load_dwordx4 a[160:163], v16, s[8:11], s25 offen sc1
buffer_load_dwordx4 a[164:167], v16, s[8:11], s25 offen offset:1024 sc1
buffer_load_dwordx4 a[168:171], v16, s[8:11], s25 offen offset:2048 sc1
buffer_load_dwordx4 a[172:175], v16, s[8:11], s25 offen offset:3072 sc1
s_add_u32 s25, s46, 12288
buffer_load_dwordx4 a[176:179], v16, s[8:11], s25 offen sc1
buffer_load_dwordx4 a[180:183], v16, s[8:11], s25 offen offset:1024 sc1
buffer_load_dwordx4 a[184:187], v16, s[8:11], s25 offen offset:2048 sc1
buffer_load_dwordx4 a[188:191], v16, s[8:11], s25 offen offset:3072 sc1
s_lshl_b32 s25, s42, 7
s_add_u32 s25, s25, 111153152
s_mov_b32 s28, 0
L_poll_26:
buffer_load_dword v26, v4, s[8:11], s25 offen sc1
s_add_u32 s28, s28, 1
s_cmp_gt_u32 s28, 40000
s_cbranch_scc1 L_end
s_waitcnt vmcnt(0)
v_cmp_ge_u32 vcc, s43, v26
s_cbranch_vccz L_pd_27
s_sleep 1
s_cmp_lt_u32 s28, 32
s_cbranch_scc1 L_poll_26
s_sleep 32
s_branch L_poll_26
L_pd_27:
buffer_load_dwordx4 v[96:99], v2, s[8:11], s26 offen sc1
buffer_load_dwordx4 v[100:103], v7, s[8:11], s26 offen offset:256 sc1
buffer_load_dwordx4 v[104:107], v2, s[8:11], s26 offen offset:512 sc1
buffer_load_dwordx4 v[108:111], v7, s[8:11], s26 offen offset:768 sc1
buffer_load_dwordx4 v[112:115], v2, s[8:11], s26 offen offset:1024 sc1
buffer_load_dwordx4 v[116:119], v7, s[8:11], s26 offen offset:1280 sc1
buffer_load_dwordx4 v[120:123], v2, s[8:11], s26 offen offset:1536 sc1
buffer_load_dwordx4 v[124:127], v7, s[8:11], s26 offen offset:1792 sc1
buffer_load_dword v8, v3, s[8:11], s26 offen offset:2048 sc1
buffer_load_dword v9, v3, s[8:11], s26 offen offset:2176 sc1
buffer_load_dword v10, v3, s[8:11], s26 offen offset:2560 sc1
buffer_load_dword v11, v3, s[8:11], s26 offen offset:2688 sc1
buffer_load_dword v12, v3, s[8:11], s26 offen offset:3072 sc1
buffer_load_dword v13, v3, s[8:11], s26 offen offset:3200 sc1
buffer_load_dword v14, v3, s[8:11], s26 offen offset:3584 sc1
buffer_load_dword v15, v3, s[8:11], s26 offen offset:3712 sc1
v_readfirstlane_b32 s49, v26
s_nop 0
s_min_u32 s49, s49, 63
s_sub_u32 s49, s49, 1
s_waitcnt vmcnt(15)
v_mfma_f32_32x32x16_bf16 v[64:79], v[96:99], a[0:3], 0
s_waitcnt vmcnt(14)
v_mfma_f32_32x32x16_bf16 v[64:79], v[100:103], a[4:7], v[64:79]
s_waitcnt vmcnt(13)
v_mfma_f32_32x32x16_bf16 v[64:79], v[104:107], a[8:11], v[64:79]
s_waitcnt vmcnt(12)
v_mfma_f32_32x32x16_bf16 v[64:79], v[108:111], a[12:15], v[64:79]
s_waitcnt vmcnt(11)
v_mfma_f32_32x32x16_bf16 v[64:79], v[112:115], a[16:19], v[64:79]
s_waitcnt vmcnt(10)
v_mfma_f32_32x32x16_bf16 v[64:79], v[116:119], a[20:23], v[64:79]
s_waitcnt vmcnt(9)
v_mfma_f32_32x32x16_bf16 v[64:79], v[120:123], a[24:27], v[64:79]
s_waitcnt vmcnt(8)
v_mfma_f32_32x32x16_bf16 v[64:79], v[124:127], a[28:31], v[64:79]
s_waitcnt vmcnt(0)
s_branch L_kj_20
L_kn_19:
buffer_load_dwordx4 v[96:99], v2, s[8:11], s26 offen sc1
buffer_load_dwordx4 v[100:103], v7, s[8:11], s26 offen offset:256 sc1
buffer_load_dwordx4 v[104:107], v2, s[8:11], s26 offen offset:512 sc1
buffer_load_dwordx4 v[108:111], v7, s[8:11], s26 offen offset:768 sc1
buffer_load_dwordx4 v[112:115], v2, s[8:11], s26 offen offset:1024 sc1
buffer_load_dwordx4 v[116:119], v7, s[8:11], s26 offen offset:1280 sc1
buffer_load_dwordx4 v[120:123], v2, s[8:11], s26 offen offset:1536 sc1
buffer_load_dwordx4 v[124:127], v7, s[8:11], s26 offen offset:1792 sc1
buffer_load_dword v8, v3, s[8:11], s26 offen offset:2048 sc1
buffer_load_dword v9, v3, s[8:11], s26 offen offset:2176 sc1
buffer_load_dword v10, v3, s[8:11], s26 offen offset:2560 sc1
buffer_load_dword v11, v3, s[8:11], s26 offen offset:2688 sc1
buffer_load_dword v12, v3, s[8:11], s26 offen offset:3072 sc1
buffer_load_dword v13, v3, s[8:11], s26 offen offset:3200 sc1
buffer_load_dword v14, v3, s[8:11], s26 offen offset:3584 sc1
buffer_load_dword v15, v3, s[8:11], s26 offen offset:3712 sc1
v_mov_b32 v26, 1
s_waitcnt vmcnt(16)
s_mov_b64 exec, 1
buffer_store_dword v26, v4, s[8:11], s54 offen
s_mov_b64 exec, -1
L_nb_29:
s_ff1_i32_b64 s48, s[52:53]
s_cmp_lt_u32 s41, 32
s_cbranch_scc1 L_nb_30
s_bitset0_b64 s[52:53], s48
s_sub_u32 s41, s41, 32
s_branch L_nb_29
L_nb_30:
s_lshl_b32 s48, s48, 5
s_add_u32 s48, s48, s41
s_add_u32 s41, s41, 56
s_and_b32 s24, s48, 31
s_lshr_b32 s25, s48, 5
s_lshl_b32 s46, s24, 6
s_add_u32 s46, s46, s25
s_lshl_b32 s46, s46, 14
s_add_u32 s46, s46, 33554432
s_lshr_b32 s44, s24, 1
s_lshl_b32 s44, s44, 6
s_add_u32 s44, s44, s25
s_lshl_b32 s44, s44, 1
s_and_b32 s24, s24, 1
s_add_u32 s44, s44, s24
s_lshl_b32 s44, s44, 13
s_add_u32 s44, s44, 134217728
s_cmp_ge_u32 s48, 2048
s_cselect_b32 s44, 536870912, s44
s_cselect_b32 s46, 536870912, s46
s_cbranch_scc1 L_nb_28
s_lshr_b32 s25, s48, 8
s_lshl_b32 s25, s25, 2
s_cmp_eq_u32 s25, s45
s_cbranch_scc1 L_nb_28
s_mov_b32 s45, s25
s_mov_b32 s28, 0
L_poll_31:
buffer_load_dword v26, v17, s[8:11], s45 offen sc1
s_add_u32 s28, s28, 1
s_cmp_gt_u32 s28, 40000
s_cbranch_scc1 L_end
s_waitcnt vmcnt(0)
v_cmp_ne_u32 vcc, 1, v26
s_cbranch_vccz L_pd_32
s_sleep 8
s_cmp_lt_u32 s28, 32
s_cbranch_scc1 L_poll_31
s_sleep 32
s_branch L_poll_31
L_pd_32:
L_nb_28:
s_add_u32 s25, s44, 0
buffer_load_dwordx4 a[96:99], v1, s[8:11], s25 offen sc1
buffer_load_dwordx4 a[100:103], v1, s[8:11], s25 offen offset:1024 sc1
buffer_load_dwordx4 a[104:107], v1, s[8:11], s25 offen offset:2048 sc1
buffer_load_dwordx4 a[108:111], v1, s[8:11], s25 offen offset:3072 sc1
s_add_u32 s25, s44, 4096
buffer_load_dwordx4 a[112:115], v1, s[8:11], s25 offen sc1
buffer_load_dwordx4 a[116:119], v1, s[8:11], s25 offen offset:1024 sc1
buffer_load_dwordx4 a[120:123], v1, s[8:11], s25 offen offset:2048 sc1
buffer_load_dwordx4 a[124:127], v1, s[8:11], s25 offen offset:3072 sc1
s_waitcnt vmcnt(24)
v_mfma_f32_32x32x16_bf16 v[64:79], v[96:99], a[0:3], 0
s_add_u32 s25, s46, 0
buffer_load_dwordx4 a[128:131], v1, s[8:11], s25 offen sc1
buffer_load_dwordx4 a[132:135], v1, s[8:11], s25 offen offset:1024 sc1
s_waitcnt vmcnt(25)
v_mfma_f32_32x32x16_bf16 v[64:79], v[100:103], a[4:7], v[64:79]
buffer_load_dwordx4 a[136:139], v1, s[8:11], s25 offen offset:2048 sc1
buffer_load_dwordx4 a[140:143], v1, s[8:11], s25 offen offset:3072 sc1
s_waitcnt vmcnt(26)
v_mfma_f32_32x32x16_bf16 v[64:79], v[104:107], a[8:11], v[64:79]
s_add_u32 s25, s46, 4096
buffer_load_dwordx4 a[144:147], v1, s[8:11], s25 offen sc1
buffer_load_dwordx4 a[148:151], v1, s[8:11], s25 offen offset:1024 sc1
s_waitcnt vmcnt(27)
v_mfma_f32_32x32x16_bf16 v[64:79], v[108:111], a[12:15], v[64:79]
buffer_load_dwordx4 a[152:155], v1, s[8:11], s25 offen offset:2048 sc1
buffer_load_dwordx4 a[156:159], v1, s[8:11], s25 offen offset:3072 sc1
s_waitcnt vmcnt(28)
v_mfma_f32_32x32x16_bf16 v[64:79], v[112:115], a[16:19], v[64:79]
s_add_u32 s25, s46, 8192
buffer_load_dwordx4 a[160:163], v16, s[8:11], s25 offen sc1
buffer_load_dwordx4 a[164:167], v16, s[8:11], s25 offen offset:1024 sc1
s_waitcnt vmcnt(29)
v_mfma_f32_32x32x16_bf16 v[64:79], v[116:119], a[20:23], v[64:79]
buffer_load_dwordx4 a[168:171], v16, s[8:11], s25 offen offset:2048 sc1
buffer_load_dwordx4 a[172:175], v16, s[8:11], s25 offen offset:3072 sc1
s_waitcnt vmcnt(30)
v_mfma_f32_32x32x16_bf16 v[64:79], v[120:123], a[24:27], v[64:79]
s_add_u32 s25, s46, 12288
buffer_load_dwordx4 a[176:179], v16, s[8:11], s25 offen sc1
buffer_load_dwordx4 a[180:183], v16, s[8:11], s25 offen offset:1024 sc1
s_waitcnt vmcnt(31)
v_mfma_f32_32x32x16_bf16 v[64:79], v[124:127], a[28:31], v[64:79]
buffer_load_dwordx4 a[184:187], v16, s[8:11], s25 offen offset:2048 sc1
buffer_load_dwordx4 a[188:191], v16, s[8:11], s25 offen offset:3072 sc1
s_waitcnt vmcnt(25)
L_kj_20:
s_nop 9
v_max3_f32 v20, v20, v64, v65
v_max3_f32 v20, v20, v66, v67
v_mov_b32 v26, v20
s_nop 1
v_permlane32_swap_b32 v26, v20
v_max_f32 v20, v20, v26
v_mul_f32 v20, s40, v20
v_pk_fma_f32 v[64:65], v[64:65], s[40:41], v[20:21] op_sel_hi:[1,0,0] neg_lo:[0,0,1] neg_hi:[0,0,1]
v_pk_fma_f32 v[66:67], v[66:67], s[40:41], v[20:21] op_sel_hi:[1,0,0] neg_lo:[0,0,1] neg_hi:[0,0,1]
v_pk_fma_f32 v[32:33], v[32:33], s[40:41], v[20:21] op_sel_hi:[1,0,0] neg_lo:[0,0,1] neg_hi:[0,0,1]
v_pk_fma_f32 v[34:35], v[34:35], s[40:41], v[20:21] op_sel_hi:[1,0,0] neg_lo:[0,0,1] neg_hi:[0,0,1]
v_pk_fma_f32 v[36:37], v[36:37], s[40:41], v[20:21] op_sel_hi:[1,0,0] neg_lo:[0,0,1] neg_hi:[0,0,1]
v_pk_fma_f32 v[38:39], v[38:39], s[40:41], v[20:21] op_sel_hi:[1,0,0] neg_lo:[0,0,1] neg_hi:[0,0,1]
v_pk_fma_f32 v[40:41], v[40:41], s[40:41], v[20:21] op_sel_hi:[1,0,0] neg_lo:[0,0,1] neg_hi:[0,0,1]
v_pk_fma_f32 v[42:43], v[42:43], s[40:41], v[20:21] op_sel_hi:[1,0,0] neg_lo:[0,0,1] neg_hi:[0,0,1]
v_pk_fma_f32 v[44:45], v[44:45], s[40:41], v[20:21] op_sel_hi:[1,0,0] neg_lo:[0,0,1] neg_hi:[0,0,1]
v_pk_fma_f32 v[46:47], v[46:47], s[40:41], v[20:21] op_sel_hi:[1,0,0] neg_lo:[0,0,1] neg_hi:[0,0,1]
v_exp_f32 v64, v64
v_exp_f32 v65, v65
v_exp_f32 v66, v66
v_exp_f32 v67, v67
v_exp_f32 v32, v32
v_exp_f32 v33, v33
v_cvt_pk_bf16_f32 v88, v64, v65
v_cvt_pk_bf16_f32 v89, v66, v67
s_nop 1
v_mfma_f32_32x32x8_bf16 v[128:143], v[8:9], v[88:89], 0
v_exp_f32 v34, v34
v_exp_f32 v35, v35
v_exp_f32 v36, v36
v_mfma_f32_32x32x8_bf16 v[160:175], v[10:11], v[88:89], 0
v_exp_f32 v37, v37
v_exp_f32 v38, v38
v_mfma_f32_32x32x8_bf16 v[192:207], v[12:13], v[88:89], 0
v_exp_f32 v39, v39
v_exp_f32 v40, v40
v_exp_f32 v41, v41
v_mfma_f32_32x32x8_bf16 v[224:239], v[14:15], v[88:89], 0
v_cvt_pk_bf16_f32 v80, v32, v33
v_cvt_pk_bf16_f32 v81, v34, v35
v_cvt_pk_bf16_f32 v82, v36, v37
v_cvt_pk_bf16_f32 v83, v38, v39
s_nop 1
v_mfma_f32_32x32x16_bf16 v[128:143], a[64:67], v[80:83], v[128:143]
v_exp_f32 v42, v42
v_exp_f32 v43, v43
v_exp_f32 v44, v44
v_mfma_f32_32x32x16_bf16 v[160:175], a[72:75], v[80:83], v[160:175]
v_exp_f32 v45, v45
v_exp_f32 v46, v46
v_mfma_f32_32x32x16_bf16 v[192:207], a[80:83], v[80:83], v[192:207]
v_exp_f32 v47, v47
v_add_f32 v22, v64, v65
v_add_f32 v22, v22, v66
v_add_f32 v22, v22, v67
v_add_f32 v22, v22, v32
v_mfma_f32_32x32x16_bf16 v[224:239], a[88:91], v[80:83], v[224:239]
v_add_f32 v22, v22, v33
v_cvt_pk_bf16_f32 v84, v40, v41
v_cvt_pk_bf16_f32 v85, v42, v43
v_cvt_pk_bf16_f32 v86, v44, v45
v_cvt_pk_bf16_f32 v87, v46, v47
s_nop 1
v_mfma_f32_32x32x16_bf16 v[128:143], a[68:71], v[84:87], v[128:143]
v_add_f32 v22, v22, v34
v_add_f32 v22, v22, v35
v_add_f32 v22, v22, v36
v_add_f32 v22, v22, v37
v_add_f32 v22, v22, v38
v_mfma_f32_32x32x16_bf16 v[160:175], a[76:79], v[84:87], v[160:175]
v_add_f32 v22, v22, v39
v_add_f32 v22, v22, v40
v_add_f32 v22, v22, v41
v_add_f32 v22, v22, v42
v_mfma_f32_32x32x16_bf16 v[192:207], a[84:87], v[84:87], v[192:207]
v_add_f32 v22, v22, v43
v_add_f32 v22, v22, v44
v_add_f32 v22, v22, v45
v_add_f32 v22, v22, v46
v_add_f32 v22, v22, v47
v_mfma_f32_32x32x16_bf16 v[224:239], a[92:95], v[84:87], v[224:239]
s_lshl_b32 s26, s43, 18
s_lshl_b32 s27, s42, 12
s_add_u32 s26, s26, s27
s_add_u32 s26, s26, 83886080
v_mov_b32 v26, v22
s_nop 1
v_permlane32_swap_b32 v26, v22
v_add_f32 v26, v26, v22
v_rcp_f32 v26, v26
s_nop 0
v_pk_mul_f32 v[128:129], v[128:129], v[26:27] op_sel_hi:[1,0]
v_pk_mul_f32 v[130:131], v[130:131], v[26:27] op_sel_hi:[1,0]
v_pk_mul_f32 v[132:133], v[132:133], v[26:27] op_sel_hi:[1,0]
v_pk_mul_f32 v[134:135], v[134:135], v[26:27] op_sel_hi:[1,0]
v_pk_mul_f32 v[136:137], v[136:137], v[26:27] op_sel_hi:[1,0]
v_pk_mul_f32 v[138:139], v[138:139], v[26:27] op_sel_hi:[1,0]
v_pk_mul_f32 v[140:141], v[140:141], v[26:27] op_sel_hi:[1,0]
v_pk_mul_f32 v[142:143], v[142:143], v[26:27] op_sel_hi:[1,0]
v_cvt_pk_bf16_f32 v128, v128, v129
v_cvt_pk_bf16_f32 v129, v130, v131
v_cvt_pk_bf16_f32 v130, v132, v133
v_cvt_pk_bf16_f32 v131, v134, v135
buffer_store_dwordx4 v[128:131], v6, s[8:11], s26 offen
v_cvt_pk_bf16_f32 v136, v136, v137
v_cvt_pk_bf16_f32 v137, v138, v139
v_cvt_pk_bf16_f32 v138, v140, v141
v_cvt_pk_bf16_f32 v139, v142, v143
buffer_store_dwordx4 v[136:139], v6, s[8:11], s26 offen offset:512
v_pk_mul_f32 v[160:161], v[160:161], v[26:27] op_sel_hi:[1,0]
v_pk_mul_f32 v[162:163], v[162:163], v[26:27] op_sel_hi:[1,0]
v_pk_mul_f32 v[164:165], v[164:165], v[26:27] op_sel_hi:[1,0]
v_pk_mul_f32 v[166:167], v[166:167], v[26:27] op_sel_hi:[1,0]
v_pk_mul_f32 v[168:169], v[168:169], v[26:27] op_sel_hi:[1,0]
v_pk_mul_f32 v[170:171], v[170:171], v[26:27] op_sel_hi:[1,0]
v_pk_mul_f32 v[172:173], v[172:173], v[26:27] op_sel_hi:[1,0]
v_pk_mul_f32 v[174:175], v[174:175], v[26:27] op_sel_hi:[1,0]
v_cvt_pk_bf16_f32 v160, v160, v161
v_cvt_pk_bf16_f32 v161, v162, v163
v_cvt_pk_bf16_f32 v162, v164, v165
v_cvt_pk_bf16_f32 v163, v166, v167
buffer_store_dwordx4 v[160:163], v6, s[8:11], s26 offen offset:1024
v_cvt_pk_bf16_f32 v168, v168, v169
v_cvt_pk_bf16_f32 v169, v170, v171
v_cvt_pk_bf16_f32 v170, v172, v173
v_cvt_pk_bf16_f32 v171, v174, v175
buffer_store_dwordx4 v[168:171], v6, s[8:11], s26 offen offset:1536
v_pk_mul_f32 v[192:193], v[192:193], v[26:27] op_sel_hi:[1,0]
v_pk_mul_f32 v[194:195], v[194:195], v[26:27] op_sel_hi:[1,0]
v_pk_mul_f32 v[196:197], v[196:197], v[26:27] op_sel_hi:[1,0]
v_pk_mul_f32 v[198:199], v[198:199], v[26:27] op_sel_hi:[1,0]
v_pk_mul_f32 v[200:201], v[200:201], v[26:27] op_sel_hi:[1,0]
v_pk_mul_f32 v[202:203], v[202:203], v[26:27] op_sel_hi:[1,0]
v_pk_mul_f32 v[204:205], v[204:205], v[26:27] op_sel_hi:[1,0]
v_pk_mul_f32 v[206:207], v[206:207], v[26:27] op_sel_hi:[1,0]
v_cvt_pk_bf16_f32 v192, v192, v193
v_cvt_pk_bf16_f32 v193, v194, v195
v_cvt_pk_bf16_f32 v194, v196, v197
v_cvt_pk_bf16_f32 v195, v198, v199
buffer_store_dwordx4 v[192:195], v6, s[8:11], s26 offen offset:2048
v_cvt_pk_bf16_f32 v200, v200, v201
v_cvt_pk_bf16_f32 v201, v202, v203
v_cvt_pk_bf16_f32 v202, v204, v205
v_cvt_pk_bf16_f32 v203, v206, v207
buffer_store_dwordx4 v[200:203], v6, s[8:11], s26 offen offset:2560
v_pk_mul_f32 v[224:225], v[224:225], v[26:27] op_sel_hi:[1,0]
v_pk_mul_f32 v[226:227], v[226:227], v[26:27] op_sel_hi:[1,0]
v_pk_mul_f32 v[228:229], v[228:229], v[26:27] op_sel_hi:[1,0]
v_pk_mul_f32 v[230:231], v[230:231], v[26:27] op_sel_hi:[1,0]
v_pk_mul_f32 v[232:233], v[232:233], v[26:27] op_sel_hi:[1,0]
v_pk_mul_f32 v[234:235], v[234:235], v[26:27] op_sel_hi:[1,0]
v_pk_mul_f32 v[236:237], v[236:237], v[26:27] op_sel_hi:[1,0]
v_pk_mul_f32 v[238:239], v[238:239], v[26:27] op_sel_hi:[1,0]
v_cvt_pk_bf16_f32 v224, v224, v225
v_cvt_pk_bf16_f32 v225, v226, v227
v_cvt_pk_bf16_f32 v226, v228, v229
v_cvt_pk_bf16_f32 v227, v230, v231
buffer_store_dwordx4 v[224:227], v6, s[8:11], s26 offen offset:3072
v_cvt_pk_bf16_f32 v232, v232, v233
v_cvt_pk_bf16_f32 v233, v234, v235
v_cvt_pk_bf16_f32 v234, v236, v237
v_cvt_pk_bf16_f32 v235, v238, v239
buffer_store_dwordx4 v[232:235], v6, s[8:11], s26 offen offset:3584
s_lshl_b32 s54, s47, 2
s_add_u32 s54, s54, 111157248
s_mov_b32 s47, s48
s_cmp_lt_u32 s47, 2048
s_cbranch_scc0 L_bt_f
s_waitcnt vmcnt(8)
v_mfma_f32_32x32x16_bf16 v[32:47], a[128:131], a[96:99], 0
v_mfma_f32_32x32x16_bf16 v[32:47], a[132:135], a[100:103], v[32:47]
v_mfma_f32_32x32x16_bf16 v[32:47], a[136:139], a[104:107], v[32:47]
v_mfma_f32_32x32x16_bf16 v[32:47], a[140:143], a[108:111], v[32:47]
v_mfma_f32_32x32x16_bf16 v[32:47], a[144:147], a[112:115], v[32:47]
v_mfma_f32_32x32x16_bf16 v[32:47], a[148:151], a[116:119], v[32:47]
v_mfma_f32_32x32x16_bf16 v[32:47], a[152:155], a[120:123], v[32:47]
v_mfma_f32_32x32x16_bf16 v[32:47], a[156:159], a[124:127], v[32:47]
s_and_b32 s42, s47, 31
s_lshr_b32 s43, s47, 5
s_lshl_b32 s26, s47, 12
s_add_u32 s26, s26, 100663296
s_nop 7
v_cndmask_b32 v32, v31, v32, s[64:65]
v_cndmask_b32 v33, v31, v33, s[66:67]
v_cndmask_b32 v34, v31, v34, s[68:69]
v_cndmask_b32 v35, v31, v35, s[70:71]
v_cndmask_b32 v36, v31, v36, s[72:73]
v_cndmask_b32 v37, v31, v37, s[74:75]
v_cndmask_b32 v38, v31, v38, s[76:77]
v_cndmask_b32 v39, v31, v39, s[78:79]
v_cndmask_b32 v40, v31, v40, s[80:81]
v_cndmask_b32 v41, v31, v41, s[82:83]
v_cndmask_b32 v42, v31, v42, s[84:85]
v_cndmask_b32 v43, v31, v43, s[86:87]
v_cndmask_b32 v44, v31, v44, s[88:89]
v_cndmask_b32 v45, v31, v45, s[90:91]
v_cndmask_b32 v46, v31, v46, s[92:93]
v_cndmask_b32 v47, v31, v47, s[94:95]
v_max3_f32 v20, v32, v33, v34
v_max3_f32 v20, v20, v35, v36
v_max3_f32 v20, v20, v37, v38
v_max3_f32 v20, v20, v39, v40
v_max3_f32 v20, v20, v41, v42
v_max3_f32 v20, v20, v43, v44
v_max3_f32 v20, v20, v45, v46
v_max_f32 v20, v20, v47
s_cmp_lt_u32 s43, s49
s_cbranch_scc1 L_kn_33
v_mov_b32 v26, 1
s_waitcnt vmcnt(0)
s_mov_b64 exec, 1
buffer_store_dword v26, v4, s[8:11], s54 offen
s_mov_b64 exec, -1
L_nb_36:
s_ff1_i32_b64 s48, s[52:53]
s_cmp_lt_u32 s41, 32
s_cbranch_scc1 L_nb_37
s_bitset0_b64 s[52:53], s48
s_sub_u32 s41, s41, 32
s_branch L_nb_36
L_nb_37:
s_lshl_b32 s48, s48, 5
s_add_u32 s48, s48, s41
s_add_u32 s41, s41, 56
s_and_b32 s24, s48, 31
s_lshr_b32 s25, s48, 5
s_lshl_b32 s46, s24, 6
s_add_u32 s46, s46, s25
s_lshl_b32 s46, s46, 14
s_add_u32 s46, s46, 33554432
s_lshr_b32 s44, s24, 1
s_lshl_b32 s44, s44, 6
s_add_u32 s44, s44, s25
s_lshl_b32 s44, s44, 1
s_and_b32 s24, s24, 1
s_add_u32 s44, s44, s24
s_lshl_b32 s44, s44, 13
s_add_u32 s44, s44, 134217728
s_cmp_ge_u32 s48, 2048
s_cselect_b32 s44, 536870912, s44
s_cselect_b32 s46, 536870912, s46
s_cbranch_scc1 L_nb_35
s_lshr_b32 s25, s48, 8
s_lshl_b32 s25, s25, 2
s_cmp_eq_u32 s25, s45
s_cbranch_scc1 L_nb_35
s_mov_b32 s45, s25
s_mov_b32 s28, 0
L_poll_38:
buffer_load_dword v26, v17, s[8:11], s45 offen sc1
s_add_u32 s28, s28, 1
s_cmp_gt_u32 s28, 40000
s_cbranch_scc1 L_end
s_waitcnt vmcnt(0)
v_cmp_ne_u32 vcc, 1, v26
s_cbranch_vccz L_pd_39
s_sleep 8
s_cmp_lt_u32 s28, 32
s_cbranch_scc1 L_poll_38
s_sleep 32
s_branch L_poll_38
L_pd_39:
L_nb_35:
s_add_u32 s25, s44, 0
buffer_load_dwordx4 a[0:3], v1, s[8:11], s25 offen sc1
buffer_load_dwordx4 a[4:7], v1, s[8:11], s25 offen offset:1024 sc1
buffer_load_dwordx4 a[8:11], v1, s[8:11], s25 offen offset:2048 sc1
buffer_load_dwordx4 a[12:15], v1, s[8:11], s25 offen offset:3072 sc1
s_add_u32 s25, s44, 4096
buffer_load_dwordx4 a[16:19], v1, s[8:11], s25 offen sc1
buffer_load_dwordx4 a[20:23], v1, s[8:11], s25 offen offset:1024 sc1
buffer_load_dwordx4 a[24:27], v1, s[8:11], s25 offen offset:2048 sc1
buffer_load_dwordx4 a[28:31], v1, s[8:11], s25 offen offset:3072 sc1
s_add_u32 s25, s46, 0
buffer_load_dwordx4 a[32:35], v1, s[8:11], s25 offen sc1
buffer_load_dwordx4 a[36:39], v1, s[8:11], s25 offen offset:1024 sc1
buffer_load_dwordx4 a[40:43], v1, s[8:11], s25 offen offset:2048 sc1
buffer_load_dwordx4 a[44:47], v1, s[8:11], s25 offen offset:3072 sc1
s_add_u32 s25, s46, 4096
buffer_load_dwordx4 a[48:51], v1, s[8:11], s25 offen sc1
buffer_load_dwordx4 a[52:55], v1, s[8:11], s25 offen offset:1024 sc1
buffer_load_dwordx4 a[56:59], v1, s[8:11], s25 offen offset:2048 sc1
buffer_load_dwordx4 a[60:63], v1, s[8:11], s25 offen offset:3072 sc1
s_add_u32 s25, s46, 8192
buffer_load_dwordx4 a[64:67], v16, s[8:11], s25 offen sc1
buffer_load_dwordx4 a[68:71], v16, s[8:11], s25 offen offset:1024 sc1
buffer_load_dwordx4 a[72:75], v16, s[8:11], s25 offen offset:2048 sc1
buffer_load_dwordx4 a[76:79], v16, s[8:11], s25 offen offset:3072 sc1
s_add_u32 s25, s46, 12288
buffer_load_dwordx4 a[80:83], v16, s[8:11], s25 offen sc1
buffer_load_dwordx4 a[84:87], v16, s[8:11], s25 offen offset:1024 sc1
buffer_load_dwordx4 a[88:91], v16, s[8:11], s25 offen offset:2048 sc1
buffer_load_dwordx4 a[92:95], v16, s[8:11], s25 offen offset:3072 sc1
s_lshl_b32 s25, s42, 7
s_add_u32 s25, s25, 111153152
s_mov_b32 s28, 0
L_poll_40:
buffer_load_dword v26, v4, s[8:11], s25 offen sc1
s_add_u32 s28, s28, 1
s_cmp_gt_u32 s28, 40000
s_cbranch_scc1 L_end
s_waitcnt vmcnt(0)
v_cmp_ge_u32 vcc, s43, v26
s_cbranch_vccz L_pd_41
s_sleep 1
s_cmp_lt_u32 s28, 32
s_cbranch_scc1 L_poll_40
s_sleep 32
s_branch L_poll_40
L_pd_41:
buffer_load_dwordx4 v[96:99], v2, s[8:11], s26 offen sc1
buffer_load_dwordx4 v[100:103], v7, s[8:11], s26 offen offset:256 sc1
buffer_load_dwordx4 v[104:107], v2, s[8:11], s26 offen offset:512 sc1
buffer_load_dwordx4 v[108:111], v7, s[8:11], s26 offen offset:768 sc1
buffer_load_dwordx4 v[112:115], v2, s[8:11], s26 offen offset:1024 sc1
buffer_load_dwordx4 v[116:119], v7, s[8:11], s26 offen offset:1280 sc1
buffer_load_dwordx4 v[120:123], v2, s[8:11], s26 offen offset:1536 sc1
buffer_load_dwordx4 v[124:127], v7, s[8:11], s26 offen offset:1792 sc1
buffer_load_dword v8, v3, s[8:11], s26 offen offset:2048 sc1
buffer_load_dword v9, v3, s[8:11], s26 offen offset:2176 sc1
buffer_load_dword v10, v3, s[8:11], s26 offen offset:2560 sc1
buffer_load_dword v11, v3, s[8:11], s26 offen offset:2688 sc1
buffer_load_dword v12, v3, s[8:11], s26 offen offset:3072 sc1
buffer_load_dword v13, v3, s[8:11], s26 offen offset:3200 sc1
buffer_load_dword v14, v3, s[8:11], s26 offen offset:3584 sc1
buffer_load_dword v15, v3, s[8:11], s26 offen offset:3712 sc1
v_readfirstlane_b32 s49, v26
s_nop 0
s_min_u32 s49, s49, 63
s_sub_u32 s49, s49, 1
s_waitcnt vmcnt(15)
v_mfma_f32_32x32x16_bf16 v[64:79], v[96:99], a[96:99], 0
s_waitcnt vmcnt(14)
v_mfma_f32_32x32x16_bf16 v[64:79], v[100:103], a[100:103], v[64:79]
s_waitcnt vmcnt(13)
v_mfma_f32_32x32x16_bf16 v[64:79], v[104:107], a[104:107], v[64:79]
s_waitcnt vmcnt(12)
v_mfma_f32_32x32x16_bf16 v[64:79], v[108:111], a[108:111], v[64:79]
s_waitcnt vmcnt(11)
v_mfma_f32_32x32x16_bf16 v[64:79], v[112:115], a[112:115], v[64:79]
s_waitcnt vmcnt(10)
v_mfma_f32_32x32x16_bf16 v[64:79], v[116:119], a[116:119], v[64:79]
s_waitcnt vmcnt(9)
v_mfma_f32_32x32x16_bf16 v[64:79], v[120:123], a[120:123], v[64:79]
s_waitcnt vmcnt(8)
v_mfma_f32_32x32x16_bf16 v[64:79], v[124:127], a[124:127], v[64:79]
s_waitcnt vmcnt(0)
s_branch L_kj_34
L_kn_33:
buffer_load_dwordx4 v[96:99], v2, s[8:11], s26 offen sc1
buffer_load_dwordx4 v[100:103], v7, s[8:11], s26 offen offset:256 sc1
buffer_load_dwordx4 v[104:107], v2, s[8:11], s26 offen offset:512 sc1
buffer_load_dwordx4 v[108:111], v7, s[8:11], s26 offen offset:768 sc1
buffer_load_dwordx4 v[112:115], v2, s[8:11], s26 offen offset:1024 sc1
buffer_load_dwordx4 v[116:119], v7, s[8:11], s26 offen offset:1280 sc1
buffer_load_dwordx4 v[120:123], v2, s[8:11], s26 offen offset:1536 sc1
buffer_load_dwordx4 v[124:127], v7, s[8:11], s26 offen offset:1792 sc1
buffer_load_dword v8, v3, s[8:11], s26 offen offset:2048 sc1
buffer_load_dword v9, v3, s[8:11], s26 offen offset:2176 sc1
buffer_load_dword v10, v3, s[8:11], s26 offen offset:2560 sc1
buffer_load_dword v11, v3, s[8:11], s26 offen offset:2688 sc1
buffer_load_dword v12, v3, s[8:11], s26 offen offset:3072 sc1
buffer_load_dword v13, v3, s[8:11], s26 offen offset:3200 sc1
buffer_load_dword v14, v3, s[8:11], s26 offen offset:3584 sc1
buffer_load_dword v15, v3, s[8:11], s26 offen offset:3712 sc1
v_mov_b32 v26, 1
s_waitcnt vmcnt(16)
s_mov_b64 exec, 1
buffer_store_dword v26, v4, s[8:11], s54 offen
s_mov_b64 exec, -1
L_nb_43:
s_ff1_i32_b64 s48, s[52:53]
s_cmp_lt_u32 s41, 32
s_cbranch_scc1 L_nb_44
s_bitset0_b64 s[52:53], s48
s_sub_u32 s41, s41, 32
s_branch L_nb_43
L_nb_44:
s_lshl_b32 s48, s48, 5
s_add_u32 s48, s48, s41
s_add_u32 s41, s41, 56
s_and_b32 s24, s48, 31
s_lshr_b32 s25, s48, 5
s_lshl_b32 s46, s24, 6
s_add_u32 s46, s46, s25
s_lshl_b32 s46, s46, 14
s_add_u32 s46, s46, 33554432
s_lshr_b32 s44, s24, 1
s_lshl_b32 s44, s44, 6
s_add_u32 s44, s44, s25
s_lshl_b32 s44, s44, 1
s_and_b32 s24, s24, 1
s_add_u32 s44, s44, s24
s_lshl_b32 s44, s44, 13
s_add_u32 s44, s44, 134217728
s_cmp_ge_u32 s48, 2048
s_cselect_b32 s44, 536870912, s44
s_cselect_b32 s46, 536870912, s46
s_cbranch_scc1 L_nb_42
s_lshr_b32 s25, s48, 8
s_lshl_b32 s25, s25, 2
s_cmp_eq_u32 s25, s45
s_cbranch_scc1 L_nb_42
s_mov_b32 s45, s25
s_mov_b32 s28, 0
L_poll_45:
buffer_load_dword v26, v17, s[8:11], s45 offen sc1
s_add_u32 s28, s28, 1
s_cmp_gt_u32 s28, 40000
s_cbranch_scc1 L_end
s_waitcnt vmcnt(0)
v_cmp_ne_u32 vcc, 1, v26
s_cbranch_vccz L_pd_46
s_sleep 8
s_cmp_lt_u32 s28, 32
s_cbranch_scc1 L_poll_45
s_sleep 32
s_branch L_poll_45
L_pd_46:
L_nb_42:
s_add_u32 s25, s44, 0
buffer_load_dwordx4 a[0:3], v1, s[8:11], s25 offen sc1
buffer_load_dwordx4 a[4:7], v1, s[8:11], s25 offen offset:1024 sc1
buffer_load_dwordx4 a[8:11], v1, s[8:11], s25 offen offset:2048 sc1
buffer_load_dwordx4 a[12:15], v1, s[8:11], s25 offen offset:3072 sc1
s_add_u32 s25, s44, 4096
buffer_load_dwordx4 a[16:19], v1, s[8:11], s25 offen sc1
buffer_load_dwordx4 a[20:23], v1, s[8:11], s25 offen offset:1024 sc1
buffer_load_dwordx4 a[24:27], v1, s[8:11], s25 offen offset:2048 sc1
buffer_load_dwordx4 a[28:31], v1, s[8:11], s25 offen offset:3072 sc1
s_waitcnt vmcnt(24)
v_mfma_f32_32x32x16_bf16 v[64:79], v[96:99], a[96:99], 0
s_add_u32 s25, s46, 0
buffer_load_dwordx4 a[32:35], v1, s[8:11], s25 offen sc1
buffer_load_dwordx4 a[36:39], v1, s[8:11], s25 offen offset:1024 sc1
s_waitcnt vmcnt(25)
v_mfma_f32_32x32x16_bf16 v[64:79], v[100:103], a[100:103], v[64:79]
buffer_load_dwordx4 a[40:43], v1, s[8:11], s25 offen offset:2048 sc1
buffer_load_dwordx4 a[44:47], v1, s[8:11], s25 offen offset:3072 sc1
s_waitcnt vmcnt(26)
v_mfma_f32_32x32x16_bf16 v[64:79], v[104:107], a[104:107], v[64:79]
s_add_u32 s25, s46, 4096
buffer_load_dwordx4 a[48:51], v1, s[8:11], s25 offen sc1
buffer_load_dwordx4 a[52:55], v1, s[8:11], s25 offen offset:1024 sc1
s_waitcnt vmcnt(27)
v_mfma_f32_32x32x16_bf16 v[64:79], v[108:111], a[108:111], v[64:79]
buffer_load_dwordx4 a[56:59], v1, s[8:11], s25 offen offset:2048 sc1
buffer_load_dwordx4 a[60:63], v1, s[8:11], s25 offen offset:3072 sc1
s_waitcnt vmcnt(28)
v_mfma_f32_32x32x16_bf16 v[64:79], v[112:115], a[112:115], v[64:79]
s_add_u32 s25, s46, 8192
buffer_load_dwordx4 a[64:67], v16, s[8:11], s25 offen sc1
buffer_load_dwordx4 a[68:71], v16, s[8:11], s25 offen offset:1024 sc1
s_waitcnt vmcnt(29)
v_mfma_f32_32x32x16_bf16 v[64:79], v[116:119], a[116:119], v[64:79]
buffer_load_dwordx4 a[72:75], v16, s[8:11], s25 offen offset:2048 sc1
buffer_load_dwordx4 a[76:79], v16, s[8:11], s25 offen offset:3072 sc1
s_waitcnt vmcnt(30)
v_mfma_f32_32x32x16_bf16 v[64:79], v[120:123], a[120:123], v[64:79]
s_add_u32 s25, s46, 12288
buffer_load_dwordx4 a[80:83], v16, s[8:11], s25 offen sc1
buffer_load_dwordx4 a[84:87], v16, s[8:11], s25 offen offset:1024 sc1
s_waitcnt vmcnt(31)
v_mfma_f32_32x32x16_bf16 v[64:79], v[124:127], a[124:127], v[64:79]
buffer_load_dwordx4 a[88:91], v16, s[8:11], s25 offen offset:2048 sc1
buffer_load_dwordx4 a[92:95], v16, s[8:11], s25 offen offset:3072 sc1
s_waitcnt vmcnt(25)
L_kj_34:
s_nop 9
v_max3_f32 v20, v20, v64, v65
v_max3_f32 v20, v20, v66, v67
v_mov_b32 v26, v20
s_nop 1
v_permlane32_swap_b32 v26, v20
v_max_f32 v20, v20, v26
v_mul_f32 v20, s40, v20
v_pk_fma_f32 v[64:65], v[64:65], s[40:41], v[20:21] op_sel_hi:[1,0,0] neg_lo:[0,0,1] neg_hi:[0,0,1]
v_pk_fma_f32 v[66:67], v[66:67], s[40:41], v[20:21] op_sel_hi:[1,0,0] neg_lo:[0,0,1] neg_hi:[0,0,1]
v_pk_fma_f32 v[32:33], v[32:33], s[40:41], v[20:21] op_sel_hi:[1,0,0] neg_lo:[0,0,1] neg_hi:[0,0,1]
v_pk_fma_f32 v[34:35], v[34:35], s[40:41], v[20:21] op_sel_hi:[1,0,0] neg_lo:[0,0,1] neg_hi:[0,0,1]
v_pk_fma_f32 v[36:37], v[36:37], s[40:41], v[20:21] op_sel_hi:[1,0,0] neg_lo:[0,0,1] neg_hi:[0,0,1]
v_pk_fma_f32 v[38:39], v[38:39], s[40:41], v[20:21] op_sel_hi:[1,0,0] neg_lo:[0,0,1] neg_hi:[0,0,1]
v_pk_fma_f32 v[40:41], v[40:41], s[40:41], v[20:21] op_sel_hi:[1,0,0] neg_lo:[0,0,1] neg_hi:[0,0,1]
v_pk_fma_f32 v[42:43], v[42:43], s[40:41], v[20:21] op_sel_hi:[1,0,0] neg_lo:[0,0,1] neg_hi:[0,0,1]
v_pk_fma_f32 v[44:45], v[44:45], s[40:41], v[20:21] op_sel_hi:[1,0,0] neg_lo:[0,0,1] neg_hi:[0,0,1]
v_pk_fma_f32 v[46:47], v[46:47], s[40:41], v[20:21] op_sel_hi:[1,0,0] neg_lo:[0,0,1] neg_hi:[0,0,1]
v_exp_f32 v64, v64
v_exp_f32 v65, v65
v_exp_f32 v66, v66
v_exp_f32 v67, v67
v_exp_f32 v32, v32
v_exp_f32 v33, v33
v_cvt_pk_bf16_f32 v88, v64, v65
v_cvt_pk_bf16_f32 v89, v66, v67
s_nop 1
v_mfma_f32_32x32x8_bf16 v[128:143], v[8:9], v[88:89], 0
v_exp_f32 v34, v34
v_exp_f32 v35, v35
v_exp_f32 v36, v36
v_mfma_f32_32x32x8_bf16 v[160:175], v[10:11], v[88:89], 0
v_exp_f32 v37, v37
v_exp_f32 v38, v38
v_mfma_f32_32x32x8_bf16 v[192:207], v[12:13], v[88:89], 0
v_exp_f32 v39, v39
v_exp_f32 v40, v40
v_exp_f32 v41, v41
v_mfma_f32_32x32x8_bf16 v[224:239], v[14:15], v[88:89], 0
v_cvt_pk_bf16_f32 v80, v32, v33
v_cvt_pk_bf16_f32 v81, v34, v35
v_cvt_pk_bf16_f32 v82, v36, v37
v_cvt_pk_bf16_f32 v83, v38, v39
s_nop 1
v_mfma_f32_32x32x16_bf16 v[128:143], a[160:163], v[80:83], v[128:143]
v_exp_f32 v42, v42
v_exp_f32 v43, v43
v_exp_f32 v44, v44
v_mfma_f32_32x32x16_bf16 v[160:175], a[168:171], v[80:83], v[160:175]
v_exp_f32 v45, v45
v_exp_f32 v46, v46
v_mfma_f32_32x32x16_bf16 v[192:207], a[176:179], v[80:83], v[192:207]
v_exp_f32 v47, v47
v_add_f32 v22, v64, v65
v_add_f32 v22, v22, v66
v_add_f32 v22, v22, v67
v_add_f32 v22, v22, v32
v_mfma_f32_32x32x16_bf16 v[224:239], a[184:187], v[80:83], v[224:239]
v_add_f32 v22, v22, v33
v_cvt_pk_bf16_f32 v84, v40, v41
v_cvt_pk_bf16_f32 v85, v42, v43
v_cvt_pk_bf16_f32 v86, v44, v45
v_cvt_pk_bf16_f32 v87, v46, v47
s_nop 1
v_mfma_f32_32x32x16_bf16 v[128:143], a[164:167], v[84:87], v[128:143]
v_add_f32 v22, v22, v34
v_add_f32 v22, v22, v35
v_add_f32 v22, v22, v36
v_add_f32 v22, v22, v37
v_add_f32 v22, v22, v38
v_mfma_f32_32x32x16_bf16 v[160:175], a[172:175], v[84:87], v[160:175]
v_add_f32 v22, v22, v39
v_add_f32 v22, v22, v40
v_add_f32 v22, v22, v41
v_add_f32 v22, v22, v42
v_mfma_f32_32x32x16_bf16 v[192:207], a[180:183], v[84:87], v[192:207]
v_add_f32 v22, v22, v43
v_add_f32 v22, v22, v44
v_add_f32 v22, v22, v45
v_add_f32 v22, v22, v46
v_add_f32 v22, v22, v47
v_mfma_f32_32x32x16_bf16 v[224:239], a[188:191], v[84:87], v[224:239]
s_lshl_b32 s26, s43, 18
s_lshl_b32 s27, s42, 12
s_add_u32 s26, s26, s27
s_add_u32 s26, s26, 83886080
v_mov_b32 v26, v22
s_nop 1
v_permlane32_swap_b32 v26, v22
v_add_f32 v26, v26, v22
v_rcp_f32 v26, v26
s_nop 0
v_pk_mul_f32 v[128:129], v[128:129], v[26:27] op_sel_hi:[1,0]
v_pk_mul_f32 v[130:131], v[130:131], v[26:27] op_sel_hi:[1,0]
v_pk_mul_f32 v[132:133], v[132:133], v[26:27] op_sel_hi:[1,0]
v_pk_mul_f32 v[134:135], v[134:135], v[26:27] op_sel_hi:[1,0]
v_pk_mul_f32 v[136:137], v[136:137], v[26:27] op_sel_hi:[1,0]
v_pk_mul_f32 v[138:139], v[138:139], v[26:27] op_sel_hi:[1,0]
v_pk_mul_f32 v[140:141], v[140:141], v[26:27] op_sel_hi:[1,0]
v_pk_mul_f32 v[142:143], v[142:143], v[26:27] op_sel_hi:[1,0]
v_cvt_pk_bf16_f32 v128, v128, v129
v_cvt_pk_bf16_f32 v129, v130, v131
v_cvt_pk_bf16_f32 v130, v132, v133
v_cvt_pk_bf16_f32 v131, v134, v135
buffer_store_dwordx4 v[128:131], v6, s[8:11], s26 offen
v_cvt_pk_bf16_f32 v136, v136, v137
v_cvt_pk_bf16_f32 v137, v138, v139
v_cvt_pk_bf16_f32 v138, v140, v141
v_cvt_pk_bf16_f32 v139, v142, v143
buffer_store_dwordx4 v[136:139], v6, s[8:11], s26 offen offset:512
v_pk_mul_f32 v[160:161], v[160:161], v[26:27] op_sel_hi:[1,0]
v_pk_mul_f32 v[162:163], v[162:163], v[26:27] op_sel_hi:[1,0]
v_pk_mul_f32 v[164:165], v[164:165], v[26:27] op_sel_hi:[1,0]
v_pk_mul_f32 v[166:167], v[166:167], v[26:27] op_sel_hi:[1,0]
v_pk_mul_f32 v[168:169], v[168:169], v[26:27] op_sel_hi:[1,0]
v_pk_mul_f32 v[170:171], v[170:171], v[26:27] op_sel_hi:[1,0]
v_pk_mul_f32 v[172:173], v[172:173], v[26:27] op_sel_hi:[1,0]
v_pk_mul_f32 v[174:175], v[174:175], v[26:27] op_sel_hi:[1,0]
v_cvt_pk_bf16_f32 v160, v160, v161
v_cvt_pk_bf16_f32 v161, v162, v163
v_cvt_pk_bf16_f32 v162, v164, v165
v_cvt_pk_bf16_f32 v163, v166, v167
buffer_store_dwordx4 v[160:163], v6, s[8:11], s26 offen offset:1024
v_cvt_pk_bf16_f32 v168, v168, v169
v_cvt_pk_bf16_f32 v169, v170, v171
v_cvt_pk_bf16_f32 v170, v172, v173
v_cvt_pk_bf16_f32 v171, v174, v175
buffer_store_dwordx4 v[168:171], v6, s[8:11], s26 offen offset:1536
v_pk_mul_f32 v[192:193], v[192:193], v[26:27] op_sel_hi:[1,0]
v_pk_mul_f32 v[194:195], v[194:195], v[26:27] op_sel_hi:[1,0]
v_pk_mul_f32 v[196:197], v[196:197], v[26:27] op_sel_hi:[1,0]
v_pk_mul_f32 v[198:199], v[198:199], v[26:27] op_sel_hi:[1,0]
v_pk_mul_f32 v[200:201], v[200:201], v[26:27] op_sel_hi:[1,0]
v_pk_mul_f32 v[202:203], v[202:203], v[26:27] op_sel_hi:[1,0]
v_pk_mul_f32 v[204:205], v[204:205], v[26:27] op_sel_hi:[1,0]
v_pk_mul_f32 v[206:207], v[206:207], v[26:27] op_sel_hi:[1,0]
v_cvt_pk_bf16_f32 v192, v192, v193
v_cvt_pk_bf16_f32 v193, v194, v195
v_cvt_pk_bf16_f32 v194, v196, v197
v_cvt_pk_bf16_f32 v195, v198, v199
buffer_store_dwordx4 v[192:195], v6, s[8:11], s26 offen offset:2048
v_cvt_pk_bf16_f32 v200, v200, v201
v_cvt_pk_bf16_f32 v201, v202, v203
v_cvt_pk_bf16_f32 v202, v204, v205
v_cvt_pk_bf16_f32 v203, v206, v207
buffer_store_dwordx4 v[200:203], v6, s[8:11], s26 offen offset:2560
v_pk_mul_f32 v[224:225], v[224:225], v[26:27] op_sel_hi:[1,0]
v_pk_mul_f32 v[226:227], v[226:227], v[26:27] op_sel_hi:[1,0]
v_pk_mul_f32 v[228:229], v[228:229], v[26:27] op_sel_hi:[1,0]
v_pk_mul_f32 v[230:231], v[230:231], v[26:27] op_sel_hi:[1,0]
v_pk_mul_f32 v[232:233], v[232:233], v[26:27] op_sel_hi:[1,0]
v_pk_mul_f32 v[234:235], v[234:235], v[26:27] op_sel_hi:[1,0]
v_pk_mul_f32 v[236:237], v[236:237], v[26:27] op_sel_hi:[1,0]
v_pk_mul_f32 v[238:239], v[238:239], v[26:27] op_sel_hi:[1,0]
v_cvt_pk_bf16_f32 v224, v224, v225
v_cvt_pk_bf16_f32 v225, v226, v227
v_cvt_pk_bf16_f32 v226, v228, v229
v_cvt_pk_bf16_f32 v227, v230, v231
buffer_store_dwordx4 v[224:227], v6, s[8:11], s26 offen offset:3072
v_cvt_pk_bf16_f32 v232, v232, v233
v_cvt_pk_bf16_f32 v233, v234, v235
v_cvt_pk_bf16_f32 v234, v236, v237
v_cvt_pk_bf16_f32 v235, v238, v239
buffer_store_dwordx4 v[232:235], v6, s[8:11], s26 offen offset:3584
s_lshl_b32 s54, s47, 2
s_add_u32 s54, s54, 111157248
s_mov_b32 s47, s48
s_cmp_lt_u32 s47, 2048
s_cbranch_scc1 L_bt
L_bt_f:
v_mov_b32 v26, 1
s_waitcnt vmcnt(0)
s_mov_b64 exec, 1
buffer_store_dword v26, v4, s[8:11], s54 offen
s_mov_b64 exec, -1
L_bt_x:
s_branch L_done
L_bo:
s_mov_b64 s[42:43], s[4:5]
s_mov_b32 s51, s27
s_mov_b32 s40, s26
s_mov_b32 s44, 83886080
s_mov_b32 s45, 111157248
s_mov_b32 s46, 1
s_mov_b32 s47, 1152
s_load_dwordx2 s[4:5], s[0:1], 88
s_waitcnt lgkmcnt(0)
s_mov_b32 s20, s4
s_and_b32 s21, s5, 0xffff
s_mov_b32 s22, 4718592
s_mov_b32 s23, 0x20000
L_op:
s_load_dwordx2 s[4:5], s[0:1], 104
s_waitcnt lgkmcnt(0)
s_mov_b32 s12, s4
s_and_b32 s13, s5, 0xffff
s_mov_b32 s14, 4718592
s_mov_b32 s15, 0x20000
v_and_b32 v1, 63, v0
v_lshlrev_b32 v1, 4, v1
v_bfe_u32 v12, v0, 3, 3
v_mul_u32_u24 v12, 1152, v12
v_bfe_u32 v13, v0, 4, 2
v_lshlrev_b32 v13, 1, v13
v_and_b32 v14, 7, v0
v_xor_b32 v13, v13, v14
v_lshl_add_u32 v12, v13, 4, v12
s_mul_i32 s24, s17, 1179648
s_lshl_b32 s25, s40, 7
s_add_u32 s24, s24, s25
v_add_u32 v2, s24, v12
s_lshl_b32 s26, s17, 15
v_bfe_u32 v12, v0, 2, 3
v_lshlrev_b32 v12, 7, v12
v_bfe_u32 v13, v0, 5, 1
v_lshl_add_u32 v12, v13, 11, v12
v_bfe_u32 v13, v0, 3, 2
v_lshl_add_u32 v12, v13, 5, v12
v_and_b32 v13, 3, v0
v_lshl_add_u32 v12, v13, 3, v12
v_add_u32 v8, s26, v12
v_xor_b32 v9, 32, v8
v_xor_b32 v10, 64, v8
v_xor_b32 v11, 96, v8
s_add_u32 s24, s40, 0
s_and_b32 s24, s24, 7
s_lshl_b32 s30, s24, 12
s_add_u32 s24, s40, 1
s_and_b32 s24, s24, 7
s_lshl_b32 s31, s24, 12
s_add_u32 s24, s40, 2
s_and_b32 s24, s24, 7
s_lshl_b32 s32, s24, 12
s_add_u32 s24, s40, 3
s_and_b32 s24, s24, 7
s_lshl_b32 s33, s24, 12
s_add_u32 s24, s40, 4
s_and_b32 s24, s24, 7
s_lshl_b32 s34, s24, 12
s_add_u32 s24, s40, 5
s_and_b32 s24, s24, 7
s_lshl_b32 s35, s24, 12
s_add_u32 s24, s40, 6
s_and_b32 s24, s24, 7
s_lshl_b32 s36, s24, 12
s_add_u32 s24, s40, 7
s_and_b32 s24, s24, 7
s_lshl_b32 s37, s24, 12
s_mul_i32 s25, s30, 36
s_add_u32 m0, s26, 0
s_add_u32 s24, s25, 0
buffer_load_dwordx4 v2, s[20:23], s24 offen lds
s_add_u32 m0, s26, 1024
s_add_u32 s24, s25, 9216
buffer_load_dwordx4 v2, s[20:23], s24 offen lds
s_add_u32 m0, s26, 2048
s_add_u32 s24, s25, 18432
buffer_load_dwordx4 v2, s[20:23], s24 offen lds
s_add_u32 m0, s26, 3072
s_add_u32 s24, s25, 27648
buffer_load_dwordx4 v2, s[20:23], s24 offen lds
s_mul_i32 s25, s30, 36
s_add_u32 m0, s26, 4096
s_add_u32 s24, s25, 36864
buffer_load_dwordx4 v2, s[20:23], s24 offen lds
s_add_u32 m0, s26, 5120
s_add_u32 s24, s25, 46080
buffer_load_dwordx4 v2, s[20:23], s24 offen lds
s_add_u32 m0, s26, 6144
s_add_u32 s24, s25, 55296
buffer_load_dwordx4 v2, s[20:23], s24 offen lds
s_add_u32 m0, s26, 7168
s_add_u32 s24, s25, 64512
buffer_load_dwordx4 v2, s[20:23], s24 offen lds
s_mul_i32 s25, s30, 36
s_add_u32 m0, s26, 8192
s_add_u32 s24, s25, 73728
buffer_load_dwordx4 v2, s[20:23], s24 offen lds
s_add_u32 m0, s26, 9216
s_add_u32 s24, s25, 82944
buffer_load_dwordx4 v2, s[20:23], s24 offen lds
s_add_u32 m0, s26, 10240
s_add_u32 s24, s25, 92160
buffer_load_dwordx4 v2, s[20:23], s24 offen lds
s_add_u32 m0, s26, 11264
s_add_u32 s24, s25, 101376
buffer_load_dwordx4 v2, s[20:23], s24 offen lds
s_mul_i32 s25, s31, 36
s_add_u32 m0, s26, 12288
s_add_u32 s24, s25, 0
buffer_load_dwordx4 v2, s[20:23], s24 offen lds
s_add_u32 m0, s26, 13312
s_add_u32 s24, s25, 9216
buffer_load_dwordx4 v2, s[20:23], s24 offen lds
s_add_u32 m0, s26, 14336
s_add_u32 s24, s25, 18432
buffer_load_dwordx4 v2, s[20:23], s24 offen lds
s_add_u32 m0, s26, 15360
s_add_u32 s24, s25, 27648
buffer_load_dwordx4 v2, s[20:23], s24 offen lds
s_mul_i32 s25, s31, 36
s_add_u32 m0, s26, 16384
s_add_u32 s24, s25, 36864
buffer_load_dwordx4 v2, s[20:23], s24 offen lds
s_add_u32 m0, s26, 17408
s_add_u32 s24, s25, 46080
buffer_load_dwordx4 v2, s[20:23], s24 offen lds
s_add_u32 m0, s26, 18432
s_add_u32 s24, s25, 55296
buffer_load_dwordx4 v2, s[20:23], s24 offen lds
s_add_u32 m0, s26, 19456
s_add_u32 s24, s25, 64512
buffer_load_dwordx4 v2, s[20:23], s24 offen lds
s_mul_i32 s25, s31, 36
s_add_u32 m0, s26, 20480
s_add_u32 s24, s25, 73728
buffer_load_dwordx4 v2, s[20:23], s24 offen lds
s_add_u32 m0, s26, 21504
s_add_u32 s24, s25, 82944
buffer_load_dwordx4 v2, s[20:23], s24 offen lds
s_add_u32 m0, s26, 22528
s_add_u32 s24, s25, 92160
buffer_load_dwordx4 v2, s[20:23], s24 offen lds
s_add_u32 m0, s26, 23552
s_add_u32 s24, s25, 101376
buffer_load_dwordx4 v2, s[20:23], s24 offen lds
s_mul_i32 s25, s32, 36
s_add_u32 m0, s26, 24576
s_add_u32 s24, s25, 0
buffer_load_dwordx4 v2, s[20:23], s24 offen lds
s_add_u32 m0, s26, 25600
s_add_u32 s24, s25, 9216
buffer_load_dwordx4 v2, s[20:23], s24 offen lds
s_add_u32 m0, s26, 26624
s_add_u32 s24, s25, 18432
buffer_load_dwordx4 v2, s[20:23], s24 offen lds
s_add_u32 m0, s26, 27648
s_add_u32 s24, s25, 27648
buffer_load_dwordx4 v2, s[20:23], s24 offen lds
s_mul_i32 s25, s32, 36
s_add_u32 m0, s26, 28672
s_add_u32 s24, s25, 36864
buffer_load_dwordx4 v2, s[20:23], s24 offen lds
s_add_u32 m0, s26, 29696
s_add_u32 s24, s25, 46080
buffer_load_dwordx4 v2, s[20:23], s24 offen lds
s_add_u32 m0, s26, 30720
s_add_u32 s24, s25, 55296
buffer_load_dwordx4 v2, s[20:23], s24 offen lds
s_add_u32 m0, s26, 31744
s_add_u32 s24, s25, 64512
buffer_load_dwordx4 v2, s[20:23], s24 offen lds
s_waitcnt vmcnt(28)
ds_read_b64_tr_b16 v[128:129], v8
ds_read_b64_tr_b16 v[130:131], v8 offset:1024
ds_read_b64_tr_b16 v[132:133], v9
ds_read_b64_tr_b16 v[134:135], v9 offset:1024
ds_read_b64_tr_b16 v[136:137], v10
ds_read_b64_tr_b16 v[138:139], v10 offset:1024
ds_read_b64_tr_b16 v[140:141], v11
ds_read_b64_tr_b16 v[142:143], v11 offset:1024
s_waitcnt lgkmcnt(0)
s_mul_i32 s25, s32, 36
s_add_u32 m0, s26, 0
s_add_u32 s24, s25, 73728
buffer_load_dwordx4 v2, s[20:23], s24 offen lds
s_add_u32 m0, s26, 1024
s_add_u32 s24, s25, 82944
buffer_load_dwordx4 v2, s[20:23], s24 offen lds
s_add_u32 m0, s26, 2048
s_add_u32 s24, s25, 92160
buffer_load_dwordx4 v2, s[20:23], s24 offen lds
s_add_u32 m0, s26, 3072
s_add_u32 s24, s25, 101376
buffer_load_dwordx4 v2, s[20:23], s24 offen lds
s_waitcnt vmcnt(28)
ds_read_b64_tr_b16 v[144:145], v8 offset:4096
ds_read_b64_tr_b16 v[146:147], v8 offset:5120
ds_read_b64_tr_b16 v[148:149], v9 offset:4096
ds_read_b64_tr_b16 v[150:151], v9 offset:5120
ds_read_b64_tr_b16 v[152:153], v10 offset:4096
ds_read_b64_tr_b16 v[154:155], v10 offset:5120
ds_read_b64_tr_b16 v[156:157], v11 offset:4096
ds_read_b64_tr_b16 v[158:159], v11 offset:5120
s_waitcnt lgkmcnt(0)
s_mul_i32 s25, s33, 36
s_add_u32 m0, s26, 4096
s_add_u32 s24, s25, 0
buffer_load_dwordx4 v2, s[20:23], s24 offen lds
s_add_u32 m0, s26, 5120
s_add_u32 s24, s25, 9216
buffer_load_dwordx4 v2, s[20:23], s24 offen lds
s_add_u32 m0, s26, 6144
s_add_u32 s24, s25, 18432
buffer_load_dwordx4 v2, s[20:23], s24 offen lds
s_add_u32 m0, s26, 7168
s_add_u32 s24, s25, 27648
buffer_load_dwordx4 v2, s[20:23], s24 offen lds
s_waitcnt vmcnt(28)
ds_read_b64_tr_b16 v[160:161], v8 offset:8192
ds_read_b64_tr_b16 v[162:163], v8 offset:9216
ds_read_b64_tr_b16 v[164:165], v9 offset:8192
ds_read_b64_tr_b16 v[166:167], v9 offset:9216
ds_read_b64_tr_b16 v[168:169], v10 offset:8192
ds_read_b64_tr_b16 v[170:171], v10 offset:9216
ds_read_b64_tr_b16 v[172:173], v11 offset:8192
ds_read_b64_tr_b16 v[174:175], v11 offset:9216
s_waitcnt lgkmcnt(0)
s_mul_i32 s25, s33, 36
s_add_u32 m0, s26, 8192
s_add_u32 s24, s25, 36864
buffer_load_dwordx4 v2, s[20:23], s24 offen lds
s_add_u32 m0, s26, 9216
s_add_u32 s24, s25, 46080
buffer_load_dwordx4 v2, s[20:23], s24 offen lds
s_add_u32 m0, s26, 10240
s_add_u32 s24, s25, 55296
buffer_load_dwordx4 v2, s[20:23], s24 offen lds
s_add_u32 m0, s26, 11264
s_add_u32 s24, s25, 64512
buffer_load_dwordx4 v2, s[20:23], s24 offen lds
s_waitcnt vmcnt(28)
ds_read_b64_tr_b16 v[176:177], v8 offset:12288
ds_read_b64_tr_b16 v[178:179], v8 offset:13312
ds_read_b64_tr_b16 v[180:181], v9 offset:12288
ds_read_b64_tr_b16 v[182:183], v9 offset:13312
ds_read_b64_tr_b16 v[184:185], v10 offset:12288
ds_read_b64_tr_b16 v[186:187], v10 offset:13312
ds_read_b64_tr_b16 v[188:189], v11 offset:12288
ds_read_b64_tr_b16 v[190:191], v11 offset:13312
s_waitcnt lgkmcnt(0)
s_mul_i32 s25, s33, 36
s_add_u32 m0, s26, 12288
s_add_u32 s24, s25, 73728
buffer_load_dwordx4 v2, s[20:23], s24 offen lds
s_add_u32 m0, s26, 13312
s_add_u32 s24, s25, 82944
buffer_load_dwordx4 v2, s[20:23], s24 offen lds
s_add_u32 m0, s26, 14336
s_add_u32 s24, s25, 92160
buffer_load_dwordx4 v2, s[20:23], s24 offen lds
s_add_u32 m0, s26, 15360
s_add_u32 s24, s25, 101376
buffer_load_dwordx4 v2, s[20:23], s24 offen lds
s_waitcnt vmcnt(28)
ds_read_b64_tr_b16 v[192:193], v8 offset:16384
ds_read_b64_tr_b16 v[194:195], v8 offset:17408
ds_read_b64_tr_b16 v[196:197], v9 offset:16384
ds_read_b64_tr_b16 v[198:199], v9 offset:17408
ds_read_b64_tr_b16 v[200:201], v10 offset:16384
ds_read_b64_tr_b16 v[202:203], v10 offset:17408
ds_read_b64_tr_b16 v[204:205], v11 offset:16384
ds_read_b64_tr_b16 v[206:207], v11 offset:17408
s_waitcnt lgkmcnt(0)
s_mul_i32 s25, s34, 36
s_add_u32 m0, s26, 16384
s_add_u32 s24, s25, 0
buffer_load_dwordx4 v2, s[20:23], s24 offen lds
s_add_u32 m0, s26, 17408
s_add_u32 s24, s25, 9216
buffer_load_dwordx4 v2, s[20:23], s24 offen lds
s_add_u32 m0, s26, 18432
s_add_u32 s24, s25, 18432
buffer_load_dwordx4 v2, s[20:23], s24 offen lds
s_add_u32 m0, s26, 19456
s_add_u32 s24, s25, 27648
buffer_load_dwordx4 v2, s[20:23], s24 offen lds
s_waitcnt vmcnt(28)
ds_read_b64_tr_b16 v[208:209], v8 offset:20480
ds_read_b64_tr_b16 v[210:211], v8 offset:21504
ds_read_b64_tr_b16 v[212:213], v9 offset:20480
ds_read_b64_tr_b16 v[214:215], v9 offset:21504
ds_read_b64_tr_b16 v[216:217], v10 offset:20480
ds_read_b64_tr_b16 v[218:219], v10 offset:21504
ds_read_b64_tr_b16 v[220:221], v11 offset:20480
ds_read_b64_tr_b16 v[222:223], v11 offset:21504
s_waitcnt lgkmcnt(0)
s_mul_i32 s25, s34, 36
s_add_u32 m0, s26, 20480
s_add_u32 s24, s25, 36864
buffer_load_dwordx4 v2, s[20:23], s24 offen lds
s_add_u32 m0, s26, 21504
s_add_u32 s24, s25, 46080
buffer_load_dwordx4 v2, s[20:23], s24 offen lds
s_add_u32 m0, s26, 22528
s_add_u32 s24, s25, 55296
buffer_load_dwordx4 v2, s[20:23], s24 offen lds
s_add_u32 m0, s26, 23552
s_add_u32 s24, s25, 64512
buffer_load_dwordx4 v2, s[20:23], s24 offen lds
s_waitcnt vmcnt(28)
ds_read_b64_tr_b16 v[224:225], v8 offset:24576
ds_read_b64_tr_b16 v[226:227], v8 offset:25600
ds_read_b64_tr_b16 v[228:229], v9 offset:24576
ds_read_b64_tr_b16 v[230:231], v9 offset:25600
ds_read_b64_tr_b16 v[232:233], v10 offset:24576
ds_read_b64_tr_b16 v[234:235], v10 offset:25600
ds_read_b64_tr_b16 v[236:237], v11 offset:24576
ds_read_b64_tr_b16 v[238:239], v11 offset:25600
s_waitcnt lgkmcnt(0)
s_mul_i32 s25, s34, 36
s_add_u32 m0, s26, 24576
s_add_u32 s24, s25, 73728
buffer_load_dwordx4 v2, s[20:23], s24 offen lds
s_add_u32 m0, s26, 25600
s_add_u32 s24, s25, 82944
buffer_load_dwordx4 v2, s[20:23], s24 offen lds
s_add_u32 m0, s26, 26624
s_add_u32 s24, s25, 92160
buffer_load_dwordx4 v2, s[20:23], s24 offen lds
s_add_u32 m0, s26, 27648
s_add_u32 s24, s25, 101376
buffer_load_dwordx4 v2, s[20:23], s24 offen lds
s_waitcnt vmcnt(28)
ds_read_b64_tr_b16 v[240:241], v8 offset:28672
ds_read_b64_tr_b16 v[242:243], v8 offset:29696
ds_read_b64_tr_b16 v[244:245], v9 offset:28672
ds_read_b64_tr_b16 v[246:247], v9 offset:29696
ds_read_b64_tr_b16 v[248:249], v10 offset:28672
ds_read_b64_tr_b16 v[250:251], v10 offset:29696
ds_read_b64_tr_b16 v[252:253], v11 offset:28672
ds_read_b64_tr_b16 v[254:255], v11 offset:29696
s_waitcnt lgkmcnt(0)
s_mul_i32 s25, s35, 36
s_add_u32 m0, s26, 28672
s_add_u32 s24, s25, 0
buffer_load_dwordx4 v2, s[20:23], s24 offen lds
s_add_u32 m0, s26, 29696
s_add_u32 s24, s25, 9216
buffer_load_dwordx4 v2, s[20:23], s24 offen lds
s_add_u32 m0, s26, 30720
s_add_u32 s24, s25, 18432
buffer_load_dwordx4 v2, s[20:23], s24 offen lds
s_add_u32 m0, s26, 31744
s_add_u32 s24, s25, 27648
buffer_load_dwordx4 v2, s[20:23], s24 offen lds
s_waitcnt vmcnt(28)
ds_read_b64_tr_b16 a[0:1], v8
ds_read_b64_tr_b16 a[2:3], v8 offset:1024
ds_read_b64_tr_b16 a[4:5], v9
ds_read_b64_tr_b16 a[6:7], v9 offset:1024
ds_read_b64_tr_b16 a[8:9], v10
ds_read_b64_tr_b16 a[10:11], v10 offset:1024
ds_read_b64_tr_b16 a[12:13], v11
ds_read_b64_tr_b16 a[14:15], v11 offset:1024
s_waitcnt lgkmcnt(0)
s_mul_i32 s25, s35, 36
s_add_u32 m0, s26, 0
s_add_u32 s24, s25, 36864
buffer_load_dwordx4 v2, s[20:23], s24 offen lds
s_add_u32 m0, s26, 1024
s_add_u32 s24, s25, 46080
buffer_load_dwordx4 v2, s[20:23], s24 offen lds
s_add_u32 m0, s26, 2048
s_add_u32 s24, s25, 55296
buffer_load_dwordx4 v2, s[20:23], s24 offen lds
s_add_u32 m0, s26, 3072
s_add_u32 s24, s25, 64512
buffer_load_dwordx4 v2, s[20:23], s24 offen lds
s_waitcnt vmcnt(28)
ds_read_b64_tr_b16 a[16:17], v8 offset:4096
ds_read_b64_tr_b16 a[18:19], v8 offset:5120
ds_read_b64_tr_b16 a[20:21], v9 offset:4096
ds_read_b64_tr_b16 a[22:23], v9 offset:5120
ds_read_b64_tr_b16 a[24:25], v10 offset:4096
ds_read_b64_tr_b16 a[26:27], v10 offset:5120
ds_read_b64_tr_b16 a[28:29], v11 offset:4096
ds_read_b64_tr_b16 a[30:31], v11 offset:5120
s_waitcnt lgkmcnt(0)
s_mul_i32 s25, s35, 36
s_add_u32 m0, s26, 4096
s_add_u32 s24, s25, 73728
buffer_load_dwordx4 v2, s[20:23], s24 offen lds
s_add_u32 m0, s26, 5120
s_add_u32 s24, s25, 82944
buffer_load_dwordx4 v2, s[20:23], s24 offen lds
s_add_u32 m0, s26, 6144
s_add_u32 s24, s25, 92160
buffer_load_dwordx4 v2, s[20:23], s24 offen lds
s_add_u32 m0, s26, 7168
s_add_u32 s24, s25, 101376
buffer_load_dwordx4 v2, s[20:23], s24 offen lds
s_waitcnt vmcnt(28)
ds_read_b64_tr_b16 a[32:33], v8 offset:8192
ds_read_b64_tr_b16 a[34:35], v8 offset:9216
ds_read_b64_tr_b16 a[36:37], v9 offset:8192
ds_read_b64_tr_b16 a[38:39], v9 offset:9216
ds_read_b64_tr_b16 a[40:41], v10 offset:8192
ds_read_b64_tr_b16 a[42:43], v10 offset:9216
ds_read_b64_tr_b16 a[44:45], v11 offset:8192
ds_read_b64_tr_b16 a[46:47], v11 offset:9216
s_waitcnt lgkmcnt(0)
s_mul_i32 s25, s36, 36
s_add_u32 m0, s26, 8192
s_add_u32 s24, s25, 0
buffer_load_dwordx4 v2, s[20:23], s24 offen lds
s_add_u32 m0, s26, 9216
s_add_u32 s24, s25, 9216
buffer_load_dwordx4 v2, s[20:23], s24 offen lds
s_add_u32 m0, s26, 10240
s_add_u32 s24, s25, 18432
buffer_load_dwordx4 v2, s[20:23], s24 offen lds
s_add_u32 m0, s26, 11264
s_add_u32 s24, s25, 27648
buffer_load_dwordx4 v2, s[20:23], s24 offen lds
s_waitcnt vmcnt(28)
ds_read_b64_tr_b16 a[48:49], v8 offset:12288
ds_read_b64_tr_b16 a[50:51], v8 offset:13312
ds_read_b64_tr_b16 a[52:53], v9 offset:12288
ds_read_b64_tr_b16 a[54:55], v9 offset:13312
ds_read_b64_tr_b16 a[56:57], v10 offset:12288
ds_read_b64_tr_b16 a[58:59], v10 offset:13312
ds_read_b64_tr_b16 a[60:61], v11 offset:12288
ds_read_b64_tr_b16 a[62:63], v11 offset:13312
s_waitcnt lgkmcnt(0)
s_mul_i32 s25, s36, 36
s_add_u32 m0, s26, 12288
s_add_u32 s24, s25, 36864
buffer_load_dwordx4 v2, s[20:23], s24 offen lds
s_add_u32 m0, s26, 13312
s_add_u32 s24, s25, 46080
buffer_load_dwordx4 v2, s[20:23], s24 offen lds
s_add_u32 m0, s26, 14336
s_add_u32 s24, s25, 55296
buffer_load_dwordx4 v2, s[20:23], s24 offen lds
s_add_u32 m0, s26, 15360
s_add_u32 s24, s25, 64512
buffer_load_dwordx4 v2, s[20:23], s24 offen lds
s_waitcnt vmcnt(28)
ds_read_b64_tr_b16 a[64:65], v8 offset:16384
ds_read_b64_tr_b16 a[66:67], v8 offset:17408
ds_read_b64_tr_b16 a[68:69], v9 offset:16384
ds_read_b64_tr_b16 a[70:71], v9 offset:17408
ds_read_b64_tr_b16 a[72:73], v10 offset:16384
ds_read_b64_tr_b16 a[74:75], v10 offset:17408
ds_read_b64_tr_b16 a[76:77], v11 offset:16384
ds_read_b64_tr_b16 a[78:79], v11 offset:17408
s_waitcnt lgkmcnt(0)
s_mul_i32 s25, s36, 36
s_add_u32 m0, s26, 16384
s_add_u32 s24, s25, 73728
buffer_load_dwordx4 v2, s[20:23], s24 offen lds
s_add_u32 m0, s26, 17408
s_add_u32 s24, s25, 82944
buffer_load_dwordx4 v2, s[20:23], s24 offen lds
s_add_u32 m0, s26, 18432
s_add_u32 s24, s25, 92160
buffer_load_dwordx4 v2, s[20:23], s24 offen lds
s_add_u32 m0, s26, 19456
s_add_u32 s24, s25, 101376
buffer_load_dwordx4 v2, s[20:23], s24 offen lds
s_waitcnt vmcnt(28)
ds_read_b64_tr_b16 a[80:81], v8 offset:20480
ds_read_b64_tr_b16 a[82:83], v8 offset:21504
ds_read_b64_tr_b16 a[84:85], v9 offset:20480
ds_read_b64_tr_b16 a[86:87], v9 offset:21504
ds_read_b64_tr_b16 a[88:89], v10 offset:20480
ds_read_b64_tr_b16 a[90:91], v10 offset:21504
ds_read_b64_tr_b16 a[92:93], v11 offset:20480
ds_read_b64_tr_b16 a[94:95], v11 offset:21504
s_waitcnt lgkmcnt(0)
s_mul_i32 s25, s37, 36
s_add_u32 m0, s26, 20480
s_add_u32 s24, s25, 0
buffer_load_dwordx4 v2, s[20:23], s24 offen lds
s_add_u32 m0, s26, 21504
s_add_u32 s24, s25, 9216
buffer_load_dwordx4 v2, s[20:23], s24 offen lds
s_add_u32 m0, s26, 22528
s_add_u32 s24, s25, 18432
buffer_load_dwordx4 v2, s[20:23], s24 offen lds
s_add_u32 m0, s26, 23552
s_add_u32 s24, s25, 27648
buffer_load_dwordx4 v2, s[20:23], s24 offen lds
s_waitcnt vmcnt(28)
ds_read_b64_tr_b16 a[96:97], v8 offset:24576
ds_read_b64_tr_b16 a[98:99], v8 offset:25600
ds_read_b64_tr_b16 a[100:101], v9 offset:24576
ds_read_b64_tr_b16 a[102:103], v9 offset:25600
ds_read_b64_tr_b16 a[104:105], v10 offset:24576
ds_read_b64_tr_b16 a[106:107], v10 offset:25600
ds_read_b64_tr_b16 a[108:109], v11 offset:24576
ds_read_b64_tr_b16 a[110:111], v11 offset:25600
s_waitcnt lgkmcnt(0)
s_mul_i32 s25, s37, 36
s_add_u32 m0, s26, 24576
s_add_u32 s24, s25, 36864
buffer_load_dwordx4 v2, s[20:23], s24 offen lds
s_add_u32 m0, s26, 25600
s_add_u32 s24, s25, 46080
buffer_load_dwordx4 v2, s[20:23], s24 offen lds
s_add_u32 m0, s26, 26624
s_add_u32 s24, s25, 55296
buffer_load_dwordx4 v2, s[20:23], s24 offen lds
s_add_u32 m0, s26, 27648
s_add_u32 s24, s25, 64512
buffer_load_dwordx4 v2, s[20:23], s24 offen lds
s_waitcnt vmcnt(28)
ds_read_b64_tr_b16 a[112:113], v8 offset:28672
ds_read_b64_tr_b16 a[114:115], v8 offset:29696
ds_read_b64_tr_b16 a[116:117], v9 offset:28672
ds_read_b64_tr_b16 a[118:119], v9 offset:29696
ds_read_b64_tr_b16 a[120:121], v10 offset:28672
ds_read_b64_tr_b16 a[122:123], v10 offset:29696
ds_read_b64_tr_b16 a[124:125], v11 offset:28672
ds_read_b64_tr_b16 a[126:127], v11 offset:29696
s_waitcnt lgkmcnt(0)
s_mul_i32 s25, s37, 36
s_add_u32 m0, s26, 28672
s_add_u32 s24, s25, 73728
buffer_load_dwordx4 v2, s[20:23], s24 offen lds
s_add_u32 m0, s26, 29696
s_add_u32 s24, s25, 82944
buffer_load_dwordx4 v2, s[20:23], s24 offen lds
s_add_u32 m0, s26, 30720
s_add_u32 s24, s25, 92160
buffer_load_dwordx4 v2, s[20:23], s24 offen lds
s_add_u32 m0, s26, 31744
s_add_u32 s24, s25, 101376
buffer_load_dwordx4 v2, s[20:23], s24 offen lds
s_waitcnt vmcnt(28)
ds_read_b64_tr_b16 a[128:129], v8
ds_read_b64_tr_b16 a[130:131], v8 offset:1024
ds_read_b64_tr_b16 a[132:133], v9
ds_read_b64_tr_b16 a[134:135], v9 offset:1024
ds_read_b64_tr_b16 a[136:137], v10
ds_read_b64_tr_b16 a[138:139], v10 offset:1024
ds_read_b64_tr_b16 a[140:141], v11
ds_read_b64_tr_b16 a[142:143], v11 offset:1024
s_waitcnt lgkmcnt(0)
s_mul_i32 s25, s30, 36
s_add_u32 m0, s26, 0
s_add_u32 s24, s25, 110592
buffer_load_dwordx4 v2, s[20:23], s24 offen lds
s_add_u32 m0, s26, 1024
s_add_u32 s24, s25, 119808
buffer_load_dwordx4 v2, s[20:23], s24 offen lds
s_add_u32 m0, s26, 2048
s_add_u32 s24, s25, 129024
buffer_load_dwordx4 v2, s[20:23], s24 offen lds
s_add_u32 m0, s26, 3072
s_add_u32 s24, s25, 138240
buffer_load_dwordx4 v2, s[20:23], s24 offen lds
s_waitcnt vmcnt(28)
ds_read_b64_tr_b16 a[144:145], v8 offset:4096
ds_read_b64_tr_b16 a[146:147], v8 offset:5120
ds_read_b64_tr_b16 a[148:149], v9 offset:4096
ds_read_b64_tr_b16 a[150:151], v9 offset:5120
ds_read_b64_tr_b16 a[152:153], v10 offset:4096
ds_read_b64_tr_b16 a[154:155], v10 offset:5120
ds_read_b64_tr_b16 a[156:157], v11 offset:4096
ds_read_b64_tr_b16 a[158:159], v11 offset:5120
s_waitcnt lgkmcnt(0)
s_mul_i32 s25, s31, 36
s_add_u32 m0, s26, 4096
s_add_u32 s24, s25, 110592
buffer_load_dwordx4 v2, s[20:23], s24 offen lds
s_add_u32 m0, s26, 5120
s_add_u32 s24, s25, 119808
buffer_load_dwordx4 v2, s[20:23], s24 offen lds
s_add_u32 m0, s26, 6144
s_add_u32 s24, s25, 129024
buffer_load_dwordx4 v2, s[20:23], s24 offen lds
s_add_u32 m0, s26, 7168
s_add_u32 s24, s25, 138240
buffer_load_dwordx4 v2, s[20:23], s24 offen lds
s_waitcnt vmcnt(28)
ds_read_b64_tr_b16 a[160:161], v8 offset:8192
ds_read_b64_tr_b16 a[162:163], v8 offset:9216
ds_read_b64_tr_b16 a[164:165], v9 offset:8192
ds_read_b64_tr_b16 a[166:167], v9 offset:9216
ds_read_b64_tr_b16 a[168:169], v10 offset:8192
ds_read_b64_tr_b16 a[170:171], v10 offset:9216
ds_read_b64_tr_b16 a[172:173], v11 offset:8192
ds_read_b64_tr_b16 a[174:175], v11 offset:9216
s_waitcnt lgkmcnt(0)
s_mul_i32 s25, s32, 36
s_add_u32 m0, s26, 8192
s_add_u32 s24, s25, 110592
buffer_load_dwordx4 v2, s[20:23], s24 offen lds
s_add_u32 m0, s26, 9216
s_add_u32 s24, s25, 119808
buffer_load_dwordx4 v2, s[20:23], s24 offen lds
s_add_u32 m0, s26, 10240
s_add_u32 s24, s25, 129024
buffer_load_dwordx4 v2, s[20:23], s24 offen lds
s_add_u32 m0, s26, 11264
s_add_u32 s24, s25, 138240
buffer_load_dwordx4 v2, s[20:23], s24 offen lds
s_waitcnt vmcnt(28)
ds_read_b64_tr_b16 a[176:177], v8 offset:12288
ds_read_b64_tr_b16 a[178:179], v8 offset:13312
ds_read_b64_tr_b16 a[180:181], v9 offset:12288
ds_read_b64_tr_b16 a[182:183], v9 offset:13312
ds_read_b64_tr_b16 a[184:185], v10 offset:12288
ds_read_b64_tr_b16 a[186:187], v10 offset:13312
ds_read_b64_tr_b16 a[188:189], v11 offset:12288
ds_read_b64_tr_b16 a[190:191], v11 offset:13312
s_waitcnt lgkmcnt(0)
s_mul_i32 s25, s33, 36
s_add_u32 m0, s26, 12288
s_add_u32 s24, s25, 110592
buffer_load_dwordx4 v2, s[20:23], s24 offen lds
s_add_u32 m0, s26, 13312
s_add_u32 s24, s25, 119808
buffer_load_dwordx4 v2, s[20:23], s24 offen lds
s_add_u32 m0, s26, 14336
s_add_u32 s24, s25, 129024
buffer_load_dwordx4 v2, s[20:23], s24 offen lds
s_add_u32 m0, s26, 15360
s_add_u32 s24, s25, 138240
buffer_load_dwordx4 v2, s[20:23], s24 offen lds
s_waitcnt vmcnt(28)
ds_read_b64_tr_b16 a[192:193], v8 offset:16384
ds_read_b64_tr_b16 a[194:195], v8 offset:17408
ds_read_b64_tr_b16 a[196:197], v9 offset:16384
ds_read_b64_tr_b16 a[198:199], v9 offset:17408
ds_read_b64_tr_b16 a[200:201], v10 offset:16384
ds_read_b64_tr_b16 a[202:203], v10 offset:17408
ds_read_b64_tr_b16 a[204:205], v11 offset:16384
ds_read_b64_tr_b16 a[206:207], v11 offset:17408
s_waitcnt lgkmcnt(0)
s_mul_i32 s25, s34, 36
s_add_u32 m0, s26, 16384
s_add_u32 s24, s25, 110592
buffer_load_dwordx4 v2, s[20:23], s24 offen lds
s_add_u32 m0, s26, 17408
s_add_u32 s24, s25, 119808
buffer_load_dwordx4 v2, s[20:23], s24 offen lds
s_add_u32 m0, s26, 18432
s_add_u32 s24, s25, 129024
buffer_load_dwordx4 v2, s[20:23], s24 offen lds
s_add_u32 m0, s26, 19456
s_add_u32 s24, s25, 138240
buffer_load_dwordx4 v2, s[20:23], s24 offen lds
s_waitcnt vmcnt(28)
ds_read_b64_tr_b16 a[208:209], v8 offset:20480
ds_read_b64_tr_b16 a[210:211], v8 offset:21504
ds_read_b64_tr_b16 a[212:213], v9 offset:20480
ds_read_b64_tr_b16 a[214:215], v9 offset:21504
ds_read_b64_tr_b16 a[216:217], v10 offset:20480
ds_read_b64_tr_b16 a[218:219], v10 offset:21504
ds_read_b64_tr_b16 a[220:221], v11 offset:20480
ds_read_b64_tr_b16 a[222:223], v11 offset:21504
s_waitcnt lgkmcnt(0)
s_mul_i32 s25, s35, 36
s_add_u32 m0, s26, 20480
s_add_u32 s24, s25, 110592
buffer_load_dwordx4 v2, s[20:23], s24 offen lds
s_add_u32 m0, s26, 21504
s_add_u32 s24, s25, 119808
buffer_load_dwordx4 v2, s[20:23], s24 offen lds
s_add_u32 m0, s26, 22528
s_add_u32 s24, s25, 129024
buffer_load_dwordx4 v2, s[20:23], s24 offen lds
s_add_u32 m0, s26, 23552
s_add_u32 s24, s25, 138240
buffer_load_dwordx4 v2, s[20:23], s24 offen lds
s_waitcnt vmcnt(28)
ds_read_b64_tr_b16 a[224:225], v8 offset:24576
ds_read_b64_tr_b16 a[226:227], v8 offset:25600
ds_read_b64_tr_b16 a[228:229], v9 offset:24576
ds_read_b64_tr_b16 a[230:231], v9 offset:25600
ds_read_b64_tr_b16 a[232:233], v10 offset:24576
ds_read_b64_tr_b16 a[234:235], v10 offset:25600
ds_read_b64_tr_b16 a[236:237], v11 offset:24576
ds_read_b64_tr_b16 a[238:239], v11 offset:25600
s_waitcnt lgkmcnt(0)
s_mul_i32 s25, s36, 36
s_add_u32 m0, s26, 24576
s_add_u32 s24, s25, 110592
buffer_load_dwordx4 v2, s[20:23], s24 offen lds
s_add_u32 m0, s26, 25600
s_add_u32 s24, s25, 119808
buffer_load_dwordx4 v2, s[20:23], s24 offen lds
s_add_u32 m0, s26, 26624
s_add_u32 s24, s25, 129024
buffer_load_dwordx4 v2, s[20:23], s24 offen lds
s_add_u32 m0, s26, 27648
s_add_u32 s24, s25, 138240
buffer_load_dwordx4 v2, s[20:23], s24 offen lds
s_waitcnt vmcnt(28)
ds_read_b64_tr_b16 a[240:241], v8 offset:28672
ds_read_b64_tr_b16 a[242:243], v8 offset:29696
ds_read_b64_tr_b16 a[244:245], v9 offset:28672
ds_read_b64_tr_b16 a[246:247], v9 offset:29696
ds_read_b64_tr_b16 a[248:249], v10 offset:28672
ds_read_b64_tr_b16 a[250:251], v10 offset:29696
ds_read_b64_tr_b16 a[252:253], v11 offset:28672
ds_read_b64_tr_b16 a[254:255], v11 offset:29696
s_waitcnt lgkmcnt(0)
s_mul_i32 s25, s37, 36
s_add_u32 m0, s26, 28672
s_add_u32 s24, s25, 110592
buffer_load_dwordx4 v2, s[20:23], s24 offen lds
s_add_u32 m0, s26, 29696
s_add_u32 s24, s25, 119808
buffer_load_dwordx4 v2, s[20:23], s24 offen lds
s_add_u32 m0, s26, 30720
s_add_u32 s24, s25, 129024
buffer_load_dwordx4 v2, s[20:23], s24 offen lds
s_add_u32 m0, s26, 31744
s_add_u32 s24, s25, 138240
buffer_load_dwordx4 v2, s[20:23], s24 offen lds
s_waitcnt vmcnt(0)
v_and_b32 v12, 15, v0
v_mul_u32_u24 v12, 2304, v12
v_lshrrev_b32 v13, 4, v0
v_lshl_add_u32 v12, v13, 3, v12
s_lshl_b32 s24, s40, 7
s_add_u32 s24, s24, s47
v_add_u32 v4, s24, v12
v_and_b32 v5, 7, v0
v_lshlrev_b32 v5, 2, v5
s_lshl_b32 s24, s17, 5
v_add_u32 v5, s24, v5
v_lshlrev_b32 v3, 4, v0
v_add_u32 v3, 131072, v3
s_lshl_b32 s24, s17, 12
s_add_u32 s24, s24, 131072
v_add_u32 v7, s24, v1
s_lshl_b32 s24, s17, 15
s_add_u32 s44, s44, s24
s_ff1_i32_b64 s41, s[42:43]
s_bitset0_b64 s[42:43], s41
s_lshl_b32 s41, s41, 1
s_xor_b32 s41, s41, s51
s_and_b32 s41, s41, 127
L_opl_w:
s_lshr_b32 s25, s41, s46
s_lshl_b32 s25, s25, 7
s_add_u32 s25, s25, s45
s_mov_b32 s28, 0
L_poll_47:
buffer_load_dword v6, v5, s[8:11], s25 offen sc1
s_add_u32 s28, s28, 1
s_cmp_gt_u32 s28, 40000
s_cbranch_scc1 L_end
s_waitcnt vmcnt(0)
v_cmp_ne_u32 vcc, 1, v6
s_cbranch_vccz L_pd_48
s_sleep 1
s_cmp_lt_u32 s28, 32
s_cbranch_scc1 L_poll_47
s_sleep 32
s_branch L_poll_47
L_pd_48:
s_lshl_b32 s48, s41, 17
s_add_u32 s48, s48, s44
s_add_u32 s24, s48, s30
buffer_load_dwordx4 v[16:19], v1, s[8:11], s24 offen sc1
buffer_load_dwordx4 v[20:23], v1, s[8:11], s24 offen offset:1024 sc1
buffer_load_dwordx4 v[24:27], v1, s[8:11], s24 offen offset:2048 sc1
buffer_load_dwordx4 v[28:31], v1, s[8:11], s24 offen offset:3072 sc1
s_add_u32 s24, s48, s31
buffer_load_dwordx4 v[32:35], v1, s[8:11], s24 offen sc1
buffer_load_dwordx4 v[36:39], v1, s[8:11], s24 offen offset:1024 sc1
buffer_load_dwordx4 v[40:43], v1, s[8:11], s24 offen offset:2048 sc1
buffer_load_dwordx4 v[44:47], v1, s[8:11], s24 offen offset:3072 sc1
s_add_u32 s24, s48, s32
buffer_load_dwordx4 v[48:51], v1, s[8:11], s24 offen sc1
buffer_load_dwordx4 v[52:55], v1, s[8:11], s24 offen offset:1024 sc1
buffer_load_dwordx4 v[56:59], v1, s[8:11], s24 offen offset:2048 sc1
buffer_load_dwordx4 v[60:63], v1, s[8:11], s24 offen offset:3072 sc1
s_add_u32 s24, s48, s33
buffer_load_dwordx4 v[64:67], v1, s[8:11], s24 offen sc1
buffer_load_dwordx4 v[68:71], v1, s[8:11], s24 offen offset:1024 sc1
buffer_load_dwordx4 v[72:75], v1, s[8:11], s24 offen offset:2048 sc1
buffer_load_dwordx4 v[76:79], v1, s[8:11], s24 offen offset:3072 sc1
s_waitcnt vmcnt(15)
v_mfma_f32_16x16x32_bf16 v[80:83], v[128:131], v[16:19], 0
s_cmp_lg_u64 s[42:43], 0
s_cselect_b32 s52, 1, 0
ds_read_b64_tr_b16 v[112:113], v8
v_mfma_f32_16x16x32_bf16 v[84:87], v[132:135], v[16:19], 0
s_ff1_i32_b64 s27, s[42:43]
ds_read_b64_tr_b16 v[114:115], v8 offset:1024
v_mfma_f32_16x16x32_bf16 v[88:91], v[136:139], v[16:19], 0
s_bitset0_b64 s[42:43], s27
s_add_u32 s24, s48, s34
ds_read_b64_tr_b16 v[116:117], v9
v_mfma_f32_16x16x32_bf16 v[92:95], v[140:143], v[16:19], 0
s_lshl_b32 s27, s27, 1
ds_read_b64_tr_b16 v[118:119], v9 offset:1024
buffer_load_dwordx4 v[16:19], v1, s[8:11], s24 offen sc1
s_waitcnt vmcnt(15)
v_mfma_f32_16x16x32_bf16 v[80:83], v[144:147], v[20:23], v[80:83]
s_xor_b32 s27, s27, s51
ds_read_b64_tr_b16 v[120:121], v10
v_mfma_f32_16x16x32_bf16 v[84:87], v[148:151], v[20:23], v[84:87]
s_and_b32 s27, s27, 127
ds_read_b64_tr_b16 v[122:123], v10 offset:1024
v_mfma_f32_16x16x32_bf16 v[88:91], v[152:155], v[20:23], v[88:91]
s_lshr_b32 s25, s27, s46
ds_read_b64_tr_b16 v[124:125], v11
v_mfma_f32_16x16x32_bf16 v[92:95], v[156:159], v[20:23], v[92:95]
s_lshl_b32 s25, s25, 7
ds_read_b64_tr_b16 v[126:127], v11 offset:1024
buffer_load_dwordx4 v[20:23], v1, s[8:11], s24 offen offset:1024 sc1
s_waitcnt vmcnt(15)
v_mfma_f32_16x16x32_bf16 v[80:83], v[160:163], v[24:27], v[80:83]
s_add_u32 s25, s25, s45
v_mfma_f32_16x16x32_bf16 v[84:87], v[164:167], v[24:27], v[84:87]
s_lshl_b32 s49, s27, 17
v_mfma_f32_16x16x32_bf16 v[88:91], v[168:171], v[24:27], v[88:91]
s_add_u32 s49, s49, s44
v_mfma_f32_16x16x32_bf16 v[92:95], v[172:175], v[24:27], v[92:95]
buffer_load_dwordx4 v[24:27], v1, s[8:11], s24 offen offset:2048 sc1
buffer_load_dword v6, v5, s[8:11], s25 offen sc1
s_waitcnt vmcnt(16) lgkmcnt(0)
v_mfma_f32_16x16x32_bf16 v[80:83], v[112:115], v[28:31], v[80:83]
v_mfma_f32_16x16x32_bf16 v[84:87], v[116:119], v[28:31], v[84:87]
v_mfma_f32_16x16x32_bf16 v[88:91], v[120:123], v[28:31], v[88:91]
v_mfma_f32_16x16x32_bf16 v[92:95], v[124:127], v[28:31], v[92:95]
buffer_load_dwordx4 v[28:31], v1, s[8:11], s24 offen offset:3072 sc1
s_waitcnt vmcnt(16)
v_mfma_f32_16x16x32_bf16 v[80:83], v[176:179], v[32:35], v[80:83]
ds_read_b64_tr_b16 v[112:113], v8 offset:4096
v_mfma_f32_16x16x32_bf16 v[84:87], v[180:183], v[32:35], v[84:87]
ds_read_b64_tr_b16 v[114:115], v8 offset:5120
v_mfma_f32_16x16x32_bf16 v[88:91], v[184:187], v[32:35], v[88:91]
s_add_u32 s24, s48, s35
ds_read_b64_tr_b16 v[116:117], v9 offset:4096
v_mfma_f32_16x16x32_bf16 v[92:95], v[188:191], v[32:35], v[92:95]
ds_read_b64_tr_b16 v[118:119], v9 offset:5120
buffer_load_dwordx4 v[32:35], v1, s[8:11], s24 offen sc1
s_waitcnt vmcnt(16)
v_mfma_f32_16x16x32_bf16 v[80:83], v[192:195], v[36:39], v[80:83]
ds_read_b64_tr_b16 v[120:121], v10 offset:4096
v_mfma_f32_16x16x32_bf16 v[84:87], v[196:199], v[36:39], v[84:87]
ds_read_b64_tr_b16 v[122:123], v10 offset:5120
v_mfma_f32_16x16x32_bf16 v[88:91], v[200:203], v[36:39], v[88:91]
ds_read_b64_tr_b16 v[124:125], v11 offset:4096
v_mfma_f32_16x16x32_bf16 v[92:95], v[204:207], v[36:39], v[92:95]
ds_read_b64_tr_b16 v[126:127], v11 offset:5120
buffer_load_dwordx4 v[36:39], v1, s[8:11], s24 offen offset:1024 sc1
s_waitcnt vmcnt(16)
v_mfma_f32_16x16x32_bf16 v[80:83], v[208:211], v[40:43], v[80:83]
v_mfma_f32_16x16x32_bf16 v[84:87], v[212:215], v[40:43], v[84:87]
v_mfma_f32_16x16x32_bf16 v[88:91], v[216:219], v[40:43], v[88:91]
v_mfma_f32_16x16x32_bf16 v[92:95], v[220:223], v[40:43], v[92:95]
buffer_load_dwordx4 v[40:43], v1, s[8:11], s24 offen offset:2048 sc1
s_waitcnt vmcnt(16) lgkmcnt(0)
v_mfma_f32_16x16x32_bf16 v[80:83], v[112:115], v[44:47], v[80:83]
v_mfma_f32_16x16x32_bf16 v[84:87], v[116:119], v[44:47], v[84:87]
v_mfma_f32_16x16x32_bf16 v[88:91], v[120:123], v[44:47], v[88:91]
v_mfma_f32_16x16x32_bf16 v[92:95], v[124:127], v[44:47], v[92:95]
buffer_load_dwordx4 v[44:47], v1, s[8:11], s24 offen offset:3072 sc1
s_waitcnt vmcnt(16)
v_mfma_f32_16x16x32_bf16 v[80:83], v[224:227], v[48:51], v[80:83]
ds_read_b64_tr_b16 v[112:113], v8 offset:8192
v_mfma_f32_16x16x32_bf16 v[84:87], v[228:231], v[48:51], v[84:87]
ds_read_b64_tr_b16 v[114:115], v8 offset:9216
v_mfma_f32_16x16x32_bf16 v[88:91], v[232:235], v[48:51], v[88:91]
s_add_u32 s24, s48, s36
ds_read_b64_tr_b16 v[116:117], v9 offset:8192
v_mfma_f32_16x16x32_bf16 v[92:95], v[236:239], v[48:51], v[92:95]
ds_read_b64_tr_b16 v[118:119], v9 offset:9216
buffer_load_dwordx4 v[48:51], v1, s[8:11], s24 offen sc1
s_waitcnt vmcnt(16)
v_mfma_f32_16x16x32_bf16 v[80:83], v[240:243], v[52:55], v[80:83]
ds_read_b64_tr_b16 v[120:121], v10 offset:8192
v_mfma_f32_16x16x32_bf16 v[84:87], v[244:247], v[52:55], v[84:87]
ds_read_b64_tr_b16 v[122:123], v10 offset:9216
v_mfma_f32_16x16x32_bf16 v[88:91], v[248:251], v[52:55], v[88:91]
ds_read_b64_tr_b16 v[124:125], v11 offset:8192
v_mfma_f32_16x16x32_bf16 v[92:95], v[252:255], v[52:55], v[92:95]
ds_read_b64_tr_b16 v[126:127], v11 offset:9216
buffer_load_dwordx4 v[52:55], v1, s[8:11], s24 offen offset:1024 sc1
s_waitcnt vmcnt(16)
v_mfma_f32_16x16x32_bf16 v[80:83], a[0:3], v[56:59], v[80:83]
v_mfma_f32_16x16x32_bf16 v[84:87], a[4:7], v[56:59], v[84:87]
v_mfma_f32_16x16x32_bf16 v[88:91], a[8:11], v[56:59], v[88:91]
v_mfma_f32_16x16x32_bf16 v[92:95], a[12:15], v[56:59], v[92:95]
buffer_load_dwordx4 v[56:59], v1, s[8:11], s24 offen offset:2048 sc1
s_waitcnt vmcnt(16) lgkmcnt(0)
v_mfma_f32_16x16x32_bf16 v[80:83], v[112:115], v[60:63], v[80:83]
v_mfma_f32_16x16x32_bf16 v[84:87], v[116:119], v[60:63], v[84:87]
v_mfma_f32_16x16x32_bf16 v[88:91], v[120:123], v[60:63], v[88:91]
v_mfma_f32_16x16x32_bf16 v[92:95], v[124:127], v[60:63], v[92:95]
buffer_load_dwordx4 v[60:63], v1, s[8:11], s24 offen offset:3072 sc1
s_waitcnt vmcnt(16)
v_mfma_f32_16x16x32_bf16 v[80:83], a[16:19], v[64:67], v[80:83]
ds_read_b64_tr_b16 v[112:113], v8 offset:12288
v_mfma_f32_16x16x32_bf16 v[84:87], a[20:23], v[64:67], v[84:87]
ds_read_b64_tr_b16 v[114:115], v8 offset:13312
v_mfma_f32_16x16x32_bf16 v[88:91], a[24:27], v[64:67], v[88:91]
s_add_u32 s24, s48, s37
ds_read_b64_tr_b16 v[116:117], v9 offset:12288
v_mfma_f32_16x16x32_bf16 v[92:95], a[28:31], v[64:67], v[92:95]
ds_read_b64_tr_b16 v[118:119], v9 offset:13312
buffer_load_dwordx4 v[64:67], v1, s[8:11], s24 offen sc1
s_waitcnt vmcnt(16)
v_mfma_f32_16x16x32_bf16 v[80:83], a[32:35], v[68:71], v[80:83]
ds_read_b64_tr_b16 v[120:121], v10 offset:12288
v_mfma_f32_16x16x32_bf16 v[84:87], a[36:39], v[68:71], v[84:87]
ds_read_b64_tr_b16 v[122:123], v10 offset:13312
v_mfma_f32_16x16x32_bf16 v[88:91], a[40:43], v[68:71], v[88:91]
ds_read_b64_tr_b16 v[124:125], v11 offset:12288
v_mfma_f32_16x16x32_bf16 v[92:95], a[44:47], v[68:71], v[92:95]
ds_read_b64_tr_b16 v[126:127], v11 offset:13312
buffer_load_dwordx4 v[68:71], v1, s[8:11], s24 offen offset:1024 sc1
buffer_load_dword v6, v5, s[8:11], s25 offen sc1
s_branch L_opl_t0
L_opl_r0:
s_waitcnt vmcnt(15)
v_mfma_f32_16x16x32_bf16 v[80:83], v[128:131], v[16:19], 0
s_cmp_lg_u64 s[42:43], 0
s_cselect_b32 s52, 1, 0
ds_read_b64_tr_b16 v[112:113], v8
v_mfma_f32_16x16x32_bf16 v[84:87], v[132:135], v[16:19], 0
s_ff1_i32_b64 s27, s[42:43]
ds_read_b64_tr_b16 v[114:115], v8 offset:1024
v_mfma_f32_16x16x32_bf16 v[88:91], v[136:139], v[16:19], 0
s_bitset0_b64 s[42:43], s27
s_add_u32 s24, s48, s34
ds_read_b64_tr_b16 v[116:117], v9
v_mfma_f32_16x16x32_bf16 v[92:95], v[140:143], v[16:19], 0
s_lshl_b32 s27, s27, 1
ds_read_b64_tr_b16 v[118:119], v9 offset:1024
buffer_load_dwordx4 v[16:19], v1, s[8:11], s24 offen sc1
s_waitcnt vmcnt(15)
v_mfma_f32_16x16x32_bf16 v[80:83], v[144:147], v[20:23], v[80:83]
s_xor_b32 s27, s27, s51
ds_read_b64_tr_b16 v[120:121], v10
v_mfma_f32_16x16x32_bf16 v[84:87], v[148:151], v[20:23], v[84:87]
s_and_b32 s27, s27, 127
ds_read_b64_tr_b16 v[122:123], v10 offset:1024
v_mfma_f32_16x16x32_bf16 v[88:91], v[152:155], v[20:23], v[88:91]
s_lshr_b32 s25, s27, s46
ds_read_b64_tr_b16 v[124:125], v11
v_mfma_f32_16x16x32_bf16 v[92:95], v[156:159], v[20:23], v[92:95]
s_lshl_b32 s25, s25, 7
ds_read_b64_tr_b16 v[126:127], v11 offset:1024
buffer_load_dwordx4 v[20:23], v1, s[8:11], s24 offen offset:1024 sc1
s_waitcnt vmcnt(15)
v_mfma_f32_16x16x32_bf16 v[80:83], v[160:163], v[24:27], v[80:83]
s_add_u32 s25, s25, s45
v_mfma_f32_16x16x32_bf16 v[84:87], v[164:167], v[24:27], v[84:87]
s_lshl_b32 s49, s27, 17
v_mfma_f32_16x16x32_bf16 v[88:91], v[168:171], v[24:27], v[88:91]
s_add_u32 s49, s49, s44
v_mfma_f32_16x16x32_bf16 v[92:95], v[172:175], v[24:27], v[92:95]
buffer_load_dwordx4 v[24:27], v1, s[8:11], s24 offen offset:2048 sc1
buffer_load_dword v6, v5, s[8:11], s25 offen sc1
s_waitcnt vmcnt(16) lgkmcnt(0)
v_mfma_f32_16x16x32_bf16 v[80:83], v[112:115], v[28:31], v[80:83]
ds_write_b128 v3, v[96:99]
v_mfma_f32_16x16x32_bf16 v[84:87], v[116:119], v[28:31], v[84:87]
ds_write_b128 v3, v[100:103] offset:4096
v_mfma_f32_16x16x32_bf16 v[88:91], v[120:123], v[28:31], v[88:91]
ds_write_b128 v3, v[104:107] offset:8192
v_mfma_f32_16x16x32_bf16 v[92:95], v[124:127], v[28:31], v[92:95]
ds_write_b128 v3, v[108:111] offset:12288
buffer_load_dwordx4 v[28:31], v1, s[8:11], s24 offen offset:3072 sc1
s_waitcnt vmcnt(16)
v_mfma_f32_16x16x32_bf16 v[80:83], v[176:179], v[32:35], v[80:83]
ds_read_b64_tr_b16 v[112:113], v8 offset:4096
v_mfma_f32_16x16x32_bf16 v[84:87], v[180:183], v[32:35], v[84:87]
ds_read_b64_tr_b16 v[114:115], v8 offset:5120
v_mfma_f32_16x16x32_bf16 v[88:91], v[184:187], v[32:35], v[88:91]
s_add_u32 s24, s48, s35
ds_read_b64_tr_b16 v[116:117], v9 offset:4096
v_mfma_f32_16x16x32_bf16 v[92:95], v[188:191], v[32:35], v[92:95]
ds_read_b64_tr_b16 v[118:119], v9 offset:5120
buffer_load_dwordx4 v[32:35], v1, s[8:11], s24 offen sc1
s_waitcnt vmcnt(16)
v_mfma_f32_16x16x32_bf16 v[80:83], v[192:195], v[36:39], v[80:83]
ds_read_b64_tr_b16 v[120:121], v10 offset:4096
v_mfma_f32_16x16x32_bf16 v[84:87], v[196:199], v[36:39], v[84:87]
ds_read_b64_tr_b16 v[122:123], v10 offset:5120
v_mfma_f32_16x16x32_bf16 v[88:91], v[200:203], v[36:39], v[88:91]
ds_read_b64_tr_b16 v[124:125], v11 offset:4096
v_mfma_f32_16x16x32_bf16 v[92:95], v[204:207], v[36:39], v[92:95]
ds_read_b64_tr_b16 v[126:127], v11 offset:5120
buffer_load_dwordx4 v[36:39], v1, s[8:11], s24 offen offset:1024 sc1
s_waitcnt vmcnt(16)
v_mfma_f32_16x16x32_bf16 v[80:83], v[208:211], v[40:43], v[80:83]
v_mfma_f32_16x16x32_bf16 v[84:87], v[212:215], v[40:43], v[84:87]
v_mfma_f32_16x16x32_bf16 v[88:91], v[216:219], v[40:43], v[88:91]
v_mfma_f32_16x16x32_bf16 v[92:95], v[220:223], v[40:43], v[92:95]
buffer_load_dwordx4 v[40:43], v1, s[8:11], s24 offen offset:2048 sc1
s_waitcnt vmcnt(16) lgkmcnt(0)
s_barrier
v_mfma_f32_16x16x32_bf16 v[80:83], v[112:115], v[44:47], v[80:83]
ds_read_b128 v[96:99], v7
v_mfma_f32_16x16x32_bf16 v[84:87], v[116:119], v[44:47], v[84:87]
ds_read_b128 v[100:103], v7 offset:1024
v_mfma_f32_16x16x32_bf16 v[88:91], v[120:123], v[44:47], v[88:91]
ds_read_b128 v[104:107], v7 offset:2048
v_mfma_f32_16x16x32_bf16 v[92:95], v[124:127], v[44:47], v[92:95]
ds_read_b128 v[108:111], v7 offset:3072
buffer_load_dwordx4 v[44:47], v1, s[8:11], s24 offen offset:3072 sc1
s_waitcnt vmcnt(16)
v_mfma_f32_16x16x32_bf16 v[80:83], v[224:227], v[48:51], v[80:83]
ds_read_b64_tr_b16 v[112:113], v8 offset:8192
v_mfma_f32_16x16x32_bf16 v[84:87], v[228:231], v[48:51], v[84:87]
ds_read_b64_tr_b16 v[114:115], v8 offset:9216
v_mfma_f32_16x16x32_bf16 v[88:91], v[232:235], v[48:51], v[88:91]
s_add_u32 s24, s48, s36
ds_read_b64_tr_b16 v[116:117], v9 offset:8192
v_mfma_f32_16x16x32_bf16 v[92:95], v[236:239], v[48:51], v[92:95]
ds_read_b64_tr_b16 v[118:119], v9 offset:9216
buffer_load_dwordx4 v[48:51], v1, s[8:11], s24 offen sc1
s_waitcnt vmcnt(16)
v_mfma_f32_16x16x32_bf16 v[80:83], v[240:243], v[52:55], v[80:83]
ds_read_b64_tr_b16 v[120:121], v10 offset:8192
v_mfma_f32_16x16x32_bf16 v[84:87], v[244:247], v[52:55], v[84:87]
ds_read_b64_tr_b16 v[122:123], v10 offset:9216
v_mfma_f32_16x16x32_bf16 v[88:91], v[248:251], v[52:55], v[88:91]
ds_read_b64_tr_b16 v[124:125], v11 offset:8192
v_mfma_f32_16x16x32_bf16 v[92:95], v[252:255], v[52:55], v[92:95]
ds_read_b64_tr_b16 v[126:127], v11 offset:9216
buffer_load_dwordx4 v[52:55], v1, s[8:11], s24 offen offset:1024 sc1
s_waitcnt vmcnt(16)
v_mfma_f32_16x16x32_bf16 v[80:83], a[0:3], v[56:59], v[80:83]
v_mfma_f32_16x16x32_bf16 v[84:87], a[4:7], v[56:59], v[84:87]
v_mfma_f32_16x16x32_bf16 v[88:91], a[8:11], v[56:59], v[88:91]
v_mfma_f32_16x16x32_bf16 v[92:95], a[12:15], v[56:59], v[92:95]
buffer_load_dwordx4 v[56:59], v1, s[8:11], s24 offen offset:2048 sc1
s_waitcnt vmcnt(16) lgkmcnt(0)
v_mfma_f32_16x16x32_bf16 v[80:83], v[112:115], v[60:63], v[80:83]
v_add_f32 v96, v96, v100
v_add_f32 v97, v97, v101
v_mfma_f32_16x16x32_bf16 v[84:87], v[116:119], v[60:63], v[84:87]
v_add_f32 v98, v98, v102
v_add_f32 v99, v99, v103
v_mfma_f32_16x16x32_bf16 v[88:91], v[120:123], v[60:63], v[88:91]
v_add_f32 v96, v96, v104
v_add_f32 v97, v97, v105
v_mfma_f32_16x16x32_bf16 v[92:95], v[124:127], v[60:63], v[92:95]
v_add_f32 v98, v98, v106
v_add_f32 v99, v99, v107
buffer_load_dwordx4 v[60:63], v1, s[8:11], s24 offen offset:3072 sc1
s_waitcnt vmcnt(16)
v_mfma_f32_16x16x32_bf16 v[80:83], a[16:19], v[64:67], v[80:83]
ds_read_b64_tr_b16 v[112:113], v8 offset:12288
v_add_f32 v96, v96, v108
v_mfma_f32_16x16x32_bf16 v[84:87], a[20:23], v[64:67], v[84:87]
ds_read_b64_tr_b16 v[114:115], v8 offset:13312
v_add_f32 v97, v97, v109
v_mfma_f32_16x16x32_bf16 v[88:91], a[24:27], v[64:67], v[88:91]
s_add_u32 s24, s48, s37
ds_read_b64_tr_b16 v[116:117], v9 offset:12288
v_add_f32 v98, v98, v110
v_mfma_f32_16x16x32_bf16 v[92:95], a[28:31], v[64:67], v[92:95]
ds_read_b64_tr_b16 v[118:119], v9 offset:13312
v_add_f32 v99, v99, v111
buffer_load_dwordx4 v[64:67], v1, s[8:11], s24 offen sc1
s_waitcnt vmcnt(16)
v_mfma_f32_16x16x32_bf16 v[80:83], a[32:35], v[68:71], v[80:83]
ds_read_b64_tr_b16 v[120:121], v10 offset:12288
v_cvt_pk_bf16_f32 v12, v96, v97
v_mfma_f32_16x16x32_bf16 v[84:87], a[36:39], v[68:71], v[84:87]
ds_read_b64_tr_b16 v[122:123], v10 offset:13312
v_cvt_pk_bf16_f32 v13, v98, v99
v_mfma_f32_16x16x32_bf16 v[88:91], a[40:43], v[68:71], v[88:91]
ds_read_b64_tr_b16 v[124:125], v11 offset:12288
v_xor_b32 v3, 16384, v3
v_mfma_f32_16x16x32_bf16 v[92:95], a[44:47], v[68:71], v[92:95]
ds_read_b64_tr_b16 v[126:127], v11 offset:13312
v_xor_b32 v7, 16384, v7
buffer_load_dwordx4 v[68:71], v1, s[8:11], s24 offen offset:1024 sc1
buffer_store_dwordx2 v[12:13], v4, s[12:15], s53 offen
L_opl_t0:
s_waitcnt vmcnt(17)
v_mfma_f32_16x16x32_bf16 v[80:83], a[48:51], v[72:75], v[80:83]
v_mfma_f32_16x16x32_bf16 v[84:87], a[52:55], v[72:75], v[84:87]
v_mfma_f32_16x16x32_bf16 v[88:91], a[56:59], v[72:75], v[88:91]
v_mfma_f32_16x16x32_bf16 v[92:95], a[60:63], v[72:75], v[92:95]
buffer_load_dwordx4 v[72:75], v1, s[8:11], s24 offen offset:2048 sc1
s_waitcnt vmcnt(17) lgkmcnt(0)
v_mfma_f32_16x16x32_bf16 v[80:83], v[112:115], v[76:79], v[80:83]
s_waitcnt vmcnt(13)
v_cmp_ne_u32 vcc, 1, v6
v_mfma_f32_16x16x32_bf16 v[84:87], v[116:119], v[76:79], v[84:87]
v_mfma_f32_16x16x32_bf16 v[88:91], v[120:123], v[76:79], v[88:91]
s_cmp_eq_u64 vcc, 0
s_cselect_b32 s50, s52, 0
v_mfma_f32_16x16x32_bf16 v[92:95], v[124:127], v[76:79], v[92:95]
buffer_load_dwordx4 v[76:79], v1, s[8:11], s24 offen offset:3072 sc1
s_waitcnt vmcnt(17)
v_mfma_f32_16x16x32_bf16 v[80:83], a[64:67], v[16:19], v[80:83]
s_cmp_eq_u32 s50, 1
s_cselect_b32 s49, s49, 536870912
ds_read_b64_tr_b16 v[112:113], v8 offset:16384
v_mfma_f32_16x16x32_bf16 v[84:87], a[68:71], v[16:19], v[84:87]
ds_read_b64_tr_b16 v[114:115], v8 offset:17408
v_mfma_f32_16x16x32_bf16 v[88:91], a[72:75], v[16:19], v[88:91]
s_add_u32 s24, s49, s30
ds_read_b64_tr_b16 v[116:117], v9 offset:16384
v_mfma_f32_16x16x32_bf16 v[92:95], a[76:79], v[16:19], v[92:95]
ds_read_b64_tr_b16 v[118:119], v9 offset:17408
buffer_load_dwordx4 v[16:19], v1, s[8:11], s24 offen sc1
s_waitcnt vmcnt(17)
v_mfma_f32_16x16x32_bf16 v[80:83], a[80:83], v[20:23], v[80:83]
ds_read_b64_tr_b16 v[120:121], v10 offset:16384
v_mfma_f32_16x16x32_bf16 v[84:87], a[84:87], v[20:23], v[84:87]
ds_read_b64_tr_b16 v[122:123], v10 offset:17408
v_mfma_f32_16x16x32_bf16 v[88:91], a[88:91], v[20:23], v[88:91]
ds_read_b64_tr_b16 v[124:125], v11 offset:16384
v_mfma_f32_16x16x32_bf16 v[92:95], a[92:95], v[20:23], v[92:95]
ds_read_b64_tr_b16 v[126:127], v11 offset:17408
buffer_load_dwordx4 v[20:23], v1, s[8:11], s24 offen offset:1024 sc1
s_waitcnt vmcnt(17)
v_mfma_f32_16x16x32_bf16 v[80:83], a[96:99], v[24:27], v[80:83]
v_mfma_f32_16x16x32_bf16 v[84:87], a[100:103], v[24:27], v[84:87]
v_mfma_f32_16x16x32_bf16 v[88:91], a[104:107], v[24:27], v[88:91]
v_mfma_f32_16x16x32_bf16 v[92:95], a[108:111], v[24:27], v[92:95]
buffer_load_dwordx4 v[24:27], v1, s[8:11], s24 offen offset:2048 sc1
s_waitcnt vmcnt(16) lgkmcnt(0)
v_mfma_f32_16x16x32_bf16 v[80:83], v[112:115], v[28:31], v[80:83]
v_mfma_f32_16x16x32_bf16 v[84:87], v[116:119], v[28:31], v[84:87]
v_mfma_f32_16x16x32_bf16 v[88:91], v[120:123], v[28:31], v[88:91]
v_mfma_f32_16x16x32_bf16 v[92:95], v[124:127], v[28:31], v[92:95]
buffer_load_dwordx4 v[28:31], v1, s[8:11], s24 offen offset:3072 sc1
s_waitcnt vmcnt(16)
v_mfma_f32_16x16x32_bf16 v[80:83], a[112:115], v[32:35], v[80:83]
ds_read_b64_tr_b16 v[112:113], v8 offset:20480
v_mfma_f32_16x16x32_bf16 v[84:87], a[116:119], v[32:35], v[84:87]
ds_read_b64_tr_b16 v[114:115], v8 offset:21504
v_mfma_f32_16x16x32_bf16 v[88:91], a[120:123], v[32:35], v[88:91]
s_add_u32 s24, s49, s31
ds_read_b64_tr_b16 v[116:117], v9 offset:20480
v_mfma_f32_16x16x32_bf16 v[92:95], a[124:127], v[32:35], v[92:95]
ds_read_b64_tr_b16 v[118:119], v9 offset:21504
buffer_load_dwordx4 v[32:35], v1, s[8:11], s24 offen sc1
s_waitcnt vmcnt(16)
v_mfma_f32_16x16x32_bf16 v[80:83], a[128:131], v[36:39], v[80:83]
ds_read_b64_tr_b16 v[120:121], v10 offset:20480
v_mfma_f32_16x16x32_bf16 v[84:87], a[132:135], v[36:39], v[84:87]
ds_read_b64_tr_b16 v[122:123], v10 offset:21504
v_mfma_f32_16x16x32_bf16 v[88:91], a[136:139], v[36:39], v[88:91]
ds_read_b64_tr_b16 v[124:125], v11 offset:20480
v_mfma_f32_16x16x32_bf16 v[92:95], a[140:143], v[36:39], v[92:95]
ds_read_b64_tr_b16 v[126:127], v11 offset:21504
buffer_load_dwordx4 v[36:39], v1, s[8:11], s24 offen offset:1024 sc1
s_waitcnt vmcnt(16)
v_mfma_f32_16x16x32_bf16 v[80:83], a[144:147], v[40:43], v[80:83]
v_mfma_f32_16x16x32_bf16 v[84:87], a[148:151], v[40:43], v[84:87]
v_mfma_f32_16x16x32_bf16 v[88:91], a[152:155], v[40:43], v[88:91]
v_mfma_f32_16x16x32_bf16 v[92:95], a[156:159], v[40:43], v[92:95]
buffer_load_dwordx4 v[40:43], v1, s[8:11], s24 offen offset:2048 sc1
s_waitcnt vmcnt(16) lgkmcnt(0)
v_mfma_f32_16x16x32_bf16 v[80:83], v[112:115], v[44:47], v[80:83]
v_mfma_f32_16x16x32_bf16 v[84:87], v[116:119], v[44:47], v[84:87]
v_mfma_f32_16x16x32_bf16 v[88:91], v[120:123], v[44:47], v[88:91]
v_mfma_f32_16x16x32_bf16 v[92:95], v[124:127], v[44:47], v[92:95]
buffer_load_dwordx4 v[44:47], v1, s[8:11], s24 offen offset:3072 sc1
s_waitcnt vmcnt(16)
v_mfma_f32_16x16x32_bf16 v[80:83], a[160:163], v[48:51], v[80:83]
ds_read_b64_tr_b16 v[112:113], v8 offset:24576
v_mfma_f32_16x16x32_bf16 v[84:87], a[164:167], v[48:51], v[84:87]
ds_read_b64_tr_b16 v[114:115], v8 offset:25600
v_mfma_f32_16x16x32_bf16 v[88:91], a[168:171], v[48:51], v[88:91]
s_add_u32 s24, s49, s32
ds_read_b64_tr_b16 v[116:117], v9 offset:24576
v_mfma_f32_16x16x32_bf16 v[92:95], a[172:175], v[48:51], v[92:95]
ds_read_b64_tr_b16 v[118:119], v9 offset:25600
buffer_load_dwordx4 v[48:51], v1, s[8:11], s24 offen sc1
s_waitcnt vmcnt(16)
v_mfma_f32_16x16x32_bf16 v[80:83], a[176:179], v[52:55], v[80:83]
ds_read_b64_tr_b16 v[120:121], v10 offset:24576
v_mfma_f32_16x16x32_bf16 v[84:87], a[180:183], v[52:55], v[84:87]
ds_read_b64_tr_b16 v[122:123], v10 offset:25600
v_mfma_f32_16x16x32_bf16 v[88:91], a[184:187], v[52:55], v[88:91]
ds_read_b64_tr_b16 v[124:125], v11 offset:24576
v_mfma_f32_16x16x32_bf16 v[92:95], a[188:191], v[52:55], v[92:95]
ds_read_b64_tr_b16 v[126:127], v11 offset:25600
buffer_load_dwordx4 v[52:55], v1, s[8:11], s24 offen offset:1024 sc1
s_waitcnt vmcnt(16)
v_mfma_f32_16x16x32_bf16 v[80:83], a[192:195], v[56:59], v[80:83]
v_mfma_f32_16x16x32_bf16 v[84:87], a[196:199], v[56:59], v[84:87]
v_mfma_f32_16x16x32_bf16 v[88:91], a[200:203], v[56:59], v[88:91]
v_mfma_f32_16x16x32_bf16 v[92:95], a[204:207], v[56:59], v[92:95]
buffer_load_dwordx4 v[56:59], v1, s[8:11], s24 offen offset:2048 sc1
s_waitcnt vmcnt(16) lgkmcnt(0)
v_mfma_f32_16x16x32_bf16 v[80:83], v[112:115], v[60:63], v[80:83]
v_mfma_f32_16x16x32_bf16 v[84:87], v[116:119], v[60:63], v[84:87]
v_mfma_f32_16x16x32_bf16 v[88:91], v[120:123], v[60:63], v[88:91]
v_mfma_f32_16x16x32_bf16 v[92:95], v[124:127], v[60:63], v[92:95]
buffer_load_dwordx4 v[60:63], v1, s[8:11], s24 offen offset:3072 sc1
s_waitcnt vmcnt(16)
v_mfma_f32_16x16x32_bf16 v[80:83], a[208:211], v[64:67], v[80:83]
ds_read_b64_tr_b16 v[112:113], v8 offset:28672
v_mfma_f32_16x16x32_bf16 v[84:87], a[212:215], v[64:67], v[84:87]
ds_read_b64_tr_b16 v[114:115], v8 offset:29696
v_mfma_f32_16x16x32_bf16 v[88:91], a[216:219], v[64:67], v[88:91]
s_add_u32 s24, s49, s33
ds_read_b64_tr_b16 v[116:117], v9 offset:28672
v_mfma_f32_16x16x32_bf16 v[92:95], a[220:223], v[64:67], v[92:95]
ds_read_b64_tr_b16 v[118:119], v9 offset:29696
buffer_load_dwordx4 v[64:67], v1, s[8:11], s24 offen sc1
s_waitcnt vmcnt(16)
v_mfma_f32_16x16x32_bf16 v[80:83], a[224:227], v[68:71], v[80:83]
ds_read_b64_tr_b16 v[120:121], v10 offset:28672
v_mfma_f32_16x16x32_bf16 v[84:87], a[228:231], v[68:71], v[84:87]
ds_read_b64_tr_b16 v[122:123], v10 offset:29696
v_mfma_f32_16x16x32_bf16 v[88:91], a[232:235], v[68:71], v[88:91]
ds_read_b64_tr_b16 v[124:125], v11 offset:28672
v_mfma_f32_16x16x32_bf16 v[92:95], a[236:239], v[68:71], v[92:95]
ds_read_b64_tr_b16 v[126:127], v11 offset:29696
buffer_load_dwordx4 v[68:71], v1, s[8:11], s24 offen offset:1024 sc1
s_waitcnt vmcnt(15)
v_mfma_f32_16x16x32_bf16 v[80:83], a[240:243], v[72:75], v[80:83]
v_mfma_f32_16x16x32_bf16 v[84:87], a[244:247], v[72:75], v[84:87]
v_mfma_f32_16x16x32_bf16 v[88:91], a[248:251], v[72:75], v[88:91]
v_mfma_f32_16x16x32_bf16 v[92:95], a[252:255], v[72:75], v[92:95]
buffer_load_dwordx4 v[72:75], v1, s[8:11], s24 offen offset:2048 sc1
s_waitcnt vmcnt(15) lgkmcnt(0)
v_mfma_f32_16x16x32_bf16 v[80:83], v[112:115], v[76:79], v[80:83]
v_mfma_f32_16x16x32_bf16 v[84:87], v[116:119], v[76:79], v[84:87]
v_mfma_f32_16x16x32_bf16 v[88:91], v[120:123], v[76:79], v[88:91]
v_mfma_f32_16x16x32_bf16 v[92:95], v[124:127], v[76:79], v[92:95]
buffer_load_dwordx4 v[76:79], v1, s[8:11], s24 offen offset:3072 sc1
s_mul_i32 s53, s41, 36864
s_mov_b32 s41, s27
s_mov_b32 s48, s49
s_cmp_eq_u32 s50, 0
s_cbranch_scc1 L_opl_c0
L_opl_r1:
s_waitcnt vmcnt(15)
v_mfma_f32_16x16x32_bf16 v[96:99], v[128:131], v[16:19], 0
s_cmp_lg_u64 s[42:43], 0
s_cselect_b32 s52, 1, 0
ds_read_b64_tr_b16 v[112:113], v8
v_mfma_f32_16x16x32_bf16 v[100:103], v[132:135], v[16:19], 0
s_ff1_i32_b64 s27, s[42:43]
ds_read_b64_tr_b16 v[114:115], v8 offset:1024
v_mfma_f32_16x16x32_bf16 v[104:107], v[136:139], v[16:19], 0
s_bitset0_b64 s[42:43], s27
s_add_u32 s24, s48, s34
ds_read_b64_tr_b16 v[116:117], v9
v_mfma_f32_16x16x32_bf16 v[108:111], v[140:143], v[16:19], 0
s_lshl_b32 s27, s27, 1
ds_read_b64_tr_b16 v[118:119], v9 offset:1024
buffer_load_dwordx4 v[16:19], v1, s[8:11], s24 offen sc1
s_waitcnt vmcnt(15)
v_mfma_f32_16x16x32_bf16 v[96:99], v[144:147], v[20:23], v[96:99]
s_xor_b32 s27, s27, s51
ds_read_b64_tr_b16 v[120:121], v10
v_mfma_f32_16x16x32_bf16 v[100:103], v[148:151], v[20:23], v[100:103]
s_and_b32 s27, s27, 127
ds_read_b64_tr_b16 v[122:123], v10 offset:1024
v_mfma_f32_16x16x32_bf16 v[104:107], v[152:155], v[20:23], v[104:107]
s_lshr_b32 s25, s27, s46
ds_read_b64_tr_b16 v[124:125], v11
v_mfma_f32_16x16x32_bf16 v[108:111], v[156:159], v[20:23], v[108:111]
s_lshl_b32 s25, s25, 7
ds_read_b64_tr_b16 v[126:127], v11 offset:1024
buffer_load_dwordx4 v[20:23], v1, s[8:11], s24 offen offset:1024 sc1
s_waitcnt vmcnt(15)
v_mfma_f32_16x16x32_bf16 v[96:99], v[160:163], v[24:27], v[96:99]
s_add_u32 s25, s25, s45
v_mfma_f32_16x16x32_bf16 v[100:103], v[164:167], v[24:27], v[100:103]
s_lshl_b32 s49, s27, 17
v_mfma_f32_16x16x32_bf16 v[104:107], v[168:171], v[24:27], v[104:107]
s_add_u32 s49, s49, s44
v_mfma_f32_16x16x32_bf16 v[108:111], v[172:175], v[24:27], v[108:111]
buffer_load_dwordx4 v[24:27], v1, s[8:11], s24 offen offset:2048 sc1
buffer_load_dword v6, v5, s[8:11], s25 offen sc1
s_waitcnt vmcnt(16) lgkmcnt(0)
v_mfma_f32_16x16x32_bf16 v[96:99], v[112:115], v[28:31], v[96:99]
ds_write_b128 v3, v[80:83]
v_mfma_f32_16x16x32_bf16 v[100:103], v[116:119], v[28:31], v[100:103]
ds_write_b128 v3, v[84:87] offset:4096
v_mfma_f32_16x16x32_bf16 v[104:107], v[120:123], v[28:31], v[104:107]
ds_write_b128 v3, v[88:91] offset:8192
v_mfma_f32_16x16x32_bf16 v[108:111], v[124:127], v[28:31], v[108:111]
ds_write_b128 v3, v[92:95] offset:12288
buffer_load_dwordx4 v[28:31], v1, s[8:11], s24 offen offset:3072 sc1
s_waitcnt vmcnt(16)
v_mfma_f32_16x16x32_bf16 v[96:99], v[176:179], v[32:35], v[96:99]
ds_read_b64_tr_b16 v[112:113], v8 offset:4096
v_mfma_f32_16x16x32_bf16 v[100:103], v[180:183], v[32:35], v[100:103]
ds_read_b64_tr_b16 v[114:115], v8 offset:5120
v_mfma_f32_16x16x32_bf16 v[104:107], v[184:187], v[32:35], v[104:107]
s_add_u32 s24, s48, s35
ds_read_b64_tr_b16 v[116:117], v9 offset:4096
v_mfma_f32_16x16x32_bf16 v[108:111], v[188:191], v[32:35], v[108:111]
ds_read_b64_tr_b16 v[118:119], v9 offset:5120
buffer_load_dwordx4 v[32:35], v1, s[8:11], s24 offen sc1
s_waitcnt vmcnt(16)
v_mfma_f32_16x16x32_bf16 v[96:99], v[192:195], v[36:39], v[96:99]
ds_read_b64_tr_b16 v[120:121], v10 offset:4096
v_mfma_f32_16x16x32_bf16 v[100:103], v[196:199], v[36:39], v[100:103]
ds_read_b64_tr_b16 v[122:123], v10 offset:5120
v_mfma_f32_16x16x32_bf16 v[104:107], v[200:203], v[36:39], v[104:107]
ds_read_b64_tr_b16 v[124:125], v11 offset:4096
v_mfma_f32_16x16x32_bf16 v[108:111], v[204:207], v[36:39], v[108:111]
ds_read_b64_tr_b16 v[126:127], v11 offset:5120
buffer_load_dwordx4 v[36:39], v1, s[8:11], s24 offen offset:1024 sc1
s_waitcnt vmcnt(16)
v_mfma_f32_16x16x32_bf16 v[96:99], v[208:211], v[40:43], v[96:99]
v_mfma_f32_16x16x32_bf16 v[100:103], v[212:215], v[40:43], v[100:103]
v_mfma_f32_16x16x32_bf16 v[104:107], v[216:219], v[40:43], v[104:107]
v_mfma_f32_16x16x32_bf16 v[108:111], v[220:223], v[40:43], v[108:111]
buffer_load_dwordx4 v[40:43], v1, s[8:11], s24 offen offset:2048 sc1
s_waitcnt vmcnt(16) lgkmcnt(0)
s_barrier
v_mfma_f32_16x16x32_bf16 v[96:99], v[112:115], v[44:47], v[96:99]
ds_read_b128 v[80:83], v7
v_mfma_f32_16x16x32_bf16 v[100:103], v[116:119], v[44:47], v[100:103]
ds_read_b128 v[84:87], v7 offset:1024
v_mfma_f32_16x16x32_bf16 v[104:107], v[120:123], v[44:47], v[104:107]
ds_read_b128 v[88:91], v7 offset:2048
v_mfma_f32_16x16x32_bf16 v[108:111], v[124:127], v[44:47], v[108:111]
ds_read_b128 v[92:95], v7 offset:3072
buffer_load_dwordx4 v[44:47], v1, s[8:11], s24 offen offset:3072 sc1
s_waitcnt vmcnt(16)
v_mfma_f32_16x16x32_bf16 v[96:99], v[224:227], v[48:51], v[96:99]
ds_read_b64_tr_b16 v[112:113], v8 offset:8192
v_mfma_f32_16x16x32_bf16 v[100:103], v[228:231], v[48:51], v[100:103]
ds_read_b64_tr_b16 v[114:115], v8 offset:9216
v_mfma_f32_16x16x32_bf16 v[104:107], v[232:235], v[48:51], v[104:107]
s_add_u32 s24, s48, s36
ds_read_b64_tr_b16 v[116:117], v9 offset:8192
v_mfma_f32_16x16x32_bf16 v[108:111], v[236:239], v[48:51], v[108:111]
ds_read_b64_tr_b16 v[118:119], v9 offset:9216
buffer_load_dwordx4 v[48:51], v1, s[8:11], s24 offen sc1
s_waitcnt vmcnt(16)
v_mfma_f32_16x16x32_bf16 v[96:99], v[240:243], v[52:55], v[96:99]
ds_read_b64_tr_b16 v[120:121], v10 offset:8192
v_mfma_f32_16x16x32_bf16 v[100:103], v[244:247], v[52:55], v[100:103]
ds_read_b64_tr_b16 v[122:123], v10 offset:9216
v_mfma_f32_16x16x32_bf16 v[104:107], v[248:251], v[52:55], v[104:107]
ds_read_b64_tr_b16 v[124:125], v11 offset:8192
v_mfma_f32_16x16x32_bf16 v[108:111], v[252:255], v[52:55], v[108:111]
ds_read_b64_tr_b16 v[126:127], v11 offset:9216
buffer_load_dwordx4 v[52:55], v1, s[8:11], s24 offen offset:1024 sc1
s_waitcnt vmcnt(16)
v_mfma_f32_16x16x32_bf16 v[96:99], a[0:3], v[56:59], v[96:99]
v_mfma_f32_16x16x32_bf16 v[100:103], a[4:7], v[56:59], v[100:103]
v_mfma_f32_16x16x32_bf16 v[104:107], a[8:11], v[56:59], v[104:107]
v_mfma_f32_16x16x32_bf16 v[108:111], a[12:15], v[56:59], v[108:111]
buffer_load_dwordx4 v[56:59], v1, s[8:11], s24 offen offset:2048 sc1
s_waitcnt vmcnt(16) lgkmcnt(0)
v_mfma_f32_16x16x32_bf16 v[96:99], v[112:115], v[60:63], v[96:99]
v_add_f32 v80, v80, v84
v_add_f32 v81, v81, v85
v_mfma_f32_16x16x32_bf16 v[100:103], v[116:119], v[60:63], v[100:103]
v_add_f32 v82, v82, v86
v_add_f32 v83, v83, v87
v_mfma_f32_16x16x32_bf16 v[104:107], v[120:123], v[60:63], v[104:107]
v_add_f32 v80, v80, v88
v_add_f32 v81, v81, v89
v_mfma_f32_16x16x32_bf16 v[108:111], v[124:127], v[60:63], v[108:111]
v_add_f32 v82, v82, v90
v_add_f32 v83, v83, v91
buffer_load_dwordx4 v[60:63], v1, s[8:11], s24 offen offset:3072 sc1
s_waitcnt vmcnt(16)
v_mfma_f32_16x16x32_bf16 v[96:99], a[16:19], v[64:67], v[96:99]
ds_read_b64_tr_b16 v[112:113], v8 offset:12288
v_add_f32 v80, v80, v92
v_mfma_f32_16x16x32_bf16 v[100:103], a[20:23], v[64:67], v[100:103]
ds_read_b64_tr_b16 v[114:115], v8 offset:13312
v_add_f32 v81, v81, v93
v_mfma_f32_16x16x32_bf16 v[104:107], a[24:27], v[64:67], v[104:107]
s_add_u32 s24, s48, s37
ds_read_b64_tr_b16 v[116:117], v9 offset:12288
v_add_f32 v82, v82, v94
v_mfma_f32_16x16x32_bf16 v[108:111], a[28:31], v[64:67], v[108:111]
ds_read_b64_tr_b16 v[118:119], v9 offset:13312
v_add_f32 v83, v83, v95
buffer_load_dwordx4 v[64:67], v1, s[8:11], s24 offen sc1
s_waitcnt vmcnt(16)
v_mfma_f32_16x16x32_bf16 v[96:99], a[32:35], v[68:71], v[96:99]
ds_read_b64_tr_b16 v[120:121], v10 offset:12288
v_cvt_pk_bf16_f32 v12, v80, v81
v_mfma_f32_16x16x32_bf16 v[100:103], a[36:39], v[68:71], v[100:103]
ds_read_b64_tr_b16 v[122:123], v10 offset:13312
v_cvt_pk_bf16_f32 v13, v82, v83
v_mfma_f32_16x16x32_bf16 v[104:107], a[40:43], v[68:71], v[104:107]
ds_read_b64_tr_b16 v[124:125], v11 offset:12288
v_xor_b32 v3, 16384, v3
v_mfma_f32_16x16x32_bf16 v[108:111], a[44:47], v[68:71], v[108:111]
ds_read_b64_tr_b16 v[126:127], v11 offset:13312
v_xor_b32 v7, 16384, v7
buffer_load_dwordx4 v[68:71], v1, s[8:11], s24 offen offset:1024 sc1
buffer_store_dwordx2 v[12:13], v4, s[12:15], s53 offen
L_opl_t1:
s_waitcnt vmcnt(17)
v_mfma_f32_16x16x32_bf16 v[96:99], a[48:51], v[72:75], v[96:99]
v_mfma_f32_16x16x32_bf16 v[100:103], a[52:55], v[72:75], v[100:103]
v_mfma_f32_16x16x32_bf16 v[104:107], a[56:59], v[72:75], v[104:107]
v_mfma_f32_16x16x32_bf16 v[108:111], a[60:63], v[72:75], v[108:111]
buffer_load_dwordx4 v[72:75], v1, s[8:11], s24 offen offset:2048 sc1
s_waitcnt vmcnt(17) lgkmcnt(0)
v_mfma_f32_16x16x32_bf16 v[96:99], v[112:115], v[76:79], v[96:99]
s_waitcnt vmcnt(13)
v_cmp_ne_u32 vcc, 1, v6
v_mfma_f32_16x16x32_bf16 v[100:103], v[116:119], v[76:79], v[100:103]
v_mfma_f32_16x16x32_bf16 v[104:107], v[120:123], v[76:79], v[104:107]
s_cmp_eq_u64 vcc, 0
s_cselect_b32 s50, s52, 0
v_mfma_f32_16x16x32_bf16 v[108:111], v[124:127], v[76:79], v[108:111]
buffer_load_dwordx4 v[76:79], v1, s[8:11], s24 offen offset:3072 sc1
s_waitcnt vmcnt(17)
v_mfma_f32_16x16x32_bf16 v[96:99], a[64:67], v[16:19], v[96:99]
s_cmp_eq_u32 s50, 1
s_cselect_b32 s49, s49, 536870912
ds_read_b64_tr_b16 v[112:113], v8 offset:16384
v_mfma_f32_16x16x32_bf16 v[100:103], a[68:71], v[16:19], v[100:103]
ds_read_b64_tr_b16 v[114:115], v8 offset:17408
v_mfma_f32_16x16x32_bf16 v[104:107], a[72:75], v[16:19], v[104:107]
s_add_u32 s24, s49, s30
ds_read_b64_tr_b16 v[116:117], v9 offset:16384
v_mfma_f32_16x16x32_bf16 v[108:111], a[76:79], v[16:19], v[108:111]
ds_read_b64_tr_b16 v[118:119], v9 offset:17408
buffer_load_dwordx4 v[16:19], v1, s[8:11], s24 offen sc1
s_waitcnt vmcnt(17)
v_mfma_f32_16x16x32_bf16 v[96:99], a[80:83], v[20:23], v[96:99]
ds_read_b64_tr_b16 v[120:121], v10 offset:16384
v_mfma_f32_16x16x32_bf16 v[100:103], a[84:87], v[20:23], v[100:103]
ds_read_b64_tr_b16 v[122:123], v10 offset:17408
v_mfma_f32_16x16x32_bf16 v[104:107], a[88:91], v[20:23], v[104:107]
ds_read_b64_tr_b16 v[124:125], v11 offset:16384
v_mfma_f32_16x16x32_bf16 v[108:111], a[92:95], v[20:23], v[108:111]
ds_read_b64_tr_b16 v[126:127], v11 offset:17408
buffer_load_dwordx4 v[20:23], v1, s[8:11], s24 offen offset:1024 sc1
s_waitcnt vmcnt(17)
v_mfma_f32_16x16x32_bf16 v[96:99], a[96:99], v[24:27], v[96:99]
v_mfma_f32_16x16x32_bf16 v[100:103], a[100:103], v[24:27], v[100:103]
v_mfma_f32_16x16x32_bf16 v[104:107], a[104:107], v[24:27], v[104:107]
v_mfma_f32_16x16x32_bf16 v[108:111], a[108:111], v[24:27], v[108:111]
buffer_load_dwordx4 v[24:27], v1, s[8:11], s24 offen offset:2048 sc1
s_waitcnt vmcnt(16) lgkmcnt(0)
v_mfma_f32_16x16x32_bf16 v[96:99], v[112:115], v[28:31], v[96:99]
v_mfma_f32_16x16x32_bf16 v[100:103], v[116:119], v[28:31], v[100:103]
v_mfma_f32_16x16x32_bf16 v[104:107], v[120:123], v[28:31], v[104:107]
v_mfma_f32_16x16x32_bf16 v[108:111], v[124:127], v[28:31], v[108:111]
buffer_load_dwordx4 v[28:31], v1, s[8:11], s24 offen offset:3072 sc1
s_waitcnt vmcnt(16)
v_mfma_f32_16x16x32_bf16 v[96:99], a[112:115], v[32:35], v[96:99]
ds_read_b64_tr_b16 v[112:113], v8 offset:20480
v_mfma_f32_16x16x32_bf16 v[100:103], a[116:119], v[32:35], v[100:103]
ds_read_b64_tr_b16 v[114:115], v8 offset:21504
v_mfma_f32_16x16x32_bf16 v[104:107], a[120:123], v[32:35], v[104:107]
s_add_u32 s24, s49, s31
ds_read_b64_tr_b16 v[116:117], v9 offset:20480
v_mfma_f32_16x16x32_bf16 v[108:111], a[124:127], v[32:35], v[108:111]
ds_read_b64_tr_b16 v[118:119], v9 offset:21504
buffer_load_dwordx4 v[32:35], v1, s[8:11], s24 offen sc1
s_waitcnt vmcnt(16)
v_mfma_f32_16x16x32_bf16 v[96:99], a[128:131], v[36:39], v[96:99]
ds_read_b64_tr_b16 v[120:121], v10 offset:20480
v_mfma_f32_16x16x32_bf16 v[100:103], a[132:135], v[36:39], v[100:103]
ds_read_b64_tr_b16 v[122:123], v10 offset:21504
v_mfma_f32_16x16x32_bf16 v[104:107], a[136:139], v[36:39], v[104:107]
ds_read_b64_tr_b16 v[124:125], v11 offset:20480
v_mfma_f32_16x16x32_bf16 v[108:111], a[140:143], v[36:39], v[108:111]
ds_read_b64_tr_b16 v[126:127], v11 offset:21504
buffer_load_dwordx4 v[36:39], v1, s[8:11], s24 offen offset:1024 sc1
s_waitcnt vmcnt(16)
v_mfma_f32_16x16x32_bf16 v[96:99], a[144:147], v[40:43], v[96:99]
v_mfma_f32_16x16x32_bf16 v[100:103], a[148:151], v[40:43], v[100:103]
v_mfma_f32_16x16x32_bf16 v[104:107], a[152:155], v[40:43], v[104:107]
v_mfma_f32_16x16x32_bf16 v[108:111], a[156:159], v[40:43], v[108:111]
buffer_load_dwordx4 v[40:43], v1, s[8:11], s24 offen offset:2048 sc1
s_waitcnt vmcnt(16) lgkmcnt(0)
v_mfma_f32_16x16x32_bf16 v[96:99], v[112:115], v[44:47], v[96:99]
v_mfma_f32_16x16x32_bf16 v[100:103], v[116:119], v[44:47], v[100:103]
v_mfma_f32_16x16x32_bf16 v[104:107], v[120:123], v[44:47], v[104:107]
v_mfma_f32_16x16x32_bf16 v[108:111], v[124:127], v[44:47], v[108:111]
buffer_load_dwordx4 v[44:47], v1, s[8:11], s24 offen offset:3072 sc1
s_waitcnt vmcnt(16)
v_mfma_f32_16x16x32_bf16 v[96:99], a[160:163], v[48:51], v[96:99]
ds_read_b64_tr_b16 v[112:113], v8 offset:24576
v_mfma_f32_16x16x32_bf16 v[100:103], a[164:167], v[48:51], v[100:103]
ds_read_b64_tr_b16 v[114:115], v8 offset:25600
v_mfma_f32_16x16x32_bf16 v[104:107], a[168:171], v[48:51], v[104:107]
s_add_u32 s24, s49, s32
ds_read_b64_tr_b16 v[116:117], v9 offset:24576
v_mfma_f32_16x16x32_bf16 v[108:111], a[172:175], v[48:51], v[108:111]
ds_read_b64_tr_b16 v[118:119], v9 offset:25600
buffer_load_dwordx4 v[48:51], v1, s[8:11], s24 offen sc1
s_waitcnt vmcnt(16)
v_mfma_f32_16x16x32_bf16 v[96:99], a[176:179], v[52:55], v[96:99]
ds_read_b64_tr_b16 v[120:121], v10 offset:24576
v_mfma_f32_16x16x32_bf16 v[100:103], a[180:183], v[52:55], v[100:103]
ds_read_b64_tr_b16 v[122:123], v10 offset:25600
v_mfma_f32_16x16x32_bf16 v[104:107], a[184:187], v[52:55], v[104:107]
ds_read_b64_tr_b16 v[124:125], v11 offset:24576
v_mfma_f32_16x16x32_bf16 v[108:111], a[188:191], v[52:55], v[108:111]
ds_read_b64_tr_b16 v[126:127], v11 offset:25600
buffer_load_dwordx4 v[52:55], v1, s[8:11], s24 offen offset:1024 sc1
s_waitcnt vmcnt(16)
v_mfma_f32_16x16x32_bf16 v[96:99], a[192:195], v[56:59], v[96:99]
v_mfma_f32_16x16x32_bf16 v[100:103], a[196:199], v[56:59], v[100:103]
v_mfma_f32_16x16x32_bf16 v[104:107], a[200:203], v[56:59], v[104:107]
v_mfma_f32_16x16x32_bf16 v[108:111], a[204:207], v[56:59], v[108:111]
buffer_load_dwordx4 v[56:59], v1, s[8:11], s24 offen offset:2048 sc1
s_waitcnt vmcnt(16) lgkmcnt(0)
v_mfma_f32_16x16x32_bf16 v[96:99], v[112:115], v[60:63], v[96:99]
v_mfma_f32_16x16x32_bf16 v[100:103], v[116:119], v[60:63], v[100:103]
v_mfma_f32_16x16x32_bf16 v[104:107], v[120:123], v[60:63], v[104:107]
v_mfma_f32_16x16x32_bf16 v[108:111], v[124:127], v[60:63], v[108:111]
buffer_load_dwordx4 v[60:63], v1, s[8:11], s24 offen offset:3072 sc1
s_waitcnt vmcnt(16)
v_mfma_f32_16x16x32_bf16 v[96:99], a[208:211], v[64:67], v[96:99]
ds_read_b64_tr_b16 v[112:113], v8 offset:28672
v_mfma_f32_16x16x32_bf16 v[100:103], a[212:215], v[64:67], v[100:103]
ds_read_b64_tr_b16 v[114:115], v8 offset:29696
v_mfma_f32_16x16x32_bf16 v[104:107], a[216:219], v[64:67], v[104:107]
s_add_u32 s24, s49, s33
ds_read_b64_tr_b16 v[116:117], v9 offset:28672
v_mfma_f32_16x16x32_bf16 v[108:111], a[220:223], v[64:67], v[108:111]
ds_read_b64_tr_b16 v[118:119], v9 offset:29696
buffer_load_dwordx4 v[64:67], v1, s[8:11], s24 offen sc1
s_waitcnt vmcnt(16)
v_mfma_f32_16x16x32_bf16 v[96:99], a[224:227], v[68:71], v[96:99]
ds_read_b64_tr_b16 v[120:121], v10 offset:28672
v_mfma_f32_16x16x32_bf16 v[100:103], a[228:231], v[68:71], v[100:103]
ds_read_b64_tr_b16 v[122:123], v10 offset:29696
v_mfma_f32_16x16x32_bf16 v[104:107], a[232:235], v[68:71], v[104:107]
ds_read_b64_tr_b16 v[124:125], v11 offset:28672
v_mfma_f32_16x16x32_bf16 v[108:111], a[236:239], v[68:71], v[108:111]
ds_read_b64_tr_b16 v[126:127], v11 offset:29696
buffer_load_dwordx4 v[68:71], v1, s[8:11], s24 offen offset:1024 sc1
s_waitcnt vmcnt(15)
v_mfma_f32_16x16x32_bf16 v[96:99], a[240:243], v[72:75], v[96:99]
v_mfma_f32_16x16x32_bf16 v[100:103], a[244:247], v[72:75], v[100:103]
v_mfma_f32_16x16x32_bf16 v[104:107], a[248:251], v[72:75], v[104:107]
v_mfma_f32_16x16x32_bf16 v[108:111], a[252:255], v[72:75], v[108:111]
buffer_load_dwordx4 v[72:75], v1, s[8:11], s24 offen offset:2048 sc1
s_waitcnt vmcnt(15) lgkmcnt(0)
v_mfma_f32_16x16x32_bf16 v[96:99], v[112:115], v[76:79], v[96:99]
v_mfma_f32_16x16x32_bf16 v[100:103], v[116:119], v[76:79], v[100:103]
v_mfma_f32_16x16x32_bf16 v[104:107], v[120:123], v[76:79], v[104:107]
v_mfma_f32_16x16x32_bf16 v[108:111], v[124:127], v[76:79], v[108:111]
buffer_load_dwordx4 v[76:79], v1, s[8:11], s24 offen offset:3072 sc1
s_mul_i32 s53, s41, 36864
s_mov_b32 s41, s27
s_mov_b32 s48, s49
s_cmp_eq_u32 s50, 0
s_cbranch_scc0 L_opl_r0
L_opl_c1:
ds_write_b128 v3, v[96:99]
ds_write_b128 v3, v[100:103] offset:4096
ds_write_b128 v3, v[104:107] offset:8192
ds_write_b128 v3, v[108:111] offset:12288
s_waitcnt lgkmcnt(0)
s_barrier
ds_read_b128 v[96:99], v7
ds_read_b128 v[100:103], v7 offset:1024
ds_read_b128 v[104:107], v7 offset:2048
ds_read_b128 v[108:111], v7 offset:3072
s_waitcnt lgkmcnt(2)
v_pk_add_f32 v[96:97], v[96:97], v[100:101]
v_pk_add_f32 v[98:99], v[98:99], v[102:103]
s_waitcnt lgkmcnt(1)
v_pk_add_f32 v[96:97], v[96:97], v[104:105]
v_pk_add_f32 v[98:99], v[98:99], v[106:107]
s_waitcnt lgkmcnt(0)
v_pk_add_f32 v[96:97], v[96:97], v[108:109]
v_pk_add_f32 v[98:99], v[98:99], v[110:111]
v_cvt_pk_bf16_f32 v12, v96, v97
v_cvt_pk_bf16_f32 v13, v98, v99
buffer_store_dwordx2 v[12:13], v4, s[12:15], s53 offen
v_xor_b32 v3, 16384, v3
v_xor_b32 v7, 16384, v7
s_cmp_lg_u32 s52, 0
s_cbranch_scc1 L_opl_w
s_branch L_opl_x
L_opl_c0:
ds_write_b128 v3, v[80:83]
ds_write_b128 v3, v[84:87] offset:4096
ds_write_b128 v3, v[88:91] offset:8192
ds_write_b128 v3, v[92:95] offset:12288
s_waitcnt lgkmcnt(0)
s_barrier
ds_read_b128 v[80:83], v7
ds_read_b128 v[84:87], v7 offset:1024
ds_read_b128 v[88:91], v7 offset:2048
ds_read_b128 v[92:95], v7 offset:3072
s_waitcnt lgkmcnt(2)
v_pk_add_f32 v[80:81], v[80:81], v[84:85]
v_pk_add_f32 v[82:83], v[82:83], v[86:87]
s_waitcnt lgkmcnt(1)
v_pk_add_f32 v[80:81], v[80:81], v[88:89]
v_pk_add_f32 v[82:83], v[82:83], v[90:91]
s_waitcnt lgkmcnt(0)
v_pk_add_f32 v[80:81], v[80:81], v[92:93]
v_pk_add_f32 v[82:83], v[82:83], v[94:95]
v_cvt_pk_bf16_f32 v12, v80, v81
v_cvt_pk_bf16_f32 v13, v82, v83
buffer_store_dwordx2 v[12:13], v4, s[12:15], s53 offen
v_xor_b32 v3, 16384, v3
v_xor_b32 v7, 16384, v7
s_cmp_lg_u32 s52, 0
s_cbranch_scc1 L_opl_w
L_opl_x:
s_branch L_done
L_team:
s_load_dwordx8 s[88:95], s[0:1], 64
s_load_dwordx2 s[96:97], s[0:1], 56
v_mov_b32 v12, v0
v_and_b32 v13, 15, v0
v_bfe_u32 v14, v0, 4, 2
v_lshlrev_b32 v1, 4, v12
v_and_b32 v2, 0x3f0, v1
s_mul_i32 s20, s17, 34816
s_add_u32 s20, s20, 24576
v_add_u32 v2, s20, v2
v_and_b32 v15, 1, v12
v_mul_u32_u24 v0, 0xaaaa, v15
v_add_u32 v0, 0xffff4444, v0
v_lshrrev_b32 v18, 2, v13
v_lshl_add_u32 v18, v18, 1, v15
v_bfe_u32 v19, v13, 1, 1
v_lshrrev_b32 v16, 5, v12
v_lshlrev_b32 v16, 8, v16
v_lshl_add_u32 v16, v18, 5, v16
v_and_b32 v17, 1, v14
v_lshl_add_u32 v16, v17, 4, v16
v_and_b32 v17, 0x7f, v16
v_xor_b32 v17, 16, v17
v_add_u32 v16, 4224, v16
v_add_u32 v17, 6272, v17
v_cmp_eq_u32 vcc, 1, v19
s_nop 1
v_cndmask_b32 v7, v17, v16, vcc
v_and_b32 v16, 1, v14
v_xor_b32 v16, v18, v16
v_and_b32 v17, 2, v14
v_lshlrev_b32 v17, 1, v17
v_xor_b32 v16, v16, v17
v_lshlrev_b32 v16, 4, v16
v_lshl_add_u32 v16, v14, 7, v16
v_mul_u32_u24 v17, 2176, v19
v_add_u32 v16, v16, v17
v_add_u32 v5, 0, v16
v_bfe_u32 v20, v13, 3, 1
v_bfe_u32 v21, v13, 1, 1
v_lshlrev_b32 v16, 1, v14
v_xor_b32 v16, v16, v21
v_lshlrev_b32 v17, 2, v20
v_xor_b32 v16, v16, v17
v_lshlrev_b32 v16, 4, v16
v_lshl_add_u32 v16, v20, 8, v16
v_lshl_add_u32 v16, v21, 7, v16
v_bfe_u32 v17, v13, 2, 1
v_lshl_add_u32 v16, v17, 3, v16
v_lshl_add_u32 v16, v15, 2, v16
s_lshl_b32 s20, s17, 9
s_add_u32 s20, s20, 0
v_add_u32 v4, s20, v16
v_xor_b32 v3, 16, v4
v_lshrrev_b32 v16, 4, v12
v_xor_b32 v17, s16, v16
v_lshlrev_b32 v16, 12, v16
v_lshl_add_u32 v16, v17, 7, v16
v_lshl_add_u32 v9, v13, 3, v16
s_lshr_b32 s20, s17, 1
s_lshl_b32 s20, s20, 2
v_add_u32 v16, s20, v14
v_xor_b32 v17, s16, v16
v_lshlrev_b32 v16, 12, v16
v_lshl_add_u32 v16, v17, 7, v16
v_lshl_add_u32 v16, v13, 2, v16
s_and_b32 s20, s17, 1
s_lshl_b32 s20, s20, 6
s_add_u32 s20, s20, 262144
v_add_u32 v10, s20, v16
v_bfe_u32 v16, v13, 2, 1
v_lshlrev_b32 v16, 5, v16
v_and_b32 v17, 1, v14
v_lshl_add_u32 v16, v17, 8, v16
v_lshrrev_b32 v17, 1, v14
v_lshl_add_u32 v16, v17, 4, v16
v_and_b32 v17, 3, v13
v_lshl_add_u32 v11, v17, 2, v16
v_lshlrev_b32 v6, 7, v12
v_lshlrev_b32 v8, 2, v12
s_mov_b32 s36, 0x11111111
s_mov_b32 s37, 0x11111111
s_mov_b32 s38, 0x22222222
s_mov_b32 s39, 0x22222222
s_mov_b32 s40, 0x44444444
s_mov_b32 s41, 0x44444444
s_mov_b32 s42, 0x88888888
s_mov_b32 s43, 0x88888888
s_mov_b32 s44, 0xf0f0f0f0
s_mov_b32 s45, 0xf0f0f0f0
s_mov_b32 s18, 0x3e0293ee
s_lshl_b32 s20, s17, 5
s_add_u32 s20, s20, s16
s_cmp_lt_u32 s20, 72
s_cselect_b32 s48, 1, 0
s_lshl_b32 s23, s20, 12
s_lshl_b32 s21, s17, 10
s_sub_u32 s23, s23, s21
s_lshr_b32 s24, s20, 2
s_lshl_b32 s24, s24, 9
s_and_b32 s21, s20, 3
s_lshl_b32 s21, s21, 6
s_add_u32 s24, s24, s21
s_add_u32 s24, s24, 110100480
s_cmp_lt_u32 s20, 72
s_cselect_b32 s24, s24, 536870912
s_lshl_b32 s25, s16, 12
s_add_u32 s26, s25, 131072
s_add_u32 s27, s25, 262144
s_cmp_lt_u32 s16, 8
s_cselect_b32 s27, s27, 536870912
s_mov_b32 s28, 109051904
s_mov_b32 s29, 109346816
s_lshl_b32 s30, s16, 20
s_add_u32 s30, s30, 33554432
s_lshl_b32 s31, s16, 12
s_add_u32 s31, s31, 100663296
s_add_u32 s35, s24, 32768
s_mov_b32 s53, 0x3f803f80
s_mov_b32 s86, 0x33333333
s_mov_b32 s87, 0x33333333
s_lshl_b32 s84, s17, 13
s_sub_u32 s84, s20, s84
s_add_u32 s84, s84, 110886912
s_cmp_lt_u32 s20, 72
s_cselect_b32 s84, s84, 536870912
s_and_b32 s21, s16, 3
s_lshl_b32 s21, s21, 7
s_add_u32 s21, s21, 110886144
s_cmp_eq_u32 s17, 3
s_cselect_b32 s84, s21, s84
s_lshl_b32 s82, s16, 7
s_add_u32 s83, s82, 111152384
s_add_u32 s82, s82, 111148288
s_mov_b32 s19, 0
v_mov_b32 v64, -1
v_mov_b32 v65, -1
v_mov_b32 v66, -1
v_mov_b32 v67, -1
s_add_u32 s20, s28, s25
buffer_store_dwordx4 v[64:67], v1, s[8:11], s20 offen
s_add_u32 s20, s28, s26
buffer_store_dwordx4 v[64:67], v1, s[8:11], s20 offen
s_add_u32 s20, s28, s27
buffer_store_dwordx4 v[64:67], v1, s[8:11], s20 offen
s_add_u32 s20, s29, s25
buffer_store_dwordx4 v[64:67], v1, s[8:11], s20 offen
s_add_u32 s20, s29, s26
buffer_store_dwordx4 v[64:67], v1, s[8:11], s20 offen
s_add_u32 s20, s29, s27
buffer_store_dwordx4 v[64:67], v1, s[8:11], s20 offen
s_add_u32 s20, s24, 16384
buffer_store_dword v64, v11, s[8:11], s20 offen
s_cmp_eq_u32 s17, 3
s_cselect_b32 s20, 536870912, s84
s_mov_b64 exec, 15
buffer_store_byte v64, v6, s[8:11], s20 offen
s_mov_b64 exec, -1
v_lshrrev_b32 v0, 4, v1
s_waitcnt lgkmcnt(0)
s_mov_b32 s46, 0x05040100
s_mov_b32 s47, 0x07060302
v_and_b32 v3, 63, v0
v_lshlrev_b32 v3, 4, v3
s_mul_i32 s20, s17, 34816
s_add_u32 s20, s20, 24576
v_add_u32 v3, s20, v3
v_bfe_u32 v64, v0, 5, 1
v_bfe_u32 v65, v0, 4, 1
v_and_b32 v66, 15, v0
v_lshlrev_b32 v1, 17, v64
v_lshl_add_u32 v1, v65, 14, v1
v_lshl_add_u32 v1, v66, 2, v1
s_lshl_b32 s20, s16, 8
s_lshl_b32 s21, s17, 6
s_add_u32 s20, s20, s21
v_add_u32 v1, s20, v1
v_lshlrev_b32 v2, 4, v64
v_lshl_add_u32 v2, v65, 2, v2
v_mul_u32_u24 v2, 1152, v2
s_mul_i32 s20, s16, 147456
v_add_u32 v2, s20, v2
v_and_b32 v4, 15, v0
s_lshl_b32 s20, s17, 4
v_add_u32 v4, s20, v4
v_lshlrev_b32 v4, 1, v4
v_add_u32 v2, v2, v4
v_add_u32 v4, v2, v4
s_barrier
s_mov_b32 s12, s90
s_and_b32 s13, s91, 0xffff
s_mov_b32 s14, 4718592
s_mov_b32 s15, 0x20000
s_mov_b32 s20, 0
buffer_load_dword v6, v1, s[12:15], s20 offen
s_mov_b32 s21, 32768
buffer_load_dword v7, v1, s[12:15], s21 offen
s_mov_b32 s20, 65536
buffer_load_dword v8, v1, s[12:15], s20 offen
s_mov_b32 s21, 98304
buffer_load_dword v9, v1, s[12:15], s21 offen
s_mov_b32 s20, 8192
buffer_load_dword v10, v1, s[12:15], s20 offen
s_mov_b32 s21, 40960
buffer_load_dword v11, v1, s[12:15], s21 offen
s_mov_b32 s20, 73728
buffer_load_dword v12, v1, s[12:15], s20 offen
s_mov_b32 s21, 106496
buffer_load_dword v13, v1, s[12:15], s21 offen
s_barrier
s_mov_b32 s20, 262144
buffer_load_dword v14, v1, s[12:15], s20 offen
s_mov_b32 s21, 294912
buffer_load_dword v15, v1, s[12:15], s21 offen
s_mov_b32 s20, 327680
buffer_load_dword v16, v1, s[12:15], s20 offen
s_mov_b32 s21, 360448
buffer_load_dword v17, v1, s[12:15], s21 offen
s_mov_b32 s20, 270336
buffer_load_dword v18, v1, s[12:15], s20 offen
s_mov_b32 s21, 303104
buffer_load_dword v19, v1, s[12:15], s21 offen
s_mov_b32 s20, 335872
buffer_load_dword v20, v1, s[12:15], s20 offen
s_mov_b32 s21, 368640
buffer_load_dword v21, v1, s[12:15], s21 offen
s_barrier
s_mov_b32 s12, s92
s_and_b32 s13, s93, 0xffff
s_mov_b32 s14, 4718592
s_mov_b32 s15, 0x20000
s_mov_b32 s20, 0
buffer_load_dword v22, v1, s[12:15], s20 offen
s_mov_b32 s21, 32768
buffer_load_dword v23, v1, s[12:15], s21 offen
s_mov_b32 s20, 65536
buffer_load_dword v24, v1, s[12:15], s20 offen
s_mov_b32 s21, 98304
buffer_load_dword v25, v1, s[12:15], s21 offen
s_mov_b32 s20, 8192
buffer_load_dword v26, v1, s[12:15], s20 offen
s_mov_b32 s21, 40960
buffer_load_dword v27, v1, s[12:15], s21 offen
s_mov_b32 s20, 73728
buffer_load_dword v28, v1, s[12:15], s20 offen
s_mov_b32 s21, 106496
buffer_load_dword v29, v1, s[12:15], s21 offen
s_barrier
s_mov_b32 s20, 262144
buffer_load_dword v30, v1, s[12:15], s20 offen
s_mov_b32 s21, 294912
buffer_load_dword v31, v1, s[12:15], s21 offen
s_mov_b32 s20, 327680
buffer_load_dword v32, v1, s[12:15], s20 offen
s_mov_b32 s21, 360448
buffer_load_dword v33, v1, s[12:15], s21 offen
s_mov_b32 s20, 270336
buffer_load_dword v34, v1, s[12:15], s20 offen
s_mov_b32 s21, 303104
buffer_load_dword v35, v1, s[12:15], s21 offen
s_mov_b32 s20, 335872
buffer_load_dword v36, v1, s[12:15], s20 offen
s_mov_b32 s21, 368640
buffer_load_dword v37, v1, s[12:15], s21 offen
s_barrier
s_mov_b32 s12, s90
s_and_b32 s13, s91, 0xffff
s_mov_b32 s14, 4718592
s_mov_b32 s15, 0x20000
s_mov_b32 s20, 524288
buffer_load_dword v38, v1, s[12:15], s20 offen
s_mov_b32 s21, 557056
buffer_load_dword v39, v1, s[12:15], s21 offen
s_mov_b32 s20, 589824
buffer_load_dword v40, v1, s[12:15], s20 offen
s_mov_b32 s21, 622592
buffer_load_dword v41, v1, s[12:15], s21 offen
s_mov_b32 s20, 532480
buffer_load_dword v42, v1, s[12:15], s20 offen
s_mov_b32 s21, 565248
buffer_load_dword v43, v1, s[12:15], s21 offen
s_mov_b32 s20, 598016
buffer_load_dword v44, v1, s[12:15], s20 offen
s_mov_b32 s21, 630784
buffer_load_dword v45, v1, s[12:15], s21 offen
s_barrier
s_mov_b32 s20, 786432
buffer_load_dword v46, v1, s[12:15], s20 offen
s_mov_b32 s21, 819200
buffer_load_dword v47, v1, s[12:15], s21 offen
s_mov_b32 s20, 851968
buffer_load_dword v48, v1, s[12:15], s20 offen
s_mov_b32 s21, 884736
buffer_load_dword v49, v1, s[12:15], s21 offen
s_mov_b32 s20, 794624
buffer_load_dword v50, v1, s[12:15], s20 offen
s_mov_b32 s21, 827392
buffer_load_dword v51, v1, s[12:15], s21 offen
s_mov_b32 s20, 860160
buffer_load_dword v52, v1, s[12:15], s20 offen
s_mov_b32 s21, 892928
buffer_load_dword v53, v1, s[12:15], s21 offen
s_barrier
s_mov_b32 s12, s92
s_and_b32 s13, s93, 0xffff
s_mov_b32 s14, 4718592
s_mov_b32 s15, 0x20000
s_mov_b32 s20, 524288
buffer_load_dword v54, v1, s[12:15], s20 offen
s_mov_b32 s21, 557056
buffer_load_dword v55, v1, s[12:15], s21 offen
s_mov_b32 s20, 589824
buffer_load_dword v56, v1, s[12:15], s20 offen
s_mov_b32 s21, 622592
buffer_load_dword v57, v1, s[12:15], s21 offen
s_mov_b32 s20, 532480
buffer_load_dword v58, v1, s[12:15], s20 offen
s_mov_b32 s21, 565248
buffer_load_dword v59, v1, s[12:15], s21 offen
s_mov_b32 s20, 598016
buffer_load_dword v60, v1, s[12:15], s20 offen
s_mov_b32 s21, 630784
buffer_load_dword v61, v1, s[12:15], s21 offen
s_waitcnt vmcnt(54)
v_perm_b32 v88, v7, v6, s46
v_perm_b32 v68, v7, v6, s47
s_barrier
s_mov_b32 s20, 786432
buffer_load_dword v6, v1, s[12:15], s20 offen
s_mov_b32 s21, 819200
buffer_load_dword v7, v1, s[12:15], s21 offen
s_waitcnt vmcnt(54)
v_perm_b32 v89, v9, v8, s46
v_perm_b32 v69, v9, v8, s47
s_mov_b32 s20, 851968
buffer_load_dword v8, v1, s[12:15], s20 offen
s_mov_b32 s21, 884736
buffer_load_dword v9, v1, s[12:15], s21 offen
s_waitcnt vmcnt(54)
v_perm_b32 v90, v11, v10, s46
v_perm_b32 v70, v11, v10, s47
s_mov_b32 s20, 794624
buffer_load_dword v10, v1, s[12:15], s20 offen
s_mov_b32 s21, 827392
buffer_load_dword v11, v1, s[12:15], s21 offen
s_waitcnt vmcnt(54)
v_perm_b32 v91, v13, v12, s46
v_perm_b32 v71, v13, v12, s47
ds_write_b128 v3, v[68:71]
s_waitcnt lgkmcnt(0)
s_mov_b32 s20, 860160
buffer_load_dword v12, v1, s[12:15], s20 offen
s_mov_b32 s21, 892928
buffer_load_dword v13, v1, s[12:15], s21 offen
s_waitcnt vmcnt(54)
v_perm_b32 v92, v15, v14, s46
v_perm_b32 v68, v15, v14, s47
s_barrier
s_cmp_eq_u32 s17, 0
s_cselect_b32 s98, 64, 536870912
v_mov_b32 v5, 1
s_mov_b64 exec, 1
buffer_atomic_add v5, v0, s[56:59], s98 offen
s_mov_b64 exec, -1
s_mov_b32 s12, s90
s_and_b32 s13, s91, 0xffff
s_mov_b32 s14, 4718592
s_mov_b32 s15, 0x20000
s_mov_b32 s20, 1048576
buffer_load_dword v14, v1, s[12:15], s20 offen
s_mov_b32 s21, 1081344
buffer_load_dword v15, v1, s[12:15], s21 offen
s_waitcnt vmcnt(55)
v_perm_b32 v93, v17, v16, s46
v_perm_b32 v69, v17, v16, s47
s_mov_b32 s20, 1114112
buffer_load_dword v16, v1, s[12:15], s20 offen
s_mov_b32 s21, 1146880
buffer_load_dword v17, v1, s[12:15], s21 offen
s_waitcnt vmcnt(55)
v_perm_b32 v94, v19, v18, s46
v_perm_b32 v70, v19, v18, s47
s_mov_b32 s20, 1056768
buffer_load_dword v18, v1, s[12:15], s20 offen
s_mov_b32 s21, 1089536
buffer_load_dword v19, v1, s[12:15], s21 offen
s_waitcnt vmcnt(55)
v_perm_b32 v95, v21, v20, s46
v_perm_b32 v71, v21, v20, s47
ds_write_b128 v3, v[68:71] offset:1024
s_waitcnt lgkmcnt(0)
s_mov_b32 s20, 1122304
buffer_load_dword v20, v1, s[12:15], s20 offen
s_mov_b32 s21, 1155072
buffer_load_dword v21, v1, s[12:15], s21 offen
s_waitcnt vmcnt(55)
v_perm_b32 v64, v23, v22, s46
v_accvgpr_write_b32 a32, v64
v_perm_b32 v68, v23, v22, s47
v_accvgpr_write_b32 a40, v68
s_barrier
s_mov_b32 s20, 1310720
buffer_load_dword v22, v1, s[12:15], s20 offen
s_mov_b32 s21, 1343488
buffer_load_dword v23, v1, s[12:15], s21 offen
s_waitcnt vmcnt(55)
v_perm_b32 v65, v25, v24, s46
v_accvgpr_write_b32 a33, v65
v_perm_b32 v69, v25, v24, s47
v_accvgpr_write_b32 a41, v69
s_mov_b32 s20, 1376256
buffer_load_dword v24, v1, s[12:15], s20 offen
s_mov_b32 s21, 1409024
buffer_load_dword v25, v1, s[12:15], s21 offen
s_waitcnt vmcnt(55)
v_perm_b32 v66, v27, v26, s46
v_accvgpr_write_b32 a34, v66
v_perm_b32 v70, v27, v26, s47
v_accvgpr_write_b32 a42, v70
s_mov_b32 s20, 1318912
buffer_load_dword v26, v1, s[12:15], s20 offen
s_mov_b32 s21, 1351680
buffer_load_dword v27, v1, s[12:15], s21 offen
s_waitcnt vmcnt(55)
v_perm_b32 v67, v29, v28, s46
v_accvgpr_write_b32 a35, v67
v_perm_b32 v71, v29, v28, s47
v_accvgpr_write_b32 a43, v71
s_mov_b32 s20, 1384448
buffer_load_dword v28, v1, s[12:15], s20 offen
s_mov_b32 s21, 1417216
buffer_load_dword v29, v1, s[12:15], s21 offen
s_waitcnt vmcnt(55)
v_perm_b32 v64, v31, v30, s46
v_accvgpr_write_b32 a36, v64
v_perm_b32 v68, v31, v30, s47
v_accvgpr_write_b32 a44, v68
s_barrier
s_mov_b32 s12, s92
s_and_b32 s13, s93, 0xffff
s_mov_b32 s14, 4718592
s_mov_b32 s15, 0x20000
s_mov_b32 s20, 1048576
buffer_load_dword v30, v1, s[12:15], s20 offen
s_mov_b32 s21, 1081344
buffer_load_dword v31, v1, s[12:15], s21 offen
s_waitcnt vmcnt(55)
v_perm_b32 v65, v33, v32, s46
v_accvgpr_write_b32 a37, v65
v_perm_b32 v69, v33, v32, s47
v_accvgpr_write_b32 a45, v69
s_mov_b32 s20, 1114112
buffer_load_dword v32, v1, s[12:15], s20 offen
s_mov_b32 s21, 1146880
buffer_load_dword v33, v1, s[12:15], s21 offen
s_waitcnt vmcnt(55)
v_perm_b32 v66, v35, v34, s46
v_accvgpr_write_b32 a38, v66
v_perm_b32 v70, v35, v34, s47
v_accvgpr_write_b32 a46, v70
s_mov_b32 s20, 1056768
buffer_load_dword v34, v1, s[12:15], s20 offen
s_mov_b32 s21, 1089536
buffer_load_dword v35, v1, s[12:15], s21 offen
s_waitcnt vmcnt(55)
v_perm_b32 v67, v37, v36, s46
v_accvgpr_write_b32 a39, v67
v_perm_b32 v71, v37, v36, s47
v_accvgpr_write_b32 a47, v71
s_mov_b32 s20, 1122304
buffer_load_dword v36, v1, s[12:15], s20 offen
s_mov_b32 s21, 1155072
buffer_load_dword v37, v1, s[12:15], s21 offen
s_waitcnt vmcnt(55)
v_perm_b32 v112, v39, v38, s46
v_perm_b32 v68, v39, v38, s47
s_barrier
s_mov_b32 s20, 1310720
buffer_load_dword v38, v1, s[12:15], s20 offen
s_mov_b32 s21, 1343488
buffer_load_dword v39, v1, s[12:15], s21 offen
s_waitcnt vmcnt(55)
v_perm_b32 v113, v41, v40, s46
v_perm_b32 v69, v41, v40, s47
s_mov_b32 s20, 1376256
buffer_load_dword v40, v1, s[12:15], s20 offen
s_mov_b32 s21, 1409024
buffer_load_dword v41, v1, s[12:15], s21 offen
s_waitcnt vmcnt(55)
v_perm_b32 v114, v43, v42, s46
v_perm_b32 v70, v43, v42, s47
s_mov_b32 s20, 1318912
buffer_load_dword v42, v1, s[12:15], s20 offen
s_mov_b32 s21, 1351680
buffer_load_dword v43, v1, s[12:15], s21 offen
s_waitcnt vmcnt(55)
v_perm_b32 v115, v45, v44, s46
v_perm_b32 v71, v45, v44, s47
ds_write_b128 v3, v[68:71] offset:2048
s_waitcnt lgkmcnt(0)
s_mov_b32 s20, 1384448
buffer_load_dword v44, v1, s[12:15], s20 offen
s_mov_b32 s21, 1417216
buffer_load_dword v45, v1, s[12:15], s21 offen
s_waitcnt vmcnt(55)
v_perm_b32 v116, v47, v46, s46
v_perm_b32 v68, v47, v46, s47
s_barrier
s_mov_b32 s12, s90
s_and_b32 s13, s91, 0xffff
s_mov_b32 s14, 4718592
s_mov_b32 s15, 0x20000
s_mov_b32 s20, 1572864
buffer_load_dword v46, v1, s[12:15], s20 offen
s_mov_b32 s21, 1605632
buffer_load_dword v47, v1, s[12:15], s21 offen
s_waitcnt vmcnt(55)
v_perm_b32 v117, v49, v48, s46
v_perm_b32 v69, v49, v48, s47
s_mov_b32 s20, 1638400
buffer_load_dword v48, v1, s[12:15], s20 offen
s_mov_b32 s21, 1671168
buffer_load_dword v49, v1, s[12:15], s21 offen
s_waitcnt vmcnt(55)
v_perm_b32 v118, v51, v50, s46
v_perm_b32 v70, v51, v50, s47
s_mov_b32 s20, 1581056
buffer_load_dword v50, v1, s[12:15], s20 offen
s_mov_b32 s21, 1613824
buffer_load_dword v51, v1, s[12:15], s21 offen
s_waitcnt vmcnt(55)
v_perm_b32 v119, v53, v52, s46
v_perm_b32 v71, v53, v52, s47
ds_write_b128 v3, v[68:71] offset:3072
s_waitcnt lgkmcnt(0)
s_mov_b32 s20, 1646592
buffer_load_dword v52, v1, s[12:15], s20 offen
s_mov_b32 s21, 1679360
buffer_load_dword v53, v1, s[12:15], s21 offen
s_waitcnt vmcnt(55)
v_perm_b32 v64, v55, v54, s46
v_accvgpr_write_b32 a48, v64
v_perm_b32 v68, v55, v54, s47
v_accvgpr_write_b32 a56, v68
s_barrier
s_mov_b32 s20, 1835008
buffer_load_dword v54, v1, s[12:15], s20 offen
s_mov_b32 s21, 1867776
buffer_load_dword v55, v1, s[12:15], s21 offen
s_waitcnt vmcnt(55)
v_perm_b32 v65, v57, v56, s46
v_accvgpr_write_b32 a49, v65
v_perm_b32 v69, v57, v56, s47
v_accvgpr_write_b32 a57, v69
s_mov_b32 s20, 1900544
buffer_load_dword v56, v1, s[12:15], s20 offen
s_mov_b32 s21, 1933312
buffer_load_dword v57, v1, s[12:15], s21 offen
s_waitcnt vmcnt(55)
v_perm_b32 v66, v59, v58, s46
v_accvgpr_write_b32 a50, v66
v_perm_b32 v70, v59, v58, s47
v_accvgpr_write_b32 a58, v70
s_mov_b32 s20, 1843200
buffer_load_dword v58, v1, s[12:15], s20 offen
s_mov_b32 s21, 1875968
buffer_load_dword v59, v1, s[12:15], s21 offen
s_waitcnt vmcnt(55)
v_perm_b32 v67, v61, v60, s46
v_accvgpr_write_b32 a51, v67
v_perm_b32 v71, v61, v60, s47
v_accvgpr_write_b32 a59, v71
s_mov_b32 s20, 1908736
buffer_load_dword v60, v1, s[12:15], s20 offen
s_mov_b32 s21, 1941504
buffer_load_dword v61, v1, s[12:15], s21 offen
s_waitcnt vmcnt(55)
v_perm_b32 v64, v7, v6, s46
v_accvgpr_write_b32 a52, v64
v_perm_b32 v68, v7, v6, s47
v_accvgpr_write_b32 a60, v68
s_barrier
s_mov_b32 s12, s92
s_and_b32 s13, s93, 0xffff
s_mov_b32 s14, 4718592
s_mov_b32 s15, 0x20000
s_mov_b32 s20, 1572864
buffer_load_dword v6, v1, s[12:15], s20 offen
s_mov_b32 s21, 1605632
buffer_load_dword v7, v1, s[12:15], s21 offen
s_waitcnt vmcnt(55)
v_perm_b32 v65, v9, v8, s46
v_accvgpr_write_b32 a53, v65
v_perm_b32 v69, v9, v8, s47
v_accvgpr_write_b32 a61, v69
s_mov_b32 s20, 1638400
buffer_load_dword v8, v1, s[12:15], s20 offen
s_mov_b32 s21, 1671168
buffer_load_dword v9, v1, s[12:15], s21 offen
s_waitcnt vmcnt(55)
v_perm_b32 v66, v11, v10, s46
v_accvgpr_write_b32 a54, v66
v_perm_b32 v70, v11, v10, s47
v_accvgpr_write_b32 a62, v70
s_mov_b32 s20, 1581056
buffer_load_dword v10, v1, s[12:15], s20 offen
s_mov_b32 s21, 1613824
buffer_load_dword v11, v1, s[12:15], s21 offen
s_waitcnt vmcnt(55)
v_perm_b32 v67, v13, v12, s46
v_accvgpr_write_b32 a55, v67
v_perm_b32 v71, v13, v12, s47
v_accvgpr_write_b32 a63, v71
s_mov_b32 s20, 1646592
buffer_load_dword v12, v1, s[12:15], s20 offen
s_mov_b32 s21, 1679360
buffer_load_dword v13, v1, s[12:15], s21 offen
s_waitcnt vmcnt(54)
v_perm_b32 v136, v15, v14, s46
v_perm_b32 v68, v15, v14, s47
s_barrier
s_mov_b32 s20, 1835008
buffer_load_dword v14, v1, s[12:15], s20 offen
s_mov_b32 s21, 1867776
buffer_load_dword v15, v1, s[12:15], s21 offen
s_waitcnt vmcnt(54)
v_perm_b32 v137, v17, v16, s46
v_perm_b32 v69, v17, v16, s47
s_mov_b32 s20, 1900544
buffer_load_dword v16, v1, s[12:15], s20 offen
s_mov_b32 s21, 1933312
buffer_load_dword v17, v1, s[12:15], s21 offen
s_waitcnt vmcnt(54)
v_perm_b32 v138, v19, v18, s46
v_perm_b32 v70, v19, v18, s47
s_mov_b32 s20, 1843200
buffer_load_dword v18, v1, s[12:15], s20 offen
s_mov_b32 s21, 1875968
buffer_load_dword v19, v1, s[12:15], s21 offen
s_waitcnt vmcnt(54)
v_perm_b32 v139, v21, v20, s46
v_perm_b32 v71, v21, v20, s47
ds_write_b128 v3, v[68:71] offset:4096
s_waitcnt lgkmcnt(0)
s_mov_b32 s20, 1908736
buffer_load_dword v20, v1, s[12:15], s20 offen
s_mov_b32 s21, 1941504
buffer_load_dword v21, v1, s[12:15], s21 offen
s_waitcnt vmcnt(54)
v_perm_b32 v140, v23, v22, s46
v_perm_b32 v68, v23, v22, s47
s_barrier
s_mov_b32 s12, s90
s_and_b32 s13, s91, 0xffff
s_mov_b32 s14, 4718592
s_mov_b32 s15, 0x20000
s_mov_b32 s20, 2097152
buffer_load_dword v22, v1, s[12:15], s20 offen
s_mov_b32 s21, 2129920
buffer_load_dword v23, v1, s[12:15], s21 offen
s_waitcnt vmcnt(54)
v_perm_b32 v141, v25, v24, s46
v_perm_b32 v69, v25, v24, s47
s_mov_b32 s20, 2162688
buffer_load_dword v24, v1, s[12:15], s20 offen
s_mov_b32 s21, 2195456
buffer_load_dword v25, v1, s[12:15], s21 offen
s_waitcnt vmcnt(54)
v_perm_b32 v142, v27, v26, s46
v_perm_b32 v70, v27, v26, s47
s_mov_b32 s20, 2105344
buffer_load_dword v26, v1, s[12:15], s20 offen
s_mov_b32 s21, 2138112
buffer_load_dword v27, v1, s[12:15], s21 offen
s_waitcnt vmcnt(54)
v_perm_b32 v143, v29, v28, s46
v_perm_b32 v71, v29, v28, s47
ds_write_b128 v3, v[68:71] offset:5120
s_waitcnt lgkmcnt(0)
s_mov_b32 s20, 2170880
buffer_load_dword v28, v1, s[12:15], s20 offen
s_mov_b32 s21, 2203648
buffer_load_dword v29, v1, s[12:15], s21 offen
s_waitcnt vmcnt(54)
v_perm_b32 v64, v31, v30, s46
v_accvgpr_write_b32 a64, v64
v_perm_b32 v68, v31, v30, s47
v_accvgpr_write_b32 a72, v68
s_barrier
s_mov_b32 s20, 2359296
buffer_load_dword v30, v1, s[12:15], s20 offen
s_mov_b32 s21, 2392064
buffer_load_dword v31, v1, s[12:15], s21 offen
s_waitcnt vmcnt(54)
v_perm_b32 v65, v33, v32, s46
v_accvgpr_write_b32 a65, v65
v_perm_b32 v69, v33, v32, s47
v_accvgpr_write_b32 a73, v69
s_mov_b32 s20, 2424832
buffer_load_dword v32, v1, s[12:15], s20 offen
s_mov_b32 s21, 2457600
buffer_load_dword v33, v1, s[12:15], s21 offen
s_waitcnt vmcnt(54)
v_perm_b32 v66, v35, v34, s46
v_accvgpr_write_b32 a66, v66
v_perm_b32 v70, v35, v34, s47
v_accvgpr_write_b32 a74, v70
s_mov_b32 s20, 2367488
buffer_load_dword v34, v1, s[12:15], s20 offen
s_mov_b32 s21, 2400256
buffer_load_dword v35, v1, s[12:15], s21 offen
s_waitcnt vmcnt(54)
v_perm_b32 v67, v37, v36, s46
v_accvgpr_write_b32 a67, v67
v_perm_b32 v71, v37, v36, s47
v_accvgpr_write_b32 a75, v71
s_mov_b32 s20, 2433024
buffer_load_dword v36, v1, s[12:15], s20 offen
s_mov_b32 s21, 2465792
buffer_load_dword v37, v1, s[12:15], s21 offen
s_waitcnt vmcnt(54)
v_perm_b32 v64, v39, v38, s46
v_accvgpr_write_b32 a68, v64
v_perm_b32 v68, v39, v38, s47
v_accvgpr_write_b32 a76, v68
s_barrier
s_mov_b32 s12, s92
s_and_b32 s13, s93, 0xffff
s_mov_b32 s14, 4718592
s_mov_b32 s15, 0x20000
s_mov_b32 s20, 2097152
buffer_load_dword v38, v1, s[12:15], s20 offen
s_mov_b32 s21, 2129920
buffer_load_dword v39, v1, s[12:15], s21 offen
s_waitcnt vmcnt(54)
v_perm_b32 v65, v41, v40, s46
v_accvgpr_write_b32 a69, v65
v_perm_b32 v69, v41, v40, s47
v_accvgpr_write_b32 a77, v69
s_mov_b32 s20, 2162688
buffer_load_dword v40, v1, s[12:15], s20 offen
s_mov_b32 s21, 2195456
buffer_load_dword v41, v1, s[12:15], s21 offen
s_waitcnt vmcnt(54)
v_perm_b32 v66, v43, v42, s46
v_accvgpr_write_b32 a70, v66
v_perm_b32 v70, v43, v42, s47
v_accvgpr_write_b32 a78, v70
s_mov_b32 s20, 2105344
buffer_load_dword v42, v1, s[12:15], s20 offen
s_mov_b32 s21, 2138112
buffer_load_dword v43, v1, s[12:15], s21 offen
s_waitcnt vmcnt(54)
v_perm_b32 v67, v45, v44, s46
v_accvgpr_write_b32 a71, v67
v_perm_b32 v71, v45, v44, s47
v_accvgpr_write_b32 a79, v71
s_mov_b32 s20, 2170880
buffer_load_dword v44, v1, s[12:15], s20 offen
s_mov_b32 s21, 2203648
buffer_load_dword v45, v1, s[12:15], s21 offen
s_waitcnt vmcnt(54)
v_perm_b32 v160, v47, v46, s46
v_perm_b32 v68, v47, v46, s47
s_barrier
s_mov_b32 s20, 2359296
buffer_load_dword v46, v1, s[12:15], s20 offen
s_mov_b32 s21, 2392064
buffer_load_dword v47, v1, s[12:15], s21 offen
s_waitcnt vmcnt(54)
v_perm_b32 v161, v49, v48, s46
v_perm_b32 v69, v49, v48, s47
s_mov_b32 s20, 2424832
buffer_load_dword v48, v1, s[12:15], s20 offen
s_mov_b32 s21, 2457600
buffer_load_dword v49, v1, s[12:15], s21 offen
s_waitcnt vmcnt(54)
v_perm_b32 v162, v51, v50, s46
v_perm_b32 v70, v51, v50, s47
s_mov_b32 s20, 2367488
buffer_load_dword v50, v1, s[12:15], s20 offen
s_mov_b32 s21, 2400256
buffer_load_dword v51, v1, s[12:15], s21 offen
s_waitcnt vmcnt(54)
v_perm_b32 v163, v53, v52, s46
v_perm_b32 v71, v53, v52, s47
ds_write_b128 v3, v[68:71] offset:6144
s_waitcnt lgkmcnt(0)
s_mov_b32 s20, 2433024
buffer_load_dword v52, v1, s[12:15], s20 offen
s_mov_b32 s21, 2465792
buffer_load_dword v53, v1, s[12:15], s21 offen
s_waitcnt vmcnt(54)
v_perm_b32 v164, v55, v54, s46
v_perm_b32 v68, v55, v54, s47
s_barrier
s_mov_b32 s12, s90
s_and_b32 s13, s91, 0xffff
s_mov_b32 s14, 4718592
s_mov_b32 s15, 0x20000
s_mov_b32 s20, 2621440
buffer_load_dword v54, v1, s[12:15], s20 offen
s_mov_b32 s21, 2654208
buffer_load_dword v55, v1, s[12:15], s21 offen
s_waitcnt vmcnt(54)
v_perm_b32 v165, v57, v56, s46
v_perm_b32 v69, v57, v56, s47
s_mov_b32 s20, 2686976
buffer_load_dword v56, v1, s[12:15], s20 offen
s_mov_b32 s21, 2719744
buffer_load_dword v57, v1, s[12:15], s21 offen
s_waitcnt vmcnt(54)
v_perm_b32 v166, v59, v58, s46
v_perm_b32 v70, v59, v58, s47
s_mov_b32 s20, 2629632
buffer_load_dword v58, v1, s[12:15], s20 offen
s_mov_b32 s21, 2662400
buffer_load_dword v59, v1, s[12:15], s21 offen
s_waitcnt vmcnt(54)
v_perm_b32 v167, v61, v60, s46
v_perm_b32 v71, v61, v60, s47
ds_write_b128 v3, v[68:71] offset:7168
s_waitcnt lgkmcnt(0)
s_mov_b32 s20, 2695168
buffer_load_dword v60, v1, s[12:15], s20 offen
s_mov_b32 s21, 2727936
buffer_load_dword v61, v1, s[12:15], s21 offen
s_waitcnt vmcnt(54)
v_perm_b32 v64, v7, v6, s46
v_accvgpr_write_b32 a80, v64
v_perm_b32 v68, v7, v6, s47
v_accvgpr_write_b32 a88, v68
s_barrier
s_mov_b32 s20, 2883584
buffer_load_dword v6, v1, s[12:15], s20 offen
s_mov_b32 s21, 2916352
buffer_load_dword v7, v1, s[12:15], s21 offen
s_waitcnt vmcnt(54)
v_perm_b32 v65, v9, v8, s46
v_accvgpr_write_b32 a81, v65
v_perm_b32 v69, v9, v8, s47
v_accvgpr_write_b32 a89, v69
s_mov_b32 s20, 2949120
buffer_load_dword v8, v1, s[12:15], s20 offen
s_mov_b32 s21, 2981888
buffer_load_dword v9, v1, s[12:15], s21 offen
s_waitcnt vmcnt(54)
v_perm_b32 v66, v11, v10, s46
v_accvgpr_write_b32 a82, v66
v_perm_b32 v70, v11, v10, s47
v_accvgpr_write_b32 a90, v70
s_mov_b32 s20, 2891776
buffer_load_dword v10, v1, s[12:15], s20 offen
s_mov_b32 s21, 2924544
buffer_load_dword v11, v1, s[12:15], s21 offen
s_waitcnt vmcnt(54)
v_perm_b32 v67, v13, v12, s46
v_accvgpr_write_b32 a83, v67
v_perm_b32 v71, v13, v12, s47
v_accvgpr_write_b32 a91, v71
s_mov_b32 s20, 2957312
buffer_load_dword v12, v1, s[12:15], s20 offen
s_mov_b32 s21, 2990080
buffer_load_dword v13, v1, s[12:15], s21 offen
s_waitcnt vmcnt(54)
v_perm_b32 v64, v15, v14, s46
v_accvgpr_write_b32 a84, v64
v_perm_b32 v68, v15, v14, s47
v_accvgpr_write_b32 a92, v68
s_barrier
s_mov_b32 s12, s92
s_and_b32 s13, s93, 0xffff
s_mov_b32 s14, 4718592
s_mov_b32 s15, 0x20000
s_mov_b32 s20, 2621440
buffer_load_dword v14, v1, s[12:15], s20 offen
s_mov_b32 s21, 2654208
buffer_load_dword v15, v1, s[12:15], s21 offen
s_waitcnt vmcnt(54)
v_perm_b32 v65, v17, v16, s46
v_accvgpr_write_b32 a85, v65
v_perm_b32 v69, v17, v16, s47
v_accvgpr_write_b32 a93, v69
s_mov_b32 s20, 2686976
buffer_load_dword v16, v1, s[12:15], s20 offen
s_mov_b32 s21, 2719744
buffer_load_dword v17, v1, s[12:15], s21 offen
s_waitcnt vmcnt(54)
v_perm_b32 v66, v19, v18, s46
v_accvgpr_write_b32 a86, v66
v_perm_b32 v70, v19, v18, s47
v_accvgpr_write_b32 a94, v70
s_mov_b32 s20, 2629632
buffer_load_dword v18, v1, s[12:15], s20 offen
s_mov_b32 s21, 2662400
buffer_load_dword v19, v1, s[12:15], s21 offen
s_waitcnt vmcnt(54)
v_perm_b32 v67, v21, v20, s46
v_accvgpr_write_b32 a87, v67
v_perm_b32 v71, v21, v20, s47
v_accvgpr_write_b32 a95, v71
s_mov_b32 s20, 2695168
buffer_load_dword v20, v1, s[12:15], s20 offen
s_mov_b32 s21, 2727936
buffer_load_dword v21, v1, s[12:15], s21 offen
s_waitcnt vmcnt(54)
v_perm_b32 v184, v23, v22, s46
v_perm_b32 v68, v23, v22, s47
s_barrier
s_mov_b32 s20, 2883584
buffer_load_dword v22, v1, s[12:15], s20 offen
s_mov_b32 s21, 2916352
buffer_load_dword v23, v1, s[12:15], s21 offen
s_waitcnt vmcnt(54)
v_perm_b32 v185, v25, v24, s46
v_perm_b32 v69, v25, v24, s47
s_mov_b32 s20, 2949120
buffer_load_dword v24, v1, s[12:15], s20 offen
s_mov_b32 s21, 2981888
buffer_load_dword v25, v1, s[12:15], s21 offen
s_waitcnt vmcnt(54)
v_perm_b32 v186, v27, v26, s46
v_perm_b32 v70, v27, v26, s47
s_mov_b32 s20, 2891776
buffer_load_dword v26, v1, s[12:15], s20 offen
s_mov_b32 s21, 2924544
buffer_load_dword v27, v1, s[12:15], s21 offen
s_waitcnt vmcnt(54)
v_perm_b32 v187, v29, v28, s46
v_perm_b32 v71, v29, v28, s47
ds_write_b128 v3, v[68:71] offset:8192
s_waitcnt lgkmcnt(0)
s_mov_b32 s20, 2957312
buffer_load_dword v28, v1, s[12:15], s20 offen
s_mov_b32 s21, 2990080
buffer_load_dword v29, v1, s[12:15], s21 offen
s_waitcnt vmcnt(54)
v_perm_b32 v188, v31, v30, s46
v_perm_b32 v68, v31, v30, s47
s_barrier
s_mov_b32 s12, s90
s_and_b32 s13, s91, 0xffff
s_mov_b32 s14, 4718592
s_mov_b32 s15, 0x20000
s_mov_b32 s20, 3145728
buffer_load_dword v30, v1, s[12:15], s20 offen
s_mov_b32 s21, 3178496
buffer_load_dword v31, v1, s[12:15], s21 offen
s_waitcnt vmcnt(54)
v_perm_b32 v189, v33, v32, s46
v_perm_b32 v69, v33, v32, s47
s_mov_b32 s20, 3211264
buffer_load_dword v32, v1, s[12:15], s20 offen
s_mov_b32 s21, 3244032
buffer_load_dword v33, v1, s[12:15], s21 offen
s_waitcnt vmcnt(54)
v_perm_b32 v190, v35, v34, s46
v_perm_b32 v70, v35, v34, s47
s_mov_b32 s20, 3153920
buffer_load_dword v34, v1, s[12:15], s20 offen
s_mov_b32 s21, 3186688
buffer_load_dword v35, v1, s[12:15], s21 offen
s_waitcnt vmcnt(54)
v_perm_b32 v191, v37, v36, s46
v_perm_b32 v71, v37, v36, s47
ds_write_b128 v3, v[68:71] offset:9216
s_waitcnt lgkmcnt(0)
s_mov_b32 s20, 3219456
buffer_load_dword v36, v1, s[12:15], s20 offen
s_mov_b32 s21, 3252224
buffer_load_dword v37, v1, s[12:15], s21 offen
s_waitcnt vmcnt(54)
v_perm_b32 v64, v39, v38, s46
v_accvgpr_write_b32 a96, v64
v_perm_b32 v68, v39, v38, s47
v_accvgpr_write_b32 a104, v68
s_barrier
s_mov_b32 s20, 3407872
buffer_load_dword v38, v1, s[12:15], s20 offen
s_mov_b32 s21, 3440640
buffer_load_dword v39, v1, s[12:15], s21 offen
s_waitcnt vmcnt(54)
v_perm_b32 v65, v41, v40, s46
v_accvgpr_write_b32 a97, v65
v_perm_b32 v69, v41, v40, s47
v_accvgpr_write_b32 a105, v69
s_mov_b32 s20, 3473408
buffer_load_dword v40, v1, s[12:15], s20 offen
s_mov_b32 s21, 3506176
buffer_load_dword v41, v1, s[12:15], s21 offen
s_waitcnt vmcnt(54)
v_perm_b32 v66, v43, v42, s46
v_accvgpr_write_b32 a98, v66
v_perm_b32 v70, v43, v42, s47
v_accvgpr_write_b32 a106, v70
s_mov_b32 s20, 3416064
buffer_load_dword v42, v1, s[12:15], s20 offen
s_mov_b32 s21, 3448832
buffer_load_dword v43, v1, s[12:15], s21 offen
s_waitcnt vmcnt(54)
v_perm_b32 v67, v45, v44, s46
v_accvgpr_write_b32 a99, v67
v_perm_b32 v71, v45, v44, s47
v_accvgpr_write_b32 a107, v71
s_mov_b32 s20, 3481600
buffer_load_dword v44, v1, s[12:15], s20 offen
s_mov_b32 s21, 3514368
buffer_load_dword v45, v1, s[12:15], s21 offen
s_waitcnt vmcnt(54)
v_perm_b32 v64, v47, v46, s46
v_accvgpr_write_b32 a100, v64
v_perm_b32 v68, v47, v46, s47
v_accvgpr_write_b32 a108, v68
s_barrier
s_mov_b32 s12, s92
s_and_b32 s13, s93, 0xffff
s_mov_b32 s14, 4718592
s_mov_b32 s15, 0x20000
s_mov_b32 s20, 3145728
buffer_load_dword v46, v1, s[12:15], s20 offen
s_mov_b32 s21, 3178496
buffer_load_dword v47, v1, s[12:15], s21 offen
s_waitcnt vmcnt(54)
v_perm_b32 v65, v49, v48, s46
v_accvgpr_write_b32 a101, v65
v_perm_b32 v69, v49, v48, s47
v_accvgpr_write_b32 a109, v69
s_mov_b32 s20, 3211264
buffer_load_dword v48, v1, s[12:15], s20 offen
s_mov_b32 s21, 3244032
buffer_load_dword v49, v1, s[12:15], s21 offen
s_waitcnt vmcnt(54)
v_perm_b32 v66, v51, v50, s46
v_accvgpr_write_b32 a102, v66
v_perm_b32 v70, v51, v50, s47
v_accvgpr_write_b32 a110, v70
s_mov_b32 s20, 3153920
buffer_load_dword v50, v1, s[12:15], s20 offen
s_mov_b32 s21, 3186688
buffer_load_dword v51, v1, s[12:15], s21 offen
s_waitcnt vmcnt(54)
v_perm_b32 v67, v53, v52, s46
v_accvgpr_write_b32 a103, v67
v_perm_b32 v71, v53, v52, s47
v_accvgpr_write_b32 a111, v71
s_mov_b32 s20, 3219456
buffer_load_dword v52, v1, s[12:15], s20 offen
s_mov_b32 s21, 3252224
buffer_load_dword v53, v1, s[12:15], s21 offen
s_waitcnt vmcnt(54)
v_perm_b32 v208, v55, v54, s46
v_perm_b32 v68, v55, v54, s47
s_barrier
s_mov_b32 s20, 3407872
buffer_load_dword v54, v1, s[12:15], s20 offen
s_mov_b32 s21, 3440640
buffer_load_dword v55, v1, s[12:15], s21 offen
s_waitcnt vmcnt(54)
v_perm_b32 v209, v57, v56, s46
v_perm_b32 v69, v57, v56, s47
s_mov_b32 s20, 3473408
buffer_load_dword v56, v1, s[12:15], s20 offen
s_mov_b32 s21, 3506176
buffer_load_dword v57, v1, s[12:15], s21 offen
s_waitcnt vmcnt(54)
v_perm_b32 v210, v59, v58, s46
v_perm_b32 v70, v59, v58, s47
s_mov_b32 s20, 3416064
buffer_load_dword v58, v1, s[12:15], s20 offen
s_mov_b32 s21, 3448832
buffer_load_dword v59, v1, s[12:15], s21 offen
s_waitcnt vmcnt(54)
v_perm_b32 v211, v61, v60, s46
v_perm_b32 v71, v61, v60, s47
ds_write_b128 v3, v[68:71] offset:10240
s_waitcnt lgkmcnt(0)
s_mov_b32 s20, 3481600
buffer_load_dword v60, v1, s[12:15], s20 offen
s_mov_b32 s21, 3514368
buffer_load_dword v61, v1, s[12:15], s21 offen
s_waitcnt vmcnt(54)
v_perm_b32 v212, v7, v6, s46
v_perm_b32 v68, v7, v6, s47
s_barrier
s_mov_b32 s12, s90
s_and_b32 s13, s91, 0xffff
s_mov_b32 s14, 4718592
s_mov_b32 s15, 0x20000
s_mov_b32 s20, 3670016
buffer_load_dword v6, v1, s[12:15], s20 offen
s_mov_b32 s21, 3702784
buffer_load_dword v7, v1, s[12:15], s21 offen
s_waitcnt vmcnt(54)
v_perm_b32 v213, v9, v8, s46
v_perm_b32 v69, v9, v8, s47
s_mov_b32 s20, 3735552
buffer_load_dword v8, v1, s[12:15], s20 offen
s_mov_b32 s21, 3768320
buffer_load_dword v9, v1, s[12:15], s21 offen
s_waitcnt vmcnt(54)
v_perm_b32 v214, v11, v10, s46
v_perm_b32 v70, v11, v10, s47
s_mov_b32 s20, 3678208
buffer_load_dword v10, v1, s[12:15], s20 offen
s_mov_b32 s21, 3710976
buffer_load_dword v11, v1, s[12:15], s21 offen
s_waitcnt vmcnt(54)
v_perm_b32 v215, v13, v12, s46
v_perm_b32 v71, v13, v12, s47
ds_write_b128 v3, v[68:71] offset:11264
s_waitcnt lgkmcnt(0)
s_mov_b32 s20, 3743744
buffer_load_dword v12, v1, s[12:15], s20 offen
s_mov_b32 s21, 3776512
buffer_load_dword v13, v1, s[12:15], s21 offen
s_waitcnt vmcnt(54)
v_perm_b32 v64, v15, v14, s46
v_accvgpr_write_b32 a112, v64
v_perm_b32 v68, v15, v14, s47
v_accvgpr_write_b32 a120, v68
s_barrier
s_mov_b32 s20, 3932160
buffer_load_dword v14, v1, s[12:15], s20 offen
s_mov_b32 s21, 3964928
buffer_load_dword v15, v1, s[12:15], s21 offen
s_waitcnt vmcnt(54)
v_perm_b32 v65, v17, v16, s46
v_accvgpr_write_b32 a113, v65
v_perm_b32 v69, v17, v16, s47
v_accvgpr_write_b32 a121, v69
s_mov_b32 s20, 3997696
buffer_load_dword v16, v1, s[12:15], s20 offen
s_mov_b32 s21, 4030464
buffer_load_dword v17, v1, s[12:15], s21 offen
s_waitcnt vmcnt(54)
v_perm_b32 v66, v19, v18, s46
v_accvgpr_write_b32 a114, v66
v_perm_b32 v70, v19, v18, s47
v_accvgpr_write_b32 a122, v70
s_mov_b32 s20, 3940352
buffer_load_dword v18, v1, s[12:15], s20 offen
s_mov_b32 s21, 3973120
buffer_load_dword v19, v1, s[12:15], s21 offen
s_waitcnt vmcnt(54)
v_perm_b32 v67, v21, v20, s46
v_accvgpr_write_b32 a115, v67
v_perm_b32 v71, v21, v20, s47
v_accvgpr_write_b32 a123, v71
s_mov_b32 s20, 4005888
buffer_load_dword v20, v1, s[12:15], s20 offen
s_mov_b32 s21, 4038656
buffer_load_dword v21, v1, s[12:15], s21 offen
s_waitcnt vmcnt(54)
v_perm_b32 v64, v23, v22, s46
v_accvgpr_write_b32 a116, v64
v_perm_b32 v68, v23, v22, s47
v_accvgpr_write_b32 a124, v68
s_barrier
s_mov_b32 s12, s92
s_and_b32 s13, s93, 0xffff
s_mov_b32 s14, 4718592
s_mov_b32 s15, 0x20000
s_mov_b32 s20, 3670016
buffer_load_dword v22, v1, s[12:15], s20 offen
s_mov_b32 s21, 3702784
buffer_load_dword v23, v1, s[12:15], s21 offen
s_waitcnt vmcnt(54)
v_perm_b32 v65, v25, v24, s46
v_accvgpr_write_b32 a117, v65
v_perm_b32 v69, v25, v24, s47
v_accvgpr_write_b32 a125, v69
s_mov_b32 s20, 3735552
buffer_load_dword v24, v1, s[12:15], s20 offen
s_mov_b32 s21, 3768320
buffer_load_dword v25, v1, s[12:15], s21 offen
s_waitcnt vmcnt(54)
v_perm_b32 v66, v27, v26, s46
v_accvgpr_write_b32 a118, v66
v_perm_b32 v70, v27, v26, s47
v_accvgpr_write_b32 a126, v70
s_mov_b32 s20, 3678208
buffer_load_dword v26, v1, s[12:15], s20 offen
s_mov_b32 s21, 3710976
buffer_load_dword v27, v1, s[12:15], s21 offen
s_waitcnt vmcnt(54)
v_perm_b32 v67, v29, v28, s46
v_accvgpr_write_b32 a119, v67
v_perm_b32 v71, v29, v28, s47
v_accvgpr_write_b32 a127, v71
s_mov_b32 s20, 3743744
buffer_load_dword v28, v1, s[12:15], s20 offen
s_mov_b32 s21, 3776512
buffer_load_dword v29, v1, s[12:15], s21 offen
s_waitcnt vmcnt(54)
v_perm_b32 v232, v31, v30, s46
v_perm_b32 v68, v31, v30, s47
s_barrier
s_mov_b32 s20, 3932160
buffer_load_dword v30, v1, s[12:15], s20 offen
s_mov_b32 s21, 3964928
buffer_load_dword v31, v1, s[12:15], s21 offen
s_waitcnt vmcnt(54)
v_perm_b32 v233, v33, v32, s46
v_perm_b32 v69, v33, v32, s47
s_mov_b32 s20, 3997696
buffer_load_dword v32, v1, s[12:15], s20 offen
s_mov_b32 s21, 4030464
buffer_load_dword v33, v1, s[12:15], s21 offen
s_waitcnt vmcnt(54)
v_perm_b32 v234, v35, v34, s46
v_perm_b32 v70, v35, v34, s47
s_mov_b32 s20, 3940352
buffer_load_dword v34, v1, s[12:15], s20 offen
s_mov_b32 s21, 3973120
buffer_load_dword v35, v1, s[12:15], s21 offen
s_waitcnt vmcnt(54)
v_perm_b32 v235, v37, v36, s46
v_perm_b32 v71, v37, v36, s47
ds_write_b128 v3, v[68:71] offset:12288
s_waitcnt lgkmcnt(0)
s_mov_b32 s20, 4005888
buffer_load_dword v36, v1, s[12:15], s20 offen
s_mov_b32 s21, 4038656
buffer_load_dword v37, v1, s[12:15], s21 offen
s_waitcnt vmcnt(54)
v_perm_b32 v236, v39, v38, s46
v_perm_b32 v68, v39, v38, s47
s_barrier
s_mov_b32 s12, s90
s_and_b32 s13, s91, 0xffff
s_mov_b32 s14, 4718592
s_mov_b32 s15, 0x20000
s_mov_b32 s20, 4194304
buffer_load_dword v38, v1, s[12:15], s20 offen
s_mov_b32 s21, 4227072
buffer_load_dword v39, v1, s[12:15], s21 offen
s_waitcnt vmcnt(54)
v_perm_b32 v237, v41, v40, s46
v_perm_b32 v69, v41, v40, s47
s_mov_b32 s20, 4259840
buffer_load_dword v40, v1, s[12:15], s20 offen
s_mov_b32 s21, 4292608
buffer_load_dword v41, v1, s[12:15], s21 offen
s_waitcnt vmcnt(54)
v_perm_b32 v238, v43, v42, s46
v_perm_b32 v70, v43, v42, s47
s_mov_b32 s20, 4202496
buffer_load_dword v42, v1, s[12:15], s20 offen
s_mov_b32 s21, 4235264
buffer_load_dword v43, v1, s[12:15], s21 offen
s_waitcnt vmcnt(54)
v_perm_b32 v239, v45, v44, s46
v_perm_b32 v71, v45, v44, s47
ds_write_b128 v3, v[68:71] offset:13312
s_waitcnt lgkmcnt(0)
s_mov_b32 s20, 4268032
buffer_load_dword v44, v1, s[12:15], s20 offen
s_mov_b32 s21, 4300800
buffer_load_dword v45, v1, s[12:15], s21 offen
s_waitcnt vmcnt(54)
v_perm_b32 v64, v47, v46, s46
v_accvgpr_write_b32 a128, v64
v_perm_b32 v68, v47, v46, s47
v_accvgpr_write_b32 a136, v68
s_barrier
s_mov_b32 s20, 4456448
buffer_load_dword v46, v1, s[12:15], s20 offen
s_mov_b32 s21, 4489216
buffer_load_dword v47, v1, s[12:15], s21 offen
s_waitcnt vmcnt(54)
v_perm_b32 v65, v49, v48, s46
v_accvgpr_write_b32 a129, v65
v_perm_b32 v69, v49, v48, s47
v_accvgpr_write_b32 a137, v69
s_mov_b32 s20, 4521984
buffer_load_dword v48, v1, s[12:15], s20 offen
s_mov_b32 s21, 4554752
buffer_load_dword v49, v1, s[12:15], s21 offen
s_waitcnt vmcnt(54)
v_perm_b32 v66, v51, v50, s46
v_accvgpr_write_b32 a130, v66
v_perm_b32 v70, v51, v50, s47
v_accvgpr_write_b32 a138, v70
s_mov_b32 s20, 4464640
buffer_load_dword v50, v1, s[12:15], s20 offen
s_mov_b32 s21, 4497408
buffer_load_dword v51, v1, s[12:15], s21 offen
s_waitcnt vmcnt(54)
v_perm_b32 v67, v53, v52, s46
v_accvgpr_write_b32 a131, v67
v_perm_b32 v71, v53, v52, s47
v_accvgpr_write_b32 a139, v71
s_mov_b32 s20, 4530176
buffer_load_dword v52, v1, s[12:15], s20 offen
s_mov_b32 s21, 4562944
buffer_load_dword v53, v1, s[12:15], s21 offen
s_waitcnt vmcnt(54)
v_perm_b32 v64, v55, v54, s46
v_accvgpr_write_b32 a132, v64
v_perm_b32 v68, v55, v54, s47
v_accvgpr_write_b32 a140, v68
s_barrier
s_mov_b32 s12, s92
s_and_b32 s13, s93, 0xffff
s_mov_b32 s14, 4718592
s_mov_b32 s15, 0x20000
s_mov_b32 s20, 4194304
buffer_load_dword v54, v1, s[12:15], s20 offen
s_mov_b32 s21, 4227072
buffer_load_dword v55, v1, s[12:15], s21 offen
s_waitcnt vmcnt(54)
v_perm_b32 v65, v57, v56, s46
v_accvgpr_write_b32 a133, v65
v_perm_b32 v69, v57, v56, s47
v_accvgpr_write_b32 a141, v69
s_mov_b32 s20, 4259840
buffer_load_dword v56, v1, s[12:15], s20 offen
s_mov_b32 s21, 4292608
buffer_load_dword v57, v1, s[12:15], s21 offen
s_waitcnt vmcnt(54)
v_perm_b32 v66, v59, v58, s46
v_accvgpr_write_b32 a134, v66
v_perm_b32 v70, v59, v58, s47
v_accvgpr_write_b32 a142, v70
s_mov_b32 s20, 4202496
buffer_load_dword v58, v1, s[12:15], s20 offen
s_mov_b32 s21, 4235264
buffer_load_dword v59, v1, s[12:15], s21 offen
s_waitcnt vmcnt(54)
v_perm_b32 v67, v61, v60, s46
v_accvgpr_write_b32 a135, v67
v_perm_b32 v71, v61, v60, s47
v_accvgpr_write_b32 a143, v71
s_mov_b32 s20, 4268032
buffer_load_dword v60, v1, s[12:15], s20 offen
s_mov_b32 s21, 4300800
buffer_load_dword v61, v1, s[12:15], s21 offen
s_waitcnt vmcnt(54)
v_perm_b32 v64, v7, v6, s46
v_accvgpr_write_b32 a0, v64
v_perm_b32 v68, v7, v6, s47
s_barrier
s_mov_b32 s20, 4456448
buffer_load_dword v6, v1, s[12:15], s20 offen
s_mov_b32 s21, 4489216
buffer_load_dword v7, v1, s[12:15], s21 offen
s_waitcnt vmcnt(54)
v_perm_b32 v65, v9, v8, s46
v_accvgpr_write_b32 a1, v65
v_perm_b32 v69, v9, v8, s47
s_mov_b32 s20, 4521984
buffer_load_dword v8, v1, s[12:15], s20 offen
s_mov_b32 s21, 4554752
buffer_load_dword v9, v1, s[12:15], s21 offen
s_waitcnt vmcnt(54)
v_perm_b32 v66, v11, v10, s46
v_accvgpr_write_b32 a2, v66
v_perm_b32 v70, v11, v10, s47
s_mov_b32 s20, 4464640
buffer_load_dword v10, v1, s[12:15], s20 offen
s_mov_b32 s21, 4497408
buffer_load_dword v11, v1, s[12:15], s21 offen
s_waitcnt vmcnt(54)
v_perm_b32 v67, v13, v12, s46
v_accvgpr_write_b32 a3, v67
v_perm_b32 v71, v13, v12, s47
ds_write_b128 v3, v[68:71] offset:14336
s_waitcnt lgkmcnt(0)
s_mov_b32 s20, 4530176
buffer_load_dword v12, v1, s[12:15], s20 offen
s_mov_b32 s21, 4562944
buffer_load_dword v13, v1, s[12:15], s21 offen
s_waitcnt vmcnt(54)
v_perm_b32 v64, v15, v14, s46
v_accvgpr_write_b32 a4, v64
v_perm_b32 v68, v15, v14, s47
s_barrier
s_mov_b32 s12, s94
s_and_b32 s13, s95, 0xffff
s_mov_b32 s14, 4718592
s_mov_b32 s15, 0x20000
s_mov_b32 s20, 0
buffer_load_dword v14, v4, s[12:15], s20 offen
s_mov_b32 s21, 1152
buffer_load_dword v15, v4, s[12:15], s21 offen
s_waitcnt vmcnt(54)
v_perm_b32 v65, v17, v16, s46
v_accvgpr_write_b32 a5, v65
v_perm_b32 v69, v17, v16, s47
s_mov_b32 s20, 9216
buffer_load_dword v16, v4, s[12:15], s20 offen
s_mov_b32 s21, 10368
buffer_load_dword v17, v4, s[12:15], s21 offen
s_waitcnt vmcnt(54)
v_perm_b32 v66, v19, v18, s46
v_accvgpr_write_b32 a6, v66
v_perm_b32 v70, v19, v18, s47
s_mov_b32 s20, 2304
buffer_load_dword v18, v4, s[12:15], s20 offen
s_mov_b32 s21, 3456
buffer_load_dword v19, v4, s[12:15], s21 offen
s_waitcnt vmcnt(54)
v_perm_b32 v67, v21, v20, s46
v_accvgpr_write_b32 a7, v67
v_perm_b32 v71, v21, v20, s47
ds_write_b128 v3, v[68:71] offset:15360
s_waitcnt lgkmcnt(0)
s_mov_b32 s20, 11520
buffer_load_dword v20, v4, s[12:15], s20 offen
s_mov_b32 s21, 12672
buffer_load_dword v21, v4, s[12:15], s21 offen
s_waitcnt vmcnt(54)
v_perm_b32 v64, v23, v22, s46
v_accvgpr_write_b32 a144, v64
v_perm_b32 v68, v23, v22, s47
v_accvgpr_write_b32 a152, v68
s_barrier
s_mov_b32 s20, 36864
buffer_load_dword v22, v4, s[12:15], s20 offen
s_mov_b32 s21, 38016
buffer_load_dword v23, v4, s[12:15], s21 offen
s_waitcnt vmcnt(54)
v_perm_b32 v65, v25, v24, s46
v_accvgpr_write_b32 a145, v65
v_perm_b32 v69, v25, v24, s47
v_accvgpr_write_b32 a153, v69
s_mov_b32 s20, 46080
buffer_load_dword v24, v4, s[12:15], s20 offen
s_mov_b32 s21, 47232
buffer_load_dword v25, v4, s[12:15], s21 offen
s_waitcnt vmcnt(54)
v_perm_b32 v66, v27, v26, s46
v_accvgpr_write_b32 a146, v66
v_perm_b32 v70, v27, v26, s47
v_accvgpr_write_b32 a154, v70
s_mov_b32 s20, 39168
buffer_load_dword v26, v4, s[12:15], s20 offen
s_mov_b32 s21, 40320
buffer_load_dword v27, v4, s[12:15], s21 offen
s_waitcnt vmcnt(54)
v_perm_b32 v67, v29, v28, s46
v_accvgpr_write_b32 a147, v67
v_perm_b32 v71, v29, v28, s47
v_accvgpr_write_b32 a155, v71
s_mov_b32 s20, 48384
buffer_load_dword v28, v4, s[12:15], s20 offen
s_mov_b32 s21, 49536
buffer_load_dword v29, v4, s[12:15], s21 offen
s_waitcnt vmcnt(54)
v_perm_b32 v64, v31, v30, s46
v_accvgpr_write_b32 a148, v64
v_perm_b32 v68, v31, v30, s47
v_accvgpr_write_b32 a156, v68
s_barrier
s_mov_b32 s20, 73728
buffer_load_dword v30, v4, s[12:15], s20 offen
s_mov_b32 s21, 74880
buffer_load_dword v31, v4, s[12:15], s21 offen
s_waitcnt vmcnt(54)
v_perm_b32 v65, v33, v32, s46
v_accvgpr_write_b32 a149, v65
v_perm_b32 v69, v33, v32, s47
v_accvgpr_write_b32 a157, v69
s_mov_b32 s20, 82944
buffer_load_dword v32, v4, s[12:15], s20 offen
s_mov_b32 s21, 84096
buffer_load_dword v33, v4, s[12:15], s21 offen
s_waitcnt vmcnt(54)
v_perm_b32 v66, v35, v34, s46
v_accvgpr_write_b32 a150, v66
v_perm_b32 v70, v35, v34, s47
v_accvgpr_write_b32 a158, v70
s_mov_b32 s20, 76032
buffer_load_dword v34, v4, s[12:15], s20 offen
s_mov_b32 s21, 77184
buffer_load_dword v35, v4, s[12:15], s21 offen
s_waitcnt vmcnt(54)
v_perm_b32 v67, v37, v36, s46
v_accvgpr_write_b32 a151, v67
v_perm_b32 v71, v37, v36, s47
v_accvgpr_write_b32 a159, v71
s_mov_b32 s20, 85248
buffer_load_dword v36, v4, s[12:15], s20 offen
s_mov_b32 s21, 86400
buffer_load_dword v37, v4, s[12:15], s21 offen
s_waitcnt vmcnt(54)
v_perm_b32 v64, v39, v38, s46
v_accvgpr_write_b32 a24, v64
v_perm_b32 v68, v39, v38, s47
s_barrier
s_mov_b32 s20, 110592
buffer_load_dword v38, v4, s[12:15], s20 offen
s_mov_b32 s21, 111744
buffer_load_dword v39, v4, s[12:15], s21 offen
s_waitcnt vmcnt(54)
v_perm_b32 v65, v41, v40, s46
v_accvgpr_write_b32 a25, v65
v_perm_b32 v69, v41, v40, s47
s_mov_b32 s20, 119808
buffer_load_dword v40, v4, s[12:15], s20 offen
s_mov_b32 s21, 120960
buffer_load_dword v41, v4, s[12:15], s21 offen
s_waitcnt vmcnt(54)
v_perm_b32 v66, v43, v42, s46
v_accvgpr_write_b32 a26, v66
v_perm_b32 v70, v43, v42, s47
s_mov_b32 s20, 112896
buffer_load_dword v42, v4, s[12:15], s20 offen
s_mov_b32 s21, 114048
buffer_load_dword v43, v4, s[12:15], s21 offen
s_waitcnt vmcnt(54)
v_perm_b32 v67, v45, v44, s46
v_accvgpr_write_b32 a27, v67
v_perm_b32 v71, v45, v44, s47
ds_write_b128 v3, v[68:71] offset:16384
s_waitcnt lgkmcnt(0)
s_mov_b32 s20, 122112
buffer_load_dword v44, v4, s[12:15], s20 offen
s_mov_b32 s21, 123264
buffer_load_dword v45, v4, s[12:15], s21 offen
s_waitcnt vmcnt(54)
v_perm_b32 v64, v47, v46, s46
v_accvgpr_write_b32 a28, v64
v_perm_b32 v68, v47, v46, s47
s_barrier
s_mov_b32 s20, 256
buffer_load_dword v46, v4, s[12:15], s20 offen
s_mov_b32 s21, 1408
buffer_load_dword v47, v4, s[12:15], s21 offen
s_waitcnt vmcnt(54)
v_perm_b32 v65, v49, v48, s46
v_accvgpr_write_b32 a29, v65
v_perm_b32 v69, v49, v48, s47
s_mov_b32 s20, 9472
buffer_load_dword v48, v4, s[12:15], s20 offen
s_mov_b32 s21, 10624
buffer_load_dword v49, v4, s[12:15], s21 offen
s_waitcnt vmcnt(54)
v_perm_b32 v66, v51, v50, s46
v_accvgpr_write_b32 a30, v66
v_perm_b32 v70, v51, v50, s47
s_mov_b32 s20, 2560
buffer_load_dword v50, v4, s[12:15], s20 offen
s_mov_b32 s21, 3712
buffer_load_dword v51, v4, s[12:15], s21 offen
s_waitcnt vmcnt(54)
v_perm_b32 v67, v53, v52, s46
v_accvgpr_write_b32 a31, v67
v_perm_b32 v71, v53, v52, s47
ds_write_b128 v3, v[68:71] offset:17408
s_waitcnt lgkmcnt(0)
s_mov_b32 s20, 11776
buffer_load_dword v52, v4, s[12:15], s20 offen
s_mov_b32 s21, 12928
buffer_load_dword v53, v4, s[12:15], s21 offen
s_waitcnt vmcnt(54)
v_perm_b32 v64, v55, v54, s46
v_accvgpr_write_b32 a160, v64
v_perm_b32 v68, v55, v54, s47
v_accvgpr_write_b32 a168, v68
s_barrier
s_mov_b32 s20, 37120
buffer_load_dword v54, v4, s[12:15], s20 offen
s_mov_b32 s21, 38272
buffer_load_dword v55, v4, s[12:15], s21 offen
s_waitcnt vmcnt(54)
v_perm_b32 v65, v57, v56, s46
v_accvgpr_write_b32 a161, v65
v_perm_b32 v69, v57, v56, s47
v_accvgpr_write_b32 a169, v69
s_mov_b32 s20, 46336
buffer_load_dword v56, v4, s[12:15], s20 offen
s_mov_b32 s21, 47488
buffer_load_dword v57, v4, s[12:15], s21 offen
s_waitcnt vmcnt(54)
v_perm_b32 v66, v59, v58, s46
v_accvgpr_write_b32 a162, v66
v_perm_b32 v70, v59, v58, s47
v_accvgpr_write_b32 a170, v70
s_mov_b32 s20, 39424
buffer_load_dword v58, v4, s[12:15], s20 offen
s_mov_b32 s21, 40576
buffer_load_dword v59, v4, s[12:15], s21 offen
s_waitcnt vmcnt(54)
v_perm_b32 v67, v61, v60, s46
v_accvgpr_write_b32 a163, v67
v_perm_b32 v71, v61, v60, s47
v_accvgpr_write_b32 a171, v71
s_mov_b32 s20, 48640
buffer_load_dword v60, v4, s[12:15], s20 offen
s_mov_b32 s21, 49792
buffer_load_dword v61, v4, s[12:15], s21 offen
s_waitcnt vmcnt(54)
v_perm_b32 v64, v7, v6, s46
v_accvgpr_write_b32 a164, v64
v_perm_b32 v68, v7, v6, s47
v_accvgpr_write_b32 a172, v68
s_barrier
s_mov_b32 s20, 73984
buffer_load_dword v6, v4, s[12:15], s20 offen
s_mov_b32 s21, 75136
buffer_load_dword v7, v4, s[12:15], s21 offen
s_waitcnt vmcnt(54)
v_perm_b32 v65, v9, v8, s46
v_accvgpr_write_b32 a165, v65
v_perm_b32 v69, v9, v8, s47
v_accvgpr_write_b32 a173, v69
s_mov_b32 s20, 83200
buffer_load_dword v8, v4, s[12:15], s20 offen
s_mov_b32 s21, 84352
buffer_load_dword v9, v4, s[12:15], s21 offen
s_waitcnt vmcnt(54)
v_perm_b32 v66, v11, v10, s46
v_accvgpr_write_b32 a166, v66
v_perm_b32 v70, v11, v10, s47
v_accvgpr_write_b32 a174, v70
s_mov_b32 s20, 76288
buffer_load_dword v10, v4, s[12:15], s20 offen
s_mov_b32 s21, 77440
buffer_load_dword v11, v4, s[12:15], s21 offen
s_waitcnt vmcnt(54)
v_perm_b32 v67, v13, v12, s46
v_accvgpr_write_b32 a167, v67
v_perm_b32 v71, v13, v12, s47
v_accvgpr_write_b32 a175, v71
s_mov_b32 s20, 85504
buffer_load_dword v12, v4, s[12:15], s20 offen
s_mov_b32 s21, 86656
buffer_load_dword v13, v4, s[12:15], s21 offen
s_waitcnt vmcnt(54)
v_perm_b32 v64, v15, v14, s46
v_accvgpr_write_b32 a176, v64
v_perm_b32 v68, v15, v14, s47
v_accvgpr_write_b32 a184, v68
s_barrier
s_mov_b32 s20, 110848
buffer_load_dword v14, v4, s[12:15], s20 offen
s_mov_b32 s21, 112000
buffer_load_dword v15, v4, s[12:15], s21 offen
s_waitcnt vmcnt(54)
v_perm_b32 v65, v17, v16, s46
v_accvgpr_write_b32 a177, v65
v_perm_b32 v69, v17, v16, s47
v_accvgpr_write_b32 a185, v69
s_mov_b32 s20, 120064
buffer_load_dword v16, v4, s[12:15], s20 offen
s_mov_b32 s21, 121216
buffer_load_dword v17, v4, s[12:15], s21 offen
s_waitcnt vmcnt(54)
v_perm_b32 v66, v19, v18, s46
v_accvgpr_write_b32 a178, v66
v_perm_b32 v70, v19, v18, s47
v_accvgpr_write_b32 a186, v70
s_mov_b32 s20, 113152
buffer_load_dword v18, v4, s[12:15], s20 offen
s_mov_b32 s21, 114304
buffer_load_dword v19, v4, s[12:15], s21 offen
s_waitcnt vmcnt(54)
v_perm_b32 v67, v21, v20, s46
v_accvgpr_write_b32 a179, v67
v_perm_b32 v71, v21, v20, s47
v_accvgpr_write_b32 a187, v71
s_mov_b32 s20, 122368
buffer_load_dword v20, v4, s[12:15], s20 offen
s_mov_b32 s21, 123520
buffer_load_dword v21, v4, s[12:15], s21 offen
s_waitcnt vmcnt(54)
v_perm_b32 v64, v23, v22, s46
v_accvgpr_write_b32 a180, v64
v_perm_b32 v68, v23, v22, s47
v_accvgpr_write_b32 a188, v68
s_barrier
s_mov_b32 s20, 512
buffer_load_dword v22, v4, s[12:15], s20 offen
s_mov_b32 s21, 1664
buffer_load_dword v23, v4, s[12:15], s21 offen
s_waitcnt vmcnt(54)
v_perm_b32 v65, v25, v24, s46
v_accvgpr_write_b32 a181, v65
v_perm_b32 v69, v25, v24, s47
v_accvgpr_write_b32 a189, v69
s_mov_b32 s20, 9728
buffer_load_dword v24, v4, s[12:15], s20 offen
s_mov_b32 s21, 10880
buffer_load_dword v25, v4, s[12:15], s21 offen
s_waitcnt vmcnt(54)
v_perm_b32 v66, v27, v26, s46
v_accvgpr_write_b32 a182, v66
v_perm_b32 v70, v27, v26, s47
v_accvgpr_write_b32 a190, v70
s_mov_b32 s20, 2816
buffer_load_dword v26, v4, s[12:15], s20 offen
s_mov_b32 s21, 3968
buffer_load_dword v27, v4, s[12:15], s21 offen
s_waitcnt vmcnt(54)
v_perm_b32 v67, v29, v28, s46
v_accvgpr_write_b32 a183, v67
v_perm_b32 v71, v29, v28, s47
v_accvgpr_write_b32 a191, v71
s_mov_b32 s20, 12032
buffer_load_dword v28, v4, s[12:15], s20 offen
s_mov_b32 s21, 13184
buffer_load_dword v29, v4, s[12:15], s21 offen
s_waitcnt vmcnt(54)
v_perm_b32 v64, v31, v30, s46
v_perm_b32 v68, v31, v30, s47
s_barrier
s_mov_b32 s20, 37376
buffer_load_dword v30, v4, s[12:15], s20 offen
s_mov_b32 s21, 38528
buffer_load_dword v31, v4, s[12:15], s21 offen
s_waitcnt vmcnt(54)
v_perm_b32 v65, v33, v32, s46
v_perm_b32 v69, v33, v32, s47
s_mov_b32 s20, 46592
buffer_load_dword v32, v4, s[12:15], s20 offen
s_mov_b32 s21, 47744
buffer_load_dword v33, v4, s[12:15], s21 offen
s_waitcnt vmcnt(54)
v_perm_b32 v66, v35, v34, s46
v_perm_b32 v70, v35, v34, s47
s_mov_b32 s20, 39680
buffer_load_dword v34, v4, s[12:15], s20 offen
s_mov_b32 s21, 40832
buffer_load_dword v35, v4, s[12:15], s21 offen
s_waitcnt vmcnt(54)
v_perm_b32 v67, v37, v36, s46
ds_write_b128 v3, v[64:67] offset:20480
s_waitcnt lgkmcnt(0)
v_perm_b32 v71, v37, v36, s47
ds_write_b128 v3, v[68:71] offset:22528
s_waitcnt lgkmcnt(0)
s_mov_b32 s20, 48896
buffer_load_dword v36, v4, s[12:15], s20 offen
s_mov_b32 s21, 50048
buffer_load_dword v37, v4, s[12:15], s21 offen
s_waitcnt vmcnt(54)
v_perm_b32 v64, v39, v38, s46
v_perm_b32 v68, v39, v38, s47
s_barrier
s_mov_b32 s20, 74240
buffer_load_dword v38, v4, s[12:15], s20 offen
s_mov_b32 s21, 75392
buffer_load_dword v39, v4, s[12:15], s21 offen
s_waitcnt vmcnt(54)
v_perm_b32 v65, v41, v40, s46
v_perm_b32 v69, v41, v40, s47
s_mov_b32 s20, 83456
buffer_load_dword v40, v4, s[12:15], s20 offen
s_mov_b32 s21, 84608
buffer_load_dword v41, v4, s[12:15], s21 offen
s_waitcnt vmcnt(54)
v_perm_b32 v66, v43, v42, s46
v_perm_b32 v70, v43, v42, s47
s_mov_b32 s20, 76544
buffer_load_dword v42, v4, s[12:15], s20 offen
s_mov_b32 s21, 77696
buffer_load_dword v43, v4, s[12:15], s21 offen
s_waitcnt vmcnt(54)
v_perm_b32 v67, v45, v44, s46
ds_write_b128 v3, v[64:67] offset:21504
s_waitcnt lgkmcnt(0)
v_perm_b32 v71, v45, v44, s47
ds_write_b128 v3, v[68:71] offset:23552
s_waitcnt lgkmcnt(0)
s_mov_b32 s20, 85760
buffer_load_dword v44, v4, s[12:15], s20 offen
s_mov_b32 s21, 86912
buffer_load_dword v45, v4, s[12:15], s21 offen
s_waitcnt vmcnt(54)
v_perm_b32 v64, v47, v46, s46
v_accvgpr_write_b32 a192, v64
v_perm_b32 v68, v47, v46, s47
v_accvgpr_write_b32 a200, v68
s_barrier
s_mov_b32 s20, 111104
buffer_load_dword v46, v4, s[12:15], s20 offen
s_mov_b32 s21, 112256
buffer_load_dword v47, v4, s[12:15], s21 offen
s_waitcnt vmcnt(54)
v_perm_b32 v65, v49, v48, s46
v_accvgpr_write_b32 a193, v65
v_perm_b32 v69, v49, v48, s47
v_accvgpr_write_b32 a201, v69
s_mov_b32 s20, 120320
buffer_load_dword v48, v4, s[12:15], s20 offen
s_mov_b32 s21, 121472
buffer_load_dword v49, v4, s[12:15], s21 offen
s_waitcnt vmcnt(54)
v_perm_b32 v66, v51, v50, s46
v_accvgpr_write_b32 a194, v66
v_perm_b32 v70, v51, v50, s47
v_accvgpr_write_b32 a202, v70
s_mov_b32 s20, 113408
buffer_load_dword v50, v4, s[12:15], s20 offen
s_mov_b32 s21, 114560
buffer_load_dword v51, v4, s[12:15], s21 offen
s_waitcnt vmcnt(54)
v_perm_b32 v67, v53, v52, s46
v_accvgpr_write_b32 a195, v67
v_perm_b32 v71, v53, v52, s47
v_accvgpr_write_b32 a203, v71
s_mov_b32 s20, 122624
buffer_load_dword v52, v4, s[12:15], s20 offen
s_mov_b32 s21, 123776
buffer_load_dword v53, v4, s[12:15], s21 offen
s_waitcnt vmcnt(54)
v_perm_b32 v64, v55, v54, s46
v_accvgpr_write_b32 a196, v64
v_perm_b32 v68, v55, v54, s47
v_accvgpr_write_b32 a204, v68
s_barrier
s_mov_b32 s20, 768
buffer_load_dword v54, v4, s[12:15], s20 offen
s_mov_b32 s21, 1920
buffer_load_dword v55, v4, s[12:15], s21 offen
s_waitcnt vmcnt(54)
v_perm_b32 v65, v57, v56, s46
v_accvgpr_write_b32 a197, v65
v_perm_b32 v69, v57, v56, s47
v_accvgpr_write_b32 a205, v69
s_mov_b32 s20, 9984
buffer_load_dword v56, v4, s[12:15], s20 offen
s_mov_b32 s21, 11136
buffer_load_dword v57, v4, s[12:15], s21 offen
s_waitcnt vmcnt(54)
v_perm_b32 v66, v59, v58, s46
v_accvgpr_write_b32 a198, v66
v_perm_b32 v70, v59, v58, s47
v_accvgpr_write_b32 a206, v70
s_mov_b32 s20, 3072
buffer_load_dword v58, v4, s[12:15], s20 offen
s_mov_b32 s21, 4224
buffer_load_dword v59, v4, s[12:15], s21 offen
s_waitcnt vmcnt(54)
v_perm_b32 v67, v61, v60, s46
v_accvgpr_write_b32 a199, v67
v_perm_b32 v71, v61, v60, s47
v_accvgpr_write_b32 a207, v71
s_mov_b32 s20, 12288
buffer_load_dword v60, v4, s[12:15], s20 offen
s_mov_b32 s21, 13440
buffer_load_dword v61, v4, s[12:15], s21 offen
s_waitcnt vmcnt(54)
v_perm_b32 v64, v7, v6, s46
v_perm_b32 v68, v7, v6, s47
s_barrier
s_mov_b32 s20, 37632
buffer_load_dword v6, v4, s[12:15], s20 offen
s_mov_b32 s21, 38784
buffer_load_dword v7, v4, s[12:15], s21 offen
s_waitcnt vmcnt(54)
v_perm_b32 v65, v9, v8, s46
v_perm_b32 v69, v9, v8, s47
s_mov_b32 s20, 46848
buffer_load_dword v8, v4, s[12:15], s20 offen
s_mov_b32 s21, 48000
buffer_load_dword v9, v4, s[12:15], s21 offen
s_waitcnt vmcnt(54)
v_perm_b32 v66, v11, v10, s46
v_perm_b32 v70, v11, v10, s47
s_mov_b32 s20, 39936
buffer_load_dword v10, v4, s[12:15], s20 offen
s_mov_b32 s21, 41088
buffer_load_dword v11, v4, s[12:15], s21 offen
s_waitcnt vmcnt(54)
v_perm_b32 v67, v13, v12, s46
ds_write_b128 v3, v[64:67] offset:24576
s_waitcnt lgkmcnt(0)
v_perm_b32 v71, v13, v12, s47
ds_write_b128 v3, v[68:71] offset:26624
s_waitcnt lgkmcnt(0)
s_mov_b32 s20, 49152
buffer_load_dword v12, v4, s[12:15], s20 offen
s_mov_b32 s21, 50304
buffer_load_dword v13, v4, s[12:15], s21 offen
s_waitcnt vmcnt(54)
v_perm_b32 v64, v15, v14, s46
v_perm_b32 v68, v15, v14, s47
s_barrier
s_mov_b32 s20, 74496
buffer_load_dword v14, v4, s[12:15], s20 offen
s_mov_b32 s21, 75648
buffer_load_dword v15, v4, s[12:15], s21 offen
s_waitcnt vmcnt(54)
v_perm_b32 v65, v17, v16, s46
v_perm_b32 v69, v17, v16, s47
s_mov_b32 s20, 83712
buffer_load_dword v16, v4, s[12:15], s20 offen
s_mov_b32 s21, 84864
buffer_load_dword v17, v4, s[12:15], s21 offen
s_waitcnt vmcnt(54)
v_perm_b32 v66, v19, v18, s46
v_perm_b32 v70, v19, v18, s47
s_mov_b32 s20, 76800
buffer_load_dword v18, v4, s[12:15], s20 offen
s_mov_b32 s21, 77952
buffer_load_dword v19, v4, s[12:15], s21 offen
s_waitcnt vmcnt(54)
v_perm_b32 v67, v21, v20, s46
ds_write_b128 v3, v[64:67] offset:25600
s_waitcnt lgkmcnt(0)
v_perm_b32 v71, v21, v20, s47
ds_write_b128 v3, v[68:71] offset:27648
s_waitcnt lgkmcnt(0)
s_mov_b32 s20, 86016
buffer_load_dword v20, v4, s[12:15], s20 offen
s_mov_b32 s21, 87168
buffer_load_dword v21, v4, s[12:15], s21 offen
s_waitcnt vmcnt(54)
v_perm_b32 v64, v23, v22, s46
v_accvgpr_write_b32 a208, v64
v_perm_b32 v68, v23, v22, s47
v_accvgpr_write_b32 a216, v68
s_barrier
s_mov_b32 s20, 111360
buffer_load_dword v22, v4, s[12:15], s20 offen
s_mov_b32 s21, 112512
buffer_load_dword v23, v4, s[12:15], s21 offen
s_waitcnt vmcnt(54)
v_perm_b32 v65, v25, v24, s46
v_accvgpr_write_b32 a209, v65
v_perm_b32 v69, v25, v24, s47
v_accvgpr_write_b32 a217, v69
s_mov_b32 s20, 120576
buffer_load_dword v24, v4, s[12:15], s20 offen
s_mov_b32 s21, 121728
buffer_load_dword v25, v4, s[12:15], s21 offen
s_waitcnt vmcnt(54)
v_perm_b32 v66, v27, v26, s46
v_accvgpr_write_b32 a210, v66
v_perm_b32 v70, v27, v26, s47
v_accvgpr_write_b32 a218, v70
s_mov_b32 s20, 113664
buffer_load_dword v26, v4, s[12:15], s20 offen
s_mov_b32 s21, 114816
buffer_load_dword v27, v4, s[12:15], s21 offen
s_waitcnt vmcnt(54)
v_perm_b32 v67, v29, v28, s46
v_accvgpr_write_b32 a211, v67
v_perm_b32 v71, v29, v28, s47
v_accvgpr_write_b32 a219, v71
s_mov_b32 s20, 122880
buffer_load_dword v28, v4, s[12:15], s20 offen
s_mov_b32 s21, 124032
buffer_load_dword v29, v4, s[12:15], s21 offen
s_waitcnt vmcnt(54)
v_perm_b32 v64, v31, v30, s46
v_accvgpr_write_b32 a212, v64
v_perm_b32 v68, v31, v30, s47
v_accvgpr_write_b32 a220, v68
s_barrier
s_mov_b32 s20, 1024
buffer_load_ushort v30, v2, s[12:15], s20 offen
s_mov_b32 s21, 2176
buffer_load_ushort v31, v2, s[12:15], s21 offen
s_waitcnt vmcnt(54)
v_perm_b32 v65, v33, v32, s46
v_accvgpr_write_b32 a213, v65
v_perm_b32 v69, v33, v32, s47
v_accvgpr_write_b32 a221, v69
s_mov_b32 s20, 10240
buffer_load_ushort v32, v2, s[12:15], s20 offen
s_mov_b32 s21, 11392
buffer_load_ushort v33, v2, s[12:15], s21 offen
s_waitcnt vmcnt(54)
v_perm_b32 v66, v35, v34, s46
v_accvgpr_write_b32 a214, v66
v_perm_b32 v70, v35, v34, s47
v_accvgpr_write_b32 a222, v70
s_mov_b32 s20, 3328
buffer_load_ushort v34, v2, s[12:15], s20 offen
s_mov_b32 s21, 4480
buffer_load_ushort v35, v2, s[12:15], s21 offen
s_waitcnt vmcnt(54)
v_perm_b32 v67, v37, v36, s46
v_accvgpr_write_b32 a215, v67
v_perm_b32 v71, v37, v36, s47
v_accvgpr_write_b32 a223, v71
s_mov_b32 s20, 12544
buffer_load_ushort v36, v2, s[12:15], s20 offen
s_mov_b32 s21, 13696
buffer_load_ushort v37, v2, s[12:15], s21 offen
s_waitcnt vmcnt(54)
v_perm_b32 v64, v39, v38, s46
v_perm_b32 v68, v39, v38, s47
s_barrier
s_mov_b32 s20, 37888
buffer_load_ushort v38, v2, s[12:15], s20 offen
s_mov_b32 s21, 39040
buffer_load_ushort v39, v2, s[12:15], s21 offen
s_waitcnt vmcnt(54)
v_perm_b32 v65, v41, v40, s46
v_perm_b32 v69, v41, v40, s47
s_mov_b32 s20, 47104
buffer_load_ushort v40, v2, s[12:15], s20 offen
s_mov_b32 s21, 48256
buffer_load_ushort v41, v2, s[12:15], s21 offen
s_waitcnt vmcnt(54)
v_perm_b32 v66, v43, v42, s46
v_perm_b32 v70, v43, v42, s47
s_mov_b32 s20, 40192
buffer_load_ushort v42, v2, s[12:15], s20 offen
s_mov_b32 s21, 41344
buffer_load_ushort v43, v2, s[12:15], s21 offen
s_waitcnt vmcnt(54)
v_perm_b32 v67, v45, v44, s46
ds_write_b128 v3, v[64:67] offset:28672
s_waitcnt lgkmcnt(0)
v_perm_b32 v71, v45, v44, s47
ds_write_b128 v3, v[68:71] offset:30720
s_waitcnt lgkmcnt(0)
s_mov_b32 s20, 49408
buffer_load_ushort v44, v2, s[12:15], s20 offen
s_mov_b32 s21, 50560
buffer_load_ushort v45, v2, s[12:15], s21 offen
s_waitcnt vmcnt(54)
v_perm_b32 v64, v47, v46, s46
v_perm_b32 v68, v47, v46, s47
s_barrier
s_mov_b32 s20, 74752
buffer_load_ushort v46, v2, s[12:15], s20 offen
s_mov_b32 s21, 75904
buffer_load_ushort v47, v2, s[12:15], s21 offen
s_waitcnt vmcnt(54)
v_perm_b32 v65, v49, v48, s46
v_perm_b32 v69, v49, v48, s47
s_mov_b32 s20, 83968
buffer_load_ushort v48, v2, s[12:15], s20 offen
s_mov_b32 s21, 85120
buffer_load_ushort v49, v2, s[12:15], s21 offen
s_waitcnt vmcnt(54)
v_perm_b32 v66, v51, v50, s46
v_perm_b32 v70, v51, v50, s47
s_mov_b32 s20, 77056
buffer_load_ushort v50, v2, s[12:15], s20 offen
s_mov_b32 s21, 78208
buffer_load_ushort v51, v2, s[12:15], s21 offen
s_waitcnt vmcnt(54)
v_perm_b32 v67, v53, v52, s46
ds_write_b128 v3, v[64:67] offset:29696
s_waitcnt lgkmcnt(0)
v_perm_b32 v71, v53, v52, s47
ds_write_b128 v3, v[68:71] offset:31744
s_waitcnt lgkmcnt(0)
s_mov_b32 s20, 86272
buffer_load_ushort v52, v2, s[12:15], s20 offen
s_mov_b32 s21, 87424
buffer_load_ushort v53, v2, s[12:15], s21 offen
s_waitcnt vmcnt(54)
v_perm_b32 v64, v55, v54, s46
v_accvgpr_write_b32 a224, v64
v_perm_b32 v68, v55, v54, s47
v_accvgpr_write_b32 a232, v68
s_barrier
s_mov_b32 s20, 111616
buffer_load_ushort v54, v2, s[12:15], s20 offen
s_mov_b32 s21, 112768
buffer_load_ushort v55, v2, s[12:15], s21 offen
s_waitcnt vmcnt(54)
v_perm_b32 v65, v57, v56, s46
v_accvgpr_write_b32 a225, v65
v_perm_b32 v69, v57, v56, s47
v_accvgpr_write_b32 a233, v69
s_mov_b32 s20, 120832
buffer_load_ushort v56, v2, s[12:15], s20 offen
s_mov_b32 s21, 121984
buffer_load_ushort v57, v2, s[12:15], s21 offen
s_waitcnt vmcnt(54)
v_perm_b32 v66, v59, v58, s46
v_accvgpr_write_b32 a226, v66
v_perm_b32 v70, v59, v58, s47
v_accvgpr_write_b32 a234, v70
s_mov_b32 s20, 113920
buffer_load_ushort v58, v2, s[12:15], s20 offen
s_mov_b32 s21, 115072
buffer_load_ushort v59, v2, s[12:15], s21 offen
s_waitcnt vmcnt(54)
v_perm_b32 v67, v61, v60, s46
v_accvgpr_write_b32 a227, v67
v_perm_b32 v71, v61, v60, s47
v_accvgpr_write_b32 a235, v71
s_mov_b32 s20, 123136
buffer_load_ushort v60, v2, s[12:15], s20 offen
s_mov_b32 s21, 124288
buffer_load_ushort v61, v2, s[12:15], s21 offen
s_waitcnt vmcnt(54)
v_perm_b32 v64, v7, v6, s46
v_accvgpr_write_b32 a228, v64
v_perm_b32 v68, v7, v6, s47
v_accvgpr_write_b32 a236, v68
s_barrier
s_mov_b32 s12, s88
s_and_b32 s13, s89, 0xffff
s_mov_b32 s14, 4718592
s_mov_b32 s15, 0x20000
s_mov_b32 s20, 0
buffer_load_dword v6, v1, s[12:15], s20 offen
s_mov_b32 s21, 32768
buffer_load_dword v7, v1, s[12:15], s21 offen
s_waitcnt vmcnt(54)
v_perm_b32 v65, v9, v8, s46
v_accvgpr_write_b32 a229, v65
v_perm_b32 v69, v9, v8, s47
v_accvgpr_write_b32 a237, v69
s_mov_b32 s20, 65536
buffer_load_dword v8, v1, s[12:15], s20 offen
s_mov_b32 s21, 98304
buffer_load_dword v9, v1, s[12:15], s21 offen
s_waitcnt vmcnt(54)
v_perm_b32 v66, v11, v10, s46
v_accvgpr_write_b32 a230, v66
v_perm_b32 v70, v11, v10, s47
v_accvgpr_write_b32 a238, v70
s_mov_b32 s20, 8192
buffer_load_dword v10, v1, s[12:15], s20 offen
s_mov_b32 s21, 40960
buffer_load_dword v11, v1, s[12:15], s21 offen
s_waitcnt vmcnt(54)
v_perm_b32 v67, v13, v12, s46
v_accvgpr_write_b32 a231, v67
v_perm_b32 v71, v13, v12, s47
v_accvgpr_write_b32 a239, v71
s_mov_b32 s20, 73728
buffer_load_dword v12, v1, s[12:15], s20 offen
s_mov_b32 s21, 106496
buffer_load_dword v13, v1, s[12:15], s21 offen
s_waitcnt vmcnt(54)
v_perm_b32 v64, v15, v14, s46
v_perm_b32 v68, v15, v14, s47
v_accvgpr_write_b32 a240, v68
s_barrier
s_mov_b32 s20, 262144
buffer_load_dword v14, v1, s[12:15], s20 offen
s_mov_b32 s21, 294912
buffer_load_dword v15, v1, s[12:15], s21 offen
s_waitcnt vmcnt(54)
v_perm_b32 v65, v17, v16, s46
v_perm_b32 v69, v17, v16, s47
v_accvgpr_write_b32 a241, v69
s_mov_b32 s20, 327680
buffer_load_dword v16, v1, s[12:15], s20 offen
s_mov_b32 s21, 360448
buffer_load_dword v17, v1, s[12:15], s21 offen
s_waitcnt vmcnt(54)
v_perm_b32 v66, v19, v18, s46
v_perm_b32 v70, v19, v18, s47
v_accvgpr_write_b32 a242, v70
s_mov_b32 s20, 270336
buffer_load_dword v18, v1, s[12:15], s20 offen
s_mov_b32 s21, 303104
buffer_load_dword v19, v1, s[12:15], s21 offen
s_waitcnt vmcnt(54)
v_perm_b32 v67, v21, v20, s46
ds_write_b128 v3, v[64:67] offset:32768
s_waitcnt lgkmcnt(0)
v_perm_b32 v71, v21, v20, s47
v_accvgpr_write_b32 a243, v71
s_mov_b32 s20, 335872
buffer_load_dword v20, v1, s[12:15], s20 offen
s_mov_b32 s21, 368640
buffer_load_dword v21, v1, s[12:15], s21 offen
s_waitcnt vmcnt(54)
v_perm_b32 v64, v23, v22, s46
v_perm_b32 v68, v23, v22, s47
v_accvgpr_write_b32 a244, v68
s_barrier
s_mov_b32 s20, 524288
buffer_load_dword v22, v1, s[12:15], s20 offen
s_mov_b32 s21, 557056
buffer_load_dword v23, v1, s[12:15], s21 offen
s_waitcnt vmcnt(54)
v_perm_b32 v65, v25, v24, s46
v_perm_b32 v69, v25, v24, s47
v_accvgpr_write_b32 a245, v69
s_mov_b32 s20, 589824
buffer_load_dword v24, v1, s[12:15], s20 offen
s_mov_b32 s21, 622592
buffer_load_dword v25, v1, s[12:15], s21 offen
s_waitcnt vmcnt(54)
v_perm_b32 v66, v27, v26, s46
v_perm_b32 v70, v27, v26, s47
v_accvgpr_write_b32 a246, v70
s_mov_b32 s20, 532480
buffer_load_dword v26, v1, s[12:15], s20 offen
s_mov_b32 s21, 565248
buffer_load_dword v27, v1, s[12:15], s21 offen
s_waitcnt vmcnt(54)
v_perm_b32 v67, v29, v28, s46
ds_write_b128 v3, v[64:67] offset:33792
s_waitcnt lgkmcnt(0)
v_perm_b32 v71, v29, v28, s47
v_accvgpr_write_b32 a247, v71
s_mov_b32 s20, 598016
buffer_load_dword v28, v1, s[12:15], s20 offen
s_mov_b32 s21, 630784
buffer_load_dword v29, v1, s[12:15], s21 offen
s_waitcnt vmcnt(54)
v_perm_b32 v64, v31, v30, s46
v_accvgpr_write_b32 a248, v64
s_barrier
s_mov_b32 s20, 786432
buffer_load_dword v30, v1, s[12:15], s20 offen
s_mov_b32 s21, 819200
buffer_load_dword v31, v1, s[12:15], s21 offen
s_waitcnt vmcnt(54)
v_perm_b32 v65, v33, v32, s46
v_accvgpr_write_b32 a249, v65
s_mov_b32 s20, 851968
buffer_load_dword v32, v1, s[12:15], s20 offen
s_mov_b32 s21, 884736
buffer_load_dword v33, v1, s[12:15], s21 offen
s_waitcnt vmcnt(54)
v_perm_b32 v66, v35, v34, s46
v_accvgpr_write_b32 a250, v66
s_mov_b32 s20, 794624
buffer_load_dword v34, v1, s[12:15], s20 offen
s_mov_b32 s21, 827392
buffer_load_dword v35, v1, s[12:15], s21 offen
s_waitcnt vmcnt(54)
v_perm_b32 v67, v37, v36, s46
v_accvgpr_write_b32 a251, v67
s_mov_b32 s20, 860160
buffer_load_dword v36, v1, s[12:15], s20 offen
s_mov_b32 s21, 892928
buffer_load_dword v37, v1, s[12:15], s21 offen
s_waitcnt vmcnt(54)
v_perm_b32 v64, v39, v38, s46
v_accvgpr_write_b32 a252, v64
s_barrier
v_and_b32 v5, 1, v0
v_lshlrev_b32 v5, 6, v5
buffer_load_dword v5, v5, s[56:59], 0 offen offset:64 sc1
s_mov_b32 s20, 1048576
buffer_load_dword v38, v1, s[12:15], s20 offen
s_mov_b32 s21, 1081344
buffer_load_dword v39, v1, s[12:15], s21 offen
s_waitcnt vmcnt(55)
v_perm_b32 v65, v41, v40, s46
v_accvgpr_write_b32 a253, v65
s_mov_b32 s20, 1114112
buffer_load_dword v40, v1, s[12:15], s20 offen
s_mov_b32 s21, 1146880
buffer_load_dword v41, v1, s[12:15], s21 offen
s_waitcnt vmcnt(55)
v_perm_b32 v66, v43, v42, s46
v_accvgpr_write_b32 a254, v66
s_mov_b32 s20, 1056768
buffer_load_dword v42, v1, s[12:15], s20 offen
s_mov_b32 s21, 1089536
buffer_load_dword v43, v1, s[12:15], s21 offen
s_waitcnt vmcnt(55)
v_perm_b32 v67, v45, v44, s46
v_accvgpr_write_b32 a255, v67
s_mov_b32 s20, 1122304
buffer_load_dword v44, v1, s[12:15], s20 offen
s_mov_b32 s21, 1155072
buffer_load_dword v45, v1, s[12:15], s21 offen
s_waitcnt vmcnt(55)
v_perm_b32 v64, v47, v46, s46
s_barrier
s_mov_b32 s20, 1310720
buffer_load_dword v46, v1, s[12:15], s20 offen
s_mov_b32 s21, 1343488
buffer_load_dword v47, v1, s[12:15], s21 offen
s_waitcnt vmcnt(55)
v_perm_b32 v65, v49, v48, s46
s_mov_b32 s20, 1376256
buffer_load_dword v48, v1, s[12:15], s20 offen
s_mov_b32 s21, 1409024
buffer_load_dword v49, v1, s[12:15], s21 offen
s_waitcnt vmcnt(55)
v_perm_b32 v66, v51, v50, s46
s_mov_b32 s20, 1318912
buffer_load_dword v50, v1, s[12:15], s20 offen
s_mov_b32 s21, 1351680
buffer_load_dword v51, v1, s[12:15], s21 offen
s_waitcnt vmcnt(55)
v_perm_b32 v67, v53, v52, s46
ds_write_b128 v3, v[64:67] offset:18432
s_waitcnt lgkmcnt(0)
s_mov_b32 s20, 1384448
buffer_load_dword v52, v1, s[12:15], s20 offen
s_mov_b32 s21, 1417216
buffer_load_dword v53, v1, s[12:15], s21 offen
s_waitcnt vmcnt(55)
v_perm_b32 v64, v55, v54, s46
s_barrier
s_mov_b32 s20, 1572864
buffer_load_dword v54, v1, s[12:15], s20 offen
s_mov_b32 s21, 1605632
buffer_load_dword v55, v1, s[12:15], s21 offen
s_waitcnt vmcnt(55)
v_perm_b32 v65, v57, v56, s46
s_mov_b32 s20, 1638400
buffer_load_dword v56, v1, s[12:15], s20 offen
s_mov_b32 s21, 1671168
buffer_load_dword v57, v1, s[12:15], s21 offen
s_waitcnt vmcnt(55)
v_perm_b32 v66, v59, v58, s46
s_mov_b32 s20, 1581056
buffer_load_dword v58, v1, s[12:15], s20 offen
s_mov_b32 s21, 1613824
buffer_load_dword v59, v1, s[12:15], s21 offen
s_waitcnt vmcnt(55)
v_perm_b32 v67, v61, v60, s46
ds_write_b128 v3, v[64:67] offset:19456
s_waitcnt lgkmcnt(0)
s_mov_b32 s20, 1646592
buffer_load_dword v60, v1, s[12:15], s20 offen
s_mov_b32 s21, 1679360
buffer_load_dword v61, v1, s[12:15], s21 offen
s_waitcnt vmcnt(55)
v_perm_b32 v72, v7, v6, s46
v_perm_b32 v80, v7, v6, s47
s_barrier
s_mov_b32 s20, 1835008
buffer_load_dword v6, v1, s[12:15], s20 offen
s_mov_b32 s21, 1867776
buffer_load_dword v7, v1, s[12:15], s21 offen
s_waitcnt vmcnt(55)
v_perm_b32 v73, v9, v8, s46
v_perm_b32 v81, v9, v8, s47
s_mov_b32 s20, 1900544
buffer_load_dword v8, v1, s[12:15], s20 offen
s_mov_b32 s21, 1933312
buffer_load_dword v9, v1, s[12:15], s21 offen
s_waitcnt vmcnt(55)
v_perm_b32 v74, v11, v10, s46
v_perm_b32 v82, v11, v10, s47
s_mov_b32 s20, 1843200
buffer_load_dword v10, v1, s[12:15], s20 offen
s_mov_b32 s21, 1875968
buffer_load_dword v11, v1, s[12:15], s21 offen
s_waitcnt vmcnt(55)
v_perm_b32 v75, v13, v12, s46
v_perm_b32 v83, v13, v12, s47
s_mov_b32 s20, 1908736
buffer_load_dword v12, v1, s[12:15], s20 offen
s_mov_b32 s21, 1941504
buffer_load_dword v13, v1, s[12:15], s21 offen
s_waitcnt vmcnt(55)
v_perm_b32 v76, v15, v14, s46
v_perm_b32 v84, v15, v14, s47
s_barrier
s_mov_b32 s20, 2097152
buffer_load_dword v14, v1, s[12:15], s20 offen
s_mov_b32 s21, 2129920
buffer_load_dword v15, v1, s[12:15], s21 offen
s_waitcnt vmcnt(55)
v_perm_b32 v77, v17, v16, s46
v_perm_b32 v85, v17, v16, s47
s_mov_b32 s20, 2162688
buffer_load_dword v16, v1, s[12:15], s20 offen
s_mov_b32 s21, 2195456
buffer_load_dword v17, v1, s[12:15], s21 offen
s_waitcnt vmcnt(55)
v_perm_b32 v78, v19, v18, s46
v_perm_b32 v86, v19, v18, s47
s_mov_b32 s20, 2105344
buffer_load_dword v18, v1, s[12:15], s20 offen
s_mov_b32 s21, 2138112
buffer_load_dword v19, v1, s[12:15], s21 offen
s_waitcnt vmcnt(55)
v_perm_b32 v79, v21, v20, s46
v_perm_b32 v87, v21, v20, s47
s_mov_b32 s20, 2170880
buffer_load_dword v20, v1, s[12:15], s20 offen
s_mov_b32 s21, 2203648
buffer_load_dword v21, v1, s[12:15], s21 offen
s_waitcnt vmcnt(55)
v_perm_b32 v96, v23, v22, s46
v_perm_b32 v104, v23, v22, s47
s_barrier
s_mov_b32 s20, 2359296
buffer_load_dword v22, v1, s[12:15], s20 offen
s_mov_b32 s21, 2392064
buffer_load_dword v23, v1, s[12:15], s21 offen
s_waitcnt vmcnt(55)
v_perm_b32 v97, v25, v24, s46
v_perm_b32 v105, v25, v24, s47
s_mov_b32 s20, 2424832
buffer_load_dword v24, v1, s[12:15], s20 offen
s_mov_b32 s21, 2457600
buffer_load_dword v25, v1, s[12:15], s21 offen
s_waitcnt vmcnt(55)
v_perm_b32 v98, v27, v26, s46
v_perm_b32 v106, v27, v26, s47
s_mov_b32 s20, 2367488
buffer_load_dword v26, v1, s[12:15], s20 offen
s_mov_b32 s21, 2400256
buffer_load_dword v27, v1, s[12:15], s21 offen
s_waitcnt vmcnt(55)
v_perm_b32 v99, v29, v28, s46
v_perm_b32 v107, v29, v28, s47
s_mov_b32 s20, 2433024
buffer_load_dword v28, v1, s[12:15], s20 offen
s_mov_b32 s21, 2465792
buffer_load_dword v29, v1, s[12:15], s21 offen
s_waitcnt vmcnt(55)
v_perm_b32 v100, v31, v30, s46
v_perm_b32 v108, v31, v30, s47
s_barrier
s_mov_b32 s20, 2621440
buffer_load_dword v30, v1, s[12:15], s20 offen
s_mov_b32 s21, 2654208
buffer_load_dword v31, v1, s[12:15], s21 offen
s_waitcnt vmcnt(55)
v_perm_b32 v101, v33, v32, s46
v_perm_b32 v109, v33, v32, s47
s_mov_b32 s20, 2686976
buffer_load_dword v32, v1, s[12:15], s20 offen
s_mov_b32 s21, 2719744
buffer_load_dword v33, v1, s[12:15], s21 offen
s_waitcnt vmcnt(55)
v_perm_b32 v102, v35, v34, s46
v_perm_b32 v110, v35, v34, s47
s_mov_b32 s20, 2629632
buffer_load_dword v34, v1, s[12:15], s20 offen
s_mov_b32 s21, 2662400
buffer_load_dword v35, v1, s[12:15], s21 offen
s_waitcnt vmcnt(55)
v_perm_b32 v103, v37, v36, s46
v_perm_b32 v111, v37, v36, s47
s_mov_b32 s20, 2695168
buffer_load_dword v36, v1, s[12:15], s20 offen
s_mov_b32 s21, 2727936
buffer_load_dword v37, v1, s[12:15], s21 offen
s_waitcnt vmcnt(54)
v_perm_b32 v120, v39, v38, s46
v_perm_b32 v128, v39, v38, s47
s_barrier
s_mov_b32 s20, 2883584
buffer_load_dword v38, v1, s[12:15], s20 offen
s_mov_b32 s21, 2916352
buffer_load_dword v39, v1, s[12:15], s21 offen
s_waitcnt vmcnt(54)
v_perm_b32 v121, v41, v40, s46
v_perm_b32 v129, v41, v40, s47
s_mov_b32 s20, 2949120
buffer_load_dword v40, v1, s[12:15], s20 offen
s_mov_b32 s21, 2981888
buffer_load_dword v41, v1, s[12:15], s21 offen
s_waitcnt vmcnt(54)
v_perm_b32 v122, v43, v42, s46
v_perm_b32 v130, v43, v42, s47
s_mov_b32 s20, 2891776
buffer_load_dword v42, v1, s[12:15], s20 offen
s_mov_b32 s21, 2924544
buffer_load_dword v43, v1, s[12:15], s21 offen
s_waitcnt vmcnt(54)
v_perm_b32 v123, v45, v44, s46
v_perm_b32 v131, v45, v44, s47
s_mov_b32 s20, 2957312
buffer_load_dword v44, v1, s[12:15], s20 offen
s_mov_b32 s21, 2990080
buffer_load_dword v45, v1, s[12:15], s21 offen
s_waitcnt vmcnt(54)
v_perm_b32 v124, v47, v46, s46
v_perm_b32 v132, v47, v46, s47
s_barrier
s_mov_b32 s20, 3145728
buffer_load_dword v46, v1, s[12:15], s20 offen
s_mov_b32 s21, 3178496
buffer_load_dword v47, v1, s[12:15], s21 offen
s_waitcnt vmcnt(54)
v_perm_b32 v125, v49, v48, s46
v_perm_b32 v133, v49, v48, s47
s_mov_b32 s20, 3211264
buffer_load_dword v48, v1, s[12:15], s20 offen
s_mov_b32 s21, 3244032
buffer_load_dword v49, v1, s[12:15], s21 offen
s_waitcnt vmcnt(54)
v_perm_b32 v126, v51, v50, s46
v_perm_b32 v134, v51, v50, s47
s_mov_b32 s20, 3153920
buffer_load_dword v50, v1, s[12:15], s20 offen
s_mov_b32 s21, 3186688
buffer_load_dword v51, v1, s[12:15], s21 offen
s_waitcnt vmcnt(54)
v_perm_b32 v127, v53, v52, s46
v_perm_b32 v135, v53, v52, s47
s_mov_b32 s20, 3219456
buffer_load_dword v52, v1, s[12:15], s20 offen
s_mov_b32 s21, 3252224
buffer_load_dword v53, v1, s[12:15], s21 offen
s_waitcnt vmcnt(54)
v_perm_b32 v144, v55, v54, s46
v_perm_b32 v152, v55, v54, s47
s_barrier
s_mov_b32 s20, 3407872
buffer_load_dword v54, v1, s[12:15], s20 offen
s_mov_b32 s21, 3440640
buffer_load_dword v55, v1, s[12:15], s21 offen
s_waitcnt vmcnt(54)
v_perm_b32 v145, v57, v56, s46
v_perm_b32 v153, v57, v56, s47
s_mov_b32 s20, 3473408
buffer_load_dword v56, v1, s[12:15], s20 offen
s_mov_b32 s21, 3506176
buffer_load_dword v57, v1, s[12:15], s21 offen
s_waitcnt vmcnt(54)
v_perm_b32 v146, v59, v58, s46
v_perm_b32 v154, v59, v58, s47
s_mov_b32 s20, 3416064
buffer_load_dword v58, v1, s[12:15], s20 offen
s_mov_b32 s21, 3448832
buffer_load_dword v59, v1, s[12:15], s21 offen
s_waitcnt vmcnt(54)
v_perm_b32 v147, v61, v60, s46
v_perm_b32 v155, v61, v60, s47
s_mov_b32 s20, 3481600
buffer_load_dword v60, v1, s[12:15], s20 offen
s_mov_b32 s21, 3514368
buffer_load_dword v61, v1, s[12:15], s21 offen
s_waitcnt vmcnt(54)
v_perm_b32 v148, v7, v6, s46
v_perm_b32 v156, v7, v6, s47
s_barrier
s_mov_b32 s20, 3670016
buffer_load_dword v6, v1, s[12:15], s20 offen
s_mov_b32 s21, 3702784
buffer_load_dword v7, v1, s[12:15], s21 offen
s_waitcnt vmcnt(54)
v_perm_b32 v149, v9, v8, s46
v_perm_b32 v157, v9, v8, s47
s_mov_b32 s20, 3735552
buffer_load_dword v8, v1, s[12:15], s20 offen
s_mov_b32 s21, 3768320
buffer_load_dword v9, v1, s[12:15], s21 offen
s_waitcnt vmcnt(54)
v_perm_b32 v150, v11, v10, s46
v_perm_b32 v158, v11, v10, s47
s_mov_b32 s20, 3678208
buffer_load_dword v10, v1, s[12:15], s20 offen
s_mov_b32 s21, 3710976
buffer_load_dword v11, v1, s[12:15], s21 offen
s_waitcnt vmcnt(54)
v_perm_b32 v151, v13, v12, s46
v_perm_b32 v159, v13, v12, s47
s_mov_b32 s20, 3743744
buffer_load_dword v12, v1, s[12:15], s20 offen
s_mov_b32 s21, 3776512
buffer_load_dword v13, v1, s[12:15], s21 offen
s_waitcnt vmcnt(54)
v_perm_b32 v168, v15, v14, s46
v_perm_b32 v176, v15, v14, s47
s_barrier
s_mov_b32 s20, 3932160
buffer_load_dword v14, v1, s[12:15], s20 offen
s_mov_b32 s21, 3964928
buffer_load_dword v15, v1, s[12:15], s21 offen
s_waitcnt vmcnt(54)
v_perm_b32 v169, v17, v16, s46
v_perm_b32 v177, v17, v16, s47
s_mov_b32 s20, 3997696
buffer_load_dword v16, v1, s[12:15], s20 offen
s_mov_b32 s21, 4030464
buffer_load_dword v17, v1, s[12:15], s21 offen
s_waitcnt vmcnt(54)
v_perm_b32 v170, v19, v18, s46
v_perm_b32 v178, v19, v18, s47
s_mov_b32 s20, 3940352
buffer_load_dword v18, v1, s[12:15], s20 offen
s_mov_b32 s21, 3973120
buffer_load_dword v19, v1, s[12:15], s21 offen
s_waitcnt vmcnt(54)
v_perm_b32 v171, v21, v20, s46
v_perm_b32 v179, v21, v20, s47
s_mov_b32 s20, 4005888
buffer_load_dword v20, v1, s[12:15], s20 offen
s_mov_b32 s21, 4038656
buffer_load_dword v21, v1, s[12:15], s21 offen
s_waitcnt vmcnt(54)
v_perm_b32 v172, v23, v22, s46
v_perm_b32 v180, v23, v22, s47
s_barrier
s_mov_b32 s20, 4194304
buffer_load_dword v22, v1, s[12:15], s20 offen
s_mov_b32 s21, 4227072
buffer_load_dword v23, v1, s[12:15], s21 offen
s_waitcnt vmcnt(54)
v_perm_b32 v173, v25, v24, s46
v_perm_b32 v181, v25, v24, s47
s_mov_b32 s20, 4259840
buffer_load_dword v24, v1, s[12:15], s20 offen
s_mov_b32 s21, 4292608
buffer_load_dword v25, v1, s[12:15], s21 offen
s_waitcnt vmcnt(54)
v_perm_b32 v174, v27, v26, s46
v_perm_b32 v182, v27, v26, s47
s_mov_b32 s20, 4202496
buffer_load_dword v26, v1, s[12:15], s20 offen
s_mov_b32 s21, 4235264
buffer_load_dword v27, v1, s[12:15], s21 offen
s_waitcnt vmcnt(54)
v_perm_b32 v175, v29, v28, s46
v_perm_b32 v183, v29, v28, s47
s_mov_b32 s20, 4268032
buffer_load_dword v28, v1, s[12:15], s20 offen
s_mov_b32 s21, 4300800
buffer_load_dword v29, v1, s[12:15], s21 offen
s_waitcnt vmcnt(54)
v_perm_b32 v192, v31, v30, s46
v_perm_b32 v200, v31, v30, s47
s_barrier
s_mov_b32 s20, 4456448
buffer_load_dword v30, v1, s[12:15], s20 offen
s_mov_b32 s21, 4489216
buffer_load_dword v31, v1, s[12:15], s21 offen
s_waitcnt vmcnt(54)
v_perm_b32 v193, v33, v32, s46
v_perm_b32 v201, v33, v32, s47
s_mov_b32 s20, 4521984
buffer_load_dword v32, v1, s[12:15], s20 offen
s_mov_b32 s21, 4554752
buffer_load_dword v33, v1, s[12:15], s21 offen
s_waitcnt vmcnt(54)
v_perm_b32 v194, v35, v34, s46
v_perm_b32 v202, v35, v34, s47
s_mov_b32 s20, 4464640
buffer_load_dword v34, v1, s[12:15], s20 offen
s_mov_b32 s21, 4497408
buffer_load_dword v35, v1, s[12:15], s21 offen
s_waitcnt vmcnt(54)
v_perm_b32 v195, v37, v36, s46
v_perm_b32 v203, v37, v36, s47
s_mov_b32 s20, 4530176
buffer_load_dword v36, v1, s[12:15], s20 offen
s_mov_b32 s21, 4562944
buffer_load_dword v37, v1, s[12:15], s21 offen
s_waitcnt vmcnt(54)
v_perm_b32 v196, v39, v38, s46
v_perm_b32 v204, v39, v38, s47
s_waitcnt vmcnt(52)
v_perm_b32 v197, v41, v40, s46
v_perm_b32 v205, v41, v40, s47
s_waitcnt vmcnt(50)
v_perm_b32 v198, v43, v42, s46
v_perm_b32 v206, v43, v42, s47
s_waitcnt vmcnt(48)
v_perm_b32 v199, v45, v44, s46
v_perm_b32 v207, v45, v44, s47
s_waitcnt vmcnt(46)
v_perm_b32 v216, v47, v46, s46
v_perm_b32 v224, v47, v46, s47
s_waitcnt vmcnt(44)
v_perm_b32 v217, v49, v48, s46
v_perm_b32 v225, v49, v48, s47
s_waitcnt vmcnt(42)
v_perm_b32 v218, v51, v50, s46
v_perm_b32 v226, v51, v50, s47
s_waitcnt vmcnt(40)
v_perm_b32 v219, v53, v52, s46
v_perm_b32 v227, v53, v52, s47
s_waitcnt vmcnt(38)
v_perm_b32 v220, v55, v54, s46
v_perm_b32 v228, v55, v54, s47
s_waitcnt vmcnt(36)
v_perm_b32 v221, v57, v56, s46
v_perm_b32 v229, v57, v56, s47
s_waitcnt vmcnt(34)
v_perm_b32 v222, v59, v58, s46
v_perm_b32 v230, v59, v58, s47
s_waitcnt vmcnt(32)
v_perm_b32 v223, v61, v60, s46
v_perm_b32 v231, v61, v60, s47
s_waitcnt vmcnt(30)
v_perm_b32 v240, v7, v6, s46
v_perm_b32 v248, v7, v6, s47
s_waitcnt vmcnt(28)
v_perm_b32 v241, v9, v8, s46
v_perm_b32 v249, v9, v8, s47
s_waitcnt vmcnt(26)
v_perm_b32 v242, v11, v10, s46
v_perm_b32 v250, v11, v10, s47
s_waitcnt vmcnt(24)
v_perm_b32 v243, v13, v12, s46
v_perm_b32 v251, v13, v12, s47
s_waitcnt vmcnt(22)
v_perm_b32 v244, v15, v14, s46
v_perm_b32 v252, v15, v14, s47
s_waitcnt vmcnt(20)
v_perm_b32 v245, v17, v16, s46
v_perm_b32 v253, v17, v16, s47
s_waitcnt vmcnt(18)
v_perm_b32 v246, v19, v18, s46
v_perm_b32 v254, v19, v18, s47
s_waitcnt vmcnt(16)
v_perm_b32 v247, v21, v20, s46
v_perm_b32 v255, v21, v20, s47
s_waitcnt vmcnt(14)
v_perm_b32 v64, v23, v22, s46
v_accvgpr_write_b32 a8, v64
v_perm_b32 v68, v23, v22, s47
v_accvgpr_write_b32 a16, v68
s_waitcnt vmcnt(12)
v_perm_b32 v65, v25, v24, s46
v_accvgpr_write_b32 a9, v65
v_perm_b32 v69, v25, v24, s47
v_accvgpr_write_b32 a17, v69
s_waitcnt vmcnt(10)
v_perm_b32 v66, v27, v26, s46
v_accvgpr_write_b32 a10, v66
v_perm_b32 v70, v27, v26, s47
v_accvgpr_write_b32 a18, v70
s_waitcnt vmcnt(8)
v_perm_b32 v67, v29, v28, s46
v_accvgpr_write_b32 a11, v67
v_perm_b32 v71, v29, v28, s47
v_accvgpr_write_b32 a19, v71
s_waitcnt vmcnt(6)
v_perm_b32 v64, v31, v30, s46
v_accvgpr_write_b32 a12, v64
v_perm_b32 v68, v31, v30, s47
v_accvgpr_write_b32 a20, v68
s_waitcnt vmcnt(4)
v_perm_b32 v65, v33, v32, s46
v_accvgpr_write_b32 a13, v65
v_perm_b32 v69, v33, v32, s47
v_accvgpr_write_b32 a21, v69
s_waitcnt vmcnt(2)
v_perm_b32 v66, v35, v34, s46
v_accvgpr_write_b32 a14, v66
v_perm_b32 v70, v35, v34, s47
v_accvgpr_write_b32 a22, v70
s_waitcnt vmcnt(0)
v_perm_b32 v67, v37, v36, s46
v_accvgpr_write_b32 a15, v67
v_perm_b32 v71, v37, v36, s47
v_accvgpr_write_b32 a23, v71
v_and_b32 v6, 1, v0
v_lshlrev_b32 v7, 6, v6
v_mul_u32_u24 v6, 24, v6
v_sub_u32 v6, 32, v6
v_cmp_ne_u32 vcc, v5, v6
s_cbranch_vccz L_tok
v_add_u32 v7, 64, v7
s_mov_b32 s28, 0
L_poll_49:
buffer_load_dword v5, v7, s[56:59], 0 offen sc1
s_add_u32 s28, s28, 1
s_cmp_gt_u32 s28, 40000
s_cbranch_scc1 L_end
s_waitcnt vmcnt(0)
v_cmp_ne_u32 vcc, v5, v6
s_cbranch_vccz L_pd_50
s_sleep 1
s_branch L_poll_49
L_pd_50:
L_tok:
v_mov_b32 v12, v0
v_and_b32 v13, 15, v0
v_bfe_u32 v14, v0, 4, 2
v_lshlrev_b32 v1, 4, v12
v_and_b32 v2, 0x3f0, v1
s_mul_i32 s20, s17, 34816
s_add_u32 s20, s20, 24576
v_add_u32 v2, s20, v2
v_and_b32 v15, 1, v12
v_mul_u32_u24 v0, 0xaaaa, v15
v_add_u32 v0, 0xffff4444, v0
v_lshrrev_b32 v18, 2, v13
v_lshl_add_u32 v18, v18, 1, v15
v_bfe_u32 v19, v13, 1, 1
v_lshrrev_b32 v16, 5, v12
v_lshlrev_b32 v16, 8, v16
v_lshl_add_u32 v16, v18, 5, v16
v_and_b32 v17, 1, v14
v_lshl_add_u32 v16, v17, 4, v16
v_and_b32 v17, 0x7f, v16
v_xor_b32 v17, 16, v17
v_add_u32 v16, 4224, v16
v_add_u32 v17, 6272, v17
v_cmp_eq_u32 vcc, 1, v19
s_nop 1
v_cndmask_b32 v7, v17, v16, vcc
v_and_b32 v16, 1, v14
v_xor_b32 v16, v18, v16
v_and_b32 v17, 2, v14
v_lshlrev_b32 v17, 1, v17
v_xor_b32 v16, v16, v17
v_lshlrev_b32 v16, 4, v16
v_lshl_add_u32 v16, v14, 7, v16
v_mul_u32_u24 v17, 2176, v19
v_add_u32 v16, v16, v17
v_add_u32 v5, 0, v16
v_bfe_u32 v20, v13, 3, 1
v_bfe_u32 v21, v13, 1, 1
v_lshlrev_b32 v16, 1, v14
v_xor_b32 v16, v16, v21
v_lshlrev_b32 v17, 2, v20
v_xor_b32 v16, v16, v17
v_lshlrev_b32 v16, 4, v16
v_lshl_add_u32 v16, v20, 8, v16
v_lshl_add_u32 v16, v21, 7, v16
v_bfe_u32 v17, v13, 2, 1
v_lshl_add_u32 v16, v17, 3, v16
v_lshl_add_u32 v16, v15, 2, v16
s_lshl_b32 s20, s17, 9
s_add_u32 s20, s20, 0
v_add_u32 v4, s20, v16
v_xor_b32 v3, 16, v4
v_lshrrev_b32 v16, 4, v12
v_xor_b32 v17, s16, v16
v_lshlrev_b32 v16, 12, v16
v_lshl_add_u32 v16, v17, 7, v16
v_lshl_add_u32 v9, v13, 3, v16
s_lshr_b32 s20, s17, 1
s_lshl_b32 s20, s20, 2
v_add_u32 v16, s20, v14
v_xor_b32 v17, s16, v16
v_lshlrev_b32 v16, 12, v16
v_lshl_add_u32 v16, v17, 7, v16
v_lshl_add_u32 v16, v13, 2, v16
s_and_b32 s20, s17, 1
s_lshl_b32 s20, s20, 6
s_add_u32 s20, s20, 262144
v_add_u32 v10, s20, v16
v_bfe_u32 v16, v13, 2, 1
v_lshlrev_b32 v16, 5, v16
v_and_b32 v17, 1, v14
v_lshl_add_u32 v16, v17, 8, v16
v_lshrrev_b32 v17, 1, v14
v_lshl_add_u32 v16, v17, 4, v16
v_and_b32 v17, 3, v13
v_lshl_add_u32 v11, v17, 2, v16
v_lshlrev_b32 v6, 7, v12
v_lshlrev_b32 v8, 2, v12
s_mov_b32 s36, 0x11111111
s_mov_b32 s37, 0x11111111
s_mov_b32 s38, 0x22222222
s_mov_b32 s39, 0x22222222
s_mov_b32 s40, 0x44444444
s_mov_b32 s41, 0x44444444
s_mov_b32 s42, 0x88888888
s_mov_b32 s43, 0x88888888
s_mov_b32 s44, 0xf0f0f0f0
s_mov_b32 s45, 0xf0f0f0f0
s_mov_b32 s18, 0x3e0293ee
s_lshl_b32 s20, s17, 5
s_add_u32 s20, s20, s16
s_cmp_lt_u32 s20, 72
s_cselect_b32 s48, 1, 0
s_lshl_b32 s23, s20, 12
s_lshl_b32 s21, s17, 10
s_sub_u32 s23, s23, s21
s_lshr_b32 s24, s20, 2
s_lshl_b32 s24, s24, 9
s_and_b32 s21, s20, 3
s_lshl_b32 s21, s21, 6
s_add_u32 s24, s24, s21
s_add_u32 s24, s24, 110100480
s_cmp_lt_u32 s20, 72
s_cselect_b32 s24, s24, 536870912
s_lshl_b32 s25, s16, 12
s_add_u32 s26, s25, 131072
s_add_u32 s27, s25, 262144
s_cmp_lt_u32 s16, 8
s_cselect_b32 s27, s27, 536870912
s_mov_b32 s28, 109051904
s_mov_b32 s29, 109346816
s_lshl_b32 s30, s16, 20
s_add_u32 s30, s30, 33554432
s_lshl_b32 s31, s16, 12
s_add_u32 s31, s31, 100663296
s_add_u32 s35, s24, 32768
s_mov_b32 s53, 0x3f803f80
s_mov_b32 s86, 0x33333333
s_mov_b32 s87, 0x33333333
s_lshl_b32 s84, s17, 13
s_sub_u32 s84, s20, s84
s_add_u32 s84, s84, 110886912
s_cmp_lt_u32 s20, 72
s_cselect_b32 s84, s84, 536870912
s_and_b32 s21, s16, 3
s_lshl_b32 s21, s21, 7
s_add_u32 s21, s21, 110886144
s_cmp_eq_u32 s17, 3
s_cselect_b32 s84, s21, s84
s_lshl_b32 s82, s16, 7
s_add_u32 s83, s82, 111152384
s_add_u32 s82, s82, 111148288
s_mov_b32 s19, 0
s_getpc_b64 s[4:5]
L_pc2:
s_mov_b32 s12, s4
s_and_b32 s13, s5, 0xffff
s_mov_b32 s14, L_end-L_pc2
s_mov_b32 s15, 0x20000
buffer_load_dword v40, v6, s[12:15], 0 offen
s_mul_i32 s20, s16, 18432
s_add_u32 s20, s20, 109051904
s_lshl_b32 s21, s16, 11
s_add_u32 s21, s21, 110075904
s_cmp_eq_u32 s17, 3
s_cselect_b32 s20, s21, s20
buffer_load_dword v41, v6, s[8:11], s20 offen sc1
s_mov_b32 s12, s96
s_and_b32 s13, s97, 0xffff
s_mov_b32 s14, 9216
s_mov_b32 s15, 0x20000
v_bfe_u32 v64, v1, 5, 3
v_mul_u32_u24 v64, 1152, v64
v_lshrrev_b32 v65, 8, v1
v_lshl_add_u32 v64, v65, 5, v64
v_and_b32 v65, 16, v1
v_add_u32 v64, v64, v65
buffer_load_dwordx4 v[24:27], v64, s[12:15], 0 offen
buffer_load_dwordx4 v[28:31], v64, s[12:15], 0 offen offset:512
buffer_load_dwordx4 v[32:35], v64, s[12:15], 0 offen offset:1024
v_mov_b32 v66, 0
s_lshl_b32 s21, s16, 7
s_add_u32 s21, s21, 111149088
s_mov_b32 s22, 0
L_poll_51:
buffer_load_dword v67, v66, s[8:11], s21 offen sc1
s_add_u32 s22, s22, 1
s_cmp_gt_u32 s22, 40000
s_cbranch_scc1 L_end
s_waitcnt vmcnt(0)
v_cmp_ne_u32 vcc, 1, v67
s_cbranch_vccz L_pd_52
s_branch L_poll_51
L_pd_52:
s_cmp_lt_u32 s17, 2
s_cselect_b32 s21, s30, 536870912
buffer_load_dword v67, v6, s[8:11], s21 offen sc1
s_waitcnt vmcnt(0)
v_perm_b32 v12, v26, v24, s46
v_perm_b32 v13, v26, v24, s47
v_perm_b32 v14, v27, v25, s46
v_perm_b32 v15, v27, v25, s47
v_min_u32 v12, 0xfffeffff, v12
v_min_u32 v13, 0xfffeffff, v13
v_min_u32 v14, 0xfffeffff, v14
v_min_u32 v15, 0xfffeffff, v15
v_perm_b32 v16, v30, v28, s46
v_perm_b32 v17, v30, v28, s47
v_perm_b32 v18, v31, v29, s46
v_perm_b32 v19, v31, v29, s47
v_min_u32 v16, 0xfffeffff, v16
v_min_u32 v17, 0xfffeffff, v17
v_min_u32 v18, 0xfffeffff, v18
v_min_u32 v19, 0xfffeffff, v19
v_perm_b32 v20, v34, v32, s46
v_perm_b32 v21, v34, v32, s47
v_perm_b32 v22, v35, v33, s46
v_perm_b32 v23, v35, v33, s47
v_min_u32 v20, 0xfffeffff, v20
v_min_u32 v21, 0xfffeffff, v21
v_min_u32 v22, 0xfffeffff, v22
v_min_u32 v23, 0xfffeffff, v23
s_cmp_lg_u32 s17, 0
s_cbranch_scc1 L_m0_53
ds_write_b128 v1, v[20:23] offset:14848
v_mov_b32 v64, 6528
v_mov_b32 v56, 0
v_mov_b32 v57, 0
v_mov_b32 v58, 0
v_mov_b32 v59, 0
ds_write_b128 v64, v[56:59]
L_m0_53:
s_waitcnt lgkmcnt(0)
s_barrier
ds_read_b32 v20, v8 offset:14848
s_waitcnt lgkmcnt(0)
s_mov_b32 s33, 110100480
s_mov_b32 s6, 110100480
s_mov_b32 s7, 110100480
s_mov_b32 s22, 0
s_cmp_eq_u32 s17, 0
s_cbranch_scc1 L_ent0
s_cmp_eq_u32 s17, 1
s_cbranch_scc1 L_ent1
s_cmp_eq_u32 s17, 2
s_cbranch_scc1 L_ent2
s_cmp_eq_u32 s17, 3
s_cbranch_scc1 L_ent3
s_branch L_end
L_ent0:
s_movk_i32 s4, -64
v_mov_b64 v[24:25], 0
v_mov_b64 v[26:27], 0
v_mov_b64 v[28:29], 0
v_mov_b64 v[30:31], 0
v_and_b32 v69, 0x380, v1
v_add_u32 v69, v69, v1
v_and_b32 v70, 0xf40, v1
v_add_u32 v70, v70, v1
v_bfe_u32 v71, v1, 7, 1
v_mad_i32_i24 v70, v71, s4, v70
v_mov_b64 v[64:65], -1
v_mov_b64 v[66:67], -1
v_xor_b32 v3, 16, v4
ds_read_b128 v[48:51], v2 offset:8192
ds_read_b128 v[52:55], v2 offset:9216
ds_read_b128 v[40:43], v2
ds_read_b128 v[44:47], v2 offset:1024
v_mov_b64 v[32:33], 0
v_mov_b64 v[34:35], 0
v_mov_b64 v[36:37], 0
v_mov_b64 v[38:39], 0
v_mov_b64 v[56:57], 0
v_mov_b64 v[58:59], 0
v_mov_b64 v[60:61], 0
v_mov_b64 v[62:63], 0
s_add_u32 s20, s30, 0
s_add_u32 s21, s30, 8192
s_add_u32 s49, s29, s25
s_add_u32 s50, s29, s26
s_add_u32 s51, s29, s27
s_add_u32 s52, s30, 16384
s_mov_b32 m0, 15872
s_nop 0
buffer_load_dwordx4 v69, s[8:11], s20 offen sc1 lds
s_mov_b32 m0, 16768
s_nop 0
buffer_load_dwordx4 v69, s[8:11], s20 offen offset:128 sc1 lds
s_waitcnt vmcnt(0) lgkmcnt(0)
s_branch L_step0
L_gr0:
buffer_load_dwordx4 v[12:15], v1, s[8:11], s33 offen sc1
buffer_load_dword v20, v8, s[8:11], s7 offen sc1
buffer_load_dwordx4 v[16:19], v1, s[8:11], s6 offen sc1
s_add_u32 s22, s22, 1
s_cmp_gt_u32 s22, 40000
s_cbranch_scc1 L_end
buffer_load_dwordx4 v[16:19], v1, s[8:11], s6 offen sc1
v_mov_b64 v[24:25], 0
v_mov_b64 v[26:27], 0
v_mov_b64 v[28:29], 0
v_mov_b64 v[30:31], 0
v_mov_b64 v[32:33], 0
v_mov_b64 v[34:35], 0
v_mov_b64 v[36:37], 0
v_mov_b64 v[38:39], 0
v_mov_b64 v[56:57], 0
v_mov_b64 v[58:59], 0
v_mov_b64 v[60:61], 0
v_mov_b64 v[62:63], 0
s_waitcnt lgkmcnt(0)
s_branch L_step0
.p2align 3
L_gat0:
buffer_load_dwordx4 v[12:15], v1, s[8:11], s33 offen sc1
buffer_load_dword v20, v8, s[8:11], s7 offen sc1
buffer_load_dwordx4 v[16:19], v1, s[8:11], s6 offen sc1
s_add_u32 s20, s30, 0
s_add_u32 s21, s30, 8192
s_add_u32 s49, s29, s25
s_add_u32 s50, s29, s26
s_add_u32 s51, s29, s27
s_add_u32 s52, s30, 16384
s_mov_b32 m0, 15872
s_waitcnt vmcnt(4)
ds_read_b128 v[40:43], v2
ds_read_b128 v[44:47], v2 offset:1024
v_mov_b64 v[32:33], 0
v_mov_b64 v[34:35], 0
v_mov_b64 v[36:37], 0
v_mov_b64 v[38:39], 0
v_mov_b64 v[56:57], 0
v_mov_b64 v[58:59], 0
v_mov_b64 v[60:61], 0
v_mov_b64 v[62:63], 0
s_nop 6
buffer_load_dwordx4 v[16:19], v1, s[8:11], s6 offen sc1
s_waitcnt lgkmcnt(0)
L_step0:
s_waitcnt vmcnt(3)
v_smfmac_f32_16x16x64_bf16 v[24:27], v[12:15], v[72:79], v0
ds_write_b128 v1, v[12:15] offset:6656
v_smfmac_f32_16x16x64_bf16 v[28:31], v[12:15], v[80:87], v0
s_waitcnt vmcnt(2)
v_max3_u32 v21, v12, v13, v14
v_max3_u32 v21, v21, v15, v20
v_cmp_le_u32 vcc, 0xffff0000, v21
v_smfmac_f32_16x16x64_bf16 v[32:35], v[12:15], v[88:95], v0
s_cbranch_vccnz L_gr0
s_waitcnt vmcnt(1)
v_max3_u32 v21, v16, v17, v18
v_max_u32 v21, v21, v19
v_cmp_le_u32 vcc, 0xffff0000, v21
ds_write_b32 v8, v20 offset:14848
v_smfmac_f32_16x16x64_bf16 v[56:59], v[12:15], a[32:39], v0
s_cbranch_vccnz L_g3r0
L_g30:
ds_write_b128 v1, v[16:19] offset:10752
v_smfmac_f32_16x16x64_bf16 v[60:63], v[12:15], a[40:47], v0
v_smfmac_f32_16x16x64_bf16 v[36:39], v[12:15], v[40:47], v0
v_smfmac_f32_16x16x64_bf16 v[24:27], v[16:19], v[168:175], v0
v_smfmac_f32_16x16x64_bf16 v[28:31], v[16:19], v[176:183], v0
s_waitcnt lgkmcnt(0)
s_barrier
ds_read_b128 v[20:23], v1 offset:7680
v_smfmac_f32_16x16x64_bf16 v[32:35], v[16:19], v[184:191], v0
ds_read_b128 v[12:15], v1 offset:8704
s_mov_b32 m0, 6272
buffer_store_dword v0, v11, s[8:11], s35 offen
v_smfmac_f32_16x16x64_bf16 v[56:59], v[16:19], a[96:103], v0
ds_read_b128 v[40:43], v2 offset:2048
buffer_store_dwordx4 v[64:67], v1, s[8:11], s49 offen
v_smfmac_f32_16x16x64_bf16 v[60:63], v[16:19], a[104:111], v0
ds_read_b128 v[44:47], v2 offset:3072
v_smfmac_f32_16x16x64_bf16 v[36:39], v[16:19], v[48:55], v0
s_waitcnt vmcnt(2)
ds_read_b128 v[16:19], v1 offset:9728
buffer_store_dwordx4 v[64:67], v1, s[8:11], s50 offen
s_waitcnt lgkmcnt(4)
v_smfmac_f32_16x16x64_bf16 v[24:27], v[20:23], v[96:103], v0
ds_read_b128 v[48:51], v2 offset:4096
v_smfmac_f32_16x16x64_bf16 v[28:31], v[20:23], v[104:111], v0
ds_read_b128 v[52:55], v2 offset:5120
buffer_store_dwordx4 v[64:67], v1, s[8:11], s51 offen
v_smfmac_f32_16x16x64_bf16 v[32:35], v[20:23], v[112:119], v0
s_waitcnt lgkmcnt(3)
v_smfmac_f32_16x16x64_bf16 v[36:39], v[20:23], v[40:47], v0
ds_read_b128 v[20:23], v1 offset:11776
buffer_load_dwordx4 v[64:67], v70, s[8:11], s21 offen sc1
v_smfmac_f32_16x16x64_bf16 v[24:27], v[12:15], v[120:127], v0
ds_read_b128 v[40:43], v2 offset:6144
v_smfmac_f32_16x16x64_bf16 v[28:31], v[12:15], v[128:135], v0
ds_read_b128 v[44:47], v2 offset:7168
buffer_load_dwordx4 v[68:71], v70, s[8:11], s21 offen offset:256 sc1
v_smfmac_f32_16x16x64_bf16 v[32:35], v[12:15], v[136:143], v0
s_waitcnt lgkmcnt(3)
v_smfmac_f32_16x16x64_bf16 v[36:39], v[12:15], v[48:55], v0
ds_read_b128 v[12:15], v1 offset:12800
v_smfmac_f32_16x16x64_bf16 v[24:27], v[16:19], v[144:151], v0
ds_read_b128 v[48:51], v2 offset:10240
v_smfmac_f32_16x16x64_bf16 v[28:31], v[16:19], v[152:159], v0
ds_read_b128 v[52:55], v2 offset:11264
v_smfmac_f32_16x16x64_bf16 v[32:35], v[16:19], v[160:167], v0
s_waitcnt lgkmcnt(3)
buffer_load_dword v6, s[8:11], s52 offen sc1 lds
v_smfmac_f32_16x16x64_bf16 v[36:39], v[16:19], v[40:47], v0
ds_read_b128 v[16:19], v1 offset:13824
v_smfmac_f32_16x16x64_bf16 v[24:27], v[20:23], v[192:199], v0
ds_read_b128 v[40:43], v2 offset:12288
v_smfmac_f32_16x16x64_bf16 v[28:31], v[20:23], v[200:207], v0
ds_read_b128 v[44:47], v2 offset:13312
v_smfmac_f32_16x16x64_bf16 v[32:35], v[20:23], v[208:215], v0
s_waitcnt lgkmcnt(3)
v_smfmac_f32_16x16x64_bf16 v[36:39], v[20:23], v[48:55], v0
ds_read_b128 v[20:23], v1 offset:14848
v_smfmac_f32_16x16x64_bf16 v[24:27], v[12:15], v[216:223], v0
ds_read_b128 v[48:51], v2 offset:14336
v_smfmac_f32_16x16x64_bf16 v[28:31], v[12:15], v[224:231], v0
ds_read_b128 v[52:55], v2 offset:15360
v_smfmac_f32_16x16x64_bf16 v[32:35], v[12:15], v[232:239], v0
s_waitcnt lgkmcnt(3)
v_smfmac_f32_16x16x64_bf16 v[36:39], v[12:15], v[40:47], v0
ds_read_b128 v[12:15], v1 offset:7680
v_smfmac_f32_16x16x64_bf16 v[24:27], v[16:19], v[240:247], v0
ds_read_b128 v[40:43], v2 offset:16384
v_smfmac_f32_16x16x64_bf16 v[28:31], v[16:19], v[248:255], v0
s_waitcnt lgkmcnt(4)
ds_read_b128 v[44:47], v2 offset:17408
v_smfmac_f32_16x16x64_bf16 v[24:27], v[20:23], a[8:15], v0
v_smfmac_f32_16x16x64_bf16 v[28:31], v[20:23], a[16:23], v0
v_smfmac_f32_16x16x64_bf16 v[32:35], v[16:19], a[0:7], v0
s_waitcnt lgkmcnt(3)
v_smfmac_f32_16x16x64_bf16 v[36:39], v[16:19], v[48:55], v0
ds_read_b128 v[16:19], v1 offset:8704
s_nop 2
v_add_f32 v24, v24, v25
v_smfmac_f32_16x16x64_bf16 v[32:35], v[20:23], a[24:31], v0
s_waitcnt lgkmcnt(1)
ds_read_b128 v[48:51], v1 offset:19968
v_add_f32 v26, v26, v27
v_smfmac_f32_16x16x64_bf16 v[36:39], v[20:23], v[40:47], v0
ds_read_b128 v[52:55], v1 offset:22016
v_add_f32 v28, v28, v29
v_smfmac_f32_16x16x64_bf16 v[56:59], v[12:15], a[48:55], v0
ds_read_b128 v[20:23], v1 offset:9728
v_add_f32 v30, v30, v31
v_cvt_pk_bf16_f32 v24, v24, v28
ds_write_b32 v4, v24 offset:2176
v_smfmac_f32_16x16x64_bf16 v[60:63], v[12:15], a[56:63], v0
s_waitcnt lgkmcnt(4)
ds_read_b128 v[12:15], v1 offset:11776
v_cvt_pk_bf16_f32 v26, v26, v30
ds_write_b32 v3, v26 offset:2176
v_add_f32 v32, v32, v33
v_smfmac_f32_16x16x64_bf16 v[56:59], v[16:19], a[64:71], v0
ds_read_b128 v[40:43], v1 offset:15872
v_add_f32 v34, v34, v35
v_add_f32 v36, v36, v37
v_add_f32 v38, v38, v39
v_smfmac_f32_16x16x64_bf16 v[60:63], v[16:19], a[72:79], v0
s_waitcnt lgkmcnt(4)
ds_read_b128 v[16:19], v1 offset:12800
v_cvt_pk_bf16_f32 v32, v32, v36
ds_write_b32 v4, v32
v_cvt_pk_bf16_f32 v34, v34, v38
v_smfmac_f32_16x16x64_bf16 v[56:59], v[20:23], a[80:87], v0
ds_read_b128 v[44:47], v1 offset:17920
ds_write_b32 v3, v34
v_smfmac_f32_16x16x64_bf16 v[60:63], v[20:23], a[88:95], v0
s_waitcnt lgkmcnt(6)
ds_read_b128 v[20:23], v1 offset:13824
v_smfmac_f32_16x16x64_bf16 v[56:59], v[12:15], a[112:119], v0
v_smfmac_f32_16x16x64_bf16 v[60:63], v[12:15], a[120:127], v0
s_waitcnt lgkmcnt(4)
ds_read_b128 v[12:15], v1 offset:14848
v_smfmac_f32_16x16x64_bf16 v[56:59], v[16:19], a[128:135], v0
v_smfmac_f32_16x16x64_bf16 v[60:63], v[16:19], a[136:143], v0
s_waitcnt lgkmcnt(1)
v_smfmac_f32_16x16x64_bf16 v[56:59], v[20:23], a[144:151], v0
s_barrier
ds_read_b128 v[24:27], v5
v_smfmac_f32_16x16x64_bf16 v[60:63], v[20:23], a[152:159], v0
s_waitcnt lgkmcnt(1)
ds_read_b128 v[28:31], v5 offset:512
v_smfmac_f32_16x16x64_bf16 v[56:59], v[12:15], a[160:167], v0
ds_read_b128 v[32:35], v5 offset:1024
v_smfmac_f32_16x16x64_bf16 v[60:63], v[12:15], a[168:175], v0
s_waitcnt lgkmcnt(2)
ds_read_b128 v[36:39], v5 offset:1536
v_mfma_f32_16x16x32_bf16 v[16:19], v[40:43], v[24:27], 0
ds_read_b128 v[40:43], v1 offset:16896
s_mov_b64 exec, s[86:87]
buffer_store_dwordx4 v[24:27], v5, s[8:11], s31 offen sc1
s_mov_b64 exec, -1
s_waitcnt lgkmcnt(3)
v_mfma_f32_16x16x32_bf16 v[16:19], v[44:47], v[28:31], v[16:19]
s_waitcnt lgkmcnt(2)
ds_read_b128 v[44:47], v1 offset:18944
v_mfma_f32_16x16x32_bf16 v[16:19], v[48:51], v[32:35], v[16:19]
s_waitcnt lgkmcnt(2)
ds_read_b128 v[48:51], v1 offset:20992
v_mfma_f32_16x16x32_bf16 v[16:19], v[52:55], v[36:39], v[16:19]
ds_read_b128 v[52:55], v1 offset:23040
v_mfma_f32_16x16x32_bf16 v[20:23], v[24:27], v[24:27], 0
v_add_f32 v56, v56, v57
v_add_f32 v58, v58, v59
v_mfma_f32_16x16x32_bf16 v[20:23], v[28:31], v[28:31], v[20:23]
v_add_f32 v60, v60, v61
v_add_f32 v62, v62, v63
v_mfma_f32_16x16x32_bf16 v[20:23], v[32:35], v[32:35], v[20:23]
v_cvt_pk_bf16_f32 v56, v56, v58
v_cvt_pk_bf16_f32 v57, v60, v62
v_mfma_f32_16x16x32_bf16 v[20:23], v[36:39], v[36:39], v[20:23]
s_waitcnt lgkmcnt(3)
v_lshrrev_b32 v58, 1, v1
v_max3_f32 v59, v16, v17, v18
v_mfma_f32_16x16x32_bf16 v[12:15], v[40:43], v[24:27], 0
s_waitcnt lgkmcnt(2)
ds_read_b128 v[40:43], v2 offset:18432
buffer_store_dwordx2 v[56:57], v58, s[8:11], s31 offen offset:2048 sc1
v_mfma_f32_16x16x32_bf16 v[12:15], v[44:47], v[28:31], v[12:15]
s_waitcnt lgkmcnt(2)
ds_read_b128 v[44:47], v2 offset:19456
v_mfma_f32_16x16x32_bf16 v[12:15], v[48:51], v[32:35], v[12:15]
s_waitcnt lgkmcnt(2)
ds_read_b128 v[48:51], v2 offset:20480
v_max3_f32 v59, v59, v19, v20
v_max_f32 v59, v59, v21
v_mfma_f32_16x16x32_bf16 v[12:15], v[52:55], v[36:39], v[12:15]
ds_read_b128 v[52:55], v2 offset:21504
v_mov_b32 v60, s53
s_add_u32 s49, s28, s23
v_mov_b32 v61, s53
s_add_u32 s50, s28, 65536
v_mov_b32 v62, s53
ds_read_b128 v[32:35], v2 offset:22528
v_mov_b32 v63, s53
v_max3_f32 v59, v59, v12, v13
v_max3_f32 v22, v59, v14, v15
v_max3_f32 v59, v59, v14, v15
s_add_u32 s51, s28, 131072
s_add_u32 s52, s28, 196608
v_permlane32_swap_b32 v22, v59
v_max_f32 v23, v59, v22
v_max_f32 v59, v59, v22
v_mov_b32 v22, 0
ds_read_b128 v[36:39], v2 offset:23552
v_permlane16_swap_b32 v23, v59
v_max_f32 v59, v59, v23
v_mul_f32 v58, s18, v59
v_pk_fma_f32 v[20:21], v[20:21], s[18:19], v[58:59] op_sel_hi:[1,0,0] neg_lo:[0,0,1] neg_hi:[0,0,1]
v_pk_fma_f32 v[16:17], v[16:17], s[18:19], v[58:59] op_sel_hi:[1,0,0] neg_lo:[0,0,1] neg_hi:[0,0,1]
v_pk_fma_f32 v[18:19], v[18:19], s[18:19], v[58:59] op_sel_hi:[1,0,0] neg_lo:[0,0,1] neg_hi:[0,0,1]
v_pk_fma_f32 v[12:13], v[12:13], s[18:19], v[58:59] op_sel_hi:[1,0,0] neg_lo:[0,0,1] neg_hi:[0,0,1]
v_pk_fma_f32 v[14:15], v[14:15], s[18:19], v[58:59] op_sel_hi:[1,0,0] neg_lo:[0,0,1] neg_hi:[0,0,1]
v_exp_f32 v20, v20
v_exp_f32 v21, v21
v_exp_f32 v16, v16
v_cvt_pk_bf16_f32 v23, v20, v21
v_cvt_pk_bf16_f32 v20, v20, v21
v_mov_b32 v21, 0
v_exp_f32 v17, v17
v_exp_f32 v18, v18
v_mfma_f32_16x16x16_bf16 v[24:27], v[56:57], v[20:21], 0
v_exp_f32 v19, v19
v_mfma_f32_16x16x16_bf16 v[28:31], v[56:57], v[22:23], 0
v_exp_f32 v12, v12
v_exp_f32 v13, v13
v_cvt_pk_bf16_f32 v16, v16, v17
v_cvt_pk_bf16_f32 v17, v18, v19
v_exp_f32 v14, v14
v_exp_f32 v15, v15
v_cvt_pk_bf16_f32 v18, v12, v13
v_cvt_pk_bf16_f32 v19, v14, v15
v_mfma_f32_16x16x16_bf16 v[12:15], v[60:61], v[20:21], 0
s_waitcnt vmcnt(3)
v_mfma_f32_16x16x32_bf16 v[12:15], v[60:63], v[16:19], v[12:15]
v_mov_b32 v20, 0
v_mov_b32 v23, 0
v_mfma_f32_16x16x32_bf16 v[24:27], v[64:67], v[16:19], v[24:27]
s_nop 1
v_mfma_f32_16x16x32_bf16 v[28:31], v[68:71], v[16:19], v[28:31]
v_mov_b32 v16, 0
v_mov_b32 v17, 0
v_rcp_f32 v12, v12
v_mov_b32 v18, 0
v_mov_b32 v19, 0
v_pk_mul_f32 v[24:25], v[24:25], v[12:13] op_sel_hi:[1,0]
v_pk_mul_f32 v[26:27], v[26:27], v[12:13] op_sel_hi:[1,0]
v_mov_b32 v15, 0
v_pk_mul_f32 v[28:29], v[28:29], v[12:13] op_sel_hi:[1,0]
v_pk_mul_f32 v[30:31], v[30:31], v[12:13] op_sel_hi:[1,0]
v_cvt_pk_bf16_f32 v24, v24, v28
v_cvt_pk_bf16_f32 v25, v25, v29
v_cvt_pk_bf16_f32 v26, v26, v30
v_cvt_pk_bf16_f32 v27, v27, v31
v_mfma_f32_16x16x32_bf16 v[56:59], v[20:23], v[20:23], 0
ds_write_b128 v7, v[24:27]
v_mfma_f32_16x16x32_bf16 v[60:63], v[20:23], v[20:23], 0
v_mov_b32 v12, 0
v_mov_b32 v13, 0
v_mov_b32 v14, 0
v_mov_b32 v3, 6528
v_and_b32 v8, 0x380, v1
v_add_u32 v8, v8, v1
v_mfma_f32_16x16x32_bf16 v[64:67], v[20:23], v[20:23], 0
s_add_u32 s20, s30, 16384
s_mov_b32 m0, 15872
s_cmp_eq_u32 s19, 63
s_cbranch_scc1 L_texit
s_waitcnt lgkmcnt(0)
s_barrier
ds_read_b128 v[24:27], v1 offset:4224
v_mfma_f32_16x16x32_bf16 v[68:71], v[20:23], v[20:23], 0
ds_read_b128 v[28:31], v1 offset:5248
s_nop 2
v_mfma_f32_16x16x32_bf16 v[68:71], v[20:23], v[20:23], 0
s_waitcnt lgkmcnt(1)
v_smfmac_f32_16x16x64_bf16 v[12:15], v[24:27], a[248:255], v0
buffer_load_dwordx4 v8, s[8:11], s20 offen sc1 lds
v_smfmac_f32_16x16x64_bf16 v[16:19], v[24:27], a[176:183], v0
s_mov_b32 m0, 16768
s_waitcnt lgkmcnt(0)
v_smfmac_f32_16x16x64_bf16 v[12:15], v[28:31], v[40:47], v0
ds_read_b128 v[40:43], v2 offset:24576
v_smfmac_f32_16x16x64_bf16 v[16:19], v[28:31], v[48:55], v0
ds_read_b128 v[44:47], v2 offset:25600
buffer_load_dwordx4 v8, s[8:11], s20 offen offset:128 sc1 lds
v_smfmac_f32_16x16x64_bf16 v[20:23], v[24:27], a[184:191], v0
ds_read_b128 v[48:51], v2 offset:26624
s_nop 1
v_add_f32 v12, v12, v13
v_add_f32 v14, v14, v15
v_cvt_pk_bf16_f32 v12, v12, v14
v_smfmac_f32_16x16x64_bf16 v[20:23], v[28:31], v[32:39], v0
ds_read_b128 v[52:55], v2 offset:27648
buffer_store_dword v12, v10, s[8:11], s28 offen
v_add_f32 v16, v16, v17
v_add_f32 v18, v18, v19
v_smfmac_f32_16x16x64_bf16 v[56:59], v[24:27], a[192:199], v0
s_waitcnt lgkmcnt(2)
ds_read_b128 v[32:35], v2 offset:28672
v_cvt_pk_bf16_f32 v16, v16, v18
v_smfmac_f32_16x16x64_bf16 v[56:59], v[28:31], v[40:47], v0
ds_read_b128 v[36:39], v2 offset:29696
v_add_f32 v20, v20, v21
v_add_f32 v22, v22, v23
v_cvt_pk_bf16_f32 v17, v20, v22
v_smfmac_f32_16x16x64_bf16 v[60:63], v[24:27], a[200:207], v0
s_waitcnt lgkmcnt(2)
ds_read_b128 v[12:15], v3
buffer_store_dwordx2 v[16:17], v9, s[8:11], s28 offen
v_smfmac_f32_16x16x64_bf16 v[60:63], v[28:31], v[48:55], v0
ds_read_b128 v[40:43], v2 offset:30720
v_add_f32 v56, v56, v57
v_add_f32 v58, v58, v59
v_cvt_pk_bf16_f32 v56, v56, v58
v_smfmac_f32_16x16x64_bf16 v[64:67], v[24:27], a[208:215], v0
s_waitcnt lgkmcnt(2)
ds_read_b128 v[44:47], v2 offset:31744
v_smfmac_f32_16x16x64_bf16 v[64:67], v[28:31], v[32:39], v0
ds_read_b128 v[20:23], v3
v_add_f32 v60, v60, v61
v_add_f32 v62, v62, v63
v_cvt_pk_bf16_f32 v57, v60, v62
v_smfmac_f32_16x16x64_bf16 v[68:71], v[24:27], a[216:223], v0
s_waitcnt lgkmcnt(1)
ds_read_b128 v[48:51], v2 offset:32768
buffer_store_dwordx2 v[56:57], v9, s[8:11], s50 offen
v_smfmac_f32_16x16x64_bf16 v[68:71], v[28:31], v[40:47], v0
ds_read_b128 v[52:55], v2 offset:33792
v_add_f32 v64, v64, v65
v_add_f32 v66, v66, v67
v_cvt_pk_bf16_f32 v64, v64, v66
v_smfmac_f32_16x16x64_bf16 v[12:15], v[24:27], a[224:231], v0
s_waitcnt lgkmcnt(0)
v_smfmac_f32_16x16x64_bf16 v[12:15], v[28:31], v[48:55], v0
s_nop 0
v_add_f32 v68, v68, v69
v_add_f32 v70, v70, v71
v_cvt_pk_bf16_f32 v65, v68, v70
v_smfmac_f32_16x16x64_bf16 v[20:23], v[24:27], a[232:239], v0
buffer_store_dwordx2 v[64:65], v9, s[8:11], s51 offen
v_smfmac_f32_16x16x64_bf16 v[20:23], v[28:31], a[240:247], v0
s_nop 0
v_add_f32 v12, v12, v13
v_add_f32 v14, v14, v15
v_cvt_pk_bf16_f32 v12, v12, v14
s_nop 3
v_add_f32 v20, v20, v21
v_add_f32 v22, v22, v23
v_cvt_pk_bf16_f32 v13, v20, v22
buffer_store_dwordx2 v[12:13], v9, s[8:11], s52 offen
s_waitcnt vmcnt(2)
L_lt0:
buffer_load_dwordx4 v[32:35], v1, s[8:11], s49 offen sc1
buffer_load_dwordx4 v[36:39], v1, s[8:11], s49 offen offset:1024 sc1
buffer_load_dwordx4 v[40:43], v1, s[8:11], s49 offen offset:2048 sc1
buffer_load_dwordx4 v[44:47], v1, s[8:11], s49 offen offset:3072 sc1
s_add_u32 s19, s19, 1
s_mov_b32 s20, s28
s_mov_b32 s28, s29
s_mov_b32 s29, s20
s_and_b32 s20, s19, 3
s_lshl_b32 s20, s20, 14
s_add_u32 s33, s20, 110100480
s_add_u32 s34, s20, s24
s_xor_b32 s20, s20, 32768
s_add_u32 s35, s20, s24
s_add_u32 s30, s30, 16384
s_add_u32 s31, s31, 131072
s_add_u32 s6, s33, 4096
s_add_u32 s7, s33, 8192
s_mov_b32 s22, 0
v_mov_b64 v[24:25], 0
v_mov_b64 v[26:27], 0
v_mov_b64 v[28:29], 0
v_mov_b64 v[30:31], 0
v_and_b32 v70, 0xf40, v1
v_add_u32 v70, v70, v1
v_bfe_u32 v71, v1, 7, 1
v_mad_i32_i24 v70, v71, s4, v70
v_mov_b64 v[64:65], -1
v_mov_b64 v[66:67], -1
v_xor_b32 v3, 16, v4
ds_read_b128 v[48:51], v2 offset:8192
ds_read_b128 v[52:55], v2 offset:9216
v_lshrrev_b32 v8, 2, v1
v_mov_b32 v56, 0x3f80
buffer_load_dwordx4 v[32:35], v1, s[8:11], s49 offen sc1
buffer_load_dwordx4 v[36:39], v1, s[8:11], s49 offen offset:1024 sc1
buffer_load_dwordx4 v[40:43], v1, s[8:11], s49 offen offset:2048 sc1
buffer_load_dwordx4 v[44:47], v1, s[8:11], s49 offen offset:3072 sc1
v_cndmask_b32 v56, v56, 1.0, s[44:45]
v_cndmask_b32 v60, 0, v56, s[36:37]
v_cndmask_b32 v61, 0, v56, s[38:39]
v_cndmask_b32 v62, 0, v56, s[40:41]
v_cndmask_b32 v63, 0, v56, s[42:43]
s_waitcnt vmcnt(7)
v_max3_u32 v16, v32, v33, v34
v_max_u32 v16, v16, v35
v_mfma_f32_16x16x32_bf16 v[56:59], v[32:35], v[60:63], 0
s_waitcnt vmcnt(6)
v_max3_u32 v16, v16, v36, v37
v_max3_u32 v16, v16, v38, v39
v_mfma_f32_16x16x32_bf16 v[56:59], v[36:39], v[60:63], v[56:59]
s_waitcnt vmcnt(5)
v_max3_u32 v16, v16, v40, v41
v_max3_u32 v16, v16, v42, v43
v_mfma_f32_16x16x32_bf16 v[56:59], v[40:43], v[60:63], v[56:59]
s_waitcnt vmcnt(4)
v_max3_u32 v16, v16, v44, v45
v_max3_u32 v16, v16, v46, v47
v_mfma_f32_16x16x32_bf16 v[56:59], v[44:47], v[60:63], v[56:59]
v_cmp_le_u32 vcc, 0xffff0000, v16
s_cbranch_vccnz L_red0
L_redb0:
s_nop 5
v_permlane32_swap_b32 v56, v58
v_permlane32_swap_b32 v57, v59
v_pk_add_f32 v[56:57], v[56:57], v[58:59]
v_cvt_pk_bf16_f32 v56, v56, v57
buffer_store_dword v56, v11, s[8:11], s34 offen
s_add_u32 s20, s30, 0
s_add_u32 s21, s30, 8192
s_add_u32 s49, s29, s25
s_add_u32 s50, s29, s26
s_add_u32 s51, s29, s27
s_add_u32 s52, s30, 16384
s_mov_b32 m0, 15872
s_nop 1
s_barrier
s_branch L_gat0
L_red0:
s_waitcnt vmcnt(3)
v_mfma_f32_16x16x32_bf16 v[56:59], v[32:35], v[60:63], 0
v_max3_u32 v16, v32, v33, v34
v_max_u32 v16, v16, v35
s_waitcnt vmcnt(2)
v_mfma_f32_16x16x32_bf16 v[56:59], v[36:39], v[60:63], v[56:59]
v_max3_u32 v16, v16, v36, v37
v_max3_u32 v16, v16, v38, v39
s_waitcnt vmcnt(1)
v_mfma_f32_16x16x32_bf16 v[56:59], v[40:43], v[60:63], v[56:59]
v_max3_u32 v16, v16, v40, v41
v_max3_u32 v16, v16, v42, v43
s_waitcnt vmcnt(0)
v_mfma_f32_16x16x32_bf16 v[56:59], v[44:47], v[60:63], v[56:59]
v_max3_u32 v16, v16, v44, v45
v_max3_u32 v16, v16, v46, v47
v_cmp_le_u32 vcc, 0xffff0000, v16
s_cbranch_vccz L_redb0
L_red0b:
buffer_load_dwordx4 v[32:35], v1, s[8:11], s49 offen sc1
buffer_load_dwordx4 v[36:39], v1, s[8:11], s49 offen offset:1024 sc1
buffer_load_dwordx4 v[40:43], v1, s[8:11], s49 offen offset:2048 sc1
buffer_load_dwordx4 v[44:47], v1, s[8:11], s49 offen offset:3072 sc1
s_add_u32 s22, s22, 1
s_cmp_gt_u32 s22, 40000
s_cbranch_scc1 L_end
s_waitcnt vmcnt(3)
v_mfma_f32_16x16x32_bf16 v[56:59], v[32:35], v[60:63], 0
v_max3_u32 v16, v32, v33, v34
v_max_u32 v16, v16, v35
s_waitcnt vmcnt(2)
v_mfma_f32_16x16x32_bf16 v[56:59], v[36:39], v[60:63], v[56:59]
v_max3_u32 v16, v16, v36, v37
v_max3_u32 v16, v16, v38, v39
s_waitcnt vmcnt(1)
v_mfma_f32_16x16x32_bf16 v[56:59], v[40:43], v[60:63], v[56:59]
v_max3_u32 v16, v16, v40, v41
v_max3_u32 v16, v16, v42, v43
s_waitcnt vmcnt(0)
v_mfma_f32_16x16x32_bf16 v[56:59], v[44:47], v[60:63], v[56:59]
v_max3_u32 v16, v16, v44, v45
v_max3_u32 v16, v16, v46, v47
v_cmp_le_u32 vcc, 0xffff0000, v16
s_cbranch_vccz L_redb0
s_branch L_red0b
L_g3r0:
buffer_load_dwordx4 v[16:19], v1, s[8:11], s6 offen sc1
s_add_u32 s22, s22, 1
s_waitcnt vmcnt(1)
v_max3_u32 v21, v16, v17, v18
v_max_u32 v21, v21, v19
v_cmp_le_u32 vcc, 0xffff0000, v21
s_cmp_gt_u32 s22, 40000
s_cbranch_vccz L_g30
s_cbranch_scc0 L_g3r0
s_branch L_end
L_ent1:
s_movk_i32 s4, -64
v_mov_b64 v[24:25], 0
v_mov_b64 v[26:27], 0
v_mov_b64 v[28:29], 0
v_mov_b64 v[30:31], 0
v_and_b32 v69, 0x380, v1
v_add_u32 v69, v69, v1
v_and_b32 v70, 0xf40, v1
v_add_u32 v70, v70, v1
v_bfe_u32 v71, v1, 7, 1
v_mad_i32_i24 v70, v71, s4, v70
v_mov_b64 v[64:65], -1
v_mov_b64 v[66:67], -1
v_xor_b32 v3, 16, v4
ds_read_b128 v[48:51], v2 offset:10240
ds_read_b128 v[52:55], v2 offset:11264
ds_read_b128 v[40:43], v2 offset:2048
ds_read_b128 v[44:47], v2 offset:3072
v_mov_b64 v[32:33], 0
v_mov_b64 v[34:35], 0
v_mov_b64 v[36:37], 0
v_mov_b64 v[38:39], 0
v_mov_b64 v[56:57], 0
v_mov_b64 v[58:59], 0
v_mov_b64 v[60:61], 0
v_mov_b64 v[62:63], 0
s_add_u32 s20, s30, 1024
s_add_u32 s21, s30, 8192
s_add_u32 s49, s29, s25
s_add_u32 s50, s29, s26
s_add_u32 s51, s29, s27
s_add_u32 s52, s30, 16384
s_mov_b32 m0, 17920
s_nop 0
buffer_load_dwordx4 v69, s[8:11], s20 offen sc1 lds
s_mov_b32 m0, 18816
s_nop 0
buffer_load_dwordx4 v69, s[8:11], s20 offen offset:128 sc1 lds
s_waitcnt vmcnt(0) lgkmcnt(0)
s_branch L_step1
L_gr1:
buffer_load_dwordx4 v[12:15], v1, s[8:11], s33 offen sc1
buffer_load_dword v20, v8, s[8:11], s7 offen sc1
buffer_load_dwordx4 v[16:19], v1, s[8:11], s6 offen sc1
s_add_u32 s22, s22, 1
s_cmp_gt_u32 s22, 40000
s_cbranch_scc1 L_end
buffer_load_dwordx4 v[16:19], v1, s[8:11], s6 offen sc1
v_mov_b64 v[24:25], 0
v_mov_b64 v[26:27], 0
v_mov_b64 v[28:29], 0
v_mov_b64 v[30:31], 0
v_mov_b64 v[32:33], 0
v_mov_b64 v[34:35], 0
v_mov_b64 v[36:37], 0
v_mov_b64 v[38:39], 0
v_mov_b64 v[56:57], 0
v_mov_b64 v[58:59], 0
v_mov_b64 v[60:61], 0
v_mov_b64 v[62:63], 0
s_waitcnt lgkmcnt(0)
s_branch L_step1
.p2align 3
L_gat1:
buffer_load_dwordx4 v[12:15], v1, s[8:11], s33 offen sc1
buffer_load_dword v20, v8, s[8:11], s7 offen sc1
buffer_load_dwordx4 v[16:19], v1, s[8:11], s6 offen sc1
s_add_u32 s20, s30, 1024
s_add_u32 s21, s30, 8192
s_add_u32 s49, s29, s25
s_add_u32 s50, s29, s26
s_add_u32 s51, s29, s27
s_add_u32 s52, s30, 16384
s_mov_b32 m0, 17920
s_waitcnt vmcnt(4)
ds_read_b128 v[40:43], v2 offset:2048
ds_read_b128 v[44:47], v2 offset:3072
v_mov_b64 v[32:33], 0
v_mov_b64 v[34:35], 0
v_mov_b64 v[36:37], 0
v_mov_b64 v[38:39], 0
v_mov_b64 v[56:57], 0
v_mov_b64 v[58:59], 0
v_mov_b64 v[60:61], 0
v_mov_b64 v[62:63], 0
s_nop 6
buffer_load_dwordx4 v[16:19], v1, s[8:11], s6 offen sc1
s_waitcnt lgkmcnt(0)
L_step1:
s_waitcnt vmcnt(3)
v_smfmac_f32_16x16x64_bf16 v[24:27], v[12:15], v[96:103], v0
ds_write_b128 v1, v[12:15] offset:6656
v_smfmac_f32_16x16x64_bf16 v[28:31], v[12:15], v[104:111], v0
s_waitcnt vmcnt(2)
v_max3_u32 v21, v12, v13, v14
v_max3_u32 v21, v21, v15, v20
v_cmp_le_u32 vcc, 0xffff0000, v21
v_smfmac_f32_16x16x64_bf16 v[32:35], v[12:15], v[112:119], v0
s_cbranch_vccnz L_gr1
s_waitcnt vmcnt(1)
v_max3_u32 v21, v16, v17, v18
v_max_u32 v21, v21, v19
v_cmp_le_u32 vcc, 0xffff0000, v21
ds_write_b32 v8, v20 offset:14848
v_smfmac_f32_16x16x64_bf16 v[56:59], v[12:15], a[48:55], v0
s_cbranch_vccnz L_g3r1
L_g31:
ds_write_b128 v1, v[16:19] offset:10752
v_smfmac_f32_16x16x64_bf16 v[60:63], v[12:15], a[56:63], v0
v_smfmac_f32_16x16x64_bf16 v[36:39], v[12:15], v[40:47], v0
v_smfmac_f32_16x16x64_bf16 v[24:27], v[16:19], v[192:199], v0
v_smfmac_f32_16x16x64_bf16 v[28:31], v[16:19], v[200:207], v0
s_waitcnt lgkmcnt(0)
s_barrier
ds_read_b128 v[20:23], v1 offset:5632
v_smfmac_f32_16x16x64_bf16 v[32:35], v[16:19], v[208:215], v0
ds_read_b128 v[12:15], v1 offset:7680
s_mov_b32 m0, 6272
buffer_store_dword v0, v11, s[8:11], s35 offen
v_smfmac_f32_16x16x64_bf16 v[56:59], v[16:19], a[112:119], v0
ds_read_b128 v[40:43], v2
v_smfmac_f32_16x16x64_bf16 v[60:63], v[16:19], a[120:127], v0
ds_read_b128 v[44:47], v2 offset:1024
buffer_store_dwordx4 v[64:67], v1, s[8:11], s49 offen
v_smfmac_f32_16x16x64_bf16 v[36:39], v[16:19], v[48:55], v0
s_waitcnt vmcnt(2)
ds_read_b128 v[16:19], v1 offset:8704
s_waitcnt lgkmcnt(4)
v_smfmac_f32_16x16x64_bf16 v[24:27], v[20:23], v[72:79], v0
ds_read_b128 v[48:51], v2 offset:4096
buffer_store_dwordx4 v[64:67], v1, s[8:11], s50 offen
v_smfmac_f32_16x16x64_bf16 v[28:31], v[20:23], v[80:87], v0
ds_read_b128 v[52:55], v2 offset:5120
v_smfmac_f32_16x16x64_bf16 v[32:35], v[20:23], v[88:95], v0
s_waitcnt lgkmcnt(3)
buffer_store_dwordx4 v[64:67], v1, s[8:11], s51 offen
v_smfmac_f32_16x16x64_bf16 v[36:39], v[20:23], v[40:47], v0
ds_read_b128 v[20:23], v1 offset:9728
buffer_load_dwordx4 v[64:67], v70, s[8:11], s21 offen sc1
v_smfmac_f32_16x16x64_bf16 v[24:27], v[12:15], v[120:127], v0
ds_read_b128 v[40:43], v2 offset:6144
v_smfmac_f32_16x16x64_bf16 v[28:31], v[12:15], v[128:135], v0
ds_read_b128 v[44:47], v2 offset:7168
buffer_load_dwordx4 v[68:71], v70, s[8:11], s21 offen offset:256 sc1
v_smfmac_f32_16x16x64_bf16 v[32:35], v[12:15], v[136:143], v0
s_waitcnt lgkmcnt(3)
v_smfmac_f32_16x16x64_bf16 v[36:39], v[12:15], v[48:55], v0
ds_read_b128 v[12:15], v1 offset:11776
v_smfmac_f32_16x16x64_bf16 v[24:27], v[16:19], v[144:151], v0
ds_read_b128 v[48:51], v2 offset:8192
v_smfmac_f32_16x16x64_bf16 v[28:31], v[16:19], v[152:159], v0
ds_read_b128 v[52:55], v2 offset:9216
v_smfmac_f32_16x16x64_bf16 v[32:35], v[16:19], v[160:167], v0
s_waitcnt lgkmcnt(3)
buffer_load_dword v6, s[8:11], s52 offen sc1 lds
v_smfmac_f32_16x16x64_bf16 v[36:39], v[16:19], v[40:47], v0
ds_read_b128 v[16:19], v1 offset:12800
v_smfmac_f32_16x16x64_bf16 v[24:27], v[20:23], v[168:175], v0
ds_read_b128 v[40:43], v2 offset:12288
v_smfmac_f32_16x16x64_bf16 v[28:31], v[20:23], v[176:183], v0
ds_read_b128 v[44:47], v2 offset:13312
v_smfmac_f32_16x16x64_bf16 v[32:35], v[20:23], v[184:191], v0
s_waitcnt lgkmcnt(3)
v_smfmac_f32_16x16x64_bf16 v[36:39], v[20:23], v[48:55], v0
ds_read_b128 v[20:23], v1 offset:13824
v_smfmac_f32_16x16x64_bf16 v[24:27], v[12:15], v[216:223], v0
ds_read_b128 v[48:51], v2 offset:14336
v_smfmac_f32_16x16x64_bf16 v[28:31], v[12:15], v[224:231], v0
ds_read_b128 v[52:55], v2 offset:15360
v_smfmac_f32_16x16x64_bf16 v[32:35], v[12:15], v[232:239], v0
s_waitcnt lgkmcnt(3)
v_smfmac_f32_16x16x64_bf16 v[36:39], v[12:15], v[40:47], v0
ds_read_b128 v[12:15], v1 offset:5632
v_smfmac_f32_16x16x64_bf16 v[24:27], v[16:19], v[240:247], v0
ds_read_b128 v[40:43], v2 offset:16384
v_smfmac_f32_16x16x64_bf16 v[28:31], v[16:19], v[248:255], v0
s_waitcnt lgkmcnt(4)
ds_read_b128 v[44:47], v2 offset:17408
v_smfmac_f32_16x16x64_bf16 v[24:27], v[20:23], a[8:15], v0
v_smfmac_f32_16x16x64_bf16 v[28:31], v[20:23], a[16:23], v0
v_smfmac_f32_16x16x64_bf16 v[32:35], v[16:19], a[0:7], v0
s_waitcnt lgkmcnt(3)
v_smfmac_f32_16x16x64_bf16 v[36:39], v[16:19], v[48:55], v0
ds_read_b128 v[16:19], v1 offset:7680
s_nop 2
v_add_f32 v24, v24, v25
v_smfmac_f32_16x16x64_bf16 v[32:35], v[20:23], a[24:31], v0
s_waitcnt lgkmcnt(1)
ds_read_b128 v[48:51], v1 offset:18944
v_add_f32 v26, v26, v27
v_smfmac_f32_16x16x64_bf16 v[36:39], v[20:23], v[40:47], v0
ds_read_b128 v[52:55], v1 offset:20992
v_add_f32 v28, v28, v29
v_smfmac_f32_16x16x64_bf16 v[56:59], v[12:15], a[32:39], v0
ds_read_b128 v[20:23], v1 offset:8704
v_add_f32 v30, v30, v31
v_cvt_pk_bf16_f32 v24, v24, v28
ds_write_b32 v4, v24 offset:2176
v_smfmac_f32_16x16x64_bf16 v[60:63], v[12:15], a[40:47], v0
s_waitcnt lgkmcnt(4)
ds_read_b128 v[12:15], v1 offset:9728
v_cvt_pk_bf16_f32 v26, v26, v30
ds_write_b32 v3, v26 offset:2176
v_add_f32 v32, v32, v33
v_smfmac_f32_16x16x64_bf16 v[56:59], v[16:19], a[64:71], v0
ds_read_b128 v[44:47], v1 offset:16896
v_add_f32 v34, v34, v35
v_add_f32 v36, v36, v37
v_add_f32 v38, v38, v39
v_smfmac_f32_16x16x64_bf16 v[60:63], v[16:19], a[72:79], v0
s_waitcnt lgkmcnt(4)
ds_read_b128 v[16:19], v1 offset:11776
v_cvt_pk_bf16_f32 v32, v32, v36
ds_write_b32 v4, v32
v_cvt_pk_bf16_f32 v34, v34, v38
v_smfmac_f32_16x16x64_bf16 v[56:59], v[20:23], a[80:87], v0
ds_read_b128 v[40:43], v1 offset:14848
ds_write_b32 v3, v34
v_smfmac_f32_16x16x64_bf16 v[60:63], v[20:23], a[88:95], v0
s_waitcnt lgkmcnt(6)
ds_read_b128 v[20:23], v1 offset:12800
v_smfmac_f32_16x16x64_bf16 v[56:59], v[12:15], a[96:103], v0
v_smfmac_f32_16x16x64_bf16 v[60:63], v[12:15], a[104:111], v0
s_waitcnt lgkmcnt(4)
ds_read_b128 v[12:15], v1 offset:13824
v_smfmac_f32_16x16x64_bf16 v[56:59], v[16:19], a[128:135], v0
v_smfmac_f32_16x16x64_bf16 v[60:63], v[16:19], a[136:143], v0
s_waitcnt lgkmcnt(1)
v_smfmac_f32_16x16x64_bf16 v[56:59], v[20:23], a[144:151], v0
s_barrier
ds_read_b128 v[28:31], v5 offset:512
v_smfmac_f32_16x16x64_bf16 v[60:63], v[20:23], a[152:159], v0
s_waitcnt lgkmcnt(1)
ds_read_b128 v[32:35], v5 offset:1024
v_smfmac_f32_16x16x64_bf16 v[56:59], v[12:15], a[160:167], v0
ds_read_b128 v[36:39], v5 offset:1536
v_smfmac_f32_16x16x64_bf16 v[60:63], v[12:15], a[168:175], v0
s_waitcnt lgkmcnt(2)
ds_read_b128 v[24:27], v5
v_mfma_f32_16x16x32_bf16 v[16:19], v[44:47], v[28:31], 0
s_waitcnt lgkmcnt(2)
ds_read_b128 v[44:47], v1 offset:17920
v_mfma_f32_16x16x32_bf16 v[16:19], v[48:51], v[32:35], v[16:19]
ds_read_b128 v[48:51], v1 offset:19968
s_mov_b64 exec, s[86:87]
buffer_store_dwordx4 v[28:31], v5, s[8:11], s31 offen offset:512 sc1
s_mov_b64 exec, -1
s_waitcnt lgkmcnt(3)
v_mfma_f32_16x16x32_bf16 v[16:19], v[52:55], v[36:39], v[16:19]
s_waitcnt lgkmcnt(2)
ds_read_b128 v[52:55], v1 offset:22016
v_mfma_f32_16x16x32_bf16 v[16:19], v[40:43], v[24:27], v[16:19]
ds_read_b128 v[40:43], v1 offset:15872
v_mfma_f32_16x16x32_bf16 v[20:23], v[28:31], v[28:31], 0
v_add_f32 v56, v56, v57
v_add_f32 v58, v58, v59
v_mfma_f32_16x16x32_bf16 v[20:23], v[32:35], v[32:35], v[20:23]
v_add_f32 v60, v60, v61
v_add_f32 v62, v62, v63
v_mfma_f32_16x16x32_bf16 v[20:23], v[36:39], v[36:39], v[20:23]
v_cvt_pk_bf16_f32 v56, v56, v58
v_cvt_pk_bf16_f32 v57, v60, v62
v_mfma_f32_16x16x32_bf16 v[20:23], v[24:27], v[24:27], v[20:23]
s_waitcnt lgkmcnt(3)
v_lshrrev_b32 v58, 1, v1
v_max3_f32 v59, v16, v17, v18
v_mfma_f32_16x16x32_bf16 v[12:15], v[44:47], v[28:31], 0
s_waitcnt lgkmcnt(2)
ds_read_b128 v[44:47], v2 offset:19456
v_mfma_f32_16x16x32_bf16 v[12:15], v[48:51], v[32:35], v[12:15]
s_waitcnt lgkmcnt(2)
ds_read_b128 v[48:51], v2 offset:20480
buffer_store_dwordx2 v[56:57], v58, s[8:11], s31 offen offset:2048 sc1
v_mfma_f32_16x16x32_bf16 v[12:15], v[52:55], v[36:39], v[12:15]
s_waitcnt lgkmcnt(2)
ds_read_b128 v[52:55], v2 offset:21504
v_max3_f32 v59, v59, v19, v20
v_max_f32 v59, v59, v21
v_mfma_f32_16x16x32_bf16 v[12:15], v[40:43], v[24:27], v[12:15]
ds_read_b128 v[40:43], v2 offset:18432
v_mov_b32 v60, s53
s_add_u32 s49, s28, s23
v_mov_b32 v61, s53
s_add_u32 s50, s28, 65536
v_mov_b32 v62, s53
ds_read_b128 v[32:35], v2 offset:22528
v_mov_b32 v63, s53
v_max3_f32 v59, v59, v12, v13
v_max3_f32 v22, v59, v14, v15
v_max3_f32 v59, v59, v14, v15
s_add_u32 s51, s28, 131072
s_add_u32 s52, s28, 196608
v_permlane32_swap_b32 v22, v59
v_max_f32 v23, v59, v22
v_max_f32 v59, v59, v22
v_mov_b32 v22, 0
ds_read_b128 v[36:39], v2 offset:23552
v_permlane16_swap_b32 v23, v59
v_max_f32 v59, v59, v23
v_mul_f32 v58, s18, v59
v_pk_fma_f32 v[20:21], v[20:21], s[18:19], v[58:59] op_sel_hi:[1,0,0] neg_lo:[0,0,1] neg_hi:[0,0,1]
v_pk_fma_f32 v[16:17], v[16:17], s[18:19], v[58:59] op_sel_hi:[1,0,0] neg_lo:[0,0,1] neg_hi:[0,0,1]
v_pk_fma_f32 v[18:19], v[18:19], s[18:19], v[58:59] op_sel_hi:[1,0,0] neg_lo:[0,0,1] neg_hi:[0,0,1]
v_pk_fma_f32 v[12:13], v[12:13], s[18:19], v[58:59] op_sel_hi:[1,0,0] neg_lo:[0,0,1] neg_hi:[0,0,1]
v_pk_fma_f32 v[14:15], v[14:15], s[18:19], v[58:59] op_sel_hi:[1,0,0] neg_lo:[0,0,1] neg_hi:[0,0,1]
v_exp_f32 v20, v20
v_exp_f32 v21, v21
v_exp_f32 v16, v16
v_cvt_pk_bf16_f32 v23, v20, v21
v_cvt_pk_bf16_f32 v20, v20, v21
v_mov_b32 v21, 0
v_exp_f32 v17, v17
v_exp_f32 v18, v18
v_mfma_f32_16x16x16_bf16 v[24:27], v[56:57], v[20:21], 0
v_exp_f32 v19, v19
v_mfma_f32_16x16x16_bf16 v[28:31], v[56:57], v[22:23], 0
v_exp_f32 v12, v12
v_exp_f32 v13, v13
v_cvt_pk_bf16_f32 v16, v16, v17
v_cvt_pk_bf16_f32 v17, v18, v19
v_exp_f32 v14, v14
v_exp_f32 v15, v15
v_cvt_pk_bf16_f32 v18, v12, v13
v_cvt_pk_bf16_f32 v19, v14, v15
v_mfma_f32_16x16x16_bf16 v[12:15], v[60:61], v[20:21], 0
s_waitcnt vmcnt(3)
v_mfma_f32_16x16x32_bf16 v[12:15], v[60:63], v[16:19], v[12:15]
v_mov_b32 v20, 0
v_mov_b32 v23, 0
v_mfma_f32_16x16x32_bf16 v[24:27], v[64:67], v[16:19], v[24:27]
s_nop 1
v_mfma_f32_16x16x32_bf16 v[28:31], v[68:71], v[16:19], v[28:31]
v_mov_b32 v16, 0
v_mov_b32 v17, 0
v_rcp_f32 v12, v12
v_mov_b32 v18, 0
v_mov_b32 v19, 0
v_pk_mul_f32 v[24:25], v[24:25], v[12:13] op_sel_hi:[1,0]
v_pk_mul_f32 v[26:27], v[26:27], v[12:13] op_sel_hi:[1,0]
v_mov_b32 v15, 0
v_pk_mul_f32 v[28:29], v[28:29], v[12:13] op_sel_hi:[1,0]
v_pk_mul_f32 v[30:31], v[30:31], v[12:13] op_sel_hi:[1,0]
v_cvt_pk_bf16_f32 v24, v24, v28
v_cvt_pk_bf16_f32 v25, v25, v29
v_cvt_pk_bf16_f32 v26, v26, v30
v_cvt_pk_bf16_f32 v27, v27, v31
v_mfma_f32_16x16x32_bf16 v[56:59], v[20:23], v[20:23], 0
ds_write_b128 v7, v[24:27]
v_mfma_f32_16x16x32_bf16 v[60:63], v[20:23], v[20:23], 0
v_mov_b32 v12, 0
v_mov_b32 v13, 0
v_mov_b32 v14, 0
v_mov_b32 v3, 6528
v_and_b32 v8, 0x380, v1
v_add_u32 v8, v8, v1
v_mfma_f32_16x16x32_bf16 v[64:67], v[20:23], v[20:23], 0
s_add_u32 s20, s30, 17408
s_mov_b32 m0, 17920
s_cmp_eq_u32 s19, 63
s_cbranch_scc1 L_texit
s_waitcnt lgkmcnt(0)
s_barrier
ds_read_b128 v[24:27], v1 offset:3200
v_mfma_f32_16x16x32_bf16 v[68:71], v[20:23], v[20:23], 0
ds_read_b128 v[28:31], v1 offset:4224
s_nop 2
v_mfma_f32_16x16x32_bf16 v[68:71], v[20:23], v[20:23], 0
s_waitcnt lgkmcnt(1)
v_smfmac_f32_16x16x64_bf16 v[12:15], v[24:27], a[248:255], v0
buffer_load_dwordx4 v8, s[8:11], s20 offen sc1 lds
v_smfmac_f32_16x16x64_bf16 v[16:19], v[24:27], a[176:183], v0
s_mov_b32 m0, 18816
s_waitcnt lgkmcnt(0)
v_smfmac_f32_16x16x64_bf16 v[12:15], v[28:31], v[40:47], v0
ds_read_b128 v[40:43], v2 offset:24576
v_smfmac_f32_16x16x64_bf16 v[16:19], v[28:31], v[48:55], v0
ds_read_b128 v[44:47], v2 offset:25600
buffer_load_dwordx4 v8, s[8:11], s20 offen offset:128 sc1 lds
v_smfmac_f32_16x16x64_bf16 v[20:23], v[24:27], a[184:191], v0
ds_read_b128 v[48:51], v2 offset:26624
s_nop 1
v_add_f32 v12, v12, v13
v_add_f32 v14, v14, v15
v_cvt_pk_bf16_f32 v12, v12, v14
v_smfmac_f32_16x16x64_bf16 v[20:23], v[28:31], v[32:39], v0
ds_read_b128 v[52:55], v2 offset:27648
buffer_store_dword v12, v10, s[8:11], s28 offen
v_add_f32 v16, v16, v17
v_add_f32 v18, v18, v19
v_smfmac_f32_16x16x64_bf16 v[56:59], v[24:27], a[192:199], v0
s_waitcnt lgkmcnt(2)
ds_read_b128 v[32:35], v2 offset:28672
v_cvt_pk_bf16_f32 v16, v16, v18
v_smfmac_f32_16x16x64_bf16 v[56:59], v[28:31], v[40:47], v0
ds_read_b128 v[36:39], v2 offset:29696
v_add_f32 v20, v20, v21
v_add_f32 v22, v22, v23
v_cvt_pk_bf16_f32 v17, v20, v22
v_smfmac_f32_16x16x64_bf16 v[60:63], v[24:27], a[200:207], v0
s_waitcnt lgkmcnt(2)
ds_read_b128 v[12:15], v3
buffer_store_dwordx2 v[16:17], v9, s[8:11], s28 offen
v_smfmac_f32_16x16x64_bf16 v[60:63], v[28:31], v[48:55], v0
ds_read_b128 v[40:43], v2 offset:30720
v_add_f32 v56, v56, v57
v_add_f32 v58, v58, v59
v_cvt_pk_bf16_f32 v56, v56, v58
v_smfmac_f32_16x16x64_bf16 v[64:67], v[24:27], a[208:215], v0
s_waitcnt lgkmcnt(2)
ds_read_b128 v[44:47], v2 offset:31744
v_smfmac_f32_16x16x64_bf16 v[64:67], v[28:31], v[32:39], v0
ds_read_b128 v[20:23], v3
v_add_f32 v60, v60, v61
v_add_f32 v62, v62, v63
v_cvt_pk_bf16_f32 v57, v60, v62
v_smfmac_f32_16x16x64_bf16 v[68:71], v[24:27], a[216:223], v0
s_waitcnt lgkmcnt(1)
ds_read_b128 v[48:51], v2 offset:32768
buffer_store_dwordx2 v[56:57], v9, s[8:11], s50 offen
v_smfmac_f32_16x16x64_bf16 v[68:71], v[28:31], v[40:47], v0
ds_read_b128 v[52:55], v2 offset:33792
v_add_f32 v64, v64, v65
v_add_f32 v66, v66, v67
v_cvt_pk_bf16_f32 v64, v64, v66
v_smfmac_f32_16x16x64_bf16 v[12:15], v[24:27], a[224:231], v0
s_waitcnt lgkmcnt(0)
v_smfmac_f32_16x16x64_bf16 v[12:15], v[28:31], v[48:55], v0
s_nop 0
v_add_f32 v68, v68, v69
v_add_f32 v70, v70, v71
v_cvt_pk_bf16_f32 v65, v68, v70
v_smfmac_f32_16x16x64_bf16 v[20:23], v[24:27], a[232:239], v0
buffer_store_dwordx2 v[64:65], v9, s[8:11], s51 offen
v_smfmac_f32_16x16x64_bf16 v[20:23], v[28:31], a[240:247], v0
s_nop 0
v_add_f32 v12, v12, v13
v_add_f32 v14, v14, v15
v_cvt_pk_bf16_f32 v12, v12, v14
s_nop 3
v_add_f32 v20, v20, v21
v_add_f32 v22, v22, v23
v_cvt_pk_bf16_f32 v13, v20, v22
buffer_store_dwordx2 v[12:13], v9, s[8:11], s52 offen
s_waitcnt vmcnt(0)
L_lt1:
buffer_load_dwordx4 v[32:35], v1, s[8:11], s49 offen sc1
buffer_load_dwordx4 v[36:39], v1, s[8:11], s49 offen offset:1024 sc1
buffer_load_dwordx4 v[40:43], v1, s[8:11], s49 offen offset:2048 sc1
buffer_load_dwordx4 v[44:47], v1, s[8:11], s49 offen offset:3072 sc1
s_add_u32 s19, s19, 1
s_mov_b32 s20, s28
s_mov_b32 s28, s29
s_mov_b32 s29, s20
s_and_b32 s20, s19, 3
s_lshl_b32 s20, s20, 14
s_add_u32 s33, s20, 110100480
s_add_u32 s34, s20, s24
s_xor_b32 s20, s20, 32768
s_add_u32 s35, s20, s24
s_add_u32 s30, s30, 16384
s_add_u32 s31, s31, 131072
s_add_u32 s6, s33, 4096
s_add_u32 s7, s33, 8192
s_mov_b32 s22, 0
v_mov_b64 v[24:25], 0
v_mov_b64 v[26:27], 0
v_mov_b64 v[28:29], 0
v_mov_b64 v[30:31], 0
buffer_load_dwordx4 v[32:35], v1, s[8:11], s49 offen sc1
buffer_load_dwordx4 v[36:39], v1, s[8:11], s49 offen offset:1024 sc1
buffer_load_dwordx4 v[40:43], v1, s[8:11], s49 offen offset:2048 sc1
buffer_load_dwordx4 v[44:47], v1, s[8:11], s49 offen offset:3072 sc1
v_and_b32 v70, 0xf40, v1
v_add_u32 v70, v70, v1
v_bfe_u32 v71, v1, 7, 1
v_mad_i32_i24 v70, v71, s4, v70
v_mov_b64 v[64:65], -1
v_mov_b64 v[66:67], -1
v_xor_b32 v3, 16, v4
ds_read_b128 v[48:51], v2 offset:10240
ds_read_b128 v[52:55], v2 offset:11264
v_lshrrev_b32 v8, 2, v1
v_mov_b32 v56, 0x3f80
v_cndmask_b32 v56, v56, 1.0, s[44:45]
v_cndmask_b32 v60, 0, v56, s[36:37]
v_cndmask_b32 v61, 0, v56, s[38:39]
v_cndmask_b32 v62, 0, v56, s[40:41]
v_cndmask_b32 v63, 0, v56, s[42:43]
s_waitcnt vmcnt(7)
v_max3_u32 v16, v32, v33, v34
v_max_u32 v16, v16, v35
v_mfma_f32_16x16x32_bf16 v[56:59], v[32:35], v[60:63], 0
s_waitcnt vmcnt(6)
v_max3_u32 v16, v16, v36, v37
v_max3_u32 v16, v16, v38, v39
v_mfma_f32_16x16x32_bf16 v[56:59], v[36:39], v[60:63], v[56:59]
s_waitcnt vmcnt(5)
v_max3_u32 v16, v16, v40, v41
v_max3_u32 v16, v16, v42, v43
v_mfma_f32_16x16x32_bf16 v[56:59], v[40:43], v[60:63], v[56:59]
s_waitcnt vmcnt(4)
v_max3_u32 v16, v16, v44, v45
v_max3_u32 v16, v16, v46, v47
v_mfma_f32_16x16x32_bf16 v[56:59], v[44:47], v[60:63], v[56:59]
v_cmp_le_u32 vcc, 0xffff0000, v16
s_cbranch_vccnz L_red1
L_redb1:
s_nop 5
v_permlane32_swap_b32 v56, v58
v_permlane32_swap_b32 v57, v59
v_pk_add_f32 v[56:57], v[56:57], v[58:59]
v_cvt_pk_bf16_f32 v56, v56, v57
buffer_store_dword v56, v11, s[8:11], s34 offen
s_add_u32 s20, s30, 1024
s_add_u32 s21, s30, 8192
s_add_u32 s49, s29, s25
s_add_u32 s50, s29, s26
s_add_u32 s51, s29, s27
s_add_u32 s52, s30, 16384
s_mov_b32 m0, 17920
s_nop 1
s_barrier
s_branch L_gat1
L_red1:
s_waitcnt vmcnt(3)
v_mfma_f32_16x16x32_bf16 v[56:59], v[32:35], v[60:63], 0
v_max3_u32 v16, v32, v33, v34
v_max_u32 v16, v16, v35
s_waitcnt vmcnt(2)
v_mfma_f32_16x16x32_bf16 v[56:59], v[36:39], v[60:63], v[56:59]
v_max3_u32 v16, v16, v36, v37
v_max3_u32 v16, v16, v38, v39
s_waitcnt vmcnt(1)
v_mfma_f32_16x16x32_bf16 v[56:59], v[40:43], v[60:63], v[56:59]
v_max3_u32 v16, v16, v40, v41
v_max3_u32 v16, v16, v42, v43
s_waitcnt vmcnt(0)
v_mfma_f32_16x16x32_bf16 v[56:59], v[44:47], v[60:63], v[56:59]
v_max3_u32 v16, v16, v44, v45
v_max3_u32 v16, v16, v46, v47
v_cmp_le_u32 vcc, 0xffff0000, v16
s_cbranch_vccz L_redb1
L_red1b:
buffer_load_dwordx4 v[32:35], v1, s[8:11], s49 offen sc1
buffer_load_dwordx4 v[36:39], v1, s[8:11], s49 offen offset:1024 sc1
buffer_load_dwordx4 v[40:43], v1, s[8:11], s49 offen offset:2048 sc1
buffer_load_dwordx4 v[44:47], v1, s[8:11], s49 offen offset:3072 sc1
s_add_u32 s22, s22, 1
s_cmp_gt_u32 s22, 40000
s_cbranch_scc1 L_end
s_waitcnt vmcnt(3)
v_mfma_f32_16x16x32_bf16 v[56:59], v[32:35], v[60:63], 0
v_max3_u32 v16, v32, v33, v34
v_max_u32 v16, v16, v35
s_waitcnt vmcnt(2)
v_mfma_f32_16x16x32_bf16 v[56:59], v[36:39], v[60:63], v[56:59]
v_max3_u32 v16, v16, v36, v37
v_max3_u32 v16, v16, v38, v39
s_waitcnt vmcnt(1)
v_mfma_f32_16x16x32_bf16 v[56:59], v[40:43], v[60:63], v[56:59]
v_max3_u32 v16, v16, v40, v41
v_max3_u32 v16, v16, v42, v43
s_waitcnt vmcnt(0)
v_mfma_f32_16x16x32_bf16 v[56:59], v[44:47], v[60:63], v[56:59]
v_max3_u32 v16, v16, v44, v45
v_max3_u32 v16, v16, v46, v47
v_cmp_le_u32 vcc, 0xffff0000, v16
s_cbranch_vccz L_redb1
s_branch L_red1b
L_g3r1:
buffer_load_dwordx4 v[16:19], v1, s[8:11], s6 offen sc1
s_add_u32 s22, s22, 1
s_waitcnt vmcnt(1)
v_max3_u32 v21, v16, v17, v18
v_max_u32 v21, v21, v19
v_cmp_le_u32 vcc, 0xffff0000, v21
s_cmp_gt_u32 s22, 40000
s_cbranch_vccz L_g31
s_cbranch_scc0 L_g3r1
s_branch L_end
L_ent2:
s_movk_i32 s4, -64
v_mov_b64 v[24:25], 0
v_mov_b64 v[26:27], 0
v_mov_b64 v[28:29], 0
v_mov_b64 v[30:31], 0
v_and_b32 v69, 0x380, v1
v_add_u32 v69, v69, v1
v_and_b32 v70, 0xf40, v1
v_add_u32 v70, v70, v1
v_bfe_u32 v71, v1, 7, 1
v_mad_i32_i24 v70, v71, s4, v70
v_mov_b64 v[64:65], -1
v_mov_b64 v[66:67], -1
v_xor_b32 v3, 16, v4
ds_read_b128 v[48:51], v2 offset:12288
ds_read_b128 v[52:55], v2 offset:13312
ds_read_b128 v[40:43], v2 offset:4096
ds_read_b128 v[44:47], v2 offset:5120
v_mov_b64 v[32:33], 0
v_mov_b64 v[34:35], 0
v_mov_b64 v[36:37], 0
v_mov_b64 v[38:39], 0
v_mov_b64 v[56:57], 0
v_mov_b64 v[58:59], 0
v_mov_b64 v[60:61], 0
v_mov_b64 v[62:63], 0
s_add_u32 s20, s30, 2048
s_add_u32 s21, s30, 8192
s_add_u32 s49, s29, s25
s_add_u32 s50, s29, s26
s_add_u32 s51, s29, s27
s_add_u32 s52, s30, 16384
s_mov_b32 m0, 19968
s_nop 0
buffer_load_dwordx4 v69, s[8:11], s20 offen sc1 lds
s_mov_b32 m0, 20864
s_nop 0
buffer_load_dwordx4 v69, s[8:11], s20 offen offset:128 sc1 lds
s_waitcnt vmcnt(0) lgkmcnt(0)
s_branch L_step2
L_gr2:
buffer_load_dwordx4 v[12:15], v1, s[8:11], s33 offen sc1
buffer_load_dword v20, v8, s[8:11], s7 offen sc1
buffer_load_dwordx4 v[16:19], v1, s[8:11], s6 offen sc1
s_add_u32 s22, s22, 1
s_cmp_gt_u32 s22, 40000
s_cbranch_scc1 L_end
buffer_load_dwordx4 v[16:19], v1, s[8:11], s6 offen sc1
v_mov_b64 v[24:25], 0
v_mov_b64 v[26:27], 0
v_mov_b64 v[28:29], 0
v_mov_b64 v[30:31], 0
v_mov_b64 v[32:33], 0
v_mov_b64 v[34:35], 0
v_mov_b64 v[36:37], 0
v_mov_b64 v[38:39], 0
v_mov_b64 v[56:57], 0
v_mov_b64 v[58:59], 0
v_mov_b64 v[60:61], 0
v_mov_b64 v[62:63], 0
s_waitcnt lgkmcnt(0)
s_branch L_step2
.p2align 3
L_gat2:
buffer_load_dwordx4 v[12:15], v1, s[8:11], s33 offen sc1
buffer_load_dword v20, v8, s[8:11], s7 offen sc1
buffer_load_dwordx4 v[16:19], v1, s[8:11], s6 offen sc1
s_add_u32 s20, s30, 2048
s_add_u32 s21, s30, 8192
s_add_u32 s49, s29, s25
s_add_u32 s50, s29, s26
s_add_u32 s51, s29, s27
s_add_u32 s52, s30, 16384
s_mov_b32 m0, 19968
ds_read_b128 v[40:43], v2 offset:4096
ds_read_b128 v[44:47], v2 offset:5120
v_mov_b64 v[32:33], 0
v_mov_b64 v[34:35], 0
v_mov_b64 v[36:37], 0
v_mov_b64 v[38:39], 0
v_mov_b64 v[56:57], 0
v_mov_b64 v[58:59], 0
v_mov_b64 v[60:61], 0
v_mov_b64 v[62:63], 0
s_nop 6
buffer_load_dwordx4 v[16:19], v1, s[8:11], s6 offen sc1
s_waitcnt lgkmcnt(0)
L_step2:
s_waitcnt vmcnt(3)
v_smfmac_f32_16x16x64_bf16 v[24:27], v[12:15], v[120:127], v0
ds_write_b128 v1, v[12:15] offset:6656
v_smfmac_f32_16x16x64_bf16 v[28:31], v[12:15], v[128:135], v0
s_waitcnt vmcnt(2)
v_max3_u32 v21, v12, v13, v14
v_max3_u32 v21, v21, v15, v20
v_cmp_le_u32 vcc, 0xffff0000, v21
v_smfmac_f32_16x16x64_bf16 v[32:35], v[12:15], v[136:143], v0
s_cbranch_vccnz L_gr2
s_waitcnt vmcnt(1)
v_max3_u32 v21, v16, v17, v18
v_max_u32 v21, v21, v19
v_cmp_le_u32 vcc, 0xffff0000, v21
ds_write_b32 v8, v20 offset:14848
v_smfmac_f32_16x16x64_bf16 v[56:59], v[12:15], a[64:71], v0
s_cbranch_vccnz L_g3r2
L_g32:
ds_write_b128 v1, v[16:19] offset:10752
v_smfmac_f32_16x16x64_bf16 v[60:63], v[12:15], a[72:79], v0
v_smfmac_f32_16x16x64_bf16 v[36:39], v[12:15], v[40:47], v0
v_smfmac_f32_16x16x64_bf16 v[24:27], v[16:19], v[216:223], v0
v_smfmac_f32_16x16x64_bf16 v[28:31], v[16:19], v[224:231], v0
s_waitcnt lgkmcnt(0)
s_barrier
ds_read_b128 v[20:23], v1 offset:4608
v_smfmac_f32_16x16x64_bf16 v[32:35], v[16:19], v[232:239], v0
ds_read_b128 v[12:15], v1 offset:5632
s_mov_b32 m0, 6272
buffer_store_dword v0, v11, s[8:11], s35 offen
v_smfmac_f32_16x16x64_bf16 v[56:59], v[16:19], a[128:135], v0
ds_read_b128 v[40:43], v2
v_smfmac_f32_16x16x64_bf16 v[60:63], v[16:19], a[136:143], v0
ds_read_b128 v[44:47], v2 offset:1024
buffer_store_dwordx4 v[64:67], v1, s[8:11], s49 offen
v_smfmac_f32_16x16x64_bf16 v[36:39], v[16:19], v[48:55], v0
s_waitcnt vmcnt(2)
ds_read_b128 v[16:19], v1 offset:7680
s_waitcnt lgkmcnt(4)
v_smfmac_f32_16x16x64_bf16 v[24:27], v[20:23], v[72:79], v0
ds_read_b128 v[48:51], v2 offset:2048
buffer_store_dwordx4 v[64:67], v1, s[8:11], s50 offen
v_smfmac_f32_16x16x64_bf16 v[28:31], v[20:23], v[80:87], v0
ds_read_b128 v[52:55], v2 offset:3072
v_smfmac_f32_16x16x64_bf16 v[32:35], v[20:23], v[88:95], v0
s_waitcnt lgkmcnt(3)
buffer_store_dwordx4 v[64:67], v1, s[8:11], s51 offen
v_smfmac_f32_16x16x64_bf16 v[36:39], v[20:23], v[40:47], v0
ds_read_b128 v[20:23], v1 offset:8704
buffer_load_dwordx4 v[64:67], v70, s[8:11], s21 offen sc1
v_smfmac_f32_16x16x64_bf16 v[24:27], v[12:15], v[96:103], v0
ds_read_b128 v[40:43], v2 offset:6144
v_smfmac_f32_16x16x64_bf16 v[28:31], v[12:15], v[104:111], v0
ds_read_b128 v[44:47], v2 offset:7168
buffer_load_dwordx4 v[68:71], v70, s[8:11], s21 offen offset:256 sc1
v_smfmac_f32_16x16x64_bf16 v[32:35], v[12:15], v[112:119], v0
s_waitcnt lgkmcnt(3)
v_smfmac_f32_16x16x64_bf16 v[36:39], v[12:15], v[48:55], v0
ds_read_b128 v[12:15], v1 offset:9728
v_smfmac_f32_16x16x64_bf16 v[24:27], v[16:19], v[144:151], v0
ds_read_b128 v[48:51], v2 offset:8192
v_smfmac_f32_16x16x64_bf16 v[28:31], v[16:19], v[152:159], v0
ds_read_b128 v[52:55], v2 offset:9216
v_smfmac_f32_16x16x64_bf16 v[32:35], v[16:19], v[160:167], v0
s_waitcnt lgkmcnt(3)
v_smfmac_f32_16x16x64_bf16 v[36:39], v[16:19], v[40:47], v0
ds_read_b128 v[16:19], v1 offset:11776
v_smfmac_f32_16x16x64_bf16 v[24:27], v[20:23], v[168:175], v0
ds_read_b128 v[40:43], v2 offset:10240
v_smfmac_f32_16x16x64_bf16 v[28:31], v[20:23], v[176:183], v0
ds_read_b128 v[44:47], v2 offset:11264
v_smfmac_f32_16x16x64_bf16 v[32:35], v[20:23], v[184:191], v0
s_waitcnt lgkmcnt(3)
v_smfmac_f32_16x16x64_bf16 v[36:39], v[20:23], v[48:55], v0
ds_read_b128 v[20:23], v1 offset:12800
v_smfmac_f32_16x16x64_bf16 v[24:27], v[12:15], v[192:199], v0
ds_read_b128 v[48:51], v2 offset:14336
v_smfmac_f32_16x16x64_bf16 v[28:31], v[12:15], v[200:207], v0
ds_read_b128 v[52:55], v2 offset:15360
v_smfmac_f32_16x16x64_bf16 v[32:35], v[12:15], v[208:215], v0
s_waitcnt lgkmcnt(3)
v_smfmac_f32_16x16x64_bf16 v[36:39], v[12:15], v[40:47], v0
ds_read_b128 v[12:15], v1 offset:4608
v_smfmac_f32_16x16x64_bf16 v[24:27], v[16:19], v[240:247], v0
ds_read_b128 v[40:43], v2 offset:16384
v_smfmac_f32_16x16x64_bf16 v[28:31], v[16:19], v[248:255], v0
s_waitcnt lgkmcnt(4)
ds_read_b128 v[44:47], v2 offset:17408
v_smfmac_f32_16x16x64_bf16 v[24:27], v[20:23], a[8:15], v0
v_smfmac_f32_16x16x64_bf16 v[28:31], v[20:23], a[16:23], v0
v_smfmac_f32_16x16x64_bf16 v[32:35], v[16:19], a[0:7], v0
s_waitcnt lgkmcnt(3)
v_smfmac_f32_16x16x64_bf16 v[36:39], v[16:19], v[48:55], v0
ds_read_b128 v[16:19], v1 offset:5632
s_nop 2
v_add_f32 v24, v24, v25
v_smfmac_f32_16x16x64_bf16 v[32:35], v[20:23], a[24:31], v0
s_waitcnt lgkmcnt(1)
ds_read_b128 v[48:51], v1 offset:17920
v_add_f32 v26, v26, v27
v_smfmac_f32_16x16x64_bf16 v[36:39], v[20:23], v[40:47], v0
ds_read_b128 v[52:55], v1 offset:19968
v_add_f32 v28, v28, v29
v_smfmac_f32_16x16x64_bf16 v[56:59], v[12:15], a[32:39], v0
ds_read_b128 v[20:23], v1 offset:7680
v_add_f32 v30, v30, v31
v_cvt_pk_bf16_f32 v24, v24, v28
ds_write_b32 v4, v24 offset:2176
v_smfmac_f32_16x16x64_bf16 v[60:63], v[12:15], a[40:47], v0
s_waitcnt lgkmcnt(4)
ds_read_b128 v[12:15], v1 offset:8704
v_cvt_pk_bf16_f32 v26, v26, v30
ds_write_b32 v3, v26 offset:2176
v_add_f32 v32, v32, v33
v_smfmac_f32_16x16x64_bf16 v[56:59], v[16:19], a[48:55], v0
ds_read_b128 v[40:43], v1 offset:13824
v_add_f32 v34, v34, v35
v_add_f32 v36, v36, v37
v_add_f32 v38, v38, v39
v_smfmac_f32_16x16x64_bf16 v[60:63], v[16:19], a[56:63], v0
s_waitcnt lgkmcnt(4)
ds_read_b128 v[16:19], v1 offset:9728
v_cvt_pk_bf16_f32 v32, v32, v36
ds_write_b32 v4, v32
v_cvt_pk_bf16_f32 v34, v34, v38
v_smfmac_f32_16x16x64_bf16 v[56:59], v[20:23], a[80:87], v0
ds_read_b128 v[44:47], v1 offset:15872
ds_write_b32 v3, v34
v_smfmac_f32_16x16x64_bf16 v[60:63], v[20:23], a[88:95], v0
s_waitcnt lgkmcnt(6)
ds_read_b128 v[20:23], v1 offset:11776
v_smfmac_f32_16x16x64_bf16 v[56:59], v[12:15], a[96:103], v0
v_smfmac_f32_16x16x64_bf16 v[60:63], v[12:15], a[104:111], v0
s_waitcnt lgkmcnt(4)
ds_read_b128 v[12:15], v1 offset:12800
v_smfmac_f32_16x16x64_bf16 v[56:59], v[16:19], a[112:119], v0
v_smfmac_f32_16x16x64_bf16 v[60:63], v[16:19], a[120:127], v0
s_waitcnt lgkmcnt(1)
v_smfmac_f32_16x16x64_bf16 v[56:59], v[20:23], a[144:151], v0
s_barrier
ds_read_b128 v[32:35], v5 offset:1024
v_smfmac_f32_16x16x64_bf16 v[60:63], v[20:23], a[152:159], v0
s_waitcnt lgkmcnt(1)
ds_read_b128 v[36:39], v5 offset:1536
v_smfmac_f32_16x16x64_bf16 v[56:59], v[12:15], a[160:167], v0
ds_read_b128 v[24:27], v5
v_smfmac_f32_16x16x64_bf16 v[60:63], v[12:15], a[168:175], v0
s_waitcnt lgkmcnt(2)
ds_read_b128 v[28:31], v5 offset:512
v_mfma_f32_16x16x32_bf16 v[16:19], v[48:51], v[32:35], 0
s_waitcnt lgkmcnt(2)
ds_read_b128 v[48:51], v1 offset:18944
v_mfma_f32_16x16x32_bf16 v[16:19], v[52:55], v[36:39], v[16:19]
s_waitcnt lgkmcnt(2)
ds_read_b128 v[52:55], v1 offset:20992
v_mfma_f32_16x16x32_bf16 v[16:19], v[40:43], v[24:27], v[16:19]
ds_read_b128 v[40:43], v1 offset:14848
s_mov_b64 exec, s[86:87]
buffer_store_dwordx4 v[32:35], v5, s[8:11], s31 offen offset:1024 sc1
s_mov_b64 exec, -1
s_waitcnt lgkmcnt(3)
v_mfma_f32_16x16x32_bf16 v[16:19], v[44:47], v[28:31], v[16:19]
ds_read_b128 v[44:47], v1 offset:16896
v_mfma_f32_16x16x32_bf16 v[20:23], v[32:35], v[32:35], 0
v_add_f32 v56, v56, v57
v_add_f32 v58, v58, v59
v_mfma_f32_16x16x32_bf16 v[20:23], v[36:39], v[36:39], v[20:23]
v_add_f32 v60, v60, v61
v_add_f32 v62, v62, v63
v_mfma_f32_16x16x32_bf16 v[20:23], v[24:27], v[24:27], v[20:23]
v_cvt_pk_bf16_f32 v56, v56, v58
v_cvt_pk_bf16_f32 v57, v60, v62
v_mfma_f32_16x16x32_bf16 v[20:23], v[28:31], v[28:31], v[20:23]
s_waitcnt lgkmcnt(3)
v_lshrrev_b32 v58, 1, v1
v_max3_f32 v59, v16, v17, v18
v_mfma_f32_16x16x32_bf16 v[12:15], v[48:51], v[32:35], 0
s_waitcnt lgkmcnt(2)
ds_read_b128 v[48:51], v2 offset:20480
v_mfma_f32_16x16x32_bf16 v[12:15], v[52:55], v[36:39], v[12:15]
s_waitcnt lgkmcnt(2)
ds_read_b128 v[52:55], v2 offset:21504
v_mfma_f32_16x16x32_bf16 v[12:15], v[40:43], v[24:27], v[12:15]
s_waitcnt lgkmcnt(2)
ds_read_b128 v[40:43], v2 offset:18432
buffer_store_dwordx2 v[56:57], v58, s[8:11], s31 offen offset:2048 sc1
v_mfma_f32_16x16x32_bf16 v[12:15], v[44:47], v[28:31], v[12:15]
ds_read_b128 v[44:47], v2 offset:19456
v_max3_f32 v59, v59, v19, v20
v_max_f32 v59, v59, v21
v_mov_b32 v60, s53
s_add_u32 s49, s28, s23
v_mov_b32 v61, s53
s_add_u32 s50, s28, 65536
v_mov_b32 v62, s53
ds_read_b128 v[32:35], v2 offset:22528
v_mov_b32 v63, s53
v_max3_f32 v59, v59, v12, v13
v_max3_f32 v22, v59, v14, v15
v_max3_f32 v59, v59, v14, v15
s_add_u32 s51, s28, 131072
s_add_u32 s52, s28, 196608
v_permlane32_swap_b32 v22, v59
v_max_f32 v23, v59, v22
v_max_f32 v59, v59, v22
v_mov_b32 v22, 0
ds_read_b128 v[36:39], v2 offset:23552
v_permlane16_swap_b32 v23, v59
v_max_f32 v59, v59, v23
v_mul_f32 v58, s18, v59
v_pk_fma_f32 v[20:21], v[20:21], s[18:19], v[58:59] op_sel_hi:[1,0,0] neg_lo:[0,0,1] neg_hi:[0,0,1]
v_pk_fma_f32 v[16:17], v[16:17], s[18:19], v[58:59] op_sel_hi:[1,0,0] neg_lo:[0,0,1] neg_hi:[0,0,1]
v_pk_fma_f32 v[18:19], v[18:19], s[18:19], v[58:59] op_sel_hi:[1,0,0] neg_lo:[0,0,1] neg_hi:[0,0,1]
v_pk_fma_f32 v[12:13], v[12:13], s[18:19], v[58:59] op_sel_hi:[1,0,0] neg_lo:[0,0,1] neg_hi:[0,0,1]
v_pk_fma_f32 v[14:15], v[14:15], s[18:19], v[58:59] op_sel_hi:[1,0,0] neg_lo:[0,0,1] neg_hi:[0,0,1]
v_exp_f32 v20, v20
v_exp_f32 v21, v21
v_exp_f32 v16, v16
v_cvt_pk_bf16_f32 v23, v20, v21
v_cvt_pk_bf16_f32 v20, v20, v21
v_mov_b32 v21, 0
v_exp_f32 v17, v17
v_exp_f32 v18, v18
v_mfma_f32_16x16x16_bf16 v[24:27], v[56:57], v[20:21], 0
v_exp_f32 v19, v19
v_mfma_f32_16x16x16_bf16 v[28:31], v[56:57], v[22:23], 0
v_exp_f32 v12, v12
v_exp_f32 v13, v13
v_cvt_pk_bf16_f32 v16, v16, v17
v_cvt_pk_bf16_f32 v17, v18, v19
v_exp_f32 v14, v14
v_exp_f32 v15, v15
v_cvt_pk_bf16_f32 v18, v12, v13
v_cvt_pk_bf16_f32 v19, v14, v15
v_mfma_f32_16x16x16_bf16 v[12:15], v[60:61], v[20:21], 0
s_waitcnt vmcnt(2)
v_mfma_f32_16x16x32_bf16 v[12:15], v[60:63], v[16:19], v[12:15]
v_mov_b32 v20, 0
v_mov_b32 v23, 0
v_mfma_f32_16x16x32_bf16 v[24:27], v[64:67], v[16:19], v[24:27]
s_nop 1
v_mfma_f32_16x16x32_bf16 v[28:31], v[68:71], v[16:19], v[28:31]
v_mov_b32 v16, 0
v_mov_b32 v17, 0
v_rcp_f32 v12, v12
v_mov_b32 v18, 0
v_mov_b32 v19, 0
v_pk_mul_f32 v[24:25], v[24:25], v[12:13] op_sel_hi:[1,0]
v_pk_mul_f32 v[26:27], v[26:27], v[12:13] op_sel_hi:[1,0]
v_mov_b32 v15, 0
v_pk_mul_f32 v[28:29], v[28:29], v[12:13] op_sel_hi:[1,0]
v_pk_mul_f32 v[30:31], v[30:31], v[12:13] op_sel_hi:[1,0]
v_cvt_pk_bf16_f32 v24, v24, v28
v_cvt_pk_bf16_f32 v25, v25, v29
v_cvt_pk_bf16_f32 v26, v26, v30
v_cvt_pk_bf16_f32 v27, v27, v31
v_mfma_f32_16x16x32_bf16 v[56:59], v[20:23], v[20:23], 0
ds_write_b128 v7, v[24:27]
v_mfma_f32_16x16x32_bf16 v[60:63], v[20:23], v[20:23], 0
v_mov_b32 v12, 0
v_mov_b32 v13, 0
v_mov_b32 v14, 0
v_mov_b32 v3, 6528
v_and_b32 v8, 0x380, v1
v_add_u32 v8, v8, v1
v_mfma_f32_16x16x32_bf16 v[64:67], v[20:23], v[20:23], 0
s_add_u32 s20, s30, 18432
s_mov_b32 m0, 19968
s_cmp_eq_u32 s19, 63
s_cbranch_scc1 L_texit
s_waitcnt lgkmcnt(0)
s_barrier
ds_read_b128 v[24:27], v1 offset:2176
v_mfma_f32_16x16x32_bf16 v[68:71], v[20:23], v[20:23], 0
ds_read_b128 v[28:31], v1 offset:3200
s_nop 2
v_mfma_f32_16x16x32_bf16 v[68:71], v[20:23], v[20:23], 0
s_waitcnt lgkmcnt(1)
v_smfmac_f32_16x16x64_bf16 v[12:15], v[24:27], a[248:255], v0
buffer_load_dwordx4 v8, s[8:11], s20 offen sc1 lds
v_smfmac_f32_16x16x64_bf16 v[16:19], v[24:27], a[176:183], v0
s_mov_b32 m0, 20864
s_waitcnt lgkmcnt(0)
v_smfmac_f32_16x16x64_bf16 v[12:15], v[28:31], v[40:47], v0
ds_read_b128 v[40:43], v2 offset:24576
v_smfmac_f32_16x16x64_bf16 v[16:19], v[28:31], v[48:55], v0
ds_read_b128 v[44:47], v2 offset:25600
buffer_load_dwordx4 v8, s[8:11], s20 offen offset:128 sc1 lds
v_smfmac_f32_16x16x64_bf16 v[20:23], v[24:27], a[184:191], v0
ds_read_b128 v[48:51], v2 offset:26624
s_nop 1
v_add_f32 v12, v12, v13
v_add_f32 v14, v14, v15
v_cvt_pk_bf16_f32 v12, v12, v14
v_smfmac_f32_16x16x64_bf16 v[20:23], v[28:31], v[32:39], v0
ds_read_b128 v[52:55], v2 offset:27648
buffer_store_dword v12, v10, s[8:11], s28 offen
v_add_f32 v16, v16, v17
v_add_f32 v18, v18, v19
v_smfmac_f32_16x16x64_bf16 v[56:59], v[24:27], a[192:199], v0
s_waitcnt lgkmcnt(2)
ds_read_b128 v[32:35], v2 offset:28672
v_cvt_pk_bf16_f32 v16, v16, v18
v_smfmac_f32_16x16x64_bf16 v[56:59], v[28:31], v[40:47], v0
ds_read_b128 v[36:39], v2 offset:29696
v_add_f32 v20, v20, v21
v_add_f32 v22, v22, v23
v_cvt_pk_bf16_f32 v17, v20, v22
v_smfmac_f32_16x16x64_bf16 v[60:63], v[24:27], a[200:207], v0
s_waitcnt lgkmcnt(2)
ds_read_b128 v[12:15], v3
buffer_store_dwordx2 v[16:17], v9, s[8:11], s28 offen
v_smfmac_f32_16x16x64_bf16 v[60:63], v[28:31], v[48:55], v0
ds_read_b128 v[40:43], v2 offset:30720
v_add_f32 v56, v56, v57
v_add_f32 v58, v58, v59
v_cvt_pk_bf16_f32 v56, v56, v58
v_smfmac_f32_16x16x64_bf16 v[64:67], v[24:27], a[208:215], v0
s_waitcnt lgkmcnt(2)
ds_read_b128 v[44:47], v2 offset:31744
v_smfmac_f32_16x16x64_bf16 v[64:67], v[28:31], v[32:39], v0
ds_read_b128 v[20:23], v3
v_add_f32 v60, v60, v61
v_add_f32 v62, v62, v63
v_cvt_pk_bf16_f32 v57, v60, v62
v_smfmac_f32_16x16x64_bf16 v[68:71], v[24:27], a[216:223], v0
s_waitcnt lgkmcnt(1)
ds_read_b128 v[48:51], v2 offset:32768
buffer_store_dwordx2 v[56:57], v9, s[8:11], s50 offen
v_smfmac_f32_16x16x64_bf16 v[68:71], v[28:31], v[40:47], v0
ds_read_b128 v[52:55], v2 offset:33792
v_add_f32 v64, v64, v65
v_add_f32 v66, v66, v67
v_cvt_pk_bf16_f32 v64, v64, v66
v_smfmac_f32_16x16x64_bf16 v[12:15], v[24:27], a[224:231], v0
s_waitcnt lgkmcnt(0)
v_smfmac_f32_16x16x64_bf16 v[12:15], v[28:31], v[48:55], v0
s_nop 0
v_add_f32 v68, v68, v69
v_add_f32 v70, v70, v71
v_cvt_pk_bf16_f32 v65, v68, v70
v_smfmac_f32_16x16x64_bf16 v[20:23], v[24:27], a[232:239], v0
buffer_store_dwordx2 v[64:65], v9, s[8:11], s51 offen
v_smfmac_f32_16x16x64_bf16 v[20:23], v[28:31], a[240:247], v0
s_nop 0
v_add_f32 v12, v12, v13
v_add_f32 v14, v14, v15
v_cvt_pk_bf16_f32 v12, v12, v14
s_nop 3
v_add_f32 v20, v20, v21
v_add_f32 v22, v22, v23
v_cvt_pk_bf16_f32 v13, v20, v22
buffer_store_dwordx2 v[12:13], v9, s[8:11], s52 offen
s_cmp_eq_u32 s48, 0
s_cbranch_scc1 L_nojob2
L_lt2:
buffer_load_dwordx4 v[32:35], v1, s[8:11], s49 offen sc1
buffer_load_dwordx4 v[36:39], v1, s[8:11], s49 offen offset:1024 sc1
buffer_load_dwordx4 v[40:43], v1, s[8:11], s49 offen offset:2048 sc1
buffer_load_dwordx4 v[44:47], v1, s[8:11], s49 offen offset:3072 sc1
s_add_u32 s19, s19, 1
s_mov_b32 s20, s28
s_mov_b32 s28, s29
s_mov_b32 s29, s20
s_and_b32 s20, s19, 3
s_lshl_b32 s20, s20, 14
s_add_u32 s33, s20, 110100480
s_add_u32 s34, s20, s24
s_xor_b32 s20, s20, 32768
s_add_u32 s35, s20, s24
s_add_u32 s30, s30, 16384
s_add_u32 s31, s31, 131072
s_add_u32 s6, s33, 4096
s_add_u32 s7, s33, 8192
s_mov_b32 s22, 0
v_mov_b64 v[24:25], 0
v_mov_b64 v[26:27], 0
v_mov_b64 v[28:29], 0
v_mov_b64 v[30:31], 0
v_and_b32 v70, 0xf40, v1
v_add_u32 v70, v70, v1
v_bfe_u32 v71, v1, 7, 1
v_mad_i32_i24 v70, v71, s4, v70
v_mov_b64 v[64:65], -1
v_mov_b64 v[66:67], -1
v_xor_b32 v3, 16, v4
ds_read_b128 v[48:51], v2 offset:12288
ds_read_b128 v[52:55], v2 offset:13312
v_lshrrev_b32 v8, 2, v1
v_mov_b32 v56, 0x3f80
v_cndmask_b32 v56, v56, 1.0, s[44:45]
v_cndmask_b32 v60, 0, v56, s[36:37]
v_cndmask_b32 v61, 0, v56, s[38:39]
v_cndmask_b32 v62, 0, v56, s[40:41]
v_cndmask_b32 v63, 0, v56, s[42:43]
s_waitcnt vmcnt(3)
s_nop 0
v_mfma_f32_16x16x32_bf16 v[56:59], v[32:35], v[60:63], 0
v_max3_u32 v16, v32, v33, v34
v_max_u32 v16, v16, v35
s_waitcnt vmcnt(2)
v_mfma_f32_16x16x32_bf16 v[56:59], v[36:39], v[60:63], v[56:59]
v_max3_u32 v16, v16, v36, v37
v_max3_u32 v16, v16, v38, v39
s_waitcnt vmcnt(1)
v_mfma_f32_16x16x32_bf16 v[56:59], v[40:43], v[60:63], v[56:59]
v_max3_u32 v16, v16, v40, v41
v_max3_u32 v16, v16, v42, v43
s_waitcnt vmcnt(0)
v_mfma_f32_16x16x32_bf16 v[56:59], v[44:47], v[60:63], v[56:59]
v_max3_u32 v16, v16, v44, v45
v_max3_u32 v16, v16, v46, v47
v_cmp_le_u32 vcc, 0xffff0000, v16
s_cbranch_vccnz L_red2
L_redb2:
s_nop 3
v_permlane32_swap_b32 v56, v58
v_permlane32_swap_b32 v57, v59
v_pk_add_f32 v[56:57], v[56:57], v[58:59]
v_cvt_pk_bf16_f32 v56, v56, v57
buffer_store_dword v56, v11, s[8:11], s34 offen
s_add_u32 s20, s30, 2048
s_add_u32 s21, s30, 8192
s_add_u32 s49, s29, s25
s_add_u32 s50, s29, s26
s_add_u32 s51, s29, s27
s_add_u32 s52, s30, 16384
s_mov_b32 m0, 19968
s_nop 1
s_barrier
s_branch L_gat2
L_red2:
L_red2b:
buffer_load_dwordx4 v[32:35], v1, s[8:11], s49 offen sc1
buffer_load_dwordx4 v[36:39], v1, s[8:11], s49 offen offset:1024 sc1
buffer_load_dwordx4 v[40:43], v1, s[8:11], s49 offen offset:2048 sc1
buffer_load_dwordx4 v[44:47], v1, s[8:11], s49 offen offset:3072 sc1
s_add_u32 s22, s22, 1
s_cmp_gt_u32 s22, 40000
s_cbranch_scc1 L_end
s_waitcnt vmcnt(3)
v_mfma_f32_16x16x32_bf16 v[56:59], v[32:35], v[60:63], 0
v_max3_u32 v16, v32, v33, v34
v_max_u32 v16, v16, v35
s_waitcnt vmcnt(2)
v_mfma_f32_16x16x32_bf16 v[56:59], v[36:39], v[60:63], v[56:59]
v_max3_u32 v16, v16, v36, v37
v_max3_u32 v16, v16, v38, v39
s_waitcnt vmcnt(1)
v_mfma_f32_16x16x32_bf16 v[56:59], v[40:43], v[60:63], v[56:59]
v_max3_u32 v16, v16, v40, v41
v_max3_u32 v16, v16, v42, v43
s_waitcnt vmcnt(0)
v_mfma_f32_16x16x32_bf16 v[56:59], v[44:47], v[60:63], v[56:59]
v_max3_u32 v16, v16, v44, v45
v_max3_u32 v16, v16, v46, v47
v_cmp_le_u32 vcc, 0xffff0000, v16
s_cbranch_vccz L_redb2
s_branch L_red2b
L_g3r2:
buffer_load_dwordx4 v[16:19], v1, s[8:11], s6 offen sc1
s_add_u32 s22, s22, 1
s_waitcnt vmcnt(1)
v_max3_u32 v21, v16, v17, v18
v_max_u32 v21, v21, v19
v_cmp_le_u32 vcc, 0xffff0000, v21
s_cmp_gt_u32 s22, 40000
s_cbranch_vccz L_g32
s_cbranch_scc0 L_g3r2
s_branch L_end
L_nojob2:
s_add_u32 s19, s19, 1
s_mov_b32 s20, s28
s_mov_b32 s28, s29
s_mov_b32 s29, s20
s_and_b32 s20, s19, 3
s_lshl_b32 s20, s20, 14
s_add_u32 s33, s20, 110100480
s_add_u32 s34, s20, s24
s_xor_b32 s20, s20, 32768
s_add_u32 s35, s20, s24
s_add_u32 s30, s30, 16384
s_add_u32 s31, s31, 131072
s_add_u32 s6, s33, 4096
s_add_u32 s7, s33, 8192
s_mov_b32 s22, 0
v_mov_b64 v[24:25], 0
v_mov_b64 v[26:27], 0
v_mov_b64 v[28:29], 0
v_mov_b64 v[30:31], 0
v_and_b32 v70, 0xf40, v1
v_add_u32 v70, v70, v1
v_bfe_u32 v71, v1, 7, 1
v_mad_i32_i24 v70, v71, s4, v70
v_mov_b64 v[64:65], -1
v_mov_b64 v[66:67], -1
v_xor_b32 v3, 16, v4
ds_read_b128 v[48:51], v2 offset:12288
ds_read_b128 v[52:55], v2 offset:13312
v_lshrrev_b32 v8, 2, v1
s_barrier
s_branch L_gat2
L_ent3:
s_movk_i32 s4, -64
v_mov_b64 v[24:25], 0
v_mov_b64 v[26:27], 0
v_mov_b64 v[28:29], 0
v_mov_b64 v[30:31], 0
v_and_b32 v69, 0x380, v1
v_add_u32 v69, v69, v1
v_and_b32 v70, 0xf40, v1
v_add_u32 v70, v70, v1
v_bfe_u32 v71, v1, 7, 1
v_mad_i32_i24 v70, v71, s4, v70
v_mov_b64 v[64:65], -1
v_mov_b64 v[66:67], -1
v_xor_b32 v3, 16, v4
ds_read_b128 v[48:51], v2 offset:14336
ds_read_b128 v[52:55], v2 offset:15360
ds_read_b128 v[40:43], v2 offset:6144
ds_read_b128 v[44:47], v2 offset:7168
v_mov_b64 v[32:33], 0
v_mov_b64 v[34:35], 0
v_mov_b64 v[36:37], 0
v_mov_b64 v[38:39], 0
v_mov_b64 v[56:57], 0
v_mov_b64 v[58:59], 0
v_mov_b64 v[60:61], 0
v_mov_b64 v[62:63], 0
s_add_u32 s20, s30, 3072
s_add_u32 s21, s30, 8192
s_add_u32 s49, s29, s25
s_add_u32 s50, s29, s26
s_add_u32 s51, s29, s27
s_add_u32 s52, s30, 16384
s_mov_b32 m0, 22016
s_nop 0
buffer_load_dwordx4 v69, s[8:11], s20 offen sc1 lds
s_mov_b32 m0, 22912
s_nop 0
buffer_load_dwordx4 v69, s[8:11], s20 offen offset:128 sc1 lds
s_waitcnt vmcnt(0) lgkmcnt(0)
s_branch L_step3
L_gr3:
buffer_load_dwordx4 v[12:15], v1, s[8:11], s33 offen sc1
buffer_load_dword v20, v8, s[8:11], s7 offen sc1
buffer_load_dwordx4 v[16:19], v1, s[8:11], s6 offen sc1
s_add_u32 s22, s22, 1
s_cmp_gt_u32 s22, 40000
s_cbranch_scc1 L_end
buffer_load_dwordx4 v[16:19], v1, s[8:11], s6 offen sc1
v_mov_b64 v[24:25], 0
v_mov_b64 v[26:27], 0
v_mov_b64 v[28:29], 0
v_mov_b64 v[30:31], 0
v_mov_b64 v[32:33], 0
v_mov_b64 v[34:35], 0
v_mov_b64 v[36:37], 0
v_mov_b64 v[38:39], 0
v_mov_b64 v[56:57], 0
v_mov_b64 v[58:59], 0
v_mov_b64 v[60:61], 0
v_mov_b64 v[62:63], 0
s_waitcnt lgkmcnt(0)
s_branch L_step3
.p2align 3
L_gat3:
buffer_load_dwordx4 v[12:15], v1, s[8:11], s33 offen sc1
buffer_load_dword v20, v8, s[8:11], s7 offen sc1
buffer_load_dwordx4 v[16:19], v1, s[8:11], s6 offen sc1
s_add_u32 s20, s30, 3072
s_add_u32 s21, s30, 8192
s_add_u32 s49, s29, s25
s_add_u32 s50, s29, s26
s_add_u32 s51, s29, s27
s_add_u32 s52, s30, 16384
s_mov_b32 m0, 22016
ds_read_b128 v[40:43], v2 offset:6144
ds_read_b128 v[44:47], v2 offset:7168
v_mov_b64 v[32:33], 0
v_mov_b64 v[34:35], 0
v_mov_b64 v[36:37], 0
v_mov_b64 v[38:39], 0
v_mov_b64 v[56:57], 0
v_mov_b64 v[58:59], 0
v_mov_b64 v[60:61], 0
v_mov_b64 v[62:63], 0
s_nop 6
buffer_load_dwordx4 v[16:19], v1, s[8:11], s6 offen sc1
s_waitcnt lgkmcnt(0)
L_step3:
s_waitcnt vmcnt(3)
v_smfmac_f32_16x16x64_bf16 v[24:27], v[12:15], v[144:151], v0
ds_write_b128 v1, v[12:15] offset:6656
v_smfmac_f32_16x16x64_bf16 v[28:31], v[12:15], v[152:159], v0
s_waitcnt vmcnt(2)
v_max3_u32 v21, v12, v13, v14
v_max3_u32 v21, v21, v15, v20
v_cmp_le_u32 vcc, 0xffff0000, v21
v_smfmac_f32_16x16x64_bf16 v[32:35], v[12:15], v[160:167], v0
s_cbranch_vccnz L_gr3
s_waitcnt vmcnt(1)
v_max3_u32 v21, v16, v17, v18
v_max_u32 v21, v21, v19
v_cmp_le_u32 vcc, 0xffff0000, v21
ds_write_b32 v8, v20 offset:14848
v_smfmac_f32_16x16x64_bf16 v[56:59], v[12:15], a[80:87], v0
s_cbranch_vccnz L_g3r3
L_g33:
ds_write_b128 v1, v[16:19] offset:10752
v_smfmac_f32_16x16x64_bf16 v[60:63], v[12:15], a[88:95], v0
v_smfmac_f32_16x16x64_bf16 v[36:39], v[12:15], v[40:47], v0
v_smfmac_f32_16x16x64_bf16 v[24:27], v[16:19], v[240:247], v0
v_smfmac_f32_16x16x64_bf16 v[28:31], v[16:19], v[248:255], v0
s_waitcnt lgkmcnt(0)
s_barrier
ds_read_b128 v[20:23], v1 offset:3584
v_smfmac_f32_16x16x64_bf16 v[32:35], v[16:19], a[0:7], v0
ds_read_b128 v[12:15], v1 offset:4608
s_mov_b32 m0, 6272
v_smfmac_f32_16x16x64_bf16 v[56:59], v[16:19], a[144:151], v0
ds_read_b128 v[40:43], v2
v_smfmac_f32_16x16x64_bf16 v[60:63], v[16:19], a[152:159], v0
ds_read_b128 v[44:47], v2 offset:1024
buffer_store_dwordx4 v[64:67], v1, s[8:11], s49 offen
v_smfmac_f32_16x16x64_bf16 v[36:39], v[16:19], v[48:55], v0
s_waitcnt vmcnt(1)
ds_read_b128 v[16:19], v1 offset:5632
s_waitcnt lgkmcnt(4)
v_smfmac_f32_16x16x64_bf16 v[24:27], v[20:23], v[72:79], v0
ds_read_b128 v[48:51], v2 offset:2048
buffer_store_dwordx4 v[64:67], v1, s[8:11], s50 offen
v_smfmac_f32_16x16x64_bf16 v[28:31], v[20:23], v[80:87], v0
ds_read_b128 v[52:55], v2 offset:3072
v_smfmac_f32_16x16x64_bf16 v[32:35], v[20:23], v[88:95], v0
s_waitcnt lgkmcnt(3)
buffer_store_dwordx4 v[64:67], v1, s[8:11], s51 offen
v_smfmac_f32_16x16x64_bf16 v[36:39], v[20:23], v[40:47], v0
ds_read_b128 v[20:23], v1 offset:7680
buffer_load_dwordx4 v[64:67], v70, s[8:11], s21 offen sc1
v_smfmac_f32_16x16x64_bf16 v[24:27], v[12:15], v[96:103], v0
ds_read_b128 v[40:43], v2 offset:4096
v_smfmac_f32_16x16x64_bf16 v[28:31], v[12:15], v[104:111], v0
ds_read_b128 v[44:47], v2 offset:5120
buffer_load_dwordx4 v[68:71], v70, s[8:11], s21 offen offset:256 sc1
v_smfmac_f32_16x16x64_bf16 v[32:35], v[12:15], v[112:119], v0
s_waitcnt lgkmcnt(3)
v_smfmac_f32_16x16x64_bf16 v[36:39], v[12:15], v[48:55], v0
ds_read_b128 v[12:15], v1 offset:8704
v_smfmac_f32_16x16x64_bf16 v[24:27], v[16:19], v[120:127], v0
ds_read_b128 v[48:51], v2 offset:8192
v_mov_b32 v11, s19
v_smfmac_f32_16x16x64_bf16 v[28:31], v[16:19], v[128:135], v0
ds_read_b128 v[52:55], v2 offset:9216
v_smfmac_f32_16x16x64_bf16 v[32:35], v[16:19], v[136:143], v0
s_mov_b64 exec, 1
buffer_store_dword v11, v8, s[8:11], s83 offen sc1
s_mov_b64 exec, -1
s_waitcnt lgkmcnt(3)
v_smfmac_f32_16x16x64_bf16 v[36:39], v[16:19], v[40:47], v0
ds_read_b128 v[16:19], v1 offset:9728
buffer_load_dword v11, v8, s[8:11], s82 offen sc1
v_smfmac_f32_16x16x64_bf16 v[24:27], v[20:23], v[168:175], v0
ds_read_b128 v[40:43], v2 offset:10240
v_smfmac_f32_16x16x64_bf16 v[28:31], v[20:23], v[176:183], v0
ds_read_b128 v[44:47], v2 offset:11264
v_smfmac_f32_16x16x64_bf16 v[32:35], v[20:23], v[184:191], v0
s_waitcnt lgkmcnt(3)
v_smfmac_f32_16x16x64_bf16 v[36:39], v[20:23], v[48:55], v0
ds_read_b128 v[20:23], v1 offset:11776
v_smfmac_f32_16x16x64_bf16 v[24:27], v[12:15], v[192:199], v0
ds_read_b128 v[48:51], v2 offset:12288
v_smfmac_f32_16x16x64_bf16 v[28:31], v[12:15], v[200:207], v0
ds_read_b128 v[52:55], v2 offset:13312
v_smfmac_f32_16x16x64_bf16 v[32:35], v[12:15], v[208:215], v0
s_waitcnt lgkmcnt(3)
v_smfmac_f32_16x16x64_bf16 v[36:39], v[12:15], v[40:47], v0
ds_read_b128 v[12:15], v1 offset:3584
v_smfmac_f32_16x16x64_bf16 v[24:27], v[16:19], v[216:223], v0
ds_read_b128 v[40:43], v2 offset:16384
v_smfmac_f32_16x16x64_bf16 v[28:31], v[16:19], v[224:231], v0
s_waitcnt lgkmcnt(4)
ds_read_b128 v[44:47], v2 offset:17408
v_smfmac_f32_16x16x64_bf16 v[24:27], v[20:23], a[8:15], v0
v_smfmac_f32_16x16x64_bf16 v[28:31], v[20:23], a[16:23], v0
v_smfmac_f32_16x16x64_bf16 v[32:35], v[16:19], v[232:239], v0
s_waitcnt lgkmcnt(3)
v_smfmac_f32_16x16x64_bf16 v[36:39], v[16:19], v[48:55], v0
ds_read_b128 v[16:19], v1 offset:4608
s_nop 2
v_add_f32 v24, v24, v25
v_smfmac_f32_16x16x64_bf16 v[32:35], v[20:23], a[24:31], v0
s_waitcnt lgkmcnt(1)
ds_read_b128 v[52:55], v1 offset:18944
v_add_f32 v26, v26, v27
v_smfmac_f32_16x16x64_bf16 v[36:39], v[20:23], v[40:47], v0
ds_read_b128 v[48:51], v1 offset:16896
v_add_f32 v28, v28, v29
v_smfmac_f32_16x16x64_bf16 v[56:59], v[12:15], a[32:39], v0
ds_read_b128 v[20:23], v1 offset:5632
v_add_f32 v30, v30, v31
v_cvt_pk_bf16_f32 v24, v24, v28
ds_write_b32 v4, v24 offset:2176
v_smfmac_f32_16x16x64_bf16 v[60:63], v[12:15], a[40:47], v0
s_waitcnt lgkmcnt(4)
ds_read_b128 v[12:15], v1 offset:7680
v_cvt_pk_bf16_f32 v26, v26, v30
ds_write_b32 v3, v26 offset:2176
v_add_f32 v32, v32, v33
v_smfmac_f32_16x16x64_bf16 v[56:59], v[16:19], a[48:55], v0
ds_read_b128 v[40:43], v1 offset:12800
v_add_f32 v34, v34, v35
v_add_f32 v36, v36, v37
v_add_f32 v38, v38, v39
v_smfmac_f32_16x16x64_bf16 v[60:63], v[16:19], a[56:63], v0
s_waitcnt lgkmcnt(4)
ds_read_b128 v[16:19], v1 offset:8704
v_cvt_pk_bf16_f32 v32, v32, v36
ds_write_b32 v4, v32
v_cvt_pk_bf16_f32 v34, v34, v38
v_smfmac_f32_16x16x64_bf16 v[56:59], v[20:23], a[64:71], v0
ds_read_b128 v[44:47], v1 offset:14848
ds_write_b32 v3, v34
v_smfmac_f32_16x16x64_bf16 v[60:63], v[20:23], a[72:79], v0
s_waitcnt lgkmcnt(6)
ds_read_b128 v[20:23], v1 offset:9728
v_smfmac_f32_16x16x64_bf16 v[56:59], v[12:15], a[96:103], v0
v_smfmac_f32_16x16x64_bf16 v[60:63], v[12:15], a[104:111], v0
s_waitcnt lgkmcnt(4)
ds_read_b128 v[12:15], v1 offset:11776
v_smfmac_f32_16x16x64_bf16 v[56:59], v[16:19], a[112:119], v0
v_smfmac_f32_16x16x64_bf16 v[60:63], v[16:19], a[120:127], v0
s_waitcnt lgkmcnt(1)
v_smfmac_f32_16x16x64_bf16 v[56:59], v[20:23], a[128:135], v0
s_barrier
ds_read_b128 v[36:39], v5 offset:1536
v_smfmac_f32_16x16x64_bf16 v[60:63], v[20:23], a[136:143], v0
s_waitcnt lgkmcnt(1)
ds_read_b128 v[24:27], v5
v_smfmac_f32_16x16x64_bf16 v[56:59], v[12:15], a[160:167], v0
ds_read_b128 v[28:31], v5 offset:512
v_smfmac_f32_16x16x64_bf16 v[60:63], v[12:15], a[168:175], v0
s_waitcnt lgkmcnt(2)
ds_read_b128 v[32:35], v5 offset:1024
v_mfma_f32_16x16x32_bf16 v[16:19], v[52:55], v[36:39], 0
s_waitcnt lgkmcnt(2)
ds_read_b128 v[52:55], v1 offset:19968
v_mfma_f32_16x16x32_bf16 v[16:19], v[40:43], v[24:27], v[16:19]
s_waitcnt lgkmcnt(2)
ds_read_b128 v[40:43], v1 offset:13824
v_mfma_f32_16x16x32_bf16 v[16:19], v[44:47], v[28:31], v[16:19]
s_waitcnt lgkmcnt(2)
ds_read_b128 v[44:47], v1 offset:15872
v_mfma_f32_16x16x32_bf16 v[16:19], v[48:51], v[32:35], v[16:19]
ds_read_b128 v[48:51], v1 offset:17920
s_mov_b64 exec, s[86:87]
buffer_store_dwordx4 v[36:39], v5, s[8:11], s31 offen offset:1536 sc1
s_mov_b64 exec, -1
v_mfma_f32_16x16x32_bf16 v[20:23], v[36:39], v[36:39], 0
v_add_f32 v56, v56, v57
v_add_f32 v58, v58, v59
v_mfma_f32_16x16x32_bf16 v[20:23], v[24:27], v[24:27], v[20:23]
v_add_f32 v60, v60, v61
v_add_f32 v62, v62, v63
v_mfma_f32_16x16x32_bf16 v[20:23], v[28:31], v[28:31], v[20:23]
v_cvt_pk_bf16_f32 v56, v56, v58
v_cvt_pk_bf16_f32 v57, v60, v62
v_mfma_f32_16x16x32_bf16 v[20:23], v[32:35], v[32:35], v[20:23]
s_waitcnt lgkmcnt(3)
v_lshrrev_b32 v58, 1, v1
v_max3_f32 v59, v16, v17, v18
v_mfma_f32_16x16x32_bf16 v[12:15], v[52:55], v[36:39], 0
s_waitcnt lgkmcnt(2)
ds_read_b128 v[52:55], v2 offset:21504
v_mfma_f32_16x16x32_bf16 v[12:15], v[40:43], v[24:27], v[12:15]
s_waitcnt lgkmcnt(2)
ds_read_b128 v[40:43], v2 offset:18432
v_mfma_f32_16x16x32_bf16 v[12:15], v[44:47], v[28:31], v[12:15]
s_waitcnt lgkmcnt(2)
ds_read_b128 v[44:47], v2 offset:19456
v_max3_f32 v59, v59, v19, v20
v_max_f32 v59, v59, v21
v_mfma_f32_16x16x32_bf16 v[12:15], v[48:51], v[32:35], v[12:15]
ds_read_b128 v[48:51], v2 offset:20480
buffer_store_dwordx2 v[56:57], v58, s[8:11], s31 offen offset:2048 sc1
v_mov_b32 v60, s53
s_add_u32 s49, s28, s23
v_mov_b32 v61, s53
s_add_u32 s50, s28, 65536
v_mov_b32 v62, s53
ds_read_b128 v[32:35], v2 offset:22528
v_mov_b32 v63, s53
v_max3_f32 v59, v59, v12, v13
v_max3_f32 v22, v59, v14, v15
v_max3_f32 v59, v59, v14, v15
s_add_u32 s51, s28, 131072
s_add_u32 s52, s28, 196608
v_permlane32_swap_b32 v22, v59
v_max_f32 v23, v59, v22
v_max_f32 v59, v59, v22
v_mov_b32 v22, 0
ds_read_b128 v[36:39], v2 offset:23552
v_permlane16_swap_b32 v23, v59
v_max_f32 v59, v59, v23
v_mul_f32 v58, s18, v59
v_pk_fma_f32 v[20:21], v[20:21], s[18:19], v[58:59] op_sel_hi:[1,0,0] neg_lo:[0,0,1] neg_hi:[0,0,1]
v_pk_fma_f32 v[16:17], v[16:17], s[18:19], v[58:59] op_sel_hi:[1,0,0] neg_lo:[0,0,1] neg_hi:[0,0,1]
v_pk_fma_f32 v[18:19], v[18:19], s[18:19], v[58:59] op_sel_hi:[1,0,0] neg_lo:[0,0,1] neg_hi:[0,0,1]
v_pk_fma_f32 v[12:13], v[12:13], s[18:19], v[58:59] op_sel_hi:[1,0,0] neg_lo:[0,0,1] neg_hi:[0,0,1]
v_pk_fma_f32 v[14:15], v[14:15], s[18:19], v[58:59] op_sel_hi:[1,0,0] neg_lo:[0,0,1] neg_hi:[0,0,1]
v_exp_f32 v20, v20
v_exp_f32 v21, v21
v_exp_f32 v16, v16
v_cvt_pk_bf16_f32 v23, v20, v21
v_cvt_pk_bf16_f32 v20, v20, v21
v_mov_b32 v21, 0
v_exp_f32 v17, v17
v_exp_f32 v18, v18
v_mfma_f32_16x16x16_bf16 v[24:27], v[56:57], v[20:21], 0
v_exp_f32 v19, v19
v_mfma_f32_16x16x16_bf16 v[28:31], v[56:57], v[22:23], 0
v_exp_f32 v12, v12
v_exp_f32 v13, v13
v_cvt_pk_bf16_f32 v16, v16, v17
v_cvt_pk_bf16_f32 v17, v18, v19
v_exp_f32 v14, v14
v_exp_f32 v15, v15
v_cvt_pk_bf16_f32 v18, v12, v13
v_cvt_pk_bf16_f32 v19, v14, v15
v_mfma_f32_16x16x16_bf16 v[12:15], v[60:61], v[20:21], 0
s_waitcnt vmcnt(4)
v_mfma_f32_16x16x32_bf16 v[12:15], v[60:63], v[16:19], v[12:15]
v_mov_b32 v20, 0
v_mov_b32 v23, 0
v_mfma_f32_16x16x32_bf16 v[24:27], v[64:67], v[16:19], v[24:27]
s_nop 1
v_mfma_f32_16x16x32_bf16 v[28:31], v[68:71], v[16:19], v[28:31]
v_mov_b32 v16, 0
v_mov_b32 v17, 0
v_rcp_f32 v12, v12
v_mov_b32 v18, 0
v_mov_b32 v19, 0
v_pk_mul_f32 v[24:25], v[24:25], v[12:13] op_sel_hi:[1,0]
v_pk_mul_f32 v[26:27], v[26:27], v[12:13] op_sel_hi:[1,0]
v_mov_b32 v15, 0
v_pk_mul_f32 v[28:29], v[28:29], v[12:13] op_sel_hi:[1,0]
v_pk_mul_f32 v[30:31], v[30:31], v[12:13] op_sel_hi:[1,0]
v_cvt_pk_bf16_f32 v24, v24, v28
v_cvt_pk_bf16_f32 v25, v25, v29
v_cvt_pk_bf16_f32 v26, v26, v30
v_cvt_pk_bf16_f32 v27, v27, v31
v_mfma_f32_16x16x32_bf16 v[56:59], v[20:23], v[20:23], 0
ds_write_b128 v7, v[24:27]
v_mfma_f32_16x16x32_bf16 v[60:63], v[20:23], v[20:23], 0
v_mov_b32 v12, 0
v_mov_b32 v13, 0
v_mov_b32 v14, 0
v_mov_b32 v3, 6528
v_and_b32 v8, 0x380, v1
v_add_u32 v8, v8, v1
v_mfma_f32_16x16x32_bf16 v[64:67], v[20:23], v[20:23], 0
s_add_u32 s20, s30, 19456
s_mov_b32 m0, 22016
s_cmp_eq_u32 s19, 63
s_cbranch_scc1 L_texit
s_waitcnt lgkmcnt(0)
s_barrier
ds_read_b128 v[24:27], v1 offset:1152
v_mfma_f32_16x16x32_bf16 v[68:71], v[20:23], v[20:23], 0
ds_read_b128 v[28:31], v1 offset:2176
s_nop 2
v_mfma_f32_16x16x32_bf16 v[68:71], v[20:23], v[20:23], 0
s_waitcnt lgkmcnt(1)
v_smfmac_f32_16x16x64_bf16 v[12:15], v[24:27], a[248:255], v0
buffer_load_dwordx4 v8, s[8:11], s20 offen sc1 lds
v_smfmac_f32_16x16x64_bf16 v[16:19], v[24:27], a[176:183], v0
s_mov_b32 m0, 22912
s_waitcnt lgkmcnt(0)
v_smfmac_f32_16x16x64_bf16 v[12:15], v[28:31], v[40:47], v0
ds_read_b128 v[40:43], v2 offset:24576
v_smfmac_f32_16x16x64_bf16 v[16:19], v[28:31], v[48:55], v0
ds_read_b128 v[44:47], v2 offset:25600
buffer_load_dwordx4 v8, s[8:11], s20 offen offset:128 sc1 lds
v_smfmac_f32_16x16x64_bf16 v[20:23], v[24:27], a[184:191], v0
ds_read_b128 v[48:51], v2 offset:26624
s_nop 1
v_add_f32 v12, v12, v13
v_add_f32 v14, v14, v15
v_cvt_pk_bf16_f32 v12, v12, v14
v_smfmac_f32_16x16x64_bf16 v[20:23], v[28:31], v[32:39], v0
ds_read_b128 v[52:55], v2 offset:27648
buffer_store_dword v12, v10, s[8:11], s28 offen
v_add_f32 v16, v16, v17
v_add_f32 v18, v18, v19
v_smfmac_f32_16x16x64_bf16 v[56:59], v[24:27], a[192:199], v0
s_waitcnt lgkmcnt(2)
ds_read_b128 v[32:35], v2 offset:28672
v_cvt_pk_bf16_f32 v16, v16, v18
v_smfmac_f32_16x16x64_bf16 v[56:59], v[28:31], v[40:47], v0
ds_read_b128 v[36:39], v2 offset:29696
v_add_f32 v20, v20, v21
v_add_f32 v22, v22, v23
v_cvt_pk_bf16_f32 v17, v20, v22
v_smfmac_f32_16x16x64_bf16 v[60:63], v[24:27], a[200:207], v0
s_waitcnt lgkmcnt(2)
ds_read_b128 v[12:15], v3
buffer_store_dwordx2 v[16:17], v9, s[8:11], s28 offen
v_smfmac_f32_16x16x64_bf16 v[60:63], v[28:31], v[48:55], v0
ds_read_b128 v[40:43], v2 offset:30720
v_add_f32 v56, v56, v57
v_add_f32 v58, v58, v59
v_cvt_pk_bf16_f32 v56, v56, v58
v_smfmac_f32_16x16x64_bf16 v[64:67], v[24:27], a[208:215], v0
s_waitcnt lgkmcnt(2)
ds_read_b128 v[44:47], v2 offset:31744
v_smfmac_f32_16x16x64_bf16 v[64:67], v[28:31], v[32:39], v0
ds_read_b128 v[20:23], v3
v_add_f32 v60, v60, v61
v_add_f32 v62, v62, v63
v_cvt_pk_bf16_f32 v57, v60, v62
v_smfmac_f32_16x16x64_bf16 v[68:71], v[24:27], a[216:223], v0
s_waitcnt lgkmcnt(1)
ds_read_b128 v[48:51], v2 offset:32768
buffer_store_dwordx2 v[56:57], v9, s[8:11], s50 offen
v_smfmac_f32_16x16x64_bf16 v[68:71], v[28:31], v[40:47], v0
ds_read_b128 v[52:55], v2 offset:33792
v_add_f32 v64, v64, v65
v_add_f32 v66, v66, v67
v_cvt_pk_bf16_f32 v64, v64, v66
v_smfmac_f32_16x16x64_bf16 v[12:15], v[24:27], a[224:231], v0
s_waitcnt lgkmcnt(0)
v_smfmac_f32_16x16x64_bf16 v[12:15], v[28:31], v[48:55], v0
s_nop 0
v_add_f32 v68, v68, v69
v_add_f32 v70, v70, v71
v_cvt_pk_bf16_f32 v65, v68, v70
v_smfmac_f32_16x16x64_bf16 v[20:23], v[24:27], a[232:239], v0
buffer_store_dwordx2 v[64:65], v9, s[8:11], s51 offen
v_smfmac_f32_16x16x64_bf16 v[20:23], v[28:31], a[240:247], v0
s_nop 0
v_add_f32 v12, v12, v13
v_add_f32 v14, v14, v15
v_cvt_pk_bf16_f32 v12, v12, v14
s_nop 3
v_add_f32 v20, v20, v21
v_add_f32 v22, v22, v23
v_cvt_pk_bf16_f32 v13, v20, v22
buffer_store_dwordx2 v[12:13], v9, s[8:11], s52 offen
s_add_u32 s19, s19, 1
s_mov_b32 s20, s28
s_mov_b32 s28, s29
s_mov_b32 s29, s20
s_and_b32 s20, s19, 3
s_lshl_b32 s20, s20, 14
s_add_u32 s33, s20, 110100480
s_add_u32 s34, s20, s24
s_xor_b32 s20, s20, 32768
s_add_u32 s35, s20, s24
s_add_u32 s30, s30, 16384
s_add_u32 s31, s31, 131072
s_add_u32 s6, s33, 4096
s_add_u32 s7, s33, 8192
s_mov_b32 s22, 0
v_mov_b64 v[24:25], 0
v_mov_b64 v[26:27], 0
v_mov_b64 v[28:29], 0
v_mov_b64 v[30:31], 0
v_and_b32 v70, 0xf40, v1
v_add_u32 v70, v70, v1
v_bfe_u32 v71, v1, 7, 1
v_mad_i32_i24 v70, v71, s4, v70
v_mov_b64 v[64:65], -1
v_mov_b64 v[66:67], -1
v_xor_b32 v3, 16, v4
ds_read_b128 v[48:51], v2 offset:14336
ds_read_b128 v[52:55], v2 offset:15360
v_lshrrev_b32 v8, 2, v1
s_add_u32 s20, s19, 1
s_lshr_b32 s20, s20, 3
s_min_u32 s20, s20, 7
s_cmp_lt_u32 s19, 3
s_cselect_b32 s20, 8, s20
s_waitcnt vmcnt(9)
L_kvw:
v_readlane_b32 s21, v11, s20
s_nop 0
s_cmp_eq_u32 s21, 1
s_cbranch_scc0 L_kvp
s_barrier
s_branch L_gat3
L_g3r3:
buffer_load_dwordx4 v[16:19], v1, s[8:11], s6 offen sc1
s_add_u32 s22, s22, 1
s_waitcnt vmcnt(1)
v_max3_u32 v21, v16, v17, v18
v_max_u32 v21, v21, v19
v_cmp_le_u32 vcc, 0xffff0000, v21
s_cmp_gt_u32 s22, 40000
s_cbranch_vccz L_g33
s_cbranch_scc0 L_g3r3
s_branch L_end
L_kvp:
buffer_load_dword v11, v8, s[8:11], s82 offen sc1
s_add_u32 s22, s22, 1
s_cmp_gt_u32 s22, 40000
s_cbranch_scc1 L_end
s_waitcnt vmcnt(0)
s_branch L_kvw
L_texit:
s_lshl_b32 s61, s16, 7
s_add_u32 s61, s61, 111153152
s_waitcnt vmcnt(0)
s_barrier
s_cmp_lg_u32 s17, 0
s_cbranch_scc1 L_sf_54
v_mov_b32 v20, 0
v_mov_b32 v21, 64
s_mov_b64 exec, 1
buffer_store_dword v21, v20, s[8:11], s61 offen sc1
s_mov_b64 exec, -1
L_sf_54:
L_done:
L_end:
s_endpgm
.section .rodata,"a"
.p2align 6
.amdhsa_kernel concat_heads__compressed_kv_cla__memory_aug_recurrent_mem_tr__prompt_kernel
  .amdhsa_next_free_vgpr 512
  .amdhsa_next_free_sgpr 102
  .amdhsa_accum_offset 256
  .amdhsa_group_segment_fixed_size 0
  .amdhsa_kernarg_size 128
  .amdhsa_user_sgpr_count 2
  .amdhsa_user_sgpr_kernarg_segment_ptr 1
  .amdhsa_system_sgpr_workgroup_id_x 1
.end_amdhsa_kernel
```

```asm
; @launch grid=(256,1,1) block=(256,1,1) lds=163840
.amdgcn_target "amdgcn-amd-amdhsa--gfx950"
.text
.globl concat_heads__compressed_kv_cla__memory_aug_recurrent_mem_tr__prompt_kernel
.p2align 8
.type concat_heads__compressed_kv_cla__memory_aug_recurrent_mem_tr__prompt_kernel,@function
concat_heads__compressed_kv_cla__memory_aug_recurrent_mem_tr__prompt_kernel:
s_cmp_lt_u32 s2, 256
s_cbranch_scc1 L_go
L_end0:
s_endpgm
L_go:
s_getreg_b32 s3, hwreg(HW_REG_XCC_ID)
s_and_b32 s3, s3, 7
s_load_dwordx2 s[4:5], s[0:1], 120
s_load_dwordx2 s[6:7], s[0:1], 112
v_lshrrev_b32 v1, 6, v0
s_nop 0
v_readfirstlane_b32 s17, v1
s_waitcnt lgkmcnt(0)
s_mov_b32 s8, s4
s_and_b32 s9, s5, 0xffff
s_mov_b32 s10, 268435456
s_mov_b32 s11, 0x20000
s_mov_b32 s56, s6
s_and_b32 s57, s7, 0xffff
s_mov_b32 s58, 256
s_mov_b32 s59, 0x20000
s_getpc_b64 s[4:5]
L_pc:
s_mov_b32 s12, s4
s_and_b32 s13, s5, 0xffff
s_mov_b32 s14, L_end-L_pc
s_mov_b32 s15, 0x20000
s_lshr_b32 s25, s2, 3
s_lshl_b32 s25, s25, 7
v_lshlrev_b32 v3, 12, v0
buffer_load_dword v3, v3, s[12:15], s25 offen
s_lshl_b32 s24, s3, 2
s_cmp_eq_u32 s17, 0
s_cbranch_scc0 L_tk
s_mov_b64 exec, 1
v_mov_b32 v1, 1
v_mov_b32 v2, 0
buffer_atomic_add v1, v2, s[56:59], s24 offen sc0
s_waitcnt vmcnt(0)
ds_write_b32 v2, v1
s_waitcnt lgkmcnt(0)
s_mov_b64 exec, -1
L_tk:
s_waitcnt vmcnt(0)
s_barrier
v_mov_b32 v2, 0
ds_read_b32 v1, v2
s_lshr_b32 s3, 0x76530142, s24
s_and_b32 s3, s3, 7
s_waitcnt lgkmcnt(0)
v_readfirstlane_b32 s16, v1
s_barrier
s_cmp_ge_u32 s16, 32
s_cbranch_scc1 L_end0
s_cmp_eq_u32 s3, 0
s_cbranch_scc1 L_team
s_cmp_eq_u32 s3, 1
s_cbranch_scc0 L_np
s_cmp_lt_u32 s16, 24
s_cbranch_scc1 L_np
v_lshlrev_b32 v1, 4, v0
v_mov_b64 v[4:5], 0
v_mov_b64 v[6:7], 0
s_sub_u32 s24, s16, 24
s_lshl_b32 s24, s24, 12
s_add_u32 s24, s24, 111149056
buffer_store_dwordx4 v[4:7], v1, s[8:11], s24 offen sc1
s_waitcnt vmcnt(0)
s_barrier
s_cmp_lg_u32 s17, 0
s_cbranch_scc1 L_np
v_mov_b32 v1, 1
v_mov_b32 v2, 128
s_mov_b64 exec, 1
buffer_atomic_add v1, v2, s[56:59], 0 offen
s_mov_b64 exec, -1
L_np:
s_cmp_lt_u32 s3, 4
s_cselect_b32 s61, 1, 0
s_cbranch_scc1 L_pb
s_load_dwordx2 s[52:53], s[0:1], 8
s_load_dwordx2 s[54:55], s[0:1], 0
s_load_dwordx2 s[6:7], s[0:1], 24
s_load_dwordx2 s[4:5], s[0:1], 32
s_load_dwordx2 s[18:19], s[0:1], 16
s_mov_b32 s45, 3
s_sub_u32 s24, s3, 4
s_lshl_b32 s24, s24, 5
s_add_u32 s24, s24, s16
s_lshr_b32 s89, s24, 2
s_lshr_b32 s90, s24, 3
s_and_b32 s24, s16, 3
s_mul_i32 s88, s24, 0x11
s_and_b32 s24, s16, 7
s_lshl_b32 s24, s24, 8
s_add_u32 s88, s88, s24
s_add_u32 s88, s88, 0x840
s_branch L_pg
L_pb:
s_load_dwordx2 s[52:53], s[0:1], 48
s_load_dwordx2 s[54:55], s[0:1], 48
s_load_dwordx2 s[6:7], s[0:1], 72
s_load_dwordx2 s[4:5], s[0:1], 80
s_load_dwordx2 s[18:19], s[0:1], 64
s_mov_b32 s45, 6
s_sub_u32 s24, s3, 2
s_lshl_b32 s24, s24, 5
s_add_u32 s24, s24, s16
s_lshr_b32 s89, s24, 1
s_lshr_b32 s90, s24, 2
s_mov_b32 s88, 0xe6a431
s_mov_b32 s25, 0xe6c431
s_bitcmp1_b32 s16, 0
s_cselect_b32 s88, 0xf7b582, s88
s_cselect_b32 s25, 0xf7d592, s25
s_bitcmp1_b32 s16, 1
s_cselect_b32 s88, s25, s88
s_cselect_b32 s45, 5, 6
s_add_u32 s45, s3, 3
s_cmp_eq_u32 s3, 1
s_cselect_b32 s45, 1, s45
s_cselect_b32 s88, 0, s88
s_cselect_b32 s89, s16, s89
L_pg:
s_waitcnt lgkmcnt(0)
s_cmp_ge_u32 s17, 2
s_cselect_b64 s[6:7], s[4:5], s[6:7]
s_cmp_eq_u32 s61, 0
s_cselect_b32 s24, 4, 1
s_mov_b32 s14, 884736
s_cselect_b32 s14, 1048576, s14
s_sub_u32 s24, s3, s24
s_lshl_b32 s24, s24, 5
s_add_u32 s24, s24, s16
s_lshl_b32 s24, s24, 13
s_mov_b32 s12, s52
s_and_b32 s13, s53, 0xffff
s_mov_b32 s15, 0x20000
v_lshlrev_b32 v15, 5, v0
buffer_load_dword v15, v15, s[12:15], s24 offen
s_sub_u32 s24, 7, s3
s_mul_i32 s25, s16, 6
s_add_u32 s24, s24, s25
s_cmp_ge_u32 s24, 36
s_cbranch_scc1 L_pf_1
s_load_dwordx2 s[4:5], s[0:1], 88
s_sub_u32 s25, s24, 0
s_mul_i32 s25, s25, 131072
s_add_u32 s25, s25, 0
s_min_u32 s25, s25, 4718592
s_sub_u32 s98, 4718592, s25
s_mov_b32 s100, 0x0
s_branch L_pfd
L_pf_1:
s_cmp_ge_u32 s24, 72
s_cbranch_scc1 L_pf_2
s_load_dwordx2 s[4:5], s[0:1], 64
s_sub_u32 s25, s24, 36
s_mul_i32 s25, s25, 131072
s_add_u32 s25, s25, 0
s_min_u32 s25, s25, 4718592
s_sub_u32 s98, 4718592, s25
s_mov_b32 s100, 0x0
s_branch L_pfd
L_pf_2:
s_cmp_ge_u32 s24, 80
s_cbranch_scc1 L_pf_3
s_load_dwordx2 s[4:5], s[0:1], 8
s_sub_u32 s25, s24, 72
s_mul_i32 s25, s25, 131072
s_add_u32 s25, s25, 1048576
s_min_u32 s25, s25, 2097152
s_sub_u32 s98, 2097152, s25
s_mov_b32 s100, 0xfffe0000
s_branch L_pfd
L_pf_3:
s_cmp_ge_u32 s24, 92
s_cbranch_scc1 L_pf_4
s_load_dwordx2 s[4:5], s[0:1], 48
s_sub_u32 s25, s24, 80
s_mul_i32 s25, s25, 131072
s_add_u32 s25, s25, 786432
s_min_u32 s25, s25, 2359296
s_sub_u32 s98, 2359296, s25
s_mov_b32 s100, 0xfffe0000
s_branch L_pfd
L_pf_4:
s_cmp_ge_u32 s24, 110
s_cbranch_scc1 L_pf_5
s_load_dwordx2 s[4:5], s[0:1], 0
s_sub_u32 s25, s24, 92
s_mul_i32 s25, s25, 131072
s_add_u32 s25, s25, 0
s_min_u32 s25, s25, 2359296
s_sub_u32 s98, 2359296, s25
s_mov_b32 s100, 0xfffe0000
s_branch L_pfd
L_pf_5:
s_cmp_ge_u32 s24, 146
s_cbranch_scc1 L_pf_6
s_load_dwordx2 s[4:5], s[0:1], 16
s_sub_u32 s25, s24, 110
s_mul_i32 s25, s25, 131072
s_add_u32 s25, s25, 0
s_min_u32 s25, s25, 4718592
s_sub_u32 s98, 4718592, s25
s_mov_b32 s100, 0xfffe0000
s_branch L_pfd
L_pf_6:
s_load_dwordx2 s[4:5], s[0:1], 40
s_sub_u32 s25, s24, 146
s_mul_i32 s25, s25, 131072
s_add_u32 s25, s25, 0
s_min_u32 s25, s25, 4718592
s_sub_u32 s98, 4718592, s25
s_mov_b32 s100, 0xfffe0000
s_branch L_pfd
L_pf_7:
L_pfd:
s_min_u32 s98, s98, 131072
s_waitcnt lgkmcnt(0)
s_add_u32 s96, s4, s25
s_addc_u32 s5, s5, 0
s_and_b32 s97, s5, 0xffff
s_mov_b32 s99, 0x20000
s_cmp_eq_u32 s3, 1
s_cselect_b32 s100, 536870912, s100
v_lshlrev_b32 v14, 6, v0
s_cmp_eq_u32 s61, 0
s_cselect_b32 s94, 0x3e0293ee, 1.0
s_cmp_eq_u32 s3, 1
s_cselect_b32 s91, 1, 0
v_bfe_u32 v16, v0, 4, 3
v_bfe_u32 v17, v0, 7, 1
v_lshlrev_b32 v17, 2, v17
v_xor_b32 v16, v16, v17
v_and_b32 v17, 7, v0
v_xor_b32 v16, v16, v17
v_lshlrev_b32 v1, 4, v16
v_bfe_u32 v17, v0, 4, 2
v_lshlrev_b32 v16, 2, v17
v_and_b32 v18, 15, v0
v_xor_b32 v16, v16, v18
v_bfe_u32 v18, v0, 6, 1
v_xor_b32 v16, v16, v18
v_lshlrev_b32 v16, 4, v16
v_lshl_add_u32 v16, v17, 13, v16
v_lshl_add_u32 v2, v18, 16, v16
s_and_b32 s24, s17, 1
s_lshr_b32 s25, s17, 1
s_lshl_b32 s25, s25, 13
s_lshl_b32 s33, s24, 11
s_add_u32 s33, s33, s25
s_lshl_b32 s32, s17, 10
s_add_u32 s32, s32, 65536
v_bfe_u32 v16, v0, 3, 1
v_lshlrev_b32 v16, 11, v16
v_and_b32 v18, 7, v0
v_lshl_add_u32 v16, v18, 7, v16
v_bfe_u32 v18, v0, 1, 3
v_xor_b32 v18, v18, v17
v_lshl_add_u32 v16, v18, 4, v16
s_lshl_b32 s24, s24, 14
s_add_u32 s24, s24, 65536
v_add_u32 v3, s24, v16
v_xor_b32 v4, 64, v3
v_bfe_u32 v18, v0, 2, 2
v_mul_u32_u24 v16, 320, v18
v_lshl_add_u32 v16, v17, 11, v16
v_bfe_u32 v18, v0, 1, 1
v_lshl_add_u32 v16, v18, 5, v16
v_bfe_u32 v18, v0, 4, 1
v_lshl_add_u32 v16, v18, 4, v16
v_and_b32 v18, 1, v0
v_lshl_add_u32 v16, v18, 3, v16
v_add_u32 v5, s25, v16
v_xor_b32 v6, 16, v5
v_xor_b32 v7, 64, v5
v_xor_b32 v8, 80, v5
v_xor_b32 v9, 128, v5
v_xor_b32 v10, 144, v5
v_xor_b32 v11, 192, v5
v_xor_b32 v12, 208, v5
s_mov_b32 s35, 0
s_lshr_b32 s24, s16, 1
s_cmp_eq_u32 s35, 5
s_cselect_b32 s90, s24, s90
s_lshl_b32 s24, s35, 2
s_lshr_b32 s26, s88, s24
s_bfe_u32 s2, s26, 0x10003
s_and_b32 s26, s26, 7
s_or_b32 s40, s2, s61
s_lshr_b32 s24, s17, 1
s_cmp_eq_u32 s2, 0
s_cselect_b32 s41, s24, 0
s_cselect_b32 s27, s89, s90
s_sub_u32 s25, s24, s41
s_and_b32 s51, s41, s61
s_lshl_b32 s51, s51, 1
s_or_b32 s51, s51, s41
s_lshl2_add_u32 s51, s2, s51
s_lshl_b32 s46, s27, s2
s_add_u32 s46, s46, s25
s_lshl_b32 s46, s46, 8
s_lshl_b32 s47, s40, 7
s_add_u32 s47, s47, 1024
s_mul_i32 s101, s26, s47
s_lshl_b32 s101, s101, 8
s_and_b32 s25, s17, 1
s_lshl1_add_u32 s42, s26, s25
s_lshl_b32 s42, s42, 7
s_lshr_b32 s42, s42, s2
s_add_u32 s42, s42, s27
s_lshl1_add_u32 s42, s42, s24
s_lshl_b32 s42, s42, 13
s_lshl_b32 s43, s27, 5
s_add_u32 s43, s43, s26
s_lshl_b32 s43, s43, 2
s_lshl_b32 s24, s2, 1
s_add_u32 s24, s24, s61
s_lshl_b32 s24, s24, 2
s_lshr_b32 s25, 0x8720, s24
s_and_b32 s25, s25, 15
s_lshl_b32 s25, s25, 24
s_add_u32 s42, s42, s25
s_lshr_b32 s25, 0x7604, s24
s_and_b32 s25, s25, 15
s_lshl_b32 s25, s25, 12
s_add_u32 s43, s43, s25
s_add_u32 s43, s43, 111149056
s_cmp_lt_u32 s35, s45
s_cselect_b32 s101, s101, 536870912
s_cselect_b32 s46, s46, 536870912
s_cmp_eq_u32 s2, 0
s_cselect_b64 s[4:5], s[52:53], s[54:55]
s_mov_b32 s12, s4
s_and_b32 s13, s5, 0xffff
s_lshl_b32 s14, s47, 11
s_mov_b32 s15, 0x20000
s_mov_b32 s30, s101
v_lshrrev_b32 v16, 3, v0
v_mul_lo_u32 v16, v16, s47
v_and_b32 v1, 0x70, v1
v_add_u32 v1, v1, v16
s_lshl_b32 s34, s47, 5
s_cmp_eq_u32 s2, 0
s_cselect_b64 s[4:5], s[6:7], s[18:19]
s_mov_b32 s20, s4
s_and_b32 s21, s5, 0xffff
s_lshl_b32 s22, s47, 12
s_mov_b32 s23, 0x20000
s_mov_b32 s31, s46
s_mov_b32 s48, s30
s_add_u32 m0, s32, 0
s_nop 0
buffer_load_dwordx4 v1, s[12:15], s48 offen lds
s_add_u32 s48, s48, s34
s_add_u32 m0, s32, 4096
s_nop 0
buffer_load_dwordx4 v1, s[12:15], s48 offen lds
s_add_u32 s48, s48, s34
s_add_u32 m0, s32, 8192
s_nop 0
buffer_load_dwordx4 v1, s[12:15], s48 offen lds
s_add_u32 s48, s48, s34
s_add_u32 m0, s32, 12288
s_nop 0
buffer_load_dwordx4 v1, s[12:15], s48 offen lds
s_add_u32 s48, s48, s34
s_add_u32 m0, s32, 16384
s_nop 0
buffer_load_dwordx4 v1, s[12:15], s48 offen lds
s_add_u32 s48, s48, s34
s_add_u32 m0, s32, 20480
s_nop 0
buffer_load_dwordx4 v1, s[12:15], s48 offen lds
s_add_u32 s48, s48, s34
s_add_u32 m0, s32, 24576
s_nop 0
buffer_load_dwordx4 v1, s[12:15], s48 offen lds
s_add_u32 s48, s48, s34
s_add_u32 m0, s32, 28672
s_nop 0
buffer_load_dwordx4 v1, s[12:15], s48 offen lds
s_add_u32 s30, s30, 128
s_add_u32 s32, s32, 32768
s_sub_u32 s48, s32, 98304
s_cmp_ge_u32 s32, 163840
s_cselect_b32 s32, s48, s32
s_add_u32 s37, s31, 0
s_add_u32 m0, s33, 0
s_nop 0
buffer_load_dwordx4 v2, s[20:23], s37 offen  lds
s_add_u32 s37, s31, 32768
s_add_u32 m0, s33, 1024
s_nop 0
buffer_load_dwordx4 v2, s[20:23], s37 offen  lds
s_add_u32 s37, s31, 131072
s_add_u32 m0, s33, 4096
s_nop 0
buffer_load_dwordx4 v2, s[20:23], s37 offen  lds
s_add_u32 s37, s31, 163840
s_add_u32 m0, s33, 5120
s_nop 0
buffer_load_dwordx4 v2, s[20:23], s37 offen  lds
s_add_u32 s31, s31, 262144
s_add_u32 s33, s33, 16384
s_and_b32 s33, s33, 65535
s_add_u32 s37, s31, 0
s_add_u32 m0, s33, 0
s_nop 0
buffer_load_dwordx4 v2, s[20:23], s37 offen  lds
s_add_u32 s37, s31, 32768
s_add_u32 m0, s33, 1024
s_nop 0
buffer_load_dwordx4 v2, s[20:23], s37 offen  lds
s_add_u32 s37, s31, 131072
s_add_u32 m0, s33, 4096
s_nop 0
buffer_load_dwordx4 v2, s[20:23], s37 offen  lds
s_add_u32 s37, s31, 163840
s_add_u32 m0, s33, 5120
s_nop 0
buffer_load_dwordx4 v2, s[20:23], s37 offen  lds
s_add_u32 s31, s31, 262144
s_add_u32 s33, s33, 16384
s_and_b32 s33, s33, 65535
s_mov_b32 s48, s30
s_add_u32 m0, s32, 0
s_nop 0
buffer_load_dwordx4 v1, s[12:15], s48 offen lds
s_add_u32 s48, s48, s34
s_add_u32 m0, s32, 4096
s_nop 0
buffer_load_dwordx4 v1, s[12:15], s48 offen lds
s_add_u32 s48, s48, s34
s_add_u32 m0, s32, 8192
s_nop 0
buffer_load_dwordx4 v1, s[12:15], s48 offen lds
s_add_u32 s48, s48, s34
s_add_u32 m0, s32, 12288
s_nop 0
buffer_load_dwordx4 v1, s[12:15], s48 offen lds
s_add_u32 s37, s31, 0
s_add_u32 m0, s33, 0
s_nop 0
buffer_load_dwordx4 v2, s[20:23], s37 offen  lds
s_add_u32 s37, s31, 32768
s_add_u32 m0, s33, 1024
s_nop 0
buffer_load_dwordx4 v2, s[20:23], s37 offen  lds
s_add_u32 s37, s31, 131072
s_add_u32 m0, s33, 4096
s_nop 0
buffer_load_dwordx4 v2, s[20:23], s37 offen  lds
s_add_u32 s37, s31, 163840
s_add_u32 m0, s33, 5120
s_nop 0
buffer_load_dwordx4 v2, s[20:23], s37 offen  lds
s_add_u32 s31, s31, 262144
s_add_u32 s33, s33, 16384
s_and_b32 s33, s33, 65535
s_add_u32 s48, s48, s34
s_add_u32 m0, s32, 16384
s_nop 0
buffer_load_dwordx4 v1, s[12:15], s48 offen lds
s_add_u32 s48, s48, s34
s_add_u32 m0, s32, 20480
s_nop 0
buffer_load_dwordx4 v1, s[12:15], s48 offen lds
s_add_u32 s48, s48, s34
s_add_u32 m0, s32, 24576
s_nop 0
buffer_load_dwordx4 v1, s[12:15], s48 offen lds
s_add_u32 s48, s48, s34
s_add_u32 m0, s32, 28672
s_nop 0
buffer_load_dwordx4 v1, s[12:15], s48 offen lds
s_add_u32 s30, s30, 128
s_add_u32 s32, s32, 32768
s_sub_u32 s48, s32, 98304
s_cmp_ge_u32 s32, 163840
s_cselect_b32 s32, s48, s32
s_add_u32 s37, s31, 0
s_add_u32 m0, s33, 0
s_nop 0
buffer_load_dwordx4 v2, s[20:23], s37 offen  lds
s_add_u32 s37, s31, 32768
s_add_u32 m0, s33, 1024
s_nop 0
buffer_load_dwordx4 v2, s[20:23], s37 offen  lds
s_add_u32 s37, s31, 131072
s_add_u32 m0, s33, 4096
s_nop 0
buffer_load_dwordx4 v2, s[20:23], s37 offen  lds
s_add_u32 s37, s31, 163840
s_add_u32 m0, s33, 5120
s_nop 0
buffer_load_dwordx4 v2, s[20:23], s37 offen  lds
s_add_u32 s31, s31, 262144
s_add_u32 s33, s33, 16384
s_and_b32 s33, s33, 65535
s_mov_b32 s48, s30
s_add_u32 m0, s32, 0
s_nop 0
buffer_load_dwordx4 v1, s[12:15], s48 offen lds
s_add_u32 s48, s48, s34
s_add_u32 m0, s32, 4096
s_nop 0
buffer_load_dwordx4 v1, s[12:15], s48 offen lds
s_add_u32 s48, s48, s34
s_add_u32 m0, s32, 8192
s_nop 0
buffer_load_dwordx4 v1, s[12:15], s48 offen lds
s_add_u32 s48, s48, s34
s_add_u32 m0, s32, 12288
s_nop 0
buffer_load_dwordx4 v1, s[12:15], s48 offen lds
s_mov_b32 s62, 536870912
s_mov_b32 s63, 536870912
s_mov_b32 s50, 0
s_waitcnt vmcnt(24)
s_barrier
s_cmp_eq_u32 s41, 0
s_cbranch_scc0 L_g_p1
ds_read_b64_tr_b16 a[160:161], v5 offset:0
ds_read_b64_tr_b16 a[162:163], v5 offset:1024
ds_read_b64_tr_b16 a[164:165], v6 offset:0
ds_read_b64_tr_b16 a[166:167], v6 offset:1024
ds_read_b64_tr_b16 a[168:169], v7 offset:0
ds_read_b64_tr_b16 a[170:171], v7 offset:1024
ds_read_b64_tr_b16 a[172:173], v8 offset:0
ds_read_b64_tr_b16 a[174:175], v8 offset:1024
ds_read_b64_tr_b16 a[176:177], v9 offset:0
ds_read_b64_tr_b16 a[178:179], v9 offset:1024
ds_read_b64_tr_b16 a[180:181], v10 offset:0
ds_read_b64_tr_b16 a[182:183], v10 offset:1024
ds_read_b64_tr_b16 a[184:185], v11 offset:0
ds_read_b64_tr_b16 a[186:187], v11 offset:1024
ds_read_b64_tr_b16 a[188:189], v12 offset:0
ds_read_b64_tr_b16 a[190:191], v12 offset:1024
ds_read_b128 a[192:195], v3 offset:0
ds_read_b128 a[196:199], v4 offset:1024
ds_read_b128 a[200:203], v3 offset:4096
ds_read_b128 a[204:207], v4 offset:5120
ds_read_b128 a[208:211], v3 offset:8192
ds_read_b128 a[212:215], v4 offset:9216
ds_read_b128 a[216:219], v3 offset:12288
ds_read_b128 a[220:223], v4 offset:13312
s_branch L_g_p2
L_g_p1:
ds_read_b128 a[160:163], v3 offset:0
ds_read_b128 a[164:167], v4 offset:1024
ds_read_b128 a[168:171], v3 offset:4096
ds_read_b128 a[172:175], v4 offset:5120
ds_read_b128 a[176:179], v3 offset:8192
ds_read_b128 a[180:183], v4 offset:9216
ds_read_b128 a[184:187], v3 offset:12288
ds_read_b128 a[188:191], v4 offset:13312
ds_read_b64_tr_b16 a[192:193], v5 offset:0
ds_read_b64_tr_b16 a[194:195], v5 offset:1024
ds_read_b64_tr_b16 a[196:197], v6 offset:0
ds_read_b64_tr_b16 a[198:199], v6 offset:1024
ds_read_b64_tr_b16 a[200:201], v7 offset:0
ds_read_b64_tr_b16 a[202:203], v7 offset:1024
ds_read_b64_tr_b16 a[204:205], v8 offset:0
ds_read_b64_tr_b16 a[206:207], v8 offset:1024
ds_read_b64_tr_b16 a[208:209], v9 offset:0
ds_read_b64_tr_b16 a[210:211], v9 offset:1024
ds_read_b64_tr_b16 a[212:213], v10 offset:0
ds_read_b64_tr_b16 a[214:215], v10 offset:1024
ds_read_b64_tr_b16 a[216:217], v11 offset:0
ds_read_b64_tr_b16 a[218:219], v11 offset:1024
ds_read_b64_tr_b16 a[220:221], v12 offset:0
ds_read_b64_tr_b16 a[222:223], v12 offset:1024
L_g_p2:
v_add_u32 v5, 16384, v5
v_and_b32 v5, 65535, v5
v_xor_b32 v6, 16, v5
v_xor_b32 v7, 64, v5
v_xor_b32 v8, 80, v5
v_xor_b32 v9, 128, v5
v_xor_b32 v10, 144, v5
v_xor_b32 v11, 192, v5
v_xor_b32 v12, 208, v5
L_g_tile:
s_cmp_eq_u32 s35, 1
s_cbranch_scc1 L_g_first
L_g_go:
s_cmp_eq_u32 s41, 0
s_cbranch_scc0 L_g_v
.p2align 3
L_g_k:
s_waitcnt vmcnt(16) lgkmcnt(0)
s_barrier
v_mfma_f32_16x16x32_bf16 v[160:163], a[160:163], a[192:195], 0
ds_read_b128 a[224:227], v4 offset:0
v_accvgpr_read_b32 v20, a64
v_accvgpr_read_b32 v21, a65
v_accvgpr_read_b32 v22, a66
v_mfma_f32_16x16x32_bf16 v[164:167], a[160:163], a[196:199], 0
s_add_u32 s37, s31, 0
v_accvgpr_read_b32 v23, a67
v_cvt_pk_bf16_f32 v98, v20, v21
v_cvt_pk_bf16_f32 v99, v22, v23
v_accvgpr_read_b32 v24, a68
v_mfma_f32_16x16x32_bf16 v[168:171], a[160:163], a[200:203], 0
s_add_u32 m0, s33, 0
ds_read_b128 a[228:231], v3 offset:1024
v_accvgpr_read_b32 v25, a69
v_accvgpr_read_b32 v26, a70
v_accvgpr_read_b32 v27, a71
v_mfma_f32_16x16x32_bf16 v[172:175], a[160:163], a[204:207], 0
buffer_load_dwordx4 v2, s[20:23], s37 offen  lds
v_cvt_pk_bf16_f32 v102, v24, v25
v_cvt_pk_bf16_f32 v103, v26, v27
v_accvgpr_read_b32 v20, a72
v_mfma_f32_16x16x32_bf16 v[176:179], a[160:163], a[208:211], 0
ds_read_b128 a[232:235], v4 offset:4096
v_accvgpr_read_b32 v21, a73
v_accvgpr_read_b32 v22, a74
v_accvgpr_read_b32 v23, a75
v_mfma_f32_16x16x32_bf16 v[180:183], a[160:163], a[212:215], 0
v_cvt_pk_bf16_f32 v106, v20, v21
v_cvt_pk_bf16_f32 v107, v22, v23
v_accvgpr_read_b32 v24, a76
v_accvgpr_read_b32 v25, a77
v_mfma_f32_16x16x32_bf16 v[184:187], a[160:163], a[216:219], 0
ds_read_b128 a[236:239], v3 offset:5120
v_accvgpr_read_b32 v26, a78
v_accvgpr_read_b32 v27, a79
v_cvt_pk_bf16_f32 v110, v24, v25
v_mfma_f32_16x16x32_bf16 v[188:191], a[160:163], a[220:223], 0
ds_read_b64_tr_b16 a[160:161], v5 offset:0
v_cvt_pk_bf16_f32 v111, v26, v27
v_accvgpr_read_b32 v20, a80
v_accvgpr_read_b32 v21, a81
v_mfma_f32_16x16x32_bf16 v[192:195], a[164:167], a[192:195], 0
s_add_u32 s37, s31, 32768
ds_read_b64_tr_b16 a[162:163], v5 offset:1024
v_accvgpr_read_b32 v22, a82
v_accvgpr_read_b32 v23, a83
v_cvt_pk_bf16_f32 v114, v20, v21
v_mfma_f32_16x16x32_bf16 v[196:199], a[164:167], a[196:199], 0
s_add_u32 m0, s33, 1024
ds_read_b128 a[240:243], v4 offset:8192
v_add_u32 v5, 16384, v5
v_cvt_pk_bf16_f32 v115, v22, v23
v_accvgpr_read_b32 v24, a84
v_mfma_f32_16x16x32_bf16 v[200:203], a[164:167], a[200:203], 0
buffer_load_dwordx4 v2, s[20:23], s37 offen  lds
v_and_b32 v5, 65535, v5
v_accvgpr_read_b32 v25, a85
v_accvgpr_read_b32 v26, a86
v_mfma_f32_16x16x32_bf16 v[204:207], a[164:167], a[204:207], 0
ds_read_b128 a[244:247], v3 offset:9216
v_accvgpr_read_b32 v27, a87
v_cvt_pk_bf16_f32 v118, v24, v25
v_cvt_pk_bf16_f32 v119, v26, v27
v_mfma_f32_16x16x32_bf16 v[208:211], a[164:167], a[208:211], 0
v_accvgpr_read_b32 v20, a88
v_accvgpr_read_b32 v21, a89
v_accvgpr_read_b32 v22, a90
v_accvgpr_read_b32 v23, a91
v_mfma_f32_16x16x32_bf16 v[212:215], a[164:167], a[212:215], 0
ds_read_b128 a[248:251], v4 offset:12288
v_cvt_pk_bf16_f32 v122, v20, v21
v_cvt_pk_bf16_f32 v123, v22, v23
v_accvgpr_read_b32 v24, a92
v_mfma_f32_16x16x32_bf16 v[216:219], a[164:167], a[216:219], 0
v_accvgpr_read_b32 v25, a93
v_accvgpr_read_b32 v26, a94
v_accvgpr_read_b32 v27, a95
v_cvt_pk_bf16_f32 v126, v24, v25
v_mfma_f32_16x16x32_bf16 v[220:223], a[164:167], a[220:223], 0
s_add_u32 s37, s31, 131072
ds_read_b64_tr_b16 a[164:165], v6 offset:0
v_cvt_pk_bf16_f32 v127, v26, v27
v_accvgpr_read_b32 v20, a96
v_accvgpr_read_b32 v21, a97
v_mfma_f32_16x16x32_bf16 v[224:227], a[168:171], a[192:195], 0
s_add_u32 m0, s33, 4096
ds_read_b64_tr_b16 a[166:167], v6 offset:1024
v_accvgpr_read_b32 v22, a98
v_accvgpr_read_b32 v23, a99
v_cvt_pk_bf16_f32 v128, v20, v21
v_mfma_f32_16x16x32_bf16 v[228:231], a[168:171], a[196:199], 0
buffer_load_dwordx4 v2, s[20:23], s37 offen  lds
v_xor_b32 v6, 16, v5
v_cvt_pk_bf16_f32 v129, v22, v23
v_accvgpr_read_b32 v24, a100
v_mfma_f32_16x16x32_bf16 v[232:235], a[168:171], a[200:203], 0
ds_read_b128 a[252:255], v3 offset:13312
v_accvgpr_read_b32 v25, a101
v_accvgpr_read_b32 v26, a102
v_accvgpr_read_b32 v27, a103
v_mfma_f32_16x16x32_bf16 v[236:239], a[168:171], a[204:207], 0
v_cvt_pk_bf16_f32 v132, v24, v25
v_cvt_pk_bf16_f32 v133, v26, v27
v_accvgpr_read_b32 v20, a104
v_accvgpr_read_b32 v21, a105
v_mfma_f32_16x16x32_bf16 v[240:243], a[168:171], a[208:211], 0
ds_read_b64_tr_b16 v[28:29], v12 offset:0
v_accvgpr_read_b32 v22, a106
v_accvgpr_read_b32 v23, a107
v_cvt_pk_bf16_f32 v136, v20, v21
v_mfma_f32_16x16x32_bf16 v[244:247], a[168:171], a[212:215], 0
v_cvt_pk_bf16_f32 v137, v22, v23
v_accvgpr_read_b32 v24, a108
v_accvgpr_read_b32 v25, a109
v_accvgpr_read_b32 v26, a110
v_mfma_f32_16x16x32_bf16 v[248:251], a[168:171], a[216:219], 0
s_add_u32 s37, s31, 163840
ds_read_b64_tr_b16 v[30:31], v12 offset:1024
v_accvgpr_read_b32 v27, a111
v_cvt_pk_bf16_f32 v140, v24, v25
v_cvt_pk_bf16_f32 v141, v26, v27
v_mfma_f32_16x16x32_bf16 v[252:255], a[168:171], a[220:223], 0
s_add_u32 m0, s33, 5120
ds_read_b64_tr_b16 a[168:169], v7 offset:0
v_accvgpr_read_b32 v20, a112
v_accvgpr_read_b32 v21, a113
v_accvgpr_read_b32 v22, a114
v_mfma_f32_16x16x32_bf16 a[0:3], a[172:175], a[192:195], 0
buffer_load_dwordx4 v2, s[20:23], s37 offen  lds
ds_read_b64_tr_b16 a[170:171], v7 offset:1024
v_accvgpr_read_b32 v23, a115
v_cvt_pk_bf16_f32 v144, v20, v21
v_mfma_f32_16x16x32_bf16 a[4:7], a[172:175], a[196:199], 0
s_add_u32 s31, s31, 262144
v_xor_b32 v7, 64, v5
v_xor_b32 v12, 208, v5
v_cvt_pk_bf16_f32 v145, v22, v23
v_accvgpr_read_b32 v24, a116
v_mfma_f32_16x16x32_bf16 a[8:11], a[172:175], a[200:203], 0
s_add_u32 s33, s33, 16384
v_add_u32 v3, 32768, v3
v_accvgpr_read_b32 v25, a117
v_accvgpr_read_b32 v26, a118
v_accvgpr_read_b32 v27, a119
v_mfma_f32_16x16x32_bf16 a[12:15], a[172:175], a[204:207], 0
s_and_b32 s33, s33, 65535
v_subrev_u32 v19, 98304, v3
v_cvt_pk_bf16_f32 v148, v24, v25
v_cvt_pk_bf16_f32 v149, v26, v27
v_accvgpr_read_b32 v20, a120
v_mfma_f32_16x16x32_bf16 a[16:19], a[172:175], a[208:211], 0
v_cmp_le_u32 vcc, 163840, v3
v_accvgpr_read_b32 v21, a121
v_accvgpr_read_b32 v22, a122
v_accvgpr_read_b32 v23, a123
v_mfma_f32_16x16x32_bf16 a[20:23], a[172:175], a[212:215], 0
s_add_u32 s48, s48, s34
v_cndmask_b32 v3, v3, v19, vcc
v_cvt_pk_bf16_f32 v152, v20, v21
v_cvt_pk_bf16_f32 v153, v22, v23
v_accvgpr_read_b32 v24, a124
v_mfma_f32_16x16x32_bf16 a[24:27], a[172:175], a[216:219], 0
s_add_u32 m0, s32, 16384
v_xor_b32 v4, 64, v3
v_accvgpr_read_b32 v25, a125
v_accvgpr_read_b32 v26, a126
v_accvgpr_read_b32 v27, a127
v_mfma_f32_16x16x32_bf16 a[28:31], a[172:175], a[220:223], 0
buffer_load_dwordx4 v1, s[12:15], s48 offen lds
ds_read_b64_tr_b16 a[172:173], v8 offset:0
v_cvt_pk_bf16_f32 v156, v24, v25
v_cvt_pk_bf16_f32 v157, v26, v27
v_mfma_f32_16x16x32_bf16 a[32:35], a[176:179], a[192:195], 0
ds_read_b64_tr_b16 a[174:175], v8 offset:1024
v_accvgpr_read_b32 v20, a128
v_accvgpr_read_b32 v21, a129
v_accvgpr_read_b32 v22, a130
v_mfma_f32_16x16x32_bf16 a[36:39], a[176:179], a[196:199], 0
v_xor_b32 v8, 80, v5
v_accvgpr_read_b32 v23, a131
v_cvt_pk_bf16_f32 v130, v20, v21
v_cvt_pk_bf16_f32 v131, v22, v23
v_mfma_f32_16x16x32_bf16 a[40:43], a[176:179], a[200:203], 0
v_accvgpr_read_b32 v24, a132
v_accvgpr_read_b32 v25, a133
v_accvgpr_read_b32 v26, a134
v_accvgpr_read_b32 v27, a135
v_mfma_f32_16x16x32_bf16 a[44:47], a[176:179], a[204:207], 0
v_cvt_pk_bf16_f32 v134, v24, v25
v_cvt_pk_bf16_f32 v135, v26, v27
v_accvgpr_read_b32 v20, a136
v_accvgpr_read_b32 v21, a137
v_mfma_f32_16x16x32_bf16 a[48:51], a[176:179], a[208:211], 0
s_add_u32 s48, s48, s34
v_accvgpr_read_b32 v22, a138
v_accvgpr_read_b32 v23, a139
v_cvt_pk_bf16_f32 v138, v20, v21
v_cvt_pk_bf16_f32 v139, v22, v23
s_mov_b32 s38, s62
s_mov_b32 s39, s63
v_mfma_f32_16x16x32_bf16 a[52:55], a[176:179], a[212:215], 0
s_add_u32 m0, s32, 20480
v_accvgpr_read_b32 v24, a140
v_accvgpr_read_b32 v25, a141
v_accvgpr_read_b32 v26, a142
v_accvgpr_read_b32 v27, a143
s_mov_b32 s49, s50
s_mov_b32 s62, s42
v_mfma_f32_16x16x32_bf16 a[56:59], a[176:179], a[216:219], 0
buffer_load_dwordx4 v1, s[12:15], s48 offen lds
v_cvt_pk_bf16_f32 v142, v24, v25
v_cvt_pk_bf16_f32 v143, v26, v27
v_accvgpr_read_b32 v20, a144
s_mov_b32 s63, s43
s_mov_b32 s50, s51
v_mfma_f32_16x16x32_bf16 a[60:63], a[176:179], a[220:223], 0
ds_read_b64_tr_b16 a[176:177], v9 offset:0
v_accvgpr_read_b32 v21, a145
v_accvgpr_read_b32 v22, a146
v_accvgpr_read_b32 v23, a147
s_mov_b32 s36, s40
s_add_u32 s35, s35, 1
v_mfma_f32_16x16x32_bf16 a[64:67], a[180:183], a[192:195], 0
ds_read_b64_tr_b16 a[178:179], v9 offset:1024
v_cvt_pk_bf16_f32 v146, v20, v21
v_cvt_pk_bf16_f32 v147, v22, v23
v_accvgpr_read_b32 v24, a148
v_bfe_u32 v16, v0, 3, 3
v_lshlrev_b32 v16, 4, v16
v_mfma_f32_16x16x32_bf16 a[68:71], a[180:183], a[196:199], 0
v_xor_b32 v9, 128, v5
v_accvgpr_read_b32 v25, a149
v_accvgpr_read_b32 v26, a150
v_accvgpr_read_b32 v27, a151
v_and_or_b32 v16, v0, 7, v16
v_bfe_u32 v17, v0, 4, 2
v_mfma_f32_16x16x32_bf16 a[72:75], a[180:183], a[200:203], 0
v_cvt_pk_bf16_f32 v150, v24, v25
v_cvt_pk_bf16_f32 v151, v26, v27
v_accvgpr_read_b32 v20, a152
v_accvgpr_read_b32 v21, a153
v_lshlrev_b32 v17, 5, v17
v_bfe_u32 v18, v0, 1, 3
v_mfma_f32_16x16x32_bf16 a[76:79], a[180:183], a[204:207], 0
s_add_u32 s48, s48, s34
v_accvgpr_read_b32 v22, a154
v_accvgpr_read_b32 v23, a155
v_cvt_pk_bf16_f32 v154, v20, v21
v_cvt_pk_bf16_f32 v155, v22, v23
v_or_b32 v17, v17, v18
v_and_b32 v18, 1, v0
v_mfma_f32_16x16x32_bf16 a[80:83], a[180:183], a[208:211], 0
s_add_u32 m0, s32, 24576
v_accvgpr_read_b32 v24, a156
v_accvgpr_read_b32 v25, a157
v_accvgpr_read_b32 v26, a158
v_accvgpr_read_b32 v27, a159
v_lshl_or_b32 v17, v18, 4, v17
v_mfma_f32_16x16x32_bf16 a[84:87], a[180:183], a[212:215], 0
buffer_load_dwordx4 v1, s[12:15], s48 offen lds
v_cvt_pk_bf16_f32 v158, v24, v25
v_cvt_pk_bf16_f32 v159, v26, v27
s_bitcmp1_b32 s49, 1
s_cselect_b64 vcc, -1, 0
s_movk_i32 s44, 0x80
v_mfma_f32_16x16x32_bf16 a[88:91], a[180:183], a[216:219], 0
v_cndmask_b32 v16, v16, v17, vcc
v_lshlrev_b32 v13, 4, v16
s_lshr_b32 s93, s49, 2
s_lshr_b32 s93, 0x80000, s93
v_mfma_f32_16x16x32_bf16 a[92:95], a[180:183], a[220:223], 0
ds_read_b64_tr_b16 a[180:181], v10 offset:0
s_bitcmp1_b32 s49, 0
s_cselect_b32 s92, s93, 0x800
s_cselect_b32 s93, 0x800, s93
s_sub_u32 s93, s93, s44
v_mfma_f32_16x16x32_bf16 a[96:99], a[184:187], a[192:195], 0
ds_read_b64_tr_b16 a[182:183], v10 offset:1024
v_mfma_f32_16x16x32_bf16 a[100:103], a[184:187], a[196:199], 0
v_xor_b32 v10, 144, v5
v_mfma_f32_16x16x32_bf16 a[104:107], a[184:187], a[200:203], 0
s_add_u32 s48, s48, s34
v_mfma_f32_16x16x32_bf16 a[108:111], a[184:187], a[204:207], 0
s_add_u32 m0, s32, 28672
v_mfma_f32_16x16x32_bf16 a[112:115], a[184:187], a[208:211], 0
buffer_load_dwordx4 v1, s[12:15], s48 offen lds
v_mfma_f32_16x16x32_bf16 a[116:119], a[184:187], a[212:215], 0
s_add_u32 s30, s30, 128
v_mfma_f32_16x16x32_bf16 a[120:123], a[184:187], a[216:219], 0
s_add_u32 s32, s32, 32768
v_mfma_f32_16x16x32_bf16 a[124:127], a[184:187], a[220:223], 0
s_sub_u32 s48, s32, 98304
ds_read_b64_tr_b16 a[184:185], v11 offset:0
v_mfma_f32_16x16x32_bf16 a[128:131], a[188:191], a[192:195], 0
s_cmp_ge_u32 s32, 163840
s_cselect_b32 s32, s48, s32
ds_read_b64_tr_b16 a[186:187], v11 offset:1024
v_mfma_f32_16x16x32_bf16 a[132:135], a[188:191], a[196:199], 0
v_xor_b32 v11, 192, v5
v_mfma_f32_16x16x32_bf16 a[136:139], a[188:191], a[200:203], 0
buffer_load_dword v15, v14, s[96:99], s100 offen
v_mfma_f32_16x16x32_bf16 a[140:143], a[188:191], a[204:207], 0
s_add_u32 s100, s100, 16384
v_mfma_f32_16x16x32_bf16 a[144:147], a[188:191], a[208:211], 0
v_mfma_f32_16x16x32_bf16 a[148:151], a[188:191], a[212:215], 0
v_mfma_f32_16x16x32_bf16 a[152:155], a[188:191], a[216:219], 0
v_mfma_f32_16x16x32_bf16 a[156:159], a[188:191], a[220:223], 0
s_waitcnt vmcnt(17) lgkmcnt(0)
s_barrier
v_mfma_f32_16x16x32_bf16 v[160:163], a[160:163], a[224:227], v[160:163]
ds_read_b128 a[192:195], v3 offset:0
v_mfma_f32_16x16x32_bf16 v[164:167], a[160:163], a[228:231], v[164:167]
s_add_u32 s37, s31, 0
v_mfma_f32_16x16x32_bf16 v[168:171], a[160:163], a[232:235], v[168:171]
s_add_u32 m0, s33, 0
ds_read_b128 a[196:199], v4 offset:1024
v_mfma_f32_16x16x32_bf16 v[172:175], a[160:163], a[236:239], v[172:175]
buffer_load_dwordx4 v2, s[20:23], s37 offen  lds
v_mfma_f32_16x16x32_bf16 v[176:179], a[160:163], a[240:243], v[176:179]
s_mov_b32 s60, s38
ds_read_b128 a[200:203], v3 offset:4096
v_mfma_f32_16x16x32_bf16 v[180:183], a[160:163], a[244:247], v[180:183]
s_mov_b32 s29, s38
v_mfma_f32_16x16x32_bf16 v[184:187], a[160:163], a[248:251], v[184:187]
buffer_store_dwordx4 v[32:35], v13, s[8:11], s29 offen sc1
v_mfma_f32_16x16x32_bf16 v[188:191], a[160:163], a[252:255], v[188:191]
ds_read_b64_tr_b16 a[160:161], v5 offset:0
v_mfma_f32_16x16x32_bf16 v[192:195], a[164:167], a[224:227], v[192:195]
s_add_u32 s37, s31, 32768
ds_read_b64_tr_b16 a[162:163], v5 offset:1024
v_mfma_f32_16x16x32_bf16 v[196:199], a[164:167], a[228:231], v[196:199]
s_add_u32 m0, s33, 1024
ds_read_b128 a[204:207], v4 offset:5120
v_add_u32 v5, 16384, v5
v_mfma_f32_16x16x32_bf16 v[200:203], a[164:167], a[232:235], v[200:203]
buffer_load_dwordx4 v2, s[20:23], s37 offen  lds
v_and_b32 v5, 65535, v5
v_mfma_f32_16x16x32_bf16 v[204:207], a[164:167], a[236:239], v[204:207]
ds_read_b128 a[208:211], v3 offset:8192
v_mfma_f32_16x16x32_bf16 v[208:211], a[164:167], a[240:243], v[208:211]
v_mfma_f32_16x16x32_bf16 v[212:215], a[164:167], a[244:247], v[212:215]
ds_read_b128 a[212:215], v4 offset:9216
v_mfma_f32_16x16x32_bf16 v[216:219], a[164:167], a[248:251], v[216:219]
v_mfma_f32_16x16x32_bf16 v[220:223], a[164:167], a[252:255], v[220:223]
s_add_u32 s37, s31, 131072
ds_read_b64_tr_b16 a[164:165], v6 offset:0
v_mfma_f32_16x16x32_bf16 v[224:227], a[168:171], a[224:227], v[224:227]
s_add_u32 m0, s33, 4096
ds_read_b64_tr_b16 a[166:167], v6 offset:1024
v_mfma_f32_16x16x32_bf16 v[228:231], a[168:171], a[228:231], v[228:231]
buffer_load_dwordx4 v2, s[20:23], s37 offen  lds
v_xor_b32 v6, 16, v5
v_mfma_f32_16x16x32_bf16 v[232:235], a[168:171], a[232:235], v[232:235]
ds_read_b128 a[216:219], v3 offset:12288
v_mfma_f32_16x16x32_bf16 v[236:239], a[168:171], a[236:239], v[236:239]
v_mfma_f32_16x16x32_bf16 v[240:243], a[168:171], a[240:243], v[240:243]
ds_read_b128 a[220:223], v4 offset:13312
v_mfma_f32_16x16x32_bf16 v[244:247], a[168:171], a[244:247], v[244:247]
v_mfma_f32_16x16x32_bf16 v[248:251], a[168:171], a[248:251], v[248:251]
s_add_u32 s37, s31, 163840
ds_read_b64_tr_b16 a[188:189], v12 offset:0
v_mfma_f32_16x16x32_bf16 v[252:255], a[168:171], a[252:255], v[252:255]
s_add_u32 m0, s33, 5120
ds_read_b64_tr_b16 a[168:169], v7 offset:0
v_mfma_f32_16x16x32_bf16 a[0:3], a[172:175], a[224:227], a[0:3]
buffer_load_dwordx4 v2, s[20:23], s37 offen  lds
ds_read_b64_tr_b16 a[170:171], v7 offset:1024
v_mfma_f32_16x16x32_bf16 a[4:7], a[172:175], a[228:231], a[4:7]
s_add_u32 s31, s31, 262144
s_add_u32 s29, s29, s44
v_xor_b32 v7, 64, v5
v_mfma_f32_16x16x32_bf16 a[8:11], a[172:175], a[232:235], a[8:11]
s_add_u32 s33, s33, 16384
ds_read_b64_tr_b16 a[190:191], v12 offset:1024
v_mfma_f32_16x16x32_bf16 a[12:15], a[172:175], a[236:239], a[12:15]
s_and_b32 s33, s33, 65535
buffer_store_dwordx4 v[36:39], v13, s[8:11], s29 offen sc1
v_mfma_f32_16x16x32_bf16 a[16:19], a[172:175], a[240:243], a[16:19]
v_mfma_f32_16x16x32_bf16 a[20:23], a[172:175], a[244:247], a[20:23]
s_mov_b32 s48, s30
v_xor_b32 v12, 208, v5
v_mfma_f32_16x16x32_bf16 a[24:27], a[172:175], a[248:251], a[24:27]
s_add_u32 m0, s32, 0
v_mfma_f32_16x16x32_bf16 a[28:31], a[172:175], a[252:255], a[28:31]
buffer_load_dwordx4 v1, s[12:15], s48 offen lds
ds_read_b64_tr_b16 a[172:173], v8 offset:0
v_mfma_f32_16x16x32_bf16 a[32:35], a[176:179], a[224:227], a[32:35]
ds_read_b64_tr_b16 a[174:175], v8 offset:1024
v_mfma_f32_16x16x32_bf16 a[36:39], a[176:179], a[228:231], a[36:39]
v_xor_b32 v8, 80, v5
v_mfma_f32_16x16x32_bf16 a[40:43], a[176:179], a[232:235], a[40:43]
v_mfma_f32_16x16x32_bf16 a[44:47], a[176:179], a[236:239], a[44:47]
v_mfma_f32_16x16x32_bf16 a[48:51], a[176:179], a[240:243], a[48:51]
s_add_u32 s48, s48, s34
v_mfma_f32_16x16x32_bf16 a[52:55], a[176:179], a[244:247], a[52:55]
s_add_u32 m0, s32, 4096
v_mfma_f32_16x16x32_bf16 a[56:59], a[176:179], a[248:251], a[56:59]
buffer_load_dwordx4 v1, s[12:15], s48 offen lds
v_mfma_f32_16x16x32_bf16 a[60:63], a[176:179], a[252:255], a[60:63]
ds_read_b64_tr_b16 a[176:177], v9 offset:0
v_mfma_f32_16x16x32_bf16 a[64:67], a[180:183], a[224:227], a[64:67]
ds_read_b64_tr_b16 a[178:179], v9 offset:1024
v_mfma_f32_16x16x32_bf16 a[68:71], a[180:183], a[228:231], a[68:71]
v_xor_b32 v9, 128, v5
v_mfma_f32_16x16x32_bf16 a[72:75], a[180:183], a[232:235], a[72:75]
v_mfma_f32_16x16x32_bf16 a[76:79], a[180:183], a[236:239], a[76:79]
s_add_u32 s48, s48, s34
v_mfma_f32_16x16x32_bf16 a[80:83], a[180:183], a[240:243], a[80:83]
s_add_u32 m0, s32, 8192
v_mfma_f32_16x16x32_bf16 a[84:87], a[180:183], a[244:247], a[84:87]
buffer_load_dwordx4 v1, s[12:15], s48 offen lds
v_mfma_f32_16x16x32_bf16 a[88:91], a[180:183], a[248:251], a[88:91]
s_add_u32 s29, s29, s93
v_mfma_f32_16x16x32_bf16 a[92:95], a[180:183], a[252:255], a[92:95]
ds_read_b64_tr_b16 a[180:181], v10 offset:0
v_mfma_f32_16x16x32_bf16 a[96:99], a[184:187], a[224:227], a[96:99]
buffer_store_dwordx4 v[40:43], v13, s[8:11], s29 offen sc1
ds_read_b64_tr_b16 a[182:183], v10 offset:1024
v_mfma_f32_16x16x32_bf16 a[100:103], a[184:187], a[228:231], a[100:103]
v_xor_b32 v10, 144, v5
v_mfma_f32_16x16x32_bf16 a[104:107], a[184:187], a[232:235], a[104:107]
s_add_u32 s48, s48, s34
v_mfma_f32_16x16x32_bf16 a[108:111], a[184:187], a[236:239], a[108:111]
s_add_u32 m0, s32, 12288
v_mfma_f32_16x16x32_bf16 a[112:115], a[184:187], a[240:243], a[112:115]
buffer_load_dwordx4 v1, s[12:15], s48 offen lds
v_mfma_f32_16x16x32_bf16 a[116:119], a[184:187], a[244:247], a[116:119]
v_mfma_f32_16x16x32_bf16 a[120:123], a[184:187], a[248:251], a[120:123]
v_mfma_f32_16x16x32_bf16 a[124:127], a[184:187], a[252:255], a[124:127]
ds_read_b64_tr_b16 a[184:185], v11 offset:0
v_mfma_f32_16x16x32_bf16 a[128:131], v[28:31], a[224:227], a[128:131]
ds_read_b64_tr_b16 a[186:187], v11 offset:1024
v_mfma_f32_16x16x32_bf16 a[132:135], v[28:31], a[228:231], a[132:135]
v_xor_b32 v11, 192, v5
v_mfma_f32_16x16x32_bf16 a[136:139], v[28:31], a[232:235], a[136:139]
buffer_load_dword v15, v14, s[96:99], s100 offen
v_mfma_f32_16x16x32_bf16 a[140:143], v[28:31], a[236:239], a[140:143]
s_add_u32 s100, s100, 16384
v_mfma_f32_16x16x32_bf16 a[144:147], v[28:31], a[240:243], a[144:147]
v_mfma_f32_16x16x32_bf16 a[148:151], v[28:31], a[244:247], a[148:151]
v_mfma_f32_16x16x32_bf16 a[152:155], v[28:31], a[248:251], a[152:155]
v_mfma_f32_16x16x32_bf16 a[156:159], v[28:31], a[252:255], a[156:159]
s_waitcnt vmcnt(21) lgkmcnt(0)
s_barrier
v_mfma_f32_16x16x32_bf16 v[160:163], a[160:163], a[192:195], v[160:163]
ds_read_b128 a[224:227], v4 offset:0
v_mfma_f32_16x16x32_bf16 v[164:167], a[160:163], a[196:199], v[164:167]
s_add_u32 s37, s31, 0
v_mfma_f32_16x16x32_bf16 v[168:171], a[160:163], a[200:203], v[168:171]
s_add_u32 m0, s33, 0
ds_read_b128 a[228:231], v3 offset:1024
v_mfma_f32_16x16x32_bf16 v[172:175], a[160:163], a[204:207], v[172:175]
buffer_load_dwordx4 v2, s[20:23], s37 offen  lds
v_mfma_f32_16x16x32_bf16 v[176:179], a[160:163], a[208:211], v[176:179]
s_add_u32 s29, s29, s44
ds_read_b128 a[232:235], v4 offset:4096
v_mfma_f32_16x16x32_bf16 v[180:183], a[160:163], a[212:215], v[180:183]
v_mfma_f32_16x16x32_bf16 v[184:187], a[160:163], a[216:219], v[184:187]
buffer_store_dwordx4 v[44:47], v13, s[8:11], s29 offen sc1
v_mfma_f32_16x16x32_bf16 v[188:191], a[160:163], a[220:223], v[188:191]
ds_read_b64_tr_b16 a[160:161], v5 offset:0
v_mfma_f32_16x16x32_bf16 v[192:195], a[164:167], a[192:195], v[192:195]
s_add_u32 s37, s31, 32768
ds_read_b64_tr_b16 a[162:163], v5 offset:1024
v_mfma_f32_16x16x32_bf16 v[196:199], a[164:167], a[196:199], v[196:199]
s_add_u32 m0, s33, 1024
ds_read_b128 a[236:239], v3 offset:5120
v_add_u32 v5, 16384, v5
v_mfma_f32_16x16x32_bf16 v[200:203], a[164:167], a[200:203], v[200:203]
buffer_load_dwordx4 v2, s[20:23], s37 offen  lds
v_and_b32 v5, 65535, v5
v_mfma_f32_16x16x32_bf16 v[204:207], a[164:167], a[204:207], v[204:207]
ds_read_b128 a[240:243], v4 offset:8192
v_mfma_f32_16x16x32_bf16 v[208:211], a[164:167], a[208:211], v[208:211]
v_mfma_f32_16x16x32_bf16 v[212:215], a[164:167], a[212:215], v[212:215]
ds_read_b128 a[244:247], v3 offset:9216
v_mfma_f32_16x16x32_bf16 v[216:219], a[164:167], a[216:219], v[216:219]
v_mfma_f32_16x16x32_bf16 v[220:223], a[164:167], a[220:223], v[220:223]
s_add_u32 s37, s31, 131072
ds_read_b64_tr_b16 a[164:165], v6 offset:0
v_mfma_f32_16x16x32_bf16 v[224:227], a[168:171], a[192:195], v[224:227]
s_add_u32 m0, s33, 4096
ds_read_b64_tr_b16 a[166:167], v6 offset:1024
v_mfma_f32_16x16x32_bf16 v[228:231], a[168:171], a[196:199], v[228:231]
buffer_load_dwordx4 v2, s[20:23], s37 offen  lds
v_xor_b32 v6, 16, v5
v_mfma_f32_16x16x32_bf16 v[232:235], a[168:171], a[200:203], v[232:235]
ds_read_b128 a[248:251], v4 offset:12288
v_mfma_f32_16x16x32_bf16 v[236:239], a[168:171], a[204:207], v[236:239]
v_mfma_f32_16x16x32_bf16 v[240:243], a[168:171], a[208:211], v[240:243]
ds_read_b128 a[252:255], v3 offset:13312
v_mfma_f32_16x16x32_bf16 v[244:247], a[168:171], a[212:215], v[244:247]
v_mfma_f32_16x16x32_bf16 v[248:251], a[168:171], a[216:219], v[248:251]
s_add_u32 s37, s31, 163840
ds_read_b64_tr_b16 v[28:29], v12 offset:0
v_mfma_f32_16x16x32_bf16 v[252:255], a[168:171], a[220:223], v[252:255]
s_add_u32 m0, s33, 5120
ds_read_b64_tr_b16 a[168:169], v7 offset:0
v_mfma_f32_16x16x32_bf16 a[0:3], a[172:175], a[192:195], a[0:3]
buffer_load_dwordx4 v2, s[20:23], s37 offen  lds
ds_read_b64_tr_b16 a[170:171], v7 offset:1024
v_mfma_f32_16x16x32_bf16 a[4:7], a[172:175], a[196:199], a[4:7]
s_add_u32 s31, s31, 262144
s_add_u32 s29, s29, s93
v_xor_b32 v7, 64, v5
v_mfma_f32_16x16x32_bf16 a[8:11], a[172:175], a[200:203], a[8:11]
s_add_u32 s33, s33, 16384
ds_read_b64_tr_b16 v[30:31], v12 offset:1024
v_mfma_f32_16x16x32_bf16 a[12:15], a[172:175], a[204:207], a[12:15]
s_and_b32 s33, s33, 65535
buffer_store_dwordx4 v[48:51], v13, s[8:11], s29 offen sc1
v_mfma_f32_16x16x32_bf16 a[16:19], a[172:175], a[208:211], a[16:19]
v_mfma_f32_16x16x32_bf16 a[20:23], a[172:175], a[212:215], a[20:23]
s_add_u32 s48, s48, s34
v_xor_b32 v12, 208, v5
v_mfma_f32_16x16x32_bf16 a[24:27], a[172:175], a[216:219], a[24:27]
s_add_u32 m0, s32, 16384
v_add_u32 v3, 32768, v3
v_mfma_f32_16x16x32_bf16 a[28:31], a[172:175], a[220:223], a[28:31]
buffer_load_dwordx4 v1, s[12:15], s48 offen lds
ds_read_b64_tr_b16 a[172:173], v8 offset:0
v_mfma_f32_16x16x32_bf16 a[32:35], a[176:179], a[192:195], a[32:35]
ds_read_b64_tr_b16 a[174:175], v8 offset:1024
v_subrev_u32 v19, 98304, v3
v_mfma_f32_16x16x32_bf16 a[36:39], a[176:179], a[196:199], a[36:39]
v_xor_b32 v8, 80, v5
v_cmp_le_u32 vcc, 163840, v3
v_mfma_f32_16x16x32_bf16 a[40:43], a[176:179], a[200:203], a[40:43]
s_nop 0
v_cndmask_b32 v3, v3, v19, vcc
v_mfma_f32_16x16x32_bf16 a[44:47], a[176:179], a[204:207], a[44:47]
v_xor_b32 v4, 64, v3
v_mfma_f32_16x16x32_bf16 a[48:51], a[176:179], a[208:211], a[48:51]
s_add_u32 s48, s48, s34
v_mfma_f32_16x16x32_bf16 a[52:55], a[176:179], a[212:215], a[52:55]
s_add_u32 m0, s32, 20480
v_mfma_f32_16x16x32_bf16 a[56:59], a[176:179], a[216:219], a[56:59]
buffer_load_dwordx4 v1, s[12:15], s48 offen lds
v_mfma_f32_16x16x32_bf16 a[60:63], a[176:179], a[220:223], a[60:63]
ds_read_b64_tr_b16 a[176:177], v9 offset:0
v_mfma_f32_16x16x32_bf16 a[64:67], a[180:183], a[192:195], a[64:67]
ds_read_b64_tr_b16 a[178:179], v9 offset:1024
v_mfma_f32_16x16x32_bf16 a[68:71], a[180:183], a[196:199], a[68:71]
v_xor_b32 v9, 128, v5
v_mfma_f32_16x16x32_bf16 a[72:75], a[180:183], a[200:203], a[72:75]
v_mfma_f32_16x16x32_bf16 a[76:79], a[180:183], a[204:207], a[76:79]
s_add_u32 s48, s48, s34
v_mfma_f32_16x16x32_bf16 a[80:83], a[180:183], a[208:211], a[80:83]
s_add_u32 m0, s32, 24576
v_mfma_f32_16x16x32_bf16 a[84:87], a[180:183], a[212:215], a[84:87]
buffer_load_dwordx4 v1, s[12:15], s48 offen lds
v_mfma_f32_16x16x32_bf16 a[88:91], a[180:183], a[216:219], a[88:91]
s_add_u32 s29, s29, s44
v_mfma_f32_16x16x32_bf16 a[92:95], a[180:183], a[220:223], a[92:95]
ds_read_b64_tr_b16 a[180:181], v10 offset:0
v_mfma_f32_16x16x32_bf16 a[96:99], a[184:187], a[192:195], a[96:99]
buffer_store_dwordx4 v[52:55], v13, s[8:11], s29 offen sc1
ds_read_b64_tr_b16 a[182:183], v10 offset:1024
v_mfma_f32_16x16x32_bf16 a[100:103], a[184:187], a[196:199], a[100:103]
v_xor_b32 v10, 144, v5
v_mfma_f32_16x16x32_bf16 a[104:107], a[184:187], a[200:203], a[104:107]
s_add_u32 s48, s48, s34
v_mfma_f32_16x16x32_bf16 a[108:111], a[184:187], a[204:207], a[108:111]
s_add_u32 m0, s32, 28672
v_mfma_f32_16x16x32_bf16 a[112:115], a[184:187], a[208:211], a[112:115]
buffer_load_dwordx4 v1, s[12:15], s48 offen lds
v_mfma_f32_16x16x32_bf16 a[116:119], a[184:187], a[212:215], a[116:119]
s_add_u32 s30, s30, 128
v_mfma_f32_16x16x32_bf16 a[120:123], a[184:187], a[216:219], a[120:123]
s_add_u32 s32, s32, 32768
v_mfma_f32_16x16x32_bf16 a[124:127], a[184:187], a[220:223], a[124:127]
s_sub_u32 s48, s32, 98304
ds_read_b64_tr_b16 a[184:185], v11 offset:0
v_mfma_f32_16x16x32_bf16 a[128:131], a[188:191], a[192:195], a[128:131]
s_cmp_ge_u32 s32, 163840
s_cselect_b32 s32, s48, s32
ds_read_b64_tr_b16 a[186:187], v11 offset:1024
v_mfma_f32_16x16x32_bf16 a[132:135], a[188:191], a[196:199], a[132:135]
v_xor_b32 v11, 192, v5
v_mfma_f32_16x16x32_bf16 a[136:139], a[188:191], a[200:203], a[136:139]
buffer_load_dword v15, v14, s[96:99], s100 offen
v_mfma_f32_16x16x32_bf16 a[140:143], a[188:191], a[204:207], a[140:143]
s_add_u32 s100, s100, 16384
v_mfma_f32_16x16x32_bf16 a[144:147], a[188:191], a[208:211], a[144:147]
v_mfma_f32_16x16x32_bf16 a[148:151], a[188:191], a[212:215], a[148:151]
v_mfma_f32_16x16x32_bf16 a[152:155], a[188:191], a[216:219], a[152:155]
v_mfma_f32_16x16x32_bf16 a[156:159], a[188:191], a[220:223], a[156:159]
s_waitcnt vmcnt(24) lgkmcnt(0)
s_barrier
v_mfma_f32_16x16x32_bf16 v[160:163], a[160:163], a[224:227], v[160:163]
ds_read_b128 a[192:195], v3 offset:0
v_mfma_f32_16x16x32_bf16 v[164:167], a[160:163], a[228:231], v[164:167]
s_add_u32 s37, s31, 0
v_mfma_f32_16x16x32_bf16 v[168:171], a[160:163], a[232:235], v[168:171]
s_add_u32 m0, s33, 0
ds_read_b128 a[196:199], v4 offset:1024
v_mfma_f32_16x16x32_bf16 v[172:175], a[160:163], a[236:239], v[172:175]
buffer_load_dwordx4 v2, s[20:23], s37 offen  lds
v_mfma_f32_16x16x32_bf16 v[176:179], a[160:163], a[240:243], v[176:179]
s_add_u32 s29, s29, s93
ds_read_b128 a[200:203], v3 offset:4096
v_mfma_f32_16x16x32_bf16 v[180:183], a[160:163], a[244:247], v[180:183]
v_mfma_f32_16x16x32_bf16 v[184:187], a[160:163], a[248:251], v[184:187]
buffer_store_dwordx4 v[56:59], v13, s[8:11], s29 offen sc1
v_mfma_f32_16x16x32_bf16 v[188:191], a[160:163], a[252:255], v[188:191]
ds_read_b64_tr_b16 a[160:161], v5 offset:0
v_mfma_f32_16x16x32_bf16 v[192:195], a[164:167], a[224:227], v[192:195]
s_add_u32 s37, s31, 32768
ds_read_b64_tr_b16 a[162:163], v5 offset:1024
v_mfma_f32_16x16x32_bf16 v[196:199], a[164:167], a[228:231], v[196:199]
s_add_u32 m0, s33, 1024
ds_read_b128 a[204:207], v4 offset:5120
v_add_u32 v5, 16384, v5
v_mfma_f32_16x16x32_bf16 v[200:203], a[164:167], a[232:235], v[200:203]
buffer_load_dwordx4 v2, s[20:23], s37 offen  lds
v_and_b32 v5, 65535, v5
v_mfma_f32_16x16x32_bf16 v[204:207], a[164:167], a[236:239], v[204:207]
ds_read_b128 a[208:211], v3 offset:8192
v_mfma_f32_16x16x32_bf16 v[208:211], a[164:167], a[240:243], v[208:211]
v_mfma_f32_16x16x32_bf16 v[212:215], a[164:167], a[244:247], v[212:215]
ds_read_b128 a[212:215], v4 offset:9216
v_mfma_f32_16x16x32_bf16 v[216:219], a[164:167], a[248:251], v[216:219]
v_mfma_f32_16x16x32_bf16 v[220:223], a[164:167], a[252:255], v[220:223]
s_add_u32 s37, s31, 131072
ds_read_b64_tr_b16 a[164:165], v6 offset:0
v_mfma_f32_16x16x32_bf16 v[224:227], a[168:171], a[224:227], v[224:227]
s_add_u32 m0, s33, 4096
ds_read_b64_tr_b16 a[166:167], v6 offset:1024
v_mfma_f32_16x16x32_bf16 v[228:231], a[168:171], a[228:231], v[228:231]
buffer_load_dwordx4 v2, s[20:23], s37 offen  lds
v_xor_b32 v6, 16, v5
v_mfma_f32_16x16x32_bf16 v[232:235], a[168:171], a[232:235], v[232:235]
ds_read_b128 a[216:219], v3 offset:12288
v_mfma_f32_16x16x32_bf16 v[236:239], a[168:171], a[236:239], v[236:239]
v_mfma_f32_16x16x32_bf16 v[240:243], a[168:171], a[240:243], v[240:243]
ds_read_b128 a[220:223], v4 offset:13312
v_mfma_f32_16x16x32_bf16 v[244:247], a[168:171], a[244:247], v[244:247]
v_mfma_f32_16x16x32_bf16 v[248:251], a[168:171], a[248:251], v[248:251]
s_add_u32 s37, s31, 163840
ds_read_b64_tr_b16 a[188:189], v12 offset:0
v_mfma_f32_16x16x32_bf16 v[252:255], a[168:171], a[252:255], v[252:255]
s_add_u32 m0, s33, 5120
ds_read_b64_tr_b16 a[168:169], v7 offset:0
v_mfma_f32_16x16x32_bf16 a[0:3], a[172:175], a[224:227], a[0:3]
buffer_load_dwordx4 v2, s[20:23], s37 offen  lds
ds_read_b64_tr_b16 a[170:171], v7 offset:1024
v_mfma_f32_16x16x32_bf16 a[4:7], a[172:175], a[228:231], a[4:7]
s_add_u32 s31, s31, 262144
s_add_u32 s29, s29, s44
v_xor_b32 v7, 64, v5
v_mfma_f32_16x16x32_bf16 a[8:11], a[172:175], a[232:235], a[8:11]
s_add_u32 s33, s33, 16384
ds_read_b64_tr_b16 a[190:191], v12 offset:1024
v_mfma_f32_16x16x32_bf16 a[12:15], a[172:175], a[236:239], a[12:15]
s_and_b32 s33, s33, 65535
buffer_store_dwordx4 v[60:63], v13, s[8:11], s29 offen sc1
v_mfma_f32_16x16x32_bf16 a[16:19], a[172:175], a[240:243], a[16:19]
v_mfma_f32_16x16x32_bf16 a[20:23], a[172:175], a[244:247], a[20:23]
s_mov_b32 s48, s30
v_xor_b32 v12, 208, v5
v_mfma_f32_16x16x32_bf16 a[24:27], a[172:175], a[248:251], a[24:27]
s_add_u32 m0, s32, 0
v_mfma_f32_16x16x32_bf16 a[28:31], a[172:175], a[252:255], a[28:31]
buffer_load_dwordx4 v1, s[12:15], s48 offen lds
ds_read_b64_tr_b16 a[172:173], v8 offset:0
v_mfma_f32_16x16x32_bf16 a[32:35], a[176:179], a[224:227], a[32:35]
ds_read_b64_tr_b16 a[174:175], v8 offset:1024
v_mfma_f32_16x16x32_bf16 a[36:39], a[176:179], a[228:231], a[36:39]
v_xor_b32 v8, 80, v5
v_mfma_f32_16x16x32_bf16 a[40:43], a[176:179], a[232:235], a[40:43]
v_mfma_f32_16x16x32_bf16 a[44:47], a[176:179], a[236:239], a[44:47]
v_mfma_f32_16x16x32_bf16 a[48:51], a[176:179], a[240:243], a[48:51]
s_add_u32 s48, s48, s34
v_mfma_f32_16x16x32_bf16 a[52:55], a[176:179], a[244:247], a[52:55]
s_add_u32 m0, s32, 4096
v_mfma_f32_16x16x32_bf16 a[56:59], a[176:179], a[248:251], a[56:59]
buffer_load_dwordx4 v1, s[12:15], s48 offen lds
v_mfma_f32_16x16x32_bf16 a[60:63], a[176:179], a[252:255], a[60:63]
ds_read_b64_tr_b16 a[176:177], v9 offset:0
v_mfma_f32_16x16x32_bf16 a[64:67], a[180:183], a[224:227], a[64:67]
ds_read_b64_tr_b16 a[178:179], v9 offset:1024
v_mfma_f32_16x16x32_bf16 a[68:71], a[180:183], a[228:231], a[68:71]
v_xor_b32 v9, 128, v5
v_mfma_f32_16x16x32_bf16 a[72:75], a[180:183], a[232:235], a[72:75]
v_mfma_f32_16x16x32_bf16 a[76:79], a[180:183], a[236:239], a[76:79]
s_add_u32 s48, s48, s34
v_mfma_f32_16x16x32_bf16 a[80:83], a[180:183], a[240:243], a[80:83]
s_add_u32 m0, s32, 8192
v_mfma_f32_16x16x32_bf16 a[84:87], a[180:183], a[244:247], a[84:87]
buffer_load_dwordx4 v1, s[12:15], s48 offen lds
v_mfma_f32_16x16x32_bf16 a[88:91], a[180:183], a[248:251], a[88:91]
v_mfma_f32_16x16x32_bf16 a[92:95], a[180:183], a[252:255], a[92:95]
ds_read_b64_tr_b16 a[180:181], v10 offset:0
v_mfma_f32_16x16x32_bf16 a[96:99], a[184:187], a[224:227], a[96:99]
ds_read_b64_tr_b16 a[182:183], v10 offset:1024
v_mfma_f32_16x16x32_bf16 a[100:103], a[184:187], a[228:231], a[100:103]
v_xor_b32 v10, 144, v5
v_mfma_f32_16x16x32_bf16 a[104:107], a[184:187], a[232:235], a[104:107]
s_add_u32 s48, s48, s34
v_mfma_f32_16x16x32_bf16 a[108:111], a[184:187], a[236:239], a[108:111]
s_add_u32 m0, s32, 12288
v_mfma_f32_16x16x32_bf16 a[112:115], a[184:187], a[240:243], a[112:115]
buffer_load_dwordx4 v1, s[12:15], s48 offen lds
v_mfma_f32_16x16x32_bf16 a[116:119], a[184:187], a[244:247], a[116:119]
v_mfma_f32_16x16x32_bf16 a[120:123], a[184:187], a[248:251], a[120:123]
v_mfma_f32_16x16x32_bf16 a[124:127], a[184:187], a[252:255], a[124:127]
ds_read_b64_tr_b16 a[184:185], v11 offset:0
v_mfma_f32_16x16x32_bf16 a[128:131], v[28:31], a[224:227], a[128:131]
ds_read_b64_tr_b16 a[186:187], v11 offset:1024
v_mfma_f32_16x16x32_bf16 a[132:135], v[28:31], a[228:231], a[132:135]
v_xor_b32 v11, 192, v5
v_mfma_f32_16x16x32_bf16 a[136:139], v[28:31], a[232:235], a[136:139]
buffer_load_dword v15, v14, s[96:99], s100 offen
v_mfma_f32_16x16x32_bf16 a[140:143], v[28:31], a[236:239], a[140:143]
s_add_u32 s100, s100, 16384
v_mfma_f32_16x16x32_bf16 a[144:147], v[28:31], a[240:243], a[144:147]
v_mfma_f32_16x16x32_bf16 a[148:151], v[28:31], a[244:247], a[148:151]
v_mfma_f32_16x16x32_bf16 a[152:155], v[28:31], a[248:251], a[152:155]
v_mfma_f32_16x16x32_bf16 a[156:159], v[28:31], a[252:255], a[156:159]
s_waitcnt vmcnt(23) lgkmcnt(0)
s_barrier
v_mfma_f32_16x16x32_bf16 v[160:163], a[160:163], a[192:195], v[160:163]
ds_read_b128 a[224:227], v4 offset:0
v_mfma_f32_16x16x32_bf16 v[164:167], a[160:163], a[196:199], v[164:167]
s_add_u32 s37, s31, 0
v_mfma_f32_16x16x32_bf16 v[168:171], a[160:163], a[200:203], v[168:171]
s_add_u32 m0, s33, 0
ds_read_b128 a[228:231], v3 offset:1024
v_mfma_f32_16x16x32_bf16 v[172:175], a[160:163], a[204:207], v[172:175]
buffer_load_dwordx4 v2, s[20:23], s37 offen  lds
v_mfma_f32_16x16x32_bf16 v[176:179], a[160:163], a[208:211], v[176:179]
s_add_u32 s60, s60, s92
ds_read_b128 a[232:235], v4 offset:4096
v_mfma_f32_16x16x32_bf16 v[180:183], a[160:163], a[212:215], v[180:183]
s_mov_b32 s29, s60
v_mfma_f32_16x16x32_bf16 v[184:187], a[160:163], a[216:219], v[184:187]
buffer_store_dwordx4 v[64:67], v13, s[8:11], s29 offen sc1
v_mfma_f32_16x16x32_bf16 v[188:191], a[160:163], a[220:223], v[188:191]
ds_read_b64_tr_b16 a[160:161], v5 offset:0
v_mfma_f32_16x16x32_bf16 v[192:195], a[164:167], a[192:195], v[192:195]
s_add_u32 s37, s31, 32768
ds_read_b64_tr_b16 a[162:163], v5 offset:1024
v_mfma_f32_16x16x32_bf16 v[196:199], a[164:167], a[196:199], v[196:199]
s_add_u32 m0, s33, 1024
ds_read_b128 a[236:239], v3 offset:5120
v_add_u32 v5, 16384, v5
v_mfma_f32_16x16x32_bf16 v[200:203], a[164:167], a[200:203], v[200:203]
buffer_load_dwordx4 v2, s[20:23], s37 offen  lds
v_and_b32 v5, 65535, v5
v_mfma_f32_16x16x32_bf16 v[204:207], a[164:167], a[204:207], v[204:207]
ds_read_b128 a[240:243], v4 offset:8192
v_mfma_f32_16x16x32_bf16 v[208:211], a[164:167], a[208:211], v[208:211]
v_mfma_f32_16x16x32_bf16 v[212:215], a[164:167], a[212:215], v[212:215]
ds_read_b128 a[244:247], v3 offset:9216
v_mfma_f32_16x16x32_bf16 v[216:219], a[164:167], a[216:219], v[216:219]
v_mfma_f32_16x16x32_bf16 v[220:223], a[164:167], a[220:223], v[220:223]
s_add_u32 s37, s31, 131072
ds_read_b64_tr_b16 a[164:165], v6 offset:0
v_mfma_f32_16x16x32_bf16 v[224:227], a[168:171], a[192:195], v[224:227]
s_add_u32 m0, s33, 4096
ds_read_b64_tr_b16 a[166:167], v6 offset:1024
v_mfma_f32_16x16x32_bf16 v[228:231], a[168:171], a[196:199], v[228:231]
buffer_load_dwordx4 v2, s[20:23], s37 offen  lds
v_xor_b32 v6, 16, v5
v_mfma_f32_16x16x32_bf16 v[232:235], a[168:171], a[200:203], v[232:235]
ds_read_b128 a[248:251], v4 offset:12288
v_mfma_f32_16x16x32_bf16 v[236:239], a[168:171], a[204:207], v[236:239]
v_mfma_f32_16x16x32_bf16 v[240:243], a[168:171], a[208:211], v[240:243]
ds_read_b128 a[252:255], v3 offset:13312
v_mfma_f32_16x16x32_bf16 v[244:247], a[168:171], a[212:215], v[244:247]
v_mfma_f32_16x16x32_bf16 v[248:251], a[168:171], a[216:219], v[248:251]
s_add_u32 s37, s31, 163840
ds_read_b64_tr_b16 v[28:29], v12 offset:0
v_mfma_f32_16x16x32_bf16 v[252:255], a[168:171], a[220:223], v[252:255]
s_add_u32 m0, s33, 5120
ds_read_b64_tr_b16 a[168:169], v7 offset:0
v_mfma_f32_16x16x32_bf16 a[0:3], a[172:175], a[192:195], a[0:3]
buffer_load_dwordx4 v2, s[20:23], s37 offen  lds
ds_read_b64_tr_b16 a[170:171], v7 offset:1024
v_mfma_f32_16x16x32_bf16 a[4:7], a[172:175], a[196:199], a[4:7]
s_add_u32 s31, s31, 262144
s_add_u32 s29, s29, s44
v_xor_b32 v7, 64, v5
v_mfma_f32_16x16x32_bf16 a[8:11], a[172:175], a[200:203], a[8:11]
s_add_u32 s33, s33, 16384
ds_read_b64_tr_b16 v[30:31], v12 offset:1024
v_mfma_f32_16x16x32_bf16 a[12:15], a[172:175], a[204:207], a[12:15]
s_and_b32 s33, s33, 65535
buffer_store_dwordx4 v[68:71], v13, s[8:11], s29 offen sc1
v_mfma_f32_16x16x32_bf16 a[16:19], a[172:175], a[208:211], a[16:19]
v_mfma_f32_16x16x32_bf16 a[20:23], a[172:175], a[212:215], a[20:23]
s_add_u32 s48, s48, s34
v_xor_b32 v12, 208, v5
v_mfma_f32_16x16x32_bf16 a[24:27], a[172:175], a[216:219], a[24:27]
s_add_u32 m0, s32, 16384
v_add_u32 v3, 32768, v3
v_mfma_f32_16x16x32_bf16 a[28:31], a[172:175], a[220:223], a[28:31]
buffer_load_dwordx4 v1, s[12:15], s48 offen lds
ds_read_b64_tr_b16 a[172:173], v8 offset:0
v_mfma_f32_16x16x32_bf16 a[32:35], a[176:179], a[192:195], a[32:35]
ds_read_b64_tr_b16 a[174:175], v8 offset:1024
v_subrev_u32 v19, 98304, v3
v_mfma_f32_16x16x32_bf16 a[36:39], a[176:179], a[196:199], a[36:39]
v_xor_b32 v8, 80, v5
v_cmp_le_u32 vcc, 163840, v3
v_mfma_f32_16x16x32_bf16 a[40:43], a[176:179], a[200:203], a[40:43]
s_nop 0
v_cndmask_b32 v3, v3, v19, vcc
v_mfma_f32_16x16x32_bf16 a[44:47], a[176:179], a[204:207], a[44:47]
v_xor_b32 v4, 64, v3
v_mfma_f32_16x16x32_bf16 a[48:51], a[176:179], a[208:211], a[48:51]
s_add_u32 s48, s48, s34
v_mfma_f32_16x16x32_bf16 a[52:55], a[176:179], a[212:215], a[52:55]
s_add_u32 m0, s32, 20480
v_mfma_f32_16x16x32_bf16 a[56:59], a[176:179], a[216:219], a[56:59]
buffer_load_dwordx4 v1, s[12:15], s48 offen lds
v_mfma_f32_16x16x32_bf16 a[60:63], a[176:179], a[220:223], a[60:63]
ds_read_b64_tr_b16 a[176:177], v9 offset:0
v_mfma_f32_16x16x32_bf16 a[64:67], a[180:183], a[192:195], a[64:67]
ds_read_b64_tr_b16 a[178:179], v9 offset:1024
v_mfma_f32_16x16x32_bf16 a[68:71], a[180:183], a[196:199], a[68:71]
v_xor_b32 v9, 128, v5
v_mfma_f32_16x16x32_bf16 a[72:75], a[180:183], a[200:203], a[72:75]
v_mfma_f32_16x16x32_bf16 a[76:79], a[180:183], a[204:207], a[76:79]
s_add_u32 s48, s48, s34
v_mfma_f32_16x16x32_bf16 a[80:83], a[180:183], a[208:211], a[80:83]
s_add_u32 m0, s32, 24576
v_mfma_f32_16x16x32_bf16 a[84:87], a[180:183], a[212:215], a[84:87]
buffer_load_dwordx4 v1, s[12:15], s48 offen lds
v_mfma_f32_16x16x32_bf16 a[88:91], a[180:183], a[216:219], a[88:91]
s_add_u32 s29, s29, s93
v_mfma_f32_16x16x32_bf16 a[92:95], a[180:183], a[220:223], a[92:95]
ds_read_b64_tr_b16 a[180:181], v10 offset:0
v_mfma_f32_16x16x32_bf16 a[96:99], a[184:187], a[192:195], a[96:99]
buffer_store_dwordx4 v[72:75], v13, s[8:11], s29 offen sc1
ds_read_b64_tr_b16 a[182:183], v10 offset:1024
v_mfma_f32_16x16x32_bf16 a[100:103], a[184:187], a[196:199], a[100:103]
v_xor_b32 v10, 144, v5
v_mfma_f32_16x16x32_bf16 a[104:107], a[184:187], a[200:203], a[104:107]
s_add_u32 s48, s48, s34
v_mfma_f32_16x16x32_bf16 a[108:111], a[184:187], a[204:207], a[108:111]
s_add_u32 m0, s32, 28672
v_mfma_f32_16x16x32_bf16 a[112:115], a[184:187], a[208:211], a[112:115]
buffer_load_dwordx4 v1, s[12:15], s48 offen lds
v_mfma_f32_16x16x32_bf16 a[116:119], a[184:187], a[212:215], a[116:119]
s_add_u32 s30, s30, 128
v_mfma_f32_16x16x32_bf16 a[120:123], a[184:187], a[216:219], a[120:123]
s_add_u32 s32, s32, 32768
v_mfma_f32_16x16x32_bf16 a[124:127], a[184:187], a[220:223], a[124:127]
s_sub_u32 s48, s32, 98304
ds_read_b64_tr_b16 a[184:185], v11 offset:0
v_mfma_f32_16x16x32_bf16 a[128:131], a[188:191], a[192:195], a[128:131]
s_cmp_ge_u32 s32, 163840
s_cselect_b32 s32, s48, s32
ds_read_b64_tr_b16 a[186:187], v11 offset:1024
v_mfma_f32_16x16x32_bf16 a[132:135], a[188:191], a[196:199], a[132:135]
v_xor_b32 v11, 192, v5
v_mfma_f32_16x16x32_bf16 a[136:139], a[188:191], a[200:203], a[136:139]
buffer_load_dword v15, v14, s[96:99], s100 offen
v_mfma_f32_16x16x32_bf16 a[140:143], a[188:191], a[204:207], a[140:143]
s_add_u32 s100, s100, 16384
v_mfma_f32_16x16x32_bf16 a[144:147], a[188:191], a[208:211], a[144:147]
v_mfma_f32_16x16x32_bf16 a[148:151], a[188:191], a[212:215], a[148:151]
v_mfma_f32_16x16x32_bf16 a[152:155], a[188:191], a[216:219], a[152:155]
v_mfma_f32_16x16x32_bf16 a[156:159], a[188:191], a[220:223], a[156:159]
s_waitcnt vmcnt(23) lgkmcnt(0)
s_barrier
v_mfma_f32_16x16x32_bf16 v[160:163], a[160:163], a[224:227], v[160:163]
ds_read_b128 a[192:195], v3 offset:0
v_mfma_f32_16x16x32_bf16 v[164:167], a[160:163], a[228:231], v[164:167]
s_add_u32 s37, s31, 0
v_mfma_f32_16x16x32_bf16 v[168:171], a[160:163], a[232:235], v[168:171]
s_add_u32 m0, s33, 0
ds_read_b128 a[196:199], v4 offset:1024
v_mfma_f32_16x16x32_bf16 v[172:175], a[160:163], a[236:239], v[172:175]
buffer_load_dwordx4 v2, s[20:23], s37 offen  lds
v_mfma_f32_16x16x32_bf16 v[176:179], a[160:163], a[240:243], v[176:179]
s_add_u32 s29, s29, s44
ds_read_b128 a[200:203], v3 offset:4096
v_mfma_f32_16x16x32_bf16 v[180:183], a[160:163], a[244:247], v[180:183]
v_mfma_f32_16x16x32_bf16 v[184:187], a[160:163], a[248:251], v[184:187]
buffer_store_dwordx4 v[76:79], v13, s[8:11], s29 offen sc1
v_mfma_f32_16x16x32_bf16 v[188:191], a[160:163], a[252:255], v[188:191]
ds_read_b64_tr_b16 a[160:161], v5 offset:0
v_mfma_f32_16x16x32_bf16 v[192:195], a[164:167], a[224:227], v[192:195]
s_add_u32 s37, s31, 32768
ds_read_b64_tr_b16 a[162:163], v5 offset:1024
v_mfma_f32_16x16x32_bf16 v[196:199], a[164:167], a[228:231], v[196:199]
s_add_u32 m0, s33, 1024
ds_read_b128 a[204:207], v4 offset:5120
v_add_u32 v5, 16384, v5
v_mfma_f32_16x16x32_bf16 v[200:203], a[164:167], a[232:235], v[200:203]
buffer_load_dwordx4 v2, s[20:23], s37 offen  lds
v_and_b32 v5, 65535, v5
v_mfma_f32_16x16x32_bf16 v[204:207], a[164:167], a[236:239], v[204:207]
ds_read_b128 a[208:211], v3 offset:8192
v_mfma_f32_16x16x32_bf16 v[208:211], a[164:167], a[240:243], v[208:211]
v_mfma_f32_16x16x32_bf16 v[212:215], a[164:167], a[244:247], v[212:215]
ds_read_b128 a[212:215], v4 offset:9216
v_mfma_f32_16x16x32_bf16 v[216:219], a[164:167], a[248:251], v[216:219]
v_mfma_f32_16x16x32_bf16 v[220:223], a[164:167], a[252:255], v[220:223]
s_add_u32 s37, s31, 131072
ds_read_b64_tr_b16 a[164:165], v6 offset:0
v_mfma_f32_16x16x32_bf16 v[224:227], a[168:171], a[224:227], v[224:227]
s_add_u32 m0, s33, 4096
ds_read_b64_tr_b16 a[166:167], v6 offset:1024
v_mfma_f32_16x16x32_bf16 v[228:231], a[168:171], a[228:231], v[228:231]
buffer_load_dwordx4 v2, s[20:23], s37 offen  lds
v_xor_b32 v6, 16, v5
v_mfma_f32_16x16x32_bf16 v[232:235], a[168:171], a[232:235], v[232:235]
ds_read_b128 a[216:219], v3 offset:12288
v_mfma_f32_16x16x32_bf16 v[236:239], a[168:171], a[236:239], v[236:239]
v_mfma_f32_16x16x32_bf16 v[240:243], a[168:171], a[240:243], v[240:243]
ds_read_b128 a[220:223], v4 offset:13312
v_mfma_f32_16x16x32_bf16 v[244:247], a[168:171], a[244:247], v[244:247]
v_mfma_f32_16x16x32_bf16 v[248:251], a[168:171], a[248:251], v[248:251]
s_add_u32 s37, s31, 163840
ds_read_b64_tr_b16 a[188:189], v12 offset:0
v_mfma_f32_16x16x32_bf16 v[252:255], a[168:171], a[252:255], v[252:255]
s_add_u32 m0, s33, 5120
ds_read_b64_tr_b16 a[168:169], v7 offset:0
v_mfma_f32_16x16x32_bf16 a[0:3], a[172:175], a[224:227], a[0:3]
buffer_load_dwordx4 v2, s[20:23], s37 offen  lds
ds_read_b64_tr_b16 a[170:171], v7 offset:1024
v_mfma_f32_16x16x32_bf16 a[4:7], a[172:175], a[228:231], a[4:7]
s_add_u32 s31, s31, 262144
s_add_u32 s29, s29, s93
v_xor_b32 v7, 64, v5
v_mfma_f32_16x16x32_bf16 a[8:11], a[172:175], a[232:235], a[8:11]
s_add_u32 s33, s33, 16384
ds_read_b64_tr_b16 a[190:191], v12 offset:1024
v_mfma_f32_16x16x32_bf16 a[12:15], a[172:175], a[236:239], a[12:15]
s_and_b32 s33, s33, 65535
buffer_store_dwordx4 v[80:83], v13, s[8:11], s29 offen sc1
v_mfma_f32_16x16x32_bf16 a[16:19], a[172:175], a[240:243], a[16:19]
v_mfma_f32_16x16x32_bf16 a[20:23], a[172:175], a[244:247], a[20:23]
s_mov_b32 s48, s30
v_xor_b32 v12, 208, v5
v_mfma_f32_16x16x32_bf16 a[24:27], a[172:175], a[248:251], a[24:27]
s_add_u32 m0, s32, 0
v_mfma_f32_16x16x32_bf16 a[28:31], a[172:175], a[252:255], a[28:31]
buffer_load_dwordx4 v1, s[12:15], s48 offen lds
ds_read_b64_tr_b16 a[172:173], v8 offset:0
v_mfma_f32_16x16x32_bf16 a[32:35], a[176:179], a[224:227], a[32:35]
ds_read_b64_tr_b16 a[174:175], v8 offset:1024
v_mfma_f32_16x16x32_bf16 a[36:39], a[176:179], a[228:231], a[36:39]
v_xor_b32 v8, 80, v5
v_mfma_f32_16x16x32_bf16 a[40:43], a[176:179], a[232:235], a[40:43]
v_mfma_f32_16x16x32_bf16 a[44:47], a[176:179], a[236:239], a[44:47]
v_mfma_f32_16x16x32_bf16 a[48:51], a[176:179], a[240:243], a[48:51]
s_add_u32 s48, s48, s34
v_mfma_f32_16x16x32_bf16 a[52:55], a[176:179], a[244:247], a[52:55]
s_add_u32 m0, s32, 4096
v_mfma_f32_16x16x32_bf16 a[56:59], a[176:179], a[248:251], a[56:59]
buffer_load_dwordx4 v1, s[12:15], s48 offen lds
v_mfma_f32_16x16x32_bf16 a[60:63], a[176:179], a[252:255], a[60:63]
ds_read_b64_tr_b16 a[176:177], v9 offset:0
v_mfma_f32_16x16x32_bf16 a[64:67], a[180:183], a[224:227], a[64:67]
ds_read_b64_tr_b16 a[178:179], v9 offset:1024
v_mfma_f32_16x16x32_bf16 a[68:71], a[180:183], a[228:231], a[68:71]
v_xor_b32 v9, 128, v5
v_mfma_f32_16x16x32_bf16 a[72:75], a[180:183], a[232:235], a[72:75]
v_mfma_f32_16x16x32_bf16 a[76:79], a[180:183], a[236:239], a[76:79]
s_add_u32 s48, s48, s34
v_mfma_f32_16x16x32_bf16 a[80:83], a[180:183], a[240:243], a[80:83]
s_add_u32 m0, s32, 8192
v_mfma_f32_16x16x32_bf16 a[84:87], a[180:183], a[244:247], a[84:87]
buffer_load_dwordx4 v1, s[12:15], s48 offen lds
v_mfma_f32_16x16x32_bf16 a[88:91], a[180:183], a[248:251], a[88:91]
s_add_u32 s29, s29, s44
v_mfma_f32_16x16x32_bf16 a[92:95], a[180:183], a[252:255], a[92:95]
ds_read_b64_tr_b16 a[180:181], v10 offset:0
v_mfma_f32_16x16x32_bf16 a[96:99], a[184:187], a[224:227], a[96:99]
buffer_store_dwordx4 v[84:87], v13, s[8:11], s29 offen sc1
ds_read_b64_tr_b16 a[182:183], v10 offset:1024
v_mfma_f32_16x16x32_bf16 a[100:103], a[184:187], a[228:231], a[100:103]
v_xor_b32 v10, 144, v5
v_mfma_f32_16x16x32_bf16 a[104:107], a[184:187], a[232:235], a[104:107]
s_add_u32 s48, s48, s34
v_mfma_f32_16x16x32_bf16 a[108:111], a[184:187], a[236:239], a[108:111]
s_add_u32 m0, s32, 12288
v_mfma_f32_16x16x32_bf16 a[112:115], a[184:187], a[240:243], a[112:115]
buffer_load_dwordx4 v1, s[12:15], s48 offen lds
v_mfma_f32_16x16x32_bf16 a[116:119], a[184:187], a[244:247], a[116:119]
v_mfma_f32_16x16x32_bf16 a[120:123], a[184:187], a[248:251], a[120:123]
v_mfma_f32_16x16x32_bf16 a[124:127], a[184:187], a[252:255], a[124:127]
ds_read_b64_tr_b16 a[184:185], v11 offset:0
v_mfma_f32_16x16x32_bf16 a[128:131], v[28:31], a[224:227], a[128:131]
ds_read_b64_tr_b16 a[186:187], v11 offset:1024
v_mfma_f32_16x16x32_bf16 a[132:135], v[28:31], a[228:231], a[132:135]
v_xor_b32 v11, 192, v5
v_mfma_f32_16x16x32_bf16 a[136:139], v[28:31], a[232:235], a[136:139]
buffer_load_dword v15, v14, s[96:99], s100 offen
v_mfma_f32_16x16x32_bf16 a[140:143], v[28:31], a[236:239], a[140:143]
s_add_u32 s100, s100, 16384
v_mfma_f32_16x16x32_bf16 a[144:147], v[28:31], a[240:243], a[144:147]
v_mfma_f32_16x16x32_bf16 a[148:151], v[28:31], a[244:247], a[148:151]
v_mfma_f32_16x16x32_bf16 a[152:155], v[28:31], a[248:251], a[152:155]
v_mfma_f32_16x16x32_bf16 a[156:159], v[28:31], a[252:255], a[156:159]
s_waitcnt vmcnt(24) lgkmcnt(0)
s_barrier
v_mfma_f32_16x16x32_bf16 v[160:163], a[160:163], a[192:195], v[160:163]
ds_read_b128 a[224:227], v4 offset:0
v_mfma_f32_16x16x32_bf16 v[164:167], a[160:163], a[196:199], v[164:167]
s_add_u32 s37, s31, 0
v_mfma_f32_16x16x32_bf16 v[168:171], a[160:163], a[200:203], v[168:171]
s_add_u32 m0, s33, 0
ds_read_b128 a[228:231], v3 offset:1024
v_mfma_f32_16x16x32_bf16 v[172:175], a[160:163], a[204:207], v[172:175]
buffer_load_dwordx4 v2, s[20:23], s37 offen  lds
v_mfma_f32_16x16x32_bf16 v[176:179], a[160:163], a[208:211], v[176:179]
s_add_u32 s29, s29, s93
ds_read_b128 a[232:235], v4 offset:4096
v_mfma_f32_16x16x32_bf16 v[180:183], a[160:163], a[212:215], v[180:183]
v_mfma_f32_16x16x32_bf16 v[184:187], a[160:163], a[216:219], v[184:187]
buffer_store_dwordx4 v[88:91], v13, s[8:11], s29 offen sc1
v_mfma_f32_16x16x32_bf16 v[188:191], a[160:163], a[220:223], v[188:191]
ds_read_b64_tr_b16 a[160:161], v5 offset:0
v_mfma_f32_16x16x32_bf16 v[192:195], a[164:167], a[192:195], v[192:195]
s_add_u32 s37, s31, 32768
ds_read_b64_tr_b16 a[162:163], v5 offset:1024
v_mfma_f32_16x16x32_bf16 v[196:199], a[164:167], a[196:199], v[196:199]
s_add_u32 m0, s33, 1024
ds_read_b128 a[236:239], v3 offset:5120
v_add_u32 v5, 16384, v5
v_mfma_f32_16x16x32_bf16 v[200:203], a[164:167], a[200:203], v[200:203]
buffer_load_dwordx4 v2, s[20:23], s37 offen  lds
v_and_b32 v5, 65535, v5
v_mfma_f32_16x16x32_bf16 v[204:207], a[164:167], a[204:207], v[204:207]
ds_read_b128 a[240:243], v4 offset:8192
v_mfma_f32_16x16x32_bf16 v[208:211], a[164:167], a[208:211], v[208:211]
v_mfma_f32_16x16x32_bf16 v[212:215], a[164:167], a[212:215], v[212:215]
ds_read_b128 a[244:247], v3 offset:9216
v_mfma_f32_16x16x32_bf16 v[216:219], a[164:167], a[216:219], v[216:219]
v_mfma_f32_16x16x32_bf16 v[220:223], a[164:167], a[220:223], v[220:223]
s_add_u32 s37, s31, 131072
ds_read_b64_tr_b16 a[164:165], v6 offset:0
v_mfma_f32_16x16x32_bf16 v[224:227], a[168:171], a[192:195], v[224:227]
s_add_u32 m0, s33, 4096
ds_read_b64_tr_b16 a[166:167], v6 offset:1024
v_mfma_f32_16x16x32_bf16 v[228:231], a[168:171], a[196:199], v[228:231]
buffer_load_dwordx4 v2, s[20:23], s37 offen  lds
v_xor_b32 v6, 16, v5
v_mfma_f32_16x16x32_bf16 v[232:235], a[168:171], a[200:203], v[232:235]
ds_read_b128 a[248:251], v4 offset:12288
v_mfma_f32_16x16x32_bf16 v[236:239], a[168:171], a[204:207], v[236:239]
v_mfma_f32_16x16x32_bf16 v[240:243], a[168:171], a[208:211], v[240:243]
ds_read_b128 a[252:255], v3 offset:13312
v_mfma_f32_16x16x32_bf16 v[244:247], a[168:171], a[212:215], v[244:247]
v_mfma_f32_16x16x32_bf16 v[248:251], a[168:171], a[216:219], v[248:251]
s_add_u32 s37, s31, 163840
ds_read_b64_tr_b16 v[28:29], v12 offset:0
v_mfma_f32_16x16x32_bf16 v[252:255], a[168:171], a[220:223], v[252:255]
s_add_u32 m0, s33, 5120
ds_read_b64_tr_b16 a[168:169], v7 offset:0
v_mfma_f32_16x16x32_bf16 a[0:3], a[172:175], a[192:195], a[0:3]
buffer_load_dwordx4 v2, s[20:23], s37 offen  lds
ds_read_b64_tr_b16 a[170:171], v7 offset:1024
v_mfma_f32_16x16x32_bf16 a[4:7], a[172:175], a[196:199], a[4:7]
s_add_u32 s31, s31, 262144
s_add_u32 s29, s29, s44
v_xor_b32 v7, 64, v5
v_mfma_f32_16x16x32_bf16 a[8:11], a[172:175], a[200:203], a[8:11]
s_add_u32 s33, s33, 16384
ds_read_b64_tr_b16 v[30:31], v12 offset:1024
v_mfma_f32_16x16x32_bf16 a[12:15], a[172:175], a[204:207], a[12:15]
s_and_b32 s33, s33, 65535
buffer_store_dwordx4 v[92:95], v13, s[8:11], s29 offen sc1
v_mfma_f32_16x16x32_bf16 a[16:19], a[172:175], a[208:211], a[16:19]
v_mfma_f32_16x16x32_bf16 a[20:23], a[172:175], a[212:215], a[20:23]
s_add_u32 s48, s48, s34
v_xor_b32 v12, 208, v5
v_mfma_f32_16x16x32_bf16 a[24:27], a[172:175], a[216:219], a[24:27]
s_add_u32 m0, s32, 16384
v_add_u32 v3, 32768, v3
v_mfma_f32_16x16x32_bf16 a[28:31], a[172:175], a[220:223], a[28:31]
buffer_load_dwordx4 v1, s[12:15], s48 offen lds
ds_read_b64_tr_b16 a[172:173], v8 offset:0
v_mfma_f32_16x16x32_bf16 a[32:35], a[176:179], a[192:195], a[32:35]
ds_read_b64_tr_b16 a[174:175], v8 offset:1024
v_subrev_u32 v19, 98304, v3
v_mfma_f32_16x16x32_bf16 a[36:39], a[176:179], a[196:199], a[36:39]
v_xor_b32 v8, 80, v5
v_cmp_le_u32 vcc, 163840, v3
v_mfma_f32_16x16x32_bf16 a[40:43], a[176:179], a[200:203], a[40:43]
s_nop 0
v_cndmask_b32 v3, v3, v19, vcc
v_mfma_f32_16x16x32_bf16 a[44:47], a[176:179], a[204:207], a[44:47]
v_xor_b32 v4, 64, v3
v_mfma_f32_16x16x32_bf16 a[48:51], a[176:179], a[208:211], a[48:51]
s_add_u32 s48, s48, s34
v_mfma_f32_16x16x32_bf16 a[52:55], a[176:179], a[212:215], a[52:55]
s_add_u32 m0, s32, 20480
v_mfma_f32_16x16x32_bf16 a[56:59], a[176:179], a[216:219], a[56:59]
buffer_load_dwordx4 v1, s[12:15], s48 offen lds
v_mfma_f32_16x16x32_bf16 a[60:63], a[176:179], a[220:223], a[60:63]
ds_read_b64_tr_b16 a[176:177], v9 offset:0
v_mfma_f32_16x16x32_bf16 a[64:67], a[180:183], a[192:195], a[64:67]
ds_read_b64_tr_b16 a[178:179], v9 offset:1024
v_mfma_f32_16x16x32_bf16 a[68:71], a[180:183], a[196:199], a[68:71]
v_xor_b32 v9, 128, v5
v_mfma_f32_16x16x32_bf16 a[72:75], a[180:183], a[200:203], a[72:75]
v_mfma_f32_16x16x32_bf16 a[76:79], a[180:183], a[204:207], a[76:79]
s_add_u32 s48, s48, s34
v_mfma_f32_16x16x32_bf16 a[80:83], a[180:183], a[208:211], a[80:83]
s_add_u32 m0, s32, 24576
v_mfma_f32_16x16x32_bf16 a[84:87], a[180:183], a[212:215], a[84:87]
buffer_load_dwordx4 v1, s[12:15], s48 offen lds
v_mfma_f32_16x16x32_bf16 a[88:91], a[180:183], a[216:219], a[88:91]
v_mfma_f32_16x16x32_bf16 a[92:95], a[180:183], a[220:223], a[92:95]
ds_read_b64_tr_b16 a[180:181], v10 offset:0
v_mfma_f32_16x16x32_bf16 a[96:99], a[184:187], a[192:195], a[96:99]
ds_read_b64_tr_b16 a[182:183], v10 offset:1024
v_mfma_f32_16x16x32_bf16 a[100:103], a[184:187], a[196:199], a[100:103]
v_xor_b32 v10, 144, v5
v_mfma_f32_16x16x32_bf16 a[104:107], a[184:187], a[200:203], a[104:107]
s_add_u32 s48, s48, s34
v_mfma_f32_16x16x32_bf16 a[108:111], a[184:187], a[204:207], a[108:111]
s_add_u32 m0, s32, 28672
v_mfma_f32_16x16x32_bf16 a[112:115], a[184:187], a[208:211], a[112:115]
buffer_load_dwordx4 v1, s[12:15], s48 offen lds
v_mfma_f32_16x16x32_bf16 a[116:119], a[184:187], a[212:215], a[116:119]
s_add_u32 s30, s30, 128
v_mfma_f32_16x16x32_bf16 a[120:123], a[184:187], a[216:219], a[120:123]
s_add_u32 s32, s32, 32768
v_mfma_f32_16x16x32_bf16 a[124:127], a[184:187], a[220:223], a[124:127]
s_sub_u32 s48, s32, 98304
ds_read_b64_tr_b16 a[184:185], v11 offset:0
v_mfma_f32_16x16x32_bf16 a[128:131], a[188:191], a[192:195], a[128:131]
s_cmp_ge_u32 s32, 163840
s_cselect_b32 s32, s48, s32
ds_read_b64_tr_b16 a[186:187], v11 offset:1024
v_mfma_f32_16x16x32_bf16 a[132:135], a[188:191], a[196:199], a[132:135]
v_xor_b32 v11, 192, v5
v_mfma_f32_16x16x32_bf16 a[136:139], a[188:191], a[200:203], a[136:139]
buffer_load_dword v15, v14, s[96:99], s100 offen
v_mfma_f32_16x16x32_bf16 a[140:143], a[188:191], a[204:207], a[140:143]
s_add_u32 s100, s100, 16384
v_mfma_f32_16x16x32_bf16 a[144:147], a[188:191], a[208:211], a[144:147]
v_mfma_f32_16x16x32_bf16 a[148:151], a[188:191], a[212:215], a[148:151]
v_mfma_f32_16x16x32_bf16 a[152:155], a[188:191], a[216:219], a[152:155]
v_mfma_f32_16x16x32_bf16 a[156:159], a[188:191], a[220:223], a[156:159]
s_waitcnt vmcnt(23) lgkmcnt(0)
s_barrier
v_mfma_f32_16x16x32_bf16 v[160:163], a[160:163], a[224:227], v[160:163]
ds_read_b128 a[192:195], v3 offset:0
v_mfma_f32_16x16x32_bf16 v[164:167], a[160:163], a[228:231], v[164:167]
s_add_u32 s37, s31, 0
v_mfma_f32_16x16x32_bf16 v[168:171], a[160:163], a[232:235], v[168:171]
s_add_u32 m0, s33, 0
ds_read_b128 a[196:199], v4 offset:1024
v_mfma_f32_16x16x32_bf16 v[172:175], a[160:163], a[236:239], v[172:175]
buffer_load_dwordx4 v2, s[20:23], s37 offen  lds
v_mfma_f32_16x16x32_bf16 v[176:179], a[160:163], a[240:243], v[176:179]
s_add_u32 s60, s60, s92
ds_read_b128 a[200:203], v3 offset:4096
v_mfma_f32_16x16x32_bf16 v[180:183], a[160:163], a[244:247], v[180:183]
s_mov_b32 s29, s60
v_mfma_f32_16x16x32_bf16 v[184:187], a[160:163], a[248:251], v[184:187]
buffer_store_dwordx4 v[96:99], v13, s[8:11], s29 offen sc1
v_mfma_f32_16x16x32_bf16 v[188:191], a[160:163], a[252:255], v[188:191]
ds_read_b64_tr_b16 a[160:161], v5 offset:0
v_mfma_f32_16x16x32_bf16 v[192:195], a[164:167], a[224:227], v[192:195]
s_add_u32 s37, s31, 32768
ds_read_b64_tr_b16 a[162:163], v5 offset:1024
v_mfma_f32_16x16x32_bf16 v[196:199], a[164:167], a[228:231], v[196:199]
s_add_u32 m0, s33, 1024
ds_read_b128 a[204:207], v4 offset:5120
v_add_u32 v5, 16384, v5
v_mfma_f32_16x16x32_bf16 v[200:203], a[164:167], a[232:235], v[200:203]
buffer_load_dwordx4 v2, s[20:23], s37 offen  lds
v_and_b32 v5, 65535, v5
v_mfma_f32_16x16x32_bf16 v[204:207], a[164:167], a[236:239], v[204:207]
ds_read_b128 a[208:211], v3 offset:8192
v_mfma_f32_16x16x32_bf16 v[208:211], a[164:167], a[240:243], v[208:211]
v_mfma_f32_16x16x32_bf16 v[212:215], a[164:167], a[244:247], v[212:215]
ds_read_b128 a[212:215], v4 offset:9216
v_mfma_f32_16x16x32_bf16 v[216:219], a[164:167], a[248:251], v[216:219]
v_mfma_f32_16x16x32_bf16 v[220:223], a[164:167], a[252:255], v[220:223]
s_add_u32 s37, s31, 131072
ds_read_b64_tr_b16 a[164:165], v6 offset:0
v_mfma_f32_16x16x32_bf16 v[224:227], a[168:171], a[224:227], v[224:227]
s_add_u32 m0, s33, 4096
ds_read_b64_tr_b16 a[166:167], v6 offset:1024
v_mfma_f32_16x16x32_bf16 v[228:231], a[168:171], a[228:231], v[228:231]
buffer_load_dwordx4 v2, s[20:23], s37 offen  lds
v_xor_b32 v6, 16, v5
v_mfma_f32_16x16x32_bf16 v[232:235], a[168:171], a[232:235], v[232:235]
ds_read_b128 a[216:219], v3 offset:12288
v_mfma_f32_16x16x32_bf16 v[236:239], a[168:171], a[236:239], v[236:239]
v_mfma_f32_16x16x32_bf16 v[240:243], a[168:171], a[240:243], v[240:243]
ds_read_b128 a[220:223], v4 offset:13312
v_mfma_f32_16x16x32_bf16 v[244:247], a[168:171], a[244:247], v[244:247]
v_mfma_f32_16x16x32_bf16 v[248:251], a[168:171], a[248:251], v[248:251]
s_add_u32 s37, s31, 163840
ds_read_b64_tr_b16 a[188:189], v12 offset:0
v_mfma_f32_16x16x32_bf16 v[252:255], a[168:171], a[252:255], v[252:255]
s_add_u32 m0, s33, 5120
ds_read_b64_tr_b16 a[168:169], v7 offset:0
v_mfma_f32_16x16x32_bf16 a[0:3], a[172:175], a[224:227], a[0:3]
buffer_load_dwordx4 v2, s[20:23], s37 offen  lds
ds_read_b64_tr_b16 a[170:171], v7 offset:1024
v_mfma_f32_16x16x32_bf16 a[4:7], a[172:175], a[228:231], a[4:7]
s_add_u32 s31, s31, 262144
s_add_u32 s29, s29, s44
v_xor_b32 v7, 64, v5
v_mfma_f32_16x16x32_bf16 a[8:11], a[172:175], a[232:235], a[8:11]
s_add_u32 s33, s33, 16384
ds_read_b64_tr_b16 a[190:191], v12 offset:1024
v_mfma_f32_16x16x32_bf16 a[12:15], a[172:175], a[236:239], a[12:15]
s_and_b32 s33, s33, 65535
buffer_store_dwordx4 v[100:103], v13, s[8:11], s29 offen sc1
v_mfma_f32_16x16x32_bf16 a[16:19], a[172:175], a[240:243], a[16:19]
v_mfma_f32_16x16x32_bf16 a[20:23], a[172:175], a[244:247], a[20:23]
s_mov_b32 s48, s30
v_xor_b32 v12, 208, v5
v_mfma_f32_16x16x32_bf16 a[24:27], a[172:175], a[248:251], a[24:27]
s_add_u32 m0, s32, 0
v_mfma_f32_16x16x32_bf16 a[28:31], a[172:175], a[252:255], a[28:31]
buffer_load_dwordx4 v1, s[12:15], s48 offen lds
ds_read_b64_tr_b16 a[172:173], v8 offset:0
v_mfma_f32_16x16x32_bf16 a[32:35], a[176:179], a[224:227], a[32:35]
ds_read_b64_tr_b16 a[174:175], v8 offset:1024
v_mfma_f32_16x16x32_bf16 a[36:39], a[176:179], a[228:231], a[36:39]
v_xor_b32 v8, 80, v5
v_mfma_f32_16x16x32_bf16 a[40:43], a[176:179], a[232:235], a[40:43]
v_mfma_f32_16x16x32_bf16 a[44:47], a[176:179], a[236:239], a[44:47]
v_mfma_f32_16x16x32_bf16 a[48:51], a[176:179], a[240:243], a[48:51]
s_add_u32 s48, s48, s34
v_mfma_f32_16x16x32_bf16 a[52:55], a[176:179], a[244:247], a[52:55]
s_add_u32 m0, s32, 4096
v_mfma_f32_16x16x32_bf16 a[56:59], a[176:179], a[248:251], a[56:59]
buffer_load_dwordx4 v1, s[12:15], s48 offen lds
v_mfma_f32_16x16x32_bf16 a[60:63], a[176:179], a[252:255], a[60:63]
ds_read_b64_tr_b16 a[176:177], v9 offset:0
v_mfma_f32_16x16x32_bf16 a[64:67], a[180:183], a[224:227], a[64:67]
ds_read_b64_tr_b16 a[178:179], v9 offset:1024
v_mfma_f32_16x16x32_bf16 a[68:71], a[180:183], a[228:231], a[68:71]
v_xor_b32 v9, 128, v5
v_mfma_f32_16x16x32_bf16 a[72:75], a[180:183], a[232:235], a[72:75]
v_mfma_f32_16x16x32_bf16 a[76:79], a[180:183], a[236:239], a[76:79]
s_add_u32 s48, s48, s34
v_mfma_f32_16x16x32_bf16 a[80:83], a[180:183], a[240:243], a[80:83]
s_add_u32 m0, s32, 8192
v_mfma_f32_16x16x32_bf16 a[84:87], a[180:183], a[244:247], a[84:87]
buffer_load_dwordx4 v1, s[12:15], s48 offen lds
v_mfma_f32_16x16x32_bf16 a[88:91], a[180:183], a[248:251], a[88:91]
s_add_u32 s29, s29, s93
v_mfma_f32_16x16x32_bf16 a[92:95], a[180:183], a[252:255], a[92:95]
ds_read_b64_tr_b16 a[180:181], v10 offset:0
v_mfma_f32_16x16x32_bf16 a[96:99], a[184:187], a[224:227], a[96:99]
buffer_store_dwordx4 v[104:107], v13, s[8:11], s29 offen sc1
ds_read_b64_tr_b16 a[182:183], v10 offset:1024
v_mfma_f32_16x16x32_bf16 a[100:103], a[184:187], a[228:231], a[100:103]
v_xor_b32 v10, 144, v5
v_mfma_f32_16x16x32_bf16 a[104:107], a[184:187], a[232:235], a[104:107]
s_add_u32 s48, s48, s34
v_mfma_f32_16x16x32_bf16 a[108:111], a[184:187], a[236:239], a[108:111]
s_add_u32 m0, s32, 12288
v_mfma_f32_16x16x32_bf16 a[112:115], a[184:187], a[240:243], a[112:115]
buffer_load_dwordx4 v1, s[12:15], s48 offen lds
v_mfma_f32_16x16x32_bf16 a[116:119], a[184:187], a[244:247], a[116:119]
v_mfma_f32_16x16x32_bf16 a[120:123], a[184:187], a[248:251], a[120:123]
v_mfma_f32_16x16x32_bf16 a[124:127], a[184:187], a[252:255], a[124:127]
ds_read_b64_tr_b16 a[184:185], v11 offset:0
v_mfma_f32_16x16x32_bf16 a[128:131], v[28:31], a[224:227], a[128:131]
ds_read_b64_tr_b16 a[186:187], v11 offset:1024
v_mfma_f32_16x16x32_bf16 a[132:135], v[28:31], a[228:231], a[132:135]
v_xor_b32 v11, 192, v5
v_mfma_f32_16x16x32_bf16 a[136:139], v[28:31], a[232:235], a[136:139]
buffer_load_dword v15, v14, s[96:99], s100 offen
v_mfma_f32_16x16x32_bf16 a[140:143], v[28:31], a[236:239], a[140:143]
s_add_u32 s100, s100, 16384
v_mfma_f32_16x16x32_bf16 a[144:147], v[28:31], a[240:243], a[144:147]
v_mfma_f32_16x16x32_bf16 a[148:151], v[28:31], a[244:247], a[148:151]
v_mfma_f32_16x16x32_bf16 a[152:155], v[28:31], a[248:251], a[152:155]
v_mfma_f32_16x16x32_bf16 a[156:159], v[28:31], a[252:255], a[156:159]
s_waitcnt vmcnt(23) lgkmcnt(0)
s_barrier
v_mfma_f32_16x16x32_bf16 v[160:163], a[160:163], a[192:195], v[160:163]
ds_read_b128 a[224:227], v4 offset:0
v_mfma_f32_16x16x32_bf16 v[164:167], a[160:163], a[196:199], v[164:167]
s_add_u32 s37, s31, 0
v_mfma_f32_16x16x32_bf16 v[168:171], a[160:163], a[200:203], v[168:171]
s_add_u32 m0, s33, 0
ds_read_b128 a[228:231], v3 offset:1024
v_mfma_f32_16x16x32_bf16 v[172:175], a[160:163], a[204:207], v[172:175]
buffer_load_dwordx4 v2, s[20:23], s37 offen  lds
v_mfma_f32_16x16x32_bf16 v[176:179], a[160:163], a[208:211], v[176:179]
s_add_u32 s29, s29, s44
ds_read_b128 a[232:235], v4 offset:4096
v_mfma_f32_16x16x32_bf16 v[180:183], a[160:163], a[212:215], v[180:183]
v_mfma_f32_16x16x32_bf16 v[184:187], a[160:163], a[216:219], v[184:187]
buffer_store_dwordx4 v[108:111], v13, s[8:11], s29 offen sc1
v_mfma_f32_16x16x32_bf16 v[188:191], a[160:163], a[220:223], v[188:191]
ds_read_b64_tr_b16 a[160:161], v5 offset:0
v_mfma_f32_16x16x32_bf16 v[192:195], a[164:167], a[192:195], v[192:195]
s_add_u32 s37, s31, 32768
ds_read_b64_tr_b16 a[162:163], v5 offset:1024
v_mfma_f32_16x16x32_bf16 v[196:199], a[164:167], a[196:199], v[196:199]
s_add_u32 m0, s33, 1024
ds_read_b128 a[236:239], v3 offset:5120
v_add_u32 v5, 16384, v5
v_mfma_f32_16x16x32_bf16 v[200:203], a[164:167], a[200:203], v[200:203]
buffer_load_dwordx4 v2, s[20:23], s37 offen  lds
v_and_b32 v5, 65535, v5
v_mfma_f32_16x16x32_bf16 v[204:207], a[164:167], a[204:207], v[204:207]
ds_read_b128 a[240:243], v4 offset:8192
v_mfma_f32_16x16x32_bf16 v[208:211], a[164:167], a[208:211], v[208:211]
v_mfma_f32_16x16x32_bf16 v[212:215], a[164:167], a[212:215], v[212:215]
ds_read_b128 a[244:247], v3 offset:9216
v_mfma_f32_16x16x32_bf16 v[216:219], a[164:167], a[216:219], v[216:219]
v_mfma_f32_16x16x32_bf16 v[220:223], a[164:167], a[220:223], v[220:223]
s_add_u32 s37, s31, 131072
ds_read_b64_tr_b16 a[164:165], v6 offset:0
v_mfma_f32_16x16x32_bf16 v[224:227], a[168:171], a[192:195], v[224:227]
s_add_u32 m0, s33, 4096
ds_read_b64_tr_b16 a[166:167], v6 offset:1024
v_mfma_f32_16x16x32_bf16 v[228:231], a[168:171], a[196:199], v[228:231]
buffer_load_dwordx4 v2, s[20:23], s37 offen  lds
v_xor_b32 v6, 16, v5
v_mfma_f32_16x16x32_bf16 v[232:235], a[168:171], a[200:203], v[232:235]
ds_read_b128 a[248:251], v4 offset:12288
v_mfma_f32_16x16x32_bf16 v[236:239], a[168:171], a[204:207], v[236:239]
v_mfma_f32_16x16x32_bf16 v[240:243], a[168:171], a[208:211], v[240:243]
ds_read_b128 a[252:255], v3 offset:13312
v_mfma_f32_16x16x32_bf16 v[244:247], a[168:171], a[212:215], v[244:247]
v_mfma_f32_16x16x32_bf16 v[248:251], a[168:171], a[216:219], v[248:251]
s_add_u32 s37, s31, 163840
ds_read_b64_tr_b16 v[28:29], v12 offset:0
v_mfma_f32_16x16x32_bf16 v[252:255], a[168:171], a[220:223], v[252:255]
s_add_u32 m0, s33, 5120
ds_read_b64_tr_b16 a[168:169], v7 offset:0
v_mfma_f32_16x16x32_bf16 a[0:3], a[172:175], a[192:195], a[0:3]
buffer_load_dwordx4 v2, s[20:23], s37 offen  lds
ds_read_b64_tr_b16 a[170:171], v7 offset:1024
v_mfma_f32_16x16x32_bf16 a[4:7], a[172:175], a[196:199], a[4:7]
s_add_u32 s31, s31, 262144
s_add_u32 s29, s29, s93
v_xor_b32 v7, 64, v5
v_mfma_f32_16x16x32_bf16 a[8:11], a[172:175], a[200:203], a[8:11]
s_add_u32 s33, s33, 16384
ds_read_b64_tr_b16 v[30:31], v12 offset:1024
v_mfma_f32_16x16x32_bf16 a[12:15], a[172:175], a[204:207], a[12:15]
s_and_b32 s33, s33, 65535
buffer_store_dwordx4 v[112:115], v13, s[8:11], s29 offen sc1
v_mfma_f32_16x16x32_bf16 a[16:19], a[172:175], a[208:211], a[16:19]
v_mfma_f32_16x16x32_bf16 a[20:23], a[172:175], a[212:215], a[20:23]
s_add_u32 s48, s48, s34
v_xor_b32 v12, 208, v5
v_mfma_f32_16x16x32_bf16 a[24:27], a[172:175], a[216:219], a[24:27]
s_add_u32 m0, s32, 16384
v_add_u32 v3, 32768, v3
v_mfma_f32_16x16x32_bf16 a[28:31], a[172:175], a[220:223], a[28:31]
buffer_load_dwordx4 v1, s[12:15], s48 offen lds
ds_read_b64_tr_b16 a[172:173], v8 offset:0
v_mfma_f32_16x16x32_bf16 a[32:35], a[176:179], a[192:195], a[32:35]
ds_read_b64_tr_b16 a[174:175], v8 offset:1024
v_subrev_u32 v19, 98304, v3
v_mfma_f32_16x16x32_bf16 a[36:39], a[176:179], a[196:199], a[36:39]
v_xor_b32 v8, 80, v5
v_cmp_le_u32 vcc, 163840, v3
v_mfma_f32_16x16x32_bf16 a[40:43], a[176:179], a[200:203], a[40:43]
s_nop 0
v_cndmask_b32 v3, v3, v19, vcc
v_mfma_f32_16x16x32_bf16 a[44:47], a[176:179], a[204:207], a[44:47]
v_xor_b32 v4, 64, v3
v_mfma_f32_16x16x32_bf16 a[48:51], a[176:179], a[208:211], a[48:51]
s_add_u32 s48, s48, s34
v_mfma_f32_16x16x32_bf16 a[52:55], a[176:179], a[212:215], a[52:55]
s_add_u32 m0, s32, 20480
v_mfma_f32_16x16x32_bf16 a[56:59], a[176:179], a[216:219], a[56:59]
buffer_load_dwordx4 v1, s[12:15], s48 offen lds
v_mfma_f32_16x16x32_bf16 a[60:63], a[176:179], a[220:223], a[60:63]
ds_read_b64_tr_b16 a[176:177], v9 offset:0
v_mfma_f32_16x16x32_bf16 a[64:67], a[180:183], a[192:195], a[64:67]
ds_read_b64_tr_b16 a[178:179], v9 offset:1024
v_mfma_f32_16x16x32_bf16 a[68:71], a[180:183], a[196:199], a[68:71]
v_xor_b32 v9, 128, v5
v_mfma_f32_16x16x32_bf16 a[72:75], a[180:183], a[200:203], a[72:75]
v_mfma_f32_16x16x32_bf16 a[76:79], a[180:183], a[204:207], a[76:79]
s_add_u32 s48, s48, s34
v_mfma_f32_16x16x32_bf16 a[80:83], a[180:183], a[208:211], a[80:83]
s_add_u32 m0, s32, 24576
v_mfma_f32_16x16x32_bf16 a[84:87], a[180:183], a[212:215], a[84:87]
buffer_load_dwordx4 v1, s[12:15], s48 offen lds
v_mfma_f32_16x16x32_bf16 a[88:91], a[180:183], a[216:219], a[88:91]
s_add_u32 s29, s29, s44
v_mfma_f32_16x16x32_bf16 a[92:95], a[180:183], a[220:223], a[92:95]
ds_read_b64_tr_b16 a[180:181], v10 offset:0
v_mfma_f32_16x16x32_bf16 a[96:99], a[184:187], a[192:195], a[96:99]
buffer_store_dwordx4 v[116:119], v13, s[8:11], s29 offen sc1
ds_read_b64_tr_b16 a[182:183], v10 offset:1024
v_mfma_f32_16x16x32_bf16 a[100:103], a[184:187], a[196:199], a[100:103]
v_xor_b32 v10, 144, v5
v_mfma_f32_16x16x32_bf16 a[104:107], a[184:187], a[200:203], a[104:107]
s_add_u32 s48, s48, s34
v_mfma_f32_16x16x32_bf16 a[108:111], a[184:187], a[204:207], a[108:111]
s_add_u32 m0, s32, 28672
v_mfma_f32_16x16x32_bf16 a[112:115], a[184:187], a[208:211], a[112:115]
buffer_load_dwordx4 v1, s[12:15], s48 offen lds
v_mfma_f32_16x16x32_bf16 a[116:119], a[184:187], a[212:215], a[116:119]
s_add_u32 s30, s30, 128
v_mfma_f32_16x16x32_bf16 a[120:123], a[184:187], a[216:219], a[120:123]
s_add_u32 s32, s32, 32768
v_mfma_f32_16x16x32_bf16 a[124:127], a[184:187], a[220:223], a[124:127]
s_sub_u32 s48, s32, 98304
ds_read_b64_tr_b16 a[184:185], v11 offset:0
v_mfma_f32_16x16x32_bf16 a[128:131], a[188:191], a[192:195], a[128:131]
s_cmp_ge_u32 s32, 163840
s_cselect_b32 s32, s48, s32
ds_read_b64_tr_b16 a[186:187], v11 offset:1024
v_mfma_f32_16x16x32_bf16 a[132:135], a[188:191], a[196:199], a[132:135]
v_xor_b32 v11, 192, v5
v_mfma_f32_16x16x32_bf16 a[136:139], a[188:191], a[200:203], a[136:139]
buffer_load_dword v15, v14, s[96:99], s100 offen
v_mfma_f32_16x16x32_bf16 a[140:143], a[188:191], a[204:207], a[140:143]
s_add_u32 s100, s100, 16384
v_mfma_f32_16x16x32_bf16 a[144:147], a[188:191], a[208:211], a[144:147]
v_mfma_f32_16x16x32_bf16 a[148:151], a[188:191], a[212:215], a[148:151]
v_mfma_f32_16x16x32_bf16 a[152:155], a[188:191], a[216:219], a[152:155]
v_mfma_f32_16x16x32_bf16 a[156:159], a[188:191], a[220:223], a[156:159]
s_waitcnt vmcnt(24) lgkmcnt(0)
s_barrier
v_mfma_f32_16x16x32_bf16 v[160:163], a[160:163], a[224:227], v[160:163]
ds_read_b128 a[192:195], v3 offset:0
v_mfma_f32_16x16x32_bf16 v[164:167], a[160:163], a[228:231], v[164:167]
s_add_u32 s37, s31, 0
v_mfma_f32_16x16x32_bf16 v[168:171], a[160:163], a[232:235], v[168:171]
s_add_u32 m0, s33, 0
ds_read_b128 a[196:199], v4 offset:1024
v_mfma_f32_16x16x32_bf16 v[172:175], a[160:163], a[236:239], v[172:175]
buffer_load_dwordx4 v2, s[20:23], s37 offen  lds
v_mfma_f32_16x16x32_bf16 v[176:179], a[160:163], a[240:243], v[176:179]
s_add_u32 s29, s29, s93
ds_read_b128 a[200:203], v3 offset:4096
v_mfma_f32_16x16x32_bf16 v[180:183], a[160:163], a[244:247], v[180:183]
v_mfma_f32_16x16x32_bf16 v[184:187], a[160:163], a[248:251], v[184:187]
buffer_store_dwordx4 v[120:123], v13, s[8:11], s29 offen sc1
v_mfma_f32_16x16x32_bf16 v[188:191], a[160:163], a[252:255], v[188:191]
ds_read_b64_tr_b16 a[160:161], v5 offset:0
v_mfma_f32_16x16x32_bf16 v[192:195], a[164:167], a[224:227], v[192:195]
s_add_u32 s37, s31, 32768
ds_read_b64_tr_b16 a[162:163], v5 offset:1024
v_mfma_f32_16x16x32_bf16 v[196:199], a[164:167], a[228:231], v[196:199]
s_add_u32 m0, s33, 1024
ds_read_b128 a[204:207], v4 offset:5120
v_add_u32 v5, 16384, v5
v_mfma_f32_16x16x32_bf16 v[200:203], a[164:167], a[232:235], v[200:203]
buffer_load_dwordx4 v2, s[20:23], s37 offen  lds
v_and_b32 v5, 65535, v5
v_mfma_f32_16x16x32_bf16 v[204:207], a[164:167], a[236:239], v[204:207]
ds_read_b128 a[208:211], v3 offset:8192
v_mfma_f32_16x16x32_bf16 v[208:211], a[164:167], a[240:243], v[208:211]
v_mfma_f32_16x16x32_bf16 v[212:215], a[164:167], a[244:247], v[212:215]
ds_read_b128 a[212:215], v4 offset:9216
v_mfma_f32_16x16x32_bf16 v[216:219], a[164:167], a[248:251], v[216:219]
v_mfma_f32_16x16x32_bf16 v[220:223], a[164:167], a[252:255], v[220:223]
s_add_u32 s37, s31, 131072
ds_read_b64_tr_b16 a[164:165], v6 offset:0
v_mfma_f32_16x16x32_bf16 v[224:227], a[168:171], a[224:227], v[224:227]
s_add_u32 m0, s33, 4096
ds_read_b64_tr_b16 a[166:167], v6 offset:1024
v_mfma_f32_16x16x32_bf16 v[228:231], a[168:171], a[228:231], v[228:231]
buffer_load_dwordx4 v2, s[20:23], s37 offen  lds
v_xor_b32 v6, 16, v5
v_mfma_f32_16x16x32_bf16 v[232:235], a[168:171], a[232:235], v[232:235]
ds_read_b128 a[216:219], v3 offset:12288
v_mfma_f32_16x16x32_bf16 v[236:239], a[168:171], a[236:239], v[236:239]
v_mfma_f32_16x16x32_bf16 v[240:243], a[168:171], a[240:243], v[240:243]
ds_read_b128 a[220:223], v4 offset:13312
v_mfma_f32_16x16x32_bf16 v[244:247], a[168:171], a[244:247], v[244:247]
v_mfma_f32_16x16x32_bf16 v[248:251], a[168:171], a[248:251], v[248:251]
s_add_u32 s37, s31, 163840
ds_read_b64_tr_b16 a[188:189], v12 offset:0
v_mfma_f32_16x16x32_bf16 v[252:255], a[168:171], a[252:255], v[252:255]
s_add_u32 m0, s33, 5120
ds_read_b64_tr_b16 a[168:169], v7 offset:0
v_mfma_f32_16x16x32_bf16 a[0:3], a[172:175], a[224:227], a[0:3]
buffer_load_dwordx4 v2, s[20:23], s37 offen  lds
ds_read_b64_tr_b16 a[170:171], v7 offset:1024
v_mfma_f32_16x16x32_bf16 a[4:7], a[172:175], a[228:231], a[4:7]
s_add_u32 s31, s31, 262144
s_add_u32 s29, s29, s44
v_xor_b32 v7, 64, v5
v_mfma_f32_16x16x32_bf16 a[8:11], a[172:175], a[232:235], a[8:11]
s_add_u32 s33, s33, 16384
ds_read_b64_tr_b16 a[190:191], v12 offset:1024
v_mfma_f32_16x16x32_bf16 a[12:15], a[172:175], a[236:239], a[12:15]
s_and_b32 s33, s33, 65535
buffer_store_dwordx4 v[124:127], v13, s[8:11], s29 offen sc1
v_mfma_f32_16x16x32_bf16 a[16:19], a[172:175], a[240:243], a[16:19]
v_mfma_f32_16x16x32_bf16 a[20:23], a[172:175], a[244:247], a[20:23]
s_mov_b32 s48, s30
v_xor_b32 v12, 208, v5
v_mfma_f32_16x16x32_bf16 a[24:27], a[172:175], a[248:251], a[24:27]
s_add_u32 m0, s32, 0
v_mfma_f32_16x16x32_bf16 a[28:31], a[172:175], a[252:255], a[28:31]
buffer_load_dwordx4 v1, s[12:15], s48 offen lds
ds_read_b64_tr_b16 a[172:173], v8 offset:0
v_mfma_f32_16x16x32_bf16 a[32:35], a[176:179], a[224:227], a[32:35]
ds_read_b64_tr_b16 a[174:175], v8 offset:1024
v_mfma_f32_16x16x32_bf16 a[36:39], a[176:179], a[228:231], a[36:39]
v_xor_b32 v8, 80, v5
v_mfma_f32_16x16x32_bf16 a[40:43], a[176:179], a[232:235], a[40:43]
v_mfma_f32_16x16x32_bf16 a[44:47], a[176:179], a[236:239], a[44:47]
v_mfma_f32_16x16x32_bf16 a[48:51], a[176:179], a[240:243], a[48:51]
s_add_u32 s48, s48, s34
v_mfma_f32_16x16x32_bf16 a[52:55], a[176:179], a[244:247], a[52:55]
s_add_u32 m0, s32, 4096
v_mfma_f32_16x16x32_bf16 a[56:59], a[176:179], a[248:251], a[56:59]
buffer_load_dwordx4 v1, s[12:15], s48 offen lds
v_mfma_f32_16x16x32_bf16 a[60:63], a[176:179], a[252:255], a[60:63]
ds_read_b64_tr_b16 a[176:177], v9 offset:0
v_mfma_f32_16x16x32_bf16 a[64:67], a[180:183], a[224:227], a[64:67]
ds_read_b64_tr_b16 a[178:179], v9 offset:1024
v_mfma_f32_16x16x32_bf16 a[68:71], a[180:183], a[228:231], a[68:71]
v_xor_b32 v9, 128, v5
v_mfma_f32_16x16x32_bf16 a[72:75], a[180:183], a[232:235], a[72:75]
v_mfma_f32_16x16x32_bf16 a[76:79], a[180:183], a[236:239], a[76:79]
s_add_u32 s48, s48, s34
v_mfma_f32_16x16x32_bf16 a[80:83], a[180:183], a[240:243], a[80:83]
s_add_u32 m0, s32, 8192
v_mfma_f32_16x16x32_bf16 a[84:87], a[180:183], a[244:247], a[84:87]
buffer_load_dwordx4 v1, s[12:15], s48 offen lds
v_mfma_f32_16x16x32_bf16 a[88:91], a[180:183], a[248:251], a[88:91]
v_mfma_f32_16x16x32_bf16 a[92:95], a[180:183], a[252:255], a[92:95]
ds_read_b64_tr_b16 a[180:181], v10 offset:0
v_mfma_f32_16x16x32_bf16 a[96:99], a[184:187], a[224:227], a[96:99]
ds_read_b64_tr_b16 a[182:183], v10 offset:1024
v_mfma_f32_16x16x32_bf16 a[100:103], a[184:187], a[228:231], a[100:103]
v_xor_b32 v10, 144, v5
v_mfma_f32_16x16x32_bf16 a[104:107], a[184:187], a[232:235], a[104:107]
s_add_u32 s48, s48, s34
v_mfma_f32_16x16x32_bf16 a[108:111], a[184:187], a[236:239], a[108:111]
s_add_u32 m0, s32, 12288
v_mfma_f32_16x16x32_bf16 a[112:115], a[184:187], a[240:243], a[112:115]
buffer_load_dwordx4 v1, s[12:15], s48 offen lds
v_mfma_f32_16x16x32_bf16 a[116:119], a[184:187], a[244:247], a[116:119]
v_mfma_f32_16x16x32_bf16 a[120:123], a[184:187], a[248:251], a[120:123]
v_mfma_f32_16x16x32_bf16 a[124:127], a[184:187], a[252:255], a[124:127]
ds_read_b64_tr_b16 a[184:185], v11 offset:0
v_mfma_f32_16x16x32_bf16 a[128:131], v[28:31], a[224:227], a[128:131]
ds_read_b64_tr_b16 a[186:187], v11 offset:1024
v_mfma_f32_16x16x32_bf16 a[132:135], v[28:31], a[228:231], a[132:135]
v_xor_b32 v11, 192, v5
v_mfma_f32_16x16x32_bf16 a[136:139], v[28:31], a[232:235], a[136:139]
buffer_load_dword v15, v14, s[96:99], s100 offen
v_mfma_f32_16x16x32_bf16 a[140:143], v[28:31], a[236:239], a[140:143]
s_add_u32 s100, s100, 16384
v_mfma_f32_16x16x32_bf16 a[144:147], v[28:31], a[240:243], a[144:147]
v_mfma_f32_16x16x32_bf16 a[148:151], v[28:31], a[244:247], a[148:151]
v_mfma_f32_16x16x32_bf16 a[152:155], v[28:31], a[248:251], a[152:155]
v_mfma_f32_16x16x32_bf16 a[156:159], v[28:31], a[252:255], a[156:159]
s_cmp_eq_u32 s36, 0
s_cbranch_scc1 L_g_k12
s_waitcnt vmcnt(23) lgkmcnt(0)
s_barrier
v_mfma_f32_16x16x32_bf16 v[160:163], a[160:163], a[192:195], v[160:163]
ds_read_b128 a[224:227], v4 offset:0
v_mfma_f32_16x16x32_bf16 v[164:167], a[160:163], a[196:199], v[164:167]
s_add_u32 s37, s31, 0
v_mfma_f32_16x16x32_bf16 v[168:171], a[160:163], a[200:203], v[168:171]
s_add_u32 m0, s33, 0
ds_read_b128 a[228:231], v3 offset:1024
v_mfma_f32_16x16x32_bf16 v[172:175], a[160:163], a[204:207], v[172:175]
buffer_load_dwordx4 v2, s[20:23], s37 offen  lds
v_mfma_f32_16x16x32_bf16 v[176:179], a[160:163], a[208:211], v[176:179]
ds_read_b128 a[232:235], v4 offset:4096
v_mfma_f32_16x16x32_bf16 v[180:183], a[160:163], a[212:215], v[180:183]
v_mfma_f32_16x16x32_bf16 v[184:187], a[160:163], a[216:219], v[184:187]
ds_read_b128 a[236:239], v3 offset:5120
v_mfma_f32_16x16x32_bf16 v[188:191], a[160:163], a[220:223], v[188:191]
ds_read_b64_tr_b16 a[160:161], v5 offset:0
v_mfma_f32_16x16x32_bf16 v[192:195], a[164:167], a[192:195], v[192:195]
s_add_u32 s37, s31, 32768
ds_read_b64_tr_b16 a[162:163], v5 offset:1024
v_mfma_f32_16x16x32_bf16 v[196:199], a[164:167], a[196:199], v[196:199]
s_add_u32 m0, s33, 1024
ds_read_b128 a[240:243], v4 offset:8192
v_add_u32 v5, 16384, v5
v_mfma_f32_16x16x32_bf16 v[200:203], a[164:167], a[200:203], v[200:203]
buffer_load_dwordx4 v2, s[20:23], s37 offen  lds
v_and_b32 v5, 65535, v5
v_mfma_f32_16x16x32_bf16 v[204:207], a[164:167], a[204:207], v[204:207]
ds_read_b128 a[244:247], v3 offset:9216
v_mfma_f32_16x16x32_bf16 v[208:211], a[164:167], a[208:211], v[208:211]
v_mfma_f32_16x16x32_bf16 v[212:215], a[164:167], a[212:215], v[212:215]
ds_read_b128 a[248:251], v4 offset:12288
v_mfma_f32_16x16x32_bf16 v[216:219], a[164:167], a[216:219], v[216:219]
v_mfma_f32_16x16x32_bf16 v[220:223], a[164:167], a[220:223], v[220:223]
s_add_u32 s37, s31, 131072
ds_read_b64_tr_b16 a[164:165], v6 offset:0
v_mfma_f32_16x16x32_bf16 v[224:227], a[168:171], a[192:195], v[224:227]
s_add_u32 m0, s33, 4096
ds_read_b64_tr_b16 a[166:167], v6 offset:1024
v_mfma_f32_16x16x32_bf16 v[228:231], a[168:171], a[196:199], v[228:231]
buffer_load_dwordx4 v2, s[20:23], s37 offen  lds
v_xor_b32 v6, 16, v5
v_mfma_f32_16x16x32_bf16 v[232:235], a[168:171], a[200:203], v[232:235]
ds_read_b128 a[252:255], v3 offset:13312
v_mfma_f32_16x16x32_bf16 v[236:239], a[168:171], a[204:207], v[236:239]
v_mfma_f32_16x16x32_bf16 v[240:243], a[168:171], a[208:211], v[240:243]
ds_read_b64_tr_b16 v[28:29], v12 offset:0
v_mfma_f32_16x16x32_bf16 v[244:247], a[168:171], a[212:215], v[244:247]
v_mfma_f32_16x16x32_bf16 v[248:251], a[168:171], a[216:219], v[248:251]
s_add_u32 s37, s31, 163840
ds_read_b64_tr_b16 v[30:31], v12 offset:1024
v_mfma_f32_16x16x32_bf16 v[252:255], a[168:171], a[220:223], v[252:255]
s_add_u32 m0, s33, 5120
ds_read_b64_tr_b16 a[168:169], v7 offset:0
v_mfma_f32_16x16x32_bf16 a[0:3], a[172:175], a[192:195], a[0:3]
buffer_load_dwordx4 v2, s[20:23], s37 offen  lds
ds_read_b64_tr_b16 a[170:171], v7 offset:1024
v_mfma_f32_16x16x32_bf16 a[4:7], a[172:175], a[196:199], a[4:7]
s_add_u32 s31, s31, 262144
v_xor_b32 v7, 64, v5
v_xor_b32 v12, 208, v5
v_mfma_f32_16x16x32_bf16 a[8:11], a[172:175], a[200:203], a[8:11]
s_add_u32 s33, s33, 16384
v_add_u32 v3, 32768, v3
v_mfma_f32_16x16x32_bf16 a[12:15], a[172:175], a[204:207], a[12:15]
s_and_b32 s33, s33, 65535
v_subrev_u32 v19, 98304, v3
v_mfma_f32_16x16x32_bf16 a[16:19], a[172:175], a[208:211], a[16:19]
v_cmp_le_u32 vcc, 163840, v3
v_mfma_f32_16x16x32_bf16 a[20:23], a[172:175], a[212:215], a[20:23]
s_add_u32 s48, s48, s34
v_cndmask_b32 v3, v3, v19, vcc
v_mfma_f32_16x16x32_bf16 a[24:27], a[172:175], a[216:219], a[24:27]
s_add_u32 m0, s32, 16384
v_xor_b32 v4, 64, v3
v_mfma_f32_16x16x32_bf16 a[28:31], a[172:175], a[220:223], a[28:31]
buffer_load_dwordx4 v1, s[12:15], s48 offen lds
ds_read_b64_tr_b16 a[172:173], v8 offset:0
v_mfma_f32_16x16x32_bf16 a[32:35], a[176:179], a[192:195], a[32:35]
ds_read_b64_tr_b16 a[174:175], v8 offset:1024
v_mfma_f32_16x16x32_bf16 a[36:39], a[176:179], a[196:199], a[36:39]
v_xor_b32 v8, 80, v5
v_mfma_f32_16x16x32_bf16 a[40:43], a[176:179], a[200:203], a[40:43]
v_mfma_f32_16x16x32_bf16 a[44:47], a[176:179], a[204:207], a[44:47]
v_mfma_f32_16x16x32_bf16 a[48:51], a[176:179], a[208:211], a[48:51]
s_add_u32 s48, s48, s34
v_mfma_f32_16x16x32_bf16 a[52:55], a[176:179], a[212:215], a[52:55]
s_add_u32 m0, s32, 20480
v_mfma_f32_16x16x32_bf16 a[56:59], a[176:179], a[216:219], a[56:59]
buffer_load_dwordx4 v1, s[12:15], s48 offen lds
v_mfma_f32_16x16x32_bf16 a[60:63], a[176:179], a[220:223], a[60:63]
ds_read_b64_tr_b16 a[176:177], v9 offset:0
v_mfma_f32_16x16x32_bf16 a[64:67], a[180:183], a[192:195], a[64:67]
ds_read_b64_tr_b16 a[178:179], v9 offset:1024
v_mfma_f32_16x16x32_bf16 a[68:71], a[180:183], a[196:199], a[68:71]
v_xor_b32 v9, 128, v5
v_mfma_f32_16x16x32_bf16 a[72:75], a[180:183], a[200:203], a[72:75]
v_mfma_f32_16x16x32_bf16 a[76:79], a[180:183], a[204:207], a[76:79]
s_add_u32 s48, s48, s34
v_mfma_f32_16x16x32_bf16 a[80:83], a[180:183], a[208:211], a[80:83]
s_add_u32 m0, s32, 24576
v_mfma_f32_16x16x32_bf16 a[84:87], a[180:183], a[212:215], a[84:87]
buffer_load_dwordx4 v1, s[12:15], s48 offen lds
v_mfma_f32_16x16x32_bf16 a[88:91], a[180:183], a[216:219], a[88:91]
v_mfma_f32_16x16x32_bf16 a[92:95], a[180:183], a[220:223], a[92:95]
ds_read_b64_tr_b16 a[180:181], v10 offset:0
v_mfma_f32_16x16x32_bf16 a[96:99], a[184:187], a[192:195], a[96:99]
ds_read_b64_tr_b16 a[182:183], v10 offset:1024
v_mfma_f32_16x16x32_bf16 a[100:103], a[184:187], a[196:199], a[100:103]
v_xor_b32 v10, 144, v5
v_mfma_f32_16x16x32_bf16 a[104:107], a[184:187], a[200:203], a[104:107]
s_add_u32 s48, s48, s34
v_mfma_f32_16x16x32_bf16 a[108:111], a[184:187], a[204:207], a[108:111]
s_add_u32 m0, s32, 28672
v_mfma_f32_16x16x32_bf16 a[112:115], a[184:187], a[208:211], a[112:115]
buffer_load_dwordx4 v1, s[12:15], s48 offen lds
v_mfma_f32_16x16x32_bf16 a[116:119], a[184:187], a[212:215], a[116:119]
s_add_u32 s30, s30, 128
v_mfma_f32_16x16x32_bf16 a[120:123], a[184:187], a[216:219], a[120:123]
s_add_u32 s32, s32, 32768
v_mfma_f32_16x16x32_bf16 a[124:127], a[184:187], a[220:223], a[124:127]
s_sub_u32 s48, s32, 98304
ds_read_b64_tr_b16 a[184:185], v11 offset:0
v_mfma_f32_16x16x32_bf16 a[128:131], a[188:191], a[192:195], a[128:131]
s_cmp_ge_u32 s32, 163840
s_cselect_b32 s32, s48, s32
ds_read_b64_tr_b16 a[186:187], v11 offset:1024
v_mfma_f32_16x16x32_bf16 a[132:135], a[188:191], a[196:199], a[132:135]
v_xor_b32 v11, 192, v5
v_mfma_f32_16x16x32_bf16 a[136:139], a[188:191], a[200:203], a[136:139]
v_mfma_f32_16x16x32_bf16 a[140:143], a[188:191], a[204:207], a[140:143]
v_mfma_f32_16x16x32_bf16 a[144:147], a[188:191], a[208:211], a[144:147]
v_mfma_f32_16x16x32_bf16 a[148:151], a[188:191], a[212:215], a[148:151]
v_mfma_f32_16x16x32_bf16 a[152:155], a[188:191], a[216:219], a[152:155]
v_mfma_f32_16x16x32_bf16 a[156:159], a[188:191], a[220:223], a[156:159]
s_waitcnt vmcnt(19) lgkmcnt(0)
s_barrier
v_mfma_f32_16x16x32_bf16 v[160:163], a[160:163], a[224:227], v[160:163]
ds_read_b128 a[192:195], v3 offset:0
v_mfma_f32_16x16x32_bf16 v[164:167], a[160:163], a[228:231], v[164:167]
s_add_u32 s37, s31, 0
v_mfma_f32_16x16x32_bf16 v[168:171], a[160:163], a[232:235], v[168:171]
s_add_u32 m0, s33, 0
ds_read_b128 a[196:199], v4 offset:1024
v_mfma_f32_16x16x32_bf16 v[172:175], a[160:163], a[236:239], v[172:175]
buffer_load_dwordx4 v2, s[20:23], s37 offen  lds
v_mfma_f32_16x16x32_bf16 v[176:179], a[160:163], a[240:243], v[176:179]
ds_read_b128 a[200:203], v3 offset:4096
v_mfma_f32_16x16x32_bf16 v[180:183], a[160:163], a[244:247], v[180:183]
v_mfma_f32_16x16x32_bf16 v[184:187], a[160:163], a[248:251], v[184:187]
ds_read_b128 a[204:207], v4 offset:5120
v_mfma_f32_16x16x32_bf16 v[188:191], a[160:163], a[252:255], v[188:191]
ds_read_b64_tr_b16 a[160:161], v5 offset:0
v_mfma_f32_16x16x32_bf16 v[192:195], a[164:167], a[224:227], v[192:195]
s_add_u32 s37, s31, 32768
ds_read_b64_tr_b16 a[162:163], v5 offset:1024
v_mfma_f32_16x16x32_bf16 v[196:199], a[164:167], a[228:231], v[196:199]
s_add_u32 m0, s33, 1024
ds_read_b128 a[208:211], v3 offset:8192
v_add_u32 v5, 16384, v5
v_mfma_f32_16x16x32_bf16 v[200:203], a[164:167], a[232:235], v[200:203]
buffer_load_dwordx4 v2, s[20:23], s37 offen  lds
v_and_b32 v5, 65535, v5
v_mfma_f32_16x16x32_bf16 v[204:207], a[164:167], a[236:239], v[204:207]
ds_read_b128 a[212:215], v4 offset:9216
v_mfma_f32_16x16x32_bf16 v[208:211], a[164:167], a[240:243], v[208:211]
v_mfma_f32_16x16x32_bf16 v[212:215], a[164:167], a[244:247], v[212:215]
ds_read_b128 a[216:219], v3 offset:12288
v_mfma_f32_16x16x32_bf16 v[216:219], a[164:167], a[248:251], v[216:219]
v_mfma_f32_16x16x32_bf16 v[220:223], a[164:167], a[252:255], v[220:223]
s_add_u32 s37, s31, 131072
ds_read_b64_tr_b16 a[164:165], v6 offset:0
v_mfma_f32_16x16x32_bf16 v[224:227], a[168:171], a[224:227], v[224:227]
s_add_u32 m0, s33, 4096
ds_read_b64_tr_b16 a[166:167], v6 offset:1024
v_mfma_f32_16x16x32_bf16 v[228:231], a[168:171], a[228:231], v[228:231]
buffer_load_dwordx4 v2, s[20:23], s37 offen  lds
v_xor_b32 v6, 16, v5
v_mfma_f32_16x16x32_bf16 v[232:235], a[168:171], a[232:235], v[232:235]
ds_read_b128 a[220:223], v4 offset:13312
v_mfma_f32_16x16x32_bf16 v[236:239], a[168:171], a[236:239], v[236:239]
v_mfma_f32_16x16x32_bf16 v[240:243], a[168:171], a[240:243], v[240:243]
ds_read_b64_tr_b16 a[188:189], v12 offset:0
v_mfma_f32_16x16x32_bf16 v[244:247], a[168:171], a[244:247], v[244:247]
v_mfma_f32_16x16x32_bf16 v[248:251], a[168:171], a[248:251], v[248:251]
s_add_u32 s37, s31, 163840
ds_read_b64_tr_b16 a[190:191], v12 offset:1024
v_mfma_f32_16x16x32_bf16 v[252:255], a[168:171], a[252:255], v[252:255]
s_add_u32 m0, s33, 5120
ds_read_b64_tr_b16 a[168:169], v7 offset:0
v_mfma_f32_16x16x32_bf16 a[0:3], a[172:175], a[224:227], a[0:3]
buffer_load_dwordx4 v2, s[20:23], s37 offen  lds
ds_read_b64_tr_b16 a[170:171], v7 offset:1024
v_mfma_f32_16x16x32_bf16 a[4:7], a[172:175], a[228:231], a[4:7]
s_add_u32 s31, s31, 262144
v_xor_b32 v7, 64, v5
v_xor_b32 v12, 208, v5
v_mfma_f32_16x16x32_bf16 a[8:11], a[172:175], a[232:235], a[8:11]
s_add_u32 s33, s33, 16384
v_mfma_f32_16x16x32_bf16 a[12:15], a[172:175], a[236:239], a[12:15]
s_and_b32 s33, s33, 65535
v_mfma_f32_16x16x32_bf16 a[16:19], a[172:175], a[240:243], a[16:19]
v_mfma_f32_16x16x32_bf16 a[20:23], a[172:175], a[244:247], a[20:23]
s_mov_b32 s48, s30
v_mfma_f32_16x16x32_bf16 a[24:27], a[172:175], a[248:251], a[24:27]
s_add_u32 m0, s32, 0
v_mfma_f32_16x16x32_bf16 a[28:31], a[172:175], a[252:255], a[28:31]
buffer_load_dwordx4 v1, s[12:15], s48 offen lds
ds_read_b64_tr_b16 a[172:173], v8 offset:0
v_mfma_f32_16x16x32_bf16 a[32:35], a[176:179], a[224:227], a[32:35]
ds_read_b64_tr_b16 a[174:175], v8 offset:1024
v_mfma_f32_16x16x32_bf16 a[36:39], a[176:179], a[228:231], a[36:39]
v_xor_b32 v8, 80, v5
v_mfma_f32_16x16x32_bf16 a[40:43], a[176:179], a[232:235], a[40:43]
v_mfma_f32_16x16x32_bf16 a[44:47], a[176:179], a[236:239], a[44:47]
v_mfma_f32_16x16x32_bf16 a[48:51], a[176:179], a[240:243], a[48:51]
s_add_u32 s48, s48, s34
v_mfma_f32_16x16x32_bf16 a[52:55], a[176:179], a[244:247], a[52:55]
s_add_u32 m0, s32, 4096
v_mfma_f32_16x16x32_bf16 a[56:59], a[176:179], a[248:251], a[56:59]
buffer_load_dwordx4 v1, s[12:15], s48 offen lds
v_mfma_f32_16x16x32_bf16 a[60:63], a[176:179], a[252:255], a[60:63]
ds_read_b64_tr_b16 a[176:177], v9 offset:0
v_mfma_f32_16x16x32_bf16 a[64:67], a[180:183], a[224:227], a[64:67]
ds_read_b64_tr_b16 a[178:179], v9 offset:1024
v_mfma_f32_16x16x32_bf16 a[68:71], a[180:183], a[228:231], a[68:71]
v_xor_b32 v9, 128, v5
v_mfma_f32_16x16x32_bf16 a[72:75], a[180:183], a[232:235], a[72:75]
v_mfma_f32_16x16x32_bf16 a[76:79], a[180:183], a[236:239], a[76:79]
s_add_u32 s48, s48, s34
v_mfma_f32_16x16x32_bf16 a[80:83], a[180:183], a[240:243], a[80:83]
s_add_u32 m0, s32, 8192
v_mfma_f32_16x16x32_bf16 a[84:87], a[180:183], a[244:247], a[84:87]
buffer_load_dwordx4 v1, s[12:15], s48 offen lds
v_mfma_f32_16x16x32_bf16 a[88:91], a[180:183], a[248:251], a[88:91]
v_mfma_f32_16x16x32_bf16 a[92:95], a[180:183], a[252:255], a[92:95]
ds_read_b64_tr_b16 a[180:181], v10 offset:0
v_mfma_f32_16x16x32_bf16 a[96:99], a[184:187], a[224:227], a[96:99]
ds_read_b64_tr_b16 a[182:183], v10 offset:1024
v_mfma_f32_16x16x32_bf16 a[100:103], a[184:187], a[228:231], a[100:103]
v_xor_b32 v10, 144, v5
v_mfma_f32_16x16x32_bf16 a[104:107], a[184:187], a[232:235], a[104:107]
s_add_u32 s48, s48, s34
v_mfma_f32_16x16x32_bf16 a[108:111], a[184:187], a[236:239], a[108:111]
s_add_u32 m0, s32, 12288
v_mfma_f32_16x16x32_bf16 a[112:115], a[184:187], a[240:243], a[112:115]
buffer_load_dwordx4 v1, s[12:15], s48 offen lds
v_mfma_f32_16x16x32_bf16 a[116:119], a[184:187], a[244:247], a[116:119]
v_mfma_f32_16x16x32_bf16 a[120:123], a[184:187], a[248:251], a[120:123]
v_mfma_f32_16x16x32_bf16 a[124:127], a[184:187], a[252:255], a[124:127]
ds_read_b64_tr_b16 a[184:185], v11 offset:0
v_mfma_f32_16x16x32_bf16 a[128:131], v[28:31], a[224:227], a[128:131]
ds_read_b64_tr_b16 a[186:187], v11 offset:1024
v_mfma_f32_16x16x32_bf16 a[132:135], v[28:31], a[228:231], a[132:135]
v_xor_b32 v11, 192, v5
v_mfma_f32_16x16x32_bf16 a[136:139], v[28:31], a[232:235], a[136:139]
v_mfma_f32_16x16x32_bf16 a[140:143], v[28:31], a[236:239], a[140:143]
v_mfma_f32_16x16x32_bf16 a[144:147], v[28:31], a[240:243], a[144:147]
v_mfma_f32_16x16x32_bf16 a[148:151], v[28:31], a[244:247], a[148:151]
v_mfma_f32_16x16x32_bf16 a[152:155], v[28:31], a[248:251], a[152:155]
v_mfma_f32_16x16x32_bf16 a[156:159], v[28:31], a[252:255], a[156:159]
L_g_k12:
s_waitcnt vmcnt(16) lgkmcnt(0)
s_barrier
v_mfma_f32_16x16x32_bf16 v[160:163], a[160:163], a[192:195], v[160:163]
ds_read_b128 a[224:227], v4 offset:0
s_lshr_b32 s24, s16, 1
v_mfma_f32_16x16x32_bf16 v[164:167], a[160:163], a[196:199], v[164:167]
s_add_u32 s37, s31, 0
s_cmp_eq_u32 s35, 5
s_cselect_b32 s90, s24, s90
v_mfma_f32_16x16x32_bf16 v[168:171], a[160:163], a[200:203], v[168:171]
s_add_u32 m0, s33, 0
ds_read_b128 a[228:231], v3 offset:1024
s_lshl_b32 s24, s35, 2
v_mfma_f32_16x16x32_bf16 v[172:175], a[160:163], a[204:207], v[172:175]
buffer_load_dwordx4 v2, s[20:23], s37 offen  lds
s_lshr_b32 s26, s88, s24
v_mfma_f32_16x16x32_bf16 v[176:179], a[160:163], a[208:211], v[176:179]
s_add_u32 s60, s60, s92
ds_read_b128 a[232:235], v4 offset:4096
s_bfe_u32 s2, s26, 0x10003
v_mfma_f32_16x16x32_bf16 v[180:183], a[160:163], a[212:215], v[180:183]
s_mov_b32 s29, s60
s_and_b32 s26, s26, 7
s_or_b32 s40, s2, s61
v_mfma_f32_16x16x32_bf16 v[184:187], a[160:163], a[216:219], v[184:187]
buffer_store_dwordx4 v[128:131], v13, s[8:11], s29 offen sc1
s_lshr_b32 s24, s17, 1
v_mfma_f32_16x16x32_bf16 v[188:191], a[160:163], a[220:223], v[188:191]
ds_read_b64_tr_b16 a[160:161], v5 offset:0
v_mfma_f32_16x16x32_bf16 v[192:195], a[164:167], a[192:195], v[192:195]
s_add_u32 s37, s31, 32768
ds_read_b64_tr_b16 a[162:163], v5 offset:1024
v_mfma_f32_16x16x32_bf16 v[196:199], a[164:167], a[196:199], v[196:199]
s_add_u32 m0, s33, 1024
ds_read_b128 a[236:239], v3 offset:5120
v_add_u32 v5, 16384, v5
v_mfma_f32_16x16x32_bf16 v[200:203], a[164:167], a[200:203], v[200:203]
buffer_load_dwordx4 v2, s[20:23], s37 offen  lds
v_and_b32 v5, 65535, v5
v_mfma_f32_16x16x32_bf16 v[204:207], a[164:167], a[204:207], v[204:207]
ds_read_b128 a[240:243], v4 offset:8192
v_mfma_f32_16x16x32_bf16 v[208:211], a[164:167], a[208:211], v[208:211]
s_cmp_eq_u32 s2, 0
s_cselect_b32 s41, s24, 0
s_cselect_b32 s27, s89, s90
v_mfma_f32_16x16x32_bf16 v[212:215], a[164:167], a[212:215], v[212:215]
ds_read_b128 a[244:247], v3 offset:9216
s_sub_u32 s25, s24, s41
v_mfma_f32_16x16x32_bf16 v[216:219], a[164:167], a[216:219], v[216:219]
s_and_b32 s51, s41, s61
s_lshl_b32 s51, s51, 1
s_or_b32 s51, s51, s41
v_mfma_f32_16x16x32_bf16 v[220:223], a[164:167], a[220:223], v[220:223]
s_add_u32 s37, s31, 131072
ds_read_b64_tr_b16 a[164:165], v6 offset:0
s_lshl2_add_u32 s51, s2, s51
v_mfma_f32_16x16x32_bf16 v[224:227], a[168:171], a[192:195], v[224:227]
s_add_u32 m0, s33, 4096
ds_read_b64_tr_b16 a[166:167], v6 offset:1024
s_lshl_b32 s46, s27, s2
v_mfma_f32_16x16x32_bf16 v[228:231], a[168:171], a[196:199], v[228:231]
buffer_load_dwordx4 v2, s[20:23], s37 offen  lds
s_add_u32 s46, s46, s25
v_mfma_f32_16x16x32_bf16 v[232:235], a[168:171], a[200:203], v[232:235]
ds_read_b128 a[248:251], v4 offset:12288
s_lshl_b32 s46, s46, 8
v_mfma_f32_16x16x32_bf16 v[236:239], a[168:171], a[204:207], v[236:239]
s_lshl_b32 s47, s40, 7
s_add_u32 s47, s47, 1024
s_mul_i32 s101, s26, s47
v_mfma_f32_16x16x32_bf16 v[240:243], a[168:171], a[208:211], v[240:243]
ds_read_b128 a[252:255], v3 offset:13312
s_lshl_b32 s101, s101, 8
v_mfma_f32_16x16x32_bf16 v[244:247], a[168:171], a[212:215], v[244:247]
s_and_b32 s25, s17, 1
s_lshl1_add_u32 s42, s26, s25
s_lshl_b32 s42, s42, 7
v_mfma_f32_16x16x32_bf16 v[248:251], a[168:171], a[216:219], v[248:251]
s_add_u32 s37, s31, 163840
ds_read_b64_tr_b16 v[28:29], v12 offset:0
s_lshr_b32 s42, s42, s2
v_mfma_f32_16x16x32_bf16 v[252:255], a[168:171], a[220:223], v[252:255]
s_add_u32 m0, s33, 5120
ds_read_b64_tr_b16 a[168:169], v7 offset:0
s_add_u32 s42, s42, s27
v_mfma_f32_16x16x32_bf16 a[0:3], a[172:175], a[192:195], a[0:3]
buffer_load_dwordx4 v2, s[20:23], s37 offen  lds
ds_read_b64_tr_b16 a[170:171], v7 offset:1024
v_mfma_f32_16x16x32_bf16 a[4:7], a[172:175], a[196:199], a[4:7]
s_add_u32 s31, s31, 262144
s_add_u32 s29, s29, s44
s_lshl1_add_u32 s42, s42, s24
v_mfma_f32_16x16x32_bf16 a[8:11], a[172:175], a[200:203], a[8:11]
s_add_u32 s33, s33, 16384
ds_read_b64_tr_b16 v[30:31], v12 offset:1024
s_lshl_b32 s42, s42, 13
v_mfma_f32_16x16x32_bf16 a[12:15], a[172:175], a[204:207], a[12:15]
s_and_b32 s33, s33, 65535
buffer_store_dwordx4 v[132:135], v13, s[8:11], s29 offen sc1
s_lshl_b32 s43, s27, 5
v_mfma_f32_16x16x32_bf16 a[16:19], a[172:175], a[208:211], a[16:19]
s_add_u32 s43, s43, s26
s_lshl_b32 s43, s43, 2
s_lshl_b32 s24, s2, 1
v_mfma_f32_16x16x32_bf16 a[20:23], a[172:175], a[212:215], a[20:23]
s_add_u32 s48, s48, s34
s_add_u32 s24, s24, s61
s_lshl_b32 s24, s24, 2
v_mfma_f32_16x16x32_bf16 a[24:27], a[172:175], a[216:219], a[24:27]
s_add_u32 m0, s32, 16384
s_lshr_b32 s25, 0x8720, s24
s_and_b32 s25, s25, 15
v_mfma_f32_16x16x32_bf16 a[28:31], a[172:175], a[220:223], a[28:31]
buffer_load_dwordx4 v1, s[12:15], s48 offen lds
ds_read_b64_tr_b16 a[172:173], v8 offset:0
v_mfma_f32_16x16x32_bf16 a[32:35], a[176:179], a[192:195], a[32:35]
ds_read_b64_tr_b16 a[174:175], v8 offset:1024
s_lshl_b32 s25, s25, 24
v_mfma_f32_16x16x32_bf16 a[36:39], a[176:179], a[196:199], a[36:39]
s_add_u32 s42, s42, s25
s_lshr_b32 s25, 0x7604, s24
s_and_b32 s25, s25, 15
v_mfma_f32_16x16x32_bf16 a[40:43], a[176:179], a[200:203], a[40:43]
s_lshl_b32 s25, s25, 12
s_add_u32 s43, s43, s25
s_add_u32 s43, s43, 111149056
v_mfma_f32_16x16x32_bf16 a[44:47], a[176:179], a[204:207], a[44:47]
s_cmp_lt_u32 s35, s45
s_cselect_b32 s101, s101, 536870912
s_cselect_b32 s46, s46, 536870912
v_mfma_f32_16x16x32_bf16 a[48:51], a[176:179], a[208:211], a[48:51]
s_add_u32 s48, s48, s34
v_xor_b32 v6, 16, v5
v_xor_b32 v7, 64, v5
v_mfma_f32_16x16x32_bf16 a[52:55], a[176:179], a[212:215], a[52:55]
s_add_u32 m0, s32, 20480
v_xor_b32 v8, 80, v5
v_xor_b32 v12, 208, v5
v_mfma_f32_16x16x32_bf16 a[56:59], a[176:179], a[216:219], a[56:59]
buffer_load_dwordx4 v1, s[12:15], s48 offen lds
v_add_u32 v3, 32768, v3
v_mfma_f32_16x16x32_bf16 a[60:63], a[176:179], a[220:223], a[60:63]
ds_read_b64_tr_b16 a[176:177], v9 offset:0
v_subrev_u32 v19, 98304, v3
v_mfma_f32_16x16x32_bf16 a[64:67], a[180:183], a[192:195], a[64:67]
ds_read_b64_tr_b16 a[178:179], v9 offset:1024
v_cmp_le_u32 vcc, 163840, v3
v_mfma_f32_16x16x32_bf16 a[68:71], a[180:183], a[196:199], a[68:71]
v_xor_b32 v9, 128, v5
v_cndmask_b32 v3, v3, v19, vcc
v_mfma_f32_16x16x32_bf16 a[72:75], a[180:183], a[200:203], a[72:75]
v_xor_b32 v4, 64, v3
v_mfma_f32_16x16x32_bf16 a[76:79], a[180:183], a[204:207], a[76:79]
s_add_u32 s48, s48, s34
v_mfma_f32_16x16x32_bf16 a[80:83], a[180:183], a[208:211], a[80:83]
s_add_u32 m0, s32, 24576
v_mfma_f32_16x16x32_bf16 a[84:87], a[180:183], a[212:215], a[84:87]
buffer_load_dwordx4 v1, s[12:15], s48 offen lds
v_mfma_f32_16x16x32_bf16 a[88:91], a[180:183], a[216:219], a[88:91]
s_add_u32 s29, s29, s93
v_mfma_f32_16x16x32_bf16 a[92:95], a[180:183], a[220:223], a[92:95]
ds_read_b64_tr_b16 a[180:181], v10 offset:0
v_mfma_f32_16x16x32_bf16 a[96:99], a[184:187], a[192:195], a[96:99]
buffer_store_dwordx4 v[136:139], v13, s[8:11], s29 offen sc1
ds_read_b64_tr_b16 a[182:183], v10 offset:1024
v_mfma_f32_16x16x32_bf16 a[100:103], a[184:187], a[196:199], a[100:103]
v_xor_b32 v10, 144, v5
v_mfma_f32_16x16x32_bf16 a[104:107], a[184:187], a[200:203], a[104:107]
s_add_u32 s48, s48, s34
v_mfma_f32_16x16x32_bf16 a[108:111], a[184:187], a[204:207], a[108:111]
s_add_u32 m0, s32, 28672
v_mfma_f32_16x16x32_bf16 a[112:115], a[184:187], a[208:211], a[112:115]
buffer_load_dwordx4 v1, s[12:15], s48 offen lds
v_mfma_f32_16x16x32_bf16 a[116:119], a[184:187], a[212:215], a[116:119]
s_add_u32 s30, s30, 128
v_mfma_f32_16x16x32_bf16 a[120:123], a[184:187], a[216:219], a[120:123]
s_add_u32 s32, s32, 32768
v_mfma_f32_16x16x32_bf16 a[124:127], a[184:187], a[220:223], a[124:127]
s_sub_u32 s48, s32, 98304
ds_read_b64_tr_b16 a[184:185], v11 offset:0
v_mfma_f32_16x16x32_bf16 a[128:131], a[188:191], a[192:195], a[128:131]
s_cmp_ge_u32 s32, 163840
s_cselect_b32 s32, s48, s32
ds_read_b64_tr_b16 a[186:187], v11 offset:1024
v_mfma_f32_16x16x32_bf16 a[132:135], a[188:191], a[196:199], a[132:135]
v_xor_b32 v11, 192, v5
v_mfma_f32_16x16x32_bf16 a[136:139], a[188:191], a[200:203], a[136:139]
buffer_load_dword v15, v14, s[96:99], s100 offen
v_mfma_f32_16x16x32_bf16 a[140:143], a[188:191], a[204:207], a[140:143]
s_add_u32 s100, s100, 16384
v_mfma_f32_16x16x32_bf16 a[144:147], a[188:191], a[208:211], a[144:147]
v_mfma_f32_16x16x32_bf16 a[148:151], a[188:191], a[212:215], a[148:151]
v_mfma_f32_16x16x32_bf16 a[152:155], a[188:191], a[216:219], a[152:155]
v_mfma_f32_16x16x32_bf16 a[156:159], a[188:191], a[220:223], a[156:159]
s_waitcnt vmcnt(20) lgkmcnt(0)
s_barrier
v_mfma_f32_16x16x32_bf16 v[160:163], a[160:163], a[224:227], v[160:163]
ds_read_b128 a[192:195], v3 offset:0
v_mfma_f32_16x16x32_bf16 v[164:167], a[160:163], a[228:231], v[164:167]
s_add_u32 s37, s31, 0
s_cmp_eq_u32 s2, 0
s_cselect_b64 s[4:5], s[52:53], s[54:55]
v_mfma_f32_16x16x32_bf16 v[168:171], a[160:163], a[232:235], v[168:171]
s_add_u32 m0, s33, 0
ds_read_b128 a[196:199], v4 offset:1024
s_mov_b32 s12, s4
v_mfma_f32_16x16x32_bf16 v[172:175], a[160:163], a[236:239], v[172:175]
buffer_load_dwordx4 v2, s[20:23], s37 offen  lds
s_and_b32 s13, s5, 0xffff
v_mfma_f32_16x16x32_bf16 v[176:179], a[160:163], a[240:243], v[176:179]
s_add_u32 s29, s29, s44
ds_read_b128 a[200:203], v3 offset:4096
s_lshl_b32 s14, s47, 11
v_mfma_f32_16x16x32_bf16 v[180:183], a[160:163], a[244:247], v[180:183]
s_mov_b32 s15, 0x20000
s_mov_b32 s30, s101
v_lshrrev_b32 v16, 3, v0
v_mfma_f32_16x16x32_bf16 v[184:187], a[160:163], a[248:251], v[184:187]
buffer_store_dwordx4 v[140:143], v13, s[8:11], s29 offen sc1
v_mul_lo_u32 v16, v16, s47
v_mfma_f32_16x16x32_bf16 v[188:191], a[160:163], a[252:255], v[188:191]
ds_read_b64_tr_b16 a[160:161], v5 offset:0
v_and_b32 v1, 0x70, v1
v_mfma_f32_16x16x32_bf16 v[192:195], a[164:167], a[224:227], v[192:195]
s_add_u32 s37, s31, 32768
ds_read_b64_tr_b16 a[162:163], v5 offset:1024
v_add_u32 v1, v1, v16
v_mfma_f32_16x16x32_bf16 v[196:199], a[164:167], a[228:231], v[196:199]
s_add_u32 m0, s33, 1024
ds_read_b128 a[204:207], v4 offset:5120
s_lshl_b32 s34, s47, 5
v_mfma_f32_16x16x32_bf16 v[200:203], a[164:167], a[232:235], v[200:203]
buffer_load_dwordx4 v2, s[20:23], s37 offen  lds
v_add_u32 v5, 16384, v5
v_mfma_f32_16x16x32_bf16 v[204:207], a[164:167], a[236:239], v[204:207]
ds_read_b128 a[208:211], v3 offset:8192
v_and_b32 v5, 65535, v5
v_mfma_f32_16x16x32_bf16 v[208:211], a[164:167], a[240:243], v[208:211]
v_mfma_f32_16x16x32_bf16 v[212:215], a[164:167], a[244:247], v[212:215]
ds_read_b128 a[212:215], v4 offset:9216
v_mfma_f32_16x16x32_bf16 v[216:219], a[164:167], a[248:251], v[216:219]
v_mfma_f32_16x16x32_bf16 v[220:223], a[164:167], a[252:255], v[220:223]
s_add_u32 s37, s31, 131072
ds_read_b64_tr_b16 a[164:165], v6 offset:0
v_mfma_f32_16x16x32_bf16 v[224:227], a[168:171], a[224:227], v[224:227]
s_add_u32 m0, s33, 4096
ds_read_b64_tr_b16 a[166:167], v6 offset:1024
v_mfma_f32_16x16x32_bf16 v[228:231], a[168:171], a[228:231], v[228:231]
buffer_load_dwordx4 v2, s[20:23], s37 offen  lds
v_xor_b32 v6, 16, v5
v_mfma_f32_16x16x32_bf16 v[232:235], a[168:171], a[232:235], v[232:235]
ds_read_b128 a[216:219], v3 offset:12288
v_mfma_f32_16x16x32_bf16 v[236:239], a[168:171], a[236:239], v[236:239]
v_mfma_f32_16x16x32_bf16 v[240:243], a[168:171], a[240:243], v[240:243]
ds_read_b128 a[220:223], v4 offset:13312
v_mfma_f32_16x16x32_bf16 v[244:247], a[168:171], a[244:247], v[244:247]
v_mfma_f32_16x16x32_bf16 v[248:251], a[168:171], a[248:251], v[248:251]
s_add_u32 s37, s31, 163840
ds_read_b64_tr_b16 a[188:189], v12 offset:0
v_mfma_f32_16x16x32_bf16 v[252:255], a[168:171], a[252:255], v[252:255]
s_add_u32 m0, s33, 5120
ds_read_b64_tr_b16 a[168:169], v7 offset:0
v_mfma_f32_16x16x32_bf16 a[0:3], a[172:175], a[224:227], a[0:3]
buffer_load_dwordx4 v2, s[20:23], s37 offen  lds
ds_read_b64_tr_b16 a[170:171], v7 offset:1024
v_mfma_f32_16x16x32_bf16 a[4:7], a[172:175], a[228:231], a[4:7]
s_add_u32 s31, s31, 262144
s_add_u32 s29, s29, s93
v_xor_b32 v7, 64, v5
v_mfma_f32_16x16x32_bf16 a[8:11], a[172:175], a[232:235], a[8:11]
s_add_u32 s33, s33, 16384
ds_read_b64_tr_b16 a[190:191], v12 offset:1024
v_mfma_f32_16x16x32_bf16 a[12:15], a[172:175], a[236:239], a[12:15]
s_and_b32 s33, s33, 65535
buffer_store_dwordx4 v[144:147], v13, s[8:11], s29 offen sc1
v_mfma_f32_16x16x32_bf16 a[16:19], a[172:175], a[240:243], a[16:19]
v_mfma_f32_16x16x32_bf16 a[20:23], a[172:175], a[244:247], a[20:23]
s_mov_b32 s48, s30
v_xor_b32 v12, 208, v5
v_mfma_f32_16x16x32_bf16 a[24:27], a[172:175], a[248:251], a[24:27]
s_add_u32 m0, s32, 0
v_mfma_f32_16x16x32_bf16 a[28:31], a[172:175], a[252:255], a[28:31]
buffer_load_dwordx4 v1, s[12:15], s48 offen lds
ds_read_b64_tr_b16 a[172:173], v8 offset:0
v_mfma_f32_16x16x32_bf16 a[32:35], a[176:179], a[224:227], a[32:35]
ds_read_b64_tr_b16 a[174:175], v8 offset:1024
v_mfma_f32_16x16x32_bf16 a[36:39], a[176:179], a[228:231], a[36:39]
v_xor_b32 v8, 80, v5
v_mfma_f32_16x16x32_bf16 a[40:43], a[176:179], a[232:235], a[40:43]
v_mfma_f32_16x16x32_bf16 a[44:47], a[176:179], a[236:239], a[44:47]
v_mfma_f32_16x16x32_bf16 a[48:51], a[176:179], a[240:243], a[48:51]
s_add_u32 s48, s48, s34
v_mfma_f32_16x16x32_bf16 a[52:55], a[176:179], a[244:247], a[52:55]
s_add_u32 m0, s32, 4096
v_mfma_f32_16x16x32_bf16 a[56:59], a[176:179], a[248:251], a[56:59]
buffer_load_dwordx4 v1, s[12:15], s48 offen lds
v_mfma_f32_16x16x32_bf16 a[60:63], a[176:179], a[252:255], a[60:63]
ds_read_b64_tr_b16 a[176:177], v9 offset:0
v_mfma_f32_16x16x32_bf16 a[64:67], a[180:183], a[224:227], a[64:67]
ds_read_b64_tr_b16 a[178:179], v9 offset:1024
v_mfma_f32_16x16x32_bf16 a[68:71], a[180:183], a[228:231], a[68:71]
v_xor_b32 v9, 128, v5
v_mfma_f32_16x16x32_bf16 a[72:75], a[180:183], a[232:235], a[72:75]
v_mfma_f32_16x16x32_bf16 a[76:79], a[180:183], a[236:239], a[76:79]
s_add_u32 s48, s48, s34
v_mfma_f32_16x16x32_bf16 a[80:83], a[180:183], a[240:243], a[80:83]
s_add_u32 m0, s32, 8192
s_cmp_eq_u32 s2, 0
s_cselect_b64 s[4:5], s[6:7], s[18:19]
v_mfma_f32_16x16x32_bf16 a[84:87], a[180:183], a[244:247], a[84:87]
buffer_load_dwordx4 v1, s[12:15], s48 offen lds
s_mov_b32 s20, s4
v_mfma_f32_16x16x32_bf16 a[88:91], a[180:183], a[248:251], a[88:91]
s_add_u32 s29, s29, s44
s_and_b32 s21, s5, 0xffff
s_lshl_b32 s22, s47, 12
v_mfma_f32_16x16x32_bf16 a[92:95], a[180:183], a[252:255], a[92:95]
ds_read_b64_tr_b16 a[180:181], v10 offset:0
s_mov_b32 s23, 0x20000
v_mfma_f32_16x16x32_bf16 a[96:99], a[184:187], a[224:227], a[96:99]
buffer_store_dwordx4 v[148:151], v13, s[8:11], s29 offen sc1
ds_read_b64_tr_b16 a[182:183], v10 offset:1024
v_mfma_f32_16x16x32_bf16 a[100:103], a[184:187], a[228:231], a[100:103]
s_mov_b32 s31, s46
v_xor_b32 v10, 144, v5
v_mfma_f32_16x16x32_bf16 a[104:107], a[184:187], a[232:235], a[104:107]
s_add_u32 s48, s48, s34
v_mfma_f32_16x16x32_bf16 a[108:111], a[184:187], a[236:239], a[108:111]
s_add_u32 m0, s32, 12288
v_mfma_f32_16x16x32_bf16 a[112:115], a[184:187], a[240:243], a[112:115]
buffer_load_dwordx4 v1, s[12:15], s48 offen lds
v_mfma_f32_16x16x32_bf16 a[116:119], a[184:187], a[244:247], a[116:119]
v_mfma_f32_16x16x32_bf16 a[120:123], a[184:187], a[248:251], a[120:123]
v_mfma_f32_16x16x32_bf16 a[124:127], a[184:187], a[252:255], a[124:127]
ds_read_b64_tr_b16 a[184:185], v11 offset:0
v_mfma_f32_16x16x32_bf16 a[128:131], v[28:31], a[224:227], a[128:131]
ds_read_b64_tr_b16 a[186:187], v11 offset:1024
v_mfma_f32_16x16x32_bf16 a[132:135], v[28:31], a[228:231], a[132:135]
v_xor_b32 v11, 192, v5
v_mfma_f32_16x16x32_bf16 a[136:139], v[28:31], a[232:235], a[136:139]
buffer_load_dword v15, v14, s[96:99], s100 offen
v_mfma_f32_16x16x32_bf16 a[140:143], v[28:31], a[236:239], a[140:143]
s_add_u32 s100, s100, 16384
v_mfma_f32_16x16x32_bf16 a[144:147], v[28:31], a[240:243], a[144:147]
v_mfma_f32_16x16x32_bf16 a[148:151], v[28:31], a[244:247], a[148:151]
v_mfma_f32_16x16x32_bf16 a[152:155], v[28:31], a[248:251], a[152:155]
v_mfma_f32_16x16x32_bf16 a[156:159], v[28:31], a[252:255], a[156:159]
s_waitcnt vmcnt(24) lgkmcnt(0)
s_barrier
v_mfma_f32_16x16x32_bf16 v[160:163], a[160:163], a[192:195], v[160:163]
ds_read_b128 a[224:227], v4 offset:0
v_mfma_f32_16x16x32_bf16 v[164:167], a[160:163], a[196:199], v[164:167]
s_add_u32 s37, s31, 0
v_mfma_f32_16x16x32_bf16 v[168:171], a[160:163], a[200:203], v[168:171]
s_add_u32 m0, s33, 0
ds_read_b128 a[228:231], v3 offset:1024
v_mfma_f32_16x16x32_bf16 v[172:175], a[160:163], a[204:207], v[172:175]
buffer_load_dwordx4 v2, s[20:23], s37 offen  lds
v_mfma_f32_16x16x32_bf16 v[176:179], a[160:163], a[208:211], v[176:179]
s_add_u32 s29, s29, s93
ds_read_b128 a[232:235], v4 offset:4096
v_mfma_f32_16x16x32_bf16 v[180:183], a[160:163], a[212:215], v[180:183]
v_mfma_f32_16x16x32_bf16 v[184:187], a[160:163], a[216:219], v[184:187]
buffer_store_dwordx4 v[152:155], v13, s[8:11], s29 offen sc1
v_mfma_f32_16x16x32_bf16 v[188:191], a[160:163], a[220:223], v[188:191]
ds_read_b64_tr_b16 a[160:161], v5 offset:0
v_mfma_f32_16x16x32_bf16 v[192:195], a[164:167], a[192:195], v[192:195]
s_add_u32 s37, s31, 32768
ds_read_b64_tr_b16 a[162:163], v5 offset:1024
v_mfma_f32_16x16x32_bf16 v[196:199], a[164:167], a[196:199], v[196:199]
s_add_u32 m0, s33, 1024
ds_read_b128 a[236:239], v3 offset:5120
v_add_u32 v5, 16384, v5
v_mfma_f32_16x16x32_bf16 v[200:203], a[164:167], a[200:203], v[200:203]
buffer_load_dwordx4 v2, s[20:23], s37 offen  lds
v_and_b32 v5, 65535, v5
v_mfma_f32_16x16x32_bf16 v[204:207], a[164:167], a[204:207], v[204:207]
ds_read_b128 a[240:243], v4 offset:8192
v_mfma_f32_16x16x32_bf16 v[208:211], a[164:167], a[208:211], v[208:211]
v_mfma_f32_16x16x32_bf16 v[212:215], a[164:167], a[212:215], v[212:215]
ds_read_b128 a[244:247], v3 offset:9216
v_mfma_f32_16x16x32_bf16 v[216:219], a[164:167], a[216:219], v[216:219]
v_mfma_f32_16x16x32_bf16 v[220:223], a[164:167], a[220:223], v[220:223]
s_add_u32 s37, s31, 131072
ds_read_b64_tr_b16 a[164:165], v6 offset:0
v_mfma_f32_16x16x32_bf16 v[224:227], a[168:171], a[192:195], v[224:227]
s_add_u32 m0, s33, 4096
ds_read_b64_tr_b16 a[166:167], v6 offset:1024
v_mfma_f32_16x16x32_bf16 v[228:231], a[168:171], a[196:199], v[228:231]
buffer_load_dwordx4 v2, s[20:23], s37 offen  lds
v_xor_b32 v6, 16, v5
v_mfma_f32_16x16x32_bf16 v[232:235], a[168:171], a[200:203], v[232:235]
ds_read_b128 a[248:251], v4 offset:12288
v_mfma_f32_16x16x32_bf16 v[236:239], a[168:171], a[204:207], v[236:239]
v_mfma_f32_16x16x32_bf16 v[240:243], a[168:171], a[208:211], v[240:243]
ds_read_b128 a[252:255], v3 offset:13312
v_mfma_f32_16x16x32_bf16 v[244:247], a[168:171], a[212:215], v[244:247]
v_mfma_f32_16x16x32_bf16 v[248:251], a[168:171], a[216:219], v[248:251]
s_add_u32 s37, s31, 163840
ds_read_b64_tr_b16 v[28:29], v12 offset:0
v_mfma_f32_16x16x32_bf16 v[252:255], a[168:171], a[220:223], v[252:255]
s_add_u32 m0, s33, 5120
ds_read_b64_tr_b16 a[168:169], v7 offset:0
v_mfma_f32_16x16x32_bf16 a[0:3], a[172:175], a[192:195], a[0:3]
buffer_load_dwordx4 v2, s[20:23], s37 offen  lds
ds_read_b64_tr_b16 a[170:171], v7 offset:1024
v_mfma_f32_16x16x32_bf16 a[4:7], a[172:175], a[196:199], a[4:7]
s_add_u32 s31, s31, 262144
s_add_u32 s29, s29, s44
v_xor_b32 v7, 64, v5
v_mfma_f32_16x16x32_bf16 a[8:11], a[172:175], a[200:203], a[8:11]
s_add_u32 s33, s33, 16384
ds_read_b64_tr_b16 v[30:31], v12 offset:1024
v_mfma_f32_16x16x32_bf16 a[12:15], a[172:175], a[204:207], a[12:15]
s_and_b32 s33, s33, 65535
buffer_store_dwordx4 v[156:159], v13, s[8:11], s29 offen sc1
v_mfma_f32_16x16x32_bf16 a[16:19], a[172:175], a[208:211], a[16:19]
v_mfma_f32_16x16x32_bf16 a[20:23], a[172:175], a[212:215], a[20:23]
s_add_u32 s48, s48, s34
v_xor_b32 v12, 208, v5
v_mfma_f32_16x16x32_bf16 a[24:27], a[172:175], a[216:219], a[24:27]
s_add_u32 m0, s32, 16384
v_add_u32 v3, 32768, v3
v_mfma_f32_16x16x32_bf16 a[28:31], a[172:175], a[220:223], a[28:31]
buffer_load_dwordx4 v1, s[12:15], s48 offen lds
ds_read_b64_tr_b16 a[172:173], v8 offset:0
v_mfma_f32_16x16x32_bf16 a[32:35], a[176:179], a[192:195], a[32:35]
ds_read_b64_tr_b16 a[174:175], v8 offset:1024
v_subrev_u32 v19, 98304, v3
v_mfma_f32_16x16x32_bf16 a[36:39], a[176:179], a[196:199], a[36:39]
v_xor_b32 v8, 80, v5
v_cmp_le_u32 vcc, 163840, v3
v_mfma_f32_16x16x32_bf16 a[40:43], a[176:179], a[200:203], a[40:43]
s_nop 0
v_cndmask_b32 v3, v3, v19, vcc
v_mfma_f32_16x16x32_bf16 a[44:47], a[176:179], a[204:207], a[44:47]
v_xor_b32 v4, 64, v3
v_mfma_f32_16x16x32_bf16 a[48:51], a[176:179], a[208:211], a[48:51]
s_add_u32 s48, s48, s34
v_mfma_f32_16x16x32_bf16 a[52:55], a[176:179], a[212:215], a[52:55]
s_add_u32 m0, s32, 20480
v_mfma_f32_16x16x32_bf16 a[56:59], a[176:179], a[216:219], a[56:59]
buffer_load_dwordx4 v1, s[12:15], s48 offen lds
v_mfma_f32_16x16x32_bf16 a[60:63], a[176:179], a[220:223], a[60:63]
ds_read_b64_tr_b16 a[176:177], v9 offset:0
v_mfma_f32_16x16x32_bf16 a[64:67], a[180:183], a[192:195], a[64:67]
ds_read_b64_tr_b16 a[178:179], v9 offset:1024
v_mfma_f32_16x16x32_bf16 a[68:71], a[180:183], a[196:199], a[68:71]
v_xor_b32 v9, 128, v5
v_mfma_f32_16x16x32_bf16 a[72:75], a[180:183], a[200:203], a[72:75]
v_mfma_f32_16x16x32_bf16 a[76:79], a[180:183], a[204:207], a[76:79]
s_add_u32 s48, s48, s34
v_mfma_f32_16x16x32_bf16 a[80:83], a[180:183], a[208:211], a[80:83]
s_add_u32 m0, s32, 24576
v_mfma_f32_16x16x32_bf16 a[84:87], a[180:183], a[212:215], a[84:87]
buffer_load_dwordx4 v1, s[12:15], s48 offen lds
v_mfma_f32_16x16x32_bf16 a[88:91], a[180:183], a[216:219], a[88:91]
v_mfma_f32_16x16x32_bf16 a[92:95], a[180:183], a[220:223], a[92:95]
ds_read_b64_tr_b16 a[180:181], v10 offset:0
v_mfma_f32_16x16x32_bf16 a[96:99], a[184:187], a[192:195], a[96:99]
ds_read_b64_tr_b16 a[182:183], v10 offset:1024
v_mfma_f32_16x16x32_bf16 a[100:103], a[184:187], a[196:199], a[100:103]
v_xor_b32 v10, 144, v5
v_mfma_f32_16x16x32_bf16 a[104:107], a[184:187], a[200:203], a[104:107]
s_add_u32 s48, s48, s34
v_mfma_f32_16x16x32_bf16 a[108:111], a[184:187], a[204:207], a[108:111]
s_add_u32 m0, s32, 28672
v_mfma_f32_16x16x32_bf16 a[112:115], a[184:187], a[208:211], a[112:115]
buffer_load_dwordx4 v1, s[12:15], s48 offen lds
v_mfma_f32_16x16x32_bf16 a[116:119], a[184:187], a[212:215], a[116:119]
s_add_u32 s30, s30, 128
v_mfma_f32_16x16x32_bf16 a[120:123], a[184:187], a[216:219], a[120:123]
s_add_u32 s32, s32, 32768
v_mfma_f32_16x16x32_bf16 a[124:127], a[184:187], a[220:223], a[124:127]
s_sub_u32 s48, s32, 98304
ds_read_b64_tr_b16 a[184:185], v11 offset:0
v_mfma_f32_16x16x32_bf16 a[128:131], a[188:191], a[192:195], a[128:131]
s_cmp_ge_u32 s32, 163840
s_cselect_b32 s32, s48, s32
ds_read_b64_tr_b16 a[186:187], v11 offset:1024
v_mfma_f32_16x16x32_bf16 a[132:135], a[188:191], a[196:199], a[132:135]
v_xor_b32 v11, 192, v5
v_mfma_f32_16x16x32_bf16 a[136:139], a[188:191], a[200:203], a[136:139]
buffer_load_dword v15, v14, s[96:99], s100 offen
v_mfma_f32_16x16x32_bf16 a[140:143], a[188:191], a[204:207], a[140:143]
s_add_u32 s100, s100, 16384
v_mfma_f32_16x16x32_bf16 a[144:147], a[188:191], a[208:211], a[144:147]
v_mfma_f32_16x16x32_bf16 a[148:151], a[188:191], a[212:215], a[148:151]
v_mfma_f32_16x16x32_bf16 a[152:155], a[188:191], a[216:219], a[152:155]
v_mfma_f32_16x16x32_bf16 a[156:159], a[188:191], a[220:223], a[156:159]
s_waitcnt vmcnt(23) lgkmcnt(0)
s_barrier
v_mfma_f32_16x16x32_bf16 v[160:163], a[160:163], a[224:227], v[160:163]
ds_read_b128 a[192:195], v3 offset:0
v_mfma_f32_16x16x32_bf16 v[164:167], a[160:163], a[228:231], v[164:167]
s_add_u32 s37, s31, 0
v_mfma_f32_16x16x32_bf16 v[168:171], a[160:163], a[232:235], v[168:171]
s_add_u32 m0, s33, 0
ds_read_b128 a[196:199], v4 offset:1024
v_mfma_f32_16x16x32_bf16 v[172:175], a[160:163], a[236:239], v[172:175]
buffer_load_dwordx4 v2, s[20:23], s37 offen  lds
v_mfma_f32_16x16x32_bf16 v[176:179], a[160:163], a[240:243], v[176:179]
ds_read_b128 a[200:203], v3 offset:4096
v_mfma_f32_16x16x32_bf16 v[180:183], a[160:163], a[244:247], v[180:183]
v_mfma_f32_16x16x32_bf16 v[184:187], a[160:163], a[248:251], v[184:187]
ds_read_b128 a[204:207], v4 offset:5120
v_mfma_f32_16x16x32_bf16 v[188:191], a[160:163], a[252:255], v[188:191]
ds_read_b64_tr_b16 a[160:161], v5 offset:0
v_mfma_f32_16x16x32_bf16 v[192:195], a[164:167], a[224:227], v[192:195]
s_add_u32 s37, s31, 32768
ds_read_b64_tr_b16 a[162:163], v5 offset:1024
v_mfma_f32_16x16x32_bf16 v[196:199], a[164:167], a[228:231], v[196:199]
s_add_u32 m0, s33, 1024
ds_read_b128 a[208:211], v3 offset:8192
v_add_u32 v5, 16384, v5
v_mfma_f32_16x16x32_bf16 v[200:203], a[164:167], a[232:235], v[200:203]
buffer_load_dwordx4 v2, s[20:23], s37 offen  lds
v_and_b32 v5, 65535, v5
v_mfma_f32_16x16x32_bf16 v[204:207], a[164:167], a[236:239], v[204:207]
ds_read_b128 a[212:215], v4 offset:9216
v_mfma_f32_16x16x32_bf16 v[208:211], a[164:167], a[240:243], v[208:211]
v_mfma_f32_16x16x32_bf16 v[212:215], a[164:167], a[244:247], v[212:215]
ds_read_b128 a[216:219], v3 offset:12288
v_mfma_f32_16x16x32_bf16 v[216:219], a[164:167], a[248:251], v[216:219]
v_mfma_f32_16x16x32_bf16 v[220:223], a[164:167], a[252:255], v[220:223]
s_add_u32 s37, s31, 131072
ds_read_b64_tr_b16 a[164:165], v6 offset:0
v_mfma_f32_16x16x32_bf16 v[224:227], a[168:171], a[224:227], v[224:227]
s_add_u32 m0, s33, 4096
ds_read_b64_tr_b16 a[166:167], v6 offset:1024
v_mfma_f32_16x16x32_bf16 v[228:231], a[168:171], a[228:231], v[228:231]
buffer_load_dwordx4 v2, s[20:23], s37 offen  lds
v_xor_b32 v6, 16, v5
v_mfma_f32_16x16x32_bf16 v[232:235], a[168:171], a[232:235], v[232:235]
ds_read_b128 a[220:223], v4 offset:13312
v_mfma_f32_16x16x32_bf16 v[236:239], a[168:171], a[236:239], v[236:239]
v_mfma_f32_16x16x32_bf16 v[240:243], a[168:171], a[240:243], v[240:243]
ds_read_b64_tr_b16 a[188:189], v12 offset:0
v_mfma_f32_16x16x32_bf16 v[244:247], a[168:171], a[244:247], v[244:247]
v_mfma_f32_16x16x32_bf16 v[248:251], a[168:171], a[248:251], v[248:251]
s_add_u32 s37, s31, 163840
ds_read_b64_tr_b16 a[190:191], v12 offset:1024
v_mfma_f32_16x16x32_bf16 v[252:255], a[168:171], a[252:255], v[252:255]
s_add_u32 m0, s33, 5120
ds_read_b64_tr_b16 a[168:169], v7 offset:0
v_mfma_f32_16x16x32_bf16 a[0:3], a[172:175], a[224:227], a[0:3]
buffer_load_dwordx4 v2, s[20:23], s37 offen  lds
ds_read_b64_tr_b16 a[170:171], v7 offset:1024
v_mfma_f32_16x16x32_bf16 a[4:7], a[172:175], a[228:231], a[4:7]
s_add_u32 s31, s31, 262144
v_xor_b32 v7, 64, v5
v_xor_b32 v12, 208, v5
v_mfma_f32_16x16x32_bf16 a[8:11], a[172:175], a[232:235], a[8:11]
s_add_u32 s33, s33, 16384
v_mfma_f32_16x16x32_bf16 a[12:15], a[172:175], a[236:239], a[12:15]
s_and_b32 s33, s33, 65535
v_mfma_f32_16x16x32_bf16 a[16:19], a[172:175], a[240:243], a[16:19]
v_mfma_f32_16x16x32_bf16 a[20:23], a[172:175], a[244:247], a[20:23]
s_mov_b32 s48, s30
v_mfma_f32_16x16x32_bf16 a[24:27], a[172:175], a[248:251], a[24:27]
s_add_u32 m0, s32, 0
v_mfma_f32_16x16x32_bf16 a[28:31], a[172:175], a[252:255], a[28:31]
buffer_load_dwordx4 v1, s[12:15], s48 offen lds
ds_read_b64_tr_b16 a[172:173], v8 offset:0
v_mfma_f32_16x16x32_bf16 a[32:35], a[176:179], a[224:227], a[32:35]
ds_read_b64_tr_b16 a[174:175], v8 offset:1024
v_mfma_f32_16x16x32_bf16 a[36:39], a[176:179], a[228:231], a[36:39]
v_xor_b32 v8, 80, v5
v_mfma_f32_16x16x32_bf16 a[40:43], a[176:179], a[232:235], a[40:43]
v_mfma_f32_16x16x32_bf16 a[44:47], a[176:179], a[236:239], a[44:47]
v_mfma_f32_16x16x32_bf16 a[48:51], a[176:179], a[240:243], a[48:51]
s_add_u32 s48, s48, s34
v_mfma_f32_16x16x32_bf16 a[52:55], a[176:179], a[244:247], a[52:55]
s_add_u32 m0, s32, 4096
v_mfma_f32_16x16x32_bf16 a[56:59], a[176:179], a[248:251], a[56:59]
buffer_load_dwordx4 v1, s[12:15], s48 offen lds
v_mfma_f32_16x16x32_bf16 a[60:63], a[176:179], a[252:255], a[60:63]
ds_read_b64_tr_b16 a[176:177], v9 offset:0
v_mfma_f32_16x16x32_bf16 a[64:67], a[180:183], a[224:227], a[64:67]
ds_read_b64_tr_b16 a[178:179], v9 offset:1024
v_mfma_f32_16x16x32_bf16 a[68:71], a[180:183], a[228:231], a[68:71]
v_xor_b32 v9, 128, v5
v_mfma_f32_16x16x32_bf16 a[72:75], a[180:183], a[232:235], a[72:75]
v_mfma_f32_16x16x32_bf16 a[76:79], a[180:183], a[236:239], a[76:79]
s_add_u32 s48, s48, s34
v_mfma_f32_16x16x32_bf16 a[80:83], a[180:183], a[240:243], a[80:83]
s_add_u32 m0, s32, 8192
v_mfma_f32_16x16x32_bf16 a[84:87], a[180:183], a[244:247], a[84:87]
buffer_load_dwordx4 v1, s[12:15], s48 offen lds
v_mfma_f32_16x16x32_bf16 a[88:91], a[180:183], a[248:251], a[88:91]
v_mfma_f32_16x16x32_bf16 a[92:95], a[180:183], a[252:255], a[92:95]
ds_read_b64_tr_b16 a[180:181], v10 offset:0
v_mfma_f32_16x16x32_bf16 a[96:99], a[184:187], a[224:227], a[96:99]
ds_read_b64_tr_b16 a[182:183], v10 offset:1024
v_mfma_f32_16x16x32_bf16 a[100:103], a[184:187], a[228:231], a[100:103]
v_xor_b32 v10, 144, v5
v_mfma_f32_16x16x32_bf16 a[104:107], a[184:187], a[232:235], a[104:107]
s_add_u32 s48, s48, s34
v_mfma_f32_16x16x32_bf16 a[108:111], a[184:187], a[236:239], a[108:111]
s_add_u32 m0, s32, 12288
v_mfma_f32_16x16x32_bf16 a[112:115], a[184:187], a[240:243], a[112:115]
buffer_load_dwordx4 v1, s[12:15], s48 offen lds
v_mfma_f32_16x16x32_bf16 a[116:119], a[184:187], a[244:247], a[116:119]
v_mfma_f32_16x16x32_bf16 a[120:123], a[184:187], a[248:251], a[120:123]
v_mfma_f32_16x16x32_bf16 a[124:127], a[184:187], a[252:255], a[124:127]
ds_read_b64_tr_b16 a[184:185], v11 offset:0
v_mfma_f32_16x16x32_bf16 a[128:131], v[28:31], a[224:227], a[128:131]
ds_read_b64_tr_b16 a[186:187], v11 offset:1024
v_mfma_f32_16x16x32_bf16 a[132:135], v[28:31], a[228:231], a[132:135]
v_xor_b32 v11, 192, v5
v_mfma_f32_16x16x32_bf16 a[136:139], v[28:31], a[232:235], a[136:139]
buffer_load_dword v15, v14, s[96:99], s100 offen
v_mfma_f32_16x16x32_bf16 a[140:143], v[28:31], a[236:239], a[140:143]
s_add_u32 s100, s100, 16384
v_mfma_f32_16x16x32_bf16 a[144:147], v[28:31], a[240:243], a[144:147]
v_mfma_f32_16x16x32_bf16 a[148:151], v[28:31], a[244:247], a[148:151]
v_mfma_f32_16x16x32_bf16 a[152:155], v[28:31], a[248:251], a[152:155]
v_mfma_f32_16x16x32_bf16 a[156:159], v[28:31], a[252:255], a[156:159]
s_waitcnt vmcnt(20) lgkmcnt(0)
s_barrier
v_mfma_f32_16x16x32_bf16 v[160:163], a[160:163], a[192:195], v[160:163]
ds_read_b128 a[224:227], v4 offset:0
v_mfma_f32_16x16x32_bf16 v[164:167], a[160:163], a[196:199], v[164:167]
s_add_u32 s37, s31, 0
v_mfma_f32_16x16x32_bf16 v[168:171], a[160:163], a[200:203], v[168:171]
s_add_u32 m0, s33, 0
ds_read_b128 a[228:231], v3 offset:1024
v_mfma_f32_16x16x32_bf16 v[172:175], a[160:163], a[204:207], v[172:175]
buffer_load_dwordx4 v2, s[20:23], s37 offen  lds
v_mfma_f32_16x16x32_bf16 v[176:179], a[160:163], a[208:211], v[176:179]
ds_read_b128 a[232:235], v4 offset:4096
v_mfma_f32_16x16x32_bf16 v[180:183], a[160:163], a[212:215], v[180:183]
v_mfma_f32_16x16x32_bf16 v[184:187], a[160:163], a[216:219], v[184:187]
ds_read_b128 a[236:239], v3 offset:5120
v_mfma_f32_16x16x32_bf16 v[188:191], a[160:163], a[220:223], v[188:191]
ds_read_b64_tr_b16 a[160:161], v5 offset:0
v_mfma_f32_16x16x32_bf16 v[192:195], a[164:167], a[192:195], v[192:195]
s_add_u32 s37, s31, 32768
ds_read_b64_tr_b16 a[162:163], v5 offset:1024
v_mfma_f32_16x16x32_bf16 v[196:199], a[164:167], a[196:199], v[196:199]
s_add_u32 m0, s33, 1024
ds_read_b128 a[240:243], v4 offset:8192
v_add_u32 v5, 16384, v5
v_mfma_f32_16x16x32_bf16 v[200:203], a[164:167], a[200:203], v[200:203]
buffer_load_dwordx4 v2, s[20:23], s37 offen  lds
v_and_b32 v5, 65535, v5
v_mfma_f32_16x16x32_bf16 v[204:207], a[164:167], a[204:207], v[204:207]
ds_read_b128 a[244:247], v3 offset:9216
v_mfma_f32_16x16x32_bf16 v[208:211], a[164:167], a[208:211], v[208:211]
v_mfma_f32_16x16x32_bf16 v[212:215], a[164:167], a[212:215], v[212:215]
ds_read_b128 a[248:251], v4 offset:12288
v_mfma_f32_16x16x32_bf16 v[216:219], a[164:167], a[216:219], v[216:219]
v_mfma_f32_16x16x32_bf16 v[220:223], a[164:167], a[220:223], v[220:223]
s_add_u32 s37, s31, 131072
ds_read_b64_tr_b16 a[164:165], v6 offset:0
v_mfma_f32_16x16x32_bf16 v[224:227], a[168:171], a[192:195], v[224:227]
s_add_u32 m0, s33, 4096
ds_read_b64_tr_b16 a[166:167], v6 offset:1024
v_mfma_f32_16x16x32_bf16 v[228:231], a[168:171], a[196:199], v[228:231]
buffer_load_dwordx4 v2, s[20:23], s37 offen  lds
v_xor_b32 v6, 16, v5
v_mfma_f32_16x16x32_bf16 v[232:235], a[168:171], a[200:203], v[232:235]
ds_read_b128 a[252:255], v3 offset:13312
v_mfma_f32_16x16x32_bf16 v[236:239], a[168:171], a[204:207], v[236:239]
v_mfma_f32_16x16x32_bf16 v[240:243], a[168:171], a[208:211], v[240:243]
ds_read_b64_tr_b16 v[28:29], v12 offset:0
v_mfma_f32_16x16x32_bf16 v[244:247], a[168:171], a[212:215], v[244:247]
v_mfma_f32_16x16x32_bf16 v[248:251], a[168:171], a[216:219], v[248:251]
s_add_u32 s37, s31, 163840
ds_read_b64_tr_b16 v[30:31], v12 offset:1024
v_mfma_f32_16x16x32_bf16 v[252:255], a[168:171], a[220:223], v[252:255]
s_add_u32 m0, s33, 5120
ds_read_b64_tr_b16 a[168:169], v7 offset:0
v_mfma_f32_16x16x32_bf16 a[0:3], a[172:175], a[192:195], a[0:3]
buffer_load_dwordx4 v2, s[20:23], s37 offen  lds
ds_read_b64_tr_b16 a[170:171], v7 offset:1024
v_mfma_f32_16x16x32_bf16 a[4:7], a[172:175], a[196:199], a[4:7]
s_add_u32 s31, s31, 262144
v_xor_b32 v7, 64, v5
v_xor_b32 v12, 208, v5
v_mfma_f32_16x16x32_bf16 a[8:11], a[172:175], a[200:203], a[8:11]
s_add_u32 s33, s33, 16384
v_add_u32 v3, 32768, v3
v_mfma_f32_16x16x32_bf16 a[12:15], a[172:175], a[204:207], a[12:15]
s_and_b32 s33, s33, 65535
v_subrev_u32 v19, 98304, v3
v_mfma_f32_16x16x32_bf16 a[16:19], a[172:175], a[208:211], a[16:19]
v_cmp_le_u32 vcc, 163840, v3
v_mfma_f32_16x16x32_bf16 a[20:23], a[172:175], a[212:215], a[20:23]
s_add_u32 s48, s48, s34
v_cndmask_b32 v3, v3, v19, vcc
v_mfma_f32_16x16x32_bf16 a[24:27], a[172:175], a[216:219], a[24:27]
s_add_u32 m0, s32, 16384
v_xor_b32 v4, 64, v3
v_mfma_f32_16x16x32_bf16 a[28:31], a[172:175], a[220:223], a[28:31]
buffer_load_dwordx4 v1, s[12:15], s48 offen lds
ds_read_b64_tr_b16 a[172:173], v8 offset:0
v_mfma_f32_16x16x32_bf16 a[32:35], a[176:179], a[192:195], a[32:35]
ds_read_b64_tr_b16 a[174:175], v8 offset:1024
v_mfma_f32_16x16x32_bf16 a[36:39], a[176:179], a[196:199], a[36:39]
v_xor_b32 v8, 80, v5
v_mfma_f32_16x16x32_bf16 a[40:43], a[176:179], a[200:203], a[40:43]
v_mfma_f32_16x16x32_bf16 a[44:47], a[176:179], a[204:207], a[44:47]
v_mfma_f32_16x16x32_bf16 a[48:51], a[176:179], a[208:211], a[48:51]
s_add_u32 s48, s48, s34
v_mfma_f32_16x16x32_bf16 a[52:55], a[176:179], a[212:215], a[52:55]
s_add_u32 m0, s32, 20480
v_mfma_f32_16x16x32_bf16 a[56:59], a[176:179], a[216:219], a[56:59]
buffer_load_dwordx4 v1, s[12:15], s48 offen lds
v_mfma_f32_16x16x32_bf16 a[60:63], a[176:179], a[220:223], a[60:63]
ds_read_b64_tr_b16 a[176:177], v9 offset:0
v_mfma_f32_16x16x32_bf16 a[64:67], a[180:183], a[192:195], a[64:67]
ds_read_b64_tr_b16 a[178:179], v9 offset:1024
v_mfma_f32_16x16x32_bf16 a[68:71], a[180:183], a[196:199], a[68:71]
v_xor_b32 v9, 128, v5
v_mfma_f32_16x16x32_bf16 a[72:75], a[180:183], a[200:203], a[72:75]
v_mfma_f32_16x16x32_bf16 a[76:79], a[180:183], a[204:207], a[76:79]
s_add_u32 s48, s48, s34
v_mfma_f32_16x16x32_bf16 a[80:83], a[180:183], a[208:211], a[80:83]
s_add_u32 m0, s32, 24576
v_mfma_f32_16x16x32_bf16 a[84:87], a[180:183], a[212:215], a[84:87]
buffer_load_dwordx4 v1, s[12:15], s48 offen lds
v_mfma_f32_16x16x32_bf16 a[88:91], a[180:183], a[216:219], a[88:91]
v_mfma_f32_16x16x32_bf16 a[92:95], a[180:183], a[220:223], a[92:95]
ds_read_b64_tr_b16 a[180:181], v10 offset:0
v_mfma_f32_16x16x32_bf16 a[96:99], a[184:187], a[192:195], a[96:99]
ds_read_b64_tr_b16 a[182:183], v10 offset:1024
v_mfma_f32_16x16x32_bf16 a[100:103], a[184:187], a[196:199], a[100:103]
v_xor_b32 v10, 144, v5
v_mfma_f32_16x16x32_bf16 a[104:107], a[184:187], a[200:203], a[104:107]
s_add_u32 s48, s48, s34
v_mfma_f32_16x16x32_bf16 a[108:111], a[184:187], a[204:207], a[108:111]
s_add_u32 m0, s32, 28672
v_mfma_f32_16x16x32_bf16 a[112:115], a[184:187], a[208:211], a[112:115]
buffer_load_dwordx4 v1, s[12:15], s48 offen lds
v_mfma_f32_16x16x32_bf16 a[116:119], a[184:187], a[212:215], a[116:119]
s_add_u32 s30, s30, 128
v_mfma_f32_16x16x32_bf16 a[120:123], a[184:187], a[216:219], a[120:123]
s_add_u32 s32, s32, 32768
v_mfma_f32_16x16x32_bf16 a[124:127], a[184:187], a[220:223], a[124:127]
s_sub_u32 s48, s32, 98304
ds_read_b64_tr_b16 a[184:185], v11 offset:0
v_mfma_f32_16x16x32_bf16 a[128:131], a[188:191], a[192:195], a[128:131]
s_cmp_ge_u32 s32, 163840
s_cselect_b32 s32, s48, s32
ds_read_b64_tr_b16 a[186:187], v11 offset:1024
v_mfma_f32_16x16x32_bf16 a[132:135], a[188:191], a[196:199], a[132:135]
v_xor_b32 v11, 192, v5
v_mfma_f32_16x16x32_bf16 a[136:139], a[188:191], a[200:203], a[136:139]
buffer_load_dword v15, v14, s[96:99], s100 offen
v_mfma_f32_16x16x32_bf16 a[140:143], a[188:191], a[204:207], a[140:143]
s_add_u32 s100, s100, 16384
v_mfma_f32_16x16x32_bf16 a[144:147], a[188:191], a[208:211], a[144:147]
v_mfma_f32_16x16x32_bf16 a[148:151], a[188:191], a[212:215], a[148:151]
v_mfma_f32_16x16x32_bf16 a[152:155], a[188:191], a[216:219], a[152:155]
v_mfma_f32_16x16x32_bf16 a[156:159], a[188:191], a[220:223], a[156:159]
s_cmp_eq_u32 s41, 0
s_cbranch_scc0 L_g_k17v
s_waitcnt vmcnt(18) lgkmcnt(0)
s_barrier
v_mfma_f32_16x16x32_bf16 v[160:163], a[160:163], a[224:227], v[160:163]
ds_read_b128 a[192:195], v3 offset:0
v_mfma_f32_16x16x32_bf16 v[164:167], a[160:163], a[228:231], v[164:167]
s_add_u32 s37, s31, 0
v_mfma_f32_16x16x32_bf16 v[168:171], a[160:163], a[232:235], v[168:171]
s_add_u32 m0, s33, 0
ds_read_b128 a[196:199], v4 offset:1024
v_mfma_f32_16x16x32_bf16 v[172:175], a[160:163], a[236:239], v[172:175]
buffer_load_dwordx4 v2, s[20:23], s37 offen  lds
v_mfma_f32_16x16x32_bf16 v[176:179], a[160:163], a[240:243], v[176:179]
ds_read_b128 a[200:203], v3 offset:4096
v_cvt_pk_bf16_f32 v32, v160, v161
v_cvt_pk_bf16_f32 v33, v162, v163
v_mfma_f32_16x16x32_bf16 v[180:183], a[160:163], a[244:247], v[180:183]
v_cvt_pk_bf16_f32 v36, v164, v165
v_cvt_pk_bf16_f32 v37, v166, v167
v_mfma_f32_16x16x32_bf16 v[184:187], a[160:163], a[248:251], v[184:187]
ds_read_b128 a[204:207], v4 offset:5120
v_cvt_pk_bf16_f32 v40, v168, v169
v_cvt_pk_bf16_f32 v41, v170, v171
v_mfma_f32_16x16x32_bf16 v[188:191], a[160:163], a[252:255], v[188:191]
ds_read_b64_tr_b16 a[160:161], v5 offset:0
v_cvt_pk_bf16_f32 v44, v172, v173
v_cvt_pk_bf16_f32 v45, v174, v175
v_mfma_f32_16x16x32_bf16 v[192:195], a[164:167], a[224:227], v[192:195]
s_add_u32 s37, s31, 32768
ds_read_b64_tr_b16 a[162:163], v5 offset:1024
v_cvt_pk_bf16_f32 v48, v176, v177
v_cvt_pk_bf16_f32 v49, v178, v179
v_mfma_f32_16x16x32_bf16 v[196:199], a[164:167], a[228:231], v[196:199]
s_add_u32 m0, s33, 1024
ds_read_b128 a[208:211], v3 offset:8192
v_add_u32 v5, 16384, v5
v_cvt_pk_bf16_f32 v52, v180, v181
v_cvt_pk_bf16_f32 v53, v182, v183
v_mfma_f32_16x16x32_bf16 v[200:203], a[164:167], a[232:235], v[200:203]
buffer_load_dwordx4 v2, s[20:23], s37 offen  lds
v_and_b32 v5, 65535, v5
v_cvt_pk_bf16_f32 v56, v184, v185
v_cvt_pk_bf16_f32 v57, v186, v187
v_mfma_f32_16x16x32_bf16 v[204:207], a[164:167], a[236:239], v[204:207]
ds_read_b128 a[212:215], v4 offset:9216
v_cvt_pk_bf16_f32 v60, v188, v189
v_cvt_pk_bf16_f32 v61, v190, v191
v_mfma_f32_16x16x32_bf16 v[208:211], a[164:167], a[240:243], v[208:211]
v_cvt_pk_bf16_f32 v34, v192, v193
v_cvt_pk_bf16_f32 v35, v194, v195
v_mfma_f32_16x16x32_bf16 v[212:215], a[164:167], a[244:247], v[212:215]
ds_read_b128 a[216:219], v3 offset:12288
v_cvt_pk_bf16_f32 v38, v196, v197
v_cvt_pk_bf16_f32 v39, v198, v199
v_mfma_f32_16x16x32_bf16 v[216:219], a[164:167], a[248:251], v[216:219]
v_cvt_pk_bf16_f32 v42, v200, v201
v_cvt_pk_bf16_f32 v43, v202, v203
v_mfma_f32_16x16x32_bf16 v[220:223], a[164:167], a[252:255], v[220:223]
s_add_u32 s37, s31, 131072
ds_read_b64_tr_b16 a[164:165], v6 offset:0
v_cvt_pk_bf16_f32 v46, v204, v205
v_cvt_pk_bf16_f32 v47, v206, v207
v_mfma_f32_16x16x32_bf16 v[224:227], a[168:171], a[224:227], v[224:227]
s_add_u32 m0, s33, 4096
ds_read_b64_tr_b16 a[166:167], v6 offset:1024
v_cvt_pk_bf16_f32 v50, v208, v209
v_cvt_pk_bf16_f32 v51, v210, v211
v_mfma_f32_16x16x32_bf16 v[228:231], a[168:171], a[228:231], v[228:231]
buffer_load_dwordx4 v2, s[20:23], s37 offen  lds
v_xor_b32 v6, 16, v5
v_cvt_pk_bf16_f32 v54, v212, v213
v_cvt_pk_bf16_f32 v55, v214, v215
v_mfma_f32_16x16x32_bf16 v[232:235], a[168:171], a[232:235], v[232:235]
ds_read_b128 a[220:223], v4 offset:13312
v_cvt_pk_bf16_f32 v58, v216, v217
v_cvt_pk_bf16_f32 v59, v218, v219
v_mfma_f32_16x16x32_bf16 v[236:239], a[168:171], a[236:239], v[236:239]
v_cvt_pk_bf16_f32 v62, v220, v221
v_cvt_pk_bf16_f32 v63, v222, v223
v_mfma_f32_16x16x32_bf16 v[240:243], a[168:171], a[240:243], v[240:243]
ds_read_b64_tr_b16 a[188:189], v12 offset:0
v_cvt_pk_bf16_f32 v64, v224, v225
v_cvt_pk_bf16_f32 v65, v226, v227
v_mfma_f32_16x16x32_bf16 v[244:247], a[168:171], a[244:247], v[244:247]
v_cvt_pk_bf16_f32 v68, v228, v229
v_cvt_pk_bf16_f32 v69, v230, v231
v_mfma_f32_16x16x32_bf16 v[248:251], a[168:171], a[248:251], v[248:251]
s_add_u32 s37, s31, 163840
ds_read_b64_tr_b16 a[190:191], v12 offset:1024
v_cvt_pk_bf16_f32 v72, v232, v233
v_cvt_pk_bf16_f32 v73, v234, v235
v_mfma_f32_16x16x32_bf16 v[252:255], a[168:171], a[252:255], v[252:255]
s_add_u32 m0, s33, 5120
ds_read_b64_tr_b16 a[168:169], v7 offset:0
v_cvt_pk_bf16_f32 v76, v236, v237
v_cvt_pk_bf16_f32 v77, v238, v239
v_mfma_f32_16x16x32_bf16 a[0:3], a[172:175], a[224:227], a[0:3]
buffer_load_dwordx4 v2, s[20:23], s37 offen  lds
ds_read_b64_tr_b16 a[170:171], v7 offset:1024
v_cvt_pk_bf16_f32 v80, v240, v241
v_cvt_pk_bf16_f32 v81, v242, v243
v_mfma_f32_16x16x32_bf16 a[4:7], a[172:175], a[228:231], a[4:7]
s_add_u32 s31, s31, 262144
v_xor_b32 v7, 64, v5
v_xor_b32 v12, 208, v5
v_cvt_pk_bf16_f32 v84, v244, v245
v_cvt_pk_bf16_f32 v85, v246, v247
v_mfma_f32_16x16x32_bf16 a[8:11], a[172:175], a[232:235], a[8:11]
s_add_u32 s33, s33, 16384
v_cvt_pk_bf16_f32 v88, v248, v249
v_cvt_pk_bf16_f32 v89, v250, v251
v_mfma_f32_16x16x32_bf16 a[12:15], a[172:175], a[236:239], a[12:15]
s_and_b32 s33, s33, 65535
v_cvt_pk_bf16_f32 v92, v252, v253
v_cvt_pk_bf16_f32 v93, v254, v255
v_mfma_f32_16x16x32_bf16 a[16:19], a[172:175], a[240:243], a[16:19]
v_accvgpr_read_b32 v20, a0
v_accvgpr_read_b32 v21, a1
v_accvgpr_read_b32 v22, a2
v_accvgpr_read_b32 v23, a3
v_mfma_f32_16x16x32_bf16 a[20:23], a[172:175], a[244:247], a[20:23]
s_mov_b32 s48, s30
v_cvt_pk_bf16_f32 v66, v20, v21
v_cvt_pk_bf16_f32 v67, v22, v23
v_accvgpr_read_b32 v24, a4
v_accvgpr_read_b32 v25, a5
v_mfma_f32_16x16x32_bf16 a[24:27], a[172:175], a[248:251], a[24:27]
s_add_u32 m0, s32, 0
v_accvgpr_read_b32 v26, a6
v_accvgpr_read_b32 v27, a7
v_cvt_pk_bf16_f32 v70, v24, v25
v_cvt_pk_bf16_f32 v71, v26, v27
v_mfma_f32_16x16x32_bf16 a[28:31], a[172:175], a[252:255], a[28:31]
buffer_load_dwordx4 v1, s[12:15], s48 offen lds
ds_read_b64_tr_b16 a[172:173], v8 offset:0
v_accvgpr_read_b32 v20, a8
v_accvgpr_read_b32 v21, a9
v_mfma_f32_16x16x32_bf16 a[32:35], a[176:179], a[224:227], a[32:35]
ds_read_b64_tr_b16 a[174:175], v8 offset:1024
v_mov_b32 v16, 0
v_accvgpr_read_b32 v22, a10
v_accvgpr_read_b32 v23, a11
v_mfma_f32_16x16x32_bf16 a[36:39], a[176:179], a[228:231], a[36:39]
v_mov_b32 v17, 1
v_xor_b32 v8, 80, v5
v_cvt_pk_bf16_f32 v74, v20, v21
v_cvt_pk_bf16_f32 v75, v22, v23
v_mfma_f32_16x16x32_bf16 a[40:43], a[176:179], a[232:235], a[40:43]
s_cmp_eq_u32 s17, 0
s_cselect_b32 s29, s39, 536870912
v_accvgpr_read_b32 v24, a12
v_accvgpr_read_b32 v25, a13
v_mfma_f32_16x16x32_bf16 a[44:47], a[176:179], a[236:239], a[44:47]
s_mov_b64 exec, 1
buffer_store_dword v17, v16, s[8:11], s29 offen sc1
s_mov_b64 exec, -1
v_accvgpr_read_b32 v26, a14
v_mfma_f32_16x16x32_bf16 a[48:51], a[176:179], a[240:243], a[48:51]
s_add_u32 s48, s48, s34
v_accvgpr_read_b32 v27, a15
v_cvt_pk_bf16_f32 v78, v24, v25
v_cvt_pk_bf16_f32 v79, v26, v27
v_accvgpr_read_b32 v20, a16
v_mfma_f32_16x16x32_bf16 a[52:55], a[176:179], a[244:247], a[52:55]
s_add_u32 m0, s32, 4096
v_accvgpr_read_b32 v21, a17
v_accvgpr_read_b32 v22, a18
v_accvgpr_read_b32 v23, a19
v_cvt_pk_bf16_f32 v82, v20, v21
v_mfma_f32_16x16x32_bf16 a[56:59], a[176:179], a[248:251], a[56:59]
buffer_load_dwordx4 v1, s[12:15], s48 offen lds
v_cvt_pk_bf16_f32 v83, v22, v23
v_accvgpr_read_b32 v24, a20
v_accvgpr_read_b32 v25, a21
v_mfma_f32_16x16x32_bf16 a[60:63], a[176:179], a[252:255], a[60:63]
ds_read_b64_tr_b16 a[176:177], v9 offset:0
v_accvgpr_read_b32 v26, a22
v_accvgpr_read_b32 v27, a23
v_cvt_pk_bf16_f32 v86, v24, v25
v_mfma_f32_16x16x32_bf16 a[64:67], a[180:183], a[224:227], a[64:67]
ds_read_b64_tr_b16 a[178:179], v9 offset:1024
v_cvt_pk_bf16_f32 v87, v26, v27
v_accvgpr_read_b32 v20, a24
v_accvgpr_read_b32 v21, a25
v_mfma_f32_16x16x32_bf16 a[68:71], a[180:183], a[228:231], a[68:71]
v_xor_b32 v9, 128, v5
v_accvgpr_read_b32 v22, a26
v_accvgpr_read_b32 v23, a27
v_cvt_pk_bf16_f32 v90, v20, v21
v_mfma_f32_16x16x32_bf16 a[72:75], a[180:183], a[232:235], a[72:75]
v_cvt_pk_bf16_f32 v91, v22, v23
v_accvgpr_read_b32 v24, a28
v_accvgpr_read_b32 v25, a29
v_accvgpr_read_b32 v26, a30
v_mfma_f32_16x16x32_bf16 a[76:79], a[180:183], a[236:239], a[76:79]
s_add_u32 s48, s48, s34
v_accvgpr_read_b32 v27, a31
v_cvt_pk_bf16_f32 v94, v24, v25
v_cvt_pk_bf16_f32 v95, v26, v27
v_accvgpr_read_b32 v20, a32
v_mfma_f32_16x16x32_bf16 a[80:83], a[180:183], a[240:243], a[80:83]
s_add_u32 m0, s32, 8192
v_accvgpr_read_b32 v21, a33
v_accvgpr_read_b32 v22, a34
v_accvgpr_read_b32 v23, a35
v_cvt_pk_bf16_f32 v96, v20, v21
v_mfma_f32_16x16x32_bf16 a[84:87], a[180:183], a[244:247], a[84:87]
buffer_load_dwordx4 v1, s[12:15], s48 offen lds
v_cvt_pk_bf16_f32 v97, v22, v23
v_accvgpr_read_b32 v24, a36
v_accvgpr_read_b32 v25, a37
v_mfma_f32_16x16x32_bf16 a[88:91], a[180:183], a[248:251], a[88:91]
v_accvgpr_read_b32 v26, a38
v_accvgpr_read_b32 v27, a39
v_cvt_pk_bf16_f32 v100, v24, v25
v_cvt_pk_bf16_f32 v101, v26, v27
v_mfma_f32_16x16x32_bf16 a[92:95], a[180:183], a[252:255], a[92:95]
ds_read_b64_tr_b16 a[180:181], v10 offset:0
v_accvgpr_read_b32 v20, a40
v_accvgpr_read_b32 v21, a41
v_accvgpr_read_b32 v22, a42
v_mfma_f32_16x16x32_bf16 a[96:99], a[184:187], a[224:227], a[96:99]
ds_read_b64_tr_b16 a[182:183], v10 offset:1024
v_accvgpr_read_b32 v23, a43
v_cvt_pk_bf16_f32 v104, v20, v21
v_cvt_pk_bf16_f32 v105, v22, v23
v_mfma_f32_16x16x32_bf16 a[100:103], a[184:187], a[228:231], a[100:103]
v_xor_b32 v10, 144, v5
v_accvgpr_read_b32 v24, a44
v_accvgpr_read_b32 v25, a45
v_accvgpr_read_b32 v26, a46
v_mfma_f32_16x16x32_bf16 a[104:107], a[184:187], a[232:235], a[104:107]
s_add_u32 s48, s48, s34
v_accvgpr_read_b32 v27, a47
v_cvt_pk_bf16_f32 v108, v24, v25
v_cvt_pk_bf16_f32 v109, v26, v27
v_accvgpr_read_b32 v20, a48
v_mfma_f32_16x16x32_bf16 a[108:111], a[184:187], a[236:239], a[108:111]
s_add_u32 m0, s32, 12288
v_accvgpr_read_b32 v21, a49
v_accvgpr_read_b32 v22, a50
v_accvgpr_read_b32 v23, a51
v_cvt_pk_bf16_f32 v112, v20, v21
v_mfma_f32_16x16x32_bf16 a[112:115], a[184:187], a[240:243], a[112:115]
buffer_load_dwordx4 v1, s[12:15], s48 offen lds
v_cvt_pk_bf16_f32 v113, v22, v23
v_accvgpr_read_b32 v24, a52
v_accvgpr_read_b32 v25, a53
v_mfma_f32_16x16x32_bf16 a[116:119], a[184:187], a[244:247], a[116:119]
v_accvgpr_read_b32 v26, a54
v_accvgpr_read_b32 v27, a55
v_cvt_pk_bf16_f32 v116, v24, v25
v_cvt_pk_bf16_f32 v117, v26, v27
v_mfma_f32_16x16x32_bf16 a[120:123], a[184:187], a[248:251], a[120:123]
v_accvgpr_read_b32 v20, a56
v_accvgpr_read_b32 v21, a57
v_accvgpr_read_b32 v22, a58
v_accvgpr_read_b32 v23, a59
v_mfma_f32_16x16x32_bf16 a[124:127], a[184:187], a[252:255], a[124:127]
ds_read_b64_tr_b16 a[184:185], v11 offset:0
v_cvt_pk_bf16_f32 v120, v20, v21
v_cvt_pk_bf16_f32 v121, v22, v23
v_accvgpr_read_b32 v24, a60
v_mfma_f32_16x16x32_bf16 a[128:131], v[28:31], a[224:227], a[128:131]
ds_read_b64_tr_b16 a[186:187], v11 offset:1024
v_accvgpr_read_b32 v25, a61
v_accvgpr_read_b32 v26, a62
v_accvgpr_read_b32 v27, a63
v_mfma_f32_16x16x32_bf16 a[132:135], v[28:31], a[228:231], a[132:135]
v_xor_b32 v11, 192, v5
v_cvt_pk_bf16_f32 v124, v24, v25
v_cvt_pk_bf16_f32 v125, v26, v27
v_mfma_f32_16x16x32_bf16 a[136:139], v[28:31], a[232:235], a[136:139]
buffer_load_dword v15, v14, s[96:99], s100 offen
v_mfma_f32_16x16x32_bf16 a[140:143], v[28:31], a[236:239], a[140:143]
s_add_u32 s100, s100, 16384
v_mfma_f32_16x16x32_bf16 a[144:147], v[28:31], a[240:243], a[144:147]
v_mfma_f32_16x16x32_bf16 a[148:151], v[28:31], a[244:247], a[148:151]
v_mfma_f32_16x16x32_bf16 a[152:155], v[28:31], a[248:251], a[152:155]
v_mfma_f32_16x16x32_bf16 a[156:159], v[28:31], a[252:255], a[156:159]
s_cmp_lt_u32 s35, s45
s_cbranch_scc1 L_g_tile
s_branch L_g_end
L_g_k17v:
s_waitcnt vmcnt(18) lgkmcnt(0)
s_barrier
v_mfma_f32_16x16x32_bf16 v[160:163], a[160:163], a[224:227], v[160:163]
ds_read_b64_tr_b16 a[192:193], v5 offset:0
v_mfma_f32_16x16x32_bf16 v[164:167], a[160:163], a[228:231], v[164:167]
s_add_u32 s37, s31, 0
v_mfma_f32_16x16x32_bf16 v[168:171], a[160:163], a[232:235], v[168:171]
s_add_u32 m0, s33, 0
ds_read_b64_tr_b16 a[194:195], v5 offset:1024
v_mfma_f32_16x16x32_bf16 v[172:175], a[160:163], a[236:239], v[172:175]
buffer_load_dwordx4 v2, s[20:23], s37 offen  lds
v_mfma_f32_16x16x32_bf16 v[176:179], a[160:163], a[240:243], v[176:179]
ds_read_b64_tr_b16 a[196:197], v6 offset:0
v_cvt_pk_bf16_f32 v32, v160, v161
v_cvt_pk_bf16_f32 v33, v162, v163
v_mfma_f32_16x16x32_bf16 v[180:183], a[160:163], a[244:247], v[180:183]
v_cvt_pk_bf16_f32 v36, v164, v165
v_cvt_pk_bf16_f32 v37, v166, v167
v_mfma_f32_16x16x32_bf16 v[184:187], a[160:163], a[248:251], v[184:187]
ds_read_b64_tr_b16 a[198:199], v6 offset:1024
v_cvt_pk_bf16_f32 v40, v168, v169
v_cvt_pk_bf16_f32 v41, v170, v171
v_mfma_f32_16x16x32_bf16 v[188:191], a[160:163], a[252:255], v[188:191]
ds_read_b128 a[160:163], v3 offset:0
v_cvt_pk_bf16_f32 v44, v172, v173
v_cvt_pk_bf16_f32 v45, v174, v175
v_mfma_f32_16x16x32_bf16 v[192:195], a[164:167], a[224:227], v[192:195]
s_add_u32 s37, s31, 32768
ds_read_b64_tr_b16 a[200:201], v7 offset:0
v_cvt_pk_bf16_f32 v48, v176, v177
v_cvt_pk_bf16_f32 v49, v178, v179
v_mfma_f32_16x16x32_bf16 v[196:199], a[164:167], a[228:231], v[196:199]
s_add_u32 m0, s33, 1024
v_cvt_pk_bf16_f32 v52, v180, v181
v_cvt_pk_bf16_f32 v53, v182, v183
v_mfma_f32_16x16x32_bf16 v[200:203], a[164:167], a[232:235], v[200:203]
buffer_load_dwordx4 v2, s[20:23], s37 offen  lds
v_cvt_pk_bf16_f32 v56, v184, v185
v_cvt_pk_bf16_f32 v57, v186, v187
v_mfma_f32_16x16x32_bf16 v[204:207], a[164:167], a[236:239], v[204:207]
ds_read_b64_tr_b16 a[202:203], v7 offset:1024
v_cvt_pk_bf16_f32 v60, v188, v189
v_cvt_pk_bf16_f32 v61, v190, v191
v_mfma_f32_16x16x32_bf16 v[208:211], a[164:167], a[240:243], v[208:211]
v_cvt_pk_bf16_f32 v34, v192, v193
v_cvt_pk_bf16_f32 v35, v194, v195
v_mfma_f32_16x16x32_bf16 v[212:215], a[164:167], a[244:247], v[212:215]
ds_read_b64_tr_b16 a[204:205], v8 offset:0
v_cvt_pk_bf16_f32 v38, v196, v197
v_cvt_pk_bf16_f32 v39, v198, v199
v_mfma_f32_16x16x32_bf16 v[216:219], a[164:167], a[248:251], v[216:219]
v_cvt_pk_bf16_f32 v42, v200, v201
v_cvt_pk_bf16_f32 v43, v202, v203
v_mfma_f32_16x16x32_bf16 v[220:223], a[164:167], a[252:255], v[220:223]
s_add_u32 s37, s31, 131072
ds_read_b128 a[164:167], v4 offset:1024
v_cvt_pk_bf16_f32 v46, v204, v205
v_cvt_pk_bf16_f32 v47, v206, v207
v_mfma_f32_16x16x32_bf16 v[224:227], a[168:171], a[224:227], v[224:227]
s_add_u32 m0, s33, 4096
ds_read_b64_tr_b16 a[206:207], v8 offset:1024
v_cvt_pk_bf16_f32 v50, v208, v209
v_cvt_pk_bf16_f32 v51, v210, v211
v_mfma_f32_16x16x32_bf16 v[228:231], a[168:171], a[228:231], v[228:231]
buffer_load_dwordx4 v2, s[20:23], s37 offen  lds
v_cvt_pk_bf16_f32 v54, v212, v213
v_cvt_pk_bf16_f32 v55, v214, v215
v_mfma_f32_16x16x32_bf16 v[232:235], a[168:171], a[232:235], v[232:235]
ds_read_b64_tr_b16 a[208:209], v9 offset:0
v_cvt_pk_bf16_f32 v58, v216, v217
v_cvt_pk_bf16_f32 v59, v218, v219
v_mfma_f32_16x16x32_bf16 v[236:239], a[168:171], a[236:239], v[236:239]
v_cvt_pk_bf16_f32 v62, v220, v221
v_cvt_pk_bf16_f32 v63, v222, v223
v_mfma_f32_16x16x32_bf16 v[240:243], a[168:171], a[240:243], v[240:243]
ds_read_b64_tr_b16 a[210:211], v9 offset:1024
v_cvt_pk_bf16_f32 v64, v224, v225
v_cvt_pk_bf16_f32 v65, v226, v227
v_mfma_f32_16x16x32_bf16 v[244:247], a[168:171], a[244:247], v[244:247]
v_cvt_pk_bf16_f32 v68, v228, v229
v_cvt_pk_bf16_f32 v69, v230, v231
v_mfma_f32_16x16x32_bf16 v[248:251], a[168:171], a[248:251], v[248:251]
s_add_u32 s37, s31, 163840
ds_read_b64_tr_b16 a[212:213], v10 offset:0
v_cvt_pk_bf16_f32 v72, v232, v233
v_cvt_pk_bf16_f32 v73, v234, v235
v_mfma_f32_16x16x32_bf16 v[252:255], a[168:171], a[252:255], v[252:255]
s_add_u32 m0, s33, 5120
ds_read_b128 a[168:171], v3 offset:4096
v_cvt_pk_bf16_f32 v76, v236, v237
v_cvt_pk_bf16_f32 v77, v238, v239
v_mfma_f32_16x16x32_bf16 a[0:3], a[172:175], a[224:227], a[0:3]
buffer_load_dwordx4 v2, s[20:23], s37 offen  lds
v_cvt_pk_bf16_f32 v80, v240, v241
v_cvt_pk_bf16_f32 v81, v242, v243
v_mfma_f32_16x16x32_bf16 a[4:7], a[172:175], a[228:231], a[4:7]
s_add_u32 s31, s31, 262144
ds_read_b64_tr_b16 a[214:215], v10 offset:1024
v_cvt_pk_bf16_f32 v84, v244, v245
v_cvt_pk_bf16_f32 v85, v246, v247
v_mfma_f32_16x16x32_bf16 a[8:11], a[172:175], a[232:235], a[8:11]
s_add_u32 s33, s33, 16384
v_cvt_pk_bf16_f32 v88, v248, v249
v_cvt_pk_bf16_f32 v89, v250, v251
v_mfma_f32_16x16x32_bf16 a[12:15], a[172:175], a[236:239], a[12:15]
s_and_b32 s33, s33, 65535
ds_read_b64_tr_b16 a[216:217], v11 offset:0
v_cvt_pk_bf16_f32 v92, v252, v253
v_cvt_pk_bf16_f32 v93, v254, v255
v_mfma_f32_16x16x32_bf16 a[16:19], a[172:175], a[240:243], a[16:19]
v_accvgpr_read_b32 v20, a0
v_accvgpr_read_b32 v21, a1
v_accvgpr_read_b32 v22, a2
v_accvgpr_read_b32 v23, a3
v_mfma_f32_16x16x32_bf16 a[20:23], a[172:175], a[244:247], a[20:23]
s_mov_b32 s48, s30
ds_read_b64_tr_b16 a[218:219], v11 offset:1024
v_cvt_pk_bf16_f32 v66, v20, v21
v_cvt_pk_bf16_f32 v67, v22, v23
v_accvgpr_read_b32 v24, a4
v_mfma_f32_16x16x32_bf16 a[24:27], a[172:175], a[248:251], a[24:27]
s_add_u32 m0, s32, 0
v_accvgpr_read_b32 v25, a5
v_accvgpr_read_b32 v26, a6
v_accvgpr_read_b32 v27, a7
v_cvt_pk_bf16_f32 v70, v24, v25
v_mfma_f32_16x16x32_bf16 a[28:31], a[172:175], a[252:255], a[28:31]
buffer_load_dwordx4 v1, s[12:15], s48 offen lds
ds_read_b128 a[172:175], v4 offset:5120
v_cvt_pk_bf16_f32 v71, v26, v27
v_accvgpr_read_b32 v20, a8
v_mfma_f32_16x16x32_bf16 a[32:35], a[176:179], a[224:227], a[32:35]
ds_read_b64_tr_b16 a[220:221], v12 offset:0
v_mov_b32 v16, 0
v_accvgpr_read_b32 v21, a9
v_accvgpr_read_b32 v22, a10
v_mfma_f32_16x16x32_bf16 a[36:39], a[176:179], a[228:231], a[36:39]
v_mov_b32 v17, 1
v_accvgpr_read_b32 v23, a11
v_cvt_pk_bf16_f32 v74, v20, v21
v_cvt_pk_bf16_f32 v75, v22, v23
v_mfma_f32_16x16x32_bf16 a[40:43], a[176:179], a[232:235], a[40:43]
ds_read_b64_tr_b16 a[222:223], v12 offset:1024
v_accvgpr_read_b32 v24, a12
v_accvgpr_read_b32 v25, a13
v_accvgpr_read_b32 v26, a14
v_mfma_f32_16x16x32_bf16 a[44:47], a[176:179], a[236:239], a[44:47]
s_cmp_eq_u32 s17, 0
s_cselect_b32 s29, s39, 536870912
v_accvgpr_read_b32 v27, a15
v_cvt_pk_bf16_f32 v78, v24, v25
v_mfma_f32_16x16x32_bf16 a[48:51], a[176:179], a[240:243], a[48:51]
s_add_u32 s48, s48, s34
ds_read_b128 a[188:191], v4 offset:13312
v_cvt_pk_bf16_f32 v79, v26, v27
v_accvgpr_read_b32 v20, a16
v_accvgpr_read_b32 v21, a17
v_mfma_f32_16x16x32_bf16 a[52:55], a[176:179], a[244:247], a[52:55]
s_add_u32 m0, s32, 4096
v_accvgpr_read_b32 v22, a18
v_accvgpr_read_b32 v23, a19
v_cvt_pk_bf16_f32 v82, v20, v21
v_cvt_pk_bf16_f32 v83, v22, v23
v_mfma_f32_16x16x32_bf16 a[56:59], a[176:179], a[248:251], a[56:59]
buffer_load_dwordx4 v1, s[12:15], s48 offen lds
v_accvgpr_read_b32 v24, a20
v_accvgpr_read_b32 v25, a21
v_accvgpr_read_b32 v26, a22
v_mfma_f32_16x16x32_bf16 a[60:63], a[176:179], a[252:255], a[60:63]
ds_read_b128 a[176:179], v3 offset:8192
v_add_u32 v5, 16384, v5
v_accvgpr_read_b32 v27, a23
v_cvt_pk_bf16_f32 v86, v24, v25
v_mfma_f32_16x16x32_bf16 a[64:67], a[180:183], a[224:227], a[64:67]
s_mov_b64 exec, 1
buffer_store_dword v17, v16, s[8:11], s29 offen sc1
s_mov_b64 exec, -1
v_cvt_pk_bf16_f32 v87, v26, v27
v_mfma_f32_16x16x32_bf16 a[68:71], a[180:183], a[228:231], a[68:71]
v_and_b32 v5, 65535, v5
v_xor_b32 v6, 16, v5
v_accvgpr_read_b32 v20, a24
v_accvgpr_read_b32 v21, a25
v_mfma_f32_16x16x32_bf16 a[72:75], a[180:183], a[232:235], a[72:75]
v_xor_b32 v7, 64, v5
v_xor_b32 v8, 80, v5
v_accvgpr_read_b32 v22, a26
v_accvgpr_read_b32 v23, a27
v_mfma_f32_16x16x32_bf16 a[76:79], a[180:183], a[236:239], a[76:79]
s_add_u32 s48, s48, s34
v_xor_b32 v9, 128, v5
v_xor_b32 v10, 144, v5
v_cvt_pk_bf16_f32 v90, v20, v21
v_cvt_pk_bf16_f32 v91, v22, v23
v_mfma_f32_16x16x32_bf16 a[80:83], a[180:183], a[240:243], a[80:83]
s_add_u32 m0, s32, 8192
v_xor_b32 v11, 192, v5
v_xor_b32 v12, 208, v5
v_accvgpr_read_b32 v24, a28
v_accvgpr_read_b32 v25, a29
v_mfma_f32_16x16x32_bf16 a[84:87], a[180:183], a[244:247], a[84:87]
buffer_load_dwordx4 v1, s[12:15], s48 offen lds
v_accvgpr_read_b32 v26, a30
v_accvgpr_read_b32 v27, a31
v_cvt_pk_bf16_f32 v94, v24, v25
v_mfma_f32_16x16x32_bf16 a[88:91], a[180:183], a[248:251], a[88:91]
v_cvt_pk_bf16_f32 v95, v26, v27
v_accvgpr_read_b32 v20, a32
v_accvgpr_read_b32 v21, a33
v_accvgpr_read_b32 v22, a34
v_mfma_f32_16x16x32_bf16 a[92:95], a[180:183], a[252:255], a[92:95]
ds_read_b128 a[180:183], v4 offset:9216
v_accvgpr_read_b32 v23, a35
v_cvt_pk_bf16_f32 v96, v20, v21
v_cvt_pk_bf16_f32 v97, v22, v23
v_mfma_f32_16x16x32_bf16 a[96:99], a[184:187], a[224:227], a[96:99]
v_accvgpr_read_b32 v24, a36
v_accvgpr_read_b32 v25, a37
v_accvgpr_read_b32 v26, a38
v_accvgpr_read_b32 v27, a39
v_mfma_f32_16x16x32_bf16 a[100:103], a[184:187], a[228:231], a[100:103]
v_cvt_pk_bf16_f32 v100, v24, v25
v_cvt_pk_bf16_f32 v101, v26, v27
v_accvgpr_read_b32 v20, a40
v_accvgpr_read_b32 v21, a41
v_mfma_f32_16x16x32_bf16 a[104:107], a[184:187], a[232:235], a[104:107]
s_add_u32 s48, s48, s34
v_accvgpr_read_b32 v22, a42
v_accvgpr_read_b32 v23, a43
v_cvt_pk_bf16_f32 v104, v20, v21
v_cvt_pk_bf16_f32 v105, v22, v23
v_mfma_f32_16x16x32_bf16 a[108:111], a[184:187], a[236:239], a[108:111]
s_add_u32 m0, s32, 12288
v_accvgpr_read_b32 v24, a44
v_accvgpr_read_b32 v25, a45
v_accvgpr_read_b32 v26, a46
v_accvgpr_read_b32 v27, a47
v_mfma_f32_16x16x32_bf16 a[112:115], a[184:187], a[240:243], a[112:115]
buffer_load_dwordx4 v1, s[12:15], s48 offen lds
v_cvt_pk_bf16_f32 v108, v24, v25
v_cvt_pk_bf16_f32 v109, v26, v27
v_accvgpr_read_b32 v20, a48
v_mfma_f32_16x16x32_bf16 a[116:119], a[184:187], a[244:247], a[116:119]
v_accvgpr_read_b32 v21, a49
v_accvgpr_read_b32 v22, a50
v_accvgpr_read_b32 v23, a51
v_cvt_pk_bf16_f32 v112, v20, v21
v_mfma_f32_16x16x32_bf16 a[120:123], a[184:187], a[248:251], a[120:123]
v_cvt_pk_bf16_f32 v113, v22, v23
v_accvgpr_read_b32 v24, a52
v_accvgpr_read_b32 v25, a53
v_accvgpr_read_b32 v26, a54
v_mfma_f32_16x16x32_bf16 a[124:127], a[184:187], a[252:255], a[124:127]
ds_read_b128 a[184:187], v3 offset:12288
v_accvgpr_read_b32 v27, a55
v_cvt_pk_bf16_f32 v116, v24, v25
v_cvt_pk_bf16_f32 v117, v26, v27
v_mfma_f32_16x16x32_bf16 a[128:131], v[28:31], a[224:227], a[128:131]
v_accvgpr_read_b32 v20, a56
v_accvgpr_read_b32 v21, a57
v_accvgpr_read_b32 v22, a58
v_accvgpr_read_b32 v23, a59
v_mfma_f32_16x16x32_bf16 a[132:135], v[28:31], a[228:231], a[132:135]
v_cvt_pk_bf16_f32 v120, v20, v21
v_cvt_pk_bf16_f32 v121, v22, v23
v_accvgpr_read_b32 v24, a60
v_accvgpr_read_b32 v25, a61
v_mfma_f32_16x16x32_bf16 a[136:139], v[28:31], a[232:235], a[136:139]
buffer_load_dword v15, v14, s[96:99], s100 offen
v_accvgpr_read_b32 v26, a62
v_accvgpr_read_b32 v27, a63
v_cvt_pk_bf16_f32 v124, v24, v25
v_mfma_f32_16x16x32_bf16 a[140:143], v[28:31], a[236:239], a[140:143]
s_add_u32 s100, s100, 16384
v_cvt_pk_bf16_f32 v125, v26, v27
v_mfma_f32_16x16x32_bf16 a[144:147], v[28:31], a[240:243], a[144:147]
v_mfma_f32_16x16x32_bf16 a[148:151], v[28:31], a[244:247], a[148:151]
v_mfma_f32_16x16x32_bf16 a[152:155], v[28:31], a[248:251], a[152:155]
v_mfma_f32_16x16x32_bf16 a[156:159], v[28:31], a[252:255], a[156:159]
s_cmp_lt_u32 s35, s45
s_cbranch_scc1 L_g_tile
s_branch L_g_end
.p2align 3
L_g_v:
s_waitcnt vmcnt(16) lgkmcnt(0)
s_barrier
v_mfma_f32_16x16x32_bf16 v[160:163], a[160:163], a[192:195], 0
ds_read_b64_tr_b16 a[224:225], v5 offset:0
v_accvgpr_read_b32 v20, a64
v_accvgpr_read_b32 v21, a65
v_accvgpr_read_b32 v22, a66
v_mfma_f32_16x16x32_bf16 v[164:167], a[160:163], a[196:199], 0
v_accvgpr_read_b32 v23, a67
v_cvt_pk_bf16_f32 v98, v20, v21
v_cvt_pk_bf16_f32 v99, v22, v23
v_accvgpr_read_b32 v24, a68
v_mfma_f32_16x16x32_bf16 v[168:171], a[160:163], a[200:203], 0
ds_read_b64_tr_b16 a[226:227], v5 offset:1024
v_accvgpr_read_b32 v25, a69
v_accvgpr_read_b32 v26, a70
v_accvgpr_read_b32 v27, a71
v_mfma_f32_16x16x32_bf16 v[172:175], a[160:163], a[204:207], 0
s_add_u32 s37, s31, 0
v_cvt_pk_bf16_f32 v102, v24, v25
v_cvt_pk_bf16_f32 v103, v26, v27
v_accvgpr_read_b32 v20, a72
v_accvgpr_read_b32 v21, a73
v_mfma_f32_16x16x32_bf16 v[176:179], a[160:163], a[208:211], 0
s_add_u32 m0, s33, 0
ds_read_b64_tr_b16 a[228:229], v6 offset:0
v_accvgpr_read_b32 v22, a74
v_accvgpr_read_b32 v23, a75
v_cvt_pk_bf16_f32 v106, v20, v21
v_mfma_f32_16x16x32_bf16 v[180:183], a[160:163], a[212:215], 0
buffer_load_dwordx4 v2, s[20:23], s37 offen  lds
v_cvt_pk_bf16_f32 v107, v22, v23
v_accvgpr_read_b32 v24, a76
v_accvgpr_read_b32 v25, a77
v_mfma_f32_16x16x32_bf16 v[184:187], a[160:163], a[216:219], 0
ds_read_b64_tr_b16 a[230:231], v6 offset:1024
v_accvgpr_read_b32 v26, a78
v_accvgpr_read_b32 v27, a79
v_cvt_pk_bf16_f32 v110, v24, v25
v_mfma_f32_16x16x32_bf16 v[188:191], a[160:163], a[220:223], 0
ds_read_b128 a[160:163], v4 offset:0
v_cvt_pk_bf16_f32 v111, v26, v27
v_accvgpr_read_b32 v20, a80
v_accvgpr_read_b32 v21, a81
v_mfma_f32_16x16x32_bf16 v[192:195], a[164:167], a[192:195], 0
ds_read_b64_tr_b16 a[232:233], v7 offset:0
v_accvgpr_read_b32 v22, a82
v_accvgpr_read_b32 v23, a83
v_cvt_pk_bf16_f32 v114, v20, v21
v_mfma_f32_16x16x32_bf16 v[196:199], a[164:167], a[196:199], 0
v_cvt_pk_bf16_f32 v115, v22, v23
v_accvgpr_read_b32 v24, a84
v_accvgpr_read_b32 v25, a85
v_accvgpr_read_b32 v26, a86
v_mfma_f32_16x16x32_bf16 v[200:203], a[164:167], a[200:203], 0
s_add_u32 s37, s31, 32768
ds_read_b64_tr_b16 a[234:235], v7 offset:1024
v_accvgpr_read_b32 v27, a87
v_cvt_pk_bf16_f32 v118, v24, v25
v_cvt_pk_bf16_f32 v119, v26, v27
v_mfma_f32_16x16x32_bf16 v[204:207], a[164:167], a[204:207], 0
s_add_u32 m0, s33, 1024
v_accvgpr_read_b32 v20, a88
v_accvgpr_read_b32 v21, a89
v_accvgpr_read_b32 v22, a90
v_accvgpr_read_b32 v23, a91
v_mfma_f32_16x16x32_bf16 v[208:211], a[164:167], a[208:211], 0
buffer_load_dwordx4 v2, s[20:23], s37 offen  lds
v_cvt_pk_bf16_f32 v122, v20, v21
v_cvt_pk_bf16_f32 v123, v22, v23
v_accvgpr_read_b32 v24, a92
v_mfma_f32_16x16x32_bf16 v[212:215], a[164:167], a[212:215], 0
ds_read_b64_tr_b16 a[236:237], v8 offset:0
v_accvgpr_read_b32 v25, a93
v_accvgpr_read_b32 v26, a94
v_accvgpr_read_b32 v27, a95
v_mfma_f32_16x16x32_bf16 v[216:219], a[164:167], a[216:219], 0
v_cvt_pk_bf16_f32 v126, v24, v25
v_cvt_pk_bf16_f32 v127, v26, v27
v_accvgpr_read_b32 v20, a96
v_accvgpr_read_b32 v21, a97
v_mfma_f32_16x16x32_bf16 v[220:223], a[164:167], a[220:223], 0
ds_read_b128 a[164:167], v3 offset:1024
v_accvgpr_read_b32 v22, a98
v_accvgpr_read_b32 v23, a99
v_cvt_pk_bf16_f32 v128, v20, v21
v_mfma_f32_16x16x32_bf16 v[224:227], a[168:171], a[192:195], 0
ds_read_b64_tr_b16 a[238:239], v8 offset:1024
v_cvt_pk_bf16_f32 v129, v22, v23
v_accvgpr_read_b32 v24, a100
v_accvgpr_read_b32 v25, a101
v_mfma_f32_16x16x32_bf16 v[228:231], a[168:171], a[196:199], 0
s_add_u32 s37, s31, 131072
v_accvgpr_read_b32 v26, a102
v_accvgpr_read_b32 v27, a103
v_cvt_pk_bf16_f32 v132, v24, v25
v_cvt_pk_bf16_f32 v133, v26, v27
v_mfma_f32_16x16x32_bf16 v[232:235], a[168:171], a[200:203], 0
s_add_u32 m0, s33, 4096
ds_read_b64_tr_b16 a[240:241], v9 offset:0
v_accvgpr_read_b32 v20, a104
v_accvgpr_read_b32 v21, a105
v_accvgpr_read_b32 v22, a106
v_mfma_f32_16x16x32_bf16 v[236:239], a[168:171], a[204:207], 0
buffer_load_dwordx4 v2, s[20:23], s37 offen  lds
v_accvgpr_read_b32 v23, a107
v_cvt_pk_bf16_f32 v136, v20, v21
v_cvt_pk_bf16_f32 v137, v22, v23
v_mfma_f32_16x16x32_bf16 v[240:243], a[168:171], a[208:211], 0
ds_read_b64_tr_b16 a[242:243], v9 offset:1024
v_accvgpr_read_b32 v24, a108
v_accvgpr_read_b32 v25, a109
v_accvgpr_read_b32 v26, a110
v_mfma_f32_16x16x32_bf16 v[244:247], a[168:171], a[212:215], 0
v_accvgpr_read_b32 v27, a111
v_cvt_pk_bf16_f32 v140, v24, v25
v_cvt_pk_bf16_f32 v141, v26, v27
v_accvgpr_read_b32 v20, a112
v_mfma_f32_16x16x32_bf16 v[248:251], a[168:171], a[216:219], 0
ds_read_b64_tr_b16 a[244:245], v10 offset:0
v_accvgpr_read_b32 v21, a113
v_accvgpr_read_b32 v22, a114
v_accvgpr_read_b32 v23, a115
v_mfma_f32_16x16x32_bf16 v[252:255], a[168:171], a[220:223], 0
ds_read_b128 a[168:171], v4 offset:4096
v_cvt_pk_bf16_f32 v144, v20, v21
v_cvt_pk_bf16_f32 v145, v22, v23
v_accvgpr_read_b32 v24, a116
v_mfma_f32_16x16x32_bf16 a[0:3], a[172:175], a[192:195], 0
s_add_u32 s37, s31, 163840
ds_read_b64_tr_b16 a[246:247], v10 offset:1024
v_accvgpr_read_b32 v25, a117
v_accvgpr_read_b32 v26, a118
v_accvgpr_read_b32 v27, a119
v_mfma_f32_16x16x32_bf16 a[4:7], a[172:175], a[196:199], 0
s_add_u32 m0, s33, 5120
v_cvt_pk_bf16_f32 v148, v24, v25
v_cvt_pk_bf16_f32 v149, v26, v27
v_accvgpr_read_b32 v20, a120
v_accvgpr_read_b32 v21, a121
v_mfma_f32_16x16x32_bf16 a[8:11], a[172:175], a[200:203], 0
buffer_load_dwordx4 v2, s[20:23], s37 offen  lds
v_accvgpr_read_b32 v22, a122
v_accvgpr_read_b32 v23, a123
v_cvt_pk_bf16_f32 v152, v20, v21
v_mfma_f32_16x16x32_bf16 a[12:15], a[172:175], a[204:207], 0
s_add_u32 s31, s31, 262144
ds_read_b64_tr_b16 a[248:249], v11 offset:0
v_cvt_pk_bf16_f32 v153, v22, v23
v_accvgpr_read_b32 v24, a124
v_accvgpr_read_b32 v25, a125
v_mfma_f32_16x16x32_bf16 a[16:19], a[172:175], a[208:211], 0
s_add_u32 s33, s33, 16384
v_accvgpr_read_b32 v26, a126
v_accvgpr_read_b32 v27, a127
v_cvt_pk_bf16_f32 v156, v24, v25
v_cvt_pk_bf16_f32 v157, v26, v27
v_mfma_f32_16x16x32_bf16 a[20:23], a[172:175], a[212:215], 0
s_and_b32 s33, s33, 65535
ds_read_b64_tr_b16 a[250:251], v11 offset:1024
v_accvgpr_read_b32 v20, a128
v_accvgpr_read_b32 v21, a129
v_accvgpr_read_b32 v22, a130
v_mfma_f32_16x16x32_bf16 a[24:27], a[172:175], a[216:219], 0
v_accvgpr_read_b32 v23, a131
v_cvt_pk_bf16_f32 v130, v20, v21
v_cvt_pk_bf16_f32 v131, v22, v23
v_accvgpr_read_b32 v24, a132
v_mfma_f32_16x16x32_bf16 a[28:31], a[172:175], a[220:223], 0
s_add_u32 s48, s48, s34
ds_read_b128 a[172:175], v3 offset:5120
v_accvgpr_read_b32 v25, a133
v_accvgpr_read_b32 v26, a134
v_accvgpr_read_b32 v27, a135
v_mfma_f32_16x16x32_bf16 a[32:35], a[176:179], a[192:195], 0
s_add_u32 m0, s32, 16384
ds_read_b64_tr_b16 a[252:253], v12 offset:0
v_cvt_pk_bf16_f32 v134, v24, v25
v_cvt_pk_bf16_f32 v135, v26, v27
v_accvgpr_read_b32 v20, a136
v_mfma_f32_16x16x32_bf16 a[36:39], a[176:179], a[196:199], 0
buffer_load_dwordx4 v1, s[12:15], s48 offen lds
v_accvgpr_read_b32 v21, a137
v_accvgpr_read_b32 v22, a138
v_accvgpr_read_b32 v23, a139
v_mfma_f32_16x16x32_bf16 a[40:43], a[176:179], a[200:203], 0
ds_read_b64_tr_b16 a[254:255], v12 offset:1024
v_cvt_pk_bf16_f32 v138, v20, v21
v_cvt_pk_bf16_f32 v139, v22, v23
v_accvgpr_read_b32 v24, a140
v_mfma_f32_16x16x32_bf16 a[44:47], a[176:179], a[204:207], 0
v_accvgpr_read_b32 v25, a141
v_accvgpr_read_b32 v26, a142
v_accvgpr_read_b32 v27, a143
v_cvt_pk_bf16_f32 v142, v24, v25
v_mfma_f32_16x16x32_bf16 a[48:51], a[176:179], a[208:211], 0
ds_read_b128 v[28:31], v3 offset:13312
v_cvt_pk_bf16_f32 v143, v26, v27
v_accvgpr_read_b32 v20, a144
v_accvgpr_read_b32 v21, a145
s_mov_b32 s38, s62
s_mov_b32 s39, s63
v_mfma_f32_16x16x32_bf16 a[52:55], a[176:179], a[212:215], 0
v_accvgpr_read_b32 v22, a146
v_accvgpr_read_b32 v23, a147
v_cvt_pk_bf16_f32 v146, v20, v21
v_cvt_pk_bf16_f32 v147, v22, v23
s_mov_b32 s49, s50
s_mov_b32 s62, s42
v_mfma_f32_16x16x32_bf16 a[56:59], a[176:179], a[216:219], 0
s_add_u32 s48, s48, s34
v_accvgpr_read_b32 v24, a148
v_accvgpr_read_b32 v25, a149
v_accvgpr_read_b32 v26, a150
v_accvgpr_read_b32 v27, a151
s_mov_b32 s63, s43
s_mov_b32 s50, s51
v_mfma_f32_16x16x32_bf16 a[60:63], a[176:179], a[220:223], 0
s_add_u32 m0, s32, 20480
ds_read_b128 a[176:179], v4 offset:8192
v_add_u32 v5, 16384, v5
v_cvt_pk_bf16_f32 v150, v24, v25
v_cvt_pk_bf16_f32 v151, v26, v27
s_mov_b32 s36, s40
s_add_u32 s35, s35, 1
v_mfma_f32_16x16x32_bf16 a[64:67], a[180:183], a[192:195], 0
buffer_load_dwordx4 v1, s[12:15], s48 offen lds
v_and_b32 v5, 65535, v5
v_accvgpr_read_b32 v20, a152
v_accvgpr_read_b32 v21, a153
v_bfe_u32 v16, v0, 3, 3
v_lshlrev_b32 v16, 4, v16
v_mfma_f32_16x16x32_bf16 a[68:71], a[180:183], a[196:199], 0
v_xor_b32 v6, 16, v5
v_xor_b32 v7, 64, v5
v_accvgpr_read_b32 v22, a154
v_accvgpr_read_b32 v23, a155
v_and_or_b32 v16, v0, 7, v16
v_bfe_u32 v17, v0, 4, 2
v_mfma_f32_16x16x32_bf16 a[72:75], a[180:183], a[200:203], 0
v_xor_b32 v8, 80, v5
v_xor_b32 v9, 128, v5
v_cvt_pk_bf16_f32 v154, v20, v21
v_cvt_pk_bf16_f32 v155, v22, v23
v_lshlrev_b32 v17, 5, v17
v_bfe_u32 v18, v0, 1, 3
v_mfma_f32_16x16x32_bf16 a[76:79], a[180:183], a[204:207], 0
v_xor_b32 v10, 144, v5
v_xor_b32 v11, 192, v5
v_accvgpr_read_b32 v24, a156
v_accvgpr_read_b32 v25, a157
v_or_b32 v17, v17, v18
v_and_b32 v18, 1, v0
v_mfma_f32_16x16x32_bf16 a[80:83], a[180:183], a[208:211], 0
v_xor_b32 v12, 208, v5
v_accvgpr_read_b32 v26, a158
v_accvgpr_read_b32 v27, a159
v_cvt_pk_bf16_f32 v158, v24, v25
v_lshl_or_b32 v17, v18, 4, v17
v_mfma_f32_16x16x32_bf16 a[84:87], a[180:183], a[212:215], 0
s_add_u32 s48, s48, s34
v_cvt_pk_bf16_f32 v159, v26, v27
s_bitcmp1_b32 s49, 1
s_cselect_b64 vcc, -1, 0
s_movk_i32 s44, 0x80
v_cndmask_b32 v16, v16, v17, vcc
v_lshlrev_b32 v13, 4, v16
v_mfma_f32_16x16x32_bf16 a[88:91], a[180:183], a[216:219], 0
s_add_u32 m0, s32, 24576
s_lshr_b32 s93, s49, 2
s_lshr_b32 s93, 0x80000, s93
s_bitcmp1_b32 s49, 0
s_cselect_b32 s92, s93, 0x800
s_cselect_b32 s93, 0x800, s93
s_sub_u32 s93, s93, s44
v_mfma_f32_16x16x32_bf16 a[92:95], a[180:183], a[220:223], 0
buffer_load_dwordx4 v1, s[12:15], s48 offen lds
ds_read_b128 a[180:183], v3 offset:9216
v_mfma_f32_16x16x32_bf16 a[96:99], a[184:187], a[192:195], 0
v_mfma_f32_16x16x32_bf16 a[100:103], a[184:187], a[196:199], 0
v_mfma_f32_16x16x32_bf16 a[104:107], a[184:187], a[200:203], 0
v_mfma_f32_16x16x32_bf16 a[108:111], a[184:187], a[204:207], 0
v_mfma_f32_16x16x32_bf16 a[112:115], a[184:187], a[208:211], 0
s_add_u32 s48, s48, s34
v_mfma_f32_16x16x32_bf16 a[116:119], a[184:187], a[212:215], 0
s_add_u32 m0, s32, 28672
v_mfma_f32_16x16x32_bf16 a[120:123], a[184:187], a[216:219], 0
buffer_load_dwordx4 v1, s[12:15], s48 offen lds
v_mfma_f32_16x16x32_bf16 a[124:127], a[184:187], a[220:223], 0
s_add_u32 s30, s30, 128
ds_read_b128 a[184:187], v4 offset:12288
v_mfma_f32_16x16x32_bf16 a[128:131], a[188:191], a[192:195], 0
s_add_u32 s32, s32, 32768
v_add_u32 v3, 32768, v3
v_mfma_f32_16x16x32_bf16 a[132:135], a[188:191], a[196:199], 0
s_sub_u32 s48, s32, 98304
v_subrev_u32 v19, 98304, v3
v_mfma_f32_16x16x32_bf16 a[136:139], a[188:191], a[200:203], 0
s_cmp_ge_u32 s32, 163840
s_cselect_b32 s32, s48, s32
buffer_load_dword v15, v14, s[96:99], s100 offen
v_mfma_f32_16x16x32_bf16 a[140:143], a[188:191], a[204:207], 0
s_add_u32 s100, s100, 16384
v_cmp_le_u32 vcc, 163840, v3
v_mfma_f32_16x16x32_bf16 a[144:147], a[188:191], a[208:211], 0
s_nop 0
v_cndmask_b32 v3, v3, v19, vcc
v_mfma_f32_16x16x32_bf16 a[148:151], a[188:191], a[212:215], 0
v_xor_b32 v4, 64, v3
v_mfma_f32_16x16x32_bf16 a[152:155], a[188:191], a[216:219], 0
v_mfma_f32_16x16x32_bf16 a[156:159], a[188:191], a[220:223], 0
s_waitcnt vmcnt(17) lgkmcnt(0)
s_barrier
v_mfma_f32_16x16x32_bf16 v[160:163], a[160:163], a[224:227], v[160:163]
ds_read_b64_tr_b16 a[192:193], v5 offset:0
v_mfma_f32_16x16x32_bf16 v[164:167], a[160:163], a[228:231], v[164:167]
v_mfma_f32_16x16x32_bf16 v[168:171], a[160:163], a[232:235], v[168:171]
ds_read_b64_tr_b16 a[194:195], v5 offset:1024
v_mfma_f32_16x16x32_bf16 v[172:175], a[160:163], a[236:239], v[172:175]
s_add_u32 s37, s31, 0
v_mfma_f32_16x16x32_bf16 v[176:179], a[160:163], a[240:243], v[176:179]
s_add_u32 m0, s33, 0
ds_read_b64_tr_b16 a[196:197], v6 offset:0
v_mfma_f32_16x16x32_bf16 v[180:183], a[160:163], a[244:247], v[180:183]
buffer_load_dwordx4 v2, s[20:23], s37 offen  lds
v_mfma_f32_16x16x32_bf16 v[184:187], a[160:163], a[248:251], v[184:187]
ds_read_b64_tr_b16 a[198:199], v6 offset:1024
v_mfma_f32_16x16x32_bf16 v[188:191], a[160:163], a[252:255], v[188:191]
ds_read_b128 a[160:163], v3 offset:0
v_mfma_f32_16x16x32_bf16 v[192:195], a[164:167], a[224:227], v[192:195]
ds_read_b64_tr_b16 a[200:201], v7 offset:0
v_mfma_f32_16x16x32_bf16 v[196:199], a[164:167], a[228:231], v[196:199]
v_mfma_f32_16x16x32_bf16 v[200:203], a[164:167], a[232:235], v[200:203]
s_add_u32 s37, s31, 32768
ds_read_b64_tr_b16 a[202:203], v7 offset:1024
v_mfma_f32_16x16x32_bf16 v[204:207], a[164:167], a[236:239], v[204:207]
s_add_u32 m0, s33, 1024
v_mfma_f32_16x16x32_bf16 v[208:211], a[164:167], a[240:243], v[208:211]
buffer_load_dwordx4 v2, s[20:23], s37 offen  lds
v_mfma_f32_16x16x32_bf16 v[212:215], a[164:167], a[244:247], v[212:215]
ds_read_b64_tr_b16 a[204:205], v8 offset:0
v_mfma_f32_16x16x32_bf16 v[216:219], a[164:167], a[248:251], v[216:219]
s_mov_b32 s60, s38
v_mfma_f32_16x16x32_bf16 v[220:223], a[164:167], a[252:255], v[220:223]
s_mov_b32 s29, s38
ds_read_b128 a[164:167], v4 offset:1024
v_mfma_f32_16x16x32_bf16 v[224:227], a[168:171], a[224:227], v[224:227]
buffer_store_dwordx4 v[32:35], v13, s[8:11], s29 offen sc1
v_mfma_f32_16x16x32_bf16 v[228:231], a[168:171], a[228:231], v[228:231]
s_add_u32 s37, s31, 131072
ds_read_b64_tr_b16 a[206:207], v8 offset:1024
v_mfma_f32_16x16x32_bf16 v[232:235], a[168:171], a[232:235], v[232:235]
s_add_u32 m0, s33, 4096
v_mfma_f32_16x16x32_bf16 v[236:239], a[168:171], a[236:239], v[236:239]
buffer_load_dwordx4 v2, s[20:23], s37 offen  lds
v_mfma_f32_16x16x32_bf16 v[240:243], a[168:171], a[240:243], v[240:243]
ds_read_b64_tr_b16 a[208:209], v9 offset:0
v_mfma_f32_16x16x32_bf16 v[244:247], a[168:171], a[244:247], v[244:247]
v_mfma_f32_16x16x32_bf16 v[248:251], a[168:171], a[248:251], v[248:251]
ds_read_b64_tr_b16 a[210:211], v9 offset:1024
v_mfma_f32_16x16x32_bf16 v[252:255], a[168:171], a[252:255], v[252:255]
ds_read_b128 a[168:171], v3 offset:4096
v_mfma_f32_16x16x32_bf16 a[0:3], a[172:175], a[224:227], a[0:3]
s_add_u32 s37, s31, 163840
ds_read_b64_tr_b16 a[212:213], v10 offset:0
v_mfma_f32_16x16x32_bf16 a[4:7], a[172:175], a[228:231], a[4:7]
s_add_u32 m0, s33, 5120
v_mfma_f32_16x16x32_bf16 a[8:11], a[172:175], a[232:235], a[8:11]
buffer_load_dwordx4 v2, s[20:23], s37 offen  lds
v_mfma_f32_16x16x32_bf16 a[12:15], a[172:175], a[236:239], a[12:15]
s_add_u32 s31, s31, 262144
ds_read_b64_tr_b16 a[214:215], v10 offset:1024
v_mfma_f32_16x16x32_bf16 a[16:19], a[172:175], a[240:243], a[16:19]
s_add_u32 s33, s33, 16384
v_mfma_f32_16x16x32_bf16 a[20:23], a[172:175], a[244:247], a[20:23]
s_and_b32 s33, s33, 65535
ds_read_b64_tr_b16 a[216:217], v11 offset:0
v_mfma_f32_16x16x32_bf16 a[24:27], a[172:175], a[248:251], a[24:27]
v_mfma_f32_16x16x32_bf16 a[28:31], a[172:175], a[252:255], a[28:31]
s_mov_b32 s48, s30
ds_read_b128 a[172:175], v4 offset:5120
v_mfma_f32_16x16x32_bf16 a[32:35], a[176:179], a[224:227], a[32:35]
s_add_u32 m0, s32, 0
ds_read_b64_tr_b16 a[218:219], v11 offset:1024
v_mfma_f32_16x16x32_bf16 a[36:39], a[176:179], a[228:231], a[36:39]
buffer_load_dwordx4 v1, s[12:15], s48 offen lds
v_mfma_f32_16x16x32_bf16 a[40:43], a[176:179], a[232:235], a[40:43]
ds_read_b64_tr_b16 a[220:221], v12 offset:0
v_mfma_f32_16x16x32_bf16 a[44:47], a[176:179], a[236:239], a[44:47]
s_add_u32 s29, s29, s44
v_mfma_f32_16x16x32_bf16 a[48:51], a[176:179], a[240:243], a[48:51]
ds_read_b64_tr_b16 a[222:223], v12 offset:1024
v_mfma_f32_16x16x32_bf16 a[52:55], a[176:179], a[244:247], a[52:55]
buffer_store_dwordx4 v[36:39], v13, s[8:11], s29 offen sc1
v_mfma_f32_16x16x32_bf16 a[56:59], a[176:179], a[248:251], a[56:59]
s_add_u32 s48, s48, s34
ds_read_b128 a[188:191], v4 offset:13312
v_mfma_f32_16x16x32_bf16 a[60:63], a[176:179], a[252:255], a[60:63]
s_add_u32 m0, s32, 4096
ds_read_b128 a[176:179], v3 offset:8192
v_mfma_f32_16x16x32_bf16 a[64:67], a[180:183], a[224:227], a[64:67]
buffer_load_dwordx4 v1, s[12:15], s48 offen lds
v_mfma_f32_16x16x32_bf16 a[68:71], a[180:183], a[228:231], a[68:71]
v_add_u32 v5, 16384, v5
v_and_b32 v5, 65535, v5
v_mfma_f32_16x16x32_bf16 a[72:75], a[180:183], a[232:235], a[72:75]
v_xor_b32 v6, 16, v5
v_xor_b32 v7, 64, v5
v_mfma_f32_16x16x32_bf16 a[76:79], a[180:183], a[236:239], a[76:79]
v_xor_b32 v8, 80, v5
v_xor_b32 v9, 128, v5
v_mfma_f32_16x16x32_bf16 a[80:83], a[180:183], a[240:243], a[80:83]
v_xor_b32 v10, 144, v5
v_xor_b32 v11, 192, v5
v_mfma_f32_16x16x32_bf16 a[84:87], a[180:183], a[244:247], a[84:87]
s_add_u32 s48, s48, s34
v_xor_b32 v12, 208, v5
v_mfma_f32_16x16x32_bf16 a[88:91], a[180:183], a[248:251], a[88:91]
s_add_u32 m0, s32, 8192
v_mfma_f32_16x16x32_bf16 a[92:95], a[180:183], a[252:255], a[92:95]
buffer_load_dwordx4 v1, s[12:15], s48 offen lds
ds_read_b128 a[180:183], v4 offset:9216
v_mfma_f32_16x16x32_bf16 a[96:99], a[184:187], a[224:227], a[96:99]
v_mfma_f32_16x16x32_bf16 a[100:103], a[184:187], a[228:231], a[100:103]
v_mfma_f32_16x16x32_bf16 a[104:107], a[184:187], a[232:235], a[104:107]
v_mfma_f32_16x16x32_bf16 a[108:111], a[184:187], a[236:239], a[108:111]
v_mfma_f32_16x16x32_bf16 a[112:115], a[184:187], a[240:243], a[112:115]
s_add_u32 s48, s48, s34
v_mfma_f32_16x16x32_bf16 a[116:119], a[184:187], a[244:247], a[116:119]
s_add_u32 m0, s32, 12288
v_mfma_f32_16x16x32_bf16 a[120:123], a[184:187], a[248:251], a[120:123]
buffer_load_dwordx4 v1, s[12:15], s48 offen lds
v_mfma_f32_16x16x32_bf16 a[124:127], a[184:187], a[252:255], a[124:127]
ds_read_b128 a[184:187], v3 offset:12288
v_mfma_f32_16x16x32_bf16 a[128:131], v[28:31], a[224:227], a[128:131]
s_add_u32 s29, s29, s93
v_mfma_f32_16x16x32_bf16 a[132:135], v[28:31], a[228:231], a[132:135]
v_mfma_f32_16x16x32_bf16 a[136:139], v[28:31], a[232:235], a[136:139]
buffer_store_dwordx4 v[40:43], v13, s[8:11], s29 offen sc1
buffer_load_dword v15, v14, s[96:99], s100 offen
v_mfma_f32_16x16x32_bf16 a[140:143], v[28:31], a[236:239], a[140:143]
s_add_u32 s100, s100, 16384
v_mfma_f32_16x16x32_bf16 a[144:147], v[28:31], a[240:243], a[144:147]
v_mfma_f32_16x16x32_bf16 a[148:151], v[28:31], a[244:247], a[148:151]
v_mfma_f32_16x16x32_bf16 a[152:155], v[28:31], a[248:251], a[152:155]
v_mfma_f32_16x16x32_bf16 a[156:159], v[28:31], a[252:255], a[156:159]
s_waitcnt vmcnt(21) lgkmcnt(0)
s_barrier
v_mfma_f32_16x16x32_bf16 v[160:163], a[160:163], a[192:195], v[160:163]
ds_read_b64_tr_b16 a[224:225], v5 offset:0
v_mfma_f32_16x16x32_bf16 v[164:167], a[160:163], a[196:199], v[164:167]
v_mfma_f32_16x16x32_bf16 v[168:171], a[160:163], a[200:203], v[168:171]
ds_read_b64_tr_b16 a[226:227], v5 offset:1024
v_mfma_f32_16x16x32_bf16 v[172:175], a[160:163], a[204:207], v[172:175]
s_add_u32 s37, s31, 0
v_mfma_f32_16x16x32_bf16 v[176:179], a[160:163], a[208:211], v[176:179]
s_add_u32 m0, s33, 0
ds_read_b64_tr_b16 a[228:229], v6 offset:0
v_mfma_f32_16x16x32_bf16 v[180:183], a[160:163], a[212:215], v[180:183]
buffer_load_dwordx4 v2, s[20:23], s37 offen  lds
v_mfma_f32_16x16x32_bf16 v[184:187], a[160:163], a[216:219], v[184:187]
ds_read_b64_tr_b16 a[230:231], v6 offset:1024
v_mfma_f32_16x16x32_bf16 v[188:191], a[160:163], a[220:223], v[188:191]
ds_read_b128 a[160:163], v4 offset:0
v_mfma_f32_16x16x32_bf16 v[192:195], a[164:167], a[192:195], v[192:195]
ds_read_b64_tr_b16 a[232:233], v7 offset:0
v_mfma_f32_16x16x32_bf16 v[196:199], a[164:167], a[196:199], v[196:199]
v_mfma_f32_16x16x32_bf16 v[200:203], a[164:167], a[200:203], v[200:203]
s_add_u32 s37, s31, 32768
ds_read_b64_tr_b16 a[234:235], v7 offset:1024
v_mfma_f32_16x16x32_bf16 v[204:207], a[164:167], a[204:207], v[204:207]
s_add_u32 m0, s33, 1024
v_mfma_f32_16x16x32_bf16 v[208:211], a[164:167], a[208:211], v[208:211]
buffer_load_dwordx4 v2, s[20:23], s37 offen  lds
v_mfma_f32_16x16x32_bf16 v[212:215], a[164:167], a[212:215], v[212:215]
ds_read_b64_tr_b16 a[236:237], v8 offset:0
v_mfma_f32_16x16x32_bf16 v[216:219], a[164:167], a[216:219], v[216:219]
s_add_u32 s29, s29, s44
v_mfma_f32_16x16x32_bf16 v[220:223], a[164:167], a[220:223], v[220:223]
ds_read_b128 a[164:167], v3 offset:1024
v_mfma_f32_16x16x32_bf16 v[224:227], a[168:171], a[192:195], v[224:227]
buffer_store_dwordx4 v[44:47], v13, s[8:11], s29 offen sc1
v_mfma_f32_16x16x32_bf16 v[228:231], a[168:171], a[196:199], v[228:231]
s_add_u32 s37, s31, 131072
ds_read_b64_tr_b16 a[238:239], v8 offset:1024
v_mfma_f32_16x16x32_bf16 v[232:235], a[168:171], a[200:203], v[232:235]
s_add_u32 m0, s33, 4096
v_mfma_f32_16x16x32_bf16 v[236:239], a[168:171], a[204:207], v[236:239]
buffer_load_dwordx4 v2, s[20:23], s37 offen  lds
v_mfma_f32_16x16x32_bf16 v[240:243], a[168:171], a[208:211], v[240:243]
ds_read_b64_tr_b16 a[240:241], v9 offset:0
v_mfma_f32_16x16x32_bf16 v[244:247], a[168:171], a[212:215], v[244:247]
v_mfma_f32_16x16x32_bf16 v[248:251], a[168:171], a[216:219], v[248:251]
ds_read_b64_tr_b16 a[242:243], v9 offset:1024
v_mfma_f32_16x16x32_bf16 v[252:255], a[168:171], a[220:223], v[252:255]
ds_read_b128 a[168:171], v4 offset:4096
v_mfma_f32_16x16x32_bf16 a[0:3], a[172:175], a[192:195], a[0:3]
s_add_u32 s37, s31, 163840
ds_read_b64_tr_b16 a[244:245], v10 offset:0
v_mfma_f32_16x16x32_bf16 a[4:7], a[172:175], a[196:199], a[4:7]
s_add_u32 m0, s33, 5120
v_mfma_f32_16x16x32_bf16 a[8:11], a[172:175], a[200:203], a[8:11]
buffer_load_dwordx4 v2, s[20:23], s37 offen  lds
v_mfma_f32_16x16x32_bf16 a[12:15], a[172:175], a[204:207], a[12:15]
s_add_u32 s31, s31, 262144
ds_read_b64_tr_b16 a[246:247], v10 offset:1024
v_mfma_f32_16x16x32_bf16 a[16:19], a[172:175], a[208:211], a[16:19]
s_add_u32 s33, s33, 16384
v_mfma_f32_16x16x32_bf16 a[20:23], a[172:175], a[212:215], a[20:23]
s_and_b32 s33, s33, 65535
ds_read_b64_tr_b16 a[248:249], v11 offset:0
v_mfma_f32_16x16x32_bf16 a[24:27], a[172:175], a[216:219], a[24:27]
v_mfma_f32_16x16x32_bf16 a[28:31], a[172:175], a[220:223], a[28:31]
s_add_u32 s48, s48, s34
ds_read_b128 a[172:175], v3 offset:5120
v_mfma_f32_16x16x32_bf16 a[32:35], a[176:179], a[192:195], a[32:35]
s_add_u32 m0, s32, 16384
ds_read_b64_tr_b16 a[250:251], v11 offset:1024
v_mfma_f32_16x16x32_bf16 a[36:39], a[176:179], a[196:199], a[36:39]
buffer_load_dwordx4 v1, s[12:15], s48 offen lds
v_mfma_f32_16x16x32_bf16 a[40:43], a[176:179], a[200:203], a[40:43]
ds_read_b64_tr_b16 a[252:253], v12 offset:0
v_mfma_f32_16x16x32_bf16 a[44:47], a[176:179], a[204:207], a[44:47]
s_add_u32 s29, s29, s93
v_mfma_f32_16x16x32_bf16 a[48:51], a[176:179], a[208:211], a[48:51]
ds_read_b64_tr_b16 a[254:255], v12 offset:1024
v_mfma_f32_16x16x32_bf16 a[52:55], a[176:179], a[212:215], a[52:55]
buffer_store_dwordx4 v[48:51], v13, s[8:11], s29 offen sc1
v_mfma_f32_16x16x32_bf16 a[56:59], a[176:179], a[216:219], a[56:59]
s_add_u32 s48, s48, s34
ds_read_b128 v[28:31], v3 offset:13312
v_mfma_f32_16x16x32_bf16 a[60:63], a[176:179], a[220:223], a[60:63]
s_add_u32 m0, s32, 20480
ds_read_b128 a[176:179], v4 offset:8192
v_mfma_f32_16x16x32_bf16 a[64:67], a[180:183], a[192:195], a[64:67]
buffer_load_dwordx4 v1, s[12:15], s48 offen lds
v_mfma_f32_16x16x32_bf16 a[68:71], a[180:183], a[196:199], a[68:71]
v_add_u32 v5, 16384, v5
v_and_b32 v5, 65535, v5
v_mfma_f32_16x16x32_bf16 a[72:75], a[180:183], a[200:203], a[72:75]
v_xor_b32 v6, 16, v5
v_xor_b32 v7, 64, v5
v_mfma_f32_16x16x32_bf16 a[76:79], a[180:183], a[204:207], a[76:79]
v_xor_b32 v8, 80, v5
v_xor_b32 v9, 128, v5
v_mfma_f32_16x16x32_bf16 a[80:83], a[180:183], a[208:211], a[80:83]
v_xor_b32 v10, 144, v5
v_xor_b32 v11, 192, v5
v_mfma_f32_16x16x32_bf16 a[84:87], a[180:183], a[212:215], a[84:87]
s_add_u32 s48, s48, s34
v_xor_b32 v12, 208, v5
v_mfma_f32_16x16x32_bf16 a[88:91], a[180:183], a[216:219], a[88:91]
s_add_u32 m0, s32, 24576
v_mfma_f32_16x16x32_bf16 a[92:95], a[180:183], a[220:223], a[92:95]
buffer_load_dwordx4 v1, s[12:15], s48 offen lds
ds_read_b128 a[180:183], v3 offset:9216
v_mfma_f32_16x16x32_bf16 a[96:99], a[184:187], a[192:195], a[96:99]
v_mfma_f32_16x16x32_bf16 a[100:103], a[184:187], a[196:199], a[100:103]
v_mfma_f32_16x16x32_bf16 a[104:107], a[184:187], a[200:203], a[104:107]
v_mfma_f32_16x16x32_bf16 a[108:111], a[184:187], a[204:207], a[108:111]
v_mfma_f32_16x16x32_bf16 a[112:115], a[184:187], a[208:211], a[112:115]
s_add_u32 s48, s48, s34
v_mfma_f32_16x16x32_bf16 a[116:119], a[184:187], a[212:215], a[116:119]
s_add_u32 m0, s32, 28672
v_mfma_f32_16x16x32_bf16 a[120:123], a[184:187], a[216:219], a[120:123]
buffer_load_dwordx4 v1, s[12:15], s48 offen lds
v_mfma_f32_16x16x32_bf16 a[124:127], a[184:187], a[220:223], a[124:127]
s_add_u32 s30, s30, 128
ds_read_b128 a[184:187], v4 offset:12288
v_mfma_f32_16x16x32_bf16 a[128:131], a[188:191], a[192:195], a[128:131]
s_add_u32 s32, s32, 32768
s_add_u32 s29, s29, s44
v_add_u32 v3, 32768, v3
v_mfma_f32_16x16x32_bf16 a[132:135], a[188:191], a[196:199], a[132:135]
s_sub_u32 s48, s32, 98304
v_subrev_u32 v19, 98304, v3
v_mfma_f32_16x16x32_bf16 a[136:139], a[188:191], a[200:203], a[136:139]
s_cmp_ge_u32 s32, 163840
s_cselect_b32 s32, s48, s32
buffer_store_dwordx4 v[52:55], v13, s[8:11], s29 offen sc1
buffer_load_dword v15, v14, s[96:99], s100 offen
v_mfma_f32_16x16x32_bf16 a[140:143], a[188:191], a[204:207], a[140:143]
s_add_u32 s100, s100, 16384
v_cmp_le_u32 vcc, 163840, v3
v_mfma_f32_16x16x32_bf16 a[144:147], a[188:191], a[208:211], a[144:147]
s_nop 0
v_cndmask_b32 v3, v3, v19, vcc
v_mfma_f32_16x16x32_bf16 a[148:151], a[188:191], a[212:215], a[148:151]
v_xor_b32 v4, 64, v3
v_mfma_f32_16x16x32_bf16 a[152:155], a[188:191], a[216:219], a[152:155]
v_mfma_f32_16x16x32_bf16 a[156:159], a[188:191], a[220:223], a[156:159]
s_waitcnt vmcnt(24) lgkmcnt(0)
s_barrier
v_mfma_f32_16x16x32_bf16 v[160:163], a[160:163], a[224:227], v[160:163]
ds_read_b64_tr_b16 a[192:193], v5 offset:0
v_mfma_f32_16x16x32_bf16 v[164:167], a[160:163], a[228:231], v[164:167]
v_mfma_f32_16x16x32_bf16 v[168:171], a[160:163], a[232:235], v[168:171]
ds_read_b64_tr_b16 a[194:195], v5 offset:1024
v_mfma_f32_16x16x32_bf16 v[172:175], a[160:163], a[236:239], v[172:175]
s_add_u32 s37, s31, 0
v_mfma_f32_16x16x32_bf16 v[176:179], a[160:163], a[240:243], v[176:179]
s_add_u32 m0, s33, 0
ds_read_b64_tr_b16 a[196:197], v6 offset:0
v_mfma_f32_16x16x32_bf16 v[180:183], a[160:163], a[244:247], v[180:183]
buffer_load_dwordx4 v2, s[20:23], s37 offen  lds
v_mfma_f32_16x16x32_bf16 v[184:187], a[160:163], a[248:251], v[184:187]
ds_read_b64_tr_b16 a[198:199], v6 offset:1024
v_mfma_f32_16x16x32_bf16 v[188:191], a[160:163], a[252:255], v[188:191]
ds_read_b128 a[160:163], v3 offset:0
v_mfma_f32_16x16x32_bf16 v[192:195], a[164:167], a[224:227], v[192:195]
ds_read_b64_tr_b16 a[200:201], v7 offset:0
v_mfma_f32_16x16x32_bf16 v[196:199], a[164:167], a[228:231], v[196:199]
v_mfma_f32_16x16x32_bf16 v[200:203], a[164:167], a[232:235], v[200:203]
s_add_u32 s37, s31, 32768
ds_read_b64_tr_b16 a[202:203], v7 offset:1024
v_mfma_f32_16x16x32_bf16 v[204:207], a[164:167], a[236:239], v[204:207]
s_add_u32 m0, s33, 1024
v_mfma_f32_16x16x32_bf16 v[208:211], a[164:167], a[240:243], v[208:211]
buffer_load_dwordx4 v2, s[20:23], s37 offen  lds
v_mfma_f32_16x16x32_bf16 v[212:215], a[164:167], a[244:247], v[212:215]
ds_read_b64_tr_b16 a[204:205], v8 offset:0
v_mfma_f32_16x16x32_bf16 v[216:219], a[164:167], a[248:251], v[216:219]
s_add_u32 s29, s29, s93
v_mfma_f32_16x16x32_bf16 v[220:223], a[164:167], a[252:255], v[220:223]
ds_read_b128 a[164:167], v4 offset:1024
v_mfma_f32_16x16x32_bf16 v[224:227], a[168:171], a[224:227], v[224:227]
buffer_store_dwordx4 v[56:59], v13, s[8:11], s29 offen sc1
v_mfma_f32_16x16x32_bf16 v[228:231], a[168:171], a[228:231], v[228:231]
s_add_u32 s37, s31, 131072
ds_read_b64_tr_b16 a[206:207], v8 offset:1024
v_mfma_f32_16x16x32_bf16 v[232:235], a[168:171], a[232:235], v[232:235]
s_add_u32 m0, s33, 4096
v_mfma_f32_16x16x32_bf16 v[236:239], a[168:171], a[236:239], v[236:239]
buffer_load_dwordx4 v2, s[20:23], s37 offen  lds
v_mfma_f32_16x16x32_bf16 v[240:243], a[168:171], a[240:243], v[240:243]
ds_read_b64_tr_b16 a[208:209], v9 offset:0
v_mfma_f32_16x16x32_bf16 v[244:247], a[168:171], a[244:247], v[244:247]
v_mfma_f32_16x16x32_bf16 v[248:251], a[168:171], a[248:251], v[248:251]
ds_read_b64_tr_b16 a[210:211], v9 offset:1024
v_mfma_f32_16x16x32_bf16 v[252:255], a[168:171], a[252:255], v[252:255]
ds_read_b128 a[168:171], v3 offset:4096
v_mfma_f32_16x16x32_bf16 a[0:3], a[172:175], a[224:227], a[0:3]
s_add_u32 s37, s31, 163840
ds_read_b64_tr_b16 a[212:213], v10 offset:0
v_mfma_f32_16x16x32_bf16 a[4:7], a[172:175], a[228:231], a[4:7]
s_add_u32 m0, s33, 5120
v_mfma_f32_16x16x32_bf16 a[8:11], a[172:175], a[232:235], a[8:11]
buffer_load_dwordx4 v2, s[20:23], s37 offen  lds
v_mfma_f32_16x16x32_bf16 a[12:15], a[172:175], a[236:239], a[12:15]
s_add_u32 s31, s31, 262144
ds_read_b64_tr_b16 a[214:215], v10 offset:1024
v_mfma_f32_16x16x32_bf16 a[16:19], a[172:175], a[240:243], a[16:19]
s_add_u32 s33, s33, 16384
v_mfma_f32_16x16x32_bf16 a[20:23], a[172:175], a[244:247], a[20:23]
s_and_b32 s33, s33, 65535
ds_read_b64_tr_b16 a[216:217], v11 offset:0
v_mfma_f32_16x16x32_bf16 a[24:27], a[172:175], a[248:251], a[24:27]
v_mfma_f32_16x16x32_bf16 a[28:31], a[172:175], a[252:255], a[28:31]
s_mov_b32 s48, s30
ds_read_b128 a[172:175], v4 offset:5120
v_mfma_f32_16x16x32_bf16 a[32:35], a[176:179], a[224:227], a[32:35]
s_add_u32 m0, s32, 0
ds_read_b64_tr_b16 a[218:219], v11 offset:1024
v_mfma_f32_16x16x32_bf16 a[36:39], a[176:179], a[228:231], a[36:39]
buffer_load_dwordx4 v1, s[12:15], s48 offen lds
v_mfma_f32_16x16x32_bf16 a[40:43], a[176:179], a[232:235], a[40:43]
ds_read_b64_tr_b16 a[220:221], v12 offset:0
v_mfma_f32_16x16x32_bf16 a[44:47], a[176:179], a[236:239], a[44:47]
s_add_u32 s29, s29, s44
v_mfma_f32_16x16x32_bf16 a[48:51], a[176:179], a[240:243], a[48:51]
ds_read_b64_tr_b16 a[222:223], v12 offset:1024
v_mfma_f32_16x16x32_bf16 a[52:55], a[176:179], a[244:247], a[52:55]
buffer_store_dwordx4 v[60:63], v13, s[8:11], s29 offen sc1
v_mfma_f32_16x16x32_bf16 a[56:59], a[176:179], a[248:251], a[56:59]
s_add_u32 s48, s48, s34
ds_read_b128 a[188:191], v4 offset:13312
v_mfma_f32_16x16x32_bf16 a[60:63], a[176:179], a[252:255], a[60:63]
s_add_u32 m0, s32, 4096
ds_read_b128 a[176:179], v3 offset:8192
v_mfma_f32_16x16x32_bf16 a[64:67], a[180:183], a[224:227], a[64:67]
buffer_load_dwordx4 v1, s[12:15], s48 offen lds
v_mfma_f32_16x16x32_bf16 a[68:71], a[180:183], a[228:231], a[68:71]
v_add_u32 v5, 16384, v5
v_and_b32 v5, 65535, v5
v_mfma_f32_16x16x32_bf16 a[72:75], a[180:183], a[232:235], a[72:75]
v_xor_b32 v6, 16, v5
v_xor_b32 v7, 64, v5
v_mfma_f32_16x16x32_bf16 a[76:79], a[180:183], a[236:239], a[76:79]
v_xor_b32 v8, 80, v5
v_xor_b32 v9, 128, v5
v_mfma_f32_16x16x32_bf16 a[80:83], a[180:183], a[240:243], a[80:83]
v_xor_b32 v10, 144, v5
v_xor_b32 v11, 192, v5
v_mfma_f32_16x16x32_bf16 a[84:87], a[180:183], a[244:247], a[84:87]
s_add_u32 s48, s48, s34
v_xor_b32 v12, 208, v5
v_mfma_f32_16x16x32_bf16 a[88:91], a[180:183], a[248:251], a[88:91]
s_add_u32 m0, s32, 8192
v_mfma_f32_16x16x32_bf16 a[92:95], a[180:183], a[252:255], a[92:95]
buffer_load_dwordx4 v1, s[12:15], s48 offen lds
ds_read_b128 a[180:183], v4 offset:9216
v_mfma_f32_16x16x32_bf16 a[96:99], a[184:187], a[224:227], a[96:99]
v_mfma_f32_16x16x32_bf16 a[100:103], a[184:187], a[228:231], a[100:103]
v_mfma_f32_16x16x32_bf16 a[104:107], a[184:187], a[232:235], a[104:107]
v_mfma_f32_16x16x32_bf16 a[108:111], a[184:187], a[236:239], a[108:111]
v_mfma_f32_16x16x32_bf16 a[112:115], a[184:187], a[240:243], a[112:115]
s_add_u32 s48, s48, s34
v_mfma_f32_16x16x32_bf16 a[116:119], a[184:187], a[244:247], a[116:119]
s_add_u32 m0, s32, 12288
v_mfma_f32_16x16x32_bf16 a[120:123], a[184:187], a[248:251], a[120:123]
buffer_load_dwordx4 v1, s[12:15], s48 offen lds
v_mfma_f32_16x16x32_bf16 a[124:127], a[184:187], a[252:255], a[124:127]
ds_read_b128 a[184:187], v3 offset:12288
v_mfma_f32_16x16x32_bf16 a[128:131], v[28:31], a[224:227], a[128:131]
v_mfma_f32_16x16x32_bf16 a[132:135], v[28:31], a[228:231], a[132:135]
v_mfma_f32_16x16x32_bf16 a[136:139], v[28:31], a[232:235], a[136:139]
buffer_load_dword v15, v14, s[96:99], s100 offen
v_mfma_f32_16x16x32_bf16 a[140:143], v[28:31], a[236:239], a[140:143]
s_add_u32 s100, s100, 16384
v_mfma_f32_16x16x32_bf16 a[144:147], v[28:31], a[240:243], a[144:147]
v_mfma_f32_16x16x32_bf16 a[148:151], v[28:31], a[244:247], a[148:151]
v_mfma_f32_16x16x32_bf16 a[152:155], v[28:31], a[248:251], a[152:155]
v_mfma_f32_16x16x32_bf16 a[156:159], v[28:31], a[252:255], a[156:159]
s_waitcnt vmcnt(23) lgkmcnt(0)
s_barrier
v_mfma_f32_16x16x32_bf16 v[160:163], a[160:163], a[192:195], v[160:163]
ds_read_b64_tr_b16 a[224:225], v5 offset:0
v_mfma_f32_16x16x32_bf16 v[164:167], a[160:163], a[196:199], v[164:167]
v_mfma_f32_16x16x32_bf16 v[168:171], a[160:163], a[200:203], v[168:171]
ds_read_b64_tr_b16 a[226:227], v5 offset:1024
v_mfma_f32_16x16x32_bf16 v[172:175], a[160:163], a[204:207], v[172:175]
s_add_u32 s37, s31, 0
v_mfma_f32_16x16x32_bf16 v[176:179], a[160:163], a[208:211], v[176:179]
s_add_u32 m0, s33, 0
ds_read_b64_tr_b16 a[228:229], v6 offset:0
v_mfma_f32_16x16x32_bf16 v[180:183], a[160:163], a[212:215], v[180:183]
buffer_load_dwordx4 v2, s[20:23], s37 offen  lds
v_mfma_f32_16x16x32_bf16 v[184:187], a[160:163], a[216:219], v[184:187]
ds_read_b64_tr_b16 a[230:231], v6 offset:1024
v_mfma_f32_16x16x32_bf16 v[188:191], a[160:163], a[220:223], v[188:191]
ds_read_b128 a[160:163], v4 offset:0
v_mfma_f32_16x16x32_bf16 v[192:195], a[164:167], a[192:195], v[192:195]
ds_read_b64_tr_b16 a[232:233], v7 offset:0
v_mfma_f32_16x16x32_bf16 v[196:199], a[164:167], a[196:199], v[196:199]
v_mfma_f32_16x16x32_bf16 v[200:203], a[164:167], a[200:203], v[200:203]
s_add_u32 s37, s31, 32768
ds_read_b64_tr_b16 a[234:235], v7 offset:1024
v_mfma_f32_16x16x32_bf16 v[204:207], a[164:167], a[204:207], v[204:207]
s_add_u32 m0, s33, 1024
v_mfma_f32_16x16x32_bf16 v[208:211], a[164:167], a[208:211], v[208:211]
buffer_load_dwordx4 v2, s[20:23], s37 offen  lds
v_mfma_f32_16x16x32_bf16 v[212:215], a[164:167], a[212:215], v[212:215]
ds_read_b64_tr_b16 a[236:237], v8 offset:0
v_mfma_f32_16x16x32_bf16 v[216:219], a[164:167], a[216:219], v[216:219]
s_add_u32 s60, s60, s92
v_mfma_f32_16x16x32_bf16 v[220:223], a[164:167], a[220:223], v[220:223]
s_mov_b32 s29, s60
ds_read_b128 a[164:167], v3 offset:1024
v_mfma_f32_16x16x32_bf16 v[224:227], a[168:171], a[192:195], v[224:227]
buffer_store_dwordx4 v[64:67], v13, s[8:11], s29 offen sc1
v_mfma_f32_16x16x32_bf16 v[228:231], a[168:171], a[196:199], v[228:231]
s_add_u32 s37, s31, 131072
ds_read_b64_tr_b16 a[238:239], v8 offset:1024
v_mfma_f32_16x16x32_bf16 v[232:235], a[168:171], a[200:203], v[232:235]
s_add_u32 m0, s33, 4096
v_mfma_f32_16x16x32_bf16 v[236:239], a[168:171], a[204:207], v[236:239]
buffer_load_dwordx4 v2, s[20:23], s37 offen  lds
v_mfma_f32_16x16x32_bf16 v[240:243], a[168:171], a[208:211], v[240:243]
ds_read_b64_tr_b16 a[240:241], v9 offset:0
v_mfma_f32_16x16x32_bf16 v[244:247], a[168:171], a[212:215], v[244:247]
v_mfma_f32_16x16x32_bf16 v[248:251], a[168:171], a[216:219], v[248:251]
ds_read_b64_tr_b16 a[242:243], v9 offset:1024
v_mfma_f32_16x16x32_bf16 v[252:255], a[168:171], a[220:223], v[252:255]
ds_read_b128 a[168:171], v4 offset:4096
v_mfma_f32_16x16x32_bf16 a[0:3], a[172:175], a[192:195], a[0:3]
s_add_u32 s37, s31, 163840
ds_read_b64_tr_b16 a[244:245], v10 offset:0
v_mfma_f32_16x16x32_bf16 a[4:7], a[172:175], a[196:199], a[4:7]
s_add_u32 m0, s33, 5120
v_mfma_f32_16x16x32_bf16 a[8:11], a[172:175], a[200:203], a[8:11]
buffer_load_dwordx4 v2, s[20:23], s37 offen  lds
v_mfma_f32_16x16x32_bf16 a[12:15], a[172:175], a[204:207], a[12:15]
s_add_u32 s31, s31, 262144
ds_read_b64_tr_b16 a[246:247], v10 offset:1024
v_mfma_f32_16x16x32_bf16 a[16:19], a[172:175], a[208:211], a[16:19]
s_add_u32 s33, s33, 16384
v_mfma_f32_16x16x32_bf16 a[20:23], a[172:175], a[212:215], a[20:23]
s_and_b32 s33, s33, 65535
ds_read_b64_tr_b16 a[248:249], v11 offset:0
v_mfma_f32_16x16x32_bf16 a[24:27], a[172:175], a[216:219], a[24:27]
v_mfma_f32_16x16x32_bf16 a[28:31], a[172:175], a[220:223], a[28:31]
s_add_u32 s48, s48, s34
ds_read_b128 a[172:175], v3 offset:5120
v_mfma_f32_16x16x32_bf16 a[32:35], a[176:179], a[192:195], a[32:35]
s_add_u32 m0, s32, 16384
ds_read_b64_tr_b16 a[250:251], v11 offset:1024
v_mfma_f32_16x16x32_bf16 a[36:39], a[176:179], a[196:199], a[36:39]
buffer_load_dwordx4 v1, s[12:15], s48 offen lds
v_mfma_f32_16x16x32_bf16 a[40:43], a[176:179], a[200:203], a[40:43]
ds_read_b64_tr_b16 a[252:253], v12 offset:0
v_mfma_f32_16x16x32_bf16 a[44:47], a[176:179], a[204:207], a[44:47]
s_add_u32 s29, s29, s44
v_mfma_f32_16x16x32_bf16 a[48:51], a[176:179], a[208:211], a[48:51]
ds_read_b64_tr_b16 a[254:255], v12 offset:1024
v_mfma_f32_16x16x32_bf16 a[52:55], a[176:179], a[212:215], a[52:55]
buffer_store_dwordx4 v[68:71], v13, s[8:11], s29 offen sc1
v_mfma_f32_16x16x32_bf16 a[56:59], a[176:179], a[216:219], a[56:59]
s_add_u32 s48, s48, s34
ds_read_b128 v[28:31], v3 offset:13312
v_mfma_f32_16x16x32_bf16 a[60:63], a[176:179], a[220:223], a[60:63]
s_add_u32 m0, s32, 20480
ds_read_b128 a[176:179], v4 offset:8192
v_mfma_f32_16x16x32_bf16 a[64:67], a[180:183], a[192:195], a[64:67]
buffer_load_dwordx4 v1, s[12:15], s48 offen lds
v_mfma_f32_16x16x32_bf16 a[68:71], a[180:183], a[196:199], a[68:71]
v_add_u32 v5, 16384, v5
v_and_b32 v5, 65535, v5
v_mfma_f32_16x16x32_bf16 a[72:75], a[180:183], a[200:203], a[72:75]
v_xor_b32 v6, 16, v5
v_xor_b32 v7, 64, v5
v_mfma_f32_16x16x32_bf16 a[76:79], a[180:183], a[204:207], a[76:79]
v_xor_b32 v8, 80, v5
v_xor_b32 v9, 128, v5
v_mfma_f32_16x16x32_bf16 a[80:83], a[180:183], a[208:211], a[80:83]
v_xor_b32 v10, 144, v5
v_xor_b32 v11, 192, v5
v_mfma_f32_16x16x32_bf16 a[84:87], a[180:183], a[212:215], a[84:87]
s_add_u32 s48, s48, s34
v_xor_b32 v12, 208, v5
v_mfma_f32_16x16x32_bf16 a[88:91], a[180:183], a[216:219], a[88:91]
s_add_u32 m0, s32, 24576
v_mfma_f32_16x16x32_bf16 a[92:95], a[180:183], a[220:223], a[92:95]
buffer_load_dwordx4 v1, s[12:15], s48 offen lds
ds_read_b128 a[180:183], v3 offset:9216
v_mfma_f32_16x16x32_bf16 a[96:99], a[184:187], a[192:195], a[96:99]
v_mfma_f32_16x16x32_bf16 a[100:103], a[184:187], a[196:199], a[100:103]
v_mfma_f32_16x16x32_bf16 a[104:107], a[184:187], a[200:203], a[104:107]
v_mfma_f32_16x16x32_bf16 a[108:111], a[184:187], a[204:207], a[108:111]
v_mfma_f32_16x16x32_bf16 a[112:115], a[184:187], a[208:211], a[112:115]
s_add_u32 s48, s48, s34
v_mfma_f32_16x16x32_bf16 a[116:119], a[184:187], a[212:215], a[116:119]
s_add_u32 m0, s32, 28672
v_mfma_f32_16x16x32_bf16 a[120:123], a[184:187], a[216:219], a[120:123]
buffer_load_dwordx4 v1, s[12:15], s48 offen lds
v_mfma_f32_16x16x32_bf16 a[124:127], a[184:187], a[220:223], a[124:127]
s_add_u32 s30, s30, 128
ds_read_b128 a[184:187], v4 offset:12288
v_mfma_f32_16x16x32_bf16 a[128:131], a[188:191], a[192:195], a[128:131]
s_add_u32 s32, s32, 32768
s_add_u32 s29, s29, s93
v_add_u32 v3, 32768, v3
v_mfma_f32_16x16x32_bf16 a[132:135], a[188:191], a[196:199], a[132:135]
s_sub_u32 s48, s32, 98304
v_subrev_u32 v19, 98304, v3
v_mfma_f32_16x16x32_bf16 a[136:139], a[188:191], a[200:203], a[136:139]
s_cmp_ge_u32 s32, 163840
s_cselect_b32 s32, s48, s32
buffer_store_dwordx4 v[72:75], v13, s[8:11], s29 offen sc1
buffer_load_dword v15, v14, s[96:99], s100 offen
v_mfma_f32_16x16x32_bf16 a[140:143], a[188:191], a[204:207], a[140:143]
s_add_u32 s100, s100, 16384
v_cmp_le_u32 vcc, 163840, v3
v_mfma_f32_16x16x32_bf16 a[144:147], a[188:191], a[208:211], a[144:147]
s_nop 0
v_cndmask_b32 v3, v3, v19, vcc
v_mfma_f32_16x16x32_bf16 a[148:151], a[188:191], a[212:215], a[148:151]
v_xor_b32 v4, 64, v3
v_mfma_f32_16x16x32_bf16 a[152:155], a[188:191], a[216:219], a[152:155]
v_mfma_f32_16x16x32_bf16 a[156:159], a[188:191], a[220:223], a[156:159]
s_waitcnt vmcnt(23) lgkmcnt(0)
s_barrier
v_mfma_f32_16x16x32_bf16 v[160:163], a[160:163], a[224:227], v[160:163]
ds_read_b64_tr_b16 a[192:193], v5 offset:0
v_mfma_f32_16x16x32_bf16 v[164:167], a[160:163], a[228:231], v[164:167]
v_mfma_f32_16x16x32_bf16 v[168:171], a[160:163], a[232:235], v[168:171]
ds_read_b64_tr_b16 a[194:195], v5 offset:1024
v_mfma_f32_16x16x32_bf16 v[172:175], a[160:163], a[236:239], v[172:175]
s_add_u32 s37, s31, 0
v_mfma_f32_16x16x32_bf16 v[176:179], a[160:163], a[240:243], v[176:179]
s_add_u32 m0, s33, 0
ds_read_b64_tr_b16 a[196:197], v6 offset:0
v_mfma_f32_16x16x32_bf16 v[180:183], a[160:163], a[244:247], v[180:183]
buffer_load_dwordx4 v2, s[20:23], s37 offen  lds
v_mfma_f32_16x16x32_bf16 v[184:187], a[160:163], a[248:251], v[184:187]
ds_read_b64_tr_b16 a[198:199], v6 offset:1024
v_mfma_f32_16x16x32_bf16 v[188:191], a[160:163], a[252:255], v[188:191]
ds_read_b128 a[160:163], v3 offset:0
v_mfma_f32_16x16x32_bf16 v[192:195], a[164:167], a[224:227], v[192:195]
ds_read_b64_tr_b16 a[200:201], v7 offset:0
v_mfma_f32_16x16x32_bf16 v[196:199], a[164:167], a[228:231], v[196:199]
v_mfma_f32_16x16x32_bf16 v[200:203], a[164:167], a[232:235], v[200:203]
s_add_u32 s37, s31, 32768
ds_read_b64_tr_b16 a[202:203], v7 offset:1024
v_mfma_f32_16x16x32_bf16 v[204:207], a[164:167], a[236:239], v[204:207]
s_add_u32 m0, s33, 1024
v_mfma_f32_16x16x32_bf16 v[208:211], a[164:167], a[240:243], v[208:211]
buffer_load_dwordx4 v2, s[20:23], s37 offen  lds
v_mfma_f32_16x16x32_bf16 v[212:215], a[164:167], a[244:247], v[212:215]
ds_read_b64_tr_b16 a[204:205], v8 offset:0
v_mfma_f32_16x16x32_bf16 v[216:219], a[164:167], a[248:251], v[216:219]
s_add_u32 s29, s29, s44
v_mfma_f32_16x16x32_bf16 v[220:223], a[164:167], a[252:255], v[220:223]
ds_read_b128 a[164:167], v4 offset:1024
v_mfma_f32_16x16x32_bf16 v[224:227], a[168:171], a[224:227], v[224:227]
buffer_store_dwordx4 v[76:79], v13, s[8:11], s29 offen sc1
v_mfma_f32_16x16x32_bf16 v[228:231], a[168:171], a[228:231], v[228:231]
s_add_u32 s37, s31, 131072
ds_read_b64_tr_b16 a[206:207], v8 offset:1024
v_mfma_f32_16x16x32_bf16 v[232:235], a[168:171], a[232:235], v[232:235]
s_add_u32 m0, s33, 4096
v_mfma_f32_16x16x32_bf16 v[236:239], a[168:171], a[236:239], v[236:239]
buffer_load_dwordx4 v2, s[20:23], s37 offen  lds
v_mfma_f32_16x16x32_bf16 v[240:243], a[168:171], a[240:243], v[240:243]
ds_read_b64_tr_b16 a[208:209], v9 offset:0
v_mfma_f32_16x16x32_bf16 v[244:247], a[168:171], a[244:247], v[244:247]
v_mfma_f32_16x16x32_bf16 v[248:251], a[168:171], a[248:251], v[248:251]
ds_read_b64_tr_b16 a[210:211], v9 offset:1024
v_mfma_f32_16x16x32_bf16 v[252:255], a[168:171], a[252:255], v[252:255]
ds_read_b128 a[168:171], v3 offset:4096
v_mfma_f32_16x16x32_bf16 a[0:3], a[172:175], a[224:227], a[0:3]
s_add_u32 s37, s31, 163840
ds_read_b64_tr_b16 a[212:213], v10 offset:0
v_mfma_f32_16x16x32_bf16 a[4:7], a[172:175], a[228:231], a[4:7]
s_add_u32 m0, s33, 5120
v_mfma_f32_16x16x32_bf16 a[8:11], a[172:175], a[232:235], a[8:11]
buffer_load_dwordx4 v2, s[20:23], s37 offen  lds
v_mfma_f32_16x16x32_bf16 a[12:15], a[172:175], a[236:239], a[12:15]
s_add_u32 s31, s31, 262144
ds_read_b64_tr_b16 a[214:215], v10 offset:1024
v_mfma_f32_16x16x32_bf16 a[16:19], a[172:175], a[240:243], a[16:19]
s_add_u32 s33, s33, 16384
v_mfma_f32_16x16x32_bf16 a[20:23], a[172:175], a[244:247], a[20:23]
s_and_b32 s33, s33, 65535
ds_read_b64_tr_b16 a[216:217], v11 offset:0
v_mfma_f32_16x16x32_bf16 a[24:27], a[172:175], a[248:251], a[24:27]
v_mfma_f32_16x16x32_bf16 a[28:31], a[172:175], a[252:255], a[28:31]
s_mov_b32 s48, s30
ds_read_b128 a[172:175], v4 offset:5120
v_mfma_f32_16x16x32_bf16 a[32:35], a[176:179], a[224:227], a[32:35]
s_add_u32 m0, s32, 0
ds_read_b64_tr_b16 a[218:219], v11 offset:1024
v_mfma_f32_16x16x32_bf16 a[36:39], a[176:179], a[228:231], a[36:39]
buffer_load_dwordx4 v1, s[12:15], s48 offen lds
v_mfma_f32_16x16x32_bf16 a[40:43], a[176:179], a[232:235], a[40:43]
ds_read_b64_tr_b16 a[220:221], v12 offset:0
v_mfma_f32_16x16x32_bf16 a[44:47], a[176:179], a[236:239], a[44:47]
s_add_u32 s29, s29, s93
v_mfma_f32_16x16x32_bf16 a[48:51], a[176:179], a[240:243], a[48:51]
ds_read_b64_tr_b16 a[222:223], v12 offset:1024
v_mfma_f32_16x16x32_bf16 a[52:55], a[176:179], a[244:247], a[52:55]
buffer_store_dwordx4 v[80:83], v13, s[8:11], s29 offen sc1
v_mfma_f32_16x16x32_bf16 a[56:59], a[176:179], a[248:251], a[56:59]
s_add_u32 s48, s48, s34
ds_read_b128 a[188:191], v4 offset:13312
v_mfma_f32_16x16x32_bf16 a[60:63], a[176:179], a[252:255], a[60:63]
s_add_u32 m0, s32, 4096
ds_read_b128 a[176:179], v3 offset:8192
v_mfma_f32_16x16x32_bf16 a[64:67], a[180:183], a[224:227], a[64:67]
buffer_load_dwordx4 v1, s[12:15], s48 offen lds
v_mfma_f32_16x16x32_bf16 a[68:71], a[180:183], a[228:231], a[68:71]
v_add_u32 v5, 16384, v5
v_and_b32 v5, 65535, v5
v_mfma_f32_16x16x32_bf16 a[72:75], a[180:183], a[232:235], a[72:75]
v_xor_b32 v6, 16, v5
v_xor_b32 v7, 64, v5
v_mfma_f32_16x16x32_bf16 a[76:79], a[180:183], a[236:239], a[76:79]
v_xor_b32 v8, 80, v5
v_xor_b32 v9, 128, v5
v_mfma_f32_16x16x32_bf16 a[80:83], a[180:183], a[240:243], a[80:83]
v_xor_b32 v10, 144, v5
v_xor_b32 v11, 192, v5
v_mfma_f32_16x16x32_bf16 a[84:87], a[180:183], a[244:247], a[84:87]
s_add_u32 s48, s48, s34
v_xor_b32 v12, 208, v5
v_mfma_f32_16x16x32_bf16 a[88:91], a[180:183], a[248:251], a[88:91]
s_add_u32 m0, s32, 8192
v_mfma_f32_16x16x32_bf16 a[92:95], a[180:183], a[252:255], a[92:95]
buffer_load_dwordx4 v1, s[12:15], s48 offen lds
ds_read_b128 a[180:183], v4 offset:9216
v_mfma_f32_16x16x32_bf16 a[96:99], a[184:187], a[224:227], a[96:99]
v_mfma_f32_16x16x32_bf16 a[100:103], a[184:187], a[228:231], a[100:103]
v_mfma_f32_16x16x32_bf16 a[104:107], a[184:187], a[232:235], a[104:107]
v_mfma_f32_16x16x32_bf16 a[108:111], a[184:187], a[236:239], a[108:111]
v_mfma_f32_16x16x32_bf16 a[112:115], a[184:187], a[240:243], a[112:115]
s_add_u32 s48, s48, s34
v_mfma_f32_16x16x32_bf16 a[116:119], a[184:187], a[244:247], a[116:119]
s_add_u32 m0, s32, 12288
v_mfma_f32_16x16x32_bf16 a[120:123], a[184:187], a[248:251], a[120:123]
buffer_load_dwordx4 v1, s[12:15], s48 offen lds
v_mfma_f32_16x16x32_bf16 a[124:127], a[184:187], a[252:255], a[124:127]
ds_read_b128 a[184:187], v3 offset:12288
v_mfma_f32_16x16x32_bf16 a[128:131], v[28:31], a[224:227], a[128:131]
s_add_u32 s29, s29, s44
v_mfma_f32_16x16x32_bf16 a[132:135], v[28:31], a[228:231], a[132:135]
v_mfma_f32_16x16x32_bf16 a[136:139], v[28:31], a[232:235], a[136:139]
buffer_store_dwordx4 v[84:87], v13, s[8:11], s29 offen sc1
buffer_load_dword v15, v14, s[96:99], s100 offen
v_mfma_f32_16x16x32_bf16 a[140:143], v[28:31], a[236:239], a[140:143]
s_add_u32 s100, s100, 16384
v_mfma_f32_16x16x32_bf16 a[144:147], v[28:31], a[240:243], a[144:147]
v_mfma_f32_16x16x32_bf16 a[148:151], v[28:31], a[244:247], a[148:151]
v_mfma_f32_16x16x32_bf16 a[152:155], v[28:31], a[248:251], a[152:155]
v_mfma_f32_16x16x32_bf16 a[156:159], v[28:31], a[252:255], a[156:159]
s_waitcnt vmcnt(24) lgkmcnt(0)
s_barrier
v_mfma_f32_16x16x32_bf16 v[160:163], a[160:163], a[192:195], v[160:163]
ds_read_b64_tr_b16 a[224:225], v5 offset:0
v_mfma_f32_16x16x32_bf16 v[164:167], a[160:163], a[196:199], v[164:167]
v_mfma_f32_16x16x32_bf16 v[168:171], a[160:163], a[200:203], v[168:171]
ds_read_b64_tr_b16 a[226:227], v5 offset:1024
v_mfma_f32_16x16x32_bf16 v[172:175], a[160:163], a[204:207], v[172:175]
s_add_u32 s37, s31, 0
v_mfma_f32_16x16x32_bf16 v[176:179], a[160:163], a[208:211], v[176:179]
s_add_u32 m0, s33, 0
ds_read_b64_tr_b16 a[228:229], v6 offset:0
v_mfma_f32_16x16x32_bf16 v[180:183], a[160:163], a[212:215], v[180:183]
buffer_load_dwordx4 v2, s[20:23], s37 offen  lds
v_mfma_f32_16x16x32_bf16 v[184:187], a[160:163], a[216:219], v[184:187]
ds_read_b64_tr_b16 a[230:231], v6 offset:1024
v_mfma_f32_16x16x32_bf16 v[188:191], a[160:163], a[220:223], v[188:191]
ds_read_b128 a[160:163], v4 offset:0
v_mfma_f32_16x16x32_bf16 v[192:195], a[164:167], a[192:195], v[192:195]
ds_read_b64_tr_b16 a[232:233], v7 offset:0
v_mfma_f32_16x16x32_bf16 v[196:199], a[164:167], a[196:199], v[196:199]
v_mfma_f32_16x16x32_bf16 v[200:203], a[164:167], a[200:203], v[200:203]
s_add_u32 s37, s31, 32768
ds_read_b64_tr_b16 a[234:235], v7 offset:1024
v_mfma_f32_16x16x32_bf16 v[204:207], a[164:167], a[204:207], v[204:207]
s_add_u32 m0, s33, 1024
v_mfma_f32_16x16x32_bf16 v[208:211], a[164:167], a[208:211], v[208:211]
buffer_load_dwordx4 v2, s[20:23], s37 offen  lds
v_mfma_f32_16x16x32_bf16 v[212:215], a[164:167], a[212:215], v[212:215]
ds_read_b64_tr_b16 a[236:237], v8 offset:0
v_mfma_f32_16x16x32_bf16 v[216:219], a[164:167], a[216:219], v[216:219]
s_add_u32 s29, s29, s93
v_mfma_f32_16x16x32_bf16 v[220:223], a[164:167], a[220:223], v[220:223]
ds_read_b128 a[164:167], v3 offset:1024
v_mfma_f32_16x16x32_bf16 v[224:227], a[168:171], a[192:195], v[224:227]
buffer_store_dwordx4 v[88:91], v13, s[8:11], s29 offen sc1
v_mfma_f32_16x16x32_bf16 v[228:231], a[168:171], a[196:199], v[228:231]
s_add_u32 s37, s31, 131072
ds_read_b64_tr_b16 a[238:239], v8 offset:1024
v_mfma_f32_16x16x32_bf16 v[232:235], a[168:171], a[200:203], v[232:235]
s_add_u32 m0, s33, 4096
v_mfma_f32_16x16x32_bf16 v[236:239], a[168:171], a[204:207], v[236:239]
buffer_load_dwordx4 v2, s[20:23], s37 offen  lds
v_mfma_f32_16x16x32_bf16 v[240:243], a[168:171], a[208:211], v[240:243]
ds_read_b64_tr_b16 a[240:241], v9 offset:0
v_mfma_f32_16x16x32_bf16 v[244:247], a[168:171], a[212:215], v[244:247]
v_mfma_f32_16x16x32_bf16 v[248:251], a[168:171], a[216:219], v[248:251]
ds_read_b64_tr_b16 a[242:243], v9 offset:1024
v_mfma_f32_16x16x32_bf16 v[252:255], a[168:171], a[220:223], v[252:255]
ds_read_b128 a[168:171], v4 offset:4096
v_mfma_f32_16x16x32_bf16 a[0:3], a[172:175], a[192:195], a[0:3]
s_add_u32 s37, s31, 163840
ds_read_b64_tr_b16 a[244:245], v10 offset:0
v_mfma_f32_16x16x32_bf16 a[4:7], a[172:175], a[196:199], a[4:7]
s_add_u32 m0, s33, 5120
v_mfma_f32_16x16x32_bf16 a[8:11], a[172:175], a[200:203], a[8:11]
buffer_load_dwordx4 v2, s[20:23], s37 offen  lds
v_mfma_f32_16x16x32_bf16 a[12:15], a[172:175], a[204:207], a[12:15]
s_add_u32 s31, s31, 262144
ds_read_b64_tr_b16 a[246:247], v10 offset:1024
v_mfma_f32_16x16x32_bf16 a[16:19], a[172:175], a[208:211], a[16:19]
s_add_u32 s33, s33, 16384
v_mfma_f32_16x16x32_bf16 a[20:23], a[172:175], a[212:215], a[20:23]
s_and_b32 s33, s33, 65535
ds_read_b64_tr_b16 a[248:249], v11 offset:0
v_mfma_f32_16x16x32_bf16 a[24:27], a[172:175], a[216:219], a[24:27]
v_mfma_f32_16x16x32_bf16 a[28:31], a[172:175], a[220:223], a[28:31]
s_add_u32 s48, s48, s34
ds_read_b128 a[172:175], v3 offset:5120
v_mfma_f32_16x16x32_bf16 a[32:35], a[176:179], a[192:195], a[32:35]
s_add_u32 m0, s32, 16384
ds_read_b64_tr_b16 a[250:251], v11 offset:1024
v_mfma_f32_16x16x32_bf16 a[36:39], a[176:179], a[196:199], a[36:39]
buffer_load_dwordx4 v1, s[12:15], s48 offen lds
v_mfma_f32_16x16x32_bf16 a[40:43], a[176:179], a[200:203], a[40:43]
ds_read_b64_tr_b16 a[252:253], v12 offset:0
v_mfma_f32_16x16x32_bf16 a[44:47], a[176:179], a[204:207], a[44:47]
s_add_u32 s29, s29, s44
v_mfma_f32_16x16x32_bf16 a[48:51], a[176:179], a[208:211], a[48:51]
ds_read_b64_tr_b16 a[254:255], v12 offset:1024
v_mfma_f32_16x16x32_bf16 a[52:55], a[176:179], a[212:215], a[52:55]
buffer_store_dwordx4 v[92:95], v13, s[8:11], s29 offen sc1
v_mfma_f32_16x16x32_bf16 a[56:59], a[176:179], a[216:219], a[56:59]
s_add_u32 s48, s48, s34
ds_read_b128 v[28:31], v3 offset:13312
v_mfma_f32_16x16x32_bf16 a[60:63], a[176:179], a[220:223], a[60:63]
s_add_u32 m0, s32, 20480
ds_read_b128 a[176:179], v4 offset:8192
v_mfma_f32_16x16x32_bf16 a[64:67], a[180:183], a[192:195], a[64:67]
buffer_load_dwordx4 v1, s[12:15], s48 offen lds
v_mfma_f32_16x16x32_bf16 a[68:71], a[180:183], a[196:199], a[68:71]
v_add_u32 v5, 16384, v5
v_and_b32 v5, 65535, v5
v_mfma_f32_16x16x32_bf16 a[72:75], a[180:183], a[200:203], a[72:75]
v_xor_b32 v6, 16, v5
v_xor_b32 v7, 64, v5
v_mfma_f32_16x16x32_bf16 a[76:79], a[180:183], a[204:207], a[76:79]
v_xor_b32 v8, 80, v5
v_xor_b32 v9, 128, v5
v_mfma_f32_16x16x32_bf16 a[80:83], a[180:183], a[208:211], a[80:83]
v_xor_b32 v10, 144, v5
v_xor_b32 v11, 192, v5
v_mfma_f32_16x16x32_bf16 a[84:87], a[180:183], a[212:215], a[84:87]
s_add_u32 s48, s48, s34
v_xor_b32 v12, 208, v5
v_mfma_f32_16x16x32_bf16 a[88:91], a[180:183], a[216:219], a[88:91]
s_add_u32 m0, s32, 24576
v_mfma_f32_16x16x32_bf16 a[92:95], a[180:183], a[220:223], a[92:95]
buffer_load_dwordx4 v1, s[12:15], s48 offen lds
ds_read_b128 a[180:183], v3 offset:9216
v_mfma_f32_16x16x32_bf16 a[96:99], a[184:187], a[192:195], a[96:99]
v_mfma_f32_16x16x32_bf16 a[100:103], a[184:187], a[196:199], a[100:103]
v_mfma_f32_16x16x32_bf16 a[104:107], a[184:187], a[200:203], a[104:107]
v_mfma_f32_16x16x32_bf16 a[108:111], a[184:187], a[204:207], a[108:111]
v_mfma_f32_16x16x32_bf16 a[112:115], a[184:187], a[208:211], a[112:115]
s_add_u32 s48, s48, s34
v_mfma_f32_16x16x32_bf16 a[116:119], a[184:187], a[212:215], a[116:119]
s_add_u32 m0, s32, 28672
v_mfma_f32_16x16x32_bf16 a[120:123], a[184:187], a[216:219], a[120:123]
buffer_load_dwordx4 v1, s[12:15], s48 offen lds
v_mfma_f32_16x16x32_bf16 a[124:127], a[184:187], a[220:223], a[124:127]
s_add_u32 s30, s30, 128
ds_read_b128 a[184:187], v4 offset:12288
v_mfma_f32_16x16x32_bf16 a[128:131], a[188:191], a[192:195], a[128:131]
s_add_u32 s32, s32, 32768
v_add_u32 v3, 32768, v3
v_mfma_f32_16x16x32_bf16 a[132:135], a[188:191], a[196:199], a[132:135]
s_sub_u32 s48, s32, 98304
v_subrev_u32 v19, 98304, v3
v_mfma_f32_16x16x32_bf16 a[136:139], a[188:191], a[200:203], a[136:139]
s_cmp_ge_u32 s32, 163840
s_cselect_b32 s32, s48, s32
buffer_load_dword v15, v14, s[96:99], s100 offen
v_mfma_f32_16x16x32_bf16 a[140:143], a[188:191], a[204:207], a[140:143]
s_add_u32 s100, s100, 16384
v_cmp_le_u32 vcc, 163840, v3
v_mfma_f32_16x16x32_bf16 a[144:147], a[188:191], a[208:211], a[144:147]
s_nop 0
v_cndmask_b32 v3, v3, v19, vcc
v_mfma_f32_16x16x32_bf16 a[148:151], a[188:191], a[212:215], a[148:151]
v_xor_b32 v4, 64, v3
v_mfma_f32_16x16x32_bf16 a[152:155], a[188:191], a[216:219], a[152:155]
v_mfma_f32_16x16x32_bf16 a[156:159], a[188:191], a[220:223], a[156:159]
s_waitcnt vmcnt(23) lgkmcnt(0)
s_barrier
v_mfma_f32_16x16x32_bf16 v[160:163], a[160:163], a[224:227], v[160:163]
ds_read_b64_tr_b16 a[192:193], v5 offset:0
v_mfma_f32_16x16x32_bf16 v[164:167], a[160:163], a[228:231], v[164:167]
v_mfma_f32_16x16x32_bf16 v[168:171], a[160:163], a[232:235], v[168:171]
ds_read_b64_tr_b16 a[194:195], v5 offset:1024
v_mfma_f32_16x16x32_bf16 v[172:175], a[160:163], a[236:239], v[172:175]
s_add_u32 s37, s31, 0
v_mfma_f32_16x16x32_bf16 v[176:179], a[160:163], a[240:243], v[176:179]
s_add_u32 m0, s33, 0
ds_read_b64_tr_b16 a[196:197], v6 offset:0
v_mfma_f32_16x16x32_bf16 v[180:183], a[160:163], a[244:247], v[180:183]
buffer_load_dwordx4 v2, s[20:23], s37 offen  lds
v_mfma_f32_16x16x32_bf16 v[184:187], a[160:163], a[248:251], v[184:187]
ds_read_b64_tr_b16 a[198:199], v6 offset:1024
v_mfma_f32_16x16x32_bf16 v[188:191], a[160:163], a[252:255], v[188:191]
ds_read_b128 a[160:163], v3 offset:0
v_mfma_f32_16x16x32_bf16 v[192:195], a[164:167], a[224:227], v[192:195]
ds_read_b64_tr_b16 a[200:201], v7 offset:0
v_mfma_f32_16x16x32_bf16 v[196:199], a[164:167], a[228:231], v[196:199]
v_mfma_f32_16x16x32_bf16 v[200:203], a[164:167], a[232:235], v[200:203]
s_add_u32 s37, s31, 32768
ds_read_b64_tr_b16 a[202:203], v7 offset:1024
v_mfma_f32_16x16x32_bf16 v[204:207], a[164:167], a[236:239], v[204:207]
s_add_u32 m0, s33, 1024
v_mfma_f32_16x16x32_bf16 v[208:211], a[164:167], a[240:243], v[208:211]
buffer_load_dwordx4 v2, s[20:23], s37 offen  lds
v_mfma_f32_16x16x32_bf16 v[212:215], a[164:167], a[244:247], v[212:215]
ds_read_b64_tr_b16 a[204:205], v8 offset:0
v_mfma_f32_16x16x32_bf16 v[216:219], a[164:167], a[248:251], v[216:219]
s_add_u32 s60, s60, s92
v_mfma_f32_16x16x32_bf16 v[220:223], a[164:167], a[252:255], v[220:223]
s_mov_b32 s29, s60
ds_read_b128 a[164:167], v4 offset:1024
v_mfma_f32_16x16x32_bf16 v[224:227], a[168:171], a[224:227], v[224:227]
buffer_store_dwordx4 v[96:99], v13, s[8:11], s29 offen sc1
v_mfma_f32_16x16x32_bf16 v[228:231], a[168:171], a[228:231], v[228:231]
s_add_u32 s37, s31, 131072
ds_read_b64_tr_b16 a[206:207], v8 offset:1024
v_mfma_f32_16x16x32_bf16 v[232:235], a[168:171], a[232:235], v[232:235]
s_add_u32 m0, s33, 4096
v_mfma_f32_16x16x32_bf16 v[236:239], a[168:171], a[236:239], v[236:239]
buffer_load_dwordx4 v2, s[20:23], s37 offen  lds
v_mfma_f32_16x16x32_bf16 v[240:243], a[168:171], a[240:243], v[240:243]
ds_read_b64_tr_b16 a[208:209], v9 offset:0
v_mfma_f32_16x16x32_bf16 v[244:247], a[168:171], a[244:247], v[244:247]
v_mfma_f32_16x16x32_bf16 v[248:251], a[168:171], a[248:251], v[248:251]
ds_read_b64_tr_b16 a[210:211], v9 offset:1024
v_mfma_f32_16x16x32_bf16 v[252:255], a[168:171], a[252:255], v[252:255]
ds_read_b128 a[168:171], v3 offset:4096
v_mfma_f32_16x16x32_bf16 a[0:3], a[172:175], a[224:227], a[0:3]
s_add_u32 s37, s31, 163840
ds_read_b64_tr_b16 a[212:213], v10 offset:0
v_mfma_f32_16x16x32_bf16 a[4:7], a[172:175], a[228:231], a[4:7]
s_add_u32 m0, s33, 5120
v_mfma_f32_16x16x32_bf16 a[8:11], a[172:175], a[232:235], a[8:11]
buffer_load_dwordx4 v2, s[20:23], s37 offen  lds
v_mfma_f32_16x16x32_bf16 a[12:15], a[172:175], a[236:239], a[12:15]
s_add_u32 s31, s31, 262144
ds_read_b64_tr_b16 a[214:215], v10 offset:1024
v_mfma_f32_16x16x32_bf16 a[16:19], a[172:175], a[240:243], a[16:19]
s_add_u32 s33, s33, 16384
v_mfma_f32_16x16x32_bf16 a[20:23], a[172:175], a[244:247], a[20:23]
s_and_b32 s33, s33, 65535
ds_read_b64_tr_b16 a[216:217], v11 offset:0
v_mfma_f32_16x16x32_bf16 a[24:27], a[172:175], a[248:251], a[24:27]
v_mfma_f32_16x16x32_bf16 a[28:31], a[172:175], a[252:255], a[28:31]
s_mov_b32 s48, s30
ds_read_b128 a[172:175], v4 offset:5120
v_mfma_f32_16x16x32_bf16 a[32:35], a[176:179], a[224:227], a[32:35]
s_add_u32 m0, s32, 0
ds_read_b64_tr_b16 a[218:219], v11 offset:1024
v_mfma_f32_16x16x32_bf16 a[36:39], a[176:179], a[228:231], a[36:39]
buffer_load_dwordx4 v1, s[12:15], s48 offen lds
v_mfma_f32_16x16x32_bf16 a[40:43], a[176:179], a[232:235], a[40:43]
ds_read_b64_tr_b16 a[220:221], v12 offset:0
v_mfma_f32_16x16x32_bf16 a[44:47], a[176:179], a[236:239], a[44:47]
s_add_u32 s29, s29, s44
v_mfma_f32_16x16x32_bf16 a[48:51], a[176:179], a[240:243], a[48:51]
ds_read_b64_tr_b16 a[222:223], v12 offset:1024
v_mfma_f32_16x16x32_bf16 a[52:55], a[176:179], a[244:247], a[52:55]
buffer_store_dwordx4 v[100:103], v13, s[8:11], s29 offen sc1
v_mfma_f32_16x16x32_bf16 a[56:59], a[176:179], a[248:251], a[56:59]
s_add_u32 s48, s48, s34
ds_read_b128 a[188:191], v4 offset:13312
v_mfma_f32_16x16x32_bf16 a[60:63], a[176:179], a[252:255], a[60:63]
s_add_u32 m0, s32, 4096
ds_read_b128 a[176:179], v3 offset:8192
v_mfma_f32_16x16x32_bf16 a[64:67], a[180:183], a[224:227], a[64:67]
buffer_load_dwordx4 v1, s[12:15], s48 offen lds
v_mfma_f32_16x16x32_bf16 a[68:71], a[180:183], a[228:231], a[68:71]
v_add_u32 v5, 16384, v5
v_and_b32 v5, 65535, v5
v_mfma_f32_16x16x32_bf16 a[72:75], a[180:183], a[232:235], a[72:75]
v_xor_b32 v6, 16, v5
v_xor_b32 v7, 64, v5
v_mfma_f32_16x16x32_bf16 a[76:79], a[180:183], a[236:239], a[76:79]
v_xor_b32 v8, 80, v5
v_xor_b32 v9, 128, v5
v_mfma_f32_16x16x32_bf16 a[80:83], a[180:183], a[240:243], a[80:83]
v_xor_b32 v10, 144, v5
v_xor_b32 v11, 192, v5
v_mfma_f32_16x16x32_bf16 a[84:87], a[180:183], a[244:247], a[84:87]
s_add_u32 s48, s48, s34
v_xor_b32 v12, 208, v5
v_mfma_f32_16x16x32_bf16 a[88:91], a[180:183], a[248:251], a[88:91]
s_add_u32 m0, s32, 8192
v_mfma_f32_16x16x32_bf16 a[92:95], a[180:183], a[252:255], a[92:95]
buffer_load_dwordx4 v1, s[12:15], s48 offen lds
ds_read_b128 a[180:183], v4 offset:9216
v_mfma_f32_16x16x32_bf16 a[96:99], a[184:187], a[224:227], a[96:99]
v_mfma_f32_16x16x32_bf16 a[100:103], a[184:187], a[228:231], a[100:103]
v_mfma_f32_16x16x32_bf16 a[104:107], a[184:187], a[232:235], a[104:107]
v_mfma_f32_16x16x32_bf16 a[108:111], a[184:187], a[236:239], a[108:111]
v_mfma_f32_16x16x32_bf16 a[112:115], a[184:187], a[240:243], a[112:115]
s_add_u32 s48, s48, s34
v_mfma_f32_16x16x32_bf16 a[116:119], a[184:187], a[244:247], a[116:119]
s_add_u32 m0, s32, 12288
v_mfma_f32_16x16x32_bf16 a[120:123], a[184:187], a[248:251], a[120:123]
buffer_load_dwordx4 v1, s[12:15], s48 offen lds
v_mfma_f32_16x16x32_bf16 a[124:127], a[184:187], a[252:255], a[124:127]
ds_read_b128 a[184:187], v3 offset:12288
v_mfma_f32_16x16x32_bf16 a[128:131], v[28:31], a[224:227], a[128:131]
s_add_u32 s29, s29, s93
v_mfma_f32_16x16x32_bf16 a[132:135], v[28:31], a[228:231], a[132:135]
v_mfma_f32_16x16x32_bf16 a[136:139], v[28:31], a[232:235], a[136:139]
buffer_store_dwordx4 v[104:107], v13, s[8:11], s29 offen sc1
buffer_load_dword v15, v14, s[96:99], s100 offen
v_mfma_f32_16x16x32_bf16 a[140:143], v[28:31], a[236:239], a[140:143]
s_add_u32 s100, s100, 16384
v_mfma_f32_16x16x32_bf16 a[144:147], v[28:31], a[240:243], a[144:147]
v_mfma_f32_16x16x32_bf16 a[148:151], v[28:31], a[244:247], a[148:151]
v_mfma_f32_16x16x32_bf16 a[152:155], v[28:31], a[248:251], a[152:155]
v_mfma_f32_16x16x32_bf16 a[156:159], v[28:31], a[252:255], a[156:159]
s_waitcnt vmcnt(23) lgkmcnt(0)
s_barrier
v_mfma_f32_16x16x32_bf16 v[160:163], a[160:163], a[192:195], v[160:163]
ds_read_b64_tr_b16 a[224:225], v5 offset:0
v_mfma_f32_16x16x32_bf16 v[164:167], a[160:163], a[196:199], v[164:167]
v_mfma_f32_16x16x32_bf16 v[168:171], a[160:163], a[200:203], v[168:171]
ds_read_b64_tr_b16 a[226:227], v5 offset:1024
v_mfma_f32_16x16x32_bf16 v[172:175], a[160:163], a[204:207], v[172:175]
s_add_u32 s37, s31, 0
v_mfma_f32_16x16x32_bf16 v[176:179], a[160:163], a[208:211], v[176:179]
s_add_u32 m0, s33, 0
ds_read_b64_tr_b16 a[228:229], v6 offset:0
v_mfma_f32_16x16x32_bf16 v[180:183], a[160:163], a[212:215], v[180:183]
buffer_load_dwordx4 v2, s[20:23], s37 offen  lds
v_mfma_f32_16x16x32_bf16 v[184:187], a[160:163], a[216:219], v[184:187]
ds_read_b64_tr_b16 a[230:231], v6 offset:1024
v_mfma_f32_16x16x32_bf16 v[188:191], a[160:163], a[220:223], v[188:191]
ds_read_b128 a[160:163], v4 offset:0
v_mfma_f32_16x16x32_bf16 v[192:195], a[164:167], a[192:195], v[192:195]
ds_read_b64_tr_b16 a[232:233], v7 offset:0
v_mfma_f32_16x16x32_bf16 v[196:199], a[164:167], a[196:199], v[196:199]
v_mfma_f32_16x16x32_bf16 v[200:203], a[164:167], a[200:203], v[200:203]
s_add_u32 s37, s31, 32768
ds_read_b64_tr_b16 a[234:235], v7 offset:1024
v_mfma_f32_16x16x32_bf16 v[204:207], a[164:167], a[204:207], v[204:207]
s_add_u32 m0, s33, 1024
v_mfma_f32_16x16x32_bf16 v[208:211], a[164:167], a[208:211], v[208:211]
buffer_load_dwordx4 v2, s[20:23], s37 offen  lds
v_mfma_f32_16x16x32_bf16 v[212:215], a[164:167], a[212:215], v[212:215]
ds_read_b64_tr_b16 a[236:237], v8 offset:0
v_mfma_f32_16x16x32_bf16 v[216:219], a[164:167], a[216:219], v[216:219]
s_add_u32 s29, s29, s44
v_mfma_f32_16x16x32_bf16 v[220:223], a[164:167], a[220:223], v[220:223]
ds_read_b128 a[164:167], v3 offset:1024
v_mfma_f32_16x16x32_bf16 v[224:227], a[168:171], a[192:195], v[224:227]
buffer_store_dwordx4 v[108:111], v13, s[8:11], s29 offen sc1
v_mfma_f32_16x16x32_bf16 v[228:231], a[168:171], a[196:199], v[228:231]
s_add_u32 s37, s31, 131072
ds_read_b64_tr_b16 a[238:239], v8 offset:1024
v_mfma_f32_16x16x32_bf16 v[232:235], a[168:171], a[200:203], v[232:235]
s_add_u32 m0, s33, 4096
v_mfma_f32_16x16x32_bf16 v[236:239], a[168:171], a[204:207], v[236:239]
buffer_load_dwordx4 v2, s[20:23], s37 offen  lds
v_mfma_f32_16x16x32_bf16 v[240:243], a[168:171], a[208:211], v[240:243]
ds_read_b64_tr_b16 a[240:241], v9 offset:0
v_mfma_f32_16x16x32_bf16 v[244:247], a[168:171], a[212:215], v[244:247]
v_mfma_f32_16x16x32_bf16 v[248:251], a[168:171], a[216:219], v[248:251]
ds_read_b64_tr_b16 a[242:243], v9 offset:1024
v_mfma_f32_16x16x32_bf16 v[252:255], a[168:171], a[220:223], v[252:255]
ds_read_b128 a[168:171], v4 offset:4096
v_mfma_f32_16x16x32_bf16 a[0:3], a[172:175], a[192:195], a[0:3]
s_add_u32 s37, s31, 163840
ds_read_b64_tr_b16 a[244:245], v10 offset:0
v_mfma_f32_16x16x32_bf16 a[4:7], a[172:175], a[196:199], a[4:7]
s_add_u32 m0, s33, 5120
v_mfma_f32_16x16x32_bf16 a[8:11], a[172:175], a[200:203], a[8:11]
buffer_load_dwordx4 v2, s[20:23], s37 offen  lds
v_mfma_f32_16x16x32_bf16 a[12:15], a[172:175], a[204:207], a[12:15]
s_add_u32 s31, s31, 262144
ds_read_b64_tr_b16 a[246:247], v10 offset:1024
v_mfma_f32_16x16x32_bf16 a[16:19], a[172:175], a[208:211], a[16:19]
s_add_u32 s33, s33, 16384
v_mfma_f32_16x16x32_bf16 a[20:23], a[172:175], a[212:215], a[20:23]
s_and_b32 s33, s33, 65535
ds_read_b64_tr_b16 a[248:249], v11 offset:0
v_mfma_f32_16x16x32_bf16 a[24:27], a[172:175], a[216:219], a[24:27]
v_mfma_f32_16x16x32_bf16 a[28:31], a[172:175], a[220:223], a[28:31]
s_add_u32 s48, s48, s34
ds_read_b128 a[172:175], v3 offset:5120
v_mfma_f32_16x16x32_bf16 a[32:35], a[176:179], a[192:195], a[32:35]
s_add_u32 m0, s32, 16384
ds_read_b64_tr_b16 a[250:251], v11 offset:1024
v_mfma_f32_16x16x32_bf16 a[36:39], a[176:179], a[196:199], a[36:39]
buffer_load_dwordx4 v1, s[12:15], s48 offen lds
v_mfma_f32_16x16x32_bf16 a[40:43], a[176:179], a[200:203], a[40:43]
ds_read_b64_tr_b16 a[252:253], v12 offset:0
v_mfma_f32_16x16x32_bf16 a[44:47], a[176:179], a[204:207], a[44:47]
s_add_u32 s29, s29, s93
v_mfma_f32_16x16x32_bf16 a[48:51], a[176:179], a[208:211], a[48:51]
ds_read_b64_tr_b16 a[254:255], v12 offset:1024
v_mfma_f32_16x16x32_bf16 a[52:55], a[176:179], a[212:215], a[52:55]
buffer_store_dwordx4 v[112:115], v13, s[8:11], s29 offen sc1
v_mfma_f32_16x16x32_bf16 a[56:59], a[176:179], a[216:219], a[56:59]
s_add_u32 s48, s48, s34
ds_read_b128 v[28:31], v3 offset:13312
v_mfma_f32_16x16x32_bf16 a[60:63], a[176:179], a[220:223], a[60:63]
s_add_u32 m0, s32, 20480
ds_read_b128 a[176:179], v4 offset:8192
v_mfma_f32_16x16x32_bf16 a[64:67], a[180:183], a[192:195], a[64:67]
buffer_load_dwordx4 v1, s[12:15], s48 offen lds
v_mfma_f32_16x16x32_bf16 a[68:71], a[180:183], a[196:199], a[68:71]
v_add_u32 v5, 16384, v5
v_and_b32 v5, 65535, v5
v_mfma_f32_16x16x32_bf16 a[72:75], a[180:183], a[200:203], a[72:75]
v_xor_b32 v6, 16, v5
v_xor_b32 v7, 64, v5
v_mfma_f32_16x16x32_bf16 a[76:79], a[180:183], a[204:207], a[76:79]
v_xor_b32 v8, 80, v5
v_xor_b32 v9, 128, v5
v_mfma_f32_16x16x32_bf16 a[80:83], a[180:183], a[208:211], a[80:83]
v_xor_b32 v10, 144, v5
v_xor_b32 v11, 192, v5
v_mfma_f32_16x16x32_bf16 a[84:87], a[180:183], a[212:215], a[84:87]
s_add_u32 s48, s48, s34
v_xor_b32 v12, 208, v5
v_mfma_f32_16x16x32_bf16 a[88:91], a[180:183], a[216:219], a[88:91]
s_add_u32 m0, s32, 24576
v_mfma_f32_16x16x32_bf16 a[92:95], a[180:183], a[220:223], a[92:95]
buffer_load_dwordx4 v1, s[12:15], s48 offen lds
ds_read_b128 a[180:183], v3 offset:9216
v_mfma_f32_16x16x32_bf16 a[96:99], a[184:187], a[192:195], a[96:99]
v_mfma_f32_16x16x32_bf16 a[100:103], a[184:187], a[196:199], a[100:103]
v_mfma_f32_16x16x32_bf16 a[104:107], a[184:187], a[200:203], a[104:107]
v_mfma_f32_16x16x32_bf16 a[108:111], a[184:187], a[204:207], a[108:111]
v_mfma_f32_16x16x32_bf16 a[112:115], a[184:187], a[208:211], a[112:115]
s_add_u32 s48, s48, s34
v_mfma_f32_16x16x32_bf16 a[116:119], a[184:187], a[212:215], a[116:119]
s_add_u32 m0, s32, 28672
v_mfma_f32_16x16x32_bf16 a[120:123], a[184:187], a[216:219], a[120:123]
buffer_load_dwordx4 v1, s[12:15], s48 offen lds
v_mfma_f32_16x16x32_bf16 a[124:127], a[184:187], a[220:223], a[124:127]
s_add_u32 s30, s30, 128
ds_read_b128 a[184:187], v4 offset:12288
v_mfma_f32_16x16x32_bf16 a[128:131], a[188:191], a[192:195], a[128:131]
s_add_u32 s32, s32, 32768
s_add_u32 s29, s29, s44
v_add_u32 v3, 32768, v3
v_mfma_f32_16x16x32_bf16 a[132:135], a[188:191], a[196:199], a[132:135]
s_sub_u32 s48, s32, 98304
v_subrev_u32 v19, 98304, v3
v_mfma_f32_16x16x32_bf16 a[136:139], a[188:191], a[200:203], a[136:139]
s_cmp_ge_u32 s32, 163840
s_cselect_b32 s32, s48, s32
buffer_store_dwordx4 v[116:119], v13, s[8:11], s29 offen sc1
buffer_load_dword v15, v14, s[96:99], s100 offen
v_mfma_f32_16x16x32_bf16 a[140:143], a[188:191], a[204:207], a[140:143]
s_add_u32 s100, s100, 16384
v_cmp_le_u32 vcc, 163840, v3
v_mfma_f32_16x16x32_bf16 a[144:147], a[188:191], a[208:211], a[144:147]
s_nop 0
v_cndmask_b32 v3, v3, v19, vcc
v_mfma_f32_16x16x32_bf16 a[148:151], a[188:191], a[212:215], a[148:151]
v_xor_b32 v4, 64, v3
v_mfma_f32_16x16x32_bf16 a[152:155], a[188:191], a[216:219], a[152:155]
v_mfma_f32_16x16x32_bf16 a[156:159], a[188:191], a[220:223], a[156:159]
s_waitcnt vmcnt(24) lgkmcnt(0)
s_barrier
v_mfma_f32_16x16x32_bf16 v[160:163], a[160:163], a[224:227], v[160:163]
ds_read_b64_tr_b16 a[192:193], v5 offset:0
v_mfma_f32_16x16x32_bf16 v[164:167], a[160:163], a[228:231], v[164:167]
v_mfma_f32_16x16x32_bf16 v[168:171], a[160:163], a[232:235], v[168:171]
ds_read_b64_tr_b16 a[194:195], v5 offset:1024
v_mfma_f32_16x16x32_bf16 v[172:175], a[160:163], a[236:239], v[172:175]
s_add_u32 s37, s31, 0
v_mfma_f32_16x16x32_bf16 v[176:179], a[160:163], a[240:243], v[176:179]
s_add_u32 m0, s33, 0
ds_read_b64_tr_b16 a[196:197], v6 offset:0
v_mfma_f32_16x16x32_bf16 v[180:183], a[160:163], a[244:247], v[180:183]
buffer_load_dwordx4 v2, s[20:23], s37 offen  lds
v_mfma_f32_16x16x32_bf16 v[184:187], a[160:163], a[248:251], v[184:187]
ds_read_b64_tr_b16 a[198:199], v6 offset:1024
v_mfma_f32_16x16x32_bf16 v[188:191], a[160:163], a[252:255], v[188:191]
ds_read_b128 a[160:163], v3 offset:0
v_mfma_f32_16x16x32_bf16 v[192:195], a[164:167], a[224:227], v[192:195]
ds_read_b64_tr_b16 a[200:201], v7 offset:0
v_mfma_f32_16x16x32_bf16 v[196:199], a[164:167], a[228:231], v[196:199]
v_mfma_f32_16x16x32_bf16 v[200:203], a[164:167], a[232:235], v[200:203]
s_add_u32 s37, s31, 32768
ds_read_b64_tr_b16 a[202:203], v7 offset:1024
v_mfma_f32_16x16x32_bf16 v[204:207], a[164:167], a[236:239], v[204:207]
s_add_u32 m0, s33, 1024
v_mfma_f32_16x16x32_bf16 v[208:211], a[164:167], a[240:243], v[208:211]
buffer_load_dwordx4 v2, s[20:23], s37 offen  lds
v_mfma_f32_16x16x32_bf16 v[212:215], a[164:167], a[244:247], v[212:215]
ds_read_b64_tr_b16 a[204:205], v8 offset:0
v_mfma_f32_16x16x32_bf16 v[216:219], a[164:167], a[248:251], v[216:219]
s_add_u32 s29, s29, s93
v_mfma_f32_16x16x32_bf16 v[220:223], a[164:167], a[252:255], v[220:223]
ds_read_b128 a[164:167], v4 offset:1024
v_mfma_f32_16x16x32_bf16 v[224:227], a[168:171], a[224:227], v[224:227]
buffer_store_dwordx4 v[120:123], v13, s[8:11], s29 offen sc1
v_mfma_f32_16x16x32_bf16 v[228:231], a[168:171], a[228:231], v[228:231]
s_add_u32 s37, s31, 131072
ds_read_b64_tr_b16 a[206:207], v8 offset:1024
v_mfma_f32_16x16x32_bf16 v[232:235], a[168:171], a[232:235], v[232:235]
s_add_u32 m0, s33, 4096
v_mfma_f32_16x16x32_bf16 v[236:239], a[168:171], a[236:239], v[236:239]
buffer_load_dwordx4 v2, s[20:23], s37 offen  lds
v_mfma_f32_16x16x32_bf16 v[240:243], a[168:171], a[240:243], v[240:243]
ds_read_b64_tr_b16 a[208:209], v9 offset:0
v_mfma_f32_16x16x32_bf16 v[244:247], a[168:171], a[244:247], v[244:247]
v_mfma_f32_16x16x32_bf16 v[248:251], a[168:171], a[248:251], v[248:251]
ds_read_b64_tr_b16 a[210:211], v9 offset:1024
v_mfma_f32_16x16x32_bf16 v[252:255], a[168:171], a[252:255], v[252:255]
ds_read_b128 a[168:171], v3 offset:4096
v_mfma_f32_16x16x32_bf16 a[0:3], a[172:175], a[224:227], a[0:3]
s_add_u32 s37, s31, 163840
ds_read_b64_tr_b16 a[212:213], v10 offset:0
v_mfma_f32_16x16x32_bf16 a[4:7], a[172:175], a[228:231], a[4:7]
s_add_u32 m0, s33, 5120
v_mfma_f32_16x16x32_bf16 a[8:11], a[172:175], a[232:235], a[8:11]
buffer_load_dwordx4 v2, s[20:23], s37 offen  lds
v_mfma_f32_16x16x32_bf16 a[12:15], a[172:175], a[236:239], a[12:15]
s_add_u32 s31, s31, 262144
ds_read_b64_tr_b16 a[214:215], v10 offset:1024
v_mfma_f32_16x16x32_bf16 a[16:19], a[172:175], a[240:243], a[16:19]
s_add_u32 s33, s33, 16384
v_mfma_f32_16x16x32_bf16 a[20:23], a[172:175], a[244:247], a[20:23]
s_and_b32 s33, s33, 65535
ds_read_b64_tr_b16 a[216:217], v11 offset:0
v_mfma_f32_16x16x32_bf16 a[24:27], a[172:175], a[248:251], a[24:27]
v_mfma_f32_16x16x32_bf16 a[28:31], a[172:175], a[252:255], a[28:31]
s_mov_b32 s48, s30
ds_read_b128 a[172:175], v4 offset:5120
v_mfma_f32_16x16x32_bf16 a[32:35], a[176:179], a[224:227], a[32:35]
s_add_u32 m0, s32, 0
ds_read_b64_tr_b16 a[218:219], v11 offset:1024
v_mfma_f32_16x16x32_bf16 a[36:39], a[176:179], a[228:231], a[36:39]
buffer_load_dwordx4 v1, s[12:15], s48 offen lds
v_mfma_f32_16x16x32_bf16 a[40:43], a[176:179], a[232:235], a[40:43]
ds_read_b64_tr_b16 a[220:221], v12 offset:0
v_mfma_f32_16x16x32_bf16 a[44:47], a[176:179], a[236:239], a[44:47]
s_add_u32 s29, s29, s44
v_mfma_f32_16x16x32_bf16 a[48:51], a[176:179], a[240:243], a[48:51]
ds_read_b64_tr_b16 a[222:223], v12 offset:1024
v_mfma_f32_16x16x32_bf16 a[52:55], a[176:179], a[244:247], a[52:55]
buffer_store_dwordx4 v[124:127], v13, s[8:11], s29 offen sc1
v_mfma_f32_16x16x32_bf16 a[56:59], a[176:179], a[248:251], a[56:59]
s_add_u32 s48, s48, s34
ds_read_b128 a[188:191], v4 offset:13312
v_mfma_f32_16x16x32_bf16 a[60:63], a[176:179], a[252:255], a[60:63]
s_add_u32 m0, s32, 4096
ds_read_b128 a[176:179], v3 offset:8192
v_mfma_f32_16x16x32_bf16 a[64:67], a[180:183], a[224:227], a[64:67]
buffer_load_dwordx4 v1, s[12:15], s48 offen lds
v_mfma_f32_16x16x32_bf16 a[68:71], a[180:183], a[228:231], a[68:71]
v_add_u32 v5, 16384, v5
v_and_b32 v5, 65535, v5
v_mfma_f32_16x16x32_bf16 a[72:75], a[180:183], a[232:235], a[72:75]
v_xor_b32 v6, 16, v5
v_xor_b32 v7, 64, v5
v_mfma_f32_16x16x32_bf16 a[76:79], a[180:183], a[236:239], a[76:79]
v_xor_b32 v8, 80, v5
v_xor_b32 v9, 128, v5
v_mfma_f32_16x16x32_bf16 a[80:83], a[180:183], a[240:243], a[80:83]
v_xor_b32 v10, 144, v5
v_xor_b32 v11, 192, v5
v_mfma_f32_16x16x32_bf16 a[84:87], a[180:183], a[244:247], a[84:87]
s_add_u32 s48, s48, s34
v_xor_b32 v12, 208, v5
v_mfma_f32_16x16x32_bf16 a[88:91], a[180:183], a[248:251], a[88:91]
s_add_u32 m0, s32, 8192
v_mfma_f32_16x16x32_bf16 a[92:95], a[180:183], a[252:255], a[92:95]
buffer_load_dwordx4 v1, s[12:15], s48 offen lds
ds_read_b128 a[180:183], v4 offset:9216
v_mfma_f32_16x16x32_bf16 a[96:99], a[184:187], a[224:227], a[96:99]
v_mfma_f32_16x16x32_bf16 a[100:103], a[184:187], a[228:231], a[100:103]
v_mfma_f32_16x16x32_bf16 a[104:107], a[184:187], a[232:235], a[104:107]
v_mfma_f32_16x16x32_bf16 a[108:111], a[184:187], a[236:239], a[108:111]
v_mfma_f32_16x16x32_bf16 a[112:115], a[184:187], a[240:243], a[112:115]
s_add_u32 s48, s48, s34
v_mfma_f32_16x16x32_bf16 a[116:119], a[184:187], a[244:247], a[116:119]
s_add_u32 m0, s32, 12288
v_mfma_f32_16x16x32_bf16 a[120:123], a[184:187], a[248:251], a[120:123]
buffer_load_dwordx4 v1, s[12:15], s48 offen lds
v_mfma_f32_16x16x32_bf16 a[124:127], a[184:187], a[252:255], a[124:127]
ds_read_b128 a[184:187], v3 offset:12288
v_mfma_f32_16x16x32_bf16 a[128:131], v[28:31], a[224:227], a[128:131]
v_mfma_f32_16x16x32_bf16 a[132:135], v[28:31], a[228:231], a[132:135]
v_mfma_f32_16x16x32_bf16 a[136:139], v[28:31], a[232:235], a[136:139]
buffer_load_dword v15, v14, s[96:99], s100 offen
v_mfma_f32_16x16x32_bf16 a[140:143], v[28:31], a[236:239], a[140:143]
s_add_u32 s100, s100, 16384
v_mfma_f32_16x16x32_bf16 a[144:147], v[28:31], a[240:243], a[144:147]
v_mfma_f32_16x16x32_bf16 a[148:151], v[28:31], a[244:247], a[148:151]
v_mfma_f32_16x16x32_bf16 a[152:155], v[28:31], a[248:251], a[152:155]
v_mfma_f32_16x16x32_bf16 a[156:159], v[28:31], a[252:255], a[156:159]
s_cmp_eq_u32 s36, 0
s_cbranch_scc1 L_g_v12
s_waitcnt vmcnt(23) lgkmcnt(0)
s_barrier
v_mfma_f32_16x16x32_bf16 v[160:163], a[160:163], a[192:195], v[160:163]
ds_read_b64_tr_b16 a[224:225], v5 offset:0
v_mfma_f32_16x16x32_bf16 v[164:167], a[160:163], a[196:199], v[164:167]
v_mfma_f32_16x16x32_bf16 v[168:171], a[160:163], a[200:203], v[168:171]
ds_read_b64_tr_b16 a[226:227], v5 offset:1024
v_mfma_f32_16x16x32_bf16 v[172:175], a[160:163], a[204:207], v[172:175]
s_add_u32 s37, s31, 0
v_mfma_f32_16x16x32_bf16 v[176:179], a[160:163], a[208:211], v[176:179]
s_add_u32 m0, s33, 0
ds_read_b64_tr_b16 a[228:229], v6 offset:0
v_mfma_f32_16x16x32_bf16 v[180:183], a[160:163], a[212:215], v[180:183]
buffer_load_dwordx4 v2, s[20:23], s37 offen  lds
v_mfma_f32_16x16x32_bf16 v[184:187], a[160:163], a[216:219], v[184:187]
ds_read_b64_tr_b16 a[230:231], v6 offset:1024
v_mfma_f32_16x16x32_bf16 v[188:191], a[160:163], a[220:223], v[188:191]
ds_read_b128 a[160:163], v4 offset:0
v_mfma_f32_16x16x32_bf16 v[192:195], a[164:167], a[192:195], v[192:195]
ds_read_b64_tr_b16 a[232:233], v7 offset:0
v_mfma_f32_16x16x32_bf16 v[196:199], a[164:167], a[196:199], v[196:199]
v_mfma_f32_16x16x32_bf16 v[200:203], a[164:167], a[200:203], v[200:203]
s_add_u32 s37, s31, 32768
ds_read_b64_tr_b16 a[234:235], v7 offset:1024
v_mfma_f32_16x16x32_bf16 v[204:207], a[164:167], a[204:207], v[204:207]
s_add_u32 m0, s33, 1024
v_mfma_f32_16x16x32_bf16 v[208:211], a[164:167], a[208:211], v[208:211]
buffer_load_dwordx4 v2, s[20:23], s37 offen  lds
v_mfma_f32_16x16x32_bf16 v[212:215], a[164:167], a[212:215], v[212:215]
ds_read_b64_tr_b16 a[236:237], v8 offset:0
v_mfma_f32_16x16x32_bf16 v[216:219], a[164:167], a[216:219], v[216:219]
v_mfma_f32_16x16x32_bf16 v[220:223], a[164:167], a[220:223], v[220:223]
ds_read_b128 a[164:167], v3 offset:1024
v_mfma_f32_16x16x32_bf16 v[224:227], a[168:171], a[192:195], v[224:227]
ds_read_b64_tr_b16 a[238:239], v8 offset:1024
v_mfma_f32_16x16x32_bf16 v[228:231], a[168:171], a[196:199], v[228:231]
s_add_u32 s37, s31, 131072
v_mfma_f32_16x16x32_bf16 v[232:235], a[168:171], a[200:203], v[232:235]
s_add_u32 m0, s33, 4096
ds_read_b64_tr_b16 a[240:241], v9 offset:0
v_mfma_f32_16x16x32_bf16 v[236:239], a[168:171], a[204:207], v[236:239]
buffer_load_dwordx4 v2, s[20:23], s37 offen  lds
v_mfma_f32_16x16x32_bf16 v[240:243], a[168:171], a[208:211], v[240:243]
ds_read_b64_tr_b16 a[242:243], v9 offset:1024
v_mfma_f32_16x16x32_bf16 v[244:247], a[168:171], a[212:215], v[244:247]
v_mfma_f32_16x16x32_bf16 v[248:251], a[168:171], a[216:219], v[248:251]
ds_read_b64_tr_b16 a[244:245], v10 offset:0
v_mfma_f32_16x16x32_bf16 v[252:255], a[168:171], a[220:223], v[252:255]
ds_read_b128 a[168:171], v4 offset:4096
v_mfma_f32_16x16x32_bf16 a[0:3], a[172:175], a[192:195], a[0:3]
s_add_u32 s37, s31, 163840
ds_read_b64_tr_b16 a[246:247], v10 offset:1024
v_mfma_f32_16x16x32_bf16 a[4:7], a[172:175], a[196:199], a[4:7]
s_add_u32 m0, s33, 5120
v_mfma_f32_16x16x32_bf16 a[8:11], a[172:175], a[200:203], a[8:11]
buffer_load_dwordx4 v2, s[20:23], s37 offen  lds
v_mfma_f32_16x16x32_bf16 a[12:15], a[172:175], a[204:207], a[12:15]
s_add_u32 s31, s31, 262144
ds_read_b64_tr_b16 a[248:249], v11 offset:0
v_mfma_f32_16x16x32_bf16 a[16:19], a[172:175], a[208:211], a[16:19]
s_add_u32 s33, s33, 16384
v_mfma_f32_16x16x32_bf16 a[20:23], a[172:175], a[212:215], a[20:23]
s_and_b32 s33, s33, 65535
ds_read_b64_tr_b16 a[250:251], v11 offset:1024
v_mfma_f32_16x16x32_bf16 a[24:27], a[172:175], a[216:219], a[24:27]
v_mfma_f32_16x16x32_bf16 a[28:31], a[172:175], a[220:223], a[28:31]
s_add_u32 s48, s48, s34
ds_read_b128 a[172:175], v3 offset:5120
v_mfma_f32_16x16x32_bf16 a[32:35], a[176:179], a[192:195], a[32:35]
s_add_u32 m0, s32, 16384
ds_read_b64_tr_b16 a[252:253], v12 offset:0
v_mfma_f32_16x16x32_bf16 a[36:39], a[176:179], a[196:199], a[36:39]
buffer_load_dwordx4 v1, s[12:15], s48 offen lds
v_mfma_f32_16x16x32_bf16 a[40:43], a[176:179], a[200:203], a[40:43]
ds_read_b64_tr_b16 a[254:255], v12 offset:1024
v_mfma_f32_16x16x32_bf16 a[44:47], a[176:179], a[204:207], a[44:47]
v_mfma_f32_16x16x32_bf16 a[48:51], a[176:179], a[208:211], a[48:51]
ds_read_b128 v[28:31], v3 offset:13312
v_mfma_f32_16x16x32_bf16 a[52:55], a[176:179], a[212:215], a[52:55]
v_mfma_f32_16x16x32_bf16 a[56:59], a[176:179], a[216:219], a[56:59]
s_add_u32 s48, s48, s34
v_mfma_f32_16x16x32_bf16 a[60:63], a[176:179], a[220:223], a[60:63]
s_add_u32 m0, s32, 20480
ds_read_b128 a[176:179], v4 offset:8192
v_add_u32 v5, 16384, v5
v_mfma_f32_16x16x32_bf16 a[64:67], a[180:183], a[192:195], a[64:67]
buffer_load_dwordx4 v1, s[12:15], s48 offen lds
v_and_b32 v5, 65535, v5
v_mfma_f32_16x16x32_bf16 a[68:71], a[180:183], a[196:199], a[68:71]
v_xor_b32 v6, 16, v5
v_xor_b32 v7, 64, v5
v_mfma_f32_16x16x32_bf16 a[72:75], a[180:183], a[200:203], a[72:75]
v_xor_b32 v8, 80, v5
v_xor_b32 v9, 128, v5
v_mfma_f32_16x16x32_bf16 a[76:79], a[180:183], a[204:207], a[76:79]
v_xor_b32 v10, 144, v5
v_xor_b32 v11, 192, v5
v_mfma_f32_16x16x32_bf16 a[80:83], a[180:183], a[208:211], a[80:83]
v_xor_b32 v12, 208, v5
v_mfma_f32_16x16x32_bf16 a[84:87], a[180:183], a[212:215], a[84:87]
s_add_u32 s48, s48, s34
v_mfma_f32_16x16x32_bf16 a[88:91], a[180:183], a[216:219], a[88:91]
s_add_u32 m0, s32, 24576
v_mfma_f32_16x16x32_bf16 a[92:95], a[180:183], a[220:223], a[92:95]
buffer_load_dwordx4 v1, s[12:15], s48 offen lds
ds_read_b128 a[180:183], v3 offset:9216
v_mfma_f32_16x16x32_bf16 a[96:99], a[184:187], a[192:195], a[96:99]
v_mfma_f32_16x16x32_bf16 a[100:103], a[184:187], a[196:199], a[100:103]
v_mfma_f32_16x16x32_bf16 a[104:107], a[184:187], a[200:203], a[104:107]
v_mfma_f32_16x16x32_bf16 a[108:111], a[184:187], a[204:207], a[108:111]
v_mfma_f32_16x16x32_bf16 a[112:115], a[184:187], a[208:211], a[112:115]
s_add_u32 s48, s48, s34
v_mfma_f32_16x16x32_bf16 a[116:119], a[184:187], a[212:215], a[116:119]
s_add_u32 m0, s32, 28672
v_mfma_f32_16x16x32_bf16 a[120:123], a[184:187], a[216:219], a[120:123]
buffer_load_dwordx4 v1, s[12:15], s48 offen lds
v_mfma_f32_16x16x32_bf16 a[124:127], a[184:187], a[220:223], a[124:127]
s_add_u32 s30, s30, 128
ds_read_b128 a[184:187], v4 offset:12288
v_mfma_f32_16x16x32_bf16 a[128:131], a[188:191], a[192:195], a[128:131]
s_add_u32 s32, s32, 32768
v_add_u32 v3, 32768, v3
v_mfma_f32_16x16x32_bf16 a[132:135], a[188:191], a[196:199], a[132:135]
s_sub_u32 s48, s32, 98304
v_subrev_u32 v19, 98304, v3
v_mfma_f32_16x16x32_bf16 a[136:139], a[188:191], a[200:203], a[136:139]
s_cmp_ge_u32 s32, 163840
s_cselect_b32 s32, s48, s32
v_mfma_f32_16x16x32_bf16 a[140:143], a[188:191], a[204:207], a[140:143]
v_cmp_le_u32 vcc, 163840, v3
v_mfma_f32_16x16x32_bf16 a[144:147], a[188:191], a[208:211], a[144:147]
s_nop 0
v_cndmask_b32 v3, v3, v19, vcc
v_mfma_f32_16x16x32_bf16 a[148:151], a[188:191], a[212:215], a[148:151]
v_xor_b32 v4, 64, v3
v_mfma_f32_16x16x32_bf16 a[152:155], a[188:191], a[216:219], a[152:155]
v_mfma_f32_16x16x32_bf16 a[156:159], a[188:191], a[220:223], a[156:159]
s_waitcnt vmcnt(19) lgkmcnt(0)
s_barrier
v_mfma_f32_16x16x32_bf16 v[160:163], a[160:163], a[224:227], v[160:163]
ds_read_b64_tr_b16 a[192:193], v5 offset:0
v_mfma_f32_16x16x32_bf16 v[164:167], a[160:163], a[228:231], v[164:167]
v_mfma_f32_16x16x32_bf16 v[168:171], a[160:163], a[232:235], v[168:171]
ds_read_b64_tr_b16 a[194:195], v5 offset:1024
v_mfma_f32_16x16x32_bf16 v[172:175], a[160:163], a[236:239], v[172:175]
s_add_u32 s37, s31, 0
v_mfma_f32_16x16x32_bf16 v[176:179], a[160:163], a[240:243], v[176:179]
s_add_u32 m0, s33, 0
ds_read_b64_tr_b16 a[196:197], v6 offset:0
v_mfma_f32_16x16x32_bf16 v[180:183], a[160:163], a[244:247], v[180:183]
buffer_load_dwordx4 v2, s[20:23], s37 offen  lds
v_mfma_f32_16x16x32_bf16 v[184:187], a[160:163], a[248:251], v[184:187]
ds_read_b64_tr_b16 a[198:199], v6 offset:1024
v_mfma_f32_16x16x32_bf16 v[188:191], a[160:163], a[252:255], v[188:191]
ds_read_b128 a[160:163], v3 offset:0
v_mfma_f32_16x16x32_bf16 v[192:195], a[164:167], a[224:227], v[192:195]
ds_read_b64_tr_b16 a[200:201], v7 offset:0
v_mfma_f32_16x16x32_bf16 v[196:199], a[164:167], a[228:231], v[196:199]
v_mfma_f32_16x16x32_bf16 v[200:203], a[164:167], a[232:235], v[200:203]
s_add_u32 s37, s31, 32768
ds_read_b64_tr_b16 a[202:203], v7 offset:1024
v_mfma_f32_16x16x32_bf16 v[204:207], a[164:167], a[236:239], v[204:207]
s_add_u32 m0, s33, 1024
v_mfma_f32_16x16x32_bf16 v[208:211], a[164:167], a[240:243], v[208:211]
buffer_load_dwordx4 v2, s[20:23], s37 offen  lds
v_mfma_f32_16x16x32_bf16 v[212:215], a[164:167], a[244:247], v[212:215]
ds_read_b64_tr_b16 a[204:205], v8 offset:0
v_mfma_f32_16x16x32_bf16 v[216:219], a[164:167], a[248:251], v[216:219]
v_mfma_f32_16x16x32_bf16 v[220:223], a[164:167], a[252:255], v[220:223]
ds_read_b128 a[164:167], v4 offset:1024
v_mfma_f32_16x16x32_bf16 v[224:227], a[168:171], a[224:227], v[224:227]
ds_read_b64_tr_b16 a[206:207], v8 offset:1024
v_mfma_f32_16x16x32_bf16 v[228:231], a[168:171], a[228:231], v[228:231]
s_add_u32 s37, s31, 131072
v_mfma_f32_16x16x32_bf16 v[232:235], a[168:171], a[232:235], v[232:235]
s_add_u32 m0, s33, 4096
ds_read_b64_tr_b16 a[208:209], v9 offset:0
v_mfma_f32_16x16x32_bf16 v[236:239], a[168:171], a[236:239], v[236:239]
buffer_load_dwordx4 v2, s[20:23], s37 offen  lds
v_mfma_f32_16x16x32_bf16 v[240:243], a[168:171], a[240:243], v[240:243]
ds_read_b64_tr_b16 a[210:211], v9 offset:1024
v_mfma_f32_16x16x32_bf16 v[244:247], a[168:171], a[244:247], v[244:247]
v_mfma_f32_16x16x32_bf16 v[248:251], a[168:171], a[248:251], v[248:251]
ds_read_b64_tr_b16 a[212:213], v10 offset:0
v_mfma_f32_16x16x32_bf16 v[252:255], a[168:171], a[252:255], v[252:255]
ds_read_b128 a[168:171], v3 offset:4096
v_mfma_f32_16x16x32_bf16 a[0:3], a[172:175], a[224:227], a[0:3]
s_add_u32 s37, s31, 163840
ds_read_b64_tr_b16 a[214:215], v10 offset:1024
v_mfma_f32_16x16x32_bf16 a[4:7], a[172:175], a[228:231], a[4:7]
s_add_u32 m0, s33, 5120
v_mfma_f32_16x16x32_bf16 a[8:11], a[172:175], a[232:235], a[8:11]
buffer_load_dwordx4 v2, s[20:23], s37 offen  lds
v_mfma_f32_16x16x32_bf16 a[12:15], a[172:175], a[236:239], a[12:15]
s_add_u32 s31, s31, 262144
ds_read_b64_tr_b16 a[216:217], v11 offset:0
v_mfma_f32_16x16x32_bf16 a[16:19], a[172:175], a[240:243], a[16:19]
s_add_u32 s33, s33, 16384
v_mfma_f32_16x16x32_bf16 a[20:23], a[172:175], a[244:247], a[20:23]
s_and_b32 s33, s33, 65535
ds_read_b64_tr_b16 a[218:219], v11 offset:1024
v_mfma_f32_16x16x32_bf16 a[24:27], a[172:175], a[248:251], a[24:27]
v_mfma_f32_16x16x32_bf16 a[28:31], a[172:175], a[252:255], a[28:31]
s_mov_b32 s48, s30
ds_read_b128 a[172:175], v4 offset:5120
v_mfma_f32_16x16x32_bf16 a[32:35], a[176:179], a[224:227], a[32:35]
s_add_u32 m0, s32, 0
ds_read_b64_tr_b16 a[220:221], v12 offset:0
v_mfma_f32_16x16x32_bf16 a[36:39], a[176:179], a[228:231], a[36:39]
buffer_load_dwordx4 v1, s[12:15], s48 offen lds
v_mfma_f32_16x16x32_bf16 a[40:43], a[176:179], a[232:235], a[40:43]
ds_read_b64_tr_b16 a[222:223], v12 offset:1024
v_mfma_f32_16x16x32_bf16 a[44:47], a[176:179], a[236:239], a[44:47]
v_mfma_f32_16x16x32_bf16 a[48:51], a[176:179], a[240:243], a[48:51]
ds_read_b128 a[188:191], v4 offset:13312
v_mfma_f32_16x16x32_bf16 a[52:55], a[176:179], a[244:247], a[52:55]
v_mfma_f32_16x16x32_bf16 a[56:59], a[176:179], a[248:251], a[56:59]
s_add_u32 s48, s48, s34
v_mfma_f32_16x16x32_bf16 a[60:63], a[176:179], a[252:255], a[60:63]
s_add_u32 m0, s32, 4096
ds_read_b128 a[176:179], v3 offset:8192
v_add_u32 v5, 16384, v5
v_mfma_f32_16x16x32_bf16 a[64:67], a[180:183], a[224:227], a[64:67]
buffer_load_dwordx4 v1, s[12:15], s48 offen lds
v_and_b32 v5, 65535, v5
v_mfma_f32_16x16x32_bf16 a[68:71], a[180:183], a[228:231], a[68:71]
v_xor_b32 v6, 16, v5
v_xor_b32 v7, 64, v5
v_mfma_f32_16x16x32_bf16 a[72:75], a[180:183], a[232:235], a[72:75]
v_xor_b32 v8, 80, v5
v_xor_b32 v9, 128, v5
v_mfma_f32_16x16x32_bf16 a[76:79], a[180:183], a[236:239], a[76:79]
v_xor_b32 v10, 144, v5
v_xor_b32 v11, 192, v5
v_mfma_f32_16x16x32_bf16 a[80:83], a[180:183], a[240:243], a[80:83]
v_xor_b32 v12, 208, v5
v_mfma_f32_16x16x32_bf16 a[84:87], a[180:183], a[244:247], a[84:87]
s_add_u32 s48, s48, s34
v_mfma_f32_16x16x32_bf16 a[88:91], a[180:183], a[248:251], a[88:91]
s_add_u32 m0, s32, 8192
v_mfma_f32_16x16x32_bf16 a[92:95], a[180:183], a[252:255], a[92:95]
buffer_load_dwordx4 v1, s[12:15], s48 offen lds
ds_read_b128 a[180:183], v4 offset:9216
v_mfma_f32_16x16x32_bf16 a[96:99], a[184:187], a[224:227], a[96:99]
v_mfma_f32_16x16x32_bf16 a[100:103], a[184:187], a[228:231], a[100:103]
v_mfma_f32_16x16x32_bf16 a[104:107], a[184:187], a[232:235], a[104:107]
v_mfma_f32_16x16x32_bf16 a[108:111], a[184:187], a[236:239], a[108:111]
v_mfma_f32_16x16x32_bf16 a[112:115], a[184:187], a[240:243], a[112:115]
s_add_u32 s48, s48, s34
v_mfma_f32_16x16x32_bf16 a[116:119], a[184:187], a[244:247], a[116:119]
s_add_u32 m0, s32, 12288
v_mfma_f32_16x16x32_bf16 a[120:123], a[184:187], a[248:251], a[120:123]
buffer_load_dwordx4 v1, s[12:15], s48 offen lds
v_mfma_f32_16x16x32_bf16 a[124:127], a[184:187], a[252:255], a[124:127]
ds_read_b128 a[184:187], v3 offset:12288
v_mfma_f32_16x16x32_bf16 a[128:131], v[28:31], a[224:227], a[128:131]
v_mfma_f32_16x16x32_bf16 a[132:135], v[28:31], a[228:231], a[132:135]
v_mfma_f32_16x16x32_bf16 a[136:139], v[28:31], a[232:235], a[136:139]
v_mfma_f32_16x16x32_bf16 a[140:143], v[28:31], a[236:239], a[140:143]
v_mfma_f32_16x16x32_bf16 a[144:147], v[28:31], a[240:243], a[144:147]
v_mfma_f32_16x16x32_bf16 a[148:151], v[28:31], a[244:247], a[148:151]
v_mfma_f32_16x16x32_bf16 a[152:155], v[28:31], a[248:251], a[152:155]
v_mfma_f32_16x16x32_bf16 a[156:159], v[28:31], a[252:255], a[156:159]
L_g_v12:
s_waitcnt vmcnt(16) lgkmcnt(0)
s_barrier
v_mfma_f32_16x16x32_bf16 v[160:163], a[160:163], a[192:195], v[160:163]
ds_read_b64_tr_b16 a[224:225], v5 offset:0
s_lshr_b32 s24, s16, 1
v_mfma_f32_16x16x32_bf16 v[164:167], a[160:163], a[196:199], v[164:167]
s_cmp_eq_u32 s35, 5
s_cselect_b32 s90, s24, s90
v_mfma_f32_16x16x32_bf16 v[168:171], a[160:163], a[200:203], v[168:171]
ds_read_b64_tr_b16 a[226:227], v5 offset:1024
s_lshl_b32 s24, s35, 2
v_mfma_f32_16x16x32_bf16 v[172:175], a[160:163], a[204:207], v[172:175]
s_add_u32 s37, s31, 0
s_lshr_b32 s26, s88, s24
s_bfe_u32 s2, s26, 0x10003
v_mfma_f32_16x16x32_bf16 v[176:179], a[160:163], a[208:211], v[176:179]
s_add_u32 m0, s33, 0
ds_read_b64_tr_b16 a[228:229], v6 offset:0
s_and_b32 s26, s26, 7
v_mfma_f32_16x16x32_bf16 v[180:183], a[160:163], a[212:215], v[180:183]
buffer_load_dwordx4 v2, s[20:23], s37 offen  lds
s_or_b32 s40, s2, s61
v_mfma_f32_16x16x32_bf16 v[184:187], a[160:163], a[216:219], v[184:187]
ds_read_b64_tr_b16 a[230:231], v6 offset:1024
s_lshr_b32 s24, s17, 1
v_mfma_f32_16x16x32_bf16 v[188:191], a[160:163], a[220:223], v[188:191]
ds_read_b128 a[160:163], v4 offset:0
v_mfma_f32_16x16x32_bf16 v[192:195], a[164:167], a[192:195], v[192:195]
ds_read_b64_tr_b16 a[232:233], v7 offset:0
v_mfma_f32_16x16x32_bf16 v[196:199], a[164:167], a[196:199], v[196:199]
s_cmp_eq_u32 s2, 0
s_cselect_b32 s41, s24, 0
s_cselect_b32 s27, s89, s90
v_mfma_f32_16x16x32_bf16 v[200:203], a[164:167], a[200:203], v[200:203]
s_add_u32 s37, s31, 32768
ds_read_b64_tr_b16 a[234:235], v7 offset:1024
s_sub_u32 s25, s24, s41
v_mfma_f32_16x16x32_bf16 v[204:207], a[164:167], a[204:207], v[204:207]
s_add_u32 m0, s33, 1024
s_and_b32 s51, s41, s61
s_lshl_b32 s51, s51, 1
v_mfma_f32_16x16x32_bf16 v[208:211], a[164:167], a[208:211], v[208:211]
buffer_load_dwordx4 v2, s[20:23], s37 offen  lds
s_or_b32 s51, s51, s41
v_mfma_f32_16x16x32_bf16 v[212:215], a[164:167], a[212:215], v[212:215]
ds_read_b64_tr_b16 a[236:237], v8 offset:0
s_lshl2_add_u32 s51, s2, s51
v_mfma_f32_16x16x32_bf16 v[216:219], a[164:167], a[216:219], v[216:219]
s_add_u32 s60, s60, s92
s_lshl_b32 s46, s27, s2
s_add_u32 s46, s46, s25
v_mfma_f32_16x16x32_bf16 v[220:223], a[164:167], a[220:223], v[220:223]
s_mov_b32 s29, s60
ds_read_b128 a[164:167], v3 offset:1024
s_lshl_b32 s46, s46, 8
v_mfma_f32_16x16x32_bf16 v[224:227], a[168:171], a[192:195], v[224:227]
buffer_store_dwordx4 v[128:131], v13, s[8:11], s29 offen sc1
s_lshl_b32 s47, s40, 7
v_mfma_f32_16x16x32_bf16 v[228:231], a[168:171], a[196:199], v[228:231]
s_add_u32 s37, s31, 131072
ds_read_b64_tr_b16 a[238:239], v8 offset:1024
s_add_u32 s47, s47, 1024
v_mfma_f32_16x16x32_bf16 v[232:235], a[168:171], a[200:203], v[232:235]
s_add_u32 m0, s33, 4096
s_mul_i32 s101, s26, s47
s_lshl_b32 s101, s101, 8
v_mfma_f32_16x16x32_bf16 v[236:239], a[168:171], a[204:207], v[236:239]
buffer_load_dwordx4 v2, s[20:23], s37 offen  lds
s_and_b32 s25, s17, 1
v_mfma_f32_16x16x32_bf16 v[240:243], a[168:171], a[208:211], v[240:243]
ds_read_b64_tr_b16 a[240:241], v9 offset:0
s_lshl1_add_u32 s42, s26, s25
v_mfma_f32_16x16x32_bf16 v[244:247], a[168:171], a[212:215], v[244:247]
s_lshl_b32 s42, s42, 7
s_lshr_b32 s42, s42, s2
s_add_u32 s42, s42, s27
v_mfma_f32_16x16x32_bf16 v[248:251], a[168:171], a[216:219], v[248:251]
ds_read_b64_tr_b16 a[242:243], v9 offset:1024
s_lshl1_add_u32 s42, s42, s24
v_mfma_f32_16x16x32_bf16 v[252:255], a[168:171], a[220:223], v[252:255]
ds_read_b128 a[168:171], v4 offset:4096
s_lshl_b32 s42, s42, 13
v_mfma_f32_16x16x32_bf16 a[0:3], a[172:175], a[192:195], a[0:3]
s_add_u32 s37, s31, 163840
ds_read_b64_tr_b16 a[244:245], v10 offset:0
s_lshl_b32 s43, s27, 5
v_mfma_f32_16x16x32_bf16 a[4:7], a[172:175], a[196:199], a[4:7]
s_add_u32 m0, s33, 5120
s_add_u32 s43, s43, s26
s_lshl_b32 s43, s43, 2
v_mfma_f32_16x16x32_bf16 a[8:11], a[172:175], a[200:203], a[8:11]
buffer_load_dwordx4 v2, s[20:23], s37 offen  lds
s_lshl_b32 s24, s2, 1
v_mfma_f32_16x16x32_bf16 a[12:15], a[172:175], a[204:207], a[12:15]
s_add_u32 s31, s31, 262144
ds_read_b64_tr_b16 a[246:247], v10 offset:1024
s_add_u32 s24, s24, s61
v_mfma_f32_16x16x32_bf16 a[16:19], a[172:175], a[208:211], a[16:19]
s_add_u32 s33, s33, 16384
s_lshl_b32 s24, s24, 2
s_lshr_b32 s25, 0x8720, s24
v_mfma_f32_16x16x32_bf16 a[20:23], a[172:175], a[212:215], a[20:23]
s_and_b32 s33, s33, 65535
ds_read_b64_tr_b16 a[248:249], v11 offset:0
s_and_b32 s25, s25, 15
v_mfma_f32_16x16x32_bf16 a[24:27], a[172:175], a[216:219], a[24:27]
s_lshl_b32 s25, s25, 24
s_add_u32 s42, s42, s25
s_lshr_b32 s25, 0x7604, s24
v_mfma_f32_16x16x32_bf16 a[28:31], a[172:175], a[220:223], a[28:31]
s_add_u32 s48, s48, s34
ds_read_b128 a[172:175], v3 offset:5120
s_and_b32 s25, s25, 15
v_mfma_f32_16x16x32_bf16 a[32:35], a[176:179], a[192:195], a[32:35]
s_add_u32 m0, s32, 16384
ds_read_b64_tr_b16 a[250:251], v11 offset:1024
s_lshl_b32 s25, s25, 12
v_mfma_f32_16x16x32_bf16 a[36:39], a[176:179], a[196:199], a[36:39]
buffer_load_dwordx4 v1, s[12:15], s48 offen lds
s_add_u32 s43, s43, s25
v_mfma_f32_16x16x32_bf16 a[40:43], a[176:179], a[200:203], a[40:43]
ds_read_b64_tr_b16 a[252:253], v12 offset:0
s_add_u32 s43, s43, 111149056
v_mfma_f32_16x16x32_bf16 a[44:47], a[176:179], a[204:207], a[44:47]
s_add_u32 s29, s29, s44
v_mfma_f32_16x16x32_bf16 a[48:51], a[176:179], a[208:211], a[48:51]
ds_read_b64_tr_b16 a[254:255], v12 offset:1024
v_mfma_f32_16x16x32_bf16 a[52:55], a[176:179], a[212:215], a[52:55]
buffer_store_dwordx4 v[132:135], v13, s[8:11], s29 offen sc1
v_mfma_f32_16x16x32_bf16 a[56:59], a[176:179], a[216:219], a[56:59]
s_add_u32 s48, s48, s34
ds_read_b128 v[28:31], v3 offset:13312
v_mfma_f32_16x16x32_bf16 a[60:63], a[176:179], a[220:223], a[60:63]
s_add_u32 m0, s32, 20480
ds_read_b128 a[176:179], v4 offset:8192
v_mfma_f32_16x16x32_bf16 a[64:67], a[180:183], a[192:195], a[64:67]
buffer_load_dwordx4 v1, s[12:15], s48 offen lds
v_mfma_f32_16x16x32_bf16 a[68:71], a[180:183], a[196:199], a[68:71]
s_cmp_lt_u32 s35, s45
s_cselect_b32 s101, s101, 536870912
s_cselect_b32 s46, s46, 536870912
v_mfma_f32_16x16x32_bf16 a[72:75], a[180:183], a[200:203], a[72:75]
v_add_u32 v5, 16384, v5
v_and_b32 v5, 65535, v5
v_mfma_f32_16x16x32_bf16 a[76:79], a[180:183], a[204:207], a[76:79]
v_xor_b32 v6, 16, v5
v_xor_b32 v7, 64, v5
v_mfma_f32_16x16x32_bf16 a[80:83], a[180:183], a[208:211], a[80:83]
v_xor_b32 v8, 80, v5
v_xor_b32 v9, 128, v5
v_mfma_f32_16x16x32_bf16 a[84:87], a[180:183], a[212:215], a[84:87]
s_add_u32 s48, s48, s34
v_xor_b32 v10, 144, v5
v_xor_b32 v11, 192, v5
v_mfma_f32_16x16x32_bf16 a[88:91], a[180:183], a[216:219], a[88:91]
s_add_u32 m0, s32, 24576
v_xor_b32 v12, 208, v5
v_mfma_f32_16x16x32_bf16 a[92:95], a[180:183], a[220:223], a[92:95]
buffer_load_dwordx4 v1, s[12:15], s48 offen lds
ds_read_b128 a[180:183], v3 offset:9216
v_mfma_f32_16x16x32_bf16 a[96:99], a[184:187], a[192:195], a[96:99]
v_mfma_f32_16x16x32_bf16 a[100:103], a[184:187], a[196:199], a[100:103]
v_mfma_f32_16x16x32_bf16 a[104:107], a[184:187], a[200:203], a[104:107]
v_mfma_f32_16x16x32_bf16 a[108:111], a[184:187], a[204:207], a[108:111]
v_mfma_f32_16x16x32_bf16 a[112:115], a[184:187], a[208:211], a[112:115]
s_add_u32 s48, s48, s34
v_mfma_f32_16x16x32_bf16 a[116:119], a[184:187], a[212:215], a[116:119]
s_add_u32 m0, s32, 28672
v_mfma_f32_16x16x32_bf16 a[120:123], a[184:187], a[216:219], a[120:123]
buffer_load_dwordx4 v1, s[12:15], s48 offen lds
v_mfma_f32_16x16x32_bf16 a[124:127], a[184:187], a[220:223], a[124:127]
s_add_u32 s30, s30, 128
ds_read_b128 a[184:187], v4 offset:12288
v_mfma_f32_16x16x32_bf16 a[128:131], a[188:191], a[192:195], a[128:131]
s_add_u32 s32, s32, 32768
s_add_u32 s29, s29, s93
v_add_u32 v3, 32768, v3
v_mfma_f32_16x16x32_bf16 a[132:135], a[188:191], a[196:199], a[132:135]
s_sub_u32 s48, s32, 98304
v_subrev_u32 v19, 98304, v3
v_mfma_f32_16x16x32_bf16 a[136:139], a[188:191], a[200:203], a[136:139]
s_cmp_ge_u32 s32, 163840
s_cselect_b32 s32, s48, s32
buffer_store_dwordx4 v[136:139], v13, s[8:11], s29 offen sc1
buffer_load_dword v15, v14, s[96:99], s100 offen
v_mfma_f32_16x16x32_bf16 a[140:143], a[188:191], a[204:207], a[140:143]
s_add_u32 s100, s100, 16384
v_cmp_le_u32 vcc, 163840, v3
v_mfma_f32_16x16x32_bf16 a[144:147], a[188:191], a[208:211], a[144:147]
s_nop 0
v_cndmask_b32 v3, v3, v19, vcc
v_mfma_f32_16x16x32_bf16 a[148:151], a[188:191], a[212:215], a[148:151]
v_xor_b32 v4, 64, v3
v_mfma_f32_16x16x32_bf16 a[152:155], a[188:191], a[216:219], a[152:155]
v_mfma_f32_16x16x32_bf16 a[156:159], a[188:191], a[220:223], a[156:159]
s_waitcnt vmcnt(20) lgkmcnt(0)
s_barrier
v_mfma_f32_16x16x32_bf16 v[160:163], a[160:163], a[224:227], v[160:163]
ds_read_b64_tr_b16 a[192:193], v5 offset:0
v_mfma_f32_16x16x32_bf16 v[164:167], a[160:163], a[228:231], v[164:167]
s_cmp_eq_u32 s2, 0
s_cselect_b64 s[4:5], s[52:53], s[54:55]
v_mfma_f32_16x16x32_bf16 v[168:171], a[160:163], a[232:235], v[168:171]
ds_read_b64_tr_b16 a[194:195], v5 offset:1024
s_mov_b32 s12, s4
v_mfma_f32_16x16x32_bf16 v[172:175], a[160:163], a[236:239], v[172:175]
s_add_u32 s37, s31, 0
s_and_b32 s13, s5, 0xffff
s_lshl_b32 s14, s47, 11
v_mfma_f32_16x16x32_bf16 v[176:179], a[160:163], a[240:243], v[176:179]
s_add_u32 m0, s33, 0
ds_read_b64_tr_b16 a[196:197], v6 offset:0
s_mov_b32 s15, 0x20000
v_mfma_f32_16x16x32_bf16 v[180:183], a[160:163], a[244:247], v[180:183]
buffer_load_dwordx4 v2, s[20:23], s37 offen  lds
s_mov_b32 s30, s101
v_mfma_f32_16x16x32_bf16 v[184:187], a[160:163], a[248:251], v[184:187]
ds_read_b64_tr_b16 a[198:199], v6 offset:1024
v_lshrrev_b32 v16, 3, v0
v_mfma_f32_16x16x32_bf16 v[188:191], a[160:163], a[252:255], v[188:191]
ds_read_b128 a[160:163], v3 offset:0
v_mul_lo_u32 v16, v16, s47
v_mfma_f32_16x16x32_bf16 v[192:195], a[164:167], a[224:227], v[192:195]
ds_read_b64_tr_b16 a[200:201], v7 offset:0
v_and_b32 v1, 0x70, v1
v_mfma_f32_16x16x32_bf16 v[196:199], a[164:167], a[228:231], v[196:199]
v_add_u32 v1, v1, v16
s_lshl_b32 s34, s47, 5
v_mfma_f32_16x16x32_bf16 v[200:203], a[164:167], a[232:235], v[200:203]
s_add_u32 s37, s31, 32768
ds_read_b64_tr_b16 a[202:203], v7 offset:1024
v_mfma_f32_16x16x32_bf16 v[204:207], a[164:167], a[236:239], v[204:207]
s_add_u32 m0, s33, 1024
v_mfma_f32_16x16x32_bf16 v[208:211], a[164:167], a[240:243], v[208:211]
buffer_load_dwordx4 v2, s[20:23], s37 offen  lds
v_mfma_f32_16x16x32_bf16 v[212:215], a[164:167], a[244:247], v[212:215]
ds_read_b64_tr_b16 a[204:205], v8 offset:0
v_mfma_f32_16x16x32_bf16 v[216:219], a[164:167], a[248:251], v[216:219]
s_add_u32 s29, s29, s44
v_mfma_f32_16x16x32_bf16 v[220:223], a[164:167], a[252:255], v[220:223]
ds_read_b128 a[164:167], v4 offset:1024
v_mfma_f32_16x16x32_bf16 v[224:227], a[168:171], a[224:227], v[224:227]
buffer_store_dwordx4 v[140:143], v13, s[8:11], s29 offen sc1
v_mfma_f32_16x16x32_bf16 v[228:231], a[168:171], a[228:231], v[228:231]
s_add_u32 s37, s31, 131072
ds_read_b64_tr_b16 a[206:207], v8 offset:1024
v_mfma_f32_16x16x32_bf16 v[232:235], a[168:171], a[232:235], v[232:235]
s_add_u32 m0, s33, 4096
v_mfma_f32_16x16x32_bf16 v[236:239], a[168:171], a[236:239], v[236:239]
buffer_load_dwordx4 v2, s[20:23], s37 offen  lds
v_mfma_f32_16x16x32_bf16 v[240:243], a[168:171], a[240:243], v[240:243]
ds_read_b64_tr_b16 a[208:209], v9 offset:0
v_mfma_f32_16x16x32_bf16 v[244:247], a[168:171], a[244:247], v[244:247]
v_mfma_f32_16x16x32_bf16 v[248:251], a[168:171], a[248:251], v[248:251]
ds_read_b64_tr_b16 a[210:211], v9 offset:1024
v_mfma_f32_16x16x32_bf16 v[252:255], a[168:171], a[252:255], v[252:255]
ds_read_b128 a[168:171], v3 offset:4096
v_mfma_f32_16x16x32_bf16 a[0:3], a[172:175], a[224:227], a[0:3]
s_add_u32 s37, s31, 163840
ds_read_b64_tr_b16 a[212:213], v10 offset:0
v_mfma_f32_16x16x32_bf16 a[4:7], a[172:175], a[228:231], a[4:7]
s_add_u32 m0, s33, 5120
v_mfma_f32_16x16x32_bf16 a[8:11], a[172:175], a[232:235], a[8:11]
buffer_load_dwordx4 v2, s[20:23], s37 offen  lds
v_mfma_f32_16x16x32_bf16 a[12:15], a[172:175], a[236:239], a[12:15]
s_add_u32 s31, s31, 262144
ds_read_b64_tr_b16 a[214:215], v10 offset:1024
v_mfma_f32_16x16x32_bf16 a[16:19], a[172:175], a[240:243], a[16:19]
s_add_u32 s33, s33, 16384
v_mfma_f32_16x16x32_bf16 a[20:23], a[172:175], a[244:247], a[20:23]
s_and_b32 s33, s33, 65535
ds_read_b64_tr_b16 a[216:217], v11 offset:0
v_mfma_f32_16x16x32_bf16 a[24:27], a[172:175], a[248:251], a[24:27]
v_mfma_f32_16x16x32_bf16 a[28:31], a[172:175], a[252:255], a[28:31]
s_mov_b32 s48, s30
ds_read_b128 a[172:175], v4 offset:5120
v_mfma_f32_16x16x32_bf16 a[32:35], a[176:179], a[224:227], a[32:35]
s_add_u32 m0, s32, 0
ds_read_b64_tr_b16 a[218:219], v11 offset:1024
v_mfma_f32_16x16x32_bf16 a[36:39], a[176:179], a[228:231], a[36:39]
buffer_load_dwordx4 v1, s[12:15], s48 offen lds
v_mfma_f32_16x16x32_bf16 a[40:43], a[176:179], a[232:235], a[40:43]
ds_read_b64_tr_b16 a[220:221], v12 offset:0
v_mfma_f32_16x16x32_bf16 a[44:47], a[176:179], a[236:239], a[44:47]
s_add_u32 s29, s29, s93
v_mfma_f32_16x16x32_bf16 a[48:51], a[176:179], a[240:243], a[48:51]
ds_read_b64_tr_b16 a[222:223], v12 offset:1024
v_mfma_f32_16x16x32_bf16 a[52:55], a[176:179], a[244:247], a[52:55]
buffer_store_dwordx4 v[144:147], v13, s[8:11], s29 offen sc1
v_mfma_f32_16x16x32_bf16 a[56:59], a[176:179], a[248:251], a[56:59]
s_add_u32 s48, s48, s34
ds_read_b128 a[188:191], v4 offset:13312
v_mfma_f32_16x16x32_bf16 a[60:63], a[176:179], a[252:255], a[60:63]
s_add_u32 m0, s32, 4096
ds_read_b128 a[176:179], v3 offset:8192
v_mfma_f32_16x16x32_bf16 a[64:67], a[180:183], a[224:227], a[64:67]
buffer_load_dwordx4 v1, s[12:15], s48 offen lds
v_mfma_f32_16x16x32_bf16 a[68:71], a[180:183], a[228:231], a[68:71]
v_add_u32 v5, 16384, v5
v_and_b32 v5, 65535, v5
v_mfma_f32_16x16x32_bf16 a[72:75], a[180:183], a[232:235], a[72:75]
v_xor_b32 v6, 16, v5
v_xor_b32 v7, 64, v5
v_mfma_f32_16x16x32_bf16 a[76:79], a[180:183], a[236:239], a[76:79]
v_xor_b32 v8, 80, v5
v_xor_b32 v9, 128, v5
v_mfma_f32_16x16x32_bf16 a[80:83], a[180:183], a[240:243], a[80:83]
s_cmp_eq_u32 s2, 0
s_cselect_b64 s[4:5], s[6:7], s[18:19]
v_mfma_f32_16x16x32_bf16 a[84:87], a[180:183], a[244:247], a[84:87]
s_add_u32 s48, s48, s34
s_mov_b32 s20, s4
s_and_b32 s21, s5, 0xffff
v_mfma_f32_16x16x32_bf16 a[88:91], a[180:183], a[248:251], a[88:91]
s_add_u32 m0, s32, 8192
s_lshl_b32 s22, s47, 12
s_mov_b32 s23, 0x20000
v_mfma_f32_16x16x32_bf16 a[92:95], a[180:183], a[252:255], a[92:95]
buffer_load_dwordx4 v1, s[12:15], s48 offen lds
ds_read_b128 a[180:183], v4 offset:9216
v_mfma_f32_16x16x32_bf16 a[96:99], a[184:187], a[224:227], a[96:99]
s_mov_b32 s31, s46
v_xor_b32 v10, 144, v5
v_xor_b32 v11, 192, v5
v_mfma_f32_16x16x32_bf16 a[100:103], a[184:187], a[228:231], a[100:103]
v_xor_b32 v12, 208, v5
v_mfma_f32_16x16x32_bf16 a[104:107], a[184:187], a[232:235], a[104:107]
v_mfma_f32_16x16x32_bf16 a[108:111], a[184:187], a[236:239], a[108:111]
v_mfma_f32_16x16x32_bf16 a[112:115], a[184:187], a[240:243], a[112:115]
s_add_u32 s48, s48, s34
v_mfma_f32_16x16x32_bf16 a[116:119], a[184:187], a[244:247], a[116:119]
s_add_u32 m0, s32, 12288
v_mfma_f32_16x16x32_bf16 a[120:123], a[184:187], a[248:251], a[120:123]
buffer_load_dwordx4 v1, s[12:15], s48 offen lds
v_mfma_f32_16x16x32_bf16 a[124:127], a[184:187], a[252:255], a[124:127]
ds_read_b128 a[184:187], v3 offset:12288
v_mfma_f32_16x16x32_bf16 a[128:131], v[28:31], a[224:227], a[128:131]
s_add_u32 s29, s29, s44
v_mfma_f32_16x16x32_bf16 a[132:135], v[28:31], a[228:231], a[132:135]
v_mfma_f32_16x16x32_bf16 a[136:139], v[28:31], a[232:235], a[136:139]
buffer_store_dwordx4 v[148:151], v13, s[8:11], s29 offen sc1
buffer_load_dword v15, v14, s[96:99], s100 offen
v_mfma_f32_16x16x32_bf16 a[140:143], v[28:31], a[236:239], a[140:143]
s_add_u32 s100, s100, 16384
v_mfma_f32_16x16x32_bf16 a[144:147], v[28:31], a[240:243], a[144:147]
v_mfma_f32_16x16x32_bf16 a[148:151], v[28:31], a[244:247], a[148:151]
v_mfma_f32_16x16x32_bf16 a[152:155], v[28:31], a[248:251], a[152:155]
v_mfma_f32_16x16x32_bf16 a[156:159], v[28:31], a[252:255], a[156:159]
s_waitcnt vmcnt(24) lgkmcnt(0)
s_barrier
v_mfma_f32_16x16x32_bf16 v[160:163], a[160:163], a[192:195], v[160:163]
ds_read_b64_tr_b16 a[224:225], v5 offset:0
v_mfma_f32_16x16x32_bf16 v[164:167], a[160:163], a[196:199], v[164:167]
v_mfma_f32_16x16x32_bf16 v[168:171], a[160:163], a[200:203], v[168:171]
ds_read_b64_tr_b16 a[226:227], v5 offset:1024
v_mfma_f32_16x16x32_bf16 v[172:175], a[160:163], a[204:207], v[172:175]
s_add_u32 s37, s31, 0
v_mfma_f32_16x16x32_bf16 v[176:179], a[160:163], a[208:211], v[176:179]
s_add_u32 m0, s33, 0
ds_read_b64_tr_b16 a[228:229], v6 offset:0
v_mfma_f32_16x16x32_bf16 v[180:183], a[160:163], a[212:215], v[180:183]
buffer_load_dwordx4 v2, s[20:23], s37 offen  lds
v_mfma_f32_16x16x32_bf16 v[184:187], a[160:163], a[216:219], v[184:187]
ds_read_b64_tr_b16 a[230:231], v6 offset:1024
v_mfma_f32_16x16x32_bf16 v[188:191], a[160:163], a[220:223], v[188:191]
ds_read_b128 a[160:163], v4 offset:0
v_mfma_f32_16x16x32_bf16 v[192:195], a[164:167], a[192:195], v[192:195]
ds_read_b64_tr_b16 a[232:233], v7 offset:0
v_mfma_f32_16x16x32_bf16 v[196:199], a[164:167], a[196:199], v[196:199]
v_mfma_f32_16x16x32_bf16 v[200:203], a[164:167], a[200:203], v[200:203]
s_add_u32 s37, s31, 32768
ds_read_b64_tr_b16 a[234:235], v7 offset:1024
v_mfma_f32_16x16x32_bf16 v[204:207], a[164:167], a[204:207], v[204:207]
s_add_u32 m0, s33, 1024
v_mfma_f32_16x16x32_bf16 v[208:211], a[164:167], a[208:211], v[208:211]
buffer_load_dwordx4 v2, s[20:23], s37 offen  lds
v_mfma_f32_16x16x32_bf16 v[212:215], a[164:167], a[212:215], v[212:215]
ds_read_b64_tr_b16 a[236:237], v8 offset:0
v_mfma_f32_16x16x32_bf16 v[216:219], a[164:167], a[216:219], v[216:219]
s_add_u32 s29, s29, s93
v_mfma_f32_16x16x32_bf16 v[220:223], a[164:167], a[220:223], v[220:223]
ds_read_b128 a[164:167], v3 offset:1024
v_mfma_f32_16x16x32_bf16 v[224:227], a[168:171], a[192:195], v[224:227]
buffer_store_dwordx4 v[152:155], v13, s[8:11], s29 offen sc1
v_mfma_f32_16x16x32_bf16 v[228:231], a[168:171], a[196:199], v[228:231]
s_add_u32 s37, s31, 131072
ds_read_b64_tr_b16 a[238:239], v8 offset:1024
v_mfma_f32_16x16x32_bf16 v[232:235], a[168:171], a[200:203], v[232:235]
s_add_u32 m0, s33, 4096
v_mfma_f32_16x16x32_bf16 v[236:239], a[168:171], a[204:207], v[236:239]
buffer_load_dwordx4 v2, s[20:23], s37 offen  lds
v_mfma_f32_16x16x32_bf16 v[240:243], a[168:171], a[208:211], v[240:243]
ds_read_b64_tr_b16 a[240:241], v9 offset:0
v_mfma_f32_16x16x32_bf16 v[244:247], a[168:171], a[212:215], v[244:247]
v_mfma_f32_16x16x32_bf16 v[248:251], a[168:171], a[216:219], v[248:251]
ds_read_b64_tr_b16 a[242:243], v9 offset:1024
v_mfma_f32_16x16x32_bf16 v[252:255], a[168:171], a[220:223], v[252:255]
ds_read_b128 a[168:171], v4 offset:4096
v_mfma_f32_16x16x32_bf16 a[0:3], a[172:175], a[192:195], a[0:3]
s_add_u32 s37, s31, 163840
ds_read_b64_tr_b16 a[244:245], v10 offset:0
v_mfma_f32_16x16x32_bf16 a[4:7], a[172:175], a[196:199], a[4:7]
s_add_u32 m0, s33, 5120
v_mfma_f32_16x16x32_bf16 a[8:11], a[172:175], a[200:203], a[8:11]
buffer_load_dwordx4 v2, s[20:23], s37 offen  lds
v_mfma_f32_16x16x32_bf16 a[12:15], a[172:175], a[204:207], a[12:15]
s_add_u32 s31, s31, 262144
ds_read_b64_tr_b16 a[246:247], v10 offset:1024
v_mfma_f32_16x16x32_bf16 a[16:19], a[172:175], a[208:211], a[16:19]
s_add_u32 s33, s33, 16384
v_mfma_f32_16x16x32_bf16 a[20:23], a[172:175], a[212:215], a[20:23]
s_and_b32 s33, s33, 65535
ds_read_b64_tr_b16 a[248:249], v11 offset:0
v_mfma_f32_16x16x32_bf16 a[24:27], a[172:175], a[216:219], a[24:27]
v_mfma_f32_16x16x32_bf16 a[28:31], a[172:175], a[220:223], a[28:31]
s_add_u32 s48, s48, s34
ds_read_b128 a[172:175], v3 offset:5120
v_mfma_f32_16x16x32_bf16 a[32:35], a[176:179], a[192:195], a[32:35]
s_add_u32 m0, s32, 16384
ds_read_b64_tr_b16 a[250:251], v11 offset:1024
v_mfma_f32_16x16x32_bf16 a[36:39], a[176:179], a[196:199], a[36:39]
buffer_load_dwordx4 v1, s[12:15], s48 offen lds
v_mfma_f32_16x16x32_bf16 a[40:43], a[176:179], a[200:203], a[40:43]
ds_read_b64_tr_b16 a[252:253], v12 offset:0
v_mfma_f32_16x16x32_bf16 a[44:47], a[176:179], a[204:207], a[44:47]
s_add_u32 s29, s29, s44
v_mfma_f32_16x16x32_bf16 a[48:51], a[176:179], a[208:211], a[48:51]
ds_read_b64_tr_b16 a[254:255], v12 offset:1024
v_mfma_f32_16x16x32_bf16 a[52:55], a[176:179], a[212:215], a[52:55]
buffer_store_dwordx4 v[156:159], v13, s[8:11], s29 offen sc1
v_mfma_f32_16x16x32_bf16 a[56:59], a[176:179], a[216:219], a[56:59]
s_add_u32 s48, s48, s34
ds_read_b128 v[28:31], v3 offset:13312
v_mfma_f32_16x16x32_bf16 a[60:63], a[176:179], a[220:223], a[60:63]
s_add_u32 m0, s32, 20480
ds_read_b128 a[176:179], v4 offset:8192
v_mfma_f32_16x16x32_bf16 a[64:67], a[180:183], a[192:195], a[64:67]
buffer_load_dwordx4 v1, s[12:15], s48 offen lds
v_mfma_f32_16x16x32_bf16 a[68:71], a[180:183], a[196:199], a[68:71]
v_add_u32 v5, 16384, v5
v_and_b32 v5, 65535, v5
v_mfma_f32_16x16x32_bf16 a[72:75], a[180:183], a[200:203], a[72:75]
v_xor_b32 v6, 16, v5
v_xor_b32 v7, 64, v5
v_mfma_f32_16x16x32_bf16 a[76:79], a[180:183], a[204:207], a[76:79]
v_xor_b32 v8, 80, v5
v_xor_b32 v9, 128, v5
v_mfma_f32_16x16x32_bf16 a[80:83], a[180:183], a[208:211], a[80:83]
v_xor_b32 v10, 144, v5
v_xor_b32 v11, 192, v5
v_mfma_f32_16x16x32_bf16 a[84:87], a[180:183], a[212:215], a[84:87]
s_add_u32 s48, s48, s34
v_xor_b32 v12, 208, v5
v_mfma_f32_16x16x32_bf16 a[88:91], a[180:183], a[216:219], a[88:91]
s_add_u32 m0, s32, 24576
v_mfma_f32_16x16x32_bf16 a[92:95], a[180:183], a[220:223], a[92:95]
buffer_load_dwordx4 v1, s[12:15], s48 offen lds
ds_read_b128 a[180:183], v3 offset:9216
v_mfma_f32_16x16x32_bf16 a[96:99], a[184:187], a[192:195], a[96:99]
v_mfma_f32_16x16x32_bf16 a[100:103], a[184:187], a[196:199], a[100:103]
v_mfma_f32_16x16x32_bf16 a[104:107], a[184:187], a[200:203], a[104:107]
v_mfma_f32_16x16x32_bf16 a[108:111], a[184:187], a[204:207], a[108:111]
v_mfma_f32_16x16x32_bf16 a[112:115], a[184:187], a[208:211], a[112:115]
s_add_u32 s48, s48, s34
v_mfma_f32_16x16x32_bf16 a[116:119], a[184:187], a[212:215], a[116:119]
s_add_u32 m0, s32, 28672
v_mfma_f32_16x16x32_bf16 a[120:123], a[184:187], a[216:219], a[120:123]
buffer_load_dwordx4 v1, s[12:15], s48 offen lds
v_mfma_f32_16x16x32_bf16 a[124:127], a[184:187], a[220:223], a[124:127]
s_add_u32 s30, s30, 128
ds_read_b128 a[184:187], v4 offset:12288
v_mfma_f32_16x16x32_bf16 a[128:131], a[188:191], a[192:195], a[128:131]
s_add_u32 s32, s32, 32768
v_add_u32 v3, 32768, v3
v_mfma_f32_16x16x32_bf16 a[132:135], a[188:191], a[196:199], a[132:135]
s_sub_u32 s48, s32, 98304
v_subrev_u32 v19, 98304, v3
v_mfma_f32_16x16x32_bf16 a[136:139], a[188:191], a[200:203], a[136:139]
s_cmp_ge_u32 s32, 163840
s_cselect_b32 s32, s48, s32
buffer_load_dword v15, v14, s[96:99], s100 offen
v_mfma_f32_16x16x32_bf16 a[140:143], a[188:191], a[204:207], a[140:143]
s_add_u32 s100, s100, 16384
v_cmp_le_u32 vcc, 163840, v3
v_mfma_f32_16x16x32_bf16 a[144:147], a[188:191], a[208:211], a[144:147]
s_nop 0
v_cndmask_b32 v3, v3, v19, vcc
v_mfma_f32_16x16x32_bf16 a[148:151], a[188:191], a[212:215], a[148:151]
v_xor_b32 v4, 64, v3
v_mfma_f32_16x16x32_bf16 a[152:155], a[188:191], a[216:219], a[152:155]
v_mfma_f32_16x16x32_bf16 a[156:159], a[188:191], a[220:223], a[156:159]
s_waitcnt vmcnt(23) lgkmcnt(0)
s_barrier
v_mfma_f32_16x16x32_bf16 v[160:163], a[160:163], a[224:227], v[160:163]
ds_read_b64_tr_b16 a[192:193], v5 offset:0
v_mfma_f32_16x16x32_bf16 v[164:167], a[160:163], a[228:231], v[164:167]
v_mfma_f32_16x16x32_bf16 v[168:171], a[160:163], a[232:235], v[168:171]
ds_read_b64_tr_b16 a[194:195], v5 offset:1024
v_mfma_f32_16x16x32_bf16 v[172:175], a[160:163], a[236:239], v[172:175]
s_add_u32 s37, s31, 0
v_mfma_f32_16x16x32_bf16 v[176:179], a[160:163], a[240:243], v[176:179]
s_add_u32 m0, s33, 0
ds_read_b64_tr_b16 a[196:197], v6 offset:0
v_mfma_f32_16x16x32_bf16 v[180:183], a[160:163], a[244:247], v[180:183]
buffer_load_dwordx4 v2, s[20:23], s37 offen  lds
v_mfma_f32_16x16x32_bf16 v[184:187], a[160:163], a[248:251], v[184:187]
ds_read_b64_tr_b16 a[198:199], v6 offset:1024
v_mfma_f32_16x16x32_bf16 v[188:191], a[160:163], a[252:255], v[188:191]
ds_read_b128 a[160:163], v3 offset:0
v_mfma_f32_16x16x32_bf16 v[192:195], a[164:167], a[224:227], v[192:195]
ds_read_b64_tr_b16 a[200:201], v7 offset:0
v_mfma_f32_16x16x32_bf16 v[196:199], a[164:167], a[228:231], v[196:199]
v_mfma_f32_16x16x32_bf16 v[200:203], a[164:167], a[232:235], v[200:203]
s_add_u32 s37, s31, 32768
ds_read_b64_tr_b16 a[202:203], v7 offset:1024
v_mfma_f32_16x16x32_bf16 v[204:207], a[164:167], a[236:239], v[204:207]
s_add_u32 m0, s33, 1024
v_mfma_f32_16x16x32_bf16 v[208:211], a[164:167], a[240:243], v[208:211]
buffer_load_dwordx4 v2, s[20:23], s37 offen  lds
v_mfma_f32_16x16x32_bf16 v[212:215], a[164:167], a[244:247], v[212:215]
ds_read_b64_tr_b16 a[204:205], v8 offset:0
v_mfma_f32_16x16x32_bf16 v[216:219], a[164:167], a[248:251], v[216:219]
v_mfma_f32_16x16x32_bf16 v[220:223], a[164:167], a[252:255], v[220:223]
ds_read_b128 a[164:167], v4 offset:1024
v_mfma_f32_16x16x32_bf16 v[224:227], a[168:171], a[224:227], v[224:227]
ds_read_b64_tr_b16 a[206:207], v8 offset:1024
v_mfma_f32_16x16x32_bf16 v[228:231], a[168:171], a[228:231], v[228:231]
s_add_u32 s37, s31, 131072
v_mfma_f32_16x16x32_bf16 v[232:235], a[168:171], a[232:235], v[232:235]
s_add_u32 m0, s33, 4096
ds_read_b64_tr_b16 a[208:209], v9 offset:0
v_mfma_f32_16x16x32_bf16 v[236:239], a[168:171], a[236:239], v[236:239]
buffer_load_dwordx4 v2, s[20:23], s37 offen  lds
v_mfma_f32_16x16x32_bf16 v[240:243], a[168:171], a[240:243], v[240:243]
ds_read_b64_tr_b16 a[210:211], v9 offset:1024
v_mfma_f32_16x16x32_bf16 v[244:247], a[168:171], a[244:247], v[244:247]
v_mfma_f32_16x16x32_bf16 v[248:251], a[168:171], a[248:251], v[248:251]
ds_read_b64_tr_b16 a[212:213], v10 offset:0
v_mfma_f32_16x16x32_bf16 v[252:255], a[168:171], a[252:255], v[252:255]
ds_read_b128 a[168:171], v3 offset:4096
v_mfma_f32_16x16x32_bf16 a[0:3], a[172:175], a[224:227], a[0:3]
s_add_u32 s37, s31, 163840
ds_read_b64_tr_b16 a[214:215], v10 offset:1024
v_mfma_f32_16x16x32_bf16 a[4:7], a[172:175], a[228:231], a[4:7]
s_add_u32 m0, s33, 5120
v_mfma_f32_16x16x32_bf16 a[8:11], a[172:175], a[232:235], a[8:11]
buffer_load_dwordx4 v2, s[20:23], s37 offen  lds
v_mfma_f32_16x16x32_bf16 a[12:15], a[172:175], a[236:239], a[12:15]
s_add_u32 s31, s31, 262144
ds_read_b64_tr_b16 a[216:217], v11 offset:0
v_mfma_f32_16x16x32_bf16 a[16:19], a[172:175], a[240:243], a[16:19]
s_add_u32 s33, s33, 16384
v_mfma_f32_16x16x32_bf16 a[20:23], a[172:175], a[244:247], a[20:23]
s_and_b32 s33, s33, 65535
ds_read_b64_tr_b16 a[218:219], v11 offset:1024
v_mfma_f32_16x16x32_bf16 a[24:27], a[172:175], a[248:251], a[24:27]
v_mfma_f32_16x16x32_bf16 a[28:31], a[172:175], a[252:255], a[28:31]
s_mov_b32 s48, s30
ds_read_b128 a[172:175], v4 offset:5120
v_mfma_f32_16x16x32_bf16 a[32:35], a[176:179], a[224:227], a[32:35]
s_add_u32 m0, s32, 0
ds_read_b64_tr_b16 a[220:221], v12 offset:0
v_mfma_f32_16x16x32_bf16 a[36:39], a[176:179], a[228:231], a[36:39]
buffer_load_dwordx4 v1, s[12:15], s48 offen lds
v_mfma_f32_16x16x32_bf16 a[40:43], a[176:179], a[232:235], a[40:43]
ds_read_b64_tr_b16 a[222:223], v12 offset:1024
v_mfma_f32_16x16x32_bf16 a[44:47], a[176:179], a[236:239], a[44:47]
v_mfma_f32_16x16x32_bf16 a[48:51], a[176:179], a[240:243], a[48:51]
ds_read_b128 a[188:191], v4 offset:13312
v_mfma_f32_16x16x32_bf16 a[52:55], a[176:179], a[244:247], a[52:55]
v_mfma_f32_16x16x32_bf16 a[56:59], a[176:179], a[248:251], a[56:59]
s_add_u32 s48, s48, s34
v_mfma_f32_16x16x32_bf16 a[60:63], a[176:179], a[252:255], a[60:63]
s_add_u32 m0, s32, 4096
ds_read_b128 a[176:179], v3 offset:8192
v_add_u32 v5, 16384, v5
v_mfma_f32_16x16x32_bf16 a[64:67], a[180:183], a[224:227], a[64:67]
buffer_load_dwordx4 v1, s[12:15], s48 offen lds
v_and_b32 v5, 65535, v5
v_mfma_f32_16x16x32_bf16 a[68:71], a[180:183], a[228:231], a[68:71]
v_xor_b32 v6, 16, v5
v_xor_b32 v7, 64, v5
v_mfma_f32_16x16x32_bf16 a[72:75], a[180:183], a[232:235], a[72:75]
v_xor_b32 v8, 80, v5
v_xor_b32 v9, 128, v5
v_mfma_f32_16x16x32_bf16 a[76:79], a[180:183], a[236:239], a[76:79]
v_xor_b32 v10, 144, v5
v_xor_b32 v11, 192, v5
v_mfma_f32_16x16x32_bf16 a[80:83], a[180:183], a[240:243], a[80:83]
v_xor_b32 v12, 208, v5
v_mfma_f32_16x16x32_bf16 a[84:87], a[180:183], a[244:247], a[84:87]
s_add_u32 s48, s48, s34
v_mfma_f32_16x16x32_bf16 a[88:91], a[180:183], a[248:251], a[88:91]
s_add_u32 m0, s32, 8192
v_mfma_f32_16x16x32_bf16 a[92:95], a[180:183], a[252:255], a[92:95]
buffer_load_dwordx4 v1, s[12:15], s48 offen lds
ds_read_b128 a[180:183], v4 offset:9216
v_mfma_f32_16x16x32_bf16 a[96:99], a[184:187], a[224:227], a[96:99]
v_mfma_f32_16x16x32_bf16 a[100:103], a[184:187], a[228:231], a[100:103]
v_mfma_f32_16x16x32_bf16 a[104:107], a[184:187], a[232:235], a[104:107]
v_mfma_f32_16x16x32_bf16 a[108:111], a[184:187], a[236:239], a[108:111]
v_mfma_f32_16x16x32_bf16 a[112:115], a[184:187], a[240:243], a[112:115]
s_add_u32 s48, s48, s34
v_mfma_f32_16x16x32_bf16 a[116:119], a[184:187], a[244:247], a[116:119]
s_add_u32 m0, s32, 12288
v_mfma_f32_16x16x32_bf16 a[120:123], a[184:187], a[248:251], a[120:123]
buffer_load_dwordx4 v1, s[12:15], s48 offen lds
v_mfma_f32_16x16x32_bf16 a[124:127], a[184:187], a[252:255], a[124:127]
ds_read_b128 a[184:187], v3 offset:12288
v_mfma_f32_16x16x32_bf16 a[128:131], v[28:31], a[224:227], a[128:131]
v_mfma_f32_16x16x32_bf16 a[132:135], v[28:31], a[228:231], a[132:135]
v_mfma_f32_16x16x32_bf16 a[136:139], v[28:31], a[232:235], a[136:139]
buffer_load_dword v15, v14, s[96:99], s100 offen
v_mfma_f32_16x16x32_bf16 a[140:143], v[28:31], a[236:239], a[140:143]
s_add_u32 s100, s100, 16384
v_mfma_f32_16x16x32_bf16 a[144:147], v[28:31], a[240:243], a[144:147]
v_mfma_f32_16x16x32_bf16 a[148:151], v[28:31], a[244:247], a[148:151]
v_mfma_f32_16x16x32_bf16 a[152:155], v[28:31], a[248:251], a[152:155]
v_mfma_f32_16x16x32_bf16 a[156:159], v[28:31], a[252:255], a[156:159]
s_waitcnt vmcnt(20) lgkmcnt(0)
s_barrier
v_mfma_f32_16x16x32_bf16 v[160:163], a[160:163], a[192:195], v[160:163]
ds_read_b64_tr_b16 a[224:225], v5 offset:0
v_mfma_f32_16x16x32_bf16 v[164:167], a[160:163], a[196:199], v[164:167]
v_mfma_f32_16x16x32_bf16 v[168:171], a[160:163], a[200:203], v[168:171]
ds_read_b64_tr_b16 a[226:227], v5 offset:1024
v_mfma_f32_16x16x32_bf16 v[172:175], a[160:163], a[204:207], v[172:175]
s_add_u32 s37, s31, 0
v_mfma_f32_16x16x32_bf16 v[176:179], a[160:163], a[208:211], v[176:179]
s_add_u32 m0, s33, 0
ds_read_b64_tr_b16 a[228:229], v6 offset:0
v_mfma_f32_16x16x32_bf16 v[180:183], a[160:163], a[212:215], v[180:183]
buffer_load_dwordx4 v2, s[20:23], s37 offen  lds
v_mfma_f32_16x16x32_bf16 v[184:187], a[160:163], a[216:219], v[184:187]
ds_read_b64_tr_b16 a[230:231], v6 offset:1024
v_mfma_f32_16x16x32_bf16 v[188:191], a[160:163], a[220:223], v[188:191]
ds_read_b128 a[160:163], v4 offset:0
v_mfma_f32_16x16x32_bf16 v[192:195], a[164:167], a[192:195], v[192:195]
ds_read_b64_tr_b16 a[232:233], v7 offset:0
v_mfma_f32_16x16x32_bf16 v[196:199], a[164:167], a[196:199], v[196:199]
v_mfma_f32_16x16x32_bf16 v[200:203], a[164:167], a[200:203], v[200:203]
s_add_u32 s37, s31, 32768
ds_read_b64_tr_b16 a[234:235], v7 offset:1024
v_mfma_f32_16x16x32_bf16 v[204:207], a[164:167], a[204:207], v[204:207]
s_add_u32 m0, s33, 1024
v_mfma_f32_16x16x32_bf16 v[208:211], a[164:167], a[208:211], v[208:211]
buffer_load_dwordx4 v2, s[20:23], s37 offen  lds
v_mfma_f32_16x16x32_bf16 v[212:215], a[164:167], a[212:215], v[212:215]
ds_read_b64_tr_b16 a[236:237], v8 offset:0
v_mfma_f32_16x16x32_bf16 v[216:219], a[164:167], a[216:219], v[216:219]
v_mfma_f32_16x16x32_bf16 v[220:223], a[164:167], a[220:223], v[220:223]
ds_read_b128 a[164:167], v3 offset:1024
v_mfma_f32_16x16x32_bf16 v[224:227], a[168:171], a[192:195], v[224:227]
ds_read_b64_tr_b16 a[238:239], v8 offset:1024
v_mfma_f32_16x16x32_bf16 v[228:231], a[168:171], a[196:199], v[228:231]
s_add_u32 s37, s31, 131072
v_mfma_f32_16x16x32_bf16 v[232:235], a[168:171], a[200:203], v[232:235]
s_add_u32 m0, s33, 4096
ds_read_b64_tr_b16 a[240:241], v9 offset:0
v_mfma_f32_16x16x32_bf16 v[236:239], a[168:171], a[204:207], v[236:239]
buffer_load_dwordx4 v2, s[20:23], s37 offen  lds
v_mfma_f32_16x16x32_bf16 v[240:243], a[168:171], a[208:211], v[240:243]
ds_read_b64_tr_b16 a[242:243], v9 offset:1024
v_mfma_f32_16x16x32_bf16 v[244:247], a[168:171], a[212:215], v[244:247]
v_mfma_f32_16x16x32_bf16 v[248:251], a[168:171], a[216:219], v[248:251]
ds_read_b64_tr_b16 a[244:245], v10 offset:0
v_mfma_f32_16x16x32_bf16 v[252:255], a[168:171], a[220:223], v[252:255]
ds_read_b128 a[168:171], v4 offset:4096
v_mfma_f32_16x16x32_bf16 a[0:3], a[172:175], a[192:195], a[0:3]
s_add_u32 s37, s31, 163840
ds_read_b64_tr_b16 a[246:247], v10 offset:1024
v_mfma_f32_16x16x32_bf16 a[4:7], a[172:175], a[196:199], a[4:7]
s_add_u32 m0, s33, 5120
v_mfma_f32_16x16x32_bf16 a[8:11], a[172:175], a[200:203], a[8:11]
buffer_load_dwordx4 v2, s[20:23], s37 offen  lds
v_mfma_f32_16x16x32_bf16 a[12:15], a[172:175], a[204:207], a[12:15]
s_add_u32 s31, s31, 262144
ds_read_b64_tr_b16 a[248:249], v11 offset:0
v_mfma_f32_16x16x32_bf16 a[16:19], a[172:175], a[208:211], a[16:19]
s_add_u32 s33, s33, 16384
v_mfma_f32_16x16x32_bf16 a[20:23], a[172:175], a[212:215], a[20:23]
s_and_b32 s33, s33, 65535
ds_read_b64_tr_b16 a[250:251], v11 offset:1024
v_mfma_f32_16x16x32_bf16 a[24:27], a[172:175], a[216:219], a[24:27]
v_mfma_f32_16x16x32_bf16 a[28:31], a[172:175], a[220:223], a[28:31]
s_add_u32 s48, s48, s34
ds_read_b128 a[172:175], v3 offset:5120
v_mfma_f32_16x16x32_bf16 a[32:35], a[176:179], a[192:195], a[32:35]
s_add_u32 m0, s32, 16384
ds_read_b64_tr_b16 a[252:253], v12 offset:0
v_mfma_f32_16x16x32_bf16 a[36:39], a[176:179], a[196:199], a[36:39]
buffer_load_dwordx4 v1, s[12:15], s48 offen lds
v_mfma_f32_16x16x32_bf16 a[40:43], a[176:179], a[200:203], a[40:43]
ds_read_b64_tr_b16 a[254:255], v12 offset:1024
v_mfma_f32_16x16x32_bf16 a[44:47], a[176:179], a[204:207], a[44:47]
v_mfma_f32_16x16x32_bf16 a[48:51], a[176:179], a[208:211], a[48:51]
ds_read_b128 v[28:31], v3 offset:13312
v_mfma_f32_16x16x32_bf16 a[52:55], a[176:179], a[212:215], a[52:55]
v_mfma_f32_16x16x32_bf16 a[56:59], a[176:179], a[216:219], a[56:59]
s_add_u32 s48, s48, s34
v_mfma_f32_16x16x32_bf16 a[60:63], a[176:179], a[220:223], a[60:63]
s_add_u32 m0, s32, 20480
ds_read_b128 a[176:179], v4 offset:8192
v_add_u32 v5, 16384, v5
v_mfma_f32_16x16x32_bf16 a[64:67], a[180:183], a[192:195], a[64:67]
buffer_load_dwordx4 v1, s[12:15], s48 offen lds
v_and_b32 v5, 65535, v5
v_mfma_f32_16x16x32_bf16 a[68:71], a[180:183], a[196:199], a[68:71]
v_xor_b32 v6, 16, v5
v_xor_b32 v7, 64, v5
v_mfma_f32_16x16x32_bf16 a[72:75], a[180:183], a[200:203], a[72:75]
v_xor_b32 v8, 80, v5
v_xor_b32 v9, 128, v5
v_mfma_f32_16x16x32_bf16 a[76:79], a[180:183], a[204:207], a[76:79]
v_xor_b32 v10, 144, v5
v_xor_b32 v11, 192, v5
v_mfma_f32_16x16x32_bf16 a[80:83], a[180:183], a[208:211], a[80:83]
v_xor_b32 v12, 208, v5
v_mfma_f32_16x16x32_bf16 a[84:87], a[180:183], a[212:215], a[84:87]
s_add_u32 s48, s48, s34
v_mfma_f32_16x16x32_bf16 a[88:91], a[180:183], a[216:219], a[88:91]
s_add_u32 m0, s32, 24576
v_mfma_f32_16x16x32_bf16 a[92:95], a[180:183], a[220:223], a[92:95]
buffer_load_dwordx4 v1, s[12:15], s48 offen lds
ds_read_b128 a[180:183], v3 offset:9216
v_mfma_f32_16x16x32_bf16 a[96:99], a[184:187], a[192:195], a[96:99]
v_mfma_f32_16x16x32_bf16 a[100:103], a[184:187], a[196:199], a[100:103]
v_mfma_f32_16x16x32_bf16 a[104:107], a[184:187], a[200:203], a[104:107]
v_mfma_f32_16x16x32_bf16 a[108:111], a[184:187], a[204:207], a[108:111]
v_mfma_f32_16x16x32_bf16 a[112:115], a[184:187], a[208:211], a[112:115]
s_add_u32 s48, s48, s34
v_mfma_f32_16x16x32_bf16 a[116:119], a[184:187], a[212:215], a[116:119]
s_add_u32 m0, s32, 28672
v_mfma_f32_16x16x32_bf16 a[120:123], a[184:187], a[216:219], a[120:123]
buffer_load_dwordx4 v1, s[12:15], s48 offen lds
v_mfma_f32_16x16x32_bf16 a[124:127], a[184:187], a[220:223], a[124:127]
s_add_u32 s30, s30, 128
ds_read_b128 a[184:187], v4 offset:12288
v_mfma_f32_16x16x32_bf16 a[128:131], a[188:191], a[192:195], a[128:131]
s_add_u32 s32, s32, 32768
v_add_u32 v3, 32768, v3
v_mfma_f32_16x16x32_bf16 a[132:135], a[188:191], a[196:199], a[132:135]
s_sub_u32 s48, s32, 98304
v_subrev_u32 v19, 98304, v3
v_mfma_f32_16x16x32_bf16 a[136:139], a[188:191], a[200:203], a[136:139]
s_cmp_ge_u32 s32, 163840
s_cselect_b32 s32, s48, s32
buffer_load_dword v15, v14, s[96:99], s100 offen
v_mfma_f32_16x16x32_bf16 a[140:143], a[188:191], a[204:207], a[140:143]
s_add_u32 s100, s100, 16384
v_cmp_le_u32 vcc, 163840, v3
v_mfma_f32_16x16x32_bf16 a[144:147], a[188:191], a[208:211], a[144:147]
s_nop 0
v_cndmask_b32 v3, v3, v19, vcc
v_mfma_f32_16x16x32_bf16 a[148:151], a[188:191], a[212:215], a[148:151]
v_xor_b32 v4, 64, v3
v_mfma_f32_16x16x32_bf16 a[152:155], a[188:191], a[216:219], a[152:155]
v_mfma_f32_16x16x32_bf16 a[156:159], a[188:191], a[220:223], a[156:159]
s_cmp_eq_u32 s41, 0
s_cbranch_scc0 L_g_v17v
s_waitcnt vmcnt(18) lgkmcnt(0)
s_barrier
v_mfma_f32_16x16x32_bf16 v[160:163], a[160:163], a[224:227], v[160:163]
ds_read_b128 a[192:195], v3 offset:0
v_mfma_f32_16x16x32_bf16 v[164:167], a[160:163], a[228:231], v[164:167]
v_mfma_f32_16x16x32_bf16 v[168:171], a[160:163], a[232:235], v[168:171]
ds_read_b128 a[196:199], v4 offset:1024
v_mfma_f32_16x16x32_bf16 v[172:175], a[160:163], a[236:239], v[172:175]
s_add_u32 s37, s31, 0
v_mfma_f32_16x16x32_bf16 v[176:179], a[160:163], a[240:243], v[176:179]
s_add_u32 m0, s33, 0
ds_read_b128 a[200:203], v3 offset:4096
v_cvt_pk_bf16_f32 v32, v160, v161
v_cvt_pk_bf16_f32 v33, v162, v163
v_mfma_f32_16x16x32_bf16 v[180:183], a[160:163], a[244:247], v[180:183]
buffer_load_dwordx4 v2, s[20:23], s37 offen  lds
v_cvt_pk_bf16_f32 v36, v164, v165
v_cvt_pk_bf16_f32 v37, v166, v167
v_mfma_f32_16x16x32_bf16 v[184:187], a[160:163], a[248:251], v[184:187]
ds_read_b128 a[204:207], v4 offset:5120
v_cvt_pk_bf16_f32 v40, v168, v169
v_cvt_pk_bf16_f32 v41, v170, v171
v_mfma_f32_16x16x32_bf16 v[188:191], a[160:163], a[252:255], v[188:191]
ds_read_b64_tr_b16 a[160:161], v5 offset:0
v_cvt_pk_bf16_f32 v44, v172, v173
v_cvt_pk_bf16_f32 v45, v174, v175
v_mfma_f32_16x16x32_bf16 v[192:195], a[164:167], a[224:227], v[192:195]
ds_read_b64_tr_b16 a[162:163], v5 offset:1024
v_cvt_pk_bf16_f32 v48, v176, v177
v_cvt_pk_bf16_f32 v49, v178, v179
v_mfma_f32_16x16x32_bf16 v[196:199], a[164:167], a[228:231], v[196:199]
ds_read_b128 a[208:211], v3 offset:8192
v_add_u32 v5, 16384, v5
v_cvt_pk_bf16_f32 v52, v180, v181
v_cvt_pk_bf16_f32 v53, v182, v183
v_mfma_f32_16x16x32_bf16 v[200:203], a[164:167], a[232:235], v[200:203]
s_add_u32 s37, s31, 32768
v_and_b32 v5, 65535, v5
v_cvt_pk_bf16_f32 v56, v184, v185
v_cvt_pk_bf16_f32 v57, v186, v187
v_mfma_f32_16x16x32_bf16 v[204:207], a[164:167], a[236:239], v[204:207]
s_add_u32 m0, s33, 1024
ds_read_b128 a[212:215], v4 offset:9216
v_cvt_pk_bf16_f32 v60, v188, v189
v_cvt_pk_bf16_f32 v61, v190, v191
v_mfma_f32_16x16x32_bf16 v[208:211], a[164:167], a[240:243], v[208:211]
buffer_load_dwordx4 v2, s[20:23], s37 offen  lds
v_cvt_pk_bf16_f32 v34, v192, v193
v_cvt_pk_bf16_f32 v35, v194, v195
v_mfma_f32_16x16x32_bf16 v[212:215], a[164:167], a[244:247], v[212:215]
ds_read_b128 a[216:219], v3 offset:12288
v_cvt_pk_bf16_f32 v38, v196, v197
v_cvt_pk_bf16_f32 v39, v198, v199
v_mfma_f32_16x16x32_bf16 v[216:219], a[164:167], a[248:251], v[216:219]
v_cvt_pk_bf16_f32 v42, v200, v201
v_cvt_pk_bf16_f32 v43, v202, v203
v_mfma_f32_16x16x32_bf16 v[220:223], a[164:167], a[252:255], v[220:223]
ds_read_b64_tr_b16 a[164:165], v6 offset:0
v_cvt_pk_bf16_f32 v46, v204, v205
v_cvt_pk_bf16_f32 v47, v206, v207
v_mfma_f32_16x16x32_bf16 v[224:227], a[168:171], a[224:227], v[224:227]
ds_read_b64_tr_b16 a[166:167], v6 offset:1024
v_cvt_pk_bf16_f32 v50, v208, v209
v_cvt_pk_bf16_f32 v51, v210, v211
v_mfma_f32_16x16x32_bf16 v[228:231], a[168:171], a[228:231], v[228:231]
s_add_u32 s37, s31, 131072
ds_read_b128 a[220:223], v4 offset:13312
v_xor_b32 v6, 16, v5
v_cvt_pk_bf16_f32 v54, v212, v213
v_cvt_pk_bf16_f32 v55, v214, v215
v_mfma_f32_16x16x32_bf16 v[232:235], a[168:171], a[232:235], v[232:235]
s_add_u32 m0, s33, 4096
v_cvt_pk_bf16_f32 v58, v216, v217
v_cvt_pk_bf16_f32 v59, v218, v219
v_mfma_f32_16x16x32_bf16 v[236:239], a[168:171], a[236:239], v[236:239]
buffer_load_dwordx4 v2, s[20:23], s37 offen  lds
v_cvt_pk_bf16_f32 v62, v220, v221
v_cvt_pk_bf16_f32 v63, v222, v223
v_mfma_f32_16x16x32_bf16 v[240:243], a[168:171], a[240:243], v[240:243]
ds_read_b64_tr_b16 a[188:189], v12 offset:0
v_cvt_pk_bf16_f32 v64, v224, v225
v_cvt_pk_bf16_f32 v65, v226, v227
v_mfma_f32_16x16x32_bf16 v[244:247], a[168:171], a[244:247], v[244:247]
v_cvt_pk_bf16_f32 v68, v228, v229
v_cvt_pk_bf16_f32 v69, v230, v231
v_mfma_f32_16x16x32_bf16 v[248:251], a[168:171], a[248:251], v[248:251]
ds_read_b64_tr_b16 a[190:191], v12 offset:1024
v_cvt_pk_bf16_f32 v72, v232, v233
v_cvt_pk_bf16_f32 v73, v234, v235
v_mfma_f32_16x16x32_bf16 v[252:255], a[168:171], a[252:255], v[252:255]
ds_read_b64_tr_b16 a[168:169], v7 offset:0
v_cvt_pk_bf16_f32 v76, v236, v237
v_cvt_pk_bf16_f32 v77, v238, v239
v_mfma_f32_16x16x32_bf16 a[0:3], a[172:175], a[224:227], a[0:3]
s_add_u32 s37, s31, 163840
ds_read_b64_tr_b16 a[170:171], v7 offset:1024
v_cvt_pk_bf16_f32 v80, v240, v241
v_cvt_pk_bf16_f32 v81, v242, v243
v_mfma_f32_16x16x32_bf16 a[4:7], a[172:175], a[228:231], a[4:7]
s_add_u32 m0, s33, 5120
v_xor_b32 v7, 64, v5
v_xor_b32 v12, 208, v5
v_cvt_pk_bf16_f32 v84, v244, v245
v_cvt_pk_bf16_f32 v85, v246, v247
v_mfma_f32_16x16x32_bf16 a[8:11], a[172:175], a[232:235], a[8:11]
buffer_load_dwordx4 v2, s[20:23], s37 offen  lds
v_cvt_pk_bf16_f32 v88, v248, v249
v_cvt_pk_bf16_f32 v89, v250, v251
v_mfma_f32_16x16x32_bf16 a[12:15], a[172:175], a[236:239], a[12:15]
s_add_u32 s31, s31, 262144
v_cvt_pk_bf16_f32 v92, v252, v253
v_cvt_pk_bf16_f32 v93, v254, v255
v_mfma_f32_16x16x32_bf16 a[16:19], a[172:175], a[240:243], a[16:19]
s_add_u32 s33, s33, 16384
v_accvgpr_read_b32 v20, a0
v_accvgpr_read_b32 v21, a1
v_accvgpr_read_b32 v22, a2
v_accvgpr_read_b32 v23, a3
v_mfma_f32_16x16x32_bf16 a[20:23], a[172:175], a[244:247], a[20:23]
s_and_b32 s33, s33, 65535
v_cvt_pk_bf16_f32 v66, v20, v21
v_cvt_pk_bf16_f32 v67, v22, v23
v_accvgpr_read_b32 v24, a4
v_accvgpr_read_b32 v25, a5
v_mfma_f32_16x16x32_bf16 a[24:27], a[172:175], a[248:251], a[24:27]
v_accvgpr_read_b32 v26, a6
v_accvgpr_read_b32 v27, a7
v_cvt_pk_bf16_f32 v70, v24, v25
v_cvt_pk_bf16_f32 v71, v26, v27
v_mfma_f32_16x16x32_bf16 a[28:31], a[172:175], a[252:255], a[28:31]
s_mov_b32 s48, s30
ds_read_b64_tr_b16 a[172:173], v8 offset:0
v_accvgpr_read_b32 v20, a8
v_accvgpr_read_b32 v21, a9
v_accvgpr_read_b32 v22, a10
v_mfma_f32_16x16x32_bf16 a[32:35], a[176:179], a[224:227], a[32:35]
s_add_u32 m0, s32, 0
ds_read_b64_tr_b16 a[174:175], v8 offset:1024
v_mov_b32 v16, 0
v_accvgpr_read_b32 v23, a11
v_cvt_pk_bf16_f32 v74, v20, v21
v_mfma_f32_16x16x32_bf16 a[36:39], a[176:179], a[228:231], a[36:39]
buffer_load_dwordx4 v1, s[12:15], s48 offen lds
v_mov_b32 v17, 1
v_cvt_pk_bf16_f32 v75, v22, v23
v_accvgpr_read_b32 v24, a12
v_mfma_f32_16x16x32_bf16 a[40:43], a[176:179], a[232:235], a[40:43]
s_cmp_eq_u32 s17, 0
s_cselect_b32 s29, s39, 536870912
v_accvgpr_read_b32 v25, a13
v_accvgpr_read_b32 v26, a14
v_mfma_f32_16x16x32_bf16 a[44:47], a[176:179], a[236:239], a[44:47]
s_mov_b64 exec, 1
buffer_store_dword v17, v16, s[8:11], s29 offen sc1
s_mov_b64 exec, -1
v_accvgpr_read_b32 v27, a15
v_mfma_f32_16x16x32_bf16 a[48:51], a[176:179], a[240:243], a[48:51]
v_xor_b32 v8, 80, v5
v_cvt_pk_bf16_f32 v78, v24, v25
v_cvt_pk_bf16_f32 v79, v26, v27
v_accvgpr_read_b32 v20, a16
v_mfma_f32_16x16x32_bf16 a[52:55], a[176:179], a[244:247], a[52:55]
v_accvgpr_read_b32 v21, a17
v_accvgpr_read_b32 v22, a18
v_accvgpr_read_b32 v23, a19
v_cvt_pk_bf16_f32 v82, v20, v21
v_mfma_f32_16x16x32_bf16 a[56:59], a[176:179], a[248:251], a[56:59]
s_add_u32 s48, s48, s34
v_cvt_pk_bf16_f32 v83, v22, v23
v_accvgpr_read_b32 v24, a20
v_accvgpr_read_b32 v25, a21
v_accvgpr_read_b32 v26, a22
v_mfma_f32_16x16x32_bf16 a[60:63], a[176:179], a[252:255], a[60:63]
s_add_u32 m0, s32, 4096
ds_read_b64_tr_b16 a[176:177], v9 offset:0
v_accvgpr_read_b32 v27, a23
v_cvt_pk_bf16_f32 v86, v24, v25
v_cvt_pk_bf16_f32 v87, v26, v27
v_mfma_f32_16x16x32_bf16 a[64:67], a[180:183], a[224:227], a[64:67]
buffer_load_dwordx4 v1, s[12:15], s48 offen lds
ds_read_b64_tr_b16 a[178:179], v9 offset:1024
v_accvgpr_read_b32 v20, a24
v_accvgpr_read_b32 v21, a25
v_mfma_f32_16x16x32_bf16 a[68:71], a[180:183], a[228:231], a[68:71]
v_xor_b32 v9, 128, v5
v_accvgpr_read_b32 v22, a26
v_accvgpr_read_b32 v23, a27
v_cvt_pk_bf16_f32 v90, v20, v21
v_mfma_f32_16x16x32_bf16 a[72:75], a[180:183], a[232:235], a[72:75]
v_cvt_pk_bf16_f32 v91, v22, v23
v_accvgpr_read_b32 v24, a28
v_accvgpr_read_b32 v25, a29
v_accvgpr_read_b32 v26, a30
v_mfma_f32_16x16x32_bf16 a[76:79], a[180:183], a[236:239], a[76:79]
v_accvgpr_read_b32 v27, a31
v_cvt_pk_bf16_f32 v94, v24, v25
v_cvt_pk_bf16_f32 v95, v26, v27
v_accvgpr_read_b32 v20, a32
v_mfma_f32_16x16x32_bf16 a[80:83], a[180:183], a[240:243], a[80:83]
v_accvgpr_read_b32 v21, a33
v_accvgpr_read_b32 v22, a34
v_accvgpr_read_b32 v23, a35
v_cvt_pk_bf16_f32 v96, v20, v21
v_mfma_f32_16x16x32_bf16 a[84:87], a[180:183], a[244:247], a[84:87]
s_add_u32 s48, s48, s34
v_cvt_pk_bf16_f32 v97, v22, v23
v_accvgpr_read_b32 v24, a36
v_accvgpr_read_b32 v25, a37
v_accvgpr_read_b32 v26, a38
v_mfma_f32_16x16x32_bf16 a[88:91], a[180:183], a[248:251], a[88:91]
s_add_u32 m0, s32, 8192
v_accvgpr_read_b32 v27, a39
v_cvt_pk_bf16_f32 v100, v24, v25
v_cvt_pk_bf16_f32 v101, v26, v27
v_accvgpr_read_b32 v20, a40
v_mfma_f32_16x16x32_bf16 a[92:95], a[180:183], a[252:255], a[92:95]
buffer_load_dwordx4 v1, s[12:15], s48 offen lds
ds_read_b64_tr_b16 a[180:181], v10 offset:0
v_accvgpr_read_b32 v21, a41
v_accvgpr_read_b32 v22, a42
v_mfma_f32_16x16x32_bf16 a[96:99], a[184:187], a[224:227], a[96:99]
ds_read_b64_tr_b16 a[182:183], v10 offset:1024
v_accvgpr_read_b32 v23, a43
v_cvt_pk_bf16_f32 v104, v20, v21
v_cvt_pk_bf16_f32 v105, v22, v23
v_mfma_f32_16x16x32_bf16 a[100:103], a[184:187], a[228:231], a[100:103]
v_xor_b32 v10, 144, v5
v_accvgpr_read_b32 v24, a44
v_accvgpr_read_b32 v25, a45
v_accvgpr_read_b32 v26, a46
v_mfma_f32_16x16x32_bf16 a[104:107], a[184:187], a[232:235], a[104:107]
v_accvgpr_read_b32 v27, a47
v_cvt_pk_bf16_f32 v108, v24, v25
v_cvt_pk_bf16_f32 v109, v26, v27
v_accvgpr_read_b32 v20, a48
v_mfma_f32_16x16x32_bf16 a[108:111], a[184:187], a[236:239], a[108:111]
v_accvgpr_read_b32 v21, a49
v_accvgpr_read_b32 v22, a50
v_accvgpr_read_b32 v23, a51
v_cvt_pk_bf16_f32 v112, v20, v21
v_mfma_f32_16x16x32_bf16 a[112:115], a[184:187], a[240:243], a[112:115]
s_add_u32 s48, s48, s34
v_cvt_pk_bf16_f32 v113, v22, v23
v_accvgpr_read_b32 v24, a52
v_accvgpr_read_b32 v25, a53
v_accvgpr_read_b32 v26, a54
v_mfma_f32_16x16x32_bf16 a[116:119], a[184:187], a[244:247], a[116:119]
s_add_u32 m0, s32, 12288
v_accvgpr_read_b32 v27, a55
v_cvt_pk_bf16_f32 v116, v24, v25
v_cvt_pk_bf16_f32 v117, v26, v27
v_accvgpr_read_b32 v20, a56
v_mfma_f32_16x16x32_bf16 a[120:123], a[184:187], a[248:251], a[120:123]
buffer_load_dwordx4 v1, s[12:15], s48 offen lds
v_accvgpr_read_b32 v21, a57
v_accvgpr_read_b32 v22, a58
v_accvgpr_read_b32 v23, a59
v_mfma_f32_16x16x32_bf16 a[124:127], a[184:187], a[252:255], a[124:127]
ds_read_b64_tr_b16 a[184:185], v11 offset:0
v_cvt_pk_bf16_f32 v120, v20, v21
v_cvt_pk_bf16_f32 v121, v22, v23
v_accvgpr_read_b32 v24, a60
v_mfma_f32_16x16x32_bf16 a[128:131], v[28:31], a[224:227], a[128:131]
ds_read_b64_tr_b16 a[186:187], v11 offset:1024
v_accvgpr_read_b32 v25, a61
v_accvgpr_read_b32 v26, a62
v_accvgpr_read_b32 v27, a63
v_mfma_f32_16x16x32_bf16 a[132:135], v[28:31], a[228:231], a[132:135]
v_xor_b32 v11, 192, v5
v_cvt_pk_bf16_f32 v124, v24, v25
v_cvt_pk_bf16_f32 v125, v26, v27
v_mfma_f32_16x16x32_bf16 a[136:139], v[28:31], a[232:235], a[136:139]
buffer_load_dword v15, v14, s[96:99], s100 offen
v_mfma_f32_16x16x32_bf16 a[140:143], v[28:31], a[236:239], a[140:143]
s_add_u32 s100, s100, 16384
v_mfma_f32_16x16x32_bf16 a[144:147], v[28:31], a[240:243], a[144:147]
v_mfma_f32_16x16x32_bf16 a[148:151], v[28:31], a[244:247], a[148:151]
v_mfma_f32_16x16x32_bf16 a[152:155], v[28:31], a[248:251], a[152:155]
v_mfma_f32_16x16x32_bf16 a[156:159], v[28:31], a[252:255], a[156:159]
s_cmp_lt_u32 s35, s45
s_cbranch_scc1 L_g_tile
s_branch L_g_end
L_g_v17v:
s_waitcnt vmcnt(18) lgkmcnt(0)
s_barrier
v_mfma_f32_16x16x32_bf16 v[160:163], a[160:163], a[224:227], v[160:163]
ds_read_b64_tr_b16 a[192:193], v5 offset:0
v_mfma_f32_16x16x32_bf16 v[164:167], a[160:163], a[228:231], v[164:167]
v_mfma_f32_16x16x32_bf16 v[168:171], a[160:163], a[232:235], v[168:171]
ds_read_b64_tr_b16 a[194:195], v5 offset:1024
v_mfma_f32_16x16x32_bf16 v[172:175], a[160:163], a[236:239], v[172:175]
s_add_u32 s37, s31, 0
v_mfma_f32_16x16x32_bf16 v[176:179], a[160:163], a[240:243], v[176:179]
s_add_u32 m0, s33, 0
ds_read_b64_tr_b16 a[196:197], v6 offset:0
v_cvt_pk_bf16_f32 v32, v160, v161
v_cvt_pk_bf16_f32 v33, v162, v163
v_mfma_f32_16x16x32_bf16 v[180:183], a[160:163], a[244:247], v[180:183]
buffer_load_dwordx4 v2, s[20:23], s37 offen  lds
v_cvt_pk_bf16_f32 v36, v164, v165
v_cvt_pk_bf16_f32 v37, v166, v167
v_mfma_f32_16x16x32_bf16 v[184:187], a[160:163], a[248:251], v[184:187]
ds_read_b64_tr_b16 a[198:199], v6 offset:1024
v_cvt_pk_bf16_f32 v40, v168, v169
v_cvt_pk_bf16_f32 v41, v170, v171
v_mfma_f32_16x16x32_bf16 v[188:191], a[160:163], a[252:255], v[188:191]
ds_read_b128 a[160:163], v3 offset:0
v_cvt_pk_bf16_f32 v44, v172, v173
v_cvt_pk_bf16_f32 v45, v174, v175
v_mfma_f32_16x16x32_bf16 v[192:195], a[164:167], a[224:227], v[192:195]
ds_read_b64_tr_b16 a[200:201], v7 offset:0
v_cvt_pk_bf16_f32 v48, v176, v177
v_cvt_pk_bf16_f32 v49, v178, v179
v_mfma_f32_16x16x32_bf16 v[196:199], a[164:167], a[228:231], v[196:199]
v_cvt_pk_bf16_f32 v52, v180, v181
v_cvt_pk_bf16_f32 v53, v182, v183
v_mfma_f32_16x16x32_bf16 v[200:203], a[164:167], a[232:235], v[200:203]
s_add_u32 s37, s31, 32768
ds_read_b64_tr_b16 a[202:203], v7 offset:1024
v_cvt_pk_bf16_f32 v56, v184, v185
v_cvt_pk_bf16_f32 v57, v186, v187
v_mfma_f32_16x16x32_bf16 v[204:207], a[164:167], a[236:239], v[204:207]
s_add_u32 m0, s33, 1024
v_cvt_pk_bf16_f32 v60, v188, v189
v_cvt_pk_bf16_f32 v61, v190, v191
v_mfma_f32_16x16x32_bf16 v[208:211], a[164:167], a[240:243], v[208:211]
buffer_load_dwordx4 v2, s[20:23], s37 offen  lds
v_cvt_pk_bf16_f32 v34, v192, v193
v_cvt_pk_bf16_f32 v35, v194, v195
v_mfma_f32_16x16x32_bf16 v[212:215], a[164:167], a[244:247], v[212:215]
ds_read_b64_tr_b16 a[204:205], v8 offset:0
v_cvt_pk_bf16_f32 v38, v196, v197
v_cvt_pk_bf16_f32 v39, v198, v199
v_mfma_f32_16x16x32_bf16 v[216:219], a[164:167], a[248:251], v[216:219]
v_cvt_pk_bf16_f32 v42, v200, v201
v_cvt_pk_bf16_f32 v43, v202, v203
v_mfma_f32_16x16x32_bf16 v[220:223], a[164:167], a[252:255], v[220:223]
ds_read_b128 a[164:167], v4 offset:1024
v_cvt_pk_bf16_f32 v46, v204, v205
v_cvt_pk_bf16_f32 v47, v206, v207
v_mfma_f32_16x16x32_bf16 v[224:227], a[168:171], a[224:227], v[224:227]
ds_read_b64_tr_b16 a[206:207], v8 offset:1024
v_cvt_pk_bf16_f32 v50, v208, v209
v_cvt_pk_bf16_f32 v51, v210, v211
v_mfma_f32_16x16x32_bf16 v[228:231], a[168:171], a[228:231], v[228:231]
s_add_u32 s37, s31, 131072
v_cvt_pk_bf16_f32 v54, v212, v213
v_cvt_pk_bf16_f32 v55, v214, v215
v_mfma_f32_16x16x32_bf16 v[232:235], a[168:171], a[232:235], v[232:235]
s_add_u32 m0, s33, 4096
ds_read_b64_tr_b16 a[208:209], v9 offset:0
v_cvt_pk_bf16_f32 v58, v216, v217
v_cvt_pk_bf16_f32 v59, v218, v219
v_mfma_f32_16x16x32_bf16 v[236:239], a[168:171], a[236:239], v[236:239]
buffer_load_dwordx4 v2, s[20:23], s37 offen  lds
v_cvt_pk_bf16_f32 v62, v220, v221
v_cvt_pk_bf16_f32 v63, v222, v223
v_mfma_f32_16x16x32_bf16 v[240:243], a[168:171], a[240:243], v[240:243]
ds_read_b64_tr_b16 a[210:211], v9 offset:1024
v_cvt_pk_bf16_f32 v64, v224, v225
v_cvt_pk_bf16_f32 v65, v226, v227
v_mfma_f32_16x16x32_bf16 v[244:247], a[168:171], a[244:247], v[244:247]
v_cvt_pk_bf16_f32 v68, v228, v229
v_cvt_pk_bf16_f32 v69, v230, v231
v_mfma_f32_16x16x32_bf16 v[248:251], a[168:171], a[248:251], v[248:251]
ds_read_b64_tr_b16 a[212:213], v10 offset:0
v_cvt_pk_bf16_f32 v72, v232, v233
v_cvt_pk_bf16_f32 v73, v234, v235
v_mfma_f32_16x16x32_bf16 v[252:255], a[168:171], a[252:255], v[252:255]
ds_read_b128 a[168:171], v3 offset:4096
v_cvt_pk_bf16_f32 v76, v236, v237
v_cvt_pk_bf16_f32 v77, v238, v239
v_mfma_f32_16x16x32_bf16 a[0:3], a[172:175], a[224:227], a[0:3]
s_add_u32 s37, s31, 163840
ds_read_b64_tr_b16 a[214:215], v10 offset:1024
v_cvt_pk_bf16_f32 v80, v240, v241
v_cvt_pk_bf16_f32 v81, v242, v243
v_mfma_f32_16x16x32_bf16 a[4:7], a[172:175], a[228:231], a[4:7]
s_add_u32 m0, s33, 5120
v_cvt_pk_bf16_f32 v84, v244, v245
v_cvt_pk_bf16_f32 v85, v246, v247
v_mfma_f32_16x16x32_bf16 a[8:11], a[172:175], a[232:235], a[8:11]
buffer_load_dwordx4 v2, s[20:23], s37 offen  lds
v_cvt_pk_bf16_f32 v88, v248, v249
v_cvt_pk_bf16_f32 v89, v250, v251
v_mfma_f32_16x16x32_bf16 a[12:15], a[172:175], a[236:239], a[12:15]
s_add_u32 s31, s31, 262144
ds_read_b64_tr_b16 a[216:217], v11 offset:0
v_cvt_pk_bf16_f32 v92, v252, v253
v_cvt_pk_bf16_f32 v93, v254, v255
v_mfma_f32_16x16x32_bf16 a[16:19], a[172:175], a[240:243], a[16:19]
s_add_u32 s33, s33, 16384
v_accvgpr_read_b32 v20, a0
v_accvgpr_read_b32 v21, a1
v_accvgpr_read_b32 v22, a2
v_accvgpr_read_b32 v23, a3
v_mfma_f32_16x16x32_bf16 a[20:23], a[172:175], a[244:247], a[20:23]
s_and_b32 s33, s33, 65535
ds_read_b64_tr_b16 a[218:219], v11 offset:1024
v_cvt_pk_bf16_f32 v66, v20, v21
v_cvt_pk_bf16_f32 v67, v22, v23
v_accvgpr_read_b32 v24, a4
v_mfma_f32_16x16x32_bf16 a[24:27], a[172:175], a[248:251], a[24:27]
v_accvgpr_read_b32 v25, a5
v_accvgpr_read_b32 v26, a6
v_accvgpr_read_b32 v27, a7
v_cvt_pk_bf16_f32 v70, v24, v25
v_mfma_f32_16x16x32_bf16 a[28:31], a[172:175], a[252:255], a[28:31]
s_mov_b32 s48, s30
ds_read_b128 a[172:175], v4 offset:5120
v_cvt_pk_bf16_f32 v71, v26, v27
v_accvgpr_read_b32 v20, a8
v_accvgpr_read_b32 v21, a9
v_mfma_f32_16x16x32_bf16 a[32:35], a[176:179], a[224:227], a[32:35]
s_add_u32 m0, s32, 0
ds_read_b64_tr_b16 a[220:221], v12 offset:0
v_mov_b32 v16, 0
v_accvgpr_read_b32 v22, a10
v_accvgpr_read_b32 v23, a11
v_mfma_f32_16x16x32_bf16 a[36:39], a[176:179], a[228:231], a[36:39]
buffer_load_dwordx4 v1, s[12:15], s48 offen lds
v_mov_b32 v17, 1
v_cvt_pk_bf16_f32 v74, v20, v21
v_cvt_pk_bf16_f32 v75, v22, v23
v_mfma_f32_16x16x32_bf16 a[40:43], a[176:179], a[232:235], a[40:43]
ds_read_b64_tr_b16 a[222:223], v12 offset:1024
v_accvgpr_read_b32 v24, a12
v_accvgpr_read_b32 v25, a13
v_accvgpr_read_b32 v26, a14
v_mfma_f32_16x16x32_bf16 a[44:47], a[176:179], a[236:239], a[44:47]
s_cmp_eq_u32 s17, 0
s_cselect_b32 s29, s39, 536870912
v_accvgpr_read_b32 v27, a15
v_cvt_pk_bf16_f32 v78, v24, v25
v_mfma_f32_16x16x32_bf16 a[48:51], a[176:179], a[240:243], a[48:51]
ds_read_b128 a[188:191], v4 offset:13312
v_cvt_pk_bf16_f32 v79, v26, v27
v_accvgpr_read_b32 v20, a16
v_accvgpr_read_b32 v21, a17
v_mfma_f32_16x16x32_bf16 a[52:55], a[176:179], a[244:247], a[52:55]
s_mov_b64 exec, 1
buffer_store_dword v17, v16, s[8:11], s29 offen sc1
s_mov_b64 exec, -1
v_accvgpr_read_b32 v22, a18
v_mfma_f32_16x16x32_bf16 a[56:59], a[176:179], a[248:251], a[56:59]
s_add_u32 s48, s48, s34
v_accvgpr_read_b32 v23, a19
v_cvt_pk_bf16_f32 v82, v20, v21
v_cvt_pk_bf16_f32 v83, v22, v23
v_accvgpr_read_b32 v24, a20
v_mfma_f32_16x16x32_bf16 a[60:63], a[176:179], a[252:255], a[60:63]
s_add_u32 m0, s32, 4096
ds_read_b128 a[176:179], v3 offset:8192
v_add_u32 v5, 16384, v5
v_accvgpr_read_b32 v25, a21
v_accvgpr_read_b32 v26, a22
v_mfma_f32_16x16x32_bf16 a[64:67], a[180:183], a[224:227], a[64:67]
buffer_load_dwordx4 v1, s[12:15], s48 offen lds
v_and_b32 v5, 65535, v5
v_accvgpr_read_b32 v27, a23
v_cvt_pk_bf16_f32 v86, v24, v25
v_mfma_f32_16x16x32_bf16 a[68:71], a[180:183], a[228:231], a[68:71]
v_xor_b32 v6, 16, v5
v_xor_b32 v7, 64, v5
v_cvt_pk_bf16_f32 v87, v26, v27
v_accvgpr_read_b32 v20, a24
v_mfma_f32_16x16x32_bf16 a[72:75], a[180:183], a[232:235], a[72:75]
v_xor_b32 v8, 80, v5
v_xor_b32 v9, 128, v5
v_accvgpr_read_b32 v21, a25
v_accvgpr_read_b32 v22, a26
v_mfma_f32_16x16x32_bf16 a[76:79], a[180:183], a[236:239], a[76:79]
v_xor_b32 v10, 144, v5
v_xor_b32 v11, 192, v5
v_accvgpr_read_b32 v23, a27
v_cvt_pk_bf16_f32 v90, v20, v21
v_mfma_f32_16x16x32_bf16 a[80:83], a[180:183], a[240:243], a[80:83]
v_xor_b32 v12, 208, v5
v_cvt_pk_bf16_f32 v91, v22, v23
v_accvgpr_read_b32 v24, a28
v_accvgpr_read_b32 v25, a29
v_mfma_f32_16x16x32_bf16 a[84:87], a[180:183], a[244:247], a[84:87]
s_add_u32 s48, s48, s34
v_accvgpr_read_b32 v26, a30
v_accvgpr_read_b32 v27, a31
v_cvt_pk_bf16_f32 v94, v24, v25
v_cvt_pk_bf16_f32 v95, v26, v27
v_mfma_f32_16x16x32_bf16 a[88:91], a[180:183], a[248:251], a[88:91]
s_add_u32 m0, s32, 8192
v_accvgpr_read_b32 v20, a32
v_accvgpr_read_b32 v21, a33
v_accvgpr_read_b32 v22, a34
v_accvgpr_read_b32 v23, a35
v_mfma_f32_16x16x32_bf16 a[92:95], a[180:183], a[252:255], a[92:95]
buffer_load_dwordx4 v1, s[12:15], s48 offen lds
ds_read_b128 a[180:183], v4 offset:9216
v_cvt_pk_bf16_f32 v96, v20, v21
v_cvt_pk_bf16_f32 v97, v22, v23
v_mfma_f32_16x16x32_bf16 a[96:99], a[184:187], a[224:227], a[96:99]
v_accvgpr_read_b32 v24, a36
v_accvgpr_read_b32 v25, a37
v_accvgpr_read_b32 v26, a38
v_accvgpr_read_b32 v27, a39
v_mfma_f32_16x16x32_bf16 a[100:103], a[184:187], a[228:231], a[100:103]
v_cvt_pk_bf16_f32 v100, v24, v25
v_cvt_pk_bf16_f32 v101, v26, v27
v_accvgpr_read_b32 v20, a40
v_accvgpr_read_b32 v21, a41
v_mfma_f32_16x16x32_bf16 a[104:107], a[184:187], a[232:235], a[104:107]
v_accvgpr_read_b32 v22, a42
v_accvgpr_read_b32 v23, a43
v_cvt_pk_bf16_f32 v104, v20, v21
v_cvt_pk_bf16_f32 v105, v22, v23
v_mfma_f32_16x16x32_bf16 a[108:111], a[184:187], a[236:239], a[108:111]
v_accvgpr_read_b32 v24, a44
v_accvgpr_read_b32 v25, a45
v_accvgpr_read_b32 v26, a46
v_accvgpr_read_b32 v27, a47
v_mfma_f32_16x16x32_bf16 a[112:115], a[184:187], a[240:243], a[112:115]
s_add_u32 s48, s48, s34
v_cvt_pk_bf16_f32 v108, v24, v25
v_cvt_pk_bf16_f32 v109, v26, v27
v_accvgpr_read_b32 v20, a48
v_accvgpr_read_b32 v21, a49
v_mfma_f32_16x16x32_bf16 a[116:119], a[184:187], a[244:247], a[116:119]
s_add_u32 m0, s32, 12288
v_accvgpr_read_b32 v22, a50
v_accvgpr_read_b32 v23, a51
v_cvt_pk_bf16_f32 v112, v20, v21
v_cvt_pk_bf16_f32 v113, v22, v23
v_mfma_f32_16x16x32_bf16 a[120:123], a[184:187], a[248:251], a[120:123]
buffer_load_dwordx4 v1, s[12:15], s48 offen lds
v_accvgpr_read_b32 v24, a52
v_accvgpr_read_b32 v25, a53
v_accvgpr_read_b32 v26, a54
v_mfma_f32_16x16x32_bf16 a[124:127], a[184:187], a[252:255], a[124:127]
ds_read_b128 a[184:187], v3 offset:12288
v_accvgpr_read_b32 v27, a55
v_cvt_pk_bf16_f32 v116, v24, v25
v_cvt_pk_bf16_f32 v117, v26, v27
v_mfma_f32_16x16x32_bf16 a[128:131], v[28:31], a[224:227], a[128:131]
v_accvgpr_read_b32 v20, a56
v_accvgpr_read_b32 v21, a57
v_accvgpr_read_b32 v22, a58
v_accvgpr_read_b32 v23, a59
v_mfma_f32_16x16x32_bf16 a[132:135], v[28:31], a[228:231], a[132:135]
v_cvt_pk_bf16_f32 v120, v20, v21
v_cvt_pk_bf16_f32 v121, v22, v23
v_accvgpr_read_b32 v24, a60
v_accvgpr_read_b32 v25, a61
v_mfma_f32_16x16x32_bf16 a[136:139], v[28:31], a[232:235], a[136:139]
buffer_load_dword v15, v14, s[96:99], s100 offen
v_accvgpr_read_b32 v26, a62
v_accvgpr_read_b32 v27, a63
v_cvt_pk_bf16_f32 v124, v24, v25
v_mfma_f32_16x16x32_bf16 a[140:143], v[28:31], a[236:239], a[140:143]
s_add_u32 s100, s100, 16384
v_cvt_pk_bf16_f32 v125, v26, v27
v_mfma_f32_16x16x32_bf16 a[144:147], v[28:31], a[240:243], a[144:147]
v_mfma_f32_16x16x32_bf16 a[148:151], v[28:31], a[244:247], a[148:151]
v_mfma_f32_16x16x32_bf16 a[152:155], v[28:31], a[248:251], a[152:155]
v_mfma_f32_16x16x32_bf16 a[156:159], v[28:31], a[252:255], a[156:159]
s_cmp_lt_u32 s35, s45
s_cbranch_scc1 L_g_tile
s_branch L_g_end
L_g_first:
s_mov_b32 s100, 536870912
s_cmp_eq_u32 s61, 0
s_cbranch_scc0 L_g_end
v_mov_b32 v20, 128
s_mov_b32 s28, 0
L_poll_8:
buffer_load_dword v21, v20, s[56:59], 0 offen sc1
s_add_u32 s28, s28, 1
s_cmp_gt_u32 s28, 40000
s_cbranch_scc1 L_end
s_waitcnt vmcnt(0)
v_cmp_ne_u32 vcc, 8, v21
s_cbranch_vccz L_pd_9
s_sleep 1
s_branch L_poll_8
L_pd_9:
s_branch L_g_go
L_g_end:
v_bfe_u32 v16, v0, 3, 3
v_lshlrev_b32 v16, 4, v16
v_and_or_b32 v16, v0, 7, v16
v_bfe_u32 v17, v0, 4, 2
v_lshlrev_b32 v17, 5, v17
v_bfe_u32 v18, v0, 1, 3
v_or_b32 v17, v17, v18
v_and_b32 v18, 1, v0
v_lshl_or_b32 v17, v18, 4, v17
s_bitcmp1_b32 s50, 1
s_cselect_b64 vcc, -1, 0
s_movk_i32 s44, 0x80
v_cndmask_b32 v16, v16, v17, vcc
v_lshlrev_b32 v13, 4, v16
s_lshr_b32 s93, s50, 2
s_lshr_b32 s93, 0x80000, s93
s_bitcmp1_b32 s50, 0
s_cselect_b32 s92, s93, 0x800
s_cselect_b32 s93, 0x800, s93
s_sub_u32 s93, s93, s44
s_and_b32 s24, s17, s91
s_cbranch_scc0 L_g_h1
s_barrier
L_g_h1:
v_pk_mul_f32 v[20:21], v[160:161], s[94:95] op_sel_hi:[1,0]
v_pk_mul_f32 v[22:23], v[162:163], s[94:95] op_sel_hi:[1,0]
v_cvt_pk_bf16_f32 v32, v20, v21
v_cvt_pk_bf16_f32 v33, v22, v23
v_pk_mul_f32 v[20:21], v[192:193], s[94:95] op_sel_hi:[1,0]
v_pk_mul_f32 v[22:23], v[194:195], s[94:95] op_sel_hi:[1,0]
v_cvt_pk_bf16_f32 v34, v20, v21
v_cvt_pk_bf16_f32 v35, v22, v23
s_mov_b32 s60, s62
s_mov_b32 s29, s62
buffer_store_dwordx4 v[32:35], v13, s[8:11], s29 offen sc1
v_pk_mul_f32 v[24:25], v[164:165], s[94:95] op_sel_hi:[1,0]
v_pk_mul_f32 v[26:27], v[166:167], s[94:95] op_sel_hi:[1,0]
v_cvt_pk_bf16_f32 v36, v24, v25
v_cvt_pk_bf16_f32 v37, v26, v27
v_pk_mul_f32 v[24:25], v[196:197], s[94:95] op_sel_hi:[1,0]
v_pk_mul_f32 v[26:27], v[198:199], s[94:95] op_sel_hi:[1,0]
v_cvt_pk_bf16_f32 v38, v24, v25
v_cvt_pk_bf16_f32 v39, v26, v27
s_add_u32 s29, s29, s44
buffer_store_dwordx4 v[36:39], v13, s[8:11], s29 offen sc1
v_pk_mul_f32 v[20:21], v[168:169], s[94:95] op_sel_hi:[1,0]
v_pk_mul_f32 v[22:23], v[170:171], s[94:95] op_sel_hi:[1,0]
v_cvt_pk_bf16_f32 v40, v20, v21
v_cvt_pk_bf16_f32 v41, v22, v23
v_pk_mul_f32 v[20:21], v[200:201], s[94:95] op_sel_hi:[1,0]
v_pk_mul_f32 v[22:23], v[202:203], s[94:95] op_sel_hi:[1,0]
v_cvt_pk_bf16_f32 v42, v20, v21
v_cvt_pk_bf16_f32 v43, v22, v23
s_add_u32 s29, s29, s93
buffer_store_dwordx4 v[40:43], v13, s[8:11], s29 offen sc1
v_pk_mul_f32 v[24:25], v[172:173], s[94:95] op_sel_hi:[1,0]
v_pk_mul_f32 v[26:27], v[174:175], s[94:95] op_sel_hi:[1,0]
v_cvt_pk_bf16_f32 v44, v24, v25
v_cvt_pk_bf16_f32 v45, v26, v27
v_pk_mul_f32 v[24:25], v[204:205], s[94:95] op_sel_hi:[1,0]
v_pk_mul_f32 v[26:27], v[206:207], s[94:95] op_sel_hi:[1,0]
v_cvt_pk_bf16_f32 v46, v24, v25
v_cvt_pk_bf16_f32 v47, v26, v27
s_add_u32 s29, s29, s44
buffer_store_dwordx4 v[44:47], v13, s[8:11], s29 offen sc1
v_pk_mul_f32 v[20:21], v[176:177], s[94:95] op_sel_hi:[1,0]
v_pk_mul_f32 v[22:23], v[178:179], s[94:95] op_sel_hi:[1,0]
v_cvt_pk_bf16_f32 v48, v20, v21
v_cvt_pk_bf16_f32 v49, v22, v23
v_pk_mul_f32 v[20:21], v[208:209], s[94:95] op_sel_hi:[1,0]
v_pk_mul_f32 v[22:23], v[210:211], s[94:95] op_sel_hi:[1,0]
v_cvt_pk_bf16_f32 v50, v20, v21
v_cvt_pk_bf16_f32 v51, v22, v23
s_add_u32 s29, s29, s93
buffer_store_dwordx4 v[48:51], v13, s[8:11], s29 offen sc1
v_pk_mul_f32 v[24:25], v[180:181], s[94:95] op_sel_hi:[1,0]
v_pk_mul_f32 v[26:27], v[182:183], s[94:95] op_sel_hi:[1,0]
v_cvt_pk_bf16_f32 v52, v24, v25
v_cvt_pk_bf16_f32 v53, v26, v27
v_pk_mul_f32 v[24:25], v[212:213], s[94:95] op_sel_hi:[1,0]
v_pk_mul_f32 v[26:27], v[214:215], s[94:95] op_sel_hi:[1,0]
v_cvt_pk_bf16_f32 v54, v24, v25
v_cvt_pk_bf16_f32 v55, v26, v27
s_add_u32 s29, s29, s44
buffer_store_dwordx4 v[52:55], v13, s[8:11], s29 offen sc1
v_pk_mul_f32 v[20:21], v[184:185], s[94:95] op_sel_hi:[1,0]
v_pk_mul_f32 v[22:23], v[186:187], s[94:95] op_sel_hi:[1,0]
v_cvt_pk_bf16_f32 v56, v20, v21
v_cvt_pk_bf16_f32 v57, v22, v23
v_pk_mul_f32 v[20:21], v[216:217], s[94:95] op_sel_hi:[1,0]
v_pk_mul_f32 v[22:23], v[218:219], s[94:95] op_sel_hi:[1,0]
v_cvt_pk_bf16_f32 v58, v20, v21
v_cvt_pk_bf16_f32 v59, v22, v23
s_add_u32 s29, s29, s93
buffer_store_dwordx4 v[56:59], v13, s[8:11], s29 offen sc1
v_pk_mul_f32 v[24:25], v[188:189], s[94:95] op_sel_hi:[1,0]
v_pk_mul_f32 v[26:27], v[190:191], s[94:95] op_sel_hi:[1,0]
v_cvt_pk_bf16_f32 v60, v24, v25
v_cvt_pk_bf16_f32 v61, v26, v27
v_pk_mul_f32 v[24:25], v[220:221], s[94:95] op_sel_hi:[1,0]
v_pk_mul_f32 v[26:27], v[222:223], s[94:95] op_sel_hi:[1,0]
v_cvt_pk_bf16_f32 v62, v24, v25
v_cvt_pk_bf16_f32 v63, v26, v27
s_add_u32 s29, s29, s44
buffer_store_dwordx4 v[60:63], v13, s[8:11], s29 offen sc1
v_pk_mul_f32 v[20:21], v[224:225], s[94:95] op_sel_hi:[1,0]
v_pk_mul_f32 v[22:23], v[226:227], s[94:95] op_sel_hi:[1,0]
v_cvt_pk_bf16_f32 v64, v20, v21
v_cvt_pk_bf16_f32 v65, v22, v23
v_accvgpr_read_b32 v20, a0
v_accvgpr_read_b32 v21, a1
v_accvgpr_read_b32 v22, a2
v_accvgpr_read_b32 v23, a3
v_pk_mul_f32 v[20:21], v[20:21], s[94:95] op_sel_hi:[1,0]
v_pk_mul_f32 v[22:23], v[22:23], s[94:95] op_sel_hi:[1,0]
v_cvt_pk_bf16_f32 v66, v20, v21
v_cvt_pk_bf16_f32 v67, v22, v23
s_add_u32 s60, s60, s92
s_mov_b32 s29, s60
buffer_store_dwordx4 v[64:67], v13, s[8:11], s29 offen sc1
v_pk_mul_f32 v[24:25], v[228:229], s[94:95] op_sel_hi:[1,0]
v_pk_mul_f32 v[26:27], v[230:231], s[94:95] op_sel_hi:[1,0]
v_cvt_pk_bf16_f32 v68, v24, v25
v_cvt_pk_bf16_f32 v69, v26, v27
v_accvgpr_read_b32 v24, a4
v_accvgpr_read_b32 v25, a5
v_accvgpr_read_b32 v26, a6
v_accvgpr_read_b32 v27, a7
v_pk_mul_f32 v[24:25], v[24:25], s[94:95] op_sel_hi:[1,0]
v_pk_mul_f32 v[26:27], v[26:27], s[94:95] op_sel_hi:[1,0]
v_cvt_pk_bf16_f32 v70, v24, v25
v_cvt_pk_bf16_f32 v71, v26, v27
s_add_u32 s29, s29, s44
buffer_store_dwordx4 v[68:71], v13, s[8:11], s29 offen sc1
v_pk_mul_f32 v[20:21], v[232:233], s[94:95] op_sel_hi:[1,0]
v_pk_mul_f32 v[22:23], v[234:235], s[94:95] op_sel_hi:[1,0]
v_cvt_pk_bf16_f32 v72, v20, v21
v_cvt_pk_bf16_f32 v73, v22, v23
v_accvgpr_read_b32 v20, a8
v_accvgpr_read_b32 v21, a9
v_accvgpr_read_b32 v22, a10
v_accvgpr_read_b32 v23, a11
v_pk_mul_f32 v[20:21], v[20:21], s[94:95] op_sel_hi:[1,0]
v_pk_mul_f32 v[22:23], v[22:23], s[94:95] op_sel_hi:[1,0]
v_cvt_pk_bf16_f32 v74, v20, v21
v_cvt_pk_bf16_f32 v75, v22, v23
s_add_u32 s29, s29, s93
buffer_store_dwordx4 v[72:75], v13, s[8:11], s29 offen sc1
v_pk_mul_f32 v[24:25], v[236:237], s[94:95] op_sel_hi:[1,0]
v_pk_mul_f32 v[26:27], v[238:239], s[94:95] op_sel_hi:[1,0]
v_cvt_pk_bf16_f32 v76, v24, v25
v_cvt_pk_bf16_f32 v77, v26, v27
v_accvgpr_read_b32 v24, a12
v_accvgpr_read_b32 v25, a13
v_accvgpr_read_b32 v26, a14
v_accvgpr_read_b32 v27, a15
v_pk_mul_f32 v[24:25], v[24:25], s[94:95] op_sel_hi:[1,0]
v_pk_mul_f32 v[26:27], v[26:27], s[94:95] op_sel_hi:[1,0]
v_cvt_pk_bf16_f32 v78, v24, v25
v_cvt_pk_bf16_f32 v79, v26, v27
s_add_u32 s29, s29, s44
buffer_store_dwordx4 v[76:79], v13, s[8:11], s29 offen sc1
v_pk_mul_f32 v[20:21], v[240:241], s[94:95] op_sel_hi:[1,0]
v_pk_mul_f32 v[22:23], v[242:243], s[94:95] op_sel_hi:[1,0]
v_cvt_pk_bf16_f32 v80, v20, v21
v_cvt_pk_bf16_f32 v81, v22, v23
v_accvgpr_read_b32 v20, a16
v_accvgpr_read_b32 v21, a17
v_accvgpr_read_b32 v22, a18
v_accvgpr_read_b32 v23, a19
v_pk_mul_f32 v[20:21], v[20:21], s[94:95] op_sel_hi:[1,0]
v_pk_mul_f32 v[22:23], v[22:23], s[94:95] op_sel_hi:[1,0]
v_cvt_pk_bf16_f32 v82, v20, v21
v_cvt_pk_bf16_f32 v83, v22, v23
s_add_u32 s29, s29, s93
buffer_store_dwordx4 v[80:83], v13, s[8:11], s29 offen sc1
v_pk_mul_f32 v[24:25], v[244:245], s[94:95] op_sel_hi:[1,0]
v_pk_mul_f32 v[26:27], v[246:247], s[94:95] op_sel_hi:[1,0]
v_cvt_pk_bf16_f32 v84, v24, v25
v_cvt_pk_bf16_f32 v85, v26, v27
v_accvgpr_read_b32 v24, a20
v_accvgpr_read_b32 v25, a21
v_accvgpr_read_b32 v26, a22
v_accvgpr_read_b32 v27, a23
v_pk_mul_f32 v[24:25], v[24:25], s[94:95] op_sel_hi:[1,0]
v_pk_mul_f32 v[26:27], v[26:27], s[94:95] op_sel_hi:[1,0]
v_cvt_pk_bf16_f32 v86, v24, v25
v_cvt_pk_bf16_f32 v87, v26, v27
s_add_u32 s29, s29, s44
buffer_store_dwordx4 v[84:87], v13, s[8:11], s29 offen sc1
v_pk_mul_f32 v[20:21], v[248:249], s[94:95] op_sel_hi:[1,0]
v_pk_mul_f32 v[22:23], v[250:251], s[94:95] op_sel_hi:[1,0]
v_cvt_pk_bf16_f32 v88, v20, v21
v_cvt_pk_bf16_f32 v89, v22, v23
v_accvgpr_read_b32 v20, a24
v_accvgpr_read_b32 v21, a25
v_accvgpr_read_b32 v22, a26
v_accvgpr_read_b32 v23, a27
v_pk_mul_f32 v[20:21], v[20:21], s[94:95] op_sel_hi:[1,0]
v_pk_mul_f32 v[22:23], v[22:23], s[94:95] op_sel_hi:[1,0]
v_cvt_pk_bf16_f32 v90, v20, v21
v_cvt_pk_bf16_f32 v91, v22, v23
s_add_u32 s29, s29, s93
buffer_store_dwordx4 v[88:91], v13, s[8:11], s29 offen sc1
v_pk_mul_f32 v[24:25], v[252:253], s[94:95] op_sel_hi:[1,0]
v_pk_mul_f32 v[26:27], v[254:255], s[94:95] op_sel_hi:[1,0]
v_cvt_pk_bf16_f32 v92, v24, v25
v_cvt_pk_bf16_f32 v93, v26, v27
v_accvgpr_read_b32 v24, a28
v_accvgpr_read_b32 v25, a29
v_accvgpr_read_b32 v26, a30
v_accvgpr_read_b32 v27, a31
v_pk_mul_f32 v[24:25], v[24:25], s[94:95] op_sel_hi:[1,0]
v_pk_mul_f32 v[26:27], v[26:27], s[94:95] op_sel_hi:[1,0]
v_cvt_pk_bf16_f32 v94, v24, v25
v_cvt_pk_bf16_f32 v95, v26, v27
s_add_u32 s29, s29, s44
buffer_store_dwordx4 v[92:95], v13, s[8:11], s29 offen sc1
v_accvgpr_read_b32 v20, a32
v_accvgpr_read_b32 v21, a33
v_accvgpr_read_b32 v22, a34
v_accvgpr_read_b32 v23, a35
v_pk_mul_f32 v[20:21], v[20:21], s[94:95] op_sel_hi:[1,0]
v_pk_mul_f32 v[22:23], v[22:23], s[94:95] op_sel_hi:[1,0]
v_cvt_pk_bf16_f32 v96, v20, v21
v_cvt_pk_bf16_f32 v97, v22, v23
v_accvgpr_read_b32 v20, a64
v_accvgpr_read_b32 v21, a65
v_accvgpr_read_b32 v22, a66
v_accvgpr_read_b32 v23, a67
v_pk_mul_f32 v[20:21], v[20:21], s[94:95] op_sel_hi:[1,0]
v_pk_mul_f32 v[22:23], v[22:23], s[94:95] op_sel_hi:[1,0]
v_cvt_pk_bf16_f32 v98, v20, v21
v_cvt_pk_bf16_f32 v99, v22, v23
s_add_u32 s60, s60, s92
s_mov_b32 s29, s60
buffer_store_dwordx4 v[96:99], v13, s[8:11], s29 offen sc1
v_accvgpr_read_b32 v24, a36
v_accvgpr_read_b32 v25, a37
v_accvgpr_read_b32 v26, a38
v_accvgpr_read_b32 v27, a39
v_pk_mul_f32 v[24:25], v[24:25], s[94:95] op_sel_hi:[1,0]
v_pk_mul_f32 v[26:27], v[26:27], s[94:95] op_sel_hi:[1,0]
v_cvt_pk_bf16_f32 v100, v24, v25
v_cvt_pk_bf16_f32 v101, v26, v27
v_accvgpr_read_b32 v24, a68
v_accvgpr_read_b32 v25, a69
v_accvgpr_read_b32 v26, a70
v_accvgpr_read_b32 v27, a71
v_pk_mul_f32 v[24:25], v[24:25], s[94:95] op_sel_hi:[1,0]
v_pk_mul_f32 v[26:27], v[26:27], s[94:95] op_sel_hi:[1,0]
v_cvt_pk_bf16_f32 v102, v24, v25
v_cvt_pk_bf16_f32 v103, v26, v27
s_add_u32 s29, s29, s44
buffer_store_dwordx4 v[100:103], v13, s[8:11], s29 offen sc1
v_accvgpr_read_b32 v20, a40
v_accvgpr_read_b32 v21, a41
v_accvgpr_read_b32 v22, a42
v_accvgpr_read_b32 v23, a43
v_pk_mul_f32 v[20:21], v[20:21], s[94:95] op_sel_hi:[1,0]
v_pk_mul_f32 v[22:23], v[22:23], s[94:95] op_sel_hi:[1,0]
v_cvt_pk_bf16_f32 v104, v20, v21
v_cvt_pk_bf16_f32 v105, v22, v23
v_accvgpr_read_b32 v20, a72
v_accvgpr_read_b32 v21, a73
v_accvgpr_read_b32 v22, a74
v_accvgpr_read_b32 v23, a75
v_pk_mul_f32 v[20:21], v[20:21], s[94:95] op_sel_hi:[1,0]
v_pk_mul_f32 v[22:23], v[22:23], s[94:95] op_sel_hi:[1,0]
v_cvt_pk_bf16_f32 v106, v20, v21
v_cvt_pk_bf16_f32 v107, v22, v23
s_add_u32 s29, s29, s93
buffer_store_dwordx4 v[104:107], v13, s[8:11], s29 offen sc1
v_accvgpr_read_b32 v24, a44
v_accvgpr_read_b32 v25, a45
v_accvgpr_read_b32 v26, a46
v_accvgpr_read_b32 v27, a47
v_pk_mul_f32 v[24:25], v[24:25], s[94:95] op_sel_hi:[1,0]
v_pk_mul_f32 v[26:27], v[26:27], s[94:95] op_sel_hi:[1,0]
v_cvt_pk_bf16_f32 v108, v24, v25
v_cvt_pk_bf16_f32 v109, v26, v27
v_accvgpr_read_b32 v24, a76
v_accvgpr_read_b32 v25, a77
v_accvgpr_read_b32 v26, a78
v_accvgpr_read_b32 v27, a79
v_pk_mul_f32 v[24:25], v[24:25], s[94:95] op_sel_hi:[1,0]
v_pk_mul_f32 v[26:27], v[26:27], s[94:95] op_sel_hi:[1,0]
v_cvt_pk_bf16_f32 v110, v24, v25
v_cvt_pk_bf16_f32 v111, v26, v27
s_add_u32 s29, s29, s44
buffer_store_dwordx4 v[108:111], v13, s[8:11], s29 offen sc1
v_accvgpr_read_b32 v20, a48
v_accvgpr_read_b32 v21, a49
v_accvgpr_read_b32 v22, a50
v_accvgpr_read_b32 v23, a51
v_pk_mul_f32 v[20:21], v[20:21], s[94:95] op_sel_hi:[1,0]
v_pk_mul_f32 v[22:23], v[22:23], s[94:95] op_sel_hi:[1,0]
v_cvt_pk_bf16_f32 v112, v20, v21
v_cvt_pk_bf16_f32 v113, v22, v23
v_accvgpr_read_b32 v20, a80
v_accvgpr_read_b32 v21, a81
v_accvgpr_read_b32 v22, a82
v_accvgpr_read_b32 v23, a83
v_pk_mul_f32 v[20:21], v[20:21], s[94:95] op_sel_hi:[1,0]
v_pk_mul_f32 v[22:23], v[22:23], s[94:95] op_sel_hi:[1,0]
v_cvt_pk_bf16_f32 v114, v20, v21
v_cvt_pk_bf16_f32 v115, v22, v23
s_add_u32 s29, s29, s93
buffer_store_dwordx4 v[112:115], v13, s[8:11], s29 offen sc1
v_accvgpr_read_b32 v24, a52
v_accvgpr_read_b32 v25, a53
v_accvgpr_read_b32 v26, a54
v_accvgpr_read_b32 v27, a55
v_pk_mul_f32 v[24:25], v[24:25], s[94:95] op_sel_hi:[1,0]
v_pk_mul_f32 v[26:27], v[26:27], s[94:95] op_sel_hi:[1,0]
v_cvt_pk_bf16_f32 v116, v24, v25
v_cvt_pk_bf16_f32 v117, v26, v27
v_accvgpr_read_b32 v24, a84
v_accvgpr_read_b32 v25, a85
v_accvgpr_read_b32 v26, a86
v_accvgpr_read_b32 v27, a87
v_pk_mul_f32 v[24:25], v[24:25], s[94:95] op_sel_hi:[1,0]
v_pk_mul_f32 v[26:27], v[26:27], s[94:95] op_sel_hi:[1,0]
v_cvt_pk_bf16_f32 v118, v24, v25
v_cvt_pk_bf16_f32 v119, v26, v27
s_add_u32 s29, s29, s44
buffer_store_dwordx4 v[116:119], v13, s[8:11], s29 offen sc1
v_accvgpr_read_b32 v20, a56
v_accvgpr_read_b32 v21, a57
v_accvgpr_read_b32 v22, a58
v_accvgpr_read_b32 v23, a59
v_pk_mul_f32 v[20:21], v[20:21], s[94:95] op_sel_hi:[1,0]
v_pk_mul_f32 v[22:23], v[22:23], s[94:95] op_sel_hi:[1,0]
v_cvt_pk_bf16_f32 v120, v20, v21
v_cvt_pk_bf16_f32 v121, v22, v23
v_accvgpr_read_b32 v20, a88
v_accvgpr_read_b32 v21, a89
v_accvgpr_read_b32 v22, a90
v_accvgpr_read_b32 v23, a91
v_pk_mul_f32 v[20:21], v[20:21], s[94:95] op_sel_hi:[1,0]
v_pk_mul_f32 v[22:23], v[22:23], s[94:95] op_sel_hi:[1,0]
v_cvt_pk_bf16_f32 v122, v20, v21
v_cvt_pk_bf16_f32 v123, v22, v23
s_add_u32 s29, s29, s93
buffer_store_dwordx4 v[120:123], v13, s[8:11], s29 offen sc1
v_accvgpr_read_b32 v24, a60
v_accvgpr_read_b32 v25, a61
v_accvgpr_read_b32 v26, a62
v_accvgpr_read_b32 v27, a63
v_pk_mul_f32 v[24:25], v[24:25], s[94:95] op_sel_hi:[1,0]
v_pk_mul_f32 v[26:27], v[26:27], s[94:95] op_sel_hi:[1,0]
v_cvt_pk_bf16_f32 v124, v24, v25
v_cvt_pk_bf16_f32 v125, v26, v27
v_accvgpr_read_b32 v24, a92
v_accvgpr_read_b32 v25, a93
v_accvgpr_read_b32 v26, a94
v_accvgpr_read_b32 v27, a95
v_pk_mul_f32 v[24:25], v[24:25], s[94:95] op_sel_hi:[1,0]
v_pk_mul_f32 v[26:27], v[26:27], s[94:95] op_sel_hi:[1,0]
v_cvt_pk_bf16_f32 v126, v24, v25
v_cvt_pk_bf16_f32 v127, v26, v27
s_add_u32 s29, s29, s44
buffer_store_dwordx4 v[124:127], v13, s[8:11], s29 offen sc1
v_accvgpr_read_b32 v20, a96
v_accvgpr_read_b32 v21, a97
v_accvgpr_read_b32 v22, a98
v_accvgpr_read_b32 v23, a99
v_pk_mul_f32 v[20:21], v[20:21], s[94:95] op_sel_hi:[1,0]
v_pk_mul_f32 v[22:23], v[22:23], s[94:95] op_sel_hi:[1,0]
v_cvt_pk_bf16_f32 v128, v20, v21
v_cvt_pk_bf16_f32 v129, v22, v23
v_accvgpr_read_b32 v20, a128
v_accvgpr_read_b32 v21, a129
v_accvgpr_read_b32 v22, a130
v_accvgpr_read_b32 v23, a131
v_pk_mul_f32 v[20:21], v[20:21], s[94:95] op_sel_hi:[1,0]
v_pk_mul_f32 v[22:23], v[22:23], s[94:95] op_sel_hi:[1,0]
v_cvt_pk_bf16_f32 v130, v20, v21
v_cvt_pk_bf16_f32 v131, v22, v23
s_add_u32 s60, s60, s92
s_mov_b32 s29, s60
buffer_store_dwordx4 v[128:131], v13, s[8:11], s29 offen sc1
v_accvgpr_read_b32 v24, a100
v_accvgpr_read_b32 v25, a101
v_accvgpr_read_b32 v26, a102
v_accvgpr_read_b32 v27, a103
v_pk_mul_f32 v[24:25], v[24:25], s[94:95] op_sel_hi:[1,0]
v_pk_mul_f32 v[26:27], v[26:27], s[94:95] op_sel_hi:[1,0]
v_cvt_pk_bf16_f32 v132, v24, v25
v_cvt_pk_bf16_f32 v133, v26, v27
v_accvgpr_read_b32 v24, a132
v_accvgpr_read_b32 v25, a133
v_accvgpr_read_b32 v26, a134
v_accvgpr_read_b32 v27, a135
v_pk_mul_f32 v[24:25], v[24:25], s[94:95] op_sel_hi:[1,0]
v_pk_mul_f32 v[26:27], v[26:27], s[94:95] op_sel_hi:[1,0]
v_cvt_pk_bf16_f32 v134, v24, v25
v_cvt_pk_bf16_f32 v135, v26, v27
s_add_u32 s29, s29, s44
buffer_store_dwordx4 v[132:135], v13, s[8:11], s29 offen sc1
v_accvgpr_read_b32 v20, a104
v_accvgpr_read_b32 v21, a105
v_accvgpr_read_b32 v22, a106
v_accvgpr_read_b32 v23, a107
v_pk_mul_f32 v[20:21], v[20:21], s[94:95] op_sel_hi:[1,0]
v_pk_mul_f32 v[22:23], v[22:23], s[94:95] op_sel_hi:[1,0]
v_cvt_pk_bf16_f32 v136, v20, v21
v_cvt_pk_bf16_f32 v137, v22, v23
v_accvgpr_read_b32 v20, a136
v_accvgpr_read_b32 v21, a137
v_accvgpr_read_b32 v22, a138
v_accvgpr_read_b32 v23, a139
v_pk_mul_f32 v[20:21], v[20:21], s[94:95] op_sel_hi:[1,0]
v_pk_mul_f32 v[22:23], v[22:23], s[94:95] op_sel_hi:[1,0]
v_cvt_pk_bf16_f32 v138, v20, v21
v_cvt_pk_bf16_f32 v139, v22, v23
s_add_u32 s29, s29, s93
buffer_store_dwordx4 v[136:139], v13, s[8:11], s29 offen sc1
v_accvgpr_read_b32 v24, a108
v_accvgpr_read_b32 v25, a109
v_accvgpr_read_b32 v26, a110
v_accvgpr_read_b32 v27, a111
v_pk_mul_f32 v[24:25], v[24:25], s[94:95] op_sel_hi:[1,0]
v_pk_mul_f32 v[26:27], v[26:27], s[94:95] op_sel_hi:[1,0]
v_cvt_pk_bf16_f32 v140, v24, v25
v_cvt_pk_bf16_f32 v141, v26, v27
v_accvgpr_read_b32 v24, a140
v_accvgpr_read_b32 v25, a141
v_accvgpr_read_b32 v26, a142
v_accvgpr_read_b32 v27, a143
v_pk_mul_f32 v[24:25], v[24:25], s[94:95] op_sel_hi:[1,0]
v_pk_mul_f32 v[26:27], v[26:27], s[94:95] op_sel_hi:[1,0]
v_cvt_pk_bf16_f32 v142, v24, v25
v_cvt_pk_bf16_f32 v143, v26, v27
s_add_u32 s29, s29, s44
buffer_store_dwordx4 v[140:143], v13, s[8:11], s29 offen sc1
v_accvgpr_read_b32 v20, a112
v_accvgpr_read_b32 v21, a113
v_accvgpr_read_b32 v22, a114
v_accvgpr_read_b32 v23, a115
v_pk_mul_f32 v[20:21], v[20:21], s[94:95] op_sel_hi:[1,0]
v_pk_mul_f32 v[22:23], v[22:23], s[94:95] op_sel_hi:[1,0]
v_cvt_pk_bf16_f32 v144, v20, v21
v_cvt_pk_bf16_f32 v145, v22, v23
v_accvgpr_read_b32 v20, a144
v_accvgpr_read_b32 v21, a145
v_accvgpr_read_b32 v22, a146
v_accvgpr_read_b32 v23, a147
v_pk_mul_f32 v[20:21], v[20:21], s[94:95] op_sel_hi:[1,0]
v_pk_mul_f32 v[22:23], v[22:23], s[94:95] op_sel_hi:[1,0]
v_cvt_pk_bf16_f32 v146, v20, v21
v_cvt_pk_bf16_f32 v147, v22, v23
s_add_u32 s29, s29, s93
buffer_store_dwordx4 v[144:147], v13, s[8:11], s29 offen sc1
v_accvgpr_read_b32 v24, a116
v_accvgpr_read_b32 v25, a117
v_accvgpr_read_b32 v26, a118
v_accvgpr_read_b32 v27, a119
v_pk_mul_f32 v[24:25], v[24:25], s[94:95] op_sel_hi:[1,0]
v_pk_mul_f32 v[26:27], v[26:27], s[94:95] op_sel_hi:[1,0]
v_cvt_pk_bf16_f32 v148, v24, v25
v_cvt_pk_bf16_f32 v149, v26, v27
v_accvgpr_read_b32 v24, a148
v_accvgpr_read_b32 v25, a149
v_accvgpr_read_b32 v26, a150
v_accvgpr_read_b32 v27, a151
v_pk_mul_f32 v[24:25], v[24:25], s[94:95] op_sel_hi:[1,0]
v_pk_mul_f32 v[26:27], v[26:27], s[94:95] op_sel_hi:[1,0]
v_cvt_pk_bf16_f32 v150, v24, v25
v_cvt_pk_bf16_f32 v151, v26, v27
s_add_u32 s29, s29, s44
buffer_store_dwordx4 v[148:151], v13, s[8:11], s29 offen sc1
v_accvgpr_read_b32 v20, a120
v_accvgpr_read_b32 v21, a121
v_accvgpr_read_b32 v22, a122
v_accvgpr_read_b32 v23, a123
v_pk_mul_f32 v[20:21], v[20:21], s[94:95] op_sel_hi:[1,0]
v_pk_mul_f32 v[22:23], v[22:23], s[94:95] op_sel_hi:[1,0]
v_cvt_pk_bf16_f32 v152, v20, v21
v_cvt_pk_bf16_f32 v153, v22, v23
v_accvgpr_read_b32 v20, a152
v_accvgpr_read_b32 v21, a153
v_accvgpr_read_b32 v22, a154
v_accvgpr_read_b32 v23, a155
v_pk_mul_f32 v[20:21], v[20:21], s[94:95] op_sel_hi:[1,0]
v_pk_mul_f32 v[22:23], v[22:23], s[94:95] op_sel_hi:[1,0]
v_cvt_pk_bf16_f32 v154, v20, v21
v_cvt_pk_bf16_f32 v155, v22, v23
s_add_u32 s29, s29, s93
buffer_store_dwordx4 v[152:155], v13, s[8:11], s29 offen sc1
v_accvgpr_read_b32 v24, a124
v_accvgpr_read_b32 v25, a125
v_accvgpr_read_b32 v26, a126
v_accvgpr_read_b32 v27, a127
v_pk_mul_f32 v[24:25], v[24:25], s[94:95] op_sel_hi:[1,0]
v_pk_mul_f32 v[26:27], v[26:27], s[94:95] op_sel_hi:[1,0]
v_cvt_pk_bf16_f32 v156, v24, v25
v_cvt_pk_bf16_f32 v157, v26, v27
v_accvgpr_read_b32 v24, a156
v_accvgpr_read_b32 v25, a157
v_accvgpr_read_b32 v26, a158
v_accvgpr_read_b32 v27, a159
v_pk_mul_f32 v[24:25], v[24:25], s[94:95] op_sel_hi:[1,0]
v_pk_mul_f32 v[26:27], v[26:27], s[94:95] op_sel_hi:[1,0]
v_cvt_pk_bf16_f32 v158, v24, v25
v_cvt_pk_bf16_f32 v159, v26, v27
s_add_u32 s29, s29, s44
buffer_store_dwordx4 v[156:159], v13, s[8:11], s29 offen sc1
v_mov_b32 v20, 128
s_mov_b32 s28, 0
L_poll_10:
buffer_load_dword v21, v20, s[56:59], 0 offen sc1
s_add_u32 s28, s28, 1
s_cmp_gt_u32 s28, 40000
s_cbranch_scc1 L_end
s_waitcnt vmcnt(0)
v_cmp_ne_u32 vcc, 8, v21
s_cbranch_vccz L_pd_11
s_sleep 1
s_branch L_poll_10
L_pd_11:
s_andn2_b32 s24, s91, s17
s_cbranch_scc0 L_g_h2
s_barrier
s_add_u32 s60, s63, 32
v_mov_b32 v16, 0
v_mov_b32 v17, 1
s_cmp_eq_u32 s17, 0
s_cselect_b32 s29, s60, 536870912
s_mov_b64 exec, 1
buffer_store_dword v17, v16, s[8:11], s29 offen sc1
s_mov_b64 exec, -1
L_g_h2:
s_waitcnt vmcnt(0) lgkmcnt(0)
s_barrier
v_mov_b32 v16, 0
v_mov_b32 v17, 1
s_cmp_eq_u32 s17, 0
s_cselect_b32 s29, s63, 536870912
s_mov_b64 exec, 1
buffer_store_dword v17, v16, s[8:11], s29 offen sc1
s_mov_b64 exec, -1
s_mov_b32 s62, 536870912
s_mov_b32 s63, 536870912
s_cmp_lt_u32 s35, s45
s_cbranch_scc1 L_g_go
s_cmp_eq_u32 s3, 1
s_cbranch_scc1 L_part
s_cmp_eq_u32 s61, 1
s_cbranch_scc1 L_bdie
s_sub_u32 s24, s3, 4
s_lshl_b32 s24, s24, 3
s_lshr_b32 s42, s16, 2
s_add_u32 s42, s42, s24
s_and_b32 s62, s16, 3
s_mov_b32 s40, 0x3e0293ee
s_mov_b32 s50, 0xf149f2ca
s_mov_b32 s51, 0x41a00000
v_and_b32 v20, 7, v0
v_lshlrev_b32 v20, 2, v20
v_bfe_u32 v21, v0, 3, 1
s_lshl_b32 s25, s42, 7
s_add_u32 s25, s25, 111165440
s_lshr_b32 s24, s42, 1
s_lshl_b32 s24, s24, 7
s_add_u32 s24, s24, 111173632
s_sub_u32 s24, s24, s25
v_mad_u32_u24 v20, v21, s24, v20
s_mov_b32 s28, 0
L_poll_12:
buffer_load_dword v21, v20, s[8:11], s25 offen sc1
s_add_u32 s28, s28, 1
s_cmp_gt_u32 s28, 40000
s_cbranch_scc1 L_end
s_waitcnt vmcnt(0)
v_cmp_ne_u32 vcc, 1, v21
s_cbranch_vccz L_pd_13
s_sleep 1
s_branch L_poll_12
L_pd_13:
s_sub_u32 s41, 7, s62
s_mov_b32 s63, s62
v_and_b32 v6, 63, v0
v_lshlrev_b32 v6, 4, v6
v_and_b32 v16, 0x380, v6
s_and_b32 s24, s17, 1
s_lshl_b32 s24, s24, 13
s_lshr_b32 s25, s17, 1
s_lshl_b32 s25, s25, 19
s_add_u32 s24, s24, s25
v_add3_u32 v1, v6, v16, s24
v_and_b32 v16, 0x300, v6
s_and_b32 s24, s17, 1
s_lshl_b32 s24, s24, 8
s_lshr_b32 s25, s17, 1
s_lshl_b32 s25, s25, 18
s_add_u32 s24, s24, s25
v_add3_u32 v7, v6, v16, s24
v_and_b32 v5, 15, v0
s_lshl_b32 s24, s17, 4
v_add_u32 v5, s24, v5
v_bfe_u32 v16, v0, 5, 1
v_lshlrev_b32 v16, 4, v16
v_sub_u32 v5, v5, v16
v_bfe_u32 v16, v0, 4, 1
v_lshlrev_b32 v16, 2, v16
v_sub_u32 v5, v5, v16
v_mov_b32 v8, s50
v_mov_b32 v16, 0x3f803f80
v_accvgpr_write_b32 a240, v16
v_accvgpr_write_b32 a241, v16
v_accvgpr_write_b32 a242, v16
v_accvgpr_write_b32 a243, v16
s_lshl_b32 s47, s17, 13
s_mov_b32 s48, 0
s_mov_b32 s60, 536870912
s_lshl_b32 s46, s42, 14
s_add_u32 s46, s46, 0
s_cmp_lt_u32 s63, 8
s_cselect_b32 s46, s46, 536870912
s_add_u32 s24, s46, 4096
s_add_u32 m0, s47, 0
s_nop 0
buffer_load_dwordx4 v1, s[8:11], s46 offen sc1 lds
buffer_load_dwordx4 v1, s[8:11], s46 offen offset:2048 sc1 lds
s_add_u32 m0, s47, 896
s_nop 0
buffer_load_dwordx4 v1, s[8:11], s46 offen offset:128 sc1 lds
buffer_load_dwordx4 v1, s[8:11], s46 offen offset:2176 sc1 lds
s_add_u32 m0, s47, 4096
s_nop 0
buffer_load_dwordx4 v1, s[8:11], s24 offen sc1 lds
buffer_load_dwordx4 v1, s[8:11], s24 offen offset:2048 sc1 lds
s_add_u32 m0, s47, 4992
s_nop 0
buffer_load_dwordx4 v1, s[8:11], s24 offen offset:128 sc1 lds
buffer_load_dwordx4 v1, s[8:11], s24 offen offset:2176 sc1 lds
s_add_u32 s46, s46, 1048576
s_add_u32 s47, s47, 32768
s_and_b32 s47, s47, 131071
s_lshl_b32 s26, s41, 8
s_add_u32 s26, s26, s42
s_lshl_b32 s26, s26, 13
s_add_u32 s26, s26, 117440512
s_cmp_lt_u32 s41, 8
s_cselect_b32 s26, s26, 536870912
s_add_u32 s27, s26, 0
buffer_load_dwordx4 v[160:163], v7, s[8:11], s27 offen sc1
buffer_load_dwordx4 v[164:167], v7, s[8:11], s27 offen offset:2048 sc1
s_add_u32 s27, s26, 4096
buffer_load_dwordx4 v[168:171], v7, s[8:11], s27 offen sc1
buffer_load_dwordx4 v[172:175], v7, s[8:11], s27 offen offset:2048 sc1
s_add_u32 s27, s26, 524288
buffer_load_dwordx4 v[176:179], v7, s[8:11], s27 offen sc1
buffer_load_dwordx4 v[180:183], v7, s[8:11], s27 offen offset:2048 sc1
s_add_u32 s27, s26, 528384
buffer_load_dwordx4 v[184:187], v7, s[8:11], s27 offen sc1
buffer_load_dwordx4 v[188:191], v7, s[8:11], s27 offen offset:2048 sc1
s_add_u32 s27, s26, 1048576
buffer_load_dwordx4 v[192:195], v7, s[8:11], s27 offen sc1
buffer_load_dwordx4 v[196:199], v7, s[8:11], s27 offen offset:2048 sc1
s_add_u32 s27, s26, 1052672
buffer_load_dwordx4 v[200:203], v7, s[8:11], s27 offen sc1
buffer_load_dwordx4 v[204:207], v7, s[8:11], s27 offen offset:2048 sc1
s_add_u32 s27, s26, 1572864
buffer_load_dwordx4 v[208:211], v7, s[8:11], s27 offen sc1
buffer_load_dwordx4 v[212:215], v7, s[8:11], s27 offen offset:2048 sc1
s_add_u32 s27, s26, 1576960
buffer_load_dwordx4 v[216:219], v7, s[8:11], s27 offen sc1
buffer_load_dwordx4 v[220:223], v7, s[8:11], s27 offen offset:2048 sc1
s_add_u32 s24, s46, 4096
s_add_u32 m0, s47, 0
s_nop 0
buffer_load_dwordx4 v1, s[8:11], s46 offen sc1 lds
buffer_load_dwordx4 v1, s[8:11], s46 offen offset:2048 sc1 lds
s_add_u32 m0, s47, 896
s_nop 0
buffer_load_dwordx4 v1, s[8:11], s46 offen offset:128 sc1 lds
buffer_load_dwordx4 v1, s[8:11], s46 offen offset:2176 sc1 lds
s_add_u32 m0, s47, 4096
s_nop 0
buffer_load_dwordx4 v1, s[8:11], s24 offen sc1 lds
buffer_load_dwordx4 v1, s[8:11], s24 offen offset:2048 sc1 lds
s_add_u32 m0, s47, 4992
s_nop 0
buffer_load_dwordx4 v1, s[8:11], s24 offen offset:128 sc1 lds
buffer_load_dwordx4 v1, s[8:11], s24 offen offset:2176 sc1 lds
s_add_u32 s46, s46, 1048576
s_add_u32 s47, s47, 32768
s_and_b32 s47, s47, 131071
s_add_u32 s24, s46, 4096
s_add_u32 m0, s47, 0
s_nop 0
buffer_load_dwordx4 v1, s[8:11], s46 offen sc1 lds
buffer_load_dwordx4 v1, s[8:11], s46 offen offset:2048 sc1 lds
s_add_u32 m0, s47, 896
s_nop 0
buffer_load_dwordx4 v1, s[8:11], s46 offen offset:128 sc1 lds
buffer_load_dwordx4 v1, s[8:11], s46 offen offset:2176 sc1 lds
s_add_u32 m0, s47, 4096
s_nop 0
buffer_load_dwordx4 v1, s[8:11], s24 offen sc1 lds
buffer_load_dwordx4 v1, s[8:11], s24 offen offset:2048 sc1 lds
s_add_u32 m0, s47, 4992
s_nop 0
buffer_load_dwordx4 v1, s[8:11], s24 offen offset:128 sc1 lds
buffer_load_dwordx4 v1, s[8:11], s24 offen offset:2176 sc1 lds
s_add_u32 s46, s46, 1048576
s_add_u32 s47, s47, 32768
s_and_b32 s47, s47, 131071
s_waitcnt vmcnt(16)
L_at_item:
s_lshl_b32 s44, s41, 2
s_mov_b32 s43, 0
s_mov_b32 s54, s50
s_mov_b32 s55, s50
v_mov_b32 v2, v6
v_add_u32 v3, 32768, v6
v_mov_b32 v4, v6
s_barrier
ds_read_b128 a[64:67], v2
ds_read_b128 a[68:71], v2 offset:1024
ds_read_b128 a[72:75], v2 offset:2048
v_accvgpr_write_b32 a0, v160
v_accvgpr_write_b32 a1, v161
v_accvgpr_write_b32 a2, v162
v_accvgpr_write_b32 a3, v163
v_accvgpr_write_b32 a4, v164
v_accvgpr_write_b32 a5, v165
v_accvgpr_write_b32 a6, v166
v_accvgpr_write_b32 a7, v167
v_accvgpr_write_b32 a8, v168
v_accvgpr_write_b32 a9, v169
v_accvgpr_write_b32 a10, v170
v_accvgpr_write_b32 a11, v171
v_accvgpr_write_b32 a12, v172
v_accvgpr_write_b32 a13, v173
v_accvgpr_write_b32 a14, v174
v_accvgpr_write_b32 a15, v175
v_accvgpr_write_b32 a16, v176
v_accvgpr_write_b32 a17, v177
v_accvgpr_write_b32 a18, v178
v_accvgpr_write_b32 a19, v179
v_accvgpr_write_b32 a20, v180
v_accvgpr_write_b32 a21, v181
v_accvgpr_write_b32 a22, v182
v_accvgpr_write_b32 a23, v183
v_accvgpr_write_b32 a24, v184
v_accvgpr_write_b32 a25, v185
v_accvgpr_write_b32 a26, v186
v_accvgpr_write_b32 a27, v187
v_accvgpr_write_b32 a28, v188
v_accvgpr_write_b32 a29, v189
v_accvgpr_write_b32 a30, v190
v_accvgpr_write_b32 a31, v191
v_accvgpr_write_b32 a32, v192
v_accvgpr_write_b32 a33, v193
v_accvgpr_write_b32 a34, v194
v_accvgpr_write_b32 a35, v195
v_accvgpr_write_b32 a36, v196
v_accvgpr_write_b32 a37, v197
v_accvgpr_write_b32 a38, v198
v_accvgpr_write_b32 a39, v199
v_accvgpr_write_b32 a40, v200
v_accvgpr_write_b32 a41, v201
v_accvgpr_write_b32 a42, v202
v_accvgpr_write_b32 a43, v203
v_accvgpr_write_b32 a44, v204
v_accvgpr_write_b32 a45, v205
v_accvgpr_write_b32 a46, v206
v_accvgpr_write_b32 a47, v207
v_accvgpr_write_b32 a48, v208
v_accvgpr_write_b32 a49, v209
v_accvgpr_write_b32 a50, v210
v_accvgpr_write_b32 a51, v211
v_accvgpr_write_b32 a52, v212
v_accvgpr_write_b32 a53, v213
v_accvgpr_write_b32 a54, v214
v_accvgpr_write_b32 a55, v215
v_accvgpr_write_b32 a56, v216
v_accvgpr_write_b32 a57, v217
v_accvgpr_write_b32 a58, v218
v_accvgpr_write_b32 a59, v219
v_accvgpr_write_b32 a60, v220
v_accvgpr_write_b32 a61, v221
v_accvgpr_write_b32 a62, v222
v_accvgpr_write_b32 a63, v223
v_mov_b64 v[112:113], 0
v_mov_b64 v[114:115], 0
v_mov_b64 v[116:117], 0
v_mov_b64 v[118:119], 0
v_mov_b64 v[120:121], 0
v_mov_b64 v[122:123], 0
v_mov_b64 v[124:125], 0
v_mov_b64 v[126:127], 0
v_mov_b64 v[128:129], 0
v_mov_b64 v[130:131], 0
v_mov_b64 v[132:133], 0
v_mov_b64 v[134:135], 0
v_mov_b64 v[136:137], 0
v_mov_b64 v[138:139], 0
v_mov_b64 v[140:141], 0
v_mov_b64 v[142:143], 0
s_waitcnt lgkmcnt(2)
v_mfma_f32_16x16x32_bf16 v[32:35], a[64:67], a[0:3], v[128:131]
ds_read_b128 a[76:79], v2 offset:3072
s_lshl_b32 s26, s63, 8
v_accvgpr_write_b32 a96, 0
v_accvgpr_write_b32 a97, 0
v_accvgpr_write_b32 a98, 0
v_mfma_f32_16x16x32_bf16 v[40:43], a[64:67], a[16:19], v[132:135]
s_add_u32 s26, s26, s42
v_accvgpr_write_b32 a99, 0
v_accvgpr_write_b32 a100, 0
v_accvgpr_write_b32 a101, 0
v_accvgpr_write_b32 a102, 0
v_accvgpr_write_b32 a103, 0
v_mfma_f32_16x16x32_bf16 v[48:51], a[64:67], a[32:35], v[136:139]
s_lshl_b32 s26, s26, 13
v_accvgpr_write_b32 a104, 0
v_accvgpr_write_b32 a105, 0
v_accvgpr_write_b32 a106, 0
v_accvgpr_write_b32 a107, 0
v_accvgpr_write_b32 a108, 0
v_mfma_f32_16x16x32_bf16 v[56:59], a[64:67], a[48:51], v[140:143]
s_waitcnt lgkmcnt(2)
s_add_u32 s26, s26, 117440512
v_accvgpr_write_b32 a109, 0
v_accvgpr_write_b32 a110, 0
v_accvgpr_write_b32 a111, 0
v_accvgpr_write_b32 a112, 0
v_accvgpr_write_b32 a113, 0
v_mfma_f32_16x16x32_bf16 v[36:39], a[68:71], a[0:3], v[128:131]
ds_read_b128 a[80:83], v2 offset:4096
s_cmp_lt_u32 s63, 8
s_cselect_b32 s26, s26, 536870912
v_accvgpr_write_b32 a114, 0
v_accvgpr_write_b32 a115, 0
v_mfma_f32_16x16x32_bf16 v[44:47], a[68:71], a[16:19], v[132:135]
s_add_u32 s27, s26, 0
v_accvgpr_write_b32 a116, 0
v_accvgpr_write_b32 a117, 0
v_accvgpr_write_b32 a118, 0
v_accvgpr_write_b32 a119, 0
v_accvgpr_write_b32 a120, 0
v_mfma_f32_16x16x32_bf16 v[52:55], a[68:71], a[32:35], v[136:139]
buffer_load_dwordx4 v[160:163], v7, s[8:11], s27 offen sc1
v_accvgpr_write_b32 a121, 0
v_accvgpr_write_b32 a122, 0
v_accvgpr_write_b32 a123, 0
v_accvgpr_write_b32 a124, 0
v_accvgpr_write_b32 a125, 0
v_mfma_f32_16x16x32_bf16 v[60:63], a[68:71], a[48:51], v[140:143]
s_waitcnt lgkmcnt(2)
buffer_load_dwordx4 v[164:167], v7, s[8:11], s27 offen offset:2048 sc1
v_accvgpr_write_b32 a126, 0
v_accvgpr_write_b32 a127, 0
v_accvgpr_write_b32 a128, 0
v_accvgpr_write_b32 a129, 0
v_mfma_f32_16x16x32_bf16 v[32:35], a[72:75], a[4:7], v[32:35]
ds_read_b128 a[84:87], v2 offset:5120
s_add_u32 s27, s26, 4096
v_accvgpr_write_b32 a130, 0
v_accvgpr_write_b32 a131, 0
v_accvgpr_write_b32 a132, 0
v_accvgpr_write_b32 a133, 0
v_mfma_f32_16x16x32_bf16 v[40:43], a[72:75], a[20:23], v[40:43]
buffer_load_dwordx4 v[168:171], v7, s[8:11], s27 offen sc1
v_accvgpr_write_b32 a134, 0
v_accvgpr_write_b32 a135, 0
v_accvgpr_write_b32 a136, 0
v_accvgpr_write_b32 a137, 0
v_mfma_f32_16x16x32_bf16 v[48:51], a[72:75], a[36:39], v[48:51]
v_accvgpr_write_b32 a138, 0
v_accvgpr_write_b32 a139, 0
v_accvgpr_write_b32 a140, 0
v_accvgpr_write_b32 a141, 0
v_accvgpr_write_b32 a142, 0
v_mfma_f32_16x16x32_bf16 v[56:59], a[72:75], a[52:55], v[56:59]
s_waitcnt lgkmcnt(2)
buffer_load_dwordx4 v[172:175], v7, s[8:11], s27 offen offset:2048 sc1
v_accvgpr_write_b32 a143, 0
v_accvgpr_write_b32 a144, 0
v_accvgpr_write_b32 a145, 0
v_accvgpr_write_b32 a146, 0
v_accvgpr_write_b32 a147, 0
v_mfma_f32_16x16x32_bf16 v[36:39], a[76:79], a[4:7], v[36:39]
ds_read_b128 a[88:91], v2 offset:6144
s_add_u32 s27, s26, 524288
v_accvgpr_write_b32 a148, 0
v_accvgpr_write_b32 a149, 0
v_accvgpr_write_b32 a150, 0
v_mfma_f32_16x16x32_bf16 v[44:47], a[76:79], a[20:23], v[44:47]
buffer_load_dwordx4 v[176:179], v7, s[8:11], s27 offen sc1
v_accvgpr_write_b32 a151, 0
v_accvgpr_write_b32 a152, 0
v_accvgpr_write_b32 a153, 0
v_accvgpr_write_b32 a154, 0
v_accvgpr_write_b32 a155, 0
v_mfma_f32_16x16x32_bf16 v[52:55], a[76:79], a[36:39], v[52:55]
buffer_load_dwordx4 v[180:183], v7, s[8:11], s27 offen offset:2048 sc1
v_accvgpr_write_b32 a156, 0
v_accvgpr_write_b32 a157, 0
v_accvgpr_write_b32 a158, 0
v_accvgpr_write_b32 a159, 0
v_mfma_f32_16x16x32_bf16 v[60:63], a[76:79], a[52:55], v[60:63]
s_waitcnt lgkmcnt(2)
s_add_u32 s27, s26, 528384
v_accvgpr_write_b32 a160, 0
v_accvgpr_write_b32 a161, 0
v_accvgpr_write_b32 a162, 0
v_accvgpr_write_b32 a163, 0
v_accvgpr_write_b32 a164, 0
v_mfma_f32_16x16x32_bf16 v[32:35], a[80:83], a[8:11], v[32:35]
ds_read_b128 a[92:95], v2 offset:7168
buffer_load_dwordx4 v[184:187], v7, s[8:11], s27 offen sc1
v_accvgpr_write_b32 a165, 0
v_accvgpr_write_b32 a166, 0
v_accvgpr_write_b32 a167, 0
v_mfma_f32_16x16x32_bf16 v[40:43], a[80:83], a[24:27], v[40:43]
buffer_load_dwordx4 v[188:191], v7, s[8:11], s27 offen offset:2048 sc1
v_accvgpr_write_b32 a168, 0
v_accvgpr_write_b32 a169, 0
v_accvgpr_write_b32 a170, 0
v_accvgpr_write_b32 a171, 0
v_accvgpr_write_b32 a172, 0
v_mfma_f32_16x16x32_bf16 v[48:51], a[80:83], a[40:43], v[48:51]
s_add_u32 s27, s26, 1048576
v_accvgpr_write_b32 a173, 0
v_accvgpr_write_b32 a174, 0
v_accvgpr_write_b32 a175, 0
v_accvgpr_write_b32 a176, 0
v_accvgpr_write_b32 a177, 0
v_mfma_f32_16x16x32_bf16 v[56:59], a[80:83], a[56:59], v[56:59]
s_waitcnt lgkmcnt(2)
buffer_load_dwordx4 v[192:195], v7, s[8:11], s27 offen sc1
v_accvgpr_write_b32 a178, 0
v_accvgpr_write_b32 a179, 0
v_accvgpr_write_b32 a180, 0
v_accvgpr_write_b32 a181, 0
v_accvgpr_write_b32 a182, 0
v_mfma_f32_16x16x32_bf16 v[36:39], a[84:87], a[8:11], v[36:39]
ds_read_b128 a[64:67], v4 offset:24576
buffer_load_dwordx4 v[196:199], v7, s[8:11], s27 offen offset:2048 sc1
v_accvgpr_write_b32 a183, 0
v_accvgpr_write_b32 a184, 0
v_accvgpr_write_b32 a185, 0
v_mfma_f32_16x16x32_bf16 v[44:47], a[84:87], a[24:27], v[44:47]
v_accvgpr_write_b32 a186, 0
v_accvgpr_write_b32 a187, 0
v_accvgpr_write_b32 a188, 0
v_accvgpr_write_b32 a189, 0
v_accvgpr_write_b32 a190, 0
v_mfma_f32_16x16x32_bf16 v[52:55], a[84:87], a[40:43], v[52:55]
s_add_u32 s27, s26, 1052672
v_accvgpr_write_b32 a191, 0
v_accvgpr_write_b32 a192, 0
v_accvgpr_write_b32 a193, 0
v_accvgpr_write_b32 a194, 0
v_accvgpr_write_b32 a195, 0
v_mfma_f32_16x16x32_bf16 v[60:63], a[84:87], a[56:59], v[60:63]
s_waitcnt lgkmcnt(2)
buffer_load_dwordx4 v[200:203], v7, s[8:11], s27 offen sc1
v_accvgpr_write_b32 a196, 0
v_accvgpr_write_b32 a197, 0
v_accvgpr_write_b32 a198, 0
v_accvgpr_write_b32 a199, 0
v_accvgpr_write_b32 a200, 0
v_mfma_f32_16x16x32_bf16 v[32:35], a[88:91], a[12:15], v[32:35]
ds_read_b128 a[68:71], v4 offset:25600
buffer_load_dwordx4 v[204:207], v7, s[8:11], s27 offen offset:2048 sc1
v_accvgpr_write_b32 a201, 0
v_accvgpr_write_b32 a202, 0
v_accvgpr_write_b32 a203, 0
v_mfma_f32_16x16x32_bf16 v[40:43], a[88:91], a[28:31], v[40:43]
s_add_u32 s27, s26, 1572864
v_accvgpr_write_b32 a204, 0
v_accvgpr_write_b32 a205, 0
v_accvgpr_write_b32 a206, 0
v_accvgpr_write_b32 a207, 0
v_accvgpr_write_b32 a208, 0
v_mfma_f32_16x16x32_bf16 v[48:51], a[88:91], a[44:47], v[48:51]
buffer_load_dwordx4 v[208:211], v7, s[8:11], s27 offen sc1
v_accvgpr_write_b32 a209, 0
v_accvgpr_write_b32 a210, 0
v_accvgpr_write_b32 a211, 0
v_accvgpr_write_b32 a212, 0
v_accvgpr_write_b32 a213, 0
v_mfma_f32_16x16x32_bf16 v[56:59], a[88:91], a[60:63], v[56:59]
s_waitcnt lgkmcnt(2)
buffer_load_dwordx4 v[212:215], v7, s[8:11], s27 offen offset:2048 sc1
v_accvgpr_write_b32 a214, 0
v_accvgpr_write_b32 a215, 0
v_accvgpr_write_b32 a216, 0
v_accvgpr_write_b32 a217, 0
v_mfma_f32_16x16x32_bf16 v[36:39], a[92:95], a[12:15], v[36:39]
ds_read_b128 a[72:75], v4 offset:26624
s_add_u32 s27, s26, 1576960
v_accvgpr_write_b32 a218, 0
v_accvgpr_write_b32 a219, 0
v_accvgpr_write_b32 a220, 0
v_accvgpr_write_b32 a221, 0
v_mfma_f32_16x16x32_bf16 v[44:47], a[92:95], a[28:31], v[44:47]
buffer_load_dwordx4 v[216:219], v7, s[8:11], s27 offen sc1
v_accvgpr_write_b32 a222, 0
v_accvgpr_write_b32 a223, 0
v_accvgpr_write_b32 a224, 0
v_accvgpr_write_b32 a225, 0
v_mfma_f32_16x16x32_bf16 v[52:55], a[92:95], a[44:47], v[52:55]
buffer_load_dwordx4 v[220:223], v7, s[8:11], s27 offen offset:2048 sc1
v_accvgpr_write_b32 a226, 0
v_accvgpr_write_b32 a227, 0
v_accvgpr_write_b32 a228, 0
v_accvgpr_write_b32 a229, 0
v_accvgpr_write_b32 a230, 0
v_mfma_f32_16x16x32_bf16 v[60:63], a[92:95], a[60:63], v[60:63]
s_waitcnt lgkmcnt(2)
v_accvgpr_write_b32 a231, 0
v_accvgpr_write_b32 a232, 0
v_accvgpr_write_b32 a233, 0
v_accvgpr_write_b32 a234, 0
v_accvgpr_write_b32 a235, 0
v_accvgpr_write_b32 a236, 0
v_accvgpr_write_b32 a237, 0
v_accvgpr_write_b32 a238, 0
v_accvgpr_write_b32 a239, 0
s_cmp_eq_u32 s44, 0
s_cbranch_scc1 L_at_last
.p2align 3
L_at_loop:
v_mfma_f32_16x16x32_bf16 a[224:227], a[240:243], v[112:115], a[224:227]
s_add_u32 s43, s43, 1
v_mfma_f32_16x16x32_bf16 a[228:231], a[240:243], v[116:119], a[228:231]
v_mfma_f32_16x16x32_bf16 a[232:235], a[240:243], v[120:123], a[232:235]
v_mfma_f32_16x16x32_bf16 a[236:239], a[240:243], v[124:127], a[236:239]
v_max3_f32 v16, v32, v33, v34
v_max3_f32 v16, v16, v35, v40
v_mfma_f32_16x16x32_bf16 a[96:99], a[64:67], v[112:115], a[96:99]
ds_read_b128 a[76:79], v4 offset:27648
v_max3_f32 v16, v16, v41, v42
v_mfma_f32_16x16x32_bf16 a[100:103], a[64:67], v[116:119], a[100:103]
v_max3_f32 v16, v16, v43, v48
v_max3_f32 v16, v16, v49, v50
v_mfma_f32_16x16x32_bf16 a[104:107], a[64:67], v[120:123], a[104:107]
v_max3_f32 v16, v16, v51, v56
v_max3_f32 v16, v16, v57, v58
v_mfma_f32_16x16x32_bf16 a[108:111], a[64:67], v[124:127], a[108:111]
s_waitcnt lgkmcnt(2)
v_max3_f32 v16, v16, v59, v36
v_max3_f32 v16, v16, v37, v38
v_mfma_f32_16x16x32_bf16 a[112:115], a[68:71], v[112:115], a[112:115]
ds_read_b128 a[80:83], v4 offset:28672
v_max3_f32 v16, v16, v39, v44
v_mfma_f32_16x16x32_bf16 a[116:119], a[68:71], v[116:119], a[116:119]
v_max3_f32 v16, v16, v45, v46
v_max3_f32 v16, v16, v47, v52
v_mfma_f32_16x16x32_bf16 a[120:123], a[68:71], v[120:123], a[120:123]
v_max3_f32 v16, v16, v53, v54
v_max3_f32 v16, v16, v55, v60
v_mfma_f32_16x16x32_bf16 a[124:127], a[68:71], v[124:127], a[124:127]
s_waitcnt lgkmcnt(2)
v_max3_f32 v16, v16, v61, v62
v_max_f32 v16, v16, v63
v_mfma_f32_16x16x32_bf16 a[128:131], a[72:75], v[112:115], a[128:131]
ds_read_b128 a[84:87], v4 offset:29696
v_cmp_lt_f32 vcc, s54, v16
v_mfma_f32_16x16x32_bf16 a[132:135], a[72:75], v[116:119], a[132:135]
s_cbranch_vccnz L_at_up0
L_at_upr0:
v_mfma_f32_16x16x32_bf16 a[136:139], a[72:75], v[120:123], a[136:139]
v_exp_f32 v32, v32
v_mfma_f32_16x16x32_bf16 a[140:143], a[72:75], v[124:127], a[140:143]
s_waitcnt lgkmcnt(2)
v_exp_f32 v33, v33
v_mfma_f32_16x16x32_bf16 a[144:147], a[76:79], v[112:115], a[144:147]
ds_read_b128 a[88:91], v4 offset:30720
v_cvt_pk_bf16_f32 v96, v32, v33
v_mfma_f32_16x16x32_bf16 a[148:151], a[76:79], v[116:119], a[148:151]
v_exp_f32 v34, v34
v_mfma_f32_16x16x32_bf16 a[152:155], a[76:79], v[120:123], a[152:155]
v_exp_f32 v35, v35
v_mfma_f32_16x16x32_bf16 a[156:159], a[76:79], v[124:127], a[156:159]
s_waitcnt lgkmcnt(2)
v_exp_f32 v36, v36
v_mfma_f32_16x16x32_bf16 a[160:163], a[80:83], v[112:115], a[160:163]
ds_read_b128 a[92:95], v4 offset:31744
v_cvt_pk_bf16_f32 v97, v34, v35
v_mfma_f32_16x16x32_bf16 a[164:167], a[80:83], v[116:119], a[164:167]
v_exp_f32 v37, v37
v_mfma_f32_16x16x32_bf16 a[168:171], a[80:83], v[120:123], a[168:171]
v_exp_f32 v38, v38
v_mfma_f32_16x16x32_bf16 a[172:175], a[80:83], v[124:127], a[172:175]
s_waitcnt lgkmcnt(2)
v_exp_f32 v39, v39
v_mfma_f32_16x16x32_bf16 a[176:179], a[84:87], v[112:115], a[176:179]
ds_read_b128 a[64:67], v2 offset:16384
v_cvt_pk_bf16_f32 v98, v36, v37
v_mfma_f32_16x16x32_bf16 a[180:183], a[84:87], v[116:119], a[180:183]
v_exp_f32 v40, v40
v_mfma_f32_16x16x32_bf16 a[184:187], a[84:87], v[120:123], a[184:187]
v_exp_f32 v41, v41
v_mfma_f32_16x16x32_bf16 a[188:191], a[84:87], v[124:127], a[188:191]
s_waitcnt lgkmcnt(2)
v_exp_f32 v42, v42
v_mfma_f32_16x16x32_bf16 a[192:195], a[88:91], v[112:115], a[192:195]
ds_read_b128 a[68:71], v2 offset:17408
v_cvt_pk_bf16_f32 v99, v38, v39
v_mfma_f32_16x16x32_bf16 a[196:199], a[88:91], v[116:119], a[196:199]
v_exp_f32 v43, v43
v_mfma_f32_16x16x32_bf16 a[200:203], a[88:91], v[120:123], a[200:203]
v_exp_f32 v44, v44
v_mfma_f32_16x16x32_bf16 a[204:207], a[88:91], v[124:127], a[204:207]
s_waitcnt lgkmcnt(2)
v_exp_f32 v45, v45
v_mfma_f32_16x16x32_bf16 a[208:211], a[92:95], v[112:115], a[208:211]
ds_read_b128 a[72:75], v2 offset:18432
v_cvt_pk_bf16_f32 v100, v40, v41
v_mfma_f32_16x16x32_bf16 a[212:215], a[92:95], v[116:119], a[212:215]
v_exp_f32 v46, v46
v_mfma_f32_16x16x32_bf16 a[216:219], a[92:95], v[120:123], a[216:219]
s_cmp_eq_u32 s48, 0
v_exp_f32 v47, v47
v_mfma_f32_16x16x32_bf16 a[220:223], a[92:95], v[124:127], a[220:223]
s_waitcnt lgkmcnt(2)
s_cbranch_scc0 L_at_rs0
L_at_rsr0:
v_mfma_f32_16x16x32_bf16 v[64:67], a[64:67], a[0:3], v[128:131]
ds_read_b128 a[76:79], v2 offset:19456
v_cvt_pk_bf16_f32 v101, v42, v43
v_mfma_f32_16x16x32_bf16 v[72:75], a[64:67], a[16:19], v[132:135]
v_exp_f32 v48, v48
v_mfma_f32_16x16x32_bf16 v[80:83], a[64:67], a[32:35], v[136:139]
v_exp_f32 v49, v49
v_mfma_f32_16x16x32_bf16 v[88:91], a[64:67], a[48:51], v[140:143]
s_waitcnt lgkmcnt(2)
v_exp_f32 v50, v50
v_mfma_f32_16x16x32_bf16 v[68:71], a[68:71], a[0:3], v[128:131]
ds_read_b128 a[80:83], v2 offset:20480
v_cvt_pk_bf16_f32 v102, v44, v45
v_mfma_f32_16x16x32_bf16 v[76:79], a[68:71], a[16:19], v[132:135]
v_exp_f32 v51, v51
v_mfma_f32_16x16x32_bf16 v[84:87], a[68:71], a[32:35], v[136:139]
v_exp_f32 v52, v52
v_mfma_f32_16x16x32_bf16 v[92:95], a[68:71], a[48:51], v[140:143]
s_waitcnt lgkmcnt(2)
v_exp_f32 v53, v53
v_mfma_f32_16x16x32_bf16 v[64:67], a[72:75], a[4:7], v[64:67]
ds_read_b128 a[84:87], v2 offset:21504
v_cvt_pk_bf16_f32 v103, v46, v47
v_mfma_f32_16x16x32_bf16 v[72:75], a[72:75], a[20:23], v[72:75]
v_exp_f32 v54, v54
v_mfma_f32_16x16x32_bf16 v[80:83], a[72:75], a[36:39], v[80:83]
v_exp_f32 v55, v55
v_mfma_f32_16x16x32_bf16 v[88:91], a[72:75], a[52:55], v[88:91]
s_waitcnt lgkmcnt(2)
v_exp_f32 v56, v56
v_mfma_f32_16x16x32_bf16 v[68:71], a[76:79], a[4:7], v[68:71]
ds_read_b128 a[88:91], v2 offset:22528
v_cvt_pk_bf16_f32 v104, v48, v49
v_mfma_f32_16x16x32_bf16 v[76:79], a[76:79], a[20:23], v[76:79]
v_exp_f32 v57, v57
v_mfma_f32_16x16x32_bf16 v[84:87], a[76:79], a[36:39], v[84:87]
v_exp_f32 v58, v58
v_mfma_f32_16x16x32_bf16 v[92:95], a[76:79], a[52:55], v[92:95]
s_waitcnt lgkmcnt(2)
v_exp_f32 v59, v59
v_mfma_f32_16x16x32_bf16 v[64:67], a[80:83], a[8:11], v[64:67]
ds_read_b128 a[92:95], v2 offset:23552
v_cvt_pk_bf16_f32 v105, v50, v51
v_mfma_f32_16x16x32_bf16 v[72:75], a[80:83], a[24:27], v[72:75]
v_exp_f32 v60, v60
v_mfma_f32_16x16x32_bf16 v[80:83], a[80:83], a[40:43], v[80:83]
v_exp_f32 v61, v61
v_mfma_f32_16x16x32_bf16 v[88:91], a[80:83], a[56:59], v[88:91]
s_waitcnt lgkmcnt(2)
v_exp_f32 v62, v62
v_mfma_f32_16x16x32_bf16 v[68:71], a[84:87], a[8:11], v[68:71]
ds_read_b128 a[64:67], v2 offset:8192
v_cvt_pk_bf16_f32 v106, v52, v53
v_mfma_f32_16x16x32_bf16 v[76:79], a[84:87], a[24:27], v[76:79]
v_exp_f32 v63, v63
v_mfma_f32_16x16x32_bf16 v[84:87], a[84:87], a[40:43], v[84:87]
v_cvt_pk_bf16_f32 v107, v54, v55
v_cvt_pk_bf16_f32 v108, v56, v57
v_mfma_f32_16x16x32_bf16 v[92:95], a[84:87], a[56:59], v[92:95]
s_waitcnt lgkmcnt(2)
v_cvt_pk_bf16_f32 v109, v58, v59
v_cvt_pk_bf16_f32 v110, v60, v61
v_mfma_f32_16x16x32_bf16 v[64:67], a[88:91], a[12:15], v[64:67]
ds_read_b128 a[68:71], v2 offset:9216
v_cvt_pk_bf16_f32 v111, v62, v63
v_mfma_f32_16x16x32_bf16 v[72:75], a[88:91], a[28:31], v[72:75]
v_mfma_f32_16x16x32_bf16 v[80:83], a[88:91], a[44:47], v[80:83]
v_mfma_f32_16x16x32_bf16 v[88:91], a[88:91], a[60:63], v[88:91]
s_waitcnt lgkmcnt(2)
v_mfma_f32_16x16x32_bf16 v[68:71], a[92:95], a[12:15], v[68:71]
ds_read_b128 a[72:75], v2 offset:10240
v_mfma_f32_16x16x32_bf16 v[76:79], a[92:95], a[28:31], v[76:79]
v_mfma_f32_16x16x32_bf16 v[84:87], a[92:95], a[44:47], v[84:87]
v_mfma_f32_16x16x32_bf16 v[92:95], a[92:95], a[60:63], v[92:95]
s_waitcnt lgkmcnt(2)
s_waitcnt vmcnt(8)
s_barrier
v_mfma_f32_16x16x32_bf16 a[224:227], a[240:243], v[96:99], a[224:227]
s_add_u32 s24, s46, 4096
s_add_u32 m0, s47, 0
v_mfma_f32_16x16x32_bf16 a[228:231], a[240:243], v[100:103], a[228:231]
buffer_load_dwordx4 v1, s[8:11], s46 offen sc1 lds
v_mfma_f32_16x16x32_bf16 a[232:235], a[240:243], v[104:107], a[232:235]
buffer_load_dwordx4 v1, s[8:11], s46 offen offset:2048 sc1 lds
v_mfma_f32_16x16x32_bf16 a[236:239], a[240:243], v[108:111], a[236:239]
v_max3_f32 v16, v64, v65, v66
v_max3_f32 v16, v16, v67, v72
v_mfma_f32_16x16x32_bf16 a[96:99], a[64:67], v[96:99], a[96:99]
ds_read_b128 a[76:79], v2 offset:11264
v_max3_f32 v16, v16, v73, v74
v_mfma_f32_16x16x32_bf16 a[100:103], a[64:67], v[100:103], a[100:103]
s_add_u32 m0, s47, 896
v_max3_f32 v16, v16, v75, v80
v_max3_f32 v16, v16, v81, v82
v_mfma_f32_16x16x32_bf16 a[104:107], a[64:67], v[104:107], a[104:107]
v_max3_f32 v16, v16, v83, v88
v_max3_f32 v16, v16, v89, v90
v_mfma_f32_16x16x32_bf16 a[108:111], a[64:67], v[108:111], a[108:111]
s_waitcnt lgkmcnt(2)
v_max3_f32 v16, v16, v91, v68
v_max3_f32 v16, v16, v69, v70
v_mfma_f32_16x16x32_bf16 a[112:115], a[68:71], v[96:99], a[112:115]
ds_read_b128 a[80:83], v2 offset:12288
v_max3_f32 v16, v16, v71, v76
v_mfma_f32_16x16x32_bf16 a[116:119], a[68:71], v[100:103], a[116:119]
buffer_load_dwordx4 v1, s[8:11], s46 offen offset:128 sc1 lds
v_max3_f32 v16, v16, v77, v78
v_mfma_f32_16x16x32_bf16 a[120:123], a[68:71], v[104:107], a[120:123]
v_max3_f32 v16, v16, v79, v84
v_max3_f32 v16, v16, v85, v86
v_mfma_f32_16x16x32_bf16 a[124:127], a[68:71], v[108:111], a[124:127]
s_waitcnt lgkmcnt(2)
v_max3_f32 v16, v16, v87, v92
v_max3_f32 v16, v16, v93, v94
v_mfma_f32_16x16x32_bf16 a[128:131], a[72:75], v[96:99], a[128:131]
ds_read_b128 a[84:87], v2 offset:13312
v_max_f32 v16, v16, v95
v_cmp_lt_f32 vcc, s54, v16
v_mfma_f32_16x16x32_bf16 a[132:135], a[72:75], v[100:103], a[132:135]
buffer_load_dwordx4 v1, s[8:11], s46 offen offset:2176 sc1 lds
s_cbranch_vccnz L_at_up1
L_at_upr1:
v_mfma_f32_16x16x32_bf16 a[136:139], a[72:75], v[104:107], a[136:139]
v_exp_f32 v64, v64
v_mfma_f32_16x16x32_bf16 a[140:143], a[72:75], v[108:111], a[140:143]
s_waitcnt lgkmcnt(2)
v_exp_f32 v65, v65
v_mfma_f32_16x16x32_bf16 a[144:147], a[76:79], v[96:99], a[144:147]
ds_read_b128 a[88:91], v2 offset:14336
v_cvt_pk_bf16_f32 v112, v64, v65
v_mfma_f32_16x16x32_bf16 a[148:151], a[76:79], v[100:103], a[148:151]
v_exp_f32 v66, v66
v_mfma_f32_16x16x32_bf16 a[152:155], a[76:79], v[104:107], a[152:155]
s_add_u32 m0, s47, 4096
v_exp_f32 v67, v67
v_mfma_f32_16x16x32_bf16 a[156:159], a[76:79], v[108:111], a[156:159]
s_waitcnt lgkmcnt(2)
v_exp_f32 v68, v68
v_mfma_f32_16x16x32_bf16 a[160:163], a[80:83], v[96:99], a[160:163]
ds_read_b128 a[92:95], v2 offset:15360
v_cvt_pk_bf16_f32 v113, v66, v67
v_mfma_f32_16x16x32_bf16 a[164:167], a[80:83], v[100:103], a[164:167]
v_exp_f32 v69, v69
v_mfma_f32_16x16x32_bf16 a[168:171], a[80:83], v[104:107], a[168:171]
buffer_load_dwordx4 v1, s[8:11], s24 offen sc1 lds
v_cvt_pk_bf16_f32 v114, v68, v69
v_mfma_f32_16x16x32_bf16 a[172:175], a[80:83], v[108:111], a[172:175]
s_waitcnt lgkmcnt(2)
v_exp_f32 v70, v70
v_mfma_f32_16x16x32_bf16 a[176:179], a[84:87], v[96:99], a[176:179]
ds_read_b128 a[64:67], v3
v_mfma_f32_16x16x32_bf16 a[180:183], a[84:87], v[100:103], a[180:183]
v_exp_f32 v71, v71
v_mfma_f32_16x16x32_bf16 a[184:187], a[84:87], v[104:107], a[184:187]
v_exp_f32 v72, v72
v_mfma_f32_16x16x32_bf16 a[188:191], a[84:87], v[108:111], a[188:191]
s_waitcnt lgkmcnt(2)
v_exp_f32 v73, v73
v_mfma_f32_16x16x32_bf16 a[192:195], a[88:91], v[96:99], a[192:195]
ds_read_b128 a[68:71], v3 offset:1024
v_cvt_pk_bf16_f32 v115, v70, v71
v_mfma_f32_16x16x32_bf16 a[196:199], a[88:91], v[100:103], a[196:199]
buffer_load_dwordx4 v1, s[8:11], s24 offen offset:2048 sc1 lds
v_cvt_pk_bf16_f32 v116, v72, v73
v_mfma_f32_16x16x32_bf16 a[200:203], a[88:91], v[104:107], a[200:203]
v_exp_f32 v74, v74
v_mfma_f32_16x16x32_bf16 a[204:207], a[88:91], v[108:111], a[204:207]
s_waitcnt lgkmcnt(2)
v_exp_f32 v75, v75
v_mfma_f32_16x16x32_bf16 a[208:211], a[92:95], v[96:99], a[208:211]
ds_read_b128 a[72:75], v3 offset:2048
v_cvt_pk_bf16_f32 v117, v74, v75
v_mfma_f32_16x16x32_bf16 a[212:215], a[92:95], v[100:103], a[212:215]
s_add_u32 m0, s47, 4992
v_exp_f32 v76, v76
v_mfma_f32_16x16x32_bf16 a[216:219], a[92:95], v[104:107], a[216:219]
s_cmp_eq_u32 s48, 0
v_exp_f32 v77, v77
v_mfma_f32_16x16x32_bf16 a[220:223], a[92:95], v[108:111], a[220:223]
s_waitcnt lgkmcnt(2)
s_cbranch_scc0 L_at_rs1
L_at_rsr1:
v_mfma_f32_16x16x32_bf16 v[32:35], a[64:67], a[0:3], v[128:131]
ds_read_b128 a[76:79], v3 offset:3072
v_cvt_pk_bf16_f32 v118, v76, v77
v_mfma_f32_16x16x32_bf16 v[40:43], a[64:67], a[16:19], v[132:135]
v_exp_f32 v78, v78
v_mfma_f32_16x16x32_bf16 v[48:51], a[64:67], a[32:35], v[136:139]
buffer_load_dwordx4 v1, s[8:11], s24 offen offset:128 sc1 lds
v_mfma_f32_16x16x32_bf16 v[56:59], a[64:67], a[48:51], v[140:143]
s_waitcnt lgkmcnt(2)
v_exp_f32 v79, v79
v_mfma_f32_16x16x32_bf16 v[36:39], a[68:71], a[0:3], v[128:131]
ds_read_b128 a[80:83], v3 offset:4096
v_cvt_pk_bf16_f32 v119, v78, v79
v_mfma_f32_16x16x32_bf16 v[44:47], a[68:71], a[16:19], v[132:135]
v_exp_f32 v80, v80
v_mfma_f32_16x16x32_bf16 v[52:55], a[68:71], a[32:35], v[136:139]
v_exp_f32 v81, v81
v_mfma_f32_16x16x32_bf16 v[60:63], a[68:71], a[48:51], v[140:143]
s_waitcnt lgkmcnt(2)
v_exp_f32 v82, v82
v_mfma_f32_16x16x32_bf16 v[32:35], a[72:75], a[4:7], v[32:35]
ds_read_b128 a[84:87], v3 offset:5120
v_cvt_pk_bf16_f32 v120, v80, v81
v_mfma_f32_16x16x32_bf16 v[40:43], a[72:75], a[20:23], v[40:43]
buffer_load_dwordx4 v1, s[8:11], s24 offen offset:2176 sc1 lds
v_mfma_f32_16x16x32_bf16 v[48:51], a[72:75], a[36:39], v[48:51]
v_exp_f32 v83, v83
v_mfma_f32_16x16x32_bf16 v[56:59], a[72:75], a[52:55], v[56:59]
s_waitcnt lgkmcnt(2)
v_exp_f32 v84, v84
v_mfma_f32_16x16x32_bf16 v[36:39], a[76:79], a[4:7], v[36:39]
ds_read_b128 a[88:91], v3 offset:6144
v_cvt_pk_bf16_f32 v121, v82, v83
v_mfma_f32_16x16x32_bf16 v[44:47], a[76:79], a[20:23], v[44:47]
s_add_u32 s46, s46, 1048576
v_exp_f32 v85, v85
v_mfma_f32_16x16x32_bf16 v[52:55], a[76:79], a[36:39], v[52:55]
v_exp_f32 v86, v86
v_mfma_f32_16x16x32_bf16 v[60:63], a[76:79], a[52:55], v[60:63]
s_waitcnt lgkmcnt(2)
v_exp_f32 v87, v87
v_mfma_f32_16x16x32_bf16 v[32:35], a[80:83], a[8:11], v[32:35]
ds_read_b128 a[92:95], v3 offset:7168
v_cvt_pk_bf16_f32 v122, v84, v85
v_mfma_f32_16x16x32_bf16 v[40:43], a[80:83], a[24:27], v[40:43]
v_exp_f32 v88, v88
v_mfma_f32_16x16x32_bf16 v[48:51], a[80:83], a[40:43], v[48:51]
s_add_u32 s47, s47, 32768
v_exp_f32 v89, v89
v_mfma_f32_16x16x32_bf16 v[56:59], a[80:83], a[56:59], v[56:59]
s_waitcnt lgkmcnt(2)
v_exp_f32 v90, v90
v_mfma_f32_16x16x32_bf16 v[36:39], a[84:87], a[8:11], v[36:39]
ds_read_b128 a[64:67], v2 offset:24576
v_cvt_pk_bf16_f32 v123, v86, v87
v_mfma_f32_16x16x32_bf16 v[44:47], a[84:87], a[24:27], v[44:47]
v_exp_f32 v91, v91
v_mfma_f32_16x16x32_bf16 v[52:55], a[84:87], a[40:43], v[52:55]
s_and_b32 s47, s47, 131071
v_exp_f32 v92, v92
v_mfma_f32_16x16x32_bf16 v[60:63], a[84:87], a[56:59], v[60:63]
s_waitcnt lgkmcnt(2)
v_exp_f32 v93, v93
v_mfma_f32_16x16x32_bf16 v[32:35], a[88:91], a[12:15], v[32:35]
ds_read_b128 a[68:71], v2 offset:25600
v_cvt_pk_bf16_f32 v124, v88, v89
v_mfma_f32_16x16x32_bf16 v[40:43], a[88:91], a[28:31], v[40:43]
v_exp_f32 v94, v94
v_mfma_f32_16x16x32_bf16 v[48:51], a[88:91], a[44:47], v[48:51]
v_exp_f32 v95, v95
v_mfma_f32_16x16x32_bf16 v[56:59], a[88:91], a[60:63], v[56:59]
s_waitcnt lgkmcnt(2)
v_cvt_pk_bf16_f32 v125, v90, v91
v_cvt_pk_bf16_f32 v126, v92, v93
v_mfma_f32_16x16x32_bf16 v[36:39], a[92:95], a[12:15], v[36:39]
ds_read_b128 a[72:75], v2 offset:26624
v_cvt_pk_bf16_f32 v127, v94, v95
v_mfma_f32_16x16x32_bf16 v[44:47], a[92:95], a[28:31], v[44:47]
s_cmp_lt_u32 s43, s44
v_mov_b32 v4, v2
v_mov_b32 v2, v3
v_mfma_f32_16x16x32_bf16 v[52:55], a[92:95], a[44:47], v[52:55]
v_add_u32 v3, 32768, v3
v_and_b32 v3, 131071, v3
v_mfma_f32_16x16x32_bf16 v[60:63], a[92:95], a[60:63], v[60:63]
s_waitcnt lgkmcnt(2)
s_cbranch_scc1 L_at_loop
L_at_last:
v_mfma_f32_16x16x32_bf16 a[224:227], a[240:243], v[112:115], a[224:227]
s_lshl_b32 s61, s41, 4
v_mfma_f32_16x16x32_bf16 a[228:231], a[240:243], v[116:119], a[228:231]
v_mfma_f32_16x16x32_bf16 a[232:235], a[240:243], v[120:123], a[232:235]
v_mfma_f32_16x16x32_bf16 a[236:239], a[240:243], v[124:127], a[236:239]
v_cmp_le_i32 s[30:31], 0, v5
v_cmp_le_i32 s[32:33], 1, v5
v_mfma_f32_16x16x32_bf16 a[96:99], a[64:67], v[112:115], a[96:99]
ds_read_b128 a[76:79], v4 offset:27648
v_cmp_le_i32 s[34:35], 2, v5
v_mfma_f32_16x16x32_bf16 a[100:103], a[64:67], v[116:119], a[100:103]
v_cmp_le_i32 s[36:37], 3, v5
v_cndmask_b32 v32, v8, v32, s[30:31]
v_mfma_f32_16x16x32_bf16 a[104:107], a[64:67], v[120:123], a[104:107]
s_add_u32 s61, s61, s17
v_cndmask_b32 v33, v8, v33, s[32:33]
v_cndmask_b32 v34, v8, v34, s[34:35]
v_mfma_f32_16x16x32_bf16 a[108:111], a[64:67], v[124:127], a[108:111]
s_waitcnt lgkmcnt(2)
v_cndmask_b32 v35, v8, v35, s[36:37]
v_cmp_le_i32 s[30:31], 8, v5
v_mfma_f32_16x16x32_bf16 a[112:115], a[68:71], v[112:115], a[112:115]
ds_read_b128 a[80:83], v4 offset:28672
v_cmp_le_i32 s[32:33], 9, v5
v_mfma_f32_16x16x32_bf16 a[116:119], a[68:71], v[116:119], a[116:119]
v_cmp_le_i32 s[34:35], 10, v5
v_cmp_le_i32 s[36:37], 11, v5
v_mfma_f32_16x16x32_bf16 a[120:123], a[68:71], v[120:123], a[120:123]
v_cndmask_b32 v36, v8, v36, s[30:31]
v_cndmask_b32 v37, v8, v37, s[32:33]
v_mfma_f32_16x16x32_bf16 a[124:127], a[68:71], v[124:127], a[124:127]
s_waitcnt lgkmcnt(2)
v_cndmask_b32 v38, v8, v38, s[34:35]
v_cndmask_b32 v39, v8, v39, s[36:37]
v_mfma_f32_16x16x32_bf16 a[128:131], a[72:75], v[112:115], a[128:131]
ds_read_b128 a[84:87], v4 offset:29696
v_max3_f32 v16, v32, v33, v34
v_mfma_f32_16x16x32_bf16 a[132:135], a[72:75], v[116:119], a[132:135]
v_max3_f32 v16, v16, v35, v40
v_max3_f32 v16, v16, v41, v42
v_mfma_f32_16x16x32_bf16 a[136:139], a[72:75], v[120:123], a[136:139]
v_max3_f32 v16, v16, v43, v48
v_max3_f32 v16, v16, v49, v50
v_mfma_f32_16x16x32_bf16 a[140:143], a[72:75], v[124:127], a[140:143]
s_waitcnt lgkmcnt(2)
v_max3_f32 v16, v16, v51, v56
v_max3_f32 v16, v16, v57, v58
v_mfma_f32_16x16x32_bf16 a[144:147], a[76:79], v[112:115], a[144:147]
ds_read_b128 a[88:91], v4 offset:30720
v_max3_f32 v16, v16, v59, v36
v_mfma_f32_16x16x32_bf16 a[148:151], a[76:79], v[116:119], a[148:151]
v_max3_f32 v16, v16, v37, v38
v_max3_f32 v16, v16, v39, v44
v_mfma_f32_16x16x32_bf16 a[152:155], a[76:79], v[120:123], a[152:155]
s_lshl_b32 s61, s61, 5
v_max3_f32 v16, v16, v45, v46
v_max3_f32 v16, v16, v47, v52
v_mfma_f32_16x16x32_bf16 a[156:159], a[76:79], v[124:127], a[156:159]
s_waitcnt lgkmcnt(2)
v_max3_f32 v16, v16, v53, v54
v_max3_f32 v16, v16, v55, v60
v_mfma_f32_16x16x32_bf16 a[160:163], a[80:83], v[112:115], a[160:163]
ds_read_b128 a[92:95], v4 offset:31744
v_max3_f32 v16, v16, v61, v62
v_mfma_f32_16x16x32_bf16 a[164:167], a[80:83], v[116:119], a[164:167]
v_max_f32 v16, v16, v63
v_cmp_lt_f32 vcc, s54, v16
v_mfma_f32_16x16x32_bf16 a[168:171], a[80:83], v[120:123], a[168:171]
s_cbranch_vccnz L_at_up2
L_at_upr2:
v_mfma_f32_16x16x32_bf16 a[172:175], a[80:83], v[124:127], a[172:175]
s_waitcnt lgkmcnt(2)
v_exp_f32 v32, v32
v_mfma_f32_16x16x32_bf16 a[176:179], a[84:87], v[112:115], a[176:179]
ds_read_b128 a[64:67], v2 offset:16384
v_exp_f32 v33, v33
v_mfma_f32_16x16x32_bf16 a[180:183], a[84:87], v[116:119], a[180:183]
v_exp_f32 v34, v34
v_cvt_pk_bf16_f32 v96, v32, v33
v_mfma_f32_16x16x32_bf16 a[184:187], a[84:87], v[120:123], a[184:187]
v_exp_f32 v35, v35
v_mfma_f32_16x16x32_bf16 a[188:191], a[84:87], v[124:127], a[188:191]
s_waitcnt lgkmcnt(2)
v_exp_f32 v36, v36
v_cvt_pk_bf16_f32 v97, v34, v35
v_mfma_f32_16x16x32_bf16 a[192:195], a[88:91], v[112:115], a[192:195]
ds_read_b128 a[68:71], v2 offset:17408
v_mfma_f32_16x16x32_bf16 a[196:199], a[88:91], v[116:119], a[196:199]
s_add_u32 s61, s61, s42
v_exp_f32 v37, v37
v_mfma_f32_16x16x32_bf16 a[200:203], a[88:91], v[120:123], a[200:203]
v_exp_f32 v38, v38
v_cvt_pk_bf16_f32 v98, v36, v37
v_mfma_f32_16x16x32_bf16 a[204:207], a[88:91], v[124:127], a[204:207]
s_waitcnt lgkmcnt(2)
v_exp_f32 v39, v39
v_mfma_f32_16x16x32_bf16 a[208:211], a[92:95], v[112:115], a[208:211]
ds_read_b128 a[72:75], v2 offset:18432
v_cvt_pk_bf16_f32 v99, v38, v39
v_mfma_f32_16x16x32_bf16 a[212:215], a[92:95], v[116:119], a[212:215]
v_exp_f32 v40, v40
v_mfma_f32_16x16x32_bf16 a[216:219], a[92:95], v[120:123], a[216:219]
v_exp_f32 v41, v41
v_mfma_f32_16x16x32_bf16 a[220:223], a[92:95], v[124:127], a[220:223]
s_waitcnt lgkmcnt(2)
s_cmp_eq_u32 s48, 0
s_cbranch_scc0 L_at_rs2
L_at_rsr2:
v_mfma_f32_16x16x32_bf16 v[64:67], a[64:67], a[0:3], v[128:131]
ds_read_b128 a[76:79], v2 offset:19456
v_cvt_pk_bf16_f32 v100, v40, v41
v_mfma_f32_16x16x32_bf16 v[72:75], a[64:67], a[16:19], v[132:135]
v_exp_f32 v42, v42
v_mfma_f32_16x16x32_bf16 v[80:83], a[64:67], a[32:35], v[136:139]
v_exp_f32 v43, v43
v_mfma_f32_16x16x32_bf16 v[88:91], a[64:67], a[48:51], v[140:143]
s_waitcnt lgkmcnt(2)
v_exp_f32 v44, v44
v_mfma_f32_16x16x32_bf16 v[68:71], a[68:71], a[0:3], v[128:131]
ds_read_b128 a[80:83], v2 offset:20480
v_cvt_pk_bf16_f32 v101, v42, v43
v_mfma_f32_16x16x32_bf16 v[76:79], a[68:71], a[16:19], v[132:135]
v_exp_f32 v45, v45
v_mfma_f32_16x16x32_bf16 v[84:87], a[68:71], a[32:35], v[136:139]
s_lshl_b32 s61, s61, 12
v_exp_f32 v46, v46
v_mfma_f32_16x16x32_bf16 v[92:95], a[68:71], a[48:51], v[140:143]
s_waitcnt lgkmcnt(2)
v_exp_f32 v47, v47
v_mfma_f32_16x16x32_bf16 v[64:67], a[72:75], a[4:7], v[64:67]
ds_read_b128 a[84:87], v2 offset:21504
v_cvt_pk_bf16_f32 v102, v44, v45
v_mfma_f32_16x16x32_bf16 v[72:75], a[72:75], a[20:23], v[72:75]
v_exp_f32 v48, v48
v_mfma_f32_16x16x32_bf16 v[80:83], a[72:75], a[36:39], v[80:83]
v_exp_f32 v49, v49
v_mfma_f32_16x16x32_bf16 v[88:91], a[72:75], a[52:55], v[88:91]
s_waitcnt lgkmcnt(2)
v_exp_f32 v50, v50
v_mfma_f32_16x16x32_bf16 v[68:71], a[76:79], a[4:7], v[68:71]
ds_read_b128 a[88:91], v2 offset:22528
v_cvt_pk_bf16_f32 v103, v46, v47
v_mfma_f32_16x16x32_bf16 v[76:79], a[76:79], a[20:23], v[76:79]
v_exp_f32 v51, v51
v_mfma_f32_16x16x32_bf16 v[84:87], a[76:79], a[36:39], v[84:87]
v_exp_f32 v52, v52
v_mfma_f32_16x16x32_bf16 v[92:95], a[76:79], a[52:55], v[92:95]
s_waitcnt lgkmcnt(2)
v_exp_f32 v53, v53
v_mfma_f32_16x16x32_bf16 v[64:67], a[80:83], a[8:11], v[64:67]
ds_read_b128 a[92:95], v2 offset:23552
v_cvt_pk_bf16_f32 v104, v48, v49
v_mfma_f32_16x16x32_bf16 v[72:75], a[80:83], a[24:27], v[72:75]
s_add_u32 s61, s61, 67108864
v_exp_f32 v54, v54
v_mfma_f32_16x16x32_bf16 v[80:83], a[80:83], a[40:43], v[80:83]
v_exp_f32 v55, v55
v_mfma_f32_16x16x32_bf16 v[88:91], a[80:83], a[56:59], v[88:91]
s_waitcnt lgkmcnt(2)
v_exp_f32 v56, v56
v_mfma_f32_16x16x32_bf16 v[68:71], a[84:87], a[8:11], v[68:71]
ds_read_b128 a[64:67], v2 offset:8192
v_cvt_pk_bf16_f32 v105, v50, v51
v_mfma_f32_16x16x32_bf16 v[76:79], a[84:87], a[24:27], v[76:79]
v_exp_f32 v57, v57
v_mfma_f32_16x16x32_bf16 v[84:87], a[84:87], a[40:43], v[84:87]
v_exp_f32 v58, v58
v_mfma_f32_16x16x32_bf16 v[92:95], a[84:87], a[56:59], v[92:95]
s_waitcnt lgkmcnt(2)
v_exp_f32 v59, v59
v_mfma_f32_16x16x32_bf16 v[64:67], a[88:91], a[12:15], v[64:67]
ds_read_b128 a[68:71], v2 offset:9216
v_cvt_pk_bf16_f32 v106, v52, v53
v_mfma_f32_16x16x32_bf16 v[72:75], a[88:91], a[28:31], v[72:75]
v_exp_f32 v60, v60
v_mfma_f32_16x16x32_bf16 v[80:83], a[88:91], a[44:47], v[80:83]
v_exp_f32 v61, v61
v_mfma_f32_16x16x32_bf16 v[88:91], a[88:91], a[60:63], v[88:91]
s_waitcnt lgkmcnt(2)
v_exp_f32 v62, v62
v_mfma_f32_16x16x32_bf16 v[68:71], a[92:95], a[12:15], v[68:71]
ds_read_b128 a[72:75], v2 offset:10240
v_cvt_pk_bf16_f32 v107, v54, v55
v_mfma_f32_16x16x32_bf16 v[76:79], a[92:95], a[28:31], v[76:79]
v_exp_f32 v63, v63
v_mfma_f32_16x16x32_bf16 v[84:87], a[92:95], a[44:47], v[84:87]
v_cvt_pk_bf16_f32 v108, v56, v57
v_cvt_pk_bf16_f32 v109, v58, v59
v_mfma_f32_16x16x32_bf16 v[92:95], a[92:95], a[60:63], v[92:95]
s_waitcnt lgkmcnt(2)
v_cvt_pk_bf16_f32 v110, v60, v61
v_cvt_pk_bf16_f32 v111, v62, v63
s_waitcnt vmcnt(8)
s_barrier
v_mfma_f32_16x16x32_bf16 a[224:227], a[240:243], v[96:99], a[224:227]
s_add_u32 s24, s46, 4096
s_add_u32 m0, s47, 0
v_mfma_f32_16x16x32_bf16 a[228:231], a[240:243], v[100:103], a[228:231]
buffer_load_dwordx4 v1, s[8:11], s46 offen sc1 lds
v_mfma_f32_16x16x32_bf16 a[232:235], a[240:243], v[104:107], a[232:235]
buffer_load_dwordx4 v1, s[8:11], s46 offen offset:2048 sc1 lds
v_mfma_f32_16x16x32_bf16 a[236:239], a[240:243], v[108:111], a[236:239]
v_cmp_le_i32 s[30:31], 32, v5
v_cmp_le_i32 s[32:33], 33, v5
v_mfma_f32_16x16x32_bf16 a[96:99], a[64:67], v[96:99], a[96:99]
ds_read_b128 a[76:79], v2 offset:11264
v_cmp_le_i32 s[34:35], 34, v5
v_mfma_f32_16x16x32_bf16 a[100:103], a[64:67], v[100:103], a[100:103]
s_add_u32 m0, s47, 896
v_cmp_le_i32 s[36:37], 35, v5
v_cndmask_b32 v64, v8, v64, s[30:31]
v_mfma_f32_16x16x32_bf16 a[104:107], a[64:67], v[104:107], a[104:107]
buffer_load_dwordx4 v1, s[8:11], s46 offen offset:128 sc1 lds
v_cndmask_b32 v65, v8, v65, s[32:33]
v_mfma_f32_16x16x32_bf16 a[108:111], a[64:67], v[108:111], a[108:111]
s_waitcnt lgkmcnt(2)
v_cndmask_b32 v66, v8, v66, s[34:35]
v_cndmask_b32 v67, v8, v67, s[36:37]
v_mfma_f32_16x16x32_bf16 a[112:115], a[68:71], v[96:99], a[112:115]
ds_read_b128 a[80:83], v2 offset:12288
v_cmp_le_i32 s[30:31], 40, v5
v_mfma_f32_16x16x32_bf16 a[116:119], a[68:71], v[100:103], a[116:119]
v_cmp_le_i32 s[32:33], 41, v5
v_cmp_le_i32 s[34:35], 42, v5
v_mfma_f32_16x16x32_bf16 a[120:123], a[68:71], v[104:107], a[120:123]
buffer_load_dwordx4 v1, s[8:11], s46 offen offset:2176 sc1 lds
v_cmp_le_i32 s[36:37], 43, v5
v_mfma_f32_16x16x32_bf16 a[124:127], a[68:71], v[108:111], a[124:127]
s_waitcnt lgkmcnt(2)
v_cndmask_b32 v68, v8, v68, s[30:31]
v_cndmask_b32 v69, v8, v69, s[32:33]
v_mfma_f32_16x16x32_bf16 a[128:131], a[72:75], v[96:99], a[128:131]
ds_read_b128 a[84:87], v2 offset:13312
v_cndmask_b32 v70, v8, v70, s[34:35]
v_mfma_f32_16x16x32_bf16 a[132:135], a[72:75], v[100:103], a[132:135]
v_cndmask_b32 v71, v8, v71, s[36:37]
v_max3_f32 v16, v64, v65, v66
v_mfma_f32_16x16x32_bf16 a[136:139], a[72:75], v[104:107], a[136:139]
s_add_u32 m0, s47, 4096
v_max3_f32 v16, v16, v67, v72
v_max3_f32 v16, v16, v73, v74
v_mfma_f32_16x16x32_bf16 a[140:143], a[72:75], v[108:111], a[140:143]
s_waitcnt lgkmcnt(2)
v_max3_f32 v16, v16, v75, v80
v_max3_f32 v16, v16, v81, v82
v_mfma_f32_16x16x32_bf16 a[144:147], a[76:79], v[96:99], a[144:147]
ds_read_b128 a[88:91], v2 offset:14336
v_max3_f32 v16, v16, v83, v88
v_mfma_f32_16x16x32_bf16 a[148:151], a[76:79], v[100:103], a[148:151]
v_max3_f32 v16, v16, v89, v90
v_max3_f32 v16, v16, v91, v68
v_mfma_f32_16x16x32_bf16 a[152:155], a[76:79], v[104:107], a[152:155]
buffer_load_dwordx4 v1, s[8:11], s24 offen sc1 lds
v_max3_f32 v16, v16, v69, v70
v_mfma_f32_16x16x32_bf16 a[156:159], a[76:79], v[108:111], a[156:159]
s_waitcnt lgkmcnt(2)
v_max3_f32 v16, v16, v71, v76
v_max3_f32 v16, v16, v77, v78
v_mfma_f32_16x16x32_bf16 a[160:163], a[80:83], v[96:99], a[160:163]
ds_read_b128 a[92:95], v2 offset:15360
v_max3_f32 v16, v16, v79, v84
v_mfma_f32_16x16x32_bf16 a[164:167], a[80:83], v[100:103], a[164:167]
v_max3_f32 v16, v16, v85, v86
v_max3_f32 v16, v16, v87, v92
v_max3_f32 v16, v16, v93, v94
v_max_f32 v16, v16, v95
v_cmp_lt_f32 vcc, s54, v16
v_mfma_f32_16x16x32_bf16 a[168:171], a[80:83], v[104:107], a[168:171]
buffer_load_dwordx4 v1, s[8:11], s24 offen offset:2048 sc1 lds
s_cbranch_vccnz L_at_up3
L_at_upr3:
v_mfma_f32_16x16x32_bf16 a[172:175], a[80:83], v[108:111], a[172:175]
s_waitcnt lgkmcnt(2)
v_exp_f32 v64, v64
v_mfma_f32_16x16x32_bf16 a[176:179], a[84:87], v[96:99], a[176:179]
ds_read_b128 a[64:67], v3
v_exp_f32 v65, v65
v_mfma_f32_16x16x32_bf16 a[180:183], a[84:87], v[100:103], a[180:183]
v_exp_f32 v66, v66
v_cvt_pk_bf16_f32 v112, v64, v65
v_mfma_f32_16x16x32_bf16 a[184:187], a[84:87], v[104:107], a[184:187]
s_add_u32 m0, s47, 4992
v_exp_f32 v67, v67
v_mfma_f32_16x16x32_bf16 a[188:191], a[84:87], v[108:111], a[188:191]
s_waitcnt lgkmcnt(2)
v_exp_f32 v68, v68
v_cvt_pk_bf16_f32 v113, v66, v67
v_mfma_f32_16x16x32_bf16 a[192:195], a[88:91], v[96:99], a[192:195]
ds_read_b128 a[68:71], v3 offset:1024
v_exp_f32 v69, v69
v_mfma_f32_16x16x32_bf16 a[196:199], a[88:91], v[100:103], a[196:199]
buffer_load_dwordx4 v1, s[8:11], s24 offen offset:128 sc1 lds
v_exp_f32 v70, v70
v_mfma_f32_16x16x32_bf16 a[200:203], a[88:91], v[104:107], a[200:203]
v_exp_f32 v71, v71
v_cvt_pk_bf16_f32 v114, v68, v69
v_mfma_f32_16x16x32_bf16 a[204:207], a[88:91], v[108:111], a[204:207]
s_waitcnt lgkmcnt(2)
v_exp_f32 v72, v72
v_cvt_pk_bf16_f32 v115, v70, v71
v_mfma_f32_16x16x32_bf16 a[208:211], a[92:95], v[96:99], a[208:211]
ds_read_b128 a[72:75], v3 offset:2048
v_exp_f32 v73, v73
v_mfma_f32_16x16x32_bf16 a[212:215], a[92:95], v[100:103], a[212:215]
buffer_load_dwordx4 v1, s[8:11], s24 offen offset:2176 sc1 lds
v_exp_f32 v74, v74
v_mfma_f32_16x16x32_bf16 a[216:219], a[92:95], v[104:107], a[216:219]
v_exp_f32 v75, v75
v_cvt_pk_bf16_f32 v116, v72, v73
v_mfma_f32_16x16x32_bf16 a[220:223], a[92:95], v[108:111], a[220:223]
s_waitcnt lgkmcnt(2)
s_cmp_eq_u32 s48, 0
s_cbranch_scc0 L_at_rs3
L_at_rsr3:
v_cvt_pk_bf16_f32 v117, v74, v75
v_mfma_f32_16x16x32_bf16 v[40:43], a[64:67], a[16:19], v[132:135]
ds_read_b128 a[76:79], v3 offset:3072
v_exp_f32 v76, v76
v_mfma_f32_16x16x32_bf16 v[48:51], a[64:67], a[32:35], v[136:139]
v_exp_f32 v77, v77
v_mfma_f32_16x16x32_bf16 v[56:59], a[64:67], a[48:51], v[140:143]
s_waitcnt lgkmcnt(2)
v_exp_f32 v78, v78
v_cvt_pk_bf16_f32 v118, v76, v77
v_mfma_f32_16x16x32_bf16 v[44:47], a[68:71], a[16:19], v[132:135]
ds_read_b128 a[80:83], v3 offset:4096
v_exp_f32 v79, v79
v_mfma_f32_16x16x32_bf16 v[52:55], a[68:71], a[32:35], v[136:139]
s_add_u32 s46, s46, 1048576
v_exp_f32 v80, v80
v_cvt_pk_bf16_f32 v119, v78, v79
v_mfma_f32_16x16x32_bf16 v[60:63], a[68:71], a[48:51], v[140:143]
s_waitcnt lgkmcnt(2)
v_exp_f32 v81, v81
v_mfma_f32_16x16x32_bf16 v[40:43], a[72:75], a[20:23], v[40:43]
ds_read_b128 a[84:87], v3 offset:5120
v_exp_f32 v82, v82
v_mfma_f32_16x16x32_bf16 v[48:51], a[72:75], a[36:39], v[48:51]
v_exp_f32 v83, v83
v_cvt_pk_bf16_f32 v120, v80, v81
v_mfma_f32_16x16x32_bf16 v[56:59], a[72:75], a[52:55], v[56:59]
s_waitcnt lgkmcnt(2)
v_exp_f32 v84, v84
v_cvt_pk_bf16_f32 v121, v82, v83
v_mfma_f32_16x16x32_bf16 v[44:47], a[76:79], a[20:23], v[44:47]
ds_read_b128 a[88:91], v3 offset:6144
v_exp_f32 v85, v85
v_mfma_f32_16x16x32_bf16 v[52:55], a[76:79], a[36:39], v[52:55]
s_add_u32 s47, s47, 32768
v_exp_f32 v86, v86
v_cvt_pk_bf16_f32 v122, v84, v85
v_mfma_f32_16x16x32_bf16 v[60:63], a[76:79], a[52:55], v[60:63]
s_waitcnt lgkmcnt(2)
v_exp_f32 v87, v87
v_mfma_f32_16x16x32_bf16 v[40:43], a[80:83], a[24:27], v[40:43]
ds_read_b128 a[92:95], v3 offset:7168
v_exp_f32 v88, v88
v_mfma_f32_16x16x32_bf16 v[48:51], a[80:83], a[40:43], v[48:51]
v_exp_f32 v89, v89
v_mfma_f32_16x16x32_bf16 v[56:59], a[80:83], a[56:59], v[56:59]
s_waitcnt lgkmcnt(2)
v_exp_f32 v90, v90
v_mfma_f32_16x16x32_bf16 v[44:47], a[84:87], a[24:27], v[44:47]
ds_read_b128 a[64:67], v2 offset:24576
v_cvt_pk_bf16_f32 v123, v86, v87
v_mfma_f32_16x16x32_bf16 v[52:55], a[84:87], a[40:43], v[52:55]
s_and_b32 s47, s47, 131071
v_exp_f32 v91, v91
v_mfma_f32_16x16x32_bf16 v[60:63], a[84:87], a[56:59], v[60:63]
s_waitcnt lgkmcnt(2)
v_exp_f32 v92, v92
v_mfma_f32_16x16x32_bf16 v[40:43], a[88:91], a[28:31], v[40:43]
ds_read_b128 a[68:71], v2 offset:25600
v_cvt_pk_bf16_f32 v124, v88, v89
v_mfma_f32_16x16x32_bf16 v[48:51], a[88:91], a[44:47], v[48:51]
v_exp_f32 v93, v93
v_mfma_f32_16x16x32_bf16 v[56:59], a[88:91], a[60:63], v[56:59]
s_waitcnt lgkmcnt(2)
v_exp_f32 v94, v94
v_mfma_f32_16x16x32_bf16 v[44:47], a[92:95], a[28:31], v[44:47]
ds_read_b128 a[72:75], v2 offset:26624
v_cvt_pk_bf16_f32 v125, v90, v91
v_mfma_f32_16x16x32_bf16 v[52:55], a[92:95], a[44:47], v[52:55]
v_exp_f32 v95, v95
v_mfma_f32_16x16x32_bf16 v[60:63], a[92:95], a[60:63], v[60:63]
s_waitcnt lgkmcnt(2)
v_cvt_pk_bf16_f32 v126, v92, v93
v_cvt_pk_bf16_f32 v127, v94, v95
v_mov_b32 v4, v2
v_mov_b32 v2, v3
v_add_u32 v3, 32768, v3
v_and_b32 v3, 131071, v3
v_mfma_f32_16x16x32_bf16 a[224:227], a[240:243], v[112:115], a[224:227]
s_lshl_b32 s46, s42, 14
v_mfma_f32_16x16x32_bf16 a[228:231], a[240:243], v[116:119], a[228:231]
v_mfma_f32_16x16x32_bf16 a[232:235], a[240:243], v[120:123], a[232:235]
v_mfma_f32_16x16x32_bf16 a[236:239], a[240:243], v[124:127], a[236:239]
v_cmp_le_i32 s[30:31], 0, v5
v_cmp_le_i32 s[32:33], 1, v5
v_mfma_f32_16x16x32_bf16 a[96:99], a[64:67], v[112:115], a[96:99]
ds_read_b128 a[76:79], v4 offset:27648
v_cmp_le_i32 s[34:35], 2, v5
v_mfma_f32_16x16x32_bf16 a[100:103], a[64:67], v[116:119], a[100:103]
v_cmp_le_i32 s[36:37], 3, v5
v_cndmask_b32 v40, v8, v40, s[30:31]
v_mfma_f32_16x16x32_bf16 a[104:107], a[64:67], v[120:123], a[104:107]
v_cndmask_b32 v41, v8, v41, s[32:33]
v_cndmask_b32 v42, v8, v42, s[34:35]
v_mfma_f32_16x16x32_bf16 a[108:111], a[64:67], v[124:127], a[108:111]
s_waitcnt lgkmcnt(2)
v_cndmask_b32 v43, v8, v43, s[36:37]
v_cmp_le_i32 s[30:31], 8, v5
v_mfma_f32_16x16x32_bf16 a[112:115], a[68:71], v[112:115], a[112:115]
ds_read_b128 a[80:83], v4 offset:28672
v_cmp_le_i32 s[32:33], 9, v5
v_mfma_f32_16x16x32_bf16 a[116:119], a[68:71], v[116:119], a[116:119]
v_cmp_le_i32 s[34:35], 10, v5
v_cmp_le_i32 s[36:37], 11, v5
v_mfma_f32_16x16x32_bf16 a[120:123], a[68:71], v[120:123], a[120:123]
v_cndmask_b32 v44, v8, v44, s[30:31]
v_cndmask_b32 v45, v8, v45, s[32:33]
v_mfma_f32_16x16x32_bf16 a[124:127], a[68:71], v[124:127], a[124:127]
s_waitcnt lgkmcnt(2)
v_cndmask_b32 v46, v8, v46, s[34:35]
v_cndmask_b32 v47, v8, v47, s[36:37]
v_mfma_f32_16x16x32_bf16 a[128:131], a[72:75], v[112:115], a[128:131]
ds_read_b128 a[84:87], v4 offset:29696
v_max3_f32 v16, v40, v41, v42
v_mfma_f32_16x16x32_bf16 a[132:135], a[72:75], v[116:119], a[132:135]
s_add_u32 s46, s46, 0
v_max3_f32 v16, v16, v43, v48
v_max3_f32 v16, v16, v49, v50
v_mfma_f32_16x16x32_bf16 a[136:139], a[72:75], v[120:123], a[136:139]
v_max3_f32 v16, v16, v51, v56
v_max3_f32 v16, v16, v57, v58
v_mfma_f32_16x16x32_bf16 a[140:143], a[72:75], v[124:127], a[140:143]
s_waitcnt lgkmcnt(2)
v_max3_f32 v16, v16, v59, v44
v_max3_f32 v16, v16, v45, v46
v_mfma_f32_16x16x32_bf16 a[144:147], a[76:79], v[112:115], a[144:147]
ds_read_b128 a[88:91], v4 offset:30720
v_max3_f32 v16, v16, v47, v52
v_mfma_f32_16x16x32_bf16 a[148:151], a[76:79], v[116:119], a[148:151]
v_max3_f32 v16, v16, v53, v54
v_max3_f32 v16, v16, v55, v60
v_mfma_f32_16x16x32_bf16 a[152:155], a[76:79], v[120:123], a[152:155]
v_max3_f32 v16, v16, v61, v62
v_max_f32 v16, v16, v63
v_mfma_f32_16x16x32_bf16 a[156:159], a[76:79], v[124:127], a[156:159]
s_waitcnt lgkmcnt(2)
v_cmp_lt_f32 vcc, s54, v16
v_mfma_f32_16x16x32_bf16 a[160:163], a[80:83], v[112:115], a[160:163]
ds_read_b128 a[92:95], v4 offset:31744
s_cbranch_vccnz L_at_up4
L_at_upr4:
v_mfma_f32_16x16x32_bf16 a[164:167], a[80:83], v[116:119], a[164:167]
v_exp_f32 v40, v40
v_mfma_f32_16x16x32_bf16 a[168:171], a[80:83], v[120:123], a[168:171]
v_exp_f32 v41, v41
v_mfma_f32_16x16x32_bf16 a[172:175], a[80:83], v[124:127], a[172:175]
s_waitcnt lgkmcnt(2)
v_exp_f32 v42, v42
v_mfma_f32_16x16x32_bf16 a[176:179], a[84:87], v[112:115], a[176:179]
ds_read_b128 a[64:67], v2 offset:16384
v_cvt_pk_bf16_f32 v100, v40, v41
v_mfma_f32_16x16x32_bf16 a[180:183], a[84:87], v[116:119], a[180:183]
v_exp_f32 v43, v43
v_mfma_f32_16x16x32_bf16 a[184:187], a[84:87], v[120:123], a[184:187]
v_exp_f32 v44, v44
v_mfma_f32_16x16x32_bf16 a[188:191], a[84:87], v[124:127], a[188:191]
s_waitcnt lgkmcnt(2)
v_exp_f32 v45, v45
v_mfma_f32_16x16x32_bf16 a[192:195], a[88:91], v[112:115], a[192:195]
ds_read_b128 a[68:71], v2 offset:17408
v_cvt_pk_bf16_f32 v101, v42, v43
v_mfma_f32_16x16x32_bf16 a[196:199], a[88:91], v[116:119], a[196:199]
v_exp_f32 v46, v46
v_mfma_f32_16x16x32_bf16 a[200:203], a[88:91], v[120:123], a[200:203]
s_cmp_lt_u32 s63, 8
s_cselect_b32 s46, s46, 536870912
v_cvt_pk_bf16_f32 v102, v44, v45
v_mfma_f32_16x16x32_bf16 a[204:207], a[88:91], v[124:127], a[204:207]
s_waitcnt lgkmcnt(2)
v_exp_f32 v47, v47
v_mfma_f32_16x16x32_bf16 a[208:211], a[92:95], v[112:115], a[208:211]
ds_read_b128 a[72:75], v2 offset:18432
v_cvt_pk_bf16_f32 v103, v46, v47
v_mfma_f32_16x16x32_bf16 a[212:215], a[92:95], v[116:119], a[212:215]
v_exp_f32 v48, v48
v_mfma_f32_16x16x32_bf16 a[216:219], a[92:95], v[120:123], a[216:219]
v_exp_f32 v49, v49
v_mfma_f32_16x16x32_bf16 a[220:223], a[92:95], v[124:127], a[220:223]
s_waitcnt lgkmcnt(2)
s_cmp_eq_u32 s48, 0
s_cbranch_scc0 L_at_rs4
L_at_rsr4:
v_mfma_f32_16x16x32_bf16 v[72:75], a[64:67], a[16:19], v[132:135]
ds_read_b128 a[76:79], v2 offset:19456
v_cvt_pk_bf16_f32 v104, v48, v49
v_mfma_f32_16x16x32_bf16 v[80:83], a[64:67], a[32:35], v[136:139]
v_exp_f32 v50, v50
v_mfma_f32_16x16x32_bf16 v[88:91], a[64:67], a[48:51], v[140:143]
s_waitcnt lgkmcnt(2)
v_exp_f32 v51, v51
v_mfma_f32_16x16x32_bf16 v[76:79], a[68:71], a[16:19], v[132:135]
ds_read_b128 a[80:83], v2 offset:20480
v_cvt_pk_bf16_f32 v105, v50, v51
v_mfma_f32_16x16x32_bf16 v[84:87], a[68:71], a[32:35], v[136:139]
v_exp_f32 v52, v52
v_mfma_f32_16x16x32_bf16 v[92:95], a[68:71], a[48:51], v[140:143]
s_waitcnt lgkmcnt(2)
v_exp_f32 v53, v53
v_mfma_f32_16x16x32_bf16 v[72:75], a[72:75], a[20:23], v[72:75]
ds_read_b128 a[84:87], v2 offset:21504
v_cvt_pk_bf16_f32 v106, v52, v53
v_mfma_f32_16x16x32_bf16 v[80:83], a[72:75], a[36:39], v[80:83]
v_exp_f32 v54, v54
v_mfma_f32_16x16x32_bf16 v[88:91], a[72:75], a[52:55], v[88:91]
s_waitcnt lgkmcnt(2)
v_exp_f32 v55, v55
v_mfma_f32_16x16x32_bf16 v[76:79], a[76:79], a[20:23], v[76:79]
ds_read_b128 a[88:91], v2 offset:22528
v_cvt_pk_bf16_f32 v107, v54, v55
v_mfma_f32_16x16x32_bf16 v[84:87], a[76:79], a[36:39], v[84:87]
v_exp_f32 v56, v56
v_mfma_f32_16x16x32_bf16 v[92:95], a[76:79], a[52:55], v[92:95]
s_waitcnt lgkmcnt(2)
v_exp_f32 v57, v57
v_mfma_f32_16x16x32_bf16 v[72:75], a[80:83], a[24:27], v[72:75]
ds_read_b128 a[92:95], v2 offset:23552
v_cvt_pk_bf16_f32 v108, v56, v57
v_mfma_f32_16x16x32_bf16 v[80:83], a[80:83], a[40:43], v[80:83]
v_exp_f32 v58, v58
v_mfma_f32_16x16x32_bf16 v[88:91], a[80:83], a[56:59], v[88:91]
s_waitcnt lgkmcnt(2)
v_exp_f32 v59, v59
v_mfma_f32_16x16x32_bf16 v[76:79], a[84:87], a[24:27], v[76:79]
ds_read_b128 a[64:67], v2 offset:8192
v_cvt_pk_bf16_f32 v109, v58, v59
v_mfma_f32_16x16x32_bf16 v[84:87], a[84:87], a[40:43], v[84:87]
v_exp_f32 v60, v60
v_mfma_f32_16x16x32_bf16 v[92:95], a[84:87], a[56:59], v[92:95]
s_waitcnt lgkmcnt(2)
v_exp_f32 v61, v61
v_mfma_f32_16x16x32_bf16 v[72:75], a[88:91], a[28:31], v[72:75]
ds_read_b128 a[68:71], v2 offset:9216
v_cvt_pk_bf16_f32 v110, v60, v61
v_mfma_f32_16x16x32_bf16 v[80:83], a[88:91], a[44:47], v[80:83]
v_exp_f32 v62, v62
v_mfma_f32_16x16x32_bf16 v[88:91], a[88:91], a[60:63], v[88:91]
s_waitcnt lgkmcnt(2)
v_exp_f32 v63, v63
v_mfma_f32_16x16x32_bf16 v[76:79], a[92:95], a[28:31], v[76:79]
ds_read_b128 a[72:75], v2 offset:10240
v_cvt_pk_bf16_f32 v111, v62, v63
v_mfma_f32_16x16x32_bf16 v[84:87], a[92:95], a[44:47], v[84:87]
v_mfma_f32_16x16x32_bf16 v[92:95], a[92:95], a[60:63], v[92:95]
s_waitcnt lgkmcnt(2)
s_waitcnt vmcnt(8)
s_barrier
s_add_u32 s25, s61, 0
v_mov_b32 v19, 1
s_mov_b64 exec, 1
buffer_store_dword v19, v6, s[8:11], s60 offen sc1
s_mov_b64 exec, -1
v_mfma_f32_16x16x32_bf16 a[228:231], a[240:243], v[100:103], a[228:231]
s_add_u32 s24, s46, 4096
v_mfma_f32_16x16x32_bf16 a[232:235], a[240:243], v[104:107], a[232:235]
v_mfma_f32_16x16x32_bf16 a[236:239], a[240:243], v[108:111], a[236:239]
s_add_u32 m0, s47, 0
v_mfma_f32_16x16x32_bf16 a[100:103], a[64:67], v[100:103], a[100:103]
ds_read_b128 a[76:79], v2 offset:11264
v_cmp_le_i32 s[30:31], 32, v5
v_mfma_f32_16x16x32_bf16 a[104:107], a[64:67], v[104:107], a[104:107]
v_cmp_le_i32 s[32:33], 33, v5
v_cmp_le_i32 s[34:35], 34, v5
v_mfma_f32_16x16x32_bf16 a[108:111], a[64:67], v[108:111], a[108:111]
s_waitcnt lgkmcnt(2)
buffer_load_dwordx4 v1, s[8:11], s46 offen sc1 lds
v_cmp_le_i32 s[36:37], 35, v5
v_mfma_f32_16x16x32_bf16 a[116:119], a[68:71], v[100:103], a[116:119]
ds_read_b128 a[80:83], v2 offset:12288
v_cndmask_b32 v72, v8, v72, s[30:31]
v_cndmask_b32 v73, v8, v73, s[32:33]
v_mfma_f32_16x16x32_bf16 a[120:123], a[68:71], v[104:107], a[120:123]
v_cndmask_b32 v74, v8, v74, s[34:35]
v_cndmask_b32 v75, v8, v75, s[36:37]
v_mfma_f32_16x16x32_bf16 a[124:127], a[68:71], v[108:111], a[124:127]
s_waitcnt lgkmcnt(2)
buffer_load_dwordx4 v1, s[8:11], s46 offen offset:2048 sc1 lds
v_cmp_le_i32 s[30:31], 40, v5
v_mfma_f32_16x16x32_bf16 a[132:135], a[72:75], v[100:103], a[132:135]
ds_read_b128 a[84:87], v2 offset:13312
v_cmp_le_i32 s[32:33], 41, v5
v_cmp_le_i32 s[34:35], 42, v5
v_mfma_f32_16x16x32_bf16 a[136:139], a[72:75], v[104:107], a[136:139]
s_add_u32 m0, s47, 896
v_cmp_le_i32 s[36:37], 43, v5
v_cndmask_b32 v76, v8, v76, s[30:31]
v_mfma_f32_16x16x32_bf16 a[140:143], a[72:75], v[108:111], a[140:143]
s_waitcnt lgkmcnt(2)
v_cndmask_b32 v77, v8, v77, s[32:33]
v_cndmask_b32 v78, v8, v78, s[34:35]
v_mfma_f32_16x16x32_bf16 a[148:151], a[76:79], v[100:103], a[148:151]
ds_read_b128 a[88:91], v2 offset:14336
v_cndmask_b32 v79, v8, v79, s[36:37]
v_mfma_f32_16x16x32_bf16 a[152:155], a[76:79], v[104:107], a[152:155]
buffer_load_dwordx4 v1, s[8:11], s46 offen offset:128 sc1 lds
v_max3_f32 v16, v72, v73, v74
v_max3_f32 v16, v16, v75, v80
v_mfma_f32_16x16x32_bf16 a[156:159], a[76:79], v[108:111], a[156:159]
s_waitcnt lgkmcnt(2)
v_max3_f32 v16, v16, v81, v82
v_max3_f32 v16, v16, v83, v88
v_mfma_f32_16x16x32_bf16 a[164:167], a[80:83], v[100:103], a[164:167]
ds_read_b128 a[92:95], v2 offset:15360
v_max3_f32 v16, v16, v89, v90
v_mfma_f32_16x16x32_bf16 a[168:171], a[80:83], v[104:107], a[168:171]
buffer_load_dwordx4 v1, s[8:11], s46 offen offset:2176 sc1 lds
v_max3_f32 v16, v16, v91, v76
v_max3_f32 v16, v16, v77, v78
v_mfma_f32_16x16x32_bf16 a[172:175], a[80:83], v[108:111], a[172:175]
s_waitcnt lgkmcnt(2)
v_max3_f32 v16, v16, v79, v84
v_max3_f32 v16, v16, v85, v86
v_mfma_f32_16x16x32_bf16 a[180:183], a[84:87], v[100:103], a[180:183]
ds_read_b128 a[64:67], v3
s_add_u32 m0, s47, 4096
v_mfma_f32_16x16x32_bf16 a[184:187], a[84:87], v[104:107], a[184:187]
v_max3_f32 v16, v16, v87, v92
v_max3_f32 v16, v16, v93, v94
v_max_f32 v16, v16, v95
v_cmp_lt_f32 vcc, s54, v16
v_mfma_f32_16x16x32_bf16 a[188:191], a[84:87], v[108:111], a[188:191]
s_waitcnt lgkmcnt(2)
s_cbranch_vccnz L_at_up5
L_at_upr5:
v_exp_f32 v72, v72
v_exp_f32 v73, v73
v_exp_f32 v74, v74
v_mfma_f32_16x16x32_bf16 a[196:199], a[88:91], v[100:103], a[196:199]
ds_read_b128 a[68:71], v3 offset:1024
buffer_load_dwordx4 v1, s[8:11], s24 offen sc1 lds
v_exp_f32 v75, v75
v_exp_f32 v76, v76
v_exp_f32 v77, v77
v_mfma_f32_16x16x32_bf16 a[200:203], a[88:91], v[104:107], a[200:203]
v_exp_f32 v78, v78
v_exp_f32 v79, v79
v_exp_f32 v80, v80
v_exp_f32 v81, v81
v_mfma_f32_16x16x32_bf16 a[204:207], a[88:91], v[108:111], a[204:207]
s_waitcnt lgkmcnt(2)
v_exp_f32 v82, v82
v_exp_f32 v83, v83
v_exp_f32 v84, v84
v_exp_f32 v85, v85
v_mfma_f32_16x16x32_bf16 a[212:215], a[92:95], v[100:103], a[212:215]
ds_read_b128 a[72:75], v3 offset:2048
buffer_load_dwordx4 v1, s[8:11], s24 offen offset:2048 sc1 lds
v_exp_f32 v86, v86
v_exp_f32 v87, v87
v_exp_f32 v88, v88
v_mfma_f32_16x16x32_bf16 a[216:219], a[92:95], v[104:107], a[216:219]
v_exp_f32 v89, v89
v_exp_f32 v90, v90
v_exp_f32 v91, v91
v_exp_f32 v92, v92
v_mfma_f32_16x16x32_bf16 a[220:223], a[92:95], v[108:111], a[220:223]
s_waitcnt lgkmcnt(2)
s_add_u32 m0, s47, 4992
s_cmp_eq_u32 s48, 0
s_cbranch_scc0 L_at_rs5
L_at_rsr5:
v_exp_f32 v93, v93
v_exp_f32 v94, v94
v_exp_f32 v95, v95
v_mfma_f32_16x16x32_bf16 v[48:51], a[64:67], a[32:35], v[136:139]
ds_read_b128 a[76:79], v3 offset:3072
v_cvt_pk_bf16_f32 v116, v72, v73
v_cvt_pk_bf16_f32 v117, v74, v75
v_cvt_pk_bf16_f32 v118, v76, v77
v_cvt_pk_bf16_f32 v119, v78, v79
v_cvt_pk_bf16_f32 v120, v80, v81
v_cvt_pk_bf16_f32 v121, v82, v83
v_cvt_pk_bf16_f32 v122, v84, v85
v_mfma_f32_16x16x32_bf16 v[56:59], a[64:67], a[48:51], v[140:143]
s_waitcnt lgkmcnt(2)
v_cvt_pk_bf16_f32 v123, v86, v87
v_cvt_pk_bf16_f32 v124, v88, v89
v_cvt_pk_bf16_f32 v125, v90, v91
v_cvt_pk_bf16_f32 v126, v92, v93
v_cvt_pk_bf16_f32 v127, v94, v95
v_accvgpr_read_b32 v18, a224
v_rcp_f32 v18, v18
v_mfma_f32_16x16x32_bf16 v[52:55], a[68:71], a[32:35], v[136:139]
ds_read_b128 a[80:83], v3 offset:4096
buffer_load_dwordx4 v1, s[8:11], s24 offen offset:128 sc1 lds
v_accvgpr_read_b32 v224, a96
v_accvgpr_read_b32 v225, a97
v_accvgpr_read_b32 v226, a98
v_accvgpr_read_b32 v227, a99
v_accvgpr_read_b32 v228, a112
v_accvgpr_read_b32 v229, a113
v_mfma_f32_16x16x32_bf16 v[60:63], a[68:71], a[48:51], v[140:143]
s_waitcnt lgkmcnt(2)
v_accvgpr_read_b32 v230, a114
v_accvgpr_read_b32 v231, a115
v_mul_f32 v224, v224, v18
v_mul_f32 v225, v225, v18
v_mul_f32 v226, v226, v18
v_mul_f32 v227, v227, v18
v_mul_f32 v228, v228, v18
v_mul_f32 v229, v229, v18
v_mfma_f32_16x16x32_bf16 v[48:51], a[72:75], a[36:39], v[48:51]
ds_read_b128 a[84:87], v3 offset:5120
v_mul_f32 v230, v230, v18
v_mul_f32 v231, v231, v18
v_cvt_pk_bf16_f32 v224, v224, v225
v_cvt_pk_bf16_f32 v225, v226, v227
v_cvt_pk_bf16_f32 v226, v228, v229
v_cvt_pk_bf16_f32 v227, v230, v231
buffer_store_dwordx4 v[224:227], v6, s[8:11], s25 offen sc1
v_mfma_f32_16x16x32_bf16 v[56:59], a[72:75], a[52:55], v[56:59]
s_waitcnt lgkmcnt(2)
buffer_load_dwordx4 v1, s[8:11], s24 offen offset:2176 sc1 lds
v_accvgpr_read_b32 v232, a128
v_accvgpr_read_b32 v233, a129
v_accvgpr_read_b32 v234, a130
v_accvgpr_read_b32 v235, a131
v_accvgpr_read_b32 v236, a144
v_accvgpr_read_b32 v237, a145
v_accvgpr_read_b32 v238, a146
v_mfma_f32_16x16x32_bf16 v[52:55], a[76:79], a[36:39], v[52:55]
ds_read_b128 a[88:91], v3 offset:6144
v_accvgpr_read_b32 v239, a147
v_mul_f32 v232, v232, v18
v_mul_f32 v233, v233, v18
v_mul_f32 v234, v234, v18
v_mul_f32 v235, v235, v18
v_mul_f32 v236, v236, v18
v_mul_f32 v237, v237, v18
v_mfma_f32_16x16x32_bf16 v[60:63], a[76:79], a[52:55], v[60:63]
s_waitcnt lgkmcnt(2)
s_add_u32 s46, s46, 1048576
v_mul_f32 v238, v238, v18
v_mul_f32 v239, v239, v18
v_cvt_pk_bf16_f32 v232, v232, v233
v_cvt_pk_bf16_f32 v233, v234, v235
v_cvt_pk_bf16_f32 v234, v236, v237
v_cvt_pk_bf16_f32 v235, v238, v239
buffer_store_dwordx4 v[232:235], v6, s[8:11], s25 offen offset:1024 sc1
v_mfma_f32_16x16x32_bf16 v[48:51], a[80:83], a[40:43], v[48:51]
ds_read_b128 a[92:95], v3 offset:7168
v_accvgpr_read_b32 v240, a160
v_accvgpr_read_b32 v241, a161
v_accvgpr_read_b32 v242, a162
v_accvgpr_read_b32 v243, a163
v_accvgpr_read_b32 v244, a176
v_accvgpr_read_b32 v245, a177
v_mfma_f32_16x16x32_bf16 v[56:59], a[80:83], a[56:59], v[56:59]
s_waitcnt lgkmcnt(2)
v_accvgpr_read_b32 v246, a178
v_accvgpr_read_b32 v247, a179
v_mul_f32 v240, v240, v18
v_mul_f32 v241, v241, v18
v_mul_f32 v242, v242, v18
v_mul_f32 v243, v243, v18
v_mul_f32 v244, v244, v18
v_mfma_f32_16x16x32_bf16 v[52:55], a[84:87], a[40:43], v[52:55]
ds_read_b128 a[64:67], v2 offset:24576
s_add_u32 s47, s47, 32768
v_mul_f32 v245, v245, v18
v_mul_f32 v246, v246, v18
v_mul_f32 v247, v247, v18
v_cvt_pk_bf16_f32 v240, v240, v241
v_cvt_pk_bf16_f32 v241, v242, v243
v_mfma_f32_16x16x32_bf16 v[60:63], a[84:87], a[56:59], v[60:63]
s_waitcnt lgkmcnt(2)
v_cvt_pk_bf16_f32 v242, v244, v245
v_cvt_pk_bf16_f32 v243, v246, v247
buffer_store_dwordx4 v[240:243], v6, s[8:11], s25 offen offset:2048 sc1
v_accvgpr_read_b32 v248, a192
v_mfma_f32_16x16x32_bf16 v[48:51], a[88:91], a[44:47], v[48:51]
ds_read_b128 a[68:71], v2 offset:25600
v_accvgpr_read_b32 v249, a193
v_accvgpr_read_b32 v250, a194
v_accvgpr_read_b32 v251, a195
v_accvgpr_read_b32 v252, a208
v_accvgpr_read_b32 v253, a209
v_accvgpr_read_b32 v254, a210
v_mfma_f32_16x16x32_bf16 v[56:59], a[88:91], a[60:63], v[56:59]
s_waitcnt lgkmcnt(2)
s_and_b32 s47, s47, 131071
v_accvgpr_read_b32 v255, a211
v_mul_f32 v248, v248, v18
v_mul_f32 v249, v249, v18
v_mul_f32 v250, v250, v18
v_mul_f32 v251, v251, v18
v_mul_f32 v252, v252, v18
v_mfma_f32_16x16x32_bf16 v[52:55], a[92:95], a[44:47], v[52:55]
ds_read_b128 a[72:75], v2 offset:26624
v_mul_f32 v253, v253, v18
v_mul_f32 v254, v254, v18
v_mul_f32 v255, v255, v18
v_cvt_pk_bf16_f32 v248, v248, v249
v_cvt_pk_bf16_f32 v249, v250, v251
v_mfma_f32_16x16x32_bf16 v[60:63], a[92:95], a[60:63], v[60:63]
s_waitcnt lgkmcnt(2)
v_cvt_pk_bf16_f32 v250, v252, v253
v_cvt_pk_bf16_f32 v251, v254, v255
buffer_store_dwordx4 v[248:251], v6, s[8:11], s25 offen offset:3072 sc1
v_mov_b32 v4, v2
v_mov_b32 v2, v3
v_add_u32 v3, 32768, v3
v_and_b32 v3, 131071, v3
v_mfma_f32_16x16x32_bf16 a[228:231], a[240:243], v[116:119], a[228:231]
v_mfma_f32_16x16x32_bf16 a[232:235], a[240:243], v[120:123], a[232:235]
v_mfma_f32_16x16x32_bf16 a[236:239], a[240:243], v[124:127], a[236:239]
v_mfma_f32_16x16x32_bf16 a[100:103], a[64:67], v[116:119], a[100:103]
ds_read_b128 a[76:79], v4 offset:27648
v_cmp_le_i32 s[30:31], 0, v5
v_mfma_f32_16x16x32_bf16 a[104:107], a[64:67], v[120:123], a[104:107]
v_cmp_le_i32 s[32:33], 1, v5
v_cmp_le_i32 s[34:35], 2, v5
v_mfma_f32_16x16x32_bf16 a[108:111], a[64:67], v[124:127], a[108:111]
s_waitcnt lgkmcnt(2)
v_cmp_le_i32 s[36:37], 3, v5
v_cndmask_b32 v48, v8, v48, s[30:31]
v_mfma_f32_16x16x32_bf16 a[116:119], a[68:71], v[116:119], a[116:119]
ds_read_b128 a[80:83], v4 offset:28672
v_cndmask_b32 v49, v8, v49, s[32:33]
v_mfma_f32_16x16x32_bf16 a[120:123], a[68:71], v[120:123], a[120:123]
v_cndmask_b32 v50, v8, v50, s[34:35]
v_cndmask_b32 v51, v8, v51, s[36:37]
v_mfma_f32_16x16x32_bf16 a[124:127], a[68:71], v[124:127], a[124:127]
s_waitcnt lgkmcnt(2)
v_cmp_le_i32 s[30:31], 8, v5
v_cmp_le_i32 s[32:33], 9, v5
v_mfma_f32_16x16x32_bf16 a[132:135], a[72:75], v[116:119], a[132:135]
ds_read_b128 a[84:87], v4 offset:29696
v_cmp_le_i32 s[34:35], 10, v5
v_mfma_f32_16x16x32_bf16 a[136:139], a[72:75], v[120:123], a[136:139]
v_cmp_le_i32 s[36:37], 11, v5
v_cndmask_b32 v52, v8, v52, s[30:31]
v_mfma_f32_16x16x32_bf16 a[140:143], a[72:75], v[124:127], a[140:143]
s_waitcnt lgkmcnt(2)
v_cndmask_b32 v53, v8, v53, s[32:33]
v_cndmask_b32 v54, v8, v54, s[34:35]
v_mfma_f32_16x16x32_bf16 a[148:151], a[76:79], v[116:119], a[148:151]
ds_read_b128 a[88:91], v4 offset:30720
v_cndmask_b32 v55, v8, v55, s[36:37]
v_mfma_f32_16x16x32_bf16 a[152:155], a[76:79], v[120:123], a[152:155]
v_max3_f32 v16, v48, v49, v50
v_max3_f32 v16, v16, v51, v56
v_mfma_f32_16x16x32_bf16 a[156:159], a[76:79], v[124:127], a[156:159]
s_waitcnt lgkmcnt(2)
v_max3_f32 v16, v16, v57, v58
v_max3_f32 v16, v16, v59, v52
v_mfma_f32_16x16x32_bf16 a[164:167], a[80:83], v[116:119], a[164:167]
ds_read_b128 a[92:95], v4 offset:31744
v_max3_f32 v16, v16, v53, v54
v_mfma_f32_16x16x32_bf16 a[168:171], a[80:83], v[120:123], a[168:171]
v_max3_f32 v16, v16, v55, v60
v_max3_f32 v16, v16, v61, v62
v_mfma_f32_16x16x32_bf16 a[172:175], a[80:83], v[124:127], a[172:175]
s_waitcnt lgkmcnt(2)
v_max_f32 v16, v16, v63
v_cmp_lt_f32 vcc, s54, v16
v_mfma_f32_16x16x32_bf16 a[180:183], a[84:87], v[116:119], a[180:183]
ds_read_b128 a[64:67], v2 offset:16384
s_cbranch_vccnz L_at_up6
L_at_upr6:
v_mfma_f32_16x16x32_bf16 a[184:187], a[84:87], v[120:123], a[184:187]
v_exp_f32 v48, v48
v_mfma_f32_16x16x32_bf16 a[188:191], a[84:87], v[124:127], a[188:191]
s_waitcnt lgkmcnt(2)
v_exp_f32 v49, v49
v_mfma_f32_16x16x32_bf16 a[196:199], a[88:91], v[116:119], a[196:199]
ds_read_b128 a[68:71], v2 offset:17408
v_exp_f32 v50, v50
v_mfma_f32_16x16x32_bf16 a[200:203], a[88:91], v[120:123], a[200:203]
v_exp_f32 v51, v51
v_cvt_pk_bf16_f32 v104, v48, v49
v_mfma_f32_16x16x32_bf16 a[204:207], a[88:91], v[124:127], a[204:207]
s_waitcnt lgkmcnt(2)
v_exp_f32 v52, v52
v_cvt_pk_bf16_f32 v105, v50, v51
v_mfma_f32_16x16x32_bf16 a[212:215], a[92:95], v[116:119], a[212:215]
ds_read_b128 a[72:75], v2 offset:18432
v_exp_f32 v53, v53
v_mfma_f32_16x16x32_bf16 a[216:219], a[92:95], v[120:123], a[216:219]
v_exp_f32 v54, v54
v_mfma_f32_16x16x32_bf16 a[220:223], a[92:95], v[124:127], a[220:223]
s_waitcnt lgkmcnt(2)
s_cmp_eq_u32 s48, 0
s_cbranch_scc0 L_at_rs6
L_at_rsr6:
v_mfma_f32_16x16x32_bf16 v[80:83], a[64:67], a[32:35], v[136:139]
ds_read_b128 a[76:79], v2 offset:19456
v_cvt_pk_bf16_f32 v106, v52, v53
v_mfma_f32_16x16x32_bf16 v[88:91], a[64:67], a[48:51], v[140:143]
s_waitcnt lgkmcnt(2)
v_exp_f32 v55, v55
v_mfma_f32_16x16x32_bf16 v[84:87], a[68:71], a[32:35], v[136:139]
ds_read_b128 a[80:83], v2 offset:20480
v_cvt_pk_bf16_f32 v107, v54, v55
v_mfma_f32_16x16x32_bf16 v[92:95], a[68:71], a[48:51], v[140:143]
s_waitcnt lgkmcnt(2)
v_exp_f32 v56, v56
v_mfma_f32_16x16x32_bf16 v[80:83], a[72:75], a[36:39], v[80:83]
ds_read_b128 a[84:87], v2 offset:21504
v_mfma_f32_16x16x32_bf16 v[88:91], a[72:75], a[52:55], v[88:91]
s_waitcnt lgkmcnt(2)
v_exp_f32 v57, v57
v_mfma_f32_16x16x32_bf16 v[84:87], a[76:79], a[36:39], v[84:87]
ds_read_b128 a[88:91], v2 offset:22528
v_exp_f32 v58, v58
v_mfma_f32_16x16x32_bf16 v[92:95], a[76:79], a[52:55], v[92:95]
s_waitcnt lgkmcnt(2)
v_exp_f32 v59, v59
v_mfma_f32_16x16x32_bf16 v[80:83], a[80:83], a[40:43], v[80:83]
ds_read_b128 a[92:95], v2 offset:23552
v_cvt_pk_bf16_f32 v108, v56, v57
v_mfma_f32_16x16x32_bf16 v[88:91], a[80:83], a[56:59], v[88:91]
s_waitcnt lgkmcnt(2)
v_exp_f32 v60, v60
v_mfma_f32_16x16x32_bf16 v[84:87], a[84:87], a[40:43], v[84:87]
ds_read_b128 a[64:67], v2 offset:8192
v_cvt_pk_bf16_f32 v109, v58, v59
v_mfma_f32_16x16x32_bf16 v[92:95], a[84:87], a[56:59], v[92:95]
s_waitcnt lgkmcnt(2)
v_exp_f32 v61, v61
v_mfma_f32_16x16x32_bf16 v[80:83], a[88:91], a[44:47], v[80:83]
ds_read_b128 a[68:71], v2 offset:9216
v_cvt_pk_bf16_f32 v110, v60, v61
v_mfma_f32_16x16x32_bf16 v[88:91], a[88:91], a[60:63], v[88:91]
s_waitcnt lgkmcnt(2)
v_exp_f32 v62, v62
v_mfma_f32_16x16x32_bf16 v[84:87], a[92:95], a[44:47], v[84:87]
ds_read_b128 a[72:75], v2 offset:10240
v_mfma_f32_16x16x32_bf16 v[92:95], a[92:95], a[60:63], v[92:95]
s_waitcnt lgkmcnt(2)
v_exp_f32 v63, v63
s_nop 0
v_cvt_pk_bf16_f32 v111, v62, v63
s_waitcnt vmcnt(12)
s_barrier
s_add_u32 s25, s61, 524288
v_mfma_f32_16x16x32_bf16 a[232:235], a[240:243], v[104:107], a[232:235]
s_add_u32 s24, s46, 4096
v_mfma_f32_16x16x32_bf16 a[236:239], a[240:243], v[108:111], a[236:239]
s_add_u32 m0, s47, 0
v_mfma_f32_16x16x32_bf16 a[104:107], a[64:67], v[104:107], a[104:107]
ds_read_b128 a[76:79], v2 offset:11264
v_mfma_f32_16x16x32_bf16 a[108:111], a[64:67], v[108:111], a[108:111]
s_waitcnt lgkmcnt(2)
buffer_load_dwordx4 v1, s[8:11], s46 offen sc1 lds
v_cmp_le_i32 s[30:31], 32, v5
v_cmp_le_i32 s[32:33], 33, v5
v_mfma_f32_16x16x32_bf16 a[120:123], a[68:71], v[104:107], a[120:123]
ds_read_b128 a[80:83], v2 offset:12288
buffer_load_dwordx4 v1, s[8:11], s46 offen offset:2048 sc1 lds
v_cmp_le_i32 s[34:35], 34, v5
v_mfma_f32_16x16x32_bf16 a[124:127], a[68:71], v[108:111], a[124:127]
s_waitcnt lgkmcnt(2)
v_cmp_le_i32 s[36:37], 35, v5
v_cndmask_b32 v80, v8, v80, s[30:31]
v_cndmask_b32 v81, v8, v81, s[32:33]
v_mfma_f32_16x16x32_bf16 a[136:139], a[72:75], v[104:107], a[136:139]
ds_read_b128 a[84:87], v2 offset:13312
s_add_u32 m0, s47, 896
v_cndmask_b32 v82, v8, v82, s[34:35]
v_mfma_f32_16x16x32_bf16 a[140:143], a[72:75], v[108:111], a[140:143]
s_waitcnt lgkmcnt(2)
v_cndmask_b32 v83, v8, v83, s[36:37]
v_cmp_le_i32 s[30:31], 40, v5
v_cmp_le_i32 s[32:33], 41, v5
v_mfma_f32_16x16x32_bf16 a[152:155], a[76:79], v[104:107], a[152:155]
ds_read_b128 a[88:91], v2 offset:14336
buffer_load_dwordx4 v1, s[8:11], s46 offen offset:128 sc1 lds
v_cmp_le_i32 s[34:35], 42, v5
v_mfma_f32_16x16x32_bf16 a[156:159], a[76:79], v[108:111], a[156:159]
s_waitcnt lgkmcnt(2)
buffer_load_dwordx4 v1, s[8:11], s46 offen offset:2176 sc1 lds
v_cmp_le_i32 s[36:37], 43, v5
v_cndmask_b32 v84, v8, v84, s[30:31]
v_mfma_f32_16x16x32_bf16 a[168:171], a[80:83], v[104:107], a[168:171]
ds_read_b128 a[92:95], v2 offset:15360
v_cndmask_b32 v85, v8, v85, s[32:33]
v_cndmask_b32 v86, v8, v86, s[34:35]
v_mfma_f32_16x16x32_bf16 a[172:175], a[80:83], v[108:111], a[172:175]
s_waitcnt lgkmcnt(2)
s_add_u32 m0, s47, 4096
v_cndmask_b32 v87, v8, v87, s[36:37]
v_max3_f32 v16, v80, v81, v82
v_mfma_f32_16x16x32_bf16 a[184:187], a[84:87], v[104:107], a[184:187]
ds_read_b128 a[64:67], v3
v_max3_f32 v16, v16, v83, v88
v_max3_f32 v16, v16, v89, v90
v_mfma_f32_16x16x32_bf16 a[188:191], a[84:87], v[108:111], a[188:191]
s_waitcnt lgkmcnt(2)
buffer_load_dwordx4 v1, s[8:11], s24 offen sc1 lds
v_max3_f32 v16, v16, v91, v84
v_max3_f32 v16, v16, v85, v86
v_mfma_f32_16x16x32_bf16 a[200:203], a[88:91], v[104:107], a[200:203]
ds_read_b128 a[68:71], v3 offset:1024
buffer_load_dwordx4 v1, s[8:11], s24 offen offset:2048 sc1 lds
v_max3_f32 v16, v16, v87, v92
v_mfma_f32_16x16x32_bf16 a[204:207], a[88:91], v[108:111], a[204:207]
s_waitcnt lgkmcnt(2)
v_max3_f32 v16, v16, v93, v94
v_max_f32 v16, v16, v95
v_cmp_lt_f32 vcc, s54, v16
v_mfma_f32_16x16x32_bf16 a[216:219], a[92:95], v[104:107], a[216:219]
ds_read_b128 a[72:75], v3 offset:2048
s_add_u32 m0, s47, 4992
s_cbranch_vccnz L_at_up7
L_at_upr7:
v_exp_f32 v80, v80
v_exp_f32 v81, v81
v_exp_f32 v82, v82
v_exp_f32 v83, v83
v_exp_f32 v84, v84
v_exp_f32 v85, v85
v_exp_f32 v86, v86
v_mfma_f32_16x16x32_bf16 a[220:223], a[92:95], v[108:111], a[220:223]
s_waitcnt lgkmcnt(2)
buffer_load_dwordx4 v1, s[8:11], s24 offen offset:128 sc1 lds
s_cmp_eq_u32 s48, 0
s_cbranch_scc0 L_at_rs7
L_at_rsr7:
v_exp_f32 v87, v87
v_exp_f32 v88, v88
v_exp_f32 v89, v89
v_exp_f32 v90, v90
v_exp_f32 v91, v91
v_exp_f32 v92, v92
v_exp_f32 v93, v93
v_mfma_f32_16x16x32_bf16 v[56:59], a[64:67], a[48:51], v[140:143]
ds_read_b128 a[76:79], v3 offset:3072
s_waitcnt lgkmcnt(2)
v_exp_f32 v94, v94
v_exp_f32 v95, v95
v_cvt_pk_bf16_f32 v120, v80, v81
v_cvt_pk_bf16_f32 v121, v82, v83
v_cvt_pk_bf16_f32 v122, v84, v85
v_cvt_pk_bf16_f32 v123, v86, v87
v_cvt_pk_bf16_f32 v124, v88, v89
v_cvt_pk_bf16_f32 v125, v90, v91
v_cvt_pk_bf16_f32 v126, v92, v93
v_accvgpr_read_b32 v18, a228
v_rcp_f32 v18, v18
v_mfma_f32_16x16x32_bf16 v[60:63], a[68:71], a[48:51], v[140:143]
ds_read_b128 a[80:83], v3 offset:4096
s_waitcnt lgkmcnt(2)
buffer_load_dwordx4 v1, s[8:11], s24 offen offset:2176 sc1 lds
v_cvt_pk_bf16_f32 v127, v94, v95
v_accvgpr_read_b32 v224, a100
v_accvgpr_read_b32 v225, a101
v_accvgpr_read_b32 v226, a102
v_accvgpr_read_b32 v227, a103
v_accvgpr_read_b32 v228, a116
v_accvgpr_read_b32 v229, a117
v_accvgpr_read_b32 v230, a118
v_accvgpr_read_b32 v231, a119
v_mul_f32 v224, v224, v18
v_mul_f32 v225, v225, v18
v_mul_f32 v226, v226, v18
v_mul_f32 v227, v227, v18
v_mul_f32 v228, v228, v18
v_mfma_f32_16x16x32_bf16 v[56:59], a[72:75], a[52:55], v[56:59]
ds_read_b128 a[84:87], v3 offset:5120
s_waitcnt lgkmcnt(2)
v_mul_f32 v229, v229, v18
v_mul_f32 v230, v230, v18
v_mul_f32 v231, v231, v18
v_cvt_pk_bf16_f32 v224, v224, v225
v_cvt_pk_bf16_f32 v225, v226, v227
v_cvt_pk_bf16_f32 v226, v228, v229
v_cvt_pk_bf16_f32 v227, v230, v231
buffer_store_dwordx4 v[224:227], v6, s[8:11], s25 offen sc1
v_accvgpr_read_b32 v232, a132
v_accvgpr_read_b32 v233, a133
v_accvgpr_read_b32 v234, a134
v_mfma_f32_16x16x32_bf16 v[60:63], a[76:79], a[52:55], v[60:63]
ds_read_b128 a[88:91], v3 offset:6144
s_waitcnt lgkmcnt(2)
s_add_u32 s46, s46, 1048576
v_accvgpr_read_b32 v235, a135
v_accvgpr_read_b32 v236, a148
v_accvgpr_read_b32 v237, a149
v_accvgpr_read_b32 v238, a150
v_accvgpr_read_b32 v239, a151
v_mul_f32 v232, v232, v18
v_mul_f32 v233, v233, v18
v_mul_f32 v234, v234, v18
v_mul_f32 v235, v235, v18
v_mul_f32 v236, v236, v18
v_mul_f32 v237, v237, v18
v_mul_f32 v238, v238, v18
v_mul_f32 v239, v239, v18
v_cvt_pk_bf16_f32 v232, v232, v233
v_mfma_f32_16x16x32_bf16 v[56:59], a[80:83], a[56:59], v[56:59]
ds_read_b128 a[92:95], v3 offset:7168
s_waitcnt lgkmcnt(2)
s_add_u32 s47, s47, 32768
v_cvt_pk_bf16_f32 v233, v234, v235
v_cvt_pk_bf16_f32 v234, v236, v237
v_cvt_pk_bf16_f32 v235, v238, v239
buffer_store_dwordx4 v[232:235], v6, s[8:11], s25 offen offset:1024 sc1
v_accvgpr_read_b32 v240, a164
v_accvgpr_read_b32 v241, a165
v_accvgpr_read_b32 v242, a166
v_accvgpr_read_b32 v243, a167
v_accvgpr_read_b32 v244, a180
v_accvgpr_read_b32 v245, a181
v_accvgpr_read_b32 v246, a182
v_mfma_f32_16x16x32_bf16 v[60:63], a[84:87], a[56:59], v[60:63]
ds_read_b128 a[64:67], v2 offset:24576
s_waitcnt lgkmcnt(2)
v_accvgpr_read_b32 v247, a183
v_mul_f32 v240, v240, v18
v_mul_f32 v241, v241, v18
v_mul_f32 v242, v242, v18
v_mul_f32 v243, v243, v18
v_mul_f32 v244, v244, v18
v_mul_f32 v245, v245, v18
v_mul_f32 v246, v246, v18
v_mul_f32 v247, v247, v18
v_cvt_pk_bf16_f32 v240, v240, v241
v_cvt_pk_bf16_f32 v241, v242, v243
v_cvt_pk_bf16_f32 v242, v244, v245
v_cvt_pk_bf16_f32 v243, v246, v247
buffer_store_dwordx4 v[240:243], v6, s[8:11], s25 offen offset:2048 sc1
v_mfma_f32_16x16x32_bf16 v[56:59], a[88:91], a[60:63], v[56:59]
ds_read_b128 a[68:71], v2 offset:25600
s_waitcnt lgkmcnt(2)
s_and_b32 s47, s47, 131071
v_accvgpr_read_b32 v248, a196
v_accvgpr_read_b32 v249, a197
v_accvgpr_read_b32 v250, a198
v_accvgpr_read_b32 v251, a199
v_accvgpr_read_b32 v252, a212
v_accvgpr_read_b32 v253, a213
v_accvgpr_read_b32 v254, a214
v_accvgpr_read_b32 v255, a215
v_mul_f32 v248, v248, v18
v_mul_f32 v249, v249, v18
v_mul_f32 v250, v250, v18
v_mul_f32 v251, v251, v18
v_mfma_f32_16x16x32_bf16 v[60:63], a[92:95], a[60:63], v[60:63]
ds_read_b128 a[72:75], v2 offset:26624
s_waitcnt lgkmcnt(2)
v_mul_f32 v252, v252, v18
v_mul_f32 v253, v253, v18
v_mul_f32 v254, v254, v18
v_mul_f32 v255, v255, v18
v_cvt_pk_bf16_f32 v248, v248, v249
v_cvt_pk_bf16_f32 v249, v250, v251
v_cvt_pk_bf16_f32 v250, v252, v253
v_cvt_pk_bf16_f32 v251, v254, v255
buffer_store_dwordx4 v[248:251], v6, s[8:11], s25 offen offset:3072 sc1
v_mov_b32 v4, v2
v_mov_b32 v2, v3
v_add_u32 v3, 32768, v3
v_and_b32 v3, 131071, v3
v_mfma_f32_16x16x32_bf16 a[232:235], a[240:243], v[120:123], a[232:235]
v_mfma_f32_16x16x32_bf16 a[236:239], a[240:243], v[124:127], a[236:239]
v_mfma_f32_16x16x32_bf16 a[104:107], a[64:67], v[120:123], a[104:107]
ds_read_b128 a[76:79], v4 offset:27648
v_mfma_f32_16x16x32_bf16 a[108:111], a[64:67], v[124:127], a[108:111]
s_waitcnt lgkmcnt(2)
v_cmp_le_i32 s[30:31], 0, v5
v_cmp_le_i32 s[32:33], 1, v5
v_mfma_f32_16x16x32_bf16 a[120:123], a[68:71], v[120:123], a[120:123]
ds_read_b128 a[80:83], v4 offset:28672
v_cmp_le_i32 s[34:35], 2, v5
v_mfma_f32_16x16x32_bf16 a[124:127], a[68:71], v[124:127], a[124:127]
s_waitcnt lgkmcnt(2)
v_cmp_le_i32 s[36:37], 3, v5
v_cndmask_b32 v56, v8, v56, s[30:31]
v_mfma_f32_16x16x32_bf16 a[136:139], a[72:75], v[120:123], a[136:139]
ds_read_b128 a[84:87], v4 offset:29696
v_cndmask_b32 v57, v8, v57, s[32:33]
v_mfma_f32_16x16x32_bf16 a[140:143], a[72:75], v[124:127], a[140:143]
s_waitcnt lgkmcnt(2)
v_cndmask_b32 v58, v8, v58, s[34:35]
v_cndmask_b32 v59, v8, v59, s[36:37]
v_mfma_f32_16x16x32_bf16 a[152:155], a[76:79], v[120:123], a[152:155]
ds_read_b128 a[88:91], v4 offset:30720
v_cmp_le_i32 s[30:31], 8, v5
v_mfma_f32_16x16x32_bf16 a[156:159], a[76:79], v[124:127], a[156:159]
s_waitcnt lgkmcnt(2)
v_cmp_le_i32 s[32:33], 9, v5
v_cmp_le_i32 s[34:35], 10, v5
v_mfma_f32_16x16x32_bf16 a[168:171], a[80:83], v[120:123], a[168:171]
ds_read_b128 a[92:95], v4 offset:31744
v_cmp_le_i32 s[36:37], 11, v5
v_mfma_f32_16x16x32_bf16 a[172:175], a[80:83], v[124:127], a[172:175]
s_waitcnt lgkmcnt(2)
v_cndmask_b32 v60, v8, v60, s[30:31]
v_cndmask_b32 v61, v8, v61, s[32:33]
v_mfma_f32_16x16x32_bf16 a[184:187], a[84:87], v[120:123], a[184:187]
ds_read_b128 a[64:67], v2 offset:16384
v_cndmask_b32 v62, v8, v62, s[34:35]
v_mfma_f32_16x16x32_bf16 a[188:191], a[84:87], v[124:127], a[188:191]
s_waitcnt lgkmcnt(2)
v_cndmask_b32 v63, v8, v63, s[36:37]
v_max3_f32 v16, v56, v57, v58
v_mfma_f32_16x16x32_bf16 a[200:203], a[88:91], v[120:123], a[200:203]
ds_read_b128 a[68:71], v2 offset:17408
v_max3_f32 v16, v16, v59, v60
v_max3_f32 v16, v16, v61, v62
v_max_f32 v16, v16, v63
v_cmp_lt_f32 vcc, s54, v16
v_mfma_f32_16x16x32_bf16 a[204:207], a[88:91], v[124:127], a[204:207]
s_waitcnt lgkmcnt(2)
s_cbranch_vccnz L_at_up8
L_at_upr8:
v_exp_f32 v56, v56
v_mfma_f32_16x16x32_bf16 a[216:219], a[92:95], v[120:123], a[216:219]
ds_read_b128 a[72:75], v2 offset:18432
v_exp_f32 v57, v57
v_mfma_f32_16x16x32_bf16 a[220:223], a[92:95], v[124:127], a[220:223]
s_waitcnt lgkmcnt(2)
s_cmp_eq_u32 s48, 0
s_cbranch_scc0 L_at_rs8
L_at_rsr8:
v_exp_f32 v58, v58
v_mfma_f32_16x16x32_bf16 v[88:91], a[64:67], a[48:51], v[140:143]
ds_read_b128 a[76:79], v2 offset:19456
s_waitcnt lgkmcnt(2)
v_exp_f32 v59, v59
v_mfma_f32_16x16x32_bf16 v[92:95], a[68:71], a[48:51], v[140:143]
ds_read_b128 a[80:83], v2 offset:20480
s_waitcnt lgkmcnt(2)
v_exp_f32 v60, v60
v_mfma_f32_16x16x32_bf16 v[88:91], a[72:75], a[52:55], v[88:91]
ds_read_b128 a[84:87], v2 offset:21504
s_waitcnt lgkmcnt(2)
v_exp_f32 v61, v61
v_mfma_f32_16x16x32_bf16 v[92:95], a[76:79], a[52:55], v[92:95]
ds_read_b128 a[88:91], v2 offset:22528
s_waitcnt lgkmcnt(2)
v_exp_f32 v62, v62
v_mfma_f32_16x16x32_bf16 v[88:91], a[80:83], a[56:59], v[88:91]
ds_read_b128 a[92:95], v2 offset:23552
s_waitcnt lgkmcnt(2)
v_exp_f32 v63, v63
v_mfma_f32_16x16x32_bf16 v[92:95], a[84:87], a[56:59], v[92:95]
ds_read_b128 a[64:67], v2 offset:8192
s_waitcnt lgkmcnt(2)
v_cvt_pk_bf16_f32 v108, v56, v57
v_cvt_pk_bf16_f32 v109, v58, v59
v_mfma_f32_16x16x32_bf16 v[88:91], a[88:91], a[60:63], v[88:91]
ds_read_b128 a[68:71], v2 offset:9216
s_waitcnt lgkmcnt(2)
v_cvt_pk_bf16_f32 v110, v60, v61
v_mfma_f32_16x16x32_bf16 v[92:95], a[92:95], a[60:63], v[92:95]
ds_read_b128 a[72:75], v2 offset:10240
s_waitcnt lgkmcnt(2)
v_cvt_pk_bf16_f32 v111, v62, v63
s_barrier
s_add_u32 s25, s61, 1048576
v_mfma_f32_16x16x32_bf16 a[236:239], a[240:243], v[108:111], a[236:239]
s_add_u32 s24, s46, 4096
s_add_u32 m0, s47, 0
v_mfma_f32_16x16x32_bf16 a[108:111], a[64:67], v[108:111], a[108:111]
ds_read_b128 a[76:79], v2 offset:11264
s_waitcnt lgkmcnt(2)
buffer_load_dwordx4 v1, s[8:11], s46 offen sc1 lds
buffer_load_dwordx4 v1, s[8:11], s46 offen offset:2048 sc1 lds
v_mfma_f32_16x16x32_bf16 a[124:127], a[68:71], v[108:111], a[124:127]
ds_read_b128 a[80:83], v2 offset:12288
s_waitcnt lgkmcnt(2)
s_add_u32 m0, s47, 896
s_nop 0
buffer_load_dwordx4 v1, s[8:11], s46 offen offset:128 sc1 lds
v_mfma_f32_16x16x32_bf16 a[140:143], a[72:75], v[108:111], a[140:143]
ds_read_b128 a[84:87], v2 offset:13312
s_waitcnt lgkmcnt(2)
buffer_load_dwordx4 v1, s[8:11], s46 offen offset:2176 sc1 lds
s_add_u32 m0, s47, 4096
v_cmp_le_i32 s[30:31], 32, v5
v_cmp_le_i32 s[32:33], 33, v5
v_cmp_le_i32 s[34:35], 34, v5
v_cmp_le_i32 s[36:37], 35, v5
v_cndmask_b32 v88, v8, v88, s[30:31]
v_mfma_f32_16x16x32_bf16 a[156:159], a[76:79], v[108:111], a[156:159]
ds_read_b128 a[88:91], v2 offset:14336
s_waitcnt lgkmcnt(2)
buffer_load_dwordx4 v1, s[8:11], s24 offen sc1 lds
v_cndmask_b32 v89, v8, v89, s[32:33]
v_cndmask_b32 v90, v8, v90, s[34:35]
v_cndmask_b32 v91, v8, v91, s[36:37]
v_cmp_le_i32 s[30:31], 40, v5
v_cmp_le_i32 s[32:33], 41, v5
v_cmp_le_i32 s[34:35], 42, v5
v_mfma_f32_16x16x32_bf16 a[172:175], a[80:83], v[108:111], a[172:175]
ds_read_b128 a[92:95], v2 offset:15360
s_waitcnt lgkmcnt(2)
buffer_load_dwordx4 v1, s[8:11], s24 offen offset:2048 sc1 lds
s_add_u32 m0, s47, 4992
v_cmp_le_i32 s[36:37], 43, v5
v_cndmask_b32 v92, v8, v92, s[30:31]
v_cndmask_b32 v93, v8, v93, s[32:33]
v_cndmask_b32 v94, v8, v94, s[34:35]
v_cndmask_b32 v95, v8, v95, s[36:37]
v_mfma_f32_16x16x32_bf16 a[188:191], a[84:87], v[108:111], a[188:191]
ds_read_b128 a[64:67], v2 offset:24576
s_waitcnt lgkmcnt(2)
buffer_load_dwordx4 v1, s[8:11], s24 offen offset:128 sc1 lds
buffer_load_dwordx4 v1, s[8:11], s24 offen offset:2176 sc1 lds
v_max3_f32 v16, v88, v89, v90
v_max3_f32 v16, v16, v91, v92
v_max3_f32 v16, v16, v93, v94
v_max_f32 v16, v16, v95
v_cmp_lt_f32 vcc, s54, v16
v_mfma_f32_16x16x32_bf16 a[204:207], a[88:91], v[108:111], a[204:207]
ds_read_b128 a[68:71], v2 offset:25600
s_waitcnt lgkmcnt(2)
s_add_u32 s46, s46, 1048576
s_add_u32 s47, s47, 32768
s_cbranch_vccnz L_at_up9
L_at_upr9:
v_exp_f32 v88, v88
v_exp_f32 v89, v89
v_exp_f32 v90, v90
v_exp_f32 v91, v91
v_exp_f32 v92, v92
v_exp_f32 v93, v93
v_exp_f32 v94, v94
v_exp_f32 v95, v95
v_accvgpr_read_b32 v18, a232
v_rcp_f32 v18, v18
v_accvgpr_read_b32 v224, a104
v_accvgpr_read_b32 v225, a105
v_accvgpr_read_b32 v226, a106
v_accvgpr_read_b32 v227, a107
v_accvgpr_read_b32 v228, a120
v_accvgpr_read_b32 v229, a121
v_accvgpr_read_b32 v230, a122
v_accvgpr_read_b32 v231, a123
v_mul_f32 v224, v224, v18
v_mul_f32 v225, v225, v18
v_mul_f32 v226, v226, v18
v_mul_f32 v227, v227, v18
v_mul_f32 v228, v228, v18
v_mul_f32 v229, v229, v18
v_mul_f32 v230, v230, v18
v_mul_f32 v231, v231, v18
v_cvt_pk_bf16_f32 v224, v224, v225
v_cvt_pk_bf16_f32 v225, v226, v227
v_cvt_pk_bf16_f32 v226, v228, v229
v_cvt_pk_bf16_f32 v227, v230, v231
buffer_store_dwordx4 v[224:227], v6, s[8:11], s25 offen sc1
v_accvgpr_read_b32 v232, a136
v_accvgpr_read_b32 v233, a137
v_accvgpr_read_b32 v234, a138
v_accvgpr_read_b32 v235, a139
v_accvgpr_read_b32 v236, a152
v_accvgpr_read_b32 v237, a153
v_accvgpr_read_b32 v238, a154
v_accvgpr_read_b32 v239, a155
v_mul_f32 v232, v232, v18
v_mul_f32 v233, v233, v18
v_mul_f32 v234, v234, v18
v_mul_f32 v235, v235, v18
v_mul_f32 v236, v236, v18
v_mul_f32 v237, v237, v18
v_mul_f32 v238, v238, v18
v_mul_f32 v239, v239, v18
v_cvt_pk_bf16_f32 v232, v232, v233
v_mfma_f32_16x16x32_bf16 a[220:223], a[92:95], v[108:111], a[220:223]
ds_read_b128 a[72:75], v2 offset:26624
s_waitcnt lgkmcnt(2)
s_and_b32 s47, s47, 131071
s_cmp_eq_u32 s48, 0
s_cbranch_scc0 L_at_rs9
L_at_rsr9:
v_cvt_pk_bf16_f32 v124, v88, v89
v_cvt_pk_bf16_f32 v125, v90, v91
v_cvt_pk_bf16_f32 v126, v92, v93
v_cvt_pk_bf16_f32 v127, v94, v95
v_cvt_pk_bf16_f32 v233, v234, v235
v_cvt_pk_bf16_f32 v234, v236, v237
v_cvt_pk_bf16_f32 v235, v238, v239
buffer_store_dwordx4 v[232:235], v6, s[8:11], s25 offen offset:1024 sc1
v_accvgpr_read_b32 v240, a168
v_accvgpr_read_b32 v241, a169
v_accvgpr_read_b32 v242, a170
v_accvgpr_read_b32 v243, a171
v_accvgpr_read_b32 v244, a184
v_accvgpr_read_b32 v245, a185
v_accvgpr_read_b32 v246, a186
v_accvgpr_read_b32 v247, a187
v_mul_f32 v240, v240, v18
v_mul_f32 v241, v241, v18
v_mul_f32 v242, v242, v18
v_mul_f32 v243, v243, v18
v_mul_f32 v244, v244, v18
v_mul_f32 v245, v245, v18
v_mul_f32 v246, v246, v18
v_mul_f32 v247, v247, v18
v_cvt_pk_bf16_f32 v240, v240, v241
v_cvt_pk_bf16_f32 v241, v242, v243
v_cvt_pk_bf16_f32 v242, v244, v245
v_cvt_pk_bf16_f32 v243, v246, v247
buffer_store_dwordx4 v[240:243], v6, s[8:11], s25 offen offset:2048 sc1
v_accvgpr_read_b32 v248, a200
v_accvgpr_read_b32 v249, a201
v_accvgpr_read_b32 v250, a202
v_accvgpr_read_b32 v251, a203
v_accvgpr_read_b32 v252, a216
v_accvgpr_read_b32 v253, a217
v_accvgpr_read_b32 v254, a218
v_accvgpr_read_b32 v255, a219
v_mul_f32 v248, v248, v18
v_mul_f32 v249, v249, v18
v_mul_f32 v250, v250, v18
v_mul_f32 v251, v251, v18
v_mul_f32 v252, v252, v18
v_mul_f32 v253, v253, v18
v_mul_f32 v254, v254, v18
v_mul_f32 v255, v255, v18
v_cvt_pk_bf16_f32 v248, v248, v249
v_cvt_pk_bf16_f32 v249, v250, v251
v_cvt_pk_bf16_f32 v250, v252, v253
v_cvt_pk_bf16_f32 v251, v254, v255
buffer_store_dwordx4 v[248:251], v6, s[8:11], s25 offen offset:3072 sc1
v_mfma_f32_16x16x32_bf16 a[236:239], a[240:243], v[124:127], a[236:239]
v_mfma_f32_16x16x32_bf16 a[108:111], a[64:67], v[124:127], a[108:111]
ds_read_b128 a[76:79], v2 offset:27648
s_waitcnt lgkmcnt(2)
v_mfma_f32_16x16x32_bf16 a[124:127], a[68:71], v[124:127], a[124:127]
ds_read_b128 a[80:83], v2 offset:28672
s_waitcnt lgkmcnt(2)
v_mfma_f32_16x16x32_bf16 a[140:143], a[72:75], v[124:127], a[140:143]
ds_read_b128 a[84:87], v2 offset:29696
s_waitcnt lgkmcnt(2)
v_mfma_f32_16x16x32_bf16 a[156:159], a[76:79], v[124:127], a[156:159]
ds_read_b128 a[88:91], v2 offset:30720
s_waitcnt lgkmcnt(2)
v_mfma_f32_16x16x32_bf16 a[172:175], a[80:83], v[124:127], a[172:175]
ds_read_b128 a[92:95], v2 offset:31744
s_waitcnt lgkmcnt(2)
v_mfma_f32_16x16x32_bf16 a[188:191], a[84:87], v[124:127], a[188:191]
s_waitcnt lgkmcnt(1)
v_mfma_f32_16x16x32_bf16 a[204:207], a[88:91], v[124:127], a[204:207]
s_waitcnt lgkmcnt(0)
v_mfma_f32_16x16x32_bf16 a[220:223], a[92:95], v[124:127], a[220:223]
s_add_u32 s25, s61, 1572864
v_accvgpr_read_b32 v18, a236
v_rcp_f32 v18, v18
v_accvgpr_read_b32 v224, a108
v_accvgpr_read_b32 v225, a109
v_accvgpr_read_b32 v226, a110
v_accvgpr_read_b32 v227, a111
v_accvgpr_read_b32 v228, a124
v_accvgpr_read_b32 v229, a125
v_accvgpr_read_b32 v230, a126
v_accvgpr_read_b32 v231, a127
v_mul_f32 v224, v224, v18
v_mul_f32 v225, v225, v18
v_mul_f32 v226, v226, v18
v_mul_f32 v227, v227, v18
v_mul_f32 v228, v228, v18
v_mul_f32 v229, v229, v18
v_mul_f32 v230, v230, v18
v_mul_f32 v231, v231, v18
v_cvt_pk_bf16_f32 v224, v224, v225
v_cvt_pk_bf16_f32 v225, v226, v227
v_cvt_pk_bf16_f32 v226, v228, v229
v_cvt_pk_bf16_f32 v227, v230, v231
buffer_store_dwordx4 v[224:227], v6, s[8:11], s25 offen sc1
v_accvgpr_read_b32 v232, a140
v_accvgpr_read_b32 v233, a141
v_accvgpr_read_b32 v234, a142
v_accvgpr_read_b32 v235, a143
v_accvgpr_read_b32 v236, a156
v_accvgpr_read_b32 v237, a157
v_accvgpr_read_b32 v238, a158
v_accvgpr_read_b32 v239, a159
v_mul_f32 v232, v232, v18
v_mul_f32 v233, v233, v18
v_mul_f32 v234, v234, v18
v_mul_f32 v235, v235, v18
v_mul_f32 v236, v236, v18
v_mul_f32 v237, v237, v18
v_mul_f32 v238, v238, v18
v_mul_f32 v239, v239, v18
v_cvt_pk_bf16_f32 v232, v232, v233
v_cvt_pk_bf16_f32 v233, v234, v235
v_cvt_pk_bf16_f32 v234, v236, v237
v_cvt_pk_bf16_f32 v235, v238, v239
buffer_store_dwordx4 v[232:235], v6, s[8:11], s25 offen offset:1024 sc1
v_accvgpr_read_b32 v240, a172
v_accvgpr_read_b32 v241, a173
v_accvgpr_read_b32 v242, a174
v_accvgpr_read_b32 v243, a175
v_accvgpr_read_b32 v244, a188
v_accvgpr_read_b32 v245, a189
v_accvgpr_read_b32 v246, a190
v_accvgpr_read_b32 v247, a191
v_mul_f32 v240, v240, v18
v_mul_f32 v241, v241, v18
v_mul_f32 v242, v242, v18
v_mul_f32 v243, v243, v18
v_mul_f32 v244, v244, v18
v_mul_f32 v245, v245, v18
v_mul_f32 v246, v246, v18
v_mul_f32 v247, v247, v18
v_cvt_pk_bf16_f32 v240, v240, v241
v_cvt_pk_bf16_f32 v241, v242, v243
v_cvt_pk_bf16_f32 v242, v244, v245
v_cvt_pk_bf16_f32 v243, v246, v247
buffer_store_dwordx4 v[240:243], v6, s[8:11], s25 offen offset:2048 sc1
v_accvgpr_read_b32 v248, a204
v_accvgpr_read_b32 v249, a205
v_accvgpr_read_b32 v250, a206
v_accvgpr_read_b32 v251, a207
v_accvgpr_read_b32 v252, a220
v_accvgpr_read_b32 v253, a221
v_accvgpr_read_b32 v254, a222
v_accvgpr_read_b32 v255, a223
v_mul_f32 v248, v248, v18
v_mul_f32 v249, v249, v18
v_mul_f32 v250, v250, v18
v_mul_f32 v251, v251, v18
v_mul_f32 v252, v252, v18
v_mul_f32 v253, v253, v18
v_mul_f32 v254, v254, v18
v_mul_f32 v255, v255, v18
v_cvt_pk_bf16_f32 v248, v248, v249
v_cvt_pk_bf16_f32 v249, v250, v251
v_cvt_pk_bf16_f32 v250, v252, v253
v_cvt_pk_bf16_f32 v251, v254, v255
buffer_store_dwordx4 v[248:251], v6, s[8:11], s25 offen offset:3072 sc1
s_lshl_b32 s60, s41, 5
s_add_u32 s60, s60, s42
s_lshl_b32 s60, s60, 2
s_add_u32 s60, s60, 111169536
s_cmp_eq_u32 s17, 0
s_cselect_b32 s60, s60, 536870912
s_mov_b32 s41, s63
s_mov_b32 s63, 8
s_waitcnt vmcnt(28)
s_cmp_lt_u32 s41, 8
s_cbranch_scc1 L_at_item
s_waitcnt vmcnt(0)
s_barrier
v_mov_b32 v19, 1
s_mov_b64 exec, 1
buffer_store_dword v19, v6, s[8:11], s60 offen sc1
s_mov_b64 exec, -1
s_branch L_at_done
L_at_up0:
v_max3_f32 v16, v32, v33, v34
v_max3_f32 v16, v16, v35, v36
v_max3_f32 v16, v16, v37, v38
v_max_f32 v16, v16, v39
v_mov_b32 v17, v16
s_nop 1
v_permlane32_swap_b32 v17, v16
v_max_f32 v16, v16, v17
v_mov_b32 v17, v16
s_nop 1
v_permlane16_swap_b32 v17, v16
v_max3_f32 v16, v16, v17, s55
v_exp_f32 v12, -v16
v_sub_f32 v32, v32, v16
v_sub_f32 v33, v33, v16
v_sub_f32 v34, v34, v16
v_sub_f32 v35, v35, v16
v_sub_f32 v36, v36, v16
v_sub_f32 v37, v37, v16
v_sub_f32 v38, v38, v16
v_sub_f32 v39, v39, v16
v_sub_f32 v128, v128, v16
v_sub_f32 v129, v129, v16
v_sub_f32 v130, v130, v16
v_sub_f32 v131, v131, v16
v_max3_f32 v16, v40, v41, v42
v_max3_f32 v16, v16, v43, v44
v_max3_f32 v16, v16, v45, v46
v_max_f32 v16, v16, v47
v_mov_b32 v17, v16
s_nop 1
v_permlane32_swap_b32 v17, v16
v_max_f32 v16, v16, v17
v_mov_b32 v17, v16
s_nop 1
v_permlane16_swap_b32 v17, v16
v_max3_f32 v16, v16, v17, s55
v_exp_f32 v13, -v16
v_sub_f32 v40, v40, v16
v_sub_f32 v41, v41, v16
v_sub_f32 v42, v42, v16
v_sub_f32 v43, v43, v16
v_sub_f32 v44, v44, v16
v_sub_f32 v45, v45, v16
v_sub_f32 v46, v46, v16
v_sub_f32 v47, v47, v16
v_sub_f32 v132, v132, v16
v_sub_f32 v133, v133, v16
v_sub_f32 v134, v134, v16
v_sub_f32 v135, v135, v16
v_max3_f32 v16, v48, v49, v50
v_max3_f32 v16, v16, v51, v52
v_max3_f32 v16, v16, v53, v54
v_max_f32 v16, v16, v55
v_mov_b32 v17, v16
s_nop 1
v_permlane32_swap_b32 v17, v16
v_max_f32 v16, v16, v17
v_mov_b32 v17, v16
s_nop 1
v_permlane16_swap_b32 v17, v16
v_max3_f32 v16, v16, v17, s55
v_exp_f32 v14, -v16
v_sub_f32 v48, v48, v16
v_sub_f32 v49, v49, v16
v_sub_f32 v50, v50, v16
v_sub_f32 v51, v51, v16
v_sub_f32 v52, v52, v16
v_sub_f32 v53, v53, v16
v_sub_f32 v54, v54, v16
v_sub_f32 v55, v55, v16
v_sub_f32 v136, v136, v16
v_sub_f32 v137, v137, v16
v_sub_f32 v138, v138, v16
v_sub_f32 v139, v139, v16
v_max3_f32 v16, v56, v57, v58
v_max3_f32 v16, v16, v59, v60
v_max3_f32 v16, v16, v61, v62
v_max_f32 v16, v16, v63
v_mov_b32 v17, v16
s_nop 1
v_permlane32_swap_b32 v17, v16
v_max_f32 v16, v16, v17
v_mov_b32 v17, v16
s_nop 1
v_permlane16_swap_b32 v17, v16
v_max3_f32 v16, v16, v17, s55
v_exp_f32 v15, -v16
v_sub_f32 v56, v56, v16
v_sub_f32 v57, v57, v16
v_sub_f32 v58, v58, v16
v_sub_f32 v59, v59, v16
v_sub_f32 v60, v60, v16
v_sub_f32 v61, v61, v16
v_sub_f32 v62, v62, v16
v_sub_f32 v63, v63, v16
v_sub_f32 v140, v140, v16
v_sub_f32 v141, v141, v16
v_sub_f32 v142, v142, v16
v_sub_f32 v143, v143, v16
s_cmp_eq_u32 s55, 0
s_cselect_b32 s48, 1, 0
s_mov_b32 s55, 0
s_mov_b32 s54, s51
s_branch L_at_upr0
L_at_rs0:
s_mov_b32 s52, 0
s_branch L_at_rescale
L_at_up1:
v_max3_f32 v16, v64, v65, v66
v_max3_f32 v16, v16, v67, v68
v_max3_f32 v16, v16, v69, v70
v_max_f32 v16, v16, v71
v_mov_b32 v17, v16
s_nop 1
v_permlane32_swap_b32 v17, v16
v_max_f32 v16, v16, v17
v_mov_b32 v17, v16
s_nop 1
v_permlane16_swap_b32 v17, v16
v_max3_f32 v16, v16, v17, s55
v_exp_f32 v12, -v16
v_sub_f32 v64, v64, v16
v_sub_f32 v65, v65, v16
v_sub_f32 v66, v66, v16
v_sub_f32 v67, v67, v16
v_sub_f32 v68, v68, v16
v_sub_f32 v69, v69, v16
v_sub_f32 v70, v70, v16
v_sub_f32 v71, v71, v16
v_sub_f32 v128, v128, v16
v_sub_f32 v129, v129, v16
v_sub_f32 v130, v130, v16
v_sub_f32 v131, v131, v16
v_max3_f32 v16, v72, v73, v74
v_max3_f32 v16, v16, v75, v76
v_max3_f32 v16, v16, v77, v78
v_max_f32 v16, v16, v79
v_mov_b32 v17, v16
s_nop 1
v_permlane32_swap_b32 v17, v16
v_max_f32 v16, v16, v17
v_mov_b32 v17, v16
s_nop 1
v_permlane16_swap_b32 v17, v16
v_max3_f32 v16, v16, v17, s55
v_exp_f32 v13, -v16
v_sub_f32 v72, v72, v16
v_sub_f32 v73, v73, v16
v_sub_f32 v74, v74, v16
v_sub_f32 v75, v75, v16
v_sub_f32 v76, v76, v16
v_sub_f32 v77, v77, v16
v_sub_f32 v78, v78, v16
v_sub_f32 v79, v79, v16
v_sub_f32 v132, v132, v16
v_sub_f32 v133, v133, v16
v_sub_f32 v134, v134, v16
v_sub_f32 v135, v135, v16
v_max3_f32 v16, v80, v81, v82
v_max3_f32 v16, v16, v83, v84
v_max3_f32 v16, v16, v85, v86
v_max_f32 v16, v16, v87
v_mov_b32 v17, v16
s_nop 1
v_permlane32_swap_b32 v17, v16
v_max_f32 v16, v16, v17
v_mov_b32 v17, v16
s_nop 1
v_permlane16_swap_b32 v17, v16
v_max3_f32 v16, v16, v17, s55
v_exp_f32 v14, -v16
v_sub_f32 v80, v80, v16
v_sub_f32 v81, v81, v16
v_sub_f32 v82, v82, v16
v_sub_f32 v83, v83, v16
v_sub_f32 v84, v84, v16
v_sub_f32 v85, v85, v16
v_sub_f32 v86, v86, v16
v_sub_f32 v87, v87, v16
v_sub_f32 v136, v136, v16
v_sub_f32 v137, v137, v16
v_sub_f32 v138, v138, v16
v_sub_f32 v139, v139, v16
v_max3_f32 v16, v88, v89, v90
v_max3_f32 v16, v16, v91, v92
v_max3_f32 v16, v16, v93, v94
v_max_f32 v16, v16, v95
v_mov_b32 v17, v16
s_nop 1
v_permlane32_swap_b32 v17, v16
v_max_f32 v16, v16, v17
v_mov_b32 v17, v16
s_nop 1
v_permlane16_swap_b32 v17, v16
v_max3_f32 v16, v16, v17, s55
v_exp_f32 v15, -v16
v_sub_f32 v88, v88, v16
v_sub_f32 v89, v89, v16
v_sub_f32 v90, v90, v16
v_sub_f32 v91, v91, v16
v_sub_f32 v92, v92, v16
v_sub_f32 v93, v93, v16
v_sub_f32 v94, v94, v16
v_sub_f32 v95, v95, v16
v_sub_f32 v140, v140, v16
v_sub_f32 v141, v141, v16
v_sub_f32 v142, v142, v16
v_sub_f32 v143, v143, v16
s_cmp_eq_u32 s55, 0
s_cselect_b32 s48, 1, 0
s_mov_b32 s55, 0
s_mov_b32 s54, s51
s_branch L_at_upr1
L_at_rs1:
s_mov_b32 s52, 1
s_branch L_at_rescale
L_at_up2:
v_max3_f32 v16, v32, v33, v34
v_max3_f32 v16, v16, v35, v36
v_max3_f32 v16, v16, v37, v38
v_max_f32 v16, v16, v39
v_mov_b32 v17, v16
s_nop 1
v_permlane32_swap_b32 v17, v16
v_max_f32 v16, v16, v17
v_mov_b32 v17, v16
s_nop 1
v_permlane16_swap_b32 v17, v16
v_max3_f32 v16, v16, v17, s55
v_exp_f32 v12, -v16
v_sub_f32 v32, v32, v16
v_sub_f32 v33, v33, v16
v_sub_f32 v34, v34, v16
v_sub_f32 v35, v35, v16
v_sub_f32 v36, v36, v16
v_sub_f32 v37, v37, v16
v_sub_f32 v38, v38, v16
v_sub_f32 v39, v39, v16
v_sub_f32 v128, v128, v16
v_sub_f32 v129, v129, v16
v_sub_f32 v130, v130, v16
v_sub_f32 v131, v131, v16
v_max3_f32 v16, v40, v41, v42
v_max3_f32 v16, v16, v43, v44
v_max3_f32 v16, v16, v45, v46
v_max_f32 v16, v16, v47
v_mov_b32 v17, v16
s_nop 1
v_permlane32_swap_b32 v17, v16
v_max_f32 v16, v16, v17
v_mov_b32 v17, v16
s_nop 1
v_permlane16_swap_b32 v17, v16
v_max3_f32 v16, v16, v17, s55
v_exp_f32 v13, -v16
v_sub_f32 v40, v40, v16
v_sub_f32 v41, v41, v16
v_sub_f32 v42, v42, v16
v_sub_f32 v43, v43, v16
v_sub_f32 v44, v44, v16
v_sub_f32 v45, v45, v16
v_sub_f32 v46, v46, v16
v_sub_f32 v47, v47, v16
v_sub_f32 v132, v132, v16
v_sub_f32 v133, v133, v16
v_sub_f32 v134, v134, v16
v_sub_f32 v135, v135, v16
v_max3_f32 v16, v48, v49, v50
v_max3_f32 v16, v16, v51, v52
v_max3_f32 v16, v16, v53, v54
v_max_f32 v16, v16, v55
v_mov_b32 v17, v16
s_nop 1
v_permlane32_swap_b32 v17, v16
v_max_f32 v16, v16, v17
v_mov_b32 v17, v16
s_nop 1
v_permlane16_swap_b32 v17, v16
v_max3_f32 v16, v16, v17, s55
v_exp_f32 v14, -v16
v_sub_f32 v48, v48, v16
v_sub_f32 v49, v49, v16
v_sub_f32 v50, v50, v16
v_sub_f32 v51, v51, v16
v_sub_f32 v52, v52, v16
v_sub_f32 v53, v53, v16
v_sub_f32 v54, v54, v16
v_sub_f32 v55, v55, v16
v_sub_f32 v136, v136, v16
v_sub_f32 v137, v137, v16
v_sub_f32 v138, v138, v16
v_sub_f32 v139, v139, v16
v_max3_f32 v16, v56, v57, v58
v_max3_f32 v16, v16, v59, v60
v_max3_f32 v16, v16, v61, v62
v_max_f32 v16, v16, v63
v_mov_b32 v17, v16
s_nop 1
v_permlane32_swap_b32 v17, v16
v_max_f32 v16, v16, v17
v_mov_b32 v17, v16
s_nop 1
v_permlane16_swap_b32 v17, v16
v_max3_f32 v16, v16, v17, s55
v_exp_f32 v15, -v16
v_sub_f32 v56, v56, v16
v_sub_f32 v57, v57, v16
v_sub_f32 v58, v58, v16
v_sub_f32 v59, v59, v16
v_sub_f32 v60, v60, v16
v_sub_f32 v61, v61, v16
v_sub_f32 v62, v62, v16
v_sub_f32 v63, v63, v16
v_sub_f32 v140, v140, v16
v_sub_f32 v141, v141, v16
v_sub_f32 v142, v142, v16
v_sub_f32 v143, v143, v16
s_cmp_eq_u32 s55, 0
s_cselect_b32 s48, 1, 0
s_mov_b32 s55, 0
s_mov_b32 s54, s51
s_branch L_at_upr2
L_at_rs2:
s_mov_b32 s52, 2
s_branch L_at_rescale
L_at_up3:
v_max3_f32 v16, v64, v65, v66
v_max3_f32 v16, v16, v67, v68
v_max3_f32 v16, v16, v69, v70
v_max_f32 v16, v16, v71
v_mov_b32 v17, v16
s_nop 1
v_permlane32_swap_b32 v17, v16
v_max_f32 v16, v16, v17
v_mov_b32 v17, v16
s_nop 1
v_permlane16_swap_b32 v17, v16
v_max3_f32 v16, v16, v17, s55
v_exp_f32 v12, -v16
v_sub_f32 v64, v64, v16
v_sub_f32 v65, v65, v16
v_sub_f32 v66, v66, v16
v_sub_f32 v67, v67, v16
v_sub_f32 v68, v68, v16
v_sub_f32 v69, v69, v16
v_sub_f32 v70, v70, v16
v_sub_f32 v71, v71, v16
v_sub_f32 v128, v128, v16
v_sub_f32 v129, v129, v16
v_sub_f32 v130, v130, v16
v_sub_f32 v131, v131, v16
v_max3_f32 v16, v72, v73, v74
v_max3_f32 v16, v16, v75, v76
v_max3_f32 v16, v16, v77, v78
v_max_f32 v16, v16, v79
v_mov_b32 v17, v16
s_nop 1
v_permlane32_swap_b32 v17, v16
v_max_f32 v16, v16, v17
v_mov_b32 v17, v16
s_nop 1
v_permlane16_swap_b32 v17, v16
v_max3_f32 v16, v16, v17, s55
v_exp_f32 v13, -v16
v_sub_f32 v72, v72, v16
v_sub_f32 v73, v73, v16
v_sub_f32 v74, v74, v16
v_sub_f32 v75, v75, v16
v_sub_f32 v76, v76, v16
v_sub_f32 v77, v77, v16
v_sub_f32 v78, v78, v16
v_sub_f32 v79, v79, v16
v_sub_f32 v132, v132, v16
v_sub_f32 v133, v133, v16
v_sub_f32 v134, v134, v16
v_sub_f32 v135, v135, v16
v_max3_f32 v16, v80, v81, v82
v_max3_f32 v16, v16, v83, v84
v_max3_f32 v16, v16, v85, v86
v_max_f32 v16, v16, v87
v_mov_b32 v17, v16
s_nop 1
v_permlane32_swap_b32 v17, v16
v_max_f32 v16, v16, v17
v_mov_b32 v17, v16
s_nop 1
v_permlane16_swap_b32 v17, v16
v_max3_f32 v16, v16, v17, s55
v_exp_f32 v14, -v16
v_sub_f32 v80, v80, v16
v_sub_f32 v81, v81, v16
v_sub_f32 v82, v82, v16
v_sub_f32 v83, v83, v16
v_sub_f32 v84, v84, v16
v_sub_f32 v85, v85, v16
v_sub_f32 v86, v86, v16
v_sub_f32 v87, v87, v16
v_sub_f32 v136, v136, v16
v_sub_f32 v137, v137, v16
v_sub_f32 v138, v138, v16
v_sub_f32 v139, v139, v16
v_max3_f32 v16, v88, v89, v90
v_max3_f32 v16, v16, v91, v92
v_max3_f32 v16, v16, v93, v94
v_max_f32 v16, v16, v95
v_mov_b32 v17, v16
s_nop 1
v_permlane32_swap_b32 v17, v16
v_max_f32 v16, v16, v17
v_mov_b32 v17, v16
s_nop 1
v_permlane16_swap_b32 v17, v16
v_max3_f32 v16, v16, v17, s55
v_exp_f32 v15, -v16
v_sub_f32 v88, v88, v16
v_sub_f32 v89, v89, v16
v_sub_f32 v90, v90, v16
v_sub_f32 v91, v91, v16
v_sub_f32 v92, v92, v16
v_sub_f32 v93, v93, v16
v_sub_f32 v94, v94, v16
v_sub_f32 v95, v95, v16
v_sub_f32 v140, v140, v16
v_sub_f32 v141, v141, v16
v_sub_f32 v142, v142, v16
v_sub_f32 v143, v143, v16
s_cmp_eq_u32 s55, 0
s_cselect_b32 s48, 1, 0
s_mov_b32 s55, 0
s_mov_b32 s54, s51
s_branch L_at_upr3
L_at_rs3:
s_mov_b32 s52, 3
s_branch L_at_rescale
L_at_up4:
v_mov_b32 v12, 1.0
v_max3_f32 v16, v40, v41, v42
v_max3_f32 v16, v16, v43, v44
v_max3_f32 v16, v16, v45, v46
v_max_f32 v16, v16, v47
v_mov_b32 v17, v16
s_nop 1
v_permlane32_swap_b32 v17, v16
v_max_f32 v16, v16, v17
v_mov_b32 v17, v16
s_nop 1
v_permlane16_swap_b32 v17, v16
v_max3_f32 v16, v16, v17, s55
v_exp_f32 v13, -v16
v_sub_f32 v40, v40, v16
v_sub_f32 v41, v41, v16
v_sub_f32 v42, v42, v16
v_sub_f32 v43, v43, v16
v_sub_f32 v44, v44, v16
v_sub_f32 v45, v45, v16
v_sub_f32 v46, v46, v16
v_sub_f32 v47, v47, v16
v_sub_f32 v132, v132, v16
v_sub_f32 v133, v133, v16
v_sub_f32 v134, v134, v16
v_sub_f32 v135, v135, v16
v_max3_f32 v16, v48, v49, v50
v_max3_f32 v16, v16, v51, v52
v_max3_f32 v16, v16, v53, v54
v_max_f32 v16, v16, v55
v_mov_b32 v17, v16
s_nop 1
v_permlane32_swap_b32 v17, v16
v_max_f32 v16, v16, v17
v_mov_b32 v17, v16
s_nop 1
v_permlane16_swap_b32 v17, v16
v_max3_f32 v16, v16, v17, s55
v_exp_f32 v14, -v16
v_sub_f32 v48, v48, v16
v_sub_f32 v49, v49, v16
v_sub_f32 v50, v50, v16
v_sub_f32 v51, v51, v16
v_sub_f32 v52, v52, v16
v_sub_f32 v53, v53, v16
v_sub_f32 v54, v54, v16
v_sub_f32 v55, v55, v16
v_sub_f32 v136, v136, v16
v_sub_f32 v137, v137, v16
v_sub_f32 v138, v138, v16
v_sub_f32 v139, v139, v16
v_max3_f32 v16, v56, v57, v58
v_max3_f32 v16, v16, v59, v60
v_max3_f32 v16, v16, v61, v62
v_max_f32 v16, v16, v63
v_mov_b32 v17, v16
s_nop 1
v_permlane32_swap_b32 v17, v16
v_max_f32 v16, v16, v17
v_mov_b32 v17, v16
s_nop 1
v_permlane16_swap_b32 v17, v16
v_max3_f32 v16, v16, v17, s55
v_exp_f32 v15, -v16
v_sub_f32 v56, v56, v16
v_sub_f32 v57, v57, v16
v_sub_f32 v58, v58, v16
v_sub_f32 v59, v59, v16
v_sub_f32 v60, v60, v16
v_sub_f32 v61, v61, v16
v_sub_f32 v62, v62, v16
v_sub_f32 v63, v63, v16
v_sub_f32 v140, v140, v16
v_sub_f32 v141, v141, v16
v_sub_f32 v142, v142, v16
v_sub_f32 v143, v143, v16
s_cmp_eq_u32 s55, 0
s_cselect_b32 s48, 1, 0
s_mov_b32 s55, 0
s_mov_b32 s54, s51
s_branch L_at_upr4
L_at_rs4:
s_mov_b32 s52, 4
s_branch L_at_rescale
L_at_up5:
v_mov_b32 v12, 1.0
v_max3_f32 v16, v72, v73, v74
v_max3_f32 v16, v16, v75, v76
v_max3_f32 v16, v16, v77, v78
v_max_f32 v16, v16, v79
v_mov_b32 v17, v16
s_nop 1
v_permlane32_swap_b32 v17, v16
v_max_f32 v16, v16, v17
v_mov_b32 v17, v16
s_nop 1
v_permlane16_swap_b32 v17, v16
v_max3_f32 v16, v16, v17, s55
v_exp_f32 v13, -v16
v_sub_f32 v72, v72, v16
v_sub_f32 v73, v73, v16
v_sub_f32 v74, v74, v16
v_sub_f32 v75, v75, v16
v_sub_f32 v76, v76, v16
v_sub_f32 v77, v77, v16
v_sub_f32 v78, v78, v16
v_sub_f32 v79, v79, v16
v_sub_f32 v132, v132, v16
v_sub_f32 v133, v133, v16
v_sub_f32 v134, v134, v16
v_sub_f32 v135, v135, v16
v_max3_f32 v16, v80, v81, v82
v_max3_f32 v16, v16, v83, v84
v_max3_f32 v16, v16, v85, v86
v_max_f32 v16, v16, v87
v_mov_b32 v17, v16
s_nop 1
v_permlane32_swap_b32 v17, v16
v_max_f32 v16, v16, v17
v_mov_b32 v17, v16
s_nop 1
v_permlane16_swap_b32 v17, v16
v_max3_f32 v16, v16, v17, s55
v_exp_f32 v14, -v16
v_sub_f32 v80, v80, v16
v_sub_f32 v81, v81, v16
v_sub_f32 v82, v82, v16
v_sub_f32 v83, v83, v16
v_sub_f32 v84, v84, v16
v_sub_f32 v85, v85, v16
v_sub_f32 v86, v86, v16
v_sub_f32 v87, v87, v16
v_sub_f32 v136, v136, v16
v_sub_f32 v137, v137, v16
v_sub_f32 v138, v138, v16
v_sub_f32 v139, v139, v16
v_max3_f32 v16, v88, v89, v90
v_max3_f32 v16, v16, v91, v92
v_max3_f32 v16, v16, v93, v94
v_max_f32 v16, v16, v95
v_mov_b32 v17, v16
s_nop 1
v_permlane32_swap_b32 v17, v16
v_max_f32 v16, v16, v17
v_mov_b32 v17, v16
s_nop 1
v_permlane16_swap_b32 v17, v16
v_max3_f32 v16, v16, v17, s55
v_exp_f32 v15, -v16
v_sub_f32 v88, v88, v16
v_sub_f32 v89, v89, v16
v_sub_f32 v90, v90, v16
v_sub_f32 v91, v91, v16
v_sub_f32 v92, v92, v16
v_sub_f32 v93, v93, v16
v_sub_f32 v94, v94, v16
v_sub_f32 v95, v95, v16
v_sub_f32 v140, v140, v16
v_sub_f32 v141, v141, v16
v_sub_f32 v142, v142, v16
v_sub_f32 v143, v143, v16
s_cmp_eq_u32 s55, 0
s_cselect_b32 s48, 1, 0
s_mov_b32 s55, 0
s_mov_b32 s54, s51
s_branch L_at_upr5
L_at_rs5:
s_mov_b32 s52, 5
s_branch L_at_rescale
L_at_up6:
v_mov_b32 v12, 1.0
v_mov_b32 v13, 1.0
v_max3_f32 v16, v48, v49, v50
v_max3_f32 v16, v16, v51, v52
v_max3_f32 v16, v16, v53, v54
v_max_f32 v16, v16, v55
v_mov_b32 v17, v16
s_nop 1
v_permlane32_swap_b32 v17, v16
v_max_f32 v16, v16, v17
v_mov_b32 v17, v16
s_nop 1
v_permlane16_swap_b32 v17, v16
v_max3_f32 v16, v16, v17, s55
v_exp_f32 v14, -v16
v_sub_f32 v48, v48, v16
v_sub_f32 v49, v49, v16
v_sub_f32 v50, v50, v16
v_sub_f32 v51, v51, v16
v_sub_f32 v52, v52, v16
v_sub_f32 v53, v53, v16
v_sub_f32 v54, v54, v16
v_sub_f32 v55, v55, v16
v_sub_f32 v136, v136, v16
v_sub_f32 v137, v137, v16
v_sub_f32 v138, v138, v16
v_sub_f32 v139, v139, v16
v_max3_f32 v16, v56, v57, v58
v_max3_f32 v16, v16, v59, v60
v_max3_f32 v16, v16, v61, v62
v_max_f32 v16, v16, v63
v_mov_b32 v17, v16
s_nop 1
v_permlane32_swap_b32 v17, v16
v_max_f32 v16, v16, v17
v_mov_b32 v17, v16
s_nop 1
v_permlane16_swap_b32 v17, v16
v_max3_f32 v16, v16, v17, s55
v_exp_f32 v15, -v16
v_sub_f32 v56, v56, v16
v_sub_f32 v57, v57, v16
v_sub_f32 v58, v58, v16
v_sub_f32 v59, v59, v16
v_sub_f32 v60, v60, v16
v_sub_f32 v61, v61, v16
v_sub_f32 v62, v62, v16
v_sub_f32 v63, v63, v16
v_sub_f32 v140, v140, v16
v_sub_f32 v141, v141, v16
v_sub_f32 v142, v142, v16
v_sub_f32 v143, v143, v16
s_cmp_eq_u32 s55, 0
s_cselect_b32 s48, 1, 0
s_mov_b32 s55, 0
s_mov_b32 s54, s51
s_branch L_at_upr6
L_at_rs6:
s_mov_b32 s52, 6
s_branch L_at_rescale
L_at_up7:
v_mov_b32 v12, 1.0
v_mov_b32 v13, 1.0
v_max3_f32 v16, v80, v81, v82
v_max3_f32 v16, v16, v83, v84
v_max3_f32 v16, v16, v85, v86
v_max_f32 v16, v16, v87
v_mov_b32 v17, v16
s_nop 1
v_permlane32_swap_b32 v17, v16
v_max_f32 v16, v16, v17
v_mov_b32 v17, v16
s_nop 1
v_permlane16_swap_b32 v17, v16
v_max3_f32 v16, v16, v17, s55
v_exp_f32 v14, -v16
v_sub_f32 v80, v80, v16
v_sub_f32 v81, v81, v16
v_sub_f32 v82, v82, v16
v_sub_f32 v83, v83, v16
v_sub_f32 v84, v84, v16
v_sub_f32 v85, v85, v16
v_sub_f32 v86, v86, v16
v_sub_f32 v87, v87, v16
v_sub_f32 v136, v136, v16
v_sub_f32 v137, v137, v16
v_sub_f32 v138, v138, v16
v_sub_f32 v139, v139, v16
v_max3_f32 v16, v88, v89, v90
v_max3_f32 v16, v16, v91, v92
v_max3_f32 v16, v16, v93, v94
v_max_f32 v16, v16, v95
v_mov_b32 v17, v16
s_nop 1
v_permlane32_swap_b32 v17, v16
v_max_f32 v16, v16, v17
v_mov_b32 v17, v16
s_nop 1
v_permlane16_swap_b32 v17, v16
v_max3_f32 v16, v16, v17, s55
v_exp_f32 v15, -v16
v_sub_f32 v88, v88, v16
v_sub_f32 v89, v89, v16
v_sub_f32 v90, v90, v16
v_sub_f32 v91, v91, v16
v_sub_f32 v92, v92, v16
v_sub_f32 v93, v93, v16
v_sub_f32 v94, v94, v16
v_sub_f32 v95, v95, v16
v_sub_f32 v140, v140, v16
v_sub_f32 v141, v141, v16
v_sub_f32 v142, v142, v16
v_sub_f32 v143, v143, v16
s_cmp_eq_u32 s55, 0
s_cselect_b32 s48, 1, 0
s_mov_b32 s55, 0
s_mov_b32 s54, s51
s_branch L_at_upr7
L_at_rs7:
s_mov_b32 s52, 7
s_branch L_at_rescale
L_at_up8:
v_mov_b32 v12, 1.0
v_mov_b32 v13, 1.0
v_mov_b32 v14, 1.0
v_max3_f32 v16, v56, v57, v58
v_max3_f32 v16, v16, v59, v60
v_max3_f32 v16, v16, v61, v62
v_max_f32 v16, v16, v63
v_mov_b32 v17, v16
s_nop 1
v_permlane32_swap_b32 v17, v16
v_max_f32 v16, v16, v17
v_mov_b32 v17, v16
s_nop 1
v_permlane16_swap_b32 v17, v16
v_max3_f32 v16, v16, v17, s55
v_exp_f32 v15, -v16
v_sub_f32 v56, v56, v16
v_sub_f32 v57, v57, v16
v_sub_f32 v58, v58, v16
v_sub_f32 v59, v59, v16
v_sub_f32 v60, v60, v16
v_sub_f32 v61, v61, v16
v_sub_f32 v62, v62, v16
v_sub_f32 v63, v63, v16
v_sub_f32 v140, v140, v16
v_sub_f32 v141, v141, v16
v_sub_f32 v142, v142, v16
v_sub_f32 v143, v143, v16
s_cmp_eq_u32 s55, 0
s_cselect_b32 s48, 1, 0
s_mov_b32 s55, 0
s_mov_b32 s54, s51
s_branch L_at_upr8
L_at_rs8:
s_mov_b32 s52, 8
s_branch L_at_rescale
L_at_up9:
v_mov_b32 v12, 1.0
v_mov_b32 v13, 1.0
v_mov_b32 v14, 1.0
v_max3_f32 v16, v88, v89, v90
v_max3_f32 v16, v16, v91, v92
v_max3_f32 v16, v16, v93, v94
v_max_f32 v16, v16, v95
v_mov_b32 v17, v16
s_nop 1
v_permlane32_swap_b32 v17, v16
v_max_f32 v16, v16, v17
v_mov_b32 v17, v16
s_nop 1
v_permlane16_swap_b32 v17, v16
v_max3_f32 v16, v16, v17, s55
v_exp_f32 v15, -v16
v_sub_f32 v88, v88, v16
v_sub_f32 v89, v89, v16
v_sub_f32 v90, v90, v16
v_sub_f32 v91, v91, v16
v_sub_f32 v92, v92, v16
v_sub_f32 v93, v93, v16
v_sub_f32 v94, v94, v16
v_sub_f32 v95, v95, v16
v_sub_f32 v140, v140, v16
v_sub_f32 v141, v141, v16
v_sub_f32 v142, v142, v16
v_sub_f32 v143, v143, v16
s_cmp_eq_u32 s55, 0
s_cselect_b32 s48, 1, 0
s_mov_b32 s55, 0
s_mov_b32 s54, s51
s_branch L_at_upr9
L_at_rs9:
s_mov_b32 s52, 9
s_branch L_at_rescale
L_at_rescale:
v_accvgpr_read_b32 v24, a96
v_accvgpr_read_b32 v25, a97
v_accvgpr_read_b32 v26, a98
v_accvgpr_read_b32 v27, a99
v_accvgpr_read_b32 v28, a100
v_accvgpr_read_b32 v29, a101
v_accvgpr_read_b32 v30, a102
v_accvgpr_read_b32 v31, a103
v_mul_f32 v24, v24, v12
v_mul_f32 v25, v25, v12
v_mul_f32 v26, v26, v12
v_mul_f32 v27, v27, v12
v_mul_f32 v28, v28, v13
v_mul_f32 v29, v29, v13
v_mul_f32 v30, v30, v13
v_mul_f32 v31, v31, v13
v_accvgpr_write_b32 a96, v24
v_accvgpr_write_b32 a97, v25
v_accvgpr_write_b32 a98, v26
v_accvgpr_write_b32 a99, v27
v_accvgpr_write_b32 a100, v28
v_accvgpr_write_b32 a101, v29
v_accvgpr_write_b32 a102, v30
v_accvgpr_write_b32 a103, v31
v_accvgpr_read_b32 v24, a104
v_accvgpr_read_b32 v25, a105
v_accvgpr_read_b32 v26, a106
v_accvgpr_read_b32 v27, a107
v_accvgpr_read_b32 v28, a108
v_accvgpr_read_b32 v29, a109
v_accvgpr_read_b32 v30, a110
v_accvgpr_read_b32 v31, a111
v_mul_f32 v24, v24, v14
v_mul_f32 v25, v25, v14
v_mul_f32 v26, v26, v14
v_mul_f32 v27, v27, v14
v_mul_f32 v28, v28, v15
v_mul_f32 v29, v29, v15
v_mul_f32 v30, v30, v15
v_mul_f32 v31, v31, v15
v_accvgpr_write_b32 a104, v24
v_accvgpr_write_b32 a105, v25
v_accvgpr_write_b32 a106, v26
v_accvgpr_write_b32 a107, v27
v_accvgpr_write_b32 a108, v28
v_accvgpr_write_b32 a109, v29
v_accvgpr_write_b32 a110, v30
v_accvgpr_write_b32 a111, v31
v_accvgpr_read_b32 v24, a112
v_accvgpr_read_b32 v25, a113
v_accvgpr_read_b32 v26, a114
v_accvgpr_read_b32 v27, a115
v_accvgpr_read_b32 v28, a116
v_accvgpr_read_b32 v29, a117
v_accvgpr_read_b32 v30, a118
v_accvgpr_read_b32 v31, a119
v_mul_f32 v24, v24, v12
v_mul_f32 v25, v25, v12
v_mul_f32 v26, v26, v12
v_mul_f32 v27, v27, v12
v_mul_f32 v28, v28, v13
v_mul_f32 v29, v29, v13
v_mul_f32 v30, v30, v13
v_mul_f32 v31, v31, v13
v_accvgpr_write_b32 a112, v24
v_accvgpr_write_b32 a113, v25
v_accvgpr_write_b32 a114, v26
v_accvgpr_write_b32 a115, v27
v_accvgpr_write_b32 a116, v28
v_accvgpr_write_b32 a117, v29
v_accvgpr_write_b32 a118, v30
v_accvgpr_write_b32 a119, v31
v_accvgpr_read_b32 v24, a120
v_accvgpr_read_b32 v25, a121
v_accvgpr_read_b32 v26, a122
v_accvgpr_read_b32 v27, a123
v_accvgpr_read_b32 v28, a124
v_accvgpr_read_b32 v29, a125
v_accvgpr_read_b32 v30, a126
v_accvgpr_read_b32 v31, a127
v_mul_f32 v24, v24, v14
v_mul_f32 v25, v25, v14
v_mul_f32 v26, v26, v14
v_mul_f32 v27, v27, v14
v_mul_f32 v28, v28, v15
v_mul_f32 v29, v29, v15
v_mul_f32 v30, v30, v15
v_mul_f32 v31, v31, v15
v_accvgpr_write_b32 a120, v24
v_accvgpr_write_b32 a121, v25
v_accvgpr_write_b32 a122, v26
v_accvgpr_write_b32 a123, v27
v_accvgpr_write_b32 a124, v28
v_accvgpr_write_b32 a125, v29
v_accvgpr_write_b32 a126, v30
v_accvgpr_write_b32 a127, v31
v_accvgpr_read_b32 v24, a128
v_accvgpr_read_b32 v25, a129
v_accvgpr_read_b32 v26, a130
v_accvgpr_read_b32 v27, a131
v_accvgpr_read_b32 v28, a132
v_accvgpr_read_b32 v29, a133
v_accvgpr_read_b32 v30, a134
v_accvgpr_read_b32 v31, a135
v_mul_f32 v24, v24, v12
v_mul_f32 v25, v25, v12
v_mul_f32 v26, v26, v12
v_mul_f32 v27, v27, v12
v_mul_f32 v28, v28, v13
v_mul_f32 v29, v29, v13
v_mul_f32 v30, v30, v13
v_mul_f32 v31, v31, v13
v_accvgpr_write_b32 a128, v24
v_accvgpr_write_b32 a129, v25
v_accvgpr_write_b32 a130, v26
v_accvgpr_write_b32 a131, v27
v_accvgpr_write_b32 a132, v28
v_accvgpr_write_b32 a133, v29
v_accvgpr_write_b32 a134, v30
v_accvgpr_write_b32 a135, v31
v_accvgpr_read_b32 v24, a136
v_accvgpr_read_b32 v25, a137
v_accvgpr_read_b32 v26, a138
v_accvgpr_read_b32 v27, a139
v_accvgpr_read_b32 v28, a140
v_accvgpr_read_b32 v29, a141
v_accvgpr_read_b32 v30, a142
v_accvgpr_read_b32 v31, a143
v_mul_f32 v24, v24, v14
v_mul_f32 v25, v25, v14
v_mul_f32 v26, v26, v14
v_mul_f32 v27, v27, v14
v_mul_f32 v28, v28, v15
v_mul_f32 v29, v29, v15
v_mul_f32 v30, v30, v15
v_mul_f32 v31, v31, v15
v_accvgpr_write_b32 a136, v24
v_accvgpr_write_b32 a137, v25
v_accvgpr_write_b32 a138, v26
v_accvgpr_write_b32 a139, v27
v_accvgpr_write_b32 a140, v28
v_accvgpr_write_b32 a141, v29
v_accvgpr_write_b32 a142, v30
v_accvgpr_write_b32 a143, v31
v_accvgpr_read_b32 v24, a144
v_accvgpr_read_b32 v25, a145
v_accvgpr_read_b32 v26, a146
v_accvgpr_read_b32 v27, a147
v_accvgpr_read_b32 v28, a148
v_accvgpr_read_b32 v29, a149
v_accvgpr_read_b32 v30, a150
v_accvgpr_read_b32 v31, a151
v_mul_f32 v24, v24, v12
v_mul_f32 v25, v25, v12
v_mul_f32 v26, v26, v12
v_mul_f32 v27, v27, v12
v_mul_f32 v28, v28, v13
v_mul_f32 v29, v29, v13
v_mul_f32 v30, v30, v13
v_mul_f32 v31, v31, v13
v_accvgpr_write_b32 a144, v24
v_accvgpr_write_b32 a145, v25
v_accvgpr_write_b32 a146, v26
v_accvgpr_write_b32 a147, v27
v_accvgpr_write_b32 a148, v28
v_accvgpr_write_b32 a149, v29
v_accvgpr_write_b32 a150, v30
v_accvgpr_write_b32 a151, v31
v_accvgpr_read_b32 v24, a152
v_accvgpr_read_b32 v25, a153
v_accvgpr_read_b32 v26, a154
v_accvgpr_read_b32 v27, a155
v_accvgpr_read_b32 v28, a156
v_accvgpr_read_b32 v29, a157
v_accvgpr_read_b32 v30, a158
v_accvgpr_read_b32 v31, a159
v_mul_f32 v24, v24, v14
v_mul_f32 v25, v25, v14
v_mul_f32 v26, v26, v14
v_mul_f32 v27, v27, v14
v_mul_f32 v28, v28, v15
v_mul_f32 v29, v29, v15
v_mul_f32 v30, v30, v15
v_mul_f32 v31, v31, v15
v_accvgpr_write_b32 a152, v24
v_accvgpr_write_b32 a153, v25
v_accvgpr_write_b32 a154, v26
v_accvgpr_write_b32 a155, v27
v_accvgpr_write_b32 a156, v28
v_accvgpr_write_b32 a157, v29
v_accvgpr_write_b32 a158, v30
v_accvgpr_write_b32 a159, v31
v_accvgpr_read_b32 v24, a160
v_accvgpr_read_b32 v25, a161
v_accvgpr_read_b32 v26, a162
v_accvgpr_read_b32 v27, a163
v_accvgpr_read_b32 v28, a164
v_accvgpr_read_b32 v29, a165
v_accvgpr_read_b32 v30, a166
v_accvgpr_read_b32 v31, a167
v_mul_f32 v24, v24, v12
v_mul_f32 v25, v25, v12
v_mul_f32 v26, v26, v12
v_mul_f32 v27, v27, v12
v_mul_f32 v28, v28, v13
v_mul_f32 v29, v29, v13
v_mul_f32 v30, v30, v13
v_mul_f32 v31, v31, v13
v_accvgpr_write_b32 a160, v24
v_accvgpr_write_b32 a161, v25
v_accvgpr_write_b32 a162, v26
v_accvgpr_write_b32 a163, v27
v_accvgpr_write_b32 a164, v28
v_accvgpr_write_b32 a165, v29
v_accvgpr_write_b32 a166, v30
v_accvgpr_write_b32 a167, v31
v_accvgpr_read_b32 v24, a168
v_accvgpr_read_b32 v25, a169
v_accvgpr_read_b32 v26, a170
v_accvgpr_read_b32 v27, a171
v_accvgpr_read_b32 v28, a172
v_accvgpr_read_b32 v29, a173
v_accvgpr_read_b32 v30, a174
v_accvgpr_read_b32 v31, a175
v_mul_f32 v24, v24, v14
v_mul_f32 v25, v25, v14
v_mul_f32 v26, v26, v14
v_mul_f32 v27, v27, v14
v_mul_f32 v28, v28, v15
v_mul_f32 v29, v29, v15
v_mul_f32 v30, v30, v15
v_mul_f32 v31, v31, v15
v_accvgpr_write_b32 a168, v24
v_accvgpr_write_b32 a169, v25
v_accvgpr_write_b32 a170, v26
v_accvgpr_write_b32 a171, v27
v_accvgpr_write_b32 a172, v28
v_accvgpr_write_b32 a173, v29
v_accvgpr_write_b32 a174, v30
v_accvgpr_write_b32 a175, v31
v_accvgpr_read_b32 v24, a176
v_accvgpr_read_b32 v25, a177
v_accvgpr_read_b32 v26, a178
v_accvgpr_read_b32 v27, a179
v_accvgpr_read_b32 v28, a180
v_accvgpr_read_b32 v29, a181
v_accvgpr_read_b32 v30, a182
v_accvgpr_read_b32 v31, a183
v_mul_f32 v24, v24, v12
v_mul_f32 v25, v25, v12
v_mul_f32 v26, v26, v12
v_mul_f32 v27, v27, v12
v_mul_f32 v28, v28, v13
v_mul_f32 v29, v29, v13
v_mul_f32 v30, v30, v13
v_mul_f32 v31, v31, v13
v_accvgpr_write_b32 a176, v24
v_accvgpr_write_b32 a177, v25
v_accvgpr_write_b32 a178, v26
v_accvgpr_write_b32 a179, v27
v_accvgpr_write_b32 a180, v28
v_accvgpr_write_b32 a181, v29
v_accvgpr_write_b32 a182, v30
v_accvgpr_write_b32 a183, v31
v_accvgpr_read_b32 v24, a184
v_accvgpr_read_b32 v25, a185
v_accvgpr_read_b32 v26, a186
v_accvgpr_read_b32 v27, a187
v_accvgpr_read_b32 v28, a188
v_accvgpr_read_b32 v29, a189
v_accvgpr_read_b32 v30, a190
v_accvgpr_read_b32 v31, a191
v_mul_f32 v24, v24, v14
v_mul_f32 v25, v25, v14
v_mul_f32 v26, v26, v14
v_mul_f32 v27, v27, v14
v_mul_f32 v28, v28, v15
v_mul_f32 v29, v29, v15
v_mul_f32 v30, v30, v15
v_mul_f32 v31, v31, v15
v_accvgpr_write_b32 a184, v24
v_accvgpr_write_b32 a185, v25
v_accvgpr_write_b32 a186, v26
v_accvgpr_write_b32 a187, v27
v_accvgpr_write_b32 a188, v28
v_accvgpr_write_b32 a189, v29
v_accvgpr_write_b32 a190, v30
v_accvgpr_write_b32 a191, v31
v_accvgpr_read_b32 v24, a192
v_accvgpr_read_b32 v25, a193
v_accvgpr_read_b32 v26, a194
v_accvgpr_read_b32 v27, a195
v_accvgpr_read_b32 v28, a196
v_accvgpr_read_b32 v29, a197
v_accvgpr_read_b32 v30, a198
v_accvgpr_read_b32 v31, a199
v_mul_f32 v24, v24, v12
v_mul_f32 v25, v25, v12
v_mul_f32 v26, v26, v12
v_mul_f32 v27, v27, v12
v_mul_f32 v28, v28, v13
v_mul_f32 v29, v29, v13
v_mul_f32 v30, v30, v13
v_mul_f32 v31, v31, v13
v_accvgpr_write_b32 a192, v24
v_accvgpr_write_b32 a193, v25
v_accvgpr_write_b32 a194, v26
v_accvgpr_write_b32 a195, v27
v_accvgpr_write_b32 a196, v28
v_accvgpr_write_b32 a197, v29
v_accvgpr_write_b32 a198, v30
v_accvgpr_write_b32 a199, v31
v_accvgpr_read_b32 v24, a200
v_accvgpr_read_b32 v25, a201
v_accvgpr_read_b32 v26, a202
v_accvgpr_read_b32 v27, a203
v_accvgpr_read_b32 v28, a204
v_accvgpr_read_b32 v29, a205
v_accvgpr_read_b32 v30, a206
v_accvgpr_read_b32 v31, a207
v_mul_f32 v24, v24, v14
v_mul_f32 v25, v25, v14
v_mul_f32 v26, v26, v14
v_mul_f32 v27, v27, v14
v_mul_f32 v28, v28, v15
v_mul_f32 v29, v29, v15
v_mul_f32 v30, v30, v15
v_mul_f32 v31, v31, v15
v_accvgpr_write_b32 a200, v24
v_accvgpr_write_b32 a201, v25
v_accvgpr_write_b32 a202, v26
v_accvgpr_write_b32 a203, v27
v_accvgpr_write_b32 a204, v28
v_accvgpr_write_b32 a205, v29
v_accvgpr_write_b32 a206, v30
v_accvgpr_write_b32 a207, v31
v_accvgpr_read_b32 v24, a208
v_accvgpr_read_b32 v25, a209
v_accvgpr_read_b32 v26, a210
v_accvgpr_read_b32 v27, a211
v_accvgpr_read_b32 v28, a212
v_accvgpr_read_b32 v29, a213
v_accvgpr_read_b32 v30, a214
v_accvgpr_read_b32 v31, a215
v_mul_f32 v24, v24, v12
v_mul_f32 v25, v25, v12
v_mul_f32 v26, v26, v12
v_mul_f32 v27, v27, v12
v_mul_f32 v28, v28, v13
v_mul_f32 v29, v29, v13
v_mul_f32 v30, v30, v13
v_mul_f32 v31, v31, v13
v_accvgpr_write_b32 a208, v24
v_accvgpr_write_b32 a209, v25
v_accvgpr_write_b32 a210, v26
v_accvgpr_write_b32 a211, v27
v_accvgpr_write_b32 a212, v28
v_accvgpr_write_b32 a213, v29
v_accvgpr_write_b32 a214, v30
v_accvgpr_write_b32 a215, v31
v_accvgpr_read_b32 v24, a216
v_accvgpr_read_b32 v25, a217
v_accvgpr_read_b32 v26, a218
v_accvgpr_read_b32 v27, a219
v_accvgpr_read_b32 v28, a220
v_accvgpr_read_b32 v29, a221
v_accvgpr_read_b32 v30, a222
v_accvgpr_read_b32 v31, a223
v_mul_f32 v24, v24, v14
v_mul_f32 v25, v25, v14
v_mul_f32 v26, v26, v14
v_mul_f32 v27, v27, v14
v_mul_f32 v28, v28, v15
v_mul_f32 v29, v29, v15
v_mul_f32 v30, v30, v15
v_mul_f32 v31, v31, v15
v_accvgpr_write_b32 a216, v24
v_accvgpr_write_b32 a217, v25
v_accvgpr_write_b32 a218, v26
v_accvgpr_write_b32 a219, v27
v_accvgpr_write_b32 a220, v28
v_accvgpr_write_b32 a221, v29
v_accvgpr_write_b32 a222, v30
v_accvgpr_write_b32 a223, v31
v_accvgpr_read_b32 v24, a224
v_accvgpr_read_b32 v25, a225
v_accvgpr_read_b32 v26, a226
v_accvgpr_read_b32 v27, a227
v_accvgpr_read_b32 v28, a228
v_accvgpr_read_b32 v29, a229
v_accvgpr_read_b32 v30, a230
v_accvgpr_read_b32 v31, a231
v_mul_f32 v24, v24, v12
v_mul_f32 v25, v25, v12
v_mul_f32 v26, v26, v12
v_mul_f32 v27, v27, v12
v_mul_f32 v28, v28, v13
v_mul_f32 v29, v29, v13
v_mul_f32 v30, v30, v13
v_mul_f32 v31, v31, v13
v_accvgpr_write_b32 a224, v24
v_accvgpr_write_b32 a225, v25
v_accvgpr_write_b32 a226, v26
v_accvgpr_write_b32 a227, v27
v_accvgpr_write_b32 a228, v28
v_accvgpr_write_b32 a229, v29
v_accvgpr_write_b32 a230, v30
v_accvgpr_write_b32 a231, v31
v_accvgpr_read_b32 v24, a232
v_accvgpr_read_b32 v25, a233
v_accvgpr_read_b32 v26, a234
v_accvgpr_read_b32 v27, a235
v_accvgpr_read_b32 v28, a236
v_accvgpr_read_b32 v29, a237
v_accvgpr_read_b32 v30, a238
v_accvgpr_read_b32 v31, a239
v_mul_f32 v24, v24, v14
v_mul_f32 v25, v25, v14
v_mul_f32 v26, v26, v14
v_mul_f32 v27, v27, v14
v_mul_f32 v28, v28, v15
v_mul_f32 v29, v29, v15
v_mul_f32 v30, v30, v15
v_mul_f32 v31, v31, v15
v_accvgpr_write_b32 a232, v24
v_accvgpr_write_b32 a233, v25
v_accvgpr_write_b32 a234, v26
v_accvgpr_write_b32 a235, v27
v_accvgpr_write_b32 a236, v28
v_accvgpr_write_b32 a237, v29
v_accvgpr_write_b32 a238, v30
v_accvgpr_write_b32 a239, v31
s_mov_b32 s48, 0
s_cmp_eq_u32 s52, 0
s_cbranch_scc1 L_at_rsr0
s_cmp_eq_u32 s52, 1
s_cbranch_scc1 L_at_rsr1
s_cmp_eq_u32 s52, 2
s_cbranch_scc1 L_at_rsr2
s_cmp_eq_u32 s52, 3
s_cbranch_scc1 L_at_rsr3
s_cmp_eq_u32 s52, 4
s_cbranch_scc1 L_at_rsr4
s_cmp_eq_u32 s52, 5
s_cbranch_scc1 L_at_rsr5
s_cmp_eq_u32 s52, 6
s_cbranch_scc1 L_at_rsr6
s_cmp_eq_u32 s52, 7
s_cbranch_scc1 L_at_rsr7
s_cmp_eq_u32 s52, 8
s_cbranch_scc1 L_at_rsr8
s_branch L_at_rsr9
L_at_done:
s_load_dwordx2 s[4:5], s[0:1], 40
s_waitcnt lgkmcnt(0)
s_mov_b32 s20, s4
s_and_b32 s21, s5, 0xffff
s_mov_b32 s22, 4718592
s_mov_b32 s23, 0x20000
s_sub_u32 s25, s3, 4
s_mul_i32 s24, s25, 27
s_add_u32 s24, s24, s16
s_mul_i32 s26, s25, 5
s_add_u32 s26, s26, s16
s_add_u32 s26, s26, 81
s_cmp_ge_u32 s16, 27
s_cselect_b32 s24, s26, s24
s_cmp_ge_u32 s24, 126
s_cbranch_scc1 L_done
s_mul_i32 s25, s24, 57
s_lshr_b32 s25, s25, 9
s_mul_i32 s26, s25, 9
s_sub_u32 s40, s24, s26
s_and_b32 s51, s25, 1
s_add_u32 s51, s51, 126
s_lshr_b32 s25, s25, 1
s_cmp_eq_u32 s25, 0
s_cselect_b32 s42, 0x20408109, s42
s_cselect_b32 s43, 0x2040810, s43
s_cmp_eq_u32 s25, 1
s_cselect_b32 s42, 0x40810212, s42
s_cselect_b32 s43, 0x4081020, s43
s_cmp_eq_u32 s25, 2
s_cselect_b32 s42, 0x81020424, s42
s_cselect_b32 s43, 0x8102040, s43
s_cmp_eq_u32 s25, 3
s_cselect_b32 s42, 0x2040840, s42
s_cselect_b32 s43, 0x10204081, s43
s_cmp_eq_u32 s25, 4
s_cselect_b32 s42, 0x4081000, s42
s_cselect_b32 s43, 0x20408102, s43
s_cmp_eq_u32 s25, 5
s_cselect_b32 s42, 0x8102000, s42
s_cselect_b32 s43, 0x40810204, s43
s_cmp_eq_u32 s25, 6
s_cselect_b32 s42, 0x10204080, s42
s_cselect_b32 s43, 0x81020408, s43
s_mov_b32 s44, 67108864
s_mov_b32 s45, 111169536
s_mov_b32 s46, 4
s_mov_b32 s47, 0
s_branch L_op
L_bdie:
s_mov_b32 s4, 0x57ff0000
s_mov_b32 s5, 0x55555555
s_cmp_eq_u32 s3, 2
s_cbranch_scc1 L_cr0
s_mov_b32 s4, 0xa8000000
s_mov_b32 s5, 0xaaaaaaaa
s_branch L_cr0
s_and_b32 s27, s3, 1
s_lshr_b32 s26, s16, 2
s_lshl_b32 s26, s26, 1
s_and_b32 s24, s16, 1
s_add_u32 s26, s26, s24
s_mov_b32 s4, 0x57ff0000
s_mov_b32 s5, 0x55555555
s_bitcmp1_b32 s16, 1
s_cbranch_scc1 L_crew
s_mov_b32 s4, 0xa8000000
s_mov_b32 s5, 0xaaaaaaaa
s_branch L_crew
L_part:
s_mov_b32 s4, 0xffff
s_mov_b32 s5, 0x0
L_cr0:
s_and_b32 s27, s16, 1
s_lshr_b32 s26, s16, 1
L_crew:
s_cmp_eq_u64 s[4:5], 0
s_cbranch_scc1 L_done
s_cmp_lt_u32 s26, 9
s_cbranch_scc1 L_bo
s_mov_b64 s[52:53], s[4:5]
s_sub_u32 s41, s26, 9
s_lshl_b32 s41, s41, 1
s_add_u32 s41, s41, s27
s_mul_i32 s24, s17, 14
s_add_u32 s41, s41, s24
s_mov_b32 s40, 0x3e0293ee
s_mov_b32 s50, 0xf149f2ca
s_mov_b32 s51, 0x41a00000
v_and_b32 v5, 31, v0
v_bfe_u32 v26, v0, 5, 1
v_lshlrev_b32 v27, 2, v26
v_sub_u32 v5, v5, v27
v_bfe_u32 v27, v0, 4, 1
v_lshlrev_b32 v6, 17, v27
v_lshl_add_u32 v6, v26, 8, v6
v_and_b32 v27, 15, v0
v_lshl_add_u32 v6, v27, 4, v6
v_and_b32 v1, 63, v0
v_min_u32 v17, 47, v1
v_lshlrev_b32 v1, 4, v1
v_bfe_u32 v26, v0, 5, 1
v_and_b32 v27, 1, v0
v_lshlrev_b32 v2, 7, v27
v_lshlrev_b32 v3, 10, v27
v_lshl_add_u32 v2, v26, 6, v2
v_lshl_add_u32 v3, v26, 7, v3
v_bfe_u32 v27, v0, 1, 2
v_lshl_add_u32 v2, v27, 4, v2
v_bfe_u32 v27, v0, 1, 4
v_lshl_add_u32 v3, v27, 2, v3
v_mov_b32 v4, 0
v_lshlrev_b32 v17, 7, v17
v_mul_u32_u24 v26, 24576, v26
v_add_u32 v17, v17, v26
v_add_u32 v17, 111149056, v17
v_bfe_u32 v26, v0, 1, 2
v_and_b32 v27, 1, v0
v_lshl_add_u32 v26, v27, 4, v26
v_bfe_u32 v27, v0, 4, 1
v_lshl_add_u32 v26, v27, 2, v26
v_and_or_b32 v26, v0, 40, v26
v_lshlrev_b32 v16, 4, v26
v_mov_b32 v31, s50
s_mov_b32 s49, 0
s_mov_b32 s45, -1
v_cmp_le_i32 s[64:65], 0, v5
v_cmp_le_i32 s[66:67], 1, v5
v_cmp_le_i32 s[68:69], 2, v5
v_cmp_le_i32 s[70:71], 3, v5
v_cmp_le_i32 s[72:73], 8, v5
v_cmp_le_i32 s[74:75], 9, v5
v_cmp_le_i32 s[76:77], 10, v5
v_cmp_le_i32 s[78:79], 11, v5
v_cmp_le_i32 s[80:81], 16, v5
v_cmp_le_i32 s[82:83], 17, v5
v_cmp_le_i32 s[84:85], 18, v5
v_cmp_le_i32 s[86:87], 19, v5
v_cmp_le_i32 s[88:89], 24, v5
v_cmp_le_i32 s[90:91], 25, v5
v_cmp_le_i32 s[92:93], 26, v5
v_cmp_le_i32 s[94:95], 27, v5
L_nb_15:
s_ff1_i32_b64 s47, s[52:53]
s_cmp_lt_u32 s41, 32
s_cbranch_scc1 L_nb_16
s_bitset0_b64 s[52:53], s47
s_sub_u32 s41, s41, 32
s_branch L_nb_15
L_nb_16:
s_lshl_b32 s47, s47, 5
s_add_u32 s47, s47, s41
s_add_u32 s41, s41, 56
s_lshl_b32 s46, s47, 14
s_add_u32 s46, s46, 33554432
s_lshl_b32 s44, s47, 13
s_add_u32 s44, s44, 134217728
s_cmp_ge_u32 s47, 2048
s_cselect_b32 s44, 536870912, s44
s_cselect_b32 s46, 536870912, s46
s_cbranch_scc1 L_nb_14
s_lshr_b32 s25, s47, 8
s_lshl_b32 s25, s25, 2
s_cmp_eq_u32 s25, s45
s_cbranch_scc1 L_nb_14
s_mov_b32 s45, s25
s_mov_b32 s28, 0
L_poll_17:
buffer_load_dword v26, v17, s[8:11], s45 offen sc1
s_add_u32 s28, s28, 1
s_cmp_gt_u32 s28, 40000
s_cbranch_scc1 L_end
s_waitcnt vmcnt(0)
v_cmp_ne_u32 vcc, 1, v26
s_cbranch_vccz L_pd_18
s_sleep 8
s_cmp_lt_u32 s28, 32
s_cbranch_scc1 L_poll_17
s_sleep 32
s_branch L_poll_17
L_pd_18:
L_nb_14:
s_cmp_ge_u32 s47, 2048
s_cbranch_scc1 L_bt_x
s_add_u32 s25, s44, 0
buffer_load_dwordx4 a[0:3], v1, s[8:11], s25 offen sc1
buffer_load_dwordx4 a[4:7], v1, s[8:11], s25 offen offset:1024 sc1
buffer_load_dwordx4 a[8:11], v1, s[8:11], s25 offen offset:2048 sc1
buffer_load_dwordx4 a[12:15], v1, s[8:11], s25 offen offset:3072 sc1
s_add_u32 s25, s44, 4096
buffer_load_dwordx4 a[16:19], v1, s[8:11], s25 offen sc1
buffer_load_dwordx4 a[20:23], v1, s[8:11], s25 offen offset:1024 sc1
buffer_load_dwordx4 a[24:27], v1, s[8:11], s25 offen offset:2048 sc1
buffer_load_dwordx4 a[28:31], v1, s[8:11], s25 offen offset:3072 sc1
s_add_u32 s25, s46, 0
buffer_load_dwordx4 a[32:35], v1, s[8:11], s25 offen sc1
buffer_load_dwordx4 a[36:39], v1, s[8:11], s25 offen offset:1024 sc1
buffer_load_dwordx4 a[40:43], v1, s[8:11], s25 offen offset:2048 sc1
buffer_load_dwordx4 a[44:47], v1, s[8:11], s25 offen offset:3072 sc1
s_add_u32 s25, s46, 4096
buffer_load_dwordx4 a[48:51], v1, s[8:11], s25 offen sc1
buffer_load_dwordx4 a[52:55], v1, s[8:11], s25 offen offset:1024 sc1
buffer_load_dwordx4 a[56:59], v1, s[8:11], s25 offen offset:2048 sc1
buffer_load_dwordx4 a[60:63], v1, s[8:11], s25 offen offset:3072 sc1
s_add_u32 s25, s46, 8192
buffer_load_dwordx4 a[64:67], v16, s[8:11], s25 offen sc1
buffer_load_dwordx4 a[68:71], v16, s[8:11], s25 offen offset:1024 sc1
buffer_load_dwordx4 a[72:75], v16, s[8:11], s25 offen offset:2048 sc1
buffer_load_dwordx4 a[76:79], v16, s[8:11], s25 offen offset:3072 sc1
s_add_u32 s25, s46, 12288
buffer_load_dwordx4 a[80:83], v16, s[8:11], s25 offen sc1
buffer_load_dwordx4 a[84:87], v16, s[8:11], s25 offen offset:1024 sc1
buffer_load_dwordx4 a[88:91], v16, s[8:11], s25 offen offset:2048 sc1
buffer_load_dwordx4 a[92:95], v16, s[8:11], s25 offen offset:3072 sc1
s_waitcnt vmcnt(0)
s_mov_b32 s54, 536870912
L_bt:
s_waitcnt vmcnt(8)
v_mfma_f32_32x32x16_bf16 v[32:47], a[32:35], a[0:3], 0
v_mfma_f32_32x32x16_bf16 v[32:47], a[36:39], a[4:7], v[32:47]
v_mfma_f32_32x32x16_bf16 v[32:47], a[40:43], a[8:11], v[32:47]
v_mfma_f32_32x32x16_bf16 v[32:47], a[44:47], a[12:15], v[32:47]
v_mfma_f32_32x32x16_bf16 v[32:47], a[48:51], a[16:19], v[32:47]
v_mfma_f32_32x32x16_bf16 v[32:47], a[52:55], a[20:23], v[32:47]
v_mfma_f32_32x32x16_bf16 v[32:47], a[56:59], a[24:27], v[32:47]
v_mfma_f32_32x32x16_bf16 v[32:47], a[60:63], a[28:31], v[32:47]
s_and_b32 s42, s47, 31
s_lshr_b32 s43, s47, 5
s_lshl_b32 s26, s47, 12
s_add_u32 s26, s26, 100663296
s_nop 7
v_cndmask_b32 v32, v31, v32, s[64:65]
v_cndmask_b32 v33, v31, v33, s[66:67]
v_cndmask_b32 v34, v31, v34, s[68:69]
v_cndmask_b32 v35, v31, v35, s[70:71]
v_cndmask_b32 v36, v31, v36, s[72:73]
v_cndmask_b32 v37, v31, v37, s[74:75]
v_cndmask_b32 v38, v31, v38, s[76:77]
v_cndmask_b32 v39, v31, v39, s[78:79]
v_cndmask_b32 v40, v31, v40, s[80:81]
v_cndmask_b32 v41, v31, v41, s[82:83]
v_cndmask_b32 v42, v31, v42, s[84:85]
v_cndmask_b32 v43, v31, v43, s[86:87]
v_cndmask_b32 v44, v31, v44, s[88:89]
v_cndmask_b32 v45, v31, v45, s[90:91]
v_cndmask_b32 v46, v31, v46, s[92:93]
v_cndmask_b32 v47, v31, v47, s[94:95]
v_max3_f32 v20, v32, v33, v34
v_max3_f32 v20, v20, v35, v36
v_max3_f32 v20, v20, v37, v38
v_max3_f32 v20, v20, v39, v40
v_max3_f32 v20, v20, v41, v42
v_max3_f32 v20, v20, v43, v44
v_max3_f32 v20, v20, v45, v46
v_max_f32 v20, v20, v47
s_cmp_lt_u32 s43, s49
s_cbranch_scc1 L_kn_19
v_mov_b32 v26, 1
s_waitcnt vmcnt(0)
s_mov_b64 exec, 1
buffer_store_dword v26, v4, s[8:11], s54 offen
s_mov_b64 exec, -1
L_nb_22:
s_ff1_i32_b64 s48, s[52:53]
s_cmp_lt_u32 s41, 32
s_cbranch_scc1 L_nb_23
s_bitset0_b64 s[52:53], s48
s_sub_u32 s41, s41, 32
s_branch L_nb_22
L_nb_23:
s_lshl_b32 s48, s48, 5
s_add_u32 s48, s48, s41
s_add_u32 s41, s41, 56
s_lshl_b32 s46, s48, 14
s_add_u32 s46, s46, 33554432
s_lshl_b32 s44, s48, 13
s_add_u32 s44, s44, 134217728
s_cmp_ge_u32 s48, 2048
s_cselect_b32 s44, 536870912, s44
s_cselect_b32 s46, 536870912, s46
s_cbranch_scc1 L_nb_21
s_lshr_b32 s25, s48, 8
s_lshl_b32 s25, s25, 2
s_cmp_eq_u32 s25, s45
s_cbranch_scc1 L_nb_21
s_mov_b32 s45, s25
s_mov_b32 s28, 0
L_poll_24:
buffer_load_dword v26, v17, s[8:11], s45 offen sc1
s_add_u32 s28, s28, 1
s_cmp_gt_u32 s28, 40000
s_cbranch_scc1 L_end
s_waitcnt vmcnt(0)
v_cmp_ne_u32 vcc, 1, v26
s_cbranch_vccz L_pd_25
s_sleep 8
s_cmp_lt_u32 s28, 32
s_cbranch_scc1 L_poll_24
s_sleep 32
s_branch L_poll_24
L_pd_25:
L_nb_21:
s_add_u32 s25, s44, 0
buffer_load_dwordx4 a[96:99], v1, s[8:11], s25 offen sc1
buffer_load_dwordx4 a[100:103], v1, s[8:11], s25 offen offset:1024 sc1
buffer_load_dwordx4 a[104:107], v1, s[8:11], s25 offen offset:2048 sc1
buffer_load_dwordx4 a[108:111], v1, s[8:11], s25 offen offset:3072 sc1
s_add_u32 s25, s44, 4096
buffer_load_dwordx4 a[112:115], v1, s[8:11], s25 offen sc1
buffer_load_dwordx4 a[116:119], v1, s[8:11], s25 offen offset:1024 sc1
buffer_load_dwordx4 a[120:123], v1, s[8:11], s25 offen offset:2048 sc1
buffer_load_dwordx4 a[124:127], v1, s[8:11], s25 offen offset:3072 sc1
s_add_u32 s25, s46, 0
buffer_load_dwordx4 a[128:131], v1, s[8:11], s25 offen sc1
buffer_load_dwordx4 a[132:135], v1, s[8:11], s25 offen offset:1024 sc1
buffer_load_dwordx4 a[136:139], v1, s[8:11], s25 offen offset:2048 sc1
buffer_load_dwordx4 a[140:143], v1, s[8:11], s25 offen offset:3072 sc1
s_add_u32 s25, s46, 4096
buffer_load_dwordx4 a[144:147], v1, s[8:11], s25 offen sc1
buffer_load_dwordx4 a[148:151], v1, s[8:11], s25 offen offset:1024 sc1
buffer_load_dwordx4 a[152:155], v1, s[8:11], s25 offen offset:2048 sc1
buffer_load_dwordx4 a[156:159], v1, s[8:11], s25 offen offset:3072 sc1
s_add_u32 s25, s46, 8192
buffer_load_dwordx4 a[160:163], v16, s[8:11], s25 offen sc1
buffer_load_dwordx4 a[164:167], v16, s[8:11], s25 offen offset:1024 sc1
buffer_load_dwordx4 a[168:171], v16, s[8:11], s25 offen offset:2048 sc1
buffer_load_dwordx4 a[172:175], v16, s[8:11], s25 offen offset:3072 sc1
s_add_u32 s25, s46, 12288
buffer_load_dwordx4 a[176:179], v16, s[8:11], s25 offen sc1
buffer_load_dwordx4 a[180:183], v16, s[8:11], s25 offen offset:1024 sc1
buffer_load_dwordx4 a[184:187], v16, s[8:11], s25 offen offset:2048 sc1
buffer_load_dwordx4 a[188:191], v16, s[8:11], s25 offen offset:3072 sc1
s_lshl_b32 s25, s42, 7
s_add_u32 s25, s25, 111153152
s_mov_b32 s28, 0
L_poll_26:
buffer_load_dword v26, v4, s[8:11], s25 offen sc1
s_add_u32 s28, s28, 1
s_cmp_gt_u32 s28, 40000
s_cbranch_scc1 L_end
s_waitcnt vmcnt(0)
v_cmp_ge_u32 vcc, s43, v26
s_cbranch_vccz L_pd_27
s_sleep 1
s_cmp_lt_u32 s28, 32
s_cbranch_scc1 L_poll_26
s_sleep 32
s_branch L_poll_26
L_pd_27:
buffer_load_dwordx4 v[96:99], v2, s[8:11], s26 offen sc1
buffer_load_dwordx4 v[100:103], v2, s[8:11], s26 offen offset:256 sc1
buffer_load_dwordx4 v[104:107], v2, s[8:11], s26 offen offset:512 sc1
buffer_load_dwordx4 v[108:111], v2, s[8:11], s26 offen offset:768 sc1
buffer_load_dwordx4 v[112:115], v2, s[8:11], s26 offen offset:1024 sc1
buffer_load_dwordx4 v[116:119], v2, s[8:11], s26 offen offset:1280 sc1
buffer_load_dwordx4 v[120:123], v2, s[8:11], s26 offen offset:1536 sc1
buffer_load_dwordx4 v[124:127], v2, s[8:11], s26 offen offset:1792 sc1
buffer_load_dword v8, v3, s[8:11], s26 offen offset:2048 sc1
buffer_load_dword v9, v3, s[8:11], s26 offen offset:2112 sc1
buffer_load_dword v10, v3, s[8:11], s26 offen offset:2304 sc1
buffer_load_dword v11, v3, s[8:11], s26 offen offset:2368 sc1
buffer_load_dword v12, v3, s[8:11], s26 offen offset:2560 sc1
buffer_load_dword v13, v3, s[8:11], s26 offen offset:2624 sc1
buffer_load_dword v14, v3, s[8:11], s26 offen offset:2816 sc1
buffer_load_dword v15, v3, s[8:11], s26 offen offset:2880 sc1
v_readfirstlane_b32 s49, v26
s_nop 0
s_min_u32 s49, s49, 63
s_sub_u32 s49, s49, 1
s_waitcnt vmcnt(15)
v_mfma_f32_32x32x16_bf16 v[64:79], v[96:99], a[0:3], 0
s_waitcnt vmcnt(14)
v_mfma_f32_32x32x16_bf16 v[64:79], v[100:103], a[4:7], v[64:79]
s_waitcnt vmcnt(13)
v_mfma_f32_32x32x16_bf16 v[64:79], v[104:107], a[8:11], v[64:79]
s_waitcnt vmcnt(12)
v_mfma_f32_32x32x16_bf16 v[64:79], v[108:111], a[12:15], v[64:79]
s_waitcnt vmcnt(11)
v_mfma_f32_32x32x16_bf16 v[64:79], v[112:115], a[16:19], v[64:79]
s_waitcnt vmcnt(10)
v_mfma_f32_32x32x16_bf16 v[64:79], v[116:119], a[20:23], v[64:79]
s_waitcnt vmcnt(9)
v_mfma_f32_32x32x16_bf16 v[64:79], v[120:123], a[24:27], v[64:79]
s_waitcnt vmcnt(8)
v_mfma_f32_32x32x16_bf16 v[64:79], v[124:127], a[28:31], v[64:79]
s_waitcnt vmcnt(0)
s_branch L_kj_20
L_kn_19:
buffer_load_dwordx4 v[96:99], v2, s[8:11], s26 offen sc1
buffer_load_dwordx4 v[100:103], v2, s[8:11], s26 offen offset:256 sc1
buffer_load_dwordx4 v[104:107], v2, s[8:11], s26 offen offset:512 sc1
buffer_load_dwordx4 v[108:111], v2, s[8:11], s26 offen offset:768 sc1
buffer_load_dwordx4 v[112:115], v2, s[8:11], s26 offen offset:1024 sc1
buffer_load_dwordx4 v[116:119], v2, s[8:11], s26 offen offset:1280 sc1
buffer_load_dwordx4 v[120:123], v2, s[8:11], s26 offen offset:1536 sc1
buffer_load_dwordx4 v[124:127], v2, s[8:11], s26 offen offset:1792 sc1
buffer_load_dword v8, v3, s[8:11], s26 offen offset:2048 sc1
buffer_load_dword v9, v3, s[8:11], s26 offen offset:2112 sc1
buffer_load_dword v10, v3, s[8:11], s26 offen offset:2304 sc1
buffer_load_dword v11, v3, s[8:11], s26 offen offset:2368 sc1
buffer_load_dword v12, v3, s[8:11], s26 offen offset:2560 sc1
buffer_load_dword v13, v3, s[8:11], s26 offen offset:2624 sc1
buffer_load_dword v14, v3, s[8:11], s26 offen offset:2816 sc1
buffer_load_dword v15, v3, s[8:11], s26 offen offset:2880 sc1
v_mov_b32 v26, 1
s_waitcnt vmcnt(16)
s_mov_b64 exec, 1
buffer_store_dword v26, v4, s[8:11], s54 offen
s_mov_b64 exec, -1
L_nb_29:
s_ff1_i32_b64 s48, s[52:53]
s_cmp_lt_u32 s41, 32
s_cbranch_scc1 L_nb_30
s_bitset0_b64 s[52:53], s48
s_sub_u32 s41, s41, 32
s_branch L_nb_29
L_nb_30:
s_lshl_b32 s48, s48, 5
s_add_u32 s48, s48, s41
s_add_u32 s41, s41, 56
s_lshl_b32 s46, s48, 14
s_add_u32 s46, s46, 33554432
s_lshl_b32 s44, s48, 13
s_add_u32 s44, s44, 134217728
s_cmp_ge_u32 s48, 2048
s_cselect_b32 s44, 536870912, s44
s_cselect_b32 s46, 536870912, s46
s_cbranch_scc1 L_nb_28
s_lshr_b32 s25, s48, 8
s_lshl_b32 s25, s25, 2
s_cmp_eq_u32 s25, s45
s_cbranch_scc1 L_nb_28
s_mov_b32 s45, s25
s_mov_b32 s28, 0
L_poll_31:
buffer_load_dword v26, v17, s[8:11], s45 offen sc1
s_add_u32 s28, s28, 1
s_cmp_gt_u32 s28, 40000
s_cbranch_scc1 L_end
s_waitcnt vmcnt(0)
v_cmp_ne_u32 vcc, 1, v26
s_cbranch_vccz L_pd_32
s_sleep 8
s_cmp_lt_u32 s28, 32
s_cbranch_scc1 L_poll_31
s_sleep 32
s_branch L_poll_31
L_pd_32:
L_nb_28:
s_add_u32 s25, s44, 0
buffer_load_dwordx4 a[96:99], v1, s[8:11], s25 offen sc1
buffer_load_dwordx4 a[100:103], v1, s[8:11], s25 offen offset:1024 sc1
buffer_load_dwordx4 a[104:107], v1, s[8:11], s25 offen offset:2048 sc1
buffer_load_dwordx4 a[108:111], v1, s[8:11], s25 offen offset:3072 sc1
s_add_u32 s25, s44, 4096
buffer_load_dwordx4 a[112:115], v1, s[8:11], s25 offen sc1
buffer_load_dwordx4 a[116:119], v1, s[8:11], s25 offen offset:1024 sc1
buffer_load_dwordx4 a[120:123], v1, s[8:11], s25 offen offset:2048 sc1
buffer_load_dwordx4 a[124:127], v1, s[8:11], s25 offen offset:3072 sc1
s_waitcnt vmcnt(24)
v_mfma_f32_32x32x16_bf16 v[64:79], v[96:99], a[0:3], 0
s_add_u32 s25, s46, 0
buffer_load_dwordx4 a[128:131], v1, s[8:11], s25 offen sc1
buffer_load_dwordx4 a[132:135], v1, s[8:11], s25 offen offset:1024 sc1
s_waitcnt vmcnt(25)
v_mfma_f32_32x32x16_bf16 v[64:79], v[100:103], a[4:7], v[64:79]
buffer_load_dwordx4 a[136:139], v1, s[8:11], s25 offen offset:2048 sc1
buffer_load_dwordx4 a[140:143], v1, s[8:11], s25 offen offset:3072 sc1
s_waitcnt vmcnt(26)
v_mfma_f32_32x32x16_bf16 v[64:79], v[104:107], a[8:11], v[64:79]
s_add_u32 s25, s46, 4096
buffer_load_dwordx4 a[144:147], v1, s[8:11], s25 offen sc1
buffer_load_dwordx4 a[148:151], v1, s[8:11], s25 offen offset:1024 sc1
s_waitcnt vmcnt(27)
v_mfma_f32_32x32x16_bf16 v[64:79], v[108:111], a[12:15], v[64:79]
buffer_load_dwordx4 a[152:155], v1, s[8:11], s25 offen offset:2048 sc1
buffer_load_dwordx4 a[156:159], v1, s[8:11], s25 offen offset:3072 sc1
s_waitcnt vmcnt(28)
v_mfma_f32_32x32x16_bf16 v[64:79], v[112:115], a[16:19], v[64:79]
s_add_u32 s25, s46, 8192
buffer_load_dwordx4 a[160:163], v16, s[8:11], s25 offen sc1
buffer_load_dwordx4 a[164:167], v16, s[8:11], s25 offen offset:1024 sc1
s_waitcnt vmcnt(29)
v_mfma_f32_32x32x16_bf16 v[64:79], v[116:119], a[20:23], v[64:79]
buffer_load_dwordx4 a[168:171], v16, s[8:11], s25 offen offset:2048 sc1
buffer_load_dwordx4 a[172:175], v16, s[8:11], s25 offen offset:3072 sc1
s_waitcnt vmcnt(30)
v_mfma_f32_32x32x16_bf16 v[64:79], v[120:123], a[24:27], v[64:79]
s_add_u32 s25, s46, 12288
buffer_load_dwordx4 a[176:179], v16, s[8:11], s25 offen sc1
buffer_load_dwordx4 a[180:183], v16, s[8:11], s25 offen offset:1024 sc1
s_waitcnt vmcnt(31)
v_mfma_f32_32x32x16_bf16 v[64:79], v[124:127], a[28:31], v[64:79]
buffer_load_dwordx4 a[184:187], v16, s[8:11], s25 offen offset:2048 sc1
buffer_load_dwordx4 a[188:191], v16, s[8:11], s25 offen offset:3072 sc1
s_waitcnt vmcnt(25)
L_kj_20:
s_nop 9
v_max3_f32 v20, v20, v64, v65
v_max3_f32 v20, v20, v66, v67
v_mov_b32 v26, v20
s_nop 1
v_permlane32_swap_b32 v26, v20
v_max_f32 v20, v20, v26
v_mul_f32 v20, s40, v20
v_pk_fma_f32 v[64:65], v[64:65], s[40:41], v[20:21] op_sel_hi:[1,0,0] neg_lo:[0,0,1] neg_hi:[0,0,1]
v_pk_fma_f32 v[66:67], v[66:67], s[40:41], v[20:21] op_sel_hi:[1,0,0] neg_lo:[0,0,1] neg_hi:[0,0,1]
v_pk_fma_f32 v[32:33], v[32:33], s[40:41], v[20:21] op_sel_hi:[1,0,0] neg_lo:[0,0,1] neg_hi:[0,0,1]
v_pk_fma_f32 v[34:35], v[34:35], s[40:41], v[20:21] op_sel_hi:[1,0,0] neg_lo:[0,0,1] neg_hi:[0,0,1]
v_pk_fma_f32 v[36:37], v[36:37], s[40:41], v[20:21] op_sel_hi:[1,0,0] neg_lo:[0,0,1] neg_hi:[0,0,1]
v_pk_fma_f32 v[38:39], v[38:39], s[40:41], v[20:21] op_sel_hi:[1,0,0] neg_lo:[0,0,1] neg_hi:[0,0,1]
v_pk_fma_f32 v[40:41], v[40:41], s[40:41], v[20:21] op_sel_hi:[1,0,0] neg_lo:[0,0,1] neg_hi:[0,0,1]
v_pk_fma_f32 v[42:43], v[42:43], s[40:41], v[20:21] op_sel_hi:[1,0,0] neg_lo:[0,0,1] neg_hi:[0,0,1]
v_pk_fma_f32 v[44:45], v[44:45], s[40:41], v[20:21] op_sel_hi:[1,0,0] neg_lo:[0,0,1] neg_hi:[0,0,1]
v_pk_fma_f32 v[46:47], v[46:47], s[40:41], v[20:21] op_sel_hi:[1,0,0] neg_lo:[0,0,1] neg_hi:[0,0,1]
v_exp_f32 v64, v64
v_exp_f32 v65, v65
v_exp_f32 v66, v66
v_exp_f32 v67, v67
v_exp_f32 v32, v32
v_exp_f32 v33, v33
v_cvt_pk_bf16_f32 v88, v64, v65
v_cvt_pk_bf16_f32 v89, v66, v67
s_nop 1
v_mfma_f32_32x32x8_bf16 v[128:143], v[8:9], v[88:89], 0
v_exp_f32 v34, v34
v_exp_f32 v35, v35
v_exp_f32 v36, v36
v_mfma_f32_32x32x8_bf16 v[160:175], v[10:11], v[88:89], 0
v_exp_f32 v37, v37
v_exp_f32 v38, v38
v_mfma_f32_32x32x8_bf16 v[192:207], v[12:13], v[88:89], 0
v_exp_f32 v39, v39
v_exp_f32 v40, v40
v_exp_f32 v41, v41
v_mfma_f32_32x32x8_bf16 v[224:239], v[14:15], v[88:89], 0
v_cvt_pk_bf16_f32 v80, v32, v33
v_cvt_pk_bf16_f32 v81, v34, v35
v_cvt_pk_bf16_f32 v82, v36, v37
v_cvt_pk_bf16_f32 v83, v38, v39
s_nop 1
v_mfma_f32_32x32x16_bf16 v[128:143], a[64:67], v[80:83], v[128:143]
v_exp_f32 v42, v42
v_exp_f32 v43, v43
v_exp_f32 v44, v44
v_mfma_f32_32x32x16_bf16 v[160:175], a[72:75], v[80:83], v[160:175]
v_exp_f32 v45, v45
v_exp_f32 v46, v46
v_mfma_f32_32x32x16_bf16 v[192:207], a[80:83], v[80:83], v[192:207]
v_exp_f32 v47, v47
v_add_f32 v22, v64, v65
v_add_f32 v22, v22, v66
v_add_f32 v22, v22, v67
v_add_f32 v22, v22, v32
v_mfma_f32_32x32x16_bf16 v[224:239], a[88:91], v[80:83], v[224:239]
v_add_f32 v22, v22, v33
v_cvt_pk_bf16_f32 v84, v40, v41
v_cvt_pk_bf16_f32 v85, v42, v43
v_cvt_pk_bf16_f32 v86, v44, v45
v_cvt_pk_bf16_f32 v87, v46, v47
s_nop 1
v_mfma_f32_32x32x16_bf16 v[128:143], a[68:71], v[84:87], v[128:143]
v_add_f32 v22, v22, v34
v_add_f32 v22, v22, v35
v_add_f32 v22, v22, v36
v_add_f32 v22, v22, v37
v_add_f32 v22, v22, v38
v_mfma_f32_32x32x16_bf16 v[160:175], a[76:79], v[84:87], v[160:175]
v_add_f32 v22, v22, v39
v_add_f32 v22, v22, v40
v_add_f32 v22, v22, v41
v_add_f32 v22, v22, v42
v_mfma_f32_32x32x16_bf16 v[192:207], a[84:87], v[84:87], v[192:207]
v_add_f32 v22, v22, v43
v_add_f32 v22, v22, v44
v_add_f32 v22, v22, v45
v_add_f32 v22, v22, v46
v_add_f32 v22, v22, v47
v_mfma_f32_32x32x16_bf16 v[224:239], a[92:95], v[84:87], v[224:239]
s_lshl_b32 s26, s43, 18
s_lshl_b32 s27, s42, 12
s_add_u32 s26, s26, s27
s_add_u32 s26, s26, 83886080
v_mov_b32 v26, v22
s_nop 1
v_permlane32_swap_b32 v26, v22
v_add_f32 v26, v26, v22
v_rcp_f32 v26, v26
s_nop 0
v_pk_mul_f32 v[128:129], v[128:129], v[26:27] op_sel_hi:[1,0]
v_pk_mul_f32 v[130:131], v[130:131], v[26:27] op_sel_hi:[1,0]
v_pk_mul_f32 v[132:133], v[132:133], v[26:27] op_sel_hi:[1,0]
v_pk_mul_f32 v[134:135], v[134:135], v[26:27] op_sel_hi:[1,0]
v_pk_mul_f32 v[136:137], v[136:137], v[26:27] op_sel_hi:[1,0]
v_pk_mul_f32 v[138:139], v[138:139], v[26:27] op_sel_hi:[1,0]
v_pk_mul_f32 v[140:141], v[140:141], v[26:27] op_sel_hi:[1,0]
v_pk_mul_f32 v[142:143], v[142:143], v[26:27] op_sel_hi:[1,0]
v_cvt_pk_bf16_f32 v128, v128, v129
v_cvt_pk_bf16_f32 v129, v130, v131
v_cvt_pk_bf16_f32 v130, v132, v133
v_cvt_pk_bf16_f32 v131, v134, v135
buffer_store_dwordx4 v[128:131], v6, s[8:11], s26 offen
v_cvt_pk_bf16_f32 v136, v136, v137
v_cvt_pk_bf16_f32 v137, v138, v139
v_cvt_pk_bf16_f32 v138, v140, v141
v_cvt_pk_bf16_f32 v139, v142, v143
buffer_store_dwordx4 v[136:139], v6, s[8:11], s26 offen offset:512
v_pk_mul_f32 v[160:161], v[160:161], v[26:27] op_sel_hi:[1,0]
v_pk_mul_f32 v[162:163], v[162:163], v[26:27] op_sel_hi:[1,0]
v_pk_mul_f32 v[164:165], v[164:165], v[26:27] op_sel_hi:[1,0]
v_pk_mul_f32 v[166:167], v[166:167], v[26:27] op_sel_hi:[1,0]
v_pk_mul_f32 v[168:169], v[168:169], v[26:27] op_sel_hi:[1,0]
v_pk_mul_f32 v[170:171], v[170:171], v[26:27] op_sel_hi:[1,0]
v_pk_mul_f32 v[172:173], v[172:173], v[26:27] op_sel_hi:[1,0]
v_pk_mul_f32 v[174:175], v[174:175], v[26:27] op_sel_hi:[1,0]
v_cvt_pk_bf16_f32 v160, v160, v161
v_cvt_pk_bf16_f32 v161, v162, v163
v_cvt_pk_bf16_f32 v162, v164, v165
v_cvt_pk_bf16_f32 v163, v166, v167
buffer_store_dwordx4 v[160:163], v6, s[8:11], s26 offen offset:1024
v_cvt_pk_bf16_f32 v168, v168, v169
v_cvt_pk_bf16_f32 v169, v170, v171
v_cvt_pk_bf16_f32 v170, v172, v173
v_cvt_pk_bf16_f32 v171, v174, v175
buffer_store_dwordx4 v[168:171], v6, s[8:11], s26 offen offset:1536
v_pk_mul_f32 v[192:193], v[192:193], v[26:27] op_sel_hi:[1,0]
v_pk_mul_f32 v[194:195], v[194:195], v[26:27] op_sel_hi:[1,0]
v_pk_mul_f32 v[196:197], v[196:197], v[26:27] op_sel_hi:[1,0]
v_pk_mul_f32 v[198:199], v[198:199], v[26:27] op_sel_hi:[1,0]
v_pk_mul_f32 v[200:201], v[200:201], v[26:27] op_sel_hi:[1,0]
v_pk_mul_f32 v[202:203], v[202:203], v[26:27] op_sel_hi:[1,0]
v_pk_mul_f32 v[204:205], v[204:205], v[26:27] op_sel_hi:[1,0]
v_pk_mul_f32 v[206:207], v[206:207], v[26:27] op_sel_hi:[1,0]
v_cvt_pk_bf16_f32 v192, v192, v193
v_cvt_pk_bf16_f32 v193, v194, v195
v_cvt_pk_bf16_f32 v194, v196, v197
v_cvt_pk_bf16_f32 v195, v198, v199
buffer_store_dwordx4 v[192:195], v6, s[8:11], s26 offen offset:2048
v_cvt_pk_bf16_f32 v200, v200, v201
v_cvt_pk_bf16_f32 v201, v202, v203
v_cvt_pk_bf16_f32 v202, v204, v205
v_cvt_pk_bf16_f32 v203, v206, v207
buffer_store_dwordx4 v[200:203], v6, s[8:11], s26 offen offset:2560
v_pk_mul_f32 v[224:225], v[224:225], v[26:27] op_sel_hi:[1,0]
v_pk_mul_f32 v[226:227], v[226:227], v[26:27] op_sel_hi:[1,0]
v_pk_mul_f32 v[228:229], v[228:229], v[26:27] op_sel_hi:[1,0]
v_pk_mul_f32 v[230:231], v[230:231], v[26:27] op_sel_hi:[1,0]
v_pk_mul_f32 v[232:233], v[232:233], v[26:27] op_sel_hi:[1,0]
v_pk_mul_f32 v[234:235], v[234:235], v[26:27] op_sel_hi:[1,0]
v_pk_mul_f32 v[236:237], v[236:237], v[26:27] op_sel_hi:[1,0]
v_pk_mul_f32 v[238:239], v[238:239], v[26:27] op_sel_hi:[1,0]
v_cvt_pk_bf16_f32 v224, v224, v225
v_cvt_pk_bf16_f32 v225, v226, v227
v_cvt_pk_bf16_f32 v226, v228, v229
v_cvt_pk_bf16_f32 v227, v230, v231
buffer_store_dwordx4 v[224:227], v6, s[8:11], s26 offen offset:3072
v_cvt_pk_bf16_f32 v232, v232, v233
v_cvt_pk_bf16_f32 v233, v234, v235
v_cvt_pk_bf16_f32 v234, v236, v237
v_cvt_pk_bf16_f32 v235, v238, v239
buffer_store_dwordx4 v[232:235], v6, s[8:11], s26 offen offset:3584
s_lshl_b32 s54, s47, 2
s_add_u32 s54, s54, 111157248
s_mov_b32 s47, s48
s_cmp_lt_u32 s47, 2048
s_cbranch_scc0 L_bt_f
s_waitcnt vmcnt(8)
v_mfma_f32_32x32x16_bf16 v[32:47], a[128:131], a[96:99], 0
v_mfma_f32_32x32x16_bf16 v[32:47], a[132:135], a[100:103], v[32:47]
v_mfma_f32_32x32x16_bf16 v[32:47], a[136:139], a[104:107], v[32:47]
v_mfma_f32_32x32x16_bf16 v[32:47], a[140:143], a[108:111], v[32:47]
v_mfma_f32_32x32x16_bf16 v[32:47], a[144:147], a[112:115], v[32:47]
v_mfma_f32_32x32x16_bf16 v[32:47], a[148:151], a[116:119], v[32:47]
v_mfma_f32_32x32x16_bf16 v[32:47], a[152:155], a[120:123], v[32:47]
v_mfma_f32_32x32x16_bf16 v[32:47], a[156:159], a[124:127], v[32:47]
s_and_b32 s42, s47, 31
s_lshr_b32 s43, s47, 5
s_lshl_b32 s26, s47, 12
s_add_u32 s26, s26, 100663296
s_nop 7
v_cndmask_b32 v32, v31, v32, s[64:65]
v_cndmask_b32 v33, v31, v33, s[66:67]
v_cndmask_b32 v34, v31, v34, s[68:69]
v_cndmask_b32 v35, v31, v35, s[70:71]
v_cndmask_b32 v36, v31, v36, s[72:73]
v_cndmask_b32 v37, v31, v37, s[74:75]
v_cndmask_b32 v38, v31, v38, s[76:77]
v_cndmask_b32 v39, v31, v39, s[78:79]
v_cndmask_b32 v40, v31, v40, s[80:81]
v_cndmask_b32 v41, v31, v41, s[82:83]
v_cndmask_b32 v42, v31, v42, s[84:85]
v_cndmask_b32 v43, v31, v43, s[86:87]
v_cndmask_b32 v44, v31, v44, s[88:89]
v_cndmask_b32 v45, v31, v45, s[90:91]
v_cndmask_b32 v46, v31, v46, s[92:93]
v_cndmask_b32 v47, v31, v47, s[94:95]
v_max3_f32 v20, v32, v33, v34
v_max3_f32 v20, v20, v35, v36
v_max3_f32 v20, v20, v37, v38
v_max3_f32 v20, v20, v39, v40
v_max3_f32 v20, v20, v41, v42
v_max3_f32 v20, v20, v43, v44
v_max3_f32 v20, v20, v45, v46
v_max_f32 v20, v20, v47
s_cmp_lt_u32 s43, s49
s_cbranch_scc1 L_kn_33
v_mov_b32 v26, 1
s_waitcnt vmcnt(0)
s_mov_b64 exec, 1
buffer_store_dword v26, v4, s[8:11], s54 offen
s_mov_b64 exec, -1
L_nb_36:
s_ff1_i32_b64 s48, s[52:53]
s_cmp_lt_u32 s41, 32
s_cbranch_scc1 L_nb_37
s_bitset0_b64 s[52:53], s48
s_sub_u32 s41, s41, 32
s_branch L_nb_36
L_nb_37:
s_lshl_b32 s48, s48, 5
s_add_u32 s48, s48, s41
s_add_u32 s41, s41, 56
s_lshl_b32 s46, s48, 14
s_add_u32 s46, s46, 33554432
s_lshl_b32 s44, s48, 13
s_add_u32 s44, s44, 134217728
s_cmp_ge_u32 s48, 2048
s_cselect_b32 s44, 536870912, s44
s_cselect_b32 s46, 536870912, s46
s_cbranch_scc1 L_nb_35
s_lshr_b32 s25, s48, 8
s_lshl_b32 s25, s25, 2
s_cmp_eq_u32 s25, s45
s_cbranch_scc1 L_nb_35
s_mov_b32 s45, s25
s_mov_b32 s28, 0
L_poll_38:
buffer_load_dword v26, v17, s[8:11], s45 offen sc1
s_add_u32 s28, s28, 1
s_cmp_gt_u32 s28, 40000
s_cbranch_scc1 L_end
s_waitcnt vmcnt(0)
v_cmp_ne_u32 vcc, 1, v26
s_cbranch_vccz L_pd_39
s_sleep 8
s_cmp_lt_u32 s28, 32
s_cbranch_scc1 L_poll_38
s_sleep 32
s_branch L_poll_38
L_pd_39:
L_nb_35:
s_add_u32 s25, s44, 0
buffer_load_dwordx4 a[0:3], v1, s[8:11], s25 offen sc1
buffer_load_dwordx4 a[4:7], v1, s[8:11], s25 offen offset:1024 sc1
buffer_load_dwordx4 a[8:11], v1, s[8:11], s25 offen offset:2048 sc1
buffer_load_dwordx4 a[12:15], v1, s[8:11], s25 offen offset:3072 sc1
s_add_u32 s25, s44, 4096
buffer_load_dwordx4 a[16:19], v1, s[8:11], s25 offen sc1
buffer_load_dwordx4 a[20:23], v1, s[8:11], s25 offen offset:1024 sc1
buffer_load_dwordx4 a[24:27], v1, s[8:11], s25 offen offset:2048 sc1
buffer_load_dwordx4 a[28:31], v1, s[8:11], s25 offen offset:3072 sc1
s_add_u32 s25, s46, 0
buffer_load_dwordx4 a[32:35], v1, s[8:11], s25 offen sc1
buffer_load_dwordx4 a[36:39], v1, s[8:11], s25 offen offset:1024 sc1
buffer_load_dwordx4 a[40:43], v1, s[8:11], s25 offen offset:2048 sc1
buffer_load_dwordx4 a[44:47], v1, s[8:11], s25 offen offset:3072 sc1
s_add_u32 s25, s46, 4096
buffer_load_dwordx4 a[48:51], v1, s[8:11], s25 offen sc1
buffer_load_dwordx4 a[52:55], v1, s[8:11], s25 offen offset:1024 sc1
buffer_load_dwordx4 a[56:59], v1, s[8:11], s25 offen offset:2048 sc1
buffer_load_dwordx4 a[60:63], v1, s[8:11], s25 offen offset:3072 sc1
s_add_u32 s25, s46, 8192
buffer_load_dwordx4 a[64:67], v16, s[8:11], s25 offen sc1
buffer_load_dwordx4 a[68:71], v16, s[8:11], s25 offen offset:1024 sc1
buffer_load_dwordx4 a[72:75], v16, s[8:11], s25 offen offset:2048 sc1
buffer_load_dwordx4 a[76:79], v16, s[8:11], s25 offen offset:3072 sc1
s_add_u32 s25, s46, 12288
buffer_load_dwordx4 a[80:83], v16, s[8:11], s25 offen sc1
buffer_load_dwordx4 a[84:87], v16, s[8:11], s25 offen offset:1024 sc1
buffer_load_dwordx4 a[88:91], v16, s[8:11], s25 offen offset:2048 sc1
buffer_load_dwordx4 a[92:95], v16, s[8:11], s25 offen offset:3072 sc1
s_lshl_b32 s25, s42, 7
s_add_u32 s25, s25, 111153152
s_mov_b32 s28, 0
L_poll_40:
buffer_load_dword v26, v4, s[8:11], s25 offen sc1
s_add_u32 s28, s28, 1
s_cmp_gt_u32 s28, 40000
s_cbranch_scc1 L_end
s_waitcnt vmcnt(0)
v_cmp_ge_u32 vcc, s43, v26
s_cbranch_vccz L_pd_41
s_sleep 1
s_cmp_lt_u32 s28, 32
s_cbranch_scc1 L_poll_40
s_sleep 32
s_branch L_poll_40
L_pd_41:
buffer_load_dwordx4 v[96:99], v2, s[8:11], s26 offen sc1
buffer_load_dwordx4 v[100:103], v2, s[8:11], s26 offen offset:256 sc1
buffer_load_dwordx4 v[104:107], v2, s[8:11], s26 offen offset:512 sc1
buffer_load_dwordx4 v[108:111], v2, s[8:11], s26 offen offset:768 sc1
buffer_load_dwordx4 v[112:115], v2, s[8:11], s26 offen offset:1024 sc1
buffer_load_dwordx4 v[116:119], v2, s[8:11], s26 offen offset:1280 sc1
buffer_load_dwordx4 v[120:123], v2, s[8:11], s26 offen offset:1536 sc1
buffer_load_dwordx4 v[124:127], v2, s[8:11], s26 offen offset:1792 sc1
buffer_load_dword v8, v3, s[8:11], s26 offen offset:2048 sc1
buffer_load_dword v9, v3, s[8:11], s26 offen offset:2112 sc1
buffer_load_dword v10, v3, s[8:11], s26 offen offset:2304 sc1
buffer_load_dword v11, v3, s[8:11], s26 offen offset:2368 sc1
buffer_load_dword v12, v3, s[8:11], s26 offen offset:2560 sc1
buffer_load_dword v13, v3, s[8:11], s26 offen offset:2624 sc1
buffer_load_dword v14, v3, s[8:11], s26 offen offset:2816 sc1
buffer_load_dword v15, v3, s[8:11], s26 offen offset:2880 sc1
v_readfirstlane_b32 s49, v26
s_nop 0
s_min_u32 s49, s49, 63
s_sub_u32 s49, s49, 1
s_waitcnt vmcnt(15)
v_mfma_f32_32x32x16_bf16 v[64:79], v[96:99], a[96:99], 0
s_waitcnt vmcnt(14)
v_mfma_f32_32x32x16_bf16 v[64:79], v[100:103], a[100:103], v[64:79]
s_waitcnt vmcnt(13)
v_mfma_f32_32x32x16_bf16 v[64:79], v[104:107], a[104:107], v[64:79]
s_waitcnt vmcnt(12)
v_mfma_f32_32x32x16_bf16 v[64:79], v[108:111], a[108:111], v[64:79]
s_waitcnt vmcnt(11)
v_mfma_f32_32x32x16_bf16 v[64:79], v[112:115], a[112:115], v[64:79]
s_waitcnt vmcnt(10)
v_mfma_f32_32x32x16_bf16 v[64:79], v[116:119], a[116:119], v[64:79]
s_waitcnt vmcnt(9)
v_mfma_f32_32x32x16_bf16 v[64:79], v[120:123], a[120:123], v[64:79]
s_waitcnt vmcnt(8)
v_mfma_f32_32x32x16_bf16 v[64:79], v[124:127], a[124:127], v[64:79]
s_waitcnt vmcnt(0)
s_branch L_kj_34
L_kn_33:
buffer_load_dwordx4 v[96:99], v2, s[8:11], s26 offen sc1
buffer_load_dwordx4 v[100:103], v2, s[8:11], s26 offen offset:256 sc1
buffer_load_dwordx4 v[104:107], v2, s[8:11], s26 offen offset:512 sc1
buffer_load_dwordx4 v[108:111], v2, s[8:11], s26 offen offset:768 sc1
buffer_load_dwordx4 v[112:115], v2, s[8:11], s26 offen offset:1024 sc1
buffer_load_dwordx4 v[116:119], v2, s[8:11], s26 offen offset:1280 sc1
buffer_load_dwordx4 v[120:123], v2, s[8:11], s26 offen offset:1536 sc1
buffer_load_dwordx4 v[124:127], v2, s[8:11], s26 offen offset:1792 sc1
buffer_load_dword v8, v3, s[8:11], s26 offen offset:2048 sc1
buffer_load_dword v9, v3, s[8:11], s26 offen offset:2112 sc1
buffer_load_dword v10, v3, s[8:11], s26 offen offset:2304 sc1
buffer_load_dword v11, v3, s[8:11], s26 offen offset:2368 sc1
buffer_load_dword v12, v3, s[8:11], s26 offen offset:2560 sc1
buffer_load_dword v13, v3, s[8:11], s26 offen offset:2624 sc1
buffer_load_dword v14, v3, s[8:11], s26 offen offset:2816 sc1
buffer_load_dword v15, v3, s[8:11], s26 offen offset:2880 sc1
v_mov_b32 v26, 1
s_waitcnt vmcnt(16)
s_mov_b64 exec, 1
buffer_store_dword v26, v4, s[8:11], s54 offen
s_mov_b64 exec, -1
L_nb_43:
s_ff1_i32_b64 s48, s[52:53]
s_cmp_lt_u32 s41, 32
s_cbranch_scc1 L_nb_44
s_bitset0_b64 s[52:53], s48
s_sub_u32 s41, s41, 32
s_branch L_nb_43
L_nb_44:
s_lshl_b32 s48, s48, 5
s_add_u32 s48, s48, s41
s_add_u32 s41, s41, 56
s_lshl_b32 s46, s48, 14
s_add_u32 s46, s46, 33554432
s_lshl_b32 s44, s48, 13
s_add_u32 s44, s44, 134217728
s_cmp_ge_u32 s48, 2048
s_cselect_b32 s44, 536870912, s44
s_cselect_b32 s46, 536870912, s46
s_cbranch_scc1 L_nb_42
s_lshr_b32 s25, s48, 8
s_lshl_b32 s25, s25, 2
s_cmp_eq_u32 s25, s45
s_cbranch_scc1 L_nb_42
s_mov_b32 s45, s25
s_mov_b32 s28, 0
L_poll_45:
buffer_load_dword v26, v17, s[8:11], s45 offen sc1
s_add_u32 s28, s28, 1
s_cmp_gt_u32 s28, 40000
s_cbranch_scc1 L_end
s_waitcnt vmcnt(0)
v_cmp_ne_u32 vcc, 1, v26
s_cbranch_vccz L_pd_46
s_sleep 8
s_cmp_lt_u32 s28, 32
s_cbranch_scc1 L_poll_45
s_sleep 32
s_branch L_poll_45
L_pd_46:
L_nb_42:
s_add_u32 s25, s44, 0
buffer_load_dwordx4 a[0:3], v1, s[8:11], s25 offen sc1
buffer_load_dwordx4 a[4:7], v1, s[8:11], s25 offen offset:1024 sc1
buffer_load_dwordx4 a[8:11], v1, s[8:11], s25 offen offset:2048 sc1
buffer_load_dwordx4 a[12:15], v1, s[8:11], s25 offen offset:3072 sc1
s_add_u32 s25, s44, 4096
buffer_load_dwordx4 a[16:19], v1, s[8:11], s25 offen sc1
buffer_load_dwordx4 a[20:23], v1, s[8:11], s25 offen offset:1024 sc1
buffer_load_dwordx4 a[24:27], v1, s[8:11], s25 offen offset:2048 sc1
buffer_load_dwordx4 a[28:31], v1, s[8:11], s25 offen offset:3072 sc1
s_waitcnt vmcnt(24)
v_mfma_f32_32x32x16_bf16 v[64:79], v[96:99], a[96:99], 0
s_add_u32 s25, s46, 0
buffer_load_dwordx4 a[32:35], v1, s[8:11], s25 offen sc1
buffer_load_dwordx4 a[36:39], v1, s[8:11], s25 offen offset:1024 sc1
s_waitcnt vmcnt(25)
v_mfma_f32_32x32x16_bf16 v[64:79], v[100:103], a[100:103], v[64:79]
buffer_load_dwordx4 a[40:43], v1, s[8:11], s25 offen offset:2048 sc1
buffer_load_dwordx4 a[44:47], v1, s[8:11], s25 offen offset:3072 sc1
s_waitcnt vmcnt(26)
v_mfma_f32_32x32x16_bf16 v[64:79], v[104:107], a[104:107], v[64:79]
s_add_u32 s25, s46, 4096
buffer_load_dwordx4 a[48:51], v1, s[8:11], s25 offen sc1
buffer_load_dwordx4 a[52:55], v1, s[8:11], s25 offen offset:1024 sc1
s_waitcnt vmcnt(27)
v_mfma_f32_32x32x16_bf16 v[64:79], v[108:111], a[108:111], v[64:79]
buffer_load_dwordx4 a[56:59], v1, s[8:11], s25 offen offset:2048 sc1
buffer_load_dwordx4 a[60:63], v1, s[8:11], s25 offen offset:3072 sc1
s_waitcnt vmcnt(28)
v_mfma_f32_32x32x16_bf16 v[64:79], v[112:115], a[112:115], v[64:79]
s_add_u32 s25, s46, 8192
buffer_load_dwordx4 a[64:67], v16, s[8:11], s25 offen sc1
buffer_load_dwordx4 a[68:71], v16, s[8:11], s25 offen offset:1024 sc1
s_waitcnt vmcnt(29)
v_mfma_f32_32x32x16_bf16 v[64:79], v[116:119], a[116:119], v[64:79]
buffer_load_dwordx4 a[72:75], v16, s[8:11], s25 offen offset:2048 sc1
buffer_load_dwordx4 a[76:79], v16, s[8:11], s25 offen offset:3072 sc1
s_waitcnt vmcnt(30)
v_mfma_f32_32x32x16_bf16 v[64:79], v[120:123], a[120:123], v[64:79]
s_add_u32 s25, s46, 12288
buffer_load_dwordx4 a[80:83], v16, s[8:11], s25 offen sc1
buffer_load_dwordx4 a[84:87], v16, s[8:11], s25 offen offset:1024 sc1
s_waitcnt vmcnt(31)
v_mfma_f32_32x32x16_bf16 v[64:79], v[124:127], a[124:127], v[64:79]
buffer_load_dwordx4 a[88:91], v16, s[8:11], s25 offen offset:2048 sc1
buffer_load_dwordx4 a[92:95], v16, s[8:11], s25 offen offset:3072 sc1
s_waitcnt vmcnt(25)
L_kj_34:
s_nop 9
v_max3_f32 v20, v20, v64, v65
v_max3_f32 v20, v20, v66, v67
v_mov_b32 v26, v20
s_nop 1
v_permlane32_swap_b32 v26, v20
v_max_f32 v20, v20, v26
v_mul_f32 v20, s40, v20
v_pk_fma_f32 v[64:65], v[64:65], s[40:41], v[20:21] op_sel_hi:[1,0,0] neg_lo:[0,0,1] neg_hi:[0,0,1]
v_pk_fma_f32 v[66:67], v[66:67], s[40:41], v[20:21] op_sel_hi:[1,0,0] neg_lo:[0,0,1] neg_hi:[0,0,1]
v_pk_fma_f32 v[32:33], v[32:33], s[40:41], v[20:21] op_sel_hi:[1,0,0] neg_lo:[0,0,1] neg_hi:[0,0,1]
v_pk_fma_f32 v[34:35], v[34:35], s[40:41], v[20:21] op_sel_hi:[1,0,0] neg_lo:[0,0,1] neg_hi:[0,0,1]
v_pk_fma_f32 v[36:37], v[36:37], s[40:41], v[20:21] op_sel_hi:[1,0,0] neg_lo:[0,0,1] neg_hi:[0,0,1]
v_pk_fma_f32 v[38:39], v[38:39], s[40:41], v[20:21] op_sel_hi:[1,0,0] neg_lo:[0,0,1] neg_hi:[0,0,1]
v_pk_fma_f32 v[40:41], v[40:41], s[40:41], v[20:21] op_sel_hi:[1,0,0] neg_lo:[0,0,1] neg_hi:[0,0,1]
v_pk_fma_f32 v[42:43], v[42:43], s[40:41], v[20:21] op_sel_hi:[1,0,0] neg_lo:[0,0,1] neg_hi:[0,0,1]
v_pk_fma_f32 v[44:45], v[44:45], s[40:41], v[20:21] op_sel_hi:[1,0,0] neg_lo:[0,0,1] neg_hi:[0,0,1]
v_pk_fma_f32 v[46:47], v[46:47], s[40:41], v[20:21] op_sel_hi:[1,0,0] neg_lo:[0,0,1] neg_hi:[0,0,1]
v_exp_f32 v64, v64
v_exp_f32 v65, v65
v_exp_f32 v66, v66
v_exp_f32 v67, v67
v_exp_f32 v32, v32
v_exp_f32 v33, v33
v_cvt_pk_bf16_f32 v88, v64, v65
v_cvt_pk_bf16_f32 v89, v66, v67
s_nop 1
v_mfma_f32_32x32x8_bf16 v[128:143], v[8:9], v[88:89], 0
v_exp_f32 v34, v34
v_exp_f32 v35, v35
v_exp_f32 v36, v36
v_mfma_f32_32x32x8_bf16 v[160:175], v[10:11], v[88:89], 0
v_exp_f32 v37, v37
v_exp_f32 v38, v38
v_mfma_f32_32x32x8_bf16 v[192:207], v[12:13], v[88:89], 0
v_exp_f32 v39, v39
v_exp_f32 v40, v40
v_exp_f32 v41, v41
v_mfma_f32_32x32x8_bf16 v[224:239], v[14:15], v[88:89], 0
v_cvt_pk_bf16_f32 v80, v32, v33
v_cvt_pk_bf16_f32 v81, v34, v35
v_cvt_pk_bf16_f32 v82, v36, v37
v_cvt_pk_bf16_f32 v83, v38, v39
s_nop 1
v_mfma_f32_32x32x16_bf16 v[128:143], a[160:163], v[80:83], v[128:143]
v_exp_f32 v42, v42
v_exp_f32 v43, v43
v_exp_f32 v44, v44
v_mfma_f32_32x32x16_bf16 v[160:175], a[168:171], v[80:83], v[160:175]
v_exp_f32 v45, v45
v_exp_f32 v46, v46
v_mfma_f32_32x32x16_bf16 v[192:207], a[176:179], v[80:83], v[192:207]
v_exp_f32 v47, v47
v_add_f32 v22, v64, v65
v_add_f32 v22, v22, v66
v_add_f32 v22, v22, v67
v_add_f32 v22, v22, v32
v_mfma_f32_32x32x16_bf16 v[224:239], a[184:187], v[80:83], v[224:239]
v_add_f32 v22, v22, v33
v_cvt_pk_bf16_f32 v84, v40, v41
v_cvt_pk_bf16_f32 v85, v42, v43
v_cvt_pk_bf16_f32 v86, v44, v45
v_cvt_pk_bf16_f32 v87, v46, v47
s_nop 1
v_mfma_f32_32x32x16_bf16 v[128:143], a[164:167], v[84:87], v[128:143]
v_add_f32 v22, v22, v34
v_add_f32 v22, v22, v35
v_add_f32 v22, v22, v36
v_add_f32 v22, v22, v37
v_add_f32 v22, v22, v38
v_mfma_f32_32x32x16_bf16 v[160:175], a[172:175], v[84:87], v[160:175]
v_add_f32 v22, v22, v39
v_add_f32 v22, v22, v40
v_add_f32 v22, v22, v41
v_add_f32 v22, v22, v42
v_mfma_f32_32x32x16_bf16 v[192:207], a[180:183], v[84:87], v[192:207]
v_add_f32 v22, v22, v43
v_add_f32 v22, v22, v44
v_add_f32 v22, v22, v45
v_add_f32 v22, v22, v46
v_add_f32 v22, v22, v47
v_mfma_f32_32x32x16_bf16 v[224:239], a[188:191], v[84:87], v[224:239]
s_lshl_b32 s26, s43, 18
s_lshl_b32 s27, s42, 12
s_add_u32 s26, s26, s27
s_add_u32 s26, s26, 83886080
v_mov_b32 v26, v22
s_nop 1
v_permlane32_swap_b32 v26, v22
v_add_f32 v26, v26, v22
v_rcp_f32 v26, v26
s_nop 0
v_pk_mul_f32 v[128:129], v[128:129], v[26:27] op_sel_hi:[1,0]
v_pk_mul_f32 v[130:131], v[130:131], v[26:27] op_sel_hi:[1,0]
v_pk_mul_f32 v[132:133], v[132:133], v[26:27] op_sel_hi:[1,0]
v_pk_mul_f32 v[134:135], v[134:135], v[26:27] op_sel_hi:[1,0]
v_pk_mul_f32 v[136:137], v[136:137], v[26:27] op_sel_hi:[1,0]
v_pk_mul_f32 v[138:139], v[138:139], v[26:27] op_sel_hi:[1,0]
v_pk_mul_f32 v[140:141], v[140:141], v[26:27] op_sel_hi:[1,0]
v_pk_mul_f32 v[142:143], v[142:143], v[26:27] op_sel_hi:[1,0]
v_cvt_pk_bf16_f32 v128, v128, v129
v_cvt_pk_bf16_f32 v129, v130, v131
v_cvt_pk_bf16_f32 v130, v132, v133
v_cvt_pk_bf16_f32 v131, v134, v135
buffer_store_dwordx4 v[128:131], v6, s[8:11], s26 offen
v_cvt_pk_bf16_f32 v136, v136, v137
v_cvt_pk_bf16_f32 v137, v138, v139
v_cvt_pk_bf16_f32 v138, v140, v141
v_cvt_pk_bf16_f32 v139, v142, v143
buffer_store_dwordx4 v[136:139], v6, s[8:11], s26 offen offset:512
v_pk_mul_f32 v[160:161], v[160:161], v[26:27] op_sel_hi:[1,0]
v_pk_mul_f32 v[162:163], v[162:163], v[26:27] op_sel_hi:[1,0]
v_pk_mul_f32 v[164:165], v[164:165], v[26:27] op_sel_hi:[1,0]
v_pk_mul_f32 v[166:167], v[166:167], v[26:27] op_sel_hi:[1,0]
v_pk_mul_f32 v[168:169], v[168:169], v[26:27] op_sel_hi:[1,0]
v_pk_mul_f32 v[170:171], v[170:171], v[26:27] op_sel_hi:[1,0]
v_pk_mul_f32 v[172:173], v[172:173], v[26:27] op_sel_hi:[1,0]
v_pk_mul_f32 v[174:175], v[174:175], v[26:27] op_sel_hi:[1,0]
v_cvt_pk_bf16_f32 v160, v160, v161
v_cvt_pk_bf16_f32 v161, v162, v163
v_cvt_pk_bf16_f32 v162, v164, v165
v_cvt_pk_bf16_f32 v163, v166, v167
buffer_store_dwordx4 v[160:163], v6, s[8:11], s26 offen offset:1024
v_cvt_pk_bf16_f32 v168, v168, v169
v_cvt_pk_bf16_f32 v169, v170, v171
v_cvt_pk_bf16_f32 v170, v172, v173
v_cvt_pk_bf16_f32 v171, v174, v175
buffer_store_dwordx4 v[168:171], v6, s[8:11], s26 offen offset:1536
v_pk_mul_f32 v[192:193], v[192:193], v[26:27] op_sel_hi:[1,0]
v_pk_mul_f32 v[194:195], v[194:195], v[26:27] op_sel_hi:[1,0]
v_pk_mul_f32 v[196:197], v[196:197], v[26:27] op_sel_hi:[1,0]
v_pk_mul_f32 v[198:199], v[198:199], v[26:27] op_sel_hi:[1,0]
v_pk_mul_f32 v[200:201], v[200:201], v[26:27] op_sel_hi:[1,0]
v_pk_mul_f32 v[202:203], v[202:203], v[26:27] op_sel_hi:[1,0]
v_pk_mul_f32 v[204:205], v[204:205], v[26:27] op_sel_hi:[1,0]
v_pk_mul_f32 v[206:207], v[206:207], v[26:27] op_sel_hi:[1,0]
v_cvt_pk_bf16_f32 v192, v192, v193
v_cvt_pk_bf16_f32 v193, v194, v195
v_cvt_pk_bf16_f32 v194, v196, v197
v_cvt_pk_bf16_f32 v195, v198, v199
buffer_store_dwordx4 v[192:195], v6, s[8:11], s26 offen offset:2048
v_cvt_pk_bf16_f32 v200, v200, v201
v_cvt_pk_bf16_f32 v201, v202, v203
v_cvt_pk_bf16_f32 v202, v204, v205
v_cvt_pk_bf16_f32 v203, v206, v207
buffer_store_dwordx4 v[200:203], v6, s[8:11], s26 offen offset:2560
v_pk_mul_f32 v[224:225], v[224:225], v[26:27] op_sel_hi:[1,0]
v_pk_mul_f32 v[226:227], v[226:227], v[26:27] op_sel_hi:[1,0]
v_pk_mul_f32 v[228:229], v[228:229], v[26:27] op_sel_hi:[1,0]
v_pk_mul_f32 v[230:231], v[230:231], v[26:27] op_sel_hi:[1,0]
v_pk_mul_f32 v[232:233], v[232:233], v[26:27] op_sel_hi:[1,0]
v_pk_mul_f32 v[234:235], v[234:235], v[26:27] op_sel_hi:[1,0]
v_pk_mul_f32 v[236:237], v[236:237], v[26:27] op_sel_hi:[1,0]
v_pk_mul_f32 v[238:239], v[238:239], v[26:27] op_sel_hi:[1,0]
v_cvt_pk_bf16_f32 v224, v224, v225
v_cvt_pk_bf16_f32 v225, v226, v227
v_cvt_pk_bf16_f32 v226, v228, v229
v_cvt_pk_bf16_f32 v227, v230, v231
buffer_store_dwordx4 v[224:227], v6, s[8:11], s26 offen offset:3072
v_cvt_pk_bf16_f32 v232, v232, v233
v_cvt_pk_bf16_f32 v233, v234, v235
v_cvt_pk_bf16_f32 v234, v236, v237
v_cvt_pk_bf16_f32 v235, v238, v239
buffer_store_dwordx4 v[232:235], v6, s[8:11], s26 offen offset:3584
s_lshl_b32 s54, s47, 2
s_add_u32 s54, s54, 111157248
s_mov_b32 s47, s48
s_cmp_lt_u32 s47, 2048
s_cbranch_scc1 L_bt
L_bt_f:
v_mov_b32 v26, 1
s_waitcnt vmcnt(0)
s_mov_b64 exec, 1
buffer_store_dword v26, v4, s[8:11], s54 offen
s_mov_b64 exec, -1
L_bt_x:
s_branch L_done
L_bo:
s_mov_b64 s[42:43], s[4:5]
s_mov_b32 s51, s27
s_mov_b32 s40, s26
s_mov_b32 s44, 83886080
s_mov_b32 s45, 111157248
s_mov_b32 s46, 1
s_mov_b32 s47, 1152
s_load_dwordx2 s[4:5], s[0:1], 88
s_waitcnt lgkmcnt(0)
s_mov_b32 s20, s4
s_and_b32 s21, s5, 0xffff
s_mov_b32 s22, 4718592
s_mov_b32 s23, 0x20000
L_op:
s_load_dwordx2 s[4:5], s[0:1], 104
s_waitcnt lgkmcnt(0)
s_mov_b32 s12, s4
s_and_b32 s13, s5, 0xffff
s_mov_b32 s14, 4718592
s_mov_b32 s15, 0x20000
v_and_b32 v1, 63, v0
v_lshlrev_b32 v1, 4, v1
v_bfe_u32 v12, v0, 3, 3
v_mul_u32_u24 v12, 1152, v12
v_bfe_u32 v13, v0, 4, 2
v_lshlrev_b32 v13, 1, v13
v_and_b32 v14, 7, v0
v_xor_b32 v13, v13, v14
v_lshl_add_u32 v12, v13, 4, v12
s_mul_i32 s24, s17, 1179648
s_lshl_b32 s25, s40, 7
s_add_u32 s24, s24, s25
v_add_u32 v2, s24, v12
s_lshl_b32 s26, s17, 15
v_bfe_u32 v12, v0, 2, 3
v_lshlrev_b32 v12, 7, v12
v_bfe_u32 v13, v0, 5, 1
v_lshl_add_u32 v12, v13, 11, v12
v_bfe_u32 v13, v0, 3, 2
v_lshl_add_u32 v12, v13, 5, v12
v_and_b32 v13, 3, v0
v_lshl_add_u32 v12, v13, 3, v12
v_add_u32 v8, s26, v12
v_xor_b32 v9, 32, v8
v_xor_b32 v10, 64, v8
v_xor_b32 v11, 96, v8
s_add_u32 s24, s40, 0
s_and_b32 s24, s24, 7
s_lshl_b32 s30, s24, 12
s_add_u32 s24, s40, 1
s_and_b32 s24, s24, 7
s_lshl_b32 s31, s24, 12
s_add_u32 s24, s40, 2
s_and_b32 s24, s24, 7
s_lshl_b32 s32, s24, 12
s_add_u32 s24, s40, 3
s_and_b32 s24, s24, 7
s_lshl_b32 s33, s24, 12
s_add_u32 s24, s40, 4
s_and_b32 s24, s24, 7
s_lshl_b32 s34, s24, 12
s_add_u32 s24, s40, 5
s_and_b32 s24, s24, 7
s_lshl_b32 s35, s24, 12
s_add_u32 s24, s40, 6
s_and_b32 s24, s24, 7
s_lshl_b32 s36, s24, 12
s_add_u32 s24, s40, 7
s_and_b32 s24, s24, 7
s_lshl_b32 s37, s24, 12
s_mul_i32 s25, s30, 36
s_add_u32 m0, s26, 0
s_add_u32 s24, s25, 0
buffer_load_dwordx4 v2, s[20:23], s24 offen lds
s_add_u32 m0, s26, 1024
s_add_u32 s24, s25, 9216
buffer_load_dwordx4 v2, s[20:23], s24 offen lds
s_add_u32 m0, s26, 2048
s_add_u32 s24, s25, 18432
buffer_load_dwordx4 v2, s[20:23], s24 offen lds
s_add_u32 m0, s26, 3072
s_add_u32 s24, s25, 27648
buffer_load_dwordx4 v2, s[20:23], s24 offen lds
s_mul_i32 s25, s30, 36
s_add_u32 m0, s26, 4096
s_add_u32 s24, s25, 36864
buffer_load_dwordx4 v2, s[20:23], s24 offen lds
s_add_u32 m0, s26, 5120
s_add_u32 s24, s25, 46080
buffer_load_dwordx4 v2, s[20:23], s24 offen lds
s_add_u32 m0, s26, 6144
s_add_u32 s24, s25, 55296
buffer_load_dwordx4 v2, s[20:23], s24 offen lds
s_add_u32 m0, s26, 7168
s_add_u32 s24, s25, 64512
buffer_load_dwordx4 v2, s[20:23], s24 offen lds
s_mul_i32 s25, s30, 36
s_add_u32 m0, s26, 8192
s_add_u32 s24, s25, 73728
buffer_load_dwordx4 v2, s[20:23], s24 offen lds
s_add_u32 m0, s26, 9216
s_add_u32 s24, s25, 82944
buffer_load_dwordx4 v2, s[20:23], s24 offen lds
s_add_u32 m0, s26, 10240
s_add_u32 s24, s25, 92160
buffer_load_dwordx4 v2, s[20:23], s24 offen lds
s_add_u32 m0, s26, 11264
s_add_u32 s24, s25, 101376
buffer_load_dwordx4 v2, s[20:23], s24 offen lds
s_mul_i32 s25, s31, 36
s_add_u32 m0, s26, 12288
s_add_u32 s24, s25, 0
buffer_load_dwordx4 v2, s[20:23], s24 offen lds
s_add_u32 m0, s26, 13312
s_add_u32 s24, s25, 9216
buffer_load_dwordx4 v2, s[20:23], s24 offen lds
s_add_u32 m0, s26, 14336
s_add_u32 s24, s25, 18432
buffer_load_dwordx4 v2, s[20:23], s24 offen lds
s_add_u32 m0, s26, 15360
s_add_u32 s24, s25, 27648
buffer_load_dwordx4 v2, s[20:23], s24 offen lds
s_mul_i32 s25, s31, 36
s_add_u32 m0, s26, 16384
s_add_u32 s24, s25, 36864
buffer_load_dwordx4 v2, s[20:23], s24 offen lds
s_add_u32 m0, s26, 17408
s_add_u32 s24, s25, 46080
buffer_load_dwordx4 v2, s[20:23], s24 offen lds
s_add_u32 m0, s26, 18432
s_add_u32 s24, s25, 55296
buffer_load_dwordx4 v2, s[20:23], s24 offen lds
s_add_u32 m0, s26, 19456
s_add_u32 s24, s25, 64512
buffer_load_dwordx4 v2, s[20:23], s24 offen lds
s_mul_i32 s25, s31, 36
s_add_u32 m0, s26, 20480
s_add_u32 s24, s25, 73728
buffer_load_dwordx4 v2, s[20:23], s24 offen lds
s_add_u32 m0, s26, 21504
s_add_u32 s24, s25, 82944
buffer_load_dwordx4 v2, s[20:23], s24 offen lds
s_add_u32 m0, s26, 22528
s_add_u32 s24, s25, 92160
buffer_load_dwordx4 v2, s[20:23], s24 offen lds
s_add_u32 m0, s26, 23552
s_add_u32 s24, s25, 101376
buffer_load_dwordx4 v2, s[20:23], s24 offen lds
s_mul_i32 s25, s32, 36
s_add_u32 m0, s26, 24576
s_add_u32 s24, s25, 0
buffer_load_dwordx4 v2, s[20:23], s24 offen lds
s_add_u32 m0, s26, 25600
s_add_u32 s24, s25, 9216
buffer_load_dwordx4 v2, s[20:23], s24 offen lds
s_add_u32 m0, s26, 26624
s_add_u32 s24, s25, 18432
buffer_load_dwordx4 v2, s[20:23], s24 offen lds
s_add_u32 m0, s26, 27648
s_add_u32 s24, s25, 27648
buffer_load_dwordx4 v2, s[20:23], s24 offen lds
s_mul_i32 s25, s32, 36
s_add_u32 m0, s26, 28672
s_add_u32 s24, s25, 36864
buffer_load_dwordx4 v2, s[20:23], s24 offen lds
s_add_u32 m0, s26, 29696
s_add_u32 s24, s25, 46080
buffer_load_dwordx4 v2, s[20:23], s24 offen lds
s_add_u32 m0, s26, 30720
s_add_u32 s24, s25, 55296
buffer_load_dwordx4 v2, s[20:23], s24 offen lds
s_add_u32 m0, s26, 31744
s_add_u32 s24, s25, 64512
buffer_load_dwordx4 v2, s[20:23], s24 offen lds
s_waitcnt vmcnt(28)
ds_read_b64_tr_b16 v[128:129], v8
ds_read_b64_tr_b16 v[130:131], v8 offset:1024
ds_read_b64_tr_b16 v[132:133], v9
ds_read_b64_tr_b16 v[134:135], v9 offset:1024
ds_read_b64_tr_b16 v[136:137], v10
ds_read_b64_tr_b16 v[138:139], v10 offset:1024
ds_read_b64_tr_b16 v[140:141], v11
ds_read_b64_tr_b16 v[142:143], v11 offset:1024
s_waitcnt lgkmcnt(0)
s_mul_i32 s25, s32, 36
s_add_u32 m0, s26, 0
s_add_u32 s24, s25, 73728
buffer_load_dwordx4 v2, s[20:23], s24 offen lds
s_add_u32 m0, s26, 1024
s_add_u32 s24, s25, 82944
buffer_load_dwordx4 v2, s[20:23], s24 offen lds
s_add_u32 m0, s26, 2048
s_add_u32 s24, s25, 92160
buffer_load_dwordx4 v2, s[20:23], s24 offen lds
s_add_u32 m0, s26, 3072
s_add_u32 s24, s25, 101376
buffer_load_dwordx4 v2, s[20:23], s24 offen lds
s_waitcnt vmcnt(28)
ds_read_b64_tr_b16 v[144:145], v8 offset:4096
ds_read_b64_tr_b16 v[146:147], v8 offset:5120
ds_read_b64_tr_b16 v[148:149], v9 offset:4096
ds_read_b64_tr_b16 v[150:151], v9 offset:5120
ds_read_b64_tr_b16 v[152:153], v10 offset:4096
ds_read_b64_tr_b16 v[154:155], v10 offset:5120
ds_read_b64_tr_b16 v[156:157], v11 offset:4096
ds_read_b64_tr_b16 v[158:159], v11 offset:5120
s_waitcnt lgkmcnt(0)
s_mul_i32 s25, s33, 36
s_add_u32 m0, s26, 4096
s_add_u32 s24, s25, 0
buffer_load_dwordx4 v2, s[20:23], s24 offen lds
s_add_u32 m0, s26, 5120
s_add_u32 s24, s25, 9216
buffer_load_dwordx4 v2, s[20:23], s24 offen lds
s_add_u32 m0, s26, 6144
s_add_u32 s24, s25, 18432
buffer_load_dwordx4 v2, s[20:23], s24 offen lds
s_add_u32 m0, s26, 7168
s_add_u32 s24, s25, 27648
buffer_load_dwordx4 v2, s[20:23], s24 offen lds
s_waitcnt vmcnt(28)
ds_read_b64_tr_b16 v[160:161], v8 offset:8192
ds_read_b64_tr_b16 v[162:163], v8 offset:9216
ds_read_b64_tr_b16 v[164:165], v9 offset:8192
ds_read_b64_tr_b16 v[166:167], v9 offset:9216
ds_read_b64_tr_b16 v[168:169], v10 offset:8192
ds_read_b64_tr_b16 v[170:171], v10 offset:9216
ds_read_b64_tr_b16 v[172:173], v11 offset:8192
ds_read_b64_tr_b16 v[174:175], v11 offset:9216
s_waitcnt lgkmcnt(0)
s_mul_i32 s25, s33, 36
s_add_u32 m0, s26, 8192
s_add_u32 s24, s25, 36864
buffer_load_dwordx4 v2, s[20:23], s24 offen lds
s_add_u32 m0, s26, 9216
s_add_u32 s24, s25, 46080
buffer_load_dwordx4 v2, s[20:23], s24 offen lds
s_add_u32 m0, s26, 10240
s_add_u32 s24, s25, 55296
buffer_load_dwordx4 v2, s[20:23], s24 offen lds
s_add_u32 m0, s26, 11264
s_add_u32 s24, s25, 64512
buffer_load_dwordx4 v2, s[20:23], s24 offen lds
s_waitcnt vmcnt(28)
ds_read_b64_tr_b16 v[176:177], v8 offset:12288
ds_read_b64_tr_b16 v[178:179], v8 offset:13312
ds_read_b64_tr_b16 v[180:181], v9 offset:12288
ds_read_b64_tr_b16 v[182:183], v9 offset:13312
ds_read_b64_tr_b16 v[184:185], v10 offset:12288
ds_read_b64_tr_b16 v[186:187], v10 offset:13312
ds_read_b64_tr_b16 v[188:189], v11 offset:12288
ds_read_b64_tr_b16 v[190:191], v11 offset:13312
s_waitcnt lgkmcnt(0)
s_mul_i32 s25, s33, 36
s_add_u32 m0, s26, 12288
s_add_u32 s24, s25, 73728
buffer_load_dwordx4 v2, s[20:23], s24 offen lds
s_add_u32 m0, s26, 13312
s_add_u32 s24, s25, 82944
buffer_load_dwordx4 v2, s[20:23], s24 offen lds
s_add_u32 m0, s26, 14336
s_add_u32 s24, s25, 92160
buffer_load_dwordx4 v2, s[20:23], s24 offen lds
s_add_u32 m0, s26, 15360
s_add_u32 s24, s25, 101376
buffer_load_dwordx4 v2, s[20:23], s24 offen lds
s_waitcnt vmcnt(28)
ds_read_b64_tr_b16 v[192:193], v8 offset:16384
ds_read_b64_tr_b16 v[194:195], v8 offset:17408
ds_read_b64_tr_b16 v[196:197], v9 offset:16384
ds_read_b64_tr_b16 v[198:199], v9 offset:17408
ds_read_b64_tr_b16 v[200:201], v10 offset:16384
ds_read_b64_tr_b16 v[202:203], v10 offset:17408
ds_read_b64_tr_b16 v[204:205], v11 offset:16384
ds_read_b64_tr_b16 v[206:207], v11 offset:17408
s_waitcnt lgkmcnt(0)
s_mul_i32 s25, s34, 36
s_add_u32 m0, s26, 16384
s_add_u32 s24, s25, 0
buffer_load_dwordx4 v2, s[20:23], s24 offen lds
s_add_u32 m0, s26, 17408
s_add_u32 s24, s25, 9216
buffer_load_dwordx4 v2, s[20:23], s24 offen lds
s_add_u32 m0, s26, 18432
s_add_u32 s24, s25, 18432
buffer_load_dwordx4 v2, s[20:23], s24 offen lds
s_add_u32 m0, s26, 19456
s_add_u32 s24, s25, 27648
buffer_load_dwordx4 v2, s[20:23], s24 offen lds
s_waitcnt vmcnt(28)
ds_read_b64_tr_b16 v[208:209], v8 offset:20480
ds_read_b64_tr_b16 v[210:211], v8 offset:21504
ds_read_b64_tr_b16 v[212:213], v9 offset:20480
ds_read_b64_tr_b16 v[214:215], v9 offset:21504
ds_read_b64_tr_b16 v[216:217], v10 offset:20480
ds_read_b64_tr_b16 v[218:219], v10 offset:21504
ds_read_b64_tr_b16 v[220:221], v11 offset:20480
ds_read_b64_tr_b16 v[222:223], v11 offset:21504
s_waitcnt lgkmcnt(0)
s_mul_i32 s25, s34, 36
s_add_u32 m0, s26, 20480
s_add_u32 s24, s25, 36864
buffer_load_dwordx4 v2, s[20:23], s24 offen lds
s_add_u32 m0, s26, 21504
s_add_u32 s24, s25, 46080
buffer_load_dwordx4 v2, s[20:23], s24 offen lds
s_add_u32 m0, s26, 22528
s_add_u32 s24, s25, 55296
buffer_load_dwordx4 v2, s[20:23], s24 offen lds
s_add_u32 m0, s26, 23552
s_add_u32 s24, s25, 64512
buffer_load_dwordx4 v2, s[20:23], s24 offen lds
s_waitcnt vmcnt(28)
ds_read_b64_tr_b16 v[224:225], v8 offset:24576
ds_read_b64_tr_b16 v[226:227], v8 offset:25600
ds_read_b64_tr_b16 v[228:229], v9 offset:24576
ds_read_b64_tr_b16 v[230:231], v9 offset:25600
ds_read_b64_tr_b16 v[232:233], v10 offset:24576
ds_read_b64_tr_b16 v[234:235], v10 offset:25600
ds_read_b64_tr_b16 v[236:237], v11 offset:24576
ds_read_b64_tr_b16 v[238:239], v11 offset:25600
s_waitcnt lgkmcnt(0)
s_mul_i32 s25, s34, 36
s_add_u32 m0, s26, 24576
s_add_u32 s24, s25, 73728
buffer_load_dwordx4 v2, s[20:23], s24 offen lds
s_add_u32 m0, s26, 25600
s_add_u32 s24, s25, 82944
buffer_load_dwordx4 v2, s[20:23], s24 offen lds
s_add_u32 m0, s26, 26624
s_add_u32 s24, s25, 92160
buffer_load_dwordx4 v2, s[20:23], s24 offen lds
s_add_u32 m0, s26, 27648
s_add_u32 s24, s25, 101376
buffer_load_dwordx4 v2, s[20:23], s24 offen lds
s_waitcnt vmcnt(28)
ds_read_b64_tr_b16 v[240:241], v8 offset:28672
ds_read_b64_tr_b16 v[242:243], v8 offset:29696
ds_read_b64_tr_b16 v[244:245], v9 offset:28672
ds_read_b64_tr_b16 v[246:247], v9 offset:29696
ds_read_b64_tr_b16 v[248:249], v10 offset:28672
ds_read_b64_tr_b16 v[250:251], v10 offset:29696
ds_read_b64_tr_b16 v[252:253], v11 offset:28672
ds_read_b64_tr_b16 v[254:255], v11 offset:29696
s_waitcnt lgkmcnt(0)
s_mul_i32 s25, s35, 36
s_add_u32 m0, s26, 28672
s_add_u32 s24, s25, 0
buffer_load_dwordx4 v2, s[20:23], s24 offen lds
s_add_u32 m0, s26, 29696
s_add_u32 s24, s25, 9216
buffer_load_dwordx4 v2, s[20:23], s24 offen lds
s_add_u32 m0, s26, 30720
s_add_u32 s24, s25, 18432
buffer_load_dwordx4 v2, s[20:23], s24 offen lds
s_add_u32 m0, s26, 31744
s_add_u32 s24, s25, 27648
buffer_load_dwordx4 v2, s[20:23], s24 offen lds
s_waitcnt vmcnt(28)
ds_read_b64_tr_b16 a[0:1], v8
ds_read_b64_tr_b16 a[2:3], v8 offset:1024
ds_read_b64_tr_b16 a[4:5], v9
ds_read_b64_tr_b16 a[6:7], v9 offset:1024
ds_read_b64_tr_b16 a[8:9], v10
ds_read_b64_tr_b16 a[10:11], v10 offset:1024
ds_read_b64_tr_b16 a[12:13], v11
ds_read_b64_tr_b16 a[14:15], v11 offset:1024
s_waitcnt lgkmcnt(0)
s_mul_i32 s25, s35, 36
s_add_u32 m0, s26, 0
s_add_u32 s24, s25, 36864
buffer_load_dwordx4 v2, s[20:23], s24 offen lds
s_add_u32 m0, s26, 1024
s_add_u32 s24, s25, 46080
buffer_load_dwordx4 v2, s[20:23], s24 offen lds
s_add_u32 m0, s26, 2048
s_add_u32 s24, s25, 55296
buffer_load_dwordx4 v2, s[20:23], s24 offen lds
s_add_u32 m0, s26, 3072
s_add_u32 s24, s25, 64512
buffer_load_dwordx4 v2, s[20:23], s24 offen lds
s_waitcnt vmcnt(28)
ds_read_b64_tr_b16 a[16:17], v8 offset:4096
ds_read_b64_tr_b16 a[18:19], v8 offset:5120
ds_read_b64_tr_b16 a[20:21], v9 offset:4096
ds_read_b64_tr_b16 a[22:23], v9 offset:5120
ds_read_b64_tr_b16 a[24:25], v10 offset:4096
ds_read_b64_tr_b16 a[26:27], v10 offset:5120
ds_read_b64_tr_b16 a[28:29], v11 offset:4096
ds_read_b64_tr_b16 a[30:31], v11 offset:5120
s_waitcnt lgkmcnt(0)
s_mul_i32 s25, s35, 36
s_add_u32 m0, s26, 4096
s_add_u32 s24, s25, 73728
buffer_load_dwordx4 v2, s[20:23], s24 offen lds
s_add_u32 m0, s26, 5120
s_add_u32 s24, s25, 82944
buffer_load_dwordx4 v2, s[20:23], s24 offen lds
s_add_u32 m0, s26, 6144
s_add_u32 s24, s25, 92160
buffer_load_dwordx4 v2, s[20:23], s24 offen lds
s_add_u32 m0, s26, 7168
s_add_u32 s24, s25, 101376
buffer_load_dwordx4 v2, s[20:23], s24 offen lds
s_waitcnt vmcnt(28)
ds_read_b64_tr_b16 a[32:33], v8 offset:8192
ds_read_b64_tr_b16 a[34:35], v8 offset:9216
ds_read_b64_tr_b16 a[36:37], v9 offset:8192
ds_read_b64_tr_b16 a[38:39], v9 offset:9216
ds_read_b64_tr_b16 a[40:41], v10 offset:8192
ds_read_b64_tr_b16 a[42:43], v10 offset:9216
ds_read_b64_tr_b16 a[44:45], v11 offset:8192
ds_read_b64_tr_b16 a[46:47], v11 offset:9216
s_waitcnt lgkmcnt(0)
s_mul_i32 s25, s36, 36
s_add_u32 m0, s26, 8192
s_add_u32 s24, s25, 0
buffer_load_dwordx4 v2, s[20:23], s24 offen lds
s_add_u32 m0, s26, 9216
s_add_u32 s24, s25, 9216
buffer_load_dwordx4 v2, s[20:23], s24 offen lds
s_add_u32 m0, s26, 10240
s_add_u32 s24, s25, 18432
buffer_load_dwordx4 v2, s[20:23], s24 offen lds
s_add_u32 m0, s26, 11264
s_add_u32 s24, s25, 27648
buffer_load_dwordx4 v2, s[20:23], s24 offen lds
s_waitcnt vmcnt(28)
ds_read_b64_tr_b16 a[48:49], v8 offset:12288
ds_read_b64_tr_b16 a[50:51], v8 offset:13312
ds_read_b64_tr_b16 a[52:53], v9 offset:12288
ds_read_b64_tr_b16 a[54:55], v9 offset:13312
ds_read_b64_tr_b16 a[56:57], v10 offset:12288
ds_read_b64_tr_b16 a[58:59], v10 offset:13312
ds_read_b64_tr_b16 a[60:61], v11 offset:12288
ds_read_b64_tr_b16 a[62:63], v11 offset:13312
s_waitcnt lgkmcnt(0)
s_mul_i32 s25, s36, 36
s_add_u32 m0, s26, 12288
s_add_u32 s24, s25, 36864
buffer_load_dwordx4 v2, s[20:23], s24 offen lds
s_add_u32 m0, s26, 13312
s_add_u32 s24, s25, 46080
buffer_load_dwordx4 v2, s[20:23], s24 offen lds
s_add_u32 m0, s26, 14336
s_add_u32 s24, s25, 55296
buffer_load_dwordx4 v2, s[20:23], s24 offen lds
s_add_u32 m0, s26, 15360
s_add_u32 s24, s25, 64512
buffer_load_dwordx4 v2, s[20:23], s24 offen lds
s_waitcnt vmcnt(28)
ds_read_b64_tr_b16 a[64:65], v8 offset:16384
ds_read_b64_tr_b16 a[66:67], v8 offset:17408
ds_read_b64_tr_b16 a[68:69], v9 offset:16384
ds_read_b64_tr_b16 a[70:71], v9 offset:17408
ds_read_b64_tr_b16 a[72:73], v10 offset:16384
ds_read_b64_tr_b16 a[74:75], v10 offset:17408
ds_read_b64_tr_b16 a[76:77], v11 offset:16384
ds_read_b64_tr_b16 a[78:79], v11 offset:17408
s_waitcnt lgkmcnt(0)
s_mul_i32 s25, s36, 36
s_add_u32 m0, s26, 16384
s_add_u32 s24, s25, 73728
buffer_load_dwordx4 v2, s[20:23], s24 offen lds
s_add_u32 m0, s26, 17408
s_add_u32 s24, s25, 82944
buffer_load_dwordx4 v2, s[20:23], s24 offen lds
s_add_u32 m0, s26, 18432
s_add_u32 s24, s25, 92160
buffer_load_dwordx4 v2, s[20:23], s24 offen lds
s_add_u32 m0, s26, 19456
s_add_u32 s24, s25, 101376
buffer_load_dwordx4 v2, s[20:23], s24 offen lds
s_waitcnt vmcnt(28)
ds_read_b64_tr_b16 a[80:81], v8 offset:20480
ds_read_b64_tr_b16 a[82:83], v8 offset:21504
ds_read_b64_tr_b16 a[84:85], v9 offset:20480
ds_read_b64_tr_b16 a[86:87], v9 offset:21504
ds_read_b64_tr_b16 a[88:89], v10 offset:20480
ds_read_b64_tr_b16 a[90:91], v10 offset:21504
ds_read_b64_tr_b16 a[92:93], v11 offset:20480
ds_read_b64_tr_b16 a[94:95], v11 offset:21504
s_waitcnt lgkmcnt(0)
s_mul_i32 s25, s37, 36
s_add_u32 m0, s26, 20480
s_add_u32 s24, s25, 0
buffer_load_dwordx4 v2, s[20:23], s24 offen lds
s_add_u32 m0, s26, 21504
s_add_u32 s24, s25, 9216
buffer_load_dwordx4 v2, s[20:23], s24 offen lds
s_add_u32 m0, s26, 22528
s_add_u32 s24, s25, 18432
buffer_load_dwordx4 v2, s[20:23], s24 offen lds
s_add_u32 m0, s26, 23552
s_add_u32 s24, s25, 27648
buffer_load_dwordx4 v2, s[20:23], s24 offen lds
s_waitcnt vmcnt(28)
ds_read_b64_tr_b16 a[96:97], v8 offset:24576
ds_read_b64_tr_b16 a[98:99], v8 offset:25600
ds_read_b64_tr_b16 a[100:101], v9 offset:24576
ds_read_b64_tr_b16 a[102:103], v9 offset:25600
ds_read_b64_tr_b16 a[104:105], v10 offset:24576
ds_read_b64_tr_b16 a[106:107], v10 offset:25600
ds_read_b64_tr_b16 a[108:109], v11 offset:24576
ds_read_b64_tr_b16 a[110:111], v11 offset:25600
s_waitcnt lgkmcnt(0)
s_mul_i32 s25, s37, 36
s_add_u32 m0, s26, 24576
s_add_u32 s24, s25, 36864
buffer_load_dwordx4 v2, s[20:23], s24 offen lds
s_add_u32 m0, s26, 25600
s_add_u32 s24, s25, 46080
buffer_load_dwordx4 v2, s[20:23], s24 offen lds
s_add_u32 m0, s26, 26624
s_add_u32 s24, s25, 55296
buffer_load_dwordx4 v2, s[20:23], s24 offen lds
s_add_u32 m0, s26, 27648
s_add_u32 s24, s25, 64512
buffer_load_dwordx4 v2, s[20:23], s24 offen lds
s_waitcnt vmcnt(28)
ds_read_b64_tr_b16 a[112:113], v8 offset:28672
ds_read_b64_tr_b16 a[114:115], v8 offset:29696
ds_read_b64_tr_b16 a[116:117], v9 offset:28672
ds_read_b64_tr_b16 a[118:119], v9 offset:29696
ds_read_b64_tr_b16 a[120:121], v10 offset:28672
ds_read_b64_tr_b16 a[122:123], v10 offset:29696
ds_read_b64_tr_b16 a[124:125], v11 offset:28672
ds_read_b64_tr_b16 a[126:127], v11 offset:29696
s_waitcnt lgkmcnt(0)
s_mul_i32 s25, s37, 36
s_add_u32 m0, s26, 28672
s_add_u32 s24, s25, 73728
buffer_load_dwordx4 v2, s[20:23], s24 offen lds
s_add_u32 m0, s26, 29696
s_add_u32 s24, s25, 82944
buffer_load_dwordx4 v2, s[20:23], s24 offen lds
s_add_u32 m0, s26, 30720
s_add_u32 s24, s25, 92160
buffer_load_dwordx4 v2, s[20:23], s24 offen lds
s_add_u32 m0, s26, 31744
s_add_u32 s24, s25, 101376
buffer_load_dwordx4 v2, s[20:23], s24 offen lds
s_waitcnt vmcnt(28)
ds_read_b64_tr_b16 a[128:129], v8
ds_read_b64_tr_b16 a[130:131], v8 offset:1024
ds_read_b64_tr_b16 a[132:133], v9
ds_read_b64_tr_b16 a[134:135], v9 offset:1024
ds_read_b64_tr_b16 a[136:137], v10
ds_read_b64_tr_b16 a[138:139], v10 offset:1024
ds_read_b64_tr_b16 a[140:141], v11
ds_read_b64_tr_b16 a[142:143], v11 offset:1024
s_waitcnt lgkmcnt(0)
s_mul_i32 s25, s30, 36
s_add_u32 m0, s26, 0
s_add_u32 s24, s25, 110592
buffer_load_dwordx4 v2, s[20:23], s24 offen lds
s_add_u32 m0, s26, 1024
s_add_u32 s24, s25, 119808
buffer_load_dwordx4 v2, s[20:23], s24 offen lds
s_add_u32 m0, s26, 2048
s_add_u32 s24, s25, 129024
buffer_load_dwordx4 v2, s[20:23], s24 offen lds
s_add_u32 m0, s26, 3072
s_add_u32 s24, s25, 138240
buffer_load_dwordx4 v2, s[20:23], s24 offen lds
s_waitcnt vmcnt(28)
ds_read_b64_tr_b16 a[144:145], v8 offset:4096
ds_read_b64_tr_b16 a[146:147], v8 offset:5120
ds_read_b64_tr_b16 a[148:149], v9 offset:4096
ds_read_b64_tr_b16 a[150:151], v9 offset:5120
ds_read_b64_tr_b16 a[152:153], v10 offset:4096
ds_read_b64_tr_b16 a[154:155], v10 offset:5120
ds_read_b64_tr_b16 a[156:157], v11 offset:4096
ds_read_b64_tr_b16 a[158:159], v11 offset:5120
s_waitcnt lgkmcnt(0)
s_mul_i32 s25, s31, 36
s_add_u32 m0, s26, 4096
s_add_u32 s24, s25, 110592
buffer_load_dwordx4 v2, s[20:23], s24 offen lds
s_add_u32 m0, s26, 5120
s_add_u32 s24, s25, 119808
buffer_load_dwordx4 v2, s[20:23], s24 offen lds
s_add_u32 m0, s26, 6144
s_add_u32 s24, s25, 129024
buffer_load_dwordx4 v2, s[20:23], s24 offen lds
s_add_u32 m0, s26, 7168
s_add_u32 s24, s25, 138240
buffer_load_dwordx4 v2, s[20:23], s24 offen lds
s_waitcnt vmcnt(28)
ds_read_b64_tr_b16 a[160:161], v8 offset:8192
ds_read_b64_tr_b16 a[162:163], v8 offset:9216
ds_read_b64_tr_b16 a[164:165], v9 offset:8192
ds_read_b64_tr_b16 a[166:167], v9 offset:9216
ds_read_b64_tr_b16 a[168:169], v10 offset:8192
ds_read_b64_tr_b16 a[170:171], v10 offset:9216
ds_read_b64_tr_b16 a[172:173], v11 offset:8192
ds_read_b64_tr_b16 a[174:175], v11 offset:9216
s_waitcnt lgkmcnt(0)
s_mul_i32 s25, s32, 36
s_add_u32 m0, s26, 8192
s_add_u32 s24, s25, 110592
buffer_load_dwordx4 v2, s[20:23], s24 offen lds
s_add_u32 m0, s26, 9216
s_add_u32 s24, s25, 119808
buffer_load_dwordx4 v2, s[20:23], s24 offen lds
s_add_u32 m0, s26, 10240
s_add_u32 s24, s25, 129024
buffer_load_dwordx4 v2, s[20:23], s24 offen lds
s_add_u32 m0, s26, 11264
s_add_u32 s24, s25, 138240
buffer_load_dwordx4 v2, s[20:23], s24 offen lds
s_waitcnt vmcnt(28)
ds_read_b64_tr_b16 a[176:177], v8 offset:12288
ds_read_b64_tr_b16 a[178:179], v8 offset:13312
ds_read_b64_tr_b16 a[180:181], v9 offset:12288
ds_read_b64_tr_b16 a[182:183], v9 offset:13312
ds_read_b64_tr_b16 a[184:185], v10 offset:12288
ds_read_b64_tr_b16 a[186:187], v10 offset:13312
ds_read_b64_tr_b16 a[188:189], v11 offset:12288
ds_read_b64_tr_b16 a[190:191], v11 offset:13312
s_waitcnt lgkmcnt(0)
s_mul_i32 s25, s33, 36
s_add_u32 m0, s26, 12288
s_add_u32 s24, s25, 110592
buffer_load_dwordx4 v2, s[20:23], s24 offen lds
s_add_u32 m0, s26, 13312
s_add_u32 s24, s25, 119808
buffer_load_dwordx4 v2, s[20:23], s24 offen lds
s_add_u32 m0, s26, 14336
s_add_u32 s24, s25, 129024
buffer_load_dwordx4 v2, s[20:23], s24 offen lds
s_add_u32 m0, s26, 15360
s_add_u32 s24, s25, 138240
buffer_load_dwordx4 v2, s[20:23], s24 offen lds
s_waitcnt vmcnt(28)
ds_read_b64_tr_b16 a[192:193], v8 offset:16384
ds_read_b64_tr_b16 a[194:195], v8 offset:17408
ds_read_b64_tr_b16 a[196:197], v9 offset:16384
ds_read_b64_tr_b16 a[198:199], v9 offset:17408
ds_read_b64_tr_b16 a[200:201], v10 offset:16384
ds_read_b64_tr_b16 a[202:203], v10 offset:17408
ds_read_b64_tr_b16 a[204:205], v11 offset:16384
ds_read_b64_tr_b16 a[206:207], v11 offset:17408
s_waitcnt lgkmcnt(0)
s_mul_i32 s25, s34, 36
s_add_u32 m0, s26, 16384
s_add_u32 s24, s25, 110592
buffer_load_dwordx4 v2, s[20:23], s24 offen lds
s_add_u32 m0, s26, 17408
s_add_u32 s24, s25, 119808
buffer_load_dwordx4 v2, s[20:23], s24 offen lds
s_add_u32 m0, s26, 18432
s_add_u32 s24, s25, 129024
buffer_load_dwordx4 v2, s[20:23], s24 offen lds
s_add_u32 m0, s26, 19456
s_add_u32 s24, s25, 138240
buffer_load_dwordx4 v2, s[20:23], s24 offen lds
s_waitcnt vmcnt(28)
ds_read_b64_tr_b16 a[208:209], v8 offset:20480
ds_read_b64_tr_b16 a[210:211], v8 offset:21504
ds_read_b64_tr_b16 a[212:213], v9 offset:20480
ds_read_b64_tr_b16 a[214:215], v9 offset:21504
ds_read_b64_tr_b16 a[216:217], v10 offset:20480
ds_read_b64_tr_b16 a[218:219], v10 offset:21504
ds_read_b64_tr_b16 a[220:221], v11 offset:20480
ds_read_b64_tr_b16 a[222:223], v11 offset:21504
s_waitcnt lgkmcnt(0)
s_mul_i32 s25, s35, 36
s_add_u32 m0, s26, 20480
s_add_u32 s24, s25, 110592
buffer_load_dwordx4 v2, s[20:23], s24 offen lds
s_add_u32 m0, s26, 21504
s_add_u32 s24, s25, 119808
buffer_load_dwordx4 v2, s[20:23], s24 offen lds
s_add_u32 m0, s26, 22528
s_add_u32 s24, s25, 129024
buffer_load_dwordx4 v2, s[20:23], s24 offen lds
s_add_u32 m0, s26, 23552
s_add_u32 s24, s25, 138240
buffer_load_dwordx4 v2, s[20:23], s24 offen lds
s_waitcnt vmcnt(28)
ds_read_b64_tr_b16 a[224:225], v8 offset:24576
ds_read_b64_tr_b16 a[226:227], v8 offset:25600
ds_read_b64_tr_b16 a[228:229], v9 offset:24576
ds_read_b64_tr_b16 a[230:231], v9 offset:25600
ds_read_b64_tr_b16 a[232:233], v10 offset:24576
ds_read_b64_tr_b16 a[234:235], v10 offset:25600
ds_read_b64_tr_b16 a[236:237], v11 offset:24576
ds_read_b64_tr_b16 a[238:239], v11 offset:25600
s_waitcnt lgkmcnt(0)
s_mul_i32 s25, s36, 36
s_add_u32 m0, s26, 24576
s_add_u32 s24, s25, 110592
buffer_load_dwordx4 v2, s[20:23], s24 offen lds
s_add_u32 m0, s26, 25600
s_add_u32 s24, s25, 119808
buffer_load_dwordx4 v2, s[20:23], s24 offen lds
s_add_u32 m0, s26, 26624
s_add_u32 s24, s25, 129024
buffer_load_dwordx4 v2, s[20:23], s24 offen lds
s_add_u32 m0, s26, 27648
s_add_u32 s24, s25, 138240
buffer_load_dwordx4 v2, s[20:23], s24 offen lds
s_waitcnt vmcnt(28)
ds_read_b64_tr_b16 a[240:241], v8 offset:28672
ds_read_b64_tr_b16 a[242:243], v8 offset:29696
ds_read_b64_tr_b16 a[244:245], v9 offset:28672
ds_read_b64_tr_b16 a[246:247], v9 offset:29696
ds_read_b64_tr_b16 a[248:249], v10 offset:28672
ds_read_b64_tr_b16 a[250:251], v10 offset:29696
ds_read_b64_tr_b16 a[252:253], v11 offset:28672
ds_read_b64_tr_b16 a[254:255], v11 offset:29696
s_waitcnt lgkmcnt(0)
s_mul_i32 s25, s37, 36
s_add_u32 m0, s26, 28672
s_add_u32 s24, s25, 110592
buffer_load_dwordx4 v2, s[20:23], s24 offen lds
s_add_u32 m0, s26, 29696
s_add_u32 s24, s25, 119808
buffer_load_dwordx4 v2, s[20:23], s24 offen lds
s_add_u32 m0, s26, 30720
s_add_u32 s24, s25, 129024
buffer_load_dwordx4 v2, s[20:23], s24 offen lds
s_add_u32 m0, s26, 31744
s_add_u32 s24, s25, 138240
buffer_load_dwordx4 v2, s[20:23], s24 offen lds
s_waitcnt vmcnt(0)
v_and_b32 v12, 15, v0
v_mul_u32_u24 v12, 2304, v12
v_lshrrev_b32 v13, 4, v0
v_lshl_add_u32 v12, v13, 3, v12
s_lshl_b32 s24, s40, 7
s_add_u32 s24, s24, s47
v_add_u32 v4, s24, v12
v_and_b32 v5, 7, v0
v_lshlrev_b32 v5, 2, v5
s_lshl_b32 s24, s17, 5
v_add_u32 v5, s24, v5
v_lshlrev_b32 v3, 4, v0
v_add_u32 v3, 131072, v3
s_lshl_b32 s24, s17, 12
s_add_u32 s24, s24, 131072
v_add_u32 v7, s24, v1
s_lshl_b32 s24, s17, 15
s_add_u32 s44, s44, s24
s_ff1_i32_b64 s41, s[42:43]
s_bitset0_b64 s[42:43], s41
s_lshl_b32 s41, s41, 1
s_xor_b32 s41, s41, s51
s_and_b32 s41, s41, 127
L_opl_w:
s_lshr_b32 s25, s41, s46
s_lshl_b32 s25, s25, 7
s_add_u32 s25, s25, s45
s_mov_b32 s28, 0
L_poll_47:
buffer_load_dword v6, v5, s[8:11], s25 offen sc1
s_add_u32 s28, s28, 1
s_cmp_gt_u32 s28, 40000
s_cbranch_scc1 L_end
s_waitcnt vmcnt(0)
v_cmp_ne_u32 vcc, 1, v6
s_cbranch_vccz L_pd_48
s_sleep 1
s_cmp_lt_u32 s28, 32
s_cbranch_scc1 L_poll_47
s_sleep 32
s_branch L_poll_47
L_pd_48:
s_lshl_b32 s48, s41, 17
s_add_u32 s48, s48, s44
s_add_u32 s24, s48, s30
buffer_load_dwordx4 v[16:19], v1, s[8:11], s24 offen sc1
buffer_load_dwordx4 v[20:23], v1, s[8:11], s24 offen offset:1024 sc1
buffer_load_dwordx4 v[24:27], v1, s[8:11], s24 offen offset:2048 sc1
buffer_load_dwordx4 v[28:31], v1, s[8:11], s24 offen offset:3072 sc1
s_add_u32 s24, s48, s31
buffer_load_dwordx4 v[32:35], v1, s[8:11], s24 offen sc1
buffer_load_dwordx4 v[36:39], v1, s[8:11], s24 offen offset:1024 sc1
buffer_load_dwordx4 v[40:43], v1, s[8:11], s24 offen offset:2048 sc1
buffer_load_dwordx4 v[44:47], v1, s[8:11], s24 offen offset:3072 sc1
s_add_u32 s24, s48, s32
buffer_load_dwordx4 v[48:51], v1, s[8:11], s24 offen sc1
buffer_load_dwordx4 v[52:55], v1, s[8:11], s24 offen offset:1024 sc1
buffer_load_dwordx4 v[56:59], v1, s[8:11], s24 offen offset:2048 sc1
buffer_load_dwordx4 v[60:63], v1, s[8:11], s24 offen offset:3072 sc1
s_add_u32 s24, s48, s33
buffer_load_dwordx4 v[64:67], v1, s[8:11], s24 offen sc1
buffer_load_dwordx4 v[68:71], v1, s[8:11], s24 offen offset:1024 sc1
buffer_load_dwordx4 v[72:75], v1, s[8:11], s24 offen offset:2048 sc1
buffer_load_dwordx4 v[76:79], v1, s[8:11], s24 offen offset:3072 sc1
s_waitcnt vmcnt(15)
v_mfma_f32_16x16x32_bf16 v[80:83], v[128:131], v[16:19], 0
s_cmp_lg_u64 s[42:43], 0
s_cselect_b32 s52, 1, 0
ds_read_b64_tr_b16 v[112:113], v8
v_mfma_f32_16x16x32_bf16 v[84:87], v[132:135], v[16:19], 0
s_ff1_i32_b64 s27, s[42:43]
ds_read_b64_tr_b16 v[114:115], v8 offset:1024
v_mfma_f32_16x16x32_bf16 v[88:91], v[136:139], v[16:19], 0
s_bitset0_b64 s[42:43], s27
s_add_u32 s24, s48, s34
ds_read_b64_tr_b16 v[116:117], v9
v_mfma_f32_16x16x32_bf16 v[92:95], v[140:143], v[16:19], 0
s_lshl_b32 s27, s27, 1
ds_read_b64_tr_b16 v[118:119], v9 offset:1024
buffer_load_dwordx4 v[16:19], v1, s[8:11], s24 offen sc1
s_waitcnt vmcnt(15)
v_mfma_f32_16x16x32_bf16 v[80:83], v[144:147], v[20:23], v[80:83]
s_xor_b32 s27, s27, s51
ds_read_b64_tr_b16 v[120:121], v10
v_mfma_f32_16x16x32_bf16 v[84:87], v[148:151], v[20:23], v[84:87]
s_and_b32 s27, s27, 127
ds_read_b64_tr_b16 v[122:123], v10 offset:1024
v_mfma_f32_16x16x32_bf16 v[88:91], v[152:155], v[20:23], v[88:91]
s_lshr_b32 s25, s27, s46
ds_read_b64_tr_b16 v[124:125], v11
v_mfma_f32_16x16x32_bf16 v[92:95], v[156:159], v[20:23], v[92:95]
s_lshl_b32 s25, s25, 7
ds_read_b64_tr_b16 v[126:127], v11 offset:1024
buffer_load_dwordx4 v[20:23], v1, s[8:11], s24 offen offset:1024 sc1
s_waitcnt vmcnt(15)
v_mfma_f32_16x16x32_bf16 v[80:83], v[160:163], v[24:27], v[80:83]
s_add_u32 s25, s25, s45
v_mfma_f32_16x16x32_bf16 v[84:87], v[164:167], v[24:27], v[84:87]
s_lshl_b32 s49, s27, 17
v_mfma_f32_16x16x32_bf16 v[88:91], v[168:171], v[24:27], v[88:91]
s_add_u32 s49, s49, s44
v_mfma_f32_16x16x32_bf16 v[92:95], v[172:175], v[24:27], v[92:95]
buffer_load_dwordx4 v[24:27], v1, s[8:11], s24 offen offset:2048 sc1
buffer_load_dword v6, v5, s[8:11], s25 offen sc1
s_waitcnt vmcnt(16) lgkmcnt(0)
v_mfma_f32_16x16x32_bf16 v[80:83], v[112:115], v[28:31], v[80:83]
v_mfma_f32_16x16x32_bf16 v[84:87], v[116:119], v[28:31], v[84:87]
v_mfma_f32_16x16x32_bf16 v[88:91], v[120:123], v[28:31], v[88:91]
v_mfma_f32_16x16x32_bf16 v[92:95], v[124:127], v[28:31], v[92:95]
buffer_load_dwordx4 v[28:31], v1, s[8:11], s24 offen offset:3072 sc1
s_waitcnt vmcnt(16)
v_mfma_f32_16x16x32_bf16 v[80:83], v[176:179], v[32:35], v[80:83]
ds_read_b64_tr_b16 v[112:113], v8 offset:4096
v_mfma_f32_16x16x32_bf16 v[84:87], v[180:183], v[32:35], v[84:87]
ds_read_b64_tr_b16 v[114:115], v8 offset:5120
v_mfma_f32_16x16x32_bf16 v[88:91], v[184:187], v[32:35], v[88:91]
s_add_u32 s24, s48, s35
ds_read_b64_tr_b16 v[116:117], v9 offset:4096
v_mfma_f32_16x16x32_bf16 v[92:95], v[188:191], v[32:35], v[92:95]
ds_read_b64_tr_b16 v[118:119], v9 offset:5120
buffer_load_dwordx4 v[32:35], v1, s[8:11], s24 offen sc1
s_waitcnt vmcnt(16)
v_mfma_f32_16x16x32_bf16 v[80:83], v[192:195], v[36:39], v[80:83]
ds_read_b64_tr_b16 v[120:121], v10 offset:4096
v_mfma_f32_16x16x32_bf16 v[84:87], v[196:199], v[36:39], v[84:87]
ds_read_b64_tr_b16 v[122:123], v10 offset:5120
v_mfma_f32_16x16x32_bf16 v[88:91], v[200:203], v[36:39], v[88:91]
ds_read_b64_tr_b16 v[124:125], v11 offset:4096
v_mfma_f32_16x16x32_bf16 v[92:95], v[204:207], v[36:39], v[92:95]
ds_read_b64_tr_b16 v[126:127], v11 offset:5120
buffer_load_dwordx4 v[36:39], v1, s[8:11], s24 offen offset:1024 sc1
s_waitcnt vmcnt(16)
v_mfma_f32_16x16x32_bf16 v[80:83], v[208:211], v[40:43], v[80:83]
v_mfma_f32_16x16x32_bf16 v[84:87], v[212:215], v[40:43], v[84:87]
v_mfma_f32_16x16x32_bf16 v[88:91], v[216:219], v[40:43], v[88:91]
v_mfma_f32_16x16x32_bf16 v[92:95], v[220:223], v[40:43], v[92:95]
buffer_load_dwordx4 v[40:43], v1, s[8:11], s24 offen offset:2048 sc1
s_waitcnt vmcnt(16) lgkmcnt(0)
v_mfma_f32_16x16x32_bf16 v[80:83], v[112:115], v[44:47], v[80:83]
v_mfma_f32_16x16x32_bf16 v[84:87], v[116:119], v[44:47], v[84:87]
v_mfma_f32_16x16x32_bf16 v[88:91], v[120:123], v[44:47], v[88:91]
v_mfma_f32_16x16x32_bf16 v[92:95], v[124:127], v[44:47], v[92:95]
buffer_load_dwordx4 v[44:47], v1, s[8:11], s24 offen offset:3072 sc1
s_waitcnt vmcnt(16)
v_mfma_f32_16x16x32_bf16 v[80:83], v[224:227], v[48:51], v[80:83]
ds_read_b64_tr_b16 v[112:113], v8 offset:8192
v_mfma_f32_16x16x32_bf16 v[84:87], v[228:231], v[48:51], v[84:87]
ds_read_b64_tr_b16 v[114:115], v8 offset:9216
v_mfma_f32_16x16x32_bf16 v[88:91], v[232:235], v[48:51], v[88:91]
s_add_u32 s24, s48, s36
ds_read_b64_tr_b16 v[116:117], v9 offset:8192
v_mfma_f32_16x16x32_bf16 v[92:95], v[236:239], v[48:51], v[92:95]
ds_read_b64_tr_b16 v[118:119], v9 offset:9216
buffer_load_dwordx4 v[48:51], v1, s[8:11], s24 offen sc1
s_waitcnt vmcnt(16)
v_mfma_f32_16x16x32_bf16 v[80:83], v[240:243], v[52:55], v[80:83]
ds_read_b64_tr_b16 v[120:121], v10 offset:8192
v_mfma_f32_16x16x32_bf16 v[84:87], v[244:247], v[52:55], v[84:87]
ds_read_b64_tr_b16 v[122:123], v10 offset:9216
v_mfma_f32_16x16x32_bf16 v[88:91], v[248:251], v[52:55], v[88:91]
ds_read_b64_tr_b16 v[124:125], v11 offset:8192
v_mfma_f32_16x16x32_bf16 v[92:95], v[252:255], v[52:55], v[92:95]
ds_read_b64_tr_b16 v[126:127], v11 offset:9216
buffer_load_dwordx4 v[52:55], v1, s[8:11], s24 offen offset:1024 sc1
s_waitcnt vmcnt(16)
v_mfma_f32_16x16x32_bf16 v[80:83], a[0:3], v[56:59], v[80:83]
v_mfma_f32_16x16x32_bf16 v[84:87], a[4:7], v[56:59], v[84:87]
v_mfma_f32_16x16x32_bf16 v[88:91], a[8:11], v[56:59], v[88:91]
v_mfma_f32_16x16x32_bf16 v[92:95], a[12:15], v[56:59], v[92:95]
buffer_load_dwordx4 v[56:59], v1, s[8:11], s24 offen offset:2048 sc1
s_waitcnt vmcnt(16) lgkmcnt(0)
v_mfma_f32_16x16x32_bf16 v[80:83], v[112:115], v[60:63], v[80:83]
v_mfma_f32_16x16x32_bf16 v[84:87], v[116:119], v[60:63], v[84:87]
v_mfma_f32_16x16x32_bf16 v[88:91], v[120:123], v[60:63], v[88:91]
v_mfma_f32_16x16x32_bf16 v[92:95], v[124:127], v[60:63], v[92:95]
buffer_load_dwordx4 v[60:63], v1, s[8:11], s24 offen offset:3072 sc1
s_waitcnt vmcnt(16)
v_mfma_f32_16x16x32_bf16 v[80:83], a[16:19], v[64:67], v[80:83]
ds_read_b64_tr_b16 v[112:113], v8 offset:12288
v_mfma_f32_16x16x32_bf16 v[84:87], a[20:23], v[64:67], v[84:87]
ds_read_b64_tr_b16 v[114:115], v8 offset:13312
v_mfma_f32_16x16x32_bf16 v[88:91], a[24:27], v[64:67], v[88:91]
s_add_u32 s24, s48, s37
ds_read_b64_tr_b16 v[116:117], v9 offset:12288
v_mfma_f32_16x16x32_bf16 v[92:95], a[28:31], v[64:67], v[92:95]
ds_read_b64_tr_b16 v[118:119], v9 offset:13312
buffer_load_dwordx4 v[64:67], v1, s[8:11], s24 offen sc1
s_waitcnt vmcnt(16)
v_mfma_f32_16x16x32_bf16 v[80:83], a[32:35], v[68:71], v[80:83]
ds_read_b64_tr_b16 v[120:121], v10 offset:12288
v_mfma_f32_16x16x32_bf16 v[84:87], a[36:39], v[68:71], v[84:87]
ds_read_b64_tr_b16 v[122:123], v10 offset:13312
v_mfma_f32_16x16x32_bf16 v[88:91], a[40:43], v[68:71], v[88:91]
ds_read_b64_tr_b16 v[124:125], v11 offset:12288
v_mfma_f32_16x16x32_bf16 v[92:95], a[44:47], v[68:71], v[92:95]
ds_read_b64_tr_b16 v[126:127], v11 offset:13312
buffer_load_dwordx4 v[68:71], v1, s[8:11], s24 offen offset:1024 sc1
buffer_load_dword v6, v5, s[8:11], s25 offen sc1
s_branch L_opl_t0
L_opl_r0:
s_waitcnt vmcnt(15)
v_mfma_f32_16x16x32_bf16 v[80:83], v[128:131], v[16:19], 0
s_cmp_lg_u64 s[42:43], 0
s_cselect_b32 s52, 1, 0
ds_read_b64_tr_b16 v[112:113], v8
v_mfma_f32_16x16x32_bf16 v[84:87], v[132:135], v[16:19], 0
s_ff1_i32_b64 s27, s[42:43]
ds_read_b64_tr_b16 v[114:115], v8 offset:1024
v_mfma_f32_16x16x32_bf16 v[88:91], v[136:139], v[16:19], 0
s_bitset0_b64 s[42:43], s27
s_add_u32 s24, s48, s34
ds_read_b64_tr_b16 v[116:117], v9
v_mfma_f32_16x16x32_bf16 v[92:95], v[140:143], v[16:19], 0
s_lshl_b32 s27, s27, 1
ds_read_b64_tr_b16 v[118:119], v9 offset:1024
buffer_load_dwordx4 v[16:19], v1, s[8:11], s24 offen sc1
s_waitcnt vmcnt(15)
v_mfma_f32_16x16x32_bf16 v[80:83], v[144:147], v[20:23], v[80:83]
s_xor_b32 s27, s27, s51
ds_read_b64_tr_b16 v[120:121], v10
v_mfma_f32_16x16x32_bf16 v[84:87], v[148:151], v[20:23], v[84:87]
s_and_b32 s27, s27, 127
ds_read_b64_tr_b16 v[122:123], v10 offset:1024
v_mfma_f32_16x16x32_bf16 v[88:91], v[152:155], v[20:23], v[88:91]
s_lshr_b32 s25, s27, s46
ds_read_b64_tr_b16 v[124:125], v11
v_mfma_f32_16x16x32_bf16 v[92:95], v[156:159], v[20:23], v[92:95]
s_lshl_b32 s25, s25, 7
ds_read_b64_tr_b16 v[126:127], v11 offset:1024
buffer_load_dwordx4 v[20:23], v1, s[8:11], s24 offen offset:1024 sc1
s_waitcnt vmcnt(15)
v_mfma_f32_16x16x32_bf16 v[80:83], v[160:163], v[24:27], v[80:83]
s_add_u32 s25, s25, s45
v_mfma_f32_16x16x32_bf16 v[84:87], v[164:167], v[24:27], v[84:87]
s_lshl_b32 s49, s27, 17
v_mfma_f32_16x16x32_bf16 v[88:91], v[168:171], v[24:27], v[88:91]
s_add_u32 s49, s49, s44
v_mfma_f32_16x16x32_bf16 v[92:95], v[172:175], v[24:27], v[92:95]
buffer_load_dwordx4 v[24:27], v1, s[8:11], s24 offen offset:2048 sc1
buffer_load_dword v6, v5, s[8:11], s25 offen sc1
s_waitcnt vmcnt(16) lgkmcnt(0)
v_mfma_f32_16x16x32_bf16 v[80:83], v[112:115], v[28:31], v[80:83]
ds_write_b128 v3, v[96:99]
v_mfma_f32_16x16x32_bf16 v[84:87], v[116:119], v[28:31], v[84:87]
ds_write_b128 v3, v[100:103] offset:4096
v_mfma_f32_16x16x32_bf16 v[88:91], v[120:123], v[28:31], v[88:91]
ds_write_b128 v3, v[104:107] offset:8192
v_mfma_f32_16x16x32_bf16 v[92:95], v[124:127], v[28:31], v[92:95]
ds_write_b128 v3, v[108:111] offset:12288
buffer_load_dwordx4 v[28:31], v1, s[8:11], s24 offen offset:3072 sc1
s_waitcnt vmcnt(16)
v_mfma_f32_16x16x32_bf16 v[80:83], v[176:179], v[32:35], v[80:83]
ds_read_b64_tr_b16 v[112:113], v8 offset:4096
v_mfma_f32_16x16x32_bf16 v[84:87], v[180:183], v[32:35], v[84:87]
ds_read_b64_tr_b16 v[114:115], v8 offset:5120
v_mfma_f32_16x16x32_bf16 v[88:91], v[184:187], v[32:35], v[88:91]
s_add_u32 s24, s48, s35
ds_read_b64_tr_b16 v[116:117], v9 offset:4096
v_mfma_f32_16x16x32_bf16 v[92:95], v[188:191], v[32:35], v[92:95]
ds_read_b64_tr_b16 v[118:119], v9 offset:5120
buffer_load_dwordx4 v[32:35], v1, s[8:11], s24 offen sc1
s_waitcnt vmcnt(16)
v_mfma_f32_16x16x32_bf16 v[80:83], v[192:195], v[36:39], v[80:83]
ds_read_b64_tr_b16 v[120:121], v10 offset:4096
v_mfma_f32_16x16x32_bf16 v[84:87], v[196:199], v[36:39], v[84:87]
ds_read_b64_tr_b16 v[122:123], v10 offset:5120
v_mfma_f32_16x16x32_bf16 v[88:91], v[200:203], v[36:39], v[88:91]
ds_read_b64_tr_b16 v[124:125], v11 offset:4096
v_mfma_f32_16x16x32_bf16 v[92:95], v[204:207], v[36:39], v[92:95]
ds_read_b64_tr_b16 v[126:127], v11 offset:5120
buffer_load_dwordx4 v[36:39], v1, s[8:11], s24 offen offset:1024 sc1
s_waitcnt vmcnt(16)
v_mfma_f32_16x16x32_bf16 v[80:83], v[208:211], v[40:43], v[80:83]
v_mfma_f32_16x16x32_bf16 v[84:87], v[212:215], v[40:43], v[84:87]
v_mfma_f32_16x16x32_bf16 v[88:91], v[216:219], v[40:43], v[88:91]
v_mfma_f32_16x16x32_bf16 v[92:95], v[220:223], v[40:43], v[92:95]
buffer_load_dwordx4 v[40:43], v1, s[8:11], s24 offen offset:2048 sc1
s_waitcnt vmcnt(16) lgkmcnt(0)
s_barrier
v_mfma_f32_16x16x32_bf16 v[80:83], v[112:115], v[44:47], v[80:83]
ds_read_b128 v[96:99], v7
v_mfma_f32_16x16x32_bf16 v[84:87], v[116:119], v[44:47], v[84:87]
ds_read_b128 v[100:103], v7 offset:1024
v_mfma_f32_16x16x32_bf16 v[88:91], v[120:123], v[44:47], v[88:91]
ds_read_b128 v[104:107], v7 offset:2048
v_mfma_f32_16x16x32_bf16 v[92:95], v[124:127], v[44:47], v[92:95]
ds_read_b128 v[108:111], v7 offset:3072
buffer_load_dwordx4 v[44:47], v1, s[8:11], s24 offen offset:3072 sc1
s_waitcnt vmcnt(16)
v_mfma_f32_16x16x32_bf16 v[80:83], v[224:227], v[48:51], v[80:83]
ds_read_b64_tr_b16 v[112:113], v8 offset:8192
v_mfma_f32_16x16x32_bf16 v[84:87], v[228:231], v[48:51], v[84:87]
ds_read_b64_tr_b16 v[114:115], v8 offset:9216
v_mfma_f32_16x16x32_bf16 v[88:91], v[232:235], v[48:51], v[88:91]
s_add_u32 s24, s48, s36
ds_read_b64_tr_b16 v[116:117], v9 offset:8192
v_mfma_f32_16x16x32_bf16 v[92:95], v[236:239], v[48:51], v[92:95]
ds_read_b64_tr_b16 v[118:119], v9 offset:9216
buffer_load_dwordx4 v[48:51], v1, s[8:11], s24 offen sc1
s_waitcnt vmcnt(16)
v_mfma_f32_16x16x32_bf16 v[80:83], v[240:243], v[52:55], v[80:83]
ds_read_b64_tr_b16 v[120:121], v10 offset:8192
v_mfma_f32_16x16x32_bf16 v[84:87], v[244:247], v[52:55], v[84:87]
ds_read_b64_tr_b16 v[122:123], v10 offset:9216
v_mfma_f32_16x16x32_bf16 v[88:91], v[248:251], v[52:55], v[88:91]
ds_read_b64_tr_b16 v[124:125], v11 offset:8192
v_mfma_f32_16x16x32_bf16 v[92:95], v[252:255], v[52:55], v[92:95]
ds_read_b64_tr_b16 v[126:127], v11 offset:9216
buffer_load_dwordx4 v[52:55], v1, s[8:11], s24 offen offset:1024 sc1
s_waitcnt vmcnt(16)
v_mfma_f32_16x16x32_bf16 v[80:83], a[0:3], v[56:59], v[80:83]
v_mfma_f32_16x16x32_bf16 v[84:87], a[4:7], v[56:59], v[84:87]
v_mfma_f32_16x16x32_bf16 v[88:91], a[8:11], v[56:59], v[88:91]
v_mfma_f32_16x16x32_bf16 v[92:95], a[12:15], v[56:59], v[92:95]
buffer_load_dwordx4 v[56:59], v1, s[8:11], s24 offen offset:2048 sc1
s_waitcnt vmcnt(16) lgkmcnt(0)
v_mfma_f32_16x16x32_bf16 v[80:83], v[112:115], v[60:63], v[80:83]
v_add_f32 v96, v96, v100
v_add_f32 v97, v97, v101
v_mfma_f32_16x16x32_bf16 v[84:87], v[116:119], v[60:63], v[84:87]
v_add_f32 v98, v98, v102
v_add_f32 v99, v99, v103
v_mfma_f32_16x16x32_bf16 v[88:91], v[120:123], v[60:63], v[88:91]
v_add_f32 v96, v96, v104
v_add_f32 v97, v97, v105
v_mfma_f32_16x16x32_bf16 v[92:95], v[124:127], v[60:63], v[92:95]
v_add_f32 v98, v98, v106
v_add_f32 v99, v99, v107
buffer_load_dwordx4 v[60:63], v1, s[8:11], s24 offen offset:3072 sc1
s_waitcnt vmcnt(16)
v_mfma_f32_16x16x32_bf16 v[80:83], a[16:19], v[64:67], v[80:83]
ds_read_b64_tr_b16 v[112:113], v8 offset:12288
v_add_f32 v96, v96, v108
v_mfma_f32_16x16x32_bf16 v[84:87], a[20:23], v[64:67], v[84:87]
ds_read_b64_tr_b16 v[114:115], v8 offset:13312
v_add_f32 v97, v97, v109
v_mfma_f32_16x16x32_bf16 v[88:91], a[24:27], v[64:67], v[88:91]
s_add_u32 s24, s48, s37
ds_read_b64_tr_b16 v[116:117], v9 offset:12288
v_add_f32 v98, v98, v110
v_mfma_f32_16x16x32_bf16 v[92:95], a[28:31], v[64:67], v[92:95]
ds_read_b64_tr_b16 v[118:119], v9 offset:13312
v_add_f32 v99, v99, v111
buffer_load_dwordx4 v[64:67], v1, s[8:11], s24 offen sc1
s_waitcnt vmcnt(16)
v_mfma_f32_16x16x32_bf16 v[80:83], a[32:35], v[68:71], v[80:83]
ds_read_b64_tr_b16 v[120:121], v10 offset:12288
v_cvt_pk_bf16_f32 v12, v96, v97
v_mfma_f32_16x16x32_bf16 v[84:87], a[36:39], v[68:71], v[84:87]
ds_read_b64_tr_b16 v[122:123], v10 offset:13312
v_cvt_pk_bf16_f32 v13, v98, v99
v_mfma_f32_16x16x32_bf16 v[88:91], a[40:43], v[68:71], v[88:91]
ds_read_b64_tr_b16 v[124:125], v11 offset:12288
v_xor_b32 v3, 16384, v3
v_mfma_f32_16x16x32_bf16 v[92:95], a[44:47], v[68:71], v[92:95]
ds_read_b64_tr_b16 v[126:127], v11 offset:13312
v_xor_b32 v7, 16384, v7
buffer_load_dwordx4 v[68:71], v1, s[8:11], s24 offen offset:1024 sc1
buffer_store_dwordx2 v[12:13], v4, s[12:15], s53 offen
L_opl_t0:
s_waitcnt vmcnt(17)
v_mfma_f32_16x16x32_bf16 v[80:83], a[48:51], v[72:75], v[80:83]
v_mfma_f32_16x16x32_bf16 v[84:87], a[52:55], v[72:75], v[84:87]
v_mfma_f32_16x16x32_bf16 v[88:91], a[56:59], v[72:75], v[88:91]
v_mfma_f32_16x16x32_bf16 v[92:95], a[60:63], v[72:75], v[92:95]
buffer_load_dwordx4 v[72:75], v1, s[8:11], s24 offen offset:2048 sc1
s_waitcnt vmcnt(17) lgkmcnt(0)
v_mfma_f32_16x16x32_bf16 v[80:83], v[112:115], v[76:79], v[80:83]
s_waitcnt vmcnt(13)
v_cmp_ne_u32 vcc, 1, v6
v_mfma_f32_16x16x32_bf16 v[84:87], v[116:119], v[76:79], v[84:87]
v_mfma_f32_16x16x32_bf16 v[88:91], v[120:123], v[76:79], v[88:91]
s_cmp_eq_u64 vcc, 0
s_cselect_b32 s50, s52, 0
v_mfma_f32_16x16x32_bf16 v[92:95], v[124:127], v[76:79], v[92:95]
buffer_load_dwordx4 v[76:79], v1, s[8:11], s24 offen offset:3072 sc1
s_waitcnt vmcnt(17)
v_mfma_f32_16x16x32_bf16 v[80:83], a[64:67], v[16:19], v[80:83]
s_cmp_eq_u32 s50, 1
s_cselect_b32 s49, s49, 536870912
ds_read_b64_tr_b16 v[112:113], v8 offset:16384
v_mfma_f32_16x16x32_bf16 v[84:87], a[68:71], v[16:19], v[84:87]
ds_read_b64_tr_b16 v[114:115], v8 offset:17408
v_mfma_f32_16x16x32_bf16 v[88:91], a[72:75], v[16:19], v[88:91]
s_add_u32 s24, s49, s30
ds_read_b64_tr_b16 v[116:117], v9 offset:16384
v_mfma_f32_16x16x32_bf16 v[92:95], a[76:79], v[16:19], v[92:95]
ds_read_b64_tr_b16 v[118:119], v9 offset:17408
buffer_load_dwordx4 v[16:19], v1, s[8:11], s24 offen sc1
s_waitcnt vmcnt(17)
v_mfma_f32_16x16x32_bf16 v[80:83], a[80:83], v[20:23], v[80:83]
ds_read_b64_tr_b16 v[120:121], v10 offset:16384
v_mfma_f32_16x16x32_bf16 v[84:87], a[84:87], v[20:23], v[84:87]
ds_read_b64_tr_b16 v[122:123], v10 offset:17408
v_mfma_f32_16x16x32_bf16 v[88:91], a[88:91], v[20:23], v[88:91]
ds_read_b64_tr_b16 v[124:125], v11 offset:16384
v_mfma_f32_16x16x32_bf16 v[92:95], a[92:95], v[20:23], v[92:95]
ds_read_b64_tr_b16 v[126:127], v11 offset:17408
buffer_load_dwordx4 v[20:23], v1, s[8:11], s24 offen offset:1024 sc1
s_waitcnt vmcnt(17)
v_mfma_f32_16x16x32_bf16 v[80:83], a[96:99], v[24:27], v[80:83]
v_mfma_f32_16x16x32_bf16 v[84:87], a[100:103], v[24:27], v[84:87]
v_mfma_f32_16x16x32_bf16 v[88:91], a[104:107], v[24:27], v[88:91]
v_mfma_f32_16x16x32_bf16 v[92:95], a[108:111], v[24:27], v[92:95]
buffer_load_dwordx4 v[24:27], v1, s[8:11], s24 offen offset:2048 sc1
s_waitcnt vmcnt(16) lgkmcnt(0)
v_mfma_f32_16x16x32_bf16 v[80:83], v[112:115], v[28:31], v[80:83]
v_mfma_f32_16x16x32_bf16 v[84:87], v[116:119], v[28:31], v[84:87]
v_mfma_f32_16x16x32_bf16 v[88:91], v[120:123], v[28:31], v[88:91]
v_mfma_f32_16x16x32_bf16 v[92:95], v[124:127], v[28:31], v[92:95]
buffer_load_dwordx4 v[28:31], v1, s[8:11], s24 offen offset:3072 sc1
s_waitcnt vmcnt(16)
v_mfma_f32_16x16x32_bf16 v[80:83], a[112:115], v[32:35], v[80:83]
ds_read_b64_tr_b16 v[112:113], v8 offset:20480
v_mfma_f32_16x16x32_bf16 v[84:87], a[116:119], v[32:35], v[84:87]
ds_read_b64_tr_b16 v[114:115], v8 offset:21504
v_mfma_f32_16x16x32_bf16 v[88:91], a[120:123], v[32:35], v[88:91]
s_add_u32 s24, s49, s31
ds_read_b64_tr_b16 v[116:117], v9 offset:20480
v_mfma_f32_16x16x32_bf16 v[92:95], a[124:127], v[32:35], v[92:95]
ds_read_b64_tr_b16 v[118:119], v9 offset:21504
buffer_load_dwordx4 v[32:35], v1, s[8:11], s24 offen sc1
s_waitcnt vmcnt(16)
v_mfma_f32_16x16x32_bf16 v[80:83], a[128:131], v[36:39], v[80:83]
ds_read_b64_tr_b16 v[120:121], v10 offset:20480
v_mfma_f32_16x16x32_bf16 v[84:87], a[132:135], v[36:39], v[84:87]
ds_read_b64_tr_b16 v[122:123], v10 offset:21504
v_mfma_f32_16x16x32_bf16 v[88:91], a[136:139], v[36:39], v[88:91]
ds_read_b64_tr_b16 v[124:125], v11 offset:20480
v_mfma_f32_16x16x32_bf16 v[92:95], a[140:143], v[36:39], v[92:95]
ds_read_b64_tr_b16 v[126:127], v11 offset:21504
buffer_load_dwordx4 v[36:39], v1, s[8:11], s24 offen offset:1024 sc1
s_waitcnt vmcnt(16)
v_mfma_f32_16x16x32_bf16 v[80:83], a[144:147], v[40:43], v[80:83]
v_mfma_f32_16x16x32_bf16 v[84:87], a[148:151], v[40:43], v[84:87]
v_mfma_f32_16x16x32_bf16 v[88:91], a[152:155], v[40:43], v[88:91]
v_mfma_f32_16x16x32_bf16 v[92:95], a[156:159], v[40:43], v[92:95]
buffer_load_dwordx4 v[40:43], v1, s[8:11], s24 offen offset:2048 sc1
s_waitcnt vmcnt(16) lgkmcnt(0)
v_mfma_f32_16x16x32_bf16 v[80:83], v[112:115], v[44:47], v[80:83]
v_mfma_f32_16x16x32_bf16 v[84:87], v[116:119], v[44:47], v[84:87]
v_mfma_f32_16x16x32_bf16 v[88:91], v[120:123], v[44:47], v[88:91]
v_mfma_f32_16x16x32_bf16 v[92:95], v[124:127], v[44:47], v[92:95]
buffer_load_dwordx4 v[44:47], v1, s[8:11], s24 offen offset:3072 sc1
s_waitcnt vmcnt(16)
v_mfma_f32_16x16x32_bf16 v[80:83], a[160:163], v[48:51], v[80:83]
ds_read_b64_tr_b16 v[112:113], v8 offset:24576
v_mfma_f32_16x16x32_bf16 v[84:87], a[164:167], v[48:51], v[84:87]
ds_read_b64_tr_b16 v[114:115], v8 offset:25600
v_mfma_f32_16x16x32_bf16 v[88:91], a[168:171], v[48:51], v[88:91]
s_add_u32 s24, s49, s32
ds_read_b64_tr_b16 v[116:117], v9 offset:24576
v_mfma_f32_16x16x32_bf16 v[92:95], a[172:175], v[48:51], v[92:95]
ds_read_b64_tr_b16 v[118:119], v9 offset:25600
buffer_load_dwordx4 v[48:51], v1, s[8:11], s24 offen sc1
s_waitcnt vmcnt(16)
v_mfma_f32_16x16x32_bf16 v[80:83], a[176:179], v[52:55], v[80:83]
ds_read_b64_tr_b16 v[120:121], v10 offset:24576
v_mfma_f32_16x16x32_bf16 v[84:87], a[180:183], v[52:55], v[84:87]
ds_read_b64_tr_b16 v[122:123], v10 offset:25600
v_mfma_f32_16x16x32_bf16 v[88:91], a[184:187], v[52:55], v[88:91]
ds_read_b64_tr_b16 v[124:125], v11 offset:24576
v_mfma_f32_16x16x32_bf16 v[92:95], a[188:191], v[52:55], v[92:95]
ds_read_b64_tr_b16 v[126:127], v11 offset:25600
buffer_load_dwordx4 v[52:55], v1, s[8:11], s24 offen offset:1024 sc1
s_waitcnt vmcnt(16)
v_mfma_f32_16x16x32_bf16 v[80:83], a[192:195], v[56:59], v[80:83]
v_mfma_f32_16x16x32_bf16 v[84:87], a[196:199], v[56:59], v[84:87]
v_mfma_f32_16x16x32_bf16 v[88:91], a[200:203], v[56:59], v[88:91]
v_mfma_f32_16x16x32_bf16 v[92:95], a[204:207], v[56:59], v[92:95]
buffer_load_dwordx4 v[56:59], v1, s[8:11], s24 offen offset:2048 sc1
s_waitcnt vmcnt(16) lgkmcnt(0)
v_mfma_f32_16x16x32_bf16 v[80:83], v[112:115], v[60:63], v[80:83]
v_mfma_f32_16x16x32_bf16 v[84:87], v[116:119], v[60:63], v[84:87]
v_mfma_f32_16x16x32_bf16 v[88:91], v[120:123], v[60:63], v[88:91]
v_mfma_f32_16x16x32_bf16 v[92:95], v[124:127], v[60:63], v[92:95]
buffer_load_dwordx4 v[60:63], v1, s[8:11], s24 offen offset:3072 sc1
s_waitcnt vmcnt(16)
v_mfma_f32_16x16x32_bf16 v[80:83], a[208:211], v[64:67], v[80:83]
ds_read_b64_tr_b16 v[112:113], v8 offset:28672
v_mfma_f32_16x16x32_bf16 v[84:87], a[212:215], v[64:67], v[84:87]
ds_read_b64_tr_b16 v[114:115], v8 offset:29696
v_mfma_f32_16x16x32_bf16 v[88:91], a[216:219], v[64:67], v[88:91]
s_add_u32 s24, s49, s33
ds_read_b64_tr_b16 v[116:117], v9 offset:28672
v_mfma_f32_16x16x32_bf16 v[92:95], a[220:223], v[64:67], v[92:95]
ds_read_b64_tr_b16 v[118:119], v9 offset:29696
buffer_load_dwordx4 v[64:67], v1, s[8:11], s24 offen sc1
s_waitcnt vmcnt(16)
v_mfma_f32_16x16x32_bf16 v[80:83], a[224:227], v[68:71], v[80:83]
ds_read_b64_tr_b16 v[120:121], v10 offset:28672
v_mfma_f32_16x16x32_bf16 v[84:87], a[228:231], v[68:71], v[84:87]
ds_read_b64_tr_b16 v[122:123], v10 offset:29696
v_mfma_f32_16x16x32_bf16 v[88:91], a[232:235], v[68:71], v[88:91]
ds_read_b64_tr_b16 v[124:125], v11 offset:28672
v_mfma_f32_16x16x32_bf16 v[92:95], a[236:239], v[68:71], v[92:95]
ds_read_b64_tr_b16 v[126:127], v11 offset:29696
buffer_load_dwordx4 v[68:71], v1, s[8:11], s24 offen offset:1024 sc1
s_waitcnt vmcnt(15)
v_mfma_f32_16x16x32_bf16 v[80:83], a[240:243], v[72:75], v[80:83]
v_mfma_f32_16x16x32_bf16 v[84:87], a[244:247], v[72:75], v[84:87]
v_mfma_f32_16x16x32_bf16 v[88:91], a[248:251], v[72:75], v[88:91]
v_mfma_f32_16x16x32_bf16 v[92:95], a[252:255], v[72:75], v[92:95]
buffer_load_dwordx4 v[72:75], v1, s[8:11], s24 offen offset:2048 sc1
s_waitcnt vmcnt(15) lgkmcnt(0)
v_mfma_f32_16x16x32_bf16 v[80:83], v[112:115], v[76:79], v[80:83]
v_mfma_f32_16x16x32_bf16 v[84:87], v[116:119], v[76:79], v[84:87]
v_mfma_f32_16x16x32_bf16 v[88:91], v[120:123], v[76:79], v[88:91]
v_mfma_f32_16x16x32_bf16 v[92:95], v[124:127], v[76:79], v[92:95]
buffer_load_dwordx4 v[76:79], v1, s[8:11], s24 offen offset:3072 sc1
s_mul_i32 s53, s41, 36864
s_mov_b32 s41, s27
s_mov_b32 s48, s49
s_cmp_eq_u32 s50, 0
s_cbranch_scc1 L_opl_c0
L_opl_r1:
s_waitcnt vmcnt(15)
v_mfma_f32_16x16x32_bf16 v[96:99], v[128:131], v[16:19], 0
s_cmp_lg_u64 s[42:43], 0
s_cselect_b32 s52, 1, 0
ds_read_b64_tr_b16 v[112:113], v8
v_mfma_f32_16x16x32_bf16 v[100:103], v[132:135], v[16:19], 0
s_ff1_i32_b64 s27, s[42:43]
ds_read_b64_tr_b16 v[114:115], v8 offset:1024
v_mfma_f32_16x16x32_bf16 v[104:107], v[136:139], v[16:19], 0
s_bitset0_b64 s[42:43], s27
s_add_u32 s24, s48, s34
ds_read_b64_tr_b16 v[116:117], v9
v_mfma_f32_16x16x32_bf16 v[108:111], v[140:143], v[16:19], 0
s_lshl_b32 s27, s27, 1
ds_read_b64_tr_b16 v[118:119], v9 offset:1024
buffer_load_dwordx4 v[16:19], v1, s[8:11], s24 offen sc1
s_waitcnt vmcnt(15)
v_mfma_f32_16x16x32_bf16 v[96:99], v[144:147], v[20:23], v[96:99]
s_xor_b32 s27, s27, s51
ds_read_b64_tr_b16 v[120:121], v10
v_mfma_f32_16x16x32_bf16 v[100:103], v[148:151], v[20:23], v[100:103]
s_and_b32 s27, s27, 127
ds_read_b64_tr_b16 v[122:123], v10 offset:1024
v_mfma_f32_16x16x32_bf16 v[104:107], v[152:155], v[20:23], v[104:107]
s_lshr_b32 s25, s27, s46
ds_read_b64_tr_b16 v[124:125], v11
v_mfma_f32_16x16x32_bf16 v[108:111], v[156:159], v[20:23], v[108:111]
s_lshl_b32 s25, s25, 7
ds_read_b64_tr_b16 v[126:127], v11 offset:1024
buffer_load_dwordx4 v[20:23], v1, s[8:11], s24 offen offset:1024 sc1
s_waitcnt vmcnt(15)
v_mfma_f32_16x16x32_bf16 v[96:99], v[160:163], v[24:27], v[96:99]
s_add_u32 s25, s25, s45
v_mfma_f32_16x16x32_bf16 v[100:103], v[164:167], v[24:27], v[100:103]
s_lshl_b32 s49, s27, 17
v_mfma_f32_16x16x32_bf16 v[104:107], v[168:171], v[24:27], v[104:107]
s_add_u32 s49, s49, s44
v_mfma_f32_16x16x32_bf16 v[108:111], v[172:175], v[24:27], v[108:111]
buffer_load_dwordx4 v[24:27], v1, s[8:11], s24 offen offset:2048 sc1
buffer_load_dword v6, v5, s[8:11], s25 offen sc1
s_waitcnt vmcnt(16) lgkmcnt(0)
v_mfma_f32_16x16x32_bf16 v[96:99], v[112:115], v[28:31], v[96:99]
ds_write_b128 v3, v[80:83]
v_mfma_f32_16x16x32_bf16 v[100:103], v[116:119], v[28:31], v[100:103]
ds_write_b128 v3, v[84:87] offset:4096
v_mfma_f32_16x16x32_bf16 v[104:107], v[120:123], v[28:31], v[104:107]
ds_write_b128 v3, v[88:91] offset:8192
v_mfma_f32_16x16x32_bf16 v[108:111], v[124:127], v[28:31], v[108:111]
ds_write_b128 v3, v[92:95] offset:12288
buffer_load_dwordx4 v[28:31], v1, s[8:11], s24 offen offset:3072 sc1
s_waitcnt vmcnt(16)
v_mfma_f32_16x16x32_bf16 v[96:99], v[176:179], v[32:35], v[96:99]
ds_read_b64_tr_b16 v[112:113], v8 offset:4096
v_mfma_f32_16x16x32_bf16 v[100:103], v[180:183], v[32:35], v[100:103]
ds_read_b64_tr_b16 v[114:115], v8 offset:5120
v_mfma_f32_16x16x32_bf16 v[104:107], v[184:187], v[32:35], v[104:107]
s_add_u32 s24, s48, s35
ds_read_b64_tr_b16 v[116:117], v9 offset:4096
v_mfma_f32_16x16x32_bf16 v[108:111], v[188:191], v[32:35], v[108:111]
ds_read_b64_tr_b16 v[118:119], v9 offset:5120
buffer_load_dwordx4 v[32:35], v1, s[8:11], s24 offen sc1
s_waitcnt vmcnt(16)
v_mfma_f32_16x16x32_bf16 v[96:99], v[192:195], v[36:39], v[96:99]
ds_read_b64_tr_b16 v[120:121], v10 offset:4096
v_mfma_f32_16x16x32_bf16 v[100:103], v[196:199], v[36:39], v[100:103]
ds_read_b64_tr_b16 v[122:123], v10 offset:5120
v_mfma_f32_16x16x32_bf16 v[104:107], v[200:203], v[36:39], v[104:107]
ds_read_b64_tr_b16 v[124:125], v11 offset:4096
v_mfma_f32_16x16x32_bf16 v[108:111], v[204:207], v[36:39], v[108:111]
ds_read_b64_tr_b16 v[126:127], v11 offset:5120
buffer_load_dwordx4 v[36:39], v1, s[8:11], s24 offen offset:1024 sc1
s_waitcnt vmcnt(16)
v_mfma_f32_16x16x32_bf16 v[96:99], v[208:211], v[40:43], v[96:99]
v_mfma_f32_16x16x32_bf16 v[100:103], v[212:215], v[40:43], v[100:103]
v_mfma_f32_16x16x32_bf16 v[104:107], v[216:219], v[40:43], v[104:107]
v_mfma_f32_16x16x32_bf16 v[108:111], v[220:223], v[40:43], v[108:111]
buffer_load_dwordx4 v[40:43], v1, s[8:11], s24 offen offset:2048 sc1
s_waitcnt vmcnt(16) lgkmcnt(0)
s_barrier
v_mfma_f32_16x16x32_bf16 v[96:99], v[112:115], v[44:47], v[96:99]
ds_read_b128 v[80:83], v7
v_mfma_f32_16x16x32_bf16 v[100:103], v[116:119], v[44:47], v[100:103]
ds_read_b128 v[84:87], v7 offset:1024
v_mfma_f32_16x16x32_bf16 v[104:107], v[120:123], v[44:47], v[104:107]
ds_read_b128 v[88:91], v7 offset:2048
v_mfma_f32_16x16x32_bf16 v[108:111], v[124:127], v[44:47], v[108:111]
ds_read_b128 v[92:95], v7 offset:3072
buffer_load_dwordx4 v[44:47], v1, s[8:11], s24 offen offset:3072 sc1
s_waitcnt vmcnt(16)
v_mfma_f32_16x16x32_bf16 v[96:99], v[224:227], v[48:51], v[96:99]
ds_read_b64_tr_b16 v[112:113], v8 offset:8192
v_mfma_f32_16x16x32_bf16 v[100:103], v[228:231], v[48:51], v[100:103]
ds_read_b64_tr_b16 v[114:115], v8 offset:9216
v_mfma_f32_16x16x32_bf16 v[104:107], v[232:235], v[48:51], v[104:107]
s_add_u32 s24, s48, s36
ds_read_b64_tr_b16 v[116:117], v9 offset:8192
v_mfma_f32_16x16x32_bf16 v[108:111], v[236:239], v[48:51], v[108:111]
ds_read_b64_tr_b16 v[118:119], v9 offset:9216
buffer_load_dwordx4 v[48:51], v1, s[8:11], s24 offen sc1
s_waitcnt vmcnt(16)
v_mfma_f32_16x16x32_bf16 v[96:99], v[240:243], v[52:55], v[96:99]
ds_read_b64_tr_b16 v[120:121], v10 offset:8192
v_mfma_f32_16x16x32_bf16 v[100:103], v[244:247], v[52:55], v[100:103]
ds_read_b64_tr_b16 v[122:123], v10 offset:9216
v_mfma_f32_16x16x32_bf16 v[104:107], v[248:251], v[52:55], v[104:107]
ds_read_b64_tr_b16 v[124:125], v11 offset:8192
v_mfma_f32_16x16x32_bf16 v[108:111], v[252:255], v[52:55], v[108:111]
ds_read_b64_tr_b16 v[126:127], v11 offset:9216
buffer_load_dwordx4 v[52:55], v1, s[8:11], s24 offen offset:1024 sc1
s_waitcnt vmcnt(16)
v_mfma_f32_16x16x32_bf16 v[96:99], a[0:3], v[56:59], v[96:99]
v_mfma_f32_16x16x32_bf16 v[100:103], a[4:7], v[56:59], v[100:103]
v_mfma_f32_16x16x32_bf16 v[104:107], a[8:11], v[56:59], v[104:107]
v_mfma_f32_16x16x32_bf16 v[108:111], a[12:15], v[56:59], v[108:111]
buffer_load_dwordx4 v[56:59], v1, s[8:11], s24 offen offset:2048 sc1
s_waitcnt vmcnt(16) lgkmcnt(0)
v_mfma_f32_16x16x32_bf16 v[96:99], v[112:115], v[60:63], v[96:99]
v_add_f32 v80, v80, v84
v_add_f32 v81, v81, v85
v_mfma_f32_16x16x32_bf16 v[100:103], v[116:119], v[60:63], v[100:103]
v_add_f32 v82, v82, v86
v_add_f32 v83, v83, v87
v_mfma_f32_16x16x32_bf16 v[104:107], v[120:123], v[60:63], v[104:107]
v_add_f32 v80, v80, v88
v_add_f32 v81, v81, v89
v_mfma_f32_16x16x32_bf16 v[108:111], v[124:127], v[60:63], v[108:111]
v_add_f32 v82, v82, v90
v_add_f32 v83, v83, v91
buffer_load_dwordx4 v[60:63], v1, s[8:11], s24 offen offset:3072 sc1
s_waitcnt vmcnt(16)
v_mfma_f32_16x16x32_bf16 v[96:99], a[16:19], v[64:67], v[96:99]
ds_read_b64_tr_b16 v[112:113], v8 offset:12288
v_add_f32 v80, v80, v92
v_mfma_f32_16x16x32_bf16 v[100:103], a[20:23], v[64:67], v[100:103]
ds_read_b64_tr_b16 v[114:115], v8 offset:13312
v_add_f32 v81, v81, v93
v_mfma_f32_16x16x32_bf16 v[104:107], a[24:27], v[64:67], v[104:107]
s_add_u32 s24, s48, s37
ds_read_b64_tr_b16 v[116:117], v9 offset:12288
v_add_f32 v82, v82, v94
v_mfma_f32_16x16x32_bf16 v[108:111], a[28:31], v[64:67], v[108:111]
ds_read_b64_tr_b16 v[118:119], v9 offset:13312
v_add_f32 v83, v83, v95
buffer_load_dwordx4 v[64:67], v1, s[8:11], s24 offen sc1
s_waitcnt vmcnt(16)
v_mfma_f32_16x16x32_bf16 v[96:99], a[32:35], v[68:71], v[96:99]
ds_read_b64_tr_b16 v[120:121], v10 offset:12288
v_cvt_pk_bf16_f32 v12, v80, v81
v_mfma_f32_16x16x32_bf16 v[100:103], a[36:39], v[68:71], v[100:103]
ds_read_b64_tr_b16 v[122:123], v10 offset:13312
v_cvt_pk_bf16_f32 v13, v82, v83
v_mfma_f32_16x16x32_bf16 v[104:107], a[40:43], v[68:71], v[104:107]
ds_read_b64_tr_b16 v[124:125], v11 offset:12288
v_xor_b32 v3, 16384, v3
v_mfma_f32_16x16x32_bf16 v[108:111], a[44:47], v[68:71], v[108:111]
ds_read_b64_tr_b16 v[126:127], v11 offset:13312
v_xor_b32 v7, 16384, v7
buffer_load_dwordx4 v[68:71], v1, s[8:11], s24 offen offset:1024 sc1
buffer_store_dwordx2 v[12:13], v4, s[12:15], s53 offen
L_opl_t1:
s_waitcnt vmcnt(17)
v_mfma_f32_16x16x32_bf16 v[96:99], a[48:51], v[72:75], v[96:99]
v_mfma_f32_16x16x32_bf16 v[100:103], a[52:55], v[72:75], v[100:103]
v_mfma_f32_16x16x32_bf16 v[104:107], a[56:59], v[72:75], v[104:107]
v_mfma_f32_16x16x32_bf16 v[108:111], a[60:63], v[72:75], v[108:111]
buffer_load_dwordx4 v[72:75], v1, s[8:11], s24 offen offset:2048 sc1
s_waitcnt vmcnt(17) lgkmcnt(0)
v_mfma_f32_16x16x32_bf16 v[96:99], v[112:115], v[76:79], v[96:99]
s_waitcnt vmcnt(13)
v_cmp_ne_u32 vcc, 1, v6
v_mfma_f32_16x16x32_bf16 v[100:103], v[116:119], v[76:79], v[100:103]
v_mfma_f32_16x16x32_bf16 v[104:107], v[120:123], v[76:79], v[104:107]
s_cmp_eq_u64 vcc, 0
s_cselect_b32 s50, s52, 0
v_mfma_f32_16x16x32_bf16 v[108:111], v[124:127], v[76:79], v[108:111]
buffer_load_dwordx4 v[76:79], v1, s[8:11], s24 offen offset:3072 sc1
s_waitcnt vmcnt(17)
v_mfma_f32_16x16x32_bf16 v[96:99], a[64:67], v[16:19], v[96:99]
s_cmp_eq_u32 s50, 1
s_cselect_b32 s49, s49, 536870912
ds_read_b64_tr_b16 v[112:113], v8 offset:16384
v_mfma_f32_16x16x32_bf16 v[100:103], a[68:71], v[16:19], v[100:103]
ds_read_b64_tr_b16 v[114:115], v8 offset:17408
v_mfma_f32_16x16x32_bf16 v[104:107], a[72:75], v[16:19], v[104:107]
s_add_u32 s24, s49, s30
ds_read_b64_tr_b16 v[116:117], v9 offset:16384
v_mfma_f32_16x16x32_bf16 v[108:111], a[76:79], v[16:19], v[108:111]
ds_read_b64_tr_b16 v[118:119], v9 offset:17408
buffer_load_dwordx4 v[16:19], v1, s[8:11], s24 offen sc1
s_waitcnt vmcnt(17)
v_mfma_f32_16x16x32_bf16 v[96:99], a[80:83], v[20:23], v[96:99]
ds_read_b64_tr_b16 v[120:121], v10 offset:16384
v_mfma_f32_16x16x32_bf16 v[100:103], a[84:87], v[20:23], v[100:103]
ds_read_b64_tr_b16 v[122:123], v10 offset:17408
v_mfma_f32_16x16x32_bf16 v[104:107], a[88:91], v[20:23], v[104:107]
ds_read_b64_tr_b16 v[124:125], v11 offset:16384
v_mfma_f32_16x16x32_bf16 v[108:111], a[92:95], v[20:23], v[108:111]
ds_read_b64_tr_b16 v[126:127], v11 offset:17408
buffer_load_dwordx4 v[20:23], v1, s[8:11], s24 offen offset:1024 sc1
s_waitcnt vmcnt(17)
v_mfma_f32_16x16x32_bf16 v[96:99], a[96:99], v[24:27], v[96:99]
v_mfma_f32_16x16x32_bf16 v[100:103], a[100:103], v[24:27], v[100:103]
v_mfma_f32_16x16x32_bf16 v[104:107], a[104:107], v[24:27], v[104:107]
v_mfma_f32_16x16x32_bf16 v[108:111], a[108:111], v[24:27], v[108:111]
buffer_load_dwordx4 v[24:27], v1, s[8:11], s24 offen offset:2048 sc1
s_waitcnt vmcnt(16) lgkmcnt(0)
v_mfma_f32_16x16x32_bf16 v[96:99], v[112:115], v[28:31], v[96:99]
v_mfma_f32_16x16x32_bf16 v[100:103], v[116:119], v[28:31], v[100:103]
v_mfma_f32_16x16x32_bf16 v[104:107], v[120:123], v[28:31], v[104:107]
v_mfma_f32_16x16x32_bf16 v[108:111], v[124:127], v[28:31], v[108:111]
buffer_load_dwordx4 v[28:31], v1, s[8:11], s24 offen offset:3072 sc1
s_waitcnt vmcnt(16)
v_mfma_f32_16x16x32_bf16 v[96:99], a[112:115], v[32:35], v[96:99]
ds_read_b64_tr_b16 v[112:113], v8 offset:20480
v_mfma_f32_16x16x32_bf16 v[100:103], a[116:119], v[32:35], v[100:103]
ds_read_b64_tr_b16 v[114:115], v8 offset:21504
v_mfma_f32_16x16x32_bf16 v[104:107], a[120:123], v[32:35], v[104:107]
s_add_u32 s24, s49, s31
ds_read_b64_tr_b16 v[116:117], v9 offset:20480
v_mfma_f32_16x16x32_bf16 v[108:111], a[124:127], v[32:35], v[108:111]
ds_read_b64_tr_b16 v[118:119], v9 offset:21504
buffer_load_dwordx4 v[32:35], v1, s[8:11], s24 offen sc1
s_waitcnt vmcnt(16)
v_mfma_f32_16x16x32_bf16 v[96:99], a[128:131], v[36:39], v[96:99]
ds_read_b64_tr_b16 v[120:121], v10 offset:20480
v_mfma_f32_16x16x32_bf16 v[100:103], a[132:135], v[36:39], v[100:103]
ds_read_b64_tr_b16 v[122:123], v10 offset:21504
v_mfma_f32_16x16x32_bf16 v[104:107], a[136:139], v[36:39], v[104:107]
ds_read_b64_tr_b16 v[124:125], v11 offset:20480
v_mfma_f32_16x16x32_bf16 v[108:111], a[140:143], v[36:39], v[108:111]
ds_read_b64_tr_b16 v[126:127], v11 offset:21504
buffer_load_dwordx4 v[36:39], v1, s[8:11], s24 offen offset:1024 sc1
s_waitcnt vmcnt(16)
v_mfma_f32_16x16x32_bf16 v[96:99], a[144:147], v[40:43], v[96:99]
v_mfma_f32_16x16x32_bf16 v[100:103], a[148:151], v[40:43], v[100:103]
v_mfma_f32_16x16x32_bf16 v[104:107], a[152:155], v[40:43], v[104:107]
v_mfma_f32_16x16x32_bf16 v[108:111], a[156:159], v[40:43], v[108:111]
buffer_load_dwordx4 v[40:43], v1, s[8:11], s24 offen offset:2048 sc1
s_waitcnt vmcnt(16) lgkmcnt(0)
v_mfma_f32_16x16x32_bf16 v[96:99], v[112:115], v[44:47], v[96:99]
v_mfma_f32_16x16x32_bf16 v[100:103], v[116:119], v[44:47], v[100:103]
v_mfma_f32_16x16x32_bf16 v[104:107], v[120:123], v[44:47], v[104:107]
v_mfma_f32_16x16x32_bf16 v[108:111], v[124:127], v[44:47], v[108:111]
buffer_load_dwordx4 v[44:47], v1, s[8:11], s24 offen offset:3072 sc1
s_waitcnt vmcnt(16)
v_mfma_f32_16x16x32_bf16 v[96:99], a[160:163], v[48:51], v[96:99]
ds_read_b64_tr_b16 v[112:113], v8 offset:24576
v_mfma_f32_16x16x32_bf16 v[100:103], a[164:167], v[48:51], v[100:103]
ds_read_b64_tr_b16 v[114:115], v8 offset:25600
v_mfma_f32_16x16x32_bf16 v[104:107], a[168:171], v[48:51], v[104:107]
s_add_u32 s24, s49, s32
ds_read_b64_tr_b16 v[116:117], v9 offset:24576
v_mfma_f32_16x16x32_bf16 v[108:111], a[172:175], v[48:51], v[108:111]
ds_read_b64_tr_b16 v[118:119], v9 offset:25600
buffer_load_dwordx4 v[48:51], v1, s[8:11], s24 offen sc1
s_waitcnt vmcnt(16)
v_mfma_f32_16x16x32_bf16 v[96:99], a[176:179], v[52:55], v[96:99]
ds_read_b64_tr_b16 v[120:121], v10 offset:24576
v_mfma_f32_16x16x32_bf16 v[100:103], a[180:183], v[52:55], v[100:103]
ds_read_b64_tr_b16 v[122:123], v10 offset:25600
v_mfma_f32_16x16x32_bf16 v[104:107], a[184:187], v[52:55], v[104:107]
ds_read_b64_tr_b16 v[124:125], v11 offset:24576
v_mfma_f32_16x16x32_bf16 v[108:111], a[188:191], v[52:55], v[108:111]
ds_read_b64_tr_b16 v[126:127], v11 offset:25600
buffer_load_dwordx4 v[52:55], v1, s[8:11], s24 offen offset:1024 sc1
s_waitcnt vmcnt(16)
v_mfma_f32_16x16x32_bf16 v[96:99], a[192:195], v[56:59], v[96:99]
v_mfma_f32_16x16x32_bf16 v[100:103], a[196:199], v[56:59], v[100:103]
v_mfma_f32_16x16x32_bf16 v[104:107], a[200:203], v[56:59], v[104:107]
v_mfma_f32_16x16x32_bf16 v[108:111], a[204:207], v[56:59], v[108:111]
buffer_load_dwordx4 v[56:59], v1, s[8:11], s24 offen offset:2048 sc1
s_waitcnt vmcnt(16) lgkmcnt(0)
v_mfma_f32_16x16x32_bf16 v[96:99], v[112:115], v[60:63], v[96:99]
v_mfma_f32_16x16x32_bf16 v[100:103], v[116:119], v[60:63], v[100:103]
v_mfma_f32_16x16x32_bf16 v[104:107], v[120:123], v[60:63], v[104:107]
v_mfma_f32_16x16x32_bf16 v[108:111], v[124:127], v[60:63], v[108:111]
buffer_load_dwordx4 v[60:63], v1, s[8:11], s24 offen offset:3072 sc1
s_waitcnt vmcnt(16)
v_mfma_f32_16x16x32_bf16 v[96:99], a[208:211], v[64:67], v[96:99]
ds_read_b64_tr_b16 v[112:113], v8 offset:28672
v_mfma_f32_16x16x32_bf16 v[100:103], a[212:215], v[64:67], v[100:103]
ds_read_b64_tr_b16 v[114:115], v8 offset:29696
v_mfma_f32_16x16x32_bf16 v[104:107], a[216:219], v[64:67], v[104:107]
s_add_u32 s24, s49, s33
ds_read_b64_tr_b16 v[116:117], v9 offset:28672
v_mfma_f32_16x16x32_bf16 v[108:111], a[220:223], v[64:67], v[108:111]
ds_read_b64_tr_b16 v[118:119], v9 offset:29696
buffer_load_dwordx4 v[64:67], v1, s[8:11], s24 offen sc1
s_waitcnt vmcnt(16)
v_mfma_f32_16x16x32_bf16 v[96:99], a[224:227], v[68:71], v[96:99]
ds_read_b64_tr_b16 v[120:121], v10 offset:28672
v_mfma_f32_16x16x32_bf16 v[100:103], a[228:231], v[68:71], v[100:103]
ds_read_b64_tr_b16 v[122:123], v10 offset:29696
v_mfma_f32_16x16x32_bf16 v[104:107], a[232:235], v[68:71], v[104:107]
ds_read_b64_tr_b16 v[124:125], v11 offset:28672
v_mfma_f32_16x16x32_bf16 v[108:111], a[236:239], v[68:71], v[108:111]
ds_read_b64_tr_b16 v[126:127], v11 offset:29696
buffer_load_dwordx4 v[68:71], v1, s[8:11], s24 offen offset:1024 sc1
s_waitcnt vmcnt(15)
v_mfma_f32_16x16x32_bf16 v[96:99], a[240:243], v[72:75], v[96:99]
v_mfma_f32_16x16x32_bf16 v[100:103], a[244:247], v[72:75], v[100:103]
v_mfma_f32_16x16x32_bf16 v[104:107], a[248:251], v[72:75], v[104:107]
v_mfma_f32_16x16x32_bf16 v[108:111], a[252:255], v[72:75], v[108:111]
buffer_load_dwordx4 v[72:75], v1, s[8:11], s24 offen offset:2048 sc1
s_waitcnt vmcnt(15) lgkmcnt(0)
v_mfma_f32_16x16x32_bf16 v[96:99], v[112:115], v[76:79], v[96:99]
v_mfma_f32_16x16x32_bf16 v[100:103], v[116:119], v[76:79], v[100:103]
v_mfma_f32_16x16x32_bf16 v[104:107], v[120:123], v[76:79], v[104:107]
v_mfma_f32_16x16x32_bf16 v[108:111], v[124:127], v[76:79], v[108:111]
buffer_load_dwordx4 v[76:79], v1, s[8:11], s24 offen offset:3072 sc1
s_mul_i32 s53, s41, 36864
s_mov_b32 s41, s27
s_mov_b32 s48, s49
s_cmp_eq_u32 s50, 0
s_cbranch_scc0 L_opl_r0
L_opl_c1:
ds_write_b128 v3, v[96:99]
ds_write_b128 v3, v[100:103] offset:4096
ds_write_b128 v3, v[104:107] offset:8192
ds_write_b128 v3, v[108:111] offset:12288
s_waitcnt lgkmcnt(0)
s_barrier
ds_read_b128 v[96:99], v7
ds_read_b128 v[100:103], v7 offset:1024
ds_read_b128 v[104:107], v7 offset:2048
ds_read_b128 v[108:111], v7 offset:3072
s_waitcnt lgkmcnt(2)
v_pk_add_f32 v[96:97], v[96:97], v[100:101]
v_pk_add_f32 v[98:99], v[98:99], v[102:103]
s_waitcnt lgkmcnt(1)
v_pk_add_f32 v[96:97], v[96:97], v[104:105]
v_pk_add_f32 v[98:99], v[98:99], v[106:107]
s_waitcnt lgkmcnt(0)
v_pk_add_f32 v[96:97], v[96:97], v[108:109]
v_pk_add_f32 v[98:99], v[98:99], v[110:111]
v_cvt_pk_bf16_f32 v12, v96, v97
v_cvt_pk_bf16_f32 v13, v98, v99
buffer_store_dwordx2 v[12:13], v4, s[12:15], s53 offen
v_xor_b32 v3, 16384, v3
v_xor_b32 v7, 16384, v7
s_cmp_lg_u32 s52, 0
s_cbranch_scc1 L_opl_w
s_branch L_opl_x
L_opl_c0:
ds_write_b128 v3, v[80:83]
ds_write_b128 v3, v[84:87] offset:4096
ds_write_b128 v3, v[88:91] offset:8192
ds_write_b128 v3, v[92:95] offset:12288
s_waitcnt lgkmcnt(0)
s_barrier
ds_read_b128 v[80:83], v7
ds_read_b128 v[84:87], v7 offset:1024
ds_read_b128 v[88:91], v7 offset:2048
ds_read_b128 v[92:95], v7 offset:3072
s_waitcnt lgkmcnt(2)
v_pk_add_f32 v[80:81], v[80:81], v[84:85]
v_pk_add_f32 v[82:83], v[82:83], v[86:87]
s_waitcnt lgkmcnt(1)
v_pk_add_f32 v[80:81], v[80:81], v[88:89]
v_pk_add_f32 v[82:83], v[82:83], v[90:91]
s_waitcnt lgkmcnt(0)
v_pk_add_f32 v[80:81], v[80:81], v[92:93]
v_pk_add_f32 v[82:83], v[82:83], v[94:95]
v_cvt_pk_bf16_f32 v12, v80, v81
v_cvt_pk_bf16_f32 v13, v82, v83
buffer_store_dwordx2 v[12:13], v4, s[12:15], s53 offen
v_xor_b32 v3, 16384, v3
v_xor_b32 v7, 16384, v7
s_cmp_lg_u32 s52, 0
s_cbranch_scc1 L_opl_w
L_opl_x:
s_branch L_done
L_team:
s_load_dwordx8 s[88:95], s[0:1], 64
s_load_dwordx2 s[96:97], s[0:1], 56
v_mov_b32 v12, v0
v_and_b32 v13, 15, v0
v_bfe_u32 v14, v0, 4, 2
v_lshlrev_b32 v3, 4, v12
v_and_b32 v2, 0x3f0, v3
s_mul_i32 s20, s17, 34816
s_add_u32 s20, s20, 24576
v_add_u32 v2, s20, v2
v_and_b32 v15, 1, v12
v_mul_u32_u24 v0, 0xaaaa, v15
v_add_u32 v0, 0xffff4444, v0
v_lshrrev_b32 v18, 2, v13
v_lshl_add_u32 v18, v18, 1, v15
v_bfe_u32 v19, v13, 1, 1
v_lshrrev_b32 v16, 5, v12
v_lshlrev_b32 v16, 8, v16
v_lshl_add_u32 v16, v18, 5, v16
v_and_b32 v17, 1, v14
v_lshl_add_u32 v16, v17, 4, v16
v_and_b32 v17, 0x7f, v16
v_xor_b32 v17, 16, v17
v_add_u32 v16, 4224, v16
v_add_u32 v17, 6272, v17
v_cmp_eq_u32 vcc, 1, v19
s_nop 1
v_cndmask_b32 v7, v17, v16, vcc
v_lshrrev_b32 v16, 1, v14
v_lshlrev_b32 v16, 8, v16
v_lshl_add_u32 v16, v15, 7, v16
v_and_b32 v17, 1, v14
v_lshl_add_u32 v16, v17, 6, v16
v_lshrrev_b32 v17, 2, v13
v_lshl_add_u32 v16, v17, 4, v16
v_mul_u32_u24 v17, 2112, v19
v_add_u32 v5, v16, v17
v_bfe_u32 v16, v13, 3, 1
v_lshlrev_b32 v16, 8, v16
v_lshl_add_u32 v16, v19, 6, v16
v_lshl_add_u32 v16, v14, 4, v16
v_bfe_u32 v17, v13, 2, 1
v_lshl_add_u32 v16, v17, 3, v16
v_lshl_add_u32 v16, v15, 2, v16
s_lshl_b32 s20, s17, 9
v_add_u32 v4, s20, v16
v_lshrrev_b32 v16, 4, v12
v_xor_b32 v17, s16, v16
v_lshlrev_b32 v16, 12, v16
v_lshl_add_u32 v16, v17, 7, v16
v_lshl_add_u32 v9, v13, 3, v16
s_lshr_b32 s20, s17, 1
s_lshl_b32 s20, s20, 2
v_add_u32 v16, s20, v14
v_xor_b32 v17, s16, v16
v_lshlrev_b32 v16, 12, v16
v_lshl_add_u32 v16, v17, 7, v16
v_lshl_add_u32 v16, v13, 2, v16
s_and_b32 s20, s17, 1
s_lshl_b32 s20, s20, 6
s_add_u32 s20, s20, 262144
v_add_u32 v10, s20, v16
v_bfe_u32 v16, v13, 2, 1
v_lshlrev_b32 v16, 5, v16
v_and_b32 v17, 1, v14
v_lshl_add_u32 v16, v17, 8, v16
v_lshrrev_b32 v17, 1, v14
v_lshl_add_u32 v16, v17, 4, v16
v_and_b32 v17, 3, v13
v_lshl_add_u32 v11, v17, 2, v16
v_lshlrev_b32 v6, 7, v12
v_lshlrev_b32 v8, 2, v12
s_mov_b32 s36, 0x11111111
s_mov_b32 s37, 0x11111111
s_mov_b32 s38, 0x22222222
s_mov_b32 s39, 0x22222222
s_mov_b32 s40, 0x44444444
s_mov_b32 s41, 0x44444444
s_mov_b32 s42, 0x88888888
s_mov_b32 s43, 0x88888888
s_mov_b32 s44, 0xf0f0f0f0
s_mov_b32 s45, 0xf0f0f0f0
s_mov_b32 s18, 0x3e0293ee
s_lshl_b32 s20, s17, 5
s_add_u32 s20, s20, s16
s_cmp_lt_u32 s20, 72
s_cselect_b32 s48, 1, 0
s_lshl_b32 s23, s20, 12
s_lshl_b32 s21, s17, 10
s_sub_u32 s23, s23, s21
s_lshr_b32 s24, s20, 2
s_lshl_b32 s24, s24, 9
s_and_b32 s21, s20, 3
s_lshl_b32 s21, s21, 6
s_add_u32 s24, s24, s21
s_add_u32 s24, s24, 110100480
s_cmp_lt_u32 s20, 72
s_cselect_b32 s24, s24, 536870912
s_lshl_b32 s25, s16, 12
s_add_u32 s26, s25, 131072
s_add_u32 s27, s25, 262144
s_cmp_lt_u32 s16, 8
s_cselect_b32 s27, s27, 536870912
s_mov_b32 s28, 109051904
s_mov_b32 s29, 109346816
s_lshl_b32 s30, s16, 14
s_add_u32 s30, s30, 33554432
s_lshl_b32 s31, s16, 12
s_add_u32 s31, s31, 100663296
s_add_u32 s35, s24, 32768
s_mov_b32 s53, 0x3f803f80
s_mov_b32 s86, 0x33333333
s_mov_b32 s87, 0x33333333
s_lshl_b32 s84, s17, 13
s_sub_u32 s84, s20, s84
s_add_u32 s84, s84, 110886912
s_cmp_lt_u32 s20, 72
s_cselect_b32 s84, s84, 536870912
s_and_b32 s21, s16, 3
s_lshl_b32 s21, s21, 7
s_add_u32 s21, s21, 110886144
s_cmp_eq_u32 s17, 3
s_cselect_b32 s84, s21, s84
s_lshl_b32 s82, s16, 7
s_add_u32 s83, s82, 111152384
s_add_u32 s82, s82, 111148288
s_mov_b32 s19, 0
v_mov_b32 v64, -1
v_mov_b32 v65, -1
v_mov_b32 v66, -1
v_mov_b32 v67, -1
s_add_u32 s20, s28, s25
buffer_store_dwordx4 v[64:67], v3, s[8:11], s20 offen
s_add_u32 s20, s28, s26
buffer_store_dwordx4 v[64:67], v3, s[8:11], s20 offen
s_add_u32 s20, s28, s27
buffer_store_dwordx4 v[64:67], v3, s[8:11], s20 offen
s_add_u32 s20, s29, s25
buffer_store_dwordx4 v[64:67], v3, s[8:11], s20 offen
s_add_u32 s20, s29, s26
buffer_store_dwordx4 v[64:67], v3, s[8:11], s20 offen
s_add_u32 s20, s29, s27
buffer_store_dwordx4 v[64:67], v3, s[8:11], s20 offen
s_add_u32 s20, s24, 16384
buffer_store_dword v64, v11, s[8:11], s20 offen
s_cmp_eq_u32 s17, 3
s_cselect_b32 s20, 536870912, s84
s_mov_b64 exec, 15
buffer_store_byte v64, v6, s[8:11], s20 offen
s_mov_b64 exec, -1
v_lshrrev_b32 v0, 4, v3
s_waitcnt lgkmcnt(0)
s_mov_b32 s46, 0x05040100
s_mov_b32 s47, 0x07060302
v_and_b32 v3, 63, v0
v_lshlrev_b32 v3, 4, v3
s_mul_i32 s20, s17, 34816
s_add_u32 s20, s20, 24576
v_add_u32 v3, s20, v3
v_bfe_u32 v64, v0, 5, 1
v_bfe_u32 v65, v0, 4, 1
v_and_b32 v66, 15, v0
v_lshlrev_b32 v1, 17, v64
v_lshl_add_u32 v1, v65, 14, v1
v_lshl_add_u32 v1, v66, 2, v1
s_lshl_b32 s20, s16, 8
s_lshl_b32 s21, s17, 6
s_add_u32 s20, s20, s21
v_add_u32 v1, s20, v1
v_lshlrev_b32 v2, 4, v64
v_lshl_add_u32 v2, v65, 2, v2
v_mul_u32_u24 v2, 1152, v2
s_mul_i32 s20, s16, 147456
v_add_u32 v2, s20, v2
v_and_b32 v4, 15, v0
s_lshl_b32 s20, s17, 4
v_add_u32 v4, s20, v4
v_lshlrev_b32 v4, 1, v4
v_add_u32 v2, v2, v4
v_add_u32 v4, v2, v4
s_barrier
s_mov_b32 s12, s90
s_and_b32 s13, s91, 0xffff
s_mov_b32 s14, 4718592
s_mov_b32 s15, 0x20000
s_mov_b32 s20, 0
buffer_load_dword v6, v1, s[12:15], s20 offen
s_mov_b32 s21, 32768
buffer_load_dword v7, v1, s[12:15], s21 offen
s_mov_b32 s20, 65536
buffer_load_dword v8, v1, s[12:15], s20 offen
s_mov_b32 s21, 98304
buffer_load_dword v9, v1, s[12:15], s21 offen
s_mov_b32 s20, 8192
buffer_load_dword v10, v1, s[12:15], s20 offen
s_mov_b32 s21, 40960
buffer_load_dword v11, v1, s[12:15], s21 offen
s_mov_b32 s20, 73728
buffer_load_dword v12, v1, s[12:15], s20 offen
s_mov_b32 s21, 106496
buffer_load_dword v13, v1, s[12:15], s21 offen
s_barrier
s_mov_b32 s20, 262144
buffer_load_dword v14, v1, s[12:15], s20 offen
s_mov_b32 s21, 294912
buffer_load_dword v15, v1, s[12:15], s21 offen
s_mov_b32 s20, 327680
buffer_load_dword v16, v1, s[12:15], s20 offen
s_mov_b32 s21, 360448
buffer_load_dword v17, v1, s[12:15], s21 offen
s_mov_b32 s20, 270336
buffer_load_dword v18, v1, s[12:15], s20 offen
s_mov_b32 s21, 303104
buffer_load_dword v19, v1, s[12:15], s21 offen
s_mov_b32 s20, 335872
buffer_load_dword v20, v1, s[12:15], s20 offen
s_mov_b32 s21, 368640
buffer_load_dword v21, v1, s[12:15], s21 offen
s_barrier
s_mov_b32 s12, s92
s_and_b32 s13, s93, 0xffff
s_mov_b32 s14, 4718592
s_mov_b32 s15, 0x20000
s_mov_b32 s20, 0
buffer_load_dword v22, v1, s[12:15], s20 offen
s_mov_b32 s21, 32768
buffer_load_dword v23, v1, s[12:15], s21 offen
s_mov_b32 s20, 65536
buffer_load_dword v24, v1, s[12:15], s20 offen
s_mov_b32 s21, 98304
buffer_load_dword v25, v1, s[12:15], s21 offen
s_mov_b32 s20, 8192
buffer_load_dword v26, v1, s[12:15], s20 offen
s_mov_b32 s21, 40960
buffer_load_dword v27, v1, s[12:15], s21 offen
s_mov_b32 s20, 73728
buffer_load_dword v28, v1, s[12:15], s20 offen
s_mov_b32 s21, 106496
buffer_load_dword v29, v1, s[12:15], s21 offen
s_barrier
s_mov_b32 s20, 262144
buffer_load_dword v30, v1, s[12:15], s20 offen
s_mov_b32 s21, 294912
buffer_load_dword v31, v1, s[12:15], s21 offen
s_mov_b32 s20, 327680
buffer_load_dword v32, v1, s[12:15], s20 offen
s_mov_b32 s21, 360448
buffer_load_dword v33, v1, s[12:15], s21 offen
s_mov_b32 s20, 270336
buffer_load_dword v34, v1, s[12:15], s20 offen
s_mov_b32 s21, 303104
buffer_load_dword v35, v1, s[12:15], s21 offen
s_mov_b32 s20, 335872
buffer_load_dword v36, v1, s[12:15], s20 offen
s_mov_b32 s21, 368640
buffer_load_dword v37, v1, s[12:15], s21 offen
s_barrier
s_mov_b32 s12, s90
s_and_b32 s13, s91, 0xffff
s_mov_b32 s14, 4718592
s_mov_b32 s15, 0x20000
s_mov_b32 s20, 524288
buffer_load_dword v38, v1, s[12:15], s20 offen
s_mov_b32 s21, 557056
buffer_load_dword v39, v1, s[12:15], s21 offen
s_mov_b32 s20, 589824
buffer_load_dword v40, v1, s[12:15], s20 offen
s_mov_b32 s21, 622592
buffer_load_dword v41, v1, s[12:15], s21 offen
s_mov_b32 s20, 532480
buffer_load_dword v42, v1, s[12:15], s20 offen
s_mov_b32 s21, 565248
buffer_load_dword v43, v1, s[12:15], s21 offen
s_mov_b32 s20, 598016
buffer_load_dword v44, v1, s[12:15], s20 offen
s_mov_b32 s21, 630784
buffer_load_dword v45, v1, s[12:15], s21 offen
s_barrier
s_mov_b32 s20, 786432
buffer_load_dword v46, v1, s[12:15], s20 offen
s_mov_b32 s21, 819200
buffer_load_dword v47, v1, s[12:15], s21 offen
s_mov_b32 s20, 851968
buffer_load_dword v48, v1, s[12:15], s20 offen
s_mov_b32 s21, 884736
buffer_load_dword v49, v1, s[12:15], s21 offen
s_mov_b32 s20, 794624
buffer_load_dword v50, v1, s[12:15], s20 offen
s_mov_b32 s21, 827392
buffer_load_dword v51, v1, s[12:15], s21 offen
s_mov_b32 s20, 860160
buffer_load_dword v52, v1, s[12:15], s20 offen
s_mov_b32 s21, 892928
buffer_load_dword v53, v1, s[12:15], s21 offen
s_barrier
s_mov_b32 s12, s92
s_and_b32 s13, s93, 0xffff
s_mov_b32 s14, 4718592
s_mov_b32 s15, 0x20000
s_mov_b32 s20, 524288
buffer_load_dword v54, v1, s[12:15], s20 offen
s_mov_b32 s21, 557056
buffer_load_dword v55, v1, s[12:15], s21 offen
s_mov_b32 s20, 589824
buffer_load_dword v56, v1, s[12:15], s20 offen
s_mov_b32 s21, 622592
buffer_load_dword v57, v1, s[12:15], s21 offen
s_mov_b32 s20, 532480
buffer_load_dword v58, v1, s[12:15], s20 offen
s_mov_b32 s21, 565248
buffer_load_dword v59, v1, s[12:15], s21 offen
s_mov_b32 s20, 598016
buffer_load_dword v60, v1, s[12:15], s20 offen
s_mov_b32 s21, 630784
buffer_load_dword v61, v1, s[12:15], s21 offen
s_waitcnt vmcnt(54)
v_perm_b32 v88, v7, v6, s46
v_perm_b32 v68, v7, v6, s47
s_barrier
s_mov_b32 s20, 786432
buffer_load_dword v6, v1, s[12:15], s20 offen
s_mov_b32 s21, 819200
buffer_load_dword v7, v1, s[12:15], s21 offen
s_waitcnt vmcnt(54)
v_perm_b32 v89, v9, v8, s46
v_perm_b32 v69, v9, v8, s47
s_mov_b32 s20, 851968
buffer_load_dword v8, v1, s[12:15], s20 offen
s_mov_b32 s21, 884736
buffer_load_dword v9, v1, s[12:15], s21 offen
s_waitcnt vmcnt(54)
v_perm_b32 v90, v11, v10, s46
v_perm_b32 v70, v11, v10, s47
s_mov_b32 s20, 794624
buffer_load_dword v10, v1, s[12:15], s20 offen
s_mov_b32 s21, 827392
buffer_load_dword v11, v1, s[12:15], s21 offen
s_waitcnt vmcnt(54)
v_perm_b32 v91, v13, v12, s46
v_perm_b32 v71, v13, v12, s47
ds_write_b128 v3, v[68:71]
s_waitcnt lgkmcnt(0)
s_mov_b32 s20, 860160
buffer_load_dword v12, v1, s[12:15], s20 offen
s_mov_b32 s21, 892928
buffer_load_dword v13, v1, s[12:15], s21 offen
s_waitcnt vmcnt(54)
v_perm_b32 v92, v15, v14, s46
v_perm_b32 v68, v15, v14, s47
s_barrier
s_cmp_eq_u32 s17, 0
s_cselect_b32 s98, 64, 536870912
v_mov_b32 v5, 1
s_mov_b64 exec, 1
buffer_atomic_add v5, v0, s[56:59], s98 offen
s_mov_b64 exec, -1
s_mov_b32 s12, s90
s_and_b32 s13, s91, 0xffff
s_mov_b32 s14, 4718592
s_mov_b32 s15, 0x20000
s_mov_b32 s20, 1048576
buffer_load_dword v14, v1, s[12:15], s20 offen
s_mov_b32 s21, 1081344
buffer_load_dword v15, v1, s[12:15], s21 offen
s_waitcnt vmcnt(55)
v_perm_b32 v93, v17, v16, s46
v_perm_b32 v69, v17, v16, s47
s_mov_b32 s20, 1114112
buffer_load_dword v16, v1, s[12:15], s20 offen
s_mov_b32 s21, 1146880
buffer_load_dword v17, v1, s[12:15], s21 offen
s_waitcnt vmcnt(55)
v_perm_b32 v94, v19, v18, s46
v_perm_b32 v70, v19, v18, s47
s_mov_b32 s20, 1056768
buffer_load_dword v18, v1, s[12:15], s20 offen
s_mov_b32 s21, 1089536
buffer_load_dword v19, v1, s[12:15], s21 offen
s_waitcnt vmcnt(55)
v_perm_b32 v95, v21, v20, s46
v_perm_b32 v71, v21, v20, s47
ds_write_b128 v3, v[68:71] offset:1024
s_waitcnt lgkmcnt(0)
s_mov_b32 s20, 1122304
buffer_load_dword v20, v1, s[12:15], s20 offen
s_mov_b32 s21, 1155072
buffer_load_dword v21, v1, s[12:15], s21 offen
s_waitcnt vmcnt(55)
v_perm_b32 v64, v23, v22, s46
v_accvgpr_write_b32 a32, v64
v_perm_b32 v68, v23, v22, s47
v_accvgpr_write_b32 a40, v68
s_barrier
s_mov_b32 s20, 1310720
buffer_load_dword v22, v1, s[12:15], s20 offen
s_mov_b32 s21, 1343488
buffer_load_dword v23, v1, s[12:15], s21 offen
s_waitcnt vmcnt(55)
v_perm_b32 v65, v25, v24, s46
v_accvgpr_write_b32 a33, v65
v_perm_b32 v69, v25, v24, s47
v_accvgpr_write_b32 a41, v69
s_mov_b32 s20, 1376256
buffer_load_dword v24, v1, s[12:15], s20 offen
s_mov_b32 s21, 1409024
buffer_load_dword v25, v1, s[12:15], s21 offen
s_waitcnt vmcnt(55)
v_perm_b32 v66, v27, v26, s46
v_accvgpr_write_b32 a34, v66
v_perm_b32 v70, v27, v26, s47
v_accvgpr_write_b32 a42, v70
s_mov_b32 s20, 1318912
buffer_load_dword v26, v1, s[12:15], s20 offen
s_mov_b32 s21, 1351680
buffer_load_dword v27, v1, s[12:15], s21 offen
s_waitcnt vmcnt(55)
v_perm_b32 v67, v29, v28, s46
v_accvgpr_write_b32 a35, v67
v_perm_b32 v71, v29, v28, s47
v_accvgpr_write_b32 a43, v71
s_mov_b32 s20, 1384448
buffer_load_dword v28, v1, s[12:15], s20 offen
s_mov_b32 s21, 1417216
buffer_load_dword v29, v1, s[12:15], s21 offen
s_waitcnt vmcnt(55)
v_perm_b32 v64, v31, v30, s46
v_accvgpr_write_b32 a36, v64
v_perm_b32 v68, v31, v30, s47
v_accvgpr_write_b32 a44, v68
s_barrier
s_mov_b32 s12, s92
s_and_b32 s13, s93, 0xffff
s_mov_b32 s14, 4718592
s_mov_b32 s15, 0x20000
s_mov_b32 s20, 1048576
buffer_load_dword v30, v1, s[12:15], s20 offen
s_mov_b32 s21, 1081344
buffer_load_dword v31, v1, s[12:15], s21 offen
s_waitcnt vmcnt(55)
v_perm_b32 v65, v33, v32, s46
v_accvgpr_write_b32 a37, v65
v_perm_b32 v69, v33, v32, s47
v_accvgpr_write_b32 a45, v69
s_mov_b32 s20, 1114112
buffer_load_dword v32, v1, s[12:15], s20 offen
s_mov_b32 s21, 1146880
buffer_load_dword v33, v1, s[12:15], s21 offen
s_waitcnt vmcnt(55)
v_perm_b32 v66, v35, v34, s46
v_accvgpr_write_b32 a38, v66
v_perm_b32 v70, v35, v34, s47
v_accvgpr_write_b32 a46, v70
s_mov_b32 s20, 1056768
buffer_load_dword v34, v1, s[12:15], s20 offen
s_mov_b32 s21, 1089536
buffer_load_dword v35, v1, s[12:15], s21 offen
s_waitcnt vmcnt(55)
v_perm_b32 v67, v37, v36, s46
v_accvgpr_write_b32 a39, v67
v_perm_b32 v71, v37, v36, s47
v_accvgpr_write_b32 a47, v71
s_mov_b32 s20, 1122304
buffer_load_dword v36, v1, s[12:15], s20 offen
s_mov_b32 s21, 1155072
buffer_load_dword v37, v1, s[12:15], s21 offen
s_waitcnt vmcnt(55)
v_perm_b32 v112, v39, v38, s46
v_perm_b32 v68, v39, v38, s47
s_barrier
s_mov_b32 s20, 1310720
buffer_load_dword v38, v1, s[12:15], s20 offen
s_mov_b32 s21, 1343488
buffer_load_dword v39, v1, s[12:15], s21 offen
s_waitcnt vmcnt(55)
v_perm_b32 v113, v41, v40, s46
v_perm_b32 v69, v41, v40, s47
s_mov_b32 s20, 1376256
buffer_load_dword v40, v1, s[12:15], s20 offen
s_mov_b32 s21, 1409024
buffer_load_dword v41, v1, s[12:15], s21 offen
s_waitcnt vmcnt(55)
v_perm_b32 v114, v43, v42, s46
v_perm_b32 v70, v43, v42, s47
s_mov_b32 s20, 1318912
buffer_load_dword v42, v1, s[12:15], s20 offen
s_mov_b32 s21, 1351680
buffer_load_dword v43, v1, s[12:15], s21 offen
s_waitcnt vmcnt(55)
v_perm_b32 v115, v45, v44, s46
v_perm_b32 v71, v45, v44, s47
ds_write_b128 v3, v[68:71] offset:2048
s_waitcnt lgkmcnt(0)
s_mov_b32 s20, 1384448
buffer_load_dword v44, v1, s[12:15], s20 offen
s_mov_b32 s21, 1417216
buffer_load_dword v45, v1, s[12:15], s21 offen
s_waitcnt vmcnt(55)
v_perm_b32 v116, v47, v46, s46
v_perm_b32 v68, v47, v46, s47
s_barrier
s_mov_b32 s12, s90
s_and_b32 s13, s91, 0xffff
s_mov_b32 s14, 4718592
s_mov_b32 s15, 0x20000
s_mov_b32 s20, 1572864
buffer_load_dword v46, v1, s[12:15], s20 offen
s_mov_b32 s21, 1605632
buffer_load_dword v47, v1, s[12:15], s21 offen
s_waitcnt vmcnt(55)
v_perm_b32 v117, v49, v48, s46
v_perm_b32 v69, v49, v48, s47
s_mov_b32 s20, 1638400
buffer_load_dword v48, v1, s[12:15], s20 offen
s_mov_b32 s21, 1671168
buffer_load_dword v49, v1, s[12:15], s21 offen
s_waitcnt vmcnt(55)
v_perm_b32 v118, v51, v50, s46
v_perm_b32 v70, v51, v50, s47
s_mov_b32 s20, 1581056
buffer_load_dword v50, v1, s[12:15], s20 offen
s_mov_b32 s21, 1613824
buffer_load_dword v51, v1, s[12:15], s21 offen
s_waitcnt vmcnt(55)
v_perm_b32 v119, v53, v52, s46
v_perm_b32 v71, v53, v52, s47
ds_write_b128 v3, v[68:71] offset:3072
s_waitcnt lgkmcnt(0)
s_mov_b32 s20, 1646592
buffer_load_dword v52, v1, s[12:15], s20 offen
s_mov_b32 s21, 1679360
buffer_load_dword v53, v1, s[12:15], s21 offen
s_waitcnt vmcnt(55)
v_perm_b32 v64, v55, v54, s46
v_accvgpr_write_b32 a48, v64
v_perm_b32 v68, v55, v54, s47
v_accvgpr_write_b32 a56, v68
s_barrier
s_mov_b32 s20, 1835008
buffer_load_dword v54, v1, s[12:15], s20 offen
s_mov_b32 s21, 1867776
buffer_load_dword v55, v1, s[12:15], s21 offen
s_waitcnt vmcnt(55)
v_perm_b32 v65, v57, v56, s46
v_accvgpr_write_b32 a49, v65
v_perm_b32 v69, v57, v56, s47
v_accvgpr_write_b32 a57, v69
s_mov_b32 s20, 1900544
buffer_load_dword v56, v1, s[12:15], s20 offen
s_mov_b32 s21, 1933312
buffer_load_dword v57, v1, s[12:15], s21 offen
s_waitcnt vmcnt(55)
v_perm_b32 v66, v59, v58, s46
v_accvgpr_write_b32 a50, v66
v_perm_b32 v70, v59, v58, s47
v_accvgpr_write_b32 a58, v70
s_mov_b32 s20, 1843200
buffer_load_dword v58, v1, s[12:15], s20 offen
s_mov_b32 s21, 1875968
buffer_load_dword v59, v1, s[12:15], s21 offen
s_waitcnt vmcnt(55)
v_perm_b32 v67, v61, v60, s46
v_accvgpr_write_b32 a51, v67
v_perm_b32 v71, v61, v60, s47
v_accvgpr_write_b32 a59, v71
s_mov_b32 s20, 1908736
buffer_load_dword v60, v1, s[12:15], s20 offen
s_mov_b32 s21, 1941504
buffer_load_dword v61, v1, s[12:15], s21 offen
s_waitcnt vmcnt(55)
v_perm_b32 v64, v7, v6, s46
v_accvgpr_write_b32 a52, v64
v_perm_b32 v68, v7, v6, s47
v_accvgpr_write_b32 a60, v68
s_barrier
s_mov_b32 s12, s92
s_and_b32 s13, s93, 0xffff
s_mov_b32 s14, 4718592
s_mov_b32 s15, 0x20000
s_mov_b32 s20, 1572864
buffer_load_dword v6, v1, s[12:15], s20 offen
s_mov_b32 s21, 1605632
buffer_load_dword v7, v1, s[12:15], s21 offen
s_waitcnt vmcnt(55)
v_perm_b32 v65, v9, v8, s46
v_accvgpr_write_b32 a53, v65
v_perm_b32 v69, v9, v8, s47
v_accvgpr_write_b32 a61, v69
s_mov_b32 s20, 1638400
buffer_load_dword v8, v1, s[12:15], s20 offen
s_mov_b32 s21, 1671168
buffer_load_dword v9, v1, s[12:15], s21 offen
s_waitcnt vmcnt(55)
v_perm_b32 v66, v11, v10, s46
v_accvgpr_write_b32 a54, v66
v_perm_b32 v70, v11, v10, s47
v_accvgpr_write_b32 a62, v70
s_mov_b32 s20, 1581056
buffer_load_dword v10, v1, s[12:15], s20 offen
s_mov_b32 s21, 1613824
buffer_load_dword v11, v1, s[12:15], s21 offen
s_waitcnt vmcnt(55)
v_perm_b32 v67, v13, v12, s46
v_accvgpr_write_b32 a55, v67
v_perm_b32 v71, v13, v12, s47
v_accvgpr_write_b32 a63, v71
s_mov_b32 s20, 1646592
buffer_load_dword v12, v1, s[12:15], s20 offen
s_mov_b32 s21, 1679360
buffer_load_dword v13, v1, s[12:15], s21 offen
s_waitcnt vmcnt(54)
v_perm_b32 v136, v15, v14, s46
v_perm_b32 v68, v15, v14, s47
s_barrier
s_mov_b32 s20, 1835008
buffer_load_dword v14, v1, s[12:15], s20 offen
s_mov_b32 s21, 1867776
buffer_load_dword v15, v1, s[12:15], s21 offen
s_waitcnt vmcnt(54)
v_perm_b32 v137, v17, v16, s46
v_perm_b32 v69, v17, v16, s47
s_mov_b32 s20, 1900544
buffer_load_dword v16, v1, s[12:15], s20 offen
s_mov_b32 s21, 1933312
buffer_load_dword v17, v1, s[12:15], s21 offen
s_waitcnt vmcnt(54)
v_perm_b32 v138, v19, v18, s46
v_perm_b32 v70, v19, v18, s47
s_mov_b32 s20, 1843200
buffer_load_dword v18, v1, s[12:15], s20 offen
s_mov_b32 s21, 1875968
buffer_load_dword v19, v1, s[12:15], s21 offen
s_waitcnt vmcnt(54)
v_perm_b32 v139, v21, v20, s46
v_perm_b32 v71, v21, v20, s47
ds_write_b128 v3, v[68:71] offset:4096
s_waitcnt lgkmcnt(0)
s_mov_b32 s20, 1908736
buffer_load_dword v20, v1, s[12:15], s20 offen
s_mov_b32 s21, 1941504
buffer_load_dword v21, v1, s[12:15], s21 offen
s_waitcnt vmcnt(54)
v_perm_b32 v140, v23, v22, s46
v_perm_b32 v68, v23, v22, s47
s_barrier
s_mov_b32 s12, s90
s_and_b32 s13, s91, 0xffff
s_mov_b32 s14, 4718592
s_mov_b32 s15, 0x20000
s_mov_b32 s20, 2097152
buffer_load_dword v22, v1, s[12:15], s20 offen
s_mov_b32 s21, 2129920
buffer_load_dword v23, v1, s[12:15], s21 offen
s_waitcnt vmcnt(54)
v_perm_b32 v141, v25, v24, s46
v_perm_b32 v69, v25, v24, s47
s_mov_b32 s20, 2162688
buffer_load_dword v24, v1, s[12:15], s20 offen
s_mov_b32 s21, 2195456
buffer_load_dword v25, v1, s[12:15], s21 offen
s_waitcnt vmcnt(54)
v_perm_b32 v142, v27, v26, s46
v_perm_b32 v70, v27, v26, s47
s_mov_b32 s20, 2105344
buffer_load_dword v26, v1, s[12:15], s20 offen
s_mov_b32 s21, 2138112
buffer_load_dword v27, v1, s[12:15], s21 offen
s_waitcnt vmcnt(54)
v_perm_b32 v143, v29, v28, s46
v_perm_b32 v71, v29, v28, s47
ds_write_b128 v3, v[68:71] offset:5120
s_waitcnt lgkmcnt(0)
s_mov_b32 s20, 2170880
buffer_load_dword v28, v1, s[12:15], s20 offen
s_mov_b32 s21, 2203648
buffer_load_dword v29, v1, s[12:15], s21 offen
s_waitcnt vmcnt(54)
v_perm_b32 v64, v31, v30, s46
v_accvgpr_write_b32 a64, v64
v_perm_b32 v68, v31, v30, s47
v_accvgpr_write_b32 a72, v68
s_barrier
s_mov_b32 s20, 2359296
buffer_load_dword v30, v1, s[12:15], s20 offen
s_mov_b32 s21, 2392064
buffer_load_dword v31, v1, s[12:15], s21 offen
s_waitcnt vmcnt(54)
v_perm_b32 v65, v33, v32, s46
v_accvgpr_write_b32 a65, v65
v_perm_b32 v69, v33, v32, s47
v_accvgpr_write_b32 a73, v69
s_mov_b32 s20, 2424832
buffer_load_dword v32, v1, s[12:15], s20 offen
s_mov_b32 s21, 2457600
buffer_load_dword v33, v1, s[12:15], s21 offen
s_waitcnt vmcnt(54)
v_perm_b32 v66, v35, v34, s46
v_accvgpr_write_b32 a66, v66
v_perm_b32 v70, v35, v34, s47
v_accvgpr_write_b32 a74, v70
s_mov_b32 s20, 2367488
buffer_load_dword v34, v1, s[12:15], s20 offen
s_mov_b32 s21, 2400256
buffer_load_dword v35, v1, s[12:15], s21 offen
s_waitcnt vmcnt(54)
v_perm_b32 v67, v37, v36, s46
v_accvgpr_write_b32 a67, v67
v_perm_b32 v71, v37, v36, s47
v_accvgpr_write_b32 a75, v71
s_mov_b32 s20, 2433024
buffer_load_dword v36, v1, s[12:15], s20 offen
s_mov_b32 s21, 2465792
buffer_load_dword v37, v1, s[12:15], s21 offen
s_waitcnt vmcnt(54)
v_perm_b32 v64, v39, v38, s46
v_accvgpr_write_b32 a68, v64
v_perm_b32 v68, v39, v38, s47
v_accvgpr_write_b32 a76, v68
s_barrier
s_mov_b32 s12, s92
s_and_b32 s13, s93, 0xffff
s_mov_b32 s14, 4718592
s_mov_b32 s15, 0x20000
s_mov_b32 s20, 2097152
buffer_load_dword v38, v1, s[12:15], s20 offen
s_mov_b32 s21, 2129920
buffer_load_dword v39, v1, s[12:15], s21 offen
s_waitcnt vmcnt(54)
v_perm_b32 v65, v41, v40, s46
v_accvgpr_write_b32 a69, v65
v_perm_b32 v69, v41, v40, s47
v_accvgpr_write_b32 a77, v69
s_mov_b32 s20, 2162688
buffer_load_dword v40, v1, s[12:15], s20 offen
s_mov_b32 s21, 2195456
buffer_load_dword v41, v1, s[12:15], s21 offen
s_waitcnt vmcnt(54)
v_perm_b32 v66, v43, v42, s46
v_accvgpr_write_b32 a70, v66
v_perm_b32 v70, v43, v42, s47
v_accvgpr_write_b32 a78, v70
s_mov_b32 s20, 2105344
buffer_load_dword v42, v1, s[12:15], s20 offen
s_mov_b32 s21, 2138112
buffer_load_dword v43, v1, s[12:15], s21 offen
s_waitcnt vmcnt(54)
v_perm_b32 v67, v45, v44, s46
v_accvgpr_write_b32 a71, v67
v_perm_b32 v71, v45, v44, s47
v_accvgpr_write_b32 a79, v71
s_mov_b32 s20, 2170880
buffer_load_dword v44, v1, s[12:15], s20 offen
s_mov_b32 s21, 2203648
buffer_load_dword v45, v1, s[12:15], s21 offen
s_waitcnt vmcnt(54)
v_perm_b32 v160, v47, v46, s46
v_perm_b32 v68, v47, v46, s47
s_barrier
s_mov_b32 s20, 2359296
buffer_load_dword v46, v1, s[12:15], s20 offen
s_mov_b32 s21, 2392064
buffer_load_dword v47, v1, s[12:15], s21 offen
s_waitcnt vmcnt(54)
v_perm_b32 v161, v49, v48, s46
v_perm_b32 v69, v49, v48, s47
s_mov_b32 s20, 2424832
buffer_load_dword v48, v1, s[12:15], s20 offen
s_mov_b32 s21, 2457600
buffer_load_dword v49, v1, s[12:15], s21 offen
s_waitcnt vmcnt(54)
v_perm_b32 v162, v51, v50, s46
v_perm_b32 v70, v51, v50, s47
s_mov_b32 s20, 2367488
buffer_load_dword v50, v1, s[12:15], s20 offen
s_mov_b32 s21, 2400256
buffer_load_dword v51, v1, s[12:15], s21 offen
s_waitcnt vmcnt(54)
v_perm_b32 v163, v53, v52, s46
v_perm_b32 v71, v53, v52, s47
ds_write_b128 v3, v[68:71] offset:6144
s_waitcnt lgkmcnt(0)
s_mov_b32 s20, 2433024
buffer_load_dword v52, v1, s[12:15], s20 offen
s_mov_b32 s21, 2465792
buffer_load_dword v53, v1, s[12:15], s21 offen
s_waitcnt vmcnt(54)
v_perm_b32 v164, v55, v54, s46
v_perm_b32 v68, v55, v54, s47
s_barrier
s_mov_b32 s12, s90
s_and_b32 s13, s91, 0xffff
s_mov_b32 s14, 4718592
s_mov_b32 s15, 0x20000
s_mov_b32 s20, 2621440
buffer_load_dword v54, v1, s[12:15], s20 offen
s_mov_b32 s21, 2654208
buffer_load_dword v55, v1, s[12:15], s21 offen
s_waitcnt vmcnt(54)
v_perm_b32 v165, v57, v56, s46
v_perm_b32 v69, v57, v56, s47
s_mov_b32 s20, 2686976
buffer_load_dword v56, v1, s[12:15], s20 offen
s_mov_b32 s21, 2719744
buffer_load_dword v57, v1, s[12:15], s21 offen
s_waitcnt vmcnt(54)
v_perm_b32 v166, v59, v58, s46
v_perm_b32 v70, v59, v58, s47
s_mov_b32 s20, 2629632
buffer_load_dword v58, v1, s[12:15], s20 offen
s_mov_b32 s21, 2662400
buffer_load_dword v59, v1, s[12:15], s21 offen
s_waitcnt vmcnt(54)
v_perm_b32 v167, v61, v60, s46
v_perm_b32 v71, v61, v60, s47
ds_write_b128 v3, v[68:71] offset:7168
s_waitcnt lgkmcnt(0)
s_mov_b32 s20, 2695168
buffer_load_dword v60, v1, s[12:15], s20 offen
s_mov_b32 s21, 2727936
buffer_load_dword v61, v1, s[12:15], s21 offen
s_waitcnt vmcnt(54)
v_perm_b32 v64, v7, v6, s46
v_accvgpr_write_b32 a80, v64
v_perm_b32 v68, v7, v6, s47
v_accvgpr_write_b32 a88, v68
s_barrier
s_mov_b32 s20, 2883584
buffer_load_dword v6, v1, s[12:15], s20 offen
s_mov_b32 s21, 2916352
buffer_load_dword v7, v1, s[12:15], s21 offen
s_waitcnt vmcnt(54)
v_perm_b32 v65, v9, v8, s46
v_accvgpr_write_b32 a81, v65
v_perm_b32 v69, v9, v8, s47
v_accvgpr_write_b32 a89, v69
s_mov_b32 s20, 2949120
buffer_load_dword v8, v1, s[12:15], s20 offen
s_mov_b32 s21, 2981888
buffer_load_dword v9, v1, s[12:15], s21 offen
s_waitcnt vmcnt(54)
v_perm_b32 v66, v11, v10, s46
v_accvgpr_write_b32 a82, v66
v_perm_b32 v70, v11, v10, s47
v_accvgpr_write_b32 a90, v70
s_mov_b32 s20, 2891776
buffer_load_dword v10, v1, s[12:15], s20 offen
s_mov_b32 s21, 2924544
buffer_load_dword v11, v1, s[12:15], s21 offen
s_waitcnt vmcnt(54)
v_perm_b32 v67, v13, v12, s46
v_accvgpr_write_b32 a83, v67
v_perm_b32 v71, v13, v12, s47
v_accvgpr_write_b32 a91, v71
s_mov_b32 s20, 2957312
buffer_load_dword v12, v1, s[12:15], s20 offen
s_mov_b32 s21, 2990080
buffer_load_dword v13, v1, s[12:15], s21 offen
s_waitcnt vmcnt(54)
v_perm_b32 v64, v15, v14, s46
v_accvgpr_write_b32 a84, v64
v_perm_b32 v68, v15, v14, s47
v_accvgpr_write_b32 a92, v68
s_barrier
s_mov_b32 s12, s92
s_and_b32 s13, s93, 0xffff
s_mov_b32 s14, 4718592
s_mov_b32 s15, 0x20000
s_mov_b32 s20, 2621440
buffer_load_dword v14, v1, s[12:15], s20 offen
s_mov_b32 s21, 2654208
buffer_load_dword v15, v1, s[12:15], s21 offen
s_waitcnt vmcnt(54)
v_perm_b32 v65, v17, v16, s46
v_accvgpr_write_b32 a85, v65
v_perm_b32 v69, v17, v16, s47
v_accvgpr_write_b32 a93, v69
s_mov_b32 s20, 2686976
buffer_load_dword v16, v1, s[12:15], s20 offen
s_mov_b32 s21, 2719744
buffer_load_dword v17, v1, s[12:15], s21 offen
s_waitcnt vmcnt(54)
v_perm_b32 v66, v19, v18, s46
v_accvgpr_write_b32 a86, v66
v_perm_b32 v70, v19, v18, s47
v_accvgpr_write_b32 a94, v70
s_mov_b32 s20, 2629632
buffer_load_dword v18, v1, s[12:15], s20 offen
s_mov_b32 s21, 2662400
buffer_load_dword v19, v1, s[12:15], s21 offen
s_waitcnt vmcnt(54)
v_perm_b32 v67, v21, v20, s46
v_accvgpr_write_b32 a87, v67
v_perm_b32 v71, v21, v20, s47
v_accvgpr_write_b32 a95, v71
s_mov_b32 s20, 2695168
buffer_load_dword v20, v1, s[12:15], s20 offen
s_mov_b32 s21, 2727936
buffer_load_dword v21, v1, s[12:15], s21 offen
s_waitcnt vmcnt(54)
v_perm_b32 v184, v23, v22, s46
v_perm_b32 v68, v23, v22, s47
s_barrier
s_mov_b32 s20, 2883584
buffer_load_dword v22, v1, s[12:15], s20 offen
s_mov_b32 s21, 2916352
buffer_load_dword v23, v1, s[12:15], s21 offen
s_waitcnt vmcnt(54)
v_perm_b32 v185, v25, v24, s46
v_perm_b32 v69, v25, v24, s47
s_mov_b32 s20, 2949120
buffer_load_dword v24, v1, s[12:15], s20 offen
s_mov_b32 s21, 2981888
buffer_load_dword v25, v1, s[12:15], s21 offen
s_waitcnt vmcnt(54)
v_perm_b32 v186, v27, v26, s46
v_perm_b32 v70, v27, v26, s47
s_mov_b32 s20, 2891776
buffer_load_dword v26, v1, s[12:15], s20 offen
s_mov_b32 s21, 2924544
buffer_load_dword v27, v1, s[12:15], s21 offen
s_waitcnt vmcnt(54)
v_perm_b32 v187, v29, v28, s46
v_perm_b32 v71, v29, v28, s47
ds_write_b128 v3, v[68:71] offset:8192
s_waitcnt lgkmcnt(0)
s_mov_b32 s20, 2957312
buffer_load_dword v28, v1, s[12:15], s20 offen
s_mov_b32 s21, 2990080
buffer_load_dword v29, v1, s[12:15], s21 offen
s_waitcnt vmcnt(54)
v_perm_b32 v188, v31, v30, s46
v_perm_b32 v68, v31, v30, s47
s_barrier
s_mov_b32 s12, s90
s_and_b32 s13, s91, 0xffff
s_mov_b32 s14, 4718592
s_mov_b32 s15, 0x20000
s_mov_b32 s20, 3145728
buffer_load_dword v30, v1, s[12:15], s20 offen
s_mov_b32 s21, 3178496
buffer_load_dword v31, v1, s[12:15], s21 offen
s_waitcnt vmcnt(54)
v_perm_b32 v189, v33, v32, s46
v_perm_b32 v69, v33, v32, s47
s_mov_b32 s20, 3211264
buffer_load_dword v32, v1, s[12:15], s20 offen
s_mov_b32 s21, 3244032
buffer_load_dword v33, v1, s[12:15], s21 offen
s_waitcnt vmcnt(54)
v_perm_b32 v190, v35, v34, s46
v_perm_b32 v70, v35, v34, s47
s_mov_b32 s20, 3153920
buffer_load_dword v34, v1, s[12:15], s20 offen
s_mov_b32 s21, 3186688
buffer_load_dword v35, v1, s[12:15], s21 offen
s_waitcnt vmcnt(54)
v_perm_b32 v191, v37, v36, s46
v_perm_b32 v71, v37, v36, s47
ds_write_b128 v3, v[68:71] offset:9216
s_waitcnt lgkmcnt(0)
s_mov_b32 s20, 3219456
buffer_load_dword v36, v1, s[12:15], s20 offen
s_mov_b32 s21, 3252224
buffer_load_dword v37, v1, s[12:15], s21 offen
s_waitcnt vmcnt(54)
v_perm_b32 v64, v39, v38, s46
v_accvgpr_write_b32 a96, v64
v_perm_b32 v68, v39, v38, s47
v_accvgpr_write_b32 a104, v68
s_barrier
s_mov_b32 s20, 3407872
buffer_load_dword v38, v1, s[12:15], s20 offen
s_mov_b32 s21, 3440640
buffer_load_dword v39, v1, s[12:15], s21 offen
s_waitcnt vmcnt(54)
v_perm_b32 v65, v41, v40, s46
v_accvgpr_write_b32 a97, v65
v_perm_b32 v69, v41, v40, s47
v_accvgpr_write_b32 a105, v69
s_mov_b32 s20, 3473408
buffer_load_dword v40, v1, s[12:15], s20 offen
s_mov_b32 s21, 3506176
buffer_load_dword v41, v1, s[12:15], s21 offen
s_waitcnt vmcnt(54)
v_perm_b32 v66, v43, v42, s46
v_accvgpr_write_b32 a98, v66
v_perm_b32 v70, v43, v42, s47
v_accvgpr_write_b32 a106, v70
s_mov_b32 s20, 3416064
buffer_load_dword v42, v1, s[12:15], s20 offen
s_mov_b32 s21, 3448832
buffer_load_dword v43, v1, s[12:15], s21 offen
s_waitcnt vmcnt(54)
v_perm_b32 v67, v45, v44, s46
v_accvgpr_write_b32 a99, v67
v_perm_b32 v71, v45, v44, s47
v_accvgpr_write_b32 a107, v71
s_mov_b32 s20, 3481600
buffer_load_dword v44, v1, s[12:15], s20 offen
s_mov_b32 s21, 3514368
buffer_load_dword v45, v1, s[12:15], s21 offen
s_waitcnt vmcnt(54)
v_perm_b32 v64, v47, v46, s46
v_accvgpr_write_b32 a100, v64
v_perm_b32 v68, v47, v46, s47
v_accvgpr_write_b32 a108, v68
s_barrier
s_mov_b32 s12, s92
s_and_b32 s13, s93, 0xffff
s_mov_b32 s14, 4718592
s_mov_b32 s15, 0x20000
s_mov_b32 s20, 3145728
buffer_load_dword v46, v1, s[12:15], s20 offen
s_mov_b32 s21, 3178496
buffer_load_dword v47, v1, s[12:15], s21 offen
s_waitcnt vmcnt(54)
v_perm_b32 v65, v49, v48, s46
v_accvgpr_write_b32 a101, v65
v_perm_b32 v69, v49, v48, s47
v_accvgpr_write_b32 a109, v69
s_mov_b32 s20, 3211264
buffer_load_dword v48, v1, s[12:15], s20 offen
s_mov_b32 s21, 3244032
buffer_load_dword v49, v1, s[12:15], s21 offen
s_waitcnt vmcnt(54)
v_perm_b32 v66, v51, v50, s46
v_accvgpr_write_b32 a102, v66
v_perm_b32 v70, v51, v50, s47
v_accvgpr_write_b32 a110, v70
s_mov_b32 s20, 3153920
buffer_load_dword v50, v1, s[12:15], s20 offen
s_mov_b32 s21, 3186688
buffer_load_dword v51, v1, s[12:15], s21 offen
s_waitcnt vmcnt(54)
v_perm_b32 v67, v53, v52, s46
v_accvgpr_write_b32 a103, v67
v_perm_b32 v71, v53, v52, s47
v_accvgpr_write_b32 a111, v71
s_mov_b32 s20, 3219456
buffer_load_dword v52, v1, s[12:15], s20 offen
s_mov_b32 s21, 3252224
buffer_load_dword v53, v1, s[12:15], s21 offen
s_waitcnt vmcnt(54)
v_perm_b32 v208, v55, v54, s46
v_perm_b32 v68, v55, v54, s47
s_barrier
s_mov_b32 s20, 3407872
buffer_load_dword v54, v1, s[12:15], s20 offen
s_mov_b32 s21, 3440640
buffer_load_dword v55, v1, s[12:15], s21 offen
s_waitcnt vmcnt(54)
v_perm_b32 v209, v57, v56, s46
v_perm_b32 v69, v57, v56, s47
s_mov_b32 s20, 3473408
buffer_load_dword v56, v1, s[12:15], s20 offen
s_mov_b32 s21, 3506176
buffer_load_dword v57, v1, s[12:15], s21 offen
s_waitcnt vmcnt(54)
v_perm_b32 v210, v59, v58, s46
v_perm_b32 v70, v59, v58, s47
s_mov_b32 s20, 3416064
buffer_load_dword v58, v1, s[12:15], s20 offen
s_mov_b32 s21, 3448832
buffer_load_dword v59, v1, s[12:15], s21 offen
s_waitcnt vmcnt(54)
v_perm_b32 v211, v61, v60, s46
v_perm_b32 v71, v61, v60, s47
ds_write_b128 v3, v[68:71] offset:10240
s_waitcnt lgkmcnt(0)
s_mov_b32 s20, 3481600
buffer_load_dword v60, v1, s[12:15], s20 offen
s_mov_b32 s21, 3514368
buffer_load_dword v61, v1, s[12:15], s21 offen
s_waitcnt vmcnt(54)
v_perm_b32 v212, v7, v6, s46
v_perm_b32 v68, v7, v6, s47
s_barrier
s_mov_b32 s12, s90
s_and_b32 s13, s91, 0xffff
s_mov_b32 s14, 4718592
s_mov_b32 s15, 0x20000
s_mov_b32 s20, 3670016
buffer_load_dword v6, v1, s[12:15], s20 offen
s_mov_b32 s21, 3702784
buffer_load_dword v7, v1, s[12:15], s21 offen
s_waitcnt vmcnt(54)
v_perm_b32 v213, v9, v8, s46
v_perm_b32 v69, v9, v8, s47
s_mov_b32 s20, 3735552
buffer_load_dword v8, v1, s[12:15], s20 offen
s_mov_b32 s21, 3768320
buffer_load_dword v9, v1, s[12:15], s21 offen
s_waitcnt vmcnt(54)
v_perm_b32 v214, v11, v10, s46
v_perm_b32 v70, v11, v10, s47
s_mov_b32 s20, 3678208
buffer_load_dword v10, v1, s[12:15], s20 offen
s_mov_b32 s21, 3710976
buffer_load_dword v11, v1, s[12:15], s21 offen
s_waitcnt vmcnt(54)
v_perm_b32 v215, v13, v12, s46
v_perm_b32 v71, v13, v12, s47
ds_write_b128 v3, v[68:71] offset:11264
s_waitcnt lgkmcnt(0)
s_mov_b32 s20, 3743744
buffer_load_dword v12, v1, s[12:15], s20 offen
s_mov_b32 s21, 3776512
buffer_load_dword v13, v1, s[12:15], s21 offen
s_waitcnt vmcnt(54)
v_perm_b32 v64, v15, v14, s46
v_accvgpr_write_b32 a112, v64
v_perm_b32 v68, v15, v14, s47
v_accvgpr_write_b32 a120, v68
s_barrier
s_mov_b32 s20, 3932160
buffer_load_dword v14, v1, s[12:15], s20 offen
s_mov_b32 s21, 3964928
buffer_load_dword v15, v1, s[12:15], s21 offen
s_waitcnt vmcnt(54)
v_perm_b32 v65, v17, v16, s46
v_accvgpr_write_b32 a113, v65
v_perm_b32 v69, v17, v16, s47
v_accvgpr_write_b32 a121, v69
s_mov_b32 s20, 3997696
buffer_load_dword v16, v1, s[12:15], s20 offen
s_mov_b32 s21, 4030464
buffer_load_dword v17, v1, s[12:15], s21 offen
s_waitcnt vmcnt(54)
v_perm_b32 v66, v19, v18, s46
v_accvgpr_write_b32 a114, v66
v_perm_b32 v70, v19, v18, s47
v_accvgpr_write_b32 a122, v70
s_mov_b32 s20, 3940352
buffer_load_dword v18, v1, s[12:15], s20 offen
s_mov_b32 s21, 3973120
buffer_load_dword v19, v1, s[12:15], s21 offen
s_waitcnt vmcnt(54)
v_perm_b32 v67, v21, v20, s46
v_accvgpr_write_b32 a115, v67
v_perm_b32 v71, v21, v20, s47
v_accvgpr_write_b32 a123, v71
s_mov_b32 s20, 4005888
buffer_load_dword v20, v1, s[12:15], s20 offen
s_mov_b32 s21, 4038656
buffer_load_dword v21, v1, s[12:15], s21 offen
s_waitcnt vmcnt(54)
v_perm_b32 v64, v23, v22, s46
v_accvgpr_write_b32 a116, v64
v_perm_b32 v68, v23, v22, s47
v_accvgpr_write_b32 a124, v68
s_barrier
s_mov_b32 s12, s92
s_and_b32 s13, s93, 0xffff
s_mov_b32 s14, 4718592
s_mov_b32 s15, 0x20000
s_mov_b32 s20, 3670016
buffer_load_dword v22, v1, s[12:15], s20 offen
s_mov_b32 s21, 3702784
buffer_load_dword v23, v1, s[12:15], s21 offen
s_waitcnt vmcnt(54)
v_perm_b32 v65, v25, v24, s46
v_accvgpr_write_b32 a117, v65
v_perm_b32 v69, v25, v24, s47
v_accvgpr_write_b32 a125, v69
s_mov_b32 s20, 3735552
buffer_load_dword v24, v1, s[12:15], s20 offen
s_mov_b32 s21, 3768320
buffer_load_dword v25, v1, s[12:15], s21 offen
s_waitcnt vmcnt(54)
v_perm_b32 v66, v27, v26, s46
v_accvgpr_write_b32 a118, v66
v_perm_b32 v70, v27, v26, s47
v_accvgpr_write_b32 a126, v70
s_mov_b32 s20, 3678208
buffer_load_dword v26, v1, s[12:15], s20 offen
s_mov_b32 s21, 3710976
buffer_load_dword v27, v1, s[12:15], s21 offen
s_waitcnt vmcnt(54)
v_perm_b32 v67, v29, v28, s46
v_accvgpr_write_b32 a119, v67
v_perm_b32 v71, v29, v28, s47
v_accvgpr_write_b32 a127, v71
s_mov_b32 s20, 3743744
buffer_load_dword v28, v1, s[12:15], s20 offen
s_mov_b32 s21, 3776512
buffer_load_dword v29, v1, s[12:15], s21 offen
s_waitcnt vmcnt(54)
v_perm_b32 v232, v31, v30, s46
v_perm_b32 v68, v31, v30, s47
s_barrier
s_mov_b32 s20, 3932160
buffer_load_dword v30, v1, s[12:15], s20 offen
s_mov_b32 s21, 3964928
buffer_load_dword v31, v1, s[12:15], s21 offen
s_waitcnt vmcnt(54)
v_perm_b32 v233, v33, v32, s46
v_perm_b32 v69, v33, v32, s47
s_mov_b32 s20, 3997696
buffer_load_dword v32, v1, s[12:15], s20 offen
s_mov_b32 s21, 4030464
buffer_load_dword v33, v1, s[12:15], s21 offen
s_waitcnt vmcnt(54)
v_perm_b32 v234, v35, v34, s46
v_perm_b32 v70, v35, v34, s47
s_mov_b32 s20, 3940352
buffer_load_dword v34, v1, s[12:15], s20 offen
s_mov_b32 s21, 3973120
buffer_load_dword v35, v1, s[12:15], s21 offen
s_waitcnt vmcnt(54)
v_perm_b32 v235, v37, v36, s46
v_perm_b32 v71, v37, v36, s47
ds_write_b128 v3, v[68:71] offset:12288
s_waitcnt lgkmcnt(0)
s_mov_b32 s20, 4005888
buffer_load_dword v36, v1, s[12:15], s20 offen
s_mov_b32 s21, 4038656
buffer_load_dword v37, v1, s[12:15], s21 offen
s_waitcnt vmcnt(54)
v_perm_b32 v236, v39, v38, s46
v_perm_b32 v68, v39, v38, s47
s_barrier
s_mov_b32 s12, s90
s_and_b32 s13, s91, 0xffff
s_mov_b32 s14, 4718592
s_mov_b32 s15, 0x20000
s_mov_b32 s20, 4194304
buffer_load_dword v38, v1, s[12:15], s20 offen
s_mov_b32 s21, 4227072
buffer_load_dword v39, v1, s[12:15], s21 offen
s_waitcnt vmcnt(54)
v_perm_b32 v237, v41, v40, s46
v_perm_b32 v69, v41, v40, s47
s_mov_b32 s20, 4259840
buffer_load_dword v40, v1, s[12:15], s20 offen
s_mov_b32 s21, 4292608
buffer_load_dword v41, v1, s[12:15], s21 offen
s_waitcnt vmcnt(54)
v_perm_b32 v238, v43, v42, s46
v_perm_b32 v70, v43, v42, s47
s_mov_b32 s20, 4202496
buffer_load_dword v42, v1, s[12:15], s20 offen
s_mov_b32 s21, 4235264
buffer_load_dword v43, v1, s[12:15], s21 offen
s_waitcnt vmcnt(54)
v_perm_b32 v239, v45, v44, s46
v_perm_b32 v71, v45, v44, s47
ds_write_b128 v3, v[68:71] offset:13312
s_waitcnt lgkmcnt(0)
s_mov_b32 s20, 4268032
buffer_load_dword v44, v1, s[12:15], s20 offen
s_mov_b32 s21, 4300800
buffer_load_dword v45, v1, s[12:15], s21 offen
s_waitcnt vmcnt(54)
v_perm_b32 v64, v47, v46, s46
v_accvgpr_write_b32 a128, v64
v_perm_b32 v68, v47, v46, s47
v_accvgpr_write_b32 a136, v68
s_barrier
s_mov_b32 s20, 4456448
buffer_load_dword v46, v1, s[12:15], s20 offen
s_mov_b32 s21, 4489216
buffer_load_dword v47, v1, s[12:15], s21 offen
s_waitcnt vmcnt(54)
v_perm_b32 v65, v49, v48, s46
v_accvgpr_write_b32 a129, v65
v_perm_b32 v69, v49, v48, s47
v_accvgpr_write_b32 a137, v69
s_mov_b32 s20, 4521984
buffer_load_dword v48, v1, s[12:15], s20 offen
s_mov_b32 s21, 4554752
buffer_load_dword v49, v1, s[12:15], s21 offen
s_waitcnt vmcnt(54)
v_perm_b32 v66, v51, v50, s46
v_accvgpr_write_b32 a130, v66
v_perm_b32 v70, v51, v50, s47
v_accvgpr_write_b32 a138, v70
s_mov_b32 s20, 4464640
buffer_load_dword v50, v1, s[12:15], s20 offen
s_mov_b32 s21, 4497408
buffer_load_dword v51, v1, s[12:15], s21 offen
s_waitcnt vmcnt(54)
v_perm_b32 v67, v53, v52, s46
v_accvgpr_write_b32 a131, v67
v_perm_b32 v71, v53, v52, s47
v_accvgpr_write_b32 a139, v71
s_mov_b32 s20, 4530176
buffer_load_dword v52, v1, s[12:15], s20 offen
s_mov_b32 s21, 4562944
buffer_load_dword v53, v1, s[12:15], s21 offen
s_waitcnt vmcnt(54)
v_perm_b32 v64, v55, v54, s46
v_accvgpr_write_b32 a132, v64
v_perm_b32 v68, v55, v54, s47
v_accvgpr_write_b32 a140, v68
s_barrier
s_mov_b32 s12, s92
s_and_b32 s13, s93, 0xffff
s_mov_b32 s14, 4718592
s_mov_b32 s15, 0x20000
s_mov_b32 s20, 4194304
buffer_load_dword v54, v1, s[12:15], s20 offen
s_mov_b32 s21, 4227072
buffer_load_dword v55, v1, s[12:15], s21 offen
s_waitcnt vmcnt(54)
v_perm_b32 v65, v57, v56, s46
v_accvgpr_write_b32 a133, v65
v_perm_b32 v69, v57, v56, s47
v_accvgpr_write_b32 a141, v69
s_mov_b32 s20, 4259840
buffer_load_dword v56, v1, s[12:15], s20 offen
s_mov_b32 s21, 4292608
buffer_load_dword v57, v1, s[12:15], s21 offen
s_waitcnt vmcnt(54)
v_perm_b32 v66, v59, v58, s46
v_accvgpr_write_b32 a134, v66
v_perm_b32 v70, v59, v58, s47
v_accvgpr_write_b32 a142, v70
s_mov_b32 s20, 4202496
buffer_load_dword v58, v1, s[12:15], s20 offen
s_mov_b32 s21, 4235264
buffer_load_dword v59, v1, s[12:15], s21 offen
s_waitcnt vmcnt(54)
v_perm_b32 v67, v61, v60, s46
v_accvgpr_write_b32 a135, v67
v_perm_b32 v71, v61, v60, s47
v_accvgpr_write_b32 a143, v71
s_mov_b32 s20, 4268032
buffer_load_dword v60, v1, s[12:15], s20 offen
s_mov_b32 s21, 4300800
buffer_load_dword v61, v1, s[12:15], s21 offen
s_waitcnt vmcnt(54)
v_perm_b32 v64, v7, v6, s46
v_accvgpr_write_b32 a0, v64
v_perm_b32 v68, v7, v6, s47
s_barrier
s_mov_b32 s20, 4456448
buffer_load_dword v6, v1, s[12:15], s20 offen
s_mov_b32 s21, 4489216
buffer_load_dword v7, v1, s[12:15], s21 offen
s_waitcnt vmcnt(54)
v_perm_b32 v65, v9, v8, s46
v_accvgpr_write_b32 a1, v65
v_perm_b32 v69, v9, v8, s47
s_mov_b32 s20, 4521984
buffer_load_dword v8, v1, s[12:15], s20 offen
s_mov_b32 s21, 4554752
buffer_load_dword v9, v1, s[12:15], s21 offen
s_waitcnt vmcnt(54)
v_perm_b32 v66, v11, v10, s46
v_accvgpr_write_b32 a2, v66
v_perm_b32 v70, v11, v10, s47
s_mov_b32 s20, 4464640
buffer_load_dword v10, v1, s[12:15], s20 offen
s_mov_b32 s21, 4497408
buffer_load_dword v11, v1, s[12:15], s21 offen
s_waitcnt vmcnt(54)
v_perm_b32 v67, v13, v12, s46
v_accvgpr_write_b32 a3, v67
v_perm_b32 v71, v13, v12, s47
ds_write_b128 v3, v[68:71] offset:14336
s_waitcnt lgkmcnt(0)
s_mov_b32 s20, 4530176
buffer_load_dword v12, v1, s[12:15], s20 offen
s_mov_b32 s21, 4562944
buffer_load_dword v13, v1, s[12:15], s21 offen
s_waitcnt vmcnt(54)
v_perm_b32 v64, v15, v14, s46
v_accvgpr_write_b32 a4, v64
v_perm_b32 v68, v15, v14, s47
s_barrier
s_mov_b32 s12, s94
s_and_b32 s13, s95, 0xffff
s_mov_b32 s14, 4718592
s_mov_b32 s15, 0x20000
s_mov_b32 s20, 0
buffer_load_dword v14, v4, s[12:15], s20 offen
s_mov_b32 s21, 1152
buffer_load_dword v15, v4, s[12:15], s21 offen
s_waitcnt vmcnt(54)
v_perm_b32 v65, v17, v16, s46
v_accvgpr_write_b32 a5, v65
v_perm_b32 v69, v17, v16, s47
s_mov_b32 s20, 9216
buffer_load_dword v16, v4, s[12:15], s20 offen
s_mov_b32 s21, 10368
buffer_load_dword v17, v4, s[12:15], s21 offen
s_waitcnt vmcnt(54)
v_perm_b32 v66, v19, v18, s46
v_accvgpr_write_b32 a6, v66
v_perm_b32 v70, v19, v18, s47
s_mov_b32 s20, 2304
buffer_load_dword v18, v4, s[12:15], s20 offen
s_mov_b32 s21, 3456
buffer_load_dword v19, v4, s[12:15], s21 offen
s_waitcnt vmcnt(54)
v_perm_b32 v67, v21, v20, s46
v_accvgpr_write_b32 a7, v67
v_perm_b32 v71, v21, v20, s47
ds_write_b128 v3, v[68:71] offset:15360
s_waitcnt lgkmcnt(0)
s_mov_b32 s20, 11520
buffer_load_dword v20, v4, s[12:15], s20 offen
s_mov_b32 s21, 12672
buffer_load_dword v21, v4, s[12:15], s21 offen
s_waitcnt vmcnt(54)
v_perm_b32 v64, v23, v22, s46
v_accvgpr_write_b32 a144, v64
v_perm_b32 v68, v23, v22, s47
v_accvgpr_write_b32 a152, v68
s_barrier
s_mov_b32 s20, 36864
buffer_load_dword v22, v4, s[12:15], s20 offen
s_mov_b32 s21, 38016
buffer_load_dword v23, v4, s[12:15], s21 offen
s_waitcnt vmcnt(54)
v_perm_b32 v65, v25, v24, s46
v_accvgpr_write_b32 a145, v65
v_perm_b32 v69, v25, v24, s47
v_accvgpr_write_b32 a153, v69
s_mov_b32 s20, 46080
buffer_load_dword v24, v4, s[12:15], s20 offen
s_mov_b32 s21, 47232
buffer_load_dword v25, v4, s[12:15], s21 offen
s_waitcnt vmcnt(54)
v_perm_b32 v66, v27, v26, s46
v_accvgpr_write_b32 a146, v66
v_perm_b32 v70, v27, v26, s47
v_accvgpr_write_b32 a154, v70
s_mov_b32 s20, 39168
buffer_load_dword v26, v4, s[12:15], s20 offen
s_mov_b32 s21, 40320
buffer_load_dword v27, v4, s[12:15], s21 offen
s_waitcnt vmcnt(54)
v_perm_b32 v67, v29, v28, s46
v_accvgpr_write_b32 a147, v67
v_perm_b32 v71, v29, v28, s47
v_accvgpr_write_b32 a155, v71
s_mov_b32 s20, 48384
buffer_load_dword v28, v4, s[12:15], s20 offen
s_mov_b32 s21, 49536
buffer_load_dword v29, v4, s[12:15], s21 offen
s_waitcnt vmcnt(54)
v_perm_b32 v64, v31, v30, s46
v_accvgpr_write_b32 a148, v64
v_perm_b32 v68, v31, v30, s47
v_accvgpr_write_b32 a156, v68
s_barrier
s_mov_b32 s20, 73728
buffer_load_dword v30, v4, s[12:15], s20 offen
s_mov_b32 s21, 74880
buffer_load_dword v31, v4, s[12:15], s21 offen
s_waitcnt vmcnt(54)
v_perm_b32 v65, v33, v32, s46
v_accvgpr_write_b32 a149, v65
v_perm_b32 v69, v33, v32, s47
v_accvgpr_write_b32 a157, v69
s_mov_b32 s20, 82944
buffer_load_dword v32, v4, s[12:15], s20 offen
s_mov_b32 s21, 84096
buffer_load_dword v33, v4, s[12:15], s21 offen
s_waitcnt vmcnt(54)
v_perm_b32 v66, v35, v34, s46
v_accvgpr_write_b32 a150, v66
v_perm_b32 v70, v35, v34, s47
v_accvgpr_write_b32 a158, v70
s_mov_b32 s20, 76032
buffer_load_dword v34, v4, s[12:15], s20 offen
s_mov_b32 s21, 77184
buffer_load_dword v35, v4, s[12:15], s21 offen
s_waitcnt vmcnt(54)
v_perm_b32 v67, v37, v36, s46
v_accvgpr_write_b32 a151, v67
v_perm_b32 v71, v37, v36, s47
v_accvgpr_write_b32 a159, v71
s_mov_b32 s20, 85248
buffer_load_dword v36, v4, s[12:15], s20 offen
s_mov_b32 s21, 86400
buffer_load_dword v37, v4, s[12:15], s21 offen
s_waitcnt vmcnt(54)
v_perm_b32 v64, v39, v38, s46
v_accvgpr_write_b32 a24, v64
v_perm_b32 v68, v39, v38, s47
s_barrier
s_mov_b32 s20, 110592
buffer_load_dword v38, v4, s[12:15], s20 offen
s_mov_b32 s21, 111744
buffer_load_dword v39, v4, s[12:15], s21 offen
s_waitcnt vmcnt(54)
v_perm_b32 v65, v41, v40, s46
v_accvgpr_write_b32 a25, v65
v_perm_b32 v69, v41, v40, s47
s_mov_b32 s20, 119808
buffer_load_dword v40, v4, s[12:15], s20 offen
s_mov_b32 s21, 120960
buffer_load_dword v41, v4, s[12:15], s21 offen
s_waitcnt vmcnt(54)
v_perm_b32 v66, v43, v42, s46
v_accvgpr_write_b32 a26, v66
v_perm_b32 v70, v43, v42, s47
s_mov_b32 s20, 112896
buffer_load_dword v42, v4, s[12:15], s20 offen
s_mov_b32 s21, 114048
buffer_load_dword v43, v4, s[12:15], s21 offen
s_waitcnt vmcnt(54)
v_perm_b32 v67, v45, v44, s46
v_accvgpr_write_b32 a27, v67
v_perm_b32 v71, v45, v44, s47
ds_write_b128 v3, v[68:71] offset:16384
s_waitcnt lgkmcnt(0)
s_mov_b32 s20, 122112
buffer_load_dword v44, v4, s[12:15], s20 offen
s_mov_b32 s21, 123264
buffer_load_dword v45, v4, s[12:15], s21 offen
s_waitcnt vmcnt(54)
v_perm_b32 v64, v47, v46, s46
v_accvgpr_write_b32 a28, v64
v_perm_b32 v68, v47, v46, s47
s_barrier
s_mov_b32 s20, 256
buffer_load_dword v46, v4, s[12:15], s20 offen
s_mov_b32 s21, 1408
buffer_load_dword v47, v4, s[12:15], s21 offen
s_waitcnt vmcnt(54)
v_perm_b32 v65, v49, v48, s46
v_accvgpr_write_b32 a29, v65
v_perm_b32 v69, v49, v48, s47
s_mov_b32 s20, 9472
buffer_load_dword v48, v4, s[12:15], s20 offen
s_mov_b32 s21, 10624
buffer_load_dword v49, v4, s[12:15], s21 offen
s_waitcnt vmcnt(54)
v_perm_b32 v66, v51, v50, s46
v_accvgpr_write_b32 a30, v66
v_perm_b32 v70, v51, v50, s47
s_mov_b32 s20, 2560
buffer_load_dword v50, v4, s[12:15], s20 offen
s_mov_b32 s21, 3712
buffer_load_dword v51, v4, s[12:15], s21 offen
s_waitcnt vmcnt(54)
v_perm_b32 v67, v53, v52, s46
v_accvgpr_write_b32 a31, v67
v_perm_b32 v71, v53, v52, s47
ds_write_b128 v3, v[68:71] offset:17408
s_waitcnt lgkmcnt(0)
s_mov_b32 s20, 11776
buffer_load_dword v52, v4, s[12:15], s20 offen
s_mov_b32 s21, 12928
buffer_load_dword v53, v4, s[12:15], s21 offen
s_waitcnt vmcnt(54)
v_perm_b32 v64, v55, v54, s46
v_accvgpr_write_b32 a160, v64
v_perm_b32 v68, v55, v54, s47
v_accvgpr_write_b32 a168, v68
s_barrier
s_mov_b32 s20, 37120
buffer_load_dword v54, v4, s[12:15], s20 offen
s_mov_b32 s21, 38272
buffer_load_dword v55, v4, s[12:15], s21 offen
s_waitcnt vmcnt(54)
v_perm_b32 v65, v57, v56, s46
v_accvgpr_write_b32 a161, v65
v_perm_b32 v69, v57, v56, s47
v_accvgpr_write_b32 a169, v69
s_mov_b32 s20, 46336
buffer_load_dword v56, v4, s[12:15], s20 offen
s_mov_b32 s21, 47488
buffer_load_dword v57, v4, s[12:15], s21 offen
s_waitcnt vmcnt(54)
v_perm_b32 v66, v59, v58, s46
v_accvgpr_write_b32 a162, v66
v_perm_b32 v70, v59, v58, s47
v_accvgpr_write_b32 a170, v70
s_mov_b32 s20, 39424
buffer_load_dword v58, v4, s[12:15], s20 offen
s_mov_b32 s21, 40576
buffer_load_dword v59, v4, s[12:15], s21 offen
s_waitcnt vmcnt(54)
v_perm_b32 v67, v61, v60, s46
v_accvgpr_write_b32 a163, v67
v_perm_b32 v71, v61, v60, s47
v_accvgpr_write_b32 a171, v71
s_mov_b32 s20, 48640
buffer_load_dword v60, v4, s[12:15], s20 offen
s_mov_b32 s21, 49792
buffer_load_dword v61, v4, s[12:15], s21 offen
s_waitcnt vmcnt(54)
v_perm_b32 v64, v7, v6, s46
v_accvgpr_write_b32 a164, v64
v_perm_b32 v68, v7, v6, s47
v_accvgpr_write_b32 a172, v68
s_barrier
s_mov_b32 s20, 73984
buffer_load_dword v6, v4, s[12:15], s20 offen
s_mov_b32 s21, 75136
buffer_load_dword v7, v4, s[12:15], s21 offen
s_waitcnt vmcnt(54)
v_perm_b32 v65, v9, v8, s46
v_accvgpr_write_b32 a165, v65
v_perm_b32 v69, v9, v8, s47
v_accvgpr_write_b32 a173, v69
s_mov_b32 s20, 83200
buffer_load_dword v8, v4, s[12:15], s20 offen
s_mov_b32 s21, 84352
buffer_load_dword v9, v4, s[12:15], s21 offen
s_waitcnt vmcnt(54)
v_perm_b32 v66, v11, v10, s46
v_accvgpr_write_b32 a166, v66
v_perm_b32 v70, v11, v10, s47
v_accvgpr_write_b32 a174, v70
s_mov_b32 s20, 76288
buffer_load_dword v10, v4, s[12:15], s20 offen
s_mov_b32 s21, 77440
buffer_load_dword v11, v4, s[12:15], s21 offen
s_waitcnt vmcnt(54)
v_perm_b32 v67, v13, v12, s46
v_accvgpr_write_b32 a167, v67
v_perm_b32 v71, v13, v12, s47
v_accvgpr_write_b32 a175, v71
s_mov_b32 s20, 85504
buffer_load_dword v12, v4, s[12:15], s20 offen
s_mov_b32 s21, 86656
buffer_load_dword v13, v4, s[12:15], s21 offen
s_waitcnt vmcnt(54)
v_perm_b32 v64, v15, v14, s46
v_accvgpr_write_b32 a176, v64
v_perm_b32 v68, v15, v14, s47
v_accvgpr_write_b32 a184, v68
s_barrier
s_mov_b32 s20, 110848
buffer_load_dword v14, v4, s[12:15], s20 offen
s_mov_b32 s21, 112000
buffer_load_dword v15, v4, s[12:15], s21 offen
s_waitcnt vmcnt(54)
v_perm_b32 v65, v17, v16, s46
v_accvgpr_write_b32 a177, v65
v_perm_b32 v69, v17, v16, s47
v_accvgpr_write_b32 a185, v69
s_mov_b32 s20, 120064
buffer_load_dword v16, v4, s[12:15], s20 offen
s_mov_b32 s21, 121216
buffer_load_dword v17, v4, s[12:15], s21 offen
s_waitcnt vmcnt(54)
v_perm_b32 v66, v19, v18, s46
v_accvgpr_write_b32 a178, v66
v_perm_b32 v70, v19, v18, s47
v_accvgpr_write_b32 a186, v70
s_mov_b32 s20, 113152
buffer_load_dword v18, v4, s[12:15], s20 offen
s_mov_b32 s21, 114304
buffer_load_dword v19, v4, s[12:15], s21 offen
s_waitcnt vmcnt(54)
v_perm_b32 v67, v21, v20, s46
v_accvgpr_write_b32 a179, v67
v_perm_b32 v71, v21, v20, s47
v_accvgpr_write_b32 a187, v71
s_mov_b32 s20, 122368
buffer_load_dword v20, v4, s[12:15], s20 offen
s_mov_b32 s21, 123520
buffer_load_dword v21, v4, s[12:15], s21 offen
s_waitcnt vmcnt(54)
v_perm_b32 v64, v23, v22, s46
v_accvgpr_write_b32 a180, v64
v_perm_b32 v68, v23, v22, s47
v_accvgpr_write_b32 a188, v68
s_barrier
s_mov_b32 s20, 512
buffer_load_dword v22, v4, s[12:15], s20 offen
s_mov_b32 s21, 1664
buffer_load_dword v23, v4, s[12:15], s21 offen
s_waitcnt vmcnt(54)
v_perm_b32 v65, v25, v24, s46
v_accvgpr_write_b32 a181, v65
v_perm_b32 v69, v25, v24, s47
v_accvgpr_write_b32 a189, v69
s_mov_b32 s20, 9728
buffer_load_dword v24, v4, s[12:15], s20 offen
s_mov_b32 s21, 10880
buffer_load_dword v25, v4, s[12:15], s21 offen
s_waitcnt vmcnt(54)
v_perm_b32 v66, v27, v26, s46
v_accvgpr_write_b32 a182, v66
v_perm_b32 v70, v27, v26, s47
v_accvgpr_write_b32 a190, v70
s_mov_b32 s20, 2816
buffer_load_dword v26, v4, s[12:15], s20 offen
s_mov_b32 s21, 3968
buffer_load_dword v27, v4, s[12:15], s21 offen
s_waitcnt vmcnt(54)
v_perm_b32 v67, v29, v28, s46
v_accvgpr_write_b32 a183, v67
v_perm_b32 v71, v29, v28, s47
v_accvgpr_write_b32 a191, v71
s_mov_b32 s20, 12032
buffer_load_dword v28, v4, s[12:15], s20 offen
s_mov_b32 s21, 13184
buffer_load_dword v29, v4, s[12:15], s21 offen
s_waitcnt vmcnt(54)
v_perm_b32 v64, v31, v30, s46
v_perm_b32 v68, v31, v30, s47
s_barrier
s_mov_b32 s20, 37376
buffer_load_dword v30, v4, s[12:15], s20 offen
s_mov_b32 s21, 38528
buffer_load_dword v31, v4, s[12:15], s21 offen
s_waitcnt vmcnt(54)
v_perm_b32 v65, v33, v32, s46
v_perm_b32 v69, v33, v32, s47
s_mov_b32 s20, 46592
buffer_load_dword v32, v4, s[12:15], s20 offen
s_mov_b32 s21, 47744
buffer_load_dword v33, v4, s[12:15], s21 offen
s_waitcnt vmcnt(54)
v_perm_b32 v66, v35, v34, s46
v_perm_b32 v70, v35, v34, s47
s_mov_b32 s20, 39680
buffer_load_dword v34, v4, s[12:15], s20 offen
s_mov_b32 s21, 40832
buffer_load_dword v35, v4, s[12:15], s21 offen
s_waitcnt vmcnt(54)
v_perm_b32 v67, v37, v36, s46
ds_write_b128 v3, v[64:67] offset:20480
s_waitcnt lgkmcnt(0)
v_perm_b32 v71, v37, v36, s47
ds_write_b128 v3, v[68:71] offset:22528
s_waitcnt lgkmcnt(0)
s_mov_b32 s20, 48896
buffer_load_dword v36, v4, s[12:15], s20 offen
s_mov_b32 s21, 50048
buffer_load_dword v37, v4, s[12:15], s21 offen
s_waitcnt vmcnt(54)
v_perm_b32 v64, v39, v38, s46
v_perm_b32 v68, v39, v38, s47
s_barrier
s_mov_b32 s20, 74240
buffer_load_dword v38, v4, s[12:15], s20 offen
s_mov_b32 s21, 75392
buffer_load_dword v39, v4, s[12:15], s21 offen
s_waitcnt vmcnt(54)
v_perm_b32 v65, v41, v40, s46
v_perm_b32 v69, v41, v40, s47
s_mov_b32 s20, 83456
buffer_load_dword v40, v4, s[12:15], s20 offen
s_mov_b32 s21, 84608
buffer_load_dword v41, v4, s[12:15], s21 offen
s_waitcnt vmcnt(54)
v_perm_b32 v66, v43, v42, s46
v_perm_b32 v70, v43, v42, s47
s_mov_b32 s20, 76544
buffer_load_dword v42, v4, s[12:15], s20 offen
s_mov_b32 s21, 77696
buffer_load_dword v43, v4, s[12:15], s21 offen
s_waitcnt vmcnt(54)
v_perm_b32 v67, v45, v44, s46
ds_write_b128 v3, v[64:67] offset:21504
s_waitcnt lgkmcnt(0)
v_perm_b32 v71, v45, v44, s47
ds_write_b128 v3, v[68:71] offset:23552
s_waitcnt lgkmcnt(0)
s_mov_b32 s20, 85760
buffer_load_dword v44, v4, s[12:15], s20 offen
s_mov_b32 s21, 86912
buffer_load_dword v45, v4, s[12:15], s21 offen
s_waitcnt vmcnt(54)
v_perm_b32 v64, v47, v46, s46
v_accvgpr_write_b32 a192, v64
v_perm_b32 v68, v47, v46, s47
v_accvgpr_write_b32 a200, v68
s_barrier
s_mov_b32 s20, 111104
buffer_load_dword v46, v4, s[12:15], s20 offen
s_mov_b32 s21, 112256
buffer_load_dword v47, v4, s[12:15], s21 offen
s_waitcnt vmcnt(54)
v_perm_b32 v65, v49, v48, s46
v_accvgpr_write_b32 a193, v65
v_perm_b32 v69, v49, v48, s47
v_accvgpr_write_b32 a201, v69
s_mov_b32 s20, 120320
buffer_load_dword v48, v4, s[12:15], s20 offen
s_mov_b32 s21, 121472
buffer_load_dword v49, v4, s[12:15], s21 offen
s_waitcnt vmcnt(54)
v_perm_b32 v66, v51, v50, s46
v_accvgpr_write_b32 a194, v66
v_perm_b32 v70, v51, v50, s47
v_accvgpr_write_b32 a202, v70
s_mov_b32 s20, 113408
buffer_load_dword v50, v4, s[12:15], s20 offen
s_mov_b32 s21, 114560
buffer_load_dword v51, v4, s[12:15], s21 offen
s_waitcnt vmcnt(54)
v_perm_b32 v67, v53, v52, s46
v_accvgpr_write_b32 a195, v67
v_perm_b32 v71, v53, v52, s47
v_accvgpr_write_b32 a203, v71
s_mov_b32 s20, 122624
buffer_load_dword v52, v4, s[12:15], s20 offen
s_mov_b32 s21, 123776
buffer_load_dword v53, v4, s[12:15], s21 offen
s_waitcnt vmcnt(54)
v_perm_b32 v64, v55, v54, s46
v_accvgpr_write_b32 a196, v64
v_perm_b32 v68, v55, v54, s47
v_accvgpr_write_b32 a204, v68
s_barrier
s_mov_b32 s20, 768
buffer_load_dword v54, v4, s[12:15], s20 offen
s_mov_b32 s21, 1920
buffer_load_dword v55, v4, s[12:15], s21 offen
s_waitcnt vmcnt(54)
v_perm_b32 v65, v57, v56, s46
v_accvgpr_write_b32 a197, v65
v_perm_b32 v69, v57, v56, s47
v_accvgpr_write_b32 a205, v69
s_mov_b32 s20, 9984
buffer_load_dword v56, v4, s[12:15], s20 offen
s_mov_b32 s21, 11136
buffer_load_dword v57, v4, s[12:15], s21 offen
s_waitcnt vmcnt(54)
v_perm_b32 v66, v59, v58, s46
v_accvgpr_write_b32 a198, v66
v_perm_b32 v70, v59, v58, s47
v_accvgpr_write_b32 a206, v70
s_mov_b32 s20, 3072
buffer_load_dword v58, v4, s[12:15], s20 offen
s_mov_b32 s21, 4224
buffer_load_dword v59, v4, s[12:15], s21 offen
s_waitcnt vmcnt(54)
v_perm_b32 v67, v61, v60, s46
v_accvgpr_write_b32 a199, v67
v_perm_b32 v71, v61, v60, s47
v_accvgpr_write_b32 a207, v71
s_mov_b32 s20, 12288
buffer_load_dword v60, v4, s[12:15], s20 offen
s_mov_b32 s21, 13440
buffer_load_dword v61, v4, s[12:15], s21 offen
s_waitcnt vmcnt(54)
v_perm_b32 v64, v7, v6, s46
v_perm_b32 v68, v7, v6, s47
s_barrier
s_mov_b32 s20, 37632
buffer_load_dword v6, v4, s[12:15], s20 offen
s_mov_b32 s21, 38784
buffer_load_dword v7, v4, s[12:15], s21 offen
s_waitcnt vmcnt(54)
v_perm_b32 v65, v9, v8, s46
v_perm_b32 v69, v9, v8, s47
s_mov_b32 s20, 46848
buffer_load_dword v8, v4, s[12:15], s20 offen
s_mov_b32 s21, 48000
buffer_load_dword v9, v4, s[12:15], s21 offen
s_waitcnt vmcnt(54)
v_perm_b32 v66, v11, v10, s46
v_perm_b32 v70, v11, v10, s47
s_mov_b32 s20, 39936
buffer_load_dword v10, v4, s[12:15], s20 offen
s_mov_b32 s21, 41088
buffer_load_dword v11, v4, s[12:15], s21 offen
s_waitcnt vmcnt(54)
v_perm_b32 v67, v13, v12, s46
ds_write_b128 v3, v[64:67] offset:24576
s_waitcnt lgkmcnt(0)
v_perm_b32 v71, v13, v12, s47
ds_write_b128 v3, v[68:71] offset:26624
s_waitcnt lgkmcnt(0)
s_mov_b32 s20, 49152
buffer_load_dword v12, v4, s[12:15], s20 offen
s_mov_b32 s21, 50304
buffer_load_dword v13, v4, s[12:15], s21 offen
s_waitcnt vmcnt(54)
v_perm_b32 v64, v15, v14, s46
v_perm_b32 v68, v15, v14, s47
s_barrier
s_mov_b32 s20, 74496
buffer_load_dword v14, v4, s[12:15], s20 offen
s_mov_b32 s21, 75648
buffer_load_dword v15, v4, s[12:15], s21 offen
s_waitcnt vmcnt(54)
v_perm_b32 v65, v17, v16, s46
v_perm_b32 v69, v17, v16, s47
s_mov_b32 s20, 83712
buffer_load_dword v16, v4, s[12:15], s20 offen
s_mov_b32 s21, 84864
buffer_load_dword v17, v4, s[12:15], s21 offen
s_waitcnt vmcnt(54)
v_perm_b32 v66, v19, v18, s46
v_perm_b32 v70, v19, v18, s47
s_mov_b32 s20, 76800
buffer_load_dword v18, v4, s[12:15], s20 offen
s_mov_b32 s21, 77952
buffer_load_dword v19, v4, s[12:15], s21 offen
s_waitcnt vmcnt(54)
v_perm_b32 v67, v21, v20, s46
ds_write_b128 v3, v[64:67] offset:25600
s_waitcnt lgkmcnt(0)
v_perm_b32 v71, v21, v20, s47
ds_write_b128 v3, v[68:71] offset:27648
s_waitcnt lgkmcnt(0)
s_mov_b32 s20, 86016
buffer_load_dword v20, v4, s[12:15], s20 offen
s_mov_b32 s21, 87168
buffer_load_dword v21, v4, s[12:15], s21 offen
s_waitcnt vmcnt(54)
v_perm_b32 v64, v23, v22, s46
v_accvgpr_write_b32 a208, v64
v_perm_b32 v68, v23, v22, s47
v_accvgpr_write_b32 a216, v68
s_barrier
s_mov_b32 s20, 111360
buffer_load_dword v22, v4, s[12:15], s20 offen
s_mov_b32 s21, 112512
buffer_load_dword v23, v4, s[12:15], s21 offen
s_waitcnt vmcnt(54)
v_perm_b32 v65, v25, v24, s46
v_accvgpr_write_b32 a209, v65
v_perm_b32 v69, v25, v24, s47
v_accvgpr_write_b32 a217, v69
s_mov_b32 s20, 120576
buffer_load_dword v24, v4, s[12:15], s20 offen
s_mov_b32 s21, 121728
buffer_load_dword v25, v4, s[12:15], s21 offen
s_waitcnt vmcnt(54)
v_perm_b32 v66, v27, v26, s46
v_accvgpr_write_b32 a210, v66
v_perm_b32 v70, v27, v26, s47
v_accvgpr_write_b32 a218, v70
s_mov_b32 s20, 113664
buffer_load_dword v26, v4, s[12:15], s20 offen
s_mov_b32 s21, 114816
buffer_load_dword v27, v4, s[12:15], s21 offen
s_waitcnt vmcnt(54)
v_perm_b32 v67, v29, v28, s46
v_accvgpr_write_b32 a211, v67
v_perm_b32 v71, v29, v28, s47
v_accvgpr_write_b32 a219, v71
s_mov_b32 s20, 122880
buffer_load_dword v28, v4, s[12:15], s20 offen
s_mov_b32 s21, 124032
buffer_load_dword v29, v4, s[12:15], s21 offen
s_waitcnt vmcnt(54)
v_perm_b32 v64, v31, v30, s46
v_accvgpr_write_b32 a212, v64
v_perm_b32 v68, v31, v30, s47
v_accvgpr_write_b32 a220, v68
s_barrier
s_mov_b32 s20, 1024
buffer_load_ushort v30, v2, s[12:15], s20 offen
s_mov_b32 s21, 2176
buffer_load_ushort v31, v2, s[12:15], s21 offen
s_waitcnt vmcnt(54)
v_perm_b32 v65, v33, v32, s46
v_accvgpr_write_b32 a213, v65
v_perm_b32 v69, v33, v32, s47
v_accvgpr_write_b32 a221, v69
s_mov_b32 s20, 10240
buffer_load_ushort v32, v2, s[12:15], s20 offen
s_mov_b32 s21, 11392
buffer_load_ushort v33, v2, s[12:15], s21 offen
s_waitcnt vmcnt(54)
v_perm_b32 v66, v35, v34, s46
v_accvgpr_write_b32 a214, v66
v_perm_b32 v70, v35, v34, s47
v_accvgpr_write_b32 a222, v70
s_mov_b32 s20, 3328
buffer_load_ushort v34, v2, s[12:15], s20 offen
s_mov_b32 s21, 4480
buffer_load_ushort v35, v2, s[12:15], s21 offen
s_waitcnt vmcnt(54)
v_perm_b32 v67, v37, v36, s46
v_accvgpr_write_b32 a215, v67
v_perm_b32 v71, v37, v36, s47
v_accvgpr_write_b32 a223, v71
s_mov_b32 s20, 12544
buffer_load_ushort v36, v2, s[12:15], s20 offen
s_mov_b32 s21, 13696
buffer_load_ushort v37, v2, s[12:15], s21 offen
s_waitcnt vmcnt(54)
v_perm_b32 v64, v39, v38, s46
v_perm_b32 v68, v39, v38, s47
s_barrier
s_mov_b32 s20, 37888
buffer_load_ushort v38, v2, s[12:15], s20 offen
s_mov_b32 s21, 39040
buffer_load_ushort v39, v2, s[12:15], s21 offen
s_waitcnt vmcnt(54)
v_perm_b32 v65, v41, v40, s46
v_perm_b32 v69, v41, v40, s47
s_mov_b32 s20, 47104
buffer_load_ushort v40, v2, s[12:15], s20 offen
s_mov_b32 s21, 48256
buffer_load_ushort v41, v2, s[12:15], s21 offen
s_waitcnt vmcnt(54)
v_perm_b32 v66, v43, v42, s46
v_perm_b32 v70, v43, v42, s47
s_mov_b32 s20, 40192
buffer_load_ushort v42, v2, s[12:15], s20 offen
s_mov_b32 s21, 41344
buffer_load_ushort v43, v2, s[12:15], s21 offen
s_waitcnt vmcnt(54)
v_perm_b32 v67, v45, v44, s46
ds_write_b128 v3, v[64:67] offset:28672
s_waitcnt lgkmcnt(0)
v_perm_b32 v71, v45, v44, s47
ds_write_b128 v3, v[68:71] offset:30720
s_waitcnt lgkmcnt(0)
s_mov_b32 s20, 49408
buffer_load_ushort v44, v2, s[12:15], s20 offen
s_mov_b32 s21, 50560
buffer_load_ushort v45, v2, s[12:15], s21 offen
s_waitcnt vmcnt(54)
v_perm_b32 v64, v47, v46, s46
v_perm_b32 v68, v47, v46, s47
s_barrier
s_mov_b32 s20, 74752
buffer_load_ushort v46, v2, s[12:15], s20 offen
s_mov_b32 s21, 75904
buffer_load_ushort v47, v2, s[12:15], s21 offen
s_waitcnt vmcnt(54)
v_perm_b32 v65, v49, v48, s46
v_perm_b32 v69, v49, v48, s47
s_mov_b32 s20, 83968
buffer_load_ushort v48, v2, s[12:15], s20 offen
s_mov_b32 s21, 85120
buffer_load_ushort v49, v2, s[12:15], s21 offen
s_waitcnt vmcnt(54)
v_perm_b32 v66, v51, v50, s46
v_perm_b32 v70, v51, v50, s47
s_mov_b32 s20, 77056
buffer_load_ushort v50, v2, s[12:15], s20 offen
s_mov_b32 s21, 78208
buffer_load_ushort v51, v2, s[12:15], s21 offen
s_waitcnt vmcnt(54)
v_perm_b32 v67, v53, v52, s46
ds_write_b128 v3, v[64:67] offset:29696
s_waitcnt lgkmcnt(0)
v_perm_b32 v71, v53, v52, s47
ds_write_b128 v3, v[68:71] offset:31744
s_waitcnt lgkmcnt(0)
s_mov_b32 s20, 86272
buffer_load_ushort v52, v2, s[12:15], s20 offen
s_mov_b32 s21, 87424
buffer_load_ushort v53, v2, s[12:15], s21 offen
s_waitcnt vmcnt(54)
v_perm_b32 v64, v55, v54, s46
v_accvgpr_write_b32 a224, v64
v_perm_b32 v68, v55, v54, s47
v_accvgpr_write_b32 a232, v68
s_barrier
s_mov_b32 s20, 111616
buffer_load_ushort v54, v2, s[12:15], s20 offen
s_mov_b32 s21, 112768
buffer_load_ushort v55, v2, s[12:15], s21 offen
s_waitcnt vmcnt(54)
v_perm_b32 v65, v57, v56, s46
v_accvgpr_write_b32 a225, v65
v_perm_b32 v69, v57, v56, s47
v_accvgpr_write_b32 a233, v69
s_mov_b32 s20, 120832
buffer_load_ushort v56, v2, s[12:15], s20 offen
s_mov_b32 s21, 121984
buffer_load_ushort v57, v2, s[12:15], s21 offen
s_waitcnt vmcnt(54)
v_perm_b32 v66, v59, v58, s46
v_accvgpr_write_b32 a226, v66
v_perm_b32 v70, v59, v58, s47
v_accvgpr_write_b32 a234, v70
s_mov_b32 s20, 113920
buffer_load_ushort v58, v2, s[12:15], s20 offen
s_mov_b32 s21, 115072
buffer_load_ushort v59, v2, s[12:15], s21 offen
s_waitcnt vmcnt(54)
v_perm_b32 v67, v61, v60, s46
v_accvgpr_write_b32 a227, v67
v_perm_b32 v71, v61, v60, s47
v_accvgpr_write_b32 a235, v71
s_mov_b32 s20, 123136
buffer_load_ushort v60, v2, s[12:15], s20 offen
s_mov_b32 s21, 124288
buffer_load_ushort v61, v2, s[12:15], s21 offen
s_waitcnt vmcnt(54)
v_perm_b32 v64, v7, v6, s46
v_accvgpr_write_b32 a228, v64
v_perm_b32 v68, v7, v6, s47
v_accvgpr_write_b32 a236, v68
s_barrier
s_mov_b32 s12, s88
s_and_b32 s13, s89, 0xffff
s_mov_b32 s14, 4718592
s_mov_b32 s15, 0x20000
s_mov_b32 s20, 0
buffer_load_dword v6, v1, s[12:15], s20 offen
s_mov_b32 s21, 32768
buffer_load_dword v7, v1, s[12:15], s21 offen
s_waitcnt vmcnt(54)
v_perm_b32 v65, v9, v8, s46
v_accvgpr_write_b32 a229, v65
v_perm_b32 v69, v9, v8, s47
v_accvgpr_write_b32 a237, v69
s_mov_b32 s20, 65536
buffer_load_dword v8, v1, s[12:15], s20 offen
s_mov_b32 s21, 98304
buffer_load_dword v9, v1, s[12:15], s21 offen
s_waitcnt vmcnt(54)
v_perm_b32 v66, v11, v10, s46
v_accvgpr_write_b32 a230, v66
v_perm_b32 v70, v11, v10, s47
v_accvgpr_write_b32 a238, v70
s_mov_b32 s20, 8192
buffer_load_dword v10, v1, s[12:15], s20 offen
s_mov_b32 s21, 40960
buffer_load_dword v11, v1, s[12:15], s21 offen
s_waitcnt vmcnt(54)
v_perm_b32 v67, v13, v12, s46
v_accvgpr_write_b32 a231, v67
v_perm_b32 v71, v13, v12, s47
v_accvgpr_write_b32 a239, v71
s_mov_b32 s20, 73728
buffer_load_dword v12, v1, s[12:15], s20 offen
s_mov_b32 s21, 106496
buffer_load_dword v13, v1, s[12:15], s21 offen
s_waitcnt vmcnt(54)
v_perm_b32 v64, v15, v14, s46
v_perm_b32 v68, v15, v14, s47
v_accvgpr_write_b32 a240, v68
s_barrier
s_mov_b32 s20, 262144
buffer_load_dword v14, v1, s[12:15], s20 offen
s_mov_b32 s21, 294912
buffer_load_dword v15, v1, s[12:15], s21 offen
s_waitcnt vmcnt(54)
v_perm_b32 v65, v17, v16, s46
v_perm_b32 v69, v17, v16, s47
v_accvgpr_write_b32 a241, v69
s_mov_b32 s20, 327680
buffer_load_dword v16, v1, s[12:15], s20 offen
s_mov_b32 s21, 360448
buffer_load_dword v17, v1, s[12:15], s21 offen
s_waitcnt vmcnt(54)
v_perm_b32 v66, v19, v18, s46
v_perm_b32 v70, v19, v18, s47
v_accvgpr_write_b32 a242, v70
s_mov_b32 s20, 270336
buffer_load_dword v18, v1, s[12:15], s20 offen
s_mov_b32 s21, 303104
buffer_load_dword v19, v1, s[12:15], s21 offen
s_waitcnt vmcnt(54)
v_perm_b32 v67, v21, v20, s46
ds_write_b128 v3, v[64:67] offset:32768
s_waitcnt lgkmcnt(0)
v_perm_b32 v71, v21, v20, s47
v_accvgpr_write_b32 a243, v71
s_mov_b32 s20, 335872
buffer_load_dword v20, v1, s[12:15], s20 offen
s_mov_b32 s21, 368640
buffer_load_dword v21, v1, s[12:15], s21 offen
s_waitcnt vmcnt(54)
v_perm_b32 v64, v23, v22, s46
v_perm_b32 v68, v23, v22, s47
v_accvgpr_write_b32 a244, v68
s_barrier
s_mov_b32 s20, 524288
buffer_load_dword v22, v1, s[12:15], s20 offen
s_mov_b32 s21, 557056
buffer_load_dword v23, v1, s[12:15], s21 offen
s_waitcnt vmcnt(54)
v_perm_b32 v65, v25, v24, s46
v_perm_b32 v69, v25, v24, s47
v_accvgpr_write_b32 a245, v69
s_mov_b32 s20, 589824
buffer_load_dword v24, v1, s[12:15], s20 offen
s_mov_b32 s21, 622592
buffer_load_dword v25, v1, s[12:15], s21 offen
s_waitcnt vmcnt(54)
v_perm_b32 v66, v27, v26, s46
v_perm_b32 v70, v27, v26, s47
v_accvgpr_write_b32 a246, v70
s_mov_b32 s20, 532480
buffer_load_dword v26, v1, s[12:15], s20 offen
s_mov_b32 s21, 565248
buffer_load_dword v27, v1, s[12:15], s21 offen
s_waitcnt vmcnt(54)
v_perm_b32 v67, v29, v28, s46
ds_write_b128 v3, v[64:67] offset:33792
s_waitcnt lgkmcnt(0)
v_perm_b32 v71, v29, v28, s47
v_accvgpr_write_b32 a247, v71
s_mov_b32 s20, 598016
buffer_load_dword v28, v1, s[12:15], s20 offen
s_mov_b32 s21, 630784
buffer_load_dword v29, v1, s[12:15], s21 offen
s_waitcnt vmcnt(54)
v_perm_b32 v64, v31, v30, s46
v_accvgpr_write_b32 a248, v64
s_barrier
s_mov_b32 s20, 786432
buffer_load_dword v30, v1, s[12:15], s20 offen
s_mov_b32 s21, 819200
buffer_load_dword v31, v1, s[12:15], s21 offen
s_waitcnt vmcnt(54)
v_perm_b32 v65, v33, v32, s46
v_accvgpr_write_b32 a249, v65
s_mov_b32 s20, 851968
buffer_load_dword v32, v1, s[12:15], s20 offen
s_mov_b32 s21, 884736
buffer_load_dword v33, v1, s[12:15], s21 offen
s_waitcnt vmcnt(54)
v_perm_b32 v66, v35, v34, s46
v_accvgpr_write_b32 a250, v66
s_mov_b32 s20, 794624
buffer_load_dword v34, v1, s[12:15], s20 offen
s_mov_b32 s21, 827392
buffer_load_dword v35, v1, s[12:15], s21 offen
s_waitcnt vmcnt(54)
v_perm_b32 v67, v37, v36, s46
v_accvgpr_write_b32 a251, v67
s_mov_b32 s20, 860160
buffer_load_dword v36, v1, s[12:15], s20 offen
s_mov_b32 s21, 892928
buffer_load_dword v37, v1, s[12:15], s21 offen
s_waitcnt vmcnt(54)
v_perm_b32 v64, v39, v38, s46
v_accvgpr_write_b32 a252, v64
s_barrier
v_and_b32 v5, 1, v0
v_lshlrev_b32 v5, 6, v5
buffer_load_dword v5, v5, s[56:59], 0 offen offset:64 sc1
s_mov_b32 s20, 1048576
buffer_load_dword v38, v1, s[12:15], s20 offen
s_mov_b32 s21, 1081344
buffer_load_dword v39, v1, s[12:15], s21 offen
s_waitcnt vmcnt(55)
v_perm_b32 v65, v41, v40, s46
v_accvgpr_write_b32 a253, v65
s_mov_b32 s20, 1114112
buffer_load_dword v40, v1, s[12:15], s20 offen
s_mov_b32 s21, 1146880
buffer_load_dword v41, v1, s[12:15], s21 offen
s_waitcnt vmcnt(55)
v_perm_b32 v66, v43, v42, s46
v_accvgpr_write_b32 a254, v66
s_mov_b32 s20, 1056768
buffer_load_dword v42, v1, s[12:15], s20 offen
s_mov_b32 s21, 1089536
buffer_load_dword v43, v1, s[12:15], s21 offen
s_waitcnt vmcnt(55)
v_perm_b32 v67, v45, v44, s46
v_accvgpr_write_b32 a255, v67
s_mov_b32 s20, 1122304
buffer_load_dword v44, v1, s[12:15], s20 offen
s_mov_b32 s21, 1155072
buffer_load_dword v45, v1, s[12:15], s21 offen
s_waitcnt vmcnt(55)
v_perm_b32 v64, v47, v46, s46
s_barrier
s_mov_b32 s20, 1310720
buffer_load_dword v46, v1, s[12:15], s20 offen
s_mov_b32 s21, 1343488
buffer_load_dword v47, v1, s[12:15], s21 offen
s_waitcnt vmcnt(55)
v_perm_b32 v65, v49, v48, s46
s_mov_b32 s20, 1376256
buffer_load_dword v48, v1, s[12:15], s20 offen
s_mov_b32 s21, 1409024
buffer_load_dword v49, v1, s[12:15], s21 offen
s_waitcnt vmcnt(55)
v_perm_b32 v66, v51, v50, s46
s_mov_b32 s20, 1318912
buffer_load_dword v50, v1, s[12:15], s20 offen
s_mov_b32 s21, 1351680
buffer_load_dword v51, v1, s[12:15], s21 offen
s_waitcnt vmcnt(55)
v_perm_b32 v67, v53, v52, s46
ds_write_b128 v3, v[64:67] offset:18432
s_waitcnt lgkmcnt(0)
s_mov_b32 s20, 1384448
buffer_load_dword v52, v1, s[12:15], s20 offen
s_mov_b32 s21, 1417216
buffer_load_dword v53, v1, s[12:15], s21 offen
s_waitcnt vmcnt(55)
v_perm_b32 v64, v55, v54, s46
s_barrier
s_mov_b32 s20, 1572864
buffer_load_dword v54, v1, s[12:15], s20 offen
s_mov_b32 s21, 1605632
buffer_load_dword v55, v1, s[12:15], s21 offen
s_waitcnt vmcnt(55)
v_perm_b32 v65, v57, v56, s46
s_mov_b32 s20, 1638400
buffer_load_dword v56, v1, s[12:15], s20 offen
s_mov_b32 s21, 1671168
buffer_load_dword v57, v1, s[12:15], s21 offen
s_waitcnt vmcnt(55)
v_perm_b32 v66, v59, v58, s46
s_mov_b32 s20, 1581056
buffer_load_dword v58, v1, s[12:15], s20 offen
s_mov_b32 s21, 1613824
buffer_load_dword v59, v1, s[12:15], s21 offen
s_waitcnt vmcnt(55)
v_perm_b32 v67, v61, v60, s46
ds_write_b128 v3, v[64:67] offset:19456
s_waitcnt lgkmcnt(0)
s_mov_b32 s20, 1646592
buffer_load_dword v60, v1, s[12:15], s20 offen
s_mov_b32 s21, 1679360
buffer_load_dword v61, v1, s[12:15], s21 offen
s_waitcnt vmcnt(55)
v_perm_b32 v72, v7, v6, s46
v_perm_b32 v80, v7, v6, s47
s_barrier
s_mov_b32 s20, 1835008
buffer_load_dword v6, v1, s[12:15], s20 offen
s_mov_b32 s21, 1867776
buffer_load_dword v7, v1, s[12:15], s21 offen
s_waitcnt vmcnt(55)
v_perm_b32 v73, v9, v8, s46
v_perm_b32 v81, v9, v8, s47
s_mov_b32 s20, 1900544
buffer_load_dword v8, v1, s[12:15], s20 offen
s_mov_b32 s21, 1933312
buffer_load_dword v9, v1, s[12:15], s21 offen
s_waitcnt vmcnt(55)
v_perm_b32 v74, v11, v10, s46
v_perm_b32 v82, v11, v10, s47
s_mov_b32 s20, 1843200
buffer_load_dword v10, v1, s[12:15], s20 offen
s_mov_b32 s21, 1875968
buffer_load_dword v11, v1, s[12:15], s21 offen
s_waitcnt vmcnt(55)
v_perm_b32 v75, v13, v12, s46
v_perm_b32 v83, v13, v12, s47
s_mov_b32 s20, 1908736
buffer_load_dword v12, v1, s[12:15], s20 offen
s_mov_b32 s21, 1941504
buffer_load_dword v13, v1, s[12:15], s21 offen
s_waitcnt vmcnt(55)
v_perm_b32 v76, v15, v14, s46
v_perm_b32 v84, v15, v14, s47
s_barrier
s_mov_b32 s20, 2097152
buffer_load_dword v14, v1, s[12:15], s20 offen
s_mov_b32 s21, 2129920
buffer_load_dword v15, v1, s[12:15], s21 offen
s_waitcnt vmcnt(55)
v_perm_b32 v77, v17, v16, s46
v_perm_b32 v85, v17, v16, s47
s_mov_b32 s20, 2162688
buffer_load_dword v16, v1, s[12:15], s20 offen
s_mov_b32 s21, 2195456
buffer_load_dword v17, v1, s[12:15], s21 offen
s_waitcnt vmcnt(55)
v_perm_b32 v78, v19, v18, s46
v_perm_b32 v86, v19, v18, s47
s_mov_b32 s20, 2105344
buffer_load_dword v18, v1, s[12:15], s20 offen
s_mov_b32 s21, 2138112
buffer_load_dword v19, v1, s[12:15], s21 offen
s_waitcnt vmcnt(55)
v_perm_b32 v79, v21, v20, s46
v_perm_b32 v87, v21, v20, s47
s_mov_b32 s20, 2170880
buffer_load_dword v20, v1, s[12:15], s20 offen
s_mov_b32 s21, 2203648
buffer_load_dword v21, v1, s[12:15], s21 offen
s_waitcnt vmcnt(55)
v_perm_b32 v96, v23, v22, s46
v_perm_b32 v104, v23, v22, s47
s_barrier
s_mov_b32 s20, 2359296
buffer_load_dword v22, v1, s[12:15], s20 offen
s_mov_b32 s21, 2392064
buffer_load_dword v23, v1, s[12:15], s21 offen
s_waitcnt vmcnt(55)
v_perm_b32 v97, v25, v24, s46
v_perm_b32 v105, v25, v24, s47
s_mov_b32 s20, 2424832
buffer_load_dword v24, v1, s[12:15], s20 offen
s_mov_b32 s21, 2457600
buffer_load_dword v25, v1, s[12:15], s21 offen
s_waitcnt vmcnt(55)
v_perm_b32 v98, v27, v26, s46
v_perm_b32 v106, v27, v26, s47
s_mov_b32 s20, 2367488
buffer_load_dword v26, v1, s[12:15], s20 offen
s_mov_b32 s21, 2400256
buffer_load_dword v27, v1, s[12:15], s21 offen
s_waitcnt vmcnt(55)
v_perm_b32 v99, v29, v28, s46
v_perm_b32 v107, v29, v28, s47
s_mov_b32 s20, 2433024
buffer_load_dword v28, v1, s[12:15], s20 offen
s_mov_b32 s21, 2465792
buffer_load_dword v29, v1, s[12:15], s21 offen
s_waitcnt vmcnt(55)
v_perm_b32 v100, v31, v30, s46
v_perm_b32 v108, v31, v30, s47
s_barrier
s_mov_b32 s20, 2621440
buffer_load_dword v30, v1, s[12:15], s20 offen
s_mov_b32 s21, 2654208
buffer_load_dword v31, v1, s[12:15], s21 offen
s_waitcnt vmcnt(55)
v_perm_b32 v101, v33, v32, s46
v_perm_b32 v109, v33, v32, s47
s_mov_b32 s20, 2686976
buffer_load_dword v32, v1, s[12:15], s20 offen
s_mov_b32 s21, 2719744
buffer_load_dword v33, v1, s[12:15], s21 offen
s_waitcnt vmcnt(55)
v_perm_b32 v102, v35, v34, s46
v_perm_b32 v110, v35, v34, s47
s_mov_b32 s20, 2629632
buffer_load_dword v34, v1, s[12:15], s20 offen
s_mov_b32 s21, 2662400
buffer_load_dword v35, v1, s[12:15], s21 offen
s_waitcnt vmcnt(55)
v_perm_b32 v103, v37, v36, s46
v_perm_b32 v111, v37, v36, s47
s_mov_b32 s20, 2695168
buffer_load_dword v36, v1, s[12:15], s20 offen
s_mov_b32 s21, 2727936
buffer_load_dword v37, v1, s[12:15], s21 offen
s_waitcnt vmcnt(54)
v_perm_b32 v120, v39, v38, s46
v_perm_b32 v128, v39, v38, s47
s_barrier
s_mov_b32 s20, 2883584
buffer_load_dword v38, v1, s[12:15], s20 offen
s_mov_b32 s21, 2916352
buffer_load_dword v39, v1, s[12:15], s21 offen
s_waitcnt vmcnt(54)
v_perm_b32 v121, v41, v40, s46
v_perm_b32 v129, v41, v40, s47
s_mov_b32 s20, 2949120
buffer_load_dword v40, v1, s[12:15], s20 offen
s_mov_b32 s21, 2981888
buffer_load_dword v41, v1, s[12:15], s21 offen
s_waitcnt vmcnt(54)
v_perm_b32 v122, v43, v42, s46
v_perm_b32 v130, v43, v42, s47
s_mov_b32 s20, 2891776
buffer_load_dword v42, v1, s[12:15], s20 offen
s_mov_b32 s21, 2924544
buffer_load_dword v43, v1, s[12:15], s21 offen
s_waitcnt vmcnt(54)
v_perm_b32 v123, v45, v44, s46
v_perm_b32 v131, v45, v44, s47
s_mov_b32 s20, 2957312
buffer_load_dword v44, v1, s[12:15], s20 offen
s_mov_b32 s21, 2990080
buffer_load_dword v45, v1, s[12:15], s21 offen
s_waitcnt vmcnt(54)
v_perm_b32 v124, v47, v46, s46
v_perm_b32 v132, v47, v46, s47
s_barrier
s_mov_b32 s20, 3145728
buffer_load_dword v46, v1, s[12:15], s20 offen
s_mov_b32 s21, 3178496
buffer_load_dword v47, v1, s[12:15], s21 offen
s_waitcnt vmcnt(54)
v_perm_b32 v125, v49, v48, s46
v_perm_b32 v133, v49, v48, s47
s_mov_b32 s20, 3211264
buffer_load_dword v48, v1, s[12:15], s20 offen
s_mov_b32 s21, 3244032
buffer_load_dword v49, v1, s[12:15], s21 offen
s_waitcnt vmcnt(54)
v_perm_b32 v126, v51, v50, s46
v_perm_b32 v134, v51, v50, s47
s_mov_b32 s20, 3153920
buffer_load_dword v50, v1, s[12:15], s20 offen
s_mov_b32 s21, 3186688
buffer_load_dword v51, v1, s[12:15], s21 offen
s_waitcnt vmcnt(54)
v_perm_b32 v127, v53, v52, s46
v_perm_b32 v135, v53, v52, s47
s_mov_b32 s20, 3219456
buffer_load_dword v52, v1, s[12:15], s20 offen
s_mov_b32 s21, 3252224
buffer_load_dword v53, v1, s[12:15], s21 offen
s_waitcnt vmcnt(54)
v_perm_b32 v144, v55, v54, s46
v_perm_b32 v152, v55, v54, s47
s_barrier
s_mov_b32 s20, 3407872
buffer_load_dword v54, v1, s[12:15], s20 offen
s_mov_b32 s21, 3440640
buffer_load_dword v55, v1, s[12:15], s21 offen
s_waitcnt vmcnt(54)
v_perm_b32 v145, v57, v56, s46
v_perm_b32 v153, v57, v56, s47
s_mov_b32 s20, 3473408
buffer_load_dword v56, v1, s[12:15], s20 offen
s_mov_b32 s21, 3506176
buffer_load_dword v57, v1, s[12:15], s21 offen
s_waitcnt vmcnt(54)
v_perm_b32 v146, v59, v58, s46
v_perm_b32 v154, v59, v58, s47
s_mov_b32 s20, 3416064
buffer_load_dword v58, v1, s[12:15], s20 offen
s_mov_b32 s21, 3448832
buffer_load_dword v59, v1, s[12:15], s21 offen
s_waitcnt vmcnt(54)
v_perm_b32 v147, v61, v60, s46
v_perm_b32 v155, v61, v60, s47
s_mov_b32 s20, 3481600
buffer_load_dword v60, v1, s[12:15], s20 offen
s_mov_b32 s21, 3514368
buffer_load_dword v61, v1, s[12:15], s21 offen
s_waitcnt vmcnt(54)
v_perm_b32 v148, v7, v6, s46
v_perm_b32 v156, v7, v6, s47
s_barrier
s_mov_b32 s20, 3670016
buffer_load_dword v6, v1, s[12:15], s20 offen
s_mov_b32 s21, 3702784
buffer_load_dword v7, v1, s[12:15], s21 offen
s_waitcnt vmcnt(54)
v_perm_b32 v149, v9, v8, s46
v_perm_b32 v157, v9, v8, s47
s_mov_b32 s20, 3735552
buffer_load_dword v8, v1, s[12:15], s20 offen
s_mov_b32 s21, 3768320
buffer_load_dword v9, v1, s[12:15], s21 offen
s_waitcnt vmcnt(54)
v_perm_b32 v150, v11, v10, s46
v_perm_b32 v158, v11, v10, s47
s_mov_b32 s20, 3678208
buffer_load_dword v10, v1, s[12:15], s20 offen
s_mov_b32 s21, 3710976
buffer_load_dword v11, v1, s[12:15], s21 offen
s_waitcnt vmcnt(54)
v_perm_b32 v151, v13, v12, s46
v_perm_b32 v159, v13, v12, s47
s_mov_b32 s20, 3743744
buffer_load_dword v12, v1, s[12:15], s20 offen
s_mov_b32 s21, 3776512
buffer_load_dword v13, v1, s[12:15], s21 offen
s_waitcnt vmcnt(54)
v_perm_b32 v168, v15, v14, s46
v_perm_b32 v176, v15, v14, s47
s_barrier
s_mov_b32 s20, 3932160
buffer_load_dword v14, v1, s[12:15], s20 offen
s_mov_b32 s21, 3964928
buffer_load_dword v15, v1, s[12:15], s21 offen
s_waitcnt vmcnt(54)
v_perm_b32 v169, v17, v16, s46
v_perm_b32 v177, v17, v16, s47
s_mov_b32 s20, 3997696
buffer_load_dword v16, v1, s[12:15], s20 offen
s_mov_b32 s21, 4030464
buffer_load_dword v17, v1, s[12:15], s21 offen
s_waitcnt vmcnt(54)
v_perm_b32 v170, v19, v18, s46
v_perm_b32 v178, v19, v18, s47
s_mov_b32 s20, 3940352
buffer_load_dword v18, v1, s[12:15], s20 offen
s_mov_b32 s21, 3973120
buffer_load_dword v19, v1, s[12:15], s21 offen
s_waitcnt vmcnt(54)
v_perm_b32 v171, v21, v20, s46
v_perm_b32 v179, v21, v20, s47
s_mov_b32 s20, 4005888
buffer_load_dword v20, v1, s[12:15], s20 offen
s_mov_b32 s21, 4038656
buffer_load_dword v21, v1, s[12:15], s21 offen
s_waitcnt vmcnt(54)
v_perm_b32 v172, v23, v22, s46
v_perm_b32 v180, v23, v22, s47
s_barrier
s_mov_b32 s20, 4194304
buffer_load_dword v22, v1, s[12:15], s20 offen
s_mov_b32 s21, 4227072
buffer_load_dword v23, v1, s[12:15], s21 offen
s_waitcnt vmcnt(54)
v_perm_b32 v173, v25, v24, s46
v_perm_b32 v181, v25, v24, s47
s_mov_b32 s20, 4259840
buffer_load_dword v24, v1, s[12:15], s20 offen
s_mov_b32 s21, 4292608
buffer_load_dword v25, v1, s[12:15], s21 offen
s_waitcnt vmcnt(54)
v_perm_b32 v174, v27, v26, s46
v_perm_b32 v182, v27, v26, s47
s_mov_b32 s20, 4202496
buffer_load_dword v26, v1, s[12:15], s20 offen
s_mov_b32 s21, 4235264
buffer_load_dword v27, v1, s[12:15], s21 offen
s_waitcnt vmcnt(54)
v_perm_b32 v175, v29, v28, s46
v_perm_b32 v183, v29, v28, s47
s_mov_b32 s20, 4268032
buffer_load_dword v28, v1, s[12:15], s20 offen
s_mov_b32 s21, 4300800
buffer_load_dword v29, v1, s[12:15], s21 offen
s_waitcnt vmcnt(54)
v_perm_b32 v192, v31, v30, s46
v_perm_b32 v200, v31, v30, s47
s_barrier
s_mov_b32 s20, 4456448
buffer_load_dword v30, v1, s[12:15], s20 offen
s_mov_b32 s21, 4489216
buffer_load_dword v31, v1, s[12:15], s21 offen
s_waitcnt vmcnt(54)
v_perm_b32 v193, v33, v32, s46
v_perm_b32 v201, v33, v32, s47
s_mov_b32 s20, 4521984
buffer_load_dword v32, v1, s[12:15], s20 offen
s_mov_b32 s21, 4554752
buffer_load_dword v33, v1, s[12:15], s21 offen
s_waitcnt vmcnt(54)
v_perm_b32 v194, v35, v34, s46
v_perm_b32 v202, v35, v34, s47
s_mov_b32 s20, 4464640
buffer_load_dword v34, v1, s[12:15], s20 offen
s_mov_b32 s21, 4497408
buffer_load_dword v35, v1, s[12:15], s21 offen
s_waitcnt vmcnt(54)
v_perm_b32 v195, v37, v36, s46
v_perm_b32 v203, v37, v36, s47
s_mov_b32 s20, 4530176
buffer_load_dword v36, v1, s[12:15], s20 offen
s_mov_b32 s21, 4562944
buffer_load_dword v37, v1, s[12:15], s21 offen
s_waitcnt vmcnt(54)
v_perm_b32 v196, v39, v38, s46
v_perm_b32 v204, v39, v38, s47
s_waitcnt vmcnt(52)
v_perm_b32 v197, v41, v40, s46
v_perm_b32 v205, v41, v40, s47
s_waitcnt vmcnt(50)
v_perm_b32 v198, v43, v42, s46
v_perm_b32 v206, v43, v42, s47
s_waitcnt vmcnt(48)
v_perm_b32 v199, v45, v44, s46
v_perm_b32 v207, v45, v44, s47
s_waitcnt vmcnt(46)
v_perm_b32 v216, v47, v46, s46
v_perm_b32 v224, v47, v46, s47
s_waitcnt vmcnt(44)
v_perm_b32 v217, v49, v48, s46
v_perm_b32 v225, v49, v48, s47
s_waitcnt vmcnt(42)
v_perm_b32 v218, v51, v50, s46
v_perm_b32 v226, v51, v50, s47
s_waitcnt vmcnt(40)
v_perm_b32 v219, v53, v52, s46
v_perm_b32 v227, v53, v52, s47
s_waitcnt vmcnt(38)
v_perm_b32 v220, v55, v54, s46
v_perm_b32 v228, v55, v54, s47
s_waitcnt vmcnt(36)
v_perm_b32 v221, v57, v56, s46
v_perm_b32 v229, v57, v56, s47
s_waitcnt vmcnt(34)
v_perm_b32 v222, v59, v58, s46
v_perm_b32 v230, v59, v58, s47
s_waitcnt vmcnt(32)
v_perm_b32 v223, v61, v60, s46
v_perm_b32 v231, v61, v60, s47
s_waitcnt vmcnt(30)
v_perm_b32 v240, v7, v6, s46
v_perm_b32 v248, v7, v6, s47
s_waitcnt vmcnt(28)
v_perm_b32 v241, v9, v8, s46
v_perm_b32 v249, v9, v8, s47
s_waitcnt vmcnt(26)
v_perm_b32 v242, v11, v10, s46
v_perm_b32 v250, v11, v10, s47
s_waitcnt vmcnt(24)
v_perm_b32 v243, v13, v12, s46
v_perm_b32 v251, v13, v12, s47
s_waitcnt vmcnt(22)
v_perm_b32 v244, v15, v14, s46
v_perm_b32 v252, v15, v14, s47
s_waitcnt vmcnt(20)
v_perm_b32 v245, v17, v16, s46
v_perm_b32 v253, v17, v16, s47
s_waitcnt vmcnt(18)
v_perm_b32 v246, v19, v18, s46
v_perm_b32 v254, v19, v18, s47
s_waitcnt vmcnt(16)
v_perm_b32 v247, v21, v20, s46
v_perm_b32 v255, v21, v20, s47
s_waitcnt vmcnt(14)
v_perm_b32 v64, v23, v22, s46
v_accvgpr_write_b32 a8, v64
v_perm_b32 v68, v23, v22, s47
v_accvgpr_write_b32 a16, v68
s_waitcnt vmcnt(12)
v_perm_b32 v65, v25, v24, s46
v_accvgpr_write_b32 a9, v65
v_perm_b32 v69, v25, v24, s47
v_accvgpr_write_b32 a17, v69
s_waitcnt vmcnt(10)
v_perm_b32 v66, v27, v26, s46
v_accvgpr_write_b32 a10, v66
v_perm_b32 v70, v27, v26, s47
v_accvgpr_write_b32 a18, v70
s_waitcnt vmcnt(8)
v_perm_b32 v67, v29, v28, s46
v_accvgpr_write_b32 a11, v67
v_perm_b32 v71, v29, v28, s47
v_accvgpr_write_b32 a19, v71
s_waitcnt vmcnt(6)
v_perm_b32 v64, v31, v30, s46
v_accvgpr_write_b32 a12, v64
v_perm_b32 v68, v31, v30, s47
v_accvgpr_write_b32 a20, v68
s_waitcnt vmcnt(4)
v_perm_b32 v65, v33, v32, s46
v_accvgpr_write_b32 a13, v65
v_perm_b32 v69, v33, v32, s47
v_accvgpr_write_b32 a21, v69
s_waitcnt vmcnt(2)
v_perm_b32 v66, v35, v34, s46
v_accvgpr_write_b32 a14, v66
v_perm_b32 v70, v35, v34, s47
v_accvgpr_write_b32 a22, v70
s_waitcnt vmcnt(0)
v_perm_b32 v67, v37, v36, s46
v_accvgpr_write_b32 a15, v67
v_perm_b32 v71, v37, v36, s47
v_accvgpr_write_b32 a23, v71
v_and_b32 v6, 1, v0
v_lshlrev_b32 v7, 6, v6
v_mul_u32_u24 v6, 24, v6
v_sub_u32 v6, 32, v6
v_cmp_ne_u32 vcc, v5, v6
s_cbranch_vccz L_tok
v_add_u32 v7, 64, v7
s_mov_b32 s28, 0
L_poll_49:
buffer_load_dword v5, v7, s[56:59], 0 offen sc1
s_add_u32 s28, s28, 1
s_cmp_gt_u32 s28, 40000
s_cbranch_scc1 L_end
s_waitcnt vmcnt(0)
v_cmp_ne_u32 vcc, v5, v6
s_cbranch_vccz L_pd_50
s_sleep 1
s_branch L_poll_49
L_pd_50:
L_tok:
v_mov_b32 v12, v0
v_and_b32 v13, 15, v0
v_bfe_u32 v14, v0, 4, 2
v_lshlrev_b32 v3, 4, v12
v_and_b32 v2, 0x3f0, v3
s_mul_i32 s20, s17, 34816
s_add_u32 s20, s20, 24576
v_add_u32 v2, s20, v2
v_and_b32 v15, 1, v12
v_mul_u32_u24 v0, 0xaaaa, v15
v_add_u32 v0, 0xffff4444, v0
v_lshrrev_b32 v18, 2, v13
v_lshl_add_u32 v18, v18, 1, v15
v_bfe_u32 v19, v13, 1, 1
v_lshrrev_b32 v16, 5, v12
v_lshlrev_b32 v16, 8, v16
v_lshl_add_u32 v16, v18, 5, v16
v_and_b32 v17, 1, v14
v_lshl_add_u32 v16, v17, 4, v16
v_and_b32 v17, 0x7f, v16
v_xor_b32 v17, 16, v17
v_add_u32 v16, 4224, v16
v_add_u32 v17, 6272, v17
v_cmp_eq_u32 vcc, 1, v19
s_nop 1
v_cndmask_b32 v7, v17, v16, vcc
v_lshrrev_b32 v16, 1, v14
v_lshlrev_b32 v16, 8, v16
v_lshl_add_u32 v16, v15, 7, v16
v_and_b32 v17, 1, v14
v_lshl_add_u32 v16, v17, 6, v16
v_lshrrev_b32 v17, 2, v13
v_lshl_add_u32 v16, v17, 4, v16
v_mul_u32_u24 v17, 2112, v19
v_add_u32 v5, v16, v17
v_bfe_u32 v16, v13, 3, 1
v_lshlrev_b32 v16, 8, v16
v_lshl_add_u32 v16, v19, 6, v16
v_lshl_add_u32 v16, v14, 4, v16
v_bfe_u32 v17, v13, 2, 1
v_lshl_add_u32 v16, v17, 3, v16
v_lshl_add_u32 v16, v15, 2, v16
s_lshl_b32 s20, s17, 9
v_add_u32 v4, s20, v16
v_lshrrev_b32 v16, 4, v12
v_xor_b32 v17, s16, v16
v_lshlrev_b32 v16, 12, v16
v_lshl_add_u32 v16, v17, 7, v16
v_lshl_add_u32 v9, v13, 3, v16
s_lshr_b32 s20, s17, 1
s_lshl_b32 s20, s20, 2
v_add_u32 v16, s20, v14
v_xor_b32 v17, s16, v16
v_lshlrev_b32 v16, 12, v16
v_lshl_add_u32 v16, v17, 7, v16
v_lshl_add_u32 v16, v13, 2, v16
s_and_b32 s20, s17, 1
s_lshl_b32 s20, s20, 6
s_add_u32 s20, s20, 262144
v_add_u32 v10, s20, v16
v_bfe_u32 v16, v13, 2, 1
v_lshlrev_b32 v16, 5, v16
v_and_b32 v17, 1, v14
v_lshl_add_u32 v16, v17, 8, v16
v_lshrrev_b32 v17, 1, v14
v_lshl_add_u32 v16, v17, 4, v16
v_and_b32 v17, 3, v13
v_lshl_add_u32 v11, v17, 2, v16
v_lshlrev_b32 v6, 7, v12
v_lshlrev_b32 v8, 2, v12
s_mov_b32 s36, 0x11111111
s_mov_b32 s37, 0x11111111
s_mov_b32 s38, 0x22222222
s_mov_b32 s39, 0x22222222
s_mov_b32 s40, 0x44444444
s_mov_b32 s41, 0x44444444
s_mov_b32 s42, 0x88888888
s_mov_b32 s43, 0x88888888
s_mov_b32 s44, 0xf0f0f0f0
s_mov_b32 s45, 0xf0f0f0f0
s_mov_b32 s18, 0x3e0293ee
s_lshl_b32 s20, s17, 5
s_add_u32 s20, s20, s16
s_cmp_lt_u32 s20, 72
s_cselect_b32 s48, 1, 0
s_lshl_b32 s23, s20, 12
s_lshl_b32 s21, s17, 10
s_sub_u32 s23, s23, s21
s_lshr_b32 s24, s20, 2
s_lshl_b32 s24, s24, 9
s_and_b32 s21, s20, 3
s_lshl_b32 s21, s21, 6
s_add_u32 s24, s24, s21
s_add_u32 s24, s24, 110100480
s_cmp_lt_u32 s20, 72
s_cselect_b32 s24, s24, 536870912
s_lshl_b32 s25, s16, 12
s_add_u32 s26, s25, 131072
s_add_u32 s27, s25, 262144
s_cmp_lt_u32 s16, 8
s_cselect_b32 s27, s27, 536870912
s_mov_b32 s28, 109051904
s_mov_b32 s29, 109346816
s_lshl_b32 s30, s16, 14
s_add_u32 s30, s30, 33554432
s_lshl_b32 s31, s16, 12
s_add_u32 s31, s31, 100663296
s_add_u32 s35, s24, 32768
s_mov_b32 s53, 0x3f803f80
s_mov_b32 s86, 0x33333333
s_mov_b32 s87, 0x33333333
s_lshl_b32 s84, s17, 13
s_sub_u32 s84, s20, s84
s_add_u32 s84, s84, 110886912
s_cmp_lt_u32 s20, 72
s_cselect_b32 s84, s84, 536870912
s_and_b32 s21, s16, 3
s_lshl_b32 s21, s21, 7
s_add_u32 s21, s21, 110886144
s_cmp_eq_u32 s17, 3
s_cselect_b32 s84, s21, s84
s_lshl_b32 s82, s16, 7
s_add_u32 s83, s82, 111152384
s_add_u32 s82, s82, 111148288
s_mov_b32 s19, 0
s_getpc_b64 s[4:5]
L_pc2:
s_mov_b32 s12, s4
s_and_b32 s13, s5, 0xffff
s_mov_b32 s14, L_end-L_pc2
s_mov_b32 s15, 0x20000
buffer_load_dword v40, v6, s[12:15], 0 offen
s_mul_i32 s20, s16, 18432
s_add_u32 s20, s20, 109051904
s_lshl_b32 s21, s16, 11
s_add_u32 s21, s21, 110075904
s_cmp_eq_u32 s17, 3
s_cselect_b32 s20, s21, s20
buffer_load_dword v41, v6, s[8:11], s20 offen sc1
s_mov_b32 s12, s96
s_and_b32 s13, s97, 0xffff
s_mov_b32 s14, 9216
s_mov_b32 s15, 0x20000
v_bfe_u32 v64, v3, 5, 3
v_mul_u32_u24 v64, 1152, v64
v_lshrrev_b32 v65, 8, v3
v_lshl_add_u32 v64, v65, 5, v64
v_and_b32 v65, 16, v3
v_add_u32 v64, v64, v65
buffer_load_dwordx4 v[24:27], v64, s[12:15], 0 offen
buffer_load_dwordx4 v[28:31], v64, s[12:15], 0 offen offset:512
buffer_load_dwordx4 v[32:35], v64, s[12:15], 0 offen offset:1024
v_mov_b32 v66, 0
s_lshl_b32 s21, s16, 7
s_add_u32 s21, s21, 111149088
s_mov_b32 s22, 0
L_poll_51:
buffer_load_dword v67, v66, s[8:11], s21 offen sc1
s_add_u32 s22, s22, 1
s_cmp_gt_u32 s22, 40000
s_cbranch_scc1 L_end
s_waitcnt vmcnt(0)
v_cmp_ne_u32 vcc, 1, v67
s_cbranch_vccz L_pd_52
s_branch L_poll_51
L_pd_52:
s_cmp_lt_u32 s17, 2
s_cselect_b32 s21, s30, 536870912
buffer_load_dword v67, v6, s[8:11], s21 offen sc1
s_waitcnt vmcnt(0)
v_perm_b32 v12, v26, v24, s46
v_perm_b32 v13, v26, v24, s47
v_perm_b32 v14, v27, v25, s46
v_perm_b32 v15, v27, v25, s47
v_min_u32 v12, 0xfffeffff, v12
v_min_u32 v13, 0xfffeffff, v13
v_min_u32 v14, 0xfffeffff, v14
v_min_u32 v15, 0xfffeffff, v15
v_perm_b32 v16, v30, v28, s46
v_perm_b32 v17, v30, v28, s47
v_perm_b32 v18, v31, v29, s46
v_perm_b32 v19, v31, v29, s47
v_min_u32 v16, 0xfffeffff, v16
v_min_u32 v17, 0xfffeffff, v17
v_min_u32 v18, 0xfffeffff, v18
v_min_u32 v19, 0xfffeffff, v19
v_perm_b32 v20, v34, v32, s46
v_perm_b32 v21, v34, v32, s47
v_perm_b32 v22, v35, v33, s46
v_perm_b32 v23, v35, v33, s47
v_min_u32 v20, 0xfffeffff, v20
v_min_u32 v21, 0xfffeffff, v21
v_min_u32 v22, 0xfffeffff, v22
v_min_u32 v23, 0xfffeffff, v23
s_cmp_lg_u32 s17, 0
s_cbranch_scc1 L_m0_53
ds_write_b128 v3, v[20:23] offset:14848
v_mov_b32 v64, 6528
v_mov_b32 v56, 0
v_mov_b32 v57, 0
v_mov_b32 v58, 0
v_mov_b32 v59, 0
ds_write_b128 v64, v[56:59]
L_m0_53:
s_waitcnt lgkmcnt(0)
s_barrier
ds_read_b32 v20, v8 offset:14848
s_waitcnt lgkmcnt(0)
s_mov_b32 s33, 110100480
s_mov_b32 s6, 110100480
s_mov_b32 s7, 110100480
s_mov_b32 s22, 0
s_cmp_eq_u32 s17, 0
s_cbranch_scc1 L_ent0
s_cmp_eq_u32 s17, 1
s_cbranch_scc1 L_ent1
s_cmp_eq_u32 s17, 2
s_cbranch_scc1 L_ent2
s_cmp_eq_u32 s17, 3
s_cbranch_scc1 L_ent3
s_branch L_end
L_ent0:
s_movk_i32 s4, -64
s_mov_b32 s14, s53
s_mov_b32 s15, s53
v_mov_b64 v[24:25], 0
v_mov_b64 v[26:27], 0
v_mov_b64 v[28:29], 0
v_mov_b64 v[30:31], 0
v_and_b32 v69, 0x380, v3
v_add_u32 v69, v69, v3
v_and_b32 v70, 0xf40, v3
v_add_u32 v70, v70, v3
v_bfe_u32 v71, v3, 7, 1
v_mad_i32_i24 v70, v71, s4, v70
v_mov_b64 v[64:65], -1
v_mov_b64 v[66:67], -1
v_add_u32 v1, 2112, v4
ds_read_b128 v[48:51], v2 offset:8192
ds_read_b128 v[52:55], v2 offset:9216
ds_read_b128 v[40:43], v2
ds_read_b128 v[44:47], v2 offset:1024
v_mov_b64 v[32:33], 0
v_mov_b64 v[34:35], 0
v_mov_b64 v[36:37], 0
v_mov_b64 v[38:39], 0
v_mov_b64 v[56:57], 0
v_mov_b64 v[58:59], 0
v_mov_b64 v[60:61], 0
v_mov_b64 v[62:63], 0
s_add_u32 s20, s30, 0
s_add_u32 s21, s30, 8192
s_add_u32 s49, s29, s25
s_add_u32 s50, s29, s26
s_add_u32 s51, s29, s27
s_add_u32 s52, s30, 524288
s_mov_b32 m0, 15872
s_nop 0
buffer_load_dwordx4 v69, s[8:11], s20 offen sc1 lds
s_mov_b32 m0, 16768
s_nop 0
buffer_load_dwordx4 v69, s[8:11], s20 offen offset:128 sc1 lds
s_waitcnt vmcnt(0) lgkmcnt(0)
s_branch L_step0
L_gr0:
buffer_load_dwordx4 v[12:15], v3, s[8:11], s33 offen sc1
buffer_load_dword v20, v8, s[8:11], s7 offen sc1
buffer_load_dwordx4 v[16:19], v3, s[8:11], s6 offen sc1
s_add_u32 s22, s22, 1
s_cmp_gt_u32 s22, 40000
s_cbranch_scc1 L_end
buffer_load_dwordx4 v[16:19], v3, s[8:11], s6 offen sc1
v_mov_b64 v[24:25], 0
v_mov_b64 v[26:27], 0
v_mov_b64 v[28:29], 0
v_mov_b64 v[30:31], 0
v_mov_b64 v[32:33], 0
v_mov_b64 v[34:35], 0
v_mov_b64 v[36:37], 0
v_mov_b64 v[38:39], 0
v_mov_b64 v[56:57], 0
v_mov_b64 v[58:59], 0
v_mov_b64 v[60:61], 0
v_mov_b64 v[62:63], 0
s_waitcnt lgkmcnt(0)
s_branch L_step0
.p2align 3
L_gat0:
buffer_load_dwordx4 v[12:15], v3, s[8:11], s33 offen sc1
buffer_load_dword v20, v8, s[8:11], s7 offen sc1
s_add_u32 s20, s30, 0
s_add_u32 s21, s30, 8192
s_add_u32 s49, s29, s25
s_add_u32 s50, s29, s26
s_add_u32 s51, s29, s27
s_add_u32 s52, s30, 524288
buffer_load_dwordx4 v[16:19], v3, s[8:11], s6 offen sc1
s_mov_b32 m0, 15872
s_waitcnt vmcnt(4)
ds_read_b128 v[40:43], v2
ds_read_b128 v[44:47], v2 offset:1024
v_mov_b64 v[32:33], 0
v_mov_b64 v[34:35], 0
v_mov_b64 v[36:37], 0
v_mov_b64 v[38:39], 0
v_mov_b64 v[56:57], 0
v_mov_b64 v[58:59], 0
v_mov_b64 v[60:61], 0
v_mov_b64 v[62:63], 0
s_nop 3
buffer_load_dwordx4 v[16:19], v3, s[8:11], s6 offen sc1
s_waitcnt lgkmcnt(0)
L_step0:
s_waitcnt vmcnt(3)
v_smfmac_f32_16x16x64_bf16 v[24:27], v[12:15], v[72:79], v0
ds_write_b128 v3, v[12:15] offset:6656
v_smfmac_f32_16x16x64_bf16 v[28:31], v[12:15], v[80:87], v0
s_waitcnt vmcnt(2)
v_max3_u32 v21, v12, v13, v14
v_max3_u32 v21, v21, v15, v20
v_cmp_le_u32 vcc, 0xffff0000, v21
v_smfmac_f32_16x16x64_bf16 v[32:35], v[12:15], v[88:95], v0
s_cbranch_vccnz L_gr0
s_waitcnt vmcnt(1)
v_max3_u32 v21, v16, v17, v18
v_max_u32 v21, v21, v19
v_cmp_le_u32 vcc, 0xffff0000, v21
ds_write_b32 v8, v20 offset:14848
v_smfmac_f32_16x16x64_bf16 v[56:59], v[12:15], a[32:39], v0
s_cbranch_vccnz L_g3r0
L_g30:
ds_write_b128 v3, v[16:19] offset:10752
v_smfmac_f32_16x16x64_bf16 v[60:63], v[12:15], a[40:47], v0
v_smfmac_f32_16x16x64_bf16 v[36:39], v[12:15], v[40:47], v0
v_smfmac_f32_16x16x64_bf16 v[24:27], v[16:19], v[168:175], v0
v_smfmac_f32_16x16x64_bf16 v[28:31], v[16:19], v[176:183], v0
s_waitcnt lgkmcnt(0)
s_barrier
ds_read_b128 v[20:23], v3 offset:7680
v_smfmac_f32_16x16x64_bf16 v[32:35], v[16:19], v[184:191], v0
ds_read_b128 v[12:15], v3 offset:8704
s_mov_b32 m0, 6272
buffer_store_dword v0, v11, s[8:11], s35 offen
v_smfmac_f32_16x16x64_bf16 v[56:59], v[16:19], a[96:103], v0
ds_read_b128 v[40:43], v2 offset:2048
buffer_store_dwordx4 v[64:67], v3, s[8:11], s49 offen
v_smfmac_f32_16x16x64_bf16 v[60:63], v[16:19], a[104:111], v0
ds_read_b128 v[44:47], v2 offset:3072
v_smfmac_f32_16x16x64_bf16 v[36:39], v[16:19], v[48:55], v0
s_waitcnt vmcnt(2)
ds_read_b128 v[16:19], v3 offset:9728
buffer_store_dwordx4 v[64:67], v3, s[8:11], s50 offen
s_waitcnt lgkmcnt(4)
v_smfmac_f32_16x16x64_bf16 v[24:27], v[20:23], v[96:103], v0
ds_read_b128 v[48:51], v2 offset:4096
v_smfmac_f32_16x16x64_bf16 v[28:31], v[20:23], v[104:111], v0
ds_read_b128 v[52:55], v2 offset:5120
buffer_store_dwordx4 v[64:67], v3, s[8:11], s51 offen
v_smfmac_f32_16x16x64_bf16 v[32:35], v[20:23], v[112:119], v0
s_waitcnt lgkmcnt(3)
v_smfmac_f32_16x16x64_bf16 v[36:39], v[20:23], v[40:47], v0
ds_read_b128 v[20:23], v3 offset:11776
buffer_load_dwordx4 v[64:67], v70, s[8:11], s21 offen sc1
v_smfmac_f32_16x16x64_bf16 v[24:27], v[12:15], v[120:127], v0
ds_read_b128 v[40:43], v2 offset:6144
v_smfmac_f32_16x16x64_bf16 v[28:31], v[12:15], v[128:135], v0
ds_read_b128 v[44:47], v2 offset:7168
buffer_load_dwordx4 v[68:71], v70, s[8:11], s21 offen offset:256 sc1
v_smfmac_f32_16x16x64_bf16 v[32:35], v[12:15], v[136:143], v0
s_waitcnt lgkmcnt(3)
v_smfmac_f32_16x16x64_bf16 v[36:39], v[12:15], v[48:55], v0
ds_read_b128 v[12:15], v3 offset:12800
v_smfmac_f32_16x16x64_bf16 v[24:27], v[16:19], v[144:151], v0
ds_read_b128 v[48:51], v2 offset:10240
v_smfmac_f32_16x16x64_bf16 v[28:31], v[16:19], v[152:159], v0
ds_read_b128 v[52:55], v2 offset:11264
v_smfmac_f32_16x16x64_bf16 v[32:35], v[16:19], v[160:167], v0
s_waitcnt lgkmcnt(3)
buffer_load_dword v6, s[8:11], s52 offen sc1 lds
v_smfmac_f32_16x16x64_bf16 v[36:39], v[16:19], v[40:47], v0
ds_read_b128 v[16:19], v3 offset:13824
v_smfmac_f32_16x16x64_bf16 v[24:27], v[20:23], v[192:199], v0
ds_read_b128 v[40:43], v2 offset:12288
v_smfmac_f32_16x16x64_bf16 v[28:31], v[20:23], v[200:207], v0
ds_read_b128 v[44:47], v2 offset:13312
v_smfmac_f32_16x16x64_bf16 v[32:35], v[20:23], v[208:215], v0
s_waitcnt lgkmcnt(3)
v_smfmac_f32_16x16x64_bf16 v[36:39], v[20:23], v[48:55], v0
ds_read_b128 v[20:23], v3 offset:14848
v_smfmac_f32_16x16x64_bf16 v[24:27], v[12:15], v[216:223], v0
ds_read_b128 v[48:51], v2 offset:14336
v_smfmac_f32_16x16x64_bf16 v[28:31], v[12:15], v[224:231], v0
ds_read_b128 v[52:55], v2 offset:15360
v_smfmac_f32_16x16x64_bf16 v[32:35], v[12:15], v[232:239], v0
s_waitcnt lgkmcnt(3)
v_smfmac_f32_16x16x64_bf16 v[36:39], v[12:15], v[40:47], v0
ds_read_b128 v[12:15], v3 offset:7680
v_smfmac_f32_16x16x64_bf16 v[24:27], v[16:19], v[240:247], v0
ds_read_b128 v[40:43], v2 offset:16384
v_smfmac_f32_16x16x64_bf16 v[28:31], v[16:19], v[248:255], v0
ds_read_b128 v[44:47], v2 offset:17408
v_smfmac_f32_16x16x64_bf16 v[32:35], v[16:19], a[0:7], v0
s_waitcnt lgkmcnt(3)
v_smfmac_f32_16x16x64_bf16 v[36:39], v[16:19], v[48:55], v0
ds_read_b128 v[16:19], v3 offset:8704
v_smfmac_f32_16x16x64_bf16 v[24:27], v[20:23], a[8:15], v0
ds_read_b128 v[48:51], v3 offset:19968
v_smfmac_f32_16x16x64_bf16 v[28:31], v[20:23], a[16:23], v0
ds_read_b128 v[52:55], v3 offset:22016
v_smfmac_f32_16x16x64_bf16 v[32:35], v[20:23], a[24:31], v0
s_waitcnt lgkmcnt(3)
v_smfmac_f32_16x16x64_bf16 v[36:39], v[20:23], v[40:47], v0
ds_read_b128 v[20:23], v3 offset:9728
s_nop 0
v_add_f32 v24, v24, v25
v_smfmac_f32_16x16x64_bf16 v[56:59], v[12:15], a[48:55], v0
ds_read_b128 v[40:43], v3 offset:15872
v_add_f32 v26, v26, v27
v_add_f32 v28, v28, v29
v_add_f32 v30, v30, v31
v_mul_f32 v24, s18, v24
v_smfmac_f32_16x16x64_bf16 v[60:63], v[12:15], a[56:63], v0
ds_read_b128 v[12:15], v3 offset:11776
v_mul_f32 v28, s18, v28
v_mul_f32 v26, s18, v26
v_mul_f32 v30, s18, v30
v_cvt_pk_bf16_f32 v24, v24, v28
s_waitcnt lgkmcnt(5)
v_smfmac_f32_16x16x64_bf16 v[56:59], v[16:19], a[64:71], v0
ds_read_b128 v[44:47], v3 offset:17920
v_cvt_pk_bf16_f32 v26, v26, v30
ds_write2_b32 v1, v24, v26 offset1:32
v_add_f32 v32, v32, v33
v_add_f32 v34, v34, v35
v_smfmac_f32_16x16x64_bf16 v[60:63], v[16:19], a[72:79], v0
ds_read_b128 v[16:19], v3 offset:12800
v_add_f32 v36, v36, v37
v_add_f32 v38, v38, v39
v_cvt_pk_bf16_f32 v32, v32, v36
v_cvt_pk_bf16_f32 v34, v34, v38
s_waitcnt lgkmcnt(5)
v_smfmac_f32_16x16x64_bf16 v[56:59], v[20:23], a[80:87], v0
ds_write2_b32 v4, v32, v34 offset1:32
v_smfmac_f32_16x16x64_bf16 v[60:63], v[20:23], a[88:95], v0
s_waitcnt lgkmcnt(4)
ds_read_b128 v[20:23], v3 offset:13824
buffer_store_dword v32, v4, s[8:11], s31 offen sc1
v_smfmac_f32_16x16x64_bf16 v[56:59], v[12:15], a[112:119], v0
v_smfmac_f32_16x16x64_bf16 v[60:63], v[12:15], a[120:127], v0
s_waitcnt lgkmcnt(2)
ds_read_b128 v[12:15], v3 offset:14848
buffer_store_dword v34, v4, s[8:11], s31 offen offset:128 sc1
v_smfmac_f32_16x16x64_bf16 v[56:59], v[16:19], a[128:135], v0
v_smfmac_f32_16x16x64_bf16 v[60:63], v[16:19], a[136:143], v0
s_waitcnt lgkmcnt(1)
v_smfmac_f32_16x16x64_bf16 v[56:59], v[20:23], a[144:151], v0
s_barrier
ds_read_b128 v[24:27], v5
v_smfmac_f32_16x16x64_bf16 v[60:63], v[20:23], a[152:159], v0
s_waitcnt lgkmcnt(1)
ds_read_b128 v[28:31], v5 offset:512
v_smfmac_f32_16x16x64_bf16 v[56:59], v[12:15], a[160:167], v0
ds_read_b128 v[32:35], v5 offset:1024
v_smfmac_f32_16x16x64_bf16 v[60:63], v[12:15], a[168:175], v0
s_waitcnt lgkmcnt(2)
ds_read_b128 v[36:39], v5 offset:1536
v_mfma_f32_16x16x32_bf16 v[16:19], v[40:43], v[24:27], 0
s_waitcnt lgkmcnt(2)
ds_read_b128 v[40:43], v3 offset:16896
v_mfma_f32_16x16x32_bf16 v[16:19], v[44:47], v[28:31], v[16:19]
s_waitcnt lgkmcnt(2)
ds_read_b128 v[44:47], v3 offset:18944
v_mfma_f32_16x16x32_bf16 v[16:19], v[48:51], v[32:35], v[16:19]
s_waitcnt lgkmcnt(2)
ds_read_b128 v[48:51], v3 offset:20992
v_add_f32 v56, v56, v57
v_mfma_f32_16x16x32_bf16 v[16:19], v[52:55], v[36:39], v[16:19]
ds_read_b128 v[52:55], v3 offset:23040
v_add_f32 v58, v58, v59
v_mfma_f32_16x16x32_bf16 v[20:23], v[24:27], v[24:27], 0
s_add_u32 s49, s28, s23
v_add_f32 v60, v60, v61
v_add_f32 v62, v62, v63
v_mfma_f32_16x16x32_bf16 v[20:23], v[28:31], v[28:31], v[20:23]
s_add_u32 s50, s28, 65536
v_cvt_pk_bf16_f32 v56, v56, v58
v_cvt_pk_bf16_f32 v57, v60, v62
v_mfma_f32_16x16x32_bf16 v[20:23], v[32:35], v[32:35], v[20:23]
s_add_u32 s51, s28, 131072
v_exp_f32 v16, v16
buffer_store_dword v56, v8, s[8:11], s31 offen offset:2048 sc1
v_mfma_f32_16x16x32_bf16 v[20:23], v[36:39], v[36:39], v[20:23]
s_waitcnt lgkmcnt(3)
v_exp_f32 v17, v17
v_mfma_f32_16x16x32_bf16 v[12:15], v[40:43], v[24:27], 0
s_waitcnt lgkmcnt(2)
v_exp_f32 v18, v18
buffer_store_dword v57, v8, s[8:11], s31 offen offset:3072 sc1
v_mfma_f32_16x16x32_bf16 v[12:15], v[44:47], v[28:31], v[12:15]
s_waitcnt lgkmcnt(1)
v_exp_f32 v19, v19
v_mfma_f32_16x16x32_bf16 v[12:15], v[48:51], v[32:35], v[12:15]
s_waitcnt lgkmcnt(0)
v_exp_f32 v20, v20
v_mfma_f32_16x16x32_bf16 v[12:15], v[52:55], v[36:39], v[12:15]
s_add_u32 s52, s28, 196608
v_exp_f32 v21, v21
v_mov_b64 v[60:61], s[14:15]
v_cvt_pk_bf16_f32 v23, v20, v21
v_cvt_pk_bf16_f32 v20, v20, v21
v_mov_b32 v21, 0
v_mov_b32 v22, 0
v_cvt_pk_bf16_f32 v16, v16, v17
v_cvt_pk_bf16_f32 v17, v18, v19
v_mfma_f32_16x16x16_bf16 v[24:27], v[56:57], v[20:21], 0
v_exp_f32 v12, v12
v_mfma_f32_16x16x16_bf16 v[28:31], v[56:57], v[22:23], 0
v_exp_f32 v13, v13
v_mfma_f32_16x16x16_bf16 v[32:35], v[60:61], v[20:21], 0
v_exp_f32 v14, v14
v_exp_f32 v15, v15
v_mov_b64 v[62:63], s[14:15]
v_cvt_pk_bf16_f32 v18, v12, v13
v_cvt_pk_bf16_f32 v19, v14, v15
s_waitcnt vmcnt(5)
ds_read_b128 v[40:43], v2 offset:18432
v_mfma_f32_16x16x32_bf16 v[32:35], v[60:63], v[16:19], v[32:35]
ds_read_b128 v[44:47], v2 offset:19456
v_mov_b32 v20, 0
v_mfma_f32_16x16x32_bf16 v[24:27], v[64:67], v[16:19], v[24:27]
ds_read_b128 v[48:51], v2 offset:20480
v_mov_b32 v23, 0
v_mfma_f32_16x16x32_bf16 v[28:31], v[68:71], v[16:19], v[28:31]
ds_read_b128 v[52:55], v2 offset:21504
v_mov_b32 v15, 0
v_rcp_f32 v12, v32
v_subrev_u32 v14, 0x21800000, v32
v_cmp_le_u32 vcc, 0x3c000000, v14
v_pk_mul_f32 v[24:25], v[24:25], v[12:13] op_sel_hi:[1,0]
v_pk_mul_f32 v[26:27], v[26:27], v[12:13] op_sel_hi:[1,0]
ds_read_b128 v[32:35], v2 offset:22528
v_pk_mul_f32 v[28:29], v[28:29], v[12:13] op_sel_hi:[1,0]
v_pk_mul_f32 v[30:31], v[30:31], v[12:13] op_sel_hi:[1,0]
v_cvt_pk_bf16_f32 v24, v24, v28
v_cvt_pk_bf16_f32 v25, v25, v29
v_cvt_pk_bf16_f32 v26, v26, v30
v_cvt_pk_bf16_f32 v27, v27, v31
v_mfma_f32_16x16x32_bf16 v[16:19], v[20:23], v[20:23], 0
ds_write_b128 v7, v[24:27]
v_mfma_f32_16x16x32_bf16 v[12:15], v[20:23], v[20:23], 0
s_andn2_b64 vcc, vcc, s[86:87]
ds_read_b128 v[36:39], v2 offset:23552
s_cbranch_scc1 L_sm0
L_smr0:
v_mfma_f32_16x16x32_bf16 v[56:59], v[20:23], v[20:23], 0
v_mov_b32 v1, 6528
v_and_b32 v8, 0x380, v3
v_mfma_f32_16x16x32_bf16 v[60:63], v[20:23], v[20:23], 0
s_add_u32 s20, s30, 524288
v_add_u32 v8, v8, v3
s_mov_b32 m0, 15872
s_cmp_eq_u32 s19, 63
s_cbranch_scc1 L_texit
s_waitcnt lgkmcnt(0)
s_barrier
ds_read_b128 v[24:27], v3 offset:4224
v_mfma_f32_16x16x32_bf16 v[64:67], v[20:23], v[20:23], 0
ds_read_b128 v[28:31], v3 offset:5248
s_nop 2
v_mfma_f32_16x16x32_bf16 v[68:71], v[20:23], v[20:23], 0
s_waitcnt lgkmcnt(1)
v_smfmac_f32_16x16x64_bf16 v[12:15], v[24:27], a[248:255], v0
buffer_load_dwordx4 v8, s[8:11], s20 offen sc1 lds
v_smfmac_f32_16x16x64_bf16 v[16:19], v[24:27], a[176:183], v0
s_mov_b32 m0, 16768
s_waitcnt lgkmcnt(0)
v_smfmac_f32_16x16x64_bf16 v[12:15], v[28:31], v[40:47], v0
ds_read_b128 v[40:43], v2 offset:24576
v_smfmac_f32_16x16x64_bf16 v[16:19], v[28:31], v[48:55], v0
ds_read_b128 v[44:47], v2 offset:25600
buffer_load_dwordx4 v8, s[8:11], s20 offen offset:128 sc1 lds
v_smfmac_f32_16x16x64_bf16 v[20:23], v[24:27], a[184:191], v0
ds_read_b128 v[48:51], v2 offset:26624
s_nop 1
v_add_f32 v12, v12, v13
v_add_f32 v14, v14, v15
v_cvt_pk_bf16_f32 v12, v12, v14
v_smfmac_f32_16x16x64_bf16 v[20:23], v[28:31], v[32:39], v0
ds_read_b128 v[52:55], v2 offset:27648
buffer_store_dword v12, v10, s[8:11], s28 offen
v_add_f32 v16, v16, v17
v_add_f32 v18, v18, v19
v_smfmac_f32_16x16x64_bf16 v[56:59], v[24:27], a[192:199], v0
s_waitcnt lgkmcnt(2)
ds_read_b128 v[32:35], v2 offset:28672
v_cvt_pk_bf16_f32 v16, v16, v18
v_smfmac_f32_16x16x64_bf16 v[56:59], v[28:31], v[40:47], v0
ds_read_b128 v[36:39], v2 offset:29696
v_add_f32 v20, v20, v21
v_add_f32 v22, v22, v23
v_cvt_pk_bf16_f32 v17, v20, v22
v_smfmac_f32_16x16x64_bf16 v[60:63], v[24:27], a[200:207], v0
s_waitcnt lgkmcnt(2)
ds_read_b128 v[12:15], v1
buffer_store_dwordx2 v[16:17], v9, s[8:11], s28 offen
v_smfmac_f32_16x16x64_bf16 v[60:63], v[28:31], v[48:55], v0
ds_read_b128 v[40:43], v2 offset:30720
v_add_f32 v56, v56, v57
v_add_f32 v58, v58, v59
v_cvt_pk_bf16_f32 v56, v56, v58
v_smfmac_f32_16x16x64_bf16 v[64:67], v[24:27], a[208:215], v0
s_waitcnt lgkmcnt(2)
ds_read_b128 v[44:47], v2 offset:31744
v_smfmac_f32_16x16x64_bf16 v[64:67], v[28:31], v[32:39], v0
ds_read_b128 v[20:23], v1
v_add_f32 v60, v60, v61
v_add_f32 v62, v62, v63
v_cvt_pk_bf16_f32 v57, v60, v62
v_smfmac_f32_16x16x64_bf16 v[68:71], v[24:27], a[216:223], v0
s_waitcnt lgkmcnt(1)
ds_read_b128 v[48:51], v2 offset:32768
buffer_store_dwordx2 v[56:57], v9, s[8:11], s50 offen
v_smfmac_f32_16x16x64_bf16 v[68:71], v[28:31], v[40:47], v0
ds_read_b128 v[52:55], v2 offset:33792
v_add_f32 v64, v64, v65
v_add_f32 v66, v66, v67
v_cvt_pk_bf16_f32 v64, v64, v66
v_smfmac_f32_16x16x64_bf16 v[12:15], v[24:27], a[224:231], v0
s_waitcnt lgkmcnt(0)
v_smfmac_f32_16x16x64_bf16 v[12:15], v[28:31], v[48:55], v0
s_nop 0
v_add_f32 v68, v68, v69
v_add_f32 v70, v70, v71
v_cvt_pk_bf16_f32 v65, v68, v70
v_smfmac_f32_16x16x64_bf16 v[20:23], v[24:27], a[232:239], v0
buffer_store_dwordx2 v[64:65], v9, s[8:11], s51 offen
v_smfmac_f32_16x16x64_bf16 v[20:23], v[28:31], a[240:247], v0
s_nop 0
v_add_f32 v12, v12, v13
v_add_f32 v14, v14, v15
v_cvt_pk_bf16_f32 v12, v12, v14
s_nop 3
v_add_f32 v20, v20, v21
v_add_f32 v22, v22, v23
v_cvt_pk_bf16_f32 v13, v20, v22
buffer_store_dwordx2 v[12:13], v9, s[8:11], s52 offen
L_lt0:
s_nop 15
s_nop 15
s_nop 0
buffer_load_dwordx4 v[32:35], v3, s[8:11], s49 offen sc1
buffer_load_dwordx4 v[36:39], v3, s[8:11], s49 offen offset:1024 sc1
buffer_load_dwordx4 v[40:43], v3, s[8:11], s49 offen offset:2048 sc1
buffer_load_dwordx4 v[44:47], v3, s[8:11], s49 offen offset:3072 sc1
s_add_u32 s19, s19, 1
s_mov_b32 s20, s28
s_mov_b32 s28, s29
s_mov_b32 s29, s20
s_and_b32 s20, s19, 3
s_lshl_b32 s20, s20, 14
s_add_u32 s33, s20, 110100480
s_add_u32 s34, s20, s24
s_xor_b32 s20, s20, 32768
s_add_u32 s35, s20, s24
s_add_u32 s30, s30, 524288
s_add_u32 s31, s31, 131072
s_add_u32 s6, s33, 4096
s_add_u32 s7, s33, 8192
s_mov_b32 s22, 0
buffer_load_dwordx4 v[32:35], v3, s[8:11], s49 offen sc1
buffer_load_dwordx4 v[36:39], v3, s[8:11], s49 offen offset:1024 sc1
buffer_load_dwordx4 v[40:43], v3, s[8:11], s49 offen offset:2048 sc1
buffer_load_dwordx4 v[44:47], v3, s[8:11], s49 offen offset:3072 sc1
v_mov_b64 v[24:25], 0
v_mov_b64 v[26:27], 0
v_mov_b64 v[28:29], 0
v_mov_b64 v[30:31], 0
v_and_b32 v70, 0xf40, v3
v_add_u32 v70, v70, v3
v_bfe_u32 v71, v3, 7, 1
v_mad_i32_i24 v70, v71, s4, v70
v_mov_b64 v[64:65], -1
v_mov_b64 v[66:67], -1
v_add_u32 v1, 2112, v4
ds_read_b128 v[48:51], v2 offset:8192
ds_read_b128 v[52:55], v2 offset:9216
v_lshrrev_b32 v8, 2, v3
v_mov_b32 v56, 0x3f80
v_cndmask_b32 v56, v56, 1.0, s[44:45]
v_cndmask_b32 v60, 0, v56, s[36:37]
v_cndmask_b32 v61, 0, v56, s[38:39]
v_cndmask_b32 v62, 0, v56, s[40:41]
v_cndmask_b32 v63, 0, v56, s[42:43]
s_waitcnt vmcnt(7)
v_max3_u32 v16, v32, v33, v34
v_max_u32 v16, v16, v35
v_mfma_f32_16x16x32_bf16 v[56:59], v[32:35], v[60:63], 0
s_waitcnt vmcnt(6)
v_max3_u32 v16, v16, v36, v37
v_max3_u32 v16, v16, v38, v39
v_mfma_f32_16x16x32_bf16 v[56:59], v[36:39], v[60:63], v[56:59]
s_waitcnt vmcnt(5)
v_max3_u32 v16, v16, v40, v41
v_max3_u32 v16, v16, v42, v43
v_mfma_f32_16x16x32_bf16 v[56:59], v[40:43], v[60:63], v[56:59]
s_waitcnt vmcnt(4)
v_max3_u32 v16, v16, v44, v45
v_max3_u32 v16, v16, v46, v47
v_mfma_f32_16x16x32_bf16 v[56:59], v[44:47], v[60:63], v[56:59]
v_cmp_le_u32 vcc, 0xffff0000, v16
s_cbranch_vccnz L_red0
L_redb0:
s_nop 5
v_permlane32_swap_b32 v56, v58
v_permlane32_swap_b32 v57, v59
v_pk_add_f32 v[56:57], v[56:57], v[58:59]
v_cvt_pk_bf16_f32 v56, v56, v57
buffer_store_dword v56, v11, s[8:11], s34 offen
s_add_u32 s20, s30, 0
s_add_u32 s21, s30, 8192
s_add_u32 s49, s29, s25
s_add_u32 s50, s29, s26
s_add_u32 s51, s29, s27
s_add_u32 s52, s30, 524288
s_mov_b32 m0, 15872
s_nop 9
s_barrier
s_branch L_gat0
L_red0:
s_waitcnt vmcnt(3)
v_mfma_f32_16x16x32_bf16 v[56:59], v[32:35], v[60:63], 0
v_max3_u32 v16, v32, v33, v34
v_max_u32 v16, v16, v35
s_waitcnt vmcnt(2)
v_mfma_f32_16x16x32_bf16 v[56:59], v[36:39], v[60:63], v[56:59]
v_max3_u32 v16, v16, v36, v37
v_max3_u32 v16, v16, v38, v39
s_waitcnt vmcnt(1)
v_mfma_f32_16x16x32_bf16 v[56:59], v[40:43], v[60:63], v[56:59]
v_max3_u32 v16, v16, v40, v41
v_max3_u32 v16, v16, v42, v43
s_waitcnt vmcnt(0)
v_mfma_f32_16x16x32_bf16 v[56:59], v[44:47], v[60:63], v[56:59]
v_max3_u32 v16, v16, v44, v45
v_max3_u32 v16, v16, v46, v47
v_cmp_le_u32 vcc, 0xffff0000, v16
s_cbranch_vccz L_redb0
L_red0b:
buffer_load_dwordx4 v[32:35], v3, s[8:11], s49 offen sc1
buffer_load_dwordx4 v[36:39], v3, s[8:11], s49 offen offset:1024 sc1
buffer_load_dwordx4 v[40:43], v3, s[8:11], s49 offen offset:2048 sc1
buffer_load_dwordx4 v[44:47], v3, s[8:11], s49 offen offset:3072 sc1
s_add_u32 s22, s22, 1
s_cmp_gt_u32 s22, 40000
s_cbranch_scc1 L_end
s_waitcnt vmcnt(3)
v_mfma_f32_16x16x32_bf16 v[56:59], v[32:35], v[60:63], 0
v_max3_u32 v16, v32, v33, v34
v_max_u32 v16, v16, v35
s_waitcnt vmcnt(2)
v_mfma_f32_16x16x32_bf16 v[56:59], v[36:39], v[60:63], v[56:59]
v_max3_u32 v16, v16, v36, v37
v_max3_u32 v16, v16, v38, v39
s_waitcnt vmcnt(1)
v_mfma_f32_16x16x32_bf16 v[56:59], v[40:43], v[60:63], v[56:59]
v_max3_u32 v16, v16, v40, v41
v_max3_u32 v16, v16, v42, v43
s_waitcnt vmcnt(0)
v_mfma_f32_16x16x32_bf16 v[56:59], v[44:47], v[60:63], v[56:59]
v_max3_u32 v16, v16, v44, v45
v_max3_u32 v16, v16, v46, v47
v_cmp_le_u32 vcc, 0xffff0000, v16
s_cbranch_vccz L_redb0
s_branch L_red0b
L_g3r0:
buffer_load_dwordx4 v[16:19], v3, s[8:11], s6 offen sc1
s_add_u32 s22, s22, 1
s_waitcnt vmcnt(1)
v_max3_u32 v21, v16, v17, v18
v_max_u32 v21, v21, v19
v_cmp_le_u32 vcc, 0xffff0000, v21
s_cmp_gt_u32 s22, 40000
s_cbranch_vccz L_g30
s_cbranch_scc0 L_g3r0
s_branch L_end
L_sm0:
s_waitcnt lgkmcnt(0)
ds_read_b128 v[24:27], v5
ds_read_b128 v[40:43], v3 offset:15872
ds_read_b128 v[28:31], v5 offset:512
ds_read_b128 v[44:47], v3 offset:17920
ds_read_b128 v[32:35], v5 offset:1024
ds_read_b128 v[48:51], v3 offset:19968
ds_read_b128 v[36:39], v5 offset:1536
ds_read_b128 v[52:55], v3 offset:22016
s_waitcnt lgkmcnt(0)
v_mfma_f32_16x16x32_bf16 v[16:19], v[40:43], v[24:27], 0
ds_read_b128 v[40:43], v3 offset:16896
v_mfma_f32_16x16x32_bf16 v[16:19], v[44:47], v[28:31], v[16:19]
ds_read_b128 v[44:47], v3 offset:18944
v_mfma_f32_16x16x32_bf16 v[16:19], v[48:51], v[32:35], v[16:19]
ds_read_b128 v[48:51], v3 offset:20992
v_mfma_f32_16x16x32_bf16 v[16:19], v[52:55], v[36:39], v[16:19]
ds_read_b128 v[52:55], v3 offset:23040
v_mfma_f32_16x16x32_bf16 v[20:23], v[24:27], v[24:27], 0
v_mfma_f32_16x16x32_bf16 v[20:23], v[28:31], v[28:31], v[20:23]
v_mfma_f32_16x16x32_bf16 v[20:23], v[32:35], v[32:35], v[20:23]
v_mfma_f32_16x16x32_bf16 v[20:23], v[36:39], v[36:39], v[20:23]
s_waitcnt lgkmcnt(0)
v_mfma_f32_16x16x32_bf16 v[12:15], v[40:43], v[24:27], 0
v_mfma_f32_16x16x32_bf16 v[12:15], v[44:47], v[28:31], v[12:15]
v_mfma_f32_16x16x32_bf16 v[12:15], v[48:51], v[32:35], v[12:15]
v_mfma_f32_16x16x32_bf16 v[12:15], v[52:55], v[36:39], v[12:15]
v_max3_f32 v59, v16, v17, v18
s_nop 1
v_max3_f32 v59, v59, v19, v20
s_nop 3
v_max3_f32 v59, v59, v21, v12
v_max3_f32 v59, v59, v13, v14
v_max_f32 v59, v59, v15
v_mov_b32 v22, v59
s_nop 1
v_permlane32_swap_b32 v22, v59
v_max_f32 v59, v59, v22
v_mov_b32 v22, v59
s_nop 1
v_permlane16_swap_b32 v22, v59
v_max_f32 v59, v59, v22
v_sub_f32 v20, v20, v59
v_sub_f32 v21, v21, v59
v_sub_f32 v16, v16, v59
v_sub_f32 v17, v17, v59
v_sub_f32 v18, v18, v59
v_sub_f32 v19, v19, v59
v_sub_f32 v12, v12, v59
v_sub_f32 v13, v13, v59
v_sub_f32 v14, v14, v59
v_sub_f32 v15, v15, v59
v_exp_f32 v20, v20
v_exp_f32 v21, v21
v_exp_f32 v16, v16
v_exp_f32 v17, v17
v_exp_f32 v18, v18
v_exp_f32 v19, v19
v_exp_f32 v12, v12
v_exp_f32 v13, v13
v_exp_f32 v14, v14
v_exp_f32 v15, v15
v_cvt_pk_bf16_f32 v23, v20, v21
v_cvt_pk_bf16_f32 v20, v20, v21
v_mov_b32 v21, 0
v_mov_b32 v22, 0
v_cvt_pk_bf16_f32 v16, v16, v17
v_cvt_pk_bf16_f32 v17, v18, v19
v_cvt_pk_bf16_f32 v18, v12, v13
v_cvt_pk_bf16_f32 v19, v14, v15
v_mfma_f32_16x16x16_bf16 v[24:27], v[56:57], v[20:21], 0
v_mfma_f32_16x16x16_bf16 v[28:31], v[56:57], v[22:23], 0
v_mfma_f32_16x16x16_bf16 v[32:35], v[60:61], v[20:21], 0
ds_read_b128 v[40:43], v2 offset:18432
v_mfma_f32_16x16x32_bf16 v[32:35], v[60:63], v[16:19], v[32:35]
ds_read_b128 v[44:47], v2 offset:19456
v_mov_b32 v20, 0
v_mfma_f32_16x16x32_bf16 v[24:27], v[64:67], v[16:19], v[24:27]
ds_read_b128 v[48:51], v2 offset:20480
v_mov_b32 v23, 0
v_mfma_f32_16x16x32_bf16 v[28:31], v[68:71], v[16:19], v[28:31]
ds_read_b128 v[52:55], v2 offset:21504
v_mov_b32 v15, 0
v_rcp_f32 v12, v32
v_subrev_u32 v14, 0x21800000, v32
v_cmp_le_u32 vcc, 0x3c000000, v14
v_pk_mul_f32 v[24:25], v[24:25], v[12:13] op_sel_hi:[1,0]
v_pk_mul_f32 v[26:27], v[26:27], v[12:13] op_sel_hi:[1,0]
ds_read_b128 v[32:35], v2 offset:22528
v_pk_mul_f32 v[28:29], v[28:29], v[12:13] op_sel_hi:[1,0]
v_pk_mul_f32 v[30:31], v[30:31], v[12:13] op_sel_hi:[1,0]
v_cvt_pk_bf16_f32 v24, v24, v28
v_cvt_pk_bf16_f32 v25, v25, v29
v_cvt_pk_bf16_f32 v26, v26, v30
v_cvt_pk_bf16_f32 v27, v27, v31
v_mfma_f32_16x16x32_bf16 v[16:19], v[20:23], v[20:23], 0
ds_write_b128 v7, v[24:27]
v_mfma_f32_16x16x32_bf16 v[12:15], v[20:23], v[20:23], 0
ds_read_b128 v[36:39], v2 offset:23552
s_branch L_smr0
L_ent1:
s_movk_i32 s4, -64
s_mov_b32 s14, s53
s_mov_b32 s15, s53
v_mov_b64 v[24:25], 0
v_mov_b64 v[26:27], 0
v_mov_b64 v[28:29], 0
v_mov_b64 v[30:31], 0
v_and_b32 v69, 0x380, v3
v_add_u32 v69, v69, v3
v_and_b32 v70, 0xf40, v3
v_add_u32 v70, v70, v3
v_bfe_u32 v71, v3, 7, 1
v_mad_i32_i24 v70, v71, s4, v70
v_mov_b64 v[64:65], -1
v_mov_b64 v[66:67], -1
v_add_u32 v1, 2112, v4
ds_read_b128 v[48:51], v2 offset:10240
ds_read_b128 v[52:55], v2 offset:11264
ds_read_b128 v[40:43], v2 offset:2048
ds_read_b128 v[44:47], v2 offset:3072
v_mov_b64 v[32:33], 0
v_mov_b64 v[34:35], 0
v_mov_b64 v[36:37], 0
v_mov_b64 v[38:39], 0
v_mov_b64 v[56:57], 0
v_mov_b64 v[58:59], 0
v_mov_b64 v[60:61], 0
v_mov_b64 v[62:63], 0
s_add_u32 s20, s30, 1024
s_add_u32 s21, s30, 8192
s_add_u32 s49, s29, s25
s_add_u32 s50, s29, s26
s_add_u32 s51, s29, s27
s_add_u32 s52, s30, 524288
s_mov_b32 m0, 17920
s_nop 0
buffer_load_dwordx4 v69, s[8:11], s20 offen sc1 lds
s_mov_b32 m0, 18816
s_nop 0
buffer_load_dwordx4 v69, s[8:11], s20 offen offset:128 sc1 lds
s_waitcnt vmcnt(0) lgkmcnt(0)
s_branch L_step1
L_gr1:
buffer_load_dwordx4 v[12:15], v3, s[8:11], s33 offen sc1
buffer_load_dword v20, v8, s[8:11], s7 offen sc1
buffer_load_dwordx4 v[16:19], v3, s[8:11], s6 offen sc1
s_add_u32 s22, s22, 1
s_cmp_gt_u32 s22, 40000
s_cbranch_scc1 L_end
buffer_load_dwordx4 v[16:19], v3, s[8:11], s6 offen sc1
v_mov_b64 v[24:25], 0
v_mov_b64 v[26:27], 0
v_mov_b64 v[28:29], 0
v_mov_b64 v[30:31], 0
v_mov_b64 v[32:33], 0
v_mov_b64 v[34:35], 0
v_mov_b64 v[36:37], 0
v_mov_b64 v[38:39], 0
v_mov_b64 v[56:57], 0
v_mov_b64 v[58:59], 0
v_mov_b64 v[60:61], 0
v_mov_b64 v[62:63], 0
s_waitcnt lgkmcnt(0)
s_branch L_step1
.p2align 3
L_gat1:
buffer_load_dwordx4 v[12:15], v3, s[8:11], s33 offen sc1
buffer_load_dword v20, v8, s[8:11], s7 offen sc1
s_add_u32 s20, s30, 1024
s_add_u32 s21, s30, 8192
s_add_u32 s49, s29, s25
s_add_u32 s50, s29, s26
s_add_u32 s51, s29, s27
s_add_u32 s52, s30, 524288
buffer_load_dwordx4 v[16:19], v3, s[8:11], s6 offen sc1
s_mov_b32 m0, 17920
s_waitcnt vmcnt(4)
ds_read_b128 v[40:43], v2 offset:2048
ds_read_b128 v[44:47], v2 offset:3072
v_mov_b64 v[32:33], 0
v_mov_b64 v[34:35], 0
v_mov_b64 v[36:37], 0
v_mov_b64 v[38:39], 0
v_mov_b64 v[56:57], 0
v_mov_b64 v[58:59], 0
v_mov_b64 v[60:61], 0
v_mov_b64 v[62:63], 0
s_nop 3
buffer_load_dwordx4 v[16:19], v3, s[8:11], s6 offen sc1
s_waitcnt lgkmcnt(0)
L_step1:
s_waitcnt vmcnt(3)
v_smfmac_f32_16x16x64_bf16 v[24:27], v[12:15], v[96:103], v0
ds_write_b128 v3, v[12:15] offset:6656
v_smfmac_f32_16x16x64_bf16 v[28:31], v[12:15], v[104:111], v0
s_waitcnt vmcnt(2)
v_max3_u32 v21, v12, v13, v14
v_max3_u32 v21, v21, v15, v20
v_cmp_le_u32 vcc, 0xffff0000, v21
v_smfmac_f32_16x16x64_bf16 v[32:35], v[12:15], v[112:119], v0
s_cbranch_vccnz L_gr1
s_waitcnt vmcnt(1)
v_max3_u32 v21, v16, v17, v18
v_max_u32 v21, v21, v19
v_cmp_le_u32 vcc, 0xffff0000, v21
ds_write_b32 v8, v20 offset:14848
v_smfmac_f32_16x16x64_bf16 v[56:59], v[12:15], a[48:55], v0
s_cbranch_vccnz L_g3r1
L_g31:
ds_write_b128 v3, v[16:19] offset:10752
v_smfmac_f32_16x16x64_bf16 v[60:63], v[12:15], a[56:63], v0
v_smfmac_f32_16x16x64_bf16 v[36:39], v[12:15], v[40:47], v0
v_smfmac_f32_16x16x64_bf16 v[24:27], v[16:19], v[192:199], v0
v_smfmac_f32_16x16x64_bf16 v[28:31], v[16:19], v[200:207], v0
s_waitcnt lgkmcnt(0)
s_barrier
ds_read_b128 v[20:23], v3 offset:5632
v_smfmac_f32_16x16x64_bf16 v[32:35], v[16:19], v[208:215], v0
ds_read_b128 v[12:15], v3 offset:7680
s_mov_b32 m0, 6272
buffer_store_dword v0, v11, s[8:11], s35 offen
v_smfmac_f32_16x16x64_bf16 v[56:59], v[16:19], a[112:119], v0
ds_read_b128 v[40:43], v2
v_smfmac_f32_16x16x64_bf16 v[60:63], v[16:19], a[120:127], v0
ds_read_b128 v[44:47], v2 offset:1024
buffer_store_dwordx4 v[64:67], v3, s[8:11], s49 offen
v_smfmac_f32_16x16x64_bf16 v[36:39], v[16:19], v[48:55], v0
s_waitcnt vmcnt(2)
ds_read_b128 v[16:19], v3 offset:8704
s_waitcnt lgkmcnt(4)
v_smfmac_f32_16x16x64_bf16 v[24:27], v[20:23], v[72:79], v0
ds_read_b128 v[48:51], v2 offset:4096
buffer_store_dwordx4 v[64:67], v3, s[8:11], s50 offen
v_smfmac_f32_16x16x64_bf16 v[28:31], v[20:23], v[80:87], v0
ds_read_b128 v[52:55], v2 offset:5120
v_smfmac_f32_16x16x64_bf16 v[32:35], v[20:23], v[88:95], v0
s_waitcnt lgkmcnt(3)
buffer_store_dwordx4 v[64:67], v3, s[8:11], s51 offen
v_smfmac_f32_16x16x64_bf16 v[36:39], v[20:23], v[40:47], v0
ds_read_b128 v[20:23], v3 offset:9728
buffer_load_dwordx4 v[64:67], v70, s[8:11], s21 offen sc1
v_smfmac_f32_16x16x64_bf16 v[24:27], v[12:15], v[120:127], v0
ds_read_b128 v[40:43], v2 offset:6144
v_smfmac_f32_16x16x64_bf16 v[28:31], v[12:15], v[128:135], v0
ds_read_b128 v[44:47], v2 offset:7168
buffer_load_dwordx4 v[68:71], v70, s[8:11], s21 offen offset:256 sc1
v_smfmac_f32_16x16x64_bf16 v[32:35], v[12:15], v[136:143], v0
s_waitcnt lgkmcnt(3)
v_smfmac_f32_16x16x64_bf16 v[36:39], v[12:15], v[48:55], v0
ds_read_b128 v[12:15], v3 offset:11776
v_smfmac_f32_16x16x64_bf16 v[24:27], v[16:19], v[144:151], v0
ds_read_b128 v[48:51], v2 offset:8192
v_smfmac_f32_16x16x64_bf16 v[28:31], v[16:19], v[152:159], v0
ds_read_b128 v[52:55], v2 offset:9216
v_smfmac_f32_16x16x64_bf16 v[32:35], v[16:19], v[160:167], v0
s_waitcnt lgkmcnt(3)
buffer_load_dword v6, s[8:11], s52 offen sc1 lds
v_smfmac_f32_16x16x64_bf16 v[36:39], v[16:19], v[40:47], v0
ds_read_b128 v[16:19], v3 offset:12800
v_smfmac_f32_16x16x64_bf16 v[24:27], v[20:23], v[168:175], v0
ds_read_b128 v[40:43], v2 offset:12288
v_smfmac_f32_16x16x64_bf16 v[28:31], v[20:23], v[176:183], v0
ds_read_b128 v[44:47], v2 offset:13312
v_smfmac_f32_16x16x64_bf16 v[32:35], v[20:23], v[184:191], v0
s_waitcnt lgkmcnt(3)
v_smfmac_f32_16x16x64_bf16 v[36:39], v[20:23], v[48:55], v0
ds_read_b128 v[20:23], v3 offset:13824
v_smfmac_f32_16x16x64_bf16 v[24:27], v[12:15], v[216:223], v0
ds_read_b128 v[48:51], v2 offset:14336
v_smfmac_f32_16x16x64_bf16 v[28:31], v[12:15], v[224:231], v0
ds_read_b128 v[52:55], v2 offset:15360
v_smfmac_f32_16x16x64_bf16 v[32:35], v[12:15], v[232:239], v0
s_waitcnt lgkmcnt(3)
v_smfmac_f32_16x16x64_bf16 v[36:39], v[12:15], v[40:47], v0
ds_read_b128 v[12:15], v3 offset:5632
v_smfmac_f32_16x16x64_bf16 v[24:27], v[16:19], v[240:247], v0
ds_read_b128 v[40:43], v2 offset:16384
v_smfmac_f32_16x16x64_bf16 v[28:31], v[16:19], v[248:255], v0
ds_read_b128 v[44:47], v2 offset:17408
v_smfmac_f32_16x16x64_bf16 v[32:35], v[16:19], a[0:7], v0
s_waitcnt lgkmcnt(3)
v_smfmac_f32_16x16x64_bf16 v[36:39], v[16:19], v[48:55], v0
ds_read_b128 v[16:19], v3 offset:7680
v_smfmac_f32_16x16x64_bf16 v[24:27], v[20:23], a[8:15], v0
ds_read_b128 v[48:51], v3 offset:18944
v_smfmac_f32_16x16x64_bf16 v[28:31], v[20:23], a[16:23], v0
ds_read_b128 v[52:55], v3 offset:20992
v_smfmac_f32_16x16x64_bf16 v[32:35], v[20:23], a[24:31], v0
s_waitcnt lgkmcnt(3)
v_smfmac_f32_16x16x64_bf16 v[36:39], v[20:23], v[40:47], v0
ds_read_b128 v[20:23], v3 offset:8704
s_nop 0
v_add_f32 v24, v24, v25
v_smfmac_f32_16x16x64_bf16 v[56:59], v[12:15], a[32:39], v0
ds_read_b128 v[44:47], v3 offset:16896
v_add_f32 v26, v26, v27
v_add_f32 v28, v28, v29
v_add_f32 v30, v30, v31
v_mul_f32 v24, s18, v24
v_smfmac_f32_16x16x64_bf16 v[60:63], v[12:15], a[40:47], v0
ds_read_b128 v[12:15], v3 offset:9728
v_mul_f32 v28, s18, v28
v_mul_f32 v26, s18, v26
v_mul_f32 v30, s18, v30
v_cvt_pk_bf16_f32 v24, v24, v28
s_waitcnt lgkmcnt(5)
v_smfmac_f32_16x16x64_bf16 v[56:59], v[16:19], a[64:71], v0
ds_read_b128 v[40:43], v3 offset:14848
v_cvt_pk_bf16_f32 v26, v26, v30
ds_write2_b32 v1, v24, v26 offset1:32
v_add_f32 v32, v32, v33
v_add_f32 v34, v34, v35
v_smfmac_f32_16x16x64_bf16 v[60:63], v[16:19], a[72:79], v0
ds_read_b128 v[16:19], v3 offset:11776
v_add_f32 v36, v36, v37
v_add_f32 v38, v38, v39
v_cvt_pk_bf16_f32 v32, v32, v36
v_cvt_pk_bf16_f32 v34, v34, v38
s_waitcnt lgkmcnt(5)
v_smfmac_f32_16x16x64_bf16 v[56:59], v[20:23], a[80:87], v0
ds_write2_b32 v4, v32, v34 offset1:32
v_smfmac_f32_16x16x64_bf16 v[60:63], v[20:23], a[88:95], v0
s_waitcnt lgkmcnt(4)
ds_read_b128 v[20:23], v3 offset:12800
v_smfmac_f32_16x16x64_bf16 v[56:59], v[12:15], a[96:103], v0
buffer_store_dword v32, v4, s[8:11], s31 offen sc1
v_smfmac_f32_16x16x64_bf16 v[60:63], v[12:15], a[104:111], v0
s_waitcnt lgkmcnt(2)
ds_read_b128 v[12:15], v3 offset:13824
v_smfmac_f32_16x16x64_bf16 v[56:59], v[16:19], a[128:135], v0
buffer_store_dword v34, v4, s[8:11], s31 offen offset:128 sc1
v_smfmac_f32_16x16x64_bf16 v[60:63], v[16:19], a[136:143], v0
s_waitcnt lgkmcnt(1)
v_smfmac_f32_16x16x64_bf16 v[56:59], v[20:23], a[144:151], v0
s_barrier
ds_read_b128 v[28:31], v5 offset:512
v_smfmac_f32_16x16x64_bf16 v[60:63], v[20:23], a[152:159], v0
s_waitcnt lgkmcnt(1)
ds_read_b128 v[32:35], v5 offset:1024
v_smfmac_f32_16x16x64_bf16 v[56:59], v[12:15], a[160:167], v0
ds_read_b128 v[36:39], v5 offset:1536
v_smfmac_f32_16x16x64_bf16 v[60:63], v[12:15], a[168:175], v0
s_waitcnt lgkmcnt(2)
ds_read_b128 v[24:27], v5
v_mfma_f32_16x16x32_bf16 v[16:19], v[44:47], v[28:31], 0
s_waitcnt lgkmcnt(2)
ds_read_b128 v[44:47], v3 offset:17920
v_mfma_f32_16x16x32_bf16 v[16:19], v[48:51], v[32:35], v[16:19]
s_waitcnt lgkmcnt(2)
ds_read_b128 v[48:51], v3 offset:19968
v_mfma_f32_16x16x32_bf16 v[16:19], v[52:55], v[36:39], v[16:19]
s_waitcnt lgkmcnt(2)
ds_read_b128 v[52:55], v3 offset:22016
v_add_f32 v56, v56, v57
v_mfma_f32_16x16x32_bf16 v[16:19], v[40:43], v[24:27], v[16:19]
ds_read_b128 v[40:43], v3 offset:15872
v_add_f32 v58, v58, v59
v_mfma_f32_16x16x32_bf16 v[20:23], v[28:31], v[28:31], 0
s_add_u32 s49, s28, s23
v_add_f32 v60, v60, v61
v_add_f32 v62, v62, v63
v_mfma_f32_16x16x32_bf16 v[20:23], v[32:35], v[32:35], v[20:23]
s_add_u32 s50, s28, 65536
v_cvt_pk_bf16_f32 v56, v56, v58
v_cvt_pk_bf16_f32 v57, v60, v62
v_mfma_f32_16x16x32_bf16 v[20:23], v[36:39], v[36:39], v[20:23]
s_add_u32 s51, s28, 131072
v_exp_f32 v16, v16
v_mfma_f32_16x16x32_bf16 v[20:23], v[24:27], v[24:27], v[20:23]
s_waitcnt lgkmcnt(3)
v_exp_f32 v17, v17
buffer_store_dword v56, v8, s[8:11], s31 offen offset:2048 sc1
v_mfma_f32_16x16x32_bf16 v[12:15], v[44:47], v[28:31], 0
s_waitcnt lgkmcnt(2)
v_exp_f32 v18, v18
v_mfma_f32_16x16x32_bf16 v[12:15], v[48:51], v[32:35], v[12:15]
s_waitcnt lgkmcnt(1)
v_exp_f32 v19, v19
buffer_store_dword v57, v8, s[8:11], s31 offen offset:3072 sc1
v_mfma_f32_16x16x32_bf16 v[12:15], v[52:55], v[36:39], v[12:15]
s_waitcnt lgkmcnt(0)
v_exp_f32 v20, v20
v_mfma_f32_16x16x32_bf16 v[12:15], v[40:43], v[24:27], v[12:15]
s_add_u32 s52, s28, 196608
v_exp_f32 v21, v21
v_mov_b64 v[60:61], s[14:15]
v_cvt_pk_bf16_f32 v23, v20, v21
v_cvt_pk_bf16_f32 v20, v20, v21
v_mov_b32 v21, 0
v_mov_b32 v22, 0
v_cvt_pk_bf16_f32 v16, v16, v17
v_cvt_pk_bf16_f32 v17, v18, v19
v_mfma_f32_16x16x16_bf16 v[24:27], v[56:57], v[20:21], 0
v_exp_f32 v12, v12
v_mfma_f32_16x16x16_bf16 v[28:31], v[56:57], v[22:23], 0
v_exp_f32 v13, v13
v_mfma_f32_16x16x16_bf16 v[32:35], v[60:61], v[20:21], 0
v_exp_f32 v14, v14
v_exp_f32 v15, v15
v_mov_b64 v[62:63], s[14:15]
v_cvt_pk_bf16_f32 v18, v12, v13
v_cvt_pk_bf16_f32 v19, v14, v15
s_waitcnt vmcnt(5)
ds_read_b128 v[40:43], v2 offset:18432
v_mfma_f32_16x16x32_bf16 v[32:35], v[60:63], v[16:19], v[32:35]
ds_read_b128 v[44:47], v2 offset:19456
v_mov_b32 v20, 0
v_mfma_f32_16x16x32_bf16 v[24:27], v[64:67], v[16:19], v[24:27]
ds_read_b128 v[48:51], v2 offset:20480
v_mov_b32 v23, 0
v_mfma_f32_16x16x32_bf16 v[28:31], v[68:71], v[16:19], v[28:31]
ds_read_b128 v[52:55], v2 offset:21504
v_mov_b32 v15, 0
v_rcp_f32 v12, v32
v_subrev_u32 v14, 0x21800000, v32
v_cmp_le_u32 vcc, 0x3c000000, v14
v_pk_mul_f32 v[24:25], v[24:25], v[12:13] op_sel_hi:[1,0]
v_pk_mul_f32 v[26:27], v[26:27], v[12:13] op_sel_hi:[1,0]
ds_read_b128 v[32:35], v2 offset:22528
v_pk_mul_f32 v[28:29], v[28:29], v[12:13] op_sel_hi:[1,0]
v_pk_mul_f32 v[30:31], v[30:31], v[12:13] op_sel_hi:[1,0]
v_cvt_pk_bf16_f32 v24, v24, v28
v_cvt_pk_bf16_f32 v25, v25, v29
v_cvt_pk_bf16_f32 v26, v26, v30
v_cvt_pk_bf16_f32 v27, v27, v31
v_mfma_f32_16x16x32_bf16 v[16:19], v[20:23], v[20:23], 0
ds_write_b128 v7, v[24:27]
v_mfma_f32_16x16x32_bf16 v[12:15], v[20:23], v[20:23], 0
s_andn2_b64 vcc, vcc, s[86:87]
ds_read_b128 v[36:39], v2 offset:23552
s_cbranch_scc1 L_sm1
L_smr1:
v_mfma_f32_16x16x32_bf16 v[56:59], v[20:23], v[20:23], 0
v_mov_b32 v1, 6528
v_and_b32 v8, 0x380, v3
v_mfma_f32_16x16x32_bf16 v[60:63], v[20:23], v[20:23], 0
s_add_u32 s20, s30, 525312
v_add_u32 v8, v8, v3
s_mov_b32 m0, 17920
s_cmp_eq_u32 s19, 63
s_cbranch_scc1 L_texit
s_waitcnt lgkmcnt(0)
s_barrier
ds_read_b128 v[24:27], v3 offset:3200
v_mfma_f32_16x16x32_bf16 v[64:67], v[20:23], v[20:23], 0
ds_read_b128 v[28:31], v3 offset:4224
s_nop 2
v_mfma_f32_16x16x32_bf16 v[68:71], v[20:23], v[20:23], 0
s_waitcnt lgkmcnt(1)
v_smfmac_f32_16x16x64_bf16 v[12:15], v[24:27], a[248:255], v0
buffer_load_dwordx4 v8, s[8:11], s20 offen sc1 lds
v_smfmac_f32_16x16x64_bf16 v[16:19], v[24:27], a[176:183], v0
s_mov_b32 m0, 18816
s_waitcnt lgkmcnt(0)
v_smfmac_f32_16x16x64_bf16 v[12:15], v[28:31], v[40:47], v0
ds_read_b128 v[40:43], v2 offset:24576
v_smfmac_f32_16x16x64_bf16 v[16:19], v[28:31], v[48:55], v0
ds_read_b128 v[44:47], v2 offset:25600
buffer_load_dwordx4 v8, s[8:11], s20 offen offset:128 sc1 lds
v_smfmac_f32_16x16x64_bf16 v[20:23], v[24:27], a[184:191], v0
ds_read_b128 v[48:51], v2 offset:26624
s_nop 1
v_add_f32 v12, v12, v13
v_add_f32 v14, v14, v15
v_cvt_pk_bf16_f32 v12, v12, v14
v_smfmac_f32_16x16x64_bf16 v[20:23], v[28:31], v[32:39], v0
ds_read_b128 v[52:55], v2 offset:27648
buffer_store_dword v12, v10, s[8:11], s28 offen
v_add_f32 v16, v16, v17
v_add_f32 v18, v18, v19
v_smfmac_f32_16x16x64_bf16 v[56:59], v[24:27], a[192:199], v0
s_waitcnt lgkmcnt(2)
ds_read_b128 v[32:35], v2 offset:28672
v_cvt_pk_bf16_f32 v16, v16, v18
v_smfmac_f32_16x16x64_bf16 v[56:59], v[28:31], v[40:47], v0
ds_read_b128 v[36:39], v2 offset:29696
v_add_f32 v20, v20, v21
v_add_f32 v22, v22, v23
v_cvt_pk_bf16_f32 v17, v20, v22
v_smfmac_f32_16x16x64_bf16 v[60:63], v[24:27], a[200:207], v0
s_waitcnt lgkmcnt(2)
ds_read_b128 v[12:15], v1
buffer_store_dwordx2 v[16:17], v9, s[8:11], s28 offen
v_smfmac_f32_16x16x64_bf16 v[60:63], v[28:31], v[48:55], v0
ds_read_b128 v[40:43], v2 offset:30720
v_add_f32 v56, v56, v57
v_add_f32 v58, v58, v59
v_cvt_pk_bf16_f32 v56, v56, v58
v_smfmac_f32_16x16x64_bf16 v[64:67], v[24:27], a[208:215], v0
s_waitcnt lgkmcnt(2)
ds_read_b128 v[44:47], v2 offset:31744
v_smfmac_f32_16x16x64_bf16 v[64:67], v[28:31], v[32:39], v0
ds_read_b128 v[20:23], v1
v_add_f32 v60, v60, v61
v_add_f32 v62, v62, v63
v_cvt_pk_bf16_f32 v57, v60, v62
v_smfmac_f32_16x16x64_bf16 v[68:71], v[24:27], a[216:223], v0
s_waitcnt lgkmcnt(1)
ds_read_b128 v[48:51], v2 offset:32768
buffer_store_dwordx2 v[56:57], v9, s[8:11], s50 offen
v_smfmac_f32_16x16x64_bf16 v[68:71], v[28:31], v[40:47], v0
ds_read_b128 v[52:55], v2 offset:33792
v_add_f32 v64, v64, v65
v_add_f32 v66, v66, v67
v_cvt_pk_bf16_f32 v64, v64, v66
v_smfmac_f32_16x16x64_bf16 v[12:15], v[24:27], a[224:231], v0
s_waitcnt lgkmcnt(0)
v_smfmac_f32_16x16x64_bf16 v[12:15], v[28:31], v[48:55], v0
s_nop 0
v_add_f32 v68, v68, v69
v_add_f32 v70, v70, v71
v_cvt_pk_bf16_f32 v65, v68, v70
v_smfmac_f32_16x16x64_bf16 v[20:23], v[24:27], a[232:239], v0
buffer_store_dwordx2 v[64:65], v9, s[8:11], s51 offen
v_smfmac_f32_16x16x64_bf16 v[20:23], v[28:31], a[240:247], v0
s_nop 0
v_add_f32 v12, v12, v13
v_add_f32 v14, v14, v15
v_cvt_pk_bf16_f32 v12, v12, v14
s_nop 3
v_add_f32 v20, v20, v21
v_add_f32 v22, v22, v23
v_cvt_pk_bf16_f32 v13, v20, v22
buffer_store_dwordx2 v[12:13], v9, s[8:11], s52 offen
L_lt1:
s_nop 15
s_nop 15
s_nop 15
s_nop 15
s_nop 4
buffer_load_dwordx4 v[32:35], v3, s[8:11], s49 offen sc1
buffer_load_dwordx4 v[36:39], v3, s[8:11], s49 offen offset:1024 sc1
buffer_load_dwordx4 v[40:43], v3, s[8:11], s49 offen offset:2048 sc1
buffer_load_dwordx4 v[44:47], v3, s[8:11], s49 offen offset:3072 sc1
s_add_u32 s19, s19, 1
s_mov_b32 s20, s28
s_mov_b32 s28, s29
s_mov_b32 s29, s20
s_and_b32 s20, s19, 3
s_lshl_b32 s20, s20, 14
s_add_u32 s33, s20, 110100480
s_add_u32 s34, s20, s24
s_xor_b32 s20, s20, 32768
s_add_u32 s35, s20, s24
s_add_u32 s30, s30, 524288
s_add_u32 s31, s31, 131072
s_add_u32 s6, s33, 4096
s_add_u32 s7, s33, 8192
s_mov_b32 s22, 0
v_mov_b64 v[24:25], 0
v_mov_b64 v[26:27], 0
v_mov_b64 v[28:29], 0
v_mov_b64 v[30:31], 0
buffer_load_dwordx4 v[32:35], v3, s[8:11], s49 offen sc1
buffer_load_dwordx4 v[36:39], v3, s[8:11], s49 offen offset:1024 sc1
buffer_load_dwordx4 v[40:43], v3, s[8:11], s49 offen offset:2048 sc1
buffer_load_dwordx4 v[44:47], v3, s[8:11], s49 offen offset:3072 sc1
v_and_b32 v70, 0xf40, v3
v_add_u32 v70, v70, v3
v_bfe_u32 v71, v3, 7, 1
v_mad_i32_i24 v70, v71, s4, v70
v_mov_b64 v[64:65], -1
v_mov_b64 v[66:67], -1
v_add_u32 v1, 2112, v4
ds_read_b128 v[48:51], v2 offset:10240
ds_read_b128 v[52:55], v2 offset:11264
v_lshrrev_b32 v8, 2, v3
v_mov_b32 v56, 0x3f80
v_cndmask_b32 v56, v56, 1.0, s[44:45]
v_cndmask_b32 v60, 0, v56, s[36:37]
v_cndmask_b32 v61, 0, v56, s[38:39]
v_cndmask_b32 v62, 0, v56, s[40:41]
v_cndmask_b32 v63, 0, v56, s[42:43]
s_waitcnt vmcnt(7)
v_max3_u32 v16, v32, v33, v34
v_max_u32 v16, v16, v35
v_mfma_f32_16x16x32_bf16 v[56:59], v[32:35], v[60:63], 0
s_waitcnt vmcnt(6)
v_max3_u32 v16, v16, v36, v37
v_max3_u32 v16, v16, v38, v39
v_mfma_f32_16x16x32_bf16 v[56:59], v[36:39], v[60:63], v[56:59]
s_waitcnt vmcnt(5)
v_max3_u32 v16, v16, v40, v41
v_max3_u32 v16, v16, v42, v43
v_mfma_f32_16x16x32_bf16 v[56:59], v[40:43], v[60:63], v[56:59]
s_waitcnt vmcnt(4)
v_max3_u32 v16, v16, v44, v45
v_max3_u32 v16, v16, v46, v47
v_mfma_f32_16x16x32_bf16 v[56:59], v[44:47], v[60:63], v[56:59]
v_cmp_le_u32 vcc, 0xffff0000, v16
s_cbranch_vccnz L_red1
L_redb1:
s_nop 5
v_permlane32_swap_b32 v56, v58
v_permlane32_swap_b32 v57, v59
v_pk_add_f32 v[56:57], v[56:57], v[58:59]
v_cvt_pk_bf16_f32 v56, v56, v57
buffer_store_dword v56, v11, s[8:11], s34 offen
s_add_u32 s20, s30, 1024
s_add_u32 s21, s30, 8192
s_add_u32 s49, s29, s25
s_add_u32 s50, s29, s26
s_add_u32 s51, s29, s27
s_add_u32 s52, s30, 524288
s_mov_b32 m0, 17920
s_nop 9
s_barrier
s_branch L_gat1
L_red1:
s_waitcnt vmcnt(3)
v_mfma_f32_16x16x32_bf16 v[56:59], v[32:35], v[60:63], 0
v_max3_u32 v16, v32, v33, v34
v_max_u32 v16, v16, v35
s_waitcnt vmcnt(2)
v_mfma_f32_16x16x32_bf16 v[56:59], v[36:39], v[60:63], v[56:59]
v_max3_u32 v16, v16, v36, v37
v_max3_u32 v16, v16, v38, v39
s_waitcnt vmcnt(1)
v_mfma_f32_16x16x32_bf16 v[56:59], v[40:43], v[60:63], v[56:59]
v_max3_u32 v16, v16, v40, v41
v_max3_u32 v16, v16, v42, v43
s_waitcnt vmcnt(0)
v_mfma_f32_16x16x32_bf16 v[56:59], v[44:47], v[60:63], v[56:59]
v_max3_u32 v16, v16, v44, v45
v_max3_u32 v16, v16, v46, v47
v_cmp_le_u32 vcc, 0xffff0000, v16
s_cbranch_vccz L_redb1
L_red1b:
buffer_load_dwordx4 v[32:35], v3, s[8:11], s49 offen sc1
buffer_load_dwordx4 v[36:39], v3, s[8:11], s49 offen offset:1024 sc1
buffer_load_dwordx4 v[40:43], v3, s[8:11], s49 offen offset:2048 sc1
buffer_load_dwordx4 v[44:47], v3, s[8:11], s49 offen offset:3072 sc1
s_add_u32 s22, s22, 1
s_cmp_gt_u32 s22, 40000
s_cbranch_scc1 L_end
s_waitcnt vmcnt(3)
v_mfma_f32_16x16x32_bf16 v[56:59], v[32:35], v[60:63], 0
v_max3_u32 v16, v32, v33, v34
v_max_u32 v16, v16, v35
s_waitcnt vmcnt(2)
v_mfma_f32_16x16x32_bf16 v[56:59], v[36:39], v[60:63], v[56:59]
v_max3_u32 v16, v16, v36, v37
v_max3_u32 v16, v16, v38, v39
s_waitcnt vmcnt(1)
v_mfma_f32_16x16x32_bf16 v[56:59], v[40:43], v[60:63], v[56:59]
v_max3_u32 v16, v16, v40, v41
v_max3_u32 v16, v16, v42, v43
s_waitcnt vmcnt(0)
v_mfma_f32_16x16x32_bf16 v[56:59], v[44:47], v[60:63], v[56:59]
v_max3_u32 v16, v16, v44, v45
v_max3_u32 v16, v16, v46, v47
v_cmp_le_u32 vcc, 0xffff0000, v16
s_cbranch_vccz L_redb1
s_branch L_red1b
L_g3r1:
buffer_load_dwordx4 v[16:19], v3, s[8:11], s6 offen sc1
s_add_u32 s22, s22, 1
s_waitcnt vmcnt(1)
v_max3_u32 v21, v16, v17, v18
v_max_u32 v21, v21, v19
v_cmp_le_u32 vcc, 0xffff0000, v21
s_cmp_gt_u32 s22, 40000
s_cbranch_vccz L_g31
s_cbranch_scc0 L_g3r1
s_branch L_end
L_sm1:
s_waitcnt lgkmcnt(0)
ds_read_b128 v[24:27], v5
ds_read_b128 v[40:43], v3 offset:14848
ds_read_b128 v[28:31], v5 offset:512
ds_read_b128 v[44:47], v3 offset:16896
ds_read_b128 v[32:35], v5 offset:1024
ds_read_b128 v[48:51], v3 offset:18944
ds_read_b128 v[36:39], v5 offset:1536
ds_read_b128 v[52:55], v3 offset:20992
s_waitcnt lgkmcnt(0)
v_mfma_f32_16x16x32_bf16 v[16:19], v[40:43], v[24:27], 0
ds_read_b128 v[40:43], v3 offset:15872
v_mfma_f32_16x16x32_bf16 v[16:19], v[44:47], v[28:31], v[16:19]
ds_read_b128 v[44:47], v3 offset:17920
v_mfma_f32_16x16x32_bf16 v[16:19], v[48:51], v[32:35], v[16:19]
ds_read_b128 v[48:51], v3 offset:19968
v_mfma_f32_16x16x32_bf16 v[16:19], v[52:55], v[36:39], v[16:19]
ds_read_b128 v[52:55], v3 offset:22016
v_mfma_f32_16x16x32_bf16 v[20:23], v[24:27], v[24:27], 0
v_mfma_f32_16x16x32_bf16 v[20:23], v[28:31], v[28:31], v[20:23]
v_mfma_f32_16x16x32_bf16 v[20:23], v[32:35], v[32:35], v[20:23]
v_mfma_f32_16x16x32_bf16 v[20:23], v[36:39], v[36:39], v[20:23]
s_waitcnt lgkmcnt(0)
v_mfma_f32_16x16x32_bf16 v[12:15], v[40:43], v[24:27], 0
v_mfma_f32_16x16x32_bf16 v[12:15], v[44:47], v[28:31], v[12:15]
v_mfma_f32_16x16x32_bf16 v[12:15], v[48:51], v[32:35], v[12:15]
v_mfma_f32_16x16x32_bf16 v[12:15], v[52:55], v[36:39], v[12:15]
v_max3_f32 v59, v16, v17, v18
s_nop 1
v_max3_f32 v59, v59, v19, v20
s_nop 3
v_max3_f32 v59, v59, v21, v12
v_max3_f32 v59, v59, v13, v14
v_max_f32 v59, v59, v15
v_mov_b32 v22, v59
s_nop 1
v_permlane32_swap_b32 v22, v59
v_max_f32 v59, v59, v22
v_mov_b32 v22, v59
s_nop 1
v_permlane16_swap_b32 v22, v59
v_max_f32 v59, v59, v22
v_sub_f32 v20, v20, v59
v_sub_f32 v21, v21, v59
v_sub_f32 v16, v16, v59
v_sub_f32 v17, v17, v59
v_sub_f32 v18, v18, v59
v_sub_f32 v19, v19, v59
v_sub_f32 v12, v12, v59
v_sub_f32 v13, v13, v59
v_sub_f32 v14, v14, v59
v_sub_f32 v15, v15, v59
v_exp_f32 v20, v20
v_exp_f32 v21, v21
v_exp_f32 v16, v16
v_exp_f32 v17, v17
v_exp_f32 v18, v18
v_exp_f32 v19, v19
v_exp_f32 v12, v12
v_exp_f32 v13, v13
v_exp_f32 v14, v14
v_exp_f32 v15, v15
v_cvt_pk_bf16_f32 v23, v20, v21
v_cvt_pk_bf16_f32 v20, v20, v21
v_mov_b32 v21, 0
v_mov_b32 v22, 0
v_cvt_pk_bf16_f32 v16, v16, v17
v_cvt_pk_bf16_f32 v17, v18, v19
v_cvt_pk_bf16_f32 v18, v12, v13
v_cvt_pk_bf16_f32 v19, v14, v15
v_mfma_f32_16x16x16_bf16 v[24:27], v[56:57], v[20:21], 0
v_mfma_f32_16x16x16_bf16 v[28:31], v[56:57], v[22:23], 0
v_mfma_f32_16x16x16_bf16 v[32:35], v[60:61], v[20:21], 0
ds_read_b128 v[40:43], v2 offset:18432
v_mfma_f32_16x16x32_bf16 v[32:35], v[60:63], v[16:19], v[32:35]
ds_read_b128 v[44:47], v2 offset:19456
v_mov_b32 v20, 0
v_mfma_f32_16x16x32_bf16 v[24:27], v[64:67], v[16:19], v[24:27]
ds_read_b128 v[48:51], v2 offset:20480
v_mov_b32 v23, 0
v_mfma_f32_16x16x32_bf16 v[28:31], v[68:71], v[16:19], v[28:31]
ds_read_b128 v[52:55], v2 offset:21504
v_mov_b32 v15, 0
v_rcp_f32 v12, v32
v_subrev_u32 v14, 0x21800000, v32
v_cmp_le_u32 vcc, 0x3c000000, v14
v_pk_mul_f32 v[24:25], v[24:25], v[12:13] op_sel_hi:[1,0]
v_pk_mul_f32 v[26:27], v[26:27], v[12:13] op_sel_hi:[1,0]
ds_read_b128 v[32:35], v2 offset:22528
v_pk_mul_f32 v[28:29], v[28:29], v[12:13] op_sel_hi:[1,0]
v_pk_mul_f32 v[30:31], v[30:31], v[12:13] op_sel_hi:[1,0]
v_cvt_pk_bf16_f32 v24, v24, v28
v_cvt_pk_bf16_f32 v25, v25, v29
v_cvt_pk_bf16_f32 v26, v26, v30
v_cvt_pk_bf16_f32 v27, v27, v31
v_mfma_f32_16x16x32_bf16 v[16:19], v[20:23], v[20:23], 0
ds_write_b128 v7, v[24:27]
v_mfma_f32_16x16x32_bf16 v[12:15], v[20:23], v[20:23], 0
ds_read_b128 v[36:39], v2 offset:23552
s_branch L_smr1
L_ent2:
s_movk_i32 s4, -64
s_mov_b32 s14, s53
s_mov_b32 s15, s53
v_mov_b64 v[24:25], 0
v_mov_b64 v[26:27], 0
v_mov_b64 v[28:29], 0
v_mov_b64 v[30:31], 0
v_and_b32 v69, 0x380, v3
v_add_u32 v69, v69, v3
v_and_b32 v70, 0xf40, v3
v_add_u32 v70, v70, v3
v_bfe_u32 v71, v3, 7, 1
v_mad_i32_i24 v70, v71, s4, v70
v_mov_b64 v[64:65], -1
v_mov_b64 v[66:67], -1
v_add_u32 v1, 2112, v4
ds_read_b128 v[48:51], v2 offset:12288
ds_read_b128 v[52:55], v2 offset:13312
ds_read_b128 v[40:43], v2 offset:4096
ds_read_b128 v[44:47], v2 offset:5120
v_mov_b64 v[32:33], 0
v_mov_b64 v[34:35], 0
v_mov_b64 v[36:37], 0
v_mov_b64 v[38:39], 0
v_mov_b64 v[56:57], 0
v_mov_b64 v[58:59], 0
v_mov_b64 v[60:61], 0
v_mov_b64 v[62:63], 0
s_add_u32 s20, s30, 2048
s_add_u32 s21, s30, 8192
s_add_u32 s49, s29, s25
s_add_u32 s50, s29, s26
s_add_u32 s51, s29, s27
s_add_u32 s52, s30, 524288
s_mov_b32 m0, 19968
s_nop 0
buffer_load_dwordx4 v69, s[8:11], s20 offen sc1 lds
s_mov_b32 m0, 20864
s_nop 0
buffer_load_dwordx4 v69, s[8:11], s20 offen offset:128 sc1 lds
s_waitcnt vmcnt(0) lgkmcnt(0)
s_branch L_step2
L_gr2:
buffer_load_dwordx4 v[12:15], v3, s[8:11], s33 offen sc1
buffer_load_dword v20, v8, s[8:11], s7 offen sc1
buffer_load_dwordx4 v[16:19], v3, s[8:11], s6 offen sc1
s_add_u32 s22, s22, 1
s_cmp_gt_u32 s22, 40000
s_cbranch_scc1 L_end
buffer_load_dwordx4 v[16:19], v3, s[8:11], s6 offen sc1
v_mov_b64 v[24:25], 0
v_mov_b64 v[26:27], 0
v_mov_b64 v[28:29], 0
v_mov_b64 v[30:31], 0
v_mov_b64 v[32:33], 0
v_mov_b64 v[34:35], 0
v_mov_b64 v[36:37], 0
v_mov_b64 v[38:39], 0
v_mov_b64 v[56:57], 0
v_mov_b64 v[58:59], 0
v_mov_b64 v[60:61], 0
v_mov_b64 v[62:63], 0
s_waitcnt lgkmcnt(0)
s_branch L_step2
.p2align 3
L_gat2:
buffer_load_dwordx4 v[12:15], v3, s[8:11], s33 offen sc1
buffer_load_dword v20, v8, s[8:11], s7 offen sc1
s_add_u32 s20, s30, 2048
s_add_u32 s21, s30, 8192
s_add_u32 s49, s29, s25
s_add_u32 s50, s29, s26
s_add_u32 s51, s29, s27
s_add_u32 s52, s30, 524288
buffer_load_dwordx4 v[16:19], v3, s[8:11], s6 offen sc1
s_mov_b32 m0, 19968
ds_read_b128 v[40:43], v2 offset:4096
ds_read_b128 v[44:47], v2 offset:5120
v_mov_b64 v[32:33], 0
v_mov_b64 v[34:35], 0
v_mov_b64 v[36:37], 0
v_mov_b64 v[38:39], 0
v_mov_b64 v[56:57], 0
v_mov_b64 v[58:59], 0
v_mov_b64 v[60:61], 0
v_mov_b64 v[62:63], 0
s_nop 3
buffer_load_dwordx4 v[16:19], v3, s[8:11], s6 offen sc1
s_waitcnt lgkmcnt(0)
L_step2:
s_waitcnt vmcnt(3)
v_smfmac_f32_16x16x64_bf16 v[24:27], v[12:15], v[120:127], v0
ds_write_b128 v3, v[12:15] offset:6656
v_smfmac_f32_16x16x64_bf16 v[28:31], v[12:15], v[128:135], v0
s_waitcnt vmcnt(2)
v_max3_u32 v21, v12, v13, v14
v_max3_u32 v21, v21, v15, v20
v_cmp_le_u32 vcc, 0xffff0000, v21
v_smfmac_f32_16x16x64_bf16 v[32:35], v[12:15], v[136:143], v0
s_cbranch_vccnz L_gr2
s_waitcnt vmcnt(1)
v_max3_u32 v21, v16, v17, v18
v_max_u32 v21, v21, v19
v_cmp_le_u32 vcc, 0xffff0000, v21
ds_write_b32 v8, v20 offset:14848
v_smfmac_f32_16x16x64_bf16 v[56:59], v[12:15], a[64:71], v0
s_cbranch_vccnz L_g3r2
L_g32:
ds_write_b128 v3, v[16:19] offset:10752
v_smfmac_f32_16x16x64_bf16 v[60:63], v[12:15], a[72:79], v0
v_smfmac_f32_16x16x64_bf16 v[36:39], v[12:15], v[40:47], v0
v_smfmac_f32_16x16x64_bf16 v[24:27], v[16:19], v[216:223], v0
v_smfmac_f32_16x16x64_bf16 v[28:31], v[16:19], v[224:231], v0
s_waitcnt lgkmcnt(0)
s_barrier
ds_read_b128 v[20:23], v3 offset:4608
v_smfmac_f32_16x16x64_bf16 v[32:35], v[16:19], v[232:239], v0
ds_read_b128 v[12:15], v3 offset:5632
s_mov_b32 m0, 6272
buffer_store_dword v0, v11, s[8:11], s35 offen
v_smfmac_f32_16x16x64_bf16 v[56:59], v[16:19], a[128:135], v0
ds_read_b128 v[40:43], v2
v_smfmac_f32_16x16x64_bf16 v[60:63], v[16:19], a[136:143], v0
ds_read_b128 v[44:47], v2 offset:1024
buffer_store_dwordx4 v[64:67], v3, s[8:11], s49 offen
v_smfmac_f32_16x16x64_bf16 v[36:39], v[16:19], v[48:55], v0
s_waitcnt vmcnt(2)
ds_read_b128 v[16:19], v3 offset:7680
s_waitcnt lgkmcnt(4)
v_smfmac_f32_16x16x64_bf16 v[24:27], v[20:23], v[72:79], v0
ds_read_b128 v[48:51], v2 offset:2048
buffer_store_dwordx4 v[64:67], v3, s[8:11], s50 offen
v_smfmac_f32_16x16x64_bf16 v[28:31], v[20:23], v[80:87], v0
ds_read_b128 v[52:55], v2 offset:3072
v_smfmac_f32_16x16x64_bf16 v[32:35], v[20:23], v[88:95], v0
s_waitcnt lgkmcnt(3)
buffer_store_dwordx4 v[64:67], v3, s[8:11], s51 offen
v_smfmac_f32_16x16x64_bf16 v[36:39], v[20:23], v[40:47], v0
ds_read_b128 v[20:23], v3 offset:8704
buffer_load_dwordx4 v[64:67], v70, s[8:11], s21 offen sc1
v_smfmac_f32_16x16x64_bf16 v[24:27], v[12:15], v[96:103], v0
ds_read_b128 v[40:43], v2 offset:6144
v_smfmac_f32_16x16x64_bf16 v[28:31], v[12:15], v[104:111], v0
ds_read_b128 v[44:47], v2 offset:7168
buffer_load_dwordx4 v[68:71], v70, s[8:11], s21 offen offset:256 sc1
v_smfmac_f32_16x16x64_bf16 v[32:35], v[12:15], v[112:119], v0
s_waitcnt lgkmcnt(3)
v_smfmac_f32_16x16x64_bf16 v[36:39], v[12:15], v[48:55], v0
ds_read_b128 v[12:15], v3 offset:9728
v_smfmac_f32_16x16x64_bf16 v[24:27], v[16:19], v[144:151], v0
ds_read_b128 v[48:51], v2 offset:8192
v_smfmac_f32_16x16x64_bf16 v[28:31], v[16:19], v[152:159], v0
ds_read_b128 v[52:55], v2 offset:9216
v_smfmac_f32_16x16x64_bf16 v[32:35], v[16:19], v[160:167], v0
s_waitcnt lgkmcnt(3)
v_smfmac_f32_16x16x64_bf16 v[36:39], v[16:19], v[40:47], v0
ds_read_b128 v[16:19], v3 offset:11776
v_smfmac_f32_16x16x64_bf16 v[24:27], v[20:23], v[168:175], v0
ds_read_b128 v[40:43], v2 offset:10240
v_smfmac_f32_16x16x64_bf16 v[28:31], v[20:23], v[176:183], v0
ds_read_b128 v[44:47], v2 offset:11264
v_smfmac_f32_16x16x64_bf16 v[32:35], v[20:23], v[184:191], v0
s_waitcnt lgkmcnt(3)
v_smfmac_f32_16x16x64_bf16 v[36:39], v[20:23], v[48:55], v0
ds_read_b128 v[20:23], v3 offset:12800
v_smfmac_f32_16x16x64_bf16 v[24:27], v[12:15], v[192:199], v0
ds_read_b128 v[48:51], v2 offset:14336
v_smfmac_f32_16x16x64_bf16 v[28:31], v[12:15], v[200:207], v0
ds_read_b128 v[52:55], v2 offset:15360
v_smfmac_f32_16x16x64_bf16 v[32:35], v[12:15], v[208:215], v0
s_waitcnt lgkmcnt(3)
v_smfmac_f32_16x16x64_bf16 v[36:39], v[12:15], v[40:47], v0
ds_read_b128 v[12:15], v3 offset:4608
v_smfmac_f32_16x16x64_bf16 v[24:27], v[16:19], v[240:247], v0
ds_read_b128 v[40:43], v2 offset:16384
v_smfmac_f32_16x16x64_bf16 v[28:31], v[16:19], v[248:255], v0
ds_read_b128 v[44:47], v2 offset:17408
v_smfmac_f32_16x16x64_bf16 v[32:35], v[16:19], a[0:7], v0
s_waitcnt lgkmcnt(3)
v_smfmac_f32_16x16x64_bf16 v[36:39], v[16:19], v[48:55], v0
ds_read_b128 v[16:19], v3 offset:5632
v_smfmac_f32_16x16x64_bf16 v[24:27], v[20:23], a[8:15], v0
ds_read_b128 v[48:51], v3 offset:17920
v_smfmac_f32_16x16x64_bf16 v[28:31], v[20:23], a[16:23], v0
ds_read_b128 v[52:55], v3 offset:19968
v_smfmac_f32_16x16x64_bf16 v[32:35], v[20:23], a[24:31], v0
s_waitcnt lgkmcnt(3)
v_smfmac_f32_16x16x64_bf16 v[36:39], v[20:23], v[40:47], v0
ds_read_b128 v[20:23], v3 offset:7680
s_nop 0
v_add_f32 v24, v24, v25
v_smfmac_f32_16x16x64_bf16 v[56:59], v[12:15], a[32:39], v0
ds_read_b128 v[40:43], v3 offset:13824
v_add_f32 v26, v26, v27
v_add_f32 v28, v28, v29
v_add_f32 v30, v30, v31
v_mul_f32 v24, s18, v24
v_smfmac_f32_16x16x64_bf16 v[60:63], v[12:15], a[40:47], v0
ds_read_b128 v[12:15], v3 offset:8704
v_mul_f32 v28, s18, v28
v_mul_f32 v26, s18, v26
v_mul_f32 v30, s18, v30
v_cvt_pk_bf16_f32 v24, v24, v28
s_waitcnt lgkmcnt(5)
v_smfmac_f32_16x16x64_bf16 v[56:59], v[16:19], a[48:55], v0
ds_read_b128 v[44:47], v3 offset:15872
v_cvt_pk_bf16_f32 v26, v26, v30
ds_write2_b32 v1, v24, v26 offset1:32
v_add_f32 v32, v32, v33
v_add_f32 v34, v34, v35
v_smfmac_f32_16x16x64_bf16 v[60:63], v[16:19], a[56:63], v0
ds_read_b128 v[16:19], v3 offset:9728
v_add_f32 v36, v36, v37
v_add_f32 v38, v38, v39
v_cvt_pk_bf16_f32 v32, v32, v36
v_cvt_pk_bf16_f32 v34, v34, v38
s_waitcnt lgkmcnt(5)
v_smfmac_f32_16x16x64_bf16 v[56:59], v[20:23], a[80:87], v0
ds_write2_b32 v4, v32, v34 offset1:32
v_smfmac_f32_16x16x64_bf16 v[60:63], v[20:23], a[88:95], v0
s_waitcnt lgkmcnt(4)
ds_read_b128 v[20:23], v3 offset:11776
buffer_store_dword v32, v4, s[8:11], s31 offen sc1
v_smfmac_f32_16x16x64_bf16 v[56:59], v[12:15], a[96:103], v0
v_smfmac_f32_16x16x64_bf16 v[60:63], v[12:15], a[104:111], v0
s_waitcnt lgkmcnt(2)
ds_read_b128 v[12:15], v3 offset:12800
buffer_store_dword v34, v4, s[8:11], s31 offen offset:128 sc1
v_smfmac_f32_16x16x64_bf16 v[56:59], v[16:19], a[112:119], v0
v_smfmac_f32_16x16x64_bf16 v[60:63], v[16:19], a[120:127], v0
s_waitcnt lgkmcnt(1)
v_smfmac_f32_16x16x64_bf16 v[56:59], v[20:23], a[144:151], v0
s_barrier
ds_read_b128 v[32:35], v5 offset:1024
v_smfmac_f32_16x16x64_bf16 v[60:63], v[20:23], a[152:159], v0
s_waitcnt lgkmcnt(1)
ds_read_b128 v[36:39], v5 offset:1536
v_smfmac_f32_16x16x64_bf16 v[56:59], v[12:15], a[160:167], v0
ds_read_b128 v[24:27], v5
v_smfmac_f32_16x16x64_bf16 v[60:63], v[12:15], a[168:175], v0
s_waitcnt lgkmcnt(2)
ds_read_b128 v[28:31], v5 offset:512
v_mfma_f32_16x16x32_bf16 v[16:19], v[48:51], v[32:35], 0
s_waitcnt lgkmcnt(2)
ds_read_b128 v[48:51], v3 offset:18944
v_mfma_f32_16x16x32_bf16 v[16:19], v[52:55], v[36:39], v[16:19]
s_waitcnt lgkmcnt(2)
ds_read_b128 v[52:55], v3 offset:20992
v_mfma_f32_16x16x32_bf16 v[16:19], v[40:43], v[24:27], v[16:19]
s_waitcnt lgkmcnt(2)
ds_read_b128 v[40:43], v3 offset:14848
v_add_f32 v56, v56, v57
v_mfma_f32_16x16x32_bf16 v[16:19], v[44:47], v[28:31], v[16:19]
ds_read_b128 v[44:47], v3 offset:16896
v_add_f32 v58, v58, v59
v_mfma_f32_16x16x32_bf16 v[20:23], v[32:35], v[32:35], 0
s_add_u32 s49, s28, s23
v_add_f32 v60, v60, v61
v_add_f32 v62, v62, v63
v_mfma_f32_16x16x32_bf16 v[20:23], v[36:39], v[36:39], v[20:23]
s_add_u32 s50, s28, 65536
v_cvt_pk_bf16_f32 v56, v56, v58
v_cvt_pk_bf16_f32 v57, v60, v62
v_mfma_f32_16x16x32_bf16 v[20:23], v[24:27], v[24:27], v[20:23]
s_add_u32 s51, s28, 131072
v_exp_f32 v16, v16
buffer_store_dword v56, v8, s[8:11], s31 offen offset:2048 sc1
v_mfma_f32_16x16x32_bf16 v[20:23], v[28:31], v[28:31], v[20:23]
s_waitcnt lgkmcnt(3)
v_exp_f32 v17, v17
v_mfma_f32_16x16x32_bf16 v[12:15], v[48:51], v[32:35], 0
s_waitcnt lgkmcnt(2)
v_exp_f32 v18, v18
buffer_store_dword v57, v8, s[8:11], s31 offen offset:3072 sc1
v_mfma_f32_16x16x32_bf16 v[12:15], v[52:55], v[36:39], v[12:15]
s_waitcnt lgkmcnt(1)
v_exp_f32 v19, v19
v_mfma_f32_16x16x32_bf16 v[12:15], v[40:43], v[24:27], v[12:15]
s_waitcnt lgkmcnt(0)
v_exp_f32 v20, v20
v_mfma_f32_16x16x32_bf16 v[12:15], v[44:47], v[28:31], v[12:15]
s_add_u32 s52, s28, 196608
v_exp_f32 v21, v21
v_mov_b64 v[60:61], s[14:15]
v_cvt_pk_bf16_f32 v23, v20, v21
v_cvt_pk_bf16_f32 v20, v20, v21
v_mov_b32 v21, 0
v_mov_b32 v22, 0
v_cvt_pk_bf16_f32 v16, v16, v17
v_cvt_pk_bf16_f32 v17, v18, v19
v_mfma_f32_16x16x16_bf16 v[24:27], v[56:57], v[20:21], 0
v_exp_f32 v12, v12
v_mfma_f32_16x16x16_bf16 v[28:31], v[56:57], v[22:23], 0
v_exp_f32 v13, v13
v_mfma_f32_16x16x16_bf16 v[32:35], v[60:61], v[20:21], 0
v_exp_f32 v14, v14
v_exp_f32 v15, v15
v_mov_b64 v[62:63], s[14:15]
v_cvt_pk_bf16_f32 v18, v12, v13
v_cvt_pk_bf16_f32 v19, v14, v15
s_waitcnt vmcnt(4)
ds_read_b128 v[40:43], v2 offset:18432
v_mfma_f32_16x16x32_bf16 v[32:35], v[60:63], v[16:19], v[32:35]
ds_read_b128 v[44:47], v2 offset:19456
v_mov_b32 v20, 0
v_mfma_f32_16x16x32_bf16 v[24:27], v[64:67], v[16:19], v[24:27]
ds_read_b128 v[48:51], v2 offset:20480
v_mov_b32 v23, 0
v_mfma_f32_16x16x32_bf16 v[28:31], v[68:71], v[16:19], v[28:31]
ds_read_b128 v[52:55], v2 offset:21504
v_mov_b32 v15, 0
v_rcp_f32 v12, v32
v_subrev_u32 v14, 0x21800000, v32
v_cmp_le_u32 vcc, 0x3c000000, v14
v_pk_mul_f32 v[24:25], v[24:25], v[12:13] op_sel_hi:[1,0]
v_pk_mul_f32 v[26:27], v[26:27], v[12:13] op_sel_hi:[1,0]
ds_read_b128 v[32:35], v2 offset:22528
v_pk_mul_f32 v[28:29], v[28:29], v[12:13] op_sel_hi:[1,0]
v_pk_mul_f32 v[30:31], v[30:31], v[12:13] op_sel_hi:[1,0]
v_cvt_pk_bf16_f32 v24, v24, v28
v_cvt_pk_bf16_f32 v25, v25, v29
v_cvt_pk_bf16_f32 v26, v26, v30
v_cvt_pk_bf16_f32 v27, v27, v31
v_mfma_f32_16x16x32_bf16 v[16:19], v[20:23], v[20:23], 0
ds_write_b128 v7, v[24:27]
v_mfma_f32_16x16x32_bf16 v[12:15], v[20:23], v[20:23], 0
s_andn2_b64 vcc, vcc, s[86:87]
ds_read_b128 v[36:39], v2 offset:23552
s_cbranch_scc1 L_sm2
L_smr2:
v_mfma_f32_16x16x32_bf16 v[56:59], v[20:23], v[20:23], 0
v_mov_b32 v1, 6528
v_and_b32 v8, 0x380, v3
v_mfma_f32_16x16x32_bf16 v[60:63], v[20:23], v[20:23], 0
s_add_u32 s20, s30, 526336
v_add_u32 v8, v8, v3
s_mov_b32 m0, 19968
s_cmp_eq_u32 s19, 63
s_cbranch_scc1 L_texit
s_waitcnt lgkmcnt(0)
s_barrier
ds_read_b128 v[24:27], v3 offset:2176
v_mfma_f32_16x16x32_bf16 v[64:67], v[20:23], v[20:23], 0
ds_read_b128 v[28:31], v3 offset:3200
s_nop 2
v_mfma_f32_16x16x32_bf16 v[68:71], v[20:23], v[20:23], 0
s_waitcnt lgkmcnt(1)
v_smfmac_f32_16x16x64_bf16 v[12:15], v[24:27], a[248:255], v0
buffer_load_dwordx4 v8, s[8:11], s20 offen sc1 lds
v_smfmac_f32_16x16x64_bf16 v[16:19], v[24:27], a[176:183], v0
s_mov_b32 m0, 20864
s_waitcnt lgkmcnt(0)
v_smfmac_f32_16x16x64_bf16 v[12:15], v[28:31], v[40:47], v0
ds_read_b128 v[40:43], v2 offset:24576
v_smfmac_f32_16x16x64_bf16 v[16:19], v[28:31], v[48:55], v0
ds_read_b128 v[44:47], v2 offset:25600
buffer_load_dwordx4 v8, s[8:11], s20 offen offset:128 sc1 lds
v_smfmac_f32_16x16x64_bf16 v[20:23], v[24:27], a[184:191], v0
ds_read_b128 v[48:51], v2 offset:26624
s_nop 1
v_add_f32 v12, v12, v13
v_add_f32 v14, v14, v15
v_cvt_pk_bf16_f32 v12, v12, v14
v_smfmac_f32_16x16x64_bf16 v[20:23], v[28:31], v[32:39], v0
ds_read_b128 v[52:55], v2 offset:27648
buffer_store_dword v12, v10, s[8:11], s28 offen
v_add_f32 v16, v16, v17
v_add_f32 v18, v18, v19
v_smfmac_f32_16x16x64_bf16 v[56:59], v[24:27], a[192:199], v0
s_waitcnt lgkmcnt(2)
ds_read_b128 v[32:35], v2 offset:28672
v_cvt_pk_bf16_f32 v16, v16, v18
v_smfmac_f32_16x16x64_bf16 v[56:59], v[28:31], v[40:47], v0
ds_read_b128 v[36:39], v2 offset:29696
v_add_f32 v20, v20, v21
v_add_f32 v22, v22, v23
v_cvt_pk_bf16_f32 v17, v20, v22
v_smfmac_f32_16x16x64_bf16 v[60:63], v[24:27], a[200:207], v0
s_waitcnt lgkmcnt(2)
ds_read_b128 v[12:15], v1
buffer_store_dwordx2 v[16:17], v9, s[8:11], s28 offen
v_smfmac_f32_16x16x64_bf16 v[60:63], v[28:31], v[48:55], v0
ds_read_b128 v[40:43], v2 offset:30720
v_add_f32 v56, v56, v57
v_add_f32 v58, v58, v59
v_cvt_pk_bf16_f32 v56, v56, v58
v_smfmac_f32_16x16x64_bf16 v[64:67], v[24:27], a[208:215], v0
s_waitcnt lgkmcnt(2)
ds_read_b128 v[44:47], v2 offset:31744
v_smfmac_f32_16x16x64_bf16 v[64:67], v[28:31], v[32:39], v0
ds_read_b128 v[20:23], v1
v_add_f32 v60, v60, v61
v_add_f32 v62, v62, v63
v_cvt_pk_bf16_f32 v57, v60, v62
v_smfmac_f32_16x16x64_bf16 v[68:71], v[24:27], a[216:223], v0
s_waitcnt lgkmcnt(1)
ds_read_b128 v[48:51], v2 offset:32768
buffer_store_dwordx2 v[56:57], v9, s[8:11], s50 offen
v_smfmac_f32_16x16x64_bf16 v[68:71], v[28:31], v[40:47], v0
ds_read_b128 v[52:55], v2 offset:33792
v_add_f32 v64, v64, v65
v_add_f32 v66, v66, v67
v_cvt_pk_bf16_f32 v64, v64, v66
v_smfmac_f32_16x16x64_bf16 v[12:15], v[24:27], a[224:231], v0
s_waitcnt lgkmcnt(0)
v_smfmac_f32_16x16x64_bf16 v[12:15], v[28:31], v[48:55], v0
s_nop 0
v_add_f32 v68, v68, v69
v_add_f32 v70, v70, v71
v_cvt_pk_bf16_f32 v65, v68, v70
v_smfmac_f32_16x16x64_bf16 v[20:23], v[24:27], a[232:239], v0
buffer_store_dwordx2 v[64:65], v9, s[8:11], s51 offen
v_smfmac_f32_16x16x64_bf16 v[20:23], v[28:31], a[240:247], v0
s_nop 0
v_add_f32 v12, v12, v13
v_add_f32 v14, v14, v15
v_cvt_pk_bf16_f32 v12, v12, v14
s_nop 3
v_add_f32 v20, v20, v21
v_add_f32 v22, v22, v23
v_cvt_pk_bf16_f32 v13, v20, v22
buffer_store_dwordx2 v[12:13], v9, s[8:11], s52 offen
s_cmp_eq_u32 s48, 0
s_cbranch_scc1 L_nojob2
L_lt2:
s_nop 9
buffer_load_dwordx4 v[32:35], v3, s[8:11], s49 offen sc1
buffer_load_dwordx4 v[36:39], v3, s[8:11], s49 offen offset:1024 sc1
buffer_load_dwordx4 v[40:43], v3, s[8:11], s49 offen offset:2048 sc1
buffer_load_dwordx4 v[44:47], v3, s[8:11], s49 offen offset:3072 sc1
s_add_u32 s19, s19, 1
s_mov_b32 s20, s28
s_mov_b32 s28, s29
s_mov_b32 s29, s20
s_and_b32 s20, s19, 3
s_lshl_b32 s20, s20, 14
s_add_u32 s33, s20, 110100480
s_add_u32 s34, s20, s24
s_xor_b32 s20, s20, 32768
s_add_u32 s35, s20, s24
s_add_u32 s30, s30, 524288
s_add_u32 s31, s31, 131072
s_add_u32 s6, s33, 4096
s_add_u32 s7, s33, 8192
s_mov_b32 s22, 0
v_mov_b64 v[24:25], 0
v_mov_b64 v[26:27], 0
v_mov_b64 v[28:29], 0
v_mov_b64 v[30:31], 0
v_and_b32 v70, 0xf40, v3
v_add_u32 v70, v70, v3
v_bfe_u32 v71, v3, 7, 1
v_mad_i32_i24 v70, v71, s4, v70
v_mov_b64 v[64:65], -1
v_mov_b64 v[66:67], -1
v_add_u32 v1, 2112, v4
ds_read_b128 v[48:51], v2 offset:12288
ds_read_b128 v[52:55], v2 offset:13312
v_lshrrev_b32 v8, 2, v3
v_mov_b32 v56, 0x3f80
v_cndmask_b32 v56, v56, 1.0, s[44:45]
v_cndmask_b32 v60, 0, v56, s[36:37]
v_cndmask_b32 v61, 0, v56, s[38:39]
v_cndmask_b32 v62, 0, v56, s[40:41]
v_cndmask_b32 v63, 0, v56, s[42:43]
s_waitcnt vmcnt(3)
s_nop 0
v_mfma_f32_16x16x32_bf16 v[56:59], v[32:35], v[60:63], 0
v_max3_u32 v16, v32, v33, v34
v_max_u32 v16, v16, v35
s_waitcnt vmcnt(2)
v_mfma_f32_16x16x32_bf16 v[56:59], v[36:39], v[60:63], v[56:59]
v_max3_u32 v16, v16, v36, v37
v_max3_u32 v16, v16, v38, v39
s_waitcnt vmcnt(1)
v_mfma_f32_16x16x32_bf16 v[56:59], v[40:43], v[60:63], v[56:59]
v_max3_u32 v16, v16, v40, v41
v_max3_u32 v16, v16, v42, v43
s_waitcnt vmcnt(0)
v_mfma_f32_16x16x32_bf16 v[56:59], v[44:47], v[60:63], v[56:59]
v_max3_u32 v16, v16, v44, v45
v_max3_u32 v16, v16, v46, v47
v_cmp_le_u32 vcc, 0xffff0000, v16
s_cbranch_vccnz L_red2
L_redb2:
s_nop 3
v_permlane32_swap_b32 v56, v58
v_permlane32_swap_b32 v57, v59
v_pk_add_f32 v[56:57], v[56:57], v[58:59]
v_cvt_pk_bf16_f32 v56, v56, v57
buffer_store_dword v56, v11, s[8:11], s34 offen
s_add_u32 s20, s30, 2048
s_add_u32 s21, s30, 8192
s_add_u32 s49, s29, s25
s_add_u32 s50, s29, s26
s_add_u32 s51, s29, s27
s_add_u32 s52, s30, 524288
s_mov_b32 m0, 19968
s_nop 9
s_barrier
s_branch L_gat2
L_red2:
L_red2b:
buffer_load_dwordx4 v[32:35], v3, s[8:11], s49 offen sc1
buffer_load_dwordx4 v[36:39], v3, s[8:11], s49 offen offset:1024 sc1
buffer_load_dwordx4 v[40:43], v3, s[8:11], s49 offen offset:2048 sc1
buffer_load_dwordx4 v[44:47], v3, s[8:11], s49 offen offset:3072 sc1
s_add_u32 s22, s22, 1
s_cmp_gt_u32 s22, 40000
s_cbranch_scc1 L_end
s_waitcnt vmcnt(3)
v_mfma_f32_16x16x32_bf16 v[56:59], v[32:35], v[60:63], 0
v_max3_u32 v16, v32, v33, v34
v_max_u32 v16, v16, v35
s_waitcnt vmcnt(2)
v_mfma_f32_16x16x32_bf16 v[56:59], v[36:39], v[60:63], v[56:59]
v_max3_u32 v16, v16, v36, v37
v_max3_u32 v16, v16, v38, v39
s_waitcnt vmcnt(1)
v_mfma_f32_16x16x32_bf16 v[56:59], v[40:43], v[60:63], v[56:59]
v_max3_u32 v16, v16, v40, v41
v_max3_u32 v16, v16, v42, v43
s_waitcnt vmcnt(0)
v_mfma_f32_16x16x32_bf16 v[56:59], v[44:47], v[60:63], v[56:59]
v_max3_u32 v16, v16, v44, v45
v_max3_u32 v16, v16, v46, v47
v_cmp_le_u32 vcc, 0xffff0000, v16
s_cbranch_vccz L_redb2
s_branch L_red2b
L_g3r2:
buffer_load_dwordx4 v[16:19], v3, s[8:11], s6 offen sc1
s_add_u32 s22, s22, 1
s_waitcnt vmcnt(1)
v_max3_u32 v21, v16, v17, v18
v_max_u32 v21, v21, v19
v_cmp_le_u32 vcc, 0xffff0000, v21
s_cmp_gt_u32 s22, 40000
s_cbranch_vccz L_g32
s_cbranch_scc0 L_g3r2
s_branch L_end
L_sm2:
s_waitcnt lgkmcnt(0)
ds_read_b128 v[24:27], v5
ds_read_b128 v[40:43], v3 offset:13824
ds_read_b128 v[28:31], v5 offset:512
ds_read_b128 v[44:47], v3 offset:15872
ds_read_b128 v[32:35], v5 offset:1024
ds_read_b128 v[48:51], v3 offset:17920
ds_read_b128 v[36:39], v5 offset:1536
ds_read_b128 v[52:55], v3 offset:19968
s_waitcnt lgkmcnt(0)
v_mfma_f32_16x16x32_bf16 v[16:19], v[40:43], v[24:27], 0
ds_read_b128 v[40:43], v3 offset:14848
v_mfma_f32_16x16x32_bf16 v[16:19], v[44:47], v[28:31], v[16:19]
ds_read_b128 v[44:47], v3 offset:16896
v_mfma_f32_16x16x32_bf16 v[16:19], v[48:51], v[32:35], v[16:19]
ds_read_b128 v[48:51], v3 offset:18944
v_mfma_f32_16x16x32_bf16 v[16:19], v[52:55], v[36:39], v[16:19]
ds_read_b128 v[52:55], v3 offset:20992
v_mfma_f32_16x16x32_bf16 v[20:23], v[24:27], v[24:27], 0
v_mfma_f32_16x16x32_bf16 v[20:23], v[28:31], v[28:31], v[20:23]
v_mfma_f32_16x16x32_bf16 v[20:23], v[32:35], v[32:35], v[20:23]
v_mfma_f32_16x16x32_bf16 v[20:23], v[36:39], v[36:39], v[20:23]
s_waitcnt lgkmcnt(0)
v_mfma_f32_16x16x32_bf16 v[12:15], v[40:43], v[24:27], 0
v_mfma_f32_16x16x32_bf16 v[12:15], v[44:47], v[28:31], v[12:15]
v_mfma_f32_16x16x32_bf16 v[12:15], v[48:51], v[32:35], v[12:15]
v_mfma_f32_16x16x32_bf16 v[12:15], v[52:55], v[36:39], v[12:15]
v_max3_f32 v59, v16, v17, v18
s_nop 1
v_max3_f32 v59, v59, v19, v20
s_nop 3
v_max3_f32 v59, v59, v21, v12
v_max3_f32 v59, v59, v13, v14
v_max_f32 v59, v59, v15
v_mov_b32 v22, v59
s_nop 1
v_permlane32_swap_b32 v22, v59
v_max_f32 v59, v59, v22
v_mov_b32 v22, v59
s_nop 1
v_permlane16_swap_b32 v22, v59
v_max_f32 v59, v59, v22
v_sub_f32 v20, v20, v59
v_sub_f32 v21, v21, v59
v_sub_f32 v16, v16, v59
v_sub_f32 v17, v17, v59
v_sub_f32 v18, v18, v59
v_sub_f32 v19, v19, v59
v_sub_f32 v12, v12, v59
v_sub_f32 v13, v13, v59
v_sub_f32 v14, v14, v59
v_sub_f32 v15, v15, v59
v_exp_f32 v20, v20
v_exp_f32 v21, v21
v_exp_f32 v16, v16
v_exp_f32 v17, v17
v_exp_f32 v18, v18
v_exp_f32 v19, v19
v_exp_f32 v12, v12
v_exp_f32 v13, v13
v_exp_f32 v14, v14
v_exp_f32 v15, v15
v_cvt_pk_bf16_f32 v23, v20, v21
v_cvt_pk_bf16_f32 v20, v20, v21
v_mov_b32 v21, 0
v_mov_b32 v22, 0
v_cvt_pk_bf16_f32 v16, v16, v17
v_cvt_pk_bf16_f32 v17, v18, v19
v_cvt_pk_bf16_f32 v18, v12, v13
v_cvt_pk_bf16_f32 v19, v14, v15
v_mfma_f32_16x16x16_bf16 v[24:27], v[56:57], v[20:21], 0
v_mfma_f32_16x16x16_bf16 v[28:31], v[56:57], v[22:23], 0
v_mfma_f32_16x16x16_bf16 v[32:35], v[60:61], v[20:21], 0
ds_read_b128 v[40:43], v2 offset:18432
v_mfma_f32_16x16x32_bf16 v[32:35], v[60:63], v[16:19], v[32:35]
ds_read_b128 v[44:47], v2 offset:19456
v_mov_b32 v20, 0
v_mfma_f32_16x16x32_bf16 v[24:27], v[64:67], v[16:19], v[24:27]
ds_read_b128 v[48:51], v2 offset:20480
v_mov_b32 v23, 0
v_mfma_f32_16x16x32_bf16 v[28:31], v[68:71], v[16:19], v[28:31]
ds_read_b128 v[52:55], v2 offset:21504
v_mov_b32 v15, 0
v_rcp_f32 v12, v32
v_subrev_u32 v14, 0x21800000, v32
v_cmp_le_u32 vcc, 0x3c000000, v14
v_pk_mul_f32 v[24:25], v[24:25], v[12:13] op_sel_hi:[1,0]
v_pk_mul_f32 v[26:27], v[26:27], v[12:13] op_sel_hi:[1,0]
ds_read_b128 v[32:35], v2 offset:22528
v_pk_mul_f32 v[28:29], v[28:29], v[12:13] op_sel_hi:[1,0]
v_pk_mul_f32 v[30:31], v[30:31], v[12:13] op_sel_hi:[1,0]
v_cvt_pk_bf16_f32 v24, v24, v28
v_cvt_pk_bf16_f32 v25, v25, v29
v_cvt_pk_bf16_f32 v26, v26, v30
v_cvt_pk_bf16_f32 v27, v27, v31
v_mfma_f32_16x16x32_bf16 v[16:19], v[20:23], v[20:23], 0
ds_write_b128 v7, v[24:27]
v_mfma_f32_16x16x32_bf16 v[12:15], v[20:23], v[20:23], 0
ds_read_b128 v[36:39], v2 offset:23552
s_branch L_smr2
L_nojob2:
s_add_u32 s19, s19, 1
s_mov_b32 s20, s28
s_mov_b32 s28, s29
s_mov_b32 s29, s20
s_and_b32 s20, s19, 3
s_lshl_b32 s20, s20, 14
s_add_u32 s33, s20, 110100480
s_add_u32 s34, s20, s24
s_xor_b32 s20, s20, 32768
s_add_u32 s35, s20, s24
s_add_u32 s30, s30, 524288
s_add_u32 s31, s31, 131072
s_add_u32 s6, s33, 4096
s_add_u32 s7, s33, 8192
s_mov_b32 s22, 0
v_mov_b64 v[24:25], 0
v_mov_b64 v[26:27], 0
v_mov_b64 v[28:29], 0
v_mov_b64 v[30:31], 0
v_and_b32 v70, 0xf40, v3
v_add_u32 v70, v70, v3
v_bfe_u32 v71, v3, 7, 1
v_mad_i32_i24 v70, v71, s4, v70
v_mov_b64 v[64:65], -1
v_mov_b64 v[66:67], -1
v_add_u32 v1, 2112, v4
ds_read_b128 v[48:51], v2 offset:12288
ds_read_b128 v[52:55], v2 offset:13312
v_lshrrev_b32 v8, 2, v3
s_barrier
s_branch L_gat2
L_ent3:
s_movk_i32 s4, -64
s_mov_b32 s14, s53
s_mov_b32 s15, s53
v_mov_b64 v[24:25], 0
v_mov_b64 v[26:27], 0
v_mov_b64 v[28:29], 0
v_mov_b64 v[30:31], 0
v_and_b32 v69, 0x380, v3
v_add_u32 v69, v69, v3
v_and_b32 v70, 0xf40, v3
v_add_u32 v70, v70, v3
v_bfe_u32 v71, v3, 7, 1
v_mad_i32_i24 v70, v71, s4, v70
v_mov_b64 v[64:65], -1
v_mov_b64 v[66:67], -1
v_add_u32 v1, 2112, v4
ds_read_b128 v[48:51], v2 offset:14336
ds_read_b128 v[52:55], v2 offset:15360
ds_read_b128 v[40:43], v2 offset:6144
ds_read_b128 v[44:47], v2 offset:7168
v_mov_b64 v[32:33], 0
v_mov_b64 v[34:35], 0
v_mov_b64 v[36:37], 0
v_mov_b64 v[38:39], 0
v_mov_b64 v[56:57], 0
v_mov_b64 v[58:59], 0
v_mov_b64 v[60:61], 0
v_mov_b64 v[62:63], 0
s_add_u32 s20, s30, 3072
s_add_u32 s21, s30, 8192
s_add_u32 s49, s29, s25
s_add_u32 s50, s29, s26
s_add_u32 s51, s29, s27
s_add_u32 s52, s30, 524288
s_mov_b32 m0, 22016
s_nop 0
buffer_load_dwordx4 v69, s[8:11], s20 offen sc1 lds
s_mov_b32 m0, 22912
s_nop 0
buffer_load_dwordx4 v69, s[8:11], s20 offen offset:128 sc1 lds
s_waitcnt vmcnt(0) lgkmcnt(0)
s_branch L_step3
L_gr3:
buffer_load_dwordx4 v[12:15], v3, s[8:11], s33 offen sc1
buffer_load_dword v20, v8, s[8:11], s7 offen sc1
buffer_load_dwordx4 v[16:19], v3, s[8:11], s6 offen sc1
s_add_u32 s22, s22, 1
s_cmp_gt_u32 s22, 40000
s_cbranch_scc1 L_end
buffer_load_dwordx4 v[16:19], v3, s[8:11], s6 offen sc1
v_mov_b64 v[24:25], 0
v_mov_b64 v[26:27], 0
v_mov_b64 v[28:29], 0
v_mov_b64 v[30:31], 0
v_mov_b64 v[32:33], 0
v_mov_b64 v[34:35], 0
v_mov_b64 v[36:37], 0
v_mov_b64 v[38:39], 0
v_mov_b64 v[56:57], 0
v_mov_b64 v[58:59], 0
v_mov_b64 v[60:61], 0
v_mov_b64 v[62:63], 0
s_waitcnt lgkmcnt(0)
s_branch L_step3
.p2align 3
L_gat3:
buffer_load_dwordx4 v[12:15], v3, s[8:11], s33 offen sc1
buffer_load_dword v20, v8, s[8:11], s7 offen sc1
s_add_u32 s20, s30, 3072
s_add_u32 s21, s30, 8192
s_add_u32 s49, s29, s25
s_add_u32 s50, s29, s26
s_add_u32 s51, s29, s27
s_add_u32 s52, s30, 524288
buffer_load_dwordx4 v[16:19], v3, s[8:11], s6 offen sc1
s_mov_b32 m0, 22016
ds_read_b128 v[40:43], v2 offset:6144
ds_read_b128 v[44:47], v2 offset:7168
v_mov_b64 v[32:33], 0
v_mov_b64 v[34:35], 0
v_mov_b64 v[36:37], 0
v_mov_b64 v[38:39], 0
v_mov_b64 v[56:57], 0
v_mov_b64 v[58:59], 0
v_mov_b64 v[60:61], 0
v_mov_b64 v[62:63], 0
s_nop 3
buffer_load_dwordx4 v[16:19], v3, s[8:11], s6 offen sc1
s_waitcnt lgkmcnt(0)
L_step3:
s_waitcnt vmcnt(3)
v_smfmac_f32_16x16x64_bf16 v[24:27], v[12:15], v[144:151], v0
ds_write_b128 v3, v[12:15] offset:6656
v_smfmac_f32_16x16x64_bf16 v[28:31], v[12:15], v[152:159], v0
s_waitcnt vmcnt(2)
v_max3_u32 v21, v12, v13, v14
v_max3_u32 v21, v21, v15, v20
v_cmp_le_u32 vcc, 0xffff0000, v21
v_smfmac_f32_16x16x64_bf16 v[32:35], v[12:15], v[160:167], v0
s_cbranch_vccnz L_gr3
s_waitcnt vmcnt(1)
v_max3_u32 v21, v16, v17, v18
v_max_u32 v21, v21, v19
v_cmp_le_u32 vcc, 0xffff0000, v21
ds_write_b32 v8, v20 offset:14848
v_smfmac_f32_16x16x64_bf16 v[56:59], v[12:15], a[80:87], v0
s_cbranch_vccnz L_g3r3
L_g33:
ds_write_b128 v3, v[16:19] offset:10752
v_smfmac_f32_16x16x64_bf16 v[60:63], v[12:15], a[88:95], v0
v_smfmac_f32_16x16x64_bf16 v[36:39], v[12:15], v[40:47], v0
v_smfmac_f32_16x16x64_bf16 v[24:27], v[16:19], v[240:247], v0
v_smfmac_f32_16x16x64_bf16 v[28:31], v[16:19], v[248:255], v0
s_waitcnt lgkmcnt(0)
s_barrier
ds_read_b128 v[20:23], v3 offset:3584
v_smfmac_f32_16x16x64_bf16 v[32:35], v[16:19], a[0:7], v0
ds_read_b128 v[12:15], v3 offset:4608
s_mov_b32 m0, 6272
v_smfmac_f32_16x16x64_bf16 v[56:59], v[16:19], a[144:151], v0
ds_read_b128 v[40:43], v2
v_smfmac_f32_16x16x64_bf16 v[60:63], v[16:19], a[152:159], v0
ds_read_b128 v[44:47], v2 offset:1024
buffer_store_dwordx4 v[64:67], v3, s[8:11], s49 offen
v_smfmac_f32_16x16x64_bf16 v[36:39], v[16:19], v[48:55], v0
s_waitcnt vmcnt(1)
ds_read_b128 v[16:19], v3 offset:5632
s_waitcnt lgkmcnt(4)
v_smfmac_f32_16x16x64_bf16 v[24:27], v[20:23], v[72:79], v0
ds_read_b128 v[48:51], v2 offset:2048
buffer_store_dwordx4 v[64:67], v3, s[8:11], s50 offen
v_smfmac_f32_16x16x64_bf16 v[28:31], v[20:23], v[80:87], v0
ds_read_b128 v[52:55], v2 offset:3072
v_smfmac_f32_16x16x64_bf16 v[32:35], v[20:23], v[88:95], v0
s_waitcnt lgkmcnt(3)
buffer_store_dwordx4 v[64:67], v3, s[8:11], s51 offen
v_smfmac_f32_16x16x64_bf16 v[36:39], v[20:23], v[40:47], v0
ds_read_b128 v[20:23], v3 offset:7680
buffer_load_dwordx4 v[64:67], v70, s[8:11], s21 offen sc1
v_smfmac_f32_16x16x64_bf16 v[24:27], v[12:15], v[96:103], v0
ds_read_b128 v[40:43], v2 offset:4096
v_smfmac_f32_16x16x64_bf16 v[28:31], v[12:15], v[104:111], v0
ds_read_b128 v[44:47], v2 offset:5120
buffer_load_dwordx4 v[68:71], v70, s[8:11], s21 offen offset:256 sc1
v_smfmac_f32_16x16x64_bf16 v[32:35], v[12:15], v[112:119], v0
s_waitcnt lgkmcnt(3)
v_smfmac_f32_16x16x64_bf16 v[36:39], v[12:15], v[48:55], v0
ds_read_b128 v[12:15], v3 offset:8704
v_smfmac_f32_16x16x64_bf16 v[24:27], v[16:19], v[120:127], v0
ds_read_b128 v[48:51], v2 offset:8192
v_smfmac_f32_16x16x64_bf16 v[28:31], v[16:19], v[128:135], v0
ds_read_b128 v[52:55], v2 offset:9216
v_mov_b32 v11, s19
v_smfmac_f32_16x16x64_bf16 v[32:35], v[16:19], v[136:143], v0
s_mov_b64 exec, 1
buffer_store_dword v11, v8, s[8:11], s83 offen sc1
s_mov_b64 exec, -1
s_waitcnt lgkmcnt(3)
v_smfmac_f32_16x16x64_bf16 v[36:39], v[16:19], v[40:47], v0
ds_read_b128 v[16:19], v3 offset:9728
buffer_load_dword v11, v8, s[8:11], s82 offen sc1
v_smfmac_f32_16x16x64_bf16 v[24:27], v[20:23], v[168:175], v0
ds_read_b128 v[40:43], v2 offset:10240
v_smfmac_f32_16x16x64_bf16 v[28:31], v[20:23], v[176:183], v0
ds_read_b128 v[44:47], v2 offset:11264
v_smfmac_f32_16x16x64_bf16 v[32:35], v[20:23], v[184:191], v0
s_waitcnt lgkmcnt(3)
v_smfmac_f32_16x16x64_bf16 v[36:39], v[20:23], v[48:55], v0
ds_read_b128 v[20:23], v3 offset:11776
v_smfmac_f32_16x16x64_bf16 v[24:27], v[12:15], v[192:199], v0
ds_read_b128 v[48:51], v2 offset:12288
v_smfmac_f32_16x16x64_bf16 v[28:31], v[12:15], v[200:207], v0
ds_read_b128 v[52:55], v2 offset:13312
v_smfmac_f32_16x16x64_bf16 v[32:35], v[12:15], v[208:215], v0
s_waitcnt lgkmcnt(3)
v_smfmac_f32_16x16x64_bf16 v[36:39], v[12:15], v[40:47], v0
ds_read_b128 v[12:15], v3 offset:3584
v_smfmac_f32_16x16x64_bf16 v[24:27], v[16:19], v[216:223], v0
ds_read_b128 v[40:43], v2 offset:16384
v_smfmac_f32_16x16x64_bf16 v[28:31], v[16:19], v[224:231], v0
ds_read_b128 v[44:47], v2 offset:17408
v_smfmac_f32_16x16x64_bf16 v[32:35], v[16:19], v[232:239], v0
s_waitcnt lgkmcnt(3)
v_smfmac_f32_16x16x64_bf16 v[36:39], v[16:19], v[48:55], v0
ds_read_b128 v[16:19], v3 offset:4608
v_smfmac_f32_16x16x64_bf16 v[24:27], v[20:23], a[8:15], v0
ds_read_b128 v[52:55], v3 offset:18944
v_smfmac_f32_16x16x64_bf16 v[28:31], v[20:23], a[16:23], v0
ds_read_b128 v[48:51], v3 offset:16896
v_smfmac_f32_16x16x64_bf16 v[32:35], v[20:23], a[24:31], v0
s_waitcnt lgkmcnt(3)
v_smfmac_f32_16x16x64_bf16 v[36:39], v[20:23], v[40:47], v0
ds_read_b128 v[20:23], v3 offset:5632
s_nop 0
v_add_f32 v24, v24, v25
v_smfmac_f32_16x16x64_bf16 v[56:59], v[12:15], a[32:39], v0
ds_read_b128 v[40:43], v3 offset:12800
v_add_f32 v26, v26, v27
v_add_f32 v28, v28, v29
v_add_f32 v30, v30, v31
v_mul_f32 v24, s18, v24
v_smfmac_f32_16x16x64_bf16 v[60:63], v[12:15], a[40:47], v0
ds_read_b128 v[12:15], v3 offset:7680
v_mul_f32 v28, s18, v28
v_mul_f32 v26, s18, v26
v_mul_f32 v30, s18, v30
v_cvt_pk_bf16_f32 v24, v24, v28
s_waitcnt lgkmcnt(5)
v_smfmac_f32_16x16x64_bf16 v[56:59], v[16:19], a[48:55], v0
ds_read_b128 v[44:47], v3 offset:14848
v_cvt_pk_bf16_f32 v26, v26, v30
ds_write2_b32 v1, v24, v26 offset1:32
v_add_f32 v32, v32, v33
v_add_f32 v34, v34, v35
v_smfmac_f32_16x16x64_bf16 v[60:63], v[16:19], a[56:63], v0
ds_read_b128 v[16:19], v3 offset:8704
v_add_f32 v36, v36, v37
v_add_f32 v38, v38, v39
v_cvt_pk_bf16_f32 v32, v32, v36
v_cvt_pk_bf16_f32 v34, v34, v38
s_waitcnt lgkmcnt(5)
v_smfmac_f32_16x16x64_bf16 v[56:59], v[20:23], a[64:71], v0
ds_write2_b32 v4, v32, v34 offset1:32
v_smfmac_f32_16x16x64_bf16 v[60:63], v[20:23], a[72:79], v0
s_waitcnt lgkmcnt(4)
ds_read_b128 v[20:23], v3 offset:9728
v_smfmac_f32_16x16x64_bf16 v[56:59], v[12:15], a[96:103], v0
buffer_store_dword v32, v4, s[8:11], s31 offen sc1
v_smfmac_f32_16x16x64_bf16 v[60:63], v[12:15], a[104:111], v0
s_waitcnt lgkmcnt(2)
ds_read_b128 v[12:15], v3 offset:11776
v_smfmac_f32_16x16x64_bf16 v[56:59], v[16:19], a[112:119], v0
buffer_store_dword v34, v4, s[8:11], s31 offen offset:128 sc1
v_smfmac_f32_16x16x64_bf16 v[60:63], v[16:19], a[120:127], v0
s_waitcnt lgkmcnt(1)
v_smfmac_f32_16x16x64_bf16 v[56:59], v[20:23], a[128:135], v0
s_barrier
ds_read_b128 v[36:39], v5 offset:1536
v_smfmac_f32_16x16x64_bf16 v[60:63], v[20:23], a[136:143], v0
s_waitcnt lgkmcnt(1)
ds_read_b128 v[24:27], v5
v_smfmac_f32_16x16x64_bf16 v[56:59], v[12:15], a[160:167], v0
ds_read_b128 v[28:31], v5 offset:512
v_smfmac_f32_16x16x64_bf16 v[60:63], v[12:15], a[168:175], v0
s_waitcnt lgkmcnt(2)
ds_read_b128 v[32:35], v5 offset:1024
v_mfma_f32_16x16x32_bf16 v[16:19], v[52:55], v[36:39], 0
s_waitcnt lgkmcnt(2)
ds_read_b128 v[52:55], v3 offset:19968
v_mfma_f32_16x16x32_bf16 v[16:19], v[40:43], v[24:27], v[16:19]
s_waitcnt lgkmcnt(2)
ds_read_b128 v[40:43], v3 offset:13824
v_mfma_f32_16x16x32_bf16 v[16:19], v[44:47], v[28:31], v[16:19]
s_waitcnt lgkmcnt(2)
ds_read_b128 v[44:47], v3 offset:15872
v_add_f32 v56, v56, v57
v_mfma_f32_16x16x32_bf16 v[16:19], v[48:51], v[32:35], v[16:19]
ds_read_b128 v[48:51], v3 offset:17920
v_add_f32 v58, v58, v59
v_mfma_f32_16x16x32_bf16 v[20:23], v[36:39], v[36:39], 0
s_add_u32 s49, s28, s23
v_add_f32 v60, v60, v61
v_add_f32 v62, v62, v63
v_mfma_f32_16x16x32_bf16 v[20:23], v[24:27], v[24:27], v[20:23]
s_add_u32 s50, s28, 65536
v_cvt_pk_bf16_f32 v56, v56, v58
v_cvt_pk_bf16_f32 v57, v60, v62
v_mfma_f32_16x16x32_bf16 v[20:23], v[28:31], v[28:31], v[20:23]
s_add_u32 s51, s28, 131072
v_exp_f32 v16, v16
v_mfma_f32_16x16x32_bf16 v[20:23], v[32:35], v[32:35], v[20:23]
s_waitcnt lgkmcnt(3)
v_exp_f32 v17, v17
buffer_store_dword v56, v8, s[8:11], s31 offen offset:2048 sc1
v_mfma_f32_16x16x32_bf16 v[12:15], v[52:55], v[36:39], 0
s_waitcnt lgkmcnt(2)
v_exp_f32 v18, v18
v_mfma_f32_16x16x32_bf16 v[12:15], v[40:43], v[24:27], v[12:15]
s_waitcnt lgkmcnt(1)
v_exp_f32 v19, v19
buffer_store_dword v57, v8, s[8:11], s31 offen offset:3072 sc1
v_mfma_f32_16x16x32_bf16 v[12:15], v[44:47], v[28:31], v[12:15]
s_waitcnt lgkmcnt(0)
v_exp_f32 v20, v20
v_mfma_f32_16x16x32_bf16 v[12:15], v[48:51], v[32:35], v[12:15]
s_add_u32 s52, s28, 196608
v_exp_f32 v21, v21
v_mov_b64 v[60:61], s[14:15]
v_cvt_pk_bf16_f32 v23, v20, v21
v_cvt_pk_bf16_f32 v20, v20, v21
v_mov_b32 v21, 0
v_mov_b32 v22, 0
v_cvt_pk_bf16_f32 v16, v16, v17
v_cvt_pk_bf16_f32 v17, v18, v19
v_mfma_f32_16x16x16_bf16 v[24:27], v[56:57], v[20:21], 0
v_exp_f32 v12, v12
v_mfma_f32_16x16x16_bf16 v[28:31], v[56:57], v[22:23], 0
v_exp_f32 v13, v13
v_mfma_f32_16x16x16_bf16 v[32:35], v[60:61], v[20:21], 0
v_exp_f32 v14, v14
v_exp_f32 v15, v15
v_mov_b64 v[62:63], s[14:15]
v_cvt_pk_bf16_f32 v18, v12, v13
v_cvt_pk_bf16_f32 v19, v14, v15
s_waitcnt vmcnt(6)
ds_read_b128 v[40:43], v2 offset:18432
v_mfma_f32_16x16x32_bf16 v[32:35], v[60:63], v[16:19], v[32:35]
ds_read_b128 v[44:47], v2 offset:19456
v_mov_b32 v20, 0
v_mfma_f32_16x16x32_bf16 v[24:27], v[64:67], v[16:19], v[24:27]
ds_read_b128 v[48:51], v2 offset:20480
v_mov_b32 v23, 0
v_mfma_f32_16x16x32_bf16 v[28:31], v[68:71], v[16:19], v[28:31]
ds_read_b128 v[52:55], v2 offset:21504
v_mov_b32 v15, 0
v_rcp_f32 v12, v32
v_subrev_u32 v14, 0x21800000, v32
v_cmp_le_u32 vcc, 0x3c000000, v14
v_pk_mul_f32 v[24:25], v[24:25], v[12:13] op_sel_hi:[1,0]
v_pk_mul_f32 v[26:27], v[26:27], v[12:13] op_sel_hi:[1,0]
ds_read_b128 v[32:35], v2 offset:22528
v_pk_mul_f32 v[28:29], v[28:29], v[12:13] op_sel_hi:[1,0]
v_pk_mul_f32 v[30:31], v[30:31], v[12:13] op_sel_hi:[1,0]
v_cvt_pk_bf16_f32 v24, v24, v28
v_cvt_pk_bf16_f32 v25, v25, v29
v_cvt_pk_bf16_f32 v26, v26, v30
v_cvt_pk_bf16_f32 v27, v27, v31
v_mfma_f32_16x16x32_bf16 v[16:19], v[20:23], v[20:23], 0
ds_write_b128 v7, v[24:27]
v_mfma_f32_16x16x32_bf16 v[12:15], v[20:23], v[20:23], 0
s_andn2_b64 vcc, vcc, s[86:87]
ds_read_b128 v[36:39], v2 offset:23552
s_cbranch_scc1 L_sm3
L_smr3:
v_mfma_f32_16x16x32_bf16 v[56:59], v[20:23], v[20:23], 0
v_mov_b32 v1, 6528
v_and_b32 v8, 0x380, v3
v_mfma_f32_16x16x32_bf16 v[60:63], v[20:23], v[20:23], 0
s_add_u32 s20, s30, 527360
v_add_u32 v8, v8, v3
s_mov_b32 m0, 22016
s_cmp_eq_u32 s19, 63
s_cbranch_scc1 L_texit
s_waitcnt lgkmcnt(0)
s_barrier
ds_read_b128 v[24:27], v3 offset:1152
v_mfma_f32_16x16x32_bf16 v[64:67], v[20:23], v[20:23], 0
ds_read_b128 v[28:31], v3 offset:2176
s_nop 2
v_mfma_f32_16x16x32_bf16 v[68:71], v[20:23], v[20:23], 0
s_waitcnt lgkmcnt(1)
v_smfmac_f32_16x16x64_bf16 v[12:15], v[24:27], a[248:255], v0
buffer_load_dwordx4 v8, s[8:11], s20 offen sc1 lds
v_smfmac_f32_16x16x64_bf16 v[16:19], v[24:27], a[176:183], v0
s_mov_b32 m0, 22912
s_waitcnt lgkmcnt(0)
v_smfmac_f32_16x16x64_bf16 v[12:15], v[28:31], v[40:47], v0
ds_read_b128 v[40:43], v2 offset:24576
v_smfmac_f32_16x16x64_bf16 v[16:19], v[28:31], v[48:55], v0
ds_read_b128 v[44:47], v2 offset:25600
buffer_load_dwordx4 v8, s[8:11], s20 offen offset:128 sc1 lds
v_smfmac_f32_16x16x64_bf16 v[20:23], v[24:27], a[184:191], v0
ds_read_b128 v[48:51], v2 offset:26624
s_nop 1
v_add_f32 v12, v12, v13
v_add_f32 v14, v14, v15
v_cvt_pk_bf16_f32 v12, v12, v14
v_smfmac_f32_16x16x64_bf16 v[20:23], v[28:31], v[32:39], v0
ds_read_b128 v[52:55], v2 offset:27648
buffer_store_dword v12, v10, s[8:11], s28 offen
v_add_f32 v16, v16, v17
v_add_f32 v18, v18, v19
v_smfmac_f32_16x16x64_bf16 v[56:59], v[24:27], a[192:199], v0
s_waitcnt lgkmcnt(2)
ds_read_b128 v[32:35], v2 offset:28672
v_cvt_pk_bf16_f32 v16, v16, v18
v_smfmac_f32_16x16x64_bf16 v[56:59], v[28:31], v[40:47], v0
ds_read_b128 v[36:39], v2 offset:29696
v_add_f32 v20, v20, v21
v_add_f32 v22, v22, v23
v_cvt_pk_bf16_f32 v17, v20, v22
v_smfmac_f32_16x16x64_bf16 v[60:63], v[24:27], a[200:207], v0
s_waitcnt lgkmcnt(2)
ds_read_b128 v[12:15], v1
buffer_store_dwordx2 v[16:17], v9, s[8:11], s28 offen
v_smfmac_f32_16x16x64_bf16 v[60:63], v[28:31], v[48:55], v0
ds_read_b128 v[40:43], v2 offset:30720
v_add_f32 v56, v56, v57
v_add_f32 v58, v58, v59
v_cvt_pk_bf16_f32 v56, v56, v58
v_smfmac_f32_16x16x64_bf16 v[64:67], v[24:27], a[208:215], v0
s_waitcnt lgkmcnt(2)
ds_read_b128 v[44:47], v2 offset:31744
v_smfmac_f32_16x16x64_bf16 v[64:67], v[28:31], v[32:39], v0
ds_read_b128 v[20:23], v1
v_add_f32 v60, v60, v61
v_add_f32 v62, v62, v63
v_cvt_pk_bf16_f32 v57, v60, v62
v_smfmac_f32_16x16x64_bf16 v[68:71], v[24:27], a[216:223], v0
s_waitcnt lgkmcnt(1)
ds_read_b128 v[48:51], v2 offset:32768
buffer_store_dwordx2 v[56:57], v9, s[8:11], s50 offen
v_smfmac_f32_16x16x64_bf16 v[68:71], v[28:31], v[40:47], v0
ds_read_b128 v[52:55], v2 offset:33792
v_add_f32 v64, v64, v65
v_add_f32 v66, v66, v67
v_cvt_pk_bf16_f32 v64, v64, v66
v_smfmac_f32_16x16x64_bf16 v[12:15], v[24:27], a[224:231], v0
s_waitcnt lgkmcnt(0)
v_smfmac_f32_16x16x64_bf16 v[12:15], v[28:31], v[48:55], v0
s_nop 0
v_add_f32 v68, v68, v69
v_add_f32 v70, v70, v71
v_cvt_pk_bf16_f32 v65, v68, v70
v_smfmac_f32_16x16x64_bf16 v[20:23], v[24:27], a[232:239], v0
buffer_store_dwordx2 v[64:65], v9, s[8:11], s51 offen
v_smfmac_f32_16x16x64_bf16 v[20:23], v[28:31], a[240:247], v0
s_nop 0
v_add_f32 v12, v12, v13
v_add_f32 v14, v14, v15
v_cvt_pk_bf16_f32 v12, v12, v14
s_nop 3
v_add_f32 v20, v20, v21
v_add_f32 v22, v22, v23
v_cvt_pk_bf16_f32 v13, v20, v22
buffer_store_dwordx2 v[12:13], v9, s[8:11], s52 offen
s_add_u32 s19, s19, 1
s_mov_b32 s20, s28
s_mov_b32 s28, s29
s_mov_b32 s29, s20
s_and_b32 s20, s19, 3
s_lshl_b32 s20, s20, 14
s_add_u32 s33, s20, 110100480
s_add_u32 s34, s20, s24
s_xor_b32 s20, s20, 32768
s_add_u32 s35, s20, s24
s_add_u32 s30, s30, 524288
s_add_u32 s31, s31, 131072
s_add_u32 s6, s33, 4096
s_add_u32 s7, s33, 8192
s_mov_b32 s22, 0
v_mov_b64 v[24:25], 0
v_mov_b64 v[26:27], 0
v_mov_b64 v[28:29], 0
v_mov_b64 v[30:31], 0
v_and_b32 v70, 0xf40, v3
v_add_u32 v70, v70, v3
v_bfe_u32 v71, v3, 7, 1
v_mad_i32_i24 v70, v71, s4, v70
v_mov_b64 v[64:65], -1
v_mov_b64 v[66:67], -1
v_add_u32 v1, 2112, v4
ds_read_b128 v[48:51], v2 offset:14336
ds_read_b128 v[52:55], v2 offset:15360
v_lshrrev_b32 v8, 2, v3
s_add_u32 s20, s19, 1
s_lshr_b32 s20, s20, 3
s_min_u32 s20, s20, 7
s_cmp_lt_u32 s19, 3
s_cselect_b32 s20, 8, s20
s_waitcnt vmcnt(11)
L_kvw:
v_readlane_b32 s21, v11, s20
s_nop 0
s_cmp_eq_u32 s21, 1
s_cbranch_scc0 L_kvp
s_barrier
s_branch L_gat3
L_g3r3:
buffer_load_dwordx4 v[16:19], v3, s[8:11], s6 offen sc1
s_add_u32 s22, s22, 1
s_waitcnt vmcnt(1)
v_max3_u32 v21, v16, v17, v18
v_max_u32 v21, v21, v19
v_cmp_le_u32 vcc, 0xffff0000, v21
s_cmp_gt_u32 s22, 40000
s_cbranch_vccz L_g33
s_cbranch_scc0 L_g3r3
s_branch L_end
L_sm3:
s_waitcnt lgkmcnt(0)
ds_read_b128 v[24:27], v5
ds_read_b128 v[40:43], v3 offset:12800
ds_read_b128 v[28:31], v5 offset:512
ds_read_b128 v[44:47], v3 offset:14848
ds_read_b128 v[32:35], v5 offset:1024
ds_read_b128 v[48:51], v3 offset:16896
ds_read_b128 v[36:39], v5 offset:1536
ds_read_b128 v[52:55], v3 offset:18944
s_waitcnt lgkmcnt(0)
v_mfma_f32_16x16x32_bf16 v[16:19], v[40:43], v[24:27], 0
ds_read_b128 v[40:43], v3 offset:13824
v_mfma_f32_16x16x32_bf16 v[16:19], v[44:47], v[28:31], v[16:19]
ds_read_b128 v[44:47], v3 offset:15872
v_mfma_f32_16x16x32_bf16 v[16:19], v[48:51], v[32:35], v[16:19]
ds_read_b128 v[48:51], v3 offset:17920
v_mfma_f32_16x16x32_bf16 v[16:19], v[52:55], v[36:39], v[16:19]
ds_read_b128 v[52:55], v3 offset:19968
v_mfma_f32_16x16x32_bf16 v[20:23], v[24:27], v[24:27], 0
v_mfma_f32_16x16x32_bf16 v[20:23], v[28:31], v[28:31], v[20:23]
v_mfma_f32_16x16x32_bf16 v[20:23], v[32:35], v[32:35], v[20:23]
v_mfma_f32_16x16x32_bf16 v[20:23], v[36:39], v[36:39], v[20:23]
s_waitcnt lgkmcnt(0)
v_mfma_f32_16x16x32_bf16 v[12:15], v[40:43], v[24:27], 0
v_mfma_f32_16x16x32_bf16 v[12:15], v[44:47], v[28:31], v[12:15]
v_mfma_f32_16x16x32_bf16 v[12:15], v[48:51], v[32:35], v[12:15]
v_mfma_f32_16x16x32_bf16 v[12:15], v[52:55], v[36:39], v[12:15]
v_max3_f32 v59, v16, v17, v18
s_nop 1
v_max3_f32 v59, v59, v19, v20
s_nop 3
v_max3_f32 v59, v59, v21, v12
v_max3_f32 v59, v59, v13, v14
v_max_f32 v59, v59, v15
v_mov_b32 v22, v59
s_nop 1
v_permlane32_swap_b32 v22, v59
v_max_f32 v59, v59, v22
v_mov_b32 v22, v59
s_nop 1
v_permlane16_swap_b32 v22, v59
v_max_f32 v59, v59, v22
v_sub_f32 v20, v20, v59
v_sub_f32 v21, v21, v59
v_sub_f32 v16, v16, v59
v_sub_f32 v17, v17, v59
v_sub_f32 v18, v18, v59
v_sub_f32 v19, v19, v59
v_sub_f32 v12, v12, v59
v_sub_f32 v13, v13, v59
v_sub_f32 v14, v14, v59
v_sub_f32 v15, v15, v59
v_exp_f32 v20, v20
v_exp_f32 v21, v21
v_exp_f32 v16, v16
v_exp_f32 v17, v17
v_exp_f32 v18, v18
v_exp_f32 v19, v19
v_exp_f32 v12, v12
v_exp_f32 v13, v13
v_exp_f32 v14, v14
v_exp_f32 v15, v15
v_cvt_pk_bf16_f32 v23, v20, v21
v_cvt_pk_bf16_f32 v20, v20, v21
v_mov_b32 v21, 0
v_mov_b32 v22, 0
v_cvt_pk_bf16_f32 v16, v16, v17
v_cvt_pk_bf16_f32 v17, v18, v19
v_cvt_pk_bf16_f32 v18, v12, v13
v_cvt_pk_bf16_f32 v19, v14, v15
v_mfma_f32_16x16x16_bf16 v[24:27], v[56:57], v[20:21], 0
v_mfma_f32_16x16x16_bf16 v[28:31], v[56:57], v[22:23], 0
v_mfma_f32_16x16x16_bf16 v[32:35], v[60:61], v[20:21], 0
ds_read_b128 v[40:43], v2 offset:18432
v_mfma_f32_16x16x32_bf16 v[32:35], v[60:63], v[16:19], v[32:35]
ds_read_b128 v[44:47], v2 offset:19456
v_mov_b32 v20, 0
v_mfma_f32_16x16x32_bf16 v[24:27], v[64:67], v[16:19], v[24:27]
ds_read_b128 v[48:51], v2 offset:20480
v_mov_b32 v23, 0
v_mfma_f32_16x16x32_bf16 v[28:31], v[68:71], v[16:19], v[28:31]
ds_read_b128 v[52:55], v2 offset:21504
v_mov_b32 v15, 0
v_rcp_f32 v12, v32
v_subrev_u32 v14, 0x21800000, v32
v_cmp_le_u32 vcc, 0x3c000000, v14
v_pk_mul_f32 v[24:25], v[24:25], v[12:13] op_sel_hi:[1,0]
v_pk_mul_f32 v[26:27], v[26:27], v[12:13] op_sel_hi:[1,0]
ds_read_b128 v[32:35], v2 offset:22528
v_pk_mul_f32 v[28:29], v[28:29], v[12:13] op_sel_hi:[1,0]
v_pk_mul_f32 v[30:31], v[30:31], v[12:13] op_sel_hi:[1,0]
v_cvt_pk_bf16_f32 v24, v24, v28
v_cvt_pk_bf16_f32 v25, v25, v29
v_cvt_pk_bf16_f32 v26, v26, v30
v_cvt_pk_bf16_f32 v27, v27, v31
v_mfma_f32_16x16x32_bf16 v[16:19], v[20:23], v[20:23], 0
ds_write_b128 v7, v[24:27]
v_mfma_f32_16x16x32_bf16 v[12:15], v[20:23], v[20:23], 0
ds_read_b128 v[36:39], v2 offset:23552
s_branch L_smr3
L_kvp:
buffer_load_dword v11, v8, s[8:11], s82 offen sc1
s_add_u32 s22, s22, 1
s_cmp_gt_u32 s22, 40000
s_cbranch_scc1 L_end
s_waitcnt vmcnt(0)
s_branch L_kvw
L_texit:
s_lshl_b32 s61, s16, 7
s_add_u32 s61, s61, 111153152
s_waitcnt vmcnt(0)
s_barrier
s_cmp_lg_u32 s17, 0
s_cbranch_scc1 L_sf_54
v_mov_b32 v20, 0
v_mov_b32 v21, 64
s_mov_b64 exec, 1
buffer_store_dword v21, v20, s[8:11], s61 offen sc1
s_mov_b64 exec, -1
L_sf_54:
L_done:
L_end:
s_endpgm
.section .rodata,"a"
.p2align 6
.amdhsa_kernel concat_heads__compressed_kv_cla__memory_aug_recurrent_mem_tr__prompt_kernel
  .amdhsa_next_free_vgpr 512
  .amdhsa_next_free_sgpr 102
  .amdhsa_accum_offset 256
  .amdhsa_group_segment_fixed_size 0
  .amdhsa_kernarg_size 128
  .amdhsa_user_sgpr_count 2
  .amdhsa_user_sgpr_kernarg_segment_ptr 1
  .amdhsa_system_sgpr_workgroup_id_x 1
.end_amdhsa_kernel
```

```asm
; @launch grid=(256,1,1) block=(256,1,1) lds=163840
.amdgcn_target "amdgcn-amd-amdhsa--gfx950"
.text
.globl concat_heads__compressed_kv_cla__memory_aug_recurrent_mem_tr__prompt_kernel
.p2align 8
.type concat_heads__compressed_kv_cla__memory_aug_recurrent_mem_tr__prompt_kernel,@function
concat_heads__compressed_kv_cla__memory_aug_recurrent_mem_tr__prompt_kernel:
s_cmp_lt_u32 s2, 256
s_cbranch_scc1 L_go
L_end0:
s_endpgm
L_go:
s_getreg_b32 s3, hwreg(HW_REG_XCC_ID)
s_and_b32 s3, s3, 7
s_load_dwordx2 s[4:5], s[0:1], 120
s_load_dwordx2 s[6:7], s[0:1], 112
v_lshrrev_b32 v1, 6, v0
s_nop 0
v_readfirstlane_b32 s17, v1
s_waitcnt lgkmcnt(0)
s_mov_b32 s8, s4
s_and_b32 s9, s5, 0xffff
s_mov_b32 s10, 268435456
s_mov_b32 s11, 0x20000
s_mov_b32 s56, s6
s_and_b32 s57, s7, 0xffff
s_mov_b32 s58, 256
s_mov_b32 s59, 0x20000
s_lshl_b32 s24, s3, 2
s_cmp_eq_u32 s17, 0
s_cbranch_scc0 L_tk
v_lshlrev_b32 v3, 12, v0
s_mov_b64 exec, 1
v_mov_b32 v1, 1
v_mov_b32 v2, 0
buffer_atomic_add v1, v2, s[56:59], s24 offen sc0
s_mov_b64 exec, -1
s_getpc_b64 s[4:5]
L_pc:
s_mov_b32 s12, s4
s_and_b32 s13, s5, 0xffff
s_mov_b32 s14, L_end-L_pc
s_mov_b32 s15, 0x20000
s_lshr_b32 s25, s2, 3
s_lshl_b32 s25, s25, 7
buffer_load_dword a255, v3, s[12:15], s25 offen
s_mov_b64 exec, 1
s_waitcnt vmcnt(1)
ds_write_b32 v2, v1
s_waitcnt lgkmcnt(0)
s_mov_b64 exec, -1
L_tk:
s_barrier
v_mov_b32 v2, 0
ds_read_b32 v1, v2
s_lshr_b32 s3, 0x76530142, s24
s_and_b32 s3, s3, 7
s_waitcnt lgkmcnt(0)
v_readfirstlane_b32 s16, v1
s_barrier
s_cmp_ge_u32 s16, 32
s_cbranch_scc1 L_end0
s_cmp_eq_u32 s3, 0
s_cbranch_scc1 L_team
s_cmp_eq_u32 s3, 1
s_cbranch_scc0 L_np
s_cmp_lt_u32 s16, 24
s_cbranch_scc1 L_np
v_lshlrev_b32 v1, 4, v0
v_mov_b64 v[4:5], 0
v_mov_b64 v[6:7], 0
s_sub_u32 s24, s16, 24
s_lshl_b32 s24, s24, 12
s_add_u32 s24, s24, 111149056
buffer_store_dwordx4 v[4:7], v1, s[8:11], s24 offen sc1
s_waitcnt vmcnt(0)
s_barrier
s_cmp_lg_u32 s17, 0
s_cbranch_scc1 L_np
v_mov_b32 v1, 1
v_mov_b32 v2, 128
s_mov_b64 exec, 1
buffer_atomic_add v1, v2, s[56:59], 0 offen
s_mov_b64 exec, -1
L_np:
s_cmp_lt_u32 s3, 4
s_cselect_b32 s61, 1, 0
s_cbranch_scc1 L_pb
s_load_dwordx2 s[52:53], s[0:1], 8
s_load_dwordx2 s[54:55], s[0:1], 0
s_load_dwordx2 s[6:7], s[0:1], 24
s_load_dwordx2 s[4:5], s[0:1], 32
s_load_dwordx2 s[18:19], s[0:1], 16
s_mov_b32 s45, 3
s_sub_u32 s24, s3, 4
s_lshl_b32 s24, s24, 5
s_add_u32 s24, s24, s16
s_lshr_b32 s89, s24, 2
s_lshr_b32 s90, s24, 3
s_and_b32 s24, s16, 3
s_mul_i32 s88, s24, 0x11
s_and_b32 s24, s16, 7
s_bitcmp1_b32 s16, 2
s_cselect_b32 s25, 3, 0
s_xor_b32 s24, s24, s25
s_lshl_b32 s24, s24, 8
s_add_u32 s88, s88, s24
s_add_u32 s88, s88, 0x840
s_branch L_pg
L_pb:
s_load_dwordx2 s[52:53], s[0:1], 48
s_load_dwordx2 s[54:55], s[0:1], 48
s_load_dwordx2 s[6:7], s[0:1], 72
s_load_dwordx2 s[4:5], s[0:1], 80
s_load_dwordx2 s[18:19], s[0:1], 64
s_mov_b32 s45, 6
s_sub_u32 s24, s3, 2
s_lshl_b32 s24, s24, 5
s_add_u32 s24, s24, s16
s_lshr_b32 s89, s24, 1
s_lshr_b32 s90, s24, 2
s_mov_b32 s88, 0xe6a431
s_mov_b32 s25, 0xe6c431
s_bitcmp1_b32 s16, 0
s_cselect_b32 s88, 0xf7b582, s88
s_cselect_b32 s25, 0xf7d592, s25
s_bitcmp1_b32 s16, 1
s_cselect_b32 s88, s25, s88
s_cselect_b32 s45, 5, 6
s_add_u32 s45, s3, 3
s_cmp_eq_u32 s3, 1
s_cselect_b32 s45, 1, s45
s_cselect_b32 s88, 0, s88
s_cselect_b32 s89, s16, s89
L_pg:
s_waitcnt lgkmcnt(0)
s_cmp_ge_u32 s17, 2
s_cselect_b64 s[6:7], s[4:5], s[6:7]
s_cmp_eq_u32 s61, 0
s_cselect_b32 s24, 4, 1
s_mov_b32 s14, 884736
s_cselect_b32 s14, 1048576, s14
s_sub_u32 s24, s3, s24
s_lshl_b32 s24, s24, 5
s_add_u32 s24, s24, s16
s_lshl_b32 s24, s24, 13
s_mov_b32 s12, s52
s_and_b32 s13, s53, 0xffff
s_mov_b32 s15, 0x20000
v_lshlrev_b32 v15, 5, v0
buffer_load_dword v15, v15, s[12:15], s24 offen
s_sub_u32 s24, 7, s3
s_mul_i32 s25, s16, 6
s_add_u32 s24, s24, s25
s_cmp_ge_u32 s24, 36
s_cbranch_scc1 L_pf_1
s_load_dwordx2 s[4:5], s[0:1], 88
s_sub_u32 s25, s24, 0
s_mul_i32 s25, s25, 131072
s_add_u32 s25, s25, 0
s_min_u32 s25, s25, 4718592
s_sub_u32 s98, 4718592, s25
s_mov_b32 s100, 0x0
s_branch L_pfd
L_pf_1:
s_cmp_ge_u32 s24, 72
s_cbranch_scc1 L_pf_2
s_load_dwordx2 s[4:5], s[0:1], 64
s_sub_u32 s25, s24, 36
s_mul_i32 s25, s25, 131072
s_add_u32 s25, s25, 0
s_min_u32 s25, s25, 4718592
s_sub_u32 s98, 4718592, s25
s_mov_b32 s100, 0x0
s_branch L_pfd
L_pf_2:
s_cmp_ge_u32 s24, 80
s_cbranch_scc1 L_pf_3
s_load_dwordx2 s[4:5], s[0:1], 8
s_sub_u32 s25, s24, 72
s_mul_i32 s25, s25, 131072
s_add_u32 s25, s25, 1048576
s_min_u32 s25, s25, 2097152
s_sub_u32 s98, 2097152, s25
s_mov_b32 s100, 0xfffe0000
s_branch L_pfd
L_pf_3:
s_cmp_ge_u32 s24, 92
s_cbranch_scc1 L_pf_4
s_load_dwordx2 s[4:5], s[0:1], 48
s_sub_u32 s25, s24, 80
s_mul_i32 s25, s25, 131072
s_add_u32 s25, s25, 786432
s_min_u32 s25, s25, 2359296
s_sub_u32 s98, 2359296, s25
s_mov_b32 s100, 0xfffe0000
s_branch L_pfd
L_pf_4:
s_cmp_ge_u32 s24, 110
s_cbranch_scc1 L_pf_5
s_load_dwordx2 s[4:5], s[0:1], 0
s_sub_u32 s25, s24, 92
s_mul_i32 s25, s25, 131072
s_add_u32 s25, s25, 0
s_min_u32 s25, s25, 2359296
s_sub_u32 s98, 2359296, s25
s_mov_b32 s100, 0xfffe0000
s_branch L_pfd
L_pf_5:
s_cmp_ge_u32 s24, 146
s_cbranch_scc1 L_pf_6
s_load_dwordx2 s[4:5], s[0:1], 16
s_sub_u32 s25, s24, 110
s_mul_i32 s25, s25, 131072
s_add_u32 s25, s25, 0
s_min_u32 s25, s25, 4718592
s_sub_u32 s98, 4718592, s25
s_mov_b32 s100, 0xfffe0000
s_branch L_pfd
L_pf_6:
s_load_dwordx2 s[4:5], s[0:1], 40
s_sub_u32 s25, s24, 146
s_mul_i32 s25, s25, 131072
s_add_u32 s25, s25, 0
s_min_u32 s25, s25, 4718592
s_sub_u32 s98, 4718592, s25
s_mov_b32 s100, 0xfffe0000
s_branch L_pfd
L_pf_7:
L_pfd:
s_min_u32 s98, s98, 131072
s_waitcnt lgkmcnt(0)
s_add_u32 s96, s4, s25
s_addc_u32 s5, s5, 0
s_and_b32 s97, s5, 0xffff
s_mov_b32 s99, 0x20000
s_cmp_eq_u32 s3, 1
s_cselect_b32 s100, 536870912, s100
v_lshlrev_b32 v14, 6, v0
s_cmp_eq_u32 s3, 1
s_cselect_b32 s91, 1, 0
s_andn2_b32 s95, s61, s16
v_bfe_u32 v16, v0, 4, 3
v_bfe_u32 v17, v0, 7, 1
v_lshlrev_b32 v17, 2, v17
v_xor_b32 v16, v16, v17
v_and_b32 v17, 7, v0
v_xor_b32 v16, v16, v17
v_lshlrev_b32 v1, 4, v16
v_bfe_u32 v17, v0, 4, 2
v_lshlrev_b32 v16, 2, v17
v_and_b32 v18, 15, v0
v_xor_b32 v16, v16, v18
v_bfe_u32 v18, v0, 6, 1
v_xor_b32 v16, v16, v18
v_lshlrev_b32 v16, 4, v16
v_lshl_add_u32 v16, v17, 13, v16
v_lshl_add_u32 v2, v18, 16, v16
s_and_b32 s24, s17, 1
s_lshr_b32 s25, s17, 1
s_lshl_b32 s25, s25, 13
s_lshl_b32 s33, s24, 11
s_add_u32 s33, s33, s25
s_lshl_b32 s32, s17, 10
s_add_u32 s32, s32, 65536
v_bfe_u32 v16, v0, 3, 1
v_lshlrev_b32 v16, 11, v16
v_and_b32 v18, 7, v0
v_lshl_add_u32 v16, v18, 7, v16
v_bfe_u32 v18, v0, 1, 3
v_xor_b32 v18, v18, v17
v_lshl_add_u32 v16, v18, 4, v16
s_lshl_b32 s24, s24, 14
s_add_u32 s24, s24, 65536
v_add_u32 v3, s24, v16
v_xor_b32 v4, 64, v3
v_bfe_u32 v18, v0, 2, 2
v_mul_u32_u24 v16, 320, v18
v_lshl_add_u32 v16, v17, 11, v16
v_bfe_u32 v18, v0, 1, 1
v_lshl_add_u32 v16, v18, 5, v16
v_bfe_u32 v18, v0, 4, 1
v_lshl_add_u32 v16, v18, 4, v16
v_and_b32 v18, 1, v0
v_lshl_add_u32 v16, v18, 3, v16
v_add_u32 v5, s25, v16
v_xor_b32 v6, 16, v5
v_xor_b32 v7, 64, v5
v_xor_b32 v8, 80, v5
v_xor_b32 v9, 128, v5
v_xor_b32 v10, 144, v5
v_xor_b32 v11, 192, v5
v_xor_b32 v12, 208, v5
s_mov_b32 s35, 0
s_lshr_b32 s24, s16, 1
s_cmp_eq_u32 s35, 5
s_cselect_b32 s90, s24, s90
s_lshl_b32 s24, s35, 2
s_lshr_b32 s26, s88, s24
s_bfe_u32 s2, s26, 0x10003
s_and_b32 s26, s26, 7
s_or_b32 s40, s2, s61
s_lshr_b32 s24, s17, 1
s_cmp_eq_u32 s2, 0
s_cselect_b32 s41, s24, 0
s_cselect_b32 s27, s89, s90
s_sub_u32 s25, s24, s41
s_and_b32 s51, s41, s61
s_lshl_b32 s51, s51, 1
s_or_b32 s51, s51, s41
s_lshl2_add_u32 s51, s2, s51
s_lshl_b32 s46, s27, s2
s_add_u32 s46, s46, s25
s_lshl_b32 s46, s46, 8
s_lshl_b32 s47, s40, 7
s_add_u32 s47, s47, 1024
s_mul_i32 s101, s26, s47
s_lshl_b32 s101, s101, 8
s_and_b32 s25, s17, 1
s_lshl1_add_u32 s42, s26, s25
s_lshl_b32 s42, s42, 7
s_lshr_b32 s42, s42, s2
s_add_u32 s42, s42, s27
s_lshl1_add_u32 s42, s42, s24
s_lshl_b32 s42, s42, 13
s_lshl_b32 s43, s27, 5
s_add_u32 s43, s43, s26
s_lshl_b32 s43, s43, 2
s_lshl_b32 s24, s2, 1
s_add_u32 s24, s24, s61
s_lshl_b32 s24, s24, 2
s_lshr_b32 s25, 0x8720, s24
s_and_b32 s25, s25, 15
s_lshl_b32 s25, s25, 24
s_add_u32 s42, s42, s25
s_lshr_b32 s25, 0x7604, s24
s_and_b32 s25, s25, 15
s_lshl_b32 s25, s25, 12
s_add_u32 s43, s43, s25
s_add_u32 s43, s43, 111149056
s_cmp_lt_u32 s35, s45
s_cselect_b32 s101, s101, 536870912
s_cselect_b32 s46, s46, 536870912
s_cmp_eq_u32 s2, 0
s_cselect_b64 s[4:5], s[52:53], s[54:55]
s_mov_b32 s12, s4
s_and_b32 s13, s5, 0xffff
s_lshl_b32 s14, s47, 11
s_mov_b32 s15, 0x20000
s_mov_b32 s30, s101
v_lshrrev_b32 v16, 3, v0
v_mul_lo_u32 v16, v16, s47
v_and_b32 v1, 0x70, v1
v_add_u32 v1, v1, v16
s_lshl_b32 s34, s47, 5
s_cmp_eq_u32 s2, 0
s_cselect_b64 s[4:5], s[6:7], s[18:19]
s_mov_b32 s20, s4
s_and_b32 s21, s5, 0xffff
s_lshl_b32 s22, s47, 12
s_mov_b32 s23, 0x20000
s_mov_b32 s31, s46
s_mov_b32 s48, s30
s_add_u32 m0, s32, 0
s_nop 0
buffer_load_dwordx4 v1, s[12:15], s48 offen lds
s_add_u32 s48, s48, s34
s_add_u32 m0, s32, 4096
s_nop 0
buffer_load_dwordx4 v1, s[12:15], s48 offen lds
s_add_u32 s48, s48, s34
s_add_u32 m0, s32, 8192
s_nop 0
buffer_load_dwordx4 v1, s[12:15], s48 offen lds
s_add_u32 s48, s48, s34
s_add_u32 m0, s32, 12288
s_nop 0
buffer_load_dwordx4 v1, s[12:15], s48 offen lds
s_add_u32 s48, s48, s34
s_add_u32 m0, s32, 16384
s_nop 0
buffer_load_dwordx4 v1, s[12:15], s48 offen lds
s_add_u32 s48, s48, s34
s_add_u32 m0, s32, 20480
s_nop 0
buffer_load_dwordx4 v1, s[12:15], s48 offen lds
s_add_u32 s48, s48, s34
s_add_u32 m0, s32, 24576
s_nop 0
buffer_load_dwordx4 v1, s[12:15], s48 offen lds
s_add_u32 s48, s48, s34
s_add_u32 m0, s32, 28672
s_nop 0
buffer_load_dwordx4 v1, s[12:15], s48 offen lds
s_add_u32 s30, s30, 128
s_add_u32 s32, s32, 32768
s_sub_u32 s48, s32, 98304
s_cmp_ge_u32 s32, 163840
s_cselect_b32 s32, s48, s32
s_add_u32 s37, s31, 0
s_add_u32 m0, s33, 0
s_nop 0
buffer_load_dwordx4 v2, s[20:23], s37 offen  lds
s_add_u32 s37, s31, 32768
s_add_u32 m0, s33, 1024
s_nop 0
buffer_load_dwordx4 v2, s[20:23], s37 offen  lds
s_add_u32 s37, s31, 131072
s_add_u32 m0, s33, 4096
s_nop 0
buffer_load_dwordx4 v2, s[20:23], s37 offen  lds
s_add_u32 s37, s31, 163840
s_add_u32 m0, s33, 5120
s_nop 0
buffer_load_dwordx4 v2, s[20:23], s37 offen  lds
s_add_u32 s31, s31, 262144
s_add_u32 s33, s33, 16384
s_and_b32 s33, s33, 65535
s_add_u32 s37, s31, 0
s_add_u32 m0, s33, 0
s_nop 0
buffer_load_dwordx4 v2, s[20:23], s37 offen  lds
s_add_u32 s37, s31, 32768
s_add_u32 m0, s33, 1024
s_nop 0
buffer_load_dwordx4 v2, s[20:23], s37 offen  lds
s_add_u32 s37, s31, 131072
s_add_u32 m0, s33, 4096
s_nop 0
buffer_load_dwordx4 v2, s[20:23], s37 offen  lds
s_add_u32 s37, s31, 163840
s_add_u32 m0, s33, 5120
s_nop 0
buffer_load_dwordx4 v2, s[20:23], s37 offen  lds
s_add_u32 s31, s31, 262144
s_add_u32 s33, s33, 16384
s_and_b32 s33, s33, 65535
s_mov_b32 s48, s30
s_add_u32 m0, s32, 0
s_nop 0
buffer_load_dwordx4 v1, s[12:15], s48 offen lds
s_add_u32 s48, s48, s34
s_add_u32 m0, s32, 4096
s_nop 0
buffer_load_dwordx4 v1, s[12:15], s48 offen lds
s_add_u32 s48, s48, s34
s_add_u32 m0, s32, 8192
s_nop 0
buffer_load_dwordx4 v1, s[12:15], s48 offen lds
s_add_u32 s48, s48, s34
s_add_u32 m0, s32, 12288
s_nop 0
buffer_load_dwordx4 v1, s[12:15], s48 offen lds
s_add_u32 s37, s31, 0
s_add_u32 m0, s33, 0
s_nop 0
buffer_load_dwordx4 v2, s[20:23], s37 offen  lds
s_add_u32 s37, s31, 32768
s_add_u32 m0, s33, 1024
s_nop 0
buffer_load_dwordx4 v2, s[20:23], s37 offen  lds
s_add_u32 s37, s31, 131072
s_add_u32 m0, s33, 4096
s_nop 0
buffer_load_dwordx4 v2, s[20:23], s37 offen  lds
s_add_u32 s37, s31, 163840
s_add_u32 m0, s33, 5120
s_nop 0
buffer_load_dwordx4 v2, s[20:23], s37 offen  lds
s_add_u32 s31, s31, 262144
s_add_u32 s33, s33, 16384
s_and_b32 s33, s33, 65535
s_add_u32 s48, s48, s34
s_add_u32 m0, s32, 16384
s_nop 0
buffer_load_dwordx4 v1, s[12:15], s48 offen lds
s_add_u32 s48, s48, s34
s_add_u32 m0, s32, 20480
s_nop 0
buffer_load_dwordx4 v1, s[12:15], s48 offen lds
s_add_u32 s48, s48, s34
s_add_u32 m0, s32, 24576
s_nop 0
buffer_load_dwordx4 v1, s[12:15], s48 offen lds
s_add_u32 s48, s48, s34
s_add_u32 m0, s32, 28672
s_nop 0
buffer_load_dwordx4 v1, s[12:15], s48 offen lds
s_add_u32 s30, s30, 128
s_add_u32 s32, s32, 32768
s_sub_u32 s48, s32, 98304
s_cmp_ge_u32 s32, 163840
s_cselect_b32 s32, s48, s32
s_add_u32 s37, s31, 0
s_add_u32 m0, s33, 0
s_nop 0
buffer_load_dwordx4 v2, s[20:23], s37 offen  lds
s_add_u32 s37, s31, 32768
s_add_u32 m0, s33, 1024
s_nop 0
buffer_load_dwordx4 v2, s[20:23], s37 offen  lds
s_add_u32 s37, s31, 131072
s_add_u32 m0, s33, 4096
s_nop 0
buffer_load_dwordx4 v2, s[20:23], s37 offen  lds
s_add_u32 s37, s31, 163840
s_add_u32 m0, s33, 5120
s_nop 0
buffer_load_dwordx4 v2, s[20:23], s37 offen  lds
s_add_u32 s31, s31, 262144
s_add_u32 s33, s33, 16384
s_and_b32 s33, s33, 65535
s_mov_b32 s48, s30
s_add_u32 m0, s32, 0
s_nop 0
buffer_load_dwordx4 v1, s[12:15], s48 offen lds
s_add_u32 s48, s48, s34
s_add_u32 m0, s32, 4096
s_nop 0
buffer_load_dwordx4 v1, s[12:15], s48 offen lds
s_add_u32 s48, s48, s34
s_add_u32 m0, s32, 8192
s_nop 0
buffer_load_dwordx4 v1, s[12:15], s48 offen lds
s_add_u32 s48, s48, s34
s_add_u32 m0, s32, 12288
s_nop 0
buffer_load_dwordx4 v1, s[12:15], s48 offen lds
s_mov_b32 s62, 536870912
s_mov_b32 s63, 536870912
s_mov_b32 s50, 0
s_waitcnt vmcnt(24)
s_barrier
s_cmp_eq_u32 s41, 0
s_cbranch_scc0 L_g_p1
ds_read_b64_tr_b16 a[160:161], v5 offset:0
ds_read_b64_tr_b16 a[162:163], v5 offset:1024
ds_read_b64_tr_b16 a[164:165], v6 offset:0
ds_read_b64_tr_b16 a[166:167], v6 offset:1024
ds_read_b64_tr_b16 a[168:169], v7 offset:0
ds_read_b64_tr_b16 a[170:171], v7 offset:1024
ds_read_b64_tr_b16 a[172:173], v8 offset:0
ds_read_b64_tr_b16 a[174:175], v8 offset:1024
ds_read_b64_tr_b16 a[176:177], v9 offset:0
ds_read_b64_tr_b16 a[178:179], v9 offset:1024
ds_read_b64_tr_b16 a[180:181], v10 offset:0
ds_read_b64_tr_b16 a[182:183], v10 offset:1024
ds_read_b64_tr_b16 a[184:185], v11 offset:0
ds_read_b64_tr_b16 a[186:187], v11 offset:1024
ds_read_b64_tr_b16 a[188:189], v12 offset:0
ds_read_b64_tr_b16 a[190:191], v12 offset:1024
ds_read_b128 a[192:195], v3 offset:0
ds_read_b128 a[196:199], v4 offset:1024
ds_read_b128 a[200:203], v3 offset:4096
ds_read_b128 a[204:207], v4 offset:5120
ds_read_b128 a[208:211], v3 offset:8192
ds_read_b128 a[212:215], v4 offset:9216
ds_read_b128 a[216:219], v3 offset:12288
ds_read_b128 a[220:223], v4 offset:13312
s_branch L_g_p2
L_g_p1:
ds_read_b128 a[160:163], v3 offset:0
ds_read_b128 a[164:167], v4 offset:1024
ds_read_b128 a[168:171], v3 offset:4096
ds_read_b128 a[172:175], v4 offset:5120
ds_read_b128 a[176:179], v3 offset:8192
ds_read_b128 a[180:183], v4 offset:9216
ds_read_b128 a[184:187], v3 offset:12288
ds_read_b128 a[188:191], v4 offset:13312
ds_read_b64_tr_b16 a[192:193], v5 offset:0
ds_read_b64_tr_b16 a[194:195], v5 offset:1024
ds_read_b64_tr_b16 a[196:197], v6 offset:0
ds_read_b64_tr_b16 a[198:199], v6 offset:1024
ds_read_b64_tr_b16 a[200:201], v7 offset:0
ds_read_b64_tr_b16 a[202:203], v7 offset:1024
ds_read_b64_tr_b16 a[204:205], v8 offset:0
ds_read_b64_tr_b16 a[206:207], v8 offset:1024
ds_read_b64_tr_b16 a[208:209], v9 offset:0
ds_read_b64_tr_b16 a[210:211], v9 offset:1024
ds_read_b64_tr_b16 a[212:213], v10 offset:0
ds_read_b64_tr_b16 a[214:215], v10 offset:1024
ds_read_b64_tr_b16 a[216:217], v11 offset:0
ds_read_b64_tr_b16 a[218:219], v11 offset:1024
ds_read_b64_tr_b16 a[220:221], v12 offset:0
ds_read_b64_tr_b16 a[222:223], v12 offset:1024
L_g_p2:
v_add_u32 v5, 16384, v5
v_and_b32 v5, 65535, v5
v_xor_b32 v6, 16, v5
v_xor_b32 v7, 64, v5
v_xor_b32 v8, 80, v5
v_xor_b32 v9, 128, v5
v_xor_b32 v10, 144, v5
v_xor_b32 v11, 192, v5
v_xor_b32 v12, 208, v5
L_g_tile:
s_cmp_eq_u32 s35, 1
s_cbranch_scc1 L_g_first
L_g_go:
s_cmp_eq_u32 s41, 0
s_cbranch_scc0 L_g_v
.p2align 3
L_g_k:
s_waitcnt vmcnt(16) lgkmcnt(0)
s_barrier
v_mfma_f32_16x16x32_bf16 v[160:163], a[160:163], a[192:195], 0
ds_read_b128 a[224:227], v4 offset:0
v_accvgpr_read_b32 v20, a64
v_accvgpr_read_b32 v21, a65
v_accvgpr_read_b32 v22, a66
v_mfma_f32_16x16x32_bf16 v[164:167], a[160:163], a[196:199], 0
s_add_u32 s37, s31, 0
v_accvgpr_read_b32 v23, a67
v_cvt_pk_bf16_f32 v98, v20, v21
v_cvt_pk_bf16_f32 v99, v22, v23
v_accvgpr_read_b32 v24, a68
v_mfma_f32_16x16x32_bf16 v[168:171], a[160:163], a[200:203], 0
s_add_u32 m0, s33, 0
ds_read_b128 a[228:231], v3 offset:1024
v_accvgpr_read_b32 v25, a69
v_accvgpr_read_b32 v26, a70
v_accvgpr_read_b32 v27, a71
v_mfma_f32_16x16x32_bf16 v[172:175], a[160:163], a[204:207], 0
buffer_load_dwordx4 v2, s[20:23], s37 offen  lds
v_cvt_pk_bf16_f32 v102, v24, v25
v_cvt_pk_bf16_f32 v103, v26, v27
v_accvgpr_read_b32 v20, a72
v_mfma_f32_16x16x32_bf16 v[176:179], a[160:163], a[208:211], 0
ds_read_b128 a[232:235], v4 offset:4096
v_accvgpr_read_b32 v21, a73
v_accvgpr_read_b32 v22, a74
v_accvgpr_read_b32 v23, a75
v_mfma_f32_16x16x32_bf16 v[180:183], a[160:163], a[212:215], 0
v_cvt_pk_bf16_f32 v106, v20, v21
v_cvt_pk_bf16_f32 v107, v22, v23
v_accvgpr_read_b32 v24, a76
v_accvgpr_read_b32 v25, a77
v_mfma_f32_16x16x32_bf16 v[184:187], a[160:163], a[216:219], 0
ds_read_b128 a[236:239], v3 offset:5120
v_accvgpr_read_b32 v26, a78
v_accvgpr_read_b32 v27, a79
v_cvt_pk_bf16_f32 v110, v24, v25
v_mfma_f32_16x16x32_bf16 v[188:191], a[160:163], a[220:223], 0
ds_read_b64_tr_b16 a[160:161], v5 offset:0
v_cvt_pk_bf16_f32 v111, v26, v27
v_accvgpr_read_b32 v20, a80
v_accvgpr_read_b32 v21, a81
v_mfma_f32_16x16x32_bf16 v[192:195], a[164:167], a[192:195], 0
s_add_u32 s37, s31, 32768
ds_read_b64_tr_b16 a[162:163], v5 offset:1024
v_accvgpr_read_b32 v22, a82
v_accvgpr_read_b32 v23, a83
v_cvt_pk_bf16_f32 v114, v20, v21
v_mfma_f32_16x16x32_bf16 v[196:199], a[164:167], a[196:199], 0
s_add_u32 m0, s33, 1024
ds_read_b128 a[240:243], v4 offset:8192
v_add_u32 v5, 16384, v5
v_cvt_pk_bf16_f32 v115, v22, v23
v_accvgpr_read_b32 v24, a84
v_mfma_f32_16x16x32_bf16 v[200:203], a[164:167], a[200:203], 0
buffer_load_dwordx4 v2, s[20:23], s37 offen  lds
v_and_b32 v5, 65535, v5
v_accvgpr_read_b32 v25, a85
v_accvgpr_read_b32 v26, a86
v_mfma_f32_16x16x32_bf16 v[204:207], a[164:167], a[204:207], 0
ds_read_b128 a[244:247], v3 offset:9216
v_accvgpr_read_b32 v27, a87
v_cvt_pk_bf16_f32 v118, v24, v25
v_cvt_pk_bf16_f32 v119, v26, v27
v_mfma_f32_16x16x32_bf16 v[208:211], a[164:167], a[208:211], 0
v_accvgpr_read_b32 v20, a88
v_accvgpr_read_b32 v21, a89
v_accvgpr_read_b32 v22, a90
v_accvgpr_read_b32 v23, a91
v_mfma_f32_16x16x32_bf16 v[212:215], a[164:167], a[212:215], 0
ds_read_b128 a[248:251], v4 offset:12288
v_cvt_pk_bf16_f32 v122, v20, v21
v_cvt_pk_bf16_f32 v123, v22, v23
v_accvgpr_read_b32 v24, a92
v_mfma_f32_16x16x32_bf16 v[216:219], a[164:167], a[216:219], 0
v_accvgpr_read_b32 v25, a93
v_accvgpr_read_b32 v26, a94
v_accvgpr_read_b32 v27, a95
v_cvt_pk_bf16_f32 v126, v24, v25
v_mfma_f32_16x16x32_bf16 v[220:223], a[164:167], a[220:223], 0
s_add_u32 s37, s31, 131072
ds_read_b64_tr_b16 a[164:165], v6 offset:0
v_cvt_pk_bf16_f32 v127, v26, v27
v_accvgpr_read_b32 v20, a96
v_accvgpr_read_b32 v21, a97
v_mfma_f32_16x16x32_bf16 v[224:227], a[168:171], a[192:195], 0
s_add_u32 m0, s33, 4096
ds_read_b64_tr_b16 a[166:167], v6 offset:1024
v_accvgpr_read_b32 v22, a98
v_accvgpr_read_b32 v23, a99
v_cvt_pk_bf16_f32 v128, v20, v21
v_mfma_f32_16x16x32_bf16 v[228:231], a[168:171], a[196:199], 0
buffer_load_dwordx4 v2, s[20:23], s37 offen  lds
v_xor_b32 v6, 16, v5
v_cvt_pk_bf16_f32 v129, v22, v23
v_accvgpr_read_b32 v24, a100
v_mfma_f32_16x16x32_bf16 v[232:235], a[168:171], a[200:203], 0
ds_read_b128 a[252:255], v3 offset:13312
v_accvgpr_read_b32 v25, a101
v_accvgpr_read_b32 v26, a102
v_accvgpr_read_b32 v27, a103
v_mfma_f32_16x16x32_bf16 v[236:239], a[168:171], a[204:207], 0
v_cvt_pk_bf16_f32 v132, v24, v25
v_cvt_pk_bf16_f32 v133, v26, v27
v_accvgpr_read_b32 v20, a104
v_accvgpr_read_b32 v21, a105
v_mfma_f32_16x16x32_bf16 v[240:243], a[168:171], a[208:211], 0
ds_read_b64_tr_b16 v[28:29], v12 offset:0
v_accvgpr_read_b32 v22, a106
v_accvgpr_read_b32 v23, a107
v_cvt_pk_bf16_f32 v136, v20, v21
v_mfma_f32_16x16x32_bf16 v[244:247], a[168:171], a[212:215], 0
v_cvt_pk_bf16_f32 v137, v22, v23
v_accvgpr_read_b32 v24, a108
v_accvgpr_read_b32 v25, a109
v_accvgpr_read_b32 v26, a110
v_mfma_f32_16x16x32_bf16 v[248:251], a[168:171], a[216:219], 0
s_add_u32 s37, s31, 163840
ds_read_b64_tr_b16 v[30:31], v12 offset:1024
v_accvgpr_read_b32 v27, a111
v_cvt_pk_bf16_f32 v140, v24, v25
v_cvt_pk_bf16_f32 v141, v26, v27
v_mfma_f32_16x16x32_bf16 v[252:255], a[168:171], a[220:223], 0
s_add_u32 m0, s33, 5120
ds_read_b64_tr_b16 a[168:169], v7 offset:0
v_accvgpr_read_b32 v20, a112
v_accvgpr_read_b32 v21, a113
v_accvgpr_read_b32 v22, a114
v_mfma_f32_16x16x32_bf16 a[0:3], a[172:175], a[192:195], 0
buffer_load_dwordx4 v2, s[20:23], s37 offen  lds
ds_read_b64_tr_b16 a[170:171], v7 offset:1024
v_accvgpr_read_b32 v23, a115
v_cvt_pk_bf16_f32 v144, v20, v21
v_mfma_f32_16x16x32_bf16 a[4:7], a[172:175], a[196:199], 0
s_add_u32 s31, s31, 262144
v_xor_b32 v7, 64, v5
v_xor_b32 v12, 208, v5
v_cvt_pk_bf16_f32 v145, v22, v23
v_accvgpr_read_b32 v24, a116
v_mfma_f32_16x16x32_bf16 a[8:11], a[172:175], a[200:203], 0
s_add_u32 s33, s33, 16384
v_add_u32 v3, 32768, v3
v_accvgpr_read_b32 v25, a117
v_accvgpr_read_b32 v26, a118
v_accvgpr_read_b32 v27, a119
v_mfma_f32_16x16x32_bf16 a[12:15], a[172:175], a[204:207], 0
s_and_b32 s33, s33, 65535
v_subrev_u32 v19, 98304, v3
v_cvt_pk_bf16_f32 v148, v24, v25
v_cvt_pk_bf16_f32 v149, v26, v27
v_accvgpr_read_b32 v20, a120
v_mfma_f32_16x16x32_bf16 a[16:19], a[172:175], a[208:211], 0
v_cmp_le_u32 vcc, 163840, v3
v_accvgpr_read_b32 v21, a121
v_accvgpr_read_b32 v22, a122
v_accvgpr_read_b32 v23, a123
v_mfma_f32_16x16x32_bf16 a[20:23], a[172:175], a[212:215], 0
s_add_u32 s48, s48, s34
v_cndmask_b32 v3, v3, v19, vcc
v_cvt_pk_bf16_f32 v152, v20, v21
v_cvt_pk_bf16_f32 v153, v22, v23
v_accvgpr_read_b32 v24, a124
v_mfma_f32_16x16x32_bf16 a[24:27], a[172:175], a[216:219], 0
s_add_u32 m0, s32, 16384
v_xor_b32 v4, 64, v3
v_accvgpr_read_b32 v25, a125
v_accvgpr_read_b32 v26, a126
v_accvgpr_read_b32 v27, a127
v_mfma_f32_16x16x32_bf16 a[28:31], a[172:175], a[220:223], 0
buffer_load_dwordx4 v1, s[12:15], s48 offen lds
ds_read_b64_tr_b16 a[172:173], v8 offset:0
v_cvt_pk_bf16_f32 v156, v24, v25
v_cvt_pk_bf16_f32 v157, v26, v27
v_mfma_f32_16x16x32_bf16 a[32:35], a[176:179], a[192:195], 0
ds_read_b64_tr_b16 a[174:175], v8 offset:1024
v_accvgpr_read_b32 v20, a128
v_accvgpr_read_b32 v21, a129
v_accvgpr_read_b32 v22, a130
v_mfma_f32_16x16x32_bf16 a[36:39], a[176:179], a[196:199], 0
v_xor_b32 v8, 80, v5
v_accvgpr_read_b32 v23, a131
v_cvt_pk_bf16_f32 v130, v20, v21
v_cvt_pk_bf16_f32 v131, v22, v23
v_mfma_f32_16x16x32_bf16 a[40:43], a[176:179], a[200:203], 0
v_accvgpr_read_b32 v24, a132
v_accvgpr_read_b32 v25, a133
v_accvgpr_read_b32 v26, a134
v_accvgpr_read_b32 v27, a135
v_mfma_f32_16x16x32_bf16 a[44:47], a[176:179], a[204:207], 0
v_cvt_pk_bf16_f32 v134, v24, v25
v_cvt_pk_bf16_f32 v135, v26, v27
v_accvgpr_read_b32 v20, a136
v_accvgpr_read_b32 v21, a137
v_mfma_f32_16x16x32_bf16 a[48:51], a[176:179], a[208:211], 0
s_add_u32 s48, s48, s34
v_accvgpr_read_b32 v22, a138
v_accvgpr_read_b32 v23, a139
v_cvt_pk_bf16_f32 v138, v20, v21
v_cvt_pk_bf16_f32 v139, v22, v23
s_mov_b32 s38, s62
s_mov_b32 s39, s63
v_mfma_f32_16x16x32_bf16 a[52:55], a[176:179], a[212:215], 0
s_add_u32 m0, s32, 20480
v_accvgpr_read_b32 v24, a140
v_accvgpr_read_b32 v25, a141
v_accvgpr_read_b32 v26, a142
v_accvgpr_read_b32 v27, a143
s_mov_b32 s49, s50
s_mov_b32 s62, s42
v_mfma_f32_16x16x32_bf16 a[56:59], a[176:179], a[216:219], 0
buffer_load_dwordx4 v1, s[12:15], s48 offen lds
v_cvt_pk_bf16_f32 v142, v24, v25
v_cvt_pk_bf16_f32 v143, v26, v27
v_accvgpr_read_b32 v20, a144
s_mov_b32 s63, s43
s_mov_b32 s50, s51
v_mfma_f32_16x16x32_bf16 a[60:63], a[176:179], a[220:223], 0
ds_read_b64_tr_b16 a[176:177], v9 offset:0
v_accvgpr_read_b32 v21, a145
v_accvgpr_read_b32 v22, a146
v_accvgpr_read_b32 v23, a147
s_mov_b32 s36, s40
s_add_u32 s35, s35, 1
v_mfma_f32_16x16x32_bf16 a[64:67], a[180:183], a[192:195], 0
ds_read_b64_tr_b16 a[178:179], v9 offset:1024
v_cvt_pk_bf16_f32 v146, v20, v21
v_cvt_pk_bf16_f32 v147, v22, v23
v_accvgpr_read_b32 v24, a148
v_bfe_u32 v16, v0, 3, 3
v_lshlrev_b32 v16, 4, v16
v_mfma_f32_16x16x32_bf16 a[68:71], a[180:183], a[196:199], 0
v_xor_b32 v9, 128, v5
v_accvgpr_read_b32 v25, a149
v_accvgpr_read_b32 v26, a150
v_accvgpr_read_b32 v27, a151
v_and_or_b32 v16, v0, 7, v16
v_bfe_u32 v17, v0, 4, 2
v_mfma_f32_16x16x32_bf16 a[72:75], a[180:183], a[200:203], 0
v_cvt_pk_bf16_f32 v150, v24, v25
v_cvt_pk_bf16_f32 v151, v26, v27
v_accvgpr_read_b32 v20, a152
v_accvgpr_read_b32 v21, a153
v_lshlrev_b32 v17, 5, v17
v_bfe_u32 v18, v0, 1, 3
v_mfma_f32_16x16x32_bf16 a[76:79], a[180:183], a[204:207], 0
s_add_u32 s48, s48, s34
v_accvgpr_read_b32 v22, a154
v_accvgpr_read_b32 v23, a155
v_cvt_pk_bf16_f32 v154, v20, v21
v_cvt_pk_bf16_f32 v155, v22, v23
v_or_b32 v17, v17, v18
v_and_b32 v18, 1, v0
v_mfma_f32_16x16x32_bf16 a[80:83], a[180:183], a[208:211], 0
s_add_u32 m0, s32, 24576
v_accvgpr_read_b32 v24, a156
v_accvgpr_read_b32 v25, a157
v_accvgpr_read_b32 v26, a158
v_accvgpr_read_b32 v27, a159
v_lshl_or_b32 v17, v18, 4, v17
v_mfma_f32_16x16x32_bf16 a[84:87], a[180:183], a[212:215], 0
buffer_load_dwordx4 v1, s[12:15], s48 offen lds
v_cvt_pk_bf16_f32 v158, v24, v25
v_cvt_pk_bf16_f32 v159, v26, v27
s_bitcmp1_b32 s49, 1
s_cselect_b64 vcc, -1, 0
s_movk_i32 s44, 0x80
v_mfma_f32_16x16x32_bf16 a[88:91], a[180:183], a[216:219], 0
v_cndmask_b32 v16, v16, v17, vcc
v_lshlrev_b32 v13, 4, v16
s_lshr_b32 s93, s49, 2
s_lshr_b32 s93, 0x80000, s93
v_mfma_f32_16x16x32_bf16 a[92:95], a[180:183], a[220:223], 0
ds_read_b64_tr_b16 a[180:181], v10 offset:0
s_bitcmp1_b32 s49, 0
s_cselect_b32 s92, s93, 0x800
s_cselect_b32 s93, 0x800, s93
s_sub_u32 s93, s93, s44
v_mfma_f32_16x16x32_bf16 a[96:99], a[184:187], a[192:195], 0
ds_read_b64_tr_b16 a[182:183], v10 offset:1024
v_mfma_f32_16x16x32_bf16 a[100:103], a[184:187], a[196:199], 0
v_xor_b32 v10, 144, v5
v_mfma_f32_16x16x32_bf16 a[104:107], a[184:187], a[200:203], 0
s_add_u32 s48, s48, s34
v_mfma_f32_16x16x32_bf16 a[108:111], a[184:187], a[204:207], 0
s_add_u32 m0, s32, 28672
v_mfma_f32_16x16x32_bf16 a[112:115], a[184:187], a[208:211], 0
buffer_load_dwordx4 v1, s[12:15], s48 offen lds
v_mfma_f32_16x16x32_bf16 a[116:119], a[184:187], a[212:215], 0
s_add_u32 s30, s30, 128
v_mfma_f32_16x16x32_bf16 a[120:123], a[184:187], a[216:219], 0
s_add_u32 s32, s32, 32768
v_mfma_f32_16x16x32_bf16 a[124:127], a[184:187], a[220:223], 0
s_sub_u32 s48, s32, 98304
ds_read_b64_tr_b16 a[184:185], v11 offset:0
v_mfma_f32_16x16x32_bf16 a[128:131], a[188:191], a[192:195], 0
s_cmp_ge_u32 s32, 163840
s_cselect_b32 s32, s48, s32
ds_read_b64_tr_b16 a[186:187], v11 offset:1024
v_mfma_f32_16x16x32_bf16 a[132:135], a[188:191], a[196:199], 0
v_xor_b32 v11, 192, v5
v_mfma_f32_16x16x32_bf16 a[136:139], a[188:191], a[200:203], 0
buffer_load_dword v15, v14, s[96:99], s100 offen
v_mfma_f32_16x16x32_bf16 a[140:143], a[188:191], a[204:207], 0
s_add_u32 s100, s100, 16384
v_mfma_f32_16x16x32_bf16 a[144:147], a[188:191], a[208:211], 0
v_mfma_f32_16x16x32_bf16 a[148:151], a[188:191], a[212:215], 0
v_mfma_f32_16x16x32_bf16 a[152:155], a[188:191], a[216:219], 0
v_mfma_f32_16x16x32_bf16 a[156:159], a[188:191], a[220:223], 0
s_waitcnt vmcnt(17) lgkmcnt(0)
s_barrier
v_mfma_f32_16x16x32_bf16 v[160:163], a[160:163], a[224:227], v[160:163]
ds_read_b128 a[192:195], v3 offset:0
v_mfma_f32_16x16x32_bf16 v[164:167], a[160:163], a[228:231], v[164:167]
s_add_u32 s37, s31, 0
v_mfma_f32_16x16x32_bf16 v[168:171], a[160:163], a[232:235], v[168:171]
s_add_u32 m0, s33, 0
ds_read_b128 a[196:199], v4 offset:1024
v_mfma_f32_16x16x32_bf16 v[172:175], a[160:163], a[236:239], v[172:175]
buffer_load_dwordx4 v2, s[20:23], s37 offen  lds
v_mfma_f32_16x16x32_bf16 v[176:179], a[160:163], a[240:243], v[176:179]
s_mov_b32 s60, s38
ds_read_b128 a[200:203], v3 offset:4096
v_mfma_f32_16x16x32_bf16 v[180:183], a[160:163], a[244:247], v[180:183]
s_mov_b32 s29, s38
v_mfma_f32_16x16x32_bf16 v[184:187], a[160:163], a[248:251], v[184:187]
buffer_store_dwordx4 v[32:35], v13, s[8:11], s29 offen sc1
v_mfma_f32_16x16x32_bf16 v[188:191], a[160:163], a[252:255], v[188:191]
ds_read_b64_tr_b16 a[160:161], v5 offset:0
v_mfma_f32_16x16x32_bf16 v[192:195], a[164:167], a[224:227], v[192:195]
s_add_u32 s37, s31, 32768
ds_read_b64_tr_b16 a[162:163], v5 offset:1024
v_mfma_f32_16x16x32_bf16 v[196:199], a[164:167], a[228:231], v[196:199]
s_add_u32 m0, s33, 1024
ds_read_b128 a[204:207], v4 offset:5120
v_add_u32 v5, 16384, v5
v_mfma_f32_16x16x32_bf16 v[200:203], a[164:167], a[232:235], v[200:203]
buffer_load_dwordx4 v2, s[20:23], s37 offen  lds
v_and_b32 v5, 65535, v5
v_mfma_f32_16x16x32_bf16 v[204:207], a[164:167], a[236:239], v[204:207]
ds_read_b128 a[208:211], v3 offset:8192
v_mfma_f32_16x16x32_bf16 v[208:211], a[164:167], a[240:243], v[208:211]
v_mfma_f32_16x16x32_bf16 v[212:215], a[164:167], a[244:247], v[212:215]
ds_read_b128 a[212:215], v4 offset:9216
v_mfma_f32_16x16x32_bf16 v[216:219], a[164:167], a[248:251], v[216:219]
v_mfma_f32_16x16x32_bf16 v[220:223], a[164:167], a[252:255], v[220:223]
s_add_u32 s37, s31, 131072
ds_read_b64_tr_b16 a[164:165], v6 offset:0
v_mfma_f32_16x16x32_bf16 v[224:227], a[168:171], a[224:227], v[224:227]
s_add_u32 m0, s33, 4096
ds_read_b64_tr_b16 a[166:167], v6 offset:1024
v_mfma_f32_16x16x32_bf16 v[228:231], a[168:171], a[228:231], v[228:231]
buffer_load_dwordx4 v2, s[20:23], s37 offen  lds
v_xor_b32 v6, 16, v5
v_mfma_f32_16x16x32_bf16 v[232:235], a[168:171], a[232:235], v[232:235]
ds_read_b128 a[216:219], v3 offset:12288
v_mfma_f32_16x16x32_bf16 v[236:239], a[168:171], a[236:239], v[236:239]
v_mfma_f32_16x16x32_bf16 v[240:243], a[168:171], a[240:243], v[240:243]
ds_read_b128 a[220:223], v4 offset:13312
v_mfma_f32_16x16x32_bf16 v[244:247], a[168:171], a[244:247], v[244:247]
v_mfma_f32_16x16x32_bf16 v[248:251], a[168:171], a[248:251], v[248:251]
s_add_u32 s37, s31, 163840
ds_read_b64_tr_b16 a[188:189], v12 offset:0
v_mfma_f32_16x16x32_bf16 v[252:255], a[168:171], a[252:255], v[252:255]
s_add_u32 m0, s33, 5120
ds_read_b64_tr_b16 a[168:169], v7 offset:0
v_mfma_f32_16x16x32_bf16 a[0:3], a[172:175], a[224:227], a[0:3]
buffer_load_dwordx4 v2, s[20:23], s37 offen  lds
ds_read_b64_tr_b16 a[170:171], v7 offset:1024
v_mfma_f32_16x16x32_bf16 a[4:7], a[172:175], a[228:231], a[4:7]
s_add_u32 s31, s31, 262144
s_add_u32 s29, s29, s44
v_xor_b32 v7, 64, v5
v_mfma_f32_16x16x32_bf16 a[8:11], a[172:175], a[232:235], a[8:11]
s_add_u32 s33, s33, 16384
ds_read_b64_tr_b16 a[190:191], v12 offset:1024
v_mfma_f32_16x16x32_bf16 a[12:15], a[172:175], a[236:239], a[12:15]
s_and_b32 s33, s33, 65535
buffer_store_dwordx4 v[36:39], v13, s[8:11], s29 offen sc1
v_mfma_f32_16x16x32_bf16 a[16:19], a[172:175], a[240:243], a[16:19]
v_mfma_f32_16x16x32_bf16 a[20:23], a[172:175], a[244:247], a[20:23]
s_mov_b32 s48, s30
v_xor_b32 v12, 208, v5
v_mfma_f32_16x16x32_bf16 a[24:27], a[172:175], a[248:251], a[24:27]
s_add_u32 m0, s32, 0
v_mfma_f32_16x16x32_bf16 a[28:31], a[172:175], a[252:255], a[28:31]
buffer_load_dwordx4 v1, s[12:15], s48 offen lds
ds_read_b64_tr_b16 a[172:173], v8 offset:0
v_mfma_f32_16x16x32_bf16 a[32:35], a[176:179], a[224:227], a[32:35]
ds_read_b64_tr_b16 a[174:175], v8 offset:1024
v_mfma_f32_16x16x32_bf16 a[36:39], a[176:179], a[228:231], a[36:39]
v_xor_b32 v8, 80, v5
v_mfma_f32_16x16x32_bf16 a[40:43], a[176:179], a[232:235], a[40:43]
v_mfma_f32_16x16x32_bf16 a[44:47], a[176:179], a[236:239], a[44:47]
v_mfma_f32_16x16x32_bf16 a[48:51], a[176:179], a[240:243], a[48:51]
s_add_u32 s48, s48, s34
v_mfma_f32_16x16x32_bf16 a[52:55], a[176:179], a[244:247], a[52:55]
s_add_u32 m0, s32, 4096
v_mfma_f32_16x16x32_bf16 a[56:59], a[176:179], a[248:251], a[56:59]
buffer_load_dwordx4 v1, s[12:15], s48 offen lds
v_mfma_f32_16x16x32_bf16 a[60:63], a[176:179], a[252:255], a[60:63]
ds_read_b64_tr_b16 a[176:177], v9 offset:0
v_mfma_f32_16x16x32_bf16 a[64:67], a[180:183], a[224:227], a[64:67]
ds_read_b64_tr_b16 a[178:179], v9 offset:1024
v_mfma_f32_16x16x32_bf16 a[68:71], a[180:183], a[228:231], a[68:71]
v_xor_b32 v9, 128, v5
v_mfma_f32_16x16x32_bf16 a[72:75], a[180:183], a[232:235], a[72:75]
v_mfma_f32_16x16x32_bf16 a[76:79], a[180:183], a[236:239], a[76:79]
s_add_u32 s48, s48, s34
v_mfma_f32_16x16x32_bf16 a[80:83], a[180:183], a[240:243], a[80:83]
s_add_u32 m0, s32, 8192
v_mfma_f32_16x16x32_bf16 a[84:87], a[180:183], a[244:247], a[84:87]
buffer_load_dwordx4 v1, s[12:15], s48 offen lds
v_mfma_f32_16x16x32_bf16 a[88:91], a[180:183], a[248:251], a[88:91]
s_add_u32 s29, s29, s93
v_mfma_f32_16x16x32_bf16 a[92:95], a[180:183], a[252:255], a[92:95]
ds_read_b64_tr_b16 a[180:181], v10 offset:0
v_mfma_f32_16x16x32_bf16 a[96:99], a[184:187], a[224:227], a[96:99]
buffer_store_dwordx4 v[40:43], v13, s[8:11], s29 offen sc1
ds_read_b64_tr_b16 a[182:183], v10 offset:1024
v_mfma_f32_16x16x32_bf16 a[100:103], a[184:187], a[228:231], a[100:103]
v_xor_b32 v10, 144, v5
v_mfma_f32_16x16x32_bf16 a[104:107], a[184:187], a[232:235], a[104:107]
s_add_u32 s48, s48, s34
v_mfma_f32_16x16x32_bf16 a[108:111], a[184:187], a[236:239], a[108:111]
s_add_u32 m0, s32, 12288
v_mfma_f32_16x16x32_bf16 a[112:115], a[184:187], a[240:243], a[112:115]
buffer_load_dwordx4 v1, s[12:15], s48 offen lds
v_mfma_f32_16x16x32_bf16 a[116:119], a[184:187], a[244:247], a[116:119]
v_mfma_f32_16x16x32_bf16 a[120:123], a[184:187], a[248:251], a[120:123]
v_mfma_f32_16x16x32_bf16 a[124:127], a[184:187], a[252:255], a[124:127]
ds_read_b64_tr_b16 a[184:185], v11 offset:0
v_mfma_f32_16x16x32_bf16 a[128:131], v[28:31], a[224:227], a[128:131]
ds_read_b64_tr_b16 a[186:187], v11 offset:1024
v_mfma_f32_16x16x32_bf16 a[132:135], v[28:31], a[228:231], a[132:135]
v_xor_b32 v11, 192, v5
v_mfma_f32_16x16x32_bf16 a[136:139], v[28:31], a[232:235], a[136:139]
buffer_load_dword v15, v14, s[96:99], s100 offen
v_mfma_f32_16x16x32_bf16 a[140:143], v[28:31], a[236:239], a[140:143]
s_add_u32 s100, s100, 16384
v_mfma_f32_16x16x32_bf16 a[144:147], v[28:31], a[240:243], a[144:147]
v_mfma_f32_16x16x32_bf16 a[148:151], v[28:31], a[244:247], a[148:151]
v_mfma_f32_16x16x32_bf16 a[152:155], v[28:31], a[248:251], a[152:155]
v_mfma_f32_16x16x32_bf16 a[156:159], v[28:31], a[252:255], a[156:159]
s_waitcnt vmcnt(21) lgkmcnt(0)
s_barrier
v_mfma_f32_16x16x32_bf16 v[160:163], a[160:163], a[192:195], v[160:163]
ds_read_b128 a[224:227], v4 offset:0
v_mfma_f32_16x16x32_bf16 v[164:167], a[160:163], a[196:199], v[164:167]
s_add_u32 s37, s31, 0
v_mfma_f32_16x16x32_bf16 v[168:171], a[160:163], a[200:203], v[168:171]
s_add_u32 m0, s33, 0
ds_read_b128 a[228:231], v3 offset:1024
v_mfma_f32_16x16x32_bf16 v[172:175], a[160:163], a[204:207], v[172:175]
buffer_load_dwordx4 v2, s[20:23], s37 offen  lds
v_mfma_f32_16x16x32_bf16 v[176:179], a[160:163], a[208:211], v[176:179]
s_add_u32 s29, s29, s44
ds_read_b128 a[232:235], v4 offset:4096
v_mfma_f32_16x16x32_bf16 v[180:183], a[160:163], a[212:215], v[180:183]
v_mfma_f32_16x16x32_bf16 v[184:187], a[160:163], a[216:219], v[184:187]
buffer_store_dwordx4 v[44:47], v13, s[8:11], s29 offen sc1
v_mfma_f32_16x16x32_bf16 v[188:191], a[160:163], a[220:223], v[188:191]
ds_read_b64_tr_b16 a[160:161], v5 offset:0
v_mfma_f32_16x16x32_bf16 v[192:195], a[164:167], a[192:195], v[192:195]
s_add_u32 s37, s31, 32768
ds_read_b64_tr_b16 a[162:163], v5 offset:1024
v_mfma_f32_16x16x32_bf16 v[196:199], a[164:167], a[196:199], v[196:199]
s_add_u32 m0, s33, 1024
ds_read_b128 a[236:239], v3 offset:5120
v_add_u32 v5, 16384, v5
v_mfma_f32_16x16x32_bf16 v[200:203], a[164:167], a[200:203], v[200:203]
buffer_load_dwordx4 v2, s[20:23], s37 offen  lds
v_and_b32 v5, 65535, v5
v_mfma_f32_16x16x32_bf16 v[204:207], a[164:167], a[204:207], v[204:207]
ds_read_b128 a[240:243], v4 offset:8192
v_mfma_f32_16x16x32_bf16 v[208:211], a[164:167], a[208:211], v[208:211]
v_mfma_f32_16x16x32_bf16 v[212:215], a[164:167], a[212:215], v[212:215]
ds_read_b128 a[244:247], v3 offset:9216
v_mfma_f32_16x16x32_bf16 v[216:219], a[164:167], a[216:219], v[216:219]
v_mfma_f32_16x16x32_bf16 v[220:223], a[164:167], a[220:223], v[220:223]
s_add_u32 s37, s31, 131072
ds_read_b64_tr_b16 a[164:165], v6 offset:0
v_mfma_f32_16x16x32_bf16 v[224:227], a[168:171], a[192:195], v[224:227]
s_add_u32 m0, s33, 4096
ds_read_b64_tr_b16 a[166:167], v6 offset:1024
v_mfma_f32_16x16x32_bf16 v[228:231], a[168:171], a[196:199], v[228:231]
buffer_load_dwordx4 v2, s[20:23], s37 offen  lds
v_xor_b32 v6, 16, v5
v_mfma_f32_16x16x32_bf16 v[232:235], a[168:171], a[200:203], v[232:235]
ds_read_b128 a[248:251], v4 offset:12288
v_mfma_f32_16x16x32_bf16 v[236:239], a[168:171], a[204:207], v[236:239]
v_mfma_f32_16x16x32_bf16 v[240:243], a[168:171], a[208:211], v[240:243]
ds_read_b128 a[252:255], v3 offset:13312
v_mfma_f32_16x16x32_bf16 v[244:247], a[168:171], a[212:215], v[244:247]
v_mfma_f32_16x16x32_bf16 v[248:251], a[168:171], a[216:219], v[248:251]
s_add_u32 s37, s31, 163840
ds_read_b64_tr_b16 v[28:29], v12 offset:0
v_mfma_f32_16x16x32_bf16 v[252:255], a[168:171], a[220:223], v[252:255]
s_add_u32 m0, s33, 5120
ds_read_b64_tr_b16 a[168:169], v7 offset:0
v_mfma_f32_16x16x32_bf16 a[0:3], a[172:175], a[192:195], a[0:3]
buffer_load_dwordx4 v2, s[20:23], s37 offen  lds
ds_read_b64_tr_b16 a[170:171], v7 offset:1024
v_mfma_f32_16x16x32_bf16 a[4:7], a[172:175], a[196:199], a[4:7]
s_add_u32 s31, s31, 262144
s_add_u32 s29, s29, s93
v_xor_b32 v7, 64, v5
v_mfma_f32_16x16x32_bf16 a[8:11], a[172:175], a[200:203], a[8:11]
s_add_u32 s33, s33, 16384
ds_read_b64_tr_b16 v[30:31], v12 offset:1024
v_mfma_f32_16x16x32_bf16 a[12:15], a[172:175], a[204:207], a[12:15]
s_and_b32 s33, s33, 65535
buffer_store_dwordx4 v[48:51], v13, s[8:11], s29 offen sc1
v_mfma_f32_16x16x32_bf16 a[16:19], a[172:175], a[208:211], a[16:19]
v_mfma_f32_16x16x32_bf16 a[20:23], a[172:175], a[212:215], a[20:23]
s_add_u32 s48, s48, s34
v_xor_b32 v12, 208, v5
v_mfma_f32_16x16x32_bf16 a[24:27], a[172:175], a[216:219], a[24:27]
s_add_u32 m0, s32, 16384
v_add_u32 v3, 32768, v3
v_mfma_f32_16x16x32_bf16 a[28:31], a[172:175], a[220:223], a[28:31]
buffer_load_dwordx4 v1, s[12:15], s48 offen lds
ds_read_b64_tr_b16 a[172:173], v8 offset:0
v_mfma_f32_16x16x32_bf16 a[32:35], a[176:179], a[192:195], a[32:35]
ds_read_b64_tr_b16 a[174:175], v8 offset:1024
v_subrev_u32 v19, 98304, v3
v_mfma_f32_16x16x32_bf16 a[36:39], a[176:179], a[196:199], a[36:39]
v_xor_b32 v8, 80, v5
v_cmp_le_u32 vcc, 163840, v3
v_mfma_f32_16x16x32_bf16 a[40:43], a[176:179], a[200:203], a[40:43]
s_nop 0
v_cndmask_b32 v3, v3, v19, vcc
v_mfma_f32_16x16x32_bf16 a[44:47], a[176:179], a[204:207], a[44:47]
v_xor_b32 v4, 64, v3
v_mfma_f32_16x16x32_bf16 a[48:51], a[176:179], a[208:211], a[48:51]
s_add_u32 s48, s48, s34
v_mfma_f32_16x16x32_bf16 a[52:55], a[176:179], a[212:215], a[52:55]
s_add_u32 m0, s32, 20480
v_mfma_f32_16x16x32_bf16 a[56:59], a[176:179], a[216:219], a[56:59]
buffer_load_dwordx4 v1, s[12:15], s48 offen lds
v_mfma_f32_16x16x32_bf16 a[60:63], a[176:179], a[220:223], a[60:63]
ds_read_b64_tr_b16 a[176:177], v9 offset:0
v_mfma_f32_16x16x32_bf16 a[64:67], a[180:183], a[192:195], a[64:67]
ds_read_b64_tr_b16 a[178:179], v9 offset:1024
v_mfma_f32_16x16x32_bf16 a[68:71], a[180:183], a[196:199], a[68:71]
v_xor_b32 v9, 128, v5
v_mfma_f32_16x16x32_bf16 a[72:75], a[180:183], a[200:203], a[72:75]
v_mfma_f32_16x16x32_bf16 a[76:79], a[180:183], a[204:207], a[76:79]
s_add_u32 s48, s48, s34
v_mfma_f32_16x16x32_bf16 a[80:83], a[180:183], a[208:211], a[80:83]
s_add_u32 m0, s32, 24576
v_mfma_f32_16x16x32_bf16 a[84:87], a[180:183], a[212:215], a[84:87]
buffer_load_dwordx4 v1, s[12:15], s48 offen lds
v_mfma_f32_16x16x32_bf16 a[88:91], a[180:183], a[216:219], a[88:91]
s_add_u32 s29, s29, s44
v_mfma_f32_16x16x32_bf16 a[92:95], a[180:183], a[220:223], a[92:95]
ds_read_b64_tr_b16 a[180:181], v10 offset:0
v_mfma_f32_16x16x32_bf16 a[96:99], a[184:187], a[192:195], a[96:99]
buffer_store_dwordx4 v[52:55], v13, s[8:11], s29 offen sc1
ds_read_b64_tr_b16 a[182:183], v10 offset:1024
v_mfma_f32_16x16x32_bf16 a[100:103], a[184:187], a[196:199], a[100:103]
v_xor_b32 v10, 144, v5
v_mfma_f32_16x16x32_bf16 a[104:107], a[184:187], a[200:203], a[104:107]
s_add_u32 s48, s48, s34
v_mfma_f32_16x16x32_bf16 a[108:111], a[184:187], a[204:207], a[108:111]
s_add_u32 m0, s32, 28672
v_mfma_f32_16x16x32_bf16 a[112:115], a[184:187], a[208:211], a[112:115]
buffer_load_dwordx4 v1, s[12:15], s48 offen lds
v_mfma_f32_16x16x32_bf16 a[116:119], a[184:187], a[212:215], a[116:119]
s_add_u32 s30, s30, 128
v_mfma_f32_16x16x32_bf16 a[120:123], a[184:187], a[216:219], a[120:123]
s_add_u32 s32, s32, 32768
v_mfma_f32_16x16x32_bf16 a[124:127], a[184:187], a[220:223], a[124:127]
s_sub_u32 s48, s32, 98304
ds_read_b64_tr_b16 a[184:185], v11 offset:0
v_mfma_f32_16x16x32_bf16 a[128:131], a[188:191], a[192:195], a[128:131]
s_cmp_ge_u32 s32, 163840
s_cselect_b32 s32, s48, s32
ds_read_b64_tr_b16 a[186:187], v11 offset:1024
v_mfma_f32_16x16x32_bf16 a[132:135], a[188:191], a[196:199], a[132:135]
v_xor_b32 v11, 192, v5
v_mfma_f32_16x16x32_bf16 a[136:139], a[188:191], a[200:203], a[136:139]
buffer_load_dword v15, v14, s[96:99], s100 offen
v_mfma_f32_16x16x32_bf16 a[140:143], a[188:191], a[204:207], a[140:143]
s_add_u32 s100, s100, 16384
v_mfma_f32_16x16x32_bf16 a[144:147], a[188:191], a[208:211], a[144:147]
v_mfma_f32_16x16x32_bf16 a[148:151], a[188:191], a[212:215], a[148:151]
v_mfma_f32_16x16x32_bf16 a[152:155], a[188:191], a[216:219], a[152:155]
v_mfma_f32_16x16x32_bf16 a[156:159], a[188:191], a[220:223], a[156:159]
s_waitcnt vmcnt(24) lgkmcnt(0)
s_barrier
v_mfma_f32_16x16x32_bf16 v[160:163], a[160:163], a[224:227], v[160:163]
ds_read_b128 a[192:195], v3 offset:0
v_mfma_f32_16x16x32_bf16 v[164:167], a[160:163], a[228:231], v[164:167]
s_add_u32 s37, s31, 0
v_mfma_f32_16x16x32_bf16 v[168:171], a[160:163], a[232:235], v[168:171]
s_add_u32 m0, s33, 0
ds_read_b128 a[196:199], v4 offset:1024
v_mfma_f32_16x16x32_bf16 v[172:175], a[160:163], a[236:239], v[172:175]
buffer_load_dwordx4 v2, s[20:23], s37 offen  lds
v_mfma_f32_16x16x32_bf16 v[176:179], a[160:163], a[240:243], v[176:179]
s_add_u32 s29, s29, s93
ds_read_b128 a[200:203], v3 offset:4096
v_mfma_f32_16x16x32_bf16 v[180:183], a[160:163], a[244:247], v[180:183]
v_mfma_f32_16x16x32_bf16 v[184:187], a[160:163], a[248:251], v[184:187]
buffer_store_dwordx4 v[56:59], v13, s[8:11], s29 offen sc1
v_mfma_f32_16x16x32_bf16 v[188:191], a[160:163], a[252:255], v[188:191]
ds_read_b64_tr_b16 a[160:161], v5 offset:0
v_mfma_f32_16x16x32_bf16 v[192:195], a[164:167], a[224:227], v[192:195]
s_add_u32 s37, s31, 32768
ds_read_b64_tr_b16 a[162:163], v5 offset:1024
v_mfma_f32_16x16x32_bf16 v[196:199], a[164:167], a[228:231], v[196:199]
s_add_u32 m0, s33, 1024
ds_read_b128 a[204:207], v4 offset:5120
v_add_u32 v5, 16384, v5
v_mfma_f32_16x16x32_bf16 v[200:203], a[164:167], a[232:235], v[200:203]
buffer_load_dwordx4 v2, s[20:23], s37 offen  lds
v_and_b32 v5, 65535, v5
v_mfma_f32_16x16x32_bf16 v[204:207], a[164:167], a[236:239], v[204:207]
ds_read_b128 a[208:211], v3 offset:8192
v_mfma_f32_16x16x32_bf16 v[208:211], a[164:167], a[240:243], v[208:211]
v_mfma_f32_16x16x32_bf16 v[212:215], a[164:167], a[244:247], v[212:215]
ds_read_b128 a[212:215], v4 offset:9216
v_mfma_f32_16x16x32_bf16 v[216:219], a[164:167], a[248:251], v[216:219]
v_mfma_f32_16x16x32_bf16 v[220:223], a[164:167], a[252:255], v[220:223]
s_add_u32 s37, s31, 131072
ds_read_b64_tr_b16 a[164:165], v6 offset:0
v_mfma_f32_16x16x32_bf16 v[224:227], a[168:171], a[224:227], v[224:227]
s_add_u32 m0, s33, 4096
ds_read_b64_tr_b16 a[166:167], v6 offset:1024
v_mfma_f32_16x16x32_bf16 v[228:231], a[168:171], a[228:231], v[228:231]
buffer_load_dwordx4 v2, s[20:23], s37 offen  lds
v_xor_b32 v6, 16, v5
v_mfma_f32_16x16x32_bf16 v[232:235], a[168:171], a[232:235], v[232:235]
ds_read_b128 a[216:219], v3 offset:12288
v_mfma_f32_16x16x32_bf16 v[236:239], a[168:171], a[236:239], v[236:239]
v_mfma_f32_16x16x32_bf16 v[240:243], a[168:171], a[240:243], v[240:243]
ds_read_b128 a[220:223], v4 offset:13312
v_mfma_f32_16x16x32_bf16 v[244:247], a[168:171], a[244:247], v[244:247]
v_mfma_f32_16x16x32_bf16 v[248:251], a[168:171], a[248:251], v[248:251]
s_add_u32 s37, s31, 163840
ds_read_b64_tr_b16 a[188:189], v12 offset:0
v_mfma_f32_16x16x32_bf16 v[252:255], a[168:171], a[252:255], v[252:255]
s_add_u32 m0, s33, 5120
ds_read_b64_tr_b16 a[168:169], v7 offset:0
v_mfma_f32_16x16x32_bf16 a[0:3], a[172:175], a[224:227], a[0:3]
buffer_load_dwordx4 v2, s[20:23], s37 offen  lds
ds_read_b64_tr_b16 a[170:171], v7 offset:1024
v_mfma_f32_16x16x32_bf16 a[4:7], a[172:175], a[228:231], a[4:7]
s_add_u32 s31, s31, 262144
s_add_u32 s29, s29, s44
v_xor_b32 v7, 64, v5
v_mfma_f32_16x16x32_bf16 a[8:11], a[172:175], a[232:235], a[8:11]
s_add_u32 s33, s33, 16384
ds_read_b64_tr_b16 a[190:191], v12 offset:1024
v_mfma_f32_16x16x32_bf16 a[12:15], a[172:175], a[236:239], a[12:15]
s_and_b32 s33, s33, 65535
buffer_store_dwordx4 v[60:63], v13, s[8:11], s29 offen sc1
v_mfma_f32_16x16x32_bf16 a[16:19], a[172:175], a[240:243], a[16:19]
v_mfma_f32_16x16x32_bf16 a[20:23], a[172:175], a[244:247], a[20:23]
s_mov_b32 s48, s30
v_xor_b32 v12, 208, v5
v_mfma_f32_16x16x32_bf16 a[24:27], a[172:175], a[248:251], a[24:27]
s_add_u32 m0, s32, 0
v_mfma_f32_16x16x32_bf16 a[28:31], a[172:175], a[252:255], a[28:31]
buffer_load_dwordx4 v1, s[12:15], s48 offen lds
ds_read_b64_tr_b16 a[172:173], v8 offset:0
v_mfma_f32_16x16x32_bf16 a[32:35], a[176:179], a[224:227], a[32:35]
ds_read_b64_tr_b16 a[174:175], v8 offset:1024
v_mfma_f32_16x16x32_bf16 a[36:39], a[176:179], a[228:231], a[36:39]
v_xor_b32 v8, 80, v5
v_mfma_f32_16x16x32_bf16 a[40:43], a[176:179], a[232:235], a[40:43]
v_mfma_f32_16x16x32_bf16 a[44:47], a[176:179], a[236:239], a[44:47]
v_mfma_f32_16x16x32_bf16 a[48:51], a[176:179], a[240:243], a[48:51]
s_add_u32 s48, s48, s34
v_mfma_f32_16x16x32_bf16 a[52:55], a[176:179], a[244:247], a[52:55]
s_add_u32 m0, s32, 4096
v_mfma_f32_16x16x32_bf16 a[56:59], a[176:179], a[248:251], a[56:59]
buffer_load_dwordx4 v1, s[12:15], s48 offen lds
v_mfma_f32_16x16x32_bf16 a[60:63], a[176:179], a[252:255], a[60:63]
ds_read_b64_tr_b16 a[176:177], v9 offset:0
v_mfma_f32_16x16x32_bf16 a[64:67], a[180:183], a[224:227], a[64:67]
ds_read_b64_tr_b16 a[178:179], v9 offset:1024
v_mfma_f32_16x16x32_bf16 a[68:71], a[180:183], a[228:231], a[68:71]
v_xor_b32 v9, 128, v5
v_mfma_f32_16x16x32_bf16 a[72:75], a[180:183], a[232:235], a[72:75]
v_mfma_f32_16x16x32_bf16 a[76:79], a[180:183], a[236:239], a[76:79]
s_add_u32 s48, s48, s34
v_mfma_f32_16x16x32_bf16 a[80:83], a[180:183], a[240:243], a[80:83]
s_add_u32 m0, s32, 8192
v_mfma_f32_16x16x32_bf16 a[84:87], a[180:183], a[244:247], a[84:87]
buffer_load_dwordx4 v1, s[12:15], s48 offen lds
v_mfma_f32_16x16x32_bf16 a[88:91], a[180:183], a[248:251], a[88:91]
v_mfma_f32_16x16x32_bf16 a[92:95], a[180:183], a[252:255], a[92:95]
ds_read_b64_tr_b16 a[180:181], v10 offset:0
v_mfma_f32_16x16x32_bf16 a[96:99], a[184:187], a[224:227], a[96:99]
ds_read_b64_tr_b16 a[182:183], v10 offset:1024
v_mfma_f32_16x16x32_bf16 a[100:103], a[184:187], a[228:231], a[100:103]
v_xor_b32 v10, 144, v5
v_mfma_f32_16x16x32_bf16 a[104:107], a[184:187], a[232:235], a[104:107]
s_add_u32 s48, s48, s34
v_mfma_f32_16x16x32_bf16 a[108:111], a[184:187], a[236:239], a[108:111]
s_add_u32 m0, s32, 12288
v_mfma_f32_16x16x32_bf16 a[112:115], a[184:187], a[240:243], a[112:115]
buffer_load_dwordx4 v1, s[12:15], s48 offen lds
v_mfma_f32_16x16x32_bf16 a[116:119], a[184:187], a[244:247], a[116:119]
v_mfma_f32_16x16x32_bf16 a[120:123], a[184:187], a[248:251], a[120:123]
v_mfma_f32_16x16x32_bf16 a[124:127], a[184:187], a[252:255], a[124:127]
ds_read_b64_tr_b16 a[184:185], v11 offset:0
v_mfma_f32_16x16x32_bf16 a[128:131], v[28:31], a[224:227], a[128:131]
ds_read_b64_tr_b16 a[186:187], v11 offset:1024
v_mfma_f32_16x16x32_bf16 a[132:135], v[28:31], a[228:231], a[132:135]
v_xor_b32 v11, 192, v5
v_mfma_f32_16x16x32_bf16 a[136:139], v[28:31], a[232:235], a[136:139]
buffer_load_dword v15, v14, s[96:99], s100 offen
v_mfma_f32_16x16x32_bf16 a[140:143], v[28:31], a[236:239], a[140:143]
s_add_u32 s100, s100, 16384
v_mfma_f32_16x16x32_bf16 a[144:147], v[28:31], a[240:243], a[144:147]
v_mfma_f32_16x16x32_bf16 a[148:151], v[28:31], a[244:247], a[148:151]
v_mfma_f32_16x16x32_bf16 a[152:155], v[28:31], a[248:251], a[152:155]
v_mfma_f32_16x16x32_bf16 a[156:159], v[28:31], a[252:255], a[156:159]
s_waitcnt vmcnt(23) lgkmcnt(0)
s_barrier
v_mfma_f32_16x16x32_bf16 v[160:163], a[160:163], a[192:195], v[160:163]
ds_read_b128 a[224:227], v4 offset:0
v_mfma_f32_16x16x32_bf16 v[164:167], a[160:163], a[196:199], v[164:167]
s_add_u32 s37, s31, 0
v_mfma_f32_16x16x32_bf16 v[168:171], a[160:163], a[200:203], v[168:171]
s_add_u32 m0, s33, 0
ds_read_b128 a[228:231], v3 offset:1024
v_mfma_f32_16x16x32_bf16 v[172:175], a[160:163], a[204:207], v[172:175]
buffer_load_dwordx4 v2, s[20:23], s37 offen  lds
v_mfma_f32_16x16x32_bf16 v[176:179], a[160:163], a[208:211], v[176:179]
s_add_u32 s60, s60, s92
ds_read_b128 a[232:235], v4 offset:4096
v_mfma_f32_16x16x32_bf16 v[180:183], a[160:163], a[212:215], v[180:183]
s_mov_b32 s29, s60
v_mfma_f32_16x16x32_bf16 v[184:187], a[160:163], a[216:219], v[184:187]
buffer_store_dwordx4 v[64:67], v13, s[8:11], s29 offen sc1
v_mfma_f32_16x16x32_bf16 v[188:191], a[160:163], a[220:223], v[188:191]
ds_read_b64_tr_b16 a[160:161], v5 offset:0
v_mfma_f32_16x16x32_bf16 v[192:195], a[164:167], a[192:195], v[192:195]
s_add_u32 s37, s31, 32768
ds_read_b64_tr_b16 a[162:163], v5 offset:1024
v_mfma_f32_16x16x32_bf16 v[196:199], a[164:167], a[196:199], v[196:199]
s_add_u32 m0, s33, 1024
ds_read_b128 a[236:239], v3 offset:5120
v_add_u32 v5, 16384, v5
v_mfma_f32_16x16x32_bf16 v[200:203], a[164:167], a[200:203], v[200:203]
buffer_load_dwordx4 v2, s[20:23], s37 offen  lds
v_and_b32 v5, 65535, v5
v_mfma_f32_16x16x32_bf16 v[204:207], a[164:167], a[204:207], v[204:207]
ds_read_b128 a[240:243], v4 offset:8192
v_mfma_f32_16x16x32_bf16 v[208:211], a[164:167], a[208:211], v[208:211]
v_mfma_f32_16x16x32_bf16 v[212:215], a[164:167], a[212:215], v[212:215]
ds_read_b128 a[244:247], v3 offset:9216
v_mfma_f32_16x16x32_bf16 v[216:219], a[164:167], a[216:219], v[216:219]
v_mfma_f32_16x16x32_bf16 v[220:223], a[164:167], a[220:223], v[220:223]
s_add_u32 s37, s31, 131072
ds_read_b64_tr_b16 a[164:165], v6 offset:0
v_mfma_f32_16x16x32_bf16 v[224:227], a[168:171], a[192:195], v[224:227]
s_add_u32 m0, s33, 4096
ds_read_b64_tr_b16 a[166:167], v6 offset:1024
v_mfma_f32_16x16x32_bf16 v[228:231], a[168:171], a[196:199], v[228:231]
buffer_load_dwordx4 v2, s[20:23], s37 offen  lds
v_xor_b32 v6, 16, v5
v_mfma_f32_16x16x32_bf16 v[232:235], a[168:171], a[200:203], v[232:235]
ds_read_b128 a[248:251], v4 offset:12288
v_mfma_f32_16x16x32_bf16 v[236:239], a[168:171], a[204:207], v[236:239]
v_mfma_f32_16x16x32_bf16 v[240:243], a[168:171], a[208:211], v[240:243]
ds_read_b128 a[252:255], v3 offset:13312
v_mfma_f32_16x16x32_bf16 v[244:247], a[168:171], a[212:215], v[244:247]
v_mfma_f32_16x16x32_bf16 v[248:251], a[168:171], a[216:219], v[248:251]
s_add_u32 s37, s31, 163840
ds_read_b64_tr_b16 v[28:29], v12 offset:0
v_mfma_f32_16x16x32_bf16 v[252:255], a[168:171], a[220:223], v[252:255]
s_add_u32 m0, s33, 5120
ds_read_b64_tr_b16 a[168:169], v7 offset:0
v_mfma_f32_16x16x32_bf16 a[0:3], a[172:175], a[192:195], a[0:3]
buffer_load_dwordx4 v2, s[20:23], s37 offen  lds
ds_read_b64_tr_b16 a[170:171], v7 offset:1024
v_mfma_f32_16x16x32_bf16 a[4:7], a[172:175], a[196:199], a[4:7]
s_add_u32 s31, s31, 262144
s_add_u32 s29, s29, s44
v_xor_b32 v7, 64, v5
v_mfma_f32_16x16x32_bf16 a[8:11], a[172:175], a[200:203], a[8:11]
s_add_u32 s33, s33, 16384
ds_read_b64_tr_b16 v[30:31], v12 offset:1024
v_mfma_f32_16x16x32_bf16 a[12:15], a[172:175], a[204:207], a[12:15]
s_and_b32 s33, s33, 65535
buffer_store_dwordx4 v[68:71], v13, s[8:11], s29 offen sc1
v_mfma_f32_16x16x32_bf16 a[16:19], a[172:175], a[208:211], a[16:19]
v_mfma_f32_16x16x32_bf16 a[20:23], a[172:175], a[212:215], a[20:23]
s_add_u32 s48, s48, s34
v_xor_b32 v12, 208, v5
v_mfma_f32_16x16x32_bf16 a[24:27], a[172:175], a[216:219], a[24:27]
s_add_u32 m0, s32, 16384
v_add_u32 v3, 32768, v3
v_mfma_f32_16x16x32_bf16 a[28:31], a[172:175], a[220:223], a[28:31]
buffer_load_dwordx4 v1, s[12:15], s48 offen lds
ds_read_b64_tr_b16 a[172:173], v8 offset:0
v_mfma_f32_16x16x32_bf16 a[32:35], a[176:179], a[192:195], a[32:35]
ds_read_b64_tr_b16 a[174:175], v8 offset:1024
v_subrev_u32 v19, 98304, v3
v_mfma_f32_16x16x32_bf16 a[36:39], a[176:179], a[196:199], a[36:39]
v_xor_b32 v8, 80, v5
v_cmp_le_u32 vcc, 163840, v3
v_mfma_f32_16x16x32_bf16 a[40:43], a[176:179], a[200:203], a[40:43]
s_nop 0
v_cndmask_b32 v3, v3, v19, vcc
v_mfma_f32_16x16x32_bf16 a[44:47], a[176:179], a[204:207], a[44:47]
v_xor_b32 v4, 64, v3
v_mfma_f32_16x16x32_bf16 a[48:51], a[176:179], a[208:211], a[48:51]
s_add_u32 s48, s48, s34
v_mfma_f32_16x16x32_bf16 a[52:55], a[176:179], a[212:215], a[52:55]
s_add_u32 m0, s32, 20480
v_mfma_f32_16x16x32_bf16 a[56:59], a[176:179], a[216:219], a[56:59]
buffer_load_dwordx4 v1, s[12:15], s48 offen lds
v_mfma_f32_16x16x32_bf16 a[60:63], a[176:179], a[220:223], a[60:63]
ds_read_b64_tr_b16 a[176:177], v9 offset:0
v_mfma_f32_16x16x32_bf16 a[64:67], a[180:183], a[192:195], a[64:67]
ds_read_b64_tr_b16 a[178:179], v9 offset:1024
v_mfma_f32_16x16x32_bf16 a[68:71], a[180:183], a[196:199], a[68:71]
v_xor_b32 v9, 128, v5
v_mfma_f32_16x16x32_bf16 a[72:75], a[180:183], a[200:203], a[72:75]
v_mfma_f32_16x16x32_bf16 a[76:79], a[180:183], a[204:207], a[76:79]
s_add_u32 s48, s48, s34
v_mfma_f32_16x16x32_bf16 a[80:83], a[180:183], a[208:211], a[80:83]
s_add_u32 m0, s32, 24576
v_mfma_f32_16x16x32_bf16 a[84:87], a[180:183], a[212:215], a[84:87]
buffer_load_dwordx4 v1, s[12:15], s48 offen lds
v_mfma_f32_16x16x32_bf16 a[88:91], a[180:183], a[216:219], a[88:91]
s_add_u32 s29, s29, s93
v_mfma_f32_16x16x32_bf16 a[92:95], a[180:183], a[220:223], a[92:95]
ds_read_b64_tr_b16 a[180:181], v10 offset:0
v_mfma_f32_16x16x32_bf16 a[96:99], a[184:187], a[192:195], a[96:99]
buffer_store_dwordx4 v[72:75], v13, s[8:11], s29 offen sc1
ds_read_b64_tr_b16 a[182:183], v10 offset:1024
v_mfma_f32_16x16x32_bf16 a[100:103], a[184:187], a[196:199], a[100:103]
v_xor_b32 v10, 144, v5
v_mfma_f32_16x16x32_bf16 a[104:107], a[184:187], a[200:203], a[104:107]
s_add_u32 s48, s48, s34
v_mfma_f32_16x16x32_bf16 a[108:111], a[184:187], a[204:207], a[108:111]
s_add_u32 m0, s32, 28672
v_mfma_f32_16x16x32_bf16 a[112:115], a[184:187], a[208:211], a[112:115]
buffer_load_dwordx4 v1, s[12:15], s48 offen lds
v_mfma_f32_16x16x32_bf16 a[116:119], a[184:187], a[212:215], a[116:119]
s_add_u32 s30, s30, 128
v_mfma_f32_16x16x32_bf16 a[120:123], a[184:187], a[216:219], a[120:123]
s_add_u32 s32, s32, 32768
v_mfma_f32_16x16x32_bf16 a[124:127], a[184:187], a[220:223], a[124:127]
s_sub_u32 s48, s32, 98304
ds_read_b64_tr_b16 a[184:185], v11 offset:0
v_mfma_f32_16x16x32_bf16 a[128:131], a[188:191], a[192:195], a[128:131]
s_cmp_ge_u32 s32, 163840
s_cselect_b32 s32, s48, s32
ds_read_b64_tr_b16 a[186:187], v11 offset:1024
v_mfma_f32_16x16x32_bf16 a[132:135], a[188:191], a[196:199], a[132:135]
v_xor_b32 v11, 192, v5
v_mfma_f32_16x16x32_bf16 a[136:139], a[188:191], a[200:203], a[136:139]
buffer_load_dword v15, v14, s[96:99], s100 offen
v_mfma_f32_16x16x32_bf16 a[140:143], a[188:191], a[204:207], a[140:143]
s_add_u32 s100, s100, 16384
v_mfma_f32_16x16x32_bf16 a[144:147], a[188:191], a[208:211], a[144:147]
v_mfma_f32_16x16x32_bf16 a[148:151], a[188:191], a[212:215], a[148:151]
v_mfma_f32_16x16x32_bf16 a[152:155], a[188:191], a[216:219], a[152:155]
v_mfma_f32_16x16x32_bf16 a[156:159], a[188:191], a[220:223], a[156:159]
s_waitcnt vmcnt(23) lgkmcnt(0)
s_barrier
v_mfma_f32_16x16x32_bf16 v[160:163], a[160:163], a[224:227], v[160:163]
ds_read_b128 a[192:195], v3 offset:0
v_mfma_f32_16x16x32_bf16 v[164:167], a[160:163], a[228:231], v[164:167]
s_add_u32 s37, s31, 0
v_mfma_f32_16x16x32_bf16 v[168:171], a[160:163], a[232:235], v[168:171]
s_add_u32 m0, s33, 0
ds_read_b128 a[196:199], v4 offset:1024
v_mfma_f32_16x16x32_bf16 v[172:175], a[160:163], a[236:239], v[172:175]
buffer_load_dwordx4 v2, s[20:23], s37 offen  lds
v_mfma_f32_16x16x32_bf16 v[176:179], a[160:163], a[240:243], v[176:179]
s_add_u32 s29, s29, s44
ds_read_b128 a[200:203], v3 offset:4096
v_mfma_f32_16x16x32_bf16 v[180:183], a[160:163], a[244:247], v[180:183]
v_mfma_f32_16x16x32_bf16 v[184:187], a[160:163], a[248:251], v[184:187]
buffer_store_dwordx4 v[76:79], v13, s[8:11], s29 offen sc1
v_mfma_f32_16x16x32_bf16 v[188:191], a[160:163], a[252:255], v[188:191]
ds_read_b64_tr_b16 a[160:161], v5 offset:0
v_mfma_f32_16x16x32_bf16 v[192:195], a[164:167], a[224:227], v[192:195]
s_add_u32 s37, s31, 32768
ds_read_b64_tr_b16 a[162:163], v5 offset:1024
v_mfma_f32_16x16x32_bf16 v[196:199], a[164:167], a[228:231], v[196:199]
s_add_u32 m0, s33, 1024
ds_read_b128 a[204:207], v4 offset:5120
v_add_u32 v5, 16384, v5
v_mfma_f32_16x16x32_bf16 v[200:203], a[164:167], a[232:235], v[200:203]
buffer_load_dwordx4 v2, s[20:23], s37 offen  lds
v_and_b32 v5, 65535, v5
v_mfma_f32_16x16x32_bf16 v[204:207], a[164:167], a[236:239], v[204:207]
ds_read_b128 a[208:211], v3 offset:8192
v_mfma_f32_16x16x32_bf16 v[208:211], a[164:167], a[240:243], v[208:211]
v_mfma_f32_16x16x32_bf16 v[212:215], a[164:167], a[244:247], v[212:215]
ds_read_b128 a[212:215], v4 offset:9216
v_mfma_f32_16x16x32_bf16 v[216:219], a[164:167], a[248:251], v[216:219]
v_mfma_f32_16x16x32_bf16 v[220:223], a[164:167], a[252:255], v[220:223]
s_add_u32 s37, s31, 131072
ds_read_b64_tr_b16 a[164:165], v6 offset:0
v_mfma_f32_16x16x32_bf16 v[224:227], a[168:171], a[224:227], v[224:227]
s_add_u32 m0, s33, 4096
ds_read_b64_tr_b16 a[166:167], v6 offset:1024
v_mfma_f32_16x16x32_bf16 v[228:231], a[168:171], a[228:231], v[228:231]
buffer_load_dwordx4 v2, s[20:23], s37 offen  lds
v_xor_b32 v6, 16, v5
v_mfma_f32_16x16x32_bf16 v[232:235], a[168:171], a[232:235], v[232:235]
ds_read_b128 a[216:219], v3 offset:12288
v_mfma_f32_16x16x32_bf16 v[236:239], a[168:171], a[236:239], v[236:239]
v_mfma_f32_16x16x32_bf16 v[240:243], a[168:171], a[240:243], v[240:243]
ds_read_b128 a[220:223], v4 offset:13312
v_mfma_f32_16x16x32_bf16 v[244:247], a[168:171], a[244:247], v[244:247]
v_mfma_f32_16x16x32_bf16 v[248:251], a[168:171], a[248:251], v[248:251]
s_add_u32 s37, s31, 163840
ds_read_b64_tr_b16 a[188:189], v12 offset:0
v_mfma_f32_16x16x32_bf16 v[252:255], a[168:171], a[252:255], v[252:255]
s_add_u32 m0, s33, 5120
ds_read_b64_tr_b16 a[168:169], v7 offset:0
v_mfma_f32_16x16x32_bf16 a[0:3], a[172:175], a[224:227], a[0:3]
buffer_load_dwordx4 v2, s[20:23], s37 offen  lds
ds_read_b64_tr_b16 a[170:171], v7 offset:1024
v_mfma_f32_16x16x32_bf16 a[4:7], a[172:175], a[228:231], a[4:7]
s_add_u32 s31, s31, 262144
s_add_u32 s29, s29, s93
v_xor_b32 v7, 64, v5
v_mfma_f32_16x16x32_bf16 a[8:11], a[172:175], a[232:235], a[8:11]
s_add_u32 s33, s33, 16384
ds_read_b64_tr_b16 a[190:191], v12 offset:1024
v_mfma_f32_16x16x32_bf16 a[12:15], a[172:175], a[236:239], a[12:15]
s_and_b32 s33, s33, 65535
buffer_store_dwordx4 v[80:83], v13, s[8:11], s29 offen sc1
v_mfma_f32_16x16x32_bf16 a[16:19], a[172:175], a[240:243], a[16:19]
v_mfma_f32_16x16x32_bf16 a[20:23], a[172:175], a[244:247], a[20:23]
s_mov_b32 s48, s30
v_xor_b32 v12, 208, v5
v_mfma_f32_16x16x32_bf16 a[24:27], a[172:175], a[248:251], a[24:27]
s_add_u32 m0, s32, 0
v_mfma_f32_16x16x32_bf16 a[28:31], a[172:175], a[252:255], a[28:31]
buffer_load_dwordx4 v1, s[12:15], s48 offen lds
ds_read_b64_tr_b16 a[172:173], v8 offset:0
v_mfma_f32_16x16x32_bf16 a[32:35], a[176:179], a[224:227], a[32:35]
ds_read_b64_tr_b16 a[174:175], v8 offset:1024
v_mfma_f32_16x16x32_bf16 a[36:39], a[176:179], a[228:231], a[36:39]
v_xor_b32 v8, 80, v5
v_mfma_f32_16x16x32_bf16 a[40:43], a[176:179], a[232:235], a[40:43]
v_mfma_f32_16x16x32_bf16 a[44:47], a[176:179], a[236:239], a[44:47]
v_mfma_f32_16x16x32_bf16 a[48:51], a[176:179], a[240:243], a[48:51]
s_add_u32 s48, s48, s34
v_mfma_f32_16x16x32_bf16 a[52:55], a[176:179], a[244:247], a[52:55]
s_add_u32 m0, s32, 4096
v_mfma_f32_16x16x32_bf16 a[56:59], a[176:179], a[248:251], a[56:59]
buffer_load_dwordx4 v1, s[12:15], s48 offen lds
v_mfma_f32_16x16x32_bf16 a[60:63], a[176:179], a[252:255], a[60:63]
ds_read_b64_tr_b16 a[176:177], v9 offset:0
v_mfma_f32_16x16x32_bf16 a[64:67], a[180:183], a[224:227], a[64:67]
ds_read_b64_tr_b16 a[178:179], v9 offset:1024
v_mfma_f32_16x16x32_bf16 a[68:71], a[180:183], a[228:231], a[68:71]
v_xor_b32 v9, 128, v5
v_mfma_f32_16x16x32_bf16 a[72:75], a[180:183], a[232:235], a[72:75]
v_mfma_f32_16x16x32_bf16 a[76:79], a[180:183], a[236:239], a[76:79]
s_add_u32 s48, s48, s34
v_mfma_f32_16x16x32_bf16 a[80:83], a[180:183], a[240:243], a[80:83]
s_add_u32 m0, s32, 8192
v_mfma_f32_16x16x32_bf16 a[84:87], a[180:183], a[244:247], a[84:87]
buffer_load_dwordx4 v1, s[12:15], s48 offen lds
v_mfma_f32_16x16x32_bf16 a[88:91], a[180:183], a[248:251], a[88:91]
s_add_u32 s29, s29, s44
v_mfma_f32_16x16x32_bf16 a[92:95], a[180:183], a[252:255], a[92:95]
ds_read_b64_tr_b16 a[180:181], v10 offset:0
v_mfma_f32_16x16x32_bf16 a[96:99], a[184:187], a[224:227], a[96:99]
buffer_store_dwordx4 v[84:87], v13, s[8:11], s29 offen sc1
ds_read_b64_tr_b16 a[182:183], v10 offset:1024
v_mfma_f32_16x16x32_bf16 a[100:103], a[184:187], a[228:231], a[100:103]
v_xor_b32 v10, 144, v5
v_mfma_f32_16x16x32_bf16 a[104:107], a[184:187], a[232:235], a[104:107]
s_add_u32 s48, s48, s34
v_mfma_f32_16x16x32_bf16 a[108:111], a[184:187], a[236:239], a[108:111]
s_add_u32 m0, s32, 12288
v_mfma_f32_16x16x32_bf16 a[112:115], a[184:187], a[240:243], a[112:115]
buffer_load_dwordx4 v1, s[12:15], s48 offen lds
v_mfma_f32_16x16x32_bf16 a[116:119], a[184:187], a[244:247], a[116:119]
v_mfma_f32_16x16x32_bf16 a[120:123], a[184:187], a[248:251], a[120:123]
v_mfma_f32_16x16x32_bf16 a[124:127], a[184:187], a[252:255], a[124:127]
ds_read_b64_tr_b16 a[184:185], v11 offset:0
v_mfma_f32_16x16x32_bf16 a[128:131], v[28:31], a[224:227], a[128:131]
ds_read_b64_tr_b16 a[186:187], v11 offset:1024
v_mfma_f32_16x16x32_bf16 a[132:135], v[28:31], a[228:231], a[132:135]
v_xor_b32 v11, 192, v5
v_mfma_f32_16x16x32_bf16 a[136:139], v[28:31], a[232:235], a[136:139]
buffer_load_dword v15, v14, s[96:99], s100 offen
v_mfma_f32_16x16x32_bf16 a[140:143], v[28:31], a[236:239], a[140:143]
s_add_u32 s100, s100, 16384
v_mfma_f32_16x16x32_bf16 a[144:147], v[28:31], a[240:243], a[144:147]
v_mfma_f32_16x16x32_bf16 a[148:151], v[28:31], a[244:247], a[148:151]
v_mfma_f32_16x16x32_bf16 a[152:155], v[28:31], a[248:251], a[152:155]
v_mfma_f32_16x16x32_bf16 a[156:159], v[28:31], a[252:255], a[156:159]
s_waitcnt vmcnt(24) lgkmcnt(0)
s_barrier
v_mfma_f32_16x16x32_bf16 v[160:163], a[160:163], a[192:195], v[160:163]
ds_read_b128 a[224:227], v4 offset:0
v_mfma_f32_16x16x32_bf16 v[164:167], a[160:163], a[196:199], v[164:167]
s_add_u32 s37, s31, 0
v_mfma_f32_16x16x32_bf16 v[168:171], a[160:163], a[200:203], v[168:171]
s_add_u32 m0, s33, 0
ds_read_b128 a[228:231], v3 offset:1024
v_mfma_f32_16x16x32_bf16 v[172:175], a[160:163], a[204:207], v[172:175]
buffer_load_dwordx4 v2, s[20:23], s37 offen  lds
v_mfma_f32_16x16x32_bf16 v[176:179], a[160:163], a[208:211], v[176:179]
s_add_u32 s29, s29, s93
ds_read_b128 a[232:235], v4 offset:4096
v_mfma_f32_16x16x32_bf16 v[180:183], a[160:163], a[212:215], v[180:183]
v_mfma_f32_16x16x32_bf16 v[184:187], a[160:163], a[216:219], v[184:187]
buffer_store_dwordx4 v[88:91], v13, s[8:11], s29 offen sc1
v_mfma_f32_16x16x32_bf16 v[188:191], a[160:163], a[220:223], v[188:191]
ds_read_b64_tr_b16 a[160:161], v5 offset:0
v_mfma_f32_16x16x32_bf16 v[192:195], a[164:167], a[192:195], v[192:195]
s_add_u32 s37, s31, 32768
ds_read_b64_tr_b16 a[162:163], v5 offset:1024
v_mfma_f32_16x16x32_bf16 v[196:199], a[164:167], a[196:199], v[196:199]
s_add_u32 m0, s33, 1024
ds_read_b128 a[236:239], v3 offset:5120
v_add_u32 v5, 16384, v5
v_mfma_f32_16x16x32_bf16 v[200:203], a[164:167], a[200:203], v[200:203]
buffer_load_dwordx4 v2, s[20:23], s37 offen  lds
v_and_b32 v5, 65535, v5
v_mfma_f32_16x16x32_bf16 v[204:207], a[164:167], a[204:207], v[204:207]
ds_read_b128 a[240:243], v4 offset:8192
v_mfma_f32_16x16x32_bf16 v[208:211], a[164:167], a[208:211], v[208:211]
v_mfma_f32_16x16x32_bf16 v[212:215], a[164:167], a[212:215], v[212:215]
ds_read_b128 a[244:247], v3 offset:9216
v_mfma_f32_16x16x32_bf16 v[216:219], a[164:167], a[216:219], v[216:219]
v_mfma_f32_16x16x32_bf16 v[220:223], a[164:167], a[220:223], v[220:223]
s_add_u32 s37, s31, 131072
ds_read_b64_tr_b16 a[164:165], v6 offset:0
v_mfma_f32_16x16x32_bf16 v[224:227], a[168:171], a[192:195], v[224:227]
s_add_u32 m0, s33, 4096
ds_read_b64_tr_b16 a[166:167], v6 offset:1024
v_mfma_f32_16x16x32_bf16 v[228:231], a[168:171], a[196:199], v[228:231]
buffer_load_dwordx4 v2, s[20:23], s37 offen  lds
v_xor_b32 v6, 16, v5
v_mfma_f32_16x16x32_bf16 v[232:235], a[168:171], a[200:203], v[232:235]
ds_read_b128 a[248:251], v4 offset:12288
v_mfma_f32_16x16x32_bf16 v[236:239], a[168:171], a[204:207], v[236:239]
v_mfma_f32_16x16x32_bf16 v[240:243], a[168:171], a[208:211], v[240:243]
ds_read_b128 a[252:255], v3 offset:13312
v_mfma_f32_16x16x32_bf16 v[244:247], a[168:171], a[212:215], v[244:247]
v_mfma_f32_16x16x32_bf16 v[248:251], a[168:171], a[216:219], v[248:251]
s_add_u32 s37, s31, 163840
ds_read_b64_tr_b16 v[28:29], v12 offset:0
v_mfma_f32_16x16x32_bf16 v[252:255], a[168:171], a[220:223], v[252:255]
s_add_u32 m0, s33, 5120
ds_read_b64_tr_b16 a[168:169], v7 offset:0
v_mfma_f32_16x16x32_bf16 a[0:3], a[172:175], a[192:195], a[0:3]
buffer_load_dwordx4 v2, s[20:23], s37 offen  lds
ds_read_b64_tr_b16 a[170:171], v7 offset:1024
v_mfma_f32_16x16x32_bf16 a[4:7], a[172:175], a[196:199], a[4:7]
s_add_u32 s31, s31, 262144
s_add_u32 s29, s29, s44
v_xor_b32 v7, 64, v5
v_mfma_f32_16x16x32_bf16 a[8:11], a[172:175], a[200:203], a[8:11]
s_add_u32 s33, s33, 16384
ds_read_b64_tr_b16 v[30:31], v12 offset:1024
v_mfma_f32_16x16x32_bf16 a[12:15], a[172:175], a[204:207], a[12:15]
s_and_b32 s33, s33, 65535
buffer_store_dwordx4 v[92:95], v13, s[8:11], s29 offen sc1
v_mfma_f32_16x16x32_bf16 a[16:19], a[172:175], a[208:211], a[16:19]
v_mfma_f32_16x16x32_bf16 a[20:23], a[172:175], a[212:215], a[20:23]
s_add_u32 s48, s48, s34
v_xor_b32 v12, 208, v5
v_mfma_f32_16x16x32_bf16 a[24:27], a[172:175], a[216:219], a[24:27]
s_add_u32 m0, s32, 16384
v_add_u32 v3, 32768, v3
v_mfma_f32_16x16x32_bf16 a[28:31], a[172:175], a[220:223], a[28:31]
buffer_load_dwordx4 v1, s[12:15], s48 offen lds
ds_read_b64_tr_b16 a[172:173], v8 offset:0
v_mfma_f32_16x16x32_bf16 a[32:35], a[176:179], a[192:195], a[32:35]
ds_read_b64_tr_b16 a[174:175], v8 offset:1024
v_subrev_u32 v19, 98304, v3
v_mfma_f32_16x16x32_bf16 a[36:39], a[176:179], a[196:199], a[36:39]
v_xor_b32 v8, 80, v5
v_cmp_le_u32 vcc, 163840, v3
v_mfma_f32_16x16x32_bf16 a[40:43], a[176:179], a[200:203], a[40:43]
s_nop 0
v_cndmask_b32 v3, v3, v19, vcc
v_mfma_f32_16x16x32_bf16 a[44:47], a[176:179], a[204:207], a[44:47]
v_xor_b32 v4, 64, v3
v_mfma_f32_16x16x32_bf16 a[48:51], a[176:179], a[208:211], a[48:51]
s_add_u32 s48, s48, s34
v_mfma_f32_16x16x32_bf16 a[52:55], a[176:179], a[212:215], a[52:55]
s_add_u32 m0, s32, 20480
v_mfma_f32_16x16x32_bf16 a[56:59], a[176:179], a[216:219], a[56:59]
buffer_load_dwordx4 v1, s[12:15], s48 offen lds
v_mfma_f32_16x16x32_bf16 a[60:63], a[176:179], a[220:223], a[60:63]
ds_read_b64_tr_b16 a[176:177], v9 offset:0
v_mfma_f32_16x16x32_bf16 a[64:67], a[180:183], a[192:195], a[64:67]
ds_read_b64_tr_b16 a[178:179], v9 offset:1024
v_mfma_f32_16x16x32_bf16 a[68:71], a[180:183], a[196:199], a[68:71]
v_xor_b32 v9, 128, v5
v_mfma_f32_16x16x32_bf16 a[72:75], a[180:183], a[200:203], a[72:75]
v_mfma_f32_16x16x32_bf16 a[76:79], a[180:183], a[204:207], a[76:79]
s_add_u32 s48, s48, s34
v_mfma_f32_16x16x32_bf16 a[80:83], a[180:183], a[208:211], a[80:83]
s_add_u32 m0, s32, 24576
v_mfma_f32_16x16x32_bf16 a[84:87], a[180:183], a[212:215], a[84:87]
buffer_load_dwordx4 v1, s[12:15], s48 offen lds
v_mfma_f32_16x16x32_bf16 a[88:91], a[180:183], a[216:219], a[88:91]
v_mfma_f32_16x16x32_bf16 a[92:95], a[180:183], a[220:223], a[92:95]
ds_read_b64_tr_b16 a[180:181], v10 offset:0
v_mfma_f32_16x16x32_bf16 a[96:99], a[184:187], a[192:195], a[96:99]
ds_read_b64_tr_b16 a[182:183], v10 offset:1024
v_mfma_f32_16x16x32_bf16 a[100:103], a[184:187], a[196:199], a[100:103]
v_xor_b32 v10, 144, v5
v_mfma_f32_16x16x32_bf16 a[104:107], a[184:187], a[200:203], a[104:107]
s_add_u32 s48, s48, s34
v_mfma_f32_16x16x32_bf16 a[108:111], a[184:187], a[204:207], a[108:111]
s_add_u32 m0, s32, 28672
v_mfma_f32_16x16x32_bf16 a[112:115], a[184:187], a[208:211], a[112:115]
buffer_load_dwordx4 v1, s[12:15], s48 offen lds
v_mfma_f32_16x16x32_bf16 a[116:119], a[184:187], a[212:215], a[116:119]
s_add_u32 s30, s30, 128
v_mfma_f32_16x16x32_bf16 a[120:123], a[184:187], a[216:219], a[120:123]
s_add_u32 s32, s32, 32768
v_mfma_f32_16x16x32_bf16 a[124:127], a[184:187], a[220:223], a[124:127]
s_sub_u32 s48, s32, 98304
ds_read_b64_tr_b16 a[184:185], v11 offset:0
v_mfma_f32_16x16x32_bf16 a[128:131], a[188:191], a[192:195], a[128:131]
s_cmp_ge_u32 s32, 163840
s_cselect_b32 s32, s48, s32
ds_read_b64_tr_b16 a[186:187], v11 offset:1024
v_mfma_f32_16x16x32_bf16 a[132:135], a[188:191], a[196:199], a[132:135]
v_xor_b32 v11, 192, v5
v_mfma_f32_16x16x32_bf16 a[136:139], a[188:191], a[200:203], a[136:139]
buffer_load_dword v15, v14, s[96:99], s100 offen
v_mfma_f32_16x16x32_bf16 a[140:143], a[188:191], a[204:207], a[140:143]
s_add_u32 s100, s100, 16384
v_mfma_f32_16x16x32_bf16 a[144:147], a[188:191], a[208:211], a[144:147]
v_mfma_f32_16x16x32_bf16 a[148:151], a[188:191], a[212:215], a[148:151]
v_mfma_f32_16x16x32_bf16 a[152:155], a[188:191], a[216:219], a[152:155]
v_mfma_f32_16x16x32_bf16 a[156:159], a[188:191], a[220:223], a[156:159]
s_waitcnt vmcnt(23) lgkmcnt(0)
s_barrier
v_mfma_f32_16x16x32_bf16 v[160:163], a[160:163], a[224:227], v[160:163]
ds_read_b128 a[192:195], v3 offset:0
v_mfma_f32_16x16x32_bf16 v[164:167], a[160:163], a[228:231], v[164:167]
s_add_u32 s37, s31, 0
v_mfma_f32_16x16x32_bf16 v[168:171], a[160:163], a[232:235], v[168:171]
s_add_u32 m0, s33, 0
ds_read_b128 a[196:199], v4 offset:1024
v_mfma_f32_16x16x32_bf16 v[172:175], a[160:163], a[236:239], v[172:175]
buffer_load_dwordx4 v2, s[20:23], s37 offen  lds
v_mfma_f32_16x16x32_bf16 v[176:179], a[160:163], a[240:243], v[176:179]
s_add_u32 s60, s60, s92
ds_read_b128 a[200:203], v3 offset:4096
v_mfma_f32_16x16x32_bf16 v[180:183], a[160:163], a[244:247], v[180:183]
s_mov_b32 s29, s60
v_mfma_f32_16x16x32_bf16 v[184:187], a[160:163], a[248:251], v[184:187]
buffer_store_dwordx4 v[96:99], v13, s[8:11], s29 offen sc1
v_mfma_f32_16x16x32_bf16 v[188:191], a[160:163], a[252:255], v[188:191]
ds_read_b64_tr_b16 a[160:161], v5 offset:0
v_mfma_f32_16x16x32_bf16 v[192:195], a[164:167], a[224:227], v[192:195]
s_add_u32 s37, s31, 32768
ds_read_b64_tr_b16 a[162:163], v5 offset:1024
v_mfma_f32_16x16x32_bf16 v[196:199], a[164:167], a[228:231], v[196:199]
s_add_u32 m0, s33, 1024
ds_read_b128 a[204:207], v4 offset:5120
v_add_u32 v5, 16384, v5
v_mfma_f32_16x16x32_bf16 v[200:203], a[164:167], a[232:235], v[200:203]
buffer_load_dwordx4 v2, s[20:23], s37 offen  lds
v_and_b32 v5, 65535, v5
v_mfma_f32_16x16x32_bf16 v[204:207], a[164:167], a[236:239], v[204:207]
ds_read_b128 a[208:211], v3 offset:8192
v_mfma_f32_16x16x32_bf16 v[208:211], a[164:167], a[240:243], v[208:211]
v_mfma_f32_16x16x32_bf16 v[212:215], a[164:167], a[244:247], v[212:215]
ds_read_b128 a[212:215], v4 offset:9216
v_mfma_f32_16x16x32_bf16 v[216:219], a[164:167], a[248:251], v[216:219]
v_mfma_f32_16x16x32_bf16 v[220:223], a[164:167], a[252:255], v[220:223]
s_add_u32 s37, s31, 131072
ds_read_b64_tr_b16 a[164:165], v6 offset:0
v_mfma_f32_16x16x32_bf16 v[224:227], a[168:171], a[224:227], v[224:227]
s_add_u32 m0, s33, 4096
ds_read_b64_tr_b16 a[166:167], v6 offset:1024
v_mfma_f32_16x16x32_bf16 v[228:231], a[168:171], a[228:231], v[228:231]
buffer_load_dwordx4 v2, s[20:23], s37 offen  lds
v_xor_b32 v6, 16, v5
v_mfma_f32_16x16x32_bf16 v[232:235], a[168:171], a[232:235], v[232:235]
ds_read_b128 a[216:219], v3 offset:12288
v_mfma_f32_16x16x32_bf16 v[236:239], a[168:171], a[236:239], v[236:239]
v_mfma_f32_16x16x32_bf16 v[240:243], a[168:171], a[240:243], v[240:243]
ds_read_b128 a[220:223], v4 offset:13312
v_mfma_f32_16x16x32_bf16 v[244:247], a[168:171], a[244:247], v[244:247]
v_mfma_f32_16x16x32_bf16 v[248:251], a[168:171], a[248:251], v[248:251]
s_add_u32 s37, s31, 163840
ds_read_b64_tr_b16 a[188:189], v12 offset:0
v_mfma_f32_16x16x32_bf16 v[252:255], a[168:171], a[252:255], v[252:255]
s_add_u32 m0, s33, 5120
ds_read_b64_tr_b16 a[168:169], v7 offset:0
v_mfma_f32_16x16x32_bf16 a[0:3], a[172:175], a[224:227], a[0:3]
buffer_load_dwordx4 v2, s[20:23], s37 offen  lds
ds_read_b64_tr_b16 a[170:171], v7 offset:1024
v_mfma_f32_16x16x32_bf16 a[4:7], a[172:175], a[228:231], a[4:7]
s_add_u32 s31, s31, 262144
s_add_u32 s29, s29, s44
v_xor_b32 v7, 64, v5
v_mfma_f32_16x16x32_bf16 a[8:11], a[172:175], a[232:235], a[8:11]
s_add_u32 s33, s33, 16384
ds_read_b64_tr_b16 a[190:191], v12 offset:1024
v_mfma_f32_16x16x32_bf16 a[12:15], a[172:175], a[236:239], a[12:15]
s_and_b32 s33, s33, 65535
buffer_store_dwordx4 v[100:103], v13, s[8:11], s29 offen sc1
v_mfma_f32_16x16x32_bf16 a[16:19], a[172:175], a[240:243], a[16:19]
v_mfma_f32_16x16x32_bf16 a[20:23], a[172:175], a[244:247], a[20:23]
s_mov_b32 s48, s30
v_xor_b32 v12, 208, v5
v_mfma_f32_16x16x32_bf16 a[24:27], a[172:175], a[248:251], a[24:27]
s_add_u32 m0, s32, 0
v_mfma_f32_16x16x32_bf16 a[28:31], a[172:175], a[252:255], a[28:31]
buffer_load_dwordx4 v1, s[12:15], s48 offen lds
ds_read_b64_tr_b16 a[172:173], v8 offset:0
v_mfma_f32_16x16x32_bf16 a[32:35], a[176:179], a[224:227], a[32:35]
ds_read_b64_tr_b16 a[174:175], v8 offset:1024
v_mfma_f32_16x16x32_bf16 a[36:39], a[176:179], a[228:231], a[36:39]
v_xor_b32 v8, 80, v5
v_mfma_f32_16x16x32_bf16 a[40:43], a[176:179], a[232:235], a[40:43]
v_mfma_f32_16x16x32_bf16 a[44:47], a[176:179], a[236:239], a[44:47]
v_mfma_f32_16x16x32_bf16 a[48:51], a[176:179], a[240:243], a[48:51]
s_add_u32 s48, s48, s34
v_mfma_f32_16x16x32_bf16 a[52:55], a[176:179], a[244:247], a[52:55]
s_add_u32 m0, s32, 4096
v_mfma_f32_16x16x32_bf16 a[56:59], a[176:179], a[248:251], a[56:59]
buffer_load_dwordx4 v1, s[12:15], s48 offen lds
v_mfma_f32_16x16x32_bf16 a[60:63], a[176:179], a[252:255], a[60:63]
ds_read_b64_tr_b16 a[176:177], v9 offset:0
v_mfma_f32_16x16x32_bf16 a[64:67], a[180:183], a[224:227], a[64:67]
ds_read_b64_tr_b16 a[178:179], v9 offset:1024
v_mfma_f32_16x16x32_bf16 a[68:71], a[180:183], a[228:231], a[68:71]
v_xor_b32 v9, 128, v5
v_mfma_f32_16x16x32_bf16 a[72:75], a[180:183], a[232:235], a[72:75]
v_mfma_f32_16x16x32_bf16 a[76:79], a[180:183], a[236:239], a[76:79]
s_add_u32 s48, s48, s34
v_mfma_f32_16x16x32_bf16 a[80:83], a[180:183], a[240:243], a[80:83]
s_add_u32 m0, s32, 8192
v_mfma_f32_16x16x32_bf16 a[84:87], a[180:183], a[244:247], a[84:87]
buffer_load_dwordx4 v1, s[12:15], s48 offen lds
v_mfma_f32_16x16x32_bf16 a[88:91], a[180:183], a[248:251], a[88:91]
s_add_u32 s29, s29, s93
v_mfma_f32_16x16x32_bf16 a[92:95], a[180:183], a[252:255], a[92:95]
ds_read_b64_tr_b16 a[180:181], v10 offset:0
v_mfma_f32_16x16x32_bf16 a[96:99], a[184:187], a[224:227], a[96:99]
buffer_store_dwordx4 v[104:107], v13, s[8:11], s29 offen sc1
ds_read_b64_tr_b16 a[182:183], v10 offset:1024
v_mfma_f32_16x16x32_bf16 a[100:103], a[184:187], a[228:231], a[100:103]
v_xor_b32 v10, 144, v5
v_mfma_f32_16x16x32_bf16 a[104:107], a[184:187], a[232:235], a[104:107]
s_add_u32 s48, s48, s34
v_mfma_f32_16x16x32_bf16 a[108:111], a[184:187], a[236:239], a[108:111]
s_add_u32 m0, s32, 12288
v_mfma_f32_16x16x32_bf16 a[112:115], a[184:187], a[240:243], a[112:115]
buffer_load_dwordx4 v1, s[12:15], s48 offen lds
v_mfma_f32_16x16x32_bf16 a[116:119], a[184:187], a[244:247], a[116:119]
v_mfma_f32_16x16x32_bf16 a[120:123], a[184:187], a[248:251], a[120:123]
v_mfma_f32_16x16x32_bf16 a[124:127], a[184:187], a[252:255], a[124:127]
ds_read_b64_tr_b16 a[184:185], v11 offset:0
v_mfma_f32_16x16x32_bf16 a[128:131], v[28:31], a[224:227], a[128:131]
ds_read_b64_tr_b16 a[186:187], v11 offset:1024
v_mfma_f32_16x16x32_bf16 a[132:135], v[28:31], a[228:231], a[132:135]
v_xor_b32 v11, 192, v5
v_mfma_f32_16x16x32_bf16 a[136:139], v[28:31], a[232:235], a[136:139]
buffer_load_dword v15, v14, s[96:99], s100 offen
v_mfma_f32_16x16x32_bf16 a[140:143], v[28:31], a[236:239], a[140:143]
s_add_u32 s100, s100, 16384
v_mfma_f32_16x16x32_bf16 a[144:147], v[28:31], a[240:243], a[144:147]
v_mfma_f32_16x16x32_bf16 a[148:151], v[28:31], a[244:247], a[148:151]
v_mfma_f32_16x16x32_bf16 a[152:155], v[28:31], a[248:251], a[152:155]
v_mfma_f32_16x16x32_bf16 a[156:159], v[28:31], a[252:255], a[156:159]
s_waitcnt vmcnt(23) lgkmcnt(0)
s_barrier
v_mfma_f32_16x16x32_bf16 v[160:163], a[160:163], a[192:195], v[160:163]
ds_read_b128 a[224:227], v4 offset:0
v_mfma_f32_16x16x32_bf16 v[164:167], a[160:163], a[196:199], v[164:167]
s_add_u32 s37, s31, 0
v_mfma_f32_16x16x32_bf16 v[168:171], a[160:163], a[200:203], v[168:171]
s_add_u32 m0, s33, 0
ds_read_b128 a[228:231], v3 offset:1024
v_mfma_f32_16x16x32_bf16 v[172:175], a[160:163], a[204:207], v[172:175]
buffer_load_dwordx4 v2, s[20:23], s37 offen  lds
v_mfma_f32_16x16x32_bf16 v[176:179], a[160:163], a[208:211], v[176:179]
s_add_u32 s29, s29, s44
ds_read_b128 a[232:235], v4 offset:4096
v_mfma_f32_16x16x32_bf16 v[180:183], a[160:163], a[212:215], v[180:183]
v_mfma_f32_16x16x32_bf16 v[184:187], a[160:163], a[216:219], v[184:187]
buffer_store_dwordx4 v[108:111], v13, s[8:11], s29 offen sc1
v_mfma_f32_16x16x32_bf16 v[188:191], a[160:163], a[220:223], v[188:191]
ds_read_b64_tr_b16 a[160:161], v5 offset:0
v_mfma_f32_16x16x32_bf16 v[192:195], a[164:167], a[192:195], v[192:195]
s_add_u32 s37, s31, 32768
ds_read_b64_tr_b16 a[162:163], v5 offset:1024
v_mfma_f32_16x16x32_bf16 v[196:199], a[164:167], a[196:199], v[196:199]
s_add_u32 m0, s33, 1024
ds_read_b128 a[236:239], v3 offset:5120
v_add_u32 v5, 16384, v5
v_mfma_f32_16x16x32_bf16 v[200:203], a[164:167], a[200:203], v[200:203]
buffer_load_dwordx4 v2, s[20:23], s37 offen  lds
v_and_b32 v5, 65535, v5
v_mfma_f32_16x16x32_bf16 v[204:207], a[164:167], a[204:207], v[204:207]
ds_read_b128 a[240:243], v4 offset:8192
v_mfma_f32_16x16x32_bf16 v[208:211], a[164:167], a[208:211], v[208:211]
v_mfma_f32_16x16x32_bf16 v[212:215], a[164:167], a[212:215], v[212:215]
ds_read_b128 a[244:247], v3 offset:9216
v_mfma_f32_16x16x32_bf16 v[216:219], a[164:167], a[216:219], v[216:219]
v_mfma_f32_16x16x32_bf16 v[220:223], a[164:167], a[220:223], v[220:223]
s_add_u32 s37, s31, 131072
ds_read_b64_tr_b16 a[164:165], v6 offset:0
v_mfma_f32_16x16x32_bf16 v[224:227], a[168:171], a[192:195], v[224:227]
s_add_u32 m0, s33, 4096
ds_read_b64_tr_b16 a[166:167], v6 offset:1024
v_mfma_f32_16x16x32_bf16 v[228:231], a[168:171], a[196:199], v[228:231]
buffer_load_dwordx4 v2, s[20:23], s37 offen  lds
v_xor_b32 v6, 16, v5
v_mfma_f32_16x16x32_bf16 v[232:235], a[168:171], a[200:203], v[232:235]
ds_read_b128 a[248:251], v4 offset:12288
v_mfma_f32_16x16x32_bf16 v[236:239], a[168:171], a[204:207], v[236:239]
v_mfma_f32_16x16x32_bf16 v[240:243], a[168:171], a[208:211], v[240:243]
ds_read_b128 a[252:255], v3 offset:13312
v_mfma_f32_16x16x32_bf16 v[244:247], a[168:171], a[212:215], v[244:247]
v_mfma_f32_16x16x32_bf16 v[248:251], a[168:171], a[216:219], v[248:251]
s_add_u32 s37, s31, 163840
ds_read_b64_tr_b16 v[28:29], v12 offset:0
v_mfma_f32_16x16x32_bf16 v[252:255], a[168:171], a[220:223], v[252:255]
s_add_u32 m0, s33, 5120
ds_read_b64_tr_b16 a[168:169], v7 offset:0
v_mfma_f32_16x16x32_bf16 a[0:3], a[172:175], a[192:195], a[0:3]
buffer_load_dwordx4 v2, s[20:23], s37 offen  lds
ds_read_b64_tr_b16 a[170:171], v7 offset:1024
v_mfma_f32_16x16x32_bf16 a[4:7], a[172:175], a[196:199], a[4:7]
s_add_u32 s31, s31, 262144
s_add_u32 s29, s29, s93
v_xor_b32 v7, 64, v5
v_mfma_f32_16x16x32_bf16 a[8:11], a[172:175], a[200:203], a[8:11]
s_add_u32 s33, s33, 16384
ds_read_b64_tr_b16 v[30:31], v12 offset:1024
v_mfma_f32_16x16x32_bf16 a[12:15], a[172:175], a[204:207], a[12:15]
s_and_b32 s33, s33, 65535
buffer_store_dwordx4 v[112:115], v13, s[8:11], s29 offen sc1
v_mfma_f32_16x16x32_bf16 a[16:19], a[172:175], a[208:211], a[16:19]
v_mfma_f32_16x16x32_bf16 a[20:23], a[172:175], a[212:215], a[20:23]
s_add_u32 s48, s48, s34
v_xor_b32 v12, 208, v5
v_mfma_f32_16x16x32_bf16 a[24:27], a[172:175], a[216:219], a[24:27]
s_add_u32 m0, s32, 16384
v_add_u32 v3, 32768, v3
v_mfma_f32_16x16x32_bf16 a[28:31], a[172:175], a[220:223], a[28:31]
buffer_load_dwordx4 v1, s[12:15], s48 offen lds
ds_read_b64_tr_b16 a[172:173], v8 offset:0
v_mfma_f32_16x16x32_bf16 a[32:35], a[176:179], a[192:195], a[32:35]
ds_read_b64_tr_b16 a[174:175], v8 offset:1024
v_subrev_u32 v19, 98304, v3
v_mfma_f32_16x16x32_bf16 a[36:39], a[176:179], a[196:199], a[36:39]
v_xor_b32 v8, 80, v5
v_cmp_le_u32 vcc, 163840, v3
v_mfma_f32_16x16x32_bf16 a[40:43], a[176:179], a[200:203], a[40:43]
s_nop 0
v_cndmask_b32 v3, v3, v19, vcc
v_mfma_f32_16x16x32_bf16 a[44:47], a[176:179], a[204:207], a[44:47]
v_xor_b32 v4, 64, v3
v_mfma_f32_16x16x32_bf16 a[48:51], a[176:179], a[208:211], a[48:51]
s_add_u32 s48, s48, s34
v_mfma_f32_16x16x32_bf16 a[52:55], a[176:179], a[212:215], a[52:55]
s_add_u32 m0, s32, 20480
v_mfma_f32_16x16x32_bf16 a[56:59], a[176:179], a[216:219], a[56:59]
buffer_load_dwordx4 v1, s[12:15], s48 offen lds
v_mfma_f32_16x16x32_bf16 a[60:63], a[176:179], a[220:223], a[60:63]
ds_read_b64_tr_b16 a[176:177], v9 offset:0
v_mfma_f32_16x16x32_bf16 a[64:67], a[180:183], a[192:195], a[64:67]
ds_read_b64_tr_b16 a[178:179], v9 offset:1024
v_mfma_f32_16x16x32_bf16 a[68:71], a[180:183], a[196:199], a[68:71]
v_xor_b32 v9, 128, v5
v_mfma_f32_16x16x32_bf16 a[72:75], a[180:183], a[200:203], a[72:75]
v_mfma_f32_16x16x32_bf16 a[76:79], a[180:183], a[204:207], a[76:79]
s_add_u32 s48, s48, s34
v_mfma_f32_16x16x32_bf16 a[80:83], a[180:183], a[208:211], a[80:83]
s_add_u32 m0, s32, 24576
v_mfma_f32_16x16x32_bf16 a[84:87], a[180:183], a[212:215], a[84:87]
buffer_load_dwordx4 v1, s[12:15], s48 offen lds
v_mfma_f32_16x16x32_bf16 a[88:91], a[180:183], a[216:219], a[88:91]
s_add_u32 s29, s29, s44
v_mfma_f32_16x16x32_bf16 a[92:95], a[180:183], a[220:223], a[92:95]
ds_read_b64_tr_b16 a[180:181], v10 offset:0
v_mfma_f32_16x16x32_bf16 a[96:99], a[184:187], a[192:195], a[96:99]
buffer_store_dwordx4 v[116:119], v13, s[8:11], s29 offen sc1
ds_read_b64_tr_b16 a[182:183], v10 offset:1024
v_mfma_f32_16x16x32_bf16 a[100:103], a[184:187], a[196:199], a[100:103]
v_xor_b32 v10, 144, v5
v_mfma_f32_16x16x32_bf16 a[104:107], a[184:187], a[200:203], a[104:107]
s_add_u32 s48, s48, s34
v_mfma_f32_16x16x32_bf16 a[108:111], a[184:187], a[204:207], a[108:111]
s_add_u32 m0, s32, 28672
v_mfma_f32_16x16x32_bf16 a[112:115], a[184:187], a[208:211], a[112:115]
buffer_load_dwordx4 v1, s[12:15], s48 offen lds
v_mfma_f32_16x16x32_bf16 a[116:119], a[184:187], a[212:215], a[116:119]
s_add_u32 s30, s30, 128
v_mfma_f32_16x16x32_bf16 a[120:123], a[184:187], a[216:219], a[120:123]
s_add_u32 s32, s32, 32768
v_mfma_f32_16x16x32_bf16 a[124:127], a[184:187], a[220:223], a[124:127]
s_sub_u32 s48, s32, 98304
ds_read_b64_tr_b16 a[184:185], v11 offset:0
v_mfma_f32_16x16x32_bf16 a[128:131], a[188:191], a[192:195], a[128:131]
s_cmp_ge_u32 s32, 163840
s_cselect_b32 s32, s48, s32
ds_read_b64_tr_b16 a[186:187], v11 offset:1024
v_mfma_f32_16x16x32_bf16 a[132:135], a[188:191], a[196:199], a[132:135]
v_xor_b32 v11, 192, v5
v_mfma_f32_16x16x32_bf16 a[136:139], a[188:191], a[200:203], a[136:139]
buffer_load_dword v15, v14, s[96:99], s100 offen
v_mfma_f32_16x16x32_bf16 a[140:143], a[188:191], a[204:207], a[140:143]
s_add_u32 s100, s100, 16384
v_mfma_f32_16x16x32_bf16 a[144:147], a[188:191], a[208:211], a[144:147]
v_mfma_f32_16x16x32_bf16 a[148:151], a[188:191], a[212:215], a[148:151]
v_mfma_f32_16x16x32_bf16 a[152:155], a[188:191], a[216:219], a[152:155]
v_mfma_f32_16x16x32_bf16 a[156:159], a[188:191], a[220:223], a[156:159]
s_waitcnt vmcnt(24) lgkmcnt(0)
s_barrier
v_mfma_f32_16x16x32_bf16 v[160:163], a[160:163], a[224:227], v[160:163]
ds_read_b128 a[192:195], v3 offset:0
v_mfma_f32_16x16x32_bf16 v[164:167], a[160:163], a[228:231], v[164:167]
s_add_u32 s37, s31, 0
v_mfma_f32_16x16x32_bf16 v[168:171], a[160:163], a[232:235], v[168:171]
s_add_u32 m0, s33, 0
ds_read_b128 a[196:199], v4 offset:1024
v_mfma_f32_16x16x32_bf16 v[172:175], a[160:163], a[236:239], v[172:175]
buffer_load_dwordx4 v2, s[20:23], s37 offen  lds
v_mfma_f32_16x16x32_bf16 v[176:179], a[160:163], a[240:243], v[176:179]
s_add_u32 s29, s29, s93
ds_read_b128 a[200:203], v3 offset:4096
v_mfma_f32_16x16x32_bf16 v[180:183], a[160:163], a[244:247], v[180:183]
v_mfma_f32_16x16x32_bf16 v[184:187], a[160:163], a[248:251], v[184:187]
buffer_store_dwordx4 v[120:123], v13, s[8:11], s29 offen sc1
v_mfma_f32_16x16x32_bf16 v[188:191], a[160:163], a[252:255], v[188:191]
ds_read_b64_tr_b16 a[160:161], v5 offset:0
v_mfma_f32_16x16x32_bf16 v[192:195], a[164:167], a[224:227], v[192:195]
s_add_u32 s37, s31, 32768
ds_read_b64_tr_b16 a[162:163], v5 offset:1024
v_mfma_f32_16x16x32_bf16 v[196:199], a[164:167], a[228:231], v[196:199]
s_add_u32 m0, s33, 1024
ds_read_b128 a[204:207], v4 offset:5120
v_add_u32 v5, 16384, v5
v_mfma_f32_16x16x32_bf16 v[200:203], a[164:167], a[232:235], v[200:203]
buffer_load_dwordx4 v2, s[20:23], s37 offen  lds
v_and_b32 v5, 65535, v5
v_mfma_f32_16x16x32_bf16 v[204:207], a[164:167], a[236:239], v[204:207]
ds_read_b128 a[208:211], v3 offset:8192
v_mfma_f32_16x16x32_bf16 v[208:211], a[164:167], a[240:243], v[208:211]
v_mfma_f32_16x16x32_bf16 v[212:215], a[164:167], a[244:247], v[212:215]
ds_read_b128 a[212:215], v4 offset:9216
v_mfma_f32_16x16x32_bf16 v[216:219], a[164:167], a[248:251], v[216:219]
v_mfma_f32_16x16x32_bf16 v[220:223], a[164:167], a[252:255], v[220:223]
s_add_u32 s37, s31, 131072
ds_read_b64_tr_b16 a[164:165], v6 offset:0
v_mfma_f32_16x16x32_bf16 v[224:227], a[168:171], a[224:227], v[224:227]
s_add_u32 m0, s33, 4096
ds_read_b64_tr_b16 a[166:167], v6 offset:1024
v_mfma_f32_16x16x32_bf16 v[228:231], a[168:171], a[228:231], v[228:231]
buffer_load_dwordx4 v2, s[20:23], s37 offen  lds
v_xor_b32 v6, 16, v5
v_mfma_f32_16x16x32_bf16 v[232:235], a[168:171], a[232:235], v[232:235]
ds_read_b128 a[216:219], v3 offset:12288
v_mfma_f32_16x16x32_bf16 v[236:239], a[168:171], a[236:239], v[236:239]
v_mfma_f32_16x16x32_bf16 v[240:243], a[168:171], a[240:243], v[240:243]
ds_read_b128 a[220:223], v4 offset:13312
v_mfma_f32_16x16x32_bf16 v[244:247], a[168:171], a[244:247], v[244:247]
v_mfma_f32_16x16x32_bf16 v[248:251], a[168:171], a[248:251], v[248:251]
s_add_u32 s37, s31, 163840
ds_read_b64_tr_b16 a[188:189], v12 offset:0
v_mfma_f32_16x16x32_bf16 v[252:255], a[168:171], a[252:255], v[252:255]
s_add_u32 m0, s33, 5120
ds_read_b64_tr_b16 a[168:169], v7 offset:0
v_mfma_f32_16x16x32_bf16 a[0:3], a[172:175], a[224:227], a[0:3]
buffer_load_dwordx4 v2, s[20:23], s37 offen  lds
ds_read_b64_tr_b16 a[170:171], v7 offset:1024
v_mfma_f32_16x16x32_bf16 a[4:7], a[172:175], a[228:231], a[4:7]
s_add_u32 s31, s31, 262144
s_add_u32 s29, s29, s44
v_xor_b32 v7, 64, v5
v_mfma_f32_16x16x32_bf16 a[8:11], a[172:175], a[232:235], a[8:11]
s_add_u32 s33, s33, 16384
ds_read_b64_tr_b16 a[190:191], v12 offset:1024
v_mfma_f32_16x16x32_bf16 a[12:15], a[172:175], a[236:239], a[12:15]
s_and_b32 s33, s33, 65535
buffer_store_dwordx4 v[124:127], v13, s[8:11], s29 offen sc1
v_mfma_f32_16x16x32_bf16 a[16:19], a[172:175], a[240:243], a[16:19]
v_mfma_f32_16x16x32_bf16 a[20:23], a[172:175], a[244:247], a[20:23]
s_mov_b32 s48, s30
v_xor_b32 v12, 208, v5
v_mfma_f32_16x16x32_bf16 a[24:27], a[172:175], a[248:251], a[24:27]
s_add_u32 m0, s32, 0
v_mfma_f32_16x16x32_bf16 a[28:31], a[172:175], a[252:255], a[28:31]
buffer_load_dwordx4 v1, s[12:15], s48 offen lds
ds_read_b64_tr_b16 a[172:173], v8 offset:0
v_mfma_f32_16x16x32_bf16 a[32:35], a[176:179], a[224:227], a[32:35]
ds_read_b64_tr_b16 a[174:175], v8 offset:1024
v_mfma_f32_16x16x32_bf16 a[36:39], a[176:179], a[228:231], a[36:39]
v_xor_b32 v8, 80, v5
v_mfma_f32_16x16x32_bf16 a[40:43], a[176:179], a[232:235], a[40:43]
v_mfma_f32_16x16x32_bf16 a[44:47], a[176:179], a[236:239], a[44:47]
v_mfma_f32_16x16x32_bf16 a[48:51], a[176:179], a[240:243], a[48:51]
s_add_u32 s48, s48, s34
v_mfma_f32_16x16x32_bf16 a[52:55], a[176:179], a[244:247], a[52:55]
s_add_u32 m0, s32, 4096
v_mfma_f32_16x16x32_bf16 a[56:59], a[176:179], a[248:251], a[56:59]
buffer_load_dwordx4 v1, s[12:15], s48 offen lds
v_mfma_f32_16x16x32_bf16 a[60:63], a[176:179], a[252:255], a[60:63]
ds_read_b64_tr_b16 a[176:177], v9 offset:0
v_mfma_f32_16x16x32_bf16 a[64:67], a[180:183], a[224:227], a[64:67]
ds_read_b64_tr_b16 a[178:179], v9 offset:1024
v_mfma_f32_16x16x32_bf16 a[68:71], a[180:183], a[228:231], a[68:71]
v_xor_b32 v9, 128, v5
v_mfma_f32_16x16x32_bf16 a[72:75], a[180:183], a[232:235], a[72:75]
v_mfma_f32_16x16x32_bf16 a[76:79], a[180:183], a[236:239], a[76:79]
s_add_u32 s48, s48, s34
v_mfma_f32_16x16x32_bf16 a[80:83], a[180:183], a[240:243], a[80:83]
s_add_u32 m0, s32, 8192
v_mfma_f32_16x16x32_bf16 a[84:87], a[180:183], a[244:247], a[84:87]
buffer_load_dwordx4 v1, s[12:15], s48 offen lds
v_mfma_f32_16x16x32_bf16 a[88:91], a[180:183], a[248:251], a[88:91]
v_mfma_f32_16x16x32_bf16 a[92:95], a[180:183], a[252:255], a[92:95]
ds_read_b64_tr_b16 a[180:181], v10 offset:0
v_mfma_f32_16x16x32_bf16 a[96:99], a[184:187], a[224:227], a[96:99]
ds_read_b64_tr_b16 a[182:183], v10 offset:1024
v_mfma_f32_16x16x32_bf16 a[100:103], a[184:187], a[228:231], a[100:103]
v_xor_b32 v10, 144, v5
v_mfma_f32_16x16x32_bf16 a[104:107], a[184:187], a[232:235], a[104:107]
s_add_u32 s48, s48, s34
v_mfma_f32_16x16x32_bf16 a[108:111], a[184:187], a[236:239], a[108:111]
s_add_u32 m0, s32, 12288
v_mfma_f32_16x16x32_bf16 a[112:115], a[184:187], a[240:243], a[112:115]
buffer_load_dwordx4 v1, s[12:15], s48 offen lds
v_mfma_f32_16x16x32_bf16 a[116:119], a[184:187], a[244:247], a[116:119]
v_mfma_f32_16x16x32_bf16 a[120:123], a[184:187], a[248:251], a[120:123]
v_mfma_f32_16x16x32_bf16 a[124:127], a[184:187], a[252:255], a[124:127]
ds_read_b64_tr_b16 a[184:185], v11 offset:0
v_mfma_f32_16x16x32_bf16 a[128:131], v[28:31], a[224:227], a[128:131]
ds_read_b64_tr_b16 a[186:187], v11 offset:1024
v_mfma_f32_16x16x32_bf16 a[132:135], v[28:31], a[228:231], a[132:135]
v_xor_b32 v11, 192, v5
v_mfma_f32_16x16x32_bf16 a[136:139], v[28:31], a[232:235], a[136:139]
buffer_load_dword v15, v14, s[96:99], s100 offen
v_mfma_f32_16x16x32_bf16 a[140:143], v[28:31], a[236:239], a[140:143]
s_add_u32 s100, s100, 16384
v_mfma_f32_16x16x32_bf16 a[144:147], v[28:31], a[240:243], a[144:147]
v_mfma_f32_16x16x32_bf16 a[148:151], v[28:31], a[244:247], a[148:151]
v_mfma_f32_16x16x32_bf16 a[152:155], v[28:31], a[248:251], a[152:155]
v_mfma_f32_16x16x32_bf16 a[156:159], v[28:31], a[252:255], a[156:159]
s_cmp_eq_u32 s36, 0
s_cbranch_scc1 L_g_k12
s_waitcnt vmcnt(23) lgkmcnt(0)
s_barrier
v_mfma_f32_16x16x32_bf16 v[160:163], a[160:163], a[192:195], v[160:163]
ds_read_b128 a[224:227], v4 offset:0
v_mfma_f32_16x16x32_bf16 v[164:167], a[160:163], a[196:199], v[164:167]
s_add_u32 s37, s31, 0
v_mfma_f32_16x16x32_bf16 v[168:171], a[160:163], a[200:203], v[168:171]
s_add_u32 m0, s33, 0
ds_read_b128 a[228:231], v3 offset:1024
v_mfma_f32_16x16x32_bf16 v[172:175], a[160:163], a[204:207], v[172:175]
buffer_load_dwordx4 v2, s[20:23], s37 offen  lds
v_mfma_f32_16x16x32_bf16 v[176:179], a[160:163], a[208:211], v[176:179]
ds_read_b128 a[232:235], v4 offset:4096
v_mfma_f32_16x16x32_bf16 v[180:183], a[160:163], a[212:215], v[180:183]
v_mfma_f32_16x16x32_bf16 v[184:187], a[160:163], a[216:219], v[184:187]
ds_read_b128 a[236:239], v3 offset:5120
v_mfma_f32_16x16x32_bf16 v[188:191], a[160:163], a[220:223], v[188:191]
ds_read_b64_tr_b16 a[160:161], v5 offset:0
v_mfma_f32_16x16x32_bf16 v[192:195], a[164:167], a[192:195], v[192:195]
s_add_u32 s37, s31, 32768
ds_read_b64_tr_b16 a[162:163], v5 offset:1024
v_mfma_f32_16x16x32_bf16 v[196:199], a[164:167], a[196:199], v[196:199]
s_add_u32 m0, s33, 1024
ds_read_b128 a[240:243], v4 offset:8192
v_add_u32 v5, 16384, v5
v_mfma_f32_16x16x32_bf16 v[200:203], a[164:167], a[200:203], v[200:203]
buffer_load_dwordx4 v2, s[20:23], s37 offen  lds
v_and_b32 v5, 65535, v5
v_mfma_f32_16x16x32_bf16 v[204:207], a[164:167], a[204:207], v[204:207]
ds_read_b128 a[244:247], v3 offset:9216
v_mfma_f32_16x16x32_bf16 v[208:211], a[164:167], a[208:211], v[208:211]
v_mfma_f32_16x16x32_bf16 v[212:215], a[164:167], a[212:215], v[212:215]
ds_read_b128 a[248:251], v4 offset:12288
v_mfma_f32_16x16x32_bf16 v[216:219], a[164:167], a[216:219], v[216:219]
v_mfma_f32_16x16x32_bf16 v[220:223], a[164:167], a[220:223], v[220:223]
s_add_u32 s37, s31, 131072
ds_read_b64_tr_b16 a[164:165], v6 offset:0
v_mfma_f32_16x16x32_bf16 v[224:227], a[168:171], a[192:195], v[224:227]
s_add_u32 m0, s33, 4096
ds_read_b64_tr_b16 a[166:167], v6 offset:1024
v_mfma_f32_16x16x32_bf16 v[228:231], a[168:171], a[196:199], v[228:231]
buffer_load_dwordx4 v2, s[20:23], s37 offen  lds
v_xor_b32 v6, 16, v5
v_mfma_f32_16x16x32_bf16 v[232:235], a[168:171], a[200:203], v[232:235]
ds_read_b128 a[252:255], v3 offset:13312
v_mfma_f32_16x16x32_bf16 v[236:239], a[168:171], a[204:207], v[236:239]
v_mfma_f32_16x16x32_bf16 v[240:243], a[168:171], a[208:211], v[240:243]
ds_read_b64_tr_b16 v[28:29], v12 offset:0
v_mfma_f32_16x16x32_bf16 v[244:247], a[168:171], a[212:215], v[244:247]
v_mfma_f32_16x16x32_bf16 v[248:251], a[168:171], a[216:219], v[248:251]
s_add_u32 s37, s31, 163840
ds_read_b64_tr_b16 v[30:31], v12 offset:1024
v_mfma_f32_16x16x32_bf16 v[252:255], a[168:171], a[220:223], v[252:255]
s_add_u32 m0, s33, 5120
ds_read_b64_tr_b16 a[168:169], v7 offset:0
v_mfma_f32_16x16x32_bf16 a[0:3], a[172:175], a[192:195], a[0:3]
buffer_load_dwordx4 v2, s[20:23], s37 offen  lds
ds_read_b64_tr_b16 a[170:171], v7 offset:1024
v_mfma_f32_16x16x32_bf16 a[4:7], a[172:175], a[196:199], a[4:7]
s_add_u32 s31, s31, 262144
v_xor_b32 v7, 64, v5
v_xor_b32 v12, 208, v5
v_mfma_f32_16x16x32_bf16 a[8:11], a[172:175], a[200:203], a[8:11]
s_add_u32 s33, s33, 16384
v_add_u32 v3, 32768, v3
v_mfma_f32_16x16x32_bf16 a[12:15], a[172:175], a[204:207], a[12:15]
s_and_b32 s33, s33, 65535
v_subrev_u32 v19, 98304, v3
v_mfma_f32_16x16x32_bf16 a[16:19], a[172:175], a[208:211], a[16:19]
v_cmp_le_u32 vcc, 163840, v3
v_mfma_f32_16x16x32_bf16 a[20:23], a[172:175], a[212:215], a[20:23]
s_add_u32 s48, s48, s34
v_cndmask_b32 v3, v3, v19, vcc
v_mfma_f32_16x16x32_bf16 a[24:27], a[172:175], a[216:219], a[24:27]
s_add_u32 m0, s32, 16384
v_xor_b32 v4, 64, v3
v_mfma_f32_16x16x32_bf16 a[28:31], a[172:175], a[220:223], a[28:31]
buffer_load_dwordx4 v1, s[12:15], s48 offen lds
ds_read_b64_tr_b16 a[172:173], v8 offset:0
v_mfma_f32_16x16x32_bf16 a[32:35], a[176:179], a[192:195], a[32:35]
ds_read_b64_tr_b16 a[174:175], v8 offset:1024
v_mfma_f32_16x16x32_bf16 a[36:39], a[176:179], a[196:199], a[36:39]
v_xor_b32 v8, 80, v5
v_mfma_f32_16x16x32_bf16 a[40:43], a[176:179], a[200:203], a[40:43]
v_mfma_f32_16x16x32_bf16 a[44:47], a[176:179], a[204:207], a[44:47]
v_mfma_f32_16x16x32_bf16 a[48:51], a[176:179], a[208:211], a[48:51]
s_add_u32 s48, s48, s34
v_mfma_f32_16x16x32_bf16 a[52:55], a[176:179], a[212:215], a[52:55]
s_add_u32 m0, s32, 20480
v_mfma_f32_16x16x32_bf16 a[56:59], a[176:179], a[216:219], a[56:59]
buffer_load_dwordx4 v1, s[12:15], s48 offen lds
v_mfma_f32_16x16x32_bf16 a[60:63], a[176:179], a[220:223], a[60:63]
ds_read_b64_tr_b16 a[176:177], v9 offset:0
v_mfma_f32_16x16x32_bf16 a[64:67], a[180:183], a[192:195], a[64:67]
ds_read_b64_tr_b16 a[178:179], v9 offset:1024
v_mfma_f32_16x16x32_bf16 a[68:71], a[180:183], a[196:199], a[68:71]
v_xor_b32 v9, 128, v5
v_mfma_f32_16x16x32_bf16 a[72:75], a[180:183], a[200:203], a[72:75]
v_mfma_f32_16x16x32_bf16 a[76:79], a[180:183], a[204:207], a[76:79]
s_add_u32 s48, s48, s34
v_mfma_f32_16x16x32_bf16 a[80:83], a[180:183], a[208:211], a[80:83]
s_add_u32 m0, s32, 24576
v_mfma_f32_16x16x32_bf16 a[84:87], a[180:183], a[212:215], a[84:87]
buffer_load_dwordx4 v1, s[12:15], s48 offen lds
v_mfma_f32_16x16x32_bf16 a[88:91], a[180:183], a[216:219], a[88:91]
v_mfma_f32_16x16x32_bf16 a[92:95], a[180:183], a[220:223], a[92:95]
ds_read_b64_tr_b16 a[180:181], v10 offset:0
v_mfma_f32_16x16x32_bf16 a[96:99], a[184:187], a[192:195], a[96:99]
ds_read_b64_tr_b16 a[182:183], v10 offset:1024
v_mfma_f32_16x16x32_bf16 a[100:103], a[184:187], a[196:199], a[100:103]
v_xor_b32 v10, 144, v5
v_mfma_f32_16x16x32_bf16 a[104:107], a[184:187], a[200:203], a[104:107]
s_add_u32 s48, s48, s34
v_mfma_f32_16x16x32_bf16 a[108:111], a[184:187], a[204:207], a[108:111]
s_add_u32 m0, s32, 28672
v_mfma_f32_16x16x32_bf16 a[112:115], a[184:187], a[208:211], a[112:115]
buffer_load_dwordx4 v1, s[12:15], s48 offen lds
v_mfma_f32_16x16x32_bf16 a[116:119], a[184:187], a[212:215], a[116:119]
s_add_u32 s30, s30, 128
v_mfma_f32_16x16x32_bf16 a[120:123], a[184:187], a[216:219], a[120:123]
s_add_u32 s32, s32, 32768
v_mfma_f32_16x16x32_bf16 a[124:127], a[184:187], a[220:223], a[124:127]
s_sub_u32 s48, s32, 98304
ds_read_b64_tr_b16 a[184:185], v11 offset:0
v_mfma_f32_16x16x32_bf16 a[128:131], a[188:191], a[192:195], a[128:131]
s_cmp_ge_u32 s32, 163840
s_cselect_b32 s32, s48, s32
ds_read_b64_tr_b16 a[186:187], v11 offset:1024
v_mfma_f32_16x16x32_bf16 a[132:135], a[188:191], a[196:199], a[132:135]
v_xor_b32 v11, 192, v5
v_mfma_f32_16x16x32_bf16 a[136:139], a[188:191], a[200:203], a[136:139]
v_mfma_f32_16x16x32_bf16 a[140:143], a[188:191], a[204:207], a[140:143]
v_mfma_f32_16x16x32_bf16 a[144:147], a[188:191], a[208:211], a[144:147]
v_mfma_f32_16x16x32_bf16 a[148:151], a[188:191], a[212:215], a[148:151]
v_mfma_f32_16x16x32_bf16 a[152:155], a[188:191], a[216:219], a[152:155]
v_mfma_f32_16x16x32_bf16 a[156:159], a[188:191], a[220:223], a[156:159]
s_waitcnt vmcnt(19) lgkmcnt(0)
s_barrier
v_mfma_f32_16x16x32_bf16 v[160:163], a[160:163], a[224:227], v[160:163]
ds_read_b128 a[192:195], v3 offset:0
v_mfma_f32_16x16x32_bf16 v[164:167], a[160:163], a[228:231], v[164:167]
s_add_u32 s37, s31, 0
v_mfma_f32_16x16x32_bf16 v[168:171], a[160:163], a[232:235], v[168:171]
s_add_u32 m0, s33, 0
ds_read_b128 a[196:199], v4 offset:1024
v_mfma_f32_16x16x32_bf16 v[172:175], a[160:163], a[236:239], v[172:175]
buffer_load_dwordx4 v2, s[20:23], s37 offen  lds
v_mfma_f32_16x16x32_bf16 v[176:179], a[160:163], a[240:243], v[176:179]
ds_read_b128 a[200:203], v3 offset:4096
v_mfma_f32_16x16x32_bf16 v[180:183], a[160:163], a[244:247], v[180:183]
v_mfma_f32_16x16x32_bf16 v[184:187], a[160:163], a[248:251], v[184:187]
ds_read_b128 a[204:207], v4 offset:5120
v_mfma_f32_16x16x32_bf16 v[188:191], a[160:163], a[252:255], v[188:191]
ds_read_b64_tr_b16 a[160:161], v5 offset:0
v_mfma_f32_16x16x32_bf16 v[192:195], a[164:167], a[224:227], v[192:195]
s_add_u32 s37, s31, 32768
ds_read_b64_tr_b16 a[162:163], v5 offset:1024
v_mfma_f32_16x16x32_bf16 v[196:199], a[164:167], a[228:231], v[196:199]
s_add_u32 m0, s33, 1024
ds_read_b128 a[208:211], v3 offset:8192
v_add_u32 v5, 16384, v5
v_mfma_f32_16x16x32_bf16 v[200:203], a[164:167], a[232:235], v[200:203]
buffer_load_dwordx4 v2, s[20:23], s37 offen  lds
v_and_b32 v5, 65535, v5
v_mfma_f32_16x16x32_bf16 v[204:207], a[164:167], a[236:239], v[204:207]
ds_read_b128 a[212:215], v4 offset:9216
v_mfma_f32_16x16x32_bf16 v[208:211], a[164:167], a[240:243], v[208:211]
v_mfma_f32_16x16x32_bf16 v[212:215], a[164:167], a[244:247], v[212:215]
ds_read_b128 a[216:219], v3 offset:12288
v_mfma_f32_16x16x32_bf16 v[216:219], a[164:167], a[248:251], v[216:219]
v_mfma_f32_16x16x32_bf16 v[220:223], a[164:167], a[252:255], v[220:223]
s_add_u32 s37, s31, 131072
ds_read_b64_tr_b16 a[164:165], v6 offset:0
v_mfma_f32_16x16x32_bf16 v[224:227], a[168:171], a[224:227], v[224:227]
s_add_u32 m0, s33, 4096
ds_read_b64_tr_b16 a[166:167], v6 offset:1024
v_mfma_f32_16x16x32_bf16 v[228:231], a[168:171], a[228:231], v[228:231]
buffer_load_dwordx4 v2, s[20:23], s37 offen  lds
v_xor_b32 v6, 16, v5
v_mfma_f32_16x16x32_bf16 v[232:235], a[168:171], a[232:235], v[232:235]
ds_read_b128 a[220:223], v4 offset:13312
v_mfma_f32_16x16x32_bf16 v[236:239], a[168:171], a[236:239], v[236:239]
v_mfma_f32_16x16x32_bf16 v[240:243], a[168:171], a[240:243], v[240:243]
ds_read_b64_tr_b16 a[188:189], v12 offset:0
v_mfma_f32_16x16x32_bf16 v[244:247], a[168:171], a[244:247], v[244:247]
v_mfma_f32_16x16x32_bf16 v[248:251], a[168:171], a[248:251], v[248:251]
s_add_u32 s37, s31, 163840
ds_read_b64_tr_b16 a[190:191], v12 offset:1024
v_mfma_f32_16x16x32_bf16 v[252:255], a[168:171], a[252:255], v[252:255]
s_add_u32 m0, s33, 5120
ds_read_b64_tr_b16 a[168:169], v7 offset:0
v_mfma_f32_16x16x32_bf16 a[0:3], a[172:175], a[224:227], a[0:3]
buffer_load_dwordx4 v2, s[20:23], s37 offen  lds
ds_read_b64_tr_b16 a[170:171], v7 offset:1024
v_mfma_f32_16x16x32_bf16 a[4:7], a[172:175], a[228:231], a[4:7]
s_add_u32 s31, s31, 262144
v_xor_b32 v7, 64, v5
v_xor_b32 v12, 208, v5
v_mfma_f32_16x16x32_bf16 a[8:11], a[172:175], a[232:235], a[8:11]
s_add_u32 s33, s33, 16384
v_mfma_f32_16x16x32_bf16 a[12:15], a[172:175], a[236:239], a[12:15]
s_and_b32 s33, s33, 65535
v_mfma_f32_16x16x32_bf16 a[16:19], a[172:175], a[240:243], a[16:19]
v_mfma_f32_16x16x32_bf16 a[20:23], a[172:175], a[244:247], a[20:23]
s_mov_b32 s48, s30
v_mfma_f32_16x16x32_bf16 a[24:27], a[172:175], a[248:251], a[24:27]
s_add_u32 m0, s32, 0
v_mfma_f32_16x16x32_bf16 a[28:31], a[172:175], a[252:255], a[28:31]
buffer_load_dwordx4 v1, s[12:15], s48 offen lds
ds_read_b64_tr_b16 a[172:173], v8 offset:0
v_mfma_f32_16x16x32_bf16 a[32:35], a[176:179], a[224:227], a[32:35]
ds_read_b64_tr_b16 a[174:175], v8 offset:1024
v_mfma_f32_16x16x32_bf16 a[36:39], a[176:179], a[228:231], a[36:39]
v_xor_b32 v8, 80, v5
v_mfma_f32_16x16x32_bf16 a[40:43], a[176:179], a[232:235], a[40:43]
v_mfma_f32_16x16x32_bf16 a[44:47], a[176:179], a[236:239], a[44:47]
v_mfma_f32_16x16x32_bf16 a[48:51], a[176:179], a[240:243], a[48:51]
s_add_u32 s48, s48, s34
v_mfma_f32_16x16x32_bf16 a[52:55], a[176:179], a[244:247], a[52:55]
s_add_u32 m0, s32, 4096
v_mfma_f32_16x16x32_bf16 a[56:59], a[176:179], a[248:251], a[56:59]
buffer_load_dwordx4 v1, s[12:15], s48 offen lds
v_mfma_f32_16x16x32_bf16 a[60:63], a[176:179], a[252:255], a[60:63]
ds_read_b64_tr_b16 a[176:177], v9 offset:0
v_mfma_f32_16x16x32_bf16 a[64:67], a[180:183], a[224:227], a[64:67]
ds_read_b64_tr_b16 a[178:179], v9 offset:1024
v_mfma_f32_16x16x32_bf16 a[68:71], a[180:183], a[228:231], a[68:71]
v_xor_b32 v9, 128, v5
v_mfma_f32_16x16x32_bf16 a[72:75], a[180:183], a[232:235], a[72:75]
v_mfma_f32_16x16x32_bf16 a[76:79], a[180:183], a[236:239], a[76:79]
s_add_u32 s48, s48, s34
v_mfma_f32_16x16x32_bf16 a[80:83], a[180:183], a[240:243], a[80:83]
s_add_u32 m0, s32, 8192
v_mfma_f32_16x16x32_bf16 a[84:87], a[180:183], a[244:247], a[84:87]
buffer_load_dwordx4 v1, s[12:15], s48 offen lds
v_mfma_f32_16x16x32_bf16 a[88:91], a[180:183], a[248:251], a[88:91]
v_mfma_f32_16x16x32_bf16 a[92:95], a[180:183], a[252:255], a[92:95]
ds_read_b64_tr_b16 a[180:181], v10 offset:0
v_mfma_f32_16x16x32_bf16 a[96:99], a[184:187], a[224:227], a[96:99]
ds_read_b64_tr_b16 a[182:183], v10 offset:1024
v_mfma_f32_16x16x32_bf16 a[100:103], a[184:187], a[228:231], a[100:103]
v_xor_b32 v10, 144, v5
v_mfma_f32_16x16x32_bf16 a[104:107], a[184:187], a[232:235], a[104:107]
s_add_u32 s48, s48, s34
v_mfma_f32_16x16x32_bf16 a[108:111], a[184:187], a[236:239], a[108:111]
s_add_u32 m0, s32, 12288
v_mfma_f32_16x16x32_bf16 a[112:115], a[184:187], a[240:243], a[112:115]
buffer_load_dwordx4 v1, s[12:15], s48 offen lds
v_mfma_f32_16x16x32_bf16 a[116:119], a[184:187], a[244:247], a[116:119]
v_mfma_f32_16x16x32_bf16 a[120:123], a[184:187], a[248:251], a[120:123]
v_mfma_f32_16x16x32_bf16 a[124:127], a[184:187], a[252:255], a[124:127]
ds_read_b64_tr_b16 a[184:185], v11 offset:0
v_mfma_f32_16x16x32_bf16 a[128:131], v[28:31], a[224:227], a[128:131]
ds_read_b64_tr_b16 a[186:187], v11 offset:1024
v_mfma_f32_16x16x32_bf16 a[132:135], v[28:31], a[228:231], a[132:135]
v_xor_b32 v11, 192, v5
v_mfma_f32_16x16x32_bf16 a[136:139], v[28:31], a[232:235], a[136:139]
v_mfma_f32_16x16x32_bf16 a[140:143], v[28:31], a[236:239], a[140:143]
v_mfma_f32_16x16x32_bf16 a[144:147], v[28:31], a[240:243], a[144:147]
v_mfma_f32_16x16x32_bf16 a[148:151], v[28:31], a[244:247], a[148:151]
v_mfma_f32_16x16x32_bf16 a[152:155], v[28:31], a[248:251], a[152:155]
v_mfma_f32_16x16x32_bf16 a[156:159], v[28:31], a[252:255], a[156:159]
L_g_k12:
s_waitcnt vmcnt(16) lgkmcnt(0)
s_barrier
v_mfma_f32_16x16x32_bf16 v[160:163], a[160:163], a[192:195], v[160:163]
ds_read_b128 a[224:227], v4 offset:0
s_lshr_b32 s24, s16, 1
v_mfma_f32_16x16x32_bf16 v[164:167], a[160:163], a[196:199], v[164:167]
s_add_u32 s37, s31, 0
s_cmp_eq_u32 s35, 5
s_cselect_b32 s90, s24, s90
v_mfma_f32_16x16x32_bf16 v[168:171], a[160:163], a[200:203], v[168:171]
s_add_u32 m0, s33, 0
ds_read_b128 a[228:231], v3 offset:1024
s_lshl_b32 s24, s35, 2
v_mfma_f32_16x16x32_bf16 v[172:175], a[160:163], a[204:207], v[172:175]
buffer_load_dwordx4 v2, s[20:23], s37 offen  lds
s_lshr_b32 s26, s88, s24
v_mfma_f32_16x16x32_bf16 v[176:179], a[160:163], a[208:211], v[176:179]
s_add_u32 s60, s60, s92
ds_read_b128 a[232:235], v4 offset:4096
s_bfe_u32 s2, s26, 0x10003
v_mfma_f32_16x16x32_bf16 v[180:183], a[160:163], a[212:215], v[180:183]
s_mov_b32 s29, s60
s_and_b32 s26, s26, 7
s_or_b32 s40, s2, s61
v_mfma_f32_16x16x32_bf16 v[184:187], a[160:163], a[216:219], v[184:187]
buffer_store_dwordx4 v[128:131], v13, s[8:11], s29 offen sc1
s_lshr_b32 s24, s17, 1
v_mfma_f32_16x16x32_bf16 v[188:191], a[160:163], a[220:223], v[188:191]
ds_read_b64_tr_b16 a[160:161], v5 offset:0
v_mfma_f32_16x16x32_bf16 v[192:195], a[164:167], a[192:195], v[192:195]
s_add_u32 s37, s31, 32768
ds_read_b64_tr_b16 a[162:163], v5 offset:1024
v_mfma_f32_16x16x32_bf16 v[196:199], a[164:167], a[196:199], v[196:199]
s_add_u32 m0, s33, 1024
ds_read_b128 a[236:239], v3 offset:5120
v_add_u32 v5, 16384, v5
v_mfma_f32_16x16x32_bf16 v[200:203], a[164:167], a[200:203], v[200:203]
buffer_load_dwordx4 v2, s[20:23], s37 offen  lds
v_and_b32 v5, 65535, v5
v_mfma_f32_16x16x32_bf16 v[204:207], a[164:167], a[204:207], v[204:207]
ds_read_b128 a[240:243], v4 offset:8192
v_mfma_f32_16x16x32_bf16 v[208:211], a[164:167], a[208:211], v[208:211]
s_cmp_eq_u32 s2, 0
s_cselect_b32 s41, s24, 0
s_cselect_b32 s27, s89, s90
v_mfma_f32_16x16x32_bf16 v[212:215], a[164:167], a[212:215], v[212:215]
ds_read_b128 a[244:247], v3 offset:9216
s_sub_u32 s25, s24, s41
v_mfma_f32_16x16x32_bf16 v[216:219], a[164:167], a[216:219], v[216:219]
s_and_b32 s51, s41, s61
s_lshl_b32 s51, s51, 1
s_or_b32 s51, s51, s41
v_mfma_f32_16x16x32_bf16 v[220:223], a[164:167], a[220:223], v[220:223]
s_add_u32 s37, s31, 131072
ds_read_b64_tr_b16 a[164:165], v6 offset:0
s_lshl2_add_u32 s51, s2, s51
v_mfma_f32_16x16x32_bf16 v[224:227], a[168:171], a[192:195], v[224:227]
s_add_u32 m0, s33, 4096
ds_read_b64_tr_b16 a[166:167], v6 offset:1024
s_lshl_b32 s46, s27, s2
v_mfma_f32_16x16x32_bf16 v[228:231], a[168:171], a[196:199], v[228:231]
buffer_load_dwordx4 v2, s[20:23], s37 offen  lds
s_add_u32 s46, s46, s25
v_mfma_f32_16x16x32_bf16 v[232:235], a[168:171], a[200:203], v[232:235]
ds_read_b128 a[248:251], v4 offset:12288
s_lshl_b32 s46, s46, 8
v_mfma_f32_16x16x32_bf16 v[236:239], a[168:171], a[204:207], v[236:239]
s_lshl_b32 s47, s40, 7
s_add_u32 s47, s47, 1024
s_mul_i32 s101, s26, s47
v_mfma_f32_16x16x32_bf16 v[240:243], a[168:171], a[208:211], v[240:243]
ds_read_b128 a[252:255], v3 offset:13312
s_lshl_b32 s101, s101, 8
v_mfma_f32_16x16x32_bf16 v[244:247], a[168:171], a[212:215], v[244:247]
s_and_b32 s25, s17, 1
s_lshl1_add_u32 s42, s26, s25
s_lshl_b32 s42, s42, 7
v_mfma_f32_16x16x32_bf16 v[248:251], a[168:171], a[216:219], v[248:251]
s_add_u32 s37, s31, 163840
ds_read_b64_tr_b16 v[28:29], v12 offset:0
s_lshr_b32 s42, s42, s2
v_mfma_f32_16x16x32_bf16 v[252:255], a[168:171], a[220:223], v[252:255]
s_add_u32 m0, s33, 5120
ds_read_b64_tr_b16 a[168:169], v7 offset:0
s_add_u32 s42, s42, s27
v_mfma_f32_16x16x32_bf16 a[0:3], a[172:175], a[192:195], a[0:3]
buffer_load_dwordx4 v2, s[20:23], s37 offen  lds
ds_read_b64_tr_b16 a[170:171], v7 offset:1024
v_mfma_f32_16x16x32_bf16 a[4:7], a[172:175], a[196:199], a[4:7]
s_add_u32 s31, s31, 262144
s_add_u32 s29, s29, s44
s_lshl1_add_u32 s42, s42, s24
v_mfma_f32_16x16x32_bf16 a[8:11], a[172:175], a[200:203], a[8:11]
s_add_u32 s33, s33, 16384
ds_read_b64_tr_b16 v[30:31], v12 offset:1024
s_lshl_b32 s42, s42, 13
v_mfma_f32_16x16x32_bf16 a[12:15], a[172:175], a[204:207], a[12:15]
s_and_b32 s33, s33, 65535
buffer_store_dwordx4 v[132:135], v13, s[8:11], s29 offen sc1
s_lshl_b32 s43, s27, 5
v_mfma_f32_16x16x32_bf16 a[16:19], a[172:175], a[208:211], a[16:19]
s_add_u32 s43, s43, s26
s_lshl_b32 s43, s43, 2
s_lshl_b32 s24, s2, 1
v_mfma_f32_16x16x32_bf16 a[20:23], a[172:175], a[212:215], a[20:23]
s_add_u32 s48, s48, s34
s_add_u32 s24, s24, s61
s_lshl_b32 s24, s24, 2
v_mfma_f32_16x16x32_bf16 a[24:27], a[172:175], a[216:219], a[24:27]
s_add_u32 m0, s32, 16384
s_lshr_b32 s25, 0x8720, s24
s_and_b32 s25, s25, 15
v_mfma_f32_16x16x32_bf16 a[28:31], a[172:175], a[220:223], a[28:31]
buffer_load_dwordx4 v1, s[12:15], s48 offen lds
ds_read_b64_tr_b16 a[172:173], v8 offset:0
v_mfma_f32_16x16x32_bf16 a[32:35], a[176:179], a[192:195], a[32:35]
ds_read_b64_tr_b16 a[174:175], v8 offset:1024
s_lshl_b32 s25, s25, 24
v_mfma_f32_16x16x32_bf16 a[36:39], a[176:179], a[196:199], a[36:39]
s_add_u32 s42, s42, s25
s_lshr_b32 s25, 0x7604, s24
s_and_b32 s25, s25, 15
v_mfma_f32_16x16x32_bf16 a[40:43], a[176:179], a[200:203], a[40:43]
s_lshl_b32 s25, s25, 12
s_add_u32 s43, s43, s25
s_add_u32 s43, s43, 111149056
v_mfma_f32_16x16x32_bf16 a[44:47], a[176:179], a[204:207], a[44:47]
s_cmp_lt_u32 s35, s45
s_cselect_b32 s101, s101, 536870912
s_cselect_b32 s46, s46, 536870912
v_mfma_f32_16x16x32_bf16 a[48:51], a[176:179], a[208:211], a[48:51]
s_add_u32 s48, s48, s34
v_xor_b32 v6, 16, v5
v_xor_b32 v7, 64, v5
v_mfma_f32_16x16x32_bf16 a[52:55], a[176:179], a[212:215], a[52:55]
s_add_u32 m0, s32, 20480
v_xor_b32 v8, 80, v5
v_xor_b32 v12, 208, v5
v_mfma_f32_16x16x32_bf16 a[56:59], a[176:179], a[216:219], a[56:59]
buffer_load_dwordx4 v1, s[12:15], s48 offen lds
v_add_u32 v3, 32768, v3
v_mfma_f32_16x16x32_bf16 a[60:63], a[176:179], a[220:223], a[60:63]
ds_read_b64_tr_b16 a[176:177], v9 offset:0
v_subrev_u32 v19, 98304, v3
v_mfma_f32_16x16x32_bf16 a[64:67], a[180:183], a[192:195], a[64:67]
ds_read_b64_tr_b16 a[178:179], v9 offset:1024
v_cmp_le_u32 vcc, 163840, v3
v_mfma_f32_16x16x32_bf16 a[68:71], a[180:183], a[196:199], a[68:71]
v_xor_b32 v9, 128, v5
v_cndmask_b32 v3, v3, v19, vcc
v_mfma_f32_16x16x32_bf16 a[72:75], a[180:183], a[200:203], a[72:75]
v_xor_b32 v4, 64, v3
v_mfma_f32_16x16x32_bf16 a[76:79], a[180:183], a[204:207], a[76:79]
s_add_u32 s48, s48, s34
v_mfma_f32_16x16x32_bf16 a[80:83], a[180:183], a[208:211], a[80:83]
s_add_u32 m0, s32, 24576
v_mfma_f32_16x16x32_bf16 a[84:87], a[180:183], a[212:215], a[84:87]
buffer_load_dwordx4 v1, s[12:15], s48 offen lds
v_mfma_f32_16x16x32_bf16 a[88:91], a[180:183], a[216:219], a[88:91]
s_add_u32 s29, s29, s93
v_mfma_f32_16x16x32_bf16 a[92:95], a[180:183], a[220:223], a[92:95]
ds_read_b64_tr_b16 a[180:181], v10 offset:0
v_mfma_f32_16x16x32_bf16 a[96:99], a[184:187], a[192:195], a[96:99]
buffer_store_dwordx4 v[136:139], v13, s[8:11], s29 offen sc1
ds_read_b64_tr_b16 a[182:183], v10 offset:1024
v_mfma_f32_16x16x32_bf16 a[100:103], a[184:187], a[196:199], a[100:103]
v_xor_b32 v10, 144, v5
v_mfma_f32_16x16x32_bf16 a[104:107], a[184:187], a[200:203], a[104:107]
s_add_u32 s48, s48, s34
v_mfma_f32_16x16x32_bf16 a[108:111], a[184:187], a[204:207], a[108:111]
s_add_u32 m0, s32, 28672
v_mfma_f32_16x16x32_bf16 a[112:115], a[184:187], a[208:211], a[112:115]
buffer_load_dwordx4 v1, s[12:15], s48 offen lds
v_mfma_f32_16x16x32_bf16 a[116:119], a[184:187], a[212:215], a[116:119]
s_add_u32 s30, s30, 128
v_mfma_f32_16x16x32_bf16 a[120:123], a[184:187], a[216:219], a[120:123]
s_add_u32 s32, s32, 32768
v_mfma_f32_16x16x32_bf16 a[124:127], a[184:187], a[220:223], a[124:127]
s_sub_u32 s48, s32, 98304
ds_read_b64_tr_b16 a[184:185], v11 offset:0
v_mfma_f32_16x16x32_bf16 a[128:131], a[188:191], a[192:195], a[128:131]
s_cmp_ge_u32 s32, 163840
s_cselect_b32 s32, s48, s32
ds_read_b64_tr_b16 a[186:187], v11 offset:1024
v_mfma_f32_16x16x32_bf16 a[132:135], a[188:191], a[196:199], a[132:135]
v_xor_b32 v11, 192, v5
v_mfma_f32_16x16x32_bf16 a[136:139], a[188:191], a[200:203], a[136:139]
buffer_load_dword v15, v14, s[96:99], s100 offen
v_mfma_f32_16x16x32_bf16 a[140:143], a[188:191], a[204:207], a[140:143]
s_add_u32 s100, s100, 16384
v_mfma_f32_16x16x32_bf16 a[144:147], a[188:191], a[208:211], a[144:147]
v_mfma_f32_16x16x32_bf16 a[148:151], a[188:191], a[212:215], a[148:151]
v_mfma_f32_16x16x32_bf16 a[152:155], a[188:191], a[216:219], a[152:155]
v_mfma_f32_16x16x32_bf16 a[156:159], a[188:191], a[220:223], a[156:159]
s_waitcnt vmcnt(20) lgkmcnt(0)
s_barrier
v_mfma_f32_16x16x32_bf16 v[160:163], a[160:163], a[224:227], v[160:163]
ds_read_b128 a[192:195], v3 offset:0
v_mfma_f32_16x16x32_bf16 v[164:167], a[160:163], a[228:231], v[164:167]
s_add_u32 s37, s31, 0
s_cmp_eq_u32 s2, 0
s_cselect_b64 s[4:5], s[52:53], s[54:55]
v_mfma_f32_16x16x32_bf16 v[168:171], a[160:163], a[232:235], v[168:171]
s_add_u32 m0, s33, 0
ds_read_b128 a[196:199], v4 offset:1024
s_mov_b32 s12, s4
v_mfma_f32_16x16x32_bf16 v[172:175], a[160:163], a[236:239], v[172:175]
buffer_load_dwordx4 v2, s[20:23], s37 offen  lds
s_and_b32 s13, s5, 0xffff
v_mfma_f32_16x16x32_bf16 v[176:179], a[160:163], a[240:243], v[176:179]
s_add_u32 s29, s29, s44
ds_read_b128 a[200:203], v3 offset:4096
s_lshl_b32 s14, s47, 11
v_mfma_f32_16x16x32_bf16 v[180:183], a[160:163], a[244:247], v[180:183]
s_mov_b32 s15, 0x20000
s_mov_b32 s30, s101
v_lshrrev_b32 v16, 3, v0
v_mfma_f32_16x16x32_bf16 v[184:187], a[160:163], a[248:251], v[184:187]
buffer_store_dwordx4 v[140:143], v13, s[8:11], s29 offen sc1
v_mul_lo_u32 v16, v16, s47
v_mfma_f32_16x16x32_bf16 v[188:191], a[160:163], a[252:255], v[188:191]
ds_read_b64_tr_b16 a[160:161], v5 offset:0
v_and_b32 v1, 0x70, v1
v_mfma_f32_16x16x32_bf16 v[192:195], a[164:167], a[224:227], v[192:195]
s_add_u32 s37, s31, 32768
ds_read_b64_tr_b16 a[162:163], v5 offset:1024
v_add_u32 v1, v1, v16
v_mfma_f32_16x16x32_bf16 v[196:199], a[164:167], a[228:231], v[196:199]
s_add_u32 m0, s33, 1024
ds_read_b128 a[204:207], v4 offset:5120
s_lshl_b32 s34, s47, 5
v_mfma_f32_16x16x32_bf16 v[200:203], a[164:167], a[232:235], v[200:203]
buffer_load_dwordx4 v2, s[20:23], s37 offen  lds
v_add_u32 v5, 16384, v5
v_mfma_f32_16x16x32_bf16 v[204:207], a[164:167], a[236:239], v[204:207]
ds_read_b128 a[208:211], v3 offset:8192
v_and_b32 v5, 65535, v5
v_mfma_f32_16x16x32_bf16 v[208:211], a[164:167], a[240:243], v[208:211]
v_mfma_f32_16x16x32_bf16 v[212:215], a[164:167], a[244:247], v[212:215]
ds_read_b128 a[212:215], v4 offset:9216
v_mfma_f32_16x16x32_bf16 v[216:219], a[164:167], a[248:251], v[216:219]
v_mfma_f32_16x16x32_bf16 v[220:223], a[164:167], a[252:255], v[220:223]
s_add_u32 s37, s31, 131072
ds_read_b64_tr_b16 a[164:165], v6 offset:0
v_mfma_f32_16x16x32_bf16 v[224:227], a[168:171], a[224:227], v[224:227]
s_add_u32 m0, s33, 4096
ds_read_b64_tr_b16 a[166:167], v6 offset:1024
v_mfma_f32_16x16x32_bf16 v[228:231], a[168:171], a[228:231], v[228:231]
buffer_load_dwordx4 v2, s[20:23], s37 offen  lds
v_xor_b32 v6, 16, v5
v_mfma_f32_16x16x32_bf16 v[232:235], a[168:171], a[232:235], v[232:235]
ds_read_b128 a[216:219], v3 offset:12288
v_mfma_f32_16x16x32_bf16 v[236:239], a[168:171], a[236:239], v[236:239]
v_mfma_f32_16x16x32_bf16 v[240:243], a[168:171], a[240:243], v[240:243]
ds_read_b128 a[220:223], v4 offset:13312
v_mfma_f32_16x16x32_bf16 v[244:247], a[168:171], a[244:247], v[244:247]
v_mfma_f32_16x16x32_bf16 v[248:251], a[168:171], a[248:251], v[248:251]
s_add_u32 s37, s31, 163840
ds_read_b64_tr_b16 a[188:189], v12 offset:0
v_mfma_f32_16x16x32_bf16 v[252:255], a[168:171], a[252:255], v[252:255]
s_add_u32 m0, s33, 5120
ds_read_b64_tr_b16 a[168:169], v7 offset:0
v_mfma_f32_16x16x32_bf16 a[0:3], a[172:175], a[224:227], a[0:3]
buffer_load_dwordx4 v2, s[20:23], s37 offen  lds
ds_read_b64_tr_b16 a[170:171], v7 offset:1024
v_mfma_f32_16x16x32_bf16 a[4:7], a[172:175], a[228:231], a[4:7]
s_add_u32 s31, s31, 262144
s_add_u32 s29, s29, s93
v_xor_b32 v7, 64, v5
v_mfma_f32_16x16x32_bf16 a[8:11], a[172:175], a[232:235], a[8:11]
s_add_u32 s33, s33, 16384
ds_read_b64_tr_b16 a[190:191], v12 offset:1024
v_mfma_f32_16x16x32_bf16 a[12:15], a[172:175], a[236:239], a[12:15]
s_and_b32 s33, s33, 65535
buffer_store_dwordx4 v[144:147], v13, s[8:11], s29 offen sc1
v_mfma_f32_16x16x32_bf16 a[16:19], a[172:175], a[240:243], a[16:19]
v_mfma_f32_16x16x32_bf16 a[20:23], a[172:175], a[244:247], a[20:23]
s_mov_b32 s48, s30
v_xor_b32 v12, 208, v5
v_mfma_f32_16x16x32_bf16 a[24:27], a[172:175], a[248:251], a[24:27]
s_add_u32 m0, s32, 0
v_mfma_f32_16x16x32_bf16 a[28:31], a[172:175], a[252:255], a[28:31]
buffer_load_dwordx4 v1, s[12:15], s48 offen lds
ds_read_b64_tr_b16 a[172:173], v8 offset:0
v_mfma_f32_16x16x32_bf16 a[32:35], a[176:179], a[224:227], a[32:35]
ds_read_b64_tr_b16 a[174:175], v8 offset:1024
v_mfma_f32_16x16x32_bf16 a[36:39], a[176:179], a[228:231], a[36:39]
v_xor_b32 v8, 80, v5
v_mfma_f32_16x16x32_bf16 a[40:43], a[176:179], a[232:235], a[40:43]
v_mfma_f32_16x16x32_bf16 a[44:47], a[176:179], a[236:239], a[44:47]
v_mfma_f32_16x16x32_bf16 a[48:51], a[176:179], a[240:243], a[48:51]
s_add_u32 s48, s48, s34
v_mfma_f32_16x16x32_bf16 a[52:55], a[176:179], a[244:247], a[52:55]
s_add_u32 m0, s32, 4096
v_mfma_f32_16x16x32_bf16 a[56:59], a[176:179], a[248:251], a[56:59]
buffer_load_dwordx4 v1, s[12:15], s48 offen lds
v_mfma_f32_16x16x32_bf16 a[60:63], a[176:179], a[252:255], a[60:63]
ds_read_b64_tr_b16 a[176:177], v9 offset:0
v_mfma_f32_16x16x32_bf16 a[64:67], a[180:183], a[224:227], a[64:67]
ds_read_b64_tr_b16 a[178:179], v9 offset:1024
v_mfma_f32_16x16x32_bf16 a[68:71], a[180:183], a[228:231], a[68:71]
v_xor_b32 v9, 128, v5
v_mfma_f32_16x16x32_bf16 a[72:75], a[180:183], a[232:235], a[72:75]
v_mfma_f32_16x16x32_bf16 a[76:79], a[180:183], a[236:239], a[76:79]
s_add_u32 s48, s48, s34
v_mfma_f32_16x16x32_bf16 a[80:83], a[180:183], a[240:243], a[80:83]
s_add_u32 m0, s32, 8192
s_cmp_eq_u32 s2, 0
s_cselect_b64 s[4:5], s[6:7], s[18:19]
v_mfma_f32_16x16x32_bf16 a[84:87], a[180:183], a[244:247], a[84:87]
buffer_load_dwordx4 v1, s[12:15], s48 offen lds
s_mov_b32 s20, s4
v_mfma_f32_16x16x32_bf16 a[88:91], a[180:183], a[248:251], a[88:91]
s_add_u32 s29, s29, s44
s_and_b32 s21, s5, 0xffff
s_lshl_b32 s22, s47, 12
v_mfma_f32_16x16x32_bf16 a[92:95], a[180:183], a[252:255], a[92:95]
ds_read_b64_tr_b16 a[180:181], v10 offset:0
s_mov_b32 s23, 0x20000
v_mfma_f32_16x16x32_bf16 a[96:99], a[184:187], a[224:227], a[96:99]
buffer_store_dwordx4 v[148:151], v13, s[8:11], s29 offen sc1
ds_read_b64_tr_b16 a[182:183], v10 offset:1024
v_mfma_f32_16x16x32_bf16 a[100:103], a[184:187], a[228:231], a[100:103]
s_mov_b32 s31, s46
v_xor_b32 v10, 144, v5
v_mfma_f32_16x16x32_bf16 a[104:107], a[184:187], a[232:235], a[104:107]
s_add_u32 s48, s48, s34
v_mfma_f32_16x16x32_bf16 a[108:111], a[184:187], a[236:239], a[108:111]
s_add_u32 m0, s32, 12288
v_mfma_f32_16x16x32_bf16 a[112:115], a[184:187], a[240:243], a[112:115]
buffer_load_dwordx4 v1, s[12:15], s48 offen lds
v_mfma_f32_16x16x32_bf16 a[116:119], a[184:187], a[244:247], a[116:119]
v_mfma_f32_16x16x32_bf16 a[120:123], a[184:187], a[248:251], a[120:123]
v_mfma_f32_16x16x32_bf16 a[124:127], a[184:187], a[252:255], a[124:127]
ds_read_b64_tr_b16 a[184:185], v11 offset:0
v_mfma_f32_16x16x32_bf16 a[128:131], v[28:31], a[224:227], a[128:131]
ds_read_b64_tr_b16 a[186:187], v11 offset:1024
v_mfma_f32_16x16x32_bf16 a[132:135], v[28:31], a[228:231], a[132:135]
v_xor_b32 v11, 192, v5
v_mfma_f32_16x16x32_bf16 a[136:139], v[28:31], a[232:235], a[136:139]
buffer_load_dword v15, v14, s[96:99], s100 offen
v_mfma_f32_16x16x32_bf16 a[140:143], v[28:31], a[236:239], a[140:143]
s_add_u32 s100, s100, 16384
v_mfma_f32_16x16x32_bf16 a[144:147], v[28:31], a[240:243], a[144:147]
v_mfma_f32_16x16x32_bf16 a[148:151], v[28:31], a[244:247], a[148:151]
v_mfma_f32_16x16x32_bf16 a[152:155], v[28:31], a[248:251], a[152:155]
v_mfma_f32_16x16x32_bf16 a[156:159], v[28:31], a[252:255], a[156:159]
s_waitcnt vmcnt(24) lgkmcnt(0)
s_barrier
v_mfma_f32_16x16x32_bf16 v[160:163], a[160:163], a[192:195], v[160:163]
ds_read_b128 a[224:227], v4 offset:0
v_mfma_f32_16x16x32_bf16 v[164:167], a[160:163], a[196:199], v[164:167]
s_add_u32 s37, s31, 0
v_mfma_f32_16x16x32_bf16 v[168:171], a[160:163], a[200:203], v[168:171]
s_add_u32 m0, s33, 0
ds_read_b128 a[228:231], v3 offset:1024
v_mfma_f32_16x16x32_bf16 v[172:175], a[160:163], a[204:207], v[172:175]
buffer_load_dwordx4 v2, s[20:23], s37 offen  lds
v_mfma_f32_16x16x32_bf16 v[176:179], a[160:163], a[208:211], v[176:179]
s_add_u32 s29, s29, s93
ds_read_b128 a[232:235], v4 offset:4096
v_mfma_f32_16x16x32_bf16 v[180:183], a[160:163], a[212:215], v[180:183]
v_mfma_f32_16x16x32_bf16 v[184:187], a[160:163], a[216:219], v[184:187]
buffer_store_dwordx4 v[152:155], v13, s[8:11], s29 offen sc1
v_mfma_f32_16x16x32_bf16 v[188:191], a[160:163], a[220:223], v[188:191]
ds_read_b64_tr_b16 a[160:161], v5 offset:0
v_mfma_f32_16x16x32_bf16 v[192:195], a[164:167], a[192:195], v[192:195]
s_add_u32 s37, s31, 32768
ds_read_b64_tr_b16 a[162:163], v5 offset:1024
v_mfma_f32_16x16x32_bf16 v[196:199], a[164:167], a[196:199], v[196:199]
s_add_u32 m0, s33, 1024
ds_read_b128 a[236:239], v3 offset:5120
v_add_u32 v5, 16384, v5
v_mfma_f32_16x16x32_bf16 v[200:203], a[164:167], a[200:203], v[200:203]
buffer_load_dwordx4 v2, s[20:23], s37 offen  lds
v_and_b32 v5, 65535, v5
v_mfma_f32_16x16x32_bf16 v[204:207], a[164:167], a[204:207], v[204:207]
ds_read_b128 a[240:243], v4 offset:8192
v_mfma_f32_16x16x32_bf16 v[208:211], a[164:167], a[208:211], v[208:211]
v_mfma_f32_16x16x32_bf16 v[212:215], a[164:167], a[212:215], v[212:215]
ds_read_b128 a[244:247], v3 offset:9216
v_mfma_f32_16x16x32_bf16 v[216:219], a[164:167], a[216:219], v[216:219]
v_mfma_f32_16x16x32_bf16 v[220:223], a[164:167], a[220:223], v[220:223]
s_add_u32 s37, s31, 131072
ds_read_b64_tr_b16 a[164:165], v6 offset:0
v_mfma_f32_16x16x32_bf16 v[224:227], a[168:171], a[192:195], v[224:227]
s_add_u32 m0, s33, 4096
ds_read_b64_tr_b16 a[166:167], v6 offset:1024
v_mfma_f32_16x16x32_bf16 v[228:231], a[168:171], a[196:199], v[228:231]
buffer_load_dwordx4 v2, s[20:23], s37 offen  lds
v_xor_b32 v6, 16, v5
v_mfma_f32_16x16x32_bf16 v[232:235], a[168:171], a[200:203], v[232:235]
ds_read_b128 a[248:251], v4 offset:12288
v_mfma_f32_16x16x32_bf16 v[236:239], a[168:171], a[204:207], v[236:239]
v_mfma_f32_16x16x32_bf16 v[240:243], a[168:171], a[208:211], v[240:243]
ds_read_b128 a[252:255], v3 offset:13312
v_mfma_f32_16x16x32_bf16 v[244:247], a[168:171], a[212:215], v[244:247]
v_mfma_f32_16x16x32_bf16 v[248:251], a[168:171], a[216:219], v[248:251]
s_add_u32 s37, s31, 163840
ds_read_b64_tr_b16 v[28:29], v12 offset:0
v_mfma_f32_16x16x32_bf16 v[252:255], a[168:171], a[220:223], v[252:255]
s_add_u32 m0, s33, 5120
ds_read_b64_tr_b16 a[168:169], v7 offset:0
v_mfma_f32_16x16x32_bf16 a[0:3], a[172:175], a[192:195], a[0:3]
buffer_load_dwordx4 v2, s[20:23], s37 offen  lds
ds_read_b64_tr_b16 a[170:171], v7 offset:1024
v_mfma_f32_16x16x32_bf16 a[4:7], a[172:175], a[196:199], a[4:7]
s_add_u32 s31, s31, 262144
s_add_u32 s29, s29, s44
v_xor_b32 v7, 64, v5
v_mfma_f32_16x16x32_bf16 a[8:11], a[172:175], a[200:203], a[8:11]
s_add_u32 s33, s33, 16384
ds_read_b64_tr_b16 v[30:31], v12 offset:1024
v_mfma_f32_16x16x32_bf16 a[12:15], a[172:175], a[204:207], a[12:15]
s_and_b32 s33, s33, 65535
buffer_store_dwordx4 v[156:159], v13, s[8:11], s29 offen sc1
v_mfma_f32_16x16x32_bf16 a[16:19], a[172:175], a[208:211], a[16:19]
v_mfma_f32_16x16x32_bf16 a[20:23], a[172:175], a[212:215], a[20:23]
s_add_u32 s48, s48, s34
v_xor_b32 v12, 208, v5
v_mfma_f32_16x16x32_bf16 a[24:27], a[172:175], a[216:219], a[24:27]
s_add_u32 m0, s32, 16384
v_add_u32 v3, 32768, v3
v_mfma_f32_16x16x32_bf16 a[28:31], a[172:175], a[220:223], a[28:31]
buffer_load_dwordx4 v1, s[12:15], s48 offen lds
ds_read_b64_tr_b16 a[172:173], v8 offset:0
v_mfma_f32_16x16x32_bf16 a[32:35], a[176:179], a[192:195], a[32:35]
ds_read_b64_tr_b16 a[174:175], v8 offset:1024
v_subrev_u32 v19, 98304, v3
v_mfma_f32_16x16x32_bf16 a[36:39], a[176:179], a[196:199], a[36:39]
v_xor_b32 v8, 80, v5
v_cmp_le_u32 vcc, 163840, v3
v_mfma_f32_16x16x32_bf16 a[40:43], a[176:179], a[200:203], a[40:43]
s_nop 0
v_cndmask_b32 v3, v3, v19, vcc
v_mfma_f32_16x16x32_bf16 a[44:47], a[176:179], a[204:207], a[44:47]
v_xor_b32 v4, 64, v3
v_mfma_f32_16x16x32_bf16 a[48:51], a[176:179], a[208:211], a[48:51]
s_add_u32 s48, s48, s34
v_mfma_f32_16x16x32_bf16 a[52:55], a[176:179], a[212:215], a[52:55]
s_add_u32 m0, s32, 20480
v_mfma_f32_16x16x32_bf16 a[56:59], a[176:179], a[216:219], a[56:59]
buffer_load_dwordx4 v1, s[12:15], s48 offen lds
v_mfma_f32_16x16x32_bf16 a[60:63], a[176:179], a[220:223], a[60:63]
ds_read_b64_tr_b16 a[176:177], v9 offset:0
v_mfma_f32_16x16x32_bf16 a[64:67], a[180:183], a[192:195], a[64:67]
ds_read_b64_tr_b16 a[178:179], v9 offset:1024
v_mfma_f32_16x16x32_bf16 a[68:71], a[180:183], a[196:199], a[68:71]
v_xor_b32 v9, 128, v5
v_mfma_f32_16x16x32_bf16 a[72:75], a[180:183], a[200:203], a[72:75]
v_mfma_f32_16x16x32_bf16 a[76:79], a[180:183], a[204:207], a[76:79]
s_add_u32 s48, s48, s34
v_mfma_f32_16x16x32_bf16 a[80:83], a[180:183], a[208:211], a[80:83]
s_add_u32 m0, s32, 24576
v_mfma_f32_16x16x32_bf16 a[84:87], a[180:183], a[212:215], a[84:87]
buffer_load_dwordx4 v1, s[12:15], s48 offen lds
v_mfma_f32_16x16x32_bf16 a[88:91], a[180:183], a[216:219], a[88:91]
v_mfma_f32_16x16x32_bf16 a[92:95], a[180:183], a[220:223], a[92:95]
ds_read_b64_tr_b16 a[180:181], v10 offset:0
v_mfma_f32_16x16x32_bf16 a[96:99], a[184:187], a[192:195], a[96:99]
ds_read_b64_tr_b16 a[182:183], v10 offset:1024
v_mfma_f32_16x16x32_bf16 a[100:103], a[184:187], a[196:199], a[100:103]
v_xor_b32 v10, 144, v5
v_mfma_f32_16x16x32_bf16 a[104:107], a[184:187], a[200:203], a[104:107]
s_add_u32 s48, s48, s34
v_mfma_f32_16x16x32_bf16 a[108:111], a[184:187], a[204:207], a[108:111]
s_add_u32 m0, s32, 28672
v_mfma_f32_16x16x32_bf16 a[112:115], a[184:187], a[208:211], a[112:115]
buffer_load_dwordx4 v1, s[12:15], s48 offen lds
v_mfma_f32_16x16x32_bf16 a[116:119], a[184:187], a[212:215], a[116:119]
s_add_u32 s30, s30, 128
v_mfma_f32_16x16x32_bf16 a[120:123], a[184:187], a[216:219], a[120:123]
s_add_u32 s32, s32, 32768
v_mfma_f32_16x16x32_bf16 a[124:127], a[184:187], a[220:223], a[124:127]
s_sub_u32 s48, s32, 98304
ds_read_b64_tr_b16 a[184:185], v11 offset:0
v_mfma_f32_16x16x32_bf16 a[128:131], a[188:191], a[192:195], a[128:131]
s_cmp_ge_u32 s32, 163840
s_cselect_b32 s32, s48, s32
ds_read_b64_tr_b16 a[186:187], v11 offset:1024
v_mfma_f32_16x16x32_bf16 a[132:135], a[188:191], a[196:199], a[132:135]
v_xor_b32 v11, 192, v5
v_mfma_f32_16x16x32_bf16 a[136:139], a[188:191], a[200:203], a[136:139]
buffer_load_dword v15, v14, s[96:99], s100 offen
v_mfma_f32_16x16x32_bf16 a[140:143], a[188:191], a[204:207], a[140:143]
s_add_u32 s100, s100, 16384
v_mfma_f32_16x16x32_bf16 a[144:147], a[188:191], a[208:211], a[144:147]
v_mfma_f32_16x16x32_bf16 a[148:151], a[188:191], a[212:215], a[148:151]
v_mfma_f32_16x16x32_bf16 a[152:155], a[188:191], a[216:219], a[152:155]
v_mfma_f32_16x16x32_bf16 a[156:159], a[188:191], a[220:223], a[156:159]
s_waitcnt vmcnt(23) lgkmcnt(0)
s_barrier
v_mfma_f32_16x16x32_bf16 v[160:163], a[160:163], a[224:227], v[160:163]
ds_read_b128 a[192:195], v3 offset:0
v_mfma_f32_16x16x32_bf16 v[164:167], a[160:163], a[228:231], v[164:167]
s_add_u32 s37, s31, 0
v_mfma_f32_16x16x32_bf16 v[168:171], a[160:163], a[232:235], v[168:171]
s_add_u32 m0, s33, 0
ds_read_b128 a[196:199], v4 offset:1024
v_mfma_f32_16x16x32_bf16 v[172:175], a[160:163], a[236:239], v[172:175]
buffer_load_dwordx4 v2, s[20:23], s37 offen  lds
v_mfma_f32_16x16x32_bf16 v[176:179], a[160:163], a[240:243], v[176:179]
ds_read_b128 a[200:203], v3 offset:4096
v_mfma_f32_16x16x32_bf16 v[180:183], a[160:163], a[244:247], v[180:183]
v_mfma_f32_16x16x32_bf16 v[184:187], a[160:163], a[248:251], v[184:187]
ds_read_b128 a[204:207], v4 offset:5120
v_mfma_f32_16x16x32_bf16 v[188:191], a[160:163], a[252:255], v[188:191]
ds_read_b64_tr_b16 a[160:161], v5 offset:0
v_mfma_f32_16x16x32_bf16 v[192:195], a[164:167], a[224:227], v[192:195]
s_add_u32 s37, s31, 32768
ds_read_b64_tr_b16 a[162:163], v5 offset:1024
v_mfma_f32_16x16x32_bf16 v[196:199], a[164:167], a[228:231], v[196:199]
s_add_u32 m0, s33, 1024
ds_read_b128 a[208:211], v3 offset:8192
v_add_u32 v5, 16384, v5
v_mfma_f32_16x16x32_bf16 v[200:203], a[164:167], a[232:235], v[200:203]
buffer_load_dwordx4 v2, s[20:23], s37 offen  lds
v_and_b32 v5, 65535, v5
v_mfma_f32_16x16x32_bf16 v[204:207], a[164:167], a[236:239], v[204:207]
ds_read_b128 a[212:215], v4 offset:9216
v_mfma_f32_16x16x32_bf16 v[208:211], a[164:167], a[240:243], v[208:211]
v_mfma_f32_16x16x32_bf16 v[212:215], a[164:167], a[244:247], v[212:215]
ds_read_b128 a[216:219], v3 offset:12288
v_mfma_f32_16x16x32_bf16 v[216:219], a[164:167], a[248:251], v[216:219]
v_mfma_f32_16x16x32_bf16 v[220:223], a[164:167], a[252:255], v[220:223]
s_add_u32 s37, s31, 131072
ds_read_b64_tr_b16 a[164:165], v6 offset:0
v_mfma_f32_16x16x32_bf16 v[224:227], a[168:171], a[224:227], v[224:227]
s_add_u32 m0, s33, 4096
ds_read_b64_tr_b16 a[166:167], v6 offset:1024
v_mfma_f32_16x16x32_bf16 v[228:231], a[168:171], a[228:231], v[228:231]
buffer_load_dwordx4 v2, s[20:23], s37 offen  lds
v_xor_b32 v6, 16, v5
v_mfma_f32_16x16x32_bf16 v[232:235], a[168:171], a[232:235], v[232:235]
ds_read_b128 a[220:223], v4 offset:13312
v_mfma_f32_16x16x32_bf16 v[236:239], a[168:171], a[236:239], v[236:239]
v_mfma_f32_16x16x32_bf16 v[240:243], a[168:171], a[240:243], v[240:243]
ds_read_b64_tr_b16 a[188:189], v12 offset:0
v_mfma_f32_16x16x32_bf16 v[244:247], a[168:171], a[244:247], v[244:247]
v_mfma_f32_16x16x32_bf16 v[248:251], a[168:171], a[248:251], v[248:251]
s_add_u32 s37, s31, 163840
ds_read_b64_tr_b16 a[190:191], v12 offset:1024
v_mfma_f32_16x16x32_bf16 v[252:255], a[168:171], a[252:255], v[252:255]
s_add_u32 m0, s33, 5120
ds_read_b64_tr_b16 a[168:169], v7 offset:0
v_mfma_f32_16x16x32_bf16 a[0:3], a[172:175], a[224:227], a[0:3]
buffer_load_dwordx4 v2, s[20:23], s37 offen  lds
ds_read_b64_tr_b16 a[170:171], v7 offset:1024
v_mfma_f32_16x16x32_bf16 a[4:7], a[172:175], a[228:231], a[4:7]
s_add_u32 s31, s31, 262144
v_xor_b32 v7, 64, v5
v_xor_b32 v12, 208, v5
v_mfma_f32_16x16x32_bf16 a[8:11], a[172:175], a[232:235], a[8:11]
s_add_u32 s33, s33, 16384
v_mfma_f32_16x16x32_bf16 a[12:15], a[172:175], a[236:239], a[12:15]
s_and_b32 s33, s33, 65535
v_mfma_f32_16x16x32_bf16 a[16:19], a[172:175], a[240:243], a[16:19]
v_mfma_f32_16x16x32_bf16 a[20:23], a[172:175], a[244:247], a[20:23]
s_mov_b32 s48, s30
v_mfma_f32_16x16x32_bf16 a[24:27], a[172:175], a[248:251], a[24:27]
s_add_u32 m0, s32, 0
v_mfma_f32_16x16x32_bf16 a[28:31], a[172:175], a[252:255], a[28:31]
buffer_load_dwordx4 v1, s[12:15], s48 offen lds
ds_read_b64_tr_b16 a[172:173], v8 offset:0
v_mfma_f32_16x16x32_bf16 a[32:35], a[176:179], a[224:227], a[32:35]
ds_read_b64_tr_b16 a[174:175], v8 offset:1024
v_mfma_f32_16x16x32_bf16 a[36:39], a[176:179], a[228:231], a[36:39]
v_xor_b32 v8, 80, v5
v_mfma_f32_16x16x32_bf16 a[40:43], a[176:179], a[232:235], a[40:43]
v_mfma_f32_16x16x32_bf16 a[44:47], a[176:179], a[236:239], a[44:47]
v_mfma_f32_16x16x32_bf16 a[48:51], a[176:179], a[240:243], a[48:51]
s_add_u32 s48, s48, s34
v_mfma_f32_16x16x32_bf16 a[52:55], a[176:179], a[244:247], a[52:55]
s_add_u32 m0, s32, 4096
v_mfma_f32_16x16x32_bf16 a[56:59], a[176:179], a[248:251], a[56:59]
buffer_load_dwordx4 v1, s[12:15], s48 offen lds
v_mfma_f32_16x16x32_bf16 a[60:63], a[176:179], a[252:255], a[60:63]
ds_read_b64_tr_b16 a[176:177], v9 offset:0
v_mfma_f32_16x16x32_bf16 a[64:67], a[180:183], a[224:227], a[64:67]
ds_read_b64_tr_b16 a[178:179], v9 offset:1024
v_mfma_f32_16x16x32_bf16 a[68:71], a[180:183], a[228:231], a[68:71]
v_xor_b32 v9, 128, v5
v_mfma_f32_16x16x32_bf16 a[72:75], a[180:183], a[232:235], a[72:75]
v_mfma_f32_16x16x32_bf16 a[76:79], a[180:183], a[236:239], a[76:79]
s_add_u32 s48, s48, s34
v_mfma_f32_16x16x32_bf16 a[80:83], a[180:183], a[240:243], a[80:83]
s_add_u32 m0, s32, 8192
v_mfma_f32_16x16x32_bf16 a[84:87], a[180:183], a[244:247], a[84:87]
buffer_load_dwordx4 v1, s[12:15], s48 offen lds
v_mfma_f32_16x16x32_bf16 a[88:91], a[180:183], a[248:251], a[88:91]
v_mfma_f32_16x16x32_bf16 a[92:95], a[180:183], a[252:255], a[92:95]
ds_read_b64_tr_b16 a[180:181], v10 offset:0
v_mfma_f32_16x16x32_bf16 a[96:99], a[184:187], a[224:227], a[96:99]
ds_read_b64_tr_b16 a[182:183], v10 offset:1024
v_mfma_f32_16x16x32_bf16 a[100:103], a[184:187], a[228:231], a[100:103]
v_xor_b32 v10, 144, v5
v_mfma_f32_16x16x32_bf16 a[104:107], a[184:187], a[232:235], a[104:107]
s_add_u32 s48, s48, s34
v_mfma_f32_16x16x32_bf16 a[108:111], a[184:187], a[236:239], a[108:111]
s_add_u32 m0, s32, 12288
v_mfma_f32_16x16x32_bf16 a[112:115], a[184:187], a[240:243], a[112:115]
buffer_load_dwordx4 v1, s[12:15], s48 offen lds
v_mfma_f32_16x16x32_bf16 a[116:119], a[184:187], a[244:247], a[116:119]
v_mfma_f32_16x16x32_bf16 a[120:123], a[184:187], a[248:251], a[120:123]
v_mfma_f32_16x16x32_bf16 a[124:127], a[184:187], a[252:255], a[124:127]
ds_read_b64_tr_b16 a[184:185], v11 offset:0
v_mfma_f32_16x16x32_bf16 a[128:131], v[28:31], a[224:227], a[128:131]
ds_read_b64_tr_b16 a[186:187], v11 offset:1024
v_mfma_f32_16x16x32_bf16 a[132:135], v[28:31], a[228:231], a[132:135]
v_xor_b32 v11, 192, v5
v_mfma_f32_16x16x32_bf16 a[136:139], v[28:31], a[232:235], a[136:139]
buffer_load_dword v15, v14, s[96:99], s100 offen
v_mfma_f32_16x16x32_bf16 a[140:143], v[28:31], a[236:239], a[140:143]
s_add_u32 s100, s100, 16384
v_mfma_f32_16x16x32_bf16 a[144:147], v[28:31], a[240:243], a[144:147]
v_mfma_f32_16x16x32_bf16 a[148:151], v[28:31], a[244:247], a[148:151]
v_mfma_f32_16x16x32_bf16 a[152:155], v[28:31], a[248:251], a[152:155]
v_mfma_f32_16x16x32_bf16 a[156:159], v[28:31], a[252:255], a[156:159]
s_waitcnt vmcnt(20) lgkmcnt(0)
s_barrier
v_mfma_f32_16x16x32_bf16 v[160:163], a[160:163], a[192:195], v[160:163]
ds_read_b128 a[224:227], v4 offset:0
v_mfma_f32_16x16x32_bf16 v[164:167], a[160:163], a[196:199], v[164:167]
s_add_u32 s37, s31, 0
v_mfma_f32_16x16x32_bf16 v[168:171], a[160:163], a[200:203], v[168:171]
s_add_u32 m0, s33, 0
ds_read_b128 a[228:231], v3 offset:1024
v_mfma_f32_16x16x32_bf16 v[172:175], a[160:163], a[204:207], v[172:175]
buffer_load_dwordx4 v2, s[20:23], s37 offen  lds
v_mfma_f32_16x16x32_bf16 v[176:179], a[160:163], a[208:211], v[176:179]
ds_read_b128 a[232:235], v4 offset:4096
v_mfma_f32_16x16x32_bf16 v[180:183], a[160:163], a[212:215], v[180:183]
v_mfma_f32_16x16x32_bf16 v[184:187], a[160:163], a[216:219], v[184:187]
ds_read_b128 a[236:239], v3 offset:5120
v_mfma_f32_16x16x32_bf16 v[188:191], a[160:163], a[220:223], v[188:191]
ds_read_b64_tr_b16 a[160:161], v5 offset:0
v_mfma_f32_16x16x32_bf16 v[192:195], a[164:167], a[192:195], v[192:195]
s_add_u32 s37, s31, 32768
ds_read_b64_tr_b16 a[162:163], v5 offset:1024
v_mfma_f32_16x16x32_bf16 v[196:199], a[164:167], a[196:199], v[196:199]
s_add_u32 m0, s33, 1024
ds_read_b128 a[240:243], v4 offset:8192
v_add_u32 v5, 16384, v5
v_mfma_f32_16x16x32_bf16 v[200:203], a[164:167], a[200:203], v[200:203]
buffer_load_dwordx4 v2, s[20:23], s37 offen  lds
v_and_b32 v5, 65535, v5
v_mfma_f32_16x16x32_bf16 v[204:207], a[164:167], a[204:207], v[204:207]
ds_read_b128 a[244:247], v3 offset:9216
v_mfma_f32_16x16x32_bf16 v[208:211], a[164:167], a[208:211], v[208:211]
v_mfma_f32_16x16x32_bf16 v[212:215], a[164:167], a[212:215], v[212:215]
ds_read_b128 a[248:251], v4 offset:12288
v_mfma_f32_16x16x32_bf16 v[216:219], a[164:167], a[216:219], v[216:219]
v_mfma_f32_16x16x32_bf16 v[220:223], a[164:167], a[220:223], v[220:223]
s_add_u32 s37, s31, 131072
ds_read_b64_tr_b16 a[164:165], v6 offset:0
v_mfma_f32_16x16x32_bf16 v[224:227], a[168:171], a[192:195], v[224:227]
s_add_u32 m0, s33, 4096
ds_read_b64_tr_b16 a[166:167], v6 offset:1024
v_mfma_f32_16x16x32_bf16 v[228:231], a[168:171], a[196:199], v[228:231]
buffer_load_dwordx4 v2, s[20:23], s37 offen  lds
v_xor_b32 v6, 16, v5
v_mfma_f32_16x16x32_bf16 v[232:235], a[168:171], a[200:203], v[232:235]
ds_read_b128 a[252:255], v3 offset:13312
v_mfma_f32_16x16x32_bf16 v[236:239], a[168:171], a[204:207], v[236:239]
v_mfma_f32_16x16x32_bf16 v[240:243], a[168:171], a[208:211], v[240:243]
ds_read_b64_tr_b16 v[28:29], v12 offset:0
v_mfma_f32_16x16x32_bf16 v[244:247], a[168:171], a[212:215], v[244:247]
v_mfma_f32_16x16x32_bf16 v[248:251], a[168:171], a[216:219], v[248:251]
s_add_u32 s37, s31, 163840
ds_read_b64_tr_b16 v[30:31], v12 offset:1024
v_mfma_f32_16x16x32_bf16 v[252:255], a[168:171], a[220:223], v[252:255]
s_add_u32 m0, s33, 5120
ds_read_b64_tr_b16 a[168:169], v7 offset:0
v_mfma_f32_16x16x32_bf16 a[0:3], a[172:175], a[192:195], a[0:3]
buffer_load_dwordx4 v2, s[20:23], s37 offen  lds
ds_read_b64_tr_b16 a[170:171], v7 offset:1024
v_mfma_f32_16x16x32_bf16 a[4:7], a[172:175], a[196:199], a[4:7]
s_add_u32 s31, s31, 262144
v_xor_b32 v7, 64, v5
v_xor_b32 v12, 208, v5
v_mfma_f32_16x16x32_bf16 a[8:11], a[172:175], a[200:203], a[8:11]
s_add_u32 s33, s33, 16384
v_add_u32 v3, 32768, v3
v_mfma_f32_16x16x32_bf16 a[12:15], a[172:175], a[204:207], a[12:15]
s_and_b32 s33, s33, 65535
v_subrev_u32 v19, 98304, v3
v_mfma_f32_16x16x32_bf16 a[16:19], a[172:175], a[208:211], a[16:19]
v_cmp_le_u32 vcc, 163840, v3
v_mfma_f32_16x16x32_bf16 a[20:23], a[172:175], a[212:215], a[20:23]
s_add_u32 s48, s48, s34
v_cndmask_b32 v3, v3, v19, vcc
v_mfma_f32_16x16x32_bf16 a[24:27], a[172:175], a[216:219], a[24:27]
s_add_u32 m0, s32, 16384
v_xor_b32 v4, 64, v3
v_mfma_f32_16x16x32_bf16 a[28:31], a[172:175], a[220:223], a[28:31]
buffer_load_dwordx4 v1, s[12:15], s48 offen lds
ds_read_b64_tr_b16 a[172:173], v8 offset:0
v_mfma_f32_16x16x32_bf16 a[32:35], a[176:179], a[192:195], a[32:35]
ds_read_b64_tr_b16 a[174:175], v8 offset:1024
v_mfma_f32_16x16x32_bf16 a[36:39], a[176:179], a[196:199], a[36:39]
v_xor_b32 v8, 80, v5
v_mfma_f32_16x16x32_bf16 a[40:43], a[176:179], a[200:203], a[40:43]
v_mfma_f32_16x16x32_bf16 a[44:47], a[176:179], a[204:207], a[44:47]
v_mfma_f32_16x16x32_bf16 a[48:51], a[176:179], a[208:211], a[48:51]
s_add_u32 s48, s48, s34
v_mfma_f32_16x16x32_bf16 a[52:55], a[176:179], a[212:215], a[52:55]
s_add_u32 m0, s32, 20480
v_mfma_f32_16x16x32_bf16 a[56:59], a[176:179], a[216:219], a[56:59]
buffer_load_dwordx4 v1, s[12:15], s48 offen lds
v_mfma_f32_16x16x32_bf16 a[60:63], a[176:179], a[220:223], a[60:63]
ds_read_b64_tr_b16 a[176:177], v9 offset:0
v_mfma_f32_16x16x32_bf16 a[64:67], a[180:183], a[192:195], a[64:67]
ds_read_b64_tr_b16 a[178:179], v9 offset:1024
v_mfma_f32_16x16x32_bf16 a[68:71], a[180:183], a[196:199], a[68:71]
v_xor_b32 v9, 128, v5
v_mfma_f32_16x16x32_bf16 a[72:75], a[180:183], a[200:203], a[72:75]
v_mfma_f32_16x16x32_bf16 a[76:79], a[180:183], a[204:207], a[76:79]
s_add_u32 s48, s48, s34
v_mfma_f32_16x16x32_bf16 a[80:83], a[180:183], a[208:211], a[80:83]
s_add_u32 m0, s32, 24576
v_mfma_f32_16x16x32_bf16 a[84:87], a[180:183], a[212:215], a[84:87]
buffer_load_dwordx4 v1, s[12:15], s48 offen lds
v_mfma_f32_16x16x32_bf16 a[88:91], a[180:183], a[216:219], a[88:91]
v_mfma_f32_16x16x32_bf16 a[92:95], a[180:183], a[220:223], a[92:95]
ds_read_b64_tr_b16 a[180:181], v10 offset:0
v_mfma_f32_16x16x32_bf16 a[96:99], a[184:187], a[192:195], a[96:99]
ds_read_b64_tr_b16 a[182:183], v10 offset:1024
v_mfma_f32_16x16x32_bf16 a[100:103], a[184:187], a[196:199], a[100:103]
v_xor_b32 v10, 144, v5
v_mfma_f32_16x16x32_bf16 a[104:107], a[184:187], a[200:203], a[104:107]
s_add_u32 s48, s48, s34
v_mfma_f32_16x16x32_bf16 a[108:111], a[184:187], a[204:207], a[108:111]
s_add_u32 m0, s32, 28672
v_mfma_f32_16x16x32_bf16 a[112:115], a[184:187], a[208:211], a[112:115]
buffer_load_dwordx4 v1, s[12:15], s48 offen lds
v_mfma_f32_16x16x32_bf16 a[116:119], a[184:187], a[212:215], a[116:119]
s_add_u32 s30, s30, 128
v_mfma_f32_16x16x32_bf16 a[120:123], a[184:187], a[216:219], a[120:123]
s_add_u32 s32, s32, 32768
v_mfma_f32_16x16x32_bf16 a[124:127], a[184:187], a[220:223], a[124:127]
s_sub_u32 s48, s32, 98304
ds_read_b64_tr_b16 a[184:185], v11 offset:0
v_mfma_f32_16x16x32_bf16 a[128:131], a[188:191], a[192:195], a[128:131]
s_cmp_ge_u32 s32, 163840
s_cselect_b32 s32, s48, s32
ds_read_b64_tr_b16 a[186:187], v11 offset:1024
v_mfma_f32_16x16x32_bf16 a[132:135], a[188:191], a[196:199], a[132:135]
v_xor_b32 v11, 192, v5
v_mfma_f32_16x16x32_bf16 a[136:139], a[188:191], a[200:203], a[136:139]
buffer_load_dword v15, v14, s[96:99], s100 offen
v_mfma_f32_16x16x32_bf16 a[140:143], a[188:191], a[204:207], a[140:143]
s_add_u32 s100, s100, 16384
v_mfma_f32_16x16x32_bf16 a[144:147], a[188:191], a[208:211], a[144:147]
v_mfma_f32_16x16x32_bf16 a[148:151], a[188:191], a[212:215], a[148:151]
v_mfma_f32_16x16x32_bf16 a[152:155], a[188:191], a[216:219], a[152:155]
v_mfma_f32_16x16x32_bf16 a[156:159], a[188:191], a[220:223], a[156:159]
s_cmp_eq_u32 s41, 0
s_cbranch_scc0 L_g_k17v
s_waitcnt vmcnt(18) lgkmcnt(0)
s_barrier
v_mfma_f32_16x16x32_bf16 v[160:163], a[160:163], a[224:227], v[160:163]
ds_read_b128 a[192:195], v3 offset:0
v_mfma_f32_16x16x32_bf16 v[164:167], a[160:163], a[228:231], v[164:167]
s_add_u32 s37, s31, 0
v_mfma_f32_16x16x32_bf16 v[168:171], a[160:163], a[232:235], v[168:171]
s_add_u32 m0, s33, 0
ds_read_b128 a[196:199], v4 offset:1024
v_mfma_f32_16x16x32_bf16 v[172:175], a[160:163], a[236:239], v[172:175]
buffer_load_dwordx4 v2, s[20:23], s37 offen  lds
v_mfma_f32_16x16x32_bf16 v[176:179], a[160:163], a[240:243], v[176:179]
ds_read_b128 a[200:203], v3 offset:4096
v_cvt_pk_bf16_f32 v32, v160, v161
v_cvt_pk_bf16_f32 v33, v162, v163
v_mfma_f32_16x16x32_bf16 v[180:183], a[160:163], a[244:247], v[180:183]
v_cvt_pk_bf16_f32 v36, v164, v165
v_cvt_pk_bf16_f32 v37, v166, v167
v_mfma_f32_16x16x32_bf16 v[184:187], a[160:163], a[248:251], v[184:187]
ds_read_b128 a[204:207], v4 offset:5120
v_cvt_pk_bf16_f32 v40, v168, v169
v_cvt_pk_bf16_f32 v41, v170, v171
v_mfma_f32_16x16x32_bf16 v[188:191], a[160:163], a[252:255], v[188:191]
ds_read_b64_tr_b16 a[160:161], v5 offset:0
v_cvt_pk_bf16_f32 v44, v172, v173
v_cvt_pk_bf16_f32 v45, v174, v175
v_mfma_f32_16x16x32_bf16 v[192:195], a[164:167], a[224:227], v[192:195]
s_add_u32 s37, s31, 32768
ds_read_b64_tr_b16 a[162:163], v5 offset:1024
v_cvt_pk_bf16_f32 v48, v176, v177
v_cvt_pk_bf16_f32 v49, v178, v179
v_mfma_f32_16x16x32_bf16 v[196:199], a[164:167], a[228:231], v[196:199]
s_add_u32 m0, s33, 1024
ds_read_b128 a[208:211], v3 offset:8192
v_add_u32 v5, 16384, v5
v_cvt_pk_bf16_f32 v52, v180, v181
v_cvt_pk_bf16_f32 v53, v182, v183
v_mfma_f32_16x16x32_bf16 v[200:203], a[164:167], a[232:235], v[200:203]
buffer_load_dwordx4 v2, s[20:23], s37 offen  lds
v_and_b32 v5, 65535, v5
v_cvt_pk_bf16_f32 v56, v184, v185
v_cvt_pk_bf16_f32 v57, v186, v187
v_mfma_f32_16x16x32_bf16 v[204:207], a[164:167], a[236:239], v[204:207]
ds_read_b128 a[212:215], v4 offset:9216
v_cvt_pk_bf16_f32 v60, v188, v189
v_cvt_pk_bf16_f32 v61, v190, v191
v_mfma_f32_16x16x32_bf16 v[208:211], a[164:167], a[240:243], v[208:211]
v_cvt_pk_bf16_f32 v34, v192, v193
v_cvt_pk_bf16_f32 v35, v194, v195
v_mfma_f32_16x16x32_bf16 v[212:215], a[164:167], a[244:247], v[212:215]
ds_read_b128 a[216:219], v3 offset:12288
v_cvt_pk_bf16_f32 v38, v196, v197
v_cvt_pk_bf16_f32 v39, v198, v199
v_mfma_f32_16x16x32_bf16 v[216:219], a[164:167], a[248:251], v[216:219]
v_cvt_pk_bf16_f32 v42, v200, v201
v_cvt_pk_bf16_f32 v43, v202, v203
v_mfma_f32_16x16x32_bf16 v[220:223], a[164:167], a[252:255], v[220:223]
s_add_u32 s37, s31, 131072
ds_read_b64_tr_b16 a[164:165], v6 offset:0
v_cvt_pk_bf16_f32 v46, v204, v205
v_cvt_pk_bf16_f32 v47, v206, v207
v_mfma_f32_16x16x32_bf16 v[224:227], a[168:171], a[224:227], v[224:227]
s_add_u32 m0, s33, 4096
ds_read_b64_tr_b16 a[166:167], v6 offset:1024
v_cvt_pk_bf16_f32 v50, v208, v209
v_cvt_pk_bf16_f32 v51, v210, v211
v_mfma_f32_16x16x32_bf16 v[228:231], a[168:171], a[228:231], v[228:231]
buffer_load_dwordx4 v2, s[20:23], s37 offen  lds
v_xor_b32 v6, 16, v5
v_cvt_pk_bf16_f32 v54, v212, v213
v_cvt_pk_bf16_f32 v55, v214, v215
v_mfma_f32_16x16x32_bf16 v[232:235], a[168:171], a[232:235], v[232:235]
ds_read_b128 a[220:223], v4 offset:13312
v_cvt_pk_bf16_f32 v58, v216, v217
v_cvt_pk_bf16_f32 v59, v218, v219
v_mfma_f32_16x16x32_bf16 v[236:239], a[168:171], a[236:239], v[236:239]
v_cvt_pk_bf16_f32 v62, v220, v221
v_cvt_pk_bf16_f32 v63, v222, v223
v_mfma_f32_16x16x32_bf16 v[240:243], a[168:171], a[240:243], v[240:243]
ds_read_b64_tr_b16 a[188:189], v12 offset:0
v_cvt_pk_bf16_f32 v64, v224, v225
v_cvt_pk_bf16_f32 v65, v226, v227
v_mfma_f32_16x16x32_bf16 v[244:247], a[168:171], a[244:247], v[244:247]
v_cvt_pk_bf16_f32 v68, v228, v229
v_cvt_pk_bf16_f32 v69, v230, v231
v_mfma_f32_16x16x32_bf16 v[248:251], a[168:171], a[248:251], v[248:251]
s_add_u32 s37, s31, 163840
ds_read_b64_tr_b16 a[190:191], v12 offset:1024
v_cvt_pk_bf16_f32 v72, v232, v233
v_cvt_pk_bf16_f32 v73, v234, v235
v_mfma_f32_16x16x32_bf16 v[252:255], a[168:171], a[252:255], v[252:255]
s_add_u32 m0, s33, 5120
ds_read_b64_tr_b16 a[168:169], v7 offset:0
v_cvt_pk_bf16_f32 v76, v236, v237
v_cvt_pk_bf16_f32 v77, v238, v239
v_mfma_f32_16x16x32_bf16 a[0:3], a[172:175], a[224:227], a[0:3]
buffer_load_dwordx4 v2, s[20:23], s37 offen  lds
ds_read_b64_tr_b16 a[170:171], v7 offset:1024
v_cvt_pk_bf16_f32 v80, v240, v241
v_cvt_pk_bf16_f32 v81, v242, v243
v_mfma_f32_16x16x32_bf16 a[4:7], a[172:175], a[228:231], a[4:7]
s_add_u32 s31, s31, 262144
v_xor_b32 v7, 64, v5
v_xor_b32 v12, 208, v5
v_cvt_pk_bf16_f32 v84, v244, v245
v_cvt_pk_bf16_f32 v85, v246, v247
v_mfma_f32_16x16x32_bf16 a[8:11], a[172:175], a[232:235], a[8:11]
s_add_u32 s33, s33, 16384
v_cvt_pk_bf16_f32 v88, v248, v249
v_cvt_pk_bf16_f32 v89, v250, v251
v_mfma_f32_16x16x32_bf16 a[12:15], a[172:175], a[236:239], a[12:15]
s_and_b32 s33, s33, 65535
v_cvt_pk_bf16_f32 v92, v252, v253
v_cvt_pk_bf16_f32 v93, v254, v255
v_mfma_f32_16x16x32_bf16 a[16:19], a[172:175], a[240:243], a[16:19]
v_accvgpr_read_b32 v20, a0
v_accvgpr_read_b32 v21, a1
v_accvgpr_read_b32 v22, a2
v_accvgpr_read_b32 v23, a3
v_mfma_f32_16x16x32_bf16 a[20:23], a[172:175], a[244:247], a[20:23]
s_mov_b32 s48, s30
v_cvt_pk_bf16_f32 v66, v20, v21
v_cvt_pk_bf16_f32 v67, v22, v23
v_accvgpr_read_b32 v24, a4
v_accvgpr_read_b32 v25, a5
v_mfma_f32_16x16x32_bf16 a[24:27], a[172:175], a[248:251], a[24:27]
s_add_u32 m0, s32, 0
v_accvgpr_read_b32 v26, a6
v_accvgpr_read_b32 v27, a7
v_cvt_pk_bf16_f32 v70, v24, v25
v_cvt_pk_bf16_f32 v71, v26, v27
v_mfma_f32_16x16x32_bf16 a[28:31], a[172:175], a[252:255], a[28:31]
buffer_load_dwordx4 v1, s[12:15], s48 offen lds
ds_read_b64_tr_b16 a[172:173], v8 offset:0
v_accvgpr_read_b32 v20, a8
v_accvgpr_read_b32 v21, a9
v_mfma_f32_16x16x32_bf16 a[32:35], a[176:179], a[224:227], a[32:35]
ds_read_b64_tr_b16 a[174:175], v8 offset:1024
v_mov_b32 v16, 0
v_accvgpr_read_b32 v22, a10
v_accvgpr_read_b32 v23, a11
v_mfma_f32_16x16x32_bf16 a[36:39], a[176:179], a[228:231], a[36:39]
v_mov_b32 v17, 1
v_xor_b32 v8, 80, v5
v_cvt_pk_bf16_f32 v74, v20, v21
v_cvt_pk_bf16_f32 v75, v22, v23
v_mfma_f32_16x16x32_bf16 a[40:43], a[176:179], a[232:235], a[40:43]
s_cmp_eq_u32 s17, 0
s_cselect_b32 s29, s39, 536870912
v_accvgpr_read_b32 v24, a12
v_accvgpr_read_b32 v25, a13
v_mfma_f32_16x16x32_bf16 a[44:47], a[176:179], a[236:239], a[44:47]
s_mov_b64 exec, 1
buffer_store_dword v17, v16, s[8:11], s29 offen sc1
s_mov_b64 exec, -1
v_accvgpr_read_b32 v26, a14
v_mfma_f32_16x16x32_bf16 a[48:51], a[176:179], a[240:243], a[48:51]
s_add_u32 s48, s48, s34
v_accvgpr_read_b32 v27, a15
v_cvt_pk_bf16_f32 v78, v24, v25
v_cvt_pk_bf16_f32 v79, v26, v27
v_accvgpr_read_b32 v20, a16
v_mfma_f32_16x16x32_bf16 a[52:55], a[176:179], a[244:247], a[52:55]
s_add_u32 m0, s32, 4096
v_accvgpr_read_b32 v21, a17
v_accvgpr_read_b32 v22, a18
v_accvgpr_read_b32 v23, a19
v_cvt_pk_bf16_f32 v82, v20, v21
v_mfma_f32_16x16x32_bf16 a[56:59], a[176:179], a[248:251], a[56:59]
buffer_load_dwordx4 v1, s[12:15], s48 offen lds
v_cvt_pk_bf16_f32 v83, v22, v23
v_accvgpr_read_b32 v24, a20
v_accvgpr_read_b32 v25, a21
v_mfma_f32_16x16x32_bf16 a[60:63], a[176:179], a[252:255], a[60:63]
ds_read_b64_tr_b16 a[176:177], v9 offset:0
v_accvgpr_read_b32 v26, a22
v_accvgpr_read_b32 v27, a23
v_cvt_pk_bf16_f32 v86, v24, v25
v_mfma_f32_16x16x32_bf16 a[64:67], a[180:183], a[224:227], a[64:67]
ds_read_b64_tr_b16 a[178:179], v9 offset:1024
v_cvt_pk_bf16_f32 v87, v26, v27
v_accvgpr_read_b32 v20, a24
v_accvgpr_read_b32 v21, a25
v_mfma_f32_16x16x32_bf16 a[68:71], a[180:183], a[228:231], a[68:71]
v_xor_b32 v9, 128, v5
v_accvgpr_read_b32 v22, a26
v_accvgpr_read_b32 v23, a27
v_cvt_pk_bf16_f32 v90, v20, v21
v_mfma_f32_16x16x32_bf16 a[72:75], a[180:183], a[232:235], a[72:75]
v_cvt_pk_bf16_f32 v91, v22, v23
v_accvgpr_read_b32 v24, a28
v_accvgpr_read_b32 v25, a29
v_accvgpr_read_b32 v26, a30
v_mfma_f32_16x16x32_bf16 a[76:79], a[180:183], a[236:239], a[76:79]
s_add_u32 s48, s48, s34
v_accvgpr_read_b32 v27, a31
v_cvt_pk_bf16_f32 v94, v24, v25
v_cvt_pk_bf16_f32 v95, v26, v27
v_accvgpr_read_b32 v20, a32
v_mfma_f32_16x16x32_bf16 a[80:83], a[180:183], a[240:243], a[80:83]
s_add_u32 m0, s32, 8192
v_accvgpr_read_b32 v21, a33
v_accvgpr_read_b32 v22, a34
v_accvgpr_read_b32 v23, a35
v_cvt_pk_bf16_f32 v96, v20, v21
v_mfma_f32_16x16x32_bf16 a[84:87], a[180:183], a[244:247], a[84:87]
buffer_load_dwordx4 v1, s[12:15], s48 offen lds
v_cvt_pk_bf16_f32 v97, v22, v23
v_accvgpr_read_b32 v24, a36
v_accvgpr_read_b32 v25, a37
v_mfma_f32_16x16x32_bf16 a[88:91], a[180:183], a[248:251], a[88:91]
v_accvgpr_read_b32 v26, a38
v_accvgpr_read_b32 v27, a39
v_cvt_pk_bf16_f32 v100, v24, v25
v_cvt_pk_bf16_f32 v101, v26, v27
v_mfma_f32_16x16x32_bf16 a[92:95], a[180:183], a[252:255], a[92:95]
ds_read_b64_tr_b16 a[180:181], v10 offset:0
v_accvgpr_read_b32 v20, a40
v_accvgpr_read_b32 v21, a41
v_accvgpr_read_b32 v22, a42
v_mfma_f32_16x16x32_bf16 a[96:99], a[184:187], a[224:227], a[96:99]
ds_read_b64_tr_b16 a[182:183], v10 offset:1024
v_accvgpr_read_b32 v23, a43
v_cvt_pk_bf16_f32 v104, v20, v21
v_cvt_pk_bf16_f32 v105, v22, v23
v_mfma_f32_16x16x32_bf16 a[100:103], a[184:187], a[228:231], a[100:103]
v_xor_b32 v10, 144, v5
v_accvgpr_read_b32 v24, a44
v_accvgpr_read_b32 v25, a45
v_accvgpr_read_b32 v26, a46
v_mfma_f32_16x16x32_bf16 a[104:107], a[184:187], a[232:235], a[104:107]
s_add_u32 s48, s48, s34
v_accvgpr_read_b32 v27, a47
v_cvt_pk_bf16_f32 v108, v24, v25
v_cvt_pk_bf16_f32 v109, v26, v27
v_accvgpr_read_b32 v20, a48
v_mfma_f32_16x16x32_bf16 a[108:111], a[184:187], a[236:239], a[108:111]
s_add_u32 m0, s32, 12288
v_accvgpr_read_b32 v21, a49
v_accvgpr_read_b32 v22, a50
v_accvgpr_read_b32 v23, a51
v_cvt_pk_bf16_f32 v112, v20, v21
v_mfma_f32_16x16x32_bf16 a[112:115], a[184:187], a[240:243], a[112:115]
buffer_load_dwordx4 v1, s[12:15], s48 offen lds
v_cvt_pk_bf16_f32 v113, v22, v23
v_accvgpr_read_b32 v24, a52
v_accvgpr_read_b32 v25, a53
v_mfma_f32_16x16x32_bf16 a[116:119], a[184:187], a[244:247], a[116:119]
v_accvgpr_read_b32 v26, a54
v_accvgpr_read_b32 v27, a55
v_cvt_pk_bf16_f32 v116, v24, v25
v_cvt_pk_bf16_f32 v117, v26, v27
v_mfma_f32_16x16x32_bf16 a[120:123], a[184:187], a[248:251], a[120:123]
v_accvgpr_read_b32 v20, a56
v_accvgpr_read_b32 v21, a57
v_accvgpr_read_b32 v22, a58
v_accvgpr_read_b32 v23, a59
v_mfma_f32_16x16x32_bf16 a[124:127], a[184:187], a[252:255], a[124:127]
ds_read_b64_tr_b16 a[184:185], v11 offset:0
v_cvt_pk_bf16_f32 v120, v20, v21
v_cvt_pk_bf16_f32 v121, v22, v23
v_accvgpr_read_b32 v24, a60
v_mfma_f32_16x16x32_bf16 a[128:131], v[28:31], a[224:227], a[128:131]
ds_read_b64_tr_b16 a[186:187], v11 offset:1024
v_accvgpr_read_b32 v25, a61
v_accvgpr_read_b32 v26, a62
v_accvgpr_read_b32 v27, a63
v_mfma_f32_16x16x32_bf16 a[132:135], v[28:31], a[228:231], a[132:135]
v_xor_b32 v11, 192, v5
v_cvt_pk_bf16_f32 v124, v24, v25
v_cvt_pk_bf16_f32 v125, v26, v27
v_mfma_f32_16x16x32_bf16 a[136:139], v[28:31], a[232:235], a[136:139]
buffer_load_dword v15, v14, s[96:99], s100 offen
v_mfma_f32_16x16x32_bf16 a[140:143], v[28:31], a[236:239], a[140:143]
s_add_u32 s100, s100, 16384
v_mfma_f32_16x16x32_bf16 a[144:147], v[28:31], a[240:243], a[144:147]
v_mfma_f32_16x16x32_bf16 a[148:151], v[28:31], a[244:247], a[148:151]
v_mfma_f32_16x16x32_bf16 a[152:155], v[28:31], a[248:251], a[152:155]
v_mfma_f32_16x16x32_bf16 a[156:159], v[28:31], a[252:255], a[156:159]
s_cmp_lt_u32 s35, s45
s_cbranch_scc1 L_g_tile
s_branch L_g_end
L_g_k17v:
s_waitcnt vmcnt(18) lgkmcnt(0)
s_barrier
v_mfma_f32_16x16x32_bf16 v[160:163], a[160:163], a[224:227], v[160:163]
ds_read_b64_tr_b16 a[192:193], v5 offset:0
v_mfma_f32_16x16x32_bf16 v[164:167], a[160:163], a[228:231], v[164:167]
s_add_u32 s37, s31, 0
v_mfma_f32_16x16x32_bf16 v[168:171], a[160:163], a[232:235], v[168:171]
s_add_u32 m0, s33, 0
ds_read_b64_tr_b16 a[194:195], v5 offset:1024
v_mfma_f32_16x16x32_bf16 v[172:175], a[160:163], a[236:239], v[172:175]
buffer_load_dwordx4 v2, s[20:23], s37 offen  lds
v_mfma_f32_16x16x32_bf16 v[176:179], a[160:163], a[240:243], v[176:179]
ds_read_b64_tr_b16 a[196:197], v6 offset:0
v_cvt_pk_bf16_f32 v32, v160, v161
v_cvt_pk_bf16_f32 v33, v162, v163
v_mfma_f32_16x16x32_bf16 v[180:183], a[160:163], a[244:247], v[180:183]
v_cvt_pk_bf16_f32 v36, v164, v165
v_cvt_pk_bf16_f32 v37, v166, v167
v_mfma_f32_16x16x32_bf16 v[184:187], a[160:163], a[248:251], v[184:187]
ds_read_b64_tr_b16 a[198:199], v6 offset:1024
v_cvt_pk_bf16_f32 v40, v168, v169
v_cvt_pk_bf16_f32 v41, v170, v171
v_mfma_f32_16x16x32_bf16 v[188:191], a[160:163], a[252:255], v[188:191]
ds_read_b128 a[160:163], v3 offset:0
v_cvt_pk_bf16_f32 v44, v172, v173
v_cvt_pk_bf16_f32 v45, v174, v175
v_mfma_f32_16x16x32_bf16 v[192:195], a[164:167], a[224:227], v[192:195]
s_add_u32 s37, s31, 32768
ds_read_b64_tr_b16 a[200:201], v7 offset:0
v_cvt_pk_bf16_f32 v48, v176, v177
v_cvt_pk_bf16_f32 v49, v178, v179
v_mfma_f32_16x16x32_bf16 v[196:199], a[164:167], a[228:231], v[196:199]
s_add_u32 m0, s33, 1024
v_cvt_pk_bf16_f32 v52, v180, v181
v_cvt_pk_bf16_f32 v53, v182, v183
v_mfma_f32_16x16x32_bf16 v[200:203], a[164:167], a[232:235], v[200:203]
buffer_load_dwordx4 v2, s[20:23], s37 offen  lds
v_cvt_pk_bf16_f32 v56, v184, v185
v_cvt_pk_bf16_f32 v57, v186, v187
v_mfma_f32_16x16x32_bf16 v[204:207], a[164:167], a[236:239], v[204:207]
ds_read_b64_tr_b16 a[202:203], v7 offset:1024
v_cvt_pk_bf16_f32 v60, v188, v189
v_cvt_pk_bf16_f32 v61, v190, v191
v_mfma_f32_16x16x32_bf16 v[208:211], a[164:167], a[240:243], v[208:211]
v_cvt_pk_bf16_f32 v34, v192, v193
v_cvt_pk_bf16_f32 v35, v194, v195
v_mfma_f32_16x16x32_bf16 v[212:215], a[164:167], a[244:247], v[212:215]
ds_read_b64_tr_b16 a[204:205], v8 offset:0
v_cvt_pk_bf16_f32 v38, v196, v197
v_cvt_pk_bf16_f32 v39, v198, v199
v_mfma_f32_16x16x32_bf16 v[216:219], a[164:167], a[248:251], v[216:219]
v_cvt_pk_bf16_f32 v42, v200, v201
v_cvt_pk_bf16_f32 v43, v202, v203
v_mfma_f32_16x16x32_bf16 v[220:223], a[164:167], a[252:255], v[220:223]
s_add_u32 s37, s31, 131072
ds_read_b128 a[164:167], v4 offset:1024
v_cvt_pk_bf16_f32 v46, v204, v205
v_cvt_pk_bf16_f32 v47, v206, v207
v_mfma_f32_16x16x32_bf16 v[224:227], a[168:171], a[224:227], v[224:227]
s_add_u32 m0, s33, 4096
ds_read_b64_tr_b16 a[206:207], v8 offset:1024
v_cvt_pk_bf16_f32 v50, v208, v209
v_cvt_pk_bf16_f32 v51, v210, v211
v_mfma_f32_16x16x32_bf16 v[228:231], a[168:171], a[228:231], v[228:231]
buffer_load_dwordx4 v2, s[20:23], s37 offen  lds
v_cvt_pk_bf16_f32 v54, v212, v213
v_cvt_pk_bf16_f32 v55, v214, v215
v_mfma_f32_16x16x32_bf16 v[232:235], a[168:171], a[232:235], v[232:235]
ds_read_b64_tr_b16 a[208:209], v9 offset:0
v_cvt_pk_bf16_f32 v58, v216, v217
v_cvt_pk_bf16_f32 v59, v218, v219
v_mfma_f32_16x16x32_bf16 v[236:239], a[168:171], a[236:239], v[236:239]
v_cvt_pk_bf16_f32 v62, v220, v221
v_cvt_pk_bf16_f32 v63, v222, v223
v_mfma_f32_16x16x32_bf16 v[240:243], a[168:171], a[240:243], v[240:243]
ds_read_b64_tr_b16 a[210:211], v9 offset:1024
v_cvt_pk_bf16_f32 v64, v224, v225
v_cvt_pk_bf16_f32 v65, v226, v227
v_mfma_f32_16x16x32_bf16 v[244:247], a[168:171], a[244:247], v[244:247]
v_cvt_pk_bf16_f32 v68, v228, v229
v_cvt_pk_bf16_f32 v69, v230, v231
v_mfma_f32_16x16x32_bf16 v[248:251], a[168:171], a[248:251], v[248:251]
s_add_u32 s37, s31, 163840
ds_read_b64_tr_b16 a[212:213], v10 offset:0
v_cvt_pk_bf16_f32 v72, v232, v233
v_cvt_pk_bf16_f32 v73, v234, v235
v_mfma_f32_16x16x32_bf16 v[252:255], a[168:171], a[252:255], v[252:255]
s_add_u32 m0, s33, 5120
ds_read_b128 a[168:171], v3 offset:4096
v_cvt_pk_bf16_f32 v76, v236, v237
v_cvt_pk_bf16_f32 v77, v238, v239
v_mfma_f32_16x16x32_bf16 a[0:3], a[172:175], a[224:227], a[0:3]
buffer_load_dwordx4 v2, s[20:23], s37 offen  lds
v_cvt_pk_bf16_f32 v80, v240, v241
v_cvt_pk_bf16_f32 v81, v242, v243
v_mfma_f32_16x16x32_bf16 a[4:7], a[172:175], a[228:231], a[4:7]
s_add_u32 s31, s31, 262144
ds_read_b64_tr_b16 a[214:215], v10 offset:1024
v_cvt_pk_bf16_f32 v84, v244, v245
v_cvt_pk_bf16_f32 v85, v246, v247
v_mfma_f32_16x16x32_bf16 a[8:11], a[172:175], a[232:235], a[8:11]
s_add_u32 s33, s33, 16384
v_cvt_pk_bf16_f32 v88, v248, v249
v_cvt_pk_bf16_f32 v89, v250, v251
v_mfma_f32_16x16x32_bf16 a[12:15], a[172:175], a[236:239], a[12:15]
s_and_b32 s33, s33, 65535
ds_read_b64_tr_b16 a[216:217], v11 offset:0
v_cvt_pk_bf16_f32 v92, v252, v253
v_cvt_pk_bf16_f32 v93, v254, v255
v_mfma_f32_16x16x32_bf16 a[16:19], a[172:175], a[240:243], a[16:19]
v_accvgpr_read_b32 v20, a0
v_accvgpr_read_b32 v21, a1
v_accvgpr_read_b32 v22, a2
v_accvgpr_read_b32 v23, a3
v_mfma_f32_16x16x32_bf16 a[20:23], a[172:175], a[244:247], a[20:23]
s_mov_b32 s48, s30
ds_read_b64_tr_b16 a[218:219], v11 offset:1024
v_cvt_pk_bf16_f32 v66, v20, v21
v_cvt_pk_bf16_f32 v67, v22, v23
v_accvgpr_read_b32 v24, a4
v_mfma_f32_16x16x32_bf16 a[24:27], a[172:175], a[248:251], a[24:27]
s_add_u32 m0, s32, 0
v_accvgpr_read_b32 v25, a5
v_accvgpr_read_b32 v26, a6
v_accvgpr_read_b32 v27, a7
v_cvt_pk_bf16_f32 v70, v24, v25
v_mfma_f32_16x16x32_bf16 a[28:31], a[172:175], a[252:255], a[28:31]
buffer_load_dwordx4 v1, s[12:15], s48 offen lds
ds_read_b128 a[172:175], v4 offset:5120
v_cvt_pk_bf16_f32 v71, v26, v27
v_accvgpr_read_b32 v20, a8
v_mfma_f32_16x16x32_bf16 a[32:35], a[176:179], a[224:227], a[32:35]
ds_read_b64_tr_b16 a[220:221], v12 offset:0
v_mov_b32 v16, 0
v_accvgpr_read_b32 v21, a9
v_accvgpr_read_b32 v22, a10
v_mfma_f32_16x16x32_bf16 a[36:39], a[176:179], a[228:231], a[36:39]
v_mov_b32 v17, 1
v_accvgpr_read_b32 v23, a11
v_cvt_pk_bf16_f32 v74, v20, v21
v_cvt_pk_bf16_f32 v75, v22, v23
v_mfma_f32_16x16x32_bf16 a[40:43], a[176:179], a[232:235], a[40:43]
ds_read_b64_tr_b16 a[222:223], v12 offset:1024
v_accvgpr_read_b32 v24, a12
v_accvgpr_read_b32 v25, a13
v_accvgpr_read_b32 v26, a14
v_mfma_f32_16x16x32_bf16 a[44:47], a[176:179], a[236:239], a[44:47]
s_cmp_eq_u32 s17, 0
s_cselect_b32 s29, s39, 536870912
v_accvgpr_read_b32 v27, a15
v_cvt_pk_bf16_f32 v78, v24, v25
v_mfma_f32_16x16x32_bf16 a[48:51], a[176:179], a[240:243], a[48:51]
s_add_u32 s48, s48, s34
ds_read_b128 a[188:191], v4 offset:13312
v_cvt_pk_bf16_f32 v79, v26, v27
v_accvgpr_read_b32 v20, a16
v_accvgpr_read_b32 v21, a17
v_mfma_f32_16x16x32_bf16 a[52:55], a[176:179], a[244:247], a[52:55]
s_add_u32 m0, s32, 4096
v_accvgpr_read_b32 v22, a18
v_accvgpr_read_b32 v23, a19
v_cvt_pk_bf16_f32 v82, v20, v21
v_cvt_pk_bf16_f32 v83, v22, v23
v_mfma_f32_16x16x32_bf16 a[56:59], a[176:179], a[248:251], a[56:59]
buffer_load_dwordx4 v1, s[12:15], s48 offen lds
v_accvgpr_read_b32 v24, a20
v_accvgpr_read_b32 v25, a21
v_accvgpr_read_b32 v26, a22
v_mfma_f32_16x16x32_bf16 a[60:63], a[176:179], a[252:255], a[60:63]
ds_read_b128 a[176:179], v3 offset:8192
v_add_u32 v5, 16384, v5
v_accvgpr_read_b32 v27, a23
v_cvt_pk_bf16_f32 v86, v24, v25
v_mfma_f32_16x16x32_bf16 a[64:67], a[180:183], a[224:227], a[64:67]
s_mov_b64 exec, 1
buffer_store_dword v17, v16, s[8:11], s29 offen sc1
s_mov_b64 exec, -1
v_cvt_pk_bf16_f32 v87, v26, v27
v_mfma_f32_16x16x32_bf16 a[68:71], a[180:183], a[228:231], a[68:71]
v_and_b32 v5, 65535, v5
v_xor_b32 v6, 16, v5
v_accvgpr_read_b32 v20, a24
v_accvgpr_read_b32 v21, a25
v_mfma_f32_16x16x32_bf16 a[72:75], a[180:183], a[232:235], a[72:75]
v_xor_b32 v7, 64, v5
v_xor_b32 v8, 80, v5
v_accvgpr_read_b32 v22, a26
v_accvgpr_read_b32 v23, a27
v_mfma_f32_16x16x32_bf16 a[76:79], a[180:183], a[236:239], a[76:79]
s_add_u32 s48, s48, s34
v_xor_b32 v9, 128, v5
v_xor_b32 v10, 144, v5
v_cvt_pk_bf16_f32 v90, v20, v21
v_cvt_pk_bf16_f32 v91, v22, v23
v_mfma_f32_16x16x32_bf16 a[80:83], a[180:183], a[240:243], a[80:83]
s_add_u32 m0, s32, 8192
v_xor_b32 v11, 192, v5
v_xor_b32 v12, 208, v5
v_accvgpr_read_b32 v24, a28
v_accvgpr_read_b32 v25, a29
v_mfma_f32_16x16x32_bf16 a[84:87], a[180:183], a[244:247], a[84:87]
buffer_load_dwordx4 v1, s[12:15], s48 offen lds
v_accvgpr_read_b32 v26, a30
v_accvgpr_read_b32 v27, a31
v_cvt_pk_bf16_f32 v94, v24, v25
v_mfma_f32_16x16x32_bf16 a[88:91], a[180:183], a[248:251], a[88:91]
v_cvt_pk_bf16_f32 v95, v26, v27
v_accvgpr_read_b32 v20, a32
v_accvgpr_read_b32 v21, a33
v_accvgpr_read_b32 v22, a34
v_mfma_f32_16x16x32_bf16 a[92:95], a[180:183], a[252:255], a[92:95]
ds_read_b128 a[180:183], v4 offset:9216
v_accvgpr_read_b32 v23, a35
v_cvt_pk_bf16_f32 v96, v20, v21
v_cvt_pk_bf16_f32 v97, v22, v23
v_mfma_f32_16x16x32_bf16 a[96:99], a[184:187], a[224:227], a[96:99]
v_accvgpr_read_b32 v24, a36
v_accvgpr_read_b32 v25, a37
v_accvgpr_read_b32 v26, a38
v_accvgpr_read_b32 v27, a39
v_mfma_f32_16x16x32_bf16 a[100:103], a[184:187], a[228:231], a[100:103]
v_cvt_pk_bf16_f32 v100, v24, v25
v_cvt_pk_bf16_f32 v101, v26, v27
v_accvgpr_read_b32 v20, a40
v_accvgpr_read_b32 v21, a41
v_mfma_f32_16x16x32_bf16 a[104:107], a[184:187], a[232:235], a[104:107]
s_add_u32 s48, s48, s34
v_accvgpr_read_b32 v22, a42
v_accvgpr_read_b32 v23, a43
v_cvt_pk_bf16_f32 v104, v20, v21
v_cvt_pk_bf16_f32 v105, v22, v23
v_mfma_f32_16x16x32_bf16 a[108:111], a[184:187], a[236:239], a[108:111]
s_add_u32 m0, s32, 12288
v_accvgpr_read_b32 v24, a44
v_accvgpr_read_b32 v25, a45
v_accvgpr_read_b32 v26, a46
v_accvgpr_read_b32 v27, a47
v_mfma_f32_16x16x32_bf16 a[112:115], a[184:187], a[240:243], a[112:115]
buffer_load_dwordx4 v1, s[12:15], s48 offen lds
v_cvt_pk_bf16_f32 v108, v24, v25
v_cvt_pk_bf16_f32 v109, v26, v27
v_accvgpr_read_b32 v20, a48
v_mfma_f32_16x16x32_bf16 a[116:119], a[184:187], a[244:247], a[116:119]
v_accvgpr_read_b32 v21, a49
v_accvgpr_read_b32 v22, a50
v_accvgpr_read_b32 v23, a51
v_cvt_pk_bf16_f32 v112, v20, v21
v_mfma_f32_16x16x32_bf16 a[120:123], a[184:187], a[248:251], a[120:123]
v_cvt_pk_bf16_f32 v113, v22, v23
v_accvgpr_read_b32 v24, a52
v_accvgpr_read_b32 v25, a53
v_accvgpr_read_b32 v26, a54
v_mfma_f32_16x16x32_bf16 a[124:127], a[184:187], a[252:255], a[124:127]
ds_read_b128 a[184:187], v3 offset:12288
v_accvgpr_read_b32 v27, a55
v_cvt_pk_bf16_f32 v116, v24, v25
v_cvt_pk_bf16_f32 v117, v26, v27
v_mfma_f32_16x16x32_bf16 a[128:131], v[28:31], a[224:227], a[128:131]
v_accvgpr_read_b32 v20, a56
v_accvgpr_read_b32 v21, a57
v_accvgpr_read_b32 v22, a58
v_accvgpr_read_b32 v23, a59
v_mfma_f32_16x16x32_bf16 a[132:135], v[28:31], a[228:231], a[132:135]
v_cvt_pk_bf16_f32 v120, v20, v21
v_cvt_pk_bf16_f32 v121, v22, v23
v_accvgpr_read_b32 v24, a60
v_accvgpr_read_b32 v25, a61
v_mfma_f32_16x16x32_bf16 a[136:139], v[28:31], a[232:235], a[136:139]
buffer_load_dword v15, v14, s[96:99], s100 offen
v_accvgpr_read_b32 v26, a62
v_accvgpr_read_b32 v27, a63
v_cvt_pk_bf16_f32 v124, v24, v25
v_mfma_f32_16x16x32_bf16 a[140:143], v[28:31], a[236:239], a[140:143]
s_add_u32 s100, s100, 16384
v_cvt_pk_bf16_f32 v125, v26, v27
v_mfma_f32_16x16x32_bf16 a[144:147], v[28:31], a[240:243], a[144:147]
v_mfma_f32_16x16x32_bf16 a[148:151], v[28:31], a[244:247], a[148:151]
v_mfma_f32_16x16x32_bf16 a[152:155], v[28:31], a[248:251], a[152:155]
v_mfma_f32_16x16x32_bf16 a[156:159], v[28:31], a[252:255], a[156:159]
s_cmp_lt_u32 s35, s45
s_cbranch_scc1 L_g_tile
s_branch L_g_end
.p2align 3
L_g_v:
s_waitcnt vmcnt(16) lgkmcnt(0)
s_barrier
v_mfma_f32_16x16x32_bf16 v[160:163], a[160:163], a[192:195], 0
ds_read_b64_tr_b16 a[224:225], v5 offset:0
v_accvgpr_read_b32 v20, a64
v_accvgpr_read_b32 v21, a65
v_accvgpr_read_b32 v22, a66
v_mfma_f32_16x16x32_bf16 v[164:167], a[160:163], a[196:199], 0
v_accvgpr_read_b32 v23, a67
v_cvt_pk_bf16_f32 v98, v20, v21
v_cvt_pk_bf16_f32 v99, v22, v23
v_accvgpr_read_b32 v24, a68
v_mfma_f32_16x16x32_bf16 v[168:171], a[160:163], a[200:203], 0
ds_read_b64_tr_b16 a[226:227], v5 offset:1024
v_accvgpr_read_b32 v25, a69
v_accvgpr_read_b32 v26, a70
v_accvgpr_read_b32 v27, a71
v_mfma_f32_16x16x32_bf16 v[172:175], a[160:163], a[204:207], 0
s_add_u32 s37, s31, 0
v_cvt_pk_bf16_f32 v102, v24, v25
v_cvt_pk_bf16_f32 v103, v26, v27
v_accvgpr_read_b32 v20, a72
v_accvgpr_read_b32 v21, a73
v_mfma_f32_16x16x32_bf16 v[176:179], a[160:163], a[208:211], 0
s_add_u32 m0, s33, 0
ds_read_b64_tr_b16 a[228:229], v6 offset:0
v_accvgpr_read_b32 v22, a74
v_accvgpr_read_b32 v23, a75
v_cvt_pk_bf16_f32 v106, v20, v21
v_mfma_f32_16x16x32_bf16 v[180:183], a[160:163], a[212:215], 0
buffer_load_dwordx4 v2, s[20:23], s37 offen  lds
v_cvt_pk_bf16_f32 v107, v22, v23
v_accvgpr_read_b32 v24, a76
v_accvgpr_read_b32 v25, a77
v_mfma_f32_16x16x32_bf16 v[184:187], a[160:163], a[216:219], 0
ds_read_b64_tr_b16 a[230:231], v6 offset:1024
v_accvgpr_read_b32 v26, a78
v_accvgpr_read_b32 v27, a79
v_cvt_pk_bf16_f32 v110, v24, v25
v_mfma_f32_16x16x32_bf16 v[188:191], a[160:163], a[220:223], 0
ds_read_b128 a[160:163], v4 offset:0
v_cvt_pk_bf16_f32 v111, v26, v27
v_accvgpr_read_b32 v20, a80
v_accvgpr_read_b32 v21, a81
v_mfma_f32_16x16x32_bf16 v[192:195], a[164:167], a[192:195], 0
ds_read_b64_tr_b16 a[232:233], v7 offset:0
v_accvgpr_read_b32 v22, a82
v_accvgpr_read_b32 v23, a83
v_cvt_pk_bf16_f32 v114, v20, v21
v_mfma_f32_16x16x32_bf16 v[196:199], a[164:167], a[196:199], 0
v_cvt_pk_bf16_f32 v115, v22, v23
v_accvgpr_read_b32 v24, a84
v_accvgpr_read_b32 v25, a85
v_accvgpr_read_b32 v26, a86
v_mfma_f32_16x16x32_bf16 v[200:203], a[164:167], a[200:203], 0
s_add_u32 s37, s31, 32768
ds_read_b64_tr_b16 a[234:235], v7 offset:1024
v_accvgpr_read_b32 v27, a87
v_cvt_pk_bf16_f32 v118, v24, v25
v_cvt_pk_bf16_f32 v119, v26, v27
v_mfma_f32_16x16x32_bf16 v[204:207], a[164:167], a[204:207], 0
s_add_u32 m0, s33, 1024
v_accvgpr_read_b32 v20, a88
v_accvgpr_read_b32 v21, a89
v_accvgpr_read_b32 v22, a90
v_accvgpr_read_b32 v23, a91
v_mfma_f32_16x16x32_bf16 v[208:211], a[164:167], a[208:211], 0
buffer_load_dwordx4 v2, s[20:23], s37 offen  lds
v_cvt_pk_bf16_f32 v122, v20, v21
v_cvt_pk_bf16_f32 v123, v22, v23
v_accvgpr_read_b32 v24, a92
v_mfma_f32_16x16x32_bf16 v[212:215], a[164:167], a[212:215], 0
ds_read_b64_tr_b16 a[236:237], v8 offset:0
v_accvgpr_read_b32 v25, a93
v_accvgpr_read_b32 v26, a94
v_accvgpr_read_b32 v27, a95
v_mfma_f32_16x16x32_bf16 v[216:219], a[164:167], a[216:219], 0
v_cvt_pk_bf16_f32 v126, v24, v25
v_cvt_pk_bf16_f32 v127, v26, v27
v_accvgpr_read_b32 v20, a96
v_accvgpr_read_b32 v21, a97
v_mfma_f32_16x16x32_bf16 v[220:223], a[164:167], a[220:223], 0
ds_read_b128 a[164:167], v3 offset:1024
v_accvgpr_read_b32 v22, a98
v_accvgpr_read_b32 v23, a99
v_cvt_pk_bf16_f32 v128, v20, v21
v_mfma_f32_16x16x32_bf16 v[224:227], a[168:171], a[192:195], 0
ds_read_b64_tr_b16 a[238:239], v8 offset:1024
v_cvt_pk_bf16_f32 v129, v22, v23
v_accvgpr_read_b32 v24, a100
v_accvgpr_read_b32 v25, a101
v_mfma_f32_16x16x32_bf16 v[228:231], a[168:171], a[196:199], 0
s_add_u32 s37, s31, 131072
v_accvgpr_read_b32 v26, a102
v_accvgpr_read_b32 v27, a103
v_cvt_pk_bf16_f32 v132, v24, v25
v_cvt_pk_bf16_f32 v133, v26, v27
v_mfma_f32_16x16x32_bf16 v[232:235], a[168:171], a[200:203], 0
s_add_u32 m0, s33, 4096
ds_read_b64_tr_b16 a[240:241], v9 offset:0
v_accvgpr_read_b32 v20, a104
v_accvgpr_read_b32 v21, a105
v_accvgpr_read_b32 v22, a106
v_mfma_f32_16x16x32_bf16 v[236:239], a[168:171], a[204:207], 0
buffer_load_dwordx4 v2, s[20:23], s37 offen  lds
v_accvgpr_read_b32 v23, a107
v_cvt_pk_bf16_f32 v136, v20, v21
v_cvt_pk_bf16_f32 v137, v22, v23
v_mfma_f32_16x16x32_bf16 v[240:243], a[168:171], a[208:211], 0
ds_read_b64_tr_b16 a[242:243], v9 offset:1024
v_accvgpr_read_b32 v24, a108
v_accvgpr_read_b32 v25, a109
v_accvgpr_read_b32 v26, a110
v_mfma_f32_16x16x32_bf16 v[244:247], a[168:171], a[212:215], 0
v_accvgpr_read_b32 v27, a111
v_cvt_pk_bf16_f32 v140, v24, v25
v_cvt_pk_bf16_f32 v141, v26, v27
v_accvgpr_read_b32 v20, a112
v_mfma_f32_16x16x32_bf16 v[248:251], a[168:171], a[216:219], 0
ds_read_b64_tr_b16 a[244:245], v10 offset:0
v_accvgpr_read_b32 v21, a113
v_accvgpr_read_b32 v22, a114
v_accvgpr_read_b32 v23, a115
v_mfma_f32_16x16x32_bf16 v[252:255], a[168:171], a[220:223], 0
ds_read_b128 a[168:171], v4 offset:4096
v_cvt_pk_bf16_f32 v144, v20, v21
v_cvt_pk_bf16_f32 v145, v22, v23
v_accvgpr_read_b32 v24, a116
v_mfma_f32_16x16x32_bf16 a[0:3], a[172:175], a[192:195], 0
s_add_u32 s37, s31, 163840
ds_read_b64_tr_b16 a[246:247], v10 offset:1024
v_accvgpr_read_b32 v25, a117
v_accvgpr_read_b32 v26, a118
v_accvgpr_read_b32 v27, a119
v_mfma_f32_16x16x32_bf16 a[4:7], a[172:175], a[196:199], 0
s_add_u32 m0, s33, 5120
v_cvt_pk_bf16_f32 v148, v24, v25
v_cvt_pk_bf16_f32 v149, v26, v27
v_accvgpr_read_b32 v20, a120
v_accvgpr_read_b32 v21, a121
v_mfma_f32_16x16x32_bf16 a[8:11], a[172:175], a[200:203], 0
buffer_load_dwordx4 v2, s[20:23], s37 offen  lds
v_accvgpr_read_b32 v22, a122
v_accvgpr_read_b32 v23, a123
v_cvt_pk_bf16_f32 v152, v20, v21
v_mfma_f32_16x16x32_bf16 a[12:15], a[172:175], a[204:207], 0
s_add_u32 s31, s31, 262144
ds_read_b64_tr_b16 a[248:249], v11 offset:0
v_cvt_pk_bf16_f32 v153, v22, v23
v_accvgpr_read_b32 v24, a124
v_accvgpr_read_b32 v25, a125
v_mfma_f32_16x16x32_bf16 a[16:19], a[172:175], a[208:211], 0
s_add_u32 s33, s33, 16384
v_accvgpr_read_b32 v26, a126
v_accvgpr_read_b32 v27, a127
v_cvt_pk_bf16_f32 v156, v24, v25
v_cvt_pk_bf16_f32 v157, v26, v27
v_mfma_f32_16x16x32_bf16 a[20:23], a[172:175], a[212:215], 0
s_and_b32 s33, s33, 65535
ds_read_b64_tr_b16 a[250:251], v11 offset:1024
v_accvgpr_read_b32 v20, a128
v_accvgpr_read_b32 v21, a129
v_accvgpr_read_b32 v22, a130
v_mfma_f32_16x16x32_bf16 a[24:27], a[172:175], a[216:219], 0
v_accvgpr_read_b32 v23, a131
v_cvt_pk_bf16_f32 v130, v20, v21
v_cvt_pk_bf16_f32 v131, v22, v23
v_accvgpr_read_b32 v24, a132
v_mfma_f32_16x16x32_bf16 a[28:31], a[172:175], a[220:223], 0
s_add_u32 s48, s48, s34
ds_read_b128 a[172:175], v3 offset:5120
v_accvgpr_read_b32 v25, a133
v_accvgpr_read_b32 v26, a134
v_accvgpr_read_b32 v27, a135
v_mfma_f32_16x16x32_bf16 a[32:35], a[176:179], a[192:195], 0
s_add_u32 m0, s32, 16384
ds_read_b64_tr_b16 a[252:253], v12 offset:0
v_cvt_pk_bf16_f32 v134, v24, v25
v_cvt_pk_bf16_f32 v135, v26, v27
v_accvgpr_read_b32 v20, a136
v_mfma_f32_16x16x32_bf16 a[36:39], a[176:179], a[196:199], 0
buffer_load_dwordx4 v1, s[12:15], s48 offen lds
v_accvgpr_read_b32 v21, a137
v_accvgpr_read_b32 v22, a138
v_accvgpr_read_b32 v23, a139
v_mfma_f32_16x16x32_bf16 a[40:43], a[176:179], a[200:203], 0
ds_read_b64_tr_b16 a[254:255], v12 offset:1024
v_cvt_pk_bf16_f32 v138, v20, v21
v_cvt_pk_bf16_f32 v139, v22, v23
v_accvgpr_read_b32 v24, a140
v_mfma_f32_16x16x32_bf16 a[44:47], a[176:179], a[204:207], 0
v_accvgpr_read_b32 v25, a141
v_accvgpr_read_b32 v26, a142
v_accvgpr_read_b32 v27, a143
v_cvt_pk_bf16_f32 v142, v24, v25
v_mfma_f32_16x16x32_bf16 a[48:51], a[176:179], a[208:211], 0
ds_read_b128 v[28:31], v3 offset:13312
v_cvt_pk_bf16_f32 v143, v26, v27
v_accvgpr_read_b32 v20, a144
v_accvgpr_read_b32 v21, a145
s_mov_b32 s38, s62
s_mov_b32 s39, s63
v_mfma_f32_16x16x32_bf16 a[52:55], a[176:179], a[212:215], 0
v_accvgpr_read_b32 v22, a146
v_accvgpr_read_b32 v23, a147
v_cvt_pk_bf16_f32 v146, v20, v21
v_cvt_pk_bf16_f32 v147, v22, v23
s_mov_b32 s49, s50
s_mov_b32 s62, s42
v_mfma_f32_16x16x32_bf16 a[56:59], a[176:179], a[216:219], 0
s_add_u32 s48, s48, s34
v_accvgpr_read_b32 v24, a148
v_accvgpr_read_b32 v25, a149
v_accvgpr_read_b32 v26, a150
v_accvgpr_read_b32 v27, a151
s_mov_b32 s63, s43
s_mov_b32 s50, s51
v_mfma_f32_16x16x32_bf16 a[60:63], a[176:179], a[220:223], 0
s_add_u32 m0, s32, 20480
ds_read_b128 a[176:179], v4 offset:8192
v_add_u32 v5, 16384, v5
v_cvt_pk_bf16_f32 v150, v24, v25
v_cvt_pk_bf16_f32 v151, v26, v27
s_mov_b32 s36, s40
s_add_u32 s35, s35, 1
v_mfma_f32_16x16x32_bf16 a[64:67], a[180:183], a[192:195], 0
buffer_load_dwordx4 v1, s[12:15], s48 offen lds
v_and_b32 v5, 65535, v5
v_accvgpr_read_b32 v20, a152
v_accvgpr_read_b32 v21, a153
v_bfe_u32 v16, v0, 3, 3
v_lshlrev_b32 v16, 4, v16
v_mfma_f32_16x16x32_bf16 a[68:71], a[180:183], a[196:199], 0
v_xor_b32 v6, 16, v5
v_xor_b32 v7, 64, v5
v_accvgpr_read_b32 v22, a154
v_accvgpr_read_b32 v23, a155
v_and_or_b32 v16, v0, 7, v16
v_bfe_u32 v17, v0, 4, 2
v_mfma_f32_16x16x32_bf16 a[72:75], a[180:183], a[200:203], 0
v_xor_b32 v8, 80, v5
v_xor_b32 v9, 128, v5
v_cvt_pk_bf16_f32 v154, v20, v21
v_cvt_pk_bf16_f32 v155, v22, v23
v_lshlrev_b32 v17, 5, v17
v_bfe_u32 v18, v0, 1, 3
v_mfma_f32_16x16x32_bf16 a[76:79], a[180:183], a[204:207], 0
v_xor_b32 v10, 144, v5
v_xor_b32 v11, 192, v5
v_accvgpr_read_b32 v24, a156
v_accvgpr_read_b32 v25, a157
v_or_b32 v17, v17, v18
v_and_b32 v18, 1, v0
v_mfma_f32_16x16x32_bf16 a[80:83], a[180:183], a[208:211], 0
v_xor_b32 v12, 208, v5
v_accvgpr_read_b32 v26, a158
v_accvgpr_read_b32 v27, a159
v_cvt_pk_bf16_f32 v158, v24, v25
v_lshl_or_b32 v17, v18, 4, v17
v_mfma_f32_16x16x32_bf16 a[84:87], a[180:183], a[212:215], 0
s_add_u32 s48, s48, s34
v_cvt_pk_bf16_f32 v159, v26, v27
s_bitcmp1_b32 s49, 1
s_cselect_b64 vcc, -1, 0
s_movk_i32 s44, 0x80
v_cndmask_b32 v16, v16, v17, vcc
v_lshlrev_b32 v13, 4, v16
v_mfma_f32_16x16x32_bf16 a[88:91], a[180:183], a[216:219], 0
s_add_u32 m0, s32, 24576
s_lshr_b32 s93, s49, 2
s_lshr_b32 s93, 0x80000, s93
s_bitcmp1_b32 s49, 0
s_cselect_b32 s92, s93, 0x800
s_cselect_b32 s93, 0x800, s93
s_sub_u32 s93, s93, s44
v_mfma_f32_16x16x32_bf16 a[92:95], a[180:183], a[220:223], 0
buffer_load_dwordx4 v1, s[12:15], s48 offen lds
ds_read_b128 a[180:183], v3 offset:9216
v_mfma_f32_16x16x32_bf16 a[96:99], a[184:187], a[192:195], 0
v_mfma_f32_16x16x32_bf16 a[100:103], a[184:187], a[196:199], 0
v_mfma_f32_16x16x32_bf16 a[104:107], a[184:187], a[200:203], 0
v_mfma_f32_16x16x32_bf16 a[108:111], a[184:187], a[204:207], 0
v_mfma_f32_16x16x32_bf16 a[112:115], a[184:187], a[208:211], 0
s_add_u32 s48, s48, s34
v_mfma_f32_16x16x32_bf16 a[116:119], a[184:187], a[212:215], 0
s_add_u32 m0, s32, 28672
v_mfma_f32_16x16x32_bf16 a[120:123], a[184:187], a[216:219], 0
buffer_load_dwordx4 v1, s[12:15], s48 offen lds
v_mfma_f32_16x16x32_bf16 a[124:127], a[184:187], a[220:223], 0
s_add_u32 s30, s30, 128
ds_read_b128 a[184:187], v4 offset:12288
v_mfma_f32_16x16x32_bf16 a[128:131], a[188:191], a[192:195], 0
s_add_u32 s32, s32, 32768
v_add_u32 v3, 32768, v3
v_mfma_f32_16x16x32_bf16 a[132:135], a[188:191], a[196:199], 0
s_sub_u32 s48, s32, 98304
v_subrev_u32 v19, 98304, v3
v_mfma_f32_16x16x32_bf16 a[136:139], a[188:191], a[200:203], 0
s_cmp_ge_u32 s32, 163840
s_cselect_b32 s32, s48, s32
buffer_load_dword v15, v14, s[96:99], s100 offen
v_mfma_f32_16x16x32_bf16 a[140:143], a[188:191], a[204:207], 0
s_add_u32 s100, s100, 16384
v_cmp_le_u32 vcc, 163840, v3
v_mfma_f32_16x16x32_bf16 a[144:147], a[188:191], a[208:211], 0
s_nop 0
v_cndmask_b32 v3, v3, v19, vcc
v_mfma_f32_16x16x32_bf16 a[148:151], a[188:191], a[212:215], 0
v_xor_b32 v4, 64, v3
v_mfma_f32_16x16x32_bf16 a[152:155], a[188:191], a[216:219], 0
v_mfma_f32_16x16x32_bf16 a[156:159], a[188:191], a[220:223], 0
s_waitcnt vmcnt(17) lgkmcnt(0)
s_barrier
v_mfma_f32_16x16x32_bf16 v[160:163], a[160:163], a[224:227], v[160:163]
ds_read_b64_tr_b16 a[192:193], v5 offset:0
v_mfma_f32_16x16x32_bf16 v[164:167], a[160:163], a[228:231], v[164:167]
v_mfma_f32_16x16x32_bf16 v[168:171], a[160:163], a[232:235], v[168:171]
ds_read_b64_tr_b16 a[194:195], v5 offset:1024
v_mfma_f32_16x16x32_bf16 v[172:175], a[160:163], a[236:239], v[172:175]
s_add_u32 s37, s31, 0
v_mfma_f32_16x16x32_bf16 v[176:179], a[160:163], a[240:243], v[176:179]
s_add_u32 m0, s33, 0
ds_read_b64_tr_b16 a[196:197], v6 offset:0
v_mfma_f32_16x16x32_bf16 v[180:183], a[160:163], a[244:247], v[180:183]
buffer_load_dwordx4 v2, s[20:23], s37 offen  lds
v_mfma_f32_16x16x32_bf16 v[184:187], a[160:163], a[248:251], v[184:187]
ds_read_b64_tr_b16 a[198:199], v6 offset:1024
v_mfma_f32_16x16x32_bf16 v[188:191], a[160:163], a[252:255], v[188:191]
ds_read_b128 a[160:163], v3 offset:0
v_mfma_f32_16x16x32_bf16 v[192:195], a[164:167], a[224:227], v[192:195]
ds_read_b64_tr_b16 a[200:201], v7 offset:0
v_mfma_f32_16x16x32_bf16 v[196:199], a[164:167], a[228:231], v[196:199]
v_mfma_f32_16x16x32_bf16 v[200:203], a[164:167], a[232:235], v[200:203]
s_add_u32 s37, s31, 32768
ds_read_b64_tr_b16 a[202:203], v7 offset:1024
v_mfma_f32_16x16x32_bf16 v[204:207], a[164:167], a[236:239], v[204:207]
s_add_u32 m0, s33, 1024
v_mfma_f32_16x16x32_bf16 v[208:211], a[164:167], a[240:243], v[208:211]
buffer_load_dwordx4 v2, s[20:23], s37 offen  lds
v_mfma_f32_16x16x32_bf16 v[212:215], a[164:167], a[244:247], v[212:215]
ds_read_b64_tr_b16 a[204:205], v8 offset:0
v_mfma_f32_16x16x32_bf16 v[216:219], a[164:167], a[248:251], v[216:219]
s_mov_b32 s60, s38
v_mfma_f32_16x16x32_bf16 v[220:223], a[164:167], a[252:255], v[220:223]
s_mov_b32 s29, s38
ds_read_b128 a[164:167], v4 offset:1024
v_mfma_f32_16x16x32_bf16 v[224:227], a[168:171], a[224:227], v[224:227]
buffer_store_dwordx4 v[32:35], v13, s[8:11], s29 offen sc1
v_mfma_f32_16x16x32_bf16 v[228:231], a[168:171], a[228:231], v[228:231]
s_add_u32 s37, s31, 131072
ds_read_b64_tr_b16 a[206:207], v8 offset:1024
v_mfma_f32_16x16x32_bf16 v[232:235], a[168:171], a[232:235], v[232:235]
s_add_u32 m0, s33, 4096
v_mfma_f32_16x16x32_bf16 v[236:239], a[168:171], a[236:239], v[236:239]
buffer_load_dwordx4 v2, s[20:23], s37 offen  lds
v_mfma_f32_16x16x32_bf16 v[240:243], a[168:171], a[240:243], v[240:243]
ds_read_b64_tr_b16 a[208:209], v9 offset:0
v_mfma_f32_16x16x32_bf16 v[244:247], a[168:171], a[244:247], v[244:247]
v_mfma_f32_16x16x32_bf16 v[248:251], a[168:171], a[248:251], v[248:251]
ds_read_b64_tr_b16 a[210:211], v9 offset:1024
v_mfma_f32_16x16x32_bf16 v[252:255], a[168:171], a[252:255], v[252:255]
ds_read_b128 a[168:171], v3 offset:4096
v_mfma_f32_16x16x32_bf16 a[0:3], a[172:175], a[224:227], a[0:3]
s_add_u32 s37, s31, 163840
ds_read_b64_tr_b16 a[212:213], v10 offset:0
v_mfma_f32_16x16x32_bf16 a[4:7], a[172:175], a[228:231], a[4:7]
s_add_u32 m0, s33, 5120
v_mfma_f32_16x16x32_bf16 a[8:11], a[172:175], a[232:235], a[8:11]
buffer_load_dwordx4 v2, s[20:23], s37 offen  lds
v_mfma_f32_16x16x32_bf16 a[12:15], a[172:175], a[236:239], a[12:15]
s_add_u32 s31, s31, 262144
ds_read_b64_tr_b16 a[214:215], v10 offset:1024
v_mfma_f32_16x16x32_bf16 a[16:19], a[172:175], a[240:243], a[16:19]
s_add_u32 s33, s33, 16384
v_mfma_f32_16x16x32_bf16 a[20:23], a[172:175], a[244:247], a[20:23]
s_and_b32 s33, s33, 65535
ds_read_b64_tr_b16 a[216:217], v11 offset:0
v_mfma_f32_16x16x32_bf16 a[24:27], a[172:175], a[248:251], a[24:27]
v_mfma_f32_16x16x32_bf16 a[28:31], a[172:175], a[252:255], a[28:31]
s_mov_b32 s48, s30
ds_read_b128 a[172:175], v4 offset:5120
v_mfma_f32_16x16x32_bf16 a[32:35], a[176:179], a[224:227], a[32:35]
s_add_u32 m0, s32, 0
ds_read_b64_tr_b16 a[218:219], v11 offset:1024
v_mfma_f32_16x16x32_bf16 a[36:39], a[176:179], a[228:231], a[36:39]
buffer_load_dwordx4 v1, s[12:15], s48 offen lds
v_mfma_f32_16x16x32_bf16 a[40:43], a[176:179], a[232:235], a[40:43]
ds_read_b64_tr_b16 a[220:221], v12 offset:0
v_mfma_f32_16x16x32_bf16 a[44:47], a[176:179], a[236:239], a[44:47]
s_add_u32 s29, s29, s44
v_mfma_f32_16x16x32_bf16 a[48:51], a[176:179], a[240:243], a[48:51]
ds_read_b64_tr_b16 a[222:223], v12 offset:1024
v_mfma_f32_16x16x32_bf16 a[52:55], a[176:179], a[244:247], a[52:55]
buffer_store_dwordx4 v[36:39], v13, s[8:11], s29 offen sc1
v_mfma_f32_16x16x32_bf16 a[56:59], a[176:179], a[248:251], a[56:59]
s_add_u32 s48, s48, s34
ds_read_b128 a[188:191], v4 offset:13312
v_mfma_f32_16x16x32_bf16 a[60:63], a[176:179], a[252:255], a[60:63]
s_add_u32 m0, s32, 4096
ds_read_b128 a[176:179], v3 offset:8192
v_mfma_f32_16x16x32_bf16 a[64:67], a[180:183], a[224:227], a[64:67]
buffer_load_dwordx4 v1, s[12:15], s48 offen lds
v_mfma_f32_16x16x32_bf16 a[68:71], a[180:183], a[228:231], a[68:71]
v_add_u32 v5, 16384, v5
v_and_b32 v5, 65535, v5
v_mfma_f32_16x16x32_bf16 a[72:75], a[180:183], a[232:235], a[72:75]
v_xor_b32 v6, 16, v5
v_xor_b32 v7, 64, v5
v_mfma_f32_16x16x32_bf16 a[76:79], a[180:183], a[236:239], a[76:79]
v_xor_b32 v8, 80, v5
v_xor_b32 v9, 128, v5
v_mfma_f32_16x16x32_bf16 a[80:83], a[180:183], a[240:243], a[80:83]
v_xor_b32 v10, 144, v5
v_xor_b32 v11, 192, v5
v_mfma_f32_16x16x32_bf16 a[84:87], a[180:183], a[244:247], a[84:87]
s_add_u32 s48, s48, s34
v_xor_b32 v12, 208, v5
v_mfma_f32_16x16x32_bf16 a[88:91], a[180:183], a[248:251], a[88:91]
s_add_u32 m0, s32, 8192
v_mfma_f32_16x16x32_bf16 a[92:95], a[180:183], a[252:255], a[92:95]
buffer_load_dwordx4 v1, s[12:15], s48 offen lds
ds_read_b128 a[180:183], v4 offset:9216
v_mfma_f32_16x16x32_bf16 a[96:99], a[184:187], a[224:227], a[96:99]
v_mfma_f32_16x16x32_bf16 a[100:103], a[184:187], a[228:231], a[100:103]
v_mfma_f32_16x16x32_bf16 a[104:107], a[184:187], a[232:235], a[104:107]
v_mfma_f32_16x16x32_bf16 a[108:111], a[184:187], a[236:239], a[108:111]
v_mfma_f32_16x16x32_bf16 a[112:115], a[184:187], a[240:243], a[112:115]
s_add_u32 s48, s48, s34
v_mfma_f32_16x16x32_bf16 a[116:119], a[184:187], a[244:247], a[116:119]
s_add_u32 m0, s32, 12288
v_mfma_f32_16x16x32_bf16 a[120:123], a[184:187], a[248:251], a[120:123]
buffer_load_dwordx4 v1, s[12:15], s48 offen lds
v_mfma_f32_16x16x32_bf16 a[124:127], a[184:187], a[252:255], a[124:127]
ds_read_b128 a[184:187], v3 offset:12288
v_mfma_f32_16x16x32_bf16 a[128:131], v[28:31], a[224:227], a[128:131]
s_add_u32 s29, s29, s93
v_mfma_f32_16x16x32_bf16 a[132:135], v[28:31], a[228:231], a[132:135]
v_mfma_f32_16x16x32_bf16 a[136:139], v[28:31], a[232:235], a[136:139]
buffer_store_dwordx4 v[40:43], v13, s[8:11], s29 offen sc1
buffer_load_dword v15, v14, s[96:99], s100 offen
v_mfma_f32_16x16x32_bf16 a[140:143], v[28:31], a[236:239], a[140:143]
s_add_u32 s100, s100, 16384
v_mfma_f32_16x16x32_bf16 a[144:147], v[28:31], a[240:243], a[144:147]
v_mfma_f32_16x16x32_bf16 a[148:151], v[28:31], a[244:247], a[148:151]
v_mfma_f32_16x16x32_bf16 a[152:155], v[28:31], a[248:251], a[152:155]
v_mfma_f32_16x16x32_bf16 a[156:159], v[28:31], a[252:255], a[156:159]
s_waitcnt vmcnt(21) lgkmcnt(0)
s_barrier
v_mfma_f32_16x16x32_bf16 v[160:163], a[160:163], a[192:195], v[160:163]
ds_read_b64_tr_b16 a[224:225], v5 offset:0
v_mfma_f32_16x16x32_bf16 v[164:167], a[160:163], a[196:199], v[164:167]
v_mfma_f32_16x16x32_bf16 v[168:171], a[160:163], a[200:203], v[168:171]
ds_read_b64_tr_b16 a[226:227], v5 offset:1024
v_mfma_f32_16x16x32_bf16 v[172:175], a[160:163], a[204:207], v[172:175]
s_add_u32 s37, s31, 0
v_mfma_f32_16x16x32_bf16 v[176:179], a[160:163], a[208:211], v[176:179]
s_add_u32 m0, s33, 0
ds_read_b64_tr_b16 a[228:229], v6 offset:0
v_mfma_f32_16x16x32_bf16 v[180:183], a[160:163], a[212:215], v[180:183]
buffer_load_dwordx4 v2, s[20:23], s37 offen  lds
v_mfma_f32_16x16x32_bf16 v[184:187], a[160:163], a[216:219], v[184:187]
ds_read_b64_tr_b16 a[230:231], v6 offset:1024
v_mfma_f32_16x16x32_bf16 v[188:191], a[160:163], a[220:223], v[188:191]
ds_read_b128 a[160:163], v4 offset:0
v_mfma_f32_16x16x32_bf16 v[192:195], a[164:167], a[192:195], v[192:195]
ds_read_b64_tr_b16 a[232:233], v7 offset:0
v_mfma_f32_16x16x32_bf16 v[196:199], a[164:167], a[196:199], v[196:199]
v_mfma_f32_16x16x32_bf16 v[200:203], a[164:167], a[200:203], v[200:203]
s_add_u32 s37, s31, 32768
ds_read_b64_tr_b16 a[234:235], v7 offset:1024
v_mfma_f32_16x16x32_bf16 v[204:207], a[164:167], a[204:207], v[204:207]
s_add_u32 m0, s33, 1024
v_mfma_f32_16x16x32_bf16 v[208:211], a[164:167], a[208:211], v[208:211]
buffer_load_dwordx4 v2, s[20:23], s37 offen  lds
v_mfma_f32_16x16x32_bf16 v[212:215], a[164:167], a[212:215], v[212:215]
ds_read_b64_tr_b16 a[236:237], v8 offset:0
v_mfma_f32_16x16x32_bf16 v[216:219], a[164:167], a[216:219], v[216:219]
s_add_u32 s29, s29, s44
v_mfma_f32_16x16x32_bf16 v[220:223], a[164:167], a[220:223], v[220:223]
ds_read_b128 a[164:167], v3 offset:1024
v_mfma_f32_16x16x32_bf16 v[224:227], a[168:171], a[192:195], v[224:227]
buffer_store_dwordx4 v[44:47], v13, s[8:11], s29 offen sc1
v_mfma_f32_16x16x32_bf16 v[228:231], a[168:171], a[196:199], v[228:231]
s_add_u32 s37, s31, 131072
ds_read_b64_tr_b16 a[238:239], v8 offset:1024
v_mfma_f32_16x16x32_bf16 v[232:235], a[168:171], a[200:203], v[232:235]
s_add_u32 m0, s33, 4096
v_mfma_f32_16x16x32_bf16 v[236:239], a[168:171], a[204:207], v[236:239]
buffer_load_dwordx4 v2, s[20:23], s37 offen  lds
v_mfma_f32_16x16x32_bf16 v[240:243], a[168:171], a[208:211], v[240:243]
ds_read_b64_tr_b16 a[240:241], v9 offset:0
v_mfma_f32_16x16x32_bf16 v[244:247], a[168:171], a[212:215], v[244:247]
v_mfma_f32_16x16x32_bf16 v[248:251], a[168:171], a[216:219], v[248:251]
ds_read_b64_tr_b16 a[242:243], v9 offset:1024
v_mfma_f32_16x16x32_bf16 v[252:255], a[168:171], a[220:223], v[252:255]
ds_read_b128 a[168:171], v4 offset:4096
v_mfma_f32_16x16x32_bf16 a[0:3], a[172:175], a[192:195], a[0:3]
s_add_u32 s37, s31, 163840
ds_read_b64_tr_b16 a[244:245], v10 offset:0
v_mfma_f32_16x16x32_bf16 a[4:7], a[172:175], a[196:199], a[4:7]
s_add_u32 m0, s33, 5120
v_mfma_f32_16x16x32_bf16 a[8:11], a[172:175], a[200:203], a[8:11]
buffer_load_dwordx4 v2, s[20:23], s37 offen  lds
v_mfma_f32_16x16x32_bf16 a[12:15], a[172:175], a[204:207], a[12:15]
s_add_u32 s31, s31, 262144
ds_read_b64_tr_b16 a[246:247], v10 offset:1024
v_mfma_f32_16x16x32_bf16 a[16:19], a[172:175], a[208:211], a[16:19]
s_add_u32 s33, s33, 16384
v_mfma_f32_16x16x32_bf16 a[20:23], a[172:175], a[212:215], a[20:23]
s_and_b32 s33, s33, 65535
ds_read_b64_tr_b16 a[248:249], v11 offset:0
v_mfma_f32_16x16x32_bf16 a[24:27], a[172:175], a[216:219], a[24:27]
v_mfma_f32_16x16x32_bf16 a[28:31], a[172:175], a[220:223], a[28:31]
s_add_u32 s48, s48, s34
ds_read_b128 a[172:175], v3 offset:5120
v_mfma_f32_16x16x32_bf16 a[32:35], a[176:179], a[192:195], a[32:35]
s_add_u32 m0, s32, 16384
ds_read_b64_tr_b16 a[250:251], v11 offset:1024
v_mfma_f32_16x16x32_bf16 a[36:39], a[176:179], a[196:199], a[36:39]
buffer_load_dwordx4 v1, s[12:15], s48 offen lds
v_mfma_f32_16x16x32_bf16 a[40:43], a[176:179], a[200:203], a[40:43]
ds_read_b64_tr_b16 a[252:253], v12 offset:0
v_mfma_f32_16x16x32_bf16 a[44:47], a[176:179], a[204:207], a[44:47]
s_add_u32 s29, s29, s93
v_mfma_f32_16x16x32_bf16 a[48:51], a[176:179], a[208:211], a[48:51]
ds_read_b64_tr_b16 a[254:255], v12 offset:1024
v_mfma_f32_16x16x32_bf16 a[52:55], a[176:179], a[212:215], a[52:55]
buffer_store_dwordx4 v[48:51], v13, s[8:11], s29 offen sc1
v_mfma_f32_16x16x32_bf16 a[56:59], a[176:179], a[216:219], a[56:59]
s_add_u32 s48, s48, s34
ds_read_b128 v[28:31], v3 offset:13312
v_mfma_f32_16x16x32_bf16 a[60:63], a[176:179], a[220:223], a[60:63]
s_add_u32 m0, s32, 20480
ds_read_b128 a[176:179], v4 offset:8192
v_mfma_f32_16x16x32_bf16 a[64:67], a[180:183], a[192:195], a[64:67]
buffer_load_dwordx4 v1, s[12:15], s48 offen lds
v_mfma_f32_16x16x32_bf16 a[68:71], a[180:183], a[196:199], a[68:71]
v_add_u32 v5, 16384, v5
v_and_b32 v5, 65535, v5
v_mfma_f32_16x16x32_bf16 a[72:75], a[180:183], a[200:203], a[72:75]
v_xor_b32 v6, 16, v5
v_xor_b32 v7, 64, v5
v_mfma_f32_16x16x32_bf16 a[76:79], a[180:183], a[204:207], a[76:79]
v_xor_b32 v8, 80, v5
v_xor_b32 v9, 128, v5
v_mfma_f32_16x16x32_bf16 a[80:83], a[180:183], a[208:211], a[80:83]
v_xor_b32 v10, 144, v5
v_xor_b32 v11, 192, v5
v_mfma_f32_16x16x32_bf16 a[84:87], a[180:183], a[212:215], a[84:87]
s_add_u32 s48, s48, s34
v_xor_b32 v12, 208, v5
v_mfma_f32_16x16x32_bf16 a[88:91], a[180:183], a[216:219], a[88:91]
s_add_u32 m0, s32, 24576
v_mfma_f32_16x16x32_bf16 a[92:95], a[180:183], a[220:223], a[92:95]
buffer_load_dwordx4 v1, s[12:15], s48 offen lds
ds_read_b128 a[180:183], v3 offset:9216
v_mfma_f32_16x16x32_bf16 a[96:99], a[184:187], a[192:195], a[96:99]
v_mfma_f32_16x16x32_bf16 a[100:103], a[184:187], a[196:199], a[100:103]
v_mfma_f32_16x16x32_bf16 a[104:107], a[184:187], a[200:203], a[104:107]
v_mfma_f32_16x16x32_bf16 a[108:111], a[184:187], a[204:207], a[108:111]
v_mfma_f32_16x16x32_bf16 a[112:115], a[184:187], a[208:211], a[112:115]
s_add_u32 s48, s48, s34
v_mfma_f32_16x16x32_bf16 a[116:119], a[184:187], a[212:215], a[116:119]
s_add_u32 m0, s32, 28672
v_mfma_f32_16x16x32_bf16 a[120:123], a[184:187], a[216:219], a[120:123]
buffer_load_dwordx4 v1, s[12:15], s48 offen lds
v_mfma_f32_16x16x32_bf16 a[124:127], a[184:187], a[220:223], a[124:127]
s_add_u32 s30, s30, 128
ds_read_b128 a[184:187], v4 offset:12288
v_mfma_f32_16x16x32_bf16 a[128:131], a[188:191], a[192:195], a[128:131]
s_add_u32 s32, s32, 32768
s_add_u32 s29, s29, s44
v_add_u32 v3, 32768, v3
v_mfma_f32_16x16x32_bf16 a[132:135], a[188:191], a[196:199], a[132:135]
s_sub_u32 s48, s32, 98304
v_subrev_u32 v19, 98304, v3
v_mfma_f32_16x16x32_bf16 a[136:139], a[188:191], a[200:203], a[136:139]
s_cmp_ge_u32 s32, 163840
s_cselect_b32 s32, s48, s32
buffer_store_dwordx4 v[52:55], v13, s[8:11], s29 offen sc1
buffer_load_dword v15, v14, s[96:99], s100 offen
v_mfma_f32_16x16x32_bf16 a[140:143], a[188:191], a[204:207], a[140:143]
s_add_u32 s100, s100, 16384
v_cmp_le_u32 vcc, 163840, v3
v_mfma_f32_16x16x32_bf16 a[144:147], a[188:191], a[208:211], a[144:147]
s_nop 0
v_cndmask_b32 v3, v3, v19, vcc
v_mfma_f32_16x16x32_bf16 a[148:151], a[188:191], a[212:215], a[148:151]
v_xor_b32 v4, 64, v3
v_mfma_f32_16x16x32_bf16 a[152:155], a[188:191], a[216:219], a[152:155]
v_mfma_f32_16x16x32_bf16 a[156:159], a[188:191], a[220:223], a[156:159]
s_waitcnt vmcnt(24) lgkmcnt(0)
s_barrier
v_mfma_f32_16x16x32_bf16 v[160:163], a[160:163], a[224:227], v[160:163]
ds_read_b64_tr_b16 a[192:193], v5 offset:0
v_mfma_f32_16x16x32_bf16 v[164:167], a[160:163], a[228:231], v[164:167]
v_mfma_f32_16x16x32_bf16 v[168:171], a[160:163], a[232:235], v[168:171]
ds_read_b64_tr_b16 a[194:195], v5 offset:1024
v_mfma_f32_16x16x32_bf16 v[172:175], a[160:163], a[236:239], v[172:175]
s_add_u32 s37, s31, 0
v_mfma_f32_16x16x32_bf16 v[176:179], a[160:163], a[240:243], v[176:179]
s_add_u32 m0, s33, 0
ds_read_b64_tr_b16 a[196:197], v6 offset:0
v_mfma_f32_16x16x32_bf16 v[180:183], a[160:163], a[244:247], v[180:183]
buffer_load_dwordx4 v2, s[20:23], s37 offen  lds
v_mfma_f32_16x16x32_bf16 v[184:187], a[160:163], a[248:251], v[184:187]
ds_read_b64_tr_b16 a[198:199], v6 offset:1024
v_mfma_f32_16x16x32_bf16 v[188:191], a[160:163], a[252:255], v[188:191]
ds_read_b128 a[160:163], v3 offset:0
v_mfma_f32_16x16x32_bf16 v[192:195], a[164:167], a[224:227], v[192:195]
ds_read_b64_tr_b16 a[200:201], v7 offset:0
v_mfma_f32_16x16x32_bf16 v[196:199], a[164:167], a[228:231], v[196:199]
v_mfma_f32_16x16x32_bf16 v[200:203], a[164:167], a[232:235], v[200:203]
s_add_u32 s37, s31, 32768
ds_read_b64_tr_b16 a[202:203], v7 offset:1024
v_mfma_f32_16x16x32_bf16 v[204:207], a[164:167], a[236:239], v[204:207]
s_add_u32 m0, s33, 1024
v_mfma_f32_16x16x32_bf16 v[208:211], a[164:167], a[240:243], v[208:211]
buffer_load_dwordx4 v2, s[20:23], s37 offen  lds
v_mfma_f32_16x16x32_bf16 v[212:215], a[164:167], a[244:247], v[212:215]
ds_read_b64_tr_b16 a[204:205], v8 offset:0
v_mfma_f32_16x16x32_bf16 v[216:219], a[164:167], a[248:251], v[216:219]
s_add_u32 s29, s29, s93
v_mfma_f32_16x16x32_bf16 v[220:223], a[164:167], a[252:255], v[220:223]
ds_read_b128 a[164:167], v4 offset:1024
v_mfma_f32_16x16x32_bf16 v[224:227], a[168:171], a[224:227], v[224:227]
buffer_store_dwordx4 v[56:59], v13, s[8:11], s29 offen sc1
v_mfma_f32_16x16x32_bf16 v[228:231], a[168:171], a[228:231], v[228:231]
s_add_u32 s37, s31, 131072
ds_read_b64_tr_b16 a[206:207], v8 offset:1024
v_mfma_f32_16x16x32_bf16 v[232:235], a[168:171], a[232:235], v[232:235]
s_add_u32 m0, s33, 4096
v_mfma_f32_16x16x32_bf16 v[236:239], a[168:171], a[236:239], v[236:239]
buffer_load_dwordx4 v2, s[20:23], s37 offen  lds
v_mfma_f32_16x16x32_bf16 v[240:243], a[168:171], a[240:243], v[240:243]
ds_read_b64_tr_b16 a[208:209], v9 offset:0
v_mfma_f32_16x16x32_bf16 v[244:247], a[168:171], a[244:247], v[244:247]
v_mfma_f32_16x16x32_bf16 v[248:251], a[168:171], a[248:251], v[248:251]
ds_read_b64_tr_b16 a[210:211], v9 offset:1024
v_mfma_f32_16x16x32_bf16 v[252:255], a[168:171], a[252:255], v[252:255]
ds_read_b128 a[168:171], v3 offset:4096
v_mfma_f32_16x16x32_bf16 a[0:3], a[172:175], a[224:227], a[0:3]
s_add_u32 s37, s31, 163840
ds_read_b64_tr_b16 a[212:213], v10 offset:0
v_mfma_f32_16x16x32_bf16 a[4:7], a[172:175], a[228:231], a[4:7]
s_add_u32 m0, s33, 5120
v_mfma_f32_16x16x32_bf16 a[8:11], a[172:175], a[232:235], a[8:11]
buffer_load_dwordx4 v2, s[20:23], s37 offen  lds
v_mfma_f32_16x16x32_bf16 a[12:15], a[172:175], a[236:239], a[12:15]
s_add_u32 s31, s31, 262144
ds_read_b64_tr_b16 a[214:215], v10 offset:1024
v_mfma_f32_16x16x32_bf16 a[16:19], a[172:175], a[240:243], a[16:19]
s_add_u32 s33, s33, 16384
v_mfma_f32_16x16x32_bf16 a[20:23], a[172:175], a[244:247], a[20:23]
s_and_b32 s33, s33, 65535
ds_read_b64_tr_b16 a[216:217], v11 offset:0
v_mfma_f32_16x16x32_bf16 a[24:27], a[172:175], a[248:251], a[24:27]
v_mfma_f32_16x16x32_bf16 a[28:31], a[172:175], a[252:255], a[28:31]
s_mov_b32 s48, s30
ds_read_b128 a[172:175], v4 offset:5120
v_mfma_f32_16x16x32_bf16 a[32:35], a[176:179], a[224:227], a[32:35]
s_add_u32 m0, s32, 0
ds_read_b64_tr_b16 a[218:219], v11 offset:1024
v_mfma_f32_16x16x32_bf16 a[36:39], a[176:179], a[228:231], a[36:39]
buffer_load_dwordx4 v1, s[12:15], s48 offen lds
v_mfma_f32_16x16x32_bf16 a[40:43], a[176:179], a[232:235], a[40:43]
ds_read_b64_tr_b16 a[220:221], v12 offset:0
v_mfma_f32_16x16x32_bf16 a[44:47], a[176:179], a[236:239], a[44:47]
s_add_u32 s29, s29, s44
v_mfma_f32_16x16x32_bf16 a[48:51], a[176:179], a[240:243], a[48:51]
ds_read_b64_tr_b16 a[222:223], v12 offset:1024
v_mfma_f32_16x16x32_bf16 a[52:55], a[176:179], a[244:247], a[52:55]
buffer_store_dwordx4 v[60:63], v13, s[8:11], s29 offen sc1
v_mfma_f32_16x16x32_bf16 a[56:59], a[176:179], a[248:251], a[56:59]
s_add_u32 s48, s48, s34
ds_read_b128 a[188:191], v4 offset:13312
v_mfma_f32_16x16x32_bf16 a[60:63], a[176:179], a[252:255], a[60:63]
s_add_u32 m0, s32, 4096
ds_read_b128 a[176:179], v3 offset:8192
v_mfma_f32_16x16x32_bf16 a[64:67], a[180:183], a[224:227], a[64:67]
buffer_load_dwordx4 v1, s[12:15], s48 offen lds
v_mfma_f32_16x16x32_bf16 a[68:71], a[180:183], a[228:231], a[68:71]
v_add_u32 v5, 16384, v5
v_and_b32 v5, 65535, v5
v_mfma_f32_16x16x32_bf16 a[72:75], a[180:183], a[232:235], a[72:75]
v_xor_b32 v6, 16, v5
v_xor_b32 v7, 64, v5
v_mfma_f32_16x16x32_bf16 a[76:79], a[180:183], a[236:239], a[76:79]
v_xor_b32 v8, 80, v5
v_xor_b32 v9, 128, v5
v_mfma_f32_16x16x32_bf16 a[80:83], a[180:183], a[240:243], a[80:83]
v_xor_b32 v10, 144, v5
v_xor_b32 v11, 192, v5
v_mfma_f32_16x16x32_bf16 a[84:87], a[180:183], a[244:247], a[84:87]
s_add_u32 s48, s48, s34
v_xor_b32 v12, 208, v5
v_mfma_f32_16x16x32_bf16 a[88:91], a[180:183], a[248:251], a[88:91]
s_add_u32 m0, s32, 8192
v_mfma_f32_16x16x32_bf16 a[92:95], a[180:183], a[252:255], a[92:95]
buffer_load_dwordx4 v1, s[12:15], s48 offen lds
ds_read_b128 a[180:183], v4 offset:9216
v_mfma_f32_16x16x32_bf16 a[96:99], a[184:187], a[224:227], a[96:99]
v_mfma_f32_16x16x32_bf16 a[100:103], a[184:187], a[228:231], a[100:103]
v_mfma_f32_16x16x32_bf16 a[104:107], a[184:187], a[232:235], a[104:107]
v_mfma_f32_16x16x32_bf16 a[108:111], a[184:187], a[236:239], a[108:111]
v_mfma_f32_16x16x32_bf16 a[112:115], a[184:187], a[240:243], a[112:115]
s_add_u32 s48, s48, s34
v_mfma_f32_16x16x32_bf16 a[116:119], a[184:187], a[244:247], a[116:119]
s_add_u32 m0, s32, 12288
v_mfma_f32_16x16x32_bf16 a[120:123], a[184:187], a[248:251], a[120:123]
buffer_load_dwordx4 v1, s[12:15], s48 offen lds
v_mfma_f32_16x16x32_bf16 a[124:127], a[184:187], a[252:255], a[124:127]
ds_read_b128 a[184:187], v3 offset:12288
v_mfma_f32_16x16x32_bf16 a[128:131], v[28:31], a[224:227], a[128:131]
v_mfma_f32_16x16x32_bf16 a[132:135], v[28:31], a[228:231], a[132:135]
v_mfma_f32_16x16x32_bf16 a[136:139], v[28:31], a[232:235], a[136:139]
buffer_load_dword v15, v14, s[96:99], s100 offen
v_mfma_f32_16x16x32_bf16 a[140:143], v[28:31], a[236:239], a[140:143]
s_add_u32 s100, s100, 16384
v_mfma_f32_16x16x32_bf16 a[144:147], v[28:31], a[240:243], a[144:147]
v_mfma_f32_16x16x32_bf16 a[148:151], v[28:31], a[244:247], a[148:151]
v_mfma_f32_16x16x32_bf16 a[152:155], v[28:31], a[248:251], a[152:155]
v_mfma_f32_16x16x32_bf16 a[156:159], v[28:31], a[252:255], a[156:159]
s_waitcnt vmcnt(23) lgkmcnt(0)
s_barrier
v_mfma_f32_16x16x32_bf16 v[160:163], a[160:163], a[192:195], v[160:163]
ds_read_b64_tr_b16 a[224:225], v5 offset:0
v_mfma_f32_16x16x32_bf16 v[164:167], a[160:163], a[196:199], v[164:167]
v_mfma_f32_16x16x32_bf16 v[168:171], a[160:163], a[200:203], v[168:171]
ds_read_b64_tr_b16 a[226:227], v5 offset:1024
v_mfma_f32_16x16x32_bf16 v[172:175], a[160:163], a[204:207], v[172:175]
s_add_u32 s37, s31, 0
v_mfma_f32_16x16x32_bf16 v[176:179], a[160:163], a[208:211], v[176:179]
s_add_u32 m0, s33, 0
ds_read_b64_tr_b16 a[228:229], v6 offset:0
v_mfma_f32_16x16x32_bf16 v[180:183], a[160:163], a[212:215], v[180:183]
buffer_load_dwordx4 v2, s[20:23], s37 offen  lds
v_mfma_f32_16x16x32_bf16 v[184:187], a[160:163], a[216:219], v[184:187]
ds_read_b64_tr_b16 a[230:231], v6 offset:1024
v_mfma_f32_16x16x32_bf16 v[188:191], a[160:163], a[220:223], v[188:191]
ds_read_b128 a[160:163], v4 offset:0
v_mfma_f32_16x16x32_bf16 v[192:195], a[164:167], a[192:195], v[192:195]
ds_read_b64_tr_b16 a[232:233], v7 offset:0
v_mfma_f32_16x16x32_bf16 v[196:199], a[164:167], a[196:199], v[196:199]
v_mfma_f32_16x16x32_bf16 v[200:203], a[164:167], a[200:203], v[200:203]
s_add_u32 s37, s31, 32768
ds_read_b64_tr_b16 a[234:235], v7 offset:1024
v_mfma_f32_16x16x32_bf16 v[204:207], a[164:167], a[204:207], v[204:207]
s_add_u32 m0, s33, 1024
v_mfma_f32_16x16x32_bf16 v[208:211], a[164:167], a[208:211], v[208:211]
buffer_load_dwordx4 v2, s[20:23], s37 offen  lds
v_mfma_f32_16x16x32_bf16 v[212:215], a[164:167], a[212:215], v[212:215]
ds_read_b64_tr_b16 a[236:237], v8 offset:0
v_mfma_f32_16x16x32_bf16 v[216:219], a[164:167], a[216:219], v[216:219]
s_add_u32 s60, s60, s92
v_mfma_f32_16x16x32_bf16 v[220:223], a[164:167], a[220:223], v[220:223]
s_mov_b32 s29, s60
ds_read_b128 a[164:167], v3 offset:1024
v_mfma_f32_16x16x32_bf16 v[224:227], a[168:171], a[192:195], v[224:227]
buffer_store_dwordx4 v[64:67], v13, s[8:11], s29 offen sc1
v_mfma_f32_16x16x32_bf16 v[228:231], a[168:171], a[196:199], v[228:231]
s_add_u32 s37, s31, 131072
ds_read_b64_tr_b16 a[238:239], v8 offset:1024
v_mfma_f32_16x16x32_bf16 v[232:235], a[168:171], a[200:203], v[232:235]
s_add_u32 m0, s33, 4096
v_mfma_f32_16x16x32_bf16 v[236:239], a[168:171], a[204:207], v[236:239]
buffer_load_dwordx4 v2, s[20:23], s37 offen  lds
v_mfma_f32_16x16x32_bf16 v[240:243], a[168:171], a[208:211], v[240:243]
ds_read_b64_tr_b16 a[240:241], v9 offset:0
v_mfma_f32_16x16x32_bf16 v[244:247], a[168:171], a[212:215], v[244:247]
v_mfma_f32_16x16x32_bf16 v[248:251], a[168:171], a[216:219], v[248:251]
ds_read_b64_tr_b16 a[242:243], v9 offset:1024
v_mfma_f32_16x16x32_bf16 v[252:255], a[168:171], a[220:223], v[252:255]
ds_read_b128 a[168:171], v4 offset:4096
v_mfma_f32_16x16x32_bf16 a[0:3], a[172:175], a[192:195], a[0:3]
s_add_u32 s37, s31, 163840
ds_read_b64_tr_b16 a[244:245], v10 offset:0
v_mfma_f32_16x16x32_bf16 a[4:7], a[172:175], a[196:199], a[4:7]
s_add_u32 m0, s33, 5120
v_mfma_f32_16x16x32_bf16 a[8:11], a[172:175], a[200:203], a[8:11]
buffer_load_dwordx4 v2, s[20:23], s37 offen  lds
v_mfma_f32_16x16x32_bf16 a[12:15], a[172:175], a[204:207], a[12:15]
s_add_u32 s31, s31, 262144
ds_read_b64_tr_b16 a[246:247], v10 offset:1024
v_mfma_f32_16x16x32_bf16 a[16:19], a[172:175], a[208:211], a[16:19]
s_add_u32 s33, s33, 16384
v_mfma_f32_16x16x32_bf16 a[20:23], a[172:175], a[212:215], a[20:23]
s_and_b32 s33, s33, 65535
ds_read_b64_tr_b16 a[248:249], v11 offset:0
v_mfma_f32_16x16x32_bf16 a[24:27], a[172:175], a[216:219], a[24:27]
v_mfma_f32_16x16x32_bf16 a[28:31], a[172:175], a[220:223], a[28:31]
s_add_u32 s48, s48, s34
ds_read_b128 a[172:175], v3 offset:5120
v_mfma_f32_16x16x32_bf16 a[32:35], a[176:179], a[192:195], a[32:35]
s_add_u32 m0, s32, 16384
ds_read_b64_tr_b16 a[250:251], v11 offset:1024
v_mfma_f32_16x16x32_bf16 a[36:39], a[176:179], a[196:199], a[36:39]
buffer_load_dwordx4 v1, s[12:15], s48 offen lds
v_mfma_f32_16x16x32_bf16 a[40:43], a[176:179], a[200:203], a[40:43]
ds_read_b64_tr_b16 a[252:253], v12 offset:0
v_mfma_f32_16x16x32_bf16 a[44:47], a[176:179], a[204:207], a[44:47]
s_add_u32 s29, s29, s44
v_mfma_f32_16x16x32_bf16 a[48:51], a[176:179], a[208:211], a[48:51]
ds_read_b64_tr_b16 a[254:255], v12 offset:1024
v_mfma_f32_16x16x32_bf16 a[52:55], a[176:179], a[212:215], a[52:55]
buffer_store_dwordx4 v[68:71], v13, s[8:11], s29 offen sc1
v_mfma_f32_16x16x32_bf16 a[56:59], a[176:179], a[216:219], a[56:59]
s_add_u32 s48, s48, s34
ds_read_b128 v[28:31], v3 offset:13312
v_mfma_f32_16x16x32_bf16 a[60:63], a[176:179], a[220:223], a[60:63]
s_add_u32 m0, s32, 20480
ds_read_b128 a[176:179], v4 offset:8192
v_mfma_f32_16x16x32_bf16 a[64:67], a[180:183], a[192:195], a[64:67]
buffer_load_dwordx4 v1, s[12:15], s48 offen lds
v_mfma_f32_16x16x32_bf16 a[68:71], a[180:183], a[196:199], a[68:71]
v_add_u32 v5, 16384, v5
v_and_b32 v5, 65535, v5
v_mfma_f32_16x16x32_bf16 a[72:75], a[180:183], a[200:203], a[72:75]
v_xor_b32 v6, 16, v5
v_xor_b32 v7, 64, v5
v_mfma_f32_16x16x32_bf16 a[76:79], a[180:183], a[204:207], a[76:79]
v_xor_b32 v8, 80, v5
v_xor_b32 v9, 128, v5
v_mfma_f32_16x16x32_bf16 a[80:83], a[180:183], a[208:211], a[80:83]
v_xor_b32 v10, 144, v5
v_xor_b32 v11, 192, v5
v_mfma_f32_16x16x32_bf16 a[84:87], a[180:183], a[212:215], a[84:87]
s_add_u32 s48, s48, s34
v_xor_b32 v12, 208, v5
v_mfma_f32_16x16x32_bf16 a[88:91], a[180:183], a[216:219], a[88:91]
s_add_u32 m0, s32, 24576
v_mfma_f32_16x16x32_bf16 a[92:95], a[180:183], a[220:223], a[92:95]
buffer_load_dwordx4 v1, s[12:15], s48 offen lds
ds_read_b128 a[180:183], v3 offset:9216
v_mfma_f32_16x16x32_bf16 a[96:99], a[184:187], a[192:195], a[96:99]
v_mfma_f32_16x16x32_bf16 a[100:103], a[184:187], a[196:199], a[100:103]
v_mfma_f32_16x16x32_bf16 a[104:107], a[184:187], a[200:203], a[104:107]
v_mfma_f32_16x16x32_bf16 a[108:111], a[184:187], a[204:207], a[108:111]
v_mfma_f32_16x16x32_bf16 a[112:115], a[184:187], a[208:211], a[112:115]
s_add_u32 s48, s48, s34
v_mfma_f32_16x16x32_bf16 a[116:119], a[184:187], a[212:215], a[116:119]
s_add_u32 m0, s32, 28672
v_mfma_f32_16x16x32_bf16 a[120:123], a[184:187], a[216:219], a[120:123]
buffer_load_dwordx4 v1, s[12:15], s48 offen lds
v_mfma_f32_16x16x32_bf16 a[124:127], a[184:187], a[220:223], a[124:127]
s_add_u32 s30, s30, 128
ds_read_b128 a[184:187], v4 offset:12288
v_mfma_f32_16x16x32_bf16 a[128:131], a[188:191], a[192:195], a[128:131]
s_add_u32 s32, s32, 32768
s_add_u32 s29, s29, s93
v_add_u32 v3, 32768, v3
v_mfma_f32_16x16x32_bf16 a[132:135], a[188:191], a[196:199], a[132:135]
s_sub_u32 s48, s32, 98304
v_subrev_u32 v19, 98304, v3
v_mfma_f32_16x16x32_bf16 a[136:139], a[188:191], a[200:203], a[136:139]
s_cmp_ge_u32 s32, 163840
s_cselect_b32 s32, s48, s32
buffer_store_dwordx4 v[72:75], v13, s[8:11], s29 offen sc1
buffer_load_dword v15, v14, s[96:99], s100 offen
v_mfma_f32_16x16x32_bf16 a[140:143], a[188:191], a[204:207], a[140:143]
s_add_u32 s100, s100, 16384
v_cmp_le_u32 vcc, 163840, v3
v_mfma_f32_16x16x32_bf16 a[144:147], a[188:191], a[208:211], a[144:147]
s_nop 0
v_cndmask_b32 v3, v3, v19, vcc
v_mfma_f32_16x16x32_bf16 a[148:151], a[188:191], a[212:215], a[148:151]
v_xor_b32 v4, 64, v3
v_mfma_f32_16x16x32_bf16 a[152:155], a[188:191], a[216:219], a[152:155]
v_mfma_f32_16x16x32_bf16 a[156:159], a[188:191], a[220:223], a[156:159]
s_waitcnt vmcnt(23) lgkmcnt(0)
s_barrier
v_mfma_f32_16x16x32_bf16 v[160:163], a[160:163], a[224:227], v[160:163]
ds_read_b64_tr_b16 a[192:193], v5 offset:0
v_mfma_f32_16x16x32_bf16 v[164:167], a[160:163], a[228:231], v[164:167]
v_mfma_f32_16x16x32_bf16 v[168:171], a[160:163], a[232:235], v[168:171]
ds_read_b64_tr_b16 a[194:195], v5 offset:1024
v_mfma_f32_16x16x32_bf16 v[172:175], a[160:163], a[236:239], v[172:175]
s_add_u32 s37, s31, 0
v_mfma_f32_16x16x32_bf16 v[176:179], a[160:163], a[240:243], v[176:179]
s_add_u32 m0, s33, 0
ds_read_b64_tr_b16 a[196:197], v6 offset:0
v_mfma_f32_16x16x32_bf16 v[180:183], a[160:163], a[244:247], v[180:183]
buffer_load_dwordx4 v2, s[20:23], s37 offen  lds
v_mfma_f32_16x16x32_bf16 v[184:187], a[160:163], a[248:251], v[184:187]
ds_read_b64_tr_b16 a[198:199], v6 offset:1024
v_mfma_f32_16x16x32_bf16 v[188:191], a[160:163], a[252:255], v[188:191]
ds_read_b128 a[160:163], v3 offset:0
v_mfma_f32_16x16x32_bf16 v[192:195], a[164:167], a[224:227], v[192:195]
ds_read_b64_tr_b16 a[200:201], v7 offset:0
v_mfma_f32_16x16x32_bf16 v[196:199], a[164:167], a[228:231], v[196:199]
v_mfma_f32_16x16x32_bf16 v[200:203], a[164:167], a[232:235], v[200:203]
s_add_u32 s37, s31, 32768
ds_read_b64_tr_b16 a[202:203], v7 offset:1024
v_mfma_f32_16x16x32_bf16 v[204:207], a[164:167], a[236:239], v[204:207]
s_add_u32 m0, s33, 1024
v_mfma_f32_16x16x32_bf16 v[208:211], a[164:167], a[240:243], v[208:211]
buffer_load_dwordx4 v2, s[20:23], s37 offen  lds
v_mfma_f32_16x16x32_bf16 v[212:215], a[164:167], a[244:247], v[212:215]
ds_read_b64_tr_b16 a[204:205], v8 offset:0
v_mfma_f32_16x16x32_bf16 v[216:219], a[164:167], a[248:251], v[216:219]
s_add_u32 s29, s29, s44
v_mfma_f32_16x16x32_bf16 v[220:223], a[164:167], a[252:255], v[220:223]
ds_read_b128 a[164:167], v4 offset:1024
v_mfma_f32_16x16x32_bf16 v[224:227], a[168:171], a[224:227], v[224:227]
buffer_store_dwordx4 v[76:79], v13, s[8:11], s29 offen sc1
v_mfma_f32_16x16x32_bf16 v[228:231], a[168:171], a[228:231], v[228:231]
s_add_u32 s37, s31, 131072
ds_read_b64_tr_b16 a[206:207], v8 offset:1024
v_mfma_f32_16x16x32_bf16 v[232:235], a[168:171], a[232:235], v[232:235]
s_add_u32 m0, s33, 4096
v_mfma_f32_16x16x32_bf16 v[236:239], a[168:171], a[236:239], v[236:239]
buffer_load_dwordx4 v2, s[20:23], s37 offen  lds
v_mfma_f32_16x16x32_bf16 v[240:243], a[168:171], a[240:243], v[240:243]
ds_read_b64_tr_b16 a[208:209], v9 offset:0
v_mfma_f32_16x16x32_bf16 v[244:247], a[168:171], a[244:247], v[244:247]
v_mfma_f32_16x16x32_bf16 v[248:251], a[168:171], a[248:251], v[248:251]
ds_read_b64_tr_b16 a[210:211], v9 offset:1024
v_mfma_f32_16x16x32_bf16 v[252:255], a[168:171], a[252:255], v[252:255]
ds_read_b128 a[168:171], v3 offset:4096
v_mfma_f32_16x16x32_bf16 a[0:3], a[172:175], a[224:227], a[0:3]
s_add_u32 s37, s31, 163840
ds_read_b64_tr_b16 a[212:213], v10 offset:0
v_mfma_f32_16x16x32_bf16 a[4:7], a[172:175], a[228:231], a[4:7]
s_add_u32 m0, s33, 5120
v_mfma_f32_16x16x32_bf16 a[8:11], a[172:175], a[232:235], a[8:11]
buffer_load_dwordx4 v2, s[20:23], s37 offen  lds
v_mfma_f32_16x16x32_bf16 a[12:15], a[172:175], a[236:239], a[12:15]
s_add_u32 s31, s31, 262144
ds_read_b64_tr_b16 a[214:215], v10 offset:1024
v_mfma_f32_16x16x32_bf16 a[16:19], a[172:175], a[240:243], a[16:19]
s_add_u32 s33, s33, 16384
v_mfma_f32_16x16x32_bf16 a[20:23], a[172:175], a[244:247], a[20:23]
s_and_b32 s33, s33, 65535
ds_read_b64_tr_b16 a[216:217], v11 offset:0
v_mfma_f32_16x16x32_bf16 a[24:27], a[172:175], a[248:251], a[24:27]
v_mfma_f32_16x16x32_bf16 a[28:31], a[172:175], a[252:255], a[28:31]
s_mov_b32 s48, s30
ds_read_b128 a[172:175], v4 offset:5120
v_mfma_f32_16x16x32_bf16 a[32:35], a[176:179], a[224:227], a[32:35]
s_add_u32 m0, s32, 0
ds_read_b64_tr_b16 a[218:219], v11 offset:1024
v_mfma_f32_16x16x32_bf16 a[36:39], a[176:179], a[228:231], a[36:39]
buffer_load_dwordx4 v1, s[12:15], s48 offen lds
v_mfma_f32_16x16x32_bf16 a[40:43], a[176:179], a[232:235], a[40:43]
ds_read_b64_tr_b16 a[220:221], v12 offset:0
v_mfma_f32_16x16x32_bf16 a[44:47], a[176:179], a[236:239], a[44:47]
s_add_u32 s29, s29, s93
v_mfma_f32_16x16x32_bf16 a[48:51], a[176:179], a[240:243], a[48:51]
ds_read_b64_tr_b16 a[222:223], v12 offset:1024
v_mfma_f32_16x16x32_bf16 a[52:55], a[176:179], a[244:247], a[52:55]
buffer_store_dwordx4 v[80:83], v13, s[8:11], s29 offen sc1
v_mfma_f32_16x16x32_bf16 a[56:59], a[176:179], a[248:251], a[56:59]
s_add_u32 s48, s48, s34
ds_read_b128 a[188:191], v4 offset:13312
v_mfma_f32_16x16x32_bf16 a[60:63], a[176:179], a[252:255], a[60:63]
s_add_u32 m0, s32, 4096
ds_read_b128 a[176:179], v3 offset:8192
v_mfma_f32_16x16x32_bf16 a[64:67], a[180:183], a[224:227], a[64:67]
buffer_load_dwordx4 v1, s[12:15], s48 offen lds
v_mfma_f32_16x16x32_bf16 a[68:71], a[180:183], a[228:231], a[68:71]
v_add_u32 v5, 16384, v5
v_and_b32 v5, 65535, v5
v_mfma_f32_16x16x32_bf16 a[72:75], a[180:183], a[232:235], a[72:75]
v_xor_b32 v6, 16, v5
v_xor_b32 v7, 64, v5
v_mfma_f32_16x16x32_bf16 a[76:79], a[180:183], a[236:239], a[76:79]
v_xor_b32 v8, 80, v5
v_xor_b32 v9, 128, v5
v_mfma_f32_16x16x32_bf16 a[80:83], a[180:183], a[240:243], a[80:83]
v_xor_b32 v10, 144, v5
v_xor_b32 v11, 192, v5
v_mfma_f32_16x16x32_bf16 a[84:87], a[180:183], a[244:247], a[84:87]
s_add_u32 s48, s48, s34
v_xor_b32 v12, 208, v5
v_mfma_f32_16x16x32_bf16 a[88:91], a[180:183], a[248:251], a[88:91]
s_add_u32 m0, s32, 8192
v_mfma_f32_16x16x32_bf16 a[92:95], a[180:183], a[252:255], a[92:95]
buffer_load_dwordx4 v1, s[12:15], s48 offen lds
ds_read_b128 a[180:183], v4 offset:9216
v_mfma_f32_16x16x32_bf16 a[96:99], a[184:187], a[224:227], a[96:99]
v_mfma_f32_16x16x32_bf16 a[100:103], a[184:187], a[228:231], a[100:103]
v_mfma_f32_16x16x32_bf16 a[104:107], a[184:187], a[232:235], a[104:107]
v_mfma_f32_16x16x32_bf16 a[108:111], a[184:187], a[236:239], a[108:111]
v_mfma_f32_16x16x32_bf16 a[112:115], a[184:187], a[240:243], a[112:115]
s_add_u32 s48, s48, s34
v_mfma_f32_16x16x32_bf16 a[116:119], a[184:187], a[244:247], a[116:119]
s_add_u32 m0, s32, 12288
v_mfma_f32_16x16x32_bf16 a[120:123], a[184:187], a[248:251], a[120:123]
buffer_load_dwordx4 v1, s[12:15], s48 offen lds
v_mfma_f32_16x16x32_bf16 a[124:127], a[184:187], a[252:255], a[124:127]
ds_read_b128 a[184:187], v3 offset:12288
v_mfma_f32_16x16x32_bf16 a[128:131], v[28:31], a[224:227], a[128:131]
s_add_u32 s29, s29, s44
v_mfma_f32_16x16x32_bf16 a[132:135], v[28:31], a[228:231], a[132:135]
v_mfma_f32_16x16x32_bf16 a[136:139], v[28:31], a[232:235], a[136:139]
buffer_store_dwordx4 v[84:87], v13, s[8:11], s29 offen sc1
buffer_load_dword v15, v14, s[96:99], s100 offen
v_mfma_f32_16x16x32_bf16 a[140:143], v[28:31], a[236:239], a[140:143]
s_add_u32 s100, s100, 16384
v_mfma_f32_16x16x32_bf16 a[144:147], v[28:31], a[240:243], a[144:147]
v_mfma_f32_16x16x32_bf16 a[148:151], v[28:31], a[244:247], a[148:151]
v_mfma_f32_16x16x32_bf16 a[152:155], v[28:31], a[248:251], a[152:155]
v_mfma_f32_16x16x32_bf16 a[156:159], v[28:31], a[252:255], a[156:159]
s_waitcnt vmcnt(24) lgkmcnt(0)
s_barrier
v_mfma_f32_16x16x32_bf16 v[160:163], a[160:163], a[192:195], v[160:163]
ds_read_b64_tr_b16 a[224:225], v5 offset:0
v_mfma_f32_16x16x32_bf16 v[164:167], a[160:163], a[196:199], v[164:167]
v_mfma_f32_16x16x32_bf16 v[168:171], a[160:163], a[200:203], v[168:171]
ds_read_b64_tr_b16 a[226:227], v5 offset:1024
v_mfma_f32_16x16x32_bf16 v[172:175], a[160:163], a[204:207], v[172:175]
s_add_u32 s37, s31, 0
v_mfma_f32_16x16x32_bf16 v[176:179], a[160:163], a[208:211], v[176:179]
s_add_u32 m0, s33, 0
ds_read_b64_tr_b16 a[228:229], v6 offset:0
v_mfma_f32_16x16x32_bf16 v[180:183], a[160:163], a[212:215], v[180:183]
buffer_load_dwordx4 v2, s[20:23], s37 offen  lds
v_mfma_f32_16x16x32_bf16 v[184:187], a[160:163], a[216:219], v[184:187]
ds_read_b64_tr_b16 a[230:231], v6 offset:1024
v_mfma_f32_16x16x32_bf16 v[188:191], a[160:163], a[220:223], v[188:191]
ds_read_b128 a[160:163], v4 offset:0
v_mfma_f32_16x16x32_bf16 v[192:195], a[164:167], a[192:195], v[192:195]
ds_read_b64_tr_b16 a[232:233], v7 offset:0
v_mfma_f32_16x16x32_bf16 v[196:199], a[164:167], a[196:199], v[196:199]
v_mfma_f32_16x16x32_bf16 v[200:203], a[164:167], a[200:203], v[200:203]
s_add_u32 s37, s31, 32768
ds_read_b64_tr_b16 a[234:235], v7 offset:1024
v_mfma_f32_16x16x32_bf16 v[204:207], a[164:167], a[204:207], v[204:207]
s_add_u32 m0, s33, 1024
v_mfma_f32_16x16x32_bf16 v[208:211], a[164:167], a[208:211], v[208:211]
buffer_load_dwordx4 v2, s[20:23], s37 offen  lds
v_mfma_f32_16x16x32_bf16 v[212:215], a[164:167], a[212:215], v[212:215]
ds_read_b64_tr_b16 a[236:237], v8 offset:0
v_mfma_f32_16x16x32_bf16 v[216:219], a[164:167], a[216:219], v[216:219]
s_add_u32 s29, s29, s93
v_mfma_f32_16x16x32_bf16 v[220:223], a[164:167], a[220:223], v[220:223]
ds_read_b128 a[164:167], v3 offset:1024
v_mfma_f32_16x16x32_bf16 v[224:227], a[168:171], a[192:195], v[224:227]
buffer_store_dwordx4 v[88:91], v13, s[8:11], s29 offen sc1
v_mfma_f32_16x16x32_bf16 v[228:231], a[168:171], a[196:199], v[228:231]
s_add_u32 s37, s31, 131072
ds_read_b64_tr_b16 a[238:239], v8 offset:1024
v_mfma_f32_16x16x32_bf16 v[232:235], a[168:171], a[200:203], v[232:235]
s_add_u32 m0, s33, 4096
v_mfma_f32_16x16x32_bf16 v[236:239], a[168:171], a[204:207], v[236:239]
buffer_load_dwordx4 v2, s[20:23], s37 offen  lds
v_mfma_f32_16x16x32_bf16 v[240:243], a[168:171], a[208:211], v[240:243]
ds_read_b64_tr_b16 a[240:241], v9 offset:0
v_mfma_f32_16x16x32_bf16 v[244:247], a[168:171], a[212:215], v[244:247]
v_mfma_f32_16x16x32_bf16 v[248:251], a[168:171], a[216:219], v[248:251]
ds_read_b64_tr_b16 a[242:243], v9 offset:1024
v_mfma_f32_16x16x32_bf16 v[252:255], a[168:171], a[220:223], v[252:255]
ds_read_b128 a[168:171], v4 offset:4096
v_mfma_f32_16x16x32_bf16 a[0:3], a[172:175], a[192:195], a[0:3]
s_add_u32 s37, s31, 163840
ds_read_b64_tr_b16 a[244:245], v10 offset:0
v_mfma_f32_16x16x32_bf16 a[4:7], a[172:175], a[196:199], a[4:7]
s_add_u32 m0, s33, 5120
v_mfma_f32_16x16x32_bf16 a[8:11], a[172:175], a[200:203], a[8:11]
buffer_load_dwordx4 v2, s[20:23], s37 offen  lds
v_mfma_f32_16x16x32_bf16 a[12:15], a[172:175], a[204:207], a[12:15]
s_add_u32 s31, s31, 262144
ds_read_b64_tr_b16 a[246:247], v10 offset:1024
v_mfma_f32_16x16x32_bf16 a[16:19], a[172:175], a[208:211], a[16:19]
s_add_u32 s33, s33, 16384
v_mfma_f32_16x16x32_bf16 a[20:23], a[172:175], a[212:215], a[20:23]
s_and_b32 s33, s33, 65535
ds_read_b64_tr_b16 a[248:249], v11 offset:0
v_mfma_f32_16x16x32_bf16 a[24:27], a[172:175], a[216:219], a[24:27]
v_mfma_f32_16x16x32_bf16 a[28:31], a[172:175], a[220:223], a[28:31]
s_add_u32 s48, s48, s34
ds_read_b128 a[172:175], v3 offset:5120
v_mfma_f32_16x16x32_bf16 a[32:35], a[176:179], a[192:195], a[32:35]
s_add_u32 m0, s32, 16384
ds_read_b64_tr_b16 a[250:251], v11 offset:1024
v_mfma_f32_16x16x32_bf16 a[36:39], a[176:179], a[196:199], a[36:39]
buffer_load_dwordx4 v1, s[12:15], s48 offen lds
v_mfma_f32_16x16x32_bf16 a[40:43], a[176:179], a[200:203], a[40:43]
ds_read_b64_tr_b16 a[252:253], v12 offset:0
v_mfma_f32_16x16x32_bf16 a[44:47], a[176:179], a[204:207], a[44:47]
s_add_u32 s29, s29, s44
v_mfma_f32_16x16x32_bf16 a[48:51], a[176:179], a[208:211], a[48:51]
ds_read_b64_tr_b16 a[254:255], v12 offset:1024
v_mfma_f32_16x16x32_bf16 a[52:55], a[176:179], a[212:215], a[52:55]
buffer_store_dwordx4 v[92:95], v13, s[8:11], s29 offen sc1
v_mfma_f32_16x16x32_bf16 a[56:59], a[176:179], a[216:219], a[56:59]
s_add_u32 s48, s48, s34
ds_read_b128 v[28:31], v3 offset:13312
v_mfma_f32_16x16x32_bf16 a[60:63], a[176:179], a[220:223], a[60:63]
s_add_u32 m0, s32, 20480
ds_read_b128 a[176:179], v4 offset:8192
v_mfma_f32_16x16x32_bf16 a[64:67], a[180:183], a[192:195], a[64:67]
buffer_load_dwordx4 v1, s[12:15], s48 offen lds
v_mfma_f32_16x16x32_bf16 a[68:71], a[180:183], a[196:199], a[68:71]
v_add_u32 v5, 16384, v5
v_and_b32 v5, 65535, v5
v_mfma_f32_16x16x32_bf16 a[72:75], a[180:183], a[200:203], a[72:75]
v_xor_b32 v6, 16, v5
v_xor_b32 v7, 64, v5
v_mfma_f32_16x16x32_bf16 a[76:79], a[180:183], a[204:207], a[76:79]
v_xor_b32 v8, 80, v5
v_xor_b32 v9, 128, v5
v_mfma_f32_16x16x32_bf16 a[80:83], a[180:183], a[208:211], a[80:83]
v_xor_b32 v10, 144, v5
v_xor_b32 v11, 192, v5
v_mfma_f32_16x16x32_bf16 a[84:87], a[180:183], a[212:215], a[84:87]
s_add_u32 s48, s48, s34
v_xor_b32 v12, 208, v5
v_mfma_f32_16x16x32_bf16 a[88:91], a[180:183], a[216:219], a[88:91]
s_add_u32 m0, s32, 24576
v_mfma_f32_16x16x32_bf16 a[92:95], a[180:183], a[220:223], a[92:95]
buffer_load_dwordx4 v1, s[12:15], s48 offen lds
ds_read_b128 a[180:183], v3 offset:9216
v_mfma_f32_16x16x32_bf16 a[96:99], a[184:187], a[192:195], a[96:99]
v_mfma_f32_16x16x32_bf16 a[100:103], a[184:187], a[196:199], a[100:103]
v_mfma_f32_16x16x32_bf16 a[104:107], a[184:187], a[200:203], a[104:107]
v_mfma_f32_16x16x32_bf16 a[108:111], a[184:187], a[204:207], a[108:111]
v_mfma_f32_16x16x32_bf16 a[112:115], a[184:187], a[208:211], a[112:115]
s_add_u32 s48, s48, s34
v_mfma_f32_16x16x32_bf16 a[116:119], a[184:187], a[212:215], a[116:119]
s_add_u32 m0, s32, 28672
v_mfma_f32_16x16x32_bf16 a[120:123], a[184:187], a[216:219], a[120:123]
buffer_load_dwordx4 v1, s[12:15], s48 offen lds
v_mfma_f32_16x16x32_bf16 a[124:127], a[184:187], a[220:223], a[124:127]
s_add_u32 s30, s30, 128
ds_read_b128 a[184:187], v4 offset:12288
v_mfma_f32_16x16x32_bf16 a[128:131], a[188:191], a[192:195], a[128:131]
s_add_u32 s32, s32, 32768
v_add_u32 v3, 32768, v3
v_mfma_f32_16x16x32_bf16 a[132:135], a[188:191], a[196:199], a[132:135]
s_sub_u32 s48, s32, 98304
v_subrev_u32 v19, 98304, v3
v_mfma_f32_16x16x32_bf16 a[136:139], a[188:191], a[200:203], a[136:139]
s_cmp_ge_u32 s32, 163840
s_cselect_b32 s32, s48, s32
buffer_load_dword v15, v14, s[96:99], s100 offen
v_mfma_f32_16x16x32_bf16 a[140:143], a[188:191], a[204:207], a[140:143]
s_add_u32 s100, s100, 16384
v_cmp_le_u32 vcc, 163840, v3
v_mfma_f32_16x16x32_bf16 a[144:147], a[188:191], a[208:211], a[144:147]
s_nop 0
v_cndmask_b32 v3, v3, v19, vcc
v_mfma_f32_16x16x32_bf16 a[148:151], a[188:191], a[212:215], a[148:151]
v_xor_b32 v4, 64, v3
v_mfma_f32_16x16x32_bf16 a[152:155], a[188:191], a[216:219], a[152:155]
v_mfma_f32_16x16x32_bf16 a[156:159], a[188:191], a[220:223], a[156:159]
s_waitcnt vmcnt(23) lgkmcnt(0)
s_barrier
v_mfma_f32_16x16x32_bf16 v[160:163], a[160:163], a[224:227], v[160:163]
ds_read_b64_tr_b16 a[192:193], v5 offset:0
v_mfma_f32_16x16x32_bf16 v[164:167], a[160:163], a[228:231], v[164:167]
v_mfma_f32_16x16x32_bf16 v[168:171], a[160:163], a[232:235], v[168:171]
ds_read_b64_tr_b16 a[194:195], v5 offset:1024
v_mfma_f32_16x16x32_bf16 v[172:175], a[160:163], a[236:239], v[172:175]
s_add_u32 s37, s31, 0
v_mfma_f32_16x16x32_bf16 v[176:179], a[160:163], a[240:243], v[176:179]
s_add_u32 m0, s33, 0
ds_read_b64_tr_b16 a[196:197], v6 offset:0
v_mfma_f32_16x16x32_bf16 v[180:183], a[160:163], a[244:247], v[180:183]
buffer_load_dwordx4 v2, s[20:23], s37 offen  lds
v_mfma_f32_16x16x32_bf16 v[184:187], a[160:163], a[248:251], v[184:187]
ds_read_b64_tr_b16 a[198:199], v6 offset:1024
v_mfma_f32_16x16x32_bf16 v[188:191], a[160:163], a[252:255], v[188:191]
ds_read_b128 a[160:163], v3 offset:0
v_mfma_f32_16x16x32_bf16 v[192:195], a[164:167], a[224:227], v[192:195]
ds_read_b64_tr_b16 a[200:201], v7 offset:0
v_mfma_f32_16x16x32_bf16 v[196:199], a[164:167], a[228:231], v[196:199]
v_mfma_f32_16x16x32_bf16 v[200:203], a[164:167], a[232:235], v[200:203]
s_add_u32 s37, s31, 32768
ds_read_b64_tr_b16 a[202:203], v7 offset:1024
v_mfma_f32_16x16x32_bf16 v[204:207], a[164:167], a[236:239], v[204:207]
s_add_u32 m0, s33, 1024
v_mfma_f32_16x16x32_bf16 v[208:211], a[164:167], a[240:243], v[208:211]
buffer_load_dwordx4 v2, s[20:23], s37 offen  lds
v_mfma_f32_16x16x32_bf16 v[212:215], a[164:167], a[244:247], v[212:215]
ds_read_b64_tr_b16 a[204:205], v8 offset:0
v_mfma_f32_16x16x32_bf16 v[216:219], a[164:167], a[248:251], v[216:219]
s_add_u32 s60, s60, s92
v_mfma_f32_16x16x32_bf16 v[220:223], a[164:167], a[252:255], v[220:223]
s_mov_b32 s29, s60
ds_read_b128 a[164:167], v4 offset:1024
v_mfma_f32_16x16x32_bf16 v[224:227], a[168:171], a[224:227], v[224:227]
buffer_store_dwordx4 v[96:99], v13, s[8:11], s29 offen sc1
v_mfma_f32_16x16x32_bf16 v[228:231], a[168:171], a[228:231], v[228:231]
s_add_u32 s37, s31, 131072
ds_read_b64_tr_b16 a[206:207], v8 offset:1024
v_mfma_f32_16x16x32_bf16 v[232:235], a[168:171], a[232:235], v[232:235]
s_add_u32 m0, s33, 4096
v_mfma_f32_16x16x32_bf16 v[236:239], a[168:171], a[236:239], v[236:239]
buffer_load_dwordx4 v2, s[20:23], s37 offen  lds
v_mfma_f32_16x16x32_bf16 v[240:243], a[168:171], a[240:243], v[240:243]
ds_read_b64_tr_b16 a[208:209], v9 offset:0
v_mfma_f32_16x16x32_bf16 v[244:247], a[168:171], a[244:247], v[244:247]
v_mfma_f32_16x16x32_bf16 v[248:251], a[168:171], a[248:251], v[248:251]
ds_read_b64_tr_b16 a[210:211], v9 offset:1024
v_mfma_f32_16x16x32_bf16 v[252:255], a[168:171], a[252:255], v[252:255]
ds_read_b128 a[168:171], v3 offset:4096
v_mfma_f32_16x16x32_bf16 a[0:3], a[172:175], a[224:227], a[0:3]
s_add_u32 s37, s31, 163840
ds_read_b64_tr_b16 a[212:213], v10 offset:0
v_mfma_f32_16x16x32_bf16 a[4:7], a[172:175], a[228:231], a[4:7]
s_add_u32 m0, s33, 5120
v_mfma_f32_16x16x32_bf16 a[8:11], a[172:175], a[232:235], a[8:11]
buffer_load_dwordx4 v2, s[20:23], s37 offen  lds
v_mfma_f32_16x16x32_bf16 a[12:15], a[172:175], a[236:239], a[12:15]
s_add_u32 s31, s31, 262144
ds_read_b64_tr_b16 a[214:215], v10 offset:1024
v_mfma_f32_16x16x32_bf16 a[16:19], a[172:175], a[240:243], a[16:19]
s_add_u32 s33, s33, 16384
v_mfma_f32_16x16x32_bf16 a[20:23], a[172:175], a[244:247], a[20:23]
s_and_b32 s33, s33, 65535
ds_read_b64_tr_b16 a[216:217], v11 offset:0
v_mfma_f32_16x16x32_bf16 a[24:27], a[172:175], a[248:251], a[24:27]
v_mfma_f32_16x16x32_bf16 a[28:31], a[172:175], a[252:255], a[28:31]
s_mov_b32 s48, s30
ds_read_b128 a[172:175], v4 offset:5120
v_mfma_f32_16x16x32_bf16 a[32:35], a[176:179], a[224:227], a[32:35]
s_add_u32 m0, s32, 0
ds_read_b64_tr_b16 a[218:219], v11 offset:1024
v_mfma_f32_16x16x32_bf16 a[36:39], a[176:179], a[228:231], a[36:39]
buffer_load_dwordx4 v1, s[12:15], s48 offen lds
v_mfma_f32_16x16x32_bf16 a[40:43], a[176:179], a[232:235], a[40:43]
ds_read_b64_tr_b16 a[220:221], v12 offset:0
v_mfma_f32_16x16x32_bf16 a[44:47], a[176:179], a[236:239], a[44:47]
s_add_u32 s29, s29, s44
v_mfma_f32_16x16x32_bf16 a[48:51], a[176:179], a[240:243], a[48:51]
ds_read_b64_tr_b16 a[222:223], v12 offset:1024
v_mfma_f32_16x16x32_bf16 a[52:55], a[176:179], a[244:247], a[52:55]
buffer_store_dwordx4 v[100:103], v13, s[8:11], s29 offen sc1
v_mfma_f32_16x16x32_bf16 a[56:59], a[176:179], a[248:251], a[56:59]
s_add_u32 s48, s48, s34
ds_read_b128 a[188:191], v4 offset:13312
v_mfma_f32_16x16x32_bf16 a[60:63], a[176:179], a[252:255], a[60:63]
s_add_u32 m0, s32, 4096
ds_read_b128 a[176:179], v3 offset:8192
v_mfma_f32_16x16x32_bf16 a[64:67], a[180:183], a[224:227], a[64:67]
buffer_load_dwordx4 v1, s[12:15], s48 offen lds
v_mfma_f32_16x16x32_bf16 a[68:71], a[180:183], a[228:231], a[68:71]
v_add_u32 v5, 16384, v5
v_and_b32 v5, 65535, v5
v_mfma_f32_16x16x32_bf16 a[72:75], a[180:183], a[232:235], a[72:75]
v_xor_b32 v6, 16, v5
v_xor_b32 v7, 64, v5
v_mfma_f32_16x16x32_bf16 a[76:79], a[180:183], a[236:239], a[76:79]
v_xor_b32 v8, 80, v5
v_xor_b32 v9, 128, v5
v_mfma_f32_16x16x32_bf16 a[80:83], a[180:183], a[240:243], a[80:83]
v_xor_b32 v10, 144, v5
v_xor_b32 v11, 192, v5
v_mfma_f32_16x16x32_bf16 a[84:87], a[180:183], a[244:247], a[84:87]
s_add_u32 s48, s48, s34
v_xor_b32 v12, 208, v5
v_mfma_f32_16x16x32_bf16 a[88:91], a[180:183], a[248:251], a[88:91]
s_add_u32 m0, s32, 8192
v_mfma_f32_16x16x32_bf16 a[92:95], a[180:183], a[252:255], a[92:95]
buffer_load_dwordx4 v1, s[12:15], s48 offen lds
ds_read_b128 a[180:183], v4 offset:9216
v_mfma_f32_16x16x32_bf16 a[96:99], a[184:187], a[224:227], a[96:99]
v_mfma_f32_16x16x32_bf16 a[100:103], a[184:187], a[228:231], a[100:103]
v_mfma_f32_16x16x32_bf16 a[104:107], a[184:187], a[232:235], a[104:107]
v_mfma_f32_16x16x32_bf16 a[108:111], a[184:187], a[236:239], a[108:111]
v_mfma_f32_16x16x32_bf16 a[112:115], a[184:187], a[240:243], a[112:115]
s_add_u32 s48, s48, s34
v_mfma_f32_16x16x32_bf16 a[116:119], a[184:187], a[244:247], a[116:119]
s_add_u32 m0, s32, 12288
v_mfma_f32_16x16x32_bf16 a[120:123], a[184:187], a[248:251], a[120:123]
buffer_load_dwordx4 v1, s[12:15], s48 offen lds
v_mfma_f32_16x16x32_bf16 a[124:127], a[184:187], a[252:255], a[124:127]
ds_read_b128 a[184:187], v3 offset:12288
v_mfma_f32_16x16x32_bf16 a[128:131], v[28:31], a[224:227], a[128:131]
s_add_u32 s29, s29, s93
v_mfma_f32_16x16x32_bf16 a[132:135], v[28:31], a[228:231], a[132:135]
v_mfma_f32_16x16x32_bf16 a[136:139], v[28:31], a[232:235], a[136:139]
buffer_store_dwordx4 v[104:107], v13, s[8:11], s29 offen sc1
buffer_load_dword v15, v14, s[96:99], s100 offen
v_mfma_f32_16x16x32_bf16 a[140:143], v[28:31], a[236:239], a[140:143]
s_add_u32 s100, s100, 16384
v_mfma_f32_16x16x32_bf16 a[144:147], v[28:31], a[240:243], a[144:147]
v_mfma_f32_16x16x32_bf16 a[148:151], v[28:31], a[244:247], a[148:151]
v_mfma_f32_16x16x32_bf16 a[152:155], v[28:31], a[248:251], a[152:155]
v_mfma_f32_16x16x32_bf16 a[156:159], v[28:31], a[252:255], a[156:159]
s_waitcnt vmcnt(23) lgkmcnt(0)
s_barrier
v_mfma_f32_16x16x32_bf16 v[160:163], a[160:163], a[192:195], v[160:163]
ds_read_b64_tr_b16 a[224:225], v5 offset:0
v_mfma_f32_16x16x32_bf16 v[164:167], a[160:163], a[196:199], v[164:167]
v_mfma_f32_16x16x32_bf16 v[168:171], a[160:163], a[200:203], v[168:171]
ds_read_b64_tr_b16 a[226:227], v5 offset:1024
v_mfma_f32_16x16x32_bf16 v[172:175], a[160:163], a[204:207], v[172:175]
s_add_u32 s37, s31, 0
v_mfma_f32_16x16x32_bf16 v[176:179], a[160:163], a[208:211], v[176:179]
s_add_u32 m0, s33, 0
ds_read_b64_tr_b16 a[228:229], v6 offset:0
v_mfma_f32_16x16x32_bf16 v[180:183], a[160:163], a[212:215], v[180:183]
buffer_load_dwordx4 v2, s[20:23], s37 offen  lds
v_mfma_f32_16x16x32_bf16 v[184:187], a[160:163], a[216:219], v[184:187]
ds_read_b64_tr_b16 a[230:231], v6 offset:1024
v_mfma_f32_16x16x32_bf16 v[188:191], a[160:163], a[220:223], v[188:191]
ds_read_b128 a[160:163], v4 offset:0
v_mfma_f32_16x16x32_bf16 v[192:195], a[164:167], a[192:195], v[192:195]
ds_read_b64_tr_b16 a[232:233], v7 offset:0
v_mfma_f32_16x16x32_bf16 v[196:199], a[164:167], a[196:199], v[196:199]
v_mfma_f32_16x16x32_bf16 v[200:203], a[164:167], a[200:203], v[200:203]
s_add_u32 s37, s31, 32768
ds_read_b64_tr_b16 a[234:235], v7 offset:1024
v_mfma_f32_16x16x32_bf16 v[204:207], a[164:167], a[204:207], v[204:207]
s_add_u32 m0, s33, 1024
v_mfma_f32_16x16x32_bf16 v[208:211], a[164:167], a[208:211], v[208:211]
buffer_load_dwordx4 v2, s[20:23], s37 offen  lds
v_mfma_f32_16x16x32_bf16 v[212:215], a[164:167], a[212:215], v[212:215]
ds_read_b64_tr_b16 a[236:237], v8 offset:0
v_mfma_f32_16x16x32_bf16 v[216:219], a[164:167], a[216:219], v[216:219]
s_add_u32 s29, s29, s44
v_mfma_f32_16x16x32_bf16 v[220:223], a[164:167], a[220:223], v[220:223]
ds_read_b128 a[164:167], v3 offset:1024
v_mfma_f32_16x16x32_bf16 v[224:227], a[168:171], a[192:195], v[224:227]
buffer_store_dwordx4 v[108:111], v13, s[8:11], s29 offen sc1
v_mfma_f32_16x16x32_bf16 v[228:231], a[168:171], a[196:199], v[228:231]
s_add_u32 s37, s31, 131072
ds_read_b64_tr_b16 a[238:239], v8 offset:1024
v_mfma_f32_16x16x32_bf16 v[232:235], a[168:171], a[200:203], v[232:235]
s_add_u32 m0, s33, 4096
v_mfma_f32_16x16x32_bf16 v[236:239], a[168:171], a[204:207], v[236:239]
buffer_load_dwordx4 v2, s[20:23], s37 offen  lds
v_mfma_f32_16x16x32_bf16 v[240:243], a[168:171], a[208:211], v[240:243]
ds_read_b64_tr_b16 a[240:241], v9 offset:0
v_mfma_f32_16x16x32_bf16 v[244:247], a[168:171], a[212:215], v[244:247]
v_mfma_f32_16x16x32_bf16 v[248:251], a[168:171], a[216:219], v[248:251]
ds_read_b64_tr_b16 a[242:243], v9 offset:1024
v_mfma_f32_16x16x32_bf16 v[252:255], a[168:171], a[220:223], v[252:255]
ds_read_b128 a[168:171], v4 offset:4096
v_mfma_f32_16x16x32_bf16 a[0:3], a[172:175], a[192:195], a[0:3]
s_add_u32 s37, s31, 163840
ds_read_b64_tr_b16 a[244:245], v10 offset:0
v_mfma_f32_16x16x32_bf16 a[4:7], a[172:175], a[196:199], a[4:7]
s_add_u32 m0, s33, 5120
v_mfma_f32_16x16x32_bf16 a[8:11], a[172:175], a[200:203], a[8:11]
buffer_load_dwordx4 v2, s[20:23], s37 offen  lds
v_mfma_f32_16x16x32_bf16 a[12:15], a[172:175], a[204:207], a[12:15]
s_add_u32 s31, s31, 262144
ds_read_b64_tr_b16 a[246:247], v10 offset:1024
v_mfma_f32_16x16x32_bf16 a[16:19], a[172:175], a[208:211], a[16:19]
s_add_u32 s33, s33, 16384
v_mfma_f32_16x16x32_bf16 a[20:23], a[172:175], a[212:215], a[20:23]
s_and_b32 s33, s33, 65535
ds_read_b64_tr_b16 a[248:249], v11 offset:0
v_mfma_f32_16x16x32_bf16 a[24:27], a[172:175], a[216:219], a[24:27]
v_mfma_f32_16x16x32_bf16 a[28:31], a[172:175], a[220:223], a[28:31]
s_add_u32 s48, s48, s34
ds_read_b128 a[172:175], v3 offset:5120
v_mfma_f32_16x16x32_bf16 a[32:35], a[176:179], a[192:195], a[32:35]
s_add_u32 m0, s32, 16384
ds_read_b64_tr_b16 a[250:251], v11 offset:1024
v_mfma_f32_16x16x32_bf16 a[36:39], a[176:179], a[196:199], a[36:39]
buffer_load_dwordx4 v1, s[12:15], s48 offen lds
v_mfma_f32_16x16x32_bf16 a[40:43], a[176:179], a[200:203], a[40:43]
ds_read_b64_tr_b16 a[252:253], v12 offset:0
v_mfma_f32_16x16x32_bf16 a[44:47], a[176:179], a[204:207], a[44:47]
s_add_u32 s29, s29, s93
v_mfma_f32_16x16x32_bf16 a[48:51], a[176:179], a[208:211], a[48:51]
ds_read_b64_tr_b16 a[254:255], v12 offset:1024
v_mfma_f32_16x16x32_bf16 a[52:55], a[176:179], a[212:215], a[52:55]
buffer_store_dwordx4 v[112:115], v13, s[8:11], s29 offen sc1
v_mfma_f32_16x16x32_bf16 a[56:59], a[176:179], a[216:219], a[56:59]
s_add_u32 s48, s48, s34
ds_read_b128 v[28:31], v3 offset:13312
v_mfma_f32_16x16x32_bf16 a[60:63], a[176:179], a[220:223], a[60:63]
s_add_u32 m0, s32, 20480
ds_read_b128 a[176:179], v4 offset:8192
v_mfma_f32_16x16x32_bf16 a[64:67], a[180:183], a[192:195], a[64:67]
buffer_load_dwordx4 v1, s[12:15], s48 offen lds
v_mfma_f32_16x16x32_bf16 a[68:71], a[180:183], a[196:199], a[68:71]
v_add_u32 v5, 16384, v5
v_and_b32 v5, 65535, v5
v_mfma_f32_16x16x32_bf16 a[72:75], a[180:183], a[200:203], a[72:75]
v_xor_b32 v6, 16, v5
v_xor_b32 v7, 64, v5
v_mfma_f32_16x16x32_bf16 a[76:79], a[180:183], a[204:207], a[76:79]
v_xor_b32 v8, 80, v5
v_xor_b32 v9, 128, v5
v_mfma_f32_16x16x32_bf16 a[80:83], a[180:183], a[208:211], a[80:83]
v_xor_b32 v10, 144, v5
v_xor_b32 v11, 192, v5
v_mfma_f32_16x16x32_bf16 a[84:87], a[180:183], a[212:215], a[84:87]
s_add_u32 s48, s48, s34
v_xor_b32 v12, 208, v5
v_mfma_f32_16x16x32_bf16 a[88:91], a[180:183], a[216:219], a[88:91]
s_add_u32 m0, s32, 24576
v_mfma_f32_16x16x32_bf16 a[92:95], a[180:183], a[220:223], a[92:95]
buffer_load_dwordx4 v1, s[12:15], s48 offen lds
ds_read_b128 a[180:183], v3 offset:9216
v_mfma_f32_16x16x32_bf16 a[96:99], a[184:187], a[192:195], a[96:99]
v_mfma_f32_16x16x32_bf16 a[100:103], a[184:187], a[196:199], a[100:103]
v_mfma_f32_16x16x32_bf16 a[104:107], a[184:187], a[200:203], a[104:107]
v_mfma_f32_16x16x32_bf16 a[108:111], a[184:187], a[204:207], a[108:111]
v_mfma_f32_16x16x32_bf16 a[112:115], a[184:187], a[208:211], a[112:115]
s_add_u32 s48, s48, s34
v_mfma_f32_16x16x32_bf16 a[116:119], a[184:187], a[212:215], a[116:119]
s_add_u32 m0, s32, 28672
v_mfma_f32_16x16x32_bf16 a[120:123], a[184:187], a[216:219], a[120:123]
buffer_load_dwordx4 v1, s[12:15], s48 offen lds
v_mfma_f32_16x16x32_bf16 a[124:127], a[184:187], a[220:223], a[124:127]
s_add_u32 s30, s30, 128
ds_read_b128 a[184:187], v4 offset:12288
v_mfma_f32_16x16x32_bf16 a[128:131], a[188:191], a[192:195], a[128:131]
s_add_u32 s32, s32, 32768
s_add_u32 s29, s29, s44
v_add_u32 v3, 32768, v3
v_mfma_f32_16x16x32_bf16 a[132:135], a[188:191], a[196:199], a[132:135]
s_sub_u32 s48, s32, 98304
v_subrev_u32 v19, 98304, v3
v_mfma_f32_16x16x32_bf16 a[136:139], a[188:191], a[200:203], a[136:139]
s_cmp_ge_u32 s32, 163840
s_cselect_b32 s32, s48, s32
buffer_store_dwordx4 v[116:119], v13, s[8:11], s29 offen sc1
buffer_load_dword v15, v14, s[96:99], s100 offen
v_mfma_f32_16x16x32_bf16 a[140:143], a[188:191], a[204:207], a[140:143]
s_add_u32 s100, s100, 16384
v_cmp_le_u32 vcc, 163840, v3
v_mfma_f32_16x16x32_bf16 a[144:147], a[188:191], a[208:211], a[144:147]
s_nop 0
v_cndmask_b32 v3, v3, v19, vcc
v_mfma_f32_16x16x32_bf16 a[148:151], a[188:191], a[212:215], a[148:151]
v_xor_b32 v4, 64, v3
v_mfma_f32_16x16x32_bf16 a[152:155], a[188:191], a[216:219], a[152:155]
v_mfma_f32_16x16x32_bf16 a[156:159], a[188:191], a[220:223], a[156:159]
s_waitcnt vmcnt(24) lgkmcnt(0)
s_barrier
v_mfma_f32_16x16x32_bf16 v[160:163], a[160:163], a[224:227], v[160:163]
ds_read_b64_tr_b16 a[192:193], v5 offset:0
v_mfma_f32_16x16x32_bf16 v[164:167], a[160:163], a[228:231], v[164:167]
v_mfma_f32_16x16x32_bf16 v[168:171], a[160:163], a[232:235], v[168:171]
ds_read_b64_tr_b16 a[194:195], v5 offset:1024
v_mfma_f32_16x16x32_bf16 v[172:175], a[160:163], a[236:239], v[172:175]
s_add_u32 s37, s31, 0
v_mfma_f32_16x16x32_bf16 v[176:179], a[160:163], a[240:243], v[176:179]
s_add_u32 m0, s33, 0
ds_read_b64_tr_b16 a[196:197], v6 offset:0
v_mfma_f32_16x16x32_bf16 v[180:183], a[160:163], a[244:247], v[180:183]
buffer_load_dwordx4 v2, s[20:23], s37 offen  lds
v_mfma_f32_16x16x32_bf16 v[184:187], a[160:163], a[248:251], v[184:187]
ds_read_b64_tr_b16 a[198:199], v6 offset:1024
v_mfma_f32_16x16x32_bf16 v[188:191], a[160:163], a[252:255], v[188:191]
ds_read_b128 a[160:163], v3 offset:0
v_mfma_f32_16x16x32_bf16 v[192:195], a[164:167], a[224:227], v[192:195]
ds_read_b64_tr_b16 a[200:201], v7 offset:0
v_mfma_f32_16x16x32_bf16 v[196:199], a[164:167], a[228:231], v[196:199]
v_mfma_f32_16x16x32_bf16 v[200:203], a[164:167], a[232:235], v[200:203]
s_add_u32 s37, s31, 32768
ds_read_b64_tr_b16 a[202:203], v7 offset:1024
v_mfma_f32_16x16x32_bf16 v[204:207], a[164:167], a[236:239], v[204:207]
s_add_u32 m0, s33, 1024
v_mfma_f32_16x16x32_bf16 v[208:211], a[164:167], a[240:243], v[208:211]
buffer_load_dwordx4 v2, s[20:23], s37 offen  lds
v_mfma_f32_16x16x32_bf16 v[212:215], a[164:167], a[244:247], v[212:215]
ds_read_b64_tr_b16 a[204:205], v8 offset:0
v_mfma_f32_16x16x32_bf16 v[216:219], a[164:167], a[248:251], v[216:219]
s_add_u32 s29, s29, s93
v_mfma_f32_16x16x32_bf16 v[220:223], a[164:167], a[252:255], v[220:223]
ds_read_b128 a[164:167], v4 offset:1024
v_mfma_f32_16x16x32_bf16 v[224:227], a[168:171], a[224:227], v[224:227]
buffer_store_dwordx4 v[120:123], v13, s[8:11], s29 offen sc1
v_mfma_f32_16x16x32_bf16 v[228:231], a[168:171], a[228:231], v[228:231]
s_add_u32 s37, s31, 131072
ds_read_b64_tr_b16 a[206:207], v8 offset:1024
v_mfma_f32_16x16x32_bf16 v[232:235], a[168:171], a[232:235], v[232:235]
s_add_u32 m0, s33, 4096
v_mfma_f32_16x16x32_bf16 v[236:239], a[168:171], a[236:239], v[236:239]
buffer_load_dwordx4 v2, s[20:23], s37 offen  lds
v_mfma_f32_16x16x32_bf16 v[240:243], a[168:171], a[240:243], v[240:243]
ds_read_b64_tr_b16 a[208:209], v9 offset:0
v_mfma_f32_16x16x32_bf16 v[244:247], a[168:171], a[244:247], v[244:247]
v_mfma_f32_16x16x32_bf16 v[248:251], a[168:171], a[248:251], v[248:251]
ds_read_b64_tr_b16 a[210:211], v9 offset:1024
v_mfma_f32_16x16x32_bf16 v[252:255], a[168:171], a[252:255], v[252:255]
ds_read_b128 a[168:171], v3 offset:4096
v_mfma_f32_16x16x32_bf16 a[0:3], a[172:175], a[224:227], a[0:3]
s_add_u32 s37, s31, 163840
ds_read_b64_tr_b16 a[212:213], v10 offset:0
v_mfma_f32_16x16x32_bf16 a[4:7], a[172:175], a[228:231], a[4:7]
s_add_u32 m0, s33, 5120
v_mfma_f32_16x16x32_bf16 a[8:11], a[172:175], a[232:235], a[8:11]
buffer_load_dwordx4 v2, s[20:23], s37 offen  lds
v_mfma_f32_16x16x32_bf16 a[12:15], a[172:175], a[236:239], a[12:15]
s_add_u32 s31, s31, 262144
ds_read_b64_tr_b16 a[214:215], v10 offset:1024
v_mfma_f32_16x16x32_bf16 a[16:19], a[172:175], a[240:243], a[16:19]
s_add_u32 s33, s33, 16384
v_mfma_f32_16x16x32_bf16 a[20:23], a[172:175], a[244:247], a[20:23]
s_and_b32 s33, s33, 65535
ds_read_b64_tr_b16 a[216:217], v11 offset:0
v_mfma_f32_16x16x32_bf16 a[24:27], a[172:175], a[248:251], a[24:27]
v_mfma_f32_16x16x32_bf16 a[28:31], a[172:175], a[252:255], a[28:31]
s_mov_b32 s48, s30
ds_read_b128 a[172:175], v4 offset:5120
v_mfma_f32_16x16x32_bf16 a[32:35], a[176:179], a[224:227], a[32:35]
s_add_u32 m0, s32, 0
ds_read_b64_tr_b16 a[218:219], v11 offset:1024
v_mfma_f32_16x16x32_bf16 a[36:39], a[176:179], a[228:231], a[36:39]
buffer_load_dwordx4 v1, s[12:15], s48 offen lds
v_mfma_f32_16x16x32_bf16 a[40:43], a[176:179], a[232:235], a[40:43]
ds_read_b64_tr_b16 a[220:221], v12 offset:0
v_mfma_f32_16x16x32_bf16 a[44:47], a[176:179], a[236:239], a[44:47]
s_add_u32 s29, s29, s44
v_mfma_f32_16x16x32_bf16 a[48:51], a[176:179], a[240:243], a[48:51]
ds_read_b64_tr_b16 a[222:223], v12 offset:1024
v_mfma_f32_16x16x32_bf16 a[52:55], a[176:179], a[244:247], a[52:55]
buffer_store_dwordx4 v[124:127], v13, s[8:11], s29 offen sc1
v_mfma_f32_16x16x32_bf16 a[56:59], a[176:179], a[248:251], a[56:59]
s_add_u32 s48, s48, s34
ds_read_b128 a[188:191], v4 offset:13312
v_mfma_f32_16x16x32_bf16 a[60:63], a[176:179], a[252:255], a[60:63]
s_add_u32 m0, s32, 4096
ds_read_b128 a[176:179], v3 offset:8192
v_mfma_f32_16x16x32_bf16 a[64:67], a[180:183], a[224:227], a[64:67]
buffer_load_dwordx4 v1, s[12:15], s48 offen lds
v_mfma_f32_16x16x32_bf16 a[68:71], a[180:183], a[228:231], a[68:71]
v_add_u32 v5, 16384, v5
v_and_b32 v5, 65535, v5
v_mfma_f32_16x16x32_bf16 a[72:75], a[180:183], a[232:235], a[72:75]
v_xor_b32 v6, 16, v5
v_xor_b32 v7, 64, v5
v_mfma_f32_16x16x32_bf16 a[76:79], a[180:183], a[236:239], a[76:79]
v_xor_b32 v8, 80, v5
v_xor_b32 v9, 128, v5
v_mfma_f32_16x16x32_bf16 a[80:83], a[180:183], a[240:243], a[80:83]
v_xor_b32 v10, 144, v5
v_xor_b32 v11, 192, v5
v_mfma_f32_16x16x32_bf16 a[84:87], a[180:183], a[244:247], a[84:87]
s_add_u32 s48, s48, s34
v_xor_b32 v12, 208, v5
v_mfma_f32_16x16x32_bf16 a[88:91], a[180:183], a[248:251], a[88:91]
s_add_u32 m0, s32, 8192
v_mfma_f32_16x16x32_bf16 a[92:95], a[180:183], a[252:255], a[92:95]
buffer_load_dwordx4 v1, s[12:15], s48 offen lds
ds_read_b128 a[180:183], v4 offset:9216
v_mfma_f32_16x16x32_bf16 a[96:99], a[184:187], a[224:227], a[96:99]
v_mfma_f32_16x16x32_bf16 a[100:103], a[184:187], a[228:231], a[100:103]
v_mfma_f32_16x16x32_bf16 a[104:107], a[184:187], a[232:235], a[104:107]
v_mfma_f32_16x16x32_bf16 a[108:111], a[184:187], a[236:239], a[108:111]
v_mfma_f32_16x16x32_bf16 a[112:115], a[184:187], a[240:243], a[112:115]
s_add_u32 s48, s48, s34
v_mfma_f32_16x16x32_bf16 a[116:119], a[184:187], a[244:247], a[116:119]
s_add_u32 m0, s32, 12288
v_mfma_f32_16x16x32_bf16 a[120:123], a[184:187], a[248:251], a[120:123]
buffer_load_dwordx4 v1, s[12:15], s48 offen lds
v_mfma_f32_16x16x32_bf16 a[124:127], a[184:187], a[252:255], a[124:127]
ds_read_b128 a[184:187], v3 offset:12288
v_mfma_f32_16x16x32_bf16 a[128:131], v[28:31], a[224:227], a[128:131]
v_mfma_f32_16x16x32_bf16 a[132:135], v[28:31], a[228:231], a[132:135]
v_mfma_f32_16x16x32_bf16 a[136:139], v[28:31], a[232:235], a[136:139]
buffer_load_dword v15, v14, s[96:99], s100 offen
v_mfma_f32_16x16x32_bf16 a[140:143], v[28:31], a[236:239], a[140:143]
s_add_u32 s100, s100, 16384
v_mfma_f32_16x16x32_bf16 a[144:147], v[28:31], a[240:243], a[144:147]
v_mfma_f32_16x16x32_bf16 a[148:151], v[28:31], a[244:247], a[148:151]
v_mfma_f32_16x16x32_bf16 a[152:155], v[28:31], a[248:251], a[152:155]
v_mfma_f32_16x16x32_bf16 a[156:159], v[28:31], a[252:255], a[156:159]
s_cmp_eq_u32 s36, 0
s_cbranch_scc1 L_g_v12
s_waitcnt vmcnt(23) lgkmcnt(0)
s_barrier
v_mfma_f32_16x16x32_bf16 v[160:163], a[160:163], a[192:195], v[160:163]
ds_read_b64_tr_b16 a[224:225], v5 offset:0
v_mfma_f32_16x16x32_bf16 v[164:167], a[160:163], a[196:199], v[164:167]
v_mfma_f32_16x16x32_bf16 v[168:171], a[160:163], a[200:203], v[168:171]
ds_read_b64_tr_b16 a[226:227], v5 offset:1024
v_mfma_f32_16x16x32_bf16 v[172:175], a[160:163], a[204:207], v[172:175]
s_add_u32 s37, s31, 0
v_mfma_f32_16x16x32_bf16 v[176:179], a[160:163], a[208:211], v[176:179]
s_add_u32 m0, s33, 0
ds_read_b64_tr_b16 a[228:229], v6 offset:0
v_mfma_f32_16x16x32_bf16 v[180:183], a[160:163], a[212:215], v[180:183]
buffer_load_dwordx4 v2, s[20:23], s37 offen  lds
v_mfma_f32_16x16x32_bf16 v[184:187], a[160:163], a[216:219], v[184:187]
ds_read_b64_tr_b16 a[230:231], v6 offset:1024
v_mfma_f32_16x16x32_bf16 v[188:191], a[160:163], a[220:223], v[188:191]
ds_read_b128 a[160:163], v4 offset:0
v_mfma_f32_16x16x32_bf16 v[192:195], a[164:167], a[192:195], v[192:195]
ds_read_b64_tr_b16 a[232:233], v7 offset:0
v_mfma_f32_16x16x32_bf16 v[196:199], a[164:167], a[196:199], v[196:199]
v_mfma_f32_16x16x32_bf16 v[200:203], a[164:167], a[200:203], v[200:203]
s_add_u32 s37, s31, 32768
ds_read_b64_tr_b16 a[234:235], v7 offset:1024
v_mfma_f32_16x16x32_bf16 v[204:207], a[164:167], a[204:207], v[204:207]
s_add_u32 m0, s33, 1024
v_mfma_f32_16x16x32_bf16 v[208:211], a[164:167], a[208:211], v[208:211]
buffer_load_dwordx4 v2, s[20:23], s37 offen  lds
v_mfma_f32_16x16x32_bf16 v[212:215], a[164:167], a[212:215], v[212:215]
ds_read_b64_tr_b16 a[236:237], v8 offset:0
v_mfma_f32_16x16x32_bf16 v[216:219], a[164:167], a[216:219], v[216:219]
v_mfma_f32_16x16x32_bf16 v[220:223], a[164:167], a[220:223], v[220:223]
ds_read_b128 a[164:167], v3 offset:1024
v_mfma_f32_16x16x32_bf16 v[224:227], a[168:171], a[192:195], v[224:227]
ds_read_b64_tr_b16 a[238:239], v8 offset:1024
v_mfma_f32_16x16x32_bf16 v[228:231], a[168:171], a[196:199], v[228:231]
s_add_u32 s37, s31, 131072
v_mfma_f32_16x16x32_bf16 v[232:235], a[168:171], a[200:203], v[232:235]
s_add_u32 m0, s33, 4096
ds_read_b64_tr_b16 a[240:241], v9 offset:0
v_mfma_f32_16x16x32_bf16 v[236:239], a[168:171], a[204:207], v[236:239]
buffer_load_dwordx4 v2, s[20:23], s37 offen  lds
v_mfma_f32_16x16x32_bf16 v[240:243], a[168:171], a[208:211], v[240:243]
ds_read_b64_tr_b16 a[242:243], v9 offset:1024
v_mfma_f32_16x16x32_bf16 v[244:247], a[168:171], a[212:215], v[244:247]
v_mfma_f32_16x16x32_bf16 v[248:251], a[168:171], a[216:219], v[248:251]
ds_read_b64_tr_b16 a[244:245], v10 offset:0
v_mfma_f32_16x16x32_bf16 v[252:255], a[168:171], a[220:223], v[252:255]
ds_read_b128 a[168:171], v4 offset:4096
v_mfma_f32_16x16x32_bf16 a[0:3], a[172:175], a[192:195], a[0:3]
s_add_u32 s37, s31, 163840
ds_read_b64_tr_b16 a[246:247], v10 offset:1024
v_mfma_f32_16x16x32_bf16 a[4:7], a[172:175], a[196:199], a[4:7]
s_add_u32 m0, s33, 5120
v_mfma_f32_16x16x32_bf16 a[8:11], a[172:175], a[200:203], a[8:11]
buffer_load_dwordx4 v2, s[20:23], s37 offen  lds
v_mfma_f32_16x16x32_bf16 a[12:15], a[172:175], a[204:207], a[12:15]
s_add_u32 s31, s31, 262144
ds_read_b64_tr_b16 a[248:249], v11 offset:0
v_mfma_f32_16x16x32_bf16 a[16:19], a[172:175], a[208:211], a[16:19]
s_add_u32 s33, s33, 16384
v_mfma_f32_16x16x32_bf16 a[20:23], a[172:175], a[212:215], a[20:23]
s_and_b32 s33, s33, 65535
ds_read_b64_tr_b16 a[250:251], v11 offset:1024
v_mfma_f32_16x16x32_bf16 a[24:27], a[172:175], a[216:219], a[24:27]
v_mfma_f32_16x16x32_bf16 a[28:31], a[172:175], a[220:223], a[28:31]
s_add_u32 s48, s48, s34
ds_read_b128 a[172:175], v3 offset:5120
v_mfma_f32_16x16x32_bf16 a[32:35], a[176:179], a[192:195], a[32:35]
s_add_u32 m0, s32, 16384
ds_read_b64_tr_b16 a[252:253], v12 offset:0
v_mfma_f32_16x16x32_bf16 a[36:39], a[176:179], a[196:199], a[36:39]
buffer_load_dwordx4 v1, s[12:15], s48 offen lds
v_mfma_f32_16x16x32_bf16 a[40:43], a[176:179], a[200:203], a[40:43]
ds_read_b64_tr_b16 a[254:255], v12 offset:1024
v_mfma_f32_16x16x32_bf16 a[44:47], a[176:179], a[204:207], a[44:47]
v_mfma_f32_16x16x32_bf16 a[48:51], a[176:179], a[208:211], a[48:51]
ds_read_b128 v[28:31], v3 offset:13312
v_mfma_f32_16x16x32_bf16 a[52:55], a[176:179], a[212:215], a[52:55]
v_mfma_f32_16x16x32_bf16 a[56:59], a[176:179], a[216:219], a[56:59]
s_add_u32 s48, s48, s34
v_mfma_f32_16x16x32_bf16 a[60:63], a[176:179], a[220:223], a[60:63]
s_add_u32 m0, s32, 20480
ds_read_b128 a[176:179], v4 offset:8192
v_add_u32 v5, 16384, v5
v_mfma_f32_16x16x32_bf16 a[64:67], a[180:183], a[192:195], a[64:67]
buffer_load_dwordx4 v1, s[12:15], s48 offen lds
v_and_b32 v5, 65535, v5
v_mfma_f32_16x16x32_bf16 a[68:71], a[180:183], a[196:199], a[68:71]
v_xor_b32 v6, 16, v5
v_xor_b32 v7, 64, v5
v_mfma_f32_16x16x32_bf16 a[72:75], a[180:183], a[200:203], a[72:75]
v_xor_b32 v8, 80, v5
v_xor_b32 v9, 128, v5
v_mfma_f32_16x16x32_bf16 a[76:79], a[180:183], a[204:207], a[76:79]
v_xor_b32 v10, 144, v5
v_xor_b32 v11, 192, v5
v_mfma_f32_16x16x32_bf16 a[80:83], a[180:183], a[208:211], a[80:83]
v_xor_b32 v12, 208, v5
v_mfma_f32_16x16x32_bf16 a[84:87], a[180:183], a[212:215], a[84:87]
s_add_u32 s48, s48, s34
v_mfma_f32_16x16x32_bf16 a[88:91], a[180:183], a[216:219], a[88:91]
s_add_u32 m0, s32, 24576
v_mfma_f32_16x16x32_bf16 a[92:95], a[180:183], a[220:223], a[92:95]
buffer_load_dwordx4 v1, s[12:15], s48 offen lds
ds_read_b128 a[180:183], v3 offset:9216
v_mfma_f32_16x16x32_bf16 a[96:99], a[184:187], a[192:195], a[96:99]
v_mfma_f32_16x16x32_bf16 a[100:103], a[184:187], a[196:199], a[100:103]
v_mfma_f32_16x16x32_bf16 a[104:107], a[184:187], a[200:203], a[104:107]
v_mfma_f32_16x16x32_bf16 a[108:111], a[184:187], a[204:207], a[108:111]
v_mfma_f32_16x16x32_bf16 a[112:115], a[184:187], a[208:211], a[112:115]
s_add_u32 s48, s48, s34
v_mfma_f32_16x16x32_bf16 a[116:119], a[184:187], a[212:215], a[116:119]
s_add_u32 m0, s32, 28672
v_mfma_f32_16x16x32_bf16 a[120:123], a[184:187], a[216:219], a[120:123]
buffer_load_dwordx4 v1, s[12:15], s48 offen lds
v_mfma_f32_16x16x32_bf16 a[124:127], a[184:187], a[220:223], a[124:127]
s_add_u32 s30, s30, 128
ds_read_b128 a[184:187], v4 offset:12288
v_mfma_f32_16x16x32_bf16 a[128:131], a[188:191], a[192:195], a[128:131]
s_add_u32 s32, s32, 32768
v_add_u32 v3, 32768, v3
v_mfma_f32_16x16x32_bf16 a[132:135], a[188:191], a[196:199], a[132:135]
s_sub_u32 s48, s32, 98304
v_subrev_u32 v19, 98304, v3
v_mfma_f32_16x16x32_bf16 a[136:139], a[188:191], a[200:203], a[136:139]
s_cmp_ge_u32 s32, 163840
s_cselect_b32 s32, s48, s32
v_mfma_f32_16x16x32_bf16 a[140:143], a[188:191], a[204:207], a[140:143]
v_cmp_le_u32 vcc, 163840, v3
v_mfma_f32_16x16x32_bf16 a[144:147], a[188:191], a[208:211], a[144:147]
s_nop 0
v_cndmask_b32 v3, v3, v19, vcc
v_mfma_f32_16x16x32_bf16 a[148:151], a[188:191], a[212:215], a[148:151]
v_xor_b32 v4, 64, v3
v_mfma_f32_16x16x32_bf16 a[152:155], a[188:191], a[216:219], a[152:155]
v_mfma_f32_16x16x32_bf16 a[156:159], a[188:191], a[220:223], a[156:159]
s_waitcnt vmcnt(19) lgkmcnt(0)
s_barrier
v_mfma_f32_16x16x32_bf16 v[160:163], a[160:163], a[224:227], v[160:163]
ds_read_b64_tr_b16 a[192:193], v5 offset:0
v_mfma_f32_16x16x32_bf16 v[164:167], a[160:163], a[228:231], v[164:167]
v_mfma_f32_16x16x32_bf16 v[168:171], a[160:163], a[232:235], v[168:171]
ds_read_b64_tr_b16 a[194:195], v5 offset:1024
v_mfma_f32_16x16x32_bf16 v[172:175], a[160:163], a[236:239], v[172:175]
s_add_u32 s37, s31, 0
v_mfma_f32_16x16x32_bf16 v[176:179], a[160:163], a[240:243], v[176:179]
s_add_u32 m0, s33, 0
ds_read_b64_tr_b16 a[196:197], v6 offset:0
v_mfma_f32_16x16x32_bf16 v[180:183], a[160:163], a[244:247], v[180:183]
buffer_load_dwordx4 v2, s[20:23], s37 offen  lds
v_mfma_f32_16x16x32_bf16 v[184:187], a[160:163], a[248:251], v[184:187]
ds_read_b64_tr_b16 a[198:199], v6 offset:1024
v_mfma_f32_16x16x32_bf16 v[188:191], a[160:163], a[252:255], v[188:191]
ds_read_b128 a[160:163], v3 offset:0
v_mfma_f32_16x16x32_bf16 v[192:195], a[164:167], a[224:227], v[192:195]
ds_read_b64_tr_b16 a[200:201], v7 offset:0
v_mfma_f32_16x16x32_bf16 v[196:199], a[164:167], a[228:231], v[196:199]
v_mfma_f32_16x16x32_bf16 v[200:203], a[164:167], a[232:235], v[200:203]
s_add_u32 s37, s31, 32768
ds_read_b64_tr_b16 a[202:203], v7 offset:1024
v_mfma_f32_16x16x32_bf16 v[204:207], a[164:167], a[236:239], v[204:207]
s_add_u32 m0, s33, 1024
v_mfma_f32_16x16x32_bf16 v[208:211], a[164:167], a[240:243], v[208:211]
buffer_load_dwordx4 v2, s[20:23], s37 offen  lds
v_mfma_f32_16x16x32_bf16 v[212:215], a[164:167], a[244:247], v[212:215]
ds_read_b64_tr_b16 a[204:205], v8 offset:0
v_mfma_f32_16x16x32_bf16 v[216:219], a[164:167], a[248:251], v[216:219]
v_mfma_f32_16x16x32_bf16 v[220:223], a[164:167], a[252:255], v[220:223]
ds_read_b128 a[164:167], v4 offset:1024
v_mfma_f32_16x16x32_bf16 v[224:227], a[168:171], a[224:227], v[224:227]
ds_read_b64_tr_b16 a[206:207], v8 offset:1024
v_mfma_f32_16x16x32_bf16 v[228:231], a[168:171], a[228:231], v[228:231]
s_add_u32 s37, s31, 131072
v_mfma_f32_16x16x32_bf16 v[232:235], a[168:171], a[232:235], v[232:235]
s_add_u32 m0, s33, 4096
ds_read_b64_tr_b16 a[208:209], v9 offset:0
v_mfma_f32_16x16x32_bf16 v[236:239], a[168:171], a[236:239], v[236:239]
buffer_load_dwordx4 v2, s[20:23], s37 offen  lds
v_mfma_f32_16x16x32_bf16 v[240:243], a[168:171], a[240:243], v[240:243]
ds_read_b64_tr_b16 a[210:211], v9 offset:1024
v_mfma_f32_16x16x32_bf16 v[244:247], a[168:171], a[244:247], v[244:247]
v_mfma_f32_16x16x32_bf16 v[248:251], a[168:171], a[248:251], v[248:251]
ds_read_b64_tr_b16 a[212:213], v10 offset:0
v_mfma_f32_16x16x32_bf16 v[252:255], a[168:171], a[252:255], v[252:255]
ds_read_b128 a[168:171], v3 offset:4096
v_mfma_f32_16x16x32_bf16 a[0:3], a[172:175], a[224:227], a[0:3]
s_add_u32 s37, s31, 163840
ds_read_b64_tr_b16 a[214:215], v10 offset:1024
v_mfma_f32_16x16x32_bf16 a[4:7], a[172:175], a[228:231], a[4:7]
s_add_u32 m0, s33, 5120
v_mfma_f32_16x16x32_bf16 a[8:11], a[172:175], a[232:235], a[8:11]
buffer_load_dwordx4 v2, s[20:23], s37 offen  lds
v_mfma_f32_16x16x32_bf16 a[12:15], a[172:175], a[236:239], a[12:15]
s_add_u32 s31, s31, 262144
ds_read_b64_tr_b16 a[216:217], v11 offset:0
v_mfma_f32_16x16x32_bf16 a[16:19], a[172:175], a[240:243], a[16:19]
s_add_u32 s33, s33, 16384
v_mfma_f32_16x16x32_bf16 a[20:23], a[172:175], a[244:247], a[20:23]
s_and_b32 s33, s33, 65535
ds_read_b64_tr_b16 a[218:219], v11 offset:1024
v_mfma_f32_16x16x32_bf16 a[24:27], a[172:175], a[248:251], a[24:27]
v_mfma_f32_16x16x32_bf16 a[28:31], a[172:175], a[252:255], a[28:31]
s_mov_b32 s48, s30
ds_read_b128 a[172:175], v4 offset:5120
v_mfma_f32_16x16x32_bf16 a[32:35], a[176:179], a[224:227], a[32:35]
s_add_u32 m0, s32, 0
ds_read_b64_tr_b16 a[220:221], v12 offset:0
v_mfma_f32_16x16x32_bf16 a[36:39], a[176:179], a[228:231], a[36:39]
buffer_load_dwordx4 v1, s[12:15], s48 offen lds
v_mfma_f32_16x16x32_bf16 a[40:43], a[176:179], a[232:235], a[40:43]
ds_read_b64_tr_b16 a[222:223], v12 offset:1024
v_mfma_f32_16x16x32_bf16 a[44:47], a[176:179], a[236:239], a[44:47]
v_mfma_f32_16x16x32_bf16 a[48:51], a[176:179], a[240:243], a[48:51]
ds_read_b128 a[188:191], v4 offset:13312
v_mfma_f32_16x16x32_bf16 a[52:55], a[176:179], a[244:247], a[52:55]
v_mfma_f32_16x16x32_bf16 a[56:59], a[176:179], a[248:251], a[56:59]
s_add_u32 s48, s48, s34
v_mfma_f32_16x16x32_bf16 a[60:63], a[176:179], a[252:255], a[60:63]
s_add_u32 m0, s32, 4096
ds_read_b128 a[176:179], v3 offset:8192
v_add_u32 v5, 16384, v5
v_mfma_f32_16x16x32_bf16 a[64:67], a[180:183], a[224:227], a[64:67]
buffer_load_dwordx4 v1, s[12:15], s48 offen lds
v_and_b32 v5, 65535, v5
v_mfma_f32_16x16x32_bf16 a[68:71], a[180:183], a[228:231], a[68:71]
v_xor_b32 v6, 16, v5
v_xor_b32 v7, 64, v5
v_mfma_f32_16x16x32_bf16 a[72:75], a[180:183], a[232:235], a[72:75]
v_xor_b32 v8, 80, v5
v_xor_b32 v9, 128, v5
v_mfma_f32_16x16x32_bf16 a[76:79], a[180:183], a[236:239], a[76:79]
v_xor_b32 v10, 144, v5
v_xor_b32 v11, 192, v5
v_mfma_f32_16x16x32_bf16 a[80:83], a[180:183], a[240:243], a[80:83]
v_xor_b32 v12, 208, v5
v_mfma_f32_16x16x32_bf16 a[84:87], a[180:183], a[244:247], a[84:87]
s_add_u32 s48, s48, s34
v_mfma_f32_16x16x32_bf16 a[88:91], a[180:183], a[248:251], a[88:91]
s_add_u32 m0, s32, 8192
v_mfma_f32_16x16x32_bf16 a[92:95], a[180:183], a[252:255], a[92:95]
buffer_load_dwordx4 v1, s[12:15], s48 offen lds
ds_read_b128 a[180:183], v4 offset:9216
v_mfma_f32_16x16x32_bf16 a[96:99], a[184:187], a[224:227], a[96:99]
v_mfma_f32_16x16x32_bf16 a[100:103], a[184:187], a[228:231], a[100:103]
v_mfma_f32_16x16x32_bf16 a[104:107], a[184:187], a[232:235], a[104:107]
v_mfma_f32_16x16x32_bf16 a[108:111], a[184:187], a[236:239], a[108:111]
v_mfma_f32_16x16x32_bf16 a[112:115], a[184:187], a[240:243], a[112:115]
s_add_u32 s48, s48, s34
v_mfma_f32_16x16x32_bf16 a[116:119], a[184:187], a[244:247], a[116:119]
s_add_u32 m0, s32, 12288
v_mfma_f32_16x16x32_bf16 a[120:123], a[184:187], a[248:251], a[120:123]
buffer_load_dwordx4 v1, s[12:15], s48 offen lds
v_mfma_f32_16x16x32_bf16 a[124:127], a[184:187], a[252:255], a[124:127]
ds_read_b128 a[184:187], v3 offset:12288
v_mfma_f32_16x16x32_bf16 a[128:131], v[28:31], a[224:227], a[128:131]
v_mfma_f32_16x16x32_bf16 a[132:135], v[28:31], a[228:231], a[132:135]
v_mfma_f32_16x16x32_bf16 a[136:139], v[28:31], a[232:235], a[136:139]
v_mfma_f32_16x16x32_bf16 a[140:143], v[28:31], a[236:239], a[140:143]
v_mfma_f32_16x16x32_bf16 a[144:147], v[28:31], a[240:243], a[144:147]
v_mfma_f32_16x16x32_bf16 a[148:151], v[28:31], a[244:247], a[148:151]
v_mfma_f32_16x16x32_bf16 a[152:155], v[28:31], a[248:251], a[152:155]
v_mfma_f32_16x16x32_bf16 a[156:159], v[28:31], a[252:255], a[156:159]
L_g_v12:
s_waitcnt vmcnt(16) lgkmcnt(0)
s_barrier
v_mfma_f32_16x16x32_bf16 v[160:163], a[160:163], a[192:195], v[160:163]
ds_read_b64_tr_b16 a[224:225], v5 offset:0
s_lshr_b32 s24, s16, 1
v_mfma_f32_16x16x32_bf16 v[164:167], a[160:163], a[196:199], v[164:167]
s_cmp_eq_u32 s35, 5
s_cselect_b32 s90, s24, s90
v_mfma_f32_16x16x32_bf16 v[168:171], a[160:163], a[200:203], v[168:171]
ds_read_b64_tr_b16 a[226:227], v5 offset:1024
s_lshl_b32 s24, s35, 2
v_mfma_f32_16x16x32_bf16 v[172:175], a[160:163], a[204:207], v[172:175]
s_add_u32 s37, s31, 0
s_lshr_b32 s26, s88, s24
s_bfe_u32 s2, s26, 0x10003
v_mfma_f32_16x16x32_bf16 v[176:179], a[160:163], a[208:211], v[176:179]
s_add_u32 m0, s33, 0
ds_read_b64_tr_b16 a[228:229], v6 offset:0
s_and_b32 s26, s26, 7
v_mfma_f32_16x16x32_bf16 v[180:183], a[160:163], a[212:215], v[180:183]
buffer_load_dwordx4 v2, s[20:23], s37 offen  lds
s_or_b32 s40, s2, s61
v_mfma_f32_16x16x32_bf16 v[184:187], a[160:163], a[216:219], v[184:187]
ds_read_b64_tr_b16 a[230:231], v6 offset:1024
s_lshr_b32 s24, s17, 1
v_mfma_f32_16x16x32_bf16 v[188:191], a[160:163], a[220:223], v[188:191]
ds_read_b128 a[160:163], v4 offset:0
v_mfma_f32_16x16x32_bf16 v[192:195], a[164:167], a[192:195], v[192:195]
ds_read_b64_tr_b16 a[232:233], v7 offset:0
v_mfma_f32_16x16x32_bf16 v[196:199], a[164:167], a[196:199], v[196:199]
s_cmp_eq_u32 s2, 0
s_cselect_b32 s41, s24, 0
s_cselect_b32 s27, s89, s90
v_mfma_f32_16x16x32_bf16 v[200:203], a[164:167], a[200:203], v[200:203]
s_add_u32 s37, s31, 32768
ds_read_b64_tr_b16 a[234:235], v7 offset:1024
s_sub_u32 s25, s24, s41
v_mfma_f32_16x16x32_bf16 v[204:207], a[164:167], a[204:207], v[204:207]
s_add_u32 m0, s33, 1024
s_and_b32 s51, s41, s61
s_lshl_b32 s51, s51, 1
v_mfma_f32_16x16x32_bf16 v[208:211], a[164:167], a[208:211], v[208:211]
buffer_load_dwordx4 v2, s[20:23], s37 offen  lds
s_or_b32 s51, s51, s41
v_mfma_f32_16x16x32_bf16 v[212:215], a[164:167], a[212:215], v[212:215]
ds_read_b64_tr_b16 a[236:237], v8 offset:0
s_lshl2_add_u32 s51, s2, s51
v_mfma_f32_16x16x32_bf16 v[216:219], a[164:167], a[216:219], v[216:219]
s_add_u32 s60, s60, s92
s_lshl_b32 s46, s27, s2
s_add_u32 s46, s46, s25
v_mfma_f32_16x16x32_bf16 v[220:223], a[164:167], a[220:223], v[220:223]
s_mov_b32 s29, s60
ds_read_b128 a[164:167], v3 offset:1024
s_lshl_b32 s46, s46, 8
v_mfma_f32_16x16x32_bf16 v[224:227], a[168:171], a[192:195], v[224:227]
buffer_store_dwordx4 v[128:131], v13, s[8:11], s29 offen sc1
s_lshl_b32 s47, s40, 7
v_mfma_f32_16x16x32_bf16 v[228:231], a[168:171], a[196:199], v[228:231]
s_add_u32 s37, s31, 131072
ds_read_b64_tr_b16 a[238:239], v8 offset:1024
s_add_u32 s47, s47, 1024
v_mfma_f32_16x16x32_bf16 v[232:235], a[168:171], a[200:203], v[232:235]
s_add_u32 m0, s33, 4096
s_mul_i32 s101, s26, s47
s_lshl_b32 s101, s101, 8
v_mfma_f32_16x16x32_bf16 v[236:239], a[168:171], a[204:207], v[236:239]
buffer_load_dwordx4 v2, s[20:23], s37 offen  lds
s_and_b32 s25, s17, 1
v_mfma_f32_16x16x32_bf16 v[240:243], a[168:171], a[208:211], v[240:243]
ds_read_b64_tr_b16 a[240:241], v9 offset:0
s_lshl1_add_u32 s42, s26, s25
v_mfma_f32_16x16x32_bf16 v[244:247], a[168:171], a[212:215], v[244:247]
s_lshl_b32 s42, s42, 7
s_lshr_b32 s42, s42, s2
s_add_u32 s42, s42, s27
v_mfma_f32_16x16x32_bf16 v[248:251], a[168:171], a[216:219], v[248:251]
ds_read_b64_tr_b16 a[242:243], v9 offset:1024
s_lshl1_add_u32 s42, s42, s24
v_mfma_f32_16x16x32_bf16 v[252:255], a[168:171], a[220:223], v[252:255]
ds_read_b128 a[168:171], v4 offset:4096
s_lshl_b32 s42, s42, 13
v_mfma_f32_16x16x32_bf16 a[0:3], a[172:175], a[192:195], a[0:3]
s_add_u32 s37, s31, 163840
ds_read_b64_tr_b16 a[244:245], v10 offset:0
s_lshl_b32 s43, s27, 5
v_mfma_f32_16x16x32_bf16 a[4:7], a[172:175], a[196:199], a[4:7]
s_add_u32 m0, s33, 5120
s_add_u32 s43, s43, s26
s_lshl_b32 s43, s43, 2
v_mfma_f32_16x16x32_bf16 a[8:11], a[172:175], a[200:203], a[8:11]
buffer_load_dwordx4 v2, s[20:23], s37 offen  lds
s_lshl_b32 s24, s2, 1
v_mfma_f32_16x16x32_bf16 a[12:15], a[172:175], a[204:207], a[12:15]
s_add_u32 s31, s31, 262144
ds_read_b64_tr_b16 a[246:247], v10 offset:1024
s_add_u32 s24, s24, s61
v_mfma_f32_16x16x32_bf16 a[16:19], a[172:175], a[208:211], a[16:19]
s_add_u32 s33, s33, 16384
s_lshl_b32 s24, s24, 2
s_lshr_b32 s25, 0x8720, s24
v_mfma_f32_16x16x32_bf16 a[20:23], a[172:175], a[212:215], a[20:23]
s_and_b32 s33, s33, 65535
ds_read_b64_tr_b16 a[248:249], v11 offset:0
s_and_b32 s25, s25, 15
v_mfma_f32_16x16x32_bf16 a[24:27], a[172:175], a[216:219], a[24:27]
s_lshl_b32 s25, s25, 24
s_add_u32 s42, s42, s25
s_lshr_b32 s25, 0x7604, s24
v_mfma_f32_16x16x32_bf16 a[28:31], a[172:175], a[220:223], a[28:31]
s_add_u32 s48, s48, s34
ds_read_b128 a[172:175], v3 offset:5120
s_and_b32 s25, s25, 15
v_mfma_f32_16x16x32_bf16 a[32:35], a[176:179], a[192:195], a[32:35]
s_add_u32 m0, s32, 16384
ds_read_b64_tr_b16 a[250:251], v11 offset:1024
s_lshl_b32 s25, s25, 12
v_mfma_f32_16x16x32_bf16 a[36:39], a[176:179], a[196:199], a[36:39]
buffer_load_dwordx4 v1, s[12:15], s48 offen lds
s_add_u32 s43, s43, s25
v_mfma_f32_16x16x32_bf16 a[40:43], a[176:179], a[200:203], a[40:43]
ds_read_b64_tr_b16 a[252:253], v12 offset:0
s_add_u32 s43, s43, 111149056
v_mfma_f32_16x16x32_bf16 a[44:47], a[176:179], a[204:207], a[44:47]
s_add_u32 s29, s29, s44
v_mfma_f32_16x16x32_bf16 a[48:51], a[176:179], a[208:211], a[48:51]
ds_read_b64_tr_b16 a[254:255], v12 offset:1024
v_mfma_f32_16x16x32_bf16 a[52:55], a[176:179], a[212:215], a[52:55]
buffer_store_dwordx4 v[132:135], v13, s[8:11], s29 offen sc1
v_mfma_f32_16x16x32_bf16 a[56:59], a[176:179], a[216:219], a[56:59]
s_add_u32 s48, s48, s34
ds_read_b128 v[28:31], v3 offset:13312
v_mfma_f32_16x16x32_bf16 a[60:63], a[176:179], a[220:223], a[60:63]
s_add_u32 m0, s32, 20480
ds_read_b128 a[176:179], v4 offset:8192
v_mfma_f32_16x16x32_bf16 a[64:67], a[180:183], a[192:195], a[64:67]
buffer_load_dwordx4 v1, s[12:15], s48 offen lds
v_mfma_f32_16x16x32_bf16 a[68:71], a[180:183], a[196:199], a[68:71]
s_cmp_lt_u32 s35, s45
s_cselect_b32 s101, s101, 536870912
s_cselect_b32 s46, s46, 536870912
v_mfma_f32_16x16x32_bf16 a[72:75], a[180:183], a[200:203], a[72:75]
v_add_u32 v5, 16384, v5
v_and_b32 v5, 65535, v5
v_mfma_f32_16x16x32_bf16 a[76:79], a[180:183], a[204:207], a[76:79]
v_xor_b32 v6, 16, v5
v_xor_b32 v7, 64, v5
v_mfma_f32_16x16x32_bf16 a[80:83], a[180:183], a[208:211], a[80:83]
v_xor_b32 v8, 80, v5
v_xor_b32 v9, 128, v5
v_mfma_f32_16x16x32_bf16 a[84:87], a[180:183], a[212:215], a[84:87]
s_add_u32 s48, s48, s34
v_xor_b32 v10, 144, v5
v_xor_b32 v11, 192, v5
v_mfma_f32_16x16x32_bf16 a[88:91], a[180:183], a[216:219], a[88:91]
s_add_u32 m0, s32, 24576
v_xor_b32 v12, 208, v5
v_mfma_f32_16x16x32_bf16 a[92:95], a[180:183], a[220:223], a[92:95]
buffer_load_dwordx4 v1, s[12:15], s48 offen lds
ds_read_b128 a[180:183], v3 offset:9216
v_mfma_f32_16x16x32_bf16 a[96:99], a[184:187], a[192:195], a[96:99]
v_mfma_f32_16x16x32_bf16 a[100:103], a[184:187], a[196:199], a[100:103]
v_mfma_f32_16x16x32_bf16 a[104:107], a[184:187], a[200:203], a[104:107]
v_mfma_f32_16x16x32_bf16 a[108:111], a[184:187], a[204:207], a[108:111]
v_mfma_f32_16x16x32_bf16 a[112:115], a[184:187], a[208:211], a[112:115]
s_add_u32 s48, s48, s34
v_mfma_f32_16x16x32_bf16 a[116:119], a[184:187], a[212:215], a[116:119]
s_add_u32 m0, s32, 28672
v_mfma_f32_16x16x32_bf16 a[120:123], a[184:187], a[216:219], a[120:123]
buffer_load_dwordx4 v1, s[12:15], s48 offen lds
v_mfma_f32_16x16x32_bf16 a[124:127], a[184:187], a[220:223], a[124:127]
s_add_u32 s30, s30, 128
ds_read_b128 a[184:187], v4 offset:12288
v_mfma_f32_16x16x32_bf16 a[128:131], a[188:191], a[192:195], a[128:131]
s_add_u32 s32, s32, 32768
s_add_u32 s29, s29, s93
v_add_u32 v3, 32768, v3
v_mfma_f32_16x16x32_bf16 a[132:135], a[188:191], a[196:199], a[132:135]
s_sub_u32 s48, s32, 98304
v_subrev_u32 v19, 98304, v3
v_mfma_f32_16x16x32_bf16 a[136:139], a[188:191], a[200:203], a[136:139]
s_cmp_ge_u32 s32, 163840
s_cselect_b32 s32, s48, s32
buffer_store_dwordx4 v[136:139], v13, s[8:11], s29 offen sc1
buffer_load_dword v15, v14, s[96:99], s100 offen
v_mfma_f32_16x16x32_bf16 a[140:143], a[188:191], a[204:207], a[140:143]
s_add_u32 s100, s100, 16384
v_cmp_le_u32 vcc, 163840, v3
v_mfma_f32_16x16x32_bf16 a[144:147], a[188:191], a[208:211], a[144:147]
s_nop 0
v_cndmask_b32 v3, v3, v19, vcc
v_mfma_f32_16x16x32_bf16 a[148:151], a[188:191], a[212:215], a[148:151]
v_xor_b32 v4, 64, v3
v_mfma_f32_16x16x32_bf16 a[152:155], a[188:191], a[216:219], a[152:155]
v_mfma_f32_16x16x32_bf16 a[156:159], a[188:191], a[220:223], a[156:159]
s_waitcnt vmcnt(20) lgkmcnt(0)
s_barrier
v_mfma_f32_16x16x32_bf16 v[160:163], a[160:163], a[224:227], v[160:163]
ds_read_b64_tr_b16 a[192:193], v5 offset:0
v_mfma_f32_16x16x32_bf16 v[164:167], a[160:163], a[228:231], v[164:167]
s_cmp_eq_u32 s2, 0
s_cselect_b64 s[4:5], s[52:53], s[54:55]
v_mfma_f32_16x16x32_bf16 v[168:171], a[160:163], a[232:235], v[168:171]
ds_read_b64_tr_b16 a[194:195], v5 offset:1024
s_mov_b32 s12, s4
v_mfma_f32_16x16x32_bf16 v[172:175], a[160:163], a[236:239], v[172:175]
s_add_u32 s37, s31, 0
s_and_b32 s13, s5, 0xffff
s_lshl_b32 s14, s47, 11
v_mfma_f32_16x16x32_bf16 v[176:179], a[160:163], a[240:243], v[176:179]
s_add_u32 m0, s33, 0
ds_read_b64_tr_b16 a[196:197], v6 offset:0
s_mov_b32 s15, 0x20000
v_mfma_f32_16x16x32_bf16 v[180:183], a[160:163], a[244:247], v[180:183]
buffer_load_dwordx4 v2, s[20:23], s37 offen  lds
s_mov_b32 s30, s101
v_mfma_f32_16x16x32_bf16 v[184:187], a[160:163], a[248:251], v[184:187]
ds_read_b64_tr_b16 a[198:199], v6 offset:1024
v_lshrrev_b32 v16, 3, v0
v_mfma_f32_16x16x32_bf16 v[188:191], a[160:163], a[252:255], v[188:191]
ds_read_b128 a[160:163], v3 offset:0
v_mul_lo_u32 v16, v16, s47
v_mfma_f32_16x16x32_bf16 v[192:195], a[164:167], a[224:227], v[192:195]
ds_read_b64_tr_b16 a[200:201], v7 offset:0
v_and_b32 v1, 0x70, v1
v_mfma_f32_16x16x32_bf16 v[196:199], a[164:167], a[228:231], v[196:199]
v_add_u32 v1, v1, v16
s_lshl_b32 s34, s47, 5
v_mfma_f32_16x16x32_bf16 v[200:203], a[164:167], a[232:235], v[200:203]
s_add_u32 s37, s31, 32768
ds_read_b64_tr_b16 a[202:203], v7 offset:1024
v_mfma_f32_16x16x32_bf16 v[204:207], a[164:167], a[236:239], v[204:207]
s_add_u32 m0, s33, 1024
v_mfma_f32_16x16x32_bf16 v[208:211], a[164:167], a[240:243], v[208:211]
buffer_load_dwordx4 v2, s[20:23], s37 offen  lds
v_mfma_f32_16x16x32_bf16 v[212:215], a[164:167], a[244:247], v[212:215]
ds_read_b64_tr_b16 a[204:205], v8 offset:0
v_mfma_f32_16x16x32_bf16 v[216:219], a[164:167], a[248:251], v[216:219]
s_add_u32 s29, s29, s44
v_mfma_f32_16x16x32_bf16 v[220:223], a[164:167], a[252:255], v[220:223]
ds_read_b128 a[164:167], v4 offset:1024
v_mfma_f32_16x16x32_bf16 v[224:227], a[168:171], a[224:227], v[224:227]
buffer_store_dwordx4 v[140:143], v13, s[8:11], s29 offen sc1
v_mfma_f32_16x16x32_bf16 v[228:231], a[168:171], a[228:231], v[228:231]
s_add_u32 s37, s31, 131072
ds_read_b64_tr_b16 a[206:207], v8 offset:1024
v_mfma_f32_16x16x32_bf16 v[232:235], a[168:171], a[232:235], v[232:235]
s_add_u32 m0, s33, 4096
v_mfma_f32_16x16x32_bf16 v[236:239], a[168:171], a[236:239], v[236:239]
buffer_load_dwordx4 v2, s[20:23], s37 offen  lds
v_mfma_f32_16x16x32_bf16 v[240:243], a[168:171], a[240:243], v[240:243]
ds_read_b64_tr_b16 a[208:209], v9 offset:0
v_mfma_f32_16x16x32_bf16 v[244:247], a[168:171], a[244:247], v[244:247]
v_mfma_f32_16x16x32_bf16 v[248:251], a[168:171], a[248:251], v[248:251]
ds_read_b64_tr_b16 a[210:211], v9 offset:1024
v_mfma_f32_16x16x32_bf16 v[252:255], a[168:171], a[252:255], v[252:255]
ds_read_b128 a[168:171], v3 offset:4096
v_mfma_f32_16x16x32_bf16 a[0:3], a[172:175], a[224:227], a[0:3]
s_add_u32 s37, s31, 163840
ds_read_b64_tr_b16 a[212:213], v10 offset:0
v_mfma_f32_16x16x32_bf16 a[4:7], a[172:175], a[228:231], a[4:7]
s_add_u32 m0, s33, 5120
v_mfma_f32_16x16x32_bf16 a[8:11], a[172:175], a[232:235], a[8:11]
buffer_load_dwordx4 v2, s[20:23], s37 offen  lds
v_mfma_f32_16x16x32_bf16 a[12:15], a[172:175], a[236:239], a[12:15]
s_add_u32 s31, s31, 262144
ds_read_b64_tr_b16 a[214:215], v10 offset:1024
v_mfma_f32_16x16x32_bf16 a[16:19], a[172:175], a[240:243], a[16:19]
s_add_u32 s33, s33, 16384
v_mfma_f32_16x16x32_bf16 a[20:23], a[172:175], a[244:247], a[20:23]
s_and_b32 s33, s33, 65535
ds_read_b64_tr_b16 a[216:217], v11 offset:0
v_mfma_f32_16x16x32_bf16 a[24:27], a[172:175], a[248:251], a[24:27]
v_mfma_f32_16x16x32_bf16 a[28:31], a[172:175], a[252:255], a[28:31]
s_mov_b32 s48, s30
ds_read_b128 a[172:175], v4 offset:5120
v_mfma_f32_16x16x32_bf16 a[32:35], a[176:179], a[224:227], a[32:35]
s_add_u32 m0, s32, 0
ds_read_b64_tr_b16 a[218:219], v11 offset:1024
v_mfma_f32_16x16x32_bf16 a[36:39], a[176:179], a[228:231], a[36:39]
buffer_load_dwordx4 v1, s[12:15], s48 offen lds
v_mfma_f32_16x16x32_bf16 a[40:43], a[176:179], a[232:235], a[40:43]
ds_read_b64_tr_b16 a[220:221], v12 offset:0
v_mfma_f32_16x16x32_bf16 a[44:47], a[176:179], a[236:239], a[44:47]
s_add_u32 s29, s29, s93
v_mfma_f32_16x16x32_bf16 a[48:51], a[176:179], a[240:243], a[48:51]
ds_read_b64_tr_b16 a[222:223], v12 offset:1024
v_mfma_f32_16x16x32_bf16 a[52:55], a[176:179], a[244:247], a[52:55]
buffer_store_dwordx4 v[144:147], v13, s[8:11], s29 offen sc1
v_mfma_f32_16x16x32_bf16 a[56:59], a[176:179], a[248:251], a[56:59]
s_add_u32 s48, s48, s34
ds_read_b128 a[188:191], v4 offset:13312
v_mfma_f32_16x16x32_bf16 a[60:63], a[176:179], a[252:255], a[60:63]
s_add_u32 m0, s32, 4096
ds_read_b128 a[176:179], v3 offset:8192
v_mfma_f32_16x16x32_bf16 a[64:67], a[180:183], a[224:227], a[64:67]
buffer_load_dwordx4 v1, s[12:15], s48 offen lds
v_mfma_f32_16x16x32_bf16 a[68:71], a[180:183], a[228:231], a[68:71]
v_add_u32 v5, 16384, v5
v_and_b32 v5, 65535, v5
v_mfma_f32_16x16x32_bf16 a[72:75], a[180:183], a[232:235], a[72:75]
v_xor_b32 v6, 16, v5
v_xor_b32 v7, 64, v5
v_mfma_f32_16x16x32_bf16 a[76:79], a[180:183], a[236:239], a[76:79]
v_xor_b32 v8, 80, v5
v_xor_b32 v9, 128, v5
v_mfma_f32_16x16x32_bf16 a[80:83], a[180:183], a[240:243], a[80:83]
s_cmp_eq_u32 s2, 0
s_cselect_b64 s[4:5], s[6:7], s[18:19]
v_mfma_f32_16x16x32_bf16 a[84:87], a[180:183], a[244:247], a[84:87]
s_add_u32 s48, s48, s34
s_mov_b32 s20, s4
s_and_b32 s21, s5, 0xffff
v_mfma_f32_16x16x32_bf16 a[88:91], a[180:183], a[248:251], a[88:91]
s_add_u32 m0, s32, 8192
s_lshl_b32 s22, s47, 12
s_mov_b32 s23, 0x20000
v_mfma_f32_16x16x32_bf16 a[92:95], a[180:183], a[252:255], a[92:95]
buffer_load_dwordx4 v1, s[12:15], s48 offen lds
ds_read_b128 a[180:183], v4 offset:9216
v_mfma_f32_16x16x32_bf16 a[96:99], a[184:187], a[224:227], a[96:99]
s_mov_b32 s31, s46
v_xor_b32 v10, 144, v5
v_xor_b32 v11, 192, v5
v_mfma_f32_16x16x32_bf16 a[100:103], a[184:187], a[228:231], a[100:103]
v_xor_b32 v12, 208, v5
v_mfma_f32_16x16x32_bf16 a[104:107], a[184:187], a[232:235], a[104:107]
v_mfma_f32_16x16x32_bf16 a[108:111], a[184:187], a[236:239], a[108:111]
v_mfma_f32_16x16x32_bf16 a[112:115], a[184:187], a[240:243], a[112:115]
s_add_u32 s48, s48, s34
v_mfma_f32_16x16x32_bf16 a[116:119], a[184:187], a[244:247], a[116:119]
s_add_u32 m0, s32, 12288
v_mfma_f32_16x16x32_bf16 a[120:123], a[184:187], a[248:251], a[120:123]
buffer_load_dwordx4 v1, s[12:15], s48 offen lds
v_mfma_f32_16x16x32_bf16 a[124:127], a[184:187], a[252:255], a[124:127]
ds_read_b128 a[184:187], v3 offset:12288
v_mfma_f32_16x16x32_bf16 a[128:131], v[28:31], a[224:227], a[128:131]
s_add_u32 s29, s29, s44
v_mfma_f32_16x16x32_bf16 a[132:135], v[28:31], a[228:231], a[132:135]
v_mfma_f32_16x16x32_bf16 a[136:139], v[28:31], a[232:235], a[136:139]
buffer_store_dwordx4 v[148:151], v13, s[8:11], s29 offen sc1
buffer_load_dword v15, v14, s[96:99], s100 offen
v_mfma_f32_16x16x32_bf16 a[140:143], v[28:31], a[236:239], a[140:143]
s_add_u32 s100, s100, 16384
v_mfma_f32_16x16x32_bf16 a[144:147], v[28:31], a[240:243], a[144:147]
v_mfma_f32_16x16x32_bf16 a[148:151], v[28:31], a[244:247], a[148:151]
v_mfma_f32_16x16x32_bf16 a[152:155], v[28:31], a[248:251], a[152:155]
v_mfma_f32_16x16x32_bf16 a[156:159], v[28:31], a[252:255], a[156:159]
s_waitcnt vmcnt(24) lgkmcnt(0)
s_barrier
v_mfma_f32_16x16x32_bf16 v[160:163], a[160:163], a[192:195], v[160:163]
ds_read_b64_tr_b16 a[224:225], v5 offset:0
v_mfma_f32_16x16x32_bf16 v[164:167], a[160:163], a[196:199], v[164:167]
v_mfma_f32_16x16x32_bf16 v[168:171], a[160:163], a[200:203], v[168:171]
ds_read_b64_tr_b16 a[226:227], v5 offset:1024
v_mfma_f32_16x16x32_bf16 v[172:175], a[160:163], a[204:207], v[172:175]
s_add_u32 s37, s31, 0
v_mfma_f32_16x16x32_bf16 v[176:179], a[160:163], a[208:211], v[176:179]
s_add_u32 m0, s33, 0
ds_read_b64_tr_b16 a[228:229], v6 offset:0
v_mfma_f32_16x16x32_bf16 v[180:183], a[160:163], a[212:215], v[180:183]
buffer_load_dwordx4 v2, s[20:23], s37 offen  lds
v_mfma_f32_16x16x32_bf16 v[184:187], a[160:163], a[216:219], v[184:187]
ds_read_b64_tr_b16 a[230:231], v6 offset:1024
v_mfma_f32_16x16x32_bf16 v[188:191], a[160:163], a[220:223], v[188:191]
ds_read_b128 a[160:163], v4 offset:0
v_mfma_f32_16x16x32_bf16 v[192:195], a[164:167], a[192:195], v[192:195]
ds_read_b64_tr_b16 a[232:233], v7 offset:0
v_mfma_f32_16x16x32_bf16 v[196:199], a[164:167], a[196:199], v[196:199]
v_mfma_f32_16x16x32_bf16 v[200:203], a[164:167], a[200:203], v[200:203]
s_add_u32 s37, s31, 32768
ds_read_b64_tr_b16 a[234:235], v7 offset:1024
v_mfma_f32_16x16x32_bf16 v[204:207], a[164:167], a[204:207], v[204:207]
s_add_u32 m0, s33, 1024
v_mfma_f32_16x16x32_bf16 v[208:211], a[164:167], a[208:211], v[208:211]
buffer_load_dwordx4 v2, s[20:23], s37 offen  lds
v_mfma_f32_16x16x32_bf16 v[212:215], a[164:167], a[212:215], v[212:215]
ds_read_b64_tr_b16 a[236:237], v8 offset:0
v_mfma_f32_16x16x32_bf16 v[216:219], a[164:167], a[216:219], v[216:219]
s_add_u32 s29, s29, s93
v_mfma_f32_16x16x32_bf16 v[220:223], a[164:167], a[220:223], v[220:223]
ds_read_b128 a[164:167], v3 offset:1024
v_mfma_f32_16x16x32_bf16 v[224:227], a[168:171], a[192:195], v[224:227]
buffer_store_dwordx4 v[152:155], v13, s[8:11], s29 offen sc1
v_mfma_f32_16x16x32_bf16 v[228:231], a[168:171], a[196:199], v[228:231]
s_add_u32 s37, s31, 131072
ds_read_b64_tr_b16 a[238:239], v8 offset:1024
v_mfma_f32_16x16x32_bf16 v[232:235], a[168:171], a[200:203], v[232:235]
s_add_u32 m0, s33, 4096
v_mfma_f32_16x16x32_bf16 v[236:239], a[168:171], a[204:207], v[236:239]
buffer_load_dwordx4 v2, s[20:23], s37 offen  lds
v_mfma_f32_16x16x32_bf16 v[240:243], a[168:171], a[208:211], v[240:243]
ds_read_b64_tr_b16 a[240:241], v9 offset:0
v_mfma_f32_16x16x32_bf16 v[244:247], a[168:171], a[212:215], v[244:247]
v_mfma_f32_16x16x32_bf16 v[248:251], a[168:171], a[216:219], v[248:251]
ds_read_b64_tr_b16 a[242:243], v9 offset:1024
v_mfma_f32_16x16x32_bf16 v[252:255], a[168:171], a[220:223], v[252:255]
ds_read_b128 a[168:171], v4 offset:4096
v_mfma_f32_16x16x32_bf16 a[0:3], a[172:175], a[192:195], a[0:3]
s_add_u32 s37, s31, 163840
ds_read_b64_tr_b16 a[244:245], v10 offset:0
v_mfma_f32_16x16x32_bf16 a[4:7], a[172:175], a[196:199], a[4:7]
s_add_u32 m0, s33, 5120
v_mfma_f32_16x16x32_bf16 a[8:11], a[172:175], a[200:203], a[8:11]
buffer_load_dwordx4 v2, s[20:23], s37 offen  lds
v_mfma_f32_16x16x32_bf16 a[12:15], a[172:175], a[204:207], a[12:15]
s_add_u32 s31, s31, 262144
ds_read_b64_tr_b16 a[246:247], v10 offset:1024
v_mfma_f32_16x16x32_bf16 a[16:19], a[172:175], a[208:211], a[16:19]
s_add_u32 s33, s33, 16384
v_mfma_f32_16x16x32_bf16 a[20:23], a[172:175], a[212:215], a[20:23]
s_and_b32 s33, s33, 65535
ds_read_b64_tr_b16 a[248:249], v11 offset:0
v_mfma_f32_16x16x32_bf16 a[24:27], a[172:175], a[216:219], a[24:27]
v_mfma_f32_16x16x32_bf16 a[28:31], a[172:175], a[220:223], a[28:31]
s_add_u32 s48, s48, s34
ds_read_b128 a[172:175], v3 offset:5120
v_mfma_f32_16x16x32_bf16 a[32:35], a[176:179], a[192:195], a[32:35]
s_add_u32 m0, s32, 16384
ds_read_b64_tr_b16 a[250:251], v11 offset:1024
v_mfma_f32_16x16x32_bf16 a[36:39], a[176:179], a[196:199], a[36:39]
buffer_load_dwordx4 v1, s[12:15], s48 offen lds
v_mfma_f32_16x16x32_bf16 a[40:43], a[176:179], a[200:203], a[40:43]
ds_read_b64_tr_b16 a[252:253], v12 offset:0
v_mfma_f32_16x16x32_bf16 a[44:47], a[176:179], a[204:207], a[44:47]
s_add_u32 s29, s29, s44
v_mfma_f32_16x16x32_bf16 a[48:51], a[176:179], a[208:211], a[48:51]
ds_read_b64_tr_b16 a[254:255], v12 offset:1024
v_mfma_f32_16x16x32_bf16 a[52:55], a[176:179], a[212:215], a[52:55]
buffer_store_dwordx4 v[156:159], v13, s[8:11], s29 offen sc1
v_mfma_f32_16x16x32_bf16 a[56:59], a[176:179], a[216:219], a[56:59]
s_add_u32 s48, s48, s34
ds_read_b128 v[28:31], v3 offset:13312
v_mfma_f32_16x16x32_bf16 a[60:63], a[176:179], a[220:223], a[60:63]
s_add_u32 m0, s32, 20480
ds_read_b128 a[176:179], v4 offset:8192
v_mfma_f32_16x16x32_bf16 a[64:67], a[180:183], a[192:195], a[64:67]
buffer_load_dwordx4 v1, s[12:15], s48 offen lds
v_mfma_f32_16x16x32_bf16 a[68:71], a[180:183], a[196:199], a[68:71]
v_add_u32 v5, 16384, v5
v_and_b32 v5, 65535, v5
v_mfma_f32_16x16x32_bf16 a[72:75], a[180:183], a[200:203], a[72:75]
v_xor_b32 v6, 16, v5
v_xor_b32 v7, 64, v5
v_mfma_f32_16x16x32_bf16 a[76:79], a[180:183], a[204:207], a[76:79]
v_xor_b32 v8, 80, v5
v_xor_b32 v9, 128, v5
v_mfma_f32_16x16x32_bf16 a[80:83], a[180:183], a[208:211], a[80:83]
v_xor_b32 v10, 144, v5
v_xor_b32 v11, 192, v5
v_mfma_f32_16x16x32_bf16 a[84:87], a[180:183], a[212:215], a[84:87]
s_add_u32 s48, s48, s34
v_xor_b32 v12, 208, v5
v_mfma_f32_16x16x32_bf16 a[88:91], a[180:183], a[216:219], a[88:91]
s_add_u32 m0, s32, 24576
v_mfma_f32_16x16x32_bf16 a[92:95], a[180:183], a[220:223], a[92:95]
buffer_load_dwordx4 v1, s[12:15], s48 offen lds
ds_read_b128 a[180:183], v3 offset:9216
v_mfma_f32_16x16x32_bf16 a[96:99], a[184:187], a[192:195], a[96:99]
v_mfma_f32_16x16x32_bf16 a[100:103], a[184:187], a[196:199], a[100:103]
v_mfma_f32_16x16x32_bf16 a[104:107], a[184:187], a[200:203], a[104:107]
v_mfma_f32_16x16x32_bf16 a[108:111], a[184:187], a[204:207], a[108:111]
v_mfma_f32_16x16x32_bf16 a[112:115], a[184:187], a[208:211], a[112:115]
s_add_u32 s48, s48, s34
v_mfma_f32_16x16x32_bf16 a[116:119], a[184:187], a[212:215], a[116:119]
s_add_u32 m0, s32, 28672
v_mfma_f32_16x16x32_bf16 a[120:123], a[184:187], a[216:219], a[120:123]
buffer_load_dwordx4 v1, s[12:15], s48 offen lds
v_mfma_f32_16x16x32_bf16 a[124:127], a[184:187], a[220:223], a[124:127]
s_add_u32 s30, s30, 128
ds_read_b128 a[184:187], v4 offset:12288
v_mfma_f32_16x16x32_bf16 a[128:131], a[188:191], a[192:195], a[128:131]
s_add_u32 s32, s32, 32768
v_add_u32 v3, 32768, v3
v_mfma_f32_16x16x32_bf16 a[132:135], a[188:191], a[196:199], a[132:135]
s_sub_u32 s48, s32, 98304
v_subrev_u32 v19, 98304, v3
v_mfma_f32_16x16x32_bf16 a[136:139], a[188:191], a[200:203], a[136:139]
s_cmp_ge_u32 s32, 163840
s_cselect_b32 s32, s48, s32
buffer_load_dword v15, v14, s[96:99], s100 offen
v_mfma_f32_16x16x32_bf16 a[140:143], a[188:191], a[204:207], a[140:143]
s_add_u32 s100, s100, 16384
v_cmp_le_u32 vcc, 163840, v3
v_mfma_f32_16x16x32_bf16 a[144:147], a[188:191], a[208:211], a[144:147]
s_nop 0
v_cndmask_b32 v3, v3, v19, vcc
v_mfma_f32_16x16x32_bf16 a[148:151], a[188:191], a[212:215], a[148:151]
v_xor_b32 v4, 64, v3
v_mfma_f32_16x16x32_bf16 a[152:155], a[188:191], a[216:219], a[152:155]
v_mfma_f32_16x16x32_bf16 a[156:159], a[188:191], a[220:223], a[156:159]
s_waitcnt vmcnt(23) lgkmcnt(0)
s_barrier
v_mfma_f32_16x16x32_bf16 v[160:163], a[160:163], a[224:227], v[160:163]
ds_read_b64_tr_b16 a[192:193], v5 offset:0
v_mfma_f32_16x16x32_bf16 v[164:167], a[160:163], a[228:231], v[164:167]
v_mfma_f32_16x16x32_bf16 v[168:171], a[160:163], a[232:235], v[168:171]
ds_read_b64_tr_b16 a[194:195], v5 offset:1024
v_mfma_f32_16x16x32_bf16 v[172:175], a[160:163], a[236:239], v[172:175]
s_add_u32 s37, s31, 0
v_mfma_f32_16x16x32_bf16 v[176:179], a[160:163], a[240:243], v[176:179]
s_add_u32 m0, s33, 0
ds_read_b64_tr_b16 a[196:197], v6 offset:0
v_mfma_f32_16x16x32_bf16 v[180:183], a[160:163], a[244:247], v[180:183]
buffer_load_dwordx4 v2, s[20:23], s37 offen  lds
v_mfma_f32_16x16x32_bf16 v[184:187], a[160:163], a[248:251], v[184:187]
ds_read_b64_tr_b16 a[198:199], v6 offset:1024
v_mfma_f32_16x16x32_bf16 v[188:191], a[160:163], a[252:255], v[188:191]
ds_read_b128 a[160:163], v3 offset:0
v_mfma_f32_16x16x32_bf16 v[192:195], a[164:167], a[224:227], v[192:195]
ds_read_b64_tr_b16 a[200:201], v7 offset:0
v_mfma_f32_16x16x32_bf16 v[196:199], a[164:167], a[228:231], v[196:199]
v_mfma_f32_16x16x32_bf16 v[200:203], a[164:167], a[232:235], v[200:203]
s_add_u32 s37, s31, 32768
ds_read_b64_tr_b16 a[202:203], v7 offset:1024
v_mfma_f32_16x16x32_bf16 v[204:207], a[164:167], a[236:239], v[204:207]
s_add_u32 m0, s33, 1024
v_mfma_f32_16x16x32_bf16 v[208:211], a[164:167], a[240:243], v[208:211]
buffer_load_dwordx4 v2, s[20:23], s37 offen  lds
v_mfma_f32_16x16x32_bf16 v[212:215], a[164:167], a[244:247], v[212:215]
ds_read_b64_tr_b16 a[204:205], v8 offset:0
v_mfma_f32_16x16x32_bf16 v[216:219], a[164:167], a[248:251], v[216:219]
v_mfma_f32_16x16x32_bf16 v[220:223], a[164:167], a[252:255], v[220:223]
ds_read_b128 a[164:167], v4 offset:1024
v_mfma_f32_16x16x32_bf16 v[224:227], a[168:171], a[224:227], v[224:227]
ds_read_b64_tr_b16 a[206:207], v8 offset:1024
v_mfma_f32_16x16x32_bf16 v[228:231], a[168:171], a[228:231], v[228:231]
s_add_u32 s37, s31, 131072
v_mfma_f32_16x16x32_bf16 v[232:235], a[168:171], a[232:235], v[232:235]
s_add_u32 m0, s33, 4096
ds_read_b64_tr_b16 a[208:209], v9 offset:0
v_mfma_f32_16x16x32_bf16 v[236:239], a[168:171], a[236:239], v[236:239]
buffer_load_dwordx4 v2, s[20:23], s37 offen  lds
v_mfma_f32_16x16x32_bf16 v[240:243], a[168:171], a[240:243], v[240:243]
ds_read_b64_tr_b16 a[210:211], v9 offset:1024
v_mfma_f32_16x16x32_bf16 v[244:247], a[168:171], a[244:247], v[244:247]
v_mfma_f32_16x16x32_bf16 v[248:251], a[168:171], a[248:251], v[248:251]
ds_read_b64_tr_b16 a[212:213], v10 offset:0
v_mfma_f32_16x16x32_bf16 v[252:255], a[168:171], a[252:255], v[252:255]
ds_read_b128 a[168:171], v3 offset:4096
v_mfma_f32_16x16x32_bf16 a[0:3], a[172:175], a[224:227], a[0:3]
s_add_u32 s37, s31, 163840
ds_read_b64_tr_b16 a[214:215], v10 offset:1024
v_mfma_f32_16x16x32_bf16 a[4:7], a[172:175], a[228:231], a[4:7]
s_add_u32 m0, s33, 5120
v_mfma_f32_16x16x32_bf16 a[8:11], a[172:175], a[232:235], a[8:11]
buffer_load_dwordx4 v2, s[20:23], s37 offen  lds
v_mfma_f32_16x16x32_bf16 a[12:15], a[172:175], a[236:239], a[12:15]
s_add_u32 s31, s31, 262144
ds_read_b64_tr_b16 a[216:217], v11 offset:0
v_mfma_f32_16x16x32_bf16 a[16:19], a[172:175], a[240:243], a[16:19]
s_add_u32 s33, s33, 16384
v_mfma_f32_16x16x32_bf16 a[20:23], a[172:175], a[244:247], a[20:23]
s_and_b32 s33, s33, 65535
ds_read_b64_tr_b16 a[218:219], v11 offset:1024
v_mfma_f32_16x16x32_bf16 a[24:27], a[172:175], a[248:251], a[24:27]
v_mfma_f32_16x16x32_bf16 a[28:31], a[172:175], a[252:255], a[28:31]
s_mov_b32 s48, s30
ds_read_b128 a[172:175], v4 offset:5120
v_mfma_f32_16x16x32_bf16 a[32:35], a[176:179], a[224:227], a[32:35]
s_add_u32 m0, s32, 0
ds_read_b64_tr_b16 a[220:221], v12 offset:0
v_mfma_f32_16x16x32_bf16 a[36:39], a[176:179], a[228:231], a[36:39]
buffer_load_dwordx4 v1, s[12:15], s48 offen lds
v_mfma_f32_16x16x32_bf16 a[40:43], a[176:179], a[232:235], a[40:43]
ds_read_b64_tr_b16 a[222:223], v12 offset:1024
v_mfma_f32_16x16x32_bf16 a[44:47], a[176:179], a[236:239], a[44:47]
v_mfma_f32_16x16x32_bf16 a[48:51], a[176:179], a[240:243], a[48:51]
ds_read_b128 a[188:191], v4 offset:13312
v_mfma_f32_16x16x32_bf16 a[52:55], a[176:179], a[244:247], a[52:55]
v_mfma_f32_16x16x32_bf16 a[56:59], a[176:179], a[248:251], a[56:59]
s_add_u32 s48, s48, s34
v_mfma_f32_16x16x32_bf16 a[60:63], a[176:179], a[252:255], a[60:63]
s_add_u32 m0, s32, 4096
ds_read_b128 a[176:179], v3 offset:8192
v_add_u32 v5, 16384, v5
v_mfma_f32_16x16x32_bf16 a[64:67], a[180:183], a[224:227], a[64:67]
buffer_load_dwordx4 v1, s[12:15], s48 offen lds
v_and_b32 v5, 65535, v5
v_mfma_f32_16x16x32_bf16 a[68:71], a[180:183], a[228:231], a[68:71]
v_xor_b32 v6, 16, v5
v_xor_b32 v7, 64, v5
v_mfma_f32_16x16x32_bf16 a[72:75], a[180:183], a[232:235], a[72:75]
v_xor_b32 v8, 80, v5
v_xor_b32 v9, 128, v5
v_mfma_f32_16x16x32_bf16 a[76:79], a[180:183], a[236:239], a[76:79]
v_xor_b32 v10, 144, v5
v_xor_b32 v11, 192, v5
v_mfma_f32_16x16x32_bf16 a[80:83], a[180:183], a[240:243], a[80:83]
v_xor_b32 v12, 208, v5
v_mfma_f32_16x16x32_bf16 a[84:87], a[180:183], a[244:247], a[84:87]
s_add_u32 s48, s48, s34
v_mfma_f32_16x16x32_bf16 a[88:91], a[180:183], a[248:251], a[88:91]
s_add_u32 m0, s32, 8192
v_mfma_f32_16x16x32_bf16 a[92:95], a[180:183], a[252:255], a[92:95]
buffer_load_dwordx4 v1, s[12:15], s48 offen lds
ds_read_b128 a[180:183], v4 offset:9216
v_mfma_f32_16x16x32_bf16 a[96:99], a[184:187], a[224:227], a[96:99]
v_mfma_f32_16x16x32_bf16 a[100:103], a[184:187], a[228:231], a[100:103]
v_mfma_f32_16x16x32_bf16 a[104:107], a[184:187], a[232:235], a[104:107]
v_mfma_f32_16x16x32_bf16 a[108:111], a[184:187], a[236:239], a[108:111]
v_mfma_f32_16x16x32_bf16 a[112:115], a[184:187], a[240:243], a[112:115]
s_add_u32 s48, s48, s34
v_mfma_f32_16x16x32_bf16 a[116:119], a[184:187], a[244:247], a[116:119]
s_add_u32 m0, s32, 12288
v_mfma_f32_16x16x32_bf16 a[120:123], a[184:187], a[248:251], a[120:123]
buffer_load_dwordx4 v1, s[12:15], s48 offen lds
v_mfma_f32_16x16x32_bf16 a[124:127], a[184:187], a[252:255], a[124:127]
ds_read_b128 a[184:187], v3 offset:12288
v_mfma_f32_16x16x32_bf16 a[128:131], v[28:31], a[224:227], a[128:131]
v_mfma_f32_16x16x32_bf16 a[132:135], v[28:31], a[228:231], a[132:135]
v_mfma_f32_16x16x32_bf16 a[136:139], v[28:31], a[232:235], a[136:139]
buffer_load_dword v15, v14, s[96:99], s100 offen
v_mfma_f32_16x16x32_bf16 a[140:143], v[28:31], a[236:239], a[140:143]
s_add_u32 s100, s100, 16384
v_mfma_f32_16x16x32_bf16 a[144:147], v[28:31], a[240:243], a[144:147]
v_mfma_f32_16x16x32_bf16 a[148:151], v[28:31], a[244:247], a[148:151]
v_mfma_f32_16x16x32_bf16 a[152:155], v[28:31], a[248:251], a[152:155]
v_mfma_f32_16x16x32_bf16 a[156:159], v[28:31], a[252:255], a[156:159]
s_waitcnt vmcnt(20) lgkmcnt(0)
s_barrier
v_mfma_f32_16x16x32_bf16 v[160:163], a[160:163], a[192:195], v[160:163]
ds_read_b64_tr_b16 a[224:225], v5 offset:0
v_mfma_f32_16x16x32_bf16 v[164:167], a[160:163], a[196:199], v[164:167]
v_mfma_f32_16x16x32_bf16 v[168:171], a[160:163], a[200:203], v[168:171]
ds_read_b64_tr_b16 a[226:227], v5 offset:1024
v_mfma_f32_16x16x32_bf16 v[172:175], a[160:163], a[204:207], v[172:175]
s_add_u32 s37, s31, 0
v_mfma_f32_16x16x32_bf16 v[176:179], a[160:163], a[208:211], v[176:179]
s_add_u32 m0, s33, 0
ds_read_b64_tr_b16 a[228:229], v6 offset:0
v_mfma_f32_16x16x32_bf16 v[180:183], a[160:163], a[212:215], v[180:183]
buffer_load_dwordx4 v2, s[20:23], s37 offen  lds
v_mfma_f32_16x16x32_bf16 v[184:187], a[160:163], a[216:219], v[184:187]
ds_read_b64_tr_b16 a[230:231], v6 offset:1024
v_mfma_f32_16x16x32_bf16 v[188:191], a[160:163], a[220:223], v[188:191]
ds_read_b128 a[160:163], v4 offset:0
v_mfma_f32_16x16x32_bf16 v[192:195], a[164:167], a[192:195], v[192:195]
ds_read_b64_tr_b16 a[232:233], v7 offset:0
v_mfma_f32_16x16x32_bf16 v[196:199], a[164:167], a[196:199], v[196:199]
v_mfma_f32_16x16x32_bf16 v[200:203], a[164:167], a[200:203], v[200:203]
s_add_u32 s37, s31, 32768
ds_read_b64_tr_b16 a[234:235], v7 offset:1024
v_mfma_f32_16x16x32_bf16 v[204:207], a[164:167], a[204:207], v[204:207]
s_add_u32 m0, s33, 1024
v_mfma_f32_16x16x32_bf16 v[208:211], a[164:167], a[208:211], v[208:211]
buffer_load_dwordx4 v2, s[20:23], s37 offen  lds
v_mfma_f32_16x16x32_bf16 v[212:215], a[164:167], a[212:215], v[212:215]
ds_read_b64_tr_b16 a[236:237], v8 offset:0
v_mfma_f32_16x16x32_bf16 v[216:219], a[164:167], a[216:219], v[216:219]
v_mfma_f32_16x16x32_bf16 v[220:223], a[164:167], a[220:223], v[220:223]
ds_read_b128 a[164:167], v3 offset:1024
v_mfma_f32_16x16x32_bf16 v[224:227], a[168:171], a[192:195], v[224:227]
ds_read_b64_tr_b16 a[238:239], v8 offset:1024
v_mfma_f32_16x16x32_bf16 v[228:231], a[168:171], a[196:199], v[228:231]
s_add_u32 s37, s31, 131072
v_mfma_f32_16x16x32_bf16 v[232:235], a[168:171], a[200:203], v[232:235]
s_add_u32 m0, s33, 4096
ds_read_b64_tr_b16 a[240:241], v9 offset:0
v_mfma_f32_16x16x32_bf16 v[236:239], a[168:171], a[204:207], v[236:239]
buffer_load_dwordx4 v2, s[20:23], s37 offen  lds
v_mfma_f32_16x16x32_bf16 v[240:243], a[168:171], a[208:211], v[240:243]
ds_read_b64_tr_b16 a[242:243], v9 offset:1024
v_mfma_f32_16x16x32_bf16 v[244:247], a[168:171], a[212:215], v[244:247]
v_mfma_f32_16x16x32_bf16 v[248:251], a[168:171], a[216:219], v[248:251]
ds_read_b64_tr_b16 a[244:245], v10 offset:0
v_mfma_f32_16x16x32_bf16 v[252:255], a[168:171], a[220:223], v[252:255]
ds_read_b128 a[168:171], v4 offset:4096
v_mfma_f32_16x16x32_bf16 a[0:3], a[172:175], a[192:195], a[0:3]
s_add_u32 s37, s31, 163840
ds_read_b64_tr_b16 a[246:247], v10 offset:1024
v_mfma_f32_16x16x32_bf16 a[4:7], a[172:175], a[196:199], a[4:7]
s_add_u32 m0, s33, 5120
v_mfma_f32_16x16x32_bf16 a[8:11], a[172:175], a[200:203], a[8:11]
buffer_load_dwordx4 v2, s[20:23], s37 offen  lds
v_mfma_f32_16x16x32_bf16 a[12:15], a[172:175], a[204:207], a[12:15]
s_add_u32 s31, s31, 262144
ds_read_b64_tr_b16 a[248:249], v11 offset:0
v_mfma_f32_16x16x32_bf16 a[16:19], a[172:175], a[208:211], a[16:19]
s_add_u32 s33, s33, 16384
v_mfma_f32_16x16x32_bf16 a[20:23], a[172:175], a[212:215], a[20:23]
s_and_b32 s33, s33, 65535
ds_read_b64_tr_b16 a[250:251], v11 offset:1024
v_mfma_f32_16x16x32_bf16 a[24:27], a[172:175], a[216:219], a[24:27]
v_mfma_f32_16x16x32_bf16 a[28:31], a[172:175], a[220:223], a[28:31]
s_add_u32 s48, s48, s34
ds_read_b128 a[172:175], v3 offset:5120
v_mfma_f32_16x16x32_bf16 a[32:35], a[176:179], a[192:195], a[32:35]
s_add_u32 m0, s32, 16384
ds_read_b64_tr_b16 a[252:253], v12 offset:0
v_mfma_f32_16x16x32_bf16 a[36:39], a[176:179], a[196:199], a[36:39]
buffer_load_dwordx4 v1, s[12:15], s48 offen lds
v_mfma_f32_16x16x32_bf16 a[40:43], a[176:179], a[200:203], a[40:43]
ds_read_b64_tr_b16 a[254:255], v12 offset:1024
v_mfma_f32_16x16x32_bf16 a[44:47], a[176:179], a[204:207], a[44:47]
v_mfma_f32_16x16x32_bf16 a[48:51], a[176:179], a[208:211], a[48:51]
ds_read_b128 v[28:31], v3 offset:13312
v_mfma_f32_16x16x32_bf16 a[52:55], a[176:179], a[212:215], a[52:55]
v_mfma_f32_16x16x32_bf16 a[56:59], a[176:179], a[216:219], a[56:59]
s_add_u32 s48, s48, s34
v_mfma_f32_16x16x32_bf16 a[60:63], a[176:179], a[220:223], a[60:63]
s_add_u32 m0, s32, 20480
ds_read_b128 a[176:179], v4 offset:8192
v_add_u32 v5, 16384, v5
v_mfma_f32_16x16x32_bf16 a[64:67], a[180:183], a[192:195], a[64:67]
buffer_load_dwordx4 v1, s[12:15], s48 offen lds
v_and_b32 v5, 65535, v5
v_mfma_f32_16x16x32_bf16 a[68:71], a[180:183], a[196:199], a[68:71]
v_xor_b32 v6, 16, v5
v_xor_b32 v7, 64, v5
v_mfma_f32_16x16x32_bf16 a[72:75], a[180:183], a[200:203], a[72:75]
v_xor_b32 v8, 80, v5
v_xor_b32 v9, 128, v5
v_mfma_f32_16x16x32_bf16 a[76:79], a[180:183], a[204:207], a[76:79]
v_xor_b32 v10, 144, v5
v_xor_b32 v11, 192, v5
v_mfma_f32_16x16x32_bf16 a[80:83], a[180:183], a[208:211], a[80:83]
v_xor_b32 v12, 208, v5
v_mfma_f32_16x16x32_bf16 a[84:87], a[180:183], a[212:215], a[84:87]
s_add_u32 s48, s48, s34
v_mfma_f32_16x16x32_bf16 a[88:91], a[180:183], a[216:219], a[88:91]
s_add_u32 m0, s32, 24576
v_mfma_f32_16x16x32_bf16 a[92:95], a[180:183], a[220:223], a[92:95]
buffer_load_dwordx4 v1, s[12:15], s48 offen lds
ds_read_b128 a[180:183], v3 offset:9216
v_mfma_f32_16x16x32_bf16 a[96:99], a[184:187], a[192:195], a[96:99]
v_mfma_f32_16x16x32_bf16 a[100:103], a[184:187], a[196:199], a[100:103]
v_mfma_f32_16x16x32_bf16 a[104:107], a[184:187], a[200:203], a[104:107]
v_mfma_f32_16x16x32_bf16 a[108:111], a[184:187], a[204:207], a[108:111]
v_mfma_f32_16x16x32_bf16 a[112:115], a[184:187], a[208:211], a[112:115]
s_add_u32 s48, s48, s34
v_mfma_f32_16x16x32_bf16 a[116:119], a[184:187], a[212:215], a[116:119]
s_add_u32 m0, s32, 28672
v_mfma_f32_16x16x32_bf16 a[120:123], a[184:187], a[216:219], a[120:123]
buffer_load_dwordx4 v1, s[12:15], s48 offen lds
v_mfma_f32_16x16x32_bf16 a[124:127], a[184:187], a[220:223], a[124:127]
s_add_u32 s30, s30, 128
ds_read_b128 a[184:187], v4 offset:12288
v_mfma_f32_16x16x32_bf16 a[128:131], a[188:191], a[192:195], a[128:131]
s_add_u32 s32, s32, 32768
v_add_u32 v3, 32768, v3
v_mfma_f32_16x16x32_bf16 a[132:135], a[188:191], a[196:199], a[132:135]
s_sub_u32 s48, s32, 98304
v_subrev_u32 v19, 98304, v3
v_mfma_f32_16x16x32_bf16 a[136:139], a[188:191], a[200:203], a[136:139]
s_cmp_ge_u32 s32, 163840
s_cselect_b32 s32, s48, s32
buffer_load_dword v15, v14, s[96:99], s100 offen
v_mfma_f32_16x16x32_bf16 a[140:143], a[188:191], a[204:207], a[140:143]
s_add_u32 s100, s100, 16384
v_cmp_le_u32 vcc, 163840, v3
v_mfma_f32_16x16x32_bf16 a[144:147], a[188:191], a[208:211], a[144:147]
s_nop 0
v_cndmask_b32 v3, v3, v19, vcc
v_mfma_f32_16x16x32_bf16 a[148:151], a[188:191], a[212:215], a[148:151]
v_xor_b32 v4, 64, v3
v_mfma_f32_16x16x32_bf16 a[152:155], a[188:191], a[216:219], a[152:155]
v_mfma_f32_16x16x32_bf16 a[156:159], a[188:191], a[220:223], a[156:159]
s_cmp_eq_u32 s41, 0
s_cbranch_scc0 L_g_v17v
s_waitcnt vmcnt(18) lgkmcnt(0)
s_barrier
v_mfma_f32_16x16x32_bf16 v[160:163], a[160:163], a[224:227], v[160:163]
ds_read_b128 a[192:195], v3 offset:0
v_mfma_f32_16x16x32_bf16 v[164:167], a[160:163], a[228:231], v[164:167]
v_mfma_f32_16x16x32_bf16 v[168:171], a[160:163], a[232:235], v[168:171]
ds_read_b128 a[196:199], v4 offset:1024
v_mfma_f32_16x16x32_bf16 v[172:175], a[160:163], a[236:239], v[172:175]
s_add_u32 s37, s31, 0
v_mfma_f32_16x16x32_bf16 v[176:179], a[160:163], a[240:243], v[176:179]
s_add_u32 m0, s33, 0
ds_read_b128 a[200:203], v3 offset:4096
v_cvt_pk_bf16_f32 v32, v160, v161
v_cvt_pk_bf16_f32 v33, v162, v163
v_mfma_f32_16x16x32_bf16 v[180:183], a[160:163], a[244:247], v[180:183]
buffer_load_dwordx4 v2, s[20:23], s37 offen  lds
v_cvt_pk_bf16_f32 v36, v164, v165
v_cvt_pk_bf16_f32 v37, v166, v167
v_mfma_f32_16x16x32_bf16 v[184:187], a[160:163], a[248:251], v[184:187]
ds_read_b128 a[204:207], v4 offset:5120
v_cvt_pk_bf16_f32 v40, v168, v169
v_cvt_pk_bf16_f32 v41, v170, v171
v_mfma_f32_16x16x32_bf16 v[188:191], a[160:163], a[252:255], v[188:191]
ds_read_b64_tr_b16 a[160:161], v5 offset:0
v_cvt_pk_bf16_f32 v44, v172, v173
v_cvt_pk_bf16_f32 v45, v174, v175
v_mfma_f32_16x16x32_bf16 v[192:195], a[164:167], a[224:227], v[192:195]
ds_read_b64_tr_b16 a[162:163], v5 offset:1024
v_cvt_pk_bf16_f32 v48, v176, v177
v_cvt_pk_bf16_f32 v49, v178, v179
v_mfma_f32_16x16x32_bf16 v[196:199], a[164:167], a[228:231], v[196:199]
ds_read_b128 a[208:211], v3 offset:8192
v_add_u32 v5, 16384, v5
v_cvt_pk_bf16_f32 v52, v180, v181
v_cvt_pk_bf16_f32 v53, v182, v183
v_mfma_f32_16x16x32_bf16 v[200:203], a[164:167], a[232:235], v[200:203]
s_add_u32 s37, s31, 32768
v_and_b32 v5, 65535, v5
v_cvt_pk_bf16_f32 v56, v184, v185
v_cvt_pk_bf16_f32 v57, v186, v187
v_mfma_f32_16x16x32_bf16 v[204:207], a[164:167], a[236:239], v[204:207]
s_add_u32 m0, s33, 1024
ds_read_b128 a[212:215], v4 offset:9216
v_cvt_pk_bf16_f32 v60, v188, v189
v_cvt_pk_bf16_f32 v61, v190, v191
v_mfma_f32_16x16x32_bf16 v[208:211], a[164:167], a[240:243], v[208:211]
buffer_load_dwordx4 v2, s[20:23], s37 offen  lds
v_cvt_pk_bf16_f32 v34, v192, v193
v_cvt_pk_bf16_f32 v35, v194, v195
v_mfma_f32_16x16x32_bf16 v[212:215], a[164:167], a[244:247], v[212:215]
ds_read_b128 a[216:219], v3 offset:12288
v_cvt_pk_bf16_f32 v38, v196, v197
v_cvt_pk_bf16_f32 v39, v198, v199
v_mfma_f32_16x16x32_bf16 v[216:219], a[164:167], a[248:251], v[216:219]
v_cvt_pk_bf16_f32 v42, v200, v201
v_cvt_pk_bf16_f32 v43, v202, v203
v_mfma_f32_16x16x32_bf16 v[220:223], a[164:167], a[252:255], v[220:223]
ds_read_b64_tr_b16 a[164:165], v6 offset:0
v_cvt_pk_bf16_f32 v46, v204, v205
v_cvt_pk_bf16_f32 v47, v206, v207
v_mfma_f32_16x16x32_bf16 v[224:227], a[168:171], a[224:227], v[224:227]
ds_read_b64_tr_b16 a[166:167], v6 offset:1024
v_cvt_pk_bf16_f32 v50, v208, v209
v_cvt_pk_bf16_f32 v51, v210, v211
v_mfma_f32_16x16x32_bf16 v[228:231], a[168:171], a[228:231], v[228:231]
s_add_u32 s37, s31, 131072
ds_read_b128 a[220:223], v4 offset:13312
v_xor_b32 v6, 16, v5
v_cvt_pk_bf16_f32 v54, v212, v213
v_cvt_pk_bf16_f32 v55, v214, v215
v_mfma_f32_16x16x32_bf16 v[232:235], a[168:171], a[232:235], v[232:235]
s_add_u32 m0, s33, 4096
v_cvt_pk_bf16_f32 v58, v216, v217
v_cvt_pk_bf16_f32 v59, v218, v219
v_mfma_f32_16x16x32_bf16 v[236:239], a[168:171], a[236:239], v[236:239]
buffer_load_dwordx4 v2, s[20:23], s37 offen  lds
v_cvt_pk_bf16_f32 v62, v220, v221
v_cvt_pk_bf16_f32 v63, v222, v223
v_mfma_f32_16x16x32_bf16 v[240:243], a[168:171], a[240:243], v[240:243]
ds_read_b64_tr_b16 a[188:189], v12 offset:0
v_cvt_pk_bf16_f32 v64, v224, v225
v_cvt_pk_bf16_f32 v65, v226, v227
v_mfma_f32_16x16x32_bf16 v[244:247], a[168:171], a[244:247], v[244:247]
v_cvt_pk_bf16_f32 v68, v228, v229
v_cvt_pk_bf16_f32 v69, v230, v231
v_mfma_f32_16x16x32_bf16 v[248:251], a[168:171], a[248:251], v[248:251]
ds_read_b64_tr_b16 a[190:191], v12 offset:1024
v_cvt_pk_bf16_f32 v72, v232, v233
v_cvt_pk_bf16_f32 v73, v234, v235
v_mfma_f32_16x16x32_bf16 v[252:255], a[168:171], a[252:255], v[252:255]
ds_read_b64_tr_b16 a[168:169], v7 offset:0
v_cvt_pk_bf16_f32 v76, v236, v237
v_cvt_pk_bf16_f32 v77, v238, v239
v_mfma_f32_16x16x32_bf16 a[0:3], a[172:175], a[224:227], a[0:3]
s_add_u32 s37, s31, 163840
ds_read_b64_tr_b16 a[170:171], v7 offset:1024
v_cvt_pk_bf16_f32 v80, v240, v241
v_cvt_pk_bf16_f32 v81, v242, v243
v_mfma_f32_16x16x32_bf16 a[4:7], a[172:175], a[228:231], a[4:7]
s_add_u32 m0, s33, 5120
v_xor_b32 v7, 64, v5
v_xor_b32 v12, 208, v5
v_cvt_pk_bf16_f32 v84, v244, v245
v_cvt_pk_bf16_f32 v85, v246, v247
v_mfma_f32_16x16x32_bf16 a[8:11], a[172:175], a[232:235], a[8:11]
buffer_load_dwordx4 v2, s[20:23], s37 offen  lds
v_cvt_pk_bf16_f32 v88, v248, v249
v_cvt_pk_bf16_f32 v89, v250, v251
v_mfma_f32_16x16x32_bf16 a[12:15], a[172:175], a[236:239], a[12:15]
s_add_u32 s31, s31, 262144
v_cvt_pk_bf16_f32 v92, v252, v253
v_cvt_pk_bf16_f32 v93, v254, v255
v_mfma_f32_16x16x32_bf16 a[16:19], a[172:175], a[240:243], a[16:19]
s_add_u32 s33, s33, 16384
v_accvgpr_read_b32 v20, a0
v_accvgpr_read_b32 v21, a1
v_accvgpr_read_b32 v22, a2
v_accvgpr_read_b32 v23, a3
v_mfma_f32_16x16x32_bf16 a[20:23], a[172:175], a[244:247], a[20:23]
s_and_b32 s33, s33, 65535
v_cvt_pk_bf16_f32 v66, v20, v21
v_cvt_pk_bf16_f32 v67, v22, v23
v_accvgpr_read_b32 v24, a4
v_accvgpr_read_b32 v25, a5
v_mfma_f32_16x16x32_bf16 a[24:27], a[172:175], a[248:251], a[24:27]
v_accvgpr_read_b32 v26, a6
v_accvgpr_read_b32 v27, a7
v_cvt_pk_bf16_f32 v70, v24, v25
v_cvt_pk_bf16_f32 v71, v26, v27
v_mfma_f32_16x16x32_bf16 a[28:31], a[172:175], a[252:255], a[28:31]
s_mov_b32 s48, s30
ds_read_b64_tr_b16 a[172:173], v8 offset:0
v_accvgpr_read_b32 v20, a8
v_accvgpr_read_b32 v21, a9
v_accvgpr_read_b32 v22, a10
v_mfma_f32_16x16x32_bf16 a[32:35], a[176:179], a[224:227], a[32:35]
s_add_u32 m0, s32, 0
ds_read_b64_tr_b16 a[174:175], v8 offset:1024
v_mov_b32 v16, 0
v_accvgpr_read_b32 v23, a11
v_cvt_pk_bf16_f32 v74, v20, v21
v_mfma_f32_16x16x32_bf16 a[36:39], a[176:179], a[228:231], a[36:39]
buffer_load_dwordx4 v1, s[12:15], s48 offen lds
v_mov_b32 v17, 1
v_cvt_pk_bf16_f32 v75, v22, v23
v_accvgpr_read_b32 v24, a12
v_mfma_f32_16x16x32_bf16 a[40:43], a[176:179], a[232:235], a[40:43]
s_cmp_eq_u32 s17, 0
s_cselect_b32 s29, s39, 536870912
v_accvgpr_read_b32 v25, a13
v_accvgpr_read_b32 v26, a14
v_mfma_f32_16x16x32_bf16 a[44:47], a[176:179], a[236:239], a[44:47]
s_mov_b64 exec, 1
buffer_store_dword v17, v16, s[8:11], s29 offen sc1
s_mov_b64 exec, -1
v_accvgpr_read_b32 v27, a15
v_mfma_f32_16x16x32_bf16 a[48:51], a[176:179], a[240:243], a[48:51]
v_xor_b32 v8, 80, v5
v_cvt_pk_bf16_f32 v78, v24, v25
v_cvt_pk_bf16_f32 v79, v26, v27
v_accvgpr_read_b32 v20, a16
v_mfma_f32_16x16x32_bf16 a[52:55], a[176:179], a[244:247], a[52:55]
v_accvgpr_read_b32 v21, a17
v_accvgpr_read_b32 v22, a18
v_accvgpr_read_b32 v23, a19
v_cvt_pk_bf16_f32 v82, v20, v21
v_mfma_f32_16x16x32_bf16 a[56:59], a[176:179], a[248:251], a[56:59]
s_add_u32 s48, s48, s34
v_cvt_pk_bf16_f32 v83, v22, v23
v_accvgpr_read_b32 v24, a20
v_accvgpr_read_b32 v25, a21
v_accvgpr_read_b32 v26, a22
v_mfma_f32_16x16x32_bf16 a[60:63], a[176:179], a[252:255], a[60:63]
s_add_u32 m0, s32, 4096
ds_read_b64_tr_b16 a[176:177], v9 offset:0
v_accvgpr_read_b32 v27, a23
v_cvt_pk_bf16_f32 v86, v24, v25
v_cvt_pk_bf16_f32 v87, v26, v27
v_mfma_f32_16x16x32_bf16 a[64:67], a[180:183], a[224:227], a[64:67]
buffer_load_dwordx4 v1, s[12:15], s48 offen lds
ds_read_b64_tr_b16 a[178:179], v9 offset:1024
v_accvgpr_read_b32 v20, a24
v_accvgpr_read_b32 v21, a25
v_mfma_f32_16x16x32_bf16 a[68:71], a[180:183], a[228:231], a[68:71]
v_xor_b32 v9, 128, v5
v_accvgpr_read_b32 v22, a26
v_accvgpr_read_b32 v23, a27
v_cvt_pk_bf16_f32 v90, v20, v21
v_mfma_f32_16x16x32_bf16 a[72:75], a[180:183], a[232:235], a[72:75]
v_cvt_pk_bf16_f32 v91, v22, v23
v_accvgpr_read_b32 v24, a28
v_accvgpr_read_b32 v25, a29
v_accvgpr_read_b32 v26, a30
v_mfma_f32_16x16x32_bf16 a[76:79], a[180:183], a[236:239], a[76:79]
v_accvgpr_read_b32 v27, a31
v_cvt_pk_bf16_f32 v94, v24, v25
v_cvt_pk_bf16_f32 v95, v26, v27
v_accvgpr_read_b32 v20, a32
v_mfma_f32_16x16x32_bf16 a[80:83], a[180:183], a[240:243], a[80:83]
v_accvgpr_read_b32 v21, a33
v_accvgpr_read_b32 v22, a34
v_accvgpr_read_b32 v23, a35
v_cvt_pk_bf16_f32 v96, v20, v21
v_mfma_f32_16x16x32_bf16 a[84:87], a[180:183], a[244:247], a[84:87]
s_add_u32 s48, s48, s34
v_cvt_pk_bf16_f32 v97, v22, v23
v_accvgpr_read_b32 v24, a36
v_accvgpr_read_b32 v25, a37
v_accvgpr_read_b32 v26, a38
v_mfma_f32_16x16x32_bf16 a[88:91], a[180:183], a[248:251], a[88:91]
s_add_u32 m0, s32, 8192
v_accvgpr_read_b32 v27, a39
v_cvt_pk_bf16_f32 v100, v24, v25
v_cvt_pk_bf16_f32 v101, v26, v27
v_accvgpr_read_b32 v20, a40
v_mfma_f32_16x16x32_bf16 a[92:95], a[180:183], a[252:255], a[92:95]
buffer_load_dwordx4 v1, s[12:15], s48 offen lds
ds_read_b64_tr_b16 a[180:181], v10 offset:0
v_accvgpr_read_b32 v21, a41
v_accvgpr_read_b32 v22, a42
v_mfma_f32_16x16x32_bf16 a[96:99], a[184:187], a[224:227], a[96:99]
ds_read_b64_tr_b16 a[182:183], v10 offset:1024
v_accvgpr_read_b32 v23, a43
v_cvt_pk_bf16_f32 v104, v20, v21
v_cvt_pk_bf16_f32 v105, v22, v23
v_mfma_f32_16x16x32_bf16 a[100:103], a[184:187], a[228:231], a[100:103]
v_xor_b32 v10, 144, v5
v_accvgpr_read_b32 v24, a44
v_accvgpr_read_b32 v25, a45
v_accvgpr_read_b32 v26, a46
v_mfma_f32_16x16x32_bf16 a[104:107], a[184:187], a[232:235], a[104:107]
v_accvgpr_read_b32 v27, a47
v_cvt_pk_bf16_f32 v108, v24, v25
v_cvt_pk_bf16_f32 v109, v26, v27
v_accvgpr_read_b32 v20, a48
v_mfma_f32_16x16x32_bf16 a[108:111], a[184:187], a[236:239], a[108:111]
v_accvgpr_read_b32 v21, a49
v_accvgpr_read_b32 v22, a50
v_accvgpr_read_b32 v23, a51
v_cvt_pk_bf16_f32 v112, v20, v21
v_mfma_f32_16x16x32_bf16 a[112:115], a[184:187], a[240:243], a[112:115]
s_add_u32 s48, s48, s34
v_cvt_pk_bf16_f32 v113, v22, v23
v_accvgpr_read_b32 v24, a52
v_accvgpr_read_b32 v25, a53
v_accvgpr_read_b32 v26, a54
v_mfma_f32_16x16x32_bf16 a[116:119], a[184:187], a[244:247], a[116:119]
s_add_u32 m0, s32, 12288
v_accvgpr_read_b32 v27, a55
v_cvt_pk_bf16_f32 v116, v24, v25
v_cvt_pk_bf16_f32 v117, v26, v27
v_accvgpr_read_b32 v20, a56
v_mfma_f32_16x16x32_bf16 a[120:123], a[184:187], a[248:251], a[120:123]
buffer_load_dwordx4 v1, s[12:15], s48 offen lds
v_accvgpr_read_b32 v21, a57
v_accvgpr_read_b32 v22, a58
v_accvgpr_read_b32 v23, a59
v_mfma_f32_16x16x32_bf16 a[124:127], a[184:187], a[252:255], a[124:127]
ds_read_b64_tr_b16 a[184:185], v11 offset:0
v_cvt_pk_bf16_f32 v120, v20, v21
v_cvt_pk_bf16_f32 v121, v22, v23
v_accvgpr_read_b32 v24, a60
v_mfma_f32_16x16x32_bf16 a[128:131], v[28:31], a[224:227], a[128:131]
ds_read_b64_tr_b16 a[186:187], v11 offset:1024
v_accvgpr_read_b32 v25, a61
v_accvgpr_read_b32 v26, a62
v_accvgpr_read_b32 v27, a63
v_mfma_f32_16x16x32_bf16 a[132:135], v[28:31], a[228:231], a[132:135]
v_xor_b32 v11, 192, v5
v_cvt_pk_bf16_f32 v124, v24, v25
v_cvt_pk_bf16_f32 v125, v26, v27
v_mfma_f32_16x16x32_bf16 a[136:139], v[28:31], a[232:235], a[136:139]
buffer_load_dword v15, v14, s[96:99], s100 offen
v_mfma_f32_16x16x32_bf16 a[140:143], v[28:31], a[236:239], a[140:143]
s_add_u32 s100, s100, 16384
v_mfma_f32_16x16x32_bf16 a[144:147], v[28:31], a[240:243], a[144:147]
v_mfma_f32_16x16x32_bf16 a[148:151], v[28:31], a[244:247], a[148:151]
v_mfma_f32_16x16x32_bf16 a[152:155], v[28:31], a[248:251], a[152:155]
v_mfma_f32_16x16x32_bf16 a[156:159], v[28:31], a[252:255], a[156:159]
s_cmp_lt_u32 s35, s45
s_cbranch_scc1 L_g_tile
s_branch L_g_end
L_g_v17v:
s_waitcnt vmcnt(18) lgkmcnt(0)
s_barrier
v_mfma_f32_16x16x32_bf16 v[160:163], a[160:163], a[224:227], v[160:163]
ds_read_b64_tr_b16 a[192:193], v5 offset:0
v_mfma_f32_16x16x32_bf16 v[164:167], a[160:163], a[228:231], v[164:167]
v_mfma_f32_16x16x32_bf16 v[168:171], a[160:163], a[232:235], v[168:171]
ds_read_b64_tr_b16 a[194:195], v5 offset:1024
v_mfma_f32_16x16x32_bf16 v[172:175], a[160:163], a[236:239], v[172:175]
s_add_u32 s37, s31, 0
v_mfma_f32_16x16x32_bf16 v[176:179], a[160:163], a[240:243], v[176:179]
s_add_u32 m0, s33, 0
ds_read_b64_tr_b16 a[196:197], v6 offset:0
v_cvt_pk_bf16_f32 v32, v160, v161
v_cvt_pk_bf16_f32 v33, v162, v163
v_mfma_f32_16x16x32_bf16 v[180:183], a[160:163], a[244:247], v[180:183]
buffer_load_dwordx4 v2, s[20:23], s37 offen  lds
v_cvt_pk_bf16_f32 v36, v164, v165
v_cvt_pk_bf16_f32 v37, v166, v167
v_mfma_f32_16x16x32_bf16 v[184:187], a[160:163], a[248:251], v[184:187]
ds_read_b64_tr_b16 a[198:199], v6 offset:1024
v_cvt_pk_bf16_f32 v40, v168, v169
v_cvt_pk_bf16_f32 v41, v170, v171
v_mfma_f32_16x16x32_bf16 v[188:191], a[160:163], a[252:255], v[188:191]
ds_read_b128 a[160:163], v3 offset:0
v_cvt_pk_bf16_f32 v44, v172, v173
v_cvt_pk_bf16_f32 v45, v174, v175
v_mfma_f32_16x16x32_bf16 v[192:195], a[164:167], a[224:227], v[192:195]
ds_read_b64_tr_b16 a[200:201], v7 offset:0
v_cvt_pk_bf16_f32 v48, v176, v177
v_cvt_pk_bf16_f32 v49, v178, v179
v_mfma_f32_16x16x32_bf16 v[196:199], a[164:167], a[228:231], v[196:199]
v_cvt_pk_bf16_f32 v52, v180, v181
v_cvt_pk_bf16_f32 v53, v182, v183
v_mfma_f32_16x16x32_bf16 v[200:203], a[164:167], a[232:235], v[200:203]
s_add_u32 s37, s31, 32768
ds_read_b64_tr_b16 a[202:203], v7 offset:1024
v_cvt_pk_bf16_f32 v56, v184, v185
v_cvt_pk_bf16_f32 v57, v186, v187
v_mfma_f32_16x16x32_bf16 v[204:207], a[164:167], a[236:239], v[204:207]
s_add_u32 m0, s33, 1024
v_cvt_pk_bf16_f32 v60, v188, v189
v_cvt_pk_bf16_f32 v61, v190, v191
v_mfma_f32_16x16x32_bf16 v[208:211], a[164:167], a[240:243], v[208:211]
buffer_load_dwordx4 v2, s[20:23], s37 offen  lds
v_cvt_pk_bf16_f32 v34, v192, v193
v_cvt_pk_bf16_f32 v35, v194, v195
v_mfma_f32_16x16x32_bf16 v[212:215], a[164:167], a[244:247], v[212:215]
ds_read_b64_tr_b16 a[204:205], v8 offset:0
v_cvt_pk_bf16_f32 v38, v196, v197
v_cvt_pk_bf16_f32 v39, v198, v199
v_mfma_f32_16x16x32_bf16 v[216:219], a[164:167], a[248:251], v[216:219]
v_cvt_pk_bf16_f32 v42, v200, v201
v_cvt_pk_bf16_f32 v43, v202, v203
v_mfma_f32_16x16x32_bf16 v[220:223], a[164:167], a[252:255], v[220:223]
ds_read_b128 a[164:167], v4 offset:1024
v_cvt_pk_bf16_f32 v46, v204, v205
v_cvt_pk_bf16_f32 v47, v206, v207
v_mfma_f32_16x16x32_bf16 v[224:227], a[168:171], a[224:227], v[224:227]
ds_read_b64_tr_b16 a[206:207], v8 offset:1024
v_cvt_pk_bf16_f32 v50, v208, v209
v_cvt_pk_bf16_f32 v51, v210, v211
v_mfma_f32_16x16x32_bf16 v[228:231], a[168:171], a[228:231], v[228:231]
s_add_u32 s37, s31, 131072
v_cvt_pk_bf16_f32 v54, v212, v213
v_cvt_pk_bf16_f32 v55, v214, v215
v_mfma_f32_16x16x32_bf16 v[232:235], a[168:171], a[232:235], v[232:235]
s_add_u32 m0, s33, 4096
ds_read_b64_tr_b16 a[208:209], v9 offset:0
v_cvt_pk_bf16_f32 v58, v216, v217
v_cvt_pk_bf16_f32 v59, v218, v219
v_mfma_f32_16x16x32_bf16 v[236:239], a[168:171], a[236:239], v[236:239]
buffer_load_dwordx4 v2, s[20:23], s37 offen  lds
v_cvt_pk_bf16_f32 v62, v220, v221
v_cvt_pk_bf16_f32 v63, v222, v223
v_mfma_f32_16x16x32_bf16 v[240:243], a[168:171], a[240:243], v[240:243]
ds_read_b64_tr_b16 a[210:211], v9 offset:1024
v_cvt_pk_bf16_f32 v64, v224, v225
v_cvt_pk_bf16_f32 v65, v226, v227
v_mfma_f32_16x16x32_bf16 v[244:247], a[168:171], a[244:247], v[244:247]
v_cvt_pk_bf16_f32 v68, v228, v229
v_cvt_pk_bf16_f32 v69, v230, v231
v_mfma_f32_16x16x32_bf16 v[248:251], a[168:171], a[248:251], v[248:251]
ds_read_b64_tr_b16 a[212:213], v10 offset:0
v_cvt_pk_bf16_f32 v72, v232, v233
v_cvt_pk_bf16_f32 v73, v234, v235
v_mfma_f32_16x16x32_bf16 v[252:255], a[168:171], a[252:255], v[252:255]
ds_read_b128 a[168:171], v3 offset:4096
v_cvt_pk_bf16_f32 v76, v236, v237
v_cvt_pk_bf16_f32 v77, v238, v239
v_mfma_f32_16x16x32_bf16 a[0:3], a[172:175], a[224:227], a[0:3]
s_add_u32 s37, s31, 163840
ds_read_b64_tr_b16 a[214:215], v10 offset:1024
v_cvt_pk_bf16_f32 v80, v240, v241
v_cvt_pk_bf16_f32 v81, v242, v243
v_mfma_f32_16x16x32_bf16 a[4:7], a[172:175], a[228:231], a[4:7]
s_add_u32 m0, s33, 5120
v_cvt_pk_bf16_f32 v84, v244, v245
v_cvt_pk_bf16_f32 v85, v246, v247
v_mfma_f32_16x16x32_bf16 a[8:11], a[172:175], a[232:235], a[8:11]
buffer_load_dwordx4 v2, s[20:23], s37 offen  lds
v_cvt_pk_bf16_f32 v88, v248, v249
v_cvt_pk_bf16_f32 v89, v250, v251
v_mfma_f32_16x16x32_bf16 a[12:15], a[172:175], a[236:239], a[12:15]
s_add_u32 s31, s31, 262144
ds_read_b64_tr_b16 a[216:217], v11 offset:0
v_cvt_pk_bf16_f32 v92, v252, v253
v_cvt_pk_bf16_f32 v93, v254, v255
v_mfma_f32_16x16x32_bf16 a[16:19], a[172:175], a[240:243], a[16:19]
s_add_u32 s33, s33, 16384
v_accvgpr_read_b32 v20, a0
v_accvgpr_read_b32 v21, a1
v_accvgpr_read_b32 v22, a2
v_accvgpr_read_b32 v23, a3
v_mfma_f32_16x16x32_bf16 a[20:23], a[172:175], a[244:247], a[20:23]
s_and_b32 s33, s33, 65535
ds_read_b64_tr_b16 a[218:219], v11 offset:1024
v_cvt_pk_bf16_f32 v66, v20, v21
v_cvt_pk_bf16_f32 v67, v22, v23
v_accvgpr_read_b32 v24, a4
v_mfma_f32_16x16x32_bf16 a[24:27], a[172:175], a[248:251], a[24:27]
v_accvgpr_read_b32 v25, a5
v_accvgpr_read_b32 v26, a6
v_accvgpr_read_b32 v27, a7
v_cvt_pk_bf16_f32 v70, v24, v25
v_mfma_f32_16x16x32_bf16 a[28:31], a[172:175], a[252:255], a[28:31]
s_mov_b32 s48, s30
ds_read_b128 a[172:175], v4 offset:5120
v_cvt_pk_bf16_f32 v71, v26, v27
v_accvgpr_read_b32 v20, a8
v_accvgpr_read_b32 v21, a9
v_mfma_f32_16x16x32_bf16 a[32:35], a[176:179], a[224:227], a[32:35]
s_add_u32 m0, s32, 0
ds_read_b64_tr_b16 a[220:221], v12 offset:0
v_mov_b32 v16, 0
v_accvgpr_read_b32 v22, a10
v_accvgpr_read_b32 v23, a11
v_mfma_f32_16x16x32_bf16 a[36:39], a[176:179], a[228:231], a[36:39]
buffer_load_dwordx4 v1, s[12:15], s48 offen lds
v_mov_b32 v17, 1
v_cvt_pk_bf16_f32 v74, v20, v21
v_cvt_pk_bf16_f32 v75, v22, v23
v_mfma_f32_16x16x32_bf16 a[40:43], a[176:179], a[232:235], a[40:43]
ds_read_b64_tr_b16 a[222:223], v12 offset:1024
v_accvgpr_read_b32 v24, a12
v_accvgpr_read_b32 v25, a13
v_accvgpr_read_b32 v26, a14
v_mfma_f32_16x16x32_bf16 a[44:47], a[176:179], a[236:239], a[44:47]
s_cmp_eq_u32 s17, 0
s_cselect_b32 s29, s39, 536870912
v_accvgpr_read_b32 v27, a15
v_cvt_pk_bf16_f32 v78, v24, v25
v_mfma_f32_16x16x32_bf16 a[48:51], a[176:179], a[240:243], a[48:51]
ds_read_b128 a[188:191], v4 offset:13312
v_cvt_pk_bf16_f32 v79, v26, v27
v_accvgpr_read_b32 v20, a16
v_accvgpr_read_b32 v21, a17
v_mfma_f32_16x16x32_bf16 a[52:55], a[176:179], a[244:247], a[52:55]
s_mov_b64 exec, 1
buffer_store_dword v17, v16, s[8:11], s29 offen sc1
s_mov_b64 exec, -1
v_accvgpr_read_b32 v22, a18
v_mfma_f32_16x16x32_bf16 a[56:59], a[176:179], a[248:251], a[56:59]
s_add_u32 s48, s48, s34
v_accvgpr_read_b32 v23, a19
v_cvt_pk_bf16_f32 v82, v20, v21
v_cvt_pk_bf16_f32 v83, v22, v23
v_accvgpr_read_b32 v24, a20
v_mfma_f32_16x16x32_bf16 a[60:63], a[176:179], a[252:255], a[60:63]
s_add_u32 m0, s32, 4096
ds_read_b128 a[176:179], v3 offset:8192
v_add_u32 v5, 16384, v5
v_accvgpr_read_b32 v25, a21
v_accvgpr_read_b32 v26, a22
v_mfma_f32_16x16x32_bf16 a[64:67], a[180:183], a[224:227], a[64:67]
buffer_load_dwordx4 v1, s[12:15], s48 offen lds
v_and_b32 v5, 65535, v5
v_accvgpr_read_b32 v27, a23
v_cvt_pk_bf16_f32 v86, v24, v25
v_mfma_f32_16x16x32_bf16 a[68:71], a[180:183], a[228:231], a[68:71]
v_xor_b32 v6, 16, v5
v_xor_b32 v7, 64, v5
v_cvt_pk_bf16_f32 v87, v26, v27
v_accvgpr_read_b32 v20, a24
v_mfma_f32_16x16x32_bf16 a[72:75], a[180:183], a[232:235], a[72:75]
v_xor_b32 v8, 80, v5
v_xor_b32 v9, 128, v5
v_accvgpr_read_b32 v21, a25
v_accvgpr_read_b32 v22, a26
v_mfma_f32_16x16x32_bf16 a[76:79], a[180:183], a[236:239], a[76:79]
v_xor_b32 v10, 144, v5
v_xor_b32 v11, 192, v5
v_accvgpr_read_b32 v23, a27
v_cvt_pk_bf16_f32 v90, v20, v21
v_mfma_f32_16x16x32_bf16 a[80:83], a[180:183], a[240:243], a[80:83]
v_xor_b32 v12, 208, v5
v_cvt_pk_bf16_f32 v91, v22, v23
v_accvgpr_read_b32 v24, a28
v_accvgpr_read_b32 v25, a29
v_mfma_f32_16x16x32_bf16 a[84:87], a[180:183], a[244:247], a[84:87]
s_add_u32 s48, s48, s34
v_accvgpr_read_b32 v26, a30
v_accvgpr_read_b32 v27, a31
v_cvt_pk_bf16_f32 v94, v24, v25
v_cvt_pk_bf16_f32 v95, v26, v27
v_mfma_f32_16x16x32_bf16 a[88:91], a[180:183], a[248:251], a[88:91]
s_add_u32 m0, s32, 8192
v_accvgpr_read_b32 v20, a32
v_accvgpr_read_b32 v21, a33
v_accvgpr_read_b32 v22, a34
v_accvgpr_read_b32 v23, a35
v_mfma_f32_16x16x32_bf16 a[92:95], a[180:183], a[252:255], a[92:95]
buffer_load_dwordx4 v1, s[12:15], s48 offen lds
ds_read_b128 a[180:183], v4 offset:9216
v_cvt_pk_bf16_f32 v96, v20, v21
v_cvt_pk_bf16_f32 v97, v22, v23
v_mfma_f32_16x16x32_bf16 a[96:99], a[184:187], a[224:227], a[96:99]
v_accvgpr_read_b32 v24, a36
v_accvgpr_read_b32 v25, a37
v_accvgpr_read_b32 v26, a38
v_accvgpr_read_b32 v27, a39
v_mfma_f32_16x16x32_bf16 a[100:103], a[184:187], a[228:231], a[100:103]
v_cvt_pk_bf16_f32 v100, v24, v25
v_cvt_pk_bf16_f32 v101, v26, v27
v_accvgpr_read_b32 v20, a40
v_accvgpr_read_b32 v21, a41
v_mfma_f32_16x16x32_bf16 a[104:107], a[184:187], a[232:235], a[104:107]
v_accvgpr_read_b32 v22, a42
v_accvgpr_read_b32 v23, a43
v_cvt_pk_bf16_f32 v104, v20, v21
v_cvt_pk_bf16_f32 v105, v22, v23
v_mfma_f32_16x16x32_bf16 a[108:111], a[184:187], a[236:239], a[108:111]
v_accvgpr_read_b32 v24, a44
v_accvgpr_read_b32 v25, a45
v_accvgpr_read_b32 v26, a46
v_accvgpr_read_b32 v27, a47
v_mfma_f32_16x16x32_bf16 a[112:115], a[184:187], a[240:243], a[112:115]
s_add_u32 s48, s48, s34
v_cvt_pk_bf16_f32 v108, v24, v25
v_cvt_pk_bf16_f32 v109, v26, v27
v_accvgpr_read_b32 v20, a48
v_accvgpr_read_b32 v21, a49
v_mfma_f32_16x16x32_bf16 a[116:119], a[184:187], a[244:247], a[116:119]
s_add_u32 m0, s32, 12288
v_accvgpr_read_b32 v22, a50
v_accvgpr_read_b32 v23, a51
v_cvt_pk_bf16_f32 v112, v20, v21
v_cvt_pk_bf16_f32 v113, v22, v23
v_mfma_f32_16x16x32_bf16 a[120:123], a[184:187], a[248:251], a[120:123]
buffer_load_dwordx4 v1, s[12:15], s48 offen lds
v_accvgpr_read_b32 v24, a52
v_accvgpr_read_b32 v25, a53
v_accvgpr_read_b32 v26, a54
v_mfma_f32_16x16x32_bf16 a[124:127], a[184:187], a[252:255], a[124:127]
ds_read_b128 a[184:187], v3 offset:12288
v_accvgpr_read_b32 v27, a55
v_cvt_pk_bf16_f32 v116, v24, v25
v_cvt_pk_bf16_f32 v117, v26, v27
v_mfma_f32_16x16x32_bf16 a[128:131], v[28:31], a[224:227], a[128:131]
v_accvgpr_read_b32 v20, a56
v_accvgpr_read_b32 v21, a57
v_accvgpr_read_b32 v22, a58
v_accvgpr_read_b32 v23, a59
v_mfma_f32_16x16x32_bf16 a[132:135], v[28:31], a[228:231], a[132:135]
v_cvt_pk_bf16_f32 v120, v20, v21
v_cvt_pk_bf16_f32 v121, v22, v23
v_accvgpr_read_b32 v24, a60
v_accvgpr_read_b32 v25, a61
v_mfma_f32_16x16x32_bf16 a[136:139], v[28:31], a[232:235], a[136:139]
buffer_load_dword v15, v14, s[96:99], s100 offen
v_accvgpr_read_b32 v26, a62
v_accvgpr_read_b32 v27, a63
v_cvt_pk_bf16_f32 v124, v24, v25
v_mfma_f32_16x16x32_bf16 a[140:143], v[28:31], a[236:239], a[140:143]
s_add_u32 s100, s100, 16384
v_cvt_pk_bf16_f32 v125, v26, v27
v_mfma_f32_16x16x32_bf16 a[144:147], v[28:31], a[240:243], a[144:147]
v_mfma_f32_16x16x32_bf16 a[148:151], v[28:31], a[244:247], a[148:151]
v_mfma_f32_16x16x32_bf16 a[152:155], v[28:31], a[248:251], a[152:155]
v_mfma_f32_16x16x32_bf16 a[156:159], v[28:31], a[252:255], a[156:159]
s_cmp_lt_u32 s35, s45
s_cbranch_scc1 L_g_tile
s_branch L_g_end
L_g_first:
s_mov_b32 s100, 536870912
s_cmp_eq_u32 s95, 0
s_cbranch_scc0 L_g_end
v_mov_b32 v20, 128
s_mov_b32 s28, 0
L_poll_8:
buffer_load_dword v21, v20, s[56:59], 0 offen sc1
s_add_u32 s28, s28, 1
s_cmp_gt_u32 s28, 200000
s_cbranch_scc1 L_end
s_waitcnt vmcnt(0)
v_cmp_ne_u32 vcc, 8, v21
s_cbranch_vccz L_pd_9
s_sleep 1
s_branch L_poll_8
L_pd_9:
s_branch L_g_go
L_g_end:
s_cmp_eq_u32 s61, 0
s_cbranch_scc1 L_att
v_bfe_u32 v16, v0, 3, 3
v_lshlrev_b32 v16, 4, v16
v_and_or_b32 v16, v0, 7, v16
v_bfe_u32 v17, v0, 4, 2
v_lshlrev_b32 v17, 5, v17
v_bfe_u32 v18, v0, 1, 3
v_or_b32 v17, v17, v18
v_and_b32 v18, 1, v0
v_lshl_or_b32 v17, v18, 4, v17
s_bitcmp1_b32 s50, 1
s_cselect_b64 vcc, -1, 0
s_movk_i32 s44, 0x80
v_cndmask_b32 v16, v16, v17, vcc
v_lshlrev_b32 v13, 4, v16
s_lshr_b32 s93, s50, 2
s_lshr_b32 s93, 0x80000, s93
s_bitcmp1_b32 s50, 0
s_cselect_b32 s92, s93, 0x800
s_cselect_b32 s93, 0x800, s93
s_sub_u32 s93, s93, s44
s_and_b32 s24, s17, s91
s_cbranch_scc0 L_g_h1
s_barrier
L_g_h1:
v_cvt_pk_bf16_f32 v32, v160, v161
v_cvt_pk_bf16_f32 v33, v162, v163
v_cvt_pk_bf16_f32 v34, v192, v193
v_cvt_pk_bf16_f32 v35, v194, v195
s_mov_b32 s60, s62
s_mov_b32 s29, s62
buffer_store_dwordx4 v[32:35], v13, s[8:11], s29 offen sc1
v_cvt_pk_bf16_f32 v36, v164, v165
v_cvt_pk_bf16_f32 v37, v166, v167
v_cvt_pk_bf16_f32 v38, v196, v197
v_cvt_pk_bf16_f32 v39, v198, v199
s_add_u32 s29, s29, s44
buffer_store_dwordx4 v[36:39], v13, s[8:11], s29 offen sc1
v_cvt_pk_bf16_f32 v40, v168, v169
v_cvt_pk_bf16_f32 v41, v170, v171
v_cvt_pk_bf16_f32 v42, v200, v201
v_cvt_pk_bf16_f32 v43, v202, v203
s_add_u32 s29, s29, s93
buffer_store_dwordx4 v[40:43], v13, s[8:11], s29 offen sc1
v_cvt_pk_bf16_f32 v44, v172, v173
v_cvt_pk_bf16_f32 v45, v174, v175
v_cvt_pk_bf16_f32 v46, v204, v205
v_cvt_pk_bf16_f32 v47, v206, v207
s_add_u32 s29, s29, s44
buffer_store_dwordx4 v[44:47], v13, s[8:11], s29 offen sc1
v_cvt_pk_bf16_f32 v48, v176, v177
v_cvt_pk_bf16_f32 v49, v178, v179
v_cvt_pk_bf16_f32 v50, v208, v209
v_cvt_pk_bf16_f32 v51, v210, v211
s_add_u32 s29, s29, s93
buffer_store_dwordx4 v[48:51], v13, s[8:11], s29 offen sc1
v_cvt_pk_bf16_f32 v52, v180, v181
v_cvt_pk_bf16_f32 v53, v182, v183
v_cvt_pk_bf16_f32 v54, v212, v213
v_cvt_pk_bf16_f32 v55, v214, v215
s_add_u32 s29, s29, s44
buffer_store_dwordx4 v[52:55], v13, s[8:11], s29 offen sc1
v_cvt_pk_bf16_f32 v56, v184, v185
v_cvt_pk_bf16_f32 v57, v186, v187
v_cvt_pk_bf16_f32 v58, v216, v217
v_cvt_pk_bf16_f32 v59, v218, v219
s_add_u32 s29, s29, s93
buffer_store_dwordx4 v[56:59], v13, s[8:11], s29 offen sc1
v_cvt_pk_bf16_f32 v60, v188, v189
v_cvt_pk_bf16_f32 v61, v190, v191
v_cvt_pk_bf16_f32 v62, v220, v221
v_cvt_pk_bf16_f32 v63, v222, v223
s_add_u32 s29, s29, s44
buffer_store_dwordx4 v[60:63], v13, s[8:11], s29 offen sc1
v_cvt_pk_bf16_f32 v64, v224, v225
v_cvt_pk_bf16_f32 v65, v226, v227
v_accvgpr_read_b32 v20, a0
v_accvgpr_read_b32 v21, a1
v_accvgpr_read_b32 v22, a2
v_accvgpr_read_b32 v23, a3
v_cvt_pk_bf16_f32 v66, v20, v21
v_cvt_pk_bf16_f32 v67, v22, v23
s_add_u32 s60, s60, s92
s_mov_b32 s29, s60
buffer_store_dwordx4 v[64:67], v13, s[8:11], s29 offen sc1
v_cvt_pk_bf16_f32 v68, v228, v229
v_cvt_pk_bf16_f32 v69, v230, v231
v_accvgpr_read_b32 v24, a4
v_accvgpr_read_b32 v25, a5
v_accvgpr_read_b32 v26, a6
v_accvgpr_read_b32 v27, a7
v_cvt_pk_bf16_f32 v70, v24, v25
v_cvt_pk_bf16_f32 v71, v26, v27
s_add_u32 s29, s29, s44
buffer_store_dwordx4 v[68:71], v13, s[8:11], s29 offen sc1
v_cvt_pk_bf16_f32 v72, v232, v233
v_cvt_pk_bf16_f32 v73, v234, v235
v_accvgpr_read_b32 v20, a8
v_accvgpr_read_b32 v21, a9
v_accvgpr_read_b32 v22, a10
v_accvgpr_read_b32 v23, a11
v_cvt_pk_bf16_f32 v74, v20, v21
v_cvt_pk_bf16_f32 v75, v22, v23
s_add_u32 s29, s29, s93
buffer_store_dwordx4 v[72:75], v13, s[8:11], s29 offen sc1
v_cvt_pk_bf16_f32 v76, v236, v237
v_cvt_pk_bf16_f32 v77, v238, v239
v_accvgpr_read_b32 v24, a12
v_accvgpr_read_b32 v25, a13
v_accvgpr_read_b32 v26, a14
v_accvgpr_read_b32 v27, a15
v_cvt_pk_bf16_f32 v78, v24, v25
v_cvt_pk_bf16_f32 v79, v26, v27
s_add_u32 s29, s29, s44
buffer_store_dwordx4 v[76:79], v13, s[8:11], s29 offen sc1
v_cvt_pk_bf16_f32 v80, v240, v241
v_cvt_pk_bf16_f32 v81, v242, v243
v_accvgpr_read_b32 v20, a16
v_accvgpr_read_b32 v21, a17
v_accvgpr_read_b32 v22, a18
v_accvgpr_read_b32 v23, a19
v_cvt_pk_bf16_f32 v82, v20, v21
v_cvt_pk_bf16_f32 v83, v22, v23
s_add_u32 s29, s29, s93
buffer_store_dwordx4 v[80:83], v13, s[8:11], s29 offen sc1
v_cvt_pk_bf16_f32 v84, v244, v245
v_cvt_pk_bf16_f32 v85, v246, v247
v_accvgpr_read_b32 v24, a20
v_accvgpr_read_b32 v25, a21
v_accvgpr_read_b32 v26, a22
v_accvgpr_read_b32 v27, a23
v_cvt_pk_bf16_f32 v86, v24, v25
v_cvt_pk_bf16_f32 v87, v26, v27
s_add_u32 s29, s29, s44
buffer_store_dwordx4 v[84:87], v13, s[8:11], s29 offen sc1
v_cvt_pk_bf16_f32 v88, v248, v249
v_cvt_pk_bf16_f32 v89, v250, v251
v_accvgpr_read_b32 v20, a24
v_accvgpr_read_b32 v21, a25
v_accvgpr_read_b32 v22, a26
v_accvgpr_read_b32 v23, a27
v_cvt_pk_bf16_f32 v90, v20, v21
v_cvt_pk_bf16_f32 v91, v22, v23
s_add_u32 s29, s29, s93
buffer_store_dwordx4 v[88:91], v13, s[8:11], s29 offen sc1
v_cvt_pk_bf16_f32 v92, v252, v253
v_cvt_pk_bf16_f32 v93, v254, v255
v_accvgpr_read_b32 v24, a28
v_accvgpr_read_b32 v25, a29
v_accvgpr_read_b32 v26, a30
v_accvgpr_read_b32 v27, a31
v_cvt_pk_bf16_f32 v94, v24, v25
v_cvt_pk_bf16_f32 v95, v26, v27
s_add_u32 s29, s29, s44
buffer_store_dwordx4 v[92:95], v13, s[8:11], s29 offen sc1
v_accvgpr_read_b32 v20, a32
v_accvgpr_read_b32 v21, a33
v_accvgpr_read_b32 v22, a34
v_accvgpr_read_b32 v23, a35
v_cvt_pk_bf16_f32 v96, v20, v21
v_cvt_pk_bf16_f32 v97, v22, v23
v_accvgpr_read_b32 v20, a64
v_accvgpr_read_b32 v21, a65
v_accvgpr_read_b32 v22, a66
v_accvgpr_read_b32 v23, a67
v_cvt_pk_bf16_f32 v98, v20, v21
v_cvt_pk_bf16_f32 v99, v22, v23
s_add_u32 s60, s60, s92
s_mov_b32 s29, s60
buffer_store_dwordx4 v[96:99], v13, s[8:11], s29 offen sc1
v_accvgpr_read_b32 v24, a36
v_accvgpr_read_b32 v25, a37
v_accvgpr_read_b32 v26, a38
v_accvgpr_read_b32 v27, a39
v_cvt_pk_bf16_f32 v100, v24, v25
v_cvt_pk_bf16_f32 v101, v26, v27
v_accvgpr_read_b32 v24, a68
v_accvgpr_read_b32 v25, a69
v_accvgpr_read_b32 v26, a70
v_accvgpr_read_b32 v27, a71
v_cvt_pk_bf16_f32 v102, v24, v25
v_cvt_pk_bf16_f32 v103, v26, v27
s_add_u32 s29, s29, s44
buffer_store_dwordx4 v[100:103], v13, s[8:11], s29 offen sc1
v_accvgpr_read_b32 v20, a40
v_accvgpr_read_b32 v21, a41
v_accvgpr_read_b32 v22, a42
v_accvgpr_read_b32 v23, a43
v_cvt_pk_bf16_f32 v104, v20, v21
v_cvt_pk_bf16_f32 v105, v22, v23
v_accvgpr_read_b32 v20, a72
v_accvgpr_read_b32 v21, a73
v_accvgpr_read_b32 v22, a74
v_accvgpr_read_b32 v23, a75
v_cvt_pk_bf16_f32 v106, v20, v21
v_cvt_pk_bf16_f32 v107, v22, v23
s_add_u32 s29, s29, s93
buffer_store_dwordx4 v[104:107], v13, s[8:11], s29 offen sc1
v_accvgpr_read_b32 v24, a44
v_accvgpr_read_b32 v25, a45
v_accvgpr_read_b32 v26, a46
v_accvgpr_read_b32 v27, a47
v_cvt_pk_bf16_f32 v108, v24, v25
v_cvt_pk_bf16_f32 v109, v26, v27
v_accvgpr_read_b32 v24, a76
v_accvgpr_read_b32 v25, a77
v_accvgpr_read_b32 v26, a78
v_accvgpr_read_b32 v27, a79
v_cvt_pk_bf16_f32 v110, v24, v25
v_cvt_pk_bf16_f32 v111, v26, v27
s_add_u32 s29, s29, s44
buffer_store_dwordx4 v[108:111], v13, s[8:11], s29 offen sc1
v_accvgpr_read_b32 v20, a48
v_accvgpr_read_b32 v21, a49
v_accvgpr_read_b32 v22, a50
v_accvgpr_read_b32 v23, a51
v_cvt_pk_bf16_f32 v112, v20, v21
v_cvt_pk_bf16_f32 v113, v22, v23
v_accvgpr_read_b32 v20, a80
v_accvgpr_read_b32 v21, a81
v_accvgpr_read_b32 v22, a82
v_accvgpr_read_b32 v23, a83
v_cvt_pk_bf16_f32 v114, v20, v21
v_cvt_pk_bf16_f32 v115, v22, v23
s_add_u32 s29, s29, s93
buffer_store_dwordx4 v[112:115], v13, s[8:11], s29 offen sc1
v_accvgpr_read_b32 v24, a52
v_accvgpr_read_b32 v25, a53
v_accvgpr_read_b32 v26, a54
v_accvgpr_read_b32 v27, a55
v_cvt_pk_bf16_f32 v116, v24, v25
v_cvt_pk_bf16_f32 v117, v26, v27
v_accvgpr_read_b32 v24, a84
v_accvgpr_read_b32 v25, a85
v_accvgpr_read_b32 v26, a86
v_accvgpr_read_b32 v27, a87
v_cvt_pk_bf16_f32 v118, v24, v25
v_cvt_pk_bf16_f32 v119, v26, v27
s_add_u32 s29, s29, s44
buffer_store_dwordx4 v[116:119], v13, s[8:11], s29 offen sc1
v_accvgpr_read_b32 v20, a56
v_accvgpr_read_b32 v21, a57
v_accvgpr_read_b32 v22, a58
v_accvgpr_read_b32 v23, a59
v_cvt_pk_bf16_f32 v120, v20, v21
v_cvt_pk_bf16_f32 v121, v22, v23
v_accvgpr_read_b32 v20, a88
v_accvgpr_read_b32 v21, a89
v_accvgpr_read_b32 v22, a90
v_accvgpr_read_b32 v23, a91
v_cvt_pk_bf16_f32 v122, v20, v21
v_cvt_pk_bf16_f32 v123, v22, v23
s_add_u32 s29, s29, s93
buffer_store_dwordx4 v[120:123], v13, s[8:11], s29 offen sc1
v_accvgpr_read_b32 v24, a60
v_accvgpr_read_b32 v25, a61
v_accvgpr_read_b32 v26, a62
v_accvgpr_read_b32 v27, a63
v_cvt_pk_bf16_f32 v124, v24, v25
v_cvt_pk_bf16_f32 v125, v26, v27
v_accvgpr_read_b32 v24, a92
v_accvgpr_read_b32 v25, a93
v_accvgpr_read_b32 v26, a94
v_accvgpr_read_b32 v27, a95
v_cvt_pk_bf16_f32 v126, v24, v25
v_cvt_pk_bf16_f32 v127, v26, v27
s_add_u32 s29, s29, s44
buffer_store_dwordx4 v[124:127], v13, s[8:11], s29 offen sc1
v_accvgpr_read_b32 v20, a96
v_accvgpr_read_b32 v21, a97
v_accvgpr_read_b32 v22, a98
v_accvgpr_read_b32 v23, a99
v_cvt_pk_bf16_f32 v128, v20, v21
v_cvt_pk_bf16_f32 v129, v22, v23
v_accvgpr_read_b32 v20, a128
v_accvgpr_read_b32 v21, a129
v_accvgpr_read_b32 v22, a130
v_accvgpr_read_b32 v23, a131
v_cvt_pk_bf16_f32 v130, v20, v21
v_cvt_pk_bf16_f32 v131, v22, v23
s_add_u32 s60, s60, s92
s_mov_b32 s29, s60
buffer_store_dwordx4 v[128:131], v13, s[8:11], s29 offen sc1
v_accvgpr_read_b32 v24, a100
v_accvgpr_read_b32 v25, a101
v_accvgpr_read_b32 v26, a102
v_accvgpr_read_b32 v27, a103
v_cvt_pk_bf16_f32 v132, v24, v25
v_cvt_pk_bf16_f32 v133, v26, v27
v_accvgpr_read_b32 v24, a132
v_accvgpr_read_b32 v25, a133
v_accvgpr_read_b32 v26, a134
v_accvgpr_read_b32 v27, a135
v_cvt_pk_bf16_f32 v134, v24, v25
v_cvt_pk_bf16_f32 v135, v26, v27
s_add_u32 s29, s29, s44
buffer_store_dwordx4 v[132:135], v13, s[8:11], s29 offen sc1
v_accvgpr_read_b32 v20, a104
v_accvgpr_read_b32 v21, a105
v_accvgpr_read_b32 v22, a106
v_accvgpr_read_b32 v23, a107
v_cvt_pk_bf16_f32 v136, v20, v21
v_cvt_pk_bf16_f32 v137, v22, v23
v_accvgpr_read_b32 v20, a136
v_accvgpr_read_b32 v21, a137
v_accvgpr_read_b32 v22, a138
v_accvgpr_read_b32 v23, a139
v_cvt_pk_bf16_f32 v138, v20, v21
v_cvt_pk_bf16_f32 v139, v22, v23
s_add_u32 s29, s29, s93
buffer_store_dwordx4 v[136:139], v13, s[8:11], s29 offen sc1
v_accvgpr_read_b32 v24, a108
v_accvgpr_read_b32 v25, a109
v_accvgpr_read_b32 v26, a110
v_accvgpr_read_b32 v27, a111
v_cvt_pk_bf16_f32 v140, v24, v25
v_cvt_pk_bf16_f32 v141, v26, v27
v_accvgpr_read_b32 v24, a140
v_accvgpr_read_b32 v25, a141
v_accvgpr_read_b32 v26, a142
v_accvgpr_read_b32 v27, a143
v_cvt_pk_bf16_f32 v142, v24, v25
v_cvt_pk_bf16_f32 v143, v26, v27
s_add_u32 s29, s29, s44
buffer_store_dwordx4 v[140:143], v13, s[8:11], s29 offen sc1
v_accvgpr_read_b32 v20, a112
v_accvgpr_read_b32 v21, a113
v_accvgpr_read_b32 v22, a114
v_accvgpr_read_b32 v23, a115
v_cvt_pk_bf16_f32 v144, v20, v21
v_cvt_pk_bf16_f32 v145, v22, v23
v_accvgpr_read_b32 v20, a144
v_accvgpr_read_b32 v21, a145
v_accvgpr_read_b32 v22, a146
v_accvgpr_read_b32 v23, a147
v_cvt_pk_bf16_f32 v146, v20, v21
v_cvt_pk_bf16_f32 v147, v22, v23
s_add_u32 s29, s29, s93
buffer_store_dwordx4 v[144:147], v13, s[8:11], s29 offen sc1
v_accvgpr_read_b32 v24, a116
v_accvgpr_read_b32 v25, a117
v_accvgpr_read_b32 v26, a118
v_accvgpr_read_b32 v27, a119
v_cvt_pk_bf16_f32 v148, v24, v25
v_cvt_pk_bf16_f32 v149, v26, v27
v_accvgpr_read_b32 v24, a148
v_accvgpr_read_b32 v25, a149
v_accvgpr_read_b32 v26, a150
v_accvgpr_read_b32 v27, a151
v_cvt_pk_bf16_f32 v150, v24, v25
v_cvt_pk_bf16_f32 v151, v26, v27
s_add_u32 s29, s29, s44
buffer_store_dwordx4 v[148:151], v13, s[8:11], s29 offen sc1
v_accvgpr_read_b32 v20, a120
v_accvgpr_read_b32 v21, a121
v_accvgpr_read_b32 v22, a122
v_accvgpr_read_b32 v23, a123
v_cvt_pk_bf16_f32 v152, v20, v21
v_cvt_pk_bf16_f32 v153, v22, v23
v_accvgpr_read_b32 v20, a152
v_accvgpr_read_b32 v21, a153
v_accvgpr_read_b32 v22, a154
v_accvgpr_read_b32 v23, a155
v_cvt_pk_bf16_f32 v154, v20, v21
v_cvt_pk_bf16_f32 v155, v22, v23
s_add_u32 s29, s29, s93
buffer_store_dwordx4 v[152:155], v13, s[8:11], s29 offen sc1
v_accvgpr_read_b32 v24, a124
v_accvgpr_read_b32 v25, a125
v_accvgpr_read_b32 v26, a126
v_accvgpr_read_b32 v27, a127
v_cvt_pk_bf16_f32 v156, v24, v25
v_cvt_pk_bf16_f32 v157, v26, v27
v_accvgpr_read_b32 v24, a156
v_accvgpr_read_b32 v25, a157
v_accvgpr_read_b32 v26, a158
v_accvgpr_read_b32 v27, a159
v_cvt_pk_bf16_f32 v158, v24, v25
v_cvt_pk_bf16_f32 v159, v26, v27
s_add_u32 s29, s29, s44
buffer_store_dwordx4 v[156:159], v13, s[8:11], s29 offen sc1
v_mov_b32 v20, 128
s_mov_b32 s28, 0
L_poll_10:
buffer_load_dword v21, v20, s[56:59], 0 offen sc1
s_add_u32 s28, s28, 1
s_cmp_gt_u32 s28, 200000
s_cbranch_scc1 L_end
s_waitcnt vmcnt(0)
v_cmp_ne_u32 vcc, 8, v21
s_cbranch_vccz L_pd_11
s_sleep 1
s_branch L_poll_10
L_pd_11:
s_andn2_b32 s24, s91, s17
s_cbranch_scc0 L_g_h2
s_barrier
s_add_u32 s60, s63, 32
v_mov_b32 v16, 0
v_mov_b32 v17, 1
s_cmp_eq_u32 s17, 0
s_cselect_b32 s29, s60, 536870912
s_mov_b64 exec, 1
buffer_store_dword v17, v16, s[8:11], s29 offen sc1
s_mov_b64 exec, -1
L_g_h2:
s_waitcnt vmcnt(0) lgkmcnt(0)
s_barrier
v_mov_b32 v16, 0
v_mov_b32 v17, 1
s_cmp_eq_u32 s17, 0
s_cselect_b32 s29, s63, 536870912
s_mov_b64 exec, 1
buffer_store_dword v17, v16, s[8:11], s29 offen sc1
s_mov_b64 exec, -1
s_mov_b32 s62, 536870912
s_mov_b32 s63, 536870912
s_cmp_lt_u32 s35, s45
s_cbranch_scc1 L_g_go
s_cmp_eq_u32 s3, 1
s_cbranch_scc1 L_part
s_branch L_bdie
L_att:
s_mov_b32 s96, s62
s_mov_b32 s60, s63
s_mov_b32 s42, s89
s_bfe_u32 s41, s88, 0x30008
s_sub_u32 s63, 7, s41
s_mov_b32 s40, 0x3e0293ee
s_mov_b32 s50, 0xf149f2ca
s_mov_b32 s51, 0x41a00000
s_waitcnt lgkmcnt(0)
v_and_b32 v6, 63, v0
v_lshlrev_b32 v6, 4, v6
v_and_b32 v16, 0x380, v6
s_and_b32 s24, s17, 1
s_lshl_b32 s24, s24, 13
s_lshr_b32 s25, s17, 1
s_lshl_b32 s25, s25, 19
s_add_u32 s24, s24, s25
v_add3_u32 v1, v6, v16, s24
v_and_b32 v16, 0x300, v6
s_and_b32 s24, s17, 1
s_lshl_b32 s24, s24, 8
s_lshr_b32 s25, s17, 1
s_lshl_b32 s25, s25, 18
s_add_u32 s24, s24, s25
v_add3_u32 v7, v6, v16, s24
v_and_b32 v5, 15, v0
s_lshl_b32 s24, s17, 4
v_add_u32 v5, s24, v5
v_bfe_u32 v16, v0, 5, 1
v_lshlrev_b32 v16, 4, v16
v_sub_u32 v5, v5, v16
v_bfe_u32 v16, v0, 4, 1
v_lshlrev_b32 v16, 2, v16
v_sub_u32 v5, v5, v16
v_mov_b32 v8, s50
v_mov_b32 v16, 0x3f803f80
v_accvgpr_write_b32 a240, v16
v_accvgpr_write_b32 a241, v16
v_accvgpr_write_b32 a242, v16
v_accvgpr_write_b32 a243, v16
v_cmp_le_i32 s[64:65], 0, v5
v_cmp_le_i32 s[66:67], 1, v5
v_cmp_le_i32 s[68:69], 2, v5
v_cmp_le_i32 s[70:71], 3, v5
v_cmp_le_i32 s[72:73], 8, v5
v_cmp_le_i32 s[74:75], 9, v5
v_cmp_le_i32 s[76:77], 10, v5
v_cmp_le_i32 s[78:79], 11, v5
v_cmp_le_i32 s[80:81], 32, v5
v_cmp_le_i32 s[82:83], 33, v5
v_cmp_le_i32 s[84:85], 34, v5
v_cmp_le_i32 s[86:87], 35, v5
v_cmp_le_i32 s[88:89], 40, v5
v_cmp_le_i32 s[90:91], 41, v5
v_cmp_le_i32 s[92:93], 42, v5
v_cmp_le_i32 s[94:95], 43, v5
s_lshl_b32 s47, s17, 13
s_mov_b32 s48, 0
s_cmp_eq_u32 s17, 0
s_cselect_b32 s60, s60, 536870912
v_and_b32 v20, 3, v0
v_lshlrev_b32 v20, 2, v20
s_lshl_b32 s25, s42, 7
s_add_u32 s25, s25, 111165440
s_mov_b32 s28, 0
L_poll_12:
buffer_load_dword v21, v20, s[8:11], s25 offen sc1
s_add_u32 s28, s28, 1
s_cmp_gt_u32 s28, 200000
s_cbranch_scc1 L_end
s_waitcnt vmcnt(0)
v_cmp_ne_u32 vcc, 1, v21
s_cbranch_vccz L_pd_13
s_sleep 1
s_branch L_poll_12
L_pd_13:
s_waitcnt lgkmcnt(0)
s_barrier
s_lshl_b32 s46, s42, 14
s_add_u32 s46, s46, 0
s_cmp_lt_u32 s63, 8
s_cselect_b32 s46, s46, 536870912
s_add_u32 s24, s46, 4096
s_add_u32 m0, s47, 0
s_nop 0
buffer_load_dwordx4 v1, s[8:11], s46 offen sc1 lds
buffer_load_dwordx4 v1, s[8:11], s46 offen offset:2048 sc1 lds
s_add_u32 m0, s47, 896
s_nop 0
buffer_load_dwordx4 v1, s[8:11], s46 offen offset:128 sc1 lds
buffer_load_dwordx4 v1, s[8:11], s46 offen offset:2176 sc1 lds
s_add_u32 m0, s47, 4096
s_nop 0
buffer_load_dwordx4 v1, s[8:11], s24 offen sc1 lds
buffer_load_dwordx4 v1, s[8:11], s24 offen offset:2048 sc1 lds
s_add_u32 m0, s47, 4992
s_nop 0
buffer_load_dwordx4 v1, s[8:11], s24 offen offset:128 sc1 lds
buffer_load_dwordx4 v1, s[8:11], s24 offen offset:2176 sc1 lds
s_add_u32 s46, s46, 1048576
s_add_u32 s47, s47, 32768
s_and_b32 s47, s47, 131071
s_add_u32 s24, s46, 4096
s_add_u32 m0, s47, 0
s_nop 0
buffer_load_dwordx4 v1, s[8:11], s46 offen sc1 lds
buffer_load_dwordx4 v1, s[8:11], s46 offen offset:2048 sc1 lds
s_add_u32 m0, s47, 896
s_nop 0
buffer_load_dwordx4 v1, s[8:11], s46 offen offset:128 sc1 lds
buffer_load_dwordx4 v1, s[8:11], s46 offen offset:2176 sc1 lds
s_add_u32 m0, s47, 4096
s_nop 0
buffer_load_dwordx4 v1, s[8:11], s24 offen sc1 lds
buffer_load_dwordx4 v1, s[8:11], s24 offen offset:2048 sc1 lds
s_add_u32 m0, s47, 4992
s_nop 0
buffer_load_dwordx4 v1, s[8:11], s24 offen offset:128 sc1 lds
buffer_load_dwordx4 v1, s[8:11], s24 offen offset:2176 sc1 lds
s_add_u32 s46, s46, 1048576
s_add_u32 s47, s47, 32768
s_and_b32 s47, s47, 131071
s_add_u32 s24, s46, 4096
s_add_u32 m0, s47, 0
s_nop 0
buffer_load_dwordx4 v1, s[8:11], s46 offen sc1 lds
buffer_load_dwordx4 v1, s[8:11], s46 offen offset:2048 sc1 lds
s_add_u32 m0, s47, 896
s_nop 0
buffer_load_dwordx4 v1, s[8:11], s46 offen offset:128 sc1 lds
buffer_load_dwordx4 v1, s[8:11], s46 offen offset:2176 sc1 lds
s_add_u32 m0, s47, 4096
s_nop 0
buffer_load_dwordx4 v1, s[8:11], s24 offen sc1 lds
buffer_load_dwordx4 v1, s[8:11], s24 offen offset:2048 sc1 lds
s_add_u32 m0, s47, 4992
s_nop 0
buffer_load_dwordx4 v1, s[8:11], s24 offen offset:128 sc1 lds
buffer_load_dwordx4 v1, s[8:11], s24 offen offset:2176 sc1 lds
s_add_u32 s46, s46, 1048576
s_add_u32 s47, s47, 32768
s_and_b32 s47, s47, 131071
v_and_b32 v13, 0x380, v6
v_add_u32 v13, v13, v6
s_lshr_b32 s24, s17, 1
s_xor_b32 s24, s24, s42
s_bitcmp1_b32 s24, 0
s_cbranch_scc1 L_at_qg
s_and_b32 s24, s17, 1
s_lshl_b32 s24, s24, 15
s_add_u32 s24, s24, 98304
v_add_u32 v13, s24, v13
v_pk_mul_f32 v[20:21], v[160:161], s[40:41] op_sel_hi:[1,0]
v_pk_mul_f32 v[22:23], v[162:163], s[40:41] op_sel_hi:[1,0]
v_cvt_pk_bf16_f32 v32, v20, v21
v_cvt_pk_bf16_f32 v33, v22, v23
v_pk_mul_f32 v[20:21], v[192:193], s[40:41] op_sel_hi:[1,0]
v_pk_mul_f32 v[22:23], v[194:195], s[40:41] op_sel_hi:[1,0]
v_cvt_pk_bf16_f32 v34, v20, v21
v_cvt_pk_bf16_f32 v35, v22, v23
ds_write_b128 v13, v[32:35]
v_pk_mul_f32 v[24:25], v[164:165], s[40:41] op_sel_hi:[1,0]
v_pk_mul_f32 v[26:27], v[166:167], s[40:41] op_sel_hi:[1,0]
v_cvt_pk_bf16_f32 v36, v24, v25
v_cvt_pk_bf16_f32 v37, v26, v27
v_pk_mul_f32 v[24:25], v[196:197], s[40:41] op_sel_hi:[1,0]
v_pk_mul_f32 v[26:27], v[198:199], s[40:41] op_sel_hi:[1,0]
v_cvt_pk_bf16_f32 v38, v24, v25
v_cvt_pk_bf16_f32 v39, v26, v27
ds_write_b128 v13, v[36:39] offset:128
v_pk_mul_f32 v[20:21], v[168:169], s[40:41] op_sel_hi:[1,0]
v_pk_mul_f32 v[22:23], v[170:171], s[40:41] op_sel_hi:[1,0]
v_cvt_pk_bf16_f32 v40, v20, v21
v_cvt_pk_bf16_f32 v41, v22, v23
v_pk_mul_f32 v[20:21], v[200:201], s[40:41] op_sel_hi:[1,0]
v_pk_mul_f32 v[22:23], v[202:203], s[40:41] op_sel_hi:[1,0]
v_cvt_pk_bf16_f32 v42, v20, v21
v_cvt_pk_bf16_f32 v43, v22, v23
ds_write_b128 v13, v[40:43] offset:8192
v_pk_mul_f32 v[24:25], v[172:173], s[40:41] op_sel_hi:[1,0]
v_pk_mul_f32 v[26:27], v[174:175], s[40:41] op_sel_hi:[1,0]
v_cvt_pk_bf16_f32 v44, v24, v25
v_cvt_pk_bf16_f32 v45, v26, v27
v_pk_mul_f32 v[24:25], v[204:205], s[40:41] op_sel_hi:[1,0]
v_pk_mul_f32 v[26:27], v[206:207], s[40:41] op_sel_hi:[1,0]
v_cvt_pk_bf16_f32 v46, v24, v25
v_cvt_pk_bf16_f32 v47, v26, v27
ds_write_b128 v13, v[44:47] offset:8320
v_pk_mul_f32 v[20:21], v[176:177], s[40:41] op_sel_hi:[1,0]
v_pk_mul_f32 v[22:23], v[178:179], s[40:41] op_sel_hi:[1,0]
v_cvt_pk_bf16_f32 v48, v20, v21
v_cvt_pk_bf16_f32 v49, v22, v23
v_pk_mul_f32 v[20:21], v[208:209], s[40:41] op_sel_hi:[1,0]
v_pk_mul_f32 v[22:23], v[210:211], s[40:41] op_sel_hi:[1,0]
v_cvt_pk_bf16_f32 v50, v20, v21
v_cvt_pk_bf16_f32 v51, v22, v23
ds_write_b128 v13, v[48:51] offset:16384
v_pk_mul_f32 v[24:25], v[180:181], s[40:41] op_sel_hi:[1,0]
v_pk_mul_f32 v[26:27], v[182:183], s[40:41] op_sel_hi:[1,0]
v_cvt_pk_bf16_f32 v52, v24, v25
v_cvt_pk_bf16_f32 v53, v26, v27
v_pk_mul_f32 v[24:25], v[212:213], s[40:41] op_sel_hi:[1,0]
v_pk_mul_f32 v[26:27], v[214:215], s[40:41] op_sel_hi:[1,0]
v_cvt_pk_bf16_f32 v54, v24, v25
v_cvt_pk_bf16_f32 v55, v26, v27
ds_write_b128 v13, v[52:55] offset:16512
v_pk_mul_f32 v[20:21], v[184:185], s[40:41] op_sel_hi:[1,0]
v_pk_mul_f32 v[22:23], v[186:187], s[40:41] op_sel_hi:[1,0]
v_cvt_pk_bf16_f32 v56, v20, v21
v_cvt_pk_bf16_f32 v57, v22, v23
v_pk_mul_f32 v[20:21], v[216:217], s[40:41] op_sel_hi:[1,0]
v_pk_mul_f32 v[22:23], v[218:219], s[40:41] op_sel_hi:[1,0]
v_cvt_pk_bf16_f32 v58, v20, v21
v_cvt_pk_bf16_f32 v59, v22, v23
ds_write_b128 v13, v[56:59] offset:24576
v_pk_mul_f32 v[24:25], v[188:189], s[40:41] op_sel_hi:[1,0]
v_pk_mul_f32 v[26:27], v[190:191], s[40:41] op_sel_hi:[1,0]
v_cvt_pk_bf16_f32 v60, v24, v25
v_cvt_pk_bf16_f32 v61, v26, v27
v_pk_mul_f32 v[24:25], v[220:221], s[40:41] op_sel_hi:[1,0]
v_pk_mul_f32 v[26:27], v[222:223], s[40:41] op_sel_hi:[1,0]
v_cvt_pk_bf16_f32 v62, v24, v25
v_cvt_pk_bf16_f32 v63, v26, v27
ds_write_b128 v13, v[60:63] offset:24704
v_pk_mul_f32 v[20:21], v[224:225], s[40:41] op_sel_hi:[1,0]
v_pk_mul_f32 v[22:23], v[226:227], s[40:41] op_sel_hi:[1,0]
v_cvt_pk_bf16_f32 v64, v20, v21
v_cvt_pk_bf16_f32 v65, v22, v23
v_accvgpr_read_b32 v20, a0
v_accvgpr_read_b32 v21, a1
v_accvgpr_read_b32 v22, a2
v_accvgpr_read_b32 v23, a3
v_pk_mul_f32 v[20:21], v[20:21], s[40:41] op_sel_hi:[1,0]
v_pk_mul_f32 v[22:23], v[22:23], s[40:41] op_sel_hi:[1,0]
v_cvt_pk_bf16_f32 v66, v20, v21
v_cvt_pk_bf16_f32 v67, v22, v23
ds_write_b128 v13, v[64:67] offset:2048
v_pk_mul_f32 v[24:25], v[228:229], s[40:41] op_sel_hi:[1,0]
v_pk_mul_f32 v[26:27], v[230:231], s[40:41] op_sel_hi:[1,0]
v_cvt_pk_bf16_f32 v68, v24, v25
v_cvt_pk_bf16_f32 v69, v26, v27
v_accvgpr_read_b32 v24, a4
v_accvgpr_read_b32 v25, a5
v_accvgpr_read_b32 v26, a6
v_accvgpr_read_b32 v27, a7
v_pk_mul_f32 v[24:25], v[24:25], s[40:41] op_sel_hi:[1,0]
v_pk_mul_f32 v[26:27], v[26:27], s[40:41] op_sel_hi:[1,0]
v_cvt_pk_bf16_f32 v70, v24, v25
v_cvt_pk_bf16_f32 v71, v26, v27
ds_write_b128 v13, v[68:71] offset:2176
v_pk_mul_f32 v[20:21], v[232:233], s[40:41] op_sel_hi:[1,0]
v_pk_mul_f32 v[22:23], v[234:235], s[40:41] op_sel_hi:[1,0]
v_cvt_pk_bf16_f32 v72, v20, v21
v_cvt_pk_bf16_f32 v73, v22, v23
v_accvgpr_read_b32 v20, a8
v_accvgpr_read_b32 v21, a9
v_accvgpr_read_b32 v22, a10
v_accvgpr_read_b32 v23, a11
v_pk_mul_f32 v[20:21], v[20:21], s[40:41] op_sel_hi:[1,0]
v_pk_mul_f32 v[22:23], v[22:23], s[40:41] op_sel_hi:[1,0]
v_cvt_pk_bf16_f32 v74, v20, v21
v_cvt_pk_bf16_f32 v75, v22, v23
ds_write_b128 v13, v[72:75] offset:10240
v_pk_mul_f32 v[24:25], v[236:237], s[40:41] op_sel_hi:[1,0]
v_pk_mul_f32 v[26:27], v[238:239], s[40:41] op_sel_hi:[1,0]
v_cvt_pk_bf16_f32 v76, v24, v25
v_cvt_pk_bf16_f32 v77, v26, v27
v_accvgpr_read_b32 v24, a12
v_accvgpr_read_b32 v25, a13
v_accvgpr_read_b32 v26, a14
v_accvgpr_read_b32 v27, a15
v_pk_mul_f32 v[24:25], v[24:25], s[40:41] op_sel_hi:[1,0]
v_pk_mul_f32 v[26:27], v[26:27], s[40:41] op_sel_hi:[1,0]
v_cvt_pk_bf16_f32 v78, v24, v25
v_cvt_pk_bf16_f32 v79, v26, v27
ds_write_b128 v13, v[76:79] offset:10368
v_pk_mul_f32 v[20:21], v[240:241], s[40:41] op_sel_hi:[1,0]
v_pk_mul_f32 v[22:23], v[242:243], s[40:41] op_sel_hi:[1,0]
v_cvt_pk_bf16_f32 v80, v20, v21
v_cvt_pk_bf16_f32 v81, v22, v23
v_accvgpr_read_b32 v20, a16
v_accvgpr_read_b32 v21, a17
v_accvgpr_read_b32 v22, a18
v_accvgpr_read_b32 v23, a19
v_pk_mul_f32 v[20:21], v[20:21], s[40:41] op_sel_hi:[1,0]
v_pk_mul_f32 v[22:23], v[22:23], s[40:41] op_sel_hi:[1,0]
v_cvt_pk_bf16_f32 v82, v20, v21
v_cvt_pk_bf16_f32 v83, v22, v23
ds_write_b128 v13, v[80:83] offset:18432
v_pk_mul_f32 v[24:25], v[244:245], s[40:41] op_sel_hi:[1,0]
v_pk_mul_f32 v[26:27], v[246:247], s[40:41] op_sel_hi:[1,0]
v_cvt_pk_bf16_f32 v84, v24, v25
v_cvt_pk_bf16_f32 v85, v26, v27
v_accvgpr_read_b32 v24, a20
v_accvgpr_read_b32 v25, a21
v_accvgpr_read_b32 v26, a22
v_accvgpr_read_b32 v27, a23
v_pk_mul_f32 v[24:25], v[24:25], s[40:41] op_sel_hi:[1,0]
v_pk_mul_f32 v[26:27], v[26:27], s[40:41] op_sel_hi:[1,0]
v_cvt_pk_bf16_f32 v86, v24, v25
v_cvt_pk_bf16_f32 v87, v26, v27
ds_write_b128 v13, v[84:87] offset:18560
v_pk_mul_f32 v[20:21], v[248:249], s[40:41] op_sel_hi:[1,0]
v_pk_mul_f32 v[22:23], v[250:251], s[40:41] op_sel_hi:[1,0]
v_cvt_pk_bf16_f32 v88, v20, v21
v_cvt_pk_bf16_f32 v89, v22, v23
v_accvgpr_read_b32 v20, a24
v_accvgpr_read_b32 v21, a25
v_accvgpr_read_b32 v22, a26
v_accvgpr_read_b32 v23, a27
v_pk_mul_f32 v[20:21], v[20:21], s[40:41] op_sel_hi:[1,0]
v_pk_mul_f32 v[22:23], v[22:23], s[40:41] op_sel_hi:[1,0]
v_cvt_pk_bf16_f32 v90, v20, v21
v_cvt_pk_bf16_f32 v91, v22, v23
ds_write_b128 v13, v[88:91] offset:26624
v_pk_mul_f32 v[24:25], v[252:253], s[40:41] op_sel_hi:[1,0]
v_pk_mul_f32 v[26:27], v[254:255], s[40:41] op_sel_hi:[1,0]
v_cvt_pk_bf16_f32 v92, v24, v25
v_cvt_pk_bf16_f32 v93, v26, v27
v_accvgpr_read_b32 v24, a28
v_accvgpr_read_b32 v25, a29
v_accvgpr_read_b32 v26, a30
v_accvgpr_read_b32 v27, a31
v_pk_mul_f32 v[24:25], v[24:25], s[40:41] op_sel_hi:[1,0]
v_pk_mul_f32 v[26:27], v[26:27], s[40:41] op_sel_hi:[1,0]
v_cvt_pk_bf16_f32 v94, v24, v25
v_cvt_pk_bf16_f32 v95, v26, v27
ds_write_b128 v13, v[92:95] offset:26752
v_accvgpr_read_b32 v20, a32
v_accvgpr_read_b32 v21, a33
v_accvgpr_read_b32 v22, a34
v_accvgpr_read_b32 v23, a35
v_pk_mul_f32 v[20:21], v[20:21], s[40:41] op_sel_hi:[1,0]
v_pk_mul_f32 v[22:23], v[22:23], s[40:41] op_sel_hi:[1,0]
v_cvt_pk_bf16_f32 v96, v20, v21
v_cvt_pk_bf16_f32 v97, v22, v23
v_accvgpr_read_b32 v20, a64
v_accvgpr_read_b32 v21, a65
v_accvgpr_read_b32 v22, a66
v_accvgpr_read_b32 v23, a67
v_pk_mul_f32 v[20:21], v[20:21], s[40:41] op_sel_hi:[1,0]
v_pk_mul_f32 v[22:23], v[22:23], s[40:41] op_sel_hi:[1,0]
v_cvt_pk_bf16_f32 v98, v20, v21
v_cvt_pk_bf16_f32 v99, v22, v23
ds_write_b128 v13, v[96:99] offset:4096
v_accvgpr_read_b32 v24, a36
v_accvgpr_read_b32 v25, a37
v_accvgpr_read_b32 v26, a38
v_accvgpr_read_b32 v27, a39
v_pk_mul_f32 v[24:25], v[24:25], s[40:41] op_sel_hi:[1,0]
v_pk_mul_f32 v[26:27], v[26:27], s[40:41] op_sel_hi:[1,0]
v_cvt_pk_bf16_f32 v100, v24, v25
v_cvt_pk_bf16_f32 v101, v26, v27
v_accvgpr_read_b32 v24, a68
v_accvgpr_read_b32 v25, a69
v_accvgpr_read_b32 v26, a70
v_accvgpr_read_b32 v27, a71
v_pk_mul_f32 v[24:25], v[24:25], s[40:41] op_sel_hi:[1,0]
v_pk_mul_f32 v[26:27], v[26:27], s[40:41] op_sel_hi:[1,0]
v_cvt_pk_bf16_f32 v102, v24, v25
v_cvt_pk_bf16_f32 v103, v26, v27
ds_write_b128 v13, v[100:103] offset:4224
v_accvgpr_read_b32 v20, a40
v_accvgpr_read_b32 v21, a41
v_accvgpr_read_b32 v22, a42
v_accvgpr_read_b32 v23, a43
v_pk_mul_f32 v[20:21], v[20:21], s[40:41] op_sel_hi:[1,0]
v_pk_mul_f32 v[22:23], v[22:23], s[40:41] op_sel_hi:[1,0]
v_cvt_pk_bf16_f32 v104, v20, v21
v_cvt_pk_bf16_f32 v105, v22, v23
v_accvgpr_read_b32 v20, a72
v_accvgpr_read_b32 v21, a73
v_accvgpr_read_b32 v22, a74
v_accvgpr_read_b32 v23, a75
v_pk_mul_f32 v[20:21], v[20:21], s[40:41] op_sel_hi:[1,0]
v_pk_mul_f32 v[22:23], v[22:23], s[40:41] op_sel_hi:[1,0]
v_cvt_pk_bf16_f32 v106, v20, v21
v_cvt_pk_bf16_f32 v107, v22, v23
ds_write_b128 v13, v[104:107] offset:12288
v_accvgpr_read_b32 v24, a44
v_accvgpr_read_b32 v25, a45
v_accvgpr_read_b32 v26, a46
v_accvgpr_read_b32 v27, a47
v_pk_mul_f32 v[24:25], v[24:25], s[40:41] op_sel_hi:[1,0]
v_pk_mul_f32 v[26:27], v[26:27], s[40:41] op_sel_hi:[1,0]
v_cvt_pk_bf16_f32 v108, v24, v25
v_cvt_pk_bf16_f32 v109, v26, v27
v_accvgpr_read_b32 v24, a76
v_accvgpr_read_b32 v25, a77
v_accvgpr_read_b32 v26, a78
v_accvgpr_read_b32 v27, a79
v_pk_mul_f32 v[24:25], v[24:25], s[40:41] op_sel_hi:[1,0]
v_pk_mul_f32 v[26:27], v[26:27], s[40:41] op_sel_hi:[1,0]
v_cvt_pk_bf16_f32 v110, v24, v25
v_cvt_pk_bf16_f32 v111, v26, v27
ds_write_b128 v13, v[108:111] offset:12416
v_accvgpr_read_b32 v20, a48
v_accvgpr_read_b32 v21, a49
v_accvgpr_read_b32 v22, a50
v_accvgpr_read_b32 v23, a51
v_pk_mul_f32 v[20:21], v[20:21], s[40:41] op_sel_hi:[1,0]
v_pk_mul_f32 v[22:23], v[22:23], s[40:41] op_sel_hi:[1,0]
v_cvt_pk_bf16_f32 v112, v20, v21
v_cvt_pk_bf16_f32 v113, v22, v23
v_accvgpr_read_b32 v20, a80
v_accvgpr_read_b32 v21, a81
v_accvgpr_read_b32 v22, a82
v_accvgpr_read_b32 v23, a83
v_pk_mul_f32 v[20:21], v[20:21], s[40:41] op_sel_hi:[1,0]
v_pk_mul_f32 v[22:23], v[22:23], s[40:41] op_sel_hi:[1,0]
v_cvt_pk_bf16_f32 v114, v20, v21
v_cvt_pk_bf16_f32 v115, v22, v23
ds_write_b128 v13, v[112:115] offset:20480
v_accvgpr_read_b32 v24, a52
v_accvgpr_read_b32 v25, a53
v_accvgpr_read_b32 v26, a54
v_accvgpr_read_b32 v27, a55
v_pk_mul_f32 v[24:25], v[24:25], s[40:41] op_sel_hi:[1,0]
v_pk_mul_f32 v[26:27], v[26:27], s[40:41] op_sel_hi:[1,0]
v_cvt_pk_bf16_f32 v116, v24, v25
v_cvt_pk_bf16_f32 v117, v26, v27
v_accvgpr_read_b32 v24, a84
v_accvgpr_read_b32 v25, a85
v_accvgpr_read_b32 v26, a86
v_accvgpr_read_b32 v27, a87
v_pk_mul_f32 v[24:25], v[24:25], s[40:41] op_sel_hi:[1,0]
v_pk_mul_f32 v[26:27], v[26:27], s[40:41] op_sel_hi:[1,0]
v_cvt_pk_bf16_f32 v118, v24, v25
v_cvt_pk_bf16_f32 v119, v26, v27
ds_write_b128 v13, v[116:119] offset:20608
v_accvgpr_read_b32 v20, a56
v_accvgpr_read_b32 v21, a57
v_accvgpr_read_b32 v22, a58
v_accvgpr_read_b32 v23, a59
v_pk_mul_f32 v[20:21], v[20:21], s[40:41] op_sel_hi:[1,0]
v_pk_mul_f32 v[22:23], v[22:23], s[40:41] op_sel_hi:[1,0]
v_cvt_pk_bf16_f32 v120, v20, v21
v_cvt_pk_bf16_f32 v121, v22, v23
v_accvgpr_read_b32 v20, a88
v_accvgpr_read_b32 v21, a89
v_accvgpr_read_b32 v22, a90
v_accvgpr_read_b32 v23, a91
v_pk_mul_f32 v[20:21], v[20:21], s[40:41] op_sel_hi:[1,0]
v_pk_mul_f32 v[22:23], v[22:23], s[40:41] op_sel_hi:[1,0]
v_cvt_pk_bf16_f32 v122, v20, v21
v_cvt_pk_bf16_f32 v123, v22, v23
ds_write_b128 v13, v[120:123] offset:28672
v_accvgpr_read_b32 v24, a60
v_accvgpr_read_b32 v25, a61
v_accvgpr_read_b32 v26, a62
v_accvgpr_read_b32 v27, a63
v_pk_mul_f32 v[24:25], v[24:25], s[40:41] op_sel_hi:[1,0]
v_pk_mul_f32 v[26:27], v[26:27], s[40:41] op_sel_hi:[1,0]
v_cvt_pk_bf16_f32 v124, v24, v25
v_cvt_pk_bf16_f32 v125, v26, v27
v_accvgpr_read_b32 v24, a92
v_accvgpr_read_b32 v25, a93
v_accvgpr_read_b32 v26, a94
v_accvgpr_read_b32 v27, a95
v_pk_mul_f32 v[24:25], v[24:25], s[40:41] op_sel_hi:[1,0]
v_pk_mul_f32 v[26:27], v[26:27], s[40:41] op_sel_hi:[1,0]
v_cvt_pk_bf16_f32 v126, v24, v25
v_cvt_pk_bf16_f32 v127, v26, v27
ds_write_b128 v13, v[124:127] offset:28800
v_accvgpr_read_b32 v20, a96
v_accvgpr_read_b32 v21, a97
v_accvgpr_read_b32 v22, a98
v_accvgpr_read_b32 v23, a99
v_pk_mul_f32 v[20:21], v[20:21], s[40:41] op_sel_hi:[1,0]
v_pk_mul_f32 v[22:23], v[22:23], s[40:41] op_sel_hi:[1,0]
v_cvt_pk_bf16_f32 v128, v20, v21
v_cvt_pk_bf16_f32 v129, v22, v23
v_accvgpr_read_b32 v20, a128
v_accvgpr_read_b32 v21, a129
v_accvgpr_read_b32 v22, a130
v_accvgpr_read_b32 v23, a131
v_pk_mul_f32 v[20:21], v[20:21], s[40:41] op_sel_hi:[1,0]
v_pk_mul_f32 v[22:23], v[22:23], s[40:41] op_sel_hi:[1,0]
v_cvt_pk_bf16_f32 v130, v20, v21
v_cvt_pk_bf16_f32 v131, v22, v23
ds_write_b128 v13, v[128:131] offset:6144
v_accvgpr_read_b32 v24, a100
v_accvgpr_read_b32 v25, a101
v_accvgpr_read_b32 v26, a102
v_accvgpr_read_b32 v27, a103
v_pk_mul_f32 v[24:25], v[24:25], s[40:41] op_sel_hi:[1,0]
v_pk_mul_f32 v[26:27], v[26:27], s[40:41] op_sel_hi:[1,0]
v_cvt_pk_bf16_f32 v132, v24, v25
v_cvt_pk_bf16_f32 v133, v26, v27
v_accvgpr_read_b32 v24, a132
v_accvgpr_read_b32 v25, a133
v_accvgpr_read_b32 v26, a134
v_accvgpr_read_b32 v27, a135
v_pk_mul_f32 v[24:25], v[24:25], s[40:41] op_sel_hi:[1,0]
v_pk_mul_f32 v[26:27], v[26:27], s[40:41] op_sel_hi:[1,0]
v_cvt_pk_bf16_f32 v134, v24, v25
v_cvt_pk_bf16_f32 v135, v26, v27
ds_write_b128 v13, v[132:135] offset:6272
v_accvgpr_read_b32 v20, a104
v_accvgpr_read_b32 v21, a105
v_accvgpr_read_b32 v22, a106
v_accvgpr_read_b32 v23, a107
v_pk_mul_f32 v[20:21], v[20:21], s[40:41] op_sel_hi:[1,0]
v_pk_mul_f32 v[22:23], v[22:23], s[40:41] op_sel_hi:[1,0]
v_cvt_pk_bf16_f32 v136, v20, v21
v_cvt_pk_bf16_f32 v137, v22, v23
v_accvgpr_read_b32 v20, a136
v_accvgpr_read_b32 v21, a137
v_accvgpr_read_b32 v22, a138
v_accvgpr_read_b32 v23, a139
v_pk_mul_f32 v[20:21], v[20:21], s[40:41] op_sel_hi:[1,0]
v_pk_mul_f32 v[22:23], v[22:23], s[40:41] op_sel_hi:[1,0]
v_cvt_pk_bf16_f32 v138, v20, v21
v_cvt_pk_bf16_f32 v139, v22, v23
ds_write_b128 v13, v[136:139] offset:14336
v_accvgpr_read_b32 v24, a108
v_accvgpr_read_b32 v25, a109
v_accvgpr_read_b32 v26, a110
v_accvgpr_read_b32 v27, a111
v_pk_mul_f32 v[24:25], v[24:25], s[40:41] op_sel_hi:[1,0]
v_pk_mul_f32 v[26:27], v[26:27], s[40:41] op_sel_hi:[1,0]
v_cvt_pk_bf16_f32 v140, v24, v25
v_cvt_pk_bf16_f32 v141, v26, v27
v_accvgpr_read_b32 v24, a140
v_accvgpr_read_b32 v25, a141
v_accvgpr_read_b32 v26, a142
v_accvgpr_read_b32 v27, a143
v_pk_mul_f32 v[24:25], v[24:25], s[40:41] op_sel_hi:[1,0]
v_pk_mul_f32 v[26:27], v[26:27], s[40:41] op_sel_hi:[1,0]
v_cvt_pk_bf16_f32 v142, v24, v25
v_cvt_pk_bf16_f32 v143, v26, v27
ds_write_b128 v13, v[140:143] offset:14464
v_accvgpr_read_b32 v20, a112
v_accvgpr_read_b32 v21, a113
v_accvgpr_read_b32 v22, a114
v_accvgpr_read_b32 v23, a115
v_pk_mul_f32 v[20:21], v[20:21], s[40:41] op_sel_hi:[1,0]
v_pk_mul_f32 v[22:23], v[22:23], s[40:41] op_sel_hi:[1,0]
v_cvt_pk_bf16_f32 v144, v20, v21
v_cvt_pk_bf16_f32 v145, v22, v23
v_accvgpr_read_b32 v20, a144
v_accvgpr_read_b32 v21, a145
v_accvgpr_read_b32 v22, a146
v_accvgpr_read_b32 v23, a147
v_pk_mul_f32 v[20:21], v[20:21], s[40:41] op_sel_hi:[1,0]
v_pk_mul_f32 v[22:23], v[22:23], s[40:41] op_sel_hi:[1,0]
v_cvt_pk_bf16_f32 v146, v20, v21
v_cvt_pk_bf16_f32 v147, v22, v23
ds_write_b128 v13, v[144:147] offset:22528
v_accvgpr_read_b32 v24, a116
v_accvgpr_read_b32 v25, a117
v_accvgpr_read_b32 v26, a118
v_accvgpr_read_b32 v27, a119
v_pk_mul_f32 v[24:25], v[24:25], s[40:41] op_sel_hi:[1,0]
v_pk_mul_f32 v[26:27], v[26:27], s[40:41] op_sel_hi:[1,0]
v_cvt_pk_bf16_f32 v148, v24, v25
v_cvt_pk_bf16_f32 v149, v26, v27
v_accvgpr_read_b32 v24, a148
v_accvgpr_read_b32 v25, a149
v_accvgpr_read_b32 v26, a150
v_accvgpr_read_b32 v27, a151
v_pk_mul_f32 v[24:25], v[24:25], s[40:41] op_sel_hi:[1,0]
v_pk_mul_f32 v[26:27], v[26:27], s[40:41] op_sel_hi:[1,0]
v_cvt_pk_bf16_f32 v150, v24, v25
v_cvt_pk_bf16_f32 v151, v26, v27
ds_write_b128 v13, v[148:151] offset:22656
v_accvgpr_read_b32 v20, a120
v_accvgpr_read_b32 v21, a121
v_accvgpr_read_b32 v22, a122
v_accvgpr_read_b32 v23, a123
v_pk_mul_f32 v[20:21], v[20:21], s[40:41] op_sel_hi:[1,0]
v_pk_mul_f32 v[22:23], v[22:23], s[40:41] op_sel_hi:[1,0]
v_cvt_pk_bf16_f32 v152, v20, v21
v_cvt_pk_bf16_f32 v153, v22, v23
v_accvgpr_read_b32 v20, a152
v_accvgpr_read_b32 v21, a153
v_accvgpr_read_b32 v22, a154
v_accvgpr_read_b32 v23, a155
v_pk_mul_f32 v[20:21], v[20:21], s[40:41] op_sel_hi:[1,0]
v_pk_mul_f32 v[22:23], v[22:23], s[40:41] op_sel_hi:[1,0]
v_cvt_pk_bf16_f32 v154, v20, v21
v_cvt_pk_bf16_f32 v155, v22, v23
ds_write_b128 v13, v[152:155] offset:30720
v_accvgpr_read_b32 v24, a124
v_accvgpr_read_b32 v25, a125
v_accvgpr_read_b32 v26, a126
v_accvgpr_read_b32 v27, a127
v_pk_mul_f32 v[24:25], v[24:25], s[40:41] op_sel_hi:[1,0]
v_pk_mul_f32 v[26:27], v[26:27], s[40:41] op_sel_hi:[1,0]
v_cvt_pk_bf16_f32 v156, v24, v25
v_cvt_pk_bf16_f32 v157, v26, v27
v_accvgpr_read_b32 v24, a156
v_accvgpr_read_b32 v25, a157
v_accvgpr_read_b32 v26, a158
v_accvgpr_read_b32 v27, a159
v_pk_mul_f32 v[24:25], v[24:25], s[40:41] op_sel_hi:[1,0]
v_pk_mul_f32 v[26:27], v[26:27], s[40:41] op_sel_hi:[1,0]
v_cvt_pk_bf16_f32 v158, v24, v25
v_cvt_pk_bf16_f32 v159, v26, v27
ds_write_b128 v13, v[156:159] offset:30848
s_waitcnt vmcnt(16) lgkmcnt(0)
s_branch L_at_qx
L_at_qg:
v_pk_mul_f32 v[20:21], v[160:161], s[40:41] op_sel_hi:[1,0]
v_pk_mul_f32 v[22:23], v[162:163], s[40:41] op_sel_hi:[1,0]
v_cvt_pk_bf16_f32 v32, v20, v21
v_cvt_pk_bf16_f32 v33, v22, v23
v_pk_mul_f32 v[20:21], v[192:193], s[40:41] op_sel_hi:[1,0]
v_pk_mul_f32 v[22:23], v[194:195], s[40:41] op_sel_hi:[1,0]
v_cvt_pk_bf16_f32 v34, v20, v21
v_cvt_pk_bf16_f32 v35, v22, v23
s_add_u32 s24, s96, 0
buffer_store_dwordx4 v[32:35], v13, s[8:11], s24 offen sc1
v_pk_mul_f32 v[24:25], v[164:165], s[40:41] op_sel_hi:[1,0]
v_pk_mul_f32 v[26:27], v[166:167], s[40:41] op_sel_hi:[1,0]
v_cvt_pk_bf16_f32 v36, v24, v25
v_cvt_pk_bf16_f32 v37, v26, v27
v_pk_mul_f32 v[24:25], v[196:197], s[40:41] op_sel_hi:[1,0]
v_pk_mul_f32 v[26:27], v[198:199], s[40:41] op_sel_hi:[1,0]
v_cvt_pk_bf16_f32 v38, v24, v25
v_cvt_pk_bf16_f32 v39, v26, v27
buffer_store_dwordx4 v[36:39], v13, s[8:11], s24 offen offset:128 sc1
v_pk_mul_f32 v[20:21], v[168:169], s[40:41] op_sel_hi:[1,0]
v_pk_mul_f32 v[22:23], v[170:171], s[40:41] op_sel_hi:[1,0]
v_cvt_pk_bf16_f32 v40, v20, v21
v_cvt_pk_bf16_f32 v41, v22, v23
v_pk_mul_f32 v[20:21], v[200:201], s[40:41] op_sel_hi:[1,0]
v_pk_mul_f32 v[22:23], v[202:203], s[40:41] op_sel_hi:[1,0]
v_cvt_pk_bf16_f32 v42, v20, v21
v_cvt_pk_bf16_f32 v43, v22, v23
s_add_u32 s24, s96, 262144
buffer_store_dwordx4 v[40:43], v13, s[8:11], s24 offen sc1
v_pk_mul_f32 v[24:25], v[172:173], s[40:41] op_sel_hi:[1,0]
v_pk_mul_f32 v[26:27], v[174:175], s[40:41] op_sel_hi:[1,0]
v_cvt_pk_bf16_f32 v44, v24, v25
v_cvt_pk_bf16_f32 v45, v26, v27
v_pk_mul_f32 v[24:25], v[204:205], s[40:41] op_sel_hi:[1,0]
v_pk_mul_f32 v[26:27], v[206:207], s[40:41] op_sel_hi:[1,0]
v_cvt_pk_bf16_f32 v46, v24, v25
v_cvt_pk_bf16_f32 v47, v26, v27
buffer_store_dwordx4 v[44:47], v13, s[8:11], s24 offen offset:128 sc1
v_pk_mul_f32 v[20:21], v[176:177], s[40:41] op_sel_hi:[1,0]
v_pk_mul_f32 v[22:23], v[178:179], s[40:41] op_sel_hi:[1,0]
v_cvt_pk_bf16_f32 v48, v20, v21
v_cvt_pk_bf16_f32 v49, v22, v23
v_pk_mul_f32 v[20:21], v[208:209], s[40:41] op_sel_hi:[1,0]
v_pk_mul_f32 v[22:23], v[210:211], s[40:41] op_sel_hi:[1,0]
v_cvt_pk_bf16_f32 v50, v20, v21
v_cvt_pk_bf16_f32 v51, v22, v23
s_add_u32 s24, s96, 524288
buffer_store_dwordx4 v[48:51], v13, s[8:11], s24 offen sc1
v_pk_mul_f32 v[24:25], v[180:181], s[40:41] op_sel_hi:[1,0]
v_pk_mul_f32 v[26:27], v[182:183], s[40:41] op_sel_hi:[1,0]
v_cvt_pk_bf16_f32 v52, v24, v25
v_cvt_pk_bf16_f32 v53, v26, v27
v_pk_mul_f32 v[24:25], v[212:213], s[40:41] op_sel_hi:[1,0]
v_pk_mul_f32 v[26:27], v[214:215], s[40:41] op_sel_hi:[1,0]
v_cvt_pk_bf16_f32 v54, v24, v25
v_cvt_pk_bf16_f32 v55, v26, v27
buffer_store_dwordx4 v[52:55], v13, s[8:11], s24 offen offset:128 sc1
v_pk_mul_f32 v[20:21], v[184:185], s[40:41] op_sel_hi:[1,0]
v_pk_mul_f32 v[22:23], v[186:187], s[40:41] op_sel_hi:[1,0]
v_cvt_pk_bf16_f32 v56, v20, v21
v_cvt_pk_bf16_f32 v57, v22, v23
v_pk_mul_f32 v[20:21], v[216:217], s[40:41] op_sel_hi:[1,0]
v_pk_mul_f32 v[22:23], v[218:219], s[40:41] op_sel_hi:[1,0]
v_cvt_pk_bf16_f32 v58, v20, v21
v_cvt_pk_bf16_f32 v59, v22, v23
s_add_u32 s24, s96, 786432
buffer_store_dwordx4 v[56:59], v13, s[8:11], s24 offen sc1
v_pk_mul_f32 v[24:25], v[188:189], s[40:41] op_sel_hi:[1,0]
v_pk_mul_f32 v[26:27], v[190:191], s[40:41] op_sel_hi:[1,0]
v_cvt_pk_bf16_f32 v60, v24, v25
v_cvt_pk_bf16_f32 v61, v26, v27
v_pk_mul_f32 v[24:25], v[220:221], s[40:41] op_sel_hi:[1,0]
v_pk_mul_f32 v[26:27], v[222:223], s[40:41] op_sel_hi:[1,0]
v_cvt_pk_bf16_f32 v62, v24, v25
v_cvt_pk_bf16_f32 v63, v26, v27
buffer_store_dwordx4 v[60:63], v13, s[8:11], s24 offen offset:128 sc1
v_pk_mul_f32 v[20:21], v[224:225], s[40:41] op_sel_hi:[1,0]
v_pk_mul_f32 v[22:23], v[226:227], s[40:41] op_sel_hi:[1,0]
v_cvt_pk_bf16_f32 v64, v20, v21
v_cvt_pk_bf16_f32 v65, v22, v23
v_accvgpr_read_b32 v20, a0
v_accvgpr_read_b32 v21, a1
v_accvgpr_read_b32 v22, a2
v_accvgpr_read_b32 v23, a3
v_pk_mul_f32 v[20:21], v[20:21], s[40:41] op_sel_hi:[1,0]
v_pk_mul_f32 v[22:23], v[22:23], s[40:41] op_sel_hi:[1,0]
v_cvt_pk_bf16_f32 v66, v20, v21
v_cvt_pk_bf16_f32 v67, v22, v23
s_add_u32 s24, s96, 2048
buffer_store_dwordx4 v[64:67], v13, s[8:11], s24 offen sc1
v_pk_mul_f32 v[24:25], v[228:229], s[40:41] op_sel_hi:[1,0]
v_pk_mul_f32 v[26:27], v[230:231], s[40:41] op_sel_hi:[1,0]
v_cvt_pk_bf16_f32 v68, v24, v25
v_cvt_pk_bf16_f32 v69, v26, v27
v_accvgpr_read_b32 v24, a4
v_accvgpr_read_b32 v25, a5
v_accvgpr_read_b32 v26, a6
v_accvgpr_read_b32 v27, a7
v_pk_mul_f32 v[24:25], v[24:25], s[40:41] op_sel_hi:[1,0]
v_pk_mul_f32 v[26:27], v[26:27], s[40:41] op_sel_hi:[1,0]
v_cvt_pk_bf16_f32 v70, v24, v25
v_cvt_pk_bf16_f32 v71, v26, v27
buffer_store_dwordx4 v[68:71], v13, s[8:11], s24 offen offset:128 sc1
v_pk_mul_f32 v[20:21], v[232:233], s[40:41] op_sel_hi:[1,0]
v_pk_mul_f32 v[22:23], v[234:235], s[40:41] op_sel_hi:[1,0]
v_cvt_pk_bf16_f32 v72, v20, v21
v_cvt_pk_bf16_f32 v73, v22, v23
v_accvgpr_read_b32 v20, a8
v_accvgpr_read_b32 v21, a9
v_accvgpr_read_b32 v22, a10
v_accvgpr_read_b32 v23, a11
v_pk_mul_f32 v[20:21], v[20:21], s[40:41] op_sel_hi:[1,0]
v_pk_mul_f32 v[22:23], v[22:23], s[40:41] op_sel_hi:[1,0]
v_cvt_pk_bf16_f32 v74, v20, v21
v_cvt_pk_bf16_f32 v75, v22, v23
s_add_u32 s24, s96, 264192
buffer_store_dwordx4 v[72:75], v13, s[8:11], s24 offen sc1
v_pk_mul_f32 v[24:25], v[236:237], s[40:41] op_sel_hi:[1,0]
v_pk_mul_f32 v[26:27], v[238:239], s[40:41] op_sel_hi:[1,0]
v_cvt_pk_bf16_f32 v76, v24, v25
v_cvt_pk_bf16_f32 v77, v26, v27
v_accvgpr_read_b32 v24, a12
v_accvgpr_read_b32 v25, a13
v_accvgpr_read_b32 v26, a14
v_accvgpr_read_b32 v27, a15
v_pk_mul_f32 v[24:25], v[24:25], s[40:41] op_sel_hi:[1,0]
v_pk_mul_f32 v[26:27], v[26:27], s[40:41] op_sel_hi:[1,0]
v_cvt_pk_bf16_f32 v78, v24, v25
v_cvt_pk_bf16_f32 v79, v26, v27
buffer_store_dwordx4 v[76:79], v13, s[8:11], s24 offen offset:128 sc1
v_pk_mul_f32 v[20:21], v[240:241], s[40:41] op_sel_hi:[1,0]
v_pk_mul_f32 v[22:23], v[242:243], s[40:41] op_sel_hi:[1,0]
v_cvt_pk_bf16_f32 v80, v20, v21
v_cvt_pk_bf16_f32 v81, v22, v23
v_accvgpr_read_b32 v20, a16
v_accvgpr_read_b32 v21, a17
v_accvgpr_read_b32 v22, a18
v_accvgpr_read_b32 v23, a19
v_pk_mul_f32 v[20:21], v[20:21], s[40:41] op_sel_hi:[1,0]
v_pk_mul_f32 v[22:23], v[22:23], s[40:41] op_sel_hi:[1,0]
v_cvt_pk_bf16_f32 v82, v20, v21
v_cvt_pk_bf16_f32 v83, v22, v23
s_add_u32 s24, s96, 526336
buffer_store_dwordx4 v[80:83], v13, s[8:11], s24 offen sc1
v_pk_mul_f32 v[24:25], v[244:245], s[40:41] op_sel_hi:[1,0]
v_pk_mul_f32 v[26:27], v[246:247], s[40:41] op_sel_hi:[1,0]
v_cvt_pk_bf16_f32 v84, v24, v25
v_cvt_pk_bf16_f32 v85, v26, v27
v_accvgpr_read_b32 v24, a20
v_accvgpr_read_b32 v25, a21
v_accvgpr_read_b32 v26, a22
v_accvgpr_read_b32 v27, a23
v_pk_mul_f32 v[24:25], v[24:25], s[40:41] op_sel_hi:[1,0]
v_pk_mul_f32 v[26:27], v[26:27], s[40:41] op_sel_hi:[1,0]
v_cvt_pk_bf16_f32 v86, v24, v25
v_cvt_pk_bf16_f32 v87, v26, v27
buffer_store_dwordx4 v[84:87], v13, s[8:11], s24 offen offset:128 sc1
v_pk_mul_f32 v[20:21], v[248:249], s[40:41] op_sel_hi:[1,0]
v_pk_mul_f32 v[22:23], v[250:251], s[40:41] op_sel_hi:[1,0]
v_cvt_pk_bf16_f32 v88, v20, v21
v_cvt_pk_bf16_f32 v89, v22, v23
v_accvgpr_read_b32 v20, a24
v_accvgpr_read_b32 v21, a25
v_accvgpr_read_b32 v22, a26
v_accvgpr_read_b32 v23, a27
v_pk_mul_f32 v[20:21], v[20:21], s[40:41] op_sel_hi:[1,0]
v_pk_mul_f32 v[22:23], v[22:23], s[40:41] op_sel_hi:[1,0]
v_cvt_pk_bf16_f32 v90, v20, v21
v_cvt_pk_bf16_f32 v91, v22, v23
s_add_u32 s24, s96, 788480
buffer_store_dwordx4 v[88:91], v13, s[8:11], s24 offen sc1
v_pk_mul_f32 v[24:25], v[252:253], s[40:41] op_sel_hi:[1,0]
v_pk_mul_f32 v[26:27], v[254:255], s[40:41] op_sel_hi:[1,0]
v_cvt_pk_bf16_f32 v92, v24, v25
v_cvt_pk_bf16_f32 v93, v26, v27
v_accvgpr_read_b32 v24, a28
v_accvgpr_read_b32 v25, a29
v_accvgpr_read_b32 v26, a30
v_accvgpr_read_b32 v27, a31
v_pk_mul_f32 v[24:25], v[24:25], s[40:41] op_sel_hi:[1,0]
v_pk_mul_f32 v[26:27], v[26:27], s[40:41] op_sel_hi:[1,0]
v_cvt_pk_bf16_f32 v94, v24, v25
v_cvt_pk_bf16_f32 v95, v26, v27
buffer_store_dwordx4 v[92:95], v13, s[8:11], s24 offen offset:128 sc1
v_accvgpr_read_b32 v20, a32
v_accvgpr_read_b32 v21, a33
v_accvgpr_read_b32 v22, a34
v_accvgpr_read_b32 v23, a35
v_pk_mul_f32 v[20:21], v[20:21], s[40:41] op_sel_hi:[1,0]
v_pk_mul_f32 v[22:23], v[22:23], s[40:41] op_sel_hi:[1,0]
v_cvt_pk_bf16_f32 v96, v20, v21
v_cvt_pk_bf16_f32 v97, v22, v23
v_accvgpr_read_b32 v20, a64
v_accvgpr_read_b32 v21, a65
v_accvgpr_read_b32 v22, a66
v_accvgpr_read_b32 v23, a67
v_pk_mul_f32 v[20:21], v[20:21], s[40:41] op_sel_hi:[1,0]
v_pk_mul_f32 v[22:23], v[22:23], s[40:41] op_sel_hi:[1,0]
v_cvt_pk_bf16_f32 v98, v20, v21
v_cvt_pk_bf16_f32 v99, v22, v23
s_add_u32 s24, s96, 4096
buffer_store_dwordx4 v[96:99], v13, s[8:11], s24 offen sc1
v_accvgpr_read_b32 v24, a36
v_accvgpr_read_b32 v25, a37
v_accvgpr_read_b32 v26, a38
v_accvgpr_read_b32 v27, a39
v_pk_mul_f32 v[24:25], v[24:25], s[40:41] op_sel_hi:[1,0]
v_pk_mul_f32 v[26:27], v[26:27], s[40:41] op_sel_hi:[1,0]
v_cvt_pk_bf16_f32 v100, v24, v25
v_cvt_pk_bf16_f32 v101, v26, v27
v_accvgpr_read_b32 v24, a68
v_accvgpr_read_b32 v25, a69
v_accvgpr_read_b32 v26, a70
v_accvgpr_read_b32 v27, a71
v_pk_mul_f32 v[24:25], v[24:25], s[40:41] op_sel_hi:[1,0]
v_pk_mul_f32 v[26:27], v[26:27], s[40:41] op_sel_hi:[1,0]
v_cvt_pk_bf16_f32 v102, v24, v25
v_cvt_pk_bf16_f32 v103, v26, v27
buffer_store_dwordx4 v[100:103], v13, s[8:11], s24 offen offset:128 sc1
v_accvgpr_read_b32 v20, a40
v_accvgpr_read_b32 v21, a41
v_accvgpr_read_b32 v22, a42
v_accvgpr_read_b32 v23, a43
v_pk_mul_f32 v[20:21], v[20:21], s[40:41] op_sel_hi:[1,0]
v_pk_mul_f32 v[22:23], v[22:23], s[40:41] op_sel_hi:[1,0]
v_cvt_pk_bf16_f32 v104, v20, v21
v_cvt_pk_bf16_f32 v105, v22, v23
v_accvgpr_read_b32 v20, a72
v_accvgpr_read_b32 v21, a73
v_accvgpr_read_b32 v22, a74
v_accvgpr_read_b32 v23, a75
v_pk_mul_f32 v[20:21], v[20:21], s[40:41] op_sel_hi:[1,0]
v_pk_mul_f32 v[22:23], v[22:23], s[40:41] op_sel_hi:[1,0]
v_cvt_pk_bf16_f32 v106, v20, v21
v_cvt_pk_bf16_f32 v107, v22, v23
s_add_u32 s24, s96, 266240
buffer_store_dwordx4 v[104:107], v13, s[8:11], s24 offen sc1
v_accvgpr_read_b32 v24, a44
v_accvgpr_read_b32 v25, a45
v_accvgpr_read_b32 v26, a46
v_accvgpr_read_b32 v27, a47
v_pk_mul_f32 v[24:25], v[24:25], s[40:41] op_sel_hi:[1,0]
v_pk_mul_f32 v[26:27], v[26:27], s[40:41] op_sel_hi:[1,0]
v_cvt_pk_bf16_f32 v108, v24, v25
v_cvt_pk_bf16_f32 v109, v26, v27
v_accvgpr_read_b32 v24, a76
v_accvgpr_read_b32 v25, a77
v_accvgpr_read_b32 v26, a78
v_accvgpr_read_b32 v27, a79
v_pk_mul_f32 v[24:25], v[24:25], s[40:41] op_sel_hi:[1,0]
v_pk_mul_f32 v[26:27], v[26:27], s[40:41] op_sel_hi:[1,0]
v_cvt_pk_bf16_f32 v110, v24, v25
v_cvt_pk_bf16_f32 v111, v26, v27
buffer_store_dwordx4 v[108:111], v13, s[8:11], s24 offen offset:128 sc1
v_accvgpr_read_b32 v20, a48
v_accvgpr_read_b32 v21, a49
v_accvgpr_read_b32 v22, a50
v_accvgpr_read_b32 v23, a51
v_pk_mul_f32 v[20:21], v[20:21], s[40:41] op_sel_hi:[1,0]
v_pk_mul_f32 v[22:23], v[22:23], s[40:41] op_sel_hi:[1,0]
v_cvt_pk_bf16_f32 v112, v20, v21
v_cvt_pk_bf16_f32 v113, v22, v23
v_accvgpr_read_b32 v20, a80
v_accvgpr_read_b32 v21, a81
v_accvgpr_read_b32 v22, a82
v_accvgpr_read_b32 v23, a83
v_pk_mul_f32 v[20:21], v[20:21], s[40:41] op_sel_hi:[1,0]
v_pk_mul_f32 v[22:23], v[22:23], s[40:41] op_sel_hi:[1,0]
v_cvt_pk_bf16_f32 v114, v20, v21
v_cvt_pk_bf16_f32 v115, v22, v23
s_add_u32 s24, s96, 528384
buffer_store_dwordx4 v[112:115], v13, s[8:11], s24 offen sc1
v_accvgpr_read_b32 v24, a52
v_accvgpr_read_b32 v25, a53
v_accvgpr_read_b32 v26, a54
v_accvgpr_read_b32 v27, a55
v_pk_mul_f32 v[24:25], v[24:25], s[40:41] op_sel_hi:[1,0]
v_pk_mul_f32 v[26:27], v[26:27], s[40:41] op_sel_hi:[1,0]
v_cvt_pk_bf16_f32 v116, v24, v25
v_cvt_pk_bf16_f32 v117, v26, v27
v_accvgpr_read_b32 v24, a84
v_accvgpr_read_b32 v25, a85
v_accvgpr_read_b32 v26, a86
v_accvgpr_read_b32 v27, a87
v_pk_mul_f32 v[24:25], v[24:25], s[40:41] op_sel_hi:[1,0]
v_pk_mul_f32 v[26:27], v[26:27], s[40:41] op_sel_hi:[1,0]
v_cvt_pk_bf16_f32 v118, v24, v25
v_cvt_pk_bf16_f32 v119, v26, v27
buffer_store_dwordx4 v[116:119], v13, s[8:11], s24 offen offset:128 sc1
v_accvgpr_read_b32 v20, a56
v_accvgpr_read_b32 v21, a57
v_accvgpr_read_b32 v22, a58
v_accvgpr_read_b32 v23, a59
v_pk_mul_f32 v[20:21], v[20:21], s[40:41] op_sel_hi:[1,0]
v_pk_mul_f32 v[22:23], v[22:23], s[40:41] op_sel_hi:[1,0]
v_cvt_pk_bf16_f32 v120, v20, v21
v_cvt_pk_bf16_f32 v121, v22, v23
v_accvgpr_read_b32 v20, a88
v_accvgpr_read_b32 v21, a89
v_accvgpr_read_b32 v22, a90
v_accvgpr_read_b32 v23, a91
v_pk_mul_f32 v[20:21], v[20:21], s[40:41] op_sel_hi:[1,0]
v_pk_mul_f32 v[22:23], v[22:23], s[40:41] op_sel_hi:[1,0]
v_cvt_pk_bf16_f32 v122, v20, v21
v_cvt_pk_bf16_f32 v123, v22, v23
s_add_u32 s24, s96, 790528
buffer_store_dwordx4 v[120:123], v13, s[8:11], s24 offen sc1
v_accvgpr_read_b32 v24, a60
v_accvgpr_read_b32 v25, a61
v_accvgpr_read_b32 v26, a62
v_accvgpr_read_b32 v27, a63
v_pk_mul_f32 v[24:25], v[24:25], s[40:41] op_sel_hi:[1,0]
v_pk_mul_f32 v[26:27], v[26:27], s[40:41] op_sel_hi:[1,0]
v_cvt_pk_bf16_f32 v124, v24, v25
v_cvt_pk_bf16_f32 v125, v26, v27
v_accvgpr_read_b32 v24, a92
v_accvgpr_read_b32 v25, a93
v_accvgpr_read_b32 v26, a94
v_accvgpr_read_b32 v27, a95
v_pk_mul_f32 v[24:25], v[24:25], s[40:41] op_sel_hi:[1,0]
v_pk_mul_f32 v[26:27], v[26:27], s[40:41] op_sel_hi:[1,0]
v_cvt_pk_bf16_f32 v126, v24, v25
v_cvt_pk_bf16_f32 v127, v26, v27
buffer_store_dwordx4 v[124:127], v13, s[8:11], s24 offen offset:128 sc1
v_accvgpr_read_b32 v20, a96
v_accvgpr_read_b32 v21, a97
v_accvgpr_read_b32 v22, a98
v_accvgpr_read_b32 v23, a99
v_pk_mul_f32 v[20:21], v[20:21], s[40:41] op_sel_hi:[1,0]
v_pk_mul_f32 v[22:23], v[22:23], s[40:41] op_sel_hi:[1,0]
v_cvt_pk_bf16_f32 v128, v20, v21
v_cvt_pk_bf16_f32 v129, v22, v23
v_accvgpr_read_b32 v20, a128
v_accvgpr_read_b32 v21, a129
v_accvgpr_read_b32 v22, a130
v_accvgpr_read_b32 v23, a131
v_pk_mul_f32 v[20:21], v[20:21], s[40:41] op_sel_hi:[1,0]
v_pk_mul_f32 v[22:23], v[22:23], s[40:41] op_sel_hi:[1,0]
v_cvt_pk_bf16_f32 v130, v20, v21
v_cvt_pk_bf16_f32 v131, v22, v23
s_add_u32 s24, s96, 6144
buffer_store_dwordx4 v[128:131], v13, s[8:11], s24 offen sc1
v_accvgpr_read_b32 v24, a100
v_accvgpr_read_b32 v25, a101
v_accvgpr_read_b32 v26, a102
v_accvgpr_read_b32 v27, a103
v_pk_mul_f32 v[24:25], v[24:25], s[40:41] op_sel_hi:[1,0]
v_pk_mul_f32 v[26:27], v[26:27], s[40:41] op_sel_hi:[1,0]
v_cvt_pk_bf16_f32 v132, v24, v25
v_cvt_pk_bf16_f32 v133, v26, v27
v_accvgpr_read_b32 v24, a132
v_accvgpr_read_b32 v25, a133
v_accvgpr_read_b32 v26, a134
v_accvgpr_read_b32 v27, a135
v_pk_mul_f32 v[24:25], v[24:25], s[40:41] op_sel_hi:[1,0]
v_pk_mul_f32 v[26:27], v[26:27], s[40:41] op_sel_hi:[1,0]
v_cvt_pk_bf16_f32 v134, v24, v25
v_cvt_pk_bf16_f32 v135, v26, v27
buffer_store_dwordx4 v[132:135], v13, s[8:11], s24 offen offset:128 sc1
v_accvgpr_read_b32 v20, a104
v_accvgpr_read_b32 v21, a105
v_accvgpr_read_b32 v22, a106
v_accvgpr_read_b32 v23, a107
v_pk_mul_f32 v[20:21], v[20:21], s[40:41] op_sel_hi:[1,0]
v_pk_mul_f32 v[22:23], v[22:23], s[40:41] op_sel_hi:[1,0]
v_cvt_pk_bf16_f32 v136, v20, v21
v_cvt_pk_bf16_f32 v137, v22, v23
v_accvgpr_read_b32 v20, a136
v_accvgpr_read_b32 v21, a137
v_accvgpr_read_b32 v22, a138
v_accvgpr_read_b32 v23, a139
v_pk_mul_f32 v[20:21], v[20:21], s[40:41] op_sel_hi:[1,0]
v_pk_mul_f32 v[22:23], v[22:23], s[40:41] op_sel_hi:[1,0]
v_cvt_pk_bf16_f32 v138, v20, v21
v_cvt_pk_bf16_f32 v139, v22, v23
s_add_u32 s24, s96, 268288
buffer_store_dwordx4 v[136:139], v13, s[8:11], s24 offen sc1
v_accvgpr_read_b32 v24, a108
v_accvgpr_read_b32 v25, a109
v_accvgpr_read_b32 v26, a110
v_accvgpr_read_b32 v27, a111
v_pk_mul_f32 v[24:25], v[24:25], s[40:41] op_sel_hi:[1,0]
v_pk_mul_f32 v[26:27], v[26:27], s[40:41] op_sel_hi:[1,0]
v_cvt_pk_bf16_f32 v140, v24, v25
v_cvt_pk_bf16_f32 v141, v26, v27
v_accvgpr_read_b32 v24, a140
v_accvgpr_read_b32 v25, a141
v_accvgpr_read_b32 v26, a142
v_accvgpr_read_b32 v27, a143
v_pk_mul_f32 v[24:25], v[24:25], s[40:41] op_sel_hi:[1,0]
v_pk_mul_f32 v[26:27], v[26:27], s[40:41] op_sel_hi:[1,0]
v_cvt_pk_bf16_f32 v142, v24, v25
v_cvt_pk_bf16_f32 v143, v26, v27
buffer_store_dwordx4 v[140:143], v13, s[8:11], s24 offen offset:128 sc1
v_accvgpr_read_b32 v20, a112
v_accvgpr_read_b32 v21, a113
v_accvgpr_read_b32 v22, a114
v_accvgpr_read_b32 v23, a115
v_pk_mul_f32 v[20:21], v[20:21], s[40:41] op_sel_hi:[1,0]
v_pk_mul_f32 v[22:23], v[22:23], s[40:41] op_sel_hi:[1,0]
v_cvt_pk_bf16_f32 v144, v20, v21
v_cvt_pk_bf16_f32 v145, v22, v23
v_accvgpr_read_b32 v20, a144
v_accvgpr_read_b32 v21, a145
v_accvgpr_read_b32 v22, a146
v_accvgpr_read_b32 v23, a147
v_pk_mul_f32 v[20:21], v[20:21], s[40:41] op_sel_hi:[1,0]
v_pk_mul_f32 v[22:23], v[22:23], s[40:41] op_sel_hi:[1,0]
v_cvt_pk_bf16_f32 v146, v20, v21
v_cvt_pk_bf16_f32 v147, v22, v23
s_add_u32 s24, s96, 530432
buffer_store_dwordx4 v[144:147], v13, s[8:11], s24 offen sc1
v_accvgpr_read_b32 v24, a116
v_accvgpr_read_b32 v25, a117
v_accvgpr_read_b32 v26, a118
v_accvgpr_read_b32 v27, a119
v_pk_mul_f32 v[24:25], v[24:25], s[40:41] op_sel_hi:[1,0]
v_pk_mul_f32 v[26:27], v[26:27], s[40:41] op_sel_hi:[1,0]
v_cvt_pk_bf16_f32 v148, v24, v25
v_cvt_pk_bf16_f32 v149, v26, v27
v_accvgpr_read_b32 v24, a148
v_accvgpr_read_b32 v25, a149
v_accvgpr_read_b32 v26, a150
v_accvgpr_read_b32 v27, a151
v_pk_mul_f32 v[24:25], v[24:25], s[40:41] op_sel_hi:[1,0]
v_pk_mul_f32 v[26:27], v[26:27], s[40:41] op_sel_hi:[1,0]
v_cvt_pk_bf16_f32 v150, v24, v25
v_cvt_pk_bf16_f32 v151, v26, v27
buffer_store_dwordx4 v[148:151], v13, s[8:11], s24 offen offset:128 sc1
v_accvgpr_read_b32 v20, a120
v_accvgpr_read_b32 v21, a121
v_accvgpr_read_b32 v22, a122
v_accvgpr_read_b32 v23, a123
v_pk_mul_f32 v[20:21], v[20:21], s[40:41] op_sel_hi:[1,0]
v_pk_mul_f32 v[22:23], v[22:23], s[40:41] op_sel_hi:[1,0]
v_cvt_pk_bf16_f32 v152, v20, v21
v_cvt_pk_bf16_f32 v153, v22, v23
v_accvgpr_read_b32 v20, a152
v_accvgpr_read_b32 v21, a153
v_accvgpr_read_b32 v22, a154
v_accvgpr_read_b32 v23, a155
v_pk_mul_f32 v[20:21], v[20:21], s[40:41] op_sel_hi:[1,0]
v_pk_mul_f32 v[22:23], v[22:23], s[40:41] op_sel_hi:[1,0]
v_cvt_pk_bf16_f32 v154, v20, v21
v_cvt_pk_bf16_f32 v155, v22, v23
s_add_u32 s24, s96, 792576
buffer_store_dwordx4 v[152:155], v13, s[8:11], s24 offen sc1
v_accvgpr_read_b32 v24, a124
v_accvgpr_read_b32 v25, a125
v_accvgpr_read_b32 v26, a126
v_accvgpr_read_b32 v27, a127
v_pk_mul_f32 v[24:25], v[24:25], s[40:41] op_sel_hi:[1,0]
v_pk_mul_f32 v[26:27], v[26:27], s[40:41] op_sel_hi:[1,0]
v_cvt_pk_bf16_f32 v156, v24, v25
v_cvt_pk_bf16_f32 v157, v26, v27
v_accvgpr_read_b32 v24, a156
v_accvgpr_read_b32 v25, a157
v_accvgpr_read_b32 v26, a158
v_accvgpr_read_b32 v27, a159
v_pk_mul_f32 v[24:25], v[24:25], s[40:41] op_sel_hi:[1,0]
v_pk_mul_f32 v[26:27], v[26:27], s[40:41] op_sel_hi:[1,0]
v_cvt_pk_bf16_f32 v158, v24, v25
v_cvt_pk_bf16_f32 v159, v26, v27
buffer_store_dwordx4 v[156:159], v13, s[8:11], s24 offen offset:128 sc1
s_waitcnt vmcnt(48) lgkmcnt(0)
L_at_qx:
s_barrier
v_and_b32 v13, 0x7ff, v7
s_lshr_b32 s24, s17, 1
s_lshl_b32 s24, s24, 13
s_add_u32 s24, s24, 98304
v_add_u32 v13, s24, v13
ds_read_b128 v[160:163], v13
ds_read_b128 v[164:167], v13 offset:2048
ds_read_b128 v[168:171], v13 offset:4096
ds_read_b128 v[172:175], v13 offset:6144
ds_read_b128 v[176:179], v13 offset:16384
ds_read_b128 v[180:183], v13 offset:18432
ds_read_b128 v[184:187], v13 offset:20480
ds_read_b128 v[188:191], v13 offset:22528
ds_read_b128 v[192:195], v13 offset:32768
ds_read_b128 v[196:199], v13 offset:34816
ds_read_b128 v[200:203], v13 offset:36864
ds_read_b128 v[204:207], v13 offset:38912
ds_read_b128 v[208:211], v13 offset:49152
ds_read_b128 v[212:215], v13 offset:51200
ds_read_b128 v[216:219], v13 offset:53248
ds_read_b128 v[220:223], v13 offset:55296
s_waitcnt lgkmcnt(0)
L_at_item:
s_lshl_b32 s44, s41, 2
s_mov_b32 s43, 0
s_mov_b32 s45, 2
s_mov_b32 s54, s50
s_mov_b32 s55, s50
v_mov_b32 v2, v6
v_add_u32 v3, 32768, v6
v_mov_b32 v4, v6
s_barrier
ds_read_b128 a[64:67], v2
ds_read_b128 a[68:71], v2 offset:1024
ds_read_b128 a[72:75], v2 offset:2048
v_mov_b64 v[112:113], 0
v_mov_b64 v[114:115], 0
v_mov_b64 v[116:117], 0
v_mov_b64 v[118:119], 0
v_mov_b64 v[120:121], 0
v_mov_b64 v[122:123], 0
v_mov_b64 v[124:125], 0
v_mov_b64 v[126:127], 0
v_mov_b64 v[128:129], 0
v_mov_b64 v[130:131], 0
v_mov_b64 v[132:133], 0
v_mov_b64 v[134:135], 0
v_mov_b64 v[136:137], 0
v_mov_b64 v[138:139], 0
v_mov_b64 v[140:141], 0
v_mov_b64 v[142:143], 0
v_mfma_f32_32x32x16_bf16 a[96:111], v[112:115], v[112:115], 0
v_accvgpr_write_b32 a0, v160
v_accvgpr_write_b32 a1, v161
v_accvgpr_write_b32 a2, v162
v_accvgpr_write_b32 a3, v163
v_accvgpr_write_b32 a4, v164
v_accvgpr_write_b32 a5, v165
v_accvgpr_write_b32 a6, v166
v_mfma_f32_32x32x16_bf16 a[112:127], v[112:115], v[112:115], 0
v_accvgpr_write_b32 a7, v167
v_accvgpr_write_b32 a8, v168
v_accvgpr_write_b32 a9, v169
v_accvgpr_write_b32 a10, v170
v_accvgpr_write_b32 a11, v171
v_accvgpr_write_b32 a12, v172
v_accvgpr_write_b32 a13, v173
v_mfma_f32_32x32x16_bf16 a[128:143], v[112:115], v[112:115], 0
v_accvgpr_write_b32 a14, v174
v_accvgpr_write_b32 a15, v175
v_accvgpr_write_b32 a16, v176
v_accvgpr_write_b32 a17, v177
v_accvgpr_write_b32 a18, v178
v_accvgpr_write_b32 a19, v179
v_accvgpr_write_b32 a20, v180
v_mfma_f32_32x32x16_bf16 a[144:159], v[112:115], v[112:115], 0
v_accvgpr_write_b32 a21, v181
v_accvgpr_write_b32 a22, v182
v_accvgpr_write_b32 a23, v183
v_accvgpr_write_b32 a24, v184
v_accvgpr_write_b32 a25, v185
v_accvgpr_write_b32 a26, v186
v_accvgpr_write_b32 a27, v187
v_mfma_f32_32x32x16_bf16 a[160:175], v[112:115], v[112:115], 0
v_accvgpr_write_b32 a28, v188
v_accvgpr_write_b32 a29, v189
v_accvgpr_write_b32 a30, v190
v_accvgpr_write_b32 a31, v191
v_accvgpr_write_b32 a32, v192
v_accvgpr_write_b32 a33, v193
v_accvgpr_write_b32 a34, v194
v_accvgpr_write_b32 a35, v195
v_mfma_f32_32x32x16_bf16 a[176:191], v[112:115], v[112:115], 0
v_accvgpr_write_b32 a36, v196
v_accvgpr_write_b32 a37, v197
v_accvgpr_write_b32 a38, v198
v_accvgpr_write_b32 a39, v199
v_accvgpr_write_b32 a40, v200
v_accvgpr_write_b32 a41, v201
v_accvgpr_write_b32 a42, v202
v_mfma_f32_32x32x16_bf16 a[192:207], v[112:115], v[112:115], 0
v_accvgpr_write_b32 a43, v203
v_accvgpr_write_b32 a44, v204
v_accvgpr_write_b32 a45, v205
v_accvgpr_write_b32 a46, v206
v_accvgpr_write_b32 a47, v207
v_accvgpr_write_b32 a48, v208
v_accvgpr_write_b32 a49, v209
v_mfma_f32_32x32x16_bf16 a[208:223], v[112:115], v[112:115], 0
v_accvgpr_write_b32 a50, v210
v_accvgpr_write_b32 a51, v211
v_accvgpr_write_b32 a52, v212
v_accvgpr_write_b32 a53, v213
v_accvgpr_write_b32 a54, v214
v_accvgpr_write_b32 a55, v215
v_accvgpr_write_b32 a56, v216
v_mfma_f32_32x32x16_bf16 a[224:239], v[112:115], v[112:115], 0
v_accvgpr_write_b32 a57, v217
v_accvgpr_write_b32 a58, v218
v_accvgpr_write_b32 a59, v219
v_accvgpr_write_b32 a60, v220
v_accvgpr_write_b32 a61, v221
v_accvgpr_write_b32 a62, v222
v_accvgpr_write_b32 a63, v223
s_waitcnt lgkmcnt(2)
v_mfma_f32_16x16x32_bf16 v[32:35], a[64:67], a[0:3], v[128:131]
ds_read_b128 a[76:79], v2 offset:3072
v_mfma_f32_16x16x32_bf16 v[40:43], a[64:67], a[16:19], v[132:135]
v_mfma_f32_16x16x32_bf16 v[48:51], a[64:67], a[32:35], v[136:139]
v_mfma_f32_16x16x32_bf16 v[56:59], a[64:67], a[48:51], v[140:143]
s_waitcnt lgkmcnt(2)
v_mfma_f32_16x16x32_bf16 v[36:39], a[68:71], a[0:3], v[128:131]
ds_read_b128 a[80:83], v2 offset:4096
v_mfma_f32_16x16x32_bf16 v[44:47], a[68:71], a[16:19], v[132:135]
v_mfma_f32_16x16x32_bf16 v[52:55], a[68:71], a[32:35], v[136:139]
v_mfma_f32_16x16x32_bf16 v[60:63], a[68:71], a[48:51], v[140:143]
s_waitcnt lgkmcnt(2)
v_mfma_f32_16x16x32_bf16 v[32:35], a[72:75], a[4:7], v[32:35]
ds_read_b128 a[84:87], v2 offset:5120
v_mfma_f32_16x16x32_bf16 v[40:43], a[72:75], a[20:23], v[40:43]
v_mfma_f32_16x16x32_bf16 v[48:51], a[72:75], a[36:39], v[48:51]
v_mfma_f32_16x16x32_bf16 v[56:59], a[72:75], a[52:55], v[56:59]
s_waitcnt lgkmcnt(2)
v_mfma_f32_16x16x32_bf16 v[36:39], a[76:79], a[4:7], v[36:39]
ds_read_b128 a[88:91], v2 offset:6144
v_mfma_f32_16x16x32_bf16 v[44:47], a[76:79], a[20:23], v[44:47]
v_mfma_f32_16x16x32_bf16 v[52:55], a[76:79], a[36:39], v[52:55]
v_mfma_f32_16x16x32_bf16 v[60:63], a[76:79], a[52:55], v[60:63]
s_waitcnt lgkmcnt(2)
v_mfma_f32_16x16x32_bf16 v[32:35], a[80:83], a[8:11], v[32:35]
ds_read_b128 a[92:95], v2 offset:7168
v_mfma_f32_16x16x32_bf16 v[40:43], a[80:83], a[24:27], v[40:43]
v_mfma_f32_16x16x32_bf16 v[48:51], a[80:83], a[40:43], v[48:51]
v_mfma_f32_16x16x32_bf16 v[56:59], a[80:83], a[56:59], v[56:59]
s_waitcnt lgkmcnt(2)
v_mfma_f32_16x16x32_bf16 v[36:39], a[84:87], a[8:11], v[36:39]
ds_read_b128 a[64:67], v4 offset:24576
v_mfma_f32_16x16x32_bf16 v[44:47], a[84:87], a[24:27], v[44:47]
v_mfma_f32_16x16x32_bf16 v[52:55], a[84:87], a[40:43], v[52:55]
v_mfma_f32_16x16x32_bf16 v[60:63], a[84:87], a[56:59], v[60:63]
s_waitcnt lgkmcnt(2)
v_mfma_f32_16x16x32_bf16 v[32:35], a[88:91], a[12:15], v[32:35]
ds_read_b128 a[68:71], v4 offset:25600
v_mfma_f32_16x16x32_bf16 v[40:43], a[88:91], a[28:31], v[40:43]
v_mfma_f32_16x16x32_bf16 v[48:51], a[88:91], a[44:47], v[48:51]
v_mfma_f32_16x16x32_bf16 v[56:59], a[88:91], a[60:63], v[56:59]
s_waitcnt lgkmcnt(2)
v_mfma_f32_16x16x32_bf16 v[36:39], a[92:95], a[12:15], v[36:39]
ds_read_b128 a[72:75], v4 offset:26624
v_mfma_f32_16x16x32_bf16 v[44:47], a[92:95], a[28:31], v[44:47]
v_mfma_f32_16x16x32_bf16 v[52:55], a[92:95], a[44:47], v[52:55]
v_mfma_f32_16x16x32_bf16 v[60:63], a[92:95], a[60:63], v[60:63]
s_waitcnt lgkmcnt(2)
s_cmp_eq_u32 s44, 0
s_cbranch_scc1 L_at_last
.p2align 3
L_at_loop:
v_mfma_f32_16x16x32_bf16 a[224:227], a[240:243], v[112:115], a[224:227]
s_add_u32 s43, s43, 1
v_mfma_f32_16x16x32_bf16 a[228:231], a[240:243], v[116:119], a[228:231]
v_mfma_f32_16x16x32_bf16 a[232:235], a[240:243], v[120:123], a[232:235]
v_mfma_f32_16x16x32_bf16 a[236:239], a[240:243], v[124:127], a[236:239]
v_max3_f32 v16, v32, v33, v34
v_max3_f32 v16, v16, v35, v40
v_mfma_f32_16x16x32_bf16 a[96:99], a[64:67], v[112:115], a[96:99]
ds_read_b128 a[76:79], v4 offset:27648
v_max3_f32 v16, v16, v41, v42
v_mfma_f32_16x16x32_bf16 a[100:103], a[64:67], v[116:119], a[100:103]
v_max3_f32 v16, v16, v43, v48
v_max3_f32 v16, v16, v49, v50
v_mfma_f32_16x16x32_bf16 a[104:107], a[64:67], v[120:123], a[104:107]
v_max3_f32 v16, v16, v51, v56
v_max3_f32 v16, v16, v57, v58
v_mfma_f32_16x16x32_bf16 a[108:111], a[64:67], v[124:127], a[108:111]
s_waitcnt lgkmcnt(2)
v_max3_f32 v16, v16, v59, v36
v_max3_f32 v16, v16, v37, v38
v_mfma_f32_16x16x32_bf16 a[112:115], a[68:71], v[112:115], a[112:115]
ds_read_b128 a[80:83], v4 offset:28672
v_max3_f32 v16, v16, v39, v44
v_mfma_f32_16x16x32_bf16 a[116:119], a[68:71], v[116:119], a[116:119]
v_max3_f32 v16, v16, v45, v46
v_max3_f32 v16, v16, v47, v52
v_mfma_f32_16x16x32_bf16 a[120:123], a[68:71], v[120:123], a[120:123]
v_max3_f32 v16, v16, v53, v54
v_max3_f32 v16, v16, v55, v60
v_mfma_f32_16x16x32_bf16 a[124:127], a[68:71], v[124:127], a[124:127]
s_waitcnt lgkmcnt(2)
v_max3_f32 v16, v16, v61, v62
v_max_f32 v16, v16, v63
v_mfma_f32_16x16x32_bf16 a[128:131], a[72:75], v[112:115], a[128:131]
ds_read_b128 a[84:87], v4 offset:29696
v_cmp_lt_f32 vcc, s54, v16
v_mfma_f32_16x16x32_bf16 a[132:135], a[72:75], v[116:119], a[132:135]
s_cbranch_vccnz L_at_up0
L_at_upr0:
v_mfma_f32_16x16x32_bf16 a[136:139], a[72:75], v[120:123], a[136:139]
v_exp_f32 v32, v32
v_mfma_f32_16x16x32_bf16 a[140:143], a[72:75], v[124:127], a[140:143]
s_waitcnt lgkmcnt(2)
v_exp_f32 v33, v33
v_mfma_f32_16x16x32_bf16 a[144:147], a[76:79], v[112:115], a[144:147]
ds_read_b128 a[88:91], v4 offset:30720
v_cvt_pk_bf16_f32 v96, v32, v33
v_mfma_f32_16x16x32_bf16 a[148:151], a[76:79], v[116:119], a[148:151]
v_exp_f32 v34, v34
v_mfma_f32_16x16x32_bf16 a[152:155], a[76:79], v[120:123], a[152:155]
v_exp_f32 v35, v35
v_mfma_f32_16x16x32_bf16 a[156:159], a[76:79], v[124:127], a[156:159]
s_waitcnt lgkmcnt(2)
v_exp_f32 v36, v36
v_mfma_f32_16x16x32_bf16 a[160:163], a[80:83], v[112:115], a[160:163]
ds_read_b128 a[92:95], v4 offset:31744
v_cvt_pk_bf16_f32 v97, v34, v35
v_mfma_f32_16x16x32_bf16 a[164:167], a[80:83], v[116:119], a[164:167]
v_exp_f32 v37, v37
v_mfma_f32_16x16x32_bf16 a[168:171], a[80:83], v[120:123], a[168:171]
v_exp_f32 v38, v38
v_mfma_f32_16x16x32_bf16 a[172:175], a[80:83], v[124:127], a[172:175]
s_waitcnt lgkmcnt(2)
v_exp_f32 v39, v39
v_mfma_f32_16x16x32_bf16 a[176:179], a[84:87], v[112:115], a[176:179]
ds_read_b128 a[64:67], v2 offset:16384
v_cvt_pk_bf16_f32 v98, v36, v37
v_mfma_f32_16x16x32_bf16 a[180:183], a[84:87], v[116:119], a[180:183]
v_exp_f32 v40, v40
v_mfma_f32_16x16x32_bf16 a[184:187], a[84:87], v[120:123], a[184:187]
v_exp_f32 v41, v41
v_mfma_f32_16x16x32_bf16 a[188:191], a[84:87], v[124:127], a[188:191]
s_waitcnt lgkmcnt(2)
v_exp_f32 v42, v42
v_mfma_f32_16x16x32_bf16 a[192:195], a[88:91], v[112:115], a[192:195]
ds_read_b128 a[68:71], v2 offset:17408
v_cvt_pk_bf16_f32 v99, v38, v39
v_mfma_f32_16x16x32_bf16 a[196:199], a[88:91], v[116:119], a[196:199]
v_exp_f32 v43, v43
v_mfma_f32_16x16x32_bf16 a[200:203], a[88:91], v[120:123], a[200:203]
v_exp_f32 v44, v44
v_mfma_f32_16x16x32_bf16 a[204:207], a[88:91], v[124:127], a[204:207]
s_waitcnt lgkmcnt(2)
v_exp_f32 v45, v45
v_mfma_f32_16x16x32_bf16 a[208:211], a[92:95], v[112:115], a[208:211]
ds_read_b128 a[72:75], v2 offset:18432
v_cvt_pk_bf16_f32 v100, v40, v41
v_mfma_f32_16x16x32_bf16 a[212:215], a[92:95], v[116:119], a[212:215]
v_exp_f32 v46, v46
v_mfma_f32_16x16x32_bf16 a[216:219], a[92:95], v[120:123], a[216:219]
s_cmp_eq_u32 s48, 0
v_exp_f32 v47, v47
v_mfma_f32_16x16x32_bf16 a[220:223], a[92:95], v[124:127], a[220:223]
s_waitcnt lgkmcnt(2)
s_cbranch_scc0 L_at_rs0
L_at_rsr0:
v_mfma_f32_16x16x32_bf16 v[64:67], a[64:67], a[0:3], v[128:131]
ds_read_b128 a[76:79], v2 offset:19456
v_cvt_pk_bf16_f32 v101, v42, v43
v_mfma_f32_16x16x32_bf16 v[72:75], a[64:67], a[16:19], v[132:135]
v_exp_f32 v48, v48
v_mfma_f32_16x16x32_bf16 v[80:83], a[64:67], a[32:35], v[136:139]
v_exp_f32 v49, v49
v_mfma_f32_16x16x32_bf16 v[88:91], a[64:67], a[48:51], v[140:143]
s_waitcnt lgkmcnt(2)
v_exp_f32 v50, v50
v_mfma_f32_16x16x32_bf16 v[68:71], a[68:71], a[0:3], v[128:131]
ds_read_b128 a[80:83], v2 offset:20480
v_cvt_pk_bf16_f32 v102, v44, v45
v_mfma_f32_16x16x32_bf16 v[76:79], a[68:71], a[16:19], v[132:135]
v_exp_f32 v51, v51
v_mfma_f32_16x16x32_bf16 v[84:87], a[68:71], a[32:35], v[136:139]
v_exp_f32 v52, v52
v_mfma_f32_16x16x32_bf16 v[92:95], a[68:71], a[48:51], v[140:143]
s_waitcnt lgkmcnt(2)
v_exp_f32 v53, v53
v_mfma_f32_16x16x32_bf16 v[64:67], a[72:75], a[4:7], v[64:67]
ds_read_b128 a[84:87], v2 offset:21504
v_cvt_pk_bf16_f32 v103, v46, v47
v_mfma_f32_16x16x32_bf16 v[72:75], a[72:75], a[20:23], v[72:75]
v_exp_f32 v54, v54
v_mfma_f32_16x16x32_bf16 v[80:83], a[72:75], a[36:39], v[80:83]
v_exp_f32 v55, v55
v_mfma_f32_16x16x32_bf16 v[88:91], a[72:75], a[52:55], v[88:91]
s_waitcnt lgkmcnt(2)
v_exp_f32 v56, v56
v_mfma_f32_16x16x32_bf16 v[68:71], a[76:79], a[4:7], v[68:71]
ds_read_b128 a[88:91], v2 offset:22528
v_cvt_pk_bf16_f32 v104, v48, v49
v_mfma_f32_16x16x32_bf16 v[76:79], a[76:79], a[20:23], v[76:79]
v_exp_f32 v57, v57
v_mfma_f32_16x16x32_bf16 v[84:87], a[76:79], a[36:39], v[84:87]
v_exp_f32 v58, v58
v_mfma_f32_16x16x32_bf16 v[92:95], a[76:79], a[52:55], v[92:95]
s_waitcnt lgkmcnt(2)
v_exp_f32 v59, v59
v_mfma_f32_16x16x32_bf16 v[64:67], a[80:83], a[8:11], v[64:67]
ds_read_b128 a[92:95], v2 offset:23552
v_cvt_pk_bf16_f32 v105, v50, v51
v_mfma_f32_16x16x32_bf16 v[72:75], a[80:83], a[24:27], v[72:75]
v_exp_f32 v60, v60
v_mfma_f32_16x16x32_bf16 v[80:83], a[80:83], a[40:43], v[80:83]
v_exp_f32 v61, v61
v_mfma_f32_16x16x32_bf16 v[88:91], a[80:83], a[56:59], v[88:91]
s_waitcnt lgkmcnt(2)
v_exp_f32 v62, v62
v_mfma_f32_16x16x32_bf16 v[68:71], a[84:87], a[8:11], v[68:71]
ds_read_b128 a[64:67], v2 offset:8192
v_cvt_pk_bf16_f32 v106, v52, v53
v_mfma_f32_16x16x32_bf16 v[76:79], a[84:87], a[24:27], v[76:79]
v_exp_f32 v63, v63
v_mfma_f32_16x16x32_bf16 v[84:87], a[84:87], a[40:43], v[84:87]
v_cvt_pk_bf16_f32 v107, v54, v55
v_cvt_pk_bf16_f32 v108, v56, v57
v_mfma_f32_16x16x32_bf16 v[92:95], a[84:87], a[56:59], v[92:95]
s_waitcnt lgkmcnt(2)
v_cvt_pk_bf16_f32 v109, v58, v59
v_cvt_pk_bf16_f32 v110, v60, v61
v_mfma_f32_16x16x32_bf16 v[64:67], a[88:91], a[12:15], v[64:67]
ds_read_b128 a[68:71], v2 offset:9216
v_cvt_pk_bf16_f32 v111, v62, v63
v_mfma_f32_16x16x32_bf16 v[72:75], a[88:91], a[28:31], v[72:75]
v_mfma_f32_16x16x32_bf16 v[80:83], a[88:91], a[44:47], v[80:83]
v_mfma_f32_16x16x32_bf16 v[88:91], a[88:91], a[60:63], v[88:91]
s_waitcnt lgkmcnt(2)
v_mfma_f32_16x16x32_bf16 v[68:71], a[92:95], a[12:15], v[68:71]
ds_read_b128 a[72:75], v2 offset:10240
v_mfma_f32_16x16x32_bf16 v[76:79], a[92:95], a[28:31], v[76:79]
s_cmp_eq_u32 s43, s45
v_mfma_f32_16x16x32_bf16 v[84:87], a[92:95], a[44:47], v[84:87]
v_mfma_f32_16x16x32_bf16 v[92:95], a[92:95], a[60:63], v[92:95]
s_waitcnt lgkmcnt(2)
s_waitcnt vmcnt(8)
s_barrier
s_cbranch_scc1 L_at_hk
L_at_hkr:
v_mfma_f32_16x16x32_bf16 a[224:227], a[240:243], v[96:99], a[224:227]
s_add_u32 s24, s46, 4096
s_add_u32 m0, s47, 0
v_mfma_f32_16x16x32_bf16 a[228:231], a[240:243], v[100:103], a[228:231]
buffer_load_dwordx4 v1, s[8:11], s46 offen sc1 lds
v_mfma_f32_16x16x32_bf16 a[232:235], a[240:243], v[104:107], a[232:235]
buffer_load_dwordx4 v1, s[8:11], s46 offen offset:2048 sc1 lds
v_mfma_f32_16x16x32_bf16 a[236:239], a[240:243], v[108:111], a[236:239]
v_max3_f32 v16, v64, v65, v66
v_max3_f32 v16, v16, v67, v72
v_mfma_f32_16x16x32_bf16 a[96:99], a[64:67], v[96:99], a[96:99]
ds_read_b128 a[76:79], v2 offset:11264
v_max3_f32 v16, v16, v73, v74
v_mfma_f32_16x16x32_bf16 a[100:103], a[64:67], v[100:103], a[100:103]
s_add_u32 m0, s47, 896
v_max3_f32 v16, v16, v75, v80
v_max3_f32 v16, v16, v81, v82
v_mfma_f32_16x16x32_bf16 a[104:107], a[64:67], v[104:107], a[104:107]
v_max3_f32 v16, v16, v83, v88
v_max3_f32 v16, v16, v89, v90
v_mfma_f32_16x16x32_bf16 a[108:111], a[64:67], v[108:111], a[108:111]
s_waitcnt lgkmcnt(2)
v_max3_f32 v16, v16, v91, v68
v_max3_f32 v16, v16, v69, v70
v_mfma_f32_16x16x32_bf16 a[112:115], a[68:71], v[96:99], a[112:115]
ds_read_b128 a[80:83], v2 offset:12288
v_max3_f32 v16, v16, v71, v76
v_mfma_f32_16x16x32_bf16 a[116:119], a[68:71], v[100:103], a[116:119]
buffer_load_dwordx4 v1, s[8:11], s46 offen offset:128 sc1 lds
v_max3_f32 v16, v16, v77, v78
v_mfma_f32_16x16x32_bf16 a[120:123], a[68:71], v[104:107], a[120:123]
v_max3_f32 v16, v16, v79, v84
v_max3_f32 v16, v16, v85, v86
v_mfma_f32_16x16x32_bf16 a[124:127], a[68:71], v[108:111], a[124:127]
s_waitcnt lgkmcnt(2)
v_max3_f32 v16, v16, v87, v92
v_max3_f32 v16, v16, v93, v94
v_mfma_f32_16x16x32_bf16 a[128:131], a[72:75], v[96:99], a[128:131]
ds_read_b128 a[84:87], v2 offset:13312
v_max_f32 v16, v16, v95
v_cmp_lt_f32 vcc, s54, v16
v_mfma_f32_16x16x32_bf16 a[132:135], a[72:75], v[100:103], a[132:135]
buffer_load_dwordx4 v1, s[8:11], s46 offen offset:2176 sc1 lds
s_cbranch_vccnz L_at_up1
L_at_upr1:
v_mfma_f32_16x16x32_bf16 a[136:139], a[72:75], v[104:107], a[136:139]
v_exp_f32 v64, v64
v_mfma_f32_16x16x32_bf16 a[140:143], a[72:75], v[108:111], a[140:143]
s_waitcnt lgkmcnt(2)
v_exp_f32 v65, v65
v_mfma_f32_16x16x32_bf16 a[144:147], a[76:79], v[96:99], a[144:147]
ds_read_b128 a[88:91], v2 offset:14336
v_cvt_pk_bf16_f32 v112, v64, v65
v_mfma_f32_16x16x32_bf16 a[148:151], a[76:79], v[100:103], a[148:151]
v_exp_f32 v66, v66
v_mfma_f32_16x16x32_bf16 a[152:155], a[76:79], v[104:107], a[152:155]
s_add_u32 m0, s47, 4096
v_exp_f32 v67, v67
v_mfma_f32_16x16x32_bf16 a[156:159], a[76:79], v[108:111], a[156:159]
s_waitcnt lgkmcnt(2)
v_exp_f32 v68, v68
v_mfma_f32_16x16x32_bf16 a[160:163], a[80:83], v[96:99], a[160:163]
ds_read_b128 a[92:95], v2 offset:15360
v_cvt_pk_bf16_f32 v113, v66, v67
v_mfma_f32_16x16x32_bf16 a[164:167], a[80:83], v[100:103], a[164:167]
v_exp_f32 v69, v69
v_mfma_f32_16x16x32_bf16 a[168:171], a[80:83], v[104:107], a[168:171]
buffer_load_dwordx4 v1, s[8:11], s24 offen sc1 lds
v_cvt_pk_bf16_f32 v114, v68, v69
v_mfma_f32_16x16x32_bf16 a[172:175], a[80:83], v[108:111], a[172:175]
s_waitcnt lgkmcnt(2)
v_exp_f32 v70, v70
v_mfma_f32_16x16x32_bf16 a[176:179], a[84:87], v[96:99], a[176:179]
ds_read_b128 a[64:67], v3
v_mfma_f32_16x16x32_bf16 a[180:183], a[84:87], v[100:103], a[180:183]
v_exp_f32 v71, v71
v_mfma_f32_16x16x32_bf16 a[184:187], a[84:87], v[104:107], a[184:187]
v_exp_f32 v72, v72
v_mfma_f32_16x16x32_bf16 a[188:191], a[84:87], v[108:111], a[188:191]
s_waitcnt lgkmcnt(2)
v_exp_f32 v73, v73
v_mfma_f32_16x16x32_bf16 a[192:195], a[88:91], v[96:99], a[192:195]
ds_read_b128 a[68:71], v3 offset:1024
v_cvt_pk_bf16_f32 v115, v70, v71
v_mfma_f32_16x16x32_bf16 a[196:199], a[88:91], v[100:103], a[196:199]
buffer_load_dwordx4 v1, s[8:11], s24 offen offset:2048 sc1 lds
v_cvt_pk_bf16_f32 v116, v72, v73
v_mfma_f32_16x16x32_bf16 a[200:203], a[88:91], v[104:107], a[200:203]
v_exp_f32 v74, v74
v_mfma_f32_16x16x32_bf16 a[204:207], a[88:91], v[108:111], a[204:207]
s_waitcnt lgkmcnt(2)
v_exp_f32 v75, v75
v_mfma_f32_16x16x32_bf16 a[208:211], a[92:95], v[96:99], a[208:211]
ds_read_b128 a[72:75], v3 offset:2048
v_cvt_pk_bf16_f32 v117, v74, v75
v_mfma_f32_16x16x32_bf16 a[212:215], a[92:95], v[100:103], a[212:215]
s_add_u32 m0, s47, 4992
v_exp_f32 v76, v76
v_mfma_f32_16x16x32_bf16 a[216:219], a[92:95], v[104:107], a[216:219]
s_cmp_eq_u32 s48, 0
v_exp_f32 v77, v77
v_mfma_f32_16x16x32_bf16 a[220:223], a[92:95], v[108:111], a[220:223]
s_waitcnt lgkmcnt(2)
s_cbranch_scc0 L_at_rs1
L_at_rsr1:
v_mfma_f32_16x16x32_bf16 v[32:35], a[64:67], a[0:3], v[128:131]
ds_read_b128 a[76:79], v3 offset:3072
v_cvt_pk_bf16_f32 v118, v76, v77
v_mfma_f32_16x16x32_bf16 v[40:43], a[64:67], a[16:19], v[132:135]
v_exp_f32 v78, v78
v_mfma_f32_16x16x32_bf16 v[48:51], a[64:67], a[32:35], v[136:139]
buffer_load_dwordx4 v1, s[8:11], s24 offen offset:128 sc1 lds
v_mfma_f32_16x16x32_bf16 v[56:59], a[64:67], a[48:51], v[140:143]
s_waitcnt lgkmcnt(2)
v_exp_f32 v79, v79
v_mfma_f32_16x16x32_bf16 v[36:39], a[68:71], a[0:3], v[128:131]
ds_read_b128 a[80:83], v3 offset:4096
v_cvt_pk_bf16_f32 v119, v78, v79
v_mfma_f32_16x16x32_bf16 v[44:47], a[68:71], a[16:19], v[132:135]
v_exp_f32 v80, v80
v_mfma_f32_16x16x32_bf16 v[52:55], a[68:71], a[32:35], v[136:139]
v_exp_f32 v81, v81
v_mfma_f32_16x16x32_bf16 v[60:63], a[68:71], a[48:51], v[140:143]
s_waitcnt lgkmcnt(2)
v_exp_f32 v82, v82
v_mfma_f32_16x16x32_bf16 v[32:35], a[72:75], a[4:7], v[32:35]
ds_read_b128 a[84:87], v3 offset:5120
v_cvt_pk_bf16_f32 v120, v80, v81
v_mfma_f32_16x16x32_bf16 v[40:43], a[72:75], a[20:23], v[40:43]
buffer_load_dwordx4 v1, s[8:11], s24 offen offset:2176 sc1 lds
v_mfma_f32_16x16x32_bf16 v[48:51], a[72:75], a[36:39], v[48:51]
v_exp_f32 v83, v83
v_mfma_f32_16x16x32_bf16 v[56:59], a[72:75], a[52:55], v[56:59]
s_waitcnt lgkmcnt(2)
v_exp_f32 v84, v84
v_mfma_f32_16x16x32_bf16 v[36:39], a[76:79], a[4:7], v[36:39]
ds_read_b128 a[88:91], v3 offset:6144
v_cvt_pk_bf16_f32 v121, v82, v83
v_mfma_f32_16x16x32_bf16 v[44:47], a[76:79], a[20:23], v[44:47]
s_add_u32 s46, s46, 1048576
v_exp_f32 v85, v85
v_mfma_f32_16x16x32_bf16 v[52:55], a[76:79], a[36:39], v[52:55]
v_exp_f32 v86, v86
v_mfma_f32_16x16x32_bf16 v[60:63], a[76:79], a[52:55], v[60:63]
s_waitcnt lgkmcnt(2)
v_exp_f32 v87, v87
v_mfma_f32_16x16x32_bf16 v[32:35], a[80:83], a[8:11], v[32:35]
ds_read_b128 a[92:95], v3 offset:7168
v_cvt_pk_bf16_f32 v122, v84, v85
v_mfma_f32_16x16x32_bf16 v[40:43], a[80:83], a[24:27], v[40:43]
v_exp_f32 v88, v88
v_mfma_f32_16x16x32_bf16 v[48:51], a[80:83], a[40:43], v[48:51]
s_add_u32 s47, s47, 32768
v_exp_f32 v89, v89
v_mfma_f32_16x16x32_bf16 v[56:59], a[80:83], a[56:59], v[56:59]
s_waitcnt lgkmcnt(2)
v_exp_f32 v90, v90
v_mfma_f32_16x16x32_bf16 v[36:39], a[84:87], a[8:11], v[36:39]
ds_read_b128 a[64:67], v2 offset:24576
v_cvt_pk_bf16_f32 v123, v86, v87
v_mfma_f32_16x16x32_bf16 v[44:47], a[84:87], a[24:27], v[44:47]
v_exp_f32 v91, v91
v_mfma_f32_16x16x32_bf16 v[52:55], a[84:87], a[40:43], v[52:55]
s_and_b32 s47, s47, 131071
v_exp_f32 v92, v92
v_mfma_f32_16x16x32_bf16 v[60:63], a[84:87], a[56:59], v[60:63]
s_waitcnt lgkmcnt(2)
v_exp_f32 v93, v93
v_mfma_f32_16x16x32_bf16 v[32:35], a[88:91], a[12:15], v[32:35]
ds_read_b128 a[68:71], v2 offset:25600
v_cvt_pk_bf16_f32 v124, v88, v89
v_mfma_f32_16x16x32_bf16 v[40:43], a[88:91], a[28:31], v[40:43]
v_exp_f32 v94, v94
v_mfma_f32_16x16x32_bf16 v[48:51], a[88:91], a[44:47], v[48:51]
v_exp_f32 v95, v95
v_mfma_f32_16x16x32_bf16 v[56:59], a[88:91], a[60:63], v[56:59]
s_waitcnt lgkmcnt(2)
v_cvt_pk_bf16_f32 v125, v90, v91
v_cvt_pk_bf16_f32 v126, v92, v93
v_mfma_f32_16x16x32_bf16 v[36:39], a[92:95], a[12:15], v[36:39]
ds_read_b128 a[72:75], v2 offset:26624
v_cvt_pk_bf16_f32 v127, v94, v95
v_mfma_f32_16x16x32_bf16 v[44:47], a[92:95], a[28:31], v[44:47]
s_cmp_lt_u32 s43, s44
v_mov_b32 v4, v2
v_mov_b32 v2, v3
v_mfma_f32_16x16x32_bf16 v[52:55], a[92:95], a[44:47], v[52:55]
v_add_u32 v3, 32768, v3
v_and_b32 v3, 131071, v3
v_mfma_f32_16x16x32_bf16 v[60:63], a[92:95], a[60:63], v[60:63]
s_waitcnt lgkmcnt(2)
s_cbranch_scc1 L_at_loop
L_at_last:
v_mfma_f32_16x16x32_bf16 a[224:227], a[240:243], v[112:115], a[224:227]
s_lshl_b32 s61, s41, 4
v_mfma_f32_16x16x32_bf16 a[228:231], a[240:243], v[116:119], a[228:231]
v_mfma_f32_16x16x32_bf16 a[232:235], a[240:243], v[120:123], a[232:235]
v_mfma_f32_16x16x32_bf16 a[236:239], a[240:243], v[124:127], a[236:239]
v_cndmask_b32 v32, v8, v32, s[64:65]
v_cndmask_b32 v33, v8, v33, s[66:67]
v_mfma_f32_16x16x32_bf16 a[96:99], a[64:67], v[112:115], a[96:99]
ds_read_b128 a[76:79], v4 offset:27648
v_cndmask_b32 v34, v8, v34, s[68:69]
v_mfma_f32_16x16x32_bf16 a[100:103], a[64:67], v[116:119], a[100:103]
v_cndmask_b32 v35, v8, v35, s[70:71]
v_cndmask_b32 v36, v8, v36, s[72:73]
v_mfma_f32_16x16x32_bf16 a[104:107], a[64:67], v[120:123], a[104:107]
s_add_u32 s61, s61, s17
v_cndmask_b32 v37, v8, v37, s[74:75]
v_cndmask_b32 v38, v8, v38, s[76:77]
v_mfma_f32_16x16x32_bf16 a[108:111], a[64:67], v[124:127], a[108:111]
s_waitcnt lgkmcnt(2)
v_cndmask_b32 v39, v8, v39, s[78:79]
v_max3_f32 v16, v32, v33, v34
v_mfma_f32_16x16x32_bf16 a[112:115], a[68:71], v[112:115], a[112:115]
ds_read_b128 a[80:83], v4 offset:28672
v_max3_f32 v16, v16, v35, v40
v_mfma_f32_16x16x32_bf16 a[116:119], a[68:71], v[116:119], a[116:119]
v_max3_f32 v16, v16, v41, v42
v_max3_f32 v16, v16, v43, v48
v_mfma_f32_16x16x32_bf16 a[120:123], a[68:71], v[120:123], a[120:123]
v_max3_f32 v16, v16, v49, v50
v_max3_f32 v16, v16, v51, v56
v_mfma_f32_16x16x32_bf16 a[124:127], a[68:71], v[124:127], a[124:127]
s_waitcnt lgkmcnt(2)
v_max3_f32 v16, v16, v57, v58
v_max3_f32 v16, v16, v59, v36
v_mfma_f32_16x16x32_bf16 a[128:131], a[72:75], v[112:115], a[128:131]
ds_read_b128 a[84:87], v4 offset:29696
v_max3_f32 v16, v16, v37, v38
v_mfma_f32_16x16x32_bf16 a[132:135], a[72:75], v[116:119], a[132:135]
v_max3_f32 v16, v16, v39, v44
v_max3_f32 v16, v16, v45, v46
v_mfma_f32_16x16x32_bf16 a[136:139], a[72:75], v[120:123], a[136:139]
v_max3_f32 v16, v16, v47, v52
v_max3_f32 v16, v16, v53, v54
v_mfma_f32_16x16x32_bf16 a[140:143], a[72:75], v[124:127], a[140:143]
s_waitcnt lgkmcnt(2)
v_max3_f32 v16, v16, v55, v60
v_max3_f32 v16, v16, v61, v62
v_mfma_f32_16x16x32_bf16 a[144:147], a[76:79], v[112:115], a[144:147]
ds_read_b128 a[88:91], v4 offset:30720
v_max_f32 v16, v16, v63
v_mfma_f32_16x16x32_bf16 a[148:151], a[76:79], v[116:119], a[148:151]
v_cmp_lt_f32 vcc, s54, v16
v_mfma_f32_16x16x32_bf16 a[152:155], a[76:79], v[120:123], a[152:155]
s_lshl_b32 s61, s61, 5
s_cbranch_vccnz L_at_up2
L_at_upr2:
v_mfma_f32_16x16x32_bf16 a[156:159], a[76:79], v[124:127], a[156:159]
s_waitcnt lgkmcnt(2)
v_exp_f32 v32, v32
v_mfma_f32_16x16x32_bf16 a[160:163], a[80:83], v[112:115], a[160:163]
ds_read_b128 a[92:95], v4 offset:31744
v_mfma_f32_16x16x32_bf16 a[164:167], a[80:83], v[116:119], a[164:167]
v_exp_f32 v33, v33
v_mfma_f32_16x16x32_bf16 a[168:171], a[80:83], v[120:123], a[168:171]
v_exp_f32 v34, v34
v_mfma_f32_16x16x32_bf16 a[172:175], a[80:83], v[124:127], a[172:175]
s_waitcnt lgkmcnt(2)
v_exp_f32 v35, v35
v_mfma_f32_16x16x32_bf16 a[176:179], a[84:87], v[112:115], a[176:179]
ds_read_b128 a[64:67], v2 offset:16384
v_cvt_pk_bf16_f32 v96, v32, v33
v_mfma_f32_16x16x32_bf16 a[180:183], a[84:87], v[116:119], a[180:183]
v_exp_f32 v36, v36
v_mfma_f32_16x16x32_bf16 a[184:187], a[84:87], v[120:123], a[184:187]
v_exp_f32 v37, v37
v_mfma_f32_16x16x32_bf16 a[188:191], a[84:87], v[124:127], a[188:191]
s_waitcnt lgkmcnt(2)
v_exp_f32 v38, v38
v_mfma_f32_16x16x32_bf16 a[192:195], a[88:91], v[112:115], a[192:195]
ds_read_b128 a[68:71], v2 offset:17408
v_cvt_pk_bf16_f32 v97, v34, v35
v_mfma_f32_16x16x32_bf16 a[196:199], a[88:91], v[116:119], a[196:199]
s_add_u32 s61, s61, s42
v_exp_f32 v39, v39
v_mfma_f32_16x16x32_bf16 a[200:203], a[88:91], v[120:123], a[200:203]
v_exp_f32 v40, v40
v_mfma_f32_16x16x32_bf16 a[204:207], a[88:91], v[124:127], a[204:207]
s_waitcnt lgkmcnt(2)
v_exp_f32 v41, v41
v_mfma_f32_16x16x32_bf16 a[208:211], a[92:95], v[112:115], a[208:211]
ds_read_b128 a[72:75], v2 offset:18432
v_cvt_pk_bf16_f32 v98, v36, v37
v_mfma_f32_16x16x32_bf16 a[212:215], a[92:95], v[116:119], a[212:215]
v_exp_f32 v42, v42
v_mfma_f32_16x16x32_bf16 a[216:219], a[92:95], v[120:123], a[216:219]
v_exp_f32 v43, v43
v_mfma_f32_16x16x32_bf16 a[220:223], a[92:95], v[124:127], a[220:223]
s_waitcnt lgkmcnt(2)
s_cmp_eq_u32 s48, 0
s_cbranch_scc0 L_at_rs2
L_at_rsr2:
v_mfma_f32_16x16x32_bf16 v[64:67], a[64:67], a[0:3], v[128:131]
ds_read_b128 a[76:79], v2 offset:19456
v_cvt_pk_bf16_f32 v99, v38, v39
v_mfma_f32_16x16x32_bf16 v[72:75], a[64:67], a[16:19], v[132:135]
v_exp_f32 v44, v44
v_mfma_f32_16x16x32_bf16 v[80:83], a[64:67], a[32:35], v[136:139]
v_exp_f32 v45, v45
v_mfma_f32_16x16x32_bf16 v[88:91], a[64:67], a[48:51], v[140:143]
s_waitcnt lgkmcnt(2)
v_exp_f32 v46, v46
v_mfma_f32_16x16x32_bf16 v[68:71], a[68:71], a[0:3], v[128:131]
ds_read_b128 a[80:83], v2 offset:20480
v_cvt_pk_bf16_f32 v100, v40, v41
v_mfma_f32_16x16x32_bf16 v[76:79], a[68:71], a[16:19], v[132:135]
v_exp_f32 v47, v47
v_mfma_f32_16x16x32_bf16 v[84:87], a[68:71], a[32:35], v[136:139]
s_lshl_b32 s61, s61, 12
v_exp_f32 v48, v48
v_mfma_f32_16x16x32_bf16 v[92:95], a[68:71], a[48:51], v[140:143]
s_waitcnt lgkmcnt(2)
v_exp_f32 v49, v49
v_mfma_f32_16x16x32_bf16 v[64:67], a[72:75], a[4:7], v[64:67]
ds_read_b128 a[84:87], v2 offset:21504
v_cvt_pk_bf16_f32 v101, v42, v43
v_mfma_f32_16x16x32_bf16 v[72:75], a[72:75], a[20:23], v[72:75]
v_exp_f32 v50, v50
v_mfma_f32_16x16x32_bf16 v[80:83], a[72:75], a[36:39], v[80:83]
v_exp_f32 v51, v51
v_mfma_f32_16x16x32_bf16 v[88:91], a[72:75], a[52:55], v[88:91]
s_waitcnt lgkmcnt(2)
v_exp_f32 v52, v52
v_mfma_f32_16x16x32_bf16 v[68:71], a[76:79], a[4:7], v[68:71]
ds_read_b128 a[88:91], v2 offset:22528
v_cvt_pk_bf16_f32 v102, v44, v45
v_mfma_f32_16x16x32_bf16 v[76:79], a[76:79], a[20:23], v[76:79]
v_exp_f32 v53, v53
v_mfma_f32_16x16x32_bf16 v[84:87], a[76:79], a[36:39], v[84:87]
v_exp_f32 v54, v54
v_mfma_f32_16x16x32_bf16 v[92:95], a[76:79], a[52:55], v[92:95]
s_waitcnt lgkmcnt(2)
v_exp_f32 v55, v55
v_mfma_f32_16x16x32_bf16 v[64:67], a[80:83], a[8:11], v[64:67]
ds_read_b128 a[92:95], v2 offset:23552
v_cvt_pk_bf16_f32 v103, v46, v47
v_mfma_f32_16x16x32_bf16 v[72:75], a[80:83], a[24:27], v[72:75]
s_add_u32 s61, s61, 67108864
v_exp_f32 v56, v56
v_mfma_f32_16x16x32_bf16 v[80:83], a[80:83], a[40:43], v[80:83]
v_exp_f32 v57, v57
v_mfma_f32_16x16x32_bf16 v[88:91], a[80:83], a[56:59], v[88:91]
s_waitcnt lgkmcnt(2)
v_exp_f32 v58, v58
v_mfma_f32_16x16x32_bf16 v[68:71], a[84:87], a[8:11], v[68:71]
ds_read_b128 a[64:67], v2 offset:8192
v_cvt_pk_bf16_f32 v104, v48, v49
v_mfma_f32_16x16x32_bf16 v[76:79], a[84:87], a[24:27], v[76:79]
v_exp_f32 v59, v59
v_mfma_f32_16x16x32_bf16 v[84:87], a[84:87], a[40:43], v[84:87]
v_exp_f32 v60, v60
v_mfma_f32_16x16x32_bf16 v[92:95], a[84:87], a[56:59], v[92:95]
s_waitcnt lgkmcnt(2)
v_exp_f32 v61, v61
v_mfma_f32_16x16x32_bf16 v[64:67], a[88:91], a[12:15], v[64:67]
ds_read_b128 a[68:71], v2 offset:9216
v_cvt_pk_bf16_f32 v105, v50, v51
v_mfma_f32_16x16x32_bf16 v[72:75], a[88:91], a[28:31], v[72:75]
v_exp_f32 v62, v62
v_mfma_f32_16x16x32_bf16 v[80:83], a[88:91], a[44:47], v[80:83]
v_exp_f32 v63, v63
v_mfma_f32_16x16x32_bf16 v[88:91], a[88:91], a[60:63], v[88:91]
s_waitcnt lgkmcnt(2)
v_cvt_pk_bf16_f32 v106, v52, v53
v_cvt_pk_bf16_f32 v107, v54, v55
v_mfma_f32_16x16x32_bf16 v[68:71], a[92:95], a[12:15], v[68:71]
ds_read_b128 a[72:75], v2 offset:10240
v_cvt_pk_bf16_f32 v108, v56, v57
v_mfma_f32_16x16x32_bf16 v[76:79], a[92:95], a[28:31], v[76:79]
v_cvt_pk_bf16_f32 v109, v58, v59
v_cvt_pk_bf16_f32 v110, v60, v61
v_mfma_f32_16x16x32_bf16 v[84:87], a[92:95], a[44:47], v[84:87]
v_cvt_pk_bf16_f32 v111, v62, v63
v_mfma_f32_16x16x32_bf16 v[92:95], a[92:95], a[60:63], v[92:95]
s_waitcnt lgkmcnt(2)
s_waitcnt vmcnt(8)
s_barrier
v_mfma_f32_16x16x32_bf16 a[224:227], a[240:243], v[96:99], a[224:227]
s_add_u32 s24, s46, 4096
s_add_u32 m0, s47, 0
v_mfma_f32_16x16x32_bf16 a[228:231], a[240:243], v[100:103], a[228:231]
buffer_load_dwordx4 v1, s[8:11], s46 offen sc1 lds
v_mfma_f32_16x16x32_bf16 a[232:235], a[240:243], v[104:107], a[232:235]
buffer_load_dwordx4 v1, s[8:11], s46 offen offset:2048 sc1 lds
v_mfma_f32_16x16x32_bf16 a[236:239], a[240:243], v[108:111], a[236:239]
v_cndmask_b32 v64, v8, v64, s[80:81]
v_cndmask_b32 v65, v8, v65, s[82:83]
v_mfma_f32_16x16x32_bf16 a[96:99], a[64:67], v[96:99], a[96:99]
ds_read_b128 a[76:79], v2 offset:11264
v_cndmask_b32 v66, v8, v66, s[84:85]
v_mfma_f32_16x16x32_bf16 a[100:103], a[64:67], v[100:103], a[100:103]
s_add_u32 m0, s47, 896
v_cndmask_b32 v67, v8, v67, s[86:87]
v_cndmask_b32 v68, v8, v68, s[88:89]
v_mfma_f32_16x16x32_bf16 a[104:107], a[64:67], v[104:107], a[104:107]
buffer_load_dwordx4 v1, s[8:11], s46 offen offset:128 sc1 lds
v_cndmask_b32 v69, v8, v69, s[90:91]
v_mfma_f32_16x16x32_bf16 a[108:111], a[64:67], v[108:111], a[108:111]
s_waitcnt lgkmcnt(2)
v_cndmask_b32 v70, v8, v70, s[92:93]
v_cndmask_b32 v71, v8, v71, s[94:95]
v_mfma_f32_16x16x32_bf16 a[112:115], a[68:71], v[96:99], a[112:115]
ds_read_b128 a[80:83], v2 offset:12288
v_max3_f32 v16, v64, v65, v66
v_mfma_f32_16x16x32_bf16 a[116:119], a[68:71], v[100:103], a[116:119]
v_max3_f32 v16, v16, v67, v72
v_max3_f32 v16, v16, v73, v74
v_mfma_f32_16x16x32_bf16 a[120:123], a[68:71], v[104:107], a[120:123]
buffer_load_dwordx4 v1, s[8:11], s46 offen offset:2176 sc1 lds
v_max3_f32 v16, v16, v75, v80
v_mfma_f32_16x16x32_bf16 a[124:127], a[68:71], v[108:111], a[124:127]
s_waitcnt lgkmcnt(2)
v_max3_f32 v16, v16, v81, v82
v_max3_f32 v16, v16, v83, v88
v_mfma_f32_16x16x32_bf16 a[128:131], a[72:75], v[96:99], a[128:131]
ds_read_b128 a[84:87], v2 offset:13312
v_max3_f32 v16, v16, v89, v90
v_mfma_f32_16x16x32_bf16 a[132:135], a[72:75], v[100:103], a[132:135]
v_max3_f32 v16, v16, v91, v68
v_max3_f32 v16, v16, v69, v70
v_mfma_f32_16x16x32_bf16 a[136:139], a[72:75], v[104:107], a[136:139]
s_add_u32 m0, s47, 4096
v_max3_f32 v16, v16, v71, v76
v_max3_f32 v16, v16, v77, v78
v_mfma_f32_16x16x32_bf16 a[140:143], a[72:75], v[108:111], a[140:143]
s_waitcnt lgkmcnt(2)
v_max3_f32 v16, v16, v79, v84
v_max3_f32 v16, v16, v85, v86
v_mfma_f32_16x16x32_bf16 a[144:147], a[76:79], v[96:99], a[144:147]
ds_read_b128 a[88:91], v2 offset:14336
v_max3_f32 v16, v16, v87, v92
v_mfma_f32_16x16x32_bf16 a[148:151], a[76:79], v[100:103], a[148:151]
v_max3_f32 v16, v16, v93, v94
v_max_f32 v16, v16, v95
v_cmp_lt_f32 vcc, s54, v16
v_mfma_f32_16x16x32_bf16 a[152:155], a[76:79], v[104:107], a[152:155]
buffer_load_dwordx4 v1, s[8:11], s24 offen sc1 lds
s_cbranch_vccnz L_at_up3
L_at_upr3:
v_mfma_f32_16x16x32_bf16 a[156:159], a[76:79], v[108:111], a[156:159]
s_waitcnt lgkmcnt(2)
v_exp_f32 v64, v64
v_mfma_f32_16x16x32_bf16 a[160:163], a[80:83], v[96:99], a[160:163]
ds_read_b128 a[92:95], v2 offset:15360
v_exp_f32 v65, v65
v_mfma_f32_16x16x32_bf16 a[164:167], a[80:83], v[100:103], a[164:167]
v_exp_f32 v66, v66
v_cvt_pk_bf16_f32 v112, v64, v65
v_mfma_f32_16x16x32_bf16 a[168:171], a[80:83], v[104:107], a[168:171]
buffer_load_dwordx4 v1, s[8:11], s24 offen offset:2048 sc1 lds
v_exp_f32 v67, v67
v_mfma_f32_16x16x32_bf16 a[172:175], a[80:83], v[108:111], a[172:175]
s_waitcnt lgkmcnt(2)
v_exp_f32 v68, v68
v_cvt_pk_bf16_f32 v113, v66, v67
v_mfma_f32_16x16x32_bf16 a[176:179], a[84:87], v[96:99], a[176:179]
ds_read_b128 a[64:67], v3
v_exp_f32 v69, v69
v_mfma_f32_16x16x32_bf16 a[180:183], a[84:87], v[100:103], a[180:183]
v_exp_f32 v70, v70
v_cvt_pk_bf16_f32 v114, v68, v69
v_mfma_f32_16x16x32_bf16 a[184:187], a[84:87], v[104:107], a[184:187]
s_add_u32 m0, s47, 4992
v_exp_f32 v71, v71
v_mfma_f32_16x16x32_bf16 a[188:191], a[84:87], v[108:111], a[188:191]
s_waitcnt lgkmcnt(2)
v_exp_f32 v72, v72
v_cvt_pk_bf16_f32 v115, v70, v71
v_mfma_f32_16x16x32_bf16 a[192:195], a[88:91], v[96:99], a[192:195]
ds_read_b128 a[68:71], v3 offset:1024
v_exp_f32 v73, v73
v_mfma_f32_16x16x32_bf16 a[196:199], a[88:91], v[100:103], a[196:199]
buffer_load_dwordx4 v1, s[8:11], s24 offen offset:128 sc1 lds
v_exp_f32 v74, v74
v_mfma_f32_16x16x32_bf16 a[200:203], a[88:91], v[104:107], a[200:203]
v_exp_f32 v75, v75
v_cvt_pk_bf16_f32 v116, v72, v73
v_mfma_f32_16x16x32_bf16 a[204:207], a[88:91], v[108:111], a[204:207]
s_waitcnt lgkmcnt(2)
v_exp_f32 v76, v76
v_cvt_pk_bf16_f32 v117, v74, v75
v_mfma_f32_16x16x32_bf16 a[208:211], a[92:95], v[96:99], a[208:211]
ds_read_b128 a[72:75], v3 offset:2048
v_exp_f32 v77, v77
v_mfma_f32_16x16x32_bf16 a[212:215], a[92:95], v[100:103], a[212:215]
buffer_load_dwordx4 v1, s[8:11], s24 offen offset:2176 sc1 lds
v_exp_f32 v78, v78
v_mfma_f32_16x16x32_bf16 a[216:219], a[92:95], v[104:107], a[216:219]
v_exp_f32 v79, v79
v_cvt_pk_bf16_f32 v118, v76, v77
v_mfma_f32_16x16x32_bf16 a[220:223], a[92:95], v[108:111], a[220:223]
s_waitcnt lgkmcnt(2)
s_cmp_eq_u32 s48, 0
s_cbranch_scc0 L_at_rs3
L_at_rsr3:
v_cvt_pk_bf16_f32 v119, v78, v79
v_mfma_f32_16x16x32_bf16 v[40:43], a[64:67], a[16:19], v[132:135]
ds_read_b128 a[76:79], v3 offset:3072
v_mfma_f32_16x16x32_bf16 v[48:51], a[64:67], a[32:35], v[136:139]
v_exp_f32 v80, v80
v_mfma_f32_16x16x32_bf16 v[56:59], a[64:67], a[48:51], v[140:143]
s_waitcnt lgkmcnt(2)
v_exp_f32 v81, v81
v_mfma_f32_16x16x32_bf16 v[44:47], a[68:71], a[16:19], v[132:135]
ds_read_b128 a[80:83], v3 offset:4096
v_exp_f32 v82, v82
v_mfma_f32_16x16x32_bf16 v[52:55], a[68:71], a[32:35], v[136:139]
s_add_u32 s46, s46, 1048576
v_exp_f32 v83, v83
v_mfma_f32_16x16x32_bf16 v[60:63], a[68:71], a[48:51], v[140:143]
s_waitcnt lgkmcnt(2)
v_exp_f32 v84, v84
v_mfma_f32_16x16x32_bf16 v[40:43], a[72:75], a[20:23], v[40:43]
ds_read_b128 a[84:87], v3 offset:5120
v_cvt_pk_bf16_f32 v120, v80, v81
v_mfma_f32_16x16x32_bf16 v[48:51], a[72:75], a[36:39], v[48:51]
v_exp_f32 v85, v85
v_mfma_f32_16x16x32_bf16 v[56:59], a[72:75], a[52:55], v[56:59]
s_waitcnt lgkmcnt(2)
v_exp_f32 v86, v86
v_mfma_f32_16x16x32_bf16 v[44:47], a[76:79], a[20:23], v[44:47]
ds_read_b128 a[88:91], v3 offset:6144
v_cvt_pk_bf16_f32 v121, v82, v83
v_mfma_f32_16x16x32_bf16 v[52:55], a[76:79], a[36:39], v[52:55]
s_add_u32 s47, s47, 32768
v_exp_f32 v87, v87
v_mfma_f32_16x16x32_bf16 v[60:63], a[76:79], a[52:55], v[60:63]
s_waitcnt lgkmcnt(2)
v_exp_f32 v88, v88
v_mfma_f32_16x16x32_bf16 v[40:43], a[80:83], a[24:27], v[40:43]
ds_read_b128 a[92:95], v3 offset:7168
v_cvt_pk_bf16_f32 v122, v84, v85
v_mfma_f32_16x16x32_bf16 v[48:51], a[80:83], a[40:43], v[48:51]
v_exp_f32 v89, v89
v_mfma_f32_16x16x32_bf16 v[56:59], a[80:83], a[56:59], v[56:59]
s_waitcnt lgkmcnt(2)
v_exp_f32 v90, v90
v_mfma_f32_16x16x32_bf16 v[44:47], a[84:87], a[24:27], v[44:47]
ds_read_b128 a[64:67], v2 offset:24576
v_cvt_pk_bf16_f32 v123, v86, v87
v_mfma_f32_16x16x32_bf16 v[52:55], a[84:87], a[40:43], v[52:55]
s_and_b32 s47, s47, 131071
v_exp_f32 v91, v91
v_mfma_f32_16x16x32_bf16 v[60:63], a[84:87], a[56:59], v[60:63]
s_waitcnt lgkmcnt(2)
v_exp_f32 v92, v92
v_mfma_f32_16x16x32_bf16 v[40:43], a[88:91], a[28:31], v[40:43]
ds_read_b128 a[68:71], v2 offset:25600
v_cvt_pk_bf16_f32 v124, v88, v89
v_mfma_f32_16x16x32_bf16 v[48:51], a[88:91], a[44:47], v[48:51]
v_exp_f32 v93, v93
v_mfma_f32_16x16x32_bf16 v[56:59], a[88:91], a[60:63], v[56:59]
s_waitcnt lgkmcnt(2)
v_exp_f32 v94, v94
v_mfma_f32_16x16x32_bf16 v[44:47], a[92:95], a[28:31], v[44:47]
ds_read_b128 a[72:75], v2 offset:26624
v_cvt_pk_bf16_f32 v125, v90, v91
v_mfma_f32_16x16x32_bf16 v[52:55], a[92:95], a[44:47], v[52:55]
v_exp_f32 v95, v95
v_mfma_f32_16x16x32_bf16 v[60:63], a[92:95], a[60:63], v[60:63]
s_waitcnt lgkmcnt(2)
v_cvt_pk_bf16_f32 v126, v92, v93
v_cvt_pk_bf16_f32 v127, v94, v95
v_mov_b32 v4, v2
v_mov_b32 v2, v3
v_add_u32 v3, 32768, v3
v_and_b32 v3, 131071, v3
v_mfma_f32_16x16x32_bf16 a[224:227], a[240:243], v[112:115], a[224:227]
s_lshl_b32 s46, s42, 14
v_mfma_f32_16x16x32_bf16 a[228:231], a[240:243], v[116:119], a[228:231]
v_mfma_f32_16x16x32_bf16 a[232:235], a[240:243], v[120:123], a[232:235]
v_mfma_f32_16x16x32_bf16 a[236:239], a[240:243], v[124:127], a[236:239]
v_cndmask_b32 v40, v8, v40, s[64:65]
v_cndmask_b32 v41, v8, v41, s[66:67]
v_mfma_f32_16x16x32_bf16 a[96:99], a[64:67], v[112:115], a[96:99]
ds_read_b128 a[76:79], v4 offset:27648
v_cndmask_b32 v42, v8, v42, s[68:69]
v_mfma_f32_16x16x32_bf16 a[100:103], a[64:67], v[116:119], a[100:103]
v_cndmask_b32 v43, v8, v43, s[70:71]
v_cndmask_b32 v44, v8, v44, s[72:73]
v_mfma_f32_16x16x32_bf16 a[104:107], a[64:67], v[120:123], a[104:107]
v_cndmask_b32 v45, v8, v45, s[74:75]
v_cndmask_b32 v46, v8, v46, s[76:77]
v_mfma_f32_16x16x32_bf16 a[108:111], a[64:67], v[124:127], a[108:111]
s_waitcnt lgkmcnt(2)
v_cndmask_b32 v47, v8, v47, s[78:79]
v_max3_f32 v16, v40, v41, v42
v_mfma_f32_16x16x32_bf16 a[112:115], a[68:71], v[112:115], a[112:115]
ds_read_b128 a[80:83], v4 offset:28672
v_max3_f32 v16, v16, v43, v48
v_mfma_f32_16x16x32_bf16 a[116:119], a[68:71], v[116:119], a[116:119]
v_max3_f32 v16, v16, v49, v50
v_max3_f32 v16, v16, v51, v56
v_mfma_f32_16x16x32_bf16 a[120:123], a[68:71], v[120:123], a[120:123]
v_max3_f32 v16, v16, v57, v58
v_max3_f32 v16, v16, v59, v44
v_mfma_f32_16x16x32_bf16 a[124:127], a[68:71], v[124:127], a[124:127]
s_waitcnt lgkmcnt(2)
v_max3_f32 v16, v16, v45, v46
v_max3_f32 v16, v16, v47, v52
v_mfma_f32_16x16x32_bf16 a[128:131], a[72:75], v[112:115], a[128:131]
ds_read_b128 a[84:87], v4 offset:29696
v_max3_f32 v16, v16, v53, v54
v_mfma_f32_16x16x32_bf16 a[132:135], a[72:75], v[116:119], a[132:135]
s_add_u32 s46, s46, 0
v_max3_f32 v16, v16, v55, v60
v_max3_f32 v16, v16, v61, v62
v_mfma_f32_16x16x32_bf16 a[136:139], a[72:75], v[120:123], a[136:139]
v_max_f32 v16, v16, v63
v_cmp_lt_f32 vcc, s54, v16
v_mfma_f32_16x16x32_bf16 a[140:143], a[72:75], v[124:127], a[140:143]
s_waitcnt lgkmcnt(2)
s_cbranch_vccnz L_at_up4
L_at_upr4:
v_mfma_f32_16x16x32_bf16 a[144:147], a[76:79], v[112:115], a[144:147]
ds_read_b128 a[88:91], v4 offset:30720
v_mfma_f32_16x16x32_bf16 a[148:151], a[76:79], v[116:119], a[148:151]
v_exp_f32 v40, v40
v_mfma_f32_16x16x32_bf16 a[152:155], a[76:79], v[120:123], a[152:155]
v_exp_f32 v41, v41
v_mfma_f32_16x16x32_bf16 a[156:159], a[76:79], v[124:127], a[156:159]
s_waitcnt lgkmcnt(2)
v_exp_f32 v42, v42
v_mfma_f32_16x16x32_bf16 a[160:163], a[80:83], v[112:115], a[160:163]
ds_read_b128 a[92:95], v4 offset:31744
v_cvt_pk_bf16_f32 v100, v40, v41
v_mfma_f32_16x16x32_bf16 a[164:167], a[80:83], v[116:119], a[164:167]
v_exp_f32 v43, v43
v_mfma_f32_16x16x32_bf16 a[168:171], a[80:83], v[120:123], a[168:171]
v_exp_f32 v44, v44
v_mfma_f32_16x16x32_bf16 a[172:175], a[80:83], v[124:127], a[172:175]
s_waitcnt lgkmcnt(2)
v_exp_f32 v45, v45
v_mfma_f32_16x16x32_bf16 a[176:179], a[84:87], v[112:115], a[176:179]
ds_read_b128 a[64:67], v2 offset:16384
v_cvt_pk_bf16_f32 v101, v42, v43
v_mfma_f32_16x16x32_bf16 a[180:183], a[84:87], v[116:119], a[180:183]
v_exp_f32 v46, v46
v_mfma_f32_16x16x32_bf16 a[184:187], a[84:87], v[120:123], a[184:187]
v_exp_f32 v47, v47
v_mfma_f32_16x16x32_bf16 a[188:191], a[84:87], v[124:127], a[188:191]
s_waitcnt lgkmcnt(2)
v_exp_f32 v48, v48
v_mfma_f32_16x16x32_bf16 a[192:195], a[88:91], v[112:115], a[192:195]
ds_read_b128 a[68:71], v2 offset:17408
v_cvt_pk_bf16_f32 v102, v44, v45
v_mfma_f32_16x16x32_bf16 a[196:199], a[88:91], v[116:119], a[196:199]
v_exp_f32 v49, v49
v_mfma_f32_16x16x32_bf16 a[200:203], a[88:91], v[120:123], a[200:203]
s_cmp_lt_u32 s63, 8
s_cselect_b32 s46, s46, 536870912
v_cvt_pk_bf16_f32 v103, v46, v47
v_mfma_f32_16x16x32_bf16 a[204:207], a[88:91], v[124:127], a[204:207]
s_waitcnt lgkmcnt(2)
v_exp_f32 v50, v50
v_mfma_f32_16x16x32_bf16 a[208:211], a[92:95], v[112:115], a[208:211]
ds_read_b128 a[72:75], v2 offset:18432
v_cvt_pk_bf16_f32 v104, v48, v49
v_mfma_f32_16x16x32_bf16 a[212:215], a[92:95], v[116:119], a[212:215]
v_exp_f32 v51, v51
v_mfma_f32_16x16x32_bf16 a[216:219], a[92:95], v[120:123], a[216:219]
v_exp_f32 v52, v52
v_mfma_f32_16x16x32_bf16 a[220:223], a[92:95], v[124:127], a[220:223]
s_waitcnt lgkmcnt(2)
s_cmp_eq_u32 s48, 0
s_cbranch_scc0 L_at_rs4
L_at_rsr4:
v_mfma_f32_16x16x32_bf16 v[72:75], a[64:67], a[16:19], v[132:135]
ds_read_b128 a[76:79], v2 offset:19456
v_cvt_pk_bf16_f32 v105, v50, v51
v_mfma_f32_16x16x32_bf16 v[80:83], a[64:67], a[32:35], v[136:139]
v_exp_f32 v53, v53
v_mfma_f32_16x16x32_bf16 v[88:91], a[64:67], a[48:51], v[140:143]
s_waitcnt lgkmcnt(2)
v_exp_f32 v54, v54
v_mfma_f32_16x16x32_bf16 v[76:79], a[68:71], a[16:19], v[132:135]
ds_read_b128 a[80:83], v2 offset:20480
v_cvt_pk_bf16_f32 v106, v52, v53
v_mfma_f32_16x16x32_bf16 v[84:87], a[68:71], a[32:35], v[136:139]
v_exp_f32 v55, v55
v_mfma_f32_16x16x32_bf16 v[92:95], a[68:71], a[48:51], v[140:143]
s_waitcnt lgkmcnt(2)
v_exp_f32 v56, v56
v_mfma_f32_16x16x32_bf16 v[72:75], a[72:75], a[20:23], v[72:75]
ds_read_b128 a[84:87], v2 offset:21504
v_cvt_pk_bf16_f32 v107, v54, v55
v_mfma_f32_16x16x32_bf16 v[80:83], a[72:75], a[36:39], v[80:83]
v_exp_f32 v57, v57
v_mfma_f32_16x16x32_bf16 v[88:91], a[72:75], a[52:55], v[88:91]
s_waitcnt lgkmcnt(2)
v_exp_f32 v58, v58
v_mfma_f32_16x16x32_bf16 v[76:79], a[76:79], a[20:23], v[76:79]
ds_read_b128 a[88:91], v2 offset:22528
v_cvt_pk_bf16_f32 v108, v56, v57
v_mfma_f32_16x16x32_bf16 v[84:87], a[76:79], a[36:39], v[84:87]
v_exp_f32 v59, v59
v_mfma_f32_16x16x32_bf16 v[92:95], a[76:79], a[52:55], v[92:95]
s_waitcnt lgkmcnt(2)
v_exp_f32 v60, v60
v_mfma_f32_16x16x32_bf16 v[72:75], a[80:83], a[24:27], v[72:75]
ds_read_b128 a[92:95], v2 offset:23552
v_cvt_pk_bf16_f32 v109, v58, v59
v_mfma_f32_16x16x32_bf16 v[80:83], a[80:83], a[40:43], v[80:83]
v_exp_f32 v61, v61
v_mfma_f32_16x16x32_bf16 v[88:91], a[80:83], a[56:59], v[88:91]
s_waitcnt lgkmcnt(2)
v_exp_f32 v62, v62
v_mfma_f32_16x16x32_bf16 v[76:79], a[84:87], a[24:27], v[76:79]
ds_read_b128 a[64:67], v2 offset:8192
v_cvt_pk_bf16_f32 v110, v60, v61
v_mfma_f32_16x16x32_bf16 v[84:87], a[84:87], a[40:43], v[84:87]
v_exp_f32 v63, v63
v_mfma_f32_16x16x32_bf16 v[92:95], a[84:87], a[56:59], v[92:95]
s_waitcnt lgkmcnt(2)
v_cvt_pk_bf16_f32 v111, v62, v63
v_mfma_f32_16x16x32_bf16 v[72:75], a[88:91], a[28:31], v[72:75]
ds_read_b128 a[68:71], v2 offset:9216
v_mfma_f32_16x16x32_bf16 v[80:83], a[88:91], a[44:47], v[80:83]
v_mfma_f32_16x16x32_bf16 v[88:91], a[88:91], a[60:63], v[88:91]
s_waitcnt lgkmcnt(2)
v_mfma_f32_16x16x32_bf16 v[76:79], a[92:95], a[28:31], v[76:79]
ds_read_b128 a[72:75], v2 offset:10240
v_mfma_f32_16x16x32_bf16 v[84:87], a[92:95], a[44:47], v[84:87]
v_mfma_f32_16x16x32_bf16 v[92:95], a[92:95], a[60:63], v[92:95]
s_waitcnt lgkmcnt(2)
s_waitcnt vmcnt(8)
s_barrier
s_add_u32 s25, s61, 0
v_mov_b32 v19, 1
s_mov_b64 exec, 1
buffer_store_dword v19, v6, s[8:11], s60 offen sc1
s_mov_b64 exec, -1
v_mfma_f32_16x16x32_bf16 a[228:231], a[240:243], v[100:103], a[228:231]
s_add_u32 s24, s46, 4096
v_mfma_f32_16x16x32_bf16 a[232:235], a[240:243], v[104:107], a[232:235]
v_mfma_f32_16x16x32_bf16 a[236:239], a[240:243], v[108:111], a[236:239]
s_add_u32 m0, s47, 0
v_mfma_f32_16x16x32_bf16 a[100:103], a[64:67], v[100:103], a[100:103]
ds_read_b128 a[76:79], v2 offset:11264
v_cndmask_b32 v72, v8, v72, s[80:81]
v_mfma_f32_16x16x32_bf16 a[104:107], a[64:67], v[104:107], a[104:107]
v_cndmask_b32 v73, v8, v73, s[82:83]
v_cndmask_b32 v74, v8, v74, s[84:85]
v_mfma_f32_16x16x32_bf16 a[108:111], a[64:67], v[108:111], a[108:111]
s_waitcnt lgkmcnt(2)
buffer_load_dwordx4 v1, s[8:11], s46 offen sc1 lds
v_cndmask_b32 v75, v8, v75, s[86:87]
v_mfma_f32_16x16x32_bf16 a[116:119], a[68:71], v[100:103], a[116:119]
ds_read_b128 a[80:83], v2 offset:12288
v_cndmask_b32 v76, v8, v76, s[88:89]
v_cndmask_b32 v77, v8, v77, s[90:91]
v_mfma_f32_16x16x32_bf16 a[120:123], a[68:71], v[104:107], a[120:123]
v_cndmask_b32 v78, v8, v78, s[92:93]
v_cndmask_b32 v79, v8, v79, s[94:95]
v_mfma_f32_16x16x32_bf16 a[124:127], a[68:71], v[108:111], a[124:127]
s_waitcnt lgkmcnt(2)
buffer_load_dwordx4 v1, s[8:11], s46 offen offset:2048 sc1 lds
v_max3_f32 v16, v72, v73, v74
v_mfma_f32_16x16x32_bf16 a[132:135], a[72:75], v[100:103], a[132:135]
ds_read_b128 a[84:87], v2 offset:13312
v_max3_f32 v16, v16, v75, v80
v_max3_f32 v16, v16, v81, v82
v_mfma_f32_16x16x32_bf16 a[136:139], a[72:75], v[104:107], a[136:139]
s_add_u32 m0, s47, 896
v_max3_f32 v16, v16, v83, v88
v_max3_f32 v16, v16, v89, v90
v_mfma_f32_16x16x32_bf16 a[140:143], a[72:75], v[108:111], a[140:143]
s_waitcnt lgkmcnt(2)
v_max3_f32 v16, v16, v91, v76
v_max3_f32 v16, v16, v77, v78
v_mfma_f32_16x16x32_bf16 a[148:151], a[76:79], v[100:103], a[148:151]
ds_read_b128 a[88:91], v2 offset:14336
v_max3_f32 v16, v16, v79, v84
v_mfma_f32_16x16x32_bf16 a[152:155], a[76:79], v[104:107], a[152:155]
buffer_load_dwordx4 v1, s[8:11], s46 offen offset:128 sc1 lds
v_max3_f32 v16, v16, v85, v86
v_max3_f32 v16, v16, v87, v92
v_mfma_f32_16x16x32_bf16 a[156:159], a[76:79], v[108:111], a[156:159]
s_waitcnt lgkmcnt(2)
v_max3_f32 v16, v16, v93, v94
v_max_f32 v16, v16, v95
v_cmp_lt_f32 vcc, s54, v16
v_mfma_f32_16x16x32_bf16 a[164:167], a[80:83], v[100:103], a[164:167]
ds_read_b128 a[92:95], v2 offset:15360
s_cbranch_vccnz L_at_up5
L_at_upr5:
v_exp_f32 v72, v72
v_exp_f32 v73, v73
v_accvgpr_read_b32 v18, a224
v_mfma_f32_16x16x32_bf16 a[168:171], a[80:83], v[104:107], a[168:171]
buffer_load_dwordx4 v1, s[8:11], s46 offen offset:2176 sc1 lds
v_exp_f32 v74, v74
v_exp_f32 v75, v75
v_exp_f32 v76, v76
v_mfma_f32_16x16x32_bf16 a[172:175], a[80:83], v[108:111], a[172:175]
s_waitcnt lgkmcnt(2)
v_exp_f32 v77, v77
v_exp_f32 v78, v78
v_exp_f32 v79, v79
v_cvt_pk_bf16_f32 v116, v72, v73
v_mfma_f32_16x16x32_bf16 a[180:183], a[84:87], v[100:103], a[180:183]
ds_read_b128 a[64:67], v3
s_add_u32 m0, s47, 4096
v_exp_f32 v80, v80
v_exp_f32 v81, v81
v_cvt_pk_bf16_f32 v117, v74, v75
v_mfma_f32_16x16x32_bf16 a[184:187], a[84:87], v[104:107], a[184:187]
v_exp_f32 v82, v82
v_exp_f32 v83, v83
v_exp_f32 v84, v84
v_cvt_pk_bf16_f32 v118, v76, v77
v_mfma_f32_16x16x32_bf16 a[188:191], a[84:87], v[108:111], a[188:191]
s_waitcnt lgkmcnt(2)
v_exp_f32 v85, v85
v_exp_f32 v86, v86
v_exp_f32 v87, v87
v_cvt_pk_bf16_f32 v119, v78, v79
v_mfma_f32_16x16x32_bf16 a[196:199], a[88:91], v[100:103], a[196:199]
ds_read_b128 a[68:71], v3 offset:1024
buffer_load_dwordx4 v1, s[8:11], s24 offen sc1 lds
v_exp_f32 v88, v88
v_exp_f32 v89, v89
v_cvt_pk_bf16_f32 v120, v80, v81
v_mfma_f32_16x16x32_bf16 a[200:203], a[88:91], v[104:107], a[200:203]
v_exp_f32 v90, v90
v_exp_f32 v91, v91
v_exp_f32 v92, v92
v_cvt_pk_bf16_f32 v121, v82, v83
v_mfma_f32_16x16x32_bf16 a[204:207], a[88:91], v[108:111], a[204:207]
s_waitcnt lgkmcnt(2)
v_exp_f32 v93, v93
v_exp_f32 v94, v94
v_exp_f32 v95, v95
v_cvt_pk_bf16_f32 v122, v84, v85
v_mfma_f32_16x16x32_bf16 a[212:215], a[92:95], v[100:103], a[212:215]
ds_read_b128 a[72:75], v3 offset:2048
buffer_load_dwordx4 v1, s[8:11], s24 offen offset:2048 sc1 lds
v_cvt_pk_bf16_f32 v123, v86, v87
v_cvt_pk_bf16_f32 v124, v88, v89
v_cvt_pk_bf16_f32 v125, v90, v91
v_cvt_pk_bf16_f32 v126, v92, v93
v_cvt_pk_bf16_f32 v127, v94, v95
v_mfma_f32_16x16x32_bf16 a[216:219], a[92:95], v[104:107], a[216:219]
v_rcp_f32 v18, v18
v_accvgpr_read_b32 v224, a96
v_accvgpr_read_b32 v225, a97
v_accvgpr_read_b32 v226, a98
v_accvgpr_read_b32 v227, a99
v_accvgpr_read_b32 v228, a112
v_mfma_f32_16x16x32_bf16 a[220:223], a[92:95], v[108:111], a[220:223]
s_waitcnt lgkmcnt(2)
s_add_u32 m0, s47, 4992
s_cmp_eq_u32 s48, 0
s_cbranch_scc0 L_at_rs5
L_at_rsr5:
v_accvgpr_read_b32 v229, a113
v_accvgpr_read_b32 v230, a114
v_accvgpr_read_b32 v231, a115
v_mul_f32 v224, v224, v18
v_mul_f32 v225, v225, v18
v_mfma_f32_16x16x32_bf16 v[48:51], a[64:67], a[32:35], v[136:139]
ds_read_b128 a[76:79], v3 offset:3072
v_mul_f32 v226, v226, v18
v_mul_f32 v227, v227, v18
v_mul_f32 v228, v228, v18
v_mul_f32 v229, v229, v18
v_mul_f32 v230, v230, v18
v_mul_f32 v231, v231, v18
v_mfma_f32_16x16x32_bf16 v[56:59], a[64:67], a[48:51], v[140:143]
s_waitcnt lgkmcnt(2)
v_cvt_pk_bf16_f32 v224, v224, v225
v_cvt_pk_bf16_f32 v225, v226, v227
v_cvt_pk_bf16_f32 v226, v228, v229
v_cvt_pk_bf16_f32 v227, v230, v231
buffer_store_dwordx4 v[224:227], v6, s[8:11], s25 offen sc1
v_mfma_f32_16x16x32_bf16 v[52:55], a[68:71], a[32:35], v[136:139]
ds_read_b128 a[80:83], v3 offset:4096
buffer_load_dwordx4 v1, s[8:11], s24 offen offset:128 sc1 lds
v_accvgpr_read_b32 v232, a128
v_accvgpr_read_b32 v233, a129
v_accvgpr_read_b32 v234, a130
v_accvgpr_read_b32 v235, a131
v_mfma_f32_16x16x32_bf16 v[60:63], a[68:71], a[48:51], v[140:143]
s_waitcnt lgkmcnt(2)
v_accvgpr_read_b32 v236, a144
v_accvgpr_read_b32 v237, a145
v_accvgpr_read_b32 v238, a146
v_accvgpr_read_b32 v239, a147
v_mul_f32 v232, v232, v18
v_mul_f32 v233, v233, v18
v_mfma_f32_16x16x32_bf16 v[48:51], a[72:75], a[36:39], v[48:51]
ds_read_b128 a[84:87], v3 offset:5120
v_mul_f32 v234, v234, v18
v_mul_f32 v235, v235, v18
v_mul_f32 v236, v236, v18
v_mul_f32 v237, v237, v18
v_mul_f32 v238, v238, v18
v_mfma_f32_16x16x32_bf16 v[56:59], a[72:75], a[52:55], v[56:59]
s_waitcnt lgkmcnt(2)
buffer_load_dwordx4 v1, s[8:11], s24 offen offset:2176 sc1 lds
v_mul_f32 v239, v239, v18
v_cvt_pk_bf16_f32 v232, v232, v233
v_cvt_pk_bf16_f32 v233, v234, v235
v_cvt_pk_bf16_f32 v234, v236, v237
v_cvt_pk_bf16_f32 v235, v238, v239
v_mfma_f32_16x16x32_bf16 v[52:55], a[76:79], a[36:39], v[52:55]
ds_read_b128 a[88:91], v3 offset:6144
buffer_store_dwordx4 v[232:235], v6, s[8:11], s25 offen offset:1024 sc1
v_accvgpr_read_b32 v240, a160
v_mfma_f32_16x16x32_bf16 v[60:63], a[76:79], a[52:55], v[60:63]
s_waitcnt lgkmcnt(2)
s_add_u32 s46, s46, 1048576
v_accvgpr_read_b32 v241, a161
v_accvgpr_read_b32 v242, a162
v_accvgpr_read_b32 v243, a163
v_accvgpr_read_b32 v244, a176
v_accvgpr_read_b32 v245, a177
v_mfma_f32_16x16x32_bf16 v[48:51], a[80:83], a[40:43], v[48:51]
ds_read_b128 a[92:95], v3 offset:7168
v_accvgpr_read_b32 v246, a178
v_accvgpr_read_b32 v247, a179
v_mul_f32 v240, v240, v18
v_mul_f32 v241, v241, v18
v_mul_f32 v242, v242, v18
v_mfma_f32_16x16x32_bf16 v[56:59], a[80:83], a[56:59], v[56:59]
s_waitcnt lgkmcnt(2)
v_mul_f32 v243, v243, v18
v_mul_f32 v244, v244, v18
v_mul_f32 v245, v245, v18
v_mul_f32 v246, v246, v18
v_mul_f32 v247, v247, v18
v_cvt_pk_bf16_f32 v240, v240, v241
v_mfma_f32_16x16x32_bf16 v[52:55], a[84:87], a[40:43], v[52:55]
ds_read_b128 a[64:67], v2 offset:24576
s_add_u32 s47, s47, 32768
v_cvt_pk_bf16_f32 v241, v242, v243
v_cvt_pk_bf16_f32 v242, v244, v245
v_cvt_pk_bf16_f32 v243, v246, v247
buffer_store_dwordx4 v[240:243], v6, s[8:11], s25 offen offset:2048 sc1
v_mfma_f32_16x16x32_bf16 v[60:63], a[84:87], a[56:59], v[60:63]
s_waitcnt lgkmcnt(2)
v_accvgpr_read_b32 v248, a192
v_accvgpr_read_b32 v249, a193
v_accvgpr_read_b32 v250, a194
v_accvgpr_read_b32 v251, a195
v_accvgpr_read_b32 v252, a208
v_accvgpr_read_b32 v253, a209
v_mfma_f32_16x16x32_bf16 v[48:51], a[88:91], a[44:47], v[48:51]
ds_read_b128 a[68:71], v2 offset:25600
v_accvgpr_read_b32 v254, a210
v_accvgpr_read_b32 v255, a211
v_mul_f32 v248, v248, v18
v_mul_f32 v249, v249, v18
v_mul_f32 v250, v250, v18
v_mfma_f32_16x16x32_bf16 v[56:59], a[88:91], a[60:63], v[56:59]
s_waitcnt lgkmcnt(2)
s_and_b32 s47, s47, 131071
v_mul_f32 v251, v251, v18
v_mul_f32 v252, v252, v18
v_mul_f32 v253, v253, v18
v_mul_f32 v254, v254, v18
v_mfma_f32_16x16x32_bf16 v[52:55], a[92:95], a[44:47], v[52:55]
ds_read_b128 a[72:75], v2 offset:26624
v_mul_f32 v255, v255, v18
v_cvt_pk_bf16_f32 v248, v248, v249
v_cvt_pk_bf16_f32 v249, v250, v251
v_cvt_pk_bf16_f32 v250, v252, v253
v_mfma_f32_16x16x32_bf16 v[60:63], a[92:95], a[60:63], v[60:63]
s_waitcnt lgkmcnt(2)
v_cvt_pk_bf16_f32 v251, v254, v255
buffer_store_dwordx4 v[248:251], v6, s[8:11], s25 offen offset:3072 sc1
v_mov_b32 v4, v2
v_mov_b32 v2, v3
v_add_u32 v3, 32768, v3
v_and_b32 v3, 131071, v3
s_cmp_ge_u32 s63, 8
s_cbranch_scc1 L_at_nq
v_mov_b32 v20, 0
s_lshr_b32 s25, s42, 1
s_lshl_b32 s25, s25, 5
s_add_u32 s25, s25, s63
s_lshl_b32 s25, s25, 2
s_add_u32 s25, s25, 111173632
s_mov_b32 s28, 0
L_poll_14:
buffer_load_dword v21, v20, s[8:11], s25 offen sc1
s_add_u32 s28, s28, 1
s_cmp_gt_u32 s28, 200000
s_cbranch_scc1 L_end
s_waitcnt vmcnt(0)
v_cmp_ne_u32 vcc, 1, v21
s_cbranch_vccz L_pd_15
s_sleep 1
s_branch L_poll_14
L_pd_15:
L_at_nq:
v_mfma_f32_16x16x32_bf16 a[228:231], a[240:243], v[116:119], a[228:231]
s_lshl_b32 s26, s63, 8
v_mfma_f32_16x16x32_bf16 a[232:235], a[240:243], v[120:123], a[232:235]
s_add_u32 s26, s26, s42
v_mfma_f32_16x16x32_bf16 a[236:239], a[240:243], v[124:127], a[236:239]
s_lshl_b32 s26, s26, 13
v_mfma_f32_16x16x32_bf16 a[100:103], a[64:67], v[116:119], a[100:103]
ds_read_b128 a[76:79], v4 offset:27648
v_cndmask_b32 v48, v8, v48, s[64:65]
v_mfma_f32_16x16x32_bf16 a[104:107], a[64:67], v[120:123], a[104:107]
s_add_u32 s26, s26, 117440512
v_cndmask_b32 v49, v8, v49, s[66:67]
v_cndmask_b32 v50, v8, v50, s[68:69]
v_mfma_f32_16x16x32_bf16 a[108:111], a[64:67], v[124:127], a[108:111]
s_waitcnt lgkmcnt(2)
s_cmp_lt_u32 s63, 8
s_cselect_b32 s26, s26, 536870912
v_cndmask_b32 v51, v8, v51, s[70:71]
v_mfma_f32_16x16x32_bf16 a[116:119], a[68:71], v[116:119], a[116:119]
ds_read_b128 a[80:83], v4 offset:28672
v_cndmask_b32 v52, v8, v52, s[72:73]
v_mfma_f32_16x16x32_bf16 a[120:123], a[68:71], v[120:123], a[120:123]
s_add_u32 s27, s26, 0
v_cndmask_b32 v53, v8, v53, s[74:75]
v_cndmask_b32 v54, v8, v54, s[76:77]
v_mfma_f32_16x16x32_bf16 a[124:127], a[68:71], v[124:127], a[124:127]
s_waitcnt lgkmcnt(2)
buffer_load_dwordx4 v[160:163], v7, s[8:11], s27 offen sc1
v_cndmask_b32 v55, v8, v55, s[78:79]
v_max3_f32 v16, v48, v49, v50
v_mfma_f32_16x16x32_bf16 a[132:135], a[72:75], v[116:119], a[132:135]
ds_read_b128 a[84:87], v4 offset:29696
v_max3_f32 v16, v16, v51, v56
v_mfma_f32_16x16x32_bf16 a[136:139], a[72:75], v[120:123], a[136:139]
buffer_load_dwordx4 v[164:167], v7, s[8:11], s27 offen offset:2048 sc1
v_max3_f32 v16, v16, v57, v58
v_max3_f32 v16, v16, v59, v52
v_mfma_f32_16x16x32_bf16 a[140:143], a[72:75], v[124:127], a[140:143]
s_waitcnt lgkmcnt(2)
s_add_u32 s27, s26, 4096
v_max3_f32 v16, v16, v53, v54
v_max3_f32 v16, v16, v55, v60
v_mfma_f32_16x16x32_bf16 a[148:151], a[76:79], v[116:119], a[148:151]
ds_read_b128 a[88:91], v4 offset:30720
v_max3_f32 v16, v16, v61, v62
v_max_f32 v16, v16, v63
v_cmp_lt_f32 vcc, s54, v16
v_mfma_f32_16x16x32_bf16 a[152:155], a[76:79], v[120:123], a[152:155]
buffer_load_dwordx4 v[168:171], v7, s[8:11], s27 offen sc1
s_cbranch_vccnz L_at_up6
L_at_upr6:
v_mfma_f32_16x16x32_bf16 a[156:159], a[76:79], v[124:127], a[156:159]
s_waitcnt lgkmcnt(2)
buffer_load_dwordx4 v[172:175], v7, s[8:11], s27 offen offset:2048 sc1
v_exp_f32 v48, v48
v_mfma_f32_16x16x32_bf16 a[164:167], a[80:83], v[116:119], a[164:167]
ds_read_b128 a[92:95], v4 offset:31744
v_exp_f32 v49, v49
v_mfma_f32_16x16x32_bf16 a[168:171], a[80:83], v[120:123], a[168:171]
s_add_u32 s27, s26, 524288
v_exp_f32 v50, v50
v_cvt_pk_bf16_f32 v104, v48, v49
v_mfma_f32_16x16x32_bf16 a[172:175], a[80:83], v[124:127], a[172:175]
s_waitcnt lgkmcnt(2)
buffer_load_dwordx4 v[176:179], v7, s[8:11], s27 offen sc1
v_exp_f32 v51, v51
v_mfma_f32_16x16x32_bf16 a[180:183], a[84:87], v[116:119], a[180:183]
ds_read_b128 a[64:67], v2 offset:16384
v_exp_f32 v52, v52
v_mfma_f32_16x16x32_bf16 a[184:187], a[84:87], v[120:123], a[184:187]
buffer_load_dwordx4 v[180:183], v7, s[8:11], s27 offen offset:2048 sc1
v_exp_f32 v53, v53
v_mfma_f32_16x16x32_bf16 a[188:191], a[84:87], v[124:127], a[188:191]
s_waitcnt lgkmcnt(2)
s_add_u32 s27, s26, 528384
v_exp_f32 v54, v54
v_mfma_f32_16x16x32_bf16 a[196:199], a[88:91], v[116:119], a[196:199]
ds_read_b128 a[68:71], v2 offset:17408
v_exp_f32 v55, v55
v_mfma_f32_16x16x32_bf16 a[200:203], a[88:91], v[120:123], a[200:203]
buffer_load_dwordx4 v[184:187], v7, s[8:11], s27 offen sc1
v_exp_f32 v56, v56
v_mfma_f32_16x16x32_bf16 a[204:207], a[88:91], v[124:127], a[204:207]
s_waitcnt lgkmcnt(2)
buffer_load_dwordx4 v[188:191], v7, s[8:11], s27 offen offset:2048 sc1
v_exp_f32 v57, v57
v_mfma_f32_16x16x32_bf16 a[212:215], a[92:95], v[116:119], a[212:215]
ds_read_b128 a[72:75], v2 offset:18432
v_exp_f32 v58, v58
v_mfma_f32_16x16x32_bf16 a[216:219], a[92:95], v[120:123], a[216:219]
s_add_u32 s27, s26, 1048576
v_exp_f32 v59, v59
v_cvt_pk_bf16_f32 v105, v50, v51
v_mfma_f32_16x16x32_bf16 a[220:223], a[92:95], v[124:127], a[220:223]
s_waitcnt lgkmcnt(2)
buffer_load_dwordx4 v[192:195], v7, s[8:11], s27 offen sc1
s_cmp_eq_u32 s48, 0
s_cbranch_scc0 L_at_rs6
L_at_rsr6:
v_mfma_f32_16x16x32_bf16 v[80:83], a[64:67], a[32:35], v[136:139]
ds_read_b128 a[76:79], v2 offset:19456
v_cvt_pk_bf16_f32 v106, v52, v53
v_mfma_f32_16x16x32_bf16 v[88:91], a[64:67], a[48:51], v[140:143]
s_waitcnt lgkmcnt(2)
buffer_load_dwordx4 v[196:199], v7, s[8:11], s27 offen offset:2048 sc1
v_cvt_pk_bf16_f32 v107, v54, v55
v_mfma_f32_16x16x32_bf16 v[84:87], a[68:71], a[32:35], v[136:139]
ds_read_b128 a[80:83], v2 offset:20480
s_add_u32 s27, s26, 1052672
v_mfma_f32_16x16x32_bf16 v[92:95], a[68:71], a[48:51], v[140:143]
s_waitcnt lgkmcnt(2)
v_exp_f32 v60, v60
v_mfma_f32_16x16x32_bf16 v[80:83], a[72:75], a[36:39], v[80:83]
ds_read_b128 a[84:87], v2 offset:21504
buffer_load_dwordx4 v[200:203], v7, s[8:11], s27 offen sc1
v_mfma_f32_16x16x32_bf16 v[88:91], a[72:75], a[52:55], v[88:91]
s_waitcnt lgkmcnt(2)
buffer_load_dwordx4 v[204:207], v7, s[8:11], s27 offen offset:2048 sc1
v_cvt_pk_bf16_f32 v108, v56, v57
v_mfma_f32_16x16x32_bf16 v[84:87], a[76:79], a[36:39], v[84:87]
ds_read_b128 a[88:91], v2 offset:22528
v_cvt_pk_bf16_f32 v109, v58, v59
v_mfma_f32_16x16x32_bf16 v[92:95], a[76:79], a[52:55], v[92:95]
s_waitcnt lgkmcnt(2)
s_add_u32 s27, s26, 1572864
v_mfma_f32_16x16x32_bf16 v[80:83], a[80:83], a[40:43], v[80:83]
ds_read_b128 a[92:95], v2 offset:23552
buffer_load_dwordx4 v[208:211], v7, s[8:11], s27 offen sc1
v_mfma_f32_16x16x32_bf16 v[88:91], a[80:83], a[56:59], v[88:91]
s_waitcnt lgkmcnt(2)
v_exp_f32 v61, v61
v_mfma_f32_16x16x32_bf16 v[84:87], a[84:87], a[40:43], v[84:87]
ds_read_b128 a[64:67], v2 offset:8192
buffer_load_dwordx4 v[212:215], v7, s[8:11], s27 offen offset:2048 sc1
v_cvt_pk_bf16_f32 v110, v60, v61
v_mfma_f32_16x16x32_bf16 v[92:95], a[84:87], a[56:59], v[92:95]
s_waitcnt lgkmcnt(2)
s_add_u32 s27, s26, 1576960
v_mfma_f32_16x16x32_bf16 v[80:83], a[88:91], a[44:47], v[80:83]
ds_read_b128 a[68:71], v2 offset:9216
v_exp_f32 v62, v62
v_mfma_f32_16x16x32_bf16 v[88:91], a[88:91], a[60:63], v[88:91]
s_waitcnt lgkmcnt(2)
buffer_load_dwordx4 v[216:219], v7, s[8:11], s27 offen sc1
v_mfma_f32_16x16x32_bf16 v[84:87], a[92:95], a[44:47], v[84:87]
ds_read_b128 a[72:75], v2 offset:10240
buffer_load_dwordx4 v[220:223], v7, s[8:11], s27 offen offset:2048 sc1
v_mfma_f32_16x16x32_bf16 v[92:95], a[92:95], a[60:63], v[92:95]
s_waitcnt lgkmcnt(2)
v_exp_f32 v63, v63
s_nop 0
v_cvt_pk_bf16_f32 v111, v62, v63
s_waitcnt vmcnt(28)
s_barrier
s_add_u32 s25, s61, 524288
v_mfma_f32_16x16x32_bf16 a[232:235], a[240:243], v[104:107], a[232:235]
s_add_u32 s24, s46, 4096
v_mfma_f32_16x16x32_bf16 a[236:239], a[240:243], v[108:111], a[236:239]
s_add_u32 m0, s47, 0
v_mfma_f32_16x16x32_bf16 a[104:107], a[64:67], v[104:107], a[104:107]
ds_read_b128 a[76:79], v2 offset:11264
v_mfma_f32_16x16x32_bf16 a[108:111], a[64:67], v[108:111], a[108:111]
s_waitcnt lgkmcnt(2)
buffer_load_dwordx4 v1, s[8:11], s46 offen sc1 lds
v_cndmask_b32 v80, v8, v80, s[80:81]
v_mfma_f32_16x16x32_bf16 a[120:123], a[68:71], v[104:107], a[120:123]
ds_read_b128 a[80:83], v2 offset:12288
buffer_load_dwordx4 v1, s[8:11], s46 offen offset:2048 sc1 lds
v_cndmask_b32 v81, v8, v81, s[82:83]
v_mfma_f32_16x16x32_bf16 a[124:127], a[68:71], v[108:111], a[124:127]
s_waitcnt lgkmcnt(2)
v_cndmask_b32 v82, v8, v82, s[84:85]
v_cndmask_b32 v83, v8, v83, s[86:87]
v_mfma_f32_16x16x32_bf16 a[136:139], a[72:75], v[104:107], a[136:139]
ds_read_b128 a[84:87], v2 offset:13312
s_add_u32 m0, s47, 896
v_cndmask_b32 v84, v8, v84, s[88:89]
v_mfma_f32_16x16x32_bf16 a[140:143], a[72:75], v[108:111], a[140:143]
s_waitcnt lgkmcnt(2)
v_cndmask_b32 v85, v8, v85, s[90:91]
v_cndmask_b32 v86, v8, v86, s[92:93]
v_mfma_f32_16x16x32_bf16 a[152:155], a[76:79], v[104:107], a[152:155]
ds_read_b128 a[88:91], v2 offset:14336
buffer_load_dwordx4 v1, s[8:11], s46 offen offset:128 sc1 lds
v_cndmask_b32 v87, v8, v87, s[94:95]
v_mfma_f32_16x16x32_bf16 a[156:159], a[76:79], v[108:111], a[156:159]
s_waitcnt lgkmcnt(2)
buffer_load_dwordx4 v1, s[8:11], s46 offen offset:2176 sc1 lds
v_max3_f32 v16, v80, v81, v82
v_max3_f32 v16, v16, v83, v88
v_mfma_f32_16x16x32_bf16 a[168:171], a[80:83], v[104:107], a[168:171]
ds_read_b128 a[92:95], v2 offset:15360
v_max3_f32 v16, v16, v89, v90
v_max3_f32 v16, v16, v91, v84
v_mfma_f32_16x16x32_bf16 a[172:175], a[80:83], v[108:111], a[172:175]
s_waitcnt lgkmcnt(2)
s_add_u32 m0, s47, 4096
v_max3_f32 v16, v16, v85, v86
v_max3_f32 v16, v16, v87, v92
v_mfma_f32_16x16x32_bf16 a[184:187], a[84:87], v[104:107], a[184:187]
ds_read_b128 a[64:67], v3
v_max3_f32 v16, v16, v93, v94
v_max_f32 v16, v16, v95
v_cmp_lt_f32 vcc, s54, v16
v_mfma_f32_16x16x32_bf16 a[188:191], a[84:87], v[108:111], a[188:191]
s_waitcnt lgkmcnt(2)
buffer_load_dwordx4 v1, s[8:11], s24 offen sc1 lds
s_cbranch_vccnz L_at_up7
L_at_upr7:
v_exp_f32 v80, v80
v_exp_f32 v81, v81
v_exp_f32 v82, v82
v_exp_f32 v83, v83
v_exp_f32 v84, v84
v_accvgpr_read_b32 v18, a228
v_mfma_f32_16x16x32_bf16 a[200:203], a[88:91], v[104:107], a[200:203]
ds_read_b128 a[68:71], v3 offset:1024
buffer_load_dwordx4 v1, s[8:11], s24 offen offset:2048 sc1 lds
v_exp_f32 v85, v85
v_exp_f32 v86, v86
v_exp_f32 v87, v87
v_exp_f32 v88, v88
v_exp_f32 v89, v89
v_cvt_pk_bf16_f32 v120, v80, v81
v_mfma_f32_16x16x32_bf16 a[204:207], a[88:91], v[108:111], a[204:207]
s_waitcnt lgkmcnt(2)
v_exp_f32 v90, v90
v_exp_f32 v91, v91
v_exp_f32 v92, v92
v_exp_f32 v93, v93
v_exp_f32 v94, v94
v_exp_f32 v95, v95
v_cvt_pk_bf16_f32 v121, v82, v83
v_mfma_f32_16x16x32_bf16 a[216:219], a[92:95], v[104:107], a[216:219]
ds_read_b128 a[72:75], v3 offset:2048
s_add_u32 m0, s47, 4992
v_cvt_pk_bf16_f32 v122, v84, v85
v_cvt_pk_bf16_f32 v123, v86, v87
v_cvt_pk_bf16_f32 v124, v88, v89
v_cvt_pk_bf16_f32 v125, v90, v91
v_cvt_pk_bf16_f32 v126, v92, v93
v_cvt_pk_bf16_f32 v127, v94, v95
v_rcp_f32 v18, v18
v_accvgpr_read_b32 v224, a100
v_accvgpr_read_b32 v225, a101
v_accvgpr_read_b32 v226, a102
v_mfma_f32_16x16x32_bf16 a[220:223], a[92:95], v[108:111], a[220:223]
s_waitcnt lgkmcnt(2)
buffer_load_dwordx4 v1, s[8:11], s24 offen offset:128 sc1 lds
s_cmp_eq_u32 s48, 0
s_cbranch_scc0 L_at_rs7
L_at_rsr7:
v_accvgpr_read_b32 v227, a103
v_accvgpr_read_b32 v228, a116
v_accvgpr_read_b32 v229, a117
v_accvgpr_read_b32 v230, a118
v_accvgpr_read_b32 v231, a119
v_mul_f32 v224, v224, v18
v_mul_f32 v225, v225, v18
v_mul_f32 v226, v226, v18
v_mul_f32 v227, v227, v18
v_mul_f32 v228, v228, v18
v_mul_f32 v229, v229, v18
v_mfma_f32_16x16x32_bf16 v[56:59], a[64:67], a[48:51], v[140:143]
ds_read_b128 a[76:79], v3 offset:3072
s_waitcnt lgkmcnt(2)
v_mul_f32 v230, v230, v18
v_mul_f32 v231, v231, v18
v_cvt_pk_bf16_f32 v224, v224, v225
v_cvt_pk_bf16_f32 v225, v226, v227
v_cvt_pk_bf16_f32 v226, v228, v229
v_cvt_pk_bf16_f32 v227, v230, v231
buffer_store_dwordx4 v[224:227], v6, s[8:11], s25 offen sc1
v_accvgpr_read_b32 v232, a132
v_mfma_f32_16x16x32_bf16 v[60:63], a[68:71], a[48:51], v[140:143]
ds_read_b128 a[80:83], v3 offset:4096
s_waitcnt lgkmcnt(2)
buffer_load_dwordx4 v1, s[8:11], s24 offen offset:2176 sc1 lds
v_accvgpr_read_b32 v233, a133
v_accvgpr_read_b32 v234, a134
v_accvgpr_read_b32 v235, a135
v_accvgpr_read_b32 v236, a148
v_accvgpr_read_b32 v237, a149
v_accvgpr_read_b32 v238, a150
v_accvgpr_read_b32 v239, a151
v_mul_f32 v232, v232, v18
v_mul_f32 v233, v233, v18
v_mul_f32 v234, v234, v18
v_mul_f32 v235, v235, v18
v_mfma_f32_16x16x32_bf16 v[56:59], a[72:75], a[52:55], v[56:59]
ds_read_b128 a[84:87], v3 offset:5120
s_waitcnt lgkmcnt(2)
v_mul_f32 v236, v236, v18
v_mul_f32 v237, v237, v18
v_mul_f32 v238, v238, v18
v_mul_f32 v239, v239, v18
v_cvt_pk_bf16_f32 v232, v232, v233
v_cvt_pk_bf16_f32 v233, v234, v235
v_cvt_pk_bf16_f32 v234, v236, v237
v_cvt_pk_bf16_f32 v235, v238, v239
buffer_store_dwordx4 v[232:235], v6, s[8:11], s25 offen offset:1024 sc1
v_mfma_f32_16x16x32_bf16 v[60:63], a[76:79], a[52:55], v[60:63]
ds_read_b128 a[88:91], v3 offset:6144
s_waitcnt lgkmcnt(2)
s_add_u32 s46, s46, 1048576
v_accvgpr_read_b32 v240, a164
v_accvgpr_read_b32 v241, a165
v_accvgpr_read_b32 v242, a166
v_accvgpr_read_b32 v243, a167
v_accvgpr_read_b32 v244, a180
v_accvgpr_read_b32 v245, a181
v_accvgpr_read_b32 v246, a182
v_accvgpr_read_b32 v247, a183
v_mul_f32 v240, v240, v18
v_mul_f32 v241, v241, v18
v_mfma_f32_16x16x32_bf16 v[56:59], a[80:83], a[56:59], v[56:59]
ds_read_b128 a[92:95], v3 offset:7168
s_waitcnt lgkmcnt(2)
s_add_u32 s47, s47, 32768
v_mul_f32 v242, v242, v18
v_mul_f32 v243, v243, v18
v_mul_f32 v244, v244, v18
v_mul_f32 v245, v245, v18
v_mul_f32 v246, v246, v18
v_mul_f32 v247, v247, v18
v_cvt_pk_bf16_f32 v240, v240, v241
v_cvt_pk_bf16_f32 v241, v242, v243
v_cvt_pk_bf16_f32 v242, v244, v245
v_cvt_pk_bf16_f32 v243, v246, v247
v_mfma_f32_16x16x32_bf16 v[60:63], a[84:87], a[56:59], v[60:63]
ds_read_b128 a[64:67], v2 offset:24576
s_waitcnt lgkmcnt(2)
buffer_store_dwordx4 v[240:243], v6, s[8:11], s25 offen offset:2048 sc1
v_accvgpr_read_b32 v248, a196
v_accvgpr_read_b32 v249, a197
v_accvgpr_read_b32 v250, a198
v_accvgpr_read_b32 v251, a199
v_accvgpr_read_b32 v252, a212
v_accvgpr_read_b32 v253, a213
v_mfma_f32_16x16x32_bf16 v[56:59], a[88:91], a[60:63], v[56:59]
ds_read_b128 a[68:71], v2 offset:25600
s_waitcnt lgkmcnt(2)
s_and_b32 s47, s47, 131071
v_accvgpr_read_b32 v254, a214
v_accvgpr_read_b32 v255, a215
v_mul_f32 v248, v248, v18
v_mul_f32 v249, v249, v18
v_mul_f32 v250, v250, v18
v_mul_f32 v251, v251, v18
v_mul_f32 v252, v252, v18
v_mul_f32 v253, v253, v18
v_mul_f32 v254, v254, v18
v_mfma_f32_16x16x32_bf16 v[60:63], a[92:95], a[60:63], v[60:63]
ds_read_b128 a[72:75], v2 offset:26624
s_waitcnt lgkmcnt(2)
v_mul_f32 v255, v255, v18
v_cvt_pk_bf16_f32 v248, v248, v249
v_cvt_pk_bf16_f32 v249, v250, v251
v_cvt_pk_bf16_f32 v250, v252, v253
v_cvt_pk_bf16_f32 v251, v254, v255
buffer_store_dwordx4 v[248:251], v6, s[8:11], s25 offen offset:3072 sc1
v_mov_b32 v4, v2
v_mov_b32 v2, v3
v_add_u32 v3, 32768, v3
v_and_b32 v3, 131071, v3
v_mfma_f32_16x16x32_bf16 a[232:235], a[240:243], v[120:123], a[232:235]
v_mfma_f32_16x16x32_bf16 a[236:239], a[240:243], v[124:127], a[236:239]
v_mfma_f32_16x16x32_bf16 a[104:107], a[64:67], v[120:123], a[104:107]
ds_read_b128 a[76:79], v4 offset:27648
v_mfma_f32_16x16x32_bf16 a[108:111], a[64:67], v[124:127], a[108:111]
s_waitcnt lgkmcnt(2)
v_cndmask_b32 v56, v8, v56, s[64:65]
v_cndmask_b32 v57, v8, v57, s[66:67]
v_mfma_f32_16x16x32_bf16 a[120:123], a[68:71], v[120:123], a[120:123]
ds_read_b128 a[80:83], v4 offset:28672
v_cndmask_b32 v58, v8, v58, s[68:69]
v_mfma_f32_16x16x32_bf16 a[124:127], a[68:71], v[124:127], a[124:127]
s_waitcnt lgkmcnt(2)
v_cndmask_b32 v59, v8, v59, s[70:71]
v_cndmask_b32 v60, v8, v60, s[72:73]
v_mfma_f32_16x16x32_bf16 a[136:139], a[72:75], v[120:123], a[136:139]
ds_read_b128 a[84:87], v4 offset:29696
v_cndmask_b32 v61, v8, v61, s[74:75]
v_mfma_f32_16x16x32_bf16 a[140:143], a[72:75], v[124:127], a[140:143]
s_waitcnt lgkmcnt(2)
v_cndmask_b32 v62, v8, v62, s[76:77]
v_cndmask_b32 v63, v8, v63, s[78:79]
v_mfma_f32_16x16x32_bf16 a[152:155], a[76:79], v[120:123], a[152:155]
ds_read_b128 a[88:91], v4 offset:30720
v_max3_f32 v16, v56, v57, v58
v_mfma_f32_16x16x32_bf16 a[156:159], a[76:79], v[124:127], a[156:159]
s_waitcnt lgkmcnt(2)
v_max3_f32 v16, v16, v59, v60
v_max3_f32 v16, v16, v61, v62
v_mfma_f32_16x16x32_bf16 a[168:171], a[80:83], v[120:123], a[168:171]
ds_read_b128 a[92:95], v4 offset:31744
v_max_f32 v16, v16, v63
v_cmp_lt_f32 vcc, s54, v16
v_mfma_f32_16x16x32_bf16 a[172:175], a[80:83], v[124:127], a[172:175]
s_waitcnt lgkmcnt(2)
s_cbranch_vccnz L_at_up8
L_at_upr8:
v_mfma_f32_16x16x32_bf16 a[184:187], a[84:87], v[120:123], a[184:187]
ds_read_b128 a[64:67], v2 offset:16384
v_exp_f32 v56, v56
v_mfma_f32_16x16x32_bf16 a[188:191], a[84:87], v[124:127], a[188:191]
s_waitcnt lgkmcnt(2)
v_exp_f32 v57, v57
v_mfma_f32_16x16x32_bf16 a[200:203], a[88:91], v[120:123], a[200:203]
ds_read_b128 a[68:71], v2 offset:17408
v_exp_f32 v58, v58
v_mfma_f32_16x16x32_bf16 a[204:207], a[88:91], v[124:127], a[204:207]
s_waitcnt lgkmcnt(2)
v_exp_f32 v59, v59
v_cvt_pk_bf16_f32 v108, v56, v57
v_mfma_f32_16x16x32_bf16 a[216:219], a[92:95], v[120:123], a[216:219]
ds_read_b128 a[72:75], v2 offset:18432
v_exp_f32 v60, v60
v_mfma_f32_16x16x32_bf16 a[220:223], a[92:95], v[124:127], a[220:223]
s_waitcnt lgkmcnt(2)
s_cmp_eq_u32 s48, 0
s_cbranch_scc0 L_at_rs8
L_at_rsr8:
v_cvt_pk_bf16_f32 v109, v58, v59
v_mfma_f32_16x16x32_bf16 v[88:91], a[64:67], a[48:51], v[140:143]
ds_read_b128 a[76:79], v2 offset:19456
s_waitcnt lgkmcnt(2)
v_mfma_f32_16x16x32_bf16 v[92:95], a[68:71], a[48:51], v[140:143]
ds_read_b128 a[80:83], v2 offset:20480
s_waitcnt lgkmcnt(2)
v_exp_f32 v61, v61
v_mfma_f32_16x16x32_bf16 v[88:91], a[72:75], a[52:55], v[88:91]
ds_read_b128 a[84:87], v2 offset:21504
s_waitcnt lgkmcnt(2)
v_cvt_pk_bf16_f32 v110, v60, v61
v_mfma_f32_16x16x32_bf16 v[92:95], a[76:79], a[52:55], v[92:95]
ds_read_b128 a[88:91], v2 offset:22528
s_waitcnt lgkmcnt(2)
v_mfma_f32_16x16x32_bf16 v[88:91], a[80:83], a[56:59], v[88:91]
ds_read_b128 a[92:95], v2 offset:23552
s_waitcnt lgkmcnt(2)
v_exp_f32 v62, v62
v_mfma_f32_16x16x32_bf16 v[92:95], a[84:87], a[56:59], v[92:95]
ds_read_b128 a[64:67], v2 offset:8192
s_waitcnt lgkmcnt(2)
v_mfma_f32_16x16x32_bf16 v[88:91], a[88:91], a[60:63], v[88:91]
ds_read_b128 a[68:71], v2 offset:9216
s_waitcnt lgkmcnt(2)
v_exp_f32 v63, v63
v_mfma_f32_16x16x32_bf16 v[92:95], a[92:95], a[60:63], v[92:95]
ds_read_b128 a[72:75], v2 offset:10240
s_waitcnt lgkmcnt(2)
v_cvt_pk_bf16_f32 v111, v62, v63
s_barrier
s_add_u32 s25, s61, 1048576
v_mfma_f32_16x16x32_bf16 a[236:239], a[240:243], v[108:111], a[236:239]
s_add_u32 s24, s46, 4096
s_add_u32 m0, s47, 0
v_mfma_f32_16x16x32_bf16 a[108:111], a[64:67], v[108:111], a[108:111]
ds_read_b128 a[76:79], v2 offset:11264
s_waitcnt lgkmcnt(2)
buffer_load_dwordx4 v1, s[8:11], s46 offen sc1 lds
buffer_load_dwordx4 v1, s[8:11], s46 offen offset:2048 sc1 lds
v_mfma_f32_16x16x32_bf16 a[124:127], a[68:71], v[108:111], a[124:127]
ds_read_b128 a[80:83], v2 offset:12288
s_waitcnt lgkmcnt(2)
s_add_u32 m0, s47, 896
s_nop 0
buffer_load_dwordx4 v1, s[8:11], s46 offen offset:128 sc1 lds
v_mfma_f32_16x16x32_bf16 a[140:143], a[72:75], v[108:111], a[140:143]
ds_read_b128 a[84:87], v2 offset:13312
s_waitcnt lgkmcnt(2)
buffer_load_dwordx4 v1, s[8:11], s46 offen offset:2176 sc1 lds
s_add_u32 m0, s47, 4096
v_cndmask_b32 v88, v8, v88, s[80:81]
v_cndmask_b32 v89, v8, v89, s[82:83]
v_cndmask_b32 v90, v8, v90, s[84:85]
v_mfma_f32_16x16x32_bf16 a[156:159], a[76:79], v[108:111], a[156:159]
ds_read_b128 a[88:91], v2 offset:14336
s_waitcnt lgkmcnt(2)
buffer_load_dwordx4 v1, s[8:11], s24 offen sc1 lds
v_cndmask_b32 v91, v8, v91, s[86:87]
v_cndmask_b32 v92, v8, v92, s[88:89]
v_cndmask_b32 v93, v8, v93, s[90:91]
v_cndmask_b32 v94, v8, v94, s[92:93]
v_mfma_f32_16x16x32_bf16 a[172:175], a[80:83], v[108:111], a[172:175]
ds_read_b128 a[92:95], v2 offset:15360
s_waitcnt lgkmcnt(2)
buffer_load_dwordx4 v1, s[8:11], s24 offen offset:2048 sc1 lds
s_add_u32 m0, s47, 4992
v_cndmask_b32 v95, v8, v95, s[94:95]
v_max3_f32 v16, v88, v89, v90
v_max3_f32 v16, v16, v91, v92
v_mfma_f32_16x16x32_bf16 a[188:191], a[84:87], v[108:111], a[188:191]
ds_read_b128 a[64:67], v2 offset:24576
s_waitcnt lgkmcnt(2)
buffer_load_dwordx4 v1, s[8:11], s24 offen offset:128 sc1 lds
buffer_load_dwordx4 v1, s[8:11], s24 offen offset:2176 sc1 lds
v_max3_f32 v16, v16, v93, v94
v_max_f32 v16, v16, v95
v_cmp_lt_f32 vcc, s54, v16
v_mfma_f32_16x16x32_bf16 a[204:207], a[88:91], v[108:111], a[204:207]
ds_read_b128 a[68:71], v2 offset:25600
s_waitcnt lgkmcnt(2)
s_add_u32 s46, s46, 1048576
s_add_u32 s47, s47, 32768
s_cbranch_vccnz L_at_up9
L_at_upr9:
v_exp_f32 v88, v88
v_exp_f32 v89, v89
v_exp_f32 v90, v90
v_exp_f32 v91, v91
v_exp_f32 v92, v92
v_exp_f32 v93, v93
v_exp_f32 v94, v94
v_exp_f32 v95, v95
v_accvgpr_read_b32 v18, a232
v_rcp_f32 v18, v18
v_accvgpr_read_b32 v224, a104
v_accvgpr_read_b32 v225, a105
v_accvgpr_read_b32 v226, a106
v_accvgpr_read_b32 v227, a107
v_accvgpr_read_b32 v228, a120
v_accvgpr_read_b32 v229, a121
v_accvgpr_read_b32 v230, a122
v_accvgpr_read_b32 v231, a123
v_mul_f32 v224, v224, v18
v_mul_f32 v225, v225, v18
v_mul_f32 v226, v226, v18
v_mul_f32 v227, v227, v18
v_mul_f32 v228, v228, v18
v_mul_f32 v229, v229, v18
v_mul_f32 v230, v230, v18
v_mul_f32 v231, v231, v18
v_cvt_pk_bf16_f32 v224, v224, v225
v_cvt_pk_bf16_f32 v225, v226, v227
v_cvt_pk_bf16_f32 v226, v228, v229
v_cvt_pk_bf16_f32 v227, v230, v231
buffer_store_dwordx4 v[224:227], v6, s[8:11], s25 offen sc1
v_accvgpr_read_b32 v232, a136
v_accvgpr_read_b32 v233, a137
v_accvgpr_read_b32 v234, a138
v_accvgpr_read_b32 v235, a139
v_accvgpr_read_b32 v236, a152
v_accvgpr_read_b32 v237, a153
v_accvgpr_read_b32 v238, a154
v_accvgpr_read_b32 v239, a155
v_mul_f32 v232, v232, v18
v_mul_f32 v233, v233, v18
v_mul_f32 v234, v234, v18
v_mul_f32 v235, v235, v18
v_mul_f32 v236, v236, v18
v_mul_f32 v237, v237, v18
v_mul_f32 v238, v238, v18
v_mul_f32 v239, v239, v18
v_cvt_pk_bf16_f32 v232, v232, v233
v_mfma_f32_16x16x32_bf16 a[220:223], a[92:95], v[108:111], a[220:223]
ds_read_b128 a[72:75], v2 offset:26624
s_waitcnt lgkmcnt(2)
s_and_b32 s47, s47, 131071
s_cmp_eq_u32 s48, 0
s_cbranch_scc0 L_at_rs9
L_at_rsr9:
v_cvt_pk_bf16_f32 v124, v88, v89
v_cvt_pk_bf16_f32 v125, v90, v91
v_cvt_pk_bf16_f32 v126, v92, v93
v_cvt_pk_bf16_f32 v127, v94, v95
v_cvt_pk_bf16_f32 v233, v234, v235
v_cvt_pk_bf16_f32 v234, v236, v237
v_cvt_pk_bf16_f32 v235, v238, v239
buffer_store_dwordx4 v[232:235], v6, s[8:11], s25 offen offset:1024 sc1
v_accvgpr_read_b32 v240, a168
v_accvgpr_read_b32 v241, a169
v_accvgpr_read_b32 v242, a170
v_accvgpr_read_b32 v243, a171
v_accvgpr_read_b32 v244, a184
v_accvgpr_read_b32 v245, a185
v_accvgpr_read_b32 v246, a186
v_accvgpr_read_b32 v247, a187
v_mul_f32 v240, v240, v18
v_mul_f32 v241, v241, v18
v_mul_f32 v242, v242, v18
v_mul_f32 v243, v243, v18
v_mul_f32 v244, v244, v18
v_mul_f32 v245, v245, v18
v_mul_f32 v246, v246, v18
v_mul_f32 v247, v247, v18
v_cvt_pk_bf16_f32 v240, v240, v241
v_cvt_pk_bf16_f32 v241, v242, v243
v_cvt_pk_bf16_f32 v242, v244, v245
v_cvt_pk_bf16_f32 v243, v246, v247
buffer_store_dwordx4 v[240:243], v6, s[8:11], s25 offen offset:2048 sc1
v_accvgpr_read_b32 v248, a200
v_accvgpr_read_b32 v249, a201
v_accvgpr_read_b32 v250, a202
v_accvgpr_read_b32 v251, a203
v_accvgpr_read_b32 v252, a216
v_accvgpr_read_b32 v253, a217
v_accvgpr_read_b32 v254, a218
v_accvgpr_read_b32 v255, a219
v_mul_f32 v248, v248, v18
v_mul_f32 v249, v249, v18
v_mul_f32 v250, v250, v18
v_mul_f32 v251, v251, v18
v_mul_f32 v252, v252, v18
v_mul_f32 v253, v253, v18
v_mul_f32 v254, v254, v18
v_mul_f32 v255, v255, v18
v_cvt_pk_bf16_f32 v248, v248, v249
v_cvt_pk_bf16_f32 v249, v250, v251
v_cvt_pk_bf16_f32 v250, v252, v253
v_cvt_pk_bf16_f32 v251, v254, v255
buffer_store_dwordx4 v[248:251], v6, s[8:11], s25 offen offset:3072 sc1
v_mfma_f32_16x16x32_bf16 a[236:239], a[240:243], v[124:127], a[236:239]
v_mfma_f32_16x16x32_bf16 a[108:111], a[64:67], v[124:127], a[108:111]
ds_read_b128 a[76:79], v2 offset:27648
s_waitcnt lgkmcnt(2)
v_mfma_f32_16x16x32_bf16 a[124:127], a[68:71], v[124:127], a[124:127]
ds_read_b128 a[80:83], v2 offset:28672
s_waitcnt lgkmcnt(2)
v_mfma_f32_16x16x32_bf16 a[140:143], a[72:75], v[124:127], a[140:143]
ds_read_b128 a[84:87], v2 offset:29696
s_waitcnt lgkmcnt(2)
v_mfma_f32_16x16x32_bf16 a[156:159], a[76:79], v[124:127], a[156:159]
ds_read_b128 a[88:91], v2 offset:30720
s_waitcnt lgkmcnt(2)
v_mfma_f32_16x16x32_bf16 a[172:175], a[80:83], v[124:127], a[172:175]
ds_read_b128 a[92:95], v2 offset:31744
s_waitcnt lgkmcnt(2)
v_mfma_f32_16x16x32_bf16 a[188:191], a[84:87], v[124:127], a[188:191]
s_waitcnt lgkmcnt(1)
v_mfma_f32_16x16x32_bf16 a[204:207], a[88:91], v[124:127], a[204:207]
s_waitcnt lgkmcnt(0)
v_mfma_f32_16x16x32_bf16 a[220:223], a[92:95], v[124:127], a[220:223]
s_add_u32 s25, s61, 1572864
v_accvgpr_read_b32 v18, a236
v_rcp_f32 v18, v18
v_accvgpr_read_b32 v224, a108
v_accvgpr_read_b32 v225, a109
v_accvgpr_read_b32 v226, a110
v_accvgpr_read_b32 v227, a111
v_accvgpr_read_b32 v228, a124
v_accvgpr_read_b32 v229, a125
v_accvgpr_read_b32 v230, a126
v_accvgpr_read_b32 v231, a127
v_mul_f32 v224, v224, v18
v_mul_f32 v225, v225, v18
v_mul_f32 v226, v226, v18
v_mul_f32 v227, v227, v18
v_mul_f32 v228, v228, v18
v_mul_f32 v229, v229, v18
v_mul_f32 v230, v230, v18
v_mul_f32 v231, v231, v18
v_cvt_pk_bf16_f32 v224, v224, v225
v_cvt_pk_bf16_f32 v225, v226, v227
v_cvt_pk_bf16_f32 v226, v228, v229
v_cvt_pk_bf16_f32 v227, v230, v231
buffer_store_dwordx4 v[224:227], v6, s[8:11], s25 offen sc1
v_accvgpr_read_b32 v232, a140
v_accvgpr_read_b32 v233, a141
v_accvgpr_read_b32 v234, a142
v_accvgpr_read_b32 v235, a143
v_accvgpr_read_b32 v236, a156
v_accvgpr_read_b32 v237, a157
v_accvgpr_read_b32 v238, a158
v_accvgpr_read_b32 v239, a159
v_mul_f32 v232, v232, v18
v_mul_f32 v233, v233, v18
v_mul_f32 v234, v234, v18
v_mul_f32 v235, v235, v18
v_mul_f32 v236, v236, v18
v_mul_f32 v237, v237, v18
v_mul_f32 v238, v238, v18
v_mul_f32 v239, v239, v18
v_cvt_pk_bf16_f32 v232, v232, v233
v_cvt_pk_bf16_f32 v233, v234, v235
v_cvt_pk_bf16_f32 v234, v236, v237
v_cvt_pk_bf16_f32 v235, v238, v239
buffer_store_dwordx4 v[232:235], v6, s[8:11], s25 offen offset:1024 sc1
v_accvgpr_read_b32 v240, a172
v_accvgpr_read_b32 v241, a173
v_accvgpr_read_b32 v242, a174
v_accvgpr_read_b32 v243, a175
v_accvgpr_read_b32 v244, a188
v_accvgpr_read_b32 v245, a189
v_accvgpr_read_b32 v246, a190
v_accvgpr_read_b32 v247, a191
v_mul_f32 v240, v240, v18
v_mul_f32 v241, v241, v18
v_mul_f32 v242, v242, v18
v_mul_f32 v243, v243, v18
v_mul_f32 v244, v244, v18
v_mul_f32 v245, v245, v18
v_mul_f32 v246, v246, v18
v_mul_f32 v247, v247, v18
v_cvt_pk_bf16_f32 v240, v240, v241
v_cvt_pk_bf16_f32 v241, v242, v243
v_cvt_pk_bf16_f32 v242, v244, v245
v_cvt_pk_bf16_f32 v243, v246, v247
buffer_store_dwordx4 v[240:243], v6, s[8:11], s25 offen offset:2048 sc1
v_accvgpr_read_b32 v248, a204
v_accvgpr_read_b32 v249, a205
v_accvgpr_read_b32 v250, a206
v_accvgpr_read_b32 v251, a207
v_accvgpr_read_b32 v252, a220
v_accvgpr_read_b32 v253, a221
v_accvgpr_read_b32 v254, a222
v_accvgpr_read_b32 v255, a223
v_mul_f32 v248, v248, v18
v_mul_f32 v249, v249, v18
v_mul_f32 v250, v250, v18
v_mul_f32 v251, v251, v18
v_mul_f32 v252, v252, v18
v_mul_f32 v253, v253, v18
v_mul_f32 v254, v254, v18
v_mul_f32 v255, v255, v18
v_cvt_pk_bf16_f32 v248, v248, v249
v_cvt_pk_bf16_f32 v249, v250, v251
v_cvt_pk_bf16_f32 v250, v252, v253
v_cvt_pk_bf16_f32 v251, v254, v255
buffer_store_dwordx4 v[248:251], v6, s[8:11], s25 offen offset:3072 sc1
s_lshl_b32 s60, s41, 5
s_add_u32 s60, s60, s42
s_lshl_b32 s60, s60, 2
s_add_u32 s60, s60, 111169536
s_cmp_eq_u32 s17, 0
s_cselect_b32 s60, s60, 536870912
s_mov_b32 s41, s63
s_mov_b32 s63, 8
s_waitcnt vmcnt(28)
s_cmp_lt_u32 s41, 8
s_cbranch_scc1 L_at_item
s_waitcnt vmcnt(0)
s_barrier
v_mov_b32 v19, 1
s_mov_b64 exec, 1
buffer_store_dword v19, v6, s[8:11], s60 offen sc1
s_mov_b64 exec, -1
s_branch L_at_done
L_at_hk:
s_cmp_eq_u32 s45, 2
s_cbranch_scc0 L_at_hk2
v_mov_b32 v19, 1
s_mov_b64 exec, 1
buffer_store_dword v19, v6, s[8:11], s60 offen sc1
s_mov_b64 exec, -1
s_mov_b32 s60, 536870912
s_mov_b32 s45, 13
s_branch L_at_hkr
L_at_hk2:
v_and_b32 v20, 3, v0
v_lshlrev_b32 v20, 2, v20
s_lshl_b32 s25, s42, 7
s_add_u32 s25, s25, 111165456
s_mov_b32 s28, 0
L_poll_16:
buffer_load_dword v21, v20, s[8:11], s25 offen sc1
s_add_u32 s28, s28, 1
s_cmp_gt_u32 s28, 200000
s_cbranch_scc1 L_end
s_waitcnt vmcnt(0)
v_cmp_ne_u32 vcc, 1, v21
s_cbranch_vccz L_pd_17
s_sleep 1
s_branch L_poll_16
L_pd_17:
s_branch L_at_hkr
L_at_up0:
v_max3_f32 v16, v32, v33, v34
v_max3_f32 v16, v16, v35, v36
v_max3_f32 v16, v16, v37, v38
v_max_f32 v16, v16, v39
v_mov_b32 v17, v16
s_nop 1
v_permlane32_swap_b32 v17, v16
v_max_f32 v16, v16, v17
v_mov_b32 v17, v16
s_nop 1
v_permlane16_swap_b32 v17, v16
v_max3_f32 v16, v16, v17, s55
v_exp_f32 v12, -v16
v_sub_f32 v32, v32, v16
v_sub_f32 v33, v33, v16
v_sub_f32 v34, v34, v16
v_sub_f32 v35, v35, v16
v_sub_f32 v36, v36, v16
v_sub_f32 v37, v37, v16
v_sub_f32 v38, v38, v16
v_sub_f32 v39, v39, v16
v_sub_f32 v128, v128, v16
v_sub_f32 v129, v129, v16
v_sub_f32 v130, v130, v16
v_sub_f32 v131, v131, v16
v_max3_f32 v16, v40, v41, v42
v_max3_f32 v16, v16, v43, v44
v_max3_f32 v16, v16, v45, v46
v_max_f32 v16, v16, v47
v_mov_b32 v17, v16
s_nop 1
v_permlane32_swap_b32 v17, v16
v_max_f32 v16, v16, v17
v_mov_b32 v17, v16
s_nop 1
v_permlane16_swap_b32 v17, v16
v_max3_f32 v16, v16, v17, s55
v_exp_f32 v13, -v16
v_sub_f32 v40, v40, v16
v_sub_f32 v41, v41, v16
v_sub_f32 v42, v42, v16
v_sub_f32 v43, v43, v16
v_sub_f32 v44, v44, v16
v_sub_f32 v45, v45, v16
v_sub_f32 v46, v46, v16
v_sub_f32 v47, v47, v16
v_sub_f32 v132, v132, v16
v_sub_f32 v133, v133, v16
v_sub_f32 v134, v134, v16
v_sub_f32 v135, v135, v16
v_max3_f32 v16, v48, v49, v50
v_max3_f32 v16, v16, v51, v52
v_max3_f32 v16, v16, v53, v54
v_max_f32 v16, v16, v55
v_mov_b32 v17, v16
s_nop 1
v_permlane32_swap_b32 v17, v16
v_max_f32 v16, v16, v17
v_mov_b32 v17, v16
s_nop 1
v_permlane16_swap_b32 v17, v16
v_max3_f32 v16, v16, v17, s55
v_exp_f32 v14, -v16
v_sub_f32 v48, v48, v16
v_sub_f32 v49, v49, v16
v_sub_f32 v50, v50, v16
v_sub_f32 v51, v51, v16
v_sub_f32 v52, v52, v16
v_sub_f32 v53, v53, v16
v_sub_f32 v54, v54, v16
v_sub_f32 v55, v55, v16
v_sub_f32 v136, v136, v16
v_sub_f32 v137, v137, v16
v_sub_f32 v138, v138, v16
v_sub_f32 v139, v139, v16
v_max3_f32 v16, v56, v57, v58
v_max3_f32 v16, v16, v59, v60
v_max3_f32 v16, v16, v61, v62
v_max_f32 v16, v16, v63
v_mov_b32 v17, v16
s_nop 1
v_permlane32_swap_b32 v17, v16
v_max_f32 v16, v16, v17
v_mov_b32 v17, v16
s_nop 1
v_permlane16_swap_b32 v17, v16
v_max3_f32 v16, v16, v17, s55
v_exp_f32 v15, -v16
v_sub_f32 v56, v56, v16
v_sub_f32 v57, v57, v16
v_sub_f32 v58, v58, v16
v_sub_f32 v59, v59, v16
v_sub_f32 v60, v60, v16
v_sub_f32 v61, v61, v16
v_sub_f32 v62, v62, v16
v_sub_f32 v63, v63, v16
v_sub_f32 v140, v140, v16
v_sub_f32 v141, v141, v16
v_sub_f32 v142, v142, v16
v_sub_f32 v143, v143, v16
s_cmp_eq_u32 s55, 0
s_cselect_b32 s48, 1, 0
s_mov_b32 s55, 0
s_mov_b32 s54, s51
s_branch L_at_upr0
L_at_rs0:
s_mov_b32 s52, 0
s_branch L_at_rescale
L_at_up1:
v_max3_f32 v16, v64, v65, v66
v_max3_f32 v16, v16, v67, v68
v_max3_f32 v16, v16, v69, v70
v_max_f32 v16, v16, v71
v_mov_b32 v17, v16
s_nop 1
v_permlane32_swap_b32 v17, v16
v_max_f32 v16, v16, v17
v_mov_b32 v17, v16
s_nop 1
v_permlane16_swap_b32 v17, v16
v_max3_f32 v16, v16, v17, s55
v_exp_f32 v12, -v16
v_sub_f32 v64, v64, v16
v_sub_f32 v65, v65, v16
v_sub_f32 v66, v66, v16
v_sub_f32 v67, v67, v16
v_sub_f32 v68, v68, v16
v_sub_f32 v69, v69, v16
v_sub_f32 v70, v70, v16
v_sub_f32 v71, v71, v16
v_sub_f32 v128, v128, v16
v_sub_f32 v129, v129, v16
v_sub_f32 v130, v130, v16
v_sub_f32 v131, v131, v16
v_max3_f32 v16, v72, v73, v74
v_max3_f32 v16, v16, v75, v76
v_max3_f32 v16, v16, v77, v78
v_max_f32 v16, v16, v79
v_mov_b32 v17, v16
s_nop 1
v_permlane32_swap_b32 v17, v16
v_max_f32 v16, v16, v17
v_mov_b32 v17, v16
s_nop 1
v_permlane16_swap_b32 v17, v16
v_max3_f32 v16, v16, v17, s55
v_exp_f32 v13, -v16
v_sub_f32 v72, v72, v16
v_sub_f32 v73, v73, v16
v_sub_f32 v74, v74, v16
v_sub_f32 v75, v75, v16
v_sub_f32 v76, v76, v16
v_sub_f32 v77, v77, v16
v_sub_f32 v78, v78, v16
v_sub_f32 v79, v79, v16
v_sub_f32 v132, v132, v16
v_sub_f32 v133, v133, v16
v_sub_f32 v134, v134, v16
v_sub_f32 v135, v135, v16
v_max3_f32 v16, v80, v81, v82
v_max3_f32 v16, v16, v83, v84
v_max3_f32 v16, v16, v85, v86
v_max_f32 v16, v16, v87
v_mov_b32 v17, v16
s_nop 1
v_permlane32_swap_b32 v17, v16
v_max_f32 v16, v16, v17
v_mov_b32 v17, v16
s_nop 1
v_permlane16_swap_b32 v17, v16
v_max3_f32 v16, v16, v17, s55
v_exp_f32 v14, -v16
v_sub_f32 v80, v80, v16
v_sub_f32 v81, v81, v16
v_sub_f32 v82, v82, v16
v_sub_f32 v83, v83, v16
v_sub_f32 v84, v84, v16
v_sub_f32 v85, v85, v16
v_sub_f32 v86, v86, v16
v_sub_f32 v87, v87, v16
v_sub_f32 v136, v136, v16
v_sub_f32 v137, v137, v16
v_sub_f32 v138, v138, v16
v_sub_f32 v139, v139, v16
v_max3_f32 v16, v88, v89, v90
v_max3_f32 v16, v16, v91, v92
v_max3_f32 v16, v16, v93, v94
v_max_f32 v16, v16, v95
v_mov_b32 v17, v16
s_nop 1
v_permlane32_swap_b32 v17, v16
v_max_f32 v16, v16, v17
v_mov_b32 v17, v16
s_nop 1
v_permlane16_swap_b32 v17, v16
v_max3_f32 v16, v16, v17, s55
v_exp_f32 v15, -v16
v_sub_f32 v88, v88, v16
v_sub_f32 v89, v89, v16
v_sub_f32 v90, v90, v16
v_sub_f32 v91, v91, v16
v_sub_f32 v92, v92, v16
v_sub_f32 v93, v93, v16
v_sub_f32 v94, v94, v16
v_sub_f32 v95, v95, v16
v_sub_f32 v140, v140, v16
v_sub_f32 v141, v141, v16
v_sub_f32 v142, v142, v16
v_sub_f32 v143, v143, v16
s_cmp_eq_u32 s55, 0
s_cselect_b32 s48, 1, 0
s_mov_b32 s55, 0
s_mov_b32 s54, s51
s_branch L_at_upr1
L_at_rs1:
s_mov_b32 s52, 1
s_branch L_at_rescale
L_at_up2:
v_max3_f32 v16, v32, v33, v34
v_max3_f32 v16, v16, v35, v36
v_max3_f32 v16, v16, v37, v38
v_max_f32 v16, v16, v39
v_mov_b32 v17, v16
s_nop 1
v_permlane32_swap_b32 v17, v16
v_max_f32 v16, v16, v17
v_mov_b32 v17, v16
s_nop 1
v_permlane16_swap_b32 v17, v16
v_max3_f32 v16, v16, v17, s55
v_exp_f32 v12, -v16
v_sub_f32 v32, v32, v16
v_sub_f32 v33, v33, v16
v_sub_f32 v34, v34, v16
v_sub_f32 v35, v35, v16
v_sub_f32 v36, v36, v16
v_sub_f32 v37, v37, v16
v_sub_f32 v38, v38, v16
v_sub_f32 v39, v39, v16
v_sub_f32 v128, v128, v16
v_sub_f32 v129, v129, v16
v_sub_f32 v130, v130, v16
v_sub_f32 v131, v131, v16
v_max3_f32 v16, v40, v41, v42
v_max3_f32 v16, v16, v43, v44
v_max3_f32 v16, v16, v45, v46
v_max_f32 v16, v16, v47
v_mov_b32 v17, v16
s_nop 1
v_permlane32_swap_b32 v17, v16
v_max_f32 v16, v16, v17
v_mov_b32 v17, v16
s_nop 1
v_permlane16_swap_b32 v17, v16
v_max3_f32 v16, v16, v17, s55
v_exp_f32 v13, -v16
v_sub_f32 v40, v40, v16
v_sub_f32 v41, v41, v16
v_sub_f32 v42, v42, v16
v_sub_f32 v43, v43, v16
v_sub_f32 v44, v44, v16
v_sub_f32 v45, v45, v16
v_sub_f32 v46, v46, v16
v_sub_f32 v47, v47, v16
v_sub_f32 v132, v132, v16
v_sub_f32 v133, v133, v16
v_sub_f32 v134, v134, v16
v_sub_f32 v135, v135, v16
v_max3_f32 v16, v48, v49, v50
v_max3_f32 v16, v16, v51, v52
v_max3_f32 v16, v16, v53, v54
v_max_f32 v16, v16, v55
v_mov_b32 v17, v16
s_nop 1
v_permlane32_swap_b32 v17, v16
v_max_f32 v16, v16, v17
v_mov_b32 v17, v16
s_nop 1
v_permlane16_swap_b32 v17, v16
v_max3_f32 v16, v16, v17, s55
v_exp_f32 v14, -v16
v_sub_f32 v48, v48, v16
v_sub_f32 v49, v49, v16
v_sub_f32 v50, v50, v16
v_sub_f32 v51, v51, v16
v_sub_f32 v52, v52, v16
v_sub_f32 v53, v53, v16
v_sub_f32 v54, v54, v16
v_sub_f32 v55, v55, v16
v_sub_f32 v136, v136, v16
v_sub_f32 v137, v137, v16
v_sub_f32 v138, v138, v16
v_sub_f32 v139, v139, v16
v_max3_f32 v16, v56, v57, v58
v_max3_f32 v16, v16, v59, v60
v_max3_f32 v16, v16, v61, v62
v_max_f32 v16, v16, v63
v_mov_b32 v17, v16
s_nop 1
v_permlane32_swap_b32 v17, v16
v_max_f32 v16, v16, v17
v_mov_b32 v17, v16
s_nop 1
v_permlane16_swap_b32 v17, v16
v_max3_f32 v16, v16, v17, s55
v_exp_f32 v15, -v16
v_sub_f32 v56, v56, v16
v_sub_f32 v57, v57, v16
v_sub_f32 v58, v58, v16
v_sub_f32 v59, v59, v16
v_sub_f32 v60, v60, v16
v_sub_f32 v61, v61, v16
v_sub_f32 v62, v62, v16
v_sub_f32 v63, v63, v16
v_sub_f32 v140, v140, v16
v_sub_f32 v141, v141, v16
v_sub_f32 v142, v142, v16
v_sub_f32 v143, v143, v16
s_cmp_eq_u32 s55, 0
s_cselect_b32 s48, 1, 0
s_mov_b32 s55, 0
s_mov_b32 s54, s51
s_branch L_at_upr2
L_at_rs2:
s_mov_b32 s52, 2
s_branch L_at_rescale
L_at_up3:
v_max3_f32 v16, v64, v65, v66
v_max3_f32 v16, v16, v67, v68
v_max3_f32 v16, v16, v69, v70
v_max_f32 v16, v16, v71
v_mov_b32 v17, v16
s_nop 1
v_permlane32_swap_b32 v17, v16
v_max_f32 v16, v16, v17
v_mov_b32 v17, v16
s_nop 1
v_permlane16_swap_b32 v17, v16
v_max3_f32 v16, v16, v17, s55
v_exp_f32 v12, -v16
v_sub_f32 v64, v64, v16
v_sub_f32 v65, v65, v16
v_sub_f32 v66, v66, v16
v_sub_f32 v67, v67, v16
v_sub_f32 v68, v68, v16
v_sub_f32 v69, v69, v16
v_sub_f32 v70, v70, v16
v_sub_f32 v71, v71, v16
v_sub_f32 v128, v128, v16
v_sub_f32 v129, v129, v16
v_sub_f32 v130, v130, v16
v_sub_f32 v131, v131, v16
v_max3_f32 v16, v72, v73, v74
v_max3_f32 v16, v16, v75, v76
v_max3_f32 v16, v16, v77, v78
v_max_f32 v16, v16, v79
v_mov_b32 v17, v16
s_nop 1
v_permlane32_swap_b32 v17, v16
v_max_f32 v16, v16, v17
v_mov_b32 v17, v16
s_nop 1
v_permlane16_swap_b32 v17, v16
v_max3_f32 v16, v16, v17, s55
v_exp_f32 v13, -v16
v_sub_f32 v72, v72, v16
v_sub_f32 v73, v73, v16
v_sub_f32 v74, v74, v16
v_sub_f32 v75, v75, v16
v_sub_f32 v76, v76, v16
v_sub_f32 v77, v77, v16
v_sub_f32 v78, v78, v16
v_sub_f32 v79, v79, v16
v_sub_f32 v132, v132, v16
v_sub_f32 v133, v133, v16
v_sub_f32 v134, v134, v16
v_sub_f32 v135, v135, v16
v_max3_f32 v16, v80, v81, v82
v_max3_f32 v16, v16, v83, v84
v_max3_f32 v16, v16, v85, v86
v_max_f32 v16, v16, v87
v_mov_b32 v17, v16
s_nop 1
v_permlane32_swap_b32 v17, v16
v_max_f32 v16, v16, v17
v_mov_b32 v17, v16
s_nop 1
v_permlane16_swap_b32 v17, v16
v_max3_f32 v16, v16, v17, s55
v_exp_f32 v14, -v16
v_sub_f32 v80, v80, v16
v_sub_f32 v81, v81, v16
v_sub_f32 v82, v82, v16
v_sub_f32 v83, v83, v16
v_sub_f32 v84, v84, v16
v_sub_f32 v85, v85, v16
v_sub_f32 v86, v86, v16
v_sub_f32 v87, v87, v16
v_sub_f32 v136, v136, v16
v_sub_f32 v137, v137, v16
v_sub_f32 v138, v138, v16
v_sub_f32 v139, v139, v16
v_max3_f32 v16, v88, v89, v90
v_max3_f32 v16, v16, v91, v92
v_max3_f32 v16, v16, v93, v94
v_max_f32 v16, v16, v95
v_mov_b32 v17, v16
s_nop 1
v_permlane32_swap_b32 v17, v16
v_max_f32 v16, v16, v17
v_mov_b32 v17, v16
s_nop 1
v_permlane16_swap_b32 v17, v16
v_max3_f32 v16, v16, v17, s55
v_exp_f32 v15, -v16
v_sub_f32 v88, v88, v16
v_sub_f32 v89, v89, v16
v_sub_f32 v90, v90, v16
v_sub_f32 v91, v91, v16
v_sub_f32 v92, v92, v16
v_sub_f32 v93, v93, v16
v_sub_f32 v94, v94, v16
v_sub_f32 v95, v95, v16
v_sub_f32 v140, v140, v16
v_sub_f32 v141, v141, v16
v_sub_f32 v142, v142, v16
v_sub_f32 v143, v143, v16
s_cmp_eq_u32 s55, 0
s_cselect_b32 s48, 1, 0
s_mov_b32 s55, 0
s_mov_b32 s54, s51
s_branch L_at_upr3
L_at_rs3:
s_mov_b32 s52, 3
s_branch L_at_rescale
L_at_up4:
v_mov_b32 v12, 1.0
v_max3_f32 v16, v40, v41, v42
v_max3_f32 v16, v16, v43, v44
v_max3_f32 v16, v16, v45, v46
v_max_f32 v16, v16, v47
v_mov_b32 v17, v16
s_nop 1
v_permlane32_swap_b32 v17, v16
v_max_f32 v16, v16, v17
v_mov_b32 v17, v16
s_nop 1
v_permlane16_swap_b32 v17, v16
v_max3_f32 v16, v16, v17, s55
v_exp_f32 v13, -v16
v_sub_f32 v40, v40, v16
v_sub_f32 v41, v41, v16
v_sub_f32 v42, v42, v16
v_sub_f32 v43, v43, v16
v_sub_f32 v44, v44, v16
v_sub_f32 v45, v45, v16
v_sub_f32 v46, v46, v16
v_sub_f32 v47, v47, v16
v_sub_f32 v132, v132, v16
v_sub_f32 v133, v133, v16
v_sub_f32 v134, v134, v16
v_sub_f32 v135, v135, v16
v_max3_f32 v16, v48, v49, v50
v_max3_f32 v16, v16, v51, v52
v_max3_f32 v16, v16, v53, v54
v_max_f32 v16, v16, v55
v_mov_b32 v17, v16
s_nop 1
v_permlane32_swap_b32 v17, v16
v_max_f32 v16, v16, v17
v_mov_b32 v17, v16
s_nop 1
v_permlane16_swap_b32 v17, v16
v_max3_f32 v16, v16, v17, s55
v_exp_f32 v14, -v16
v_sub_f32 v48, v48, v16
v_sub_f32 v49, v49, v16
v_sub_f32 v50, v50, v16
v_sub_f32 v51, v51, v16
v_sub_f32 v52, v52, v16
v_sub_f32 v53, v53, v16
v_sub_f32 v54, v54, v16
v_sub_f32 v55, v55, v16
v_sub_f32 v136, v136, v16
v_sub_f32 v137, v137, v16
v_sub_f32 v138, v138, v16
v_sub_f32 v139, v139, v16
v_max3_f32 v16, v56, v57, v58
v_max3_f32 v16, v16, v59, v60
v_max3_f32 v16, v16, v61, v62
v_max_f32 v16, v16, v63
v_mov_b32 v17, v16
s_nop 1
v_permlane32_swap_b32 v17, v16
v_max_f32 v16, v16, v17
v_mov_b32 v17, v16
s_nop 1
v_permlane16_swap_b32 v17, v16
v_max3_f32 v16, v16, v17, s55
v_exp_f32 v15, -v16
v_sub_f32 v56, v56, v16
v_sub_f32 v57, v57, v16
v_sub_f32 v58, v58, v16
v_sub_f32 v59, v59, v16
v_sub_f32 v60, v60, v16
v_sub_f32 v61, v61, v16
v_sub_f32 v62, v62, v16
v_sub_f32 v63, v63, v16
v_sub_f32 v140, v140, v16
v_sub_f32 v141, v141, v16
v_sub_f32 v142, v142, v16
v_sub_f32 v143, v143, v16
s_cmp_eq_u32 s55, 0
s_cselect_b32 s48, 1, 0
s_mov_b32 s55, 0
s_mov_b32 s54, s51
s_branch L_at_upr4
L_at_rs4:
s_mov_b32 s52, 4
s_branch L_at_rescale
L_at_up5:
v_mov_b32 v12, 1.0
v_max3_f32 v16, v72, v73, v74
v_max3_f32 v16, v16, v75, v76
v_max3_f32 v16, v16, v77, v78
v_max_f32 v16, v16, v79
v_mov_b32 v17, v16
s_nop 1
v_permlane32_swap_b32 v17, v16
v_max_f32 v16, v16, v17
v_mov_b32 v17, v16
s_nop 1
v_permlane16_swap_b32 v17, v16
v_max3_f32 v16, v16, v17, s55
v_exp_f32 v13, -v16
v_sub_f32 v72, v72, v16
v_sub_f32 v73, v73, v16
v_sub_f32 v74, v74, v16
v_sub_f32 v75, v75, v16
v_sub_f32 v76, v76, v16
v_sub_f32 v77, v77, v16
v_sub_f32 v78, v78, v16
v_sub_f32 v79, v79, v16
v_sub_f32 v132, v132, v16
v_sub_f32 v133, v133, v16
v_sub_f32 v134, v134, v16
v_sub_f32 v135, v135, v16
v_max3_f32 v16, v80, v81, v82
v_max3_f32 v16, v16, v83, v84
v_max3_f32 v16, v16, v85, v86
v_max_f32 v16, v16, v87
v_mov_b32 v17, v16
s_nop 1
v_permlane32_swap_b32 v17, v16
v_max_f32 v16, v16, v17
v_mov_b32 v17, v16
s_nop 1
v_permlane16_swap_b32 v17, v16
v_max3_f32 v16, v16, v17, s55
v_exp_f32 v14, -v16
v_sub_f32 v80, v80, v16
v_sub_f32 v81, v81, v16
v_sub_f32 v82, v82, v16
v_sub_f32 v83, v83, v16
v_sub_f32 v84, v84, v16
v_sub_f32 v85, v85, v16
v_sub_f32 v86, v86, v16
v_sub_f32 v87, v87, v16
v_sub_f32 v136, v136, v16
v_sub_f32 v137, v137, v16
v_sub_f32 v138, v138, v16
v_sub_f32 v139, v139, v16
v_max3_f32 v16, v88, v89, v90
v_max3_f32 v16, v16, v91, v92
v_max3_f32 v16, v16, v93, v94
v_max_f32 v16, v16, v95
v_mov_b32 v17, v16
s_nop 1
v_permlane32_swap_b32 v17, v16
v_max_f32 v16, v16, v17
v_mov_b32 v17, v16
s_nop 1
v_permlane16_swap_b32 v17, v16
v_max3_f32 v16, v16, v17, s55
v_exp_f32 v15, -v16
v_sub_f32 v88, v88, v16
v_sub_f32 v89, v89, v16
v_sub_f32 v90, v90, v16
v_sub_f32 v91, v91, v16
v_sub_f32 v92, v92, v16
v_sub_f32 v93, v93, v16
v_sub_f32 v94, v94, v16
v_sub_f32 v95, v95, v16
v_sub_f32 v140, v140, v16
v_sub_f32 v141, v141, v16
v_sub_f32 v142, v142, v16
v_sub_f32 v143, v143, v16
s_cmp_eq_u32 s55, 0
s_cselect_b32 s48, 1, 0
s_mov_b32 s55, 0
s_mov_b32 s54, s51
s_branch L_at_upr5
L_at_rs5:
s_mov_b32 s52, 5
s_branch L_at_rescale
L_at_up6:
v_mov_b32 v12, 1.0
v_mov_b32 v13, 1.0
v_max3_f32 v16, v48, v49, v50
v_max3_f32 v16, v16, v51, v52
v_max3_f32 v16, v16, v53, v54
v_max_f32 v16, v16, v55
v_mov_b32 v17, v16
s_nop 1
v_permlane32_swap_b32 v17, v16
v_max_f32 v16, v16, v17
v_mov_b32 v17, v16
s_nop 1
v_permlane16_swap_b32 v17, v16
v_max3_f32 v16, v16, v17, s55
v_exp_f32 v14, -v16
v_sub_f32 v48, v48, v16
v_sub_f32 v49, v49, v16
v_sub_f32 v50, v50, v16
v_sub_f32 v51, v51, v16
v_sub_f32 v52, v52, v16
v_sub_f32 v53, v53, v16
v_sub_f32 v54, v54, v16
v_sub_f32 v55, v55, v16
v_sub_f32 v136, v136, v16
v_sub_f32 v137, v137, v16
v_sub_f32 v138, v138, v16
v_sub_f32 v139, v139, v16
v_max3_f32 v16, v56, v57, v58
v_max3_f32 v16, v16, v59, v60
v_max3_f32 v16, v16, v61, v62
v_max_f32 v16, v16, v63
v_mov_b32 v17, v16
s_nop 1
v_permlane32_swap_b32 v17, v16
v_max_f32 v16, v16, v17
v_mov_b32 v17, v16
s_nop 1
v_permlane16_swap_b32 v17, v16
v_max3_f32 v16, v16, v17, s55
v_exp_f32 v15, -v16
v_sub_f32 v56, v56, v16
v_sub_f32 v57, v57, v16
v_sub_f32 v58, v58, v16
v_sub_f32 v59, v59, v16
v_sub_f32 v60, v60, v16
v_sub_f32 v61, v61, v16
v_sub_f32 v62, v62, v16
v_sub_f32 v63, v63, v16
v_sub_f32 v140, v140, v16
v_sub_f32 v141, v141, v16
v_sub_f32 v142, v142, v16
v_sub_f32 v143, v143, v16
s_cmp_eq_u32 s55, 0
s_cselect_b32 s48, 1, 0
s_mov_b32 s55, 0
s_mov_b32 s54, s51
s_branch L_at_upr6
L_at_rs6:
s_mov_b32 s52, 6
s_branch L_at_rescale
L_at_up7:
v_mov_b32 v12, 1.0
v_mov_b32 v13, 1.0
v_max3_f32 v16, v80, v81, v82
v_max3_f32 v16, v16, v83, v84
v_max3_f32 v16, v16, v85, v86
v_max_f32 v16, v16, v87
v_mov_b32 v17, v16
s_nop 1
v_permlane32_swap_b32 v17, v16
v_max_f32 v16, v16, v17
v_mov_b32 v17, v16
s_nop 1
v_permlane16_swap_b32 v17, v16
v_max3_f32 v16, v16, v17, s55
v_exp_f32 v14, -v16
v_sub_f32 v80, v80, v16
v_sub_f32 v81, v81, v16
v_sub_f32 v82, v82, v16
v_sub_f32 v83, v83, v16
v_sub_f32 v84, v84, v16
v_sub_f32 v85, v85, v16
v_sub_f32 v86, v86, v16
v_sub_f32 v87, v87, v16
v_sub_f32 v136, v136, v16
v_sub_f32 v137, v137, v16
v_sub_f32 v138, v138, v16
v_sub_f32 v139, v139, v16
v_max3_f32 v16, v88, v89, v90
v_max3_f32 v16, v16, v91, v92
v_max3_f32 v16, v16, v93, v94
v_max_f32 v16, v16, v95
v_mov_b32 v17, v16
s_nop 1
v_permlane32_swap_b32 v17, v16
v_max_f32 v16, v16, v17
v_mov_b32 v17, v16
s_nop 1
v_permlane16_swap_b32 v17, v16
v_max3_f32 v16, v16, v17, s55
v_exp_f32 v15, -v16
v_sub_f32 v88, v88, v16
v_sub_f32 v89, v89, v16
v_sub_f32 v90, v90, v16
v_sub_f32 v91, v91, v16
v_sub_f32 v92, v92, v16
v_sub_f32 v93, v93, v16
v_sub_f32 v94, v94, v16
v_sub_f32 v95, v95, v16
v_sub_f32 v140, v140, v16
v_sub_f32 v141, v141, v16
v_sub_f32 v142, v142, v16
v_sub_f32 v143, v143, v16
s_cmp_eq_u32 s55, 0
s_cselect_b32 s48, 1, 0
s_mov_b32 s55, 0
s_mov_b32 s54, s51
s_branch L_at_upr7
L_at_rs7:
s_mov_b32 s52, 7
s_branch L_at_rescale
L_at_up8:
v_mov_b32 v12, 1.0
v_mov_b32 v13, 1.0
v_mov_b32 v14, 1.0
v_max3_f32 v16, v56, v57, v58
v_max3_f32 v16, v16, v59, v60
v_max3_f32 v16, v16, v61, v62
v_max_f32 v16, v16, v63
v_mov_b32 v17, v16
s_nop 1
v_permlane32_swap_b32 v17, v16
v_max_f32 v16, v16, v17
v_mov_b32 v17, v16
s_nop 1
v_permlane16_swap_b32 v17, v16
v_max3_f32 v16, v16, v17, s55
v_exp_f32 v15, -v16
v_sub_f32 v56, v56, v16
v_sub_f32 v57, v57, v16
v_sub_f32 v58, v58, v16
v_sub_f32 v59, v59, v16
v_sub_f32 v60, v60, v16
v_sub_f32 v61, v61, v16
v_sub_f32 v62, v62, v16
v_sub_f32 v63, v63, v16
v_sub_f32 v140, v140, v16
v_sub_f32 v141, v141, v16
v_sub_f32 v142, v142, v16
v_sub_f32 v143, v143, v16
s_cmp_eq_u32 s55, 0
s_cselect_b32 s48, 1, 0
s_mov_b32 s55, 0
s_mov_b32 s54, s51
s_branch L_at_upr8
L_at_rs8:
s_mov_b32 s52, 8
s_branch L_at_rescale
L_at_up9:
v_mov_b32 v12, 1.0
v_mov_b32 v13, 1.0
v_mov_b32 v14, 1.0
v_max3_f32 v16, v88, v89, v90
v_max3_f32 v16, v16, v91, v92
v_max3_f32 v16, v16, v93, v94
v_max_f32 v16, v16, v95
v_mov_b32 v17, v16
s_nop 1
v_permlane32_swap_b32 v17, v16
v_max_f32 v16, v16, v17
v_mov_b32 v17, v16
s_nop 1
v_permlane16_swap_b32 v17, v16
v_max3_f32 v16, v16, v17, s55
v_exp_f32 v15, -v16
v_sub_f32 v88, v88, v16
v_sub_f32 v89, v89, v16
v_sub_f32 v90, v90, v16
v_sub_f32 v91, v91, v16
v_sub_f32 v92, v92, v16
v_sub_f32 v93, v93, v16
v_sub_f32 v94, v94, v16
v_sub_f32 v95, v95, v16
v_sub_f32 v140, v140, v16
v_sub_f32 v141, v141, v16
v_sub_f32 v142, v142, v16
v_sub_f32 v143, v143, v16
s_cmp_eq_u32 s55, 0
s_cselect_b32 s48, 1, 0
s_mov_b32 s55, 0
s_mov_b32 s54, s51
s_branch L_at_upr9
L_at_rs9:
s_mov_b32 s52, 9
s_branch L_at_rescale
L_at_rescale:
v_accvgpr_read_b32 v24, a96
v_accvgpr_read_b32 v25, a97
v_accvgpr_read_b32 v26, a98
v_accvgpr_read_b32 v27, a99
v_accvgpr_read_b32 v28, a100
v_accvgpr_read_b32 v29, a101
v_accvgpr_read_b32 v30, a102
v_accvgpr_read_b32 v31, a103
v_mul_f32 v24, v24, v12
v_mul_f32 v25, v25, v12
v_mul_f32 v26, v26, v12
v_mul_f32 v27, v27, v12
v_mul_f32 v28, v28, v13
v_mul_f32 v29, v29, v13
v_mul_f32 v30, v30, v13
v_mul_f32 v31, v31, v13
v_accvgpr_write_b32 a96, v24
v_accvgpr_write_b32 a97, v25
v_accvgpr_write_b32 a98, v26
v_accvgpr_write_b32 a99, v27
v_accvgpr_write_b32 a100, v28
v_accvgpr_write_b32 a101, v29
v_accvgpr_write_b32 a102, v30
v_accvgpr_write_b32 a103, v31
v_accvgpr_read_b32 v24, a104
v_accvgpr_read_b32 v25, a105
v_accvgpr_read_b32 v26, a106
v_accvgpr_read_b32 v27, a107
v_accvgpr_read_b32 v28, a108
v_accvgpr_read_b32 v29, a109
v_accvgpr_read_b32 v30, a110
v_accvgpr_read_b32 v31, a111
v_mul_f32 v24, v24, v14
v_mul_f32 v25, v25, v14
v_mul_f32 v26, v26, v14
v_mul_f32 v27, v27, v14
v_mul_f32 v28, v28, v15
v_mul_f32 v29, v29, v15
v_mul_f32 v30, v30, v15
v_mul_f32 v31, v31, v15
v_accvgpr_write_b32 a104, v24
v_accvgpr_write_b32 a105, v25
v_accvgpr_write_b32 a106, v26
v_accvgpr_write_b32 a107, v27
v_accvgpr_write_b32 a108, v28
v_accvgpr_write_b32 a109, v29
v_accvgpr_write_b32 a110, v30
v_accvgpr_write_b32 a111, v31
v_accvgpr_read_b32 v24, a112
v_accvgpr_read_b32 v25, a113
v_accvgpr_read_b32 v26, a114
v_accvgpr_read_b32 v27, a115
v_accvgpr_read_b32 v28, a116
v_accvgpr_read_b32 v29, a117
v_accvgpr_read_b32 v30, a118
v_accvgpr_read_b32 v31, a119
v_mul_f32 v24, v24, v12
v_mul_f32 v25, v25, v12
v_mul_f32 v26, v26, v12
v_mul_f32 v27, v27, v12
v_mul_f32 v28, v28, v13
v_mul_f32 v29, v29, v13
v_mul_f32 v30, v30, v13
v_mul_f32 v31, v31, v13
v_accvgpr_write_b32 a112, v24
v_accvgpr_write_b32 a113, v25
v_accvgpr_write_b32 a114, v26
v_accvgpr_write_b32 a115, v27
v_accvgpr_write_b32 a116, v28
v_accvgpr_write_b32 a117, v29
v_accvgpr_write_b32 a118, v30
v_accvgpr_write_b32 a119, v31
v_accvgpr_read_b32 v24, a120
v_accvgpr_read_b32 v25, a121
v_accvgpr_read_b32 v26, a122
v_accvgpr_read_b32 v27, a123
v_accvgpr_read_b32 v28, a124
v_accvgpr_read_b32 v29, a125
v_accvgpr_read_b32 v30, a126
v_accvgpr_read_b32 v31, a127
v_mul_f32 v24, v24, v14
v_mul_f32 v25, v25, v14
v_mul_f32 v26, v26, v14
v_mul_f32 v27, v27, v14
v_mul_f32 v28, v28, v15
v_mul_f32 v29, v29, v15
v_mul_f32 v30, v30, v15
v_mul_f32 v31, v31, v15
v_accvgpr_write_b32 a120, v24
v_accvgpr_write_b32 a121, v25
v_accvgpr_write_b32 a122, v26
v_accvgpr_write_b32 a123, v27
v_accvgpr_write_b32 a124, v28
v_accvgpr_write_b32 a125, v29
v_accvgpr_write_b32 a126, v30
v_accvgpr_write_b32 a127, v31
v_accvgpr_read_b32 v24, a128
v_accvgpr_read_b32 v25, a129
v_accvgpr_read_b32 v26, a130
v_accvgpr_read_b32 v27, a131
v_accvgpr_read_b32 v28, a132
v_accvgpr_read_b32 v29, a133
v_accvgpr_read_b32 v30, a134
v_accvgpr_read_b32 v31, a135
v_mul_f32 v24, v24, v12
v_mul_f32 v25, v25, v12
v_mul_f32 v26, v26, v12
v_mul_f32 v27, v27, v12
v_mul_f32 v28, v28, v13
v_mul_f32 v29, v29, v13
v_mul_f32 v30, v30, v13
v_mul_f32 v31, v31, v13
v_accvgpr_write_b32 a128, v24
v_accvgpr_write_b32 a129, v25
v_accvgpr_write_b32 a130, v26
v_accvgpr_write_b32 a131, v27
v_accvgpr_write_b32 a132, v28
v_accvgpr_write_b32 a133, v29
v_accvgpr_write_b32 a134, v30
v_accvgpr_write_b32 a135, v31
v_accvgpr_read_b32 v24, a136
v_accvgpr_read_b32 v25, a137
v_accvgpr_read_b32 v26, a138
v_accvgpr_read_b32 v27, a139
v_accvgpr_read_b32 v28, a140
v_accvgpr_read_b32 v29, a141
v_accvgpr_read_b32 v30, a142
v_accvgpr_read_b32 v31, a143
v_mul_f32 v24, v24, v14
v_mul_f32 v25, v25, v14
v_mul_f32 v26, v26, v14
v_mul_f32 v27, v27, v14
v_mul_f32 v28, v28, v15
v_mul_f32 v29, v29, v15
v_mul_f32 v30, v30, v15
v_mul_f32 v31, v31, v15
v_accvgpr_write_b32 a136, v24
v_accvgpr_write_b32 a137, v25
v_accvgpr_write_b32 a138, v26
v_accvgpr_write_b32 a139, v27
v_accvgpr_write_b32 a140, v28
v_accvgpr_write_b32 a141, v29
v_accvgpr_write_b32 a142, v30
v_accvgpr_write_b32 a143, v31
v_accvgpr_read_b32 v24, a144
v_accvgpr_read_b32 v25, a145
v_accvgpr_read_b32 v26, a146
v_accvgpr_read_b32 v27, a147
v_accvgpr_read_b32 v28, a148
v_accvgpr_read_b32 v29, a149
v_accvgpr_read_b32 v30, a150
v_accvgpr_read_b32 v31, a151
v_mul_f32 v24, v24, v12
v_mul_f32 v25, v25, v12
v_mul_f32 v26, v26, v12
v_mul_f32 v27, v27, v12
v_mul_f32 v28, v28, v13
v_mul_f32 v29, v29, v13
v_mul_f32 v30, v30, v13
v_mul_f32 v31, v31, v13
v_accvgpr_write_b32 a144, v24
v_accvgpr_write_b32 a145, v25
v_accvgpr_write_b32 a146, v26
v_accvgpr_write_b32 a147, v27
v_accvgpr_write_b32 a148, v28
v_accvgpr_write_b32 a149, v29
v_accvgpr_write_b32 a150, v30
v_accvgpr_write_b32 a151, v31
v_accvgpr_read_b32 v24, a152
v_accvgpr_read_b32 v25, a153
v_accvgpr_read_b32 v26, a154
v_accvgpr_read_b32 v27, a155
v_accvgpr_read_b32 v28, a156
v_accvgpr_read_b32 v29, a157
v_accvgpr_read_b32 v30, a158
v_accvgpr_read_b32 v31, a159
v_mul_f32 v24, v24, v14
v_mul_f32 v25, v25, v14
v_mul_f32 v26, v26, v14
v_mul_f32 v27, v27, v14
v_mul_f32 v28, v28, v15
v_mul_f32 v29, v29, v15
v_mul_f32 v30, v30, v15
v_mul_f32 v31, v31, v15
v_accvgpr_write_b32 a152, v24
v_accvgpr_write_b32 a153, v25
v_accvgpr_write_b32 a154, v26
v_accvgpr_write_b32 a155, v27
v_accvgpr_write_b32 a156, v28
v_accvgpr_write_b32 a157, v29
v_accvgpr_write_b32 a158, v30
v_accvgpr_write_b32 a159, v31
v_accvgpr_read_b32 v24, a160
v_accvgpr_read_b32 v25, a161
v_accvgpr_read_b32 v26, a162
v_accvgpr_read_b32 v27, a163
v_accvgpr_read_b32 v28, a164
v_accvgpr_read_b32 v29, a165
v_accvgpr_read_b32 v30, a166
v_accvgpr_read_b32 v31, a167
v_mul_f32 v24, v24, v12
v_mul_f32 v25, v25, v12
v_mul_f32 v26, v26, v12
v_mul_f32 v27, v27, v12
v_mul_f32 v28, v28, v13
v_mul_f32 v29, v29, v13
v_mul_f32 v30, v30, v13
v_mul_f32 v31, v31, v13
v_accvgpr_write_b32 a160, v24
v_accvgpr_write_b32 a161, v25
v_accvgpr_write_b32 a162, v26
v_accvgpr_write_b32 a163, v27
v_accvgpr_write_b32 a164, v28
v_accvgpr_write_b32 a165, v29
v_accvgpr_write_b32 a166, v30
v_accvgpr_write_b32 a167, v31
v_accvgpr_read_b32 v24, a168
v_accvgpr_read_b32 v25, a169
v_accvgpr_read_b32 v26, a170
v_accvgpr_read_b32 v27, a171
v_accvgpr_read_b32 v28, a172
v_accvgpr_read_b32 v29, a173
v_accvgpr_read_b32 v30, a174
v_accvgpr_read_b32 v31, a175
v_mul_f32 v24, v24, v14
v_mul_f32 v25, v25, v14
v_mul_f32 v26, v26, v14
v_mul_f32 v27, v27, v14
v_mul_f32 v28, v28, v15
v_mul_f32 v29, v29, v15
v_mul_f32 v30, v30, v15
v_mul_f32 v31, v31, v15
v_accvgpr_write_b32 a168, v24
v_accvgpr_write_b32 a169, v25
v_accvgpr_write_b32 a170, v26
v_accvgpr_write_b32 a171, v27
v_accvgpr_write_b32 a172, v28
v_accvgpr_write_b32 a173, v29
v_accvgpr_write_b32 a174, v30
v_accvgpr_write_b32 a175, v31
v_accvgpr_read_b32 v24, a176
v_accvgpr_read_b32 v25, a177
v_accvgpr_read_b32 v26, a178
v_accvgpr_read_b32 v27, a179
v_accvgpr_read_b32 v28, a180
v_accvgpr_read_b32 v29, a181
v_accvgpr_read_b32 v30, a182
v_accvgpr_read_b32 v31, a183
v_mul_f32 v24, v24, v12
v_mul_f32 v25, v25, v12
v_mul_f32 v26, v26, v12
v_mul_f32 v27, v27, v12
v_mul_f32 v28, v28, v13
v_mul_f32 v29, v29, v13
v_mul_f32 v30, v30, v13
v_mul_f32 v31, v31, v13
v_accvgpr_write_b32 a176, v24
v_accvgpr_write_b32 a177, v25
v_accvgpr_write_b32 a178, v26
v_accvgpr_write_b32 a179, v27
v_accvgpr_write_b32 a180, v28
v_accvgpr_write_b32 a181, v29
v_accvgpr_write_b32 a182, v30
v_accvgpr_write_b32 a183, v31
v_accvgpr_read_b32 v24, a184
v_accvgpr_read_b32 v25, a185
v_accvgpr_read_b32 v26, a186
v_accvgpr_read_b32 v27, a187
v_accvgpr_read_b32 v28, a188
v_accvgpr_read_b32 v29, a189
v_accvgpr_read_b32 v30, a190
v_accvgpr_read_b32 v31, a191
v_mul_f32 v24, v24, v14
v_mul_f32 v25, v25, v14
v_mul_f32 v26, v26, v14
v_mul_f32 v27, v27, v14
v_mul_f32 v28, v28, v15
v_mul_f32 v29, v29, v15
v_mul_f32 v30, v30, v15
v_mul_f32 v31, v31, v15
v_accvgpr_write_b32 a184, v24
v_accvgpr_write_b32 a185, v25
v_accvgpr_write_b32 a186, v26
v_accvgpr_write_b32 a187, v27
v_accvgpr_write_b32 a188, v28
v_accvgpr_write_b32 a189, v29
v_accvgpr_write_b32 a190, v30
v_accvgpr_write_b32 a191, v31
v_accvgpr_read_b32 v24, a192
v_accvgpr_read_b32 v25, a193
v_accvgpr_read_b32 v26, a194
v_accvgpr_read_b32 v27, a195
v_accvgpr_read_b32 v28, a196
v_accvgpr_read_b32 v29, a197
v_accvgpr_read_b32 v30, a198
v_accvgpr_read_b32 v31, a199
v_mul_f32 v24, v24, v12
v_mul_f32 v25, v25, v12
v_mul_f32 v26, v26, v12
v_mul_f32 v27, v27, v12
v_mul_f32 v28, v28, v13
v_mul_f32 v29, v29, v13
v_mul_f32 v30, v30, v13
v_mul_f32 v31, v31, v13
v_accvgpr_write_b32 a192, v24
v_accvgpr_write_b32 a193, v25
v_accvgpr_write_b32 a194, v26
v_accvgpr_write_b32 a195, v27
v_accvgpr_write_b32 a196, v28
v_accvgpr_write_b32 a197, v29
v_accvgpr_write_b32 a198, v30
v_accvgpr_write_b32 a199, v31
v_accvgpr_read_b32 v24, a200
v_accvgpr_read_b32 v25, a201
v_accvgpr_read_b32 v26, a202
v_accvgpr_read_b32 v27, a203
v_accvgpr_read_b32 v28, a204
v_accvgpr_read_b32 v29, a205
v_accvgpr_read_b32 v30, a206
v_accvgpr_read_b32 v31, a207
v_mul_f32 v24, v24, v14
v_mul_f32 v25, v25, v14
v_mul_f32 v26, v26, v14
v_mul_f32 v27, v27, v14
v_mul_f32 v28, v28, v15
v_mul_f32 v29, v29, v15
v_mul_f32 v30, v30, v15
v_mul_f32 v31, v31, v15
v_accvgpr_write_b32 a200, v24
v_accvgpr_write_b32 a201, v25
v_accvgpr_write_b32 a202, v26
v_accvgpr_write_b32 a203, v27
v_accvgpr_write_b32 a204, v28
v_accvgpr_write_b32 a205, v29
v_accvgpr_write_b32 a206, v30
v_accvgpr_write_b32 a207, v31
v_accvgpr_read_b32 v24, a208
v_accvgpr_read_b32 v25, a209
v_accvgpr_read_b32 v26, a210
v_accvgpr_read_b32 v27, a211
v_accvgpr_read_b32 v28, a212
v_accvgpr_read_b32 v29, a213
v_accvgpr_read_b32 v30, a214
v_accvgpr_read_b32 v31, a215
v_mul_f32 v24, v24, v12
v_mul_f32 v25, v25, v12
v_mul_f32 v26, v26, v12
v_mul_f32 v27, v27, v12
v_mul_f32 v28, v28, v13
v_mul_f32 v29, v29, v13
v_mul_f32 v30, v30, v13
v_mul_f32 v31, v31, v13
v_accvgpr_write_b32 a208, v24
v_accvgpr_write_b32 a209, v25
v_accvgpr_write_b32 a210, v26
v_accvgpr_write_b32 a211, v27
v_accvgpr_write_b32 a212, v28
v_accvgpr_write_b32 a213, v29
v_accvgpr_write_b32 a214, v30
v_accvgpr_write_b32 a215, v31
v_accvgpr_read_b32 v24, a216
v_accvgpr_read_b32 v25, a217
v_accvgpr_read_b32 v26, a218
v_accvgpr_read_b32 v27, a219
v_accvgpr_read_b32 v28, a220
v_accvgpr_read_b32 v29, a221
v_accvgpr_read_b32 v30, a222
v_accvgpr_read_b32 v31, a223
v_mul_f32 v24, v24, v14
v_mul_f32 v25, v25, v14
v_mul_f32 v26, v26, v14
v_mul_f32 v27, v27, v14
v_mul_f32 v28, v28, v15
v_mul_f32 v29, v29, v15
v_mul_f32 v30, v30, v15
v_mul_f32 v31, v31, v15
v_accvgpr_write_b32 a216, v24
v_accvgpr_write_b32 a217, v25
v_accvgpr_write_b32 a218, v26
v_accvgpr_write_b32 a219, v27
v_accvgpr_write_b32 a220, v28
v_accvgpr_write_b32 a221, v29
v_accvgpr_write_b32 a222, v30
v_accvgpr_write_b32 a223, v31
v_accvgpr_read_b32 v24, a224
v_accvgpr_read_b32 v25, a225
v_accvgpr_read_b32 v26, a226
v_accvgpr_read_b32 v27, a227
v_accvgpr_read_b32 v28, a228
v_accvgpr_read_b32 v29, a229
v_accvgpr_read_b32 v30, a230
v_accvgpr_read_b32 v31, a231
v_mul_f32 v24, v24, v12
v_mul_f32 v25, v25, v12
v_mul_f32 v26, v26, v12
v_mul_f32 v27, v27, v12
v_mul_f32 v28, v28, v13
v_mul_f32 v29, v29, v13
v_mul_f32 v30, v30, v13
v_mul_f32 v31, v31, v13
v_accvgpr_write_b32 a224, v24
v_accvgpr_write_b32 a225, v25
v_accvgpr_write_b32 a226, v26
v_accvgpr_write_b32 a227, v27
v_accvgpr_write_b32 a228, v28
v_accvgpr_write_b32 a229, v29
v_accvgpr_write_b32 a230, v30
v_accvgpr_write_b32 a231, v31
v_accvgpr_read_b32 v24, a232
v_accvgpr_read_b32 v25, a233
v_accvgpr_read_b32 v26, a234
v_accvgpr_read_b32 v27, a235
v_accvgpr_read_b32 v28, a236
v_accvgpr_read_b32 v29, a237
v_accvgpr_read_b32 v30, a238
v_accvgpr_read_b32 v31, a239
v_mul_f32 v24, v24, v14
v_mul_f32 v25, v25, v14
v_mul_f32 v26, v26, v14
v_mul_f32 v27, v27, v14
v_mul_f32 v28, v28, v15
v_mul_f32 v29, v29, v15
v_mul_f32 v30, v30, v15
v_mul_f32 v31, v31, v15
v_accvgpr_write_b32 a232, v24
v_accvgpr_write_b32 a233, v25
v_accvgpr_write_b32 a234, v26
v_accvgpr_write_b32 a235, v27
v_accvgpr_write_b32 a236, v28
v_accvgpr_write_b32 a237, v29
v_accvgpr_write_b32 a238, v30
v_accvgpr_write_b32 a239, v31
s_mov_b32 s48, 0
s_cmp_eq_u32 s52, 0
s_cbranch_scc1 L_at_rsr0
s_cmp_eq_u32 s52, 1
s_cbranch_scc1 L_at_rsr1
s_cmp_eq_u32 s52, 2
s_cbranch_scc1 L_at_rsr2
s_cmp_eq_u32 s52, 3
s_cbranch_scc1 L_at_rsr3
s_cmp_eq_u32 s52, 4
s_cbranch_scc1 L_at_rsr4
s_cmp_eq_u32 s52, 5
s_cbranch_scc1 L_at_rsr5
s_cmp_eq_u32 s52, 6
s_cbranch_scc1 L_at_rsr6
s_cmp_eq_u32 s52, 7
s_cbranch_scc1 L_at_rsr7
s_cmp_eq_u32 s52, 8
s_cbranch_scc1 L_at_rsr8
s_branch L_at_rsr9
L_at_done:
s_load_dwordx2 s[4:5], s[0:1], 40
s_waitcnt lgkmcnt(0)
s_mov_b32 s20, s4
s_and_b32 s21, s5, 0xffff
s_mov_b32 s22, 4718592
s_mov_b32 s23, 0x20000
s_sub_u32 s25, s3, 4
s_mul_i32 s24, s25, 27
s_add_u32 s24, s24, s16
s_mul_i32 s26, s25, 5
s_add_u32 s26, s26, s16
s_add_u32 s26, s26, 81
s_cmp_ge_u32 s16, 27
s_cselect_b32 s24, s26, s24
s_cmp_ge_u32 s24, 126
s_cbranch_scc1 L_done
s_mul_i32 s25, s24, 57
s_lshr_b32 s25, s25, 9
s_mul_i32 s26, s25, 9
s_sub_u32 s40, s24, s26
s_and_b32 s27, s25, 1
s_mov_b32 s26, s40
s_mov_b32 s4, 0x0
s_mov_b32 s5, 0x0
s_cmp_ge_u32 s25, 14
s_cbranch_scc1 L_bo2
s_and_b32 s51, s25, 1
s_add_u32 s51, s51, 126
s_lshr_b32 s25, s25, 1
s_cmp_eq_u32 s25, 0
s_cselect_b32 s42, 0x20408102, s42
s_cselect_b32 s43, 0x2040810, s43
s_cmp_eq_u32 s25, 1
s_cselect_b32 s42, 0x40810204, s42
s_cselect_b32 s43, 0x4081020, s43
s_cmp_eq_u32 s25, 2
s_cselect_b32 s42, 0x81020408, s42
s_cselect_b32 s43, 0x8102040, s43
s_cmp_eq_u32 s25, 3
s_cselect_b32 s42, 0x2040811, s42
s_cselect_b32 s43, 0x10204081, s43
s_cmp_eq_u32 s25, 4
s_cselect_b32 s42, 0x4081020, s42
s_cselect_b32 s43, 0x20408102, s43
s_cmp_eq_u32 s25, 5
s_cselect_b32 s42, 0x8102040, s42
s_cselect_b32 s43, 0x40810204, s43
s_cmp_eq_u32 s25, 6
s_cselect_b32 s42, 0x10204080, s42
s_cselect_b32 s43, 0x81020408, s43
s_mov_b32 s44, 67108864
s_mov_b32 s45, 111169536
s_mov_b32 s46, 4
s_mov_b32 s47, 0
s_mov_b32 s54, 536870912
s_branch L_op
L_bdie:
s_mov_b32 s4, 0x5557fe00
s_mov_b32 s5, 0x55555555
s_cmp_eq_u32 s3, 2
s_cbranch_scc1 L_cr0
s_mov_b32 s4, 0xaaa80000
s_mov_b32 s5, 0xaaaaaaaa
s_branch L_cr0
s_and_b32 s27, s3, 1
s_lshr_b32 s26, s16, 2
s_lshl_b32 s26, s26, 1
s_and_b32 s24, s16, 1
s_add_u32 s26, s26, s24
s_mov_b32 s4, 0x5557fe00
s_mov_b32 s5, 0x55555555
s_bitcmp1_b32 s16, 1
s_cbranch_scc1 L_crew
s_mov_b32 s4, 0xaaa80000
s_mov_b32 s5, 0xaaaaaaaa
s_branch L_crew
L_part:
s_mov_b32 s4, 0x1ff
s_mov_b32 s5, 0x0
L_cr0:
s_bfe_u32 s27, s16, 0x10001
s_lshr_b32 s26, s16, 2
s_bitcmp0_b32 s16, 0
s_cselect_b32 s24, 8, 0
s_add_u32 s26, s26, s24
L_crew:
s_cmp_eq_u64 s[4:5], 0
s_cbranch_scc1 L_done
s_cmp_lt_u32 s26, 9
s_cbranch_scc1 L_bo
s_mov_b64 s[52:53], s[4:5]
s_sub_u32 s41, s26, 9
s_lshl_b32 s41, s41, 1
s_add_u32 s41, s41, s27
s_mul_i32 s24, s17, 14
s_add_u32 s41, s41, s24
s_mov_b32 s40, 0x3e0293ee
s_mov_b32 s50, 0xf149f2ca
s_mov_b32 s51, 0x41a00000
s_lshl_b32 s55, s3, 7
s_add_u32 s55, s55, 111171584
v_and_b32 v5, 31, v0
v_bfe_u32 v26, v0, 5, 1
v_lshlrev_b32 v27, 2, v26
v_sub_u32 v5, v5, v27
v_bfe_u32 v27, v0, 4, 1
v_lshlrev_b32 v6, 17, v27
v_lshl_add_u32 v6, v26, 8, v6
v_and_b32 v27, 15, v0
v_lshl_add_u32 v6, v27, 4, v6
v_and_b32 v1, 63, v0
v_min_u32 v17, 47, v1
v_lshlrev_b32 v1, 4, v1
v_bfe_u32 v26, v0, 5, 1
v_and_b32 v27, 1, v0
v_lshlrev_b32 v2, 7, v27
v_lshl_add_u32 v2, v26, 6, v2
v_lshlrev_b32 v3, 7, v26
v_bfe_u32 v27, v0, 1, 2
v_lshl_add_u32 v2, v27, 4, v2
v_bfe_u32 v27, v0, 4, 1
v_lshl_add_u32 v3, v27, 10, v3
v_bfe_u32 v27, v0, 3, 1
v_lshl_add_u32 v3, v27, 4, v3
v_bfe_u32 v27, v0, 2, 1
v_lshl_add_u32 v3, v27, 5, v3
v_and_b32 v27, 3, v0
v_lshl_add_u32 v3, v27, 2, v3
v_mov_b32 v4, 0
v_lshlrev_b32 v17, 7, v17
v_mul_u32_u24 v26, 24576, v26
v_add_u32 v17, v17, v26
v_add_u32 v17, 111149056, v17
v_mov_b32 v31, s50
s_mov_b32 s49, 0
s_mov_b32 s62, 0
s_mov_b32 s63, 0
s_mov_b32 s45, -1
v_cmp_le_i32 s[64:65], 0, v5
v_cmp_le_i32 s[66:67], 1, v5
v_cmp_le_i32 s[68:69], 2, v5
v_cmp_le_i32 s[70:71], 3, v5
v_cmp_le_i32 s[72:73], 8, v5
v_cmp_le_i32 s[74:75], 9, v5
v_cmp_le_i32 s[76:77], 10, v5
v_cmp_le_i32 s[78:79], 11, v5
v_cmp_le_i32 s[80:81], 16, v5
v_cmp_le_i32 s[82:83], 17, v5
v_cmp_le_i32 s[84:85], 18, v5
v_cmp_le_i32 s[86:87], 19, v5
v_cmp_le_i32 s[88:89], 24, v5
v_cmp_le_i32 s[90:91], 25, v5
v_cmp_le_i32 s[92:93], 26, v5
v_cmp_le_i32 s[94:95], 27, v5
L_nb_19:
s_ff1_i32_b64 s47, s[52:53]
s_cmp_lt_u32 s41, 32
s_cbranch_scc1 L_nb_20
s_bitset0_b64 s[52:53], s47
s_sub_u32 s41, s41, 32
s_add_u32 s62, s62, 1
s_branch L_nb_19
L_nb_20:
s_lshl_b32 s47, s47, 5
s_add_u32 s47, s47, s41
s_add_u32 s41, s41, 56
s_lshl_b32 s46, s47, 14
s_add_u32 s46, s46, 33554432
s_lshl_b32 s44, s47, 13
s_add_u32 s44, s44, 134217728
s_cmp_ge_u32 s47, 2048
s_cselect_b32 s44, 536870912, s44
s_cselect_b32 s46, 536870912, s46
s_cbranch_scc1 L_nb_18
s_lshr_b32 s25, s47, 8
s_lshl_b32 s25, s25, 2
s_cmp_eq_u32 s25, s45
s_cbranch_scc1 L_nb_18
s_mov_b32 s45, s25
s_mov_b32 s28, 0
L_poll_22:
buffer_load_dword v26, v17, s[8:11], s45 offen sc1
s_add_u32 s28, s28, 1
s_cmp_gt_u32 s28, 200000
s_cbranch_scc1 L_end
s_waitcnt vmcnt(0)
v_cmp_ne_u32 vcc, 1, v26
s_cbranch_vccz L_pd_23
s_sleep 8
s_cmp_lt_u32 s28, 32
s_cbranch_scc1 L_poll_22
s_sleep 32
s_branch L_poll_22
L_pd_23:
L_nb_18:
s_cmp_ge_u32 s47, 2048
s_cbranch_scc1 L_bt_x
s_add_u32 s25, s44, 0
buffer_load_dwordx4 a[0:3], v1, s[8:11], s25 offen sc1
buffer_load_dwordx4 a[4:7], v1, s[8:11], s25 offen offset:1024 sc1
buffer_load_dwordx4 a[8:11], v1, s[8:11], s25 offen offset:2048 sc1
buffer_load_dwordx4 a[12:15], v1, s[8:11], s25 offen offset:3072 sc1
s_add_u32 s25, s44, 4096
buffer_load_dwordx4 a[16:19], v1, s[8:11], s25 offen sc1
buffer_load_dwordx4 a[20:23], v1, s[8:11], s25 offen offset:1024 sc1
buffer_load_dwordx4 a[24:27], v1, s[8:11], s25 offen offset:2048 sc1
buffer_load_dwordx4 a[28:31], v1, s[8:11], s25 offen offset:3072 sc1
s_add_u32 s25, s46, 0
buffer_load_dwordx4 a[32:35], v1, s[8:11], s25 offen sc1
buffer_load_dwordx4 a[36:39], v1, s[8:11], s25 offen offset:1024 sc1
buffer_load_dwordx4 a[40:43], v1, s[8:11], s25 offen offset:2048 sc1
buffer_load_dwordx4 a[44:47], v1, s[8:11], s25 offen offset:3072 sc1
s_add_u32 s25, s46, 4096
buffer_load_dwordx4 a[48:51], v1, s[8:11], s25 offen sc1
buffer_load_dwordx4 a[52:55], v1, s[8:11], s25 offen offset:1024 sc1
buffer_load_dwordx4 a[56:59], v1, s[8:11], s25 offen offset:2048 sc1
buffer_load_dwordx4 a[60:63], v1, s[8:11], s25 offen offset:3072 sc1
s_add_u32 s25, s46, 8192
buffer_load_dwordx4 a[64:67], v1, s[8:11], s25 offen sc1
buffer_load_dwordx4 a[68:71], v1, s[8:11], s25 offen offset:1024 sc1
buffer_load_dwordx4 a[72:75], v1, s[8:11], s25 offen offset:2048 sc1
buffer_load_dwordx4 a[76:79], v1, s[8:11], s25 offen offset:3072 sc1
s_add_u32 s25, s46, 12288
buffer_load_dwordx4 a[80:83], v1, s[8:11], s25 offen sc1
buffer_load_dwordx4 a[84:87], v1, s[8:11], s25 offen offset:1024 sc1
buffer_load_dwordx4 a[88:91], v1, s[8:11], s25 offen offset:2048 sc1
buffer_load_dwordx4 a[92:95], v1, s[8:11], s25 offen offset:3072 sc1
s_waitcnt vmcnt(0)
s_mov_b32 s54, 536870912
s_mov_b32 s60, 536870912
s_mov_b32 s30, 0x0
s_mov_b32 s31, 0x0
L_bt:
s_waitcnt vmcnt(8)
v_mfma_f32_32x32x16_bf16 v[32:47], a[32:35], a[0:3], 0
v_mfma_f32_32x32x16_bf16 v[32:47], a[36:39], a[4:7], v[32:47]
v_mfma_f32_32x32x16_bf16 v[32:47], a[40:43], a[8:11], v[32:47]
v_mfma_f32_32x32x16_bf16 v[32:47], a[44:47], a[12:15], v[32:47]
v_mfma_f32_32x32x16_bf16 v[32:47], a[48:51], a[16:19], v[32:47]
v_mfma_f32_32x32x16_bf16 v[32:47], a[52:55], a[20:23], v[32:47]
v_mfma_f32_32x32x16_bf16 v[32:47], a[56:59], a[24:27], v[32:47]
v_mfma_f32_32x32x16_bf16 v[32:47], a[60:63], a[28:31], v[32:47]
s_and_b32 s42, s47, 31
s_lshr_b32 s43, s47, 5
s_lshl_b32 s26, s47, 12
s_add_u32 s26, s26, 100663296
s_nop 7
v_cndmask_b32 v32, v31, v32, s[64:65]
v_cndmask_b32 v33, v31, v33, s[66:67]
v_cndmask_b32 v34, v31, v34, s[68:69]
v_cndmask_b32 v35, v31, v35, s[70:71]
v_cndmask_b32 v36, v31, v36, s[72:73]
v_cndmask_b32 v37, v31, v37, s[74:75]
v_cndmask_b32 v38, v31, v38, s[76:77]
v_cndmask_b32 v39, v31, v39, s[78:79]
v_cndmask_b32 v40, v31, v40, s[80:81]
v_cndmask_b32 v41, v31, v41, s[82:83]
v_cndmask_b32 v42, v31, v42, s[84:85]
v_cndmask_b32 v43, v31, v43, s[86:87]
v_cndmask_b32 v44, v31, v44, s[88:89]
v_cndmask_b32 v45, v31, v45, s[90:91]
v_cndmask_b32 v46, v31, v46, s[92:93]
v_cndmask_b32 v47, v31, v47, s[94:95]
v_max3_f32 v20, v32, v33, v34
v_max3_f32 v20, v20, v35, v36
v_max3_f32 v20, v20, v37, v38
v_max3_f32 v20, v20, v39, v40
v_max3_f32 v20, v20, v41, v42
v_max3_f32 v20, v20, v43, v44
v_max3_f32 v20, v20, v45, v46
v_max_f32 v20, v20, v47
s_cmp_lt_u32 s43, s49
s_cbranch_scc1 L_kn_24
v_mov_b32 v26, 1
s_waitcnt vmcnt(0)
s_mov_b64 exec, 1
buffer_store_dword v26, v4, s[8:11], s54 offen
s_mov_b64 exec, -1
L_nb_27:
s_ff1_i32_b64 s48, s[52:53]
s_cmp_lt_u32 s41, 32
s_cbranch_scc1 L_nb_28
s_bitset0_b64 s[52:53], s48
s_sub_u32 s41, s41, 32
s_add_u32 s62, s62, 1
s_branch L_nb_27
L_nb_28:
s_lshl_b32 s48, s48, 5
s_add_u32 s48, s48, s41
s_add_u32 s41, s41, 56
s_lshl_b32 s46, s48, 14
s_add_u32 s46, s46, 33554432
s_lshl_b32 s44, s48, 13
s_add_u32 s44, s44, 134217728
s_cmp_ge_u32 s48, 2048
s_cselect_b32 s44, 536870912, s44
s_cselect_b32 s46, 536870912, s46
s_cbranch_scc1 L_nb_26
s_lshr_b32 s25, s48, 8
s_lshl_b32 s25, s25, 2
s_cmp_eq_u32 s25, s45
s_cbranch_scc1 L_nb_26
s_mov_b32 s45, s25
s_mov_b32 s28, 0
L_poll_30:
buffer_load_dword v26, v17, s[8:11], s45 offen sc1
s_add_u32 s28, s28, 1
s_cmp_gt_u32 s28, 200000
s_cbranch_scc1 L_end
s_waitcnt vmcnt(0)
v_cmp_ne_u32 vcc, 1, v26
s_cbranch_vccz L_pd_31
s_sleep 8
s_cmp_lt_u32 s28, 32
s_cbranch_scc1 L_poll_30
s_sleep 32
s_branch L_poll_30
L_pd_31:
L_nb_26:
s_add_u32 s25, s44, 0
buffer_load_dwordx4 a[96:99], v1, s[8:11], s25 offen sc1
buffer_load_dwordx4 a[100:103], v1, s[8:11], s25 offen offset:1024 sc1
buffer_load_dwordx4 a[104:107], v1, s[8:11], s25 offen offset:2048 sc1
buffer_load_dwordx4 a[108:111], v1, s[8:11], s25 offen offset:3072 sc1
s_add_u32 s25, s44, 4096
buffer_load_dwordx4 a[112:115], v1, s[8:11], s25 offen sc1
buffer_load_dwordx4 a[116:119], v1, s[8:11], s25 offen offset:1024 sc1
buffer_load_dwordx4 a[120:123], v1, s[8:11], s25 offen offset:2048 sc1
buffer_load_dwordx4 a[124:127], v1, s[8:11], s25 offen offset:3072 sc1
s_add_u32 s25, s46, 0
buffer_load_dwordx4 a[128:131], v1, s[8:11], s25 offen sc1
buffer_load_dwordx4 a[132:135], v1, s[8:11], s25 offen offset:1024 sc1
buffer_load_dwordx4 a[136:139], v1, s[8:11], s25 offen offset:2048 sc1
buffer_load_dwordx4 a[140:143], v1, s[8:11], s25 offen offset:3072 sc1
s_add_u32 s25, s46, 4096
buffer_load_dwordx4 a[144:147], v1, s[8:11], s25 offen sc1
buffer_load_dwordx4 a[148:151], v1, s[8:11], s25 offen offset:1024 sc1
buffer_load_dwordx4 a[152:155], v1, s[8:11], s25 offen offset:2048 sc1
buffer_load_dwordx4 a[156:159], v1, s[8:11], s25 offen offset:3072 sc1
s_add_u32 s25, s46, 8192
buffer_load_dwordx4 a[160:163], v1, s[8:11], s25 offen sc1
buffer_load_dwordx4 a[164:167], v1, s[8:11], s25 offen offset:1024 sc1
buffer_load_dwordx4 a[168:171], v1, s[8:11], s25 offen offset:2048 sc1
buffer_load_dwordx4 a[172:175], v1, s[8:11], s25 offen offset:3072 sc1
s_add_u32 s25, s46, 12288
buffer_load_dwordx4 a[176:179], v1, s[8:11], s25 offen sc1
buffer_load_dwordx4 a[180:183], v1, s[8:11], s25 offen offset:1024 sc1
buffer_load_dwordx4 a[184:187], v1, s[8:11], s25 offen offset:2048 sc1
buffer_load_dwordx4 a[188:191], v1, s[8:11], s25 offen offset:3072 sc1
s_lshl_b32 s25, s42, 7
s_add_u32 s25, s25, 111153152
s_mov_b32 s28, 0
L_poll_32:
buffer_load_dword v26, v4, s[8:11], s25 offen sc1
s_add_u32 s28, s28, 1
s_cmp_gt_u32 s28, 200000
s_cbranch_scc1 L_end
s_waitcnt vmcnt(0)
v_cmp_ge_u32 vcc, s43, v26
s_cbranch_vccz L_pd_33
s_sleep 1
s_cmp_lt_u32 s28, 32
s_cbranch_scc1 L_poll_32
s_sleep 32
s_branch L_poll_32
L_pd_33:
buffer_load_dwordx4 v[96:99], v2, s[8:11], s26 offen sc1
buffer_load_dwordx4 v[100:103], v2, s[8:11], s26 offen offset:256 sc1
buffer_load_dwordx4 v[104:107], v2, s[8:11], s26 offen offset:512 sc1
buffer_load_dwordx4 v[108:111], v2, s[8:11], s26 offen offset:768 sc1
buffer_load_dwordx4 v[112:115], v2, s[8:11], s26 offen offset:1024 sc1
buffer_load_dwordx4 v[116:119], v2, s[8:11], s26 offen offset:1280 sc1
buffer_load_dwordx4 v[120:123], v2, s[8:11], s26 offen offset:1536 sc1
buffer_load_dwordx4 v[124:127], v2, s[8:11], s26 offen offset:1792 sc1
buffer_load_dword v8, v3, s[8:11], s26 offen offset:2048 sc1
buffer_load_dword v9, v3, s[8:11], s26 offen offset:2112 sc1
buffer_load_dword v10, v3, s[8:11], s26 offen offset:2304 sc1
buffer_load_dword v11, v3, s[8:11], s26 offen offset:2368 sc1
buffer_load_dword v12, v3, s[8:11], s26 offen offset:2560 sc1
buffer_load_dword v13, v3, s[8:11], s26 offen offset:2624 sc1
buffer_load_dword v14, v3, s[8:11], s26 offen offset:2816 sc1
buffer_load_dword v15, v3, s[8:11], s26 offen offset:2880 sc1
v_readfirstlane_b32 s49, v26
s_nop 0
s_min_u32 s49, s49, 63
s_sub_u32 s49, s49, 1
s_waitcnt vmcnt(15)
v_mfma_f32_32x32x16_bf16 v[64:79], v[96:99], a[0:3], 0
s_waitcnt vmcnt(14)
v_mfma_f32_32x32x16_bf16 v[64:79], v[100:103], a[4:7], v[64:79]
s_waitcnt vmcnt(13)
v_mfma_f32_32x32x16_bf16 v[64:79], v[104:107], a[8:11], v[64:79]
s_waitcnt vmcnt(12)
v_mfma_f32_32x32x16_bf16 v[64:79], v[108:111], a[12:15], v[64:79]
s_waitcnt vmcnt(11)
v_mfma_f32_32x32x16_bf16 v[64:79], v[112:115], a[16:19], v[64:79]
s_waitcnt vmcnt(10)
v_mfma_f32_32x32x16_bf16 v[64:79], v[116:119], a[20:23], v[64:79]
s_waitcnt vmcnt(9)
v_mfma_f32_32x32x16_bf16 v[64:79], v[120:123], a[24:27], v[64:79]
s_waitcnt vmcnt(8)
v_mfma_f32_32x32x16_bf16 v[64:79], v[124:127], a[28:31], v[64:79]
s_waitcnt vmcnt(0)
s_branch L_kj_25
L_kn_24:
buffer_load_dwordx4 v[96:99], v2, s[8:11], s26 offen sc1
buffer_load_dwordx4 v[100:103], v2, s[8:11], s26 offen offset:256 sc1
buffer_load_dwordx4 v[104:107], v2, s[8:11], s26 offen offset:512 sc1
buffer_load_dwordx4 v[108:111], v2, s[8:11], s26 offen offset:768 sc1
buffer_load_dwordx4 v[112:115], v2, s[8:11], s26 offen offset:1024 sc1
buffer_load_dwordx4 v[116:119], v2, s[8:11], s26 offen offset:1280 sc1
buffer_load_dwordx4 v[120:123], v2, s[8:11], s26 offen offset:1536 sc1
buffer_load_dwordx4 v[124:127], v2, s[8:11], s26 offen offset:1792 sc1
buffer_load_dword v8, v3, s[8:11], s26 offen offset:2048 sc1
buffer_load_dword v9, v3, s[8:11], s26 offen offset:2112 sc1
buffer_load_dword v10, v3, s[8:11], s26 offen offset:2304 sc1
buffer_load_dword v11, v3, s[8:11], s26 offen offset:2368 sc1
buffer_load_dword v12, v3, s[8:11], s26 offen offset:2560 sc1
buffer_load_dword v13, v3, s[8:11], s26 offen offset:2624 sc1
buffer_load_dword v14, v3, s[8:11], s26 offen offset:2816 sc1
buffer_load_dword v15, v3, s[8:11], s26 offen offset:2880 sc1
v_mov_b32 v26, 1
s_waitcnt vmcnt(16)
s_mov_b64 exec, 1
buffer_store_dword v26, v4, s[8:11], s54 offen
s_mov_b64 exec, -1
L_nb_35:
s_ff1_i32_b64 s48, s[52:53]
s_cmp_lt_u32 s41, 32
s_cbranch_scc1 L_nb_36
s_bitset0_b64 s[52:53], s48
s_sub_u32 s41, s41, 32
s_add_u32 s62, s62, 1
s_branch L_nb_35
L_nb_36:
s_lshl_b32 s48, s48, 5
s_add_u32 s48, s48, s41
s_add_u32 s41, s41, 56
s_lshl_b32 s46, s48, 14
s_add_u32 s46, s46, 33554432
s_lshl_b32 s44, s48, 13
s_add_u32 s44, s44, 134217728
s_cmp_ge_u32 s48, 2048
s_cselect_b32 s44, 536870912, s44
s_cselect_b32 s46, 536870912, s46
s_cbranch_scc1 L_nb_34
s_lshr_b32 s25, s48, 8
s_lshl_b32 s25, s25, 2
s_cmp_eq_u32 s25, s45
s_cbranch_scc1 L_nb_34
s_mov_b32 s45, s25
s_mov_b32 s28, 0
L_poll_38:
buffer_load_dword v26, v17, s[8:11], s45 offen sc1
s_add_u32 s28, s28, 1
s_cmp_gt_u32 s28, 200000
s_cbranch_scc1 L_end
s_waitcnt vmcnt(0)
v_cmp_ne_u32 vcc, 1, v26
s_cbranch_vccz L_pd_39
s_sleep 8
s_cmp_lt_u32 s28, 32
s_cbranch_scc1 L_poll_38
s_sleep 32
s_branch L_poll_38
L_pd_39:
L_nb_34:
s_add_u32 s25, s44, 0
buffer_load_dwordx4 a[96:99], v1, s[8:11], s25 offen sc1
buffer_load_dwordx4 a[100:103], v1, s[8:11], s25 offen offset:1024 sc1
buffer_load_dwordx4 a[104:107], v1, s[8:11], s25 offen offset:2048 sc1
buffer_load_dwordx4 a[108:111], v1, s[8:11], s25 offen offset:3072 sc1
s_add_u32 s25, s44, 4096
buffer_load_dwordx4 a[112:115], v1, s[8:11], s25 offen sc1
buffer_load_dwordx4 a[116:119], v1, s[8:11], s25 offen offset:1024 sc1
buffer_load_dwordx4 a[120:123], v1, s[8:11], s25 offen offset:2048 sc1
buffer_load_dwordx4 a[124:127], v1, s[8:11], s25 offen offset:3072 sc1
s_waitcnt vmcnt(24)
v_mfma_f32_32x32x16_bf16 v[64:79], v[96:99], a[0:3], 0
s_add_u32 s25, s46, 0
buffer_load_dwordx4 a[128:131], v1, s[8:11], s25 offen sc1
buffer_load_dwordx4 a[132:135], v1, s[8:11], s25 offen offset:1024 sc1
s_waitcnt vmcnt(25)
v_mfma_f32_32x32x16_bf16 v[64:79], v[100:103], a[4:7], v[64:79]
buffer_load_dwordx4 a[136:139], v1, s[8:11], s25 offen offset:2048 sc1
buffer_load_dwordx4 a[140:143], v1, s[8:11], s25 offen offset:3072 sc1
s_waitcnt vmcnt(26)
v_mfma_f32_32x32x16_bf16 v[64:79], v[104:107], a[8:11], v[64:79]
s_add_u32 s25, s46, 4096
buffer_load_dwordx4 a[144:147], v1, s[8:11], s25 offen sc1
buffer_load_dwordx4 a[148:151], v1, s[8:11], s25 offen offset:1024 sc1
s_waitcnt vmcnt(27)
v_mfma_f32_32x32x16_bf16 v[64:79], v[108:111], a[12:15], v[64:79]
buffer_load_dwordx4 a[152:155], v1, s[8:11], s25 offen offset:2048 sc1
buffer_load_dwordx4 a[156:159], v1, s[8:11], s25 offen offset:3072 sc1
s_waitcnt vmcnt(28)
v_mfma_f32_32x32x16_bf16 v[64:79], v[112:115], a[16:19], v[64:79]
s_add_u32 s25, s46, 8192
buffer_load_dwordx4 a[160:163], v1, s[8:11], s25 offen sc1
buffer_load_dwordx4 a[164:167], v1, s[8:11], s25 offen offset:1024 sc1
s_waitcnt vmcnt(29)
v_mfma_f32_32x32x16_bf16 v[64:79], v[116:119], a[20:23], v[64:79]
buffer_load_dwordx4 a[168:171], v1, s[8:11], s25 offen offset:2048 sc1
buffer_load_dwordx4 a[172:175], v1, s[8:11], s25 offen offset:3072 sc1
s_waitcnt vmcnt(30)
v_mfma_f32_32x32x16_bf16 v[64:79], v[120:123], a[24:27], v[64:79]
s_add_u32 s25, s46, 12288
buffer_load_dwordx4 a[176:179], v1, s[8:11], s25 offen sc1
buffer_load_dwordx4 a[180:183], v1, s[8:11], s25 offen offset:1024 sc1
s_waitcnt vmcnt(31)
v_mfma_f32_32x32x16_bf16 v[64:79], v[124:127], a[28:31], v[64:79]
buffer_load_dwordx4 a[184:187], v1, s[8:11], s25 offen offset:2048 sc1
buffer_load_dwordx4 a[188:191], v1, s[8:11], s25 offen offset:3072 sc1
s_waitcnt vmcnt(25)
L_kj_25:
s_nop 9
v_max3_f32 v20, v20, v64, v65
v_max3_f32 v20, v20, v66, v67
v_mov_b32 v26, v20
s_nop 1
v_permlane32_swap_b32 v26, v20
v_max_f32 v20, v20, v26
v_mul_f32 v20, s40, v20
v_pk_fma_f32 v[64:65], v[64:65], s[40:41], v[20:21] op_sel_hi:[1,0,0] neg_lo:[0,0,1] neg_hi:[0,0,1]
v_pk_fma_f32 v[66:67], v[66:67], s[40:41], v[20:21] op_sel_hi:[1,0,0] neg_lo:[0,0,1] neg_hi:[0,0,1]
v_pk_fma_f32 v[32:33], v[32:33], s[40:41], v[20:21] op_sel_hi:[1,0,0] neg_lo:[0,0,1] neg_hi:[0,0,1]
v_pk_fma_f32 v[34:35], v[34:35], s[40:41], v[20:21] op_sel_hi:[1,0,0] neg_lo:[0,0,1] neg_hi:[0,0,1]
v_pk_fma_f32 v[36:37], v[36:37], s[40:41], v[20:21] op_sel_hi:[1,0,0] neg_lo:[0,0,1] neg_hi:[0,0,1]
v_pk_fma_f32 v[38:39], v[38:39], s[40:41], v[20:21] op_sel_hi:[1,0,0] neg_lo:[0,0,1] neg_hi:[0,0,1]
v_pk_fma_f32 v[40:41], v[40:41], s[40:41], v[20:21] op_sel_hi:[1,0,0] neg_lo:[0,0,1] neg_hi:[0,0,1]
v_pk_fma_f32 v[42:43], v[42:43], s[40:41], v[20:21] op_sel_hi:[1,0,0] neg_lo:[0,0,1] neg_hi:[0,0,1]
v_pk_fma_f32 v[44:45], v[44:45], s[40:41], v[20:21] op_sel_hi:[1,0,0] neg_lo:[0,0,1] neg_hi:[0,0,1]
v_pk_fma_f32 v[46:47], v[46:47], s[40:41], v[20:21] op_sel_hi:[1,0,0] neg_lo:[0,0,1] neg_hi:[0,0,1]
v_exp_f32 v64, v64
v_exp_f32 v65, v65
v_exp_f32 v66, v66
v_exp_f32 v67, v67
v_exp_f32 v32, v32
v_exp_f32 v33, v33
v_cvt_pk_bf16_f32 v88, v64, v65
v_cvt_pk_bf16_f32 v89, v66, v67
s_nop 1
v_mfma_f32_32x32x8_bf16 v[128:143], v[8:9], v[88:89], 0
v_exp_f32 v34, v34
v_exp_f32 v35, v35
v_exp_f32 v36, v36
v_mfma_f32_32x32x8_bf16 v[160:175], v[10:11], v[88:89], 0
v_exp_f32 v37, v37
v_exp_f32 v38, v38
v_mfma_f32_32x32x8_bf16 v[192:207], v[12:13], v[88:89], 0
v_exp_f32 v39, v39
v_exp_f32 v40, v40
v_exp_f32 v41, v41
v_mfma_f32_32x32x8_bf16 v[224:239], v[14:15], v[88:89], 0
v_cvt_pk_bf16_f32 v80, v32, v33
v_cvt_pk_bf16_f32 v81, v34, v35
v_cvt_pk_bf16_f32 v82, v36, v37
v_cvt_pk_bf16_f32 v83, v38, v39
s_nop 1
v_mfma_f32_32x32x16_bf16 v[128:143], a[64:67], v[80:83], v[128:143]
v_exp_f32 v42, v42
v_exp_f32 v43, v43
v_exp_f32 v44, v44
v_mfma_f32_32x32x16_bf16 v[160:175], a[72:75], v[80:83], v[160:175]
v_exp_f32 v45, v45
v_exp_f32 v46, v46
v_mfma_f32_32x32x16_bf16 v[192:207], a[80:83], v[80:83], v[192:207]
v_exp_f32 v47, v47
v_add_f32 v22, v64, v65
v_add_f32 v22, v22, v66
v_add_f32 v22, v22, v67
v_add_f32 v22, v22, v32
v_mfma_f32_32x32x16_bf16 v[224:239], a[88:91], v[80:83], v[224:239]
v_add_f32 v22, v22, v33
v_cvt_pk_bf16_f32 v84, v40, v41
v_cvt_pk_bf16_f32 v85, v42, v43
v_cvt_pk_bf16_f32 v86, v44, v45
v_cvt_pk_bf16_f32 v87, v46, v47
s_nop 1
v_mfma_f32_32x32x16_bf16 v[128:143], a[68:71], v[84:87], v[128:143]
v_add_f32 v22, v22, v34
v_add_f32 v22, v22, v35
v_add_f32 v22, v22, v36
v_add_f32 v22, v22, v37
v_add_f32 v22, v22, v38
v_mfma_f32_32x32x16_bf16 v[160:175], a[76:79], v[84:87], v[160:175]
v_add_f32 v22, v22, v39
v_add_f32 v22, v22, v40
v_add_f32 v22, v22, v41
v_add_f32 v22, v22, v42
v_mfma_f32_32x32x16_bf16 v[192:207], a[84:87], v[84:87], v[192:207]
v_add_f32 v22, v22, v43
v_add_f32 v22, v22, v44
v_add_f32 v22, v22, v45
v_add_f32 v22, v22, v46
v_add_f32 v22, v22, v47
v_mfma_f32_32x32x16_bf16 v[224:239], a[92:95], v[84:87], v[224:239]
s_lshl_b32 s26, s43, 18
s_lshl_b32 s27, s42, 12
s_add_u32 s26, s26, s27
s_add_u32 s26, s26, 83886080
v_mov_b32 v26, v22
s_nop 1
v_permlane32_swap_b32 v26, v22
v_add_f32 v26, v26, v22
v_rcp_f32 v26, v26
s_nop 0
v_pk_mul_f32 v[128:129], v[128:129], v[26:27] op_sel_hi:[1,0]
v_pk_mul_f32 v[130:131], v[130:131], v[26:27] op_sel_hi:[1,0]
v_pk_mul_f32 v[132:133], v[132:133], v[26:27] op_sel_hi:[1,0]
v_pk_mul_f32 v[134:135], v[134:135], v[26:27] op_sel_hi:[1,0]
v_pk_mul_f32 v[136:137], v[136:137], v[26:27] op_sel_hi:[1,0]
v_pk_mul_f32 v[138:139], v[138:139], v[26:27] op_sel_hi:[1,0]
v_pk_mul_f32 v[140:141], v[140:141], v[26:27] op_sel_hi:[1,0]
v_pk_mul_f32 v[142:143], v[142:143], v[26:27] op_sel_hi:[1,0]
v_cvt_pk_bf16_f32 v128, v128, v129
v_cvt_pk_bf16_f32 v129, v130, v131
v_cvt_pk_bf16_f32 v130, v132, v133
v_cvt_pk_bf16_f32 v131, v134, v135
buffer_store_dwordx4 v[128:131], v6, s[8:11], s26 offen
v_cvt_pk_bf16_f32 v136, v136, v137
v_cvt_pk_bf16_f32 v137, v138, v139
v_cvt_pk_bf16_f32 v138, v140, v141
v_cvt_pk_bf16_f32 v139, v142, v143
buffer_store_dwordx4 v[136:139], v6, s[8:11], s26 offen offset:512
v_pk_mul_f32 v[160:161], v[160:161], v[26:27] op_sel_hi:[1,0]
v_pk_mul_f32 v[162:163], v[162:163], v[26:27] op_sel_hi:[1,0]
v_pk_mul_f32 v[164:165], v[164:165], v[26:27] op_sel_hi:[1,0]
v_pk_mul_f32 v[166:167], v[166:167], v[26:27] op_sel_hi:[1,0]
v_pk_mul_f32 v[168:169], v[168:169], v[26:27] op_sel_hi:[1,0]
v_pk_mul_f32 v[170:171], v[170:171], v[26:27] op_sel_hi:[1,0]
v_pk_mul_f32 v[172:173], v[172:173], v[26:27] op_sel_hi:[1,0]
v_pk_mul_f32 v[174:175], v[174:175], v[26:27] op_sel_hi:[1,0]
v_cvt_pk_bf16_f32 v160, v160, v161
v_cvt_pk_bf16_f32 v161, v162, v163
v_cvt_pk_bf16_f32 v162, v164, v165
v_cvt_pk_bf16_f32 v163, v166, v167
buffer_store_dwordx4 v[160:163], v6, s[8:11], s26 offen offset:1024
v_cvt_pk_bf16_f32 v168, v168, v169
v_cvt_pk_bf16_f32 v169, v170, v171
v_cvt_pk_bf16_f32 v170, v172, v173
v_cvt_pk_bf16_f32 v171, v174, v175
buffer_store_dwordx4 v[168:171], v6, s[8:11], s26 offen offset:1536
v_pk_mul_f32 v[192:193], v[192:193], v[26:27] op_sel_hi:[1,0]
v_pk_mul_f32 v[194:195], v[194:195], v[26:27] op_sel_hi:[1,0]
v_pk_mul_f32 v[196:197], v[196:197], v[26:27] op_sel_hi:[1,0]
v_pk_mul_f32 v[198:199], v[198:199], v[26:27] op_sel_hi:[1,0]
v_pk_mul_f32 v[200:201], v[200:201], v[26:27] op_sel_hi:[1,0]
v_pk_mul_f32 v[202:203], v[202:203], v[26:27] op_sel_hi:[1,0]
v_pk_mul_f32 v[204:205], v[204:205], v[26:27] op_sel_hi:[1,0]
v_pk_mul_f32 v[206:207], v[206:207], v[26:27] op_sel_hi:[1,0]
v_cvt_pk_bf16_f32 v192, v192, v193
v_cvt_pk_bf16_f32 v193, v194, v195
v_cvt_pk_bf16_f32 v194, v196, v197
v_cvt_pk_bf16_f32 v195, v198, v199
buffer_store_dwordx4 v[192:195], v6, s[8:11], s26 offen offset:2048
v_cvt_pk_bf16_f32 v200, v200, v201
v_cvt_pk_bf16_f32 v201, v202, v203
v_cvt_pk_bf16_f32 v202, v204, v205
v_cvt_pk_bf16_f32 v203, v206, v207
buffer_store_dwordx4 v[200:203], v6, s[8:11], s26 offen offset:2560
v_pk_mul_f32 v[224:225], v[224:225], v[26:27] op_sel_hi:[1,0]
v_pk_mul_f32 v[226:227], v[226:227], v[26:27] op_sel_hi:[1,0]
v_pk_mul_f32 v[228:229], v[228:229], v[26:27] op_sel_hi:[1,0]
v_pk_mul_f32 v[230:231], v[230:231], v[26:27] op_sel_hi:[1,0]
v_pk_mul_f32 v[232:233], v[232:233], v[26:27] op_sel_hi:[1,0]
v_pk_mul_f32 v[234:235], v[234:235], v[26:27] op_sel_hi:[1,0]
v_pk_mul_f32 v[236:237], v[236:237], v[26:27] op_sel_hi:[1,0]
v_pk_mul_f32 v[238:239], v[238:239], v[26:27] op_sel_hi:[1,0]
v_cvt_pk_bf16_f32 v224, v224, v225
v_cvt_pk_bf16_f32 v225, v226, v227
v_cvt_pk_bf16_f32 v226, v228, v229
v_cvt_pk_bf16_f32 v227, v230, v231
buffer_store_dwordx4 v[224:227], v6, s[8:11], s26 offen offset:3072
v_cvt_pk_bf16_f32 v232, v232, v233
v_cvt_pk_bf16_f32 v233, v234, v235
v_cvt_pk_bf16_f32 v234, v236, v237
v_cvt_pk_bf16_f32 v235, v238, v239
buffer_store_dwordx4 v[232:235], v6, s[8:11], s26 offen offset:3584
s_lshl_b32 s54, s47, 2
s_add_u32 s54, s54, 111157248
s_bitcmp1_b64 s[30:31], s43
s_cselect_b32 s60, s54, 536870912
s_cselect_b32 s54, 536870912, s54
s_mov_b32 s47, s48
s_cmp_lt_u32 s47, 2048
s_cbranch_scc0 L_bt_f
s_waitcnt vmcnt(8)
v_mfma_f32_32x32x16_bf16 v[32:47], a[128:131], a[96:99], 0
v_mfma_f32_32x32x16_bf16 v[32:47], a[132:135], a[100:103], v[32:47]
v_mfma_f32_32x32x16_bf16 v[32:47], a[136:139], a[104:107], v[32:47]
v_mfma_f32_32x32x16_bf16 v[32:47], a[140:143], a[108:111], v[32:47]
v_mfma_f32_32x32x16_bf16 v[32:47], a[144:147], a[112:115], v[32:47]
v_mfma_f32_32x32x16_bf16 v[32:47], a[148:151], a[116:119], v[32:47]
v_mfma_f32_32x32x16_bf16 v[32:47], a[152:155], a[120:123], v[32:47]
v_mfma_f32_32x32x16_bf16 v[32:47], a[156:159], a[124:127], v[32:47]
s_and_b32 s42, s47, 31
s_lshr_b32 s43, s47, 5
s_lshl_b32 s26, s47, 12
s_add_u32 s26, s26, 100663296
s_nop 7
v_cndmask_b32 v32, v31, v32, s[64:65]
v_cndmask_b32 v33, v31, v33, s[66:67]
v_cndmask_b32 v34, v31, v34, s[68:69]
v_cndmask_b32 v35, v31, v35, s[70:71]
v_cndmask_b32 v36, v31, v36, s[72:73]
v_cndmask_b32 v37, v31, v37, s[74:75]
v_cndmask_b32 v38, v31, v38, s[76:77]
v_cndmask_b32 v39, v31, v39, s[78:79]
v_cndmask_b32 v40, v31, v40, s[80:81]
v_cndmask_b32 v41, v31, v41, s[82:83]
v_cndmask_b32 v42, v31, v42, s[84:85]
v_cndmask_b32 v43, v31, v43, s[86:87]
v_cndmask_b32 v44, v31, v44, s[88:89]
v_cndmask_b32 v45, v31, v45, s[90:91]
v_cndmask_b32 v46, v31, v46, s[92:93]
v_cndmask_b32 v47, v31, v47, s[94:95]
v_max3_f32 v20, v32, v33, v34
v_max3_f32 v20, v20, v35, v36
v_max3_f32 v20, v20, v37, v38
v_max3_f32 v20, v20, v39, v40
v_max3_f32 v20, v20, v41, v42
v_max3_f32 v20, v20, v43, v44
v_max3_f32 v20, v20, v45, v46
v_max_f32 v20, v20, v47
s_cmp_lt_u32 s43, s49
s_cbranch_scc1 L_kn_40
v_mov_b32 v26, 1
s_waitcnt vmcnt(0)
s_mov_b64 exec, 1
buffer_store_dword v26, v4, s[8:11], s54 offen
s_mov_b64 exec, -1
L_nb_43:
s_ff1_i32_b64 s48, s[52:53]
s_cmp_lt_u32 s41, 32
s_cbranch_scc1 L_nb_44
s_bitset0_b64 s[52:53], s48
s_sub_u32 s41, s41, 32
s_add_u32 s62, s62, 1
s_branch L_nb_43
L_nb_44:
s_lshl_b32 s48, s48, 5
s_add_u32 s48, s48, s41
s_add_u32 s41, s41, 56
s_lshl_b32 s46, s48, 14
s_add_u32 s46, s46, 33554432
s_lshl_b32 s44, s48, 13
s_add_u32 s44, s44, 134217728
s_cmp_ge_u32 s48, 2048
s_cselect_b32 s44, 536870912, s44
s_cselect_b32 s46, 536870912, s46
s_cbranch_scc1 L_nb_42
s_lshr_b32 s25, s48, 8
s_lshl_b32 s25, s25, 2
s_cmp_eq_u32 s25, s45
s_cbranch_scc1 L_nb_42
s_mov_b32 s45, s25
s_mov_b32 s28, 0
L_poll_46:
buffer_load_dword v26, v17, s[8:11], s45 offen sc1
s_add_u32 s28, s28, 1
s_cmp_gt_u32 s28, 200000
s_cbranch_scc1 L_end
s_waitcnt vmcnt(0)
v_cmp_ne_u32 vcc, 1, v26
s_cbranch_vccz L_pd_47
s_sleep 8
s_cmp_lt_u32 s28, 32
s_cbranch_scc1 L_poll_46
s_sleep 32
s_branch L_poll_46
L_pd_47:
L_nb_42:
s_add_u32 s25, s44, 0
buffer_load_dwordx4 a[0:3], v1, s[8:11], s25 offen sc1
buffer_load_dwordx4 a[4:7], v1, s[8:11], s25 offen offset:1024 sc1
buffer_load_dwordx4 a[8:11], v1, s[8:11], s25 offen offset:2048 sc1
buffer_load_dwordx4 a[12:15], v1, s[8:11], s25 offen offset:3072 sc1
s_add_u32 s25, s44, 4096
buffer_load_dwordx4 a[16:19], v1, s[8:11], s25 offen sc1
buffer_load_dwordx4 a[20:23], v1, s[8:11], s25 offen offset:1024 sc1
buffer_load_dwordx4 a[24:27], v1, s[8:11], s25 offen offset:2048 sc1
buffer_load_dwordx4 a[28:31], v1, s[8:11], s25 offen offset:3072 sc1
s_add_u32 s25, s46, 0
buffer_load_dwordx4 a[32:35], v1, s[8:11], s25 offen sc1
buffer_load_dwordx4 a[36:39], v1, s[8:11], s25 offen offset:1024 sc1
buffer_load_dwordx4 a[40:43], v1, s[8:11], s25 offen offset:2048 sc1
buffer_load_dwordx4 a[44:47], v1, s[8:11], s25 offen offset:3072 sc1
s_add_u32 s25, s46, 4096
buffer_load_dwordx4 a[48:51], v1, s[8:11], s25 offen sc1
buffer_load_dwordx4 a[52:55], v1, s[8:11], s25 offen offset:1024 sc1
buffer_load_dwordx4 a[56:59], v1, s[8:11], s25 offen offset:2048 sc1
buffer_load_dwordx4 a[60:63], v1, s[8:11], s25 offen offset:3072 sc1
s_add_u32 s25, s46, 8192
buffer_load_dwordx4 a[64:67], v1, s[8:11], s25 offen sc1
buffer_load_dwordx4 a[68:71], v1, s[8:11], s25 offen offset:1024 sc1
buffer_load_dwordx4 a[72:75], v1, s[8:11], s25 offen offset:2048 sc1
buffer_load_dwordx4 a[76:79], v1, s[8:11], s25 offen offset:3072 sc1
s_add_u32 s25, s46, 12288
buffer_load_dwordx4 a[80:83], v1, s[8:11], s25 offen sc1
buffer_load_dwordx4 a[84:87], v1, s[8:11], s25 offen offset:1024 sc1
buffer_load_dwordx4 a[88:91], v1, s[8:11], s25 offen offset:2048 sc1
buffer_load_dwordx4 a[92:95], v1, s[8:11], s25 offen offset:3072 sc1
s_lshl_b32 s25, s42, 7
s_add_u32 s25, s25, 111153152
s_mov_b32 s28, 0
L_poll_48:
buffer_load_dword v26, v4, s[8:11], s25 offen sc1
s_add_u32 s28, s28, 1
s_cmp_gt_u32 s28, 200000
s_cbranch_scc1 L_end
s_waitcnt vmcnt(0)
v_cmp_ge_u32 vcc, s43, v26
s_cbranch_vccz L_pd_49
s_sleep 1
s_cmp_lt_u32 s28, 32
s_cbranch_scc1 L_poll_48
s_sleep 32
s_branch L_poll_48
L_pd_49:
buffer_load_dwordx4 v[96:99], v2, s[8:11], s26 offen sc1
buffer_load_dwordx4 v[100:103], v2, s[8:11], s26 offen offset:256 sc1
buffer_load_dwordx4 v[104:107], v2, s[8:11], s26 offen offset:512 sc1
buffer_load_dwordx4 v[108:111], v2, s[8:11], s26 offen offset:768 sc1
buffer_load_dwordx4 v[112:115], v2, s[8:11], s26 offen offset:1024 sc1
buffer_load_dwordx4 v[116:119], v2, s[8:11], s26 offen offset:1280 sc1
buffer_load_dwordx4 v[120:123], v2, s[8:11], s26 offen offset:1536 sc1
buffer_load_dwordx4 v[124:127], v2, s[8:11], s26 offen offset:1792 sc1
buffer_load_dword v8, v3, s[8:11], s26 offen offset:2048 sc1
buffer_load_dword v9, v3, s[8:11], s26 offen offset:2112 sc1
buffer_load_dword v10, v3, s[8:11], s26 offen offset:2304 sc1
buffer_load_dword v11, v3, s[8:11], s26 offen offset:2368 sc1
buffer_load_dword v12, v3, s[8:11], s26 offen offset:2560 sc1
buffer_load_dword v13, v3, s[8:11], s26 offen offset:2624 sc1
buffer_load_dword v14, v3, s[8:11], s26 offen offset:2816 sc1
buffer_load_dword v15, v3, s[8:11], s26 offen offset:2880 sc1
v_readfirstlane_b32 s49, v26
s_nop 0
s_min_u32 s49, s49, 63
s_sub_u32 s49, s49, 1
s_waitcnt vmcnt(15)
v_mfma_f32_32x32x16_bf16 v[64:79], v[96:99], a[96:99], 0
s_waitcnt vmcnt(14)
v_mfma_f32_32x32x16_bf16 v[64:79], v[100:103], a[100:103], v[64:79]
s_waitcnt vmcnt(13)
v_mfma_f32_32x32x16_bf16 v[64:79], v[104:107], a[104:107], v[64:79]
s_waitcnt vmcnt(12)
v_mfma_f32_32x32x16_bf16 v[64:79], v[108:111], a[108:111], v[64:79]
s_waitcnt vmcnt(11)
v_mfma_f32_32x32x16_bf16 v[64:79], v[112:115], a[112:115], v[64:79]
s_waitcnt vmcnt(10)
v_mfma_f32_32x32x16_bf16 v[64:79], v[116:119], a[116:119], v[64:79]
s_waitcnt vmcnt(9)
v_mfma_f32_32x32x16_bf16 v[64:79], v[120:123], a[120:123], v[64:79]
s_waitcnt vmcnt(8)
v_mfma_f32_32x32x16_bf16 v[64:79], v[124:127], a[124:127], v[64:79]
s_waitcnt vmcnt(0)
s_branch L_kj_41
L_kn_40:
buffer_load_dwordx4 v[96:99], v2, s[8:11], s26 offen sc1
buffer_load_dwordx4 v[100:103], v2, s[8:11], s26 offen offset:256 sc1
buffer_load_dwordx4 v[104:107], v2, s[8:11], s26 offen offset:512 sc1
buffer_load_dwordx4 v[108:111], v2, s[8:11], s26 offen offset:768 sc1
buffer_load_dwordx4 v[112:115], v2, s[8:11], s26 offen offset:1024 sc1
buffer_load_dwordx4 v[116:119], v2, s[8:11], s26 offen offset:1280 sc1
buffer_load_dwordx4 v[120:123], v2, s[8:11], s26 offen offset:1536 sc1
buffer_load_dwordx4 v[124:127], v2, s[8:11], s26 offen offset:1792 sc1
buffer_load_dword v8, v3, s[8:11], s26 offen offset:2048 sc1
buffer_load_dword v9, v3, s[8:11], s26 offen offset:2112 sc1
buffer_load_dword v10, v3, s[8:11], s26 offen offset:2304 sc1
buffer_load_dword v11, v3, s[8:11], s26 offen offset:2368 sc1
buffer_load_dword v12, v3, s[8:11], s26 offen offset:2560 sc1
buffer_load_dword v13, v3, s[8:11], s26 offen offset:2624 sc1
buffer_load_dword v14, v3, s[8:11], s26 offen offset:2816 sc1
buffer_load_dword v15, v3, s[8:11], s26 offen offset:2880 sc1
v_mov_b32 v26, 1
s_waitcnt vmcnt(16)
s_mov_b64 exec, 1
buffer_store_dword v26, v4, s[8:11], s54 offen
s_mov_b64 exec, -1
L_nb_51:
s_ff1_i32_b64 s48, s[52:53]
s_cmp_lt_u32 s41, 32
s_cbranch_scc1 L_nb_52
s_bitset0_b64 s[52:53], s48
s_sub_u32 s41, s41, 32
s_add_u32 s62, s62, 1
s_branch L_nb_51
L_nb_52:
s_lshl_b32 s48, s48, 5
s_add_u32 s48, s48, s41
s_add_u32 s41, s41, 56
s_lshl_b32 s46, s48, 14
s_add_u32 s46, s46, 33554432
s_lshl_b32 s44, s48, 13
s_add_u32 s44, s44, 134217728
s_cmp_ge_u32 s48, 2048
s_cselect_b32 s44, 536870912, s44
s_cselect_b32 s46, 536870912, s46
s_cbranch_scc1 L_nb_50
s_lshr_b32 s25, s48, 8
s_lshl_b32 s25, s25, 2
s_cmp_eq_u32 s25, s45
s_cbranch_scc1 L_nb_50
s_mov_b32 s45, s25
s_mov_b32 s28, 0
L_poll_54:
buffer_load_dword v26, v17, s[8:11], s45 offen sc1
s_add_u32 s28, s28, 1
s_cmp_gt_u32 s28, 200000
s_cbranch_scc1 L_end
s_waitcnt vmcnt(0)
v_cmp_ne_u32 vcc, 1, v26
s_cbranch_vccz L_pd_55
s_sleep 8
s_cmp_lt_u32 s28, 32
s_cbranch_scc1 L_poll_54
s_sleep 32
s_branch L_poll_54
L_pd_55:
L_nb_50:
s_add_u32 s25, s44, 0
buffer_load_dwordx4 a[0:3], v1, s[8:11], s25 offen sc1
buffer_load_dwordx4 a[4:7], v1, s[8:11], s25 offen offset:1024 sc1
buffer_load_dwordx4 a[8:11], v1, s[8:11], s25 offen offset:2048 sc1
buffer_load_dwordx4 a[12:15], v1, s[8:11], s25 offen offset:3072 sc1
s_add_u32 s25, s44, 4096
buffer_load_dwordx4 a[16:19], v1, s[8:11], s25 offen sc1
buffer_load_dwordx4 a[20:23], v1, s[8:11], s25 offen offset:1024 sc1
buffer_load_dwordx4 a[24:27], v1, s[8:11], s25 offen offset:2048 sc1
buffer_load_dwordx4 a[28:31], v1, s[8:11], s25 offen offset:3072 sc1
s_waitcnt vmcnt(24)
v_mfma_f32_32x32x16_bf16 v[64:79], v[96:99], a[96:99], 0
s_add_u32 s25, s46, 0
buffer_load_dwordx4 a[32:35], v1, s[8:11], s25 offen sc1
buffer_load_dwordx4 a[36:39], v1, s[8:11], s25 offen offset:1024 sc1
s_waitcnt vmcnt(25)
v_mfma_f32_32x32x16_bf16 v[64:79], v[100:103], a[100:103], v[64:79]
buffer_load_dwordx4 a[40:43], v1, s[8:11], s25 offen offset:2048 sc1
buffer_load_dwordx4 a[44:47], v1, s[8:11], s25 offen offset:3072 sc1
s_waitcnt vmcnt(26)
v_mfma_f32_32x32x16_bf16 v[64:79], v[104:107], a[104:107], v[64:79]
s_add_u32 s25, s46, 4096
buffer_load_dwordx4 a[48:51], v1, s[8:11], s25 offen sc1
buffer_load_dwordx4 a[52:55], v1, s[8:11], s25 offen offset:1024 sc1
s_waitcnt vmcnt(27)
v_mfma_f32_32x32x16_bf16 v[64:79], v[108:111], a[108:111], v[64:79]
buffer_load_dwordx4 a[56:59], v1, s[8:11], s25 offen offset:2048 sc1
buffer_load_dwordx4 a[60:63], v1, s[8:11], s25 offen offset:3072 sc1
s_waitcnt vmcnt(28)
v_mfma_f32_32x32x16_bf16 v[64:79], v[112:115], a[112:115], v[64:79]
s_add_u32 s25, s46, 8192
buffer_load_dwordx4 a[64:67], v1, s[8:11], s25 offen sc1
buffer_load_dwordx4 a[68:71], v1, s[8:11], s25 offen offset:1024 sc1
s_waitcnt vmcnt(29)
v_mfma_f32_32x32x16_bf16 v[64:79], v[116:119], a[116:119], v[64:79]
buffer_load_dwordx4 a[72:75], v1, s[8:11], s25 offen offset:2048 sc1
buffer_load_dwordx4 a[76:79], v1, s[8:11], s25 offen offset:3072 sc1
s_waitcnt vmcnt(30)
v_mfma_f32_32x32x16_bf16 v[64:79], v[120:123], a[120:123], v[64:79]
s_add_u32 s25, s46, 12288
buffer_load_dwordx4 a[80:83], v1, s[8:11], s25 offen sc1
buffer_load_dwordx4 a[84:87], v1, s[8:11], s25 offen offset:1024 sc1
s_waitcnt vmcnt(31)
v_mfma_f32_32x32x16_bf16 v[64:79], v[124:127], a[124:127], v[64:79]
buffer_load_dwordx4 a[88:91], v1, s[8:11], s25 offen offset:2048 sc1
buffer_load_dwordx4 a[92:95], v1, s[8:11], s25 offen offset:3072 sc1
s_waitcnt vmcnt(25)
L_kj_41:
s_nop 9
v_max3_f32 v20, v20, v64, v65
v_max3_f32 v20, v20, v66, v67
v_mov_b32 v26, v20
s_nop 1
v_permlane32_swap_b32 v26, v20
v_max_f32 v20, v20, v26
v_mul_f32 v20, s40, v20
v_pk_fma_f32 v[64:65], v[64:65], s[40:41], v[20:21] op_sel_hi:[1,0,0] neg_lo:[0,0,1] neg_hi:[0,0,1]
v_pk_fma_f32 v[66:67], v[66:67], s[40:41], v[20:21] op_sel_hi:[1,0,0] neg_lo:[0,0,1] neg_hi:[0,0,1]
v_pk_fma_f32 v[32:33], v[32:33], s[40:41], v[20:21] op_sel_hi:[1,0,0] neg_lo:[0,0,1] neg_hi:[0,0,1]
v_pk_fma_f32 v[34:35], v[34:35], s[40:41], v[20:21] op_sel_hi:[1,0,0] neg_lo:[0,0,1] neg_hi:[0,0,1]
v_pk_fma_f32 v[36:37], v[36:37], s[40:41], v[20:21] op_sel_hi:[1,0,0] neg_lo:[0,0,1] neg_hi:[0,0,1]
v_pk_fma_f32 v[38:39], v[38:39], s[40:41], v[20:21] op_sel_hi:[1,0,0] neg_lo:[0,0,1] neg_hi:[0,0,1]
v_pk_fma_f32 v[40:41], v[40:41], s[40:41], v[20:21] op_sel_hi:[1,0,0] neg_lo:[0,0,1] neg_hi:[0,0,1]
v_pk_fma_f32 v[42:43], v[42:43], s[40:41], v[20:21] op_sel_hi:[1,0,0] neg_lo:[0,0,1] neg_hi:[0,0,1]
v_pk_fma_f32 v[44:45], v[44:45], s[40:41], v[20:21] op_sel_hi:[1,0,0] neg_lo:[0,0,1] neg_hi:[0,0,1]
v_pk_fma_f32 v[46:47], v[46:47], s[40:41], v[20:21] op_sel_hi:[1,0,0] neg_lo:[0,0,1] neg_hi:[0,0,1]
v_exp_f32 v64, v64
v_exp_f32 v65, v65
v_exp_f32 v66, v66
v_exp_f32 v67, v67
v_exp_f32 v32, v32
v_exp_f32 v33, v33
v_cvt_pk_bf16_f32 v88, v64, v65
v_cvt_pk_bf16_f32 v89, v66, v67
s_nop 1
v_mfma_f32_32x32x8_bf16 v[128:143], v[8:9], v[88:89], 0
v_exp_f32 v34, v34
v_exp_f32 v35, v35
v_exp_f32 v36, v36
v_mfma_f32_32x32x8_bf16 v[160:175], v[10:11], v[88:89], 0
v_exp_f32 v37, v37
v_exp_f32 v38, v38
v_mfma_f32_32x32x8_bf16 v[192:207], v[12:13], v[88:89], 0
v_exp_f32 v39, v39
v_exp_f32 v40, v40
v_exp_f32 v41, v41
v_mfma_f32_32x32x8_bf16 v[224:239], v[14:15], v[88:89], 0
v_cvt_pk_bf16_f32 v80, v32, v33
v_cvt_pk_bf16_f32 v81, v34, v35
v_cvt_pk_bf16_f32 v82, v36, v37
v_cvt_pk_bf16_f32 v83, v38, v39
s_nop 1
v_mfma_f32_32x32x16_bf16 v[128:143], a[160:163], v[80:83], v[128:143]
v_exp_f32 v42, v42
v_exp_f32 v43, v43
v_exp_f32 v44, v44
v_mfma_f32_32x32x16_bf16 v[160:175], a[168:171], v[80:83], v[160:175]
v_exp_f32 v45, v45
v_exp_f32 v46, v46
v_mfma_f32_32x32x16_bf16 v[192:207], a[176:179], v[80:83], v[192:207]
v_exp_f32 v47, v47
v_add_f32 v22, v64, v65
v_add_f32 v22, v22, v66
v_add_f32 v22, v22, v67
v_add_f32 v22, v22, v32
v_mfma_f32_32x32x16_bf16 v[224:239], a[184:187], v[80:83], v[224:239]
v_add_f32 v22, v22, v33
v_cvt_pk_bf16_f32 v84, v40, v41
v_cvt_pk_bf16_f32 v85, v42, v43
v_cvt_pk_bf16_f32 v86, v44, v45
v_cvt_pk_bf16_f32 v87, v46, v47
s_nop 1
v_mfma_f32_32x32x16_bf16 v[128:143], a[164:167], v[84:87], v[128:143]
v_add_f32 v22, v22, v34
v_add_f32 v22, v22, v35
v_add_f32 v22, v22, v36
v_add_f32 v22, v22, v37
v_add_f32 v22, v22, v38
v_mfma_f32_32x32x16_bf16 v[160:175], a[172:175], v[84:87], v[160:175]
v_add_f32 v22, v22, v39
v_add_f32 v22, v22, v40
v_add_f32 v22, v22, v41
v_add_f32 v22, v22, v42
v_mfma_f32_32x32x16_bf16 v[192:207], a[180:183], v[84:87], v[192:207]
v_add_f32 v22, v22, v43
v_add_f32 v22, v22, v44
v_add_f32 v22, v22, v45
v_add_f32 v22, v22, v46
v_add_f32 v22, v22, v47
v_mfma_f32_32x32x16_bf16 v[224:239], a[188:191], v[84:87], v[224:239]
s_lshl_b32 s26, s43, 18
s_lshl_b32 s27, s42, 12
s_add_u32 s26, s26, s27
s_add_u32 s26, s26, 83886080
v_mov_b32 v26, v22
s_nop 1
v_permlane32_swap_b32 v26, v22
v_add_f32 v26, v26, v22
v_rcp_f32 v26, v26
s_nop 0
v_pk_mul_f32 v[128:129], v[128:129], v[26:27] op_sel_hi:[1,0]
v_pk_mul_f32 v[130:131], v[130:131], v[26:27] op_sel_hi:[1,0]
v_pk_mul_f32 v[132:133], v[132:133], v[26:27] op_sel_hi:[1,0]
v_pk_mul_f32 v[134:135], v[134:135], v[26:27] op_sel_hi:[1,0]
v_pk_mul_f32 v[136:137], v[136:137], v[26:27] op_sel_hi:[1,0]
v_pk_mul_f32 v[138:139], v[138:139], v[26:27] op_sel_hi:[1,0]
v_pk_mul_f32 v[140:141], v[140:141], v[26:27] op_sel_hi:[1,0]
v_pk_mul_f32 v[142:143], v[142:143], v[26:27] op_sel_hi:[1,0]
v_cvt_pk_bf16_f32 v128, v128, v129
v_cvt_pk_bf16_f32 v129, v130, v131
v_cvt_pk_bf16_f32 v130, v132, v133
v_cvt_pk_bf16_f32 v131, v134, v135
buffer_store_dwordx4 v[128:131], v6, s[8:11], s26 offen
v_cvt_pk_bf16_f32 v136, v136, v137
v_cvt_pk_bf16_f32 v137, v138, v139
v_cvt_pk_bf16_f32 v138, v140, v141
v_cvt_pk_bf16_f32 v139, v142, v143
buffer_store_dwordx4 v[136:139], v6, s[8:11], s26 offen offset:512
v_pk_mul_f32 v[160:161], v[160:161], v[26:27] op_sel_hi:[1,0]
v_pk_mul_f32 v[162:163], v[162:163], v[26:27] op_sel_hi:[1,0]
v_pk_mul_f32 v[164:165], v[164:165], v[26:27] op_sel_hi:[1,0]
v_pk_mul_f32 v[166:167], v[166:167], v[26:27] op_sel_hi:[1,0]
v_pk_mul_f32 v[168:169], v[168:169], v[26:27] op_sel_hi:[1,0]
v_pk_mul_f32 v[170:171], v[170:171], v[26:27] op_sel_hi:[1,0]
v_pk_mul_f32 v[172:173], v[172:173], v[26:27] op_sel_hi:[1,0]
v_pk_mul_f32 v[174:175], v[174:175], v[26:27] op_sel_hi:[1,0]
v_cvt_pk_bf16_f32 v160, v160, v161
v_cvt_pk_bf16_f32 v161, v162, v163
v_cvt_pk_bf16_f32 v162, v164, v165
v_cvt_pk_bf16_f32 v163, v166, v167
buffer_store_dwordx4 v[160:163], v6, s[8:11], s26 offen offset:1024
v_cvt_pk_bf16_f32 v168, v168, v169
v_cvt_pk_bf16_f32 v169, v170, v171
v_cvt_pk_bf16_f32 v170, v172, v173
v_cvt_pk_bf16_f32 v171, v174, v175
buffer_store_dwordx4 v[168:171], v6, s[8:11], s26 offen offset:1536
v_pk_mul_f32 v[192:193], v[192:193], v[26:27] op_sel_hi:[1,0]
v_pk_mul_f32 v[194:195], v[194:195], v[26:27] op_sel_hi:[1,0]
v_pk_mul_f32 v[196:197], v[196:197], v[26:27] op_sel_hi:[1,0]
v_pk_mul_f32 v[198:199], v[198:199], v[26:27] op_sel_hi:[1,0]
v_pk_mul_f32 v[200:201], v[200:201], v[26:27] op_sel_hi:[1,0]
v_pk_mul_f32 v[202:203], v[202:203], v[26:27] op_sel_hi:[1,0]
v_pk_mul_f32 v[204:205], v[204:205], v[26:27] op_sel_hi:[1,0]
v_pk_mul_f32 v[206:207], v[206:207], v[26:27] op_sel_hi:[1,0]
v_cvt_pk_bf16_f32 v192, v192, v193
v_cvt_pk_bf16_f32 v193, v194, v195
v_cvt_pk_bf16_f32 v194, v196, v197
v_cvt_pk_bf16_f32 v195, v198, v199
buffer_store_dwordx4 v[192:195], v6, s[8:11], s26 offen offset:2048
v_cvt_pk_bf16_f32 v200, v200, v201
v_cvt_pk_bf16_f32 v201, v202, v203
v_cvt_pk_bf16_f32 v202, v204, v205
v_cvt_pk_bf16_f32 v203, v206, v207
buffer_store_dwordx4 v[200:203], v6, s[8:11], s26 offen offset:2560
v_pk_mul_f32 v[224:225], v[224:225], v[26:27] op_sel_hi:[1,0]
v_pk_mul_f32 v[226:227], v[226:227], v[26:27] op_sel_hi:[1,0]
v_pk_mul_f32 v[228:229], v[228:229], v[26:27] op_sel_hi:[1,0]
v_pk_mul_f32 v[230:231], v[230:231], v[26:27] op_sel_hi:[1,0]
v_pk_mul_f32 v[232:233], v[232:233], v[26:27] op_sel_hi:[1,0]
v_pk_mul_f32 v[234:235], v[234:235], v[26:27] op_sel_hi:[1,0]
v_pk_mul_f32 v[236:237], v[236:237], v[26:27] op_sel_hi:[1,0]
v_pk_mul_f32 v[238:239], v[238:239], v[26:27] op_sel_hi:[1,0]
v_cvt_pk_bf16_f32 v224, v224, v225
v_cvt_pk_bf16_f32 v225, v226, v227
v_cvt_pk_bf16_f32 v226, v228, v229
v_cvt_pk_bf16_f32 v227, v230, v231
buffer_store_dwordx4 v[224:227], v6, s[8:11], s26 offen offset:3072
v_cvt_pk_bf16_f32 v232, v232, v233
v_cvt_pk_bf16_f32 v233, v234, v235
v_cvt_pk_bf16_f32 v234, v236, v237
v_cvt_pk_bf16_f32 v235, v238, v239
buffer_store_dwordx4 v[232:235], v6, s[8:11], s26 offen offset:3584
s_lshl_b32 s54, s47, 2
s_add_u32 s54, s54, 111157248
s_bitcmp1_b64 s[30:31], s43
s_cselect_b32 s60, s54, 536870912
s_cselect_b32 s54, 536870912, s54
s_mov_b32 s47, s48
s_cmp_lt_u32 s47, 2048
s_cbranch_scc1 L_bt
L_bt_f:
v_mov_b32 v26, 1
s_waitcnt vmcnt(0)
s_mov_b64 exec, 1
buffer_store_dword v26, v4, s[8:11], s54 offen
s_mov_b64 exec, -1
L_bt_x:
s_branch L_done
L_bo:
s_andn2_b32 s4, s4, 0x0
s_andn2_b32 s5, s5, 0x0
L_bo2:
s_mov_b64 s[42:43], s[4:5]
s_mov_b32 s51, s27
s_mov_b32 s40, s26
s_mov_b32 s44, 83886080
s_mov_b32 s45, 111157248
s_mov_b32 s46, 1
s_mov_b32 s47, 1152
s_lshl_b32 s54, s3, 7
s_add_u32 s54, s54, 111171584
s_lshl2_add_u32 s24, s16, s17
s_cmp_eq_u32 s24, 4
s_cselect_b32 s54, s54, 536870912
s_load_dwordx2 s[4:5], s[0:1], 88
s_waitcnt lgkmcnt(0)
s_mov_b32 s20, s4
s_and_b32 s21, s5, 0xffff
s_mov_b32 s22, 4718592
s_mov_b32 s23, 0x20000
L_op:
s_load_dwordx2 s[4:5], s[0:1], 104
s_waitcnt lgkmcnt(0)
s_mov_b32 s12, s4
s_and_b32 s13, s5, 0xffff
s_mov_b32 s14, 4718592
s_mov_b32 s15, 0x20000
v_and_b32 v1, 63, v0
v_lshlrev_b32 v1, 4, v1
v_bfe_u32 v12, v0, 3, 3
v_bfe_u32 v13, v0, 5, 1
v_lshl_add_u32 v13, v13, 3, v12
v_mul_u32_u24 v13, s47, v13
v_mul_u32_u24 v12, 1152, v12
v_add_u32 v12, v12, v13
s_mul_i32 s50, s47, 15
s_sub_u32 s50, 18432, s50
v_bfe_u32 v13, v0, 4, 2
v_lshlrev_b32 v13, 1, v13
v_and_b32 v14, 7, v0
v_xor_b32 v13, v13, v14
v_lshl_add_u32 v12, v13, 4, v12
s_mul_i32 s24, s17, 1179648
s_lshl_b32 s25, s40, 7
s_add_u32 s24, s24, s25
v_add_u32 v2, s24, v12
s_lshl_b32 s26, s17, 15
v_bfe_u32 v12, v0, 2, 3
v_lshlrev_b32 v12, 7, v12
v_bfe_u32 v13, v0, 5, 1
v_lshl_add_u32 v12, v13, 11, v12
v_bfe_u32 v13, v0, 3, 2
v_lshl_add_u32 v12, v13, 5, v12
v_and_b32 v13, 3, v0
v_lshl_add_u32 v12, v13, 3, v12
v_add_u32 v8, s26, v12
v_xor_b32 v9, 32, v8
v_xor_b32 v10, 64, v8
v_xor_b32 v11, 96, v8
s_add_u32 s24, s40, 0
s_and_b32 s24, s24, 7
s_lshl_b32 s30, s24, 12
s_add_u32 s24, s40, 1
s_and_b32 s24, s24, 7
s_lshl_b32 s31, s24, 12
s_add_u32 s24, s40, 2
s_and_b32 s24, s24, 7
s_lshl_b32 s32, s24, 12
s_add_u32 s24, s40, 3
s_and_b32 s24, s24, 7
s_lshl_b32 s33, s24, 12
s_add_u32 s24, s40, 4
s_and_b32 s24, s24, 7
s_lshl_b32 s34, s24, 12
s_add_u32 s24, s40, 5
s_and_b32 s24, s24, 7
s_lshl_b32 s35, s24, 12
s_add_u32 s24, s40, 6
s_and_b32 s24, s24, 7
s_lshl_b32 s36, s24, 12
s_add_u32 s24, s40, 7
s_and_b32 s24, s24, 7
s_lshl_b32 s37, s24, 12
s_mul_i32 s25, s30, 36
s_add_u32 m0, s26, 0
s_add_u32 s24, s25, 0
buffer_load_dwordx4 v2, s[20:23], s24 offen lds
s_add_u32 m0, s26, 1024
s_add_u32 s24, s25, 9216
buffer_load_dwordx4 v2, s[20:23], s24 offen lds
s_add_u32 s25, s25, s50
s_add_u32 m0, s26, 2048
s_add_u32 s24, s25, 0
buffer_load_dwordx4 v2, s[20:23], s24 offen lds
s_add_u32 m0, s26, 3072
s_add_u32 s24, s25, 9216
buffer_load_dwordx4 v2, s[20:23], s24 offen lds
s_mul_i32 s25, s30, 36
s_add_u32 m0, s26, 4096
s_add_u32 s24, s25, 36864
buffer_load_dwordx4 v2, s[20:23], s24 offen lds
s_add_u32 m0, s26, 5120
s_add_u32 s24, s25, 46080
buffer_load_dwordx4 v2, s[20:23], s24 offen lds
s_add_u32 s25, s25, s50
s_add_u32 m0, s26, 6144
s_add_u32 s24, s25, 36864
buffer_load_dwordx4 v2, s[20:23], s24 offen lds
s_add_u32 m0, s26, 7168
s_add_u32 s24, s25, 46080
buffer_load_dwordx4 v2, s[20:23], s24 offen lds
s_mul_i32 s25, s30, 36
s_add_u32 m0, s26, 8192
s_add_u32 s24, s25, 73728
buffer_load_dwordx4 v2, s[20:23], s24 offen lds
s_add_u32 m0, s26, 9216
s_add_u32 s24, s25, 82944
buffer_load_dwordx4 v2, s[20:23], s24 offen lds
s_add_u32 s25, s25, s50
s_add_u32 m0, s26, 10240
s_add_u32 s24, s25, 73728
buffer_load_dwordx4 v2, s[20:23], s24 offen lds
s_add_u32 m0, s26, 11264
s_add_u32 s24, s25, 82944
buffer_load_dwordx4 v2, s[20:23], s24 offen lds
s_mul_i32 s25, s31, 36
s_add_u32 m0, s26, 12288
s_add_u32 s24, s25, 0
buffer_load_dwordx4 v2, s[20:23], s24 offen lds
s_add_u32 m0, s26, 13312
s_add_u32 s24, s25, 9216
buffer_load_dwordx4 v2, s[20:23], s24 offen lds
s_add_u32 s25, s25, s50
s_add_u32 m0, s26, 14336
s_add_u32 s24, s25, 0
buffer_load_dwordx4 v2, s[20:23], s24 offen lds
s_add_u32 m0, s26, 15360
s_add_u32 s24, s25, 9216
buffer_load_dwordx4 v2, s[20:23], s24 offen lds
s_mul_i32 s25, s31, 36
s_add_u32 m0, s26, 16384
s_add_u32 s24, s25, 36864
buffer_load_dwordx4 v2, s[20:23], s24 offen lds
s_add_u32 m0, s26, 17408
s_add_u32 s24, s25, 46080
buffer_load_dwordx4 v2, s[20:23], s24 offen lds
s_add_u32 s25, s25, s50
s_add_u32 m0, s26, 18432
s_add_u32 s24, s25, 36864
buffer_load_dwordx4 v2, s[20:23], s24 offen lds
s_add_u32 m0, s26, 19456
s_add_u32 s24, s25, 46080
buffer_load_dwordx4 v2, s[20:23], s24 offen lds
s_mul_i32 s25, s31, 36
s_add_u32 m0, s26, 20480
s_add_u32 s24, s25, 73728
buffer_load_dwordx4 v2, s[20:23], s24 offen lds
s_add_u32 m0, s26, 21504
s_add_u32 s24, s25, 82944
buffer_load_dwordx4 v2, s[20:23], s24 offen lds
s_add_u32 s25, s25, s50
s_add_u32 m0, s26, 22528
s_add_u32 s24, s25, 73728
buffer_load_dwordx4 v2, s[20:23], s24 offen lds
s_add_u32 m0, s26, 23552
s_add_u32 s24, s25, 82944
buffer_load_dwordx4 v2, s[20:23], s24 offen lds
s_mul_i32 s25, s32, 36
s_add_u32 m0, s26, 24576
s_add_u32 s24, s25, 0
buffer_load_dwordx4 v2, s[20:23], s24 offen lds
s_add_u32 m0, s26, 25600
s_add_u32 s24, s25, 9216
buffer_load_dwordx4 v2, s[20:23], s24 offen lds
s_add_u32 s25, s25, s50
s_add_u32 m0, s26, 26624
s_add_u32 s24, s25, 0
buffer_load_dwordx4 v2, s[20:23], s24 offen lds
s_add_u32 m0, s26, 27648
s_add_u32 s24, s25, 9216
buffer_load_dwordx4 v2, s[20:23], s24 offen lds
s_mul_i32 s25, s32, 36
s_add_u32 m0, s26, 28672
s_add_u32 s24, s25, 36864
buffer_load_dwordx4 v2, s[20:23], s24 offen lds
s_add_u32 m0, s26, 29696
s_add_u32 s24, s25, 46080
buffer_load_dwordx4 v2, s[20:23], s24 offen lds
s_add_u32 s25, s25, s50
s_add_u32 m0, s26, 30720
s_add_u32 s24, s25, 36864
buffer_load_dwordx4 v2, s[20:23], s24 offen lds
s_add_u32 m0, s26, 31744
s_add_u32 s24, s25, 46080
buffer_load_dwordx4 v2, s[20:23], s24 offen lds
s_waitcnt vmcnt(28)
ds_read_b64_tr_b16 v[128:129], v8
ds_read_b64_tr_b16 v[130:131], v8 offset:1024
ds_read_b64_tr_b16 v[132:133], v9
ds_read_b64_tr_b16 v[134:135], v9 offset:1024
ds_read_b64_tr_b16 v[136:137], v10
ds_read_b64_tr_b16 v[138:139], v10 offset:1024
ds_read_b64_tr_b16 v[140:141], v11
ds_read_b64_tr_b16 v[142:143], v11 offset:1024
s_waitcnt lgkmcnt(0)
s_mul_i32 s25, s32, 36
s_add_u32 m0, s26, 0
s_add_u32 s24, s25, 73728
buffer_load_dwordx4 v2, s[20:23], s24 offen lds
s_add_u32 m0, s26, 1024
s_add_u32 s24, s25, 82944
buffer_load_dwordx4 v2, s[20:23], s24 offen lds
s_add_u32 s25, s25, s50
s_add_u32 m0, s26, 2048
s_add_u32 s24, s25, 73728
buffer_load_dwordx4 v2, s[20:23], s24 offen lds
s_add_u32 m0, s26, 3072
s_add_u32 s24, s25, 82944
buffer_load_dwordx4 v2, s[20:23], s24 offen lds
s_waitcnt vmcnt(28)
ds_read_b64_tr_b16 v[144:145], v8 offset:4096
ds_read_b64_tr_b16 v[146:147], v8 offset:5120
ds_read_b64_tr_b16 v[148:149], v9 offset:4096
ds_read_b64_tr_b16 v[150:151], v9 offset:5120
ds_read_b64_tr_b16 v[152:153], v10 offset:4096
ds_read_b64_tr_b16 v[154:155], v10 offset:5120
ds_read_b64_tr_b16 v[156:157], v11 offset:4096
ds_read_b64_tr_b16 v[158:159], v11 offset:5120
s_waitcnt lgkmcnt(0)
s_mul_i32 s25, s33, 36
s_add_u32 m0, s26, 4096
s_add_u32 s24, s25, 0
buffer_load_dwordx4 v2, s[20:23], s24 offen lds
s_add_u32 m0, s26, 5120
s_add_u32 s24, s25, 9216
buffer_load_dwordx4 v2, s[20:23], s24 offen lds
s_add_u32 s25, s25, s50
s_add_u32 m0, s26, 6144
s_add_u32 s24, s25, 0
buffer_load_dwordx4 v2, s[20:23], s24 offen lds
s_add_u32 m0, s26, 7168
s_add_u32 s24, s25, 9216
buffer_load_dwordx4 v2, s[20:23], s24 offen lds
s_waitcnt vmcnt(28)
ds_read_b64_tr_b16 v[160:161], v8 offset:8192
ds_read_b64_tr_b16 v[162:163], v8 offset:9216
ds_read_b64_tr_b16 v[164:165], v9 offset:8192
ds_read_b64_tr_b16 v[166:167], v9 offset:9216
ds_read_b64_tr_b16 v[168:169], v10 offset:8192
ds_read_b64_tr_b16 v[170:171], v10 offset:9216
ds_read_b64_tr_b16 v[172:173], v11 offset:8192
ds_read_b64_tr_b16 v[174:175], v11 offset:9216
s_waitcnt lgkmcnt(0)
s_mul_i32 s25, s33, 36
s_add_u32 m0, s26, 8192
s_add_u32 s24, s25, 36864
buffer_load_dwordx4 v2, s[20:23], s24 offen lds
s_add_u32 m0, s26, 9216
s_add_u32 s24, s25, 46080
buffer_load_dwordx4 v2, s[20:23], s24 offen lds
s_add_u32 s25, s25, s50
s_add_u32 m0, s26, 10240
s_add_u32 s24, s25, 36864
buffer_load_dwordx4 v2, s[20:23], s24 offen lds
s_add_u32 m0, s26, 11264
s_add_u32 s24, s25, 46080
buffer_load_dwordx4 v2, s[20:23], s24 offen lds
s_waitcnt vmcnt(28)
ds_read_b64_tr_b16 v[176:177], v8 offset:12288
ds_read_b64_tr_b16 v[178:179], v8 offset:13312
ds_read_b64_tr_b16 v[180:181], v9 offset:12288
ds_read_b64_tr_b16 v[182:183], v9 offset:13312
ds_read_b64_tr_b16 v[184:185], v10 offset:12288
ds_read_b64_tr_b16 v[186:187], v10 offset:13312
ds_read_b64_tr_b16 v[188:189], v11 offset:12288
ds_read_b64_tr_b16 v[190:191], v11 offset:13312
s_waitcnt lgkmcnt(0)
s_mul_i32 s25, s33, 36
s_add_u32 m0, s26, 12288
s_add_u32 s24, s25, 73728
buffer_load_dwordx4 v2, s[20:23], s24 offen lds
s_add_u32 m0, s26, 13312
s_add_u32 s24, s25, 82944
buffer_load_dwordx4 v2, s[20:23], s24 offen lds
s_add_u32 s25, s25, s50
s_add_u32 m0, s26, 14336
s_add_u32 s24, s25, 73728
buffer_load_dwordx4 v2, s[20:23], s24 offen lds
s_add_u32 m0, s26, 15360
s_add_u32 s24, s25, 82944
buffer_load_dwordx4 v2, s[20:23], s24 offen lds
s_waitcnt vmcnt(28)
ds_read_b64_tr_b16 v[192:193], v8 offset:16384
ds_read_b64_tr_b16 v[194:195], v8 offset:17408
ds_read_b64_tr_b16 v[196:197], v9 offset:16384
ds_read_b64_tr_b16 v[198:199], v9 offset:17408
ds_read_b64_tr_b16 v[200:201], v10 offset:16384
ds_read_b64_tr_b16 v[202:203], v10 offset:17408
ds_read_b64_tr_b16 v[204:205], v11 offset:16384
ds_read_b64_tr_b16 v[206:207], v11 offset:17408
s_waitcnt lgkmcnt(0)
s_mul_i32 s25, s34, 36
s_add_u32 m0, s26, 16384
s_add_u32 s24, s25, 0
buffer_load_dwordx4 v2, s[20:23], s24 offen lds
s_add_u32 m0, s26, 17408
s_add_u32 s24, s25, 9216
buffer_load_dwordx4 v2, s[20:23], s24 offen lds
s_add_u32 s25, s25, s50
s_add_u32 m0, s26, 18432
s_add_u32 s24, s25, 0
buffer_load_dwordx4 v2, s[20:23], s24 offen lds
s_add_u32 m0, s26, 19456
s_add_u32 s24, s25, 9216
buffer_load_dwordx4 v2, s[20:23], s24 offen lds
s_waitcnt vmcnt(28)
ds_read_b64_tr_b16 v[208:209], v8 offset:20480
ds_read_b64_tr_b16 v[210:211], v8 offset:21504
ds_read_b64_tr_b16 v[212:213], v9 offset:20480
ds_read_b64_tr_b16 v[214:215], v9 offset:21504
ds_read_b64_tr_b16 v[216:217], v10 offset:20480
ds_read_b64_tr_b16 v[218:219], v10 offset:21504
ds_read_b64_tr_b16 v[220:221], v11 offset:20480
ds_read_b64_tr_b16 v[222:223], v11 offset:21504
s_waitcnt lgkmcnt(0)
s_mul_i32 s25, s34, 36
s_add_u32 m0, s26, 20480
s_add_u32 s24, s25, 36864
buffer_load_dwordx4 v2, s[20:23], s24 offen lds
s_add_u32 m0, s26, 21504
s_add_u32 s24, s25, 46080
buffer_load_dwordx4 v2, s[20:23], s24 offen lds
s_add_u32 s25, s25, s50
s_add_u32 m0, s26, 22528
s_add_u32 s24, s25, 36864
buffer_load_dwordx4 v2, s[20:23], s24 offen lds
s_add_u32 m0, s26, 23552
s_add_u32 s24, s25, 46080
buffer_load_dwordx4 v2, s[20:23], s24 offen lds
s_waitcnt vmcnt(28)
ds_read_b64_tr_b16 v[224:225], v8 offset:24576
ds_read_b64_tr_b16 v[226:227], v8 offset:25600
ds_read_b64_tr_b16 v[228:229], v9 offset:24576
ds_read_b64_tr_b16 v[230:231], v9 offset:25600
ds_read_b64_tr_b16 v[232:233], v10 offset:24576
ds_read_b64_tr_b16 v[234:235], v10 offset:25600
ds_read_b64_tr_b16 v[236:237], v11 offset:24576
ds_read_b64_tr_b16 v[238:239], v11 offset:25600
s_waitcnt lgkmcnt(0)
s_mul_i32 s25, s34, 36
s_add_u32 m0, s26, 24576
s_add_u32 s24, s25, 73728
buffer_load_dwordx4 v2, s[20:23], s24 offen lds
s_add_u32 m0, s26, 25600
s_add_u32 s24, s25, 82944
buffer_load_dwordx4 v2, s[20:23], s24 offen lds
s_add_u32 s25, s25, s50
s_add_u32 m0, s26, 26624
s_add_u32 s24, s25, 73728
buffer_load_dwordx4 v2, s[20:23], s24 offen lds
s_add_u32 m0, s26, 27648
s_add_u32 s24, s25, 82944
buffer_load_dwordx4 v2, s[20:23], s24 offen lds
s_waitcnt vmcnt(28)
ds_read_b64_tr_b16 v[240:241], v8 offset:28672
ds_read_b64_tr_b16 v[242:243], v8 offset:29696
ds_read_b64_tr_b16 v[244:245], v9 offset:28672
ds_read_b64_tr_b16 v[246:247], v9 offset:29696
ds_read_b64_tr_b16 v[248:249], v10 offset:28672
ds_read_b64_tr_b16 v[250:251], v10 offset:29696
ds_read_b64_tr_b16 v[252:253], v11 offset:28672
ds_read_b64_tr_b16 v[254:255], v11 offset:29696
s_waitcnt lgkmcnt(0)
s_mul_i32 s25, s35, 36
s_add_u32 m0, s26, 28672
s_add_u32 s24, s25, 0
buffer_load_dwordx4 v2, s[20:23], s24 offen lds
s_add_u32 m0, s26, 29696
s_add_u32 s24, s25, 9216
buffer_load_dwordx4 v2, s[20:23], s24 offen lds
s_add_u32 s25, s25, s50
s_add_u32 m0, s26, 30720
s_add_u32 s24, s25, 0
buffer_load_dwordx4 v2, s[20:23], s24 offen lds
s_add_u32 m0, s26, 31744
s_add_u32 s24, s25, 9216
buffer_load_dwordx4 v2, s[20:23], s24 offen lds
s_waitcnt vmcnt(28)
ds_read_b64_tr_b16 a[0:1], v8
ds_read_b64_tr_b16 a[2:3], v8 offset:1024
ds_read_b64_tr_b16 a[4:5], v9
ds_read_b64_tr_b16 a[6:7], v9 offset:1024
ds_read_b64_tr_b16 a[8:9], v10
ds_read_b64_tr_b16 a[10:11], v10 offset:1024
ds_read_b64_tr_b16 a[12:13], v11
ds_read_b64_tr_b16 a[14:15], v11 offset:1024
s_waitcnt lgkmcnt(0)
s_mul_i32 s25, s35, 36
s_add_u32 m0, s26, 0
s_add_u32 s24, s25, 36864
buffer_load_dwordx4 v2, s[20:23], s24 offen lds
s_add_u32 m0, s26, 1024
s_add_u32 s24, s25, 46080
buffer_load_dwordx4 v2, s[20:23], s24 offen lds
s_add_u32 s25, s25, s50
s_add_u32 m0, s26, 2048
s_add_u32 s24, s25, 36864
buffer_load_dwordx4 v2, s[20:23], s24 offen lds
s_add_u32 m0, s26, 3072
s_add_u32 s24, s25, 46080
buffer_load_dwordx4 v2, s[20:23], s24 offen lds
s_waitcnt vmcnt(28)
ds_read_b64_tr_b16 a[16:17], v8 offset:4096
ds_read_b64_tr_b16 a[18:19], v8 offset:5120
ds_read_b64_tr_b16 a[20:21], v9 offset:4096
ds_read_b64_tr_b16 a[22:23], v9 offset:5120
ds_read_b64_tr_b16 a[24:25], v10 offset:4096
ds_read_b64_tr_b16 a[26:27], v10 offset:5120
ds_read_b64_tr_b16 a[28:29], v11 offset:4096
ds_read_b64_tr_b16 a[30:31], v11 offset:5120
s_waitcnt lgkmcnt(0)
s_mul_i32 s25, s35, 36
s_add_u32 m0, s26, 4096
s_add_u32 s24, s25, 73728
buffer_load_dwordx4 v2, s[20:23], s24 offen lds
s_add_u32 m0, s26, 5120
s_add_u32 s24, s25, 82944
buffer_load_dwordx4 v2, s[20:23], s24 offen lds
s_add_u32 s25, s25, s50
s_add_u32 m0, s26, 6144
s_add_u32 s24, s25, 73728
buffer_load_dwordx4 v2, s[20:23], s24 offen lds
s_add_u32 m0, s26, 7168
s_add_u32 s24, s25, 82944
buffer_load_dwordx4 v2, s[20:23], s24 offen lds
s_waitcnt vmcnt(28)
ds_read_b64_tr_b16 a[32:33], v8 offset:8192
ds_read_b64_tr_b16 a[34:35], v8 offset:9216
ds_read_b64_tr_b16 a[36:37], v9 offset:8192
ds_read_b64_tr_b16 a[38:39], v9 offset:9216
ds_read_b64_tr_b16 a[40:41], v10 offset:8192
ds_read_b64_tr_b16 a[42:43], v10 offset:9216
ds_read_b64_tr_b16 a[44:45], v11 offset:8192
ds_read_b64_tr_b16 a[46:47], v11 offset:9216
s_waitcnt lgkmcnt(0)
s_mul_i32 s25, s36, 36
s_add_u32 m0, s26, 8192
s_add_u32 s24, s25, 0
buffer_load_dwordx4 v2, s[20:23], s24 offen lds
s_add_u32 m0, s26, 9216
s_add_u32 s24, s25, 9216
buffer_load_dwordx4 v2, s[20:23], s24 offen lds
s_add_u32 s25, s25, s50
s_add_u32 m0, s26, 10240
s_add_u32 s24, s25, 0
buffer_load_dwordx4 v2, s[20:23], s24 offen lds
s_add_u32 m0, s26, 11264
s_add_u32 s24, s25, 9216
buffer_load_dwordx4 v2, s[20:23], s24 offen lds
s_waitcnt vmcnt(28)
ds_read_b64_tr_b16 a[48:49], v8 offset:12288
ds_read_b64_tr_b16 a[50:51], v8 offset:13312
ds_read_b64_tr_b16 a[52:53], v9 offset:12288
ds_read_b64_tr_b16 a[54:55], v9 offset:13312
ds_read_b64_tr_b16 a[56:57], v10 offset:12288
ds_read_b64_tr_b16 a[58:59], v10 offset:13312
ds_read_b64_tr_b16 a[60:61], v11 offset:12288
ds_read_b64_tr_b16 a[62:63], v11 offset:13312
s_waitcnt lgkmcnt(0)
s_mul_i32 s25, s36, 36
s_add_u32 m0, s26, 12288
s_add_u32 s24, s25, 36864
buffer_load_dwordx4 v2, s[20:23], s24 offen lds
s_add_u32 m0, s26, 13312
s_add_u32 s24, s25, 46080
buffer_load_dwordx4 v2, s[20:23], s24 offen lds
s_add_u32 s25, s25, s50
s_add_u32 m0, s26, 14336
s_add_u32 s24, s25, 36864
buffer_load_dwordx4 v2, s[20:23], s24 offen lds
s_add_u32 m0, s26, 15360
s_add_u32 s24, s25, 46080
buffer_load_dwordx4 v2, s[20:23], s24 offen lds
s_waitcnt vmcnt(28)
ds_read_b64_tr_b16 a[64:65], v8 offset:16384
ds_read_b64_tr_b16 a[66:67], v8 offset:17408
ds_read_b64_tr_b16 a[68:69], v9 offset:16384
ds_read_b64_tr_b16 a[70:71], v9 offset:17408
ds_read_b64_tr_b16 a[72:73], v10 offset:16384
ds_read_b64_tr_b16 a[74:75], v10 offset:17408
ds_read_b64_tr_b16 a[76:77], v11 offset:16384
ds_read_b64_tr_b16 a[78:79], v11 offset:17408
s_waitcnt lgkmcnt(0)
s_mul_i32 s25, s36, 36
s_add_u32 m0, s26, 16384
s_add_u32 s24, s25, 73728
buffer_load_dwordx4 v2, s[20:23], s24 offen lds
s_add_u32 m0, s26, 17408
s_add_u32 s24, s25, 82944
buffer_load_dwordx4 v2, s[20:23], s24 offen lds
s_add_u32 s25, s25, s50
s_add_u32 m0, s26, 18432
s_add_u32 s24, s25, 73728
buffer_load_dwordx4 v2, s[20:23], s24 offen lds
s_add_u32 m0, s26, 19456
s_add_u32 s24, s25, 82944
buffer_load_dwordx4 v2, s[20:23], s24 offen lds
s_waitcnt vmcnt(28)
ds_read_b64_tr_b16 a[80:81], v8 offset:20480
ds_read_b64_tr_b16 a[82:83], v8 offset:21504
ds_read_b64_tr_b16 a[84:85], v9 offset:20480
ds_read_b64_tr_b16 a[86:87], v9 offset:21504
ds_read_b64_tr_b16 a[88:89], v10 offset:20480
ds_read_b64_tr_b16 a[90:91], v10 offset:21504
ds_read_b64_tr_b16 a[92:93], v11 offset:20480
ds_read_b64_tr_b16 a[94:95], v11 offset:21504
s_waitcnt lgkmcnt(0)
s_mul_i32 s25, s37, 36
s_add_u32 m0, s26, 20480
s_add_u32 s24, s25, 0
buffer_load_dwordx4 v2, s[20:23], s24 offen lds
s_add_u32 m0, s26, 21504
s_add_u32 s24, s25, 9216
buffer_load_dwordx4 v2, s[20:23], s24 offen lds
s_add_u32 s25, s25, s50
s_add_u32 m0, s26, 22528
s_add_u32 s24, s25, 0
buffer_load_dwordx4 v2, s[20:23], s24 offen lds
s_add_u32 m0, s26, 23552
s_add_u32 s24, s25, 9216
buffer_load_dwordx4 v2, s[20:23], s24 offen lds
s_waitcnt vmcnt(28)
ds_read_b64_tr_b16 a[96:97], v8 offset:24576
ds_read_b64_tr_b16 a[98:99], v8 offset:25600
ds_read_b64_tr_b16 a[100:101], v9 offset:24576
ds_read_b64_tr_b16 a[102:103], v9 offset:25600
ds_read_b64_tr_b16 a[104:105], v10 offset:24576
ds_read_b64_tr_b16 a[106:107], v10 offset:25600
ds_read_b64_tr_b16 a[108:109], v11 offset:24576
ds_read_b64_tr_b16 a[110:111], v11 offset:25600
s_waitcnt lgkmcnt(0)
s_mul_i32 s25, s37, 36
s_add_u32 m0, s26, 24576
s_add_u32 s24, s25, 36864
buffer_load_dwordx4 v2, s[20:23], s24 offen lds
s_add_u32 m0, s26, 25600
s_add_u32 s24, s25, 46080
buffer_load_dwordx4 v2, s[20:23], s24 offen lds
s_add_u32 s25, s25, s50
s_add_u32 m0, s26, 26624
s_add_u32 s24, s25, 36864
buffer_load_dwordx4 v2, s[20:23], s24 offen lds
s_add_u32 m0, s26, 27648
s_add_u32 s24, s25, 46080
buffer_load_dwordx4 v2, s[20:23], s24 offen lds
s_waitcnt vmcnt(28)
ds_read_b64_tr_b16 a[112:113], v8 offset:28672
ds_read_b64_tr_b16 a[114:115], v8 offset:29696
ds_read_b64_tr_b16 a[116:117], v9 offset:28672
ds_read_b64_tr_b16 a[118:119], v9 offset:29696
ds_read_b64_tr_b16 a[120:121], v10 offset:28672
ds_read_b64_tr_b16 a[122:123], v10 offset:29696
ds_read_b64_tr_b16 a[124:125], v11 offset:28672
ds_read_b64_tr_b16 a[126:127], v11 offset:29696
s_waitcnt lgkmcnt(0)
s_mul_i32 s25, s37, 36
s_add_u32 m0, s26, 28672
s_add_u32 s24, s25, 73728
buffer_load_dwordx4 v2, s[20:23], s24 offen lds
s_add_u32 m0, s26, 29696
s_add_u32 s24, s25, 82944
buffer_load_dwordx4 v2, s[20:23], s24 offen lds
s_add_u32 s25, s25, s50
s_add_u32 m0, s26, 30720
s_add_u32 s24, s25, 73728
buffer_load_dwordx4 v2, s[20:23], s24 offen lds
s_add_u32 m0, s26, 31744
s_add_u32 s24, s25, 82944
buffer_load_dwordx4 v2, s[20:23], s24 offen lds
s_waitcnt vmcnt(28)
ds_read_b64_tr_b16 a[128:129], v8
ds_read_b64_tr_b16 a[130:131], v8 offset:1024
ds_read_b64_tr_b16 a[132:133], v9
ds_read_b64_tr_b16 a[134:135], v9 offset:1024
ds_read_b64_tr_b16 a[136:137], v10
ds_read_b64_tr_b16 a[138:139], v10 offset:1024
ds_read_b64_tr_b16 a[140:141], v11
ds_read_b64_tr_b16 a[142:143], v11 offset:1024
s_waitcnt lgkmcnt(0)
s_mul_i32 s25, s30, 36
s_add_u32 m0, s26, 0
s_add_u32 s24, s25, 110592
buffer_load_dwordx4 v2, s[20:23], s24 offen lds
s_add_u32 m0, s26, 1024
s_add_u32 s24, s25, 119808
buffer_load_dwordx4 v2, s[20:23], s24 offen lds
s_add_u32 s25, s25, s50
s_add_u32 m0, s26, 2048
s_add_u32 s24, s25, 110592
buffer_load_dwordx4 v2, s[20:23], s24 offen lds
s_add_u32 m0, s26, 3072
s_add_u32 s24, s25, 119808
buffer_load_dwordx4 v2, s[20:23], s24 offen lds
s_waitcnt vmcnt(28)
ds_read_b64_tr_b16 a[144:145], v8 offset:4096
ds_read_b64_tr_b16 a[146:147], v8 offset:5120
ds_read_b64_tr_b16 a[148:149], v9 offset:4096
ds_read_b64_tr_b16 a[150:151], v9 offset:5120
ds_read_b64_tr_b16 a[152:153], v10 offset:4096
ds_read_b64_tr_b16 a[154:155], v10 offset:5120
ds_read_b64_tr_b16 a[156:157], v11 offset:4096
ds_read_b64_tr_b16 a[158:159], v11 offset:5120
s_waitcnt lgkmcnt(0)
s_mul_i32 s25, s31, 36
s_add_u32 m0, s26, 4096
s_add_u32 s24, s25, 110592
buffer_load_dwordx4 v2, s[20:23], s24 offen lds
s_add_u32 m0, s26, 5120
s_add_u32 s24, s25, 119808
buffer_load_dwordx4 v2, s[20:23], s24 offen lds
s_add_u32 s25, s25, s50
s_add_u32 m0, s26, 6144
s_add_u32 s24, s25, 110592
buffer_load_dwordx4 v2, s[20:23], s24 offen lds
s_add_u32 m0, s26, 7168
s_add_u32 s24, s25, 119808
buffer_load_dwordx4 v2, s[20:23], s24 offen lds
s_waitcnt vmcnt(28)
ds_read_b64_tr_b16 a[160:161], v8 offset:8192
ds_read_b64_tr_b16 a[162:163], v8 offset:9216
ds_read_b64_tr_b16 a[164:165], v9 offset:8192
ds_read_b64_tr_b16 a[166:167], v9 offset:9216
ds_read_b64_tr_b16 a[168:169], v10 offset:8192
ds_read_b64_tr_b16 a[170:171], v10 offset:9216
ds_read_b64_tr_b16 a[172:173], v11 offset:8192
ds_read_b64_tr_b16 a[174:175], v11 offset:9216
s_waitcnt lgkmcnt(0)
s_mul_i32 s25, s32, 36
s_add_u32 m0, s26, 8192
s_add_u32 s24, s25, 110592
buffer_load_dwordx4 v2, s[20:23], s24 offen lds
s_add_u32 m0, s26, 9216
s_add_u32 s24, s25, 119808
buffer_load_dwordx4 v2, s[20:23], s24 offen lds
s_add_u32 s25, s25, s50
s_add_u32 m0, s26, 10240
s_add_u32 s24, s25, 110592
buffer_load_dwordx4 v2, s[20:23], s24 offen lds
s_add_u32 m0, s26, 11264
s_add_u32 s24, s25, 119808
buffer_load_dwordx4 v2, s[20:23], s24 offen lds
s_waitcnt vmcnt(28)
ds_read_b64_tr_b16 a[176:177], v8 offset:12288
ds_read_b64_tr_b16 a[178:179], v8 offset:13312
ds_read_b64_tr_b16 a[180:181], v9 offset:12288
ds_read_b64_tr_b16 a[182:183], v9 offset:13312
ds_read_b64_tr_b16 a[184:185], v10 offset:12288
ds_read_b64_tr_b16 a[186:187], v10 offset:13312
ds_read_b64_tr_b16 a[188:189], v11 offset:12288
ds_read_b64_tr_b16 a[190:191], v11 offset:13312
s_waitcnt lgkmcnt(0)
s_mul_i32 s25, s33, 36
s_add_u32 m0, s26, 12288
s_add_u32 s24, s25, 110592
buffer_load_dwordx4 v2, s[20:23], s24 offen lds
s_add_u32 m0, s26, 13312
s_add_u32 s24, s25, 119808
buffer_load_dwordx4 v2, s[20:23], s24 offen lds
s_add_u32 s25, s25, s50
s_add_u32 m0, s26, 14336
s_add_u32 s24, s25, 110592
buffer_load_dwordx4 v2, s[20:23], s24 offen lds
s_add_u32 m0, s26, 15360
s_add_u32 s24, s25, 119808
buffer_load_dwordx4 v2, s[20:23], s24 offen lds
s_waitcnt vmcnt(28)
ds_read_b64_tr_b16 a[192:193], v8 offset:16384
ds_read_b64_tr_b16 a[194:195], v8 offset:17408
ds_read_b64_tr_b16 a[196:197], v9 offset:16384
ds_read_b64_tr_b16 a[198:199], v9 offset:17408
ds_read_b64_tr_b16 a[200:201], v10 offset:16384
ds_read_b64_tr_b16 a[202:203], v10 offset:17408
ds_read_b64_tr_b16 a[204:205], v11 offset:16384
ds_read_b64_tr_b16 a[206:207], v11 offset:17408
s_waitcnt lgkmcnt(0)
s_mul_i32 s25, s34, 36
s_add_u32 m0, s26, 16384
s_add_u32 s24, s25, 110592
buffer_load_dwordx4 v2, s[20:23], s24 offen lds
s_add_u32 m0, s26, 17408
s_add_u32 s24, s25, 119808
buffer_load_dwordx4 v2, s[20:23], s24 offen lds
s_add_u32 s25, s25, s50
s_add_u32 m0, s26, 18432
s_add_u32 s24, s25, 110592
buffer_load_dwordx4 v2, s[20:23], s24 offen lds
s_add_u32 m0, s26, 19456
s_add_u32 s24, s25, 119808
buffer_load_dwordx4 v2, s[20:23], s24 offen lds
s_waitcnt vmcnt(28)
ds_read_b64_tr_b16 a[208:209], v8 offset:20480
ds_read_b64_tr_b16 a[210:211], v8 offset:21504
ds_read_b64_tr_b16 a[212:213], v9 offset:20480
ds_read_b64_tr_b16 a[214:215], v9 offset:21504
ds_read_b64_tr_b16 a[216:217], v10 offset:20480
ds_read_b64_tr_b16 a[218:219], v10 offset:21504
ds_read_b64_tr_b16 a[220:221], v11 offset:20480
ds_read_b64_tr_b16 a[222:223], v11 offset:21504
s_waitcnt lgkmcnt(0)
s_mul_i32 s25, s35, 36
s_add_u32 m0, s26, 20480
s_add_u32 s24, s25, 110592
buffer_load_dwordx4 v2, s[20:23], s24 offen lds
s_add_u32 m0, s26, 21504
s_add_u32 s24, s25, 119808
buffer_load_dwordx4 v2, s[20:23], s24 offen lds
s_add_u32 s25, s25, s50
s_add_u32 m0, s26, 22528
s_add_u32 s24, s25, 110592
buffer_load_dwordx4 v2, s[20:23], s24 offen lds
s_add_u32 m0, s26, 23552
s_add_u32 s24, s25, 119808
buffer_load_dwordx4 v2, s[20:23], s24 offen lds
s_waitcnt vmcnt(28)
ds_read_b64_tr_b16 a[224:225], v8 offset:24576
ds_read_b64_tr_b16 a[226:227], v8 offset:25600
ds_read_b64_tr_b16 a[228:229], v9 offset:24576
ds_read_b64_tr_b16 a[230:231], v9 offset:25600
ds_read_b64_tr_b16 a[232:233], v10 offset:24576
ds_read_b64_tr_b16 a[234:235], v10 offset:25600
ds_read_b64_tr_b16 a[236:237], v11 offset:24576
ds_read_b64_tr_b16 a[238:239], v11 offset:25600
s_waitcnt lgkmcnt(0)
s_mul_i32 s25, s36, 36
s_add_u32 m0, s26, 24576
s_add_u32 s24, s25, 110592
buffer_load_dwordx4 v2, s[20:23], s24 offen lds
s_add_u32 m0, s26, 25600
s_add_u32 s24, s25, 119808
buffer_load_dwordx4 v2, s[20:23], s24 offen lds
s_add_u32 s25, s25, s50
s_add_u32 m0, s26, 26624
s_add_u32 s24, s25, 110592
buffer_load_dwordx4 v2, s[20:23], s24 offen lds
s_add_u32 m0, s26, 27648
s_add_u32 s24, s25, 119808
buffer_load_dwordx4 v2, s[20:23], s24 offen lds
s_waitcnt vmcnt(28)
ds_read_b64_tr_b16 a[240:241], v8 offset:28672
ds_read_b64_tr_b16 a[242:243], v8 offset:29696
ds_read_b64_tr_b16 a[244:245], v9 offset:28672
ds_read_b64_tr_b16 a[246:247], v9 offset:29696
ds_read_b64_tr_b16 a[248:249], v10 offset:28672
ds_read_b64_tr_b16 a[250:251], v10 offset:29696
ds_read_b64_tr_b16 a[252:253], v11 offset:28672
ds_read_b64_tr_b16 a[254:255], v11 offset:29696
s_waitcnt lgkmcnt(0)
s_mul_i32 s25, s37, 36
s_add_u32 m0, s26, 28672
s_add_u32 s24, s25, 110592
buffer_load_dwordx4 v2, s[20:23], s24 offen lds
s_add_u32 m0, s26, 29696
s_add_u32 s24, s25, 119808
buffer_load_dwordx4 v2, s[20:23], s24 offen lds
s_add_u32 s25, s25, s50
s_add_u32 m0, s26, 30720
s_add_u32 s24, s25, 110592
buffer_load_dwordx4 v2, s[20:23], s24 offen lds
s_add_u32 m0, s26, 31744
s_add_u32 s24, s25, 119808
buffer_load_dwordx4 v2, s[20:23], s24 offen lds
s_waitcnt vmcnt(0)
v_and_b32 v12, 15, v0
v_mul_u32_u24 v12, 2304, v12
v_lshrrev_b32 v13, 4, v0
v_lshl_add_u32 v12, v13, 3, v12
s_lshl_b32 s24, s40, 7
s_add_u32 s24, s24, s47
v_add_u32 v4, s24, v12
v_and_b32 v5, 7, v0
v_lshlrev_b32 v5, 2, v5
s_lshl_b32 s24, s17, 5
v_add_u32 v5, s24, v5
v_lshlrev_b32 v3, 4, v0
v_add_u32 v3, 131072, v3
s_lshl_b32 s24, s17, 12
s_add_u32 s24, s24, 131072
v_add_u32 v7, s24, v1
s_lshl_b32 s24, s17, 15
s_add_u32 s44, s44, s24
s_ff1_i32_b64 s41, s[42:43]
s_bitset0_b64 s[42:43], s41
s_lshl_b32 s41, s41, 1
s_xor_b32 s41, s41, s51
s_and_b32 s41, s41, 127
v_mov_b32 v14, 0
v_mov_b32 v15, 0
L_opl_w:
s_lshr_b32 s25, s41, s46
s_lshl_b32 s25, s25, 7
s_add_u32 s25, s25, s45
s_mov_b32 s28, 0
L_poll_56:
buffer_load_dword v6, v5, s[8:11], s25 offen sc1
s_add_u32 s28, s28, 1
s_cmp_gt_u32 s28, 200000
s_cbranch_scc1 L_end
s_waitcnt vmcnt(0)
v_cmp_ne_u32 vcc, 1, v6
s_cbranch_vccz L_pd_57
s_sleep 1
s_cmp_lt_u32 s28, 32
s_cbranch_scc1 L_poll_56
s_sleep 32
s_branch L_poll_56
L_pd_57:
s_lshl_b32 s48, s41, 17
s_add_u32 s48, s48, s44
s_add_u32 s24, s48, s30
buffer_load_dwordx4 v[16:19], v1, s[8:11], s24 offen sc1
buffer_load_dwordx4 v[20:23], v1, s[8:11], s24 offen offset:1024 sc1
buffer_load_dwordx4 v[24:27], v1, s[8:11], s24 offen offset:2048 sc1
buffer_load_dwordx4 v[28:31], v1, s[8:11], s24 offen offset:3072 sc1
s_add_u32 s24, s48, s31
buffer_load_dwordx4 v[32:35], v1, s[8:11], s24 offen sc1
buffer_load_dwordx4 v[36:39], v1, s[8:11], s24 offen offset:1024 sc1
buffer_load_dwordx4 v[40:43], v1, s[8:11], s24 offen offset:2048 sc1
buffer_load_dwordx4 v[44:47], v1, s[8:11], s24 offen offset:3072 sc1
s_add_u32 s24, s48, s32
buffer_load_dwordx4 v[48:51], v1, s[8:11], s24 offen sc1
buffer_load_dwordx4 v[52:55], v1, s[8:11], s24 offen offset:1024 sc1
buffer_load_dwordx4 v[56:59], v1, s[8:11], s24 offen offset:2048 sc1
buffer_load_dwordx4 v[60:63], v1, s[8:11], s24 offen offset:3072 sc1
s_add_u32 s24, s48, s33
buffer_load_dwordx4 v[64:67], v1, s[8:11], s24 offen sc1
buffer_load_dwordx4 v[68:71], v1, s[8:11], s24 offen offset:1024 sc1
buffer_load_dwordx4 v[72:75], v1, s[8:11], s24 offen offset:2048 sc1
buffer_load_dwordx4 v[76:79], v1, s[8:11], s24 offen offset:3072 sc1
s_waitcnt vmcnt(15)
v_mfma_f32_16x16x32_bf16 v[80:83], v[128:131], v[16:19], 0
s_cmp_lg_u64 s[42:43], 0
s_cselect_b32 s52, 1, 0
ds_read_b64_tr_b16 v[112:113], v8
v_mfma_f32_16x16x32_bf16 v[84:87], v[132:135], v[16:19], 0
s_ff1_i32_b64 s27, s[42:43]
ds_read_b64_tr_b16 v[114:115], v8 offset:1024
v_mfma_f32_16x16x32_bf16 v[88:91], v[136:139], v[16:19], 0
s_bitset0_b64 s[42:43], s27
s_add_u32 s24, s48, s34
ds_read_b64_tr_b16 v[116:117], v9
v_mfma_f32_16x16x32_bf16 v[92:95], v[140:143], v[16:19], 0
s_waitcnt vmcnt(14)
s_lshl_b32 s27, s27, 1
ds_read_b64_tr_b16 v[118:119], v9 offset:1024
buffer_load_dwordx4 v[16:19], v1, s[8:11], s24 offen sc1
v_mfma_f32_16x16x32_bf16 v[80:83], v[144:147], v[20:23], v[80:83]
s_xor_b32 s27, s27, s51
ds_read_b64_tr_b16 v[120:121], v10
v_mfma_f32_16x16x32_bf16 v[84:87], v[148:151], v[20:23], v[84:87]
s_and_b32 s27, s27, 127
ds_read_b64_tr_b16 v[122:123], v10 offset:1024
v_mfma_f32_16x16x32_bf16 v[88:91], v[152:155], v[20:23], v[88:91]
s_lshr_b32 s25, s27, s46
ds_read_b64_tr_b16 v[124:125], v11
v_mfma_f32_16x16x32_bf16 v[92:95], v[156:159], v[20:23], v[92:95]
s_waitcnt vmcnt(14)
s_lshl_b32 s25, s25, 7
ds_read_b64_tr_b16 v[126:127], v11 offset:1024
buffer_load_dwordx4 v[20:23], v1, s[8:11], s24 offen offset:1024 sc1
v_mfma_f32_16x16x32_bf16 v[80:83], v[160:163], v[24:27], v[80:83]
s_add_u32 s25, s25, s45
v_mfma_f32_16x16x32_bf16 v[84:87], v[164:167], v[24:27], v[84:87]
s_lshl_b32 s49, s27, 17
v_mfma_f32_16x16x32_bf16 v[88:91], v[168:171], v[24:27], v[88:91]
s_add_u32 s49, s49, s44
v_mfma_f32_16x16x32_bf16 v[92:95], v[172:175], v[24:27], v[92:95]
s_waitcnt vmcnt(14) lgkmcnt(0)
buffer_load_dwordx4 v[24:27], v1, s[8:11], s24 offen offset:2048 sc1
buffer_load_dword v6, v5, s[8:11], s25 offen sc1
v_mfma_f32_16x16x32_bf16 v[80:83], v[112:115], v[28:31], v[80:83]
v_mfma_f32_16x16x32_bf16 v[84:87], v[116:119], v[28:31], v[84:87]
v_mfma_f32_16x16x32_bf16 v[88:91], v[120:123], v[28:31], v[88:91]
v_mfma_f32_16x16x32_bf16 v[92:95], v[124:127], v[28:31], v[92:95]
s_waitcnt vmcnt(15)
buffer_load_dwordx4 v[28:31], v1, s[8:11], s24 offen offset:3072 sc1
v_mfma_f32_16x16x32_bf16 v[80:83], v[176:179], v[32:35], v[80:83]
ds_read_b64_tr_b16 v[112:113], v8 offset:4096
v_mfma_f32_16x16x32_bf16 v[84:87], v[180:183], v[32:35], v[84:87]
ds_read_b64_tr_b16 v[114:115], v8 offset:5120
v_mfma_f32_16x16x32_bf16 v[88:91], v[184:187], v[32:35], v[88:91]
s_add_u32 s24, s48, s35
ds_read_b64_tr_b16 v[116:117], v9 offset:4096
v_mfma_f32_16x16x32_bf16 v[92:95], v[188:191], v[32:35], v[92:95]
s_waitcnt vmcnt(15)
ds_read_b64_tr_b16 v[118:119], v9 offset:5120
buffer_load_dwordx4 v[32:35], v1, s[8:11], s24 offen sc1
v_mfma_f32_16x16x32_bf16 v[80:83], v[192:195], v[36:39], v[80:83]
ds_read_b64_tr_b16 v[120:121], v10 offset:4096
v_mfma_f32_16x16x32_bf16 v[84:87], v[196:199], v[36:39], v[84:87]
ds_read_b64_tr_b16 v[122:123], v10 offset:5120
v_mfma_f32_16x16x32_bf16 v[88:91], v[200:203], v[36:39], v[88:91]
ds_read_b64_tr_b16 v[124:125], v11 offset:4096
v_mfma_f32_16x16x32_bf16 v[92:95], v[204:207], v[36:39], v[92:95]
s_waitcnt vmcnt(15)
ds_read_b64_tr_b16 v[126:127], v11 offset:5120
buffer_load_dwordx4 v[36:39], v1, s[8:11], s24 offen offset:1024 sc1
v_mfma_f32_16x16x32_bf16 v[80:83], v[208:211], v[40:43], v[80:83]
v_mfma_f32_16x16x32_bf16 v[84:87], v[212:215], v[40:43], v[84:87]
v_mfma_f32_16x16x32_bf16 v[88:91], v[216:219], v[40:43], v[88:91]
v_mfma_f32_16x16x32_bf16 v[92:95], v[220:223], v[40:43], v[92:95]
s_waitcnt vmcnt(15) lgkmcnt(0)
buffer_load_dwordx4 v[40:43], v1, s[8:11], s24 offen offset:2048 sc1
v_mfma_f32_16x16x32_bf16 v[80:83], v[112:115], v[44:47], v[80:83]
v_mfma_f32_16x16x32_bf16 v[84:87], v[116:119], v[44:47], v[84:87]
v_mfma_f32_16x16x32_bf16 v[88:91], v[120:123], v[44:47], v[88:91]
v_mfma_f32_16x16x32_bf16 v[92:95], v[124:127], v[44:47], v[92:95]
s_waitcnt vmcnt(15)
buffer_load_dwordx4 v[44:47], v1, s[8:11], s24 offen offset:3072 sc1
v_mfma_f32_16x16x32_bf16 v[80:83], v[224:227], v[48:51], v[80:83]
ds_read_b64_tr_b16 v[112:113], v8 offset:8192
v_mfma_f32_16x16x32_bf16 v[84:87], v[228:231], v[48:51], v[84:87]
ds_read_b64_tr_b16 v[114:115], v8 offset:9216
v_mfma_f32_16x16x32_bf16 v[88:91], v[232:235], v[48:51], v[88:91]
s_add_u32 s24, s48, s36
ds_read_b64_tr_b16 v[116:117], v9 offset:8192
v_mfma_f32_16x16x32_bf16 v[92:95], v[236:239], v[48:51], v[92:95]
s_waitcnt vmcnt(15)
ds_read_b64_tr_b16 v[118:119], v9 offset:9216
buffer_load_dwordx4 v[48:51], v1, s[8:11], s24 offen sc1
v_mfma_f32_16x16x32_bf16 v[80:83], v[240:243], v[52:55], v[80:83]
ds_read_b64_tr_b16 v[120:121], v10 offset:8192
v_mfma_f32_16x16x32_bf16 v[84:87], v[244:247], v[52:55], v[84:87]
ds_read_b64_tr_b16 v[122:123], v10 offset:9216
v_mfma_f32_16x16x32_bf16 v[88:91], v[248:251], v[52:55], v[88:91]
ds_read_b64_tr_b16 v[124:125], v11 offset:8192
v_mfma_f32_16x16x32_bf16 v[92:95], v[252:255], v[52:55], v[92:95]
s_waitcnt vmcnt(15)
ds_read_b64_tr_b16 v[126:127], v11 offset:9216
buffer_load_dwordx4 v[52:55], v1, s[8:11], s24 offen offset:1024 sc1
v_mfma_f32_16x16x32_bf16 v[80:83], a[0:3], v[56:59], v[80:83]
v_mfma_f32_16x16x32_bf16 v[84:87], a[4:7], v[56:59], v[84:87]
v_mfma_f32_16x16x32_bf16 v[88:91], a[8:11], v[56:59], v[88:91]
v_mfma_f32_16x16x32_bf16 v[92:95], a[12:15], v[56:59], v[92:95]
s_waitcnt vmcnt(15) lgkmcnt(0)
buffer_load_dwordx4 v[56:59], v1, s[8:11], s24 offen offset:2048 sc1
v_mfma_f32_16x16x32_bf16 v[80:83], v[112:115], v[60:63], v[80:83]
v_mfma_f32_16x16x32_bf16 v[84:87], v[116:119], v[60:63], v[84:87]
v_mfma_f32_16x16x32_bf16 v[88:91], v[120:123], v[60:63], v[88:91]
v_mfma_f32_16x16x32_bf16 v[92:95], v[124:127], v[60:63], v[92:95]
s_waitcnt vmcnt(15)
buffer_load_dwordx4 v[60:63], v1, s[8:11], s24 offen offset:3072 sc1
v_mfma_f32_16x16x32_bf16 v[80:83], a[16:19], v[64:67], v[80:83]
ds_read_b64_tr_b16 v[112:113], v8 offset:12288
v_mfma_f32_16x16x32_bf16 v[84:87], a[20:23], v[64:67], v[84:87]
ds_read_b64_tr_b16 v[114:115], v8 offset:13312
v_mfma_f32_16x16x32_bf16 v[88:91], a[24:27], v[64:67], v[88:91]
s_add_u32 s24, s48, s37
ds_read_b64_tr_b16 v[116:117], v9 offset:12288
v_mfma_f32_16x16x32_bf16 v[92:95], a[28:31], v[64:67], v[92:95]
s_waitcnt vmcnt(15)
ds_read_b64_tr_b16 v[118:119], v9 offset:13312
buffer_load_dwordx4 v[64:67], v1, s[8:11], s24 offen sc1
v_mfma_f32_16x16x32_bf16 v[80:83], a[32:35], v[68:71], v[80:83]
ds_read_b64_tr_b16 v[120:121], v10 offset:12288
v_mfma_f32_16x16x32_bf16 v[84:87], a[36:39], v[68:71], v[84:87]
ds_read_b64_tr_b16 v[122:123], v10 offset:13312
v_mfma_f32_16x16x32_bf16 v[88:91], a[40:43], v[68:71], v[88:91]
ds_read_b64_tr_b16 v[124:125], v11 offset:12288
v_mfma_f32_16x16x32_bf16 v[92:95], a[44:47], v[68:71], v[92:95]
s_waitcnt vmcnt(15)
ds_read_b64_tr_b16 v[126:127], v11 offset:13312
buffer_load_dwordx4 v[68:71], v1, s[8:11], s24 offen offset:1024 sc1
buffer_load_dword v6, v5, s[8:11], s25 offen sc1
s_branch L_opl_t0
L_opl_r0:
v_mfma_f32_16x16x32_bf16 v[80:83], v[128:131], v[16:19], 0
s_cmp_lg_u64 s[42:43], 0
s_cselect_b32 s52, 1, 0
ds_read_b64_tr_b16 v[112:113], v8
v_mfma_f32_16x16x32_bf16 v[84:87], v[132:135], v[16:19], 0
s_ff1_i32_b64 s27, s[42:43]
ds_read_b64_tr_b16 v[114:115], v8 offset:1024
v_mfma_f32_16x16x32_bf16 v[88:91], v[136:139], v[16:19], 0
s_bitset0_b64 s[42:43], s27
s_add_u32 s24, s48, s34
ds_read_b64_tr_b16 v[116:117], v9
v_mfma_f32_16x16x32_bf16 v[92:95], v[140:143], v[16:19], 0
s_waitcnt vmcnt(14)
s_lshl_b32 s27, s27, 1
ds_read_b64_tr_b16 v[118:119], v9 offset:1024
buffer_load_dwordx4 v[16:19], v1, s[8:11], s24 offen sc1
v_mfma_f32_16x16x32_bf16 v[80:83], v[144:147], v[20:23], v[80:83]
s_xor_b32 s27, s27, s51
ds_read_b64_tr_b16 v[120:121], v10
v_mfma_f32_16x16x32_bf16 v[84:87], v[148:151], v[20:23], v[84:87]
s_and_b32 s27, s27, 127
ds_read_b64_tr_b16 v[122:123], v10 offset:1024
v_mfma_f32_16x16x32_bf16 v[88:91], v[152:155], v[20:23], v[88:91]
s_lshr_b32 s25, s27, s46
ds_read_b64_tr_b16 v[124:125], v11
v_mfma_f32_16x16x32_bf16 v[92:95], v[156:159], v[20:23], v[92:95]
s_waitcnt vmcnt(14)
s_lshl_b32 s25, s25, 7
ds_read_b64_tr_b16 v[126:127], v11 offset:1024
buffer_load_dwordx4 v[20:23], v1, s[8:11], s24 offen offset:1024 sc1
v_mfma_f32_16x16x32_bf16 v[80:83], v[160:163], v[24:27], v[80:83]
s_add_u32 s25, s25, s45
v_mfma_f32_16x16x32_bf16 v[84:87], v[164:167], v[24:27], v[84:87]
s_lshl_b32 s49, s27, 17
v_mfma_f32_16x16x32_bf16 v[88:91], v[168:171], v[24:27], v[88:91]
s_add_u32 s49, s49, s44
v_mfma_f32_16x16x32_bf16 v[92:95], v[172:175], v[24:27], v[92:95]
s_waitcnt vmcnt(14) lgkmcnt(0)
buffer_load_dwordx4 v[24:27], v1, s[8:11], s24 offen offset:2048 sc1
buffer_load_dword v6, v5, s[8:11], s25 offen sc1
v_mfma_f32_16x16x32_bf16 v[80:83], v[112:115], v[28:31], v[80:83]
ds_write_b128 v3, v[96:99]
v_mfma_f32_16x16x32_bf16 v[84:87], v[116:119], v[28:31], v[84:87]
ds_write_b128 v3, v[100:103] offset:4096
v_mfma_f32_16x16x32_bf16 v[88:91], v[120:123], v[28:31], v[88:91]
ds_write_b128 v3, v[104:107] offset:8192
v_mfma_f32_16x16x32_bf16 v[92:95], v[124:127], v[28:31], v[92:95]
s_waitcnt vmcnt(15)
ds_write_b128 v3, v[108:111] offset:12288
buffer_load_dwordx4 v[28:31], v1, s[8:11], s24 offen offset:3072 sc1
v_mfma_f32_16x16x32_bf16 v[80:83], v[176:179], v[32:35], v[80:83]
ds_read_b64_tr_b16 v[112:113], v8 offset:4096
v_mfma_f32_16x16x32_bf16 v[84:87], v[180:183], v[32:35], v[84:87]
ds_read_b64_tr_b16 v[114:115], v8 offset:5120
v_mfma_f32_16x16x32_bf16 v[88:91], v[184:187], v[32:35], v[88:91]
s_add_u32 s24, s48, s35
ds_read_b64_tr_b16 v[116:117], v9 offset:4096
v_mfma_f32_16x16x32_bf16 v[92:95], v[188:191], v[32:35], v[92:95]
s_waitcnt vmcnt(15)
ds_read_b64_tr_b16 v[118:119], v9 offset:5120
buffer_load_dwordx4 v[32:35], v1, s[8:11], s24 offen sc1
v_mfma_f32_16x16x32_bf16 v[80:83], v[192:195], v[36:39], v[80:83]
ds_read_b64_tr_b16 v[120:121], v10 offset:4096
v_mfma_f32_16x16x32_bf16 v[84:87], v[196:199], v[36:39], v[84:87]
ds_read_b64_tr_b16 v[122:123], v10 offset:5120
v_mfma_f32_16x16x32_bf16 v[88:91], v[200:203], v[36:39], v[88:91]
ds_read_b64_tr_b16 v[124:125], v11 offset:4096
v_mfma_f32_16x16x32_bf16 v[92:95], v[204:207], v[36:39], v[92:95]
s_waitcnt vmcnt(15)
ds_read_b64_tr_b16 v[126:127], v11 offset:5120
buffer_load_dwordx4 v[36:39], v1, s[8:11], s24 offen offset:1024 sc1
v_mfma_f32_16x16x32_bf16 v[80:83], v[208:211], v[40:43], v[80:83]
v_mfma_f32_16x16x32_bf16 v[84:87], v[212:215], v[40:43], v[84:87]
v_mfma_f32_16x16x32_bf16 v[88:91], v[216:219], v[40:43], v[88:91]
v_mfma_f32_16x16x32_bf16 v[92:95], v[220:223], v[40:43], v[92:95]
s_waitcnt vmcnt(15) lgkmcnt(0)
buffer_load_dwordx4 v[40:43], v1, s[8:11], s24 offen offset:2048 sc1
s_barrier
v_mfma_f32_16x16x32_bf16 v[80:83], v[112:115], v[44:47], v[80:83]
ds_read_b128 v[96:99], v7
v_mfma_f32_16x16x32_bf16 v[84:87], v[116:119], v[44:47], v[84:87]
ds_read_b128 v[100:103], v7 offset:1024
v_mfma_f32_16x16x32_bf16 v[88:91], v[120:123], v[44:47], v[88:91]
ds_read_b128 v[104:107], v7 offset:2048
v_mfma_f32_16x16x32_bf16 v[92:95], v[124:127], v[44:47], v[92:95]
s_waitcnt vmcnt(15)
ds_read_b128 v[108:111], v7 offset:3072
buffer_load_dwordx4 v[44:47], v1, s[8:11], s24 offen offset:3072 sc1
v_mfma_f32_16x16x32_bf16 v[80:83], v[224:227], v[48:51], v[80:83]
ds_read_b64_tr_b16 v[112:113], v8 offset:8192
v_mfma_f32_16x16x32_bf16 v[84:87], v[228:231], v[48:51], v[84:87]
ds_read_b64_tr_b16 v[114:115], v8 offset:9216
v_mfma_f32_16x16x32_bf16 v[88:91], v[232:235], v[48:51], v[88:91]
s_add_u32 s24, s48, s36
ds_read_b64_tr_b16 v[116:117], v9 offset:8192
v_mfma_f32_16x16x32_bf16 v[92:95], v[236:239], v[48:51], v[92:95]
s_waitcnt vmcnt(15)
ds_read_b64_tr_b16 v[118:119], v9 offset:9216
buffer_load_dwordx4 v[48:51], v1, s[8:11], s24 offen sc1
v_mfma_f32_16x16x32_bf16 v[80:83], v[240:243], v[52:55], v[80:83]
ds_read_b64_tr_b16 v[120:121], v10 offset:8192
v_mfma_f32_16x16x32_bf16 v[84:87], v[244:247], v[52:55], v[84:87]
ds_read_b64_tr_b16 v[122:123], v10 offset:9216
v_mfma_f32_16x16x32_bf16 v[88:91], v[248:251], v[52:55], v[88:91]
ds_read_b64_tr_b16 v[124:125], v11 offset:8192
v_mfma_f32_16x16x32_bf16 v[92:95], v[252:255], v[52:55], v[92:95]
s_waitcnt vmcnt(15)
ds_read_b64_tr_b16 v[126:127], v11 offset:9216
buffer_load_dwordx4 v[52:55], v1, s[8:11], s24 offen offset:1024 sc1
v_mfma_f32_16x16x32_bf16 v[80:83], a[0:3], v[56:59], v[80:83]
v_mfma_f32_16x16x32_bf16 v[84:87], a[4:7], v[56:59], v[84:87]
v_mfma_f32_16x16x32_bf16 v[88:91], a[8:11], v[56:59], v[88:91]
v_mfma_f32_16x16x32_bf16 v[92:95], a[12:15], v[56:59], v[92:95]
s_waitcnt vmcnt(15) lgkmcnt(0)
buffer_load_dwordx4 v[56:59], v1, s[8:11], s24 offen offset:2048 sc1
v_mfma_f32_16x16x32_bf16 v[80:83], v[112:115], v[60:63], v[80:83]
v_add_f32 v96, v96, v100
v_add_f32 v97, v97, v101
v_mfma_f32_16x16x32_bf16 v[84:87], v[116:119], v[60:63], v[84:87]
v_add_f32 v98, v98, v102
v_add_f32 v99, v99, v103
v_mfma_f32_16x16x32_bf16 v[88:91], v[120:123], v[60:63], v[88:91]
v_add_f32 v96, v96, v104
v_add_f32 v97, v97, v105
v_mfma_f32_16x16x32_bf16 v[92:95], v[124:127], v[60:63], v[92:95]
s_waitcnt vmcnt(15)
v_add_f32 v98, v98, v106
v_add_f32 v99, v99, v107
buffer_load_dwordx4 v[60:63], v1, s[8:11], s24 offen offset:3072 sc1
v_mfma_f32_16x16x32_bf16 v[80:83], a[16:19], v[64:67], v[80:83]
ds_read_b64_tr_b16 v[112:113], v8 offset:12288
v_add_f32 v96, v96, v108
v_mfma_f32_16x16x32_bf16 v[84:87], a[20:23], v[64:67], v[84:87]
ds_read_b64_tr_b16 v[114:115], v8 offset:13312
v_add_f32 v97, v97, v109
v_mfma_f32_16x16x32_bf16 v[88:91], a[24:27], v[64:67], v[88:91]
s_add_u32 s24, s48, s37
ds_read_b64_tr_b16 v[116:117], v9 offset:12288
v_add_f32 v98, v98, v110
v_mfma_f32_16x16x32_bf16 v[92:95], a[28:31], v[64:67], v[92:95]
s_waitcnt vmcnt(15)
ds_read_b64_tr_b16 v[118:119], v9 offset:13312
v_add_f32 v99, v99, v111
buffer_load_dwordx4 v[64:67], v1, s[8:11], s24 offen sc1
v_mfma_f32_16x16x32_bf16 v[80:83], a[32:35], v[68:71], v[80:83]
ds_read_b64_tr_b16 v[120:121], v10 offset:12288
v_cvt_pk_bf16_f32 v12, v96, v97
v_mfma_f32_16x16x32_bf16 v[84:87], a[36:39], v[68:71], v[84:87]
ds_read_b64_tr_b16 v[122:123], v10 offset:13312
v_cvt_pk_bf16_f32 v13, v98, v99
v_mfma_f32_16x16x32_bf16 v[88:91], a[40:43], v[68:71], v[88:91]
ds_read_b64_tr_b16 v[124:125], v11 offset:12288
v_xor_b32 v3, 16384, v3
v_mfma_f32_16x16x32_bf16 v[92:95], a[44:47], v[68:71], v[92:95]
s_waitcnt vmcnt(15)
ds_read_b64_tr_b16 v[126:127], v11 offset:13312
v_xor_b32 v7, 16384, v7
buffer_load_dwordx4 v[68:71], v1, s[8:11], s24 offen offset:1024 sc1
buffer_store_dwordx2 v[12:13], v4, s[12:15], s53 offen
L_opl_t0:
v_mfma_f32_16x16x32_bf16 v[80:83], a[48:51], v[72:75], v[80:83]
v_mfma_f32_16x16x32_bf16 v[84:87], a[52:55], v[72:75], v[84:87]
v_mfma_f32_16x16x32_bf16 v[88:91], a[56:59], v[72:75], v[88:91]
v_mfma_f32_16x16x32_bf16 v[92:95], a[60:63], v[72:75], v[92:95]
s_waitcnt vmcnt(16) lgkmcnt(0)
buffer_load_dwordx4 v[72:75], v1, s[8:11], s24 offen offset:2048 sc1
v_mfma_f32_16x16x32_bf16 v[80:83], v[112:115], v[76:79], v[80:83]
s_waitcnt vmcnt(13)
v_cmp_ne_u32 vcc, 1, v6
v_mfma_f32_16x16x32_bf16 v[84:87], v[116:119], v[76:79], v[84:87]
v_mfma_f32_16x16x32_bf16 v[88:91], v[120:123], v[76:79], v[88:91]
s_cmp_eq_u64 vcc, 0
s_cselect_b32 s50, s52, 0
v_mfma_f32_16x16x32_bf16 v[92:95], v[124:127], v[76:79], v[92:95]
s_waitcnt vmcnt(16)
buffer_load_dwordx4 v[76:79], v1, s[8:11], s24 offen offset:3072 sc1
v_mfma_f32_16x16x32_bf16 v[80:83], a[64:67], v[16:19], v[80:83]
s_cmp_eq_u32 s50, 1
s_cselect_b32 s49, s49, 536870912
ds_read_b64_tr_b16 v[112:113], v8 offset:16384
v_mfma_f32_16x16x32_bf16 v[84:87], a[68:71], v[16:19], v[84:87]
ds_read_b64_tr_b16 v[114:115], v8 offset:17408
v_mfma_f32_16x16x32_bf16 v[88:91], a[72:75], v[16:19], v[88:91]
s_add_u32 s24, s49, s30
ds_read_b64_tr_b16 v[116:117], v9 offset:16384
v_mfma_f32_16x16x32_bf16 v[92:95], a[76:79], v[16:19], v[92:95]
s_waitcnt vmcnt(16)
ds_read_b64_tr_b16 v[118:119], v9 offset:17408
buffer_load_dwordx4 v[16:19], v1, s[8:11], s24 offen sc1
v_mfma_f32_16x16x32_bf16 v[80:83], a[80:83], v[20:23], v[80:83]
ds_read_b64_tr_b16 v[120:121], v10 offset:16384
v_mfma_f32_16x16x32_bf16 v[84:87], a[84:87], v[20:23], v[84:87]
ds_read_b64_tr_b16 v[122:123], v10 offset:17408
v_mfma_f32_16x16x32_bf16 v[88:91], a[88:91], v[20:23], v[88:91]
ds_read_b64_tr_b16 v[124:125], v11 offset:16384
v_mfma_f32_16x16x32_bf16 v[92:95], a[92:95], v[20:23], v[92:95]
s_waitcnt vmcnt(16)
ds_read_b64_tr_b16 v[126:127], v11 offset:17408
buffer_load_dwordx4 v[20:23], v1, s[8:11], s24 offen offset:1024 sc1
v_mfma_f32_16x16x32_bf16 v[80:83], a[96:99], v[24:27], v[80:83]
v_mfma_f32_16x16x32_bf16 v[84:87], a[100:103], v[24:27], v[84:87]
v_mfma_f32_16x16x32_bf16 v[88:91], a[104:107], v[24:27], v[88:91]
v_mfma_f32_16x16x32_bf16 v[92:95], a[108:111], v[24:27], v[92:95]
s_waitcnt vmcnt(15) lgkmcnt(0)
buffer_load_dwordx4 v[24:27], v1, s[8:11], s24 offen offset:2048 sc1
v_mfma_f32_16x16x32_bf16 v[80:83], v[112:115], v[28:31], v[80:83]
v_mfma_f32_16x16x32_bf16 v[84:87], v[116:119], v[28:31], v[84:87]
v_mfma_f32_16x16x32_bf16 v[88:91], v[120:123], v[28:31], v[88:91]
v_mfma_f32_16x16x32_bf16 v[92:95], v[124:127], v[28:31], v[92:95]
s_waitcnt vmcnt(15)
buffer_load_dwordx4 v[28:31], v1, s[8:11], s24 offen offset:3072 sc1
v_mfma_f32_16x16x32_bf16 v[80:83], a[112:115], v[32:35], v[80:83]
ds_read_b64_tr_b16 v[112:113], v8 offset:20480
v_mfma_f32_16x16x32_bf16 v[84:87], a[116:119], v[32:35], v[84:87]
ds_read_b64_tr_b16 v[114:115], v8 offset:21504
v_mfma_f32_16x16x32_bf16 v[88:91], a[120:123], v[32:35], v[88:91]
s_add_u32 s24, s49, s31
ds_read_b64_tr_b16 v[116:117], v9 offset:20480
v_mfma_f32_16x16x32_bf16 v[92:95], a[124:127], v[32:35], v[92:95]
s_waitcnt vmcnt(15)
ds_read_b64_tr_b16 v[118:119], v9 offset:21504
buffer_load_dwordx4 v[32:35], v1, s[8:11], s24 offen sc1
v_mfma_f32_16x16x32_bf16 v[80:83], a[128:131], v[36:39], v[80:83]
ds_read_b64_tr_b16 v[120:121], v10 offset:20480
v_mfma_f32_16x16x32_bf16 v[84:87], a[132:135], v[36:39], v[84:87]
ds_read_b64_tr_b16 v[122:123], v10 offset:21504
v_mfma_f32_16x16x32_bf16 v[88:91], a[136:139], v[36:39], v[88:91]
ds_read_b64_tr_b16 v[124:125], v11 offset:20480
v_mfma_f32_16x16x32_bf16 v[92:95], a[140:143], v[36:39], v[92:95]
s_waitcnt vmcnt(15)
ds_read_b64_tr_b16 v[126:127], v11 offset:21504
buffer_load_dwordx4 v[36:39], v1, s[8:11], s24 offen offset:1024 sc1
v_mfma_f32_16x16x32_bf16 v[80:83], a[144:147], v[40:43], v[80:83]
v_mfma_f32_16x16x32_bf16 v[84:87], a[148:151], v[40:43], v[84:87]
v_mfma_f32_16x16x32_bf16 v[88:91], a[152:155], v[40:43], v[88:91]
v_mfma_f32_16x16x32_bf16 v[92:95], a[156:159], v[40:43], v[92:95]
s_waitcnt vmcnt(15) lgkmcnt(0)
buffer_load_dwordx4 v[40:43], v1, s[8:11], s24 offen offset:2048 sc1
v_mfma_f32_16x16x32_bf16 v[80:83], v[112:115], v[44:47], v[80:83]
v_mfma_f32_16x16x32_bf16 v[84:87], v[116:119], v[44:47], v[84:87]
v_mfma_f32_16x16x32_bf16 v[88:91], v[120:123], v[44:47], v[88:91]
v_mfma_f32_16x16x32_bf16 v[92:95], v[124:127], v[44:47], v[92:95]
s_waitcnt vmcnt(15)
buffer_load_dwordx4 v[44:47], v1, s[8:11], s24 offen offset:3072 sc1
v_mfma_f32_16x16x32_bf16 v[80:83], a[160:163], v[48:51], v[80:83]
ds_read_b64_tr_b16 v[112:113], v8 offset:24576
v_mfma_f32_16x16x32_bf16 v[84:87], a[164:167], v[48:51], v[84:87]
ds_read_b64_tr_b16 v[114:115], v8 offset:25600
v_mfma_f32_16x16x32_bf16 v[88:91], a[168:171], v[48:51], v[88:91]
s_add_u32 s24, s49, s32
ds_read_b64_tr_b16 v[116:117], v9 offset:24576
v_mfma_f32_16x16x32_bf16 v[92:95], a[172:175], v[48:51], v[92:95]
s_waitcnt vmcnt(15)
ds_read_b64_tr_b16 v[118:119], v9 offset:25600
buffer_load_dwordx4 v[48:51], v1, s[8:11], s24 offen sc1
v_mfma_f32_16x16x32_bf16 v[80:83], a[176:179], v[52:55], v[80:83]
ds_read_b64_tr_b16 v[120:121], v10 offset:24576
v_mfma_f32_16x16x32_bf16 v[84:87], a[180:183], v[52:55], v[84:87]
ds_read_b64_tr_b16 v[122:123], v10 offset:25600
v_mfma_f32_16x16x32_bf16 v[88:91], a[184:187], v[52:55], v[88:91]
ds_read_b64_tr_b16 v[124:125], v11 offset:24576
v_mfma_f32_16x16x32_bf16 v[92:95], a[188:191], v[52:55], v[92:95]
s_waitcnt vmcnt(15)
ds_read_b64_tr_b16 v[126:127], v11 offset:25600
buffer_load_dwordx4 v[52:55], v1, s[8:11], s24 offen offset:1024 sc1
v_mfma_f32_16x16x32_bf16 v[80:83], a[192:195], v[56:59], v[80:83]
v_mfma_f32_16x16x32_bf16 v[84:87], a[196:199], v[56:59], v[84:87]
v_mfma_f32_16x16x32_bf16 v[88:91], a[200:203], v[56:59], v[88:91]
v_mfma_f32_16x16x32_bf16 v[92:95], a[204:207], v[56:59], v[92:95]
s_waitcnt vmcnt(15) lgkmcnt(0)
buffer_load_dwordx4 v[56:59], v1, s[8:11], s24 offen offset:2048 sc1
v_mfma_f32_16x16x32_bf16 v[80:83], v[112:115], v[60:63], v[80:83]
v_mfma_f32_16x16x32_bf16 v[84:87], v[116:119], v[60:63], v[84:87]
v_mfma_f32_16x16x32_bf16 v[88:91], v[120:123], v[60:63], v[88:91]
v_mfma_f32_16x16x32_bf16 v[92:95], v[124:127], v[60:63], v[92:95]
s_waitcnt vmcnt(15)
buffer_load_dwordx4 v[60:63], v1, s[8:11], s24 offen offset:3072 sc1
v_mfma_f32_16x16x32_bf16 v[80:83], a[208:211], v[64:67], v[80:83]
ds_read_b64_tr_b16 v[112:113], v8 offset:28672
v_mfma_f32_16x16x32_bf16 v[84:87], a[212:215], v[64:67], v[84:87]
ds_read_b64_tr_b16 v[114:115], v8 offset:29696
v_mfma_f32_16x16x32_bf16 v[88:91], a[216:219], v[64:67], v[88:91]
s_add_u32 s24, s49, s33
ds_read_b64_tr_b16 v[116:117], v9 offset:28672
v_mfma_f32_16x16x32_bf16 v[92:95], a[220:223], v[64:67], v[92:95]
s_waitcnt vmcnt(15)
ds_read_b64_tr_b16 v[118:119], v9 offset:29696
buffer_load_dwordx4 v[64:67], v1, s[8:11], s24 offen sc1
v_mfma_f32_16x16x32_bf16 v[80:83], a[224:227], v[68:71], v[80:83]
ds_read_b64_tr_b16 v[120:121], v10 offset:28672
v_mfma_f32_16x16x32_bf16 v[84:87], a[228:231], v[68:71], v[84:87]
ds_read_b64_tr_b16 v[122:123], v10 offset:29696
v_mfma_f32_16x16x32_bf16 v[88:91], a[232:235], v[68:71], v[88:91]
ds_read_b64_tr_b16 v[124:125], v11 offset:28672
v_mfma_f32_16x16x32_bf16 v[92:95], a[236:239], v[68:71], v[92:95]
s_waitcnt vmcnt(14)
ds_read_b64_tr_b16 v[126:127], v11 offset:29696
buffer_load_dwordx4 v[68:71], v1, s[8:11], s24 offen offset:1024 sc1
v_mfma_f32_16x16x32_bf16 v[80:83], a[240:243], v[72:75], v[80:83]
v_mfma_f32_16x16x32_bf16 v[84:87], a[244:247], v[72:75], v[84:87]
v_mfma_f32_16x16x32_bf16 v[88:91], a[248:251], v[72:75], v[88:91]
v_mfma_f32_16x16x32_bf16 v[92:95], a[252:255], v[72:75], v[92:95]
s_waitcnt vmcnt(14) lgkmcnt(0)
buffer_load_dwordx4 v[72:75], v1, s[8:11], s24 offen offset:2048 sc1
v_mfma_f32_16x16x32_bf16 v[80:83], v[112:115], v[76:79], v[80:83]
v_mfma_f32_16x16x32_bf16 v[84:87], v[116:119], v[76:79], v[84:87]
v_mfma_f32_16x16x32_bf16 v[88:91], v[120:123], v[76:79], v[88:91]
v_mfma_f32_16x16x32_bf16 v[92:95], v[124:127], v[76:79], v[92:95]
s_waitcnt vmcnt(14)
buffer_load_dwordx4 v[76:79], v1, s[8:11], s24 offen offset:3072 sc1
s_mul_i32 s53, s41, 36864
s_mov_b32 s41, s27
s_mov_b32 s48, s49
s_cmp_eq_u32 s50, 0
s_cbranch_scc1 L_opl_c0
L_opl_r1:
v_mfma_f32_16x16x32_bf16 v[96:99], v[128:131], v[16:19], 0
s_cmp_lg_u64 s[42:43], 0
s_cselect_b32 s52, 1, 0
ds_read_b64_tr_b16 v[112:113], v8
v_mfma_f32_16x16x32_bf16 v[100:103], v[132:135], v[16:19], 0
s_ff1_i32_b64 s27, s[42:43]
ds_read_b64_tr_b16 v[114:115], v8 offset:1024
v_mfma_f32_16x16x32_bf16 v[104:107], v[136:139], v[16:19], 0
s_bitset0_b64 s[42:43], s27
s_add_u32 s24, s48, s34
ds_read_b64_tr_b16 v[116:117], v9
v_mfma_f32_16x16x32_bf16 v[108:111], v[140:143], v[16:19], 0
s_waitcnt vmcnt(14)
s_lshl_b32 s27, s27, 1
ds_read_b64_tr_b16 v[118:119], v9 offset:1024
buffer_load_dwordx4 v[16:19], v1, s[8:11], s24 offen sc1
v_mfma_f32_16x16x32_bf16 v[96:99], v[144:147], v[20:23], v[96:99]
s_xor_b32 s27, s27, s51
ds_read_b64_tr_b16 v[120:121], v10
v_mfma_f32_16x16x32_bf16 v[100:103], v[148:151], v[20:23], v[100:103]
s_and_b32 s27, s27, 127
ds_read_b64_tr_b16 v[122:123], v10 offset:1024
v_mfma_f32_16x16x32_bf16 v[104:107], v[152:155], v[20:23], v[104:107]
s_lshr_b32 s25, s27, s46
ds_read_b64_tr_b16 v[124:125], v11
v_mfma_f32_16x16x32_bf16 v[108:111], v[156:159], v[20:23], v[108:111]
s_waitcnt vmcnt(14)
s_lshl_b32 s25, s25, 7
ds_read_b64_tr_b16 v[126:127], v11 offset:1024
buffer_load_dwordx4 v[20:23], v1, s[8:11], s24 offen offset:1024 sc1
v_mfma_f32_16x16x32_bf16 v[96:99], v[160:163], v[24:27], v[96:99]
s_add_u32 s25, s25, s45
v_mfma_f32_16x16x32_bf16 v[100:103], v[164:167], v[24:27], v[100:103]
s_lshl_b32 s49, s27, 17
v_mfma_f32_16x16x32_bf16 v[104:107], v[168:171], v[24:27], v[104:107]
s_add_u32 s49, s49, s44
v_mfma_f32_16x16x32_bf16 v[108:111], v[172:175], v[24:27], v[108:111]
s_waitcnt vmcnt(14) lgkmcnt(0)
buffer_load_dwordx4 v[24:27], v1, s[8:11], s24 offen offset:2048 sc1
buffer_load_dword v6, v5, s[8:11], s25 offen sc1
v_mfma_f32_16x16x32_bf16 v[96:99], v[112:115], v[28:31], v[96:99]
ds_write_b128 v3, v[80:83]
v_mfma_f32_16x16x32_bf16 v[100:103], v[116:119], v[28:31], v[100:103]
ds_write_b128 v3, v[84:87] offset:4096
v_mfma_f32_16x16x32_bf16 v[104:107], v[120:123], v[28:31], v[104:107]
ds_write_b128 v3, v[88:91] offset:8192
v_mfma_f32_16x16x32_bf16 v[108:111], v[124:127], v[28:31], v[108:111]
s_waitcnt vmcnt(15)
ds_write_b128 v3, v[92:95] offset:12288
buffer_load_dwordx4 v[28:31], v1, s[8:11], s24 offen offset:3072 sc1
v_mfma_f32_16x16x32_bf16 v[96:99], v[176:179], v[32:35], v[96:99]
ds_read_b64_tr_b16 v[112:113], v8 offset:4096
v_mfma_f32_16x16x32_bf16 v[100:103], v[180:183], v[32:35], v[100:103]
ds_read_b64_tr_b16 v[114:115], v8 offset:5120
v_mfma_f32_16x16x32_bf16 v[104:107], v[184:187], v[32:35], v[104:107]
s_add_u32 s24, s48, s35
ds_read_b64_tr_b16 v[116:117], v9 offset:4096
v_mfma_f32_16x16x32_bf16 v[108:111], v[188:191], v[32:35], v[108:111]
s_waitcnt vmcnt(15)
ds_read_b64_tr_b16 v[118:119], v9 offset:5120
buffer_load_dwordx4 v[32:35], v1, s[8:11], s24 offen sc1
v_mfma_f32_16x16x32_bf16 v[96:99], v[192:195], v[36:39], v[96:99]
ds_read_b64_tr_b16 v[120:121], v10 offset:4096
v_mfma_f32_16x16x32_bf16 v[100:103], v[196:199], v[36:39], v[100:103]
ds_read_b64_tr_b16 v[122:123], v10 offset:5120
v_mfma_f32_16x16x32_bf16 v[104:107], v[200:203], v[36:39], v[104:107]
ds_read_b64_tr_b16 v[124:125], v11 offset:4096
v_mfma_f32_16x16x32_bf16 v[108:111], v[204:207], v[36:39], v[108:111]
s_waitcnt vmcnt(15)
ds_read_b64_tr_b16 v[126:127], v11 offset:5120
buffer_load_dwordx4 v[36:39], v1, s[8:11], s24 offen offset:1024 sc1
v_mfma_f32_16x16x32_bf16 v[96:99], v[208:211], v[40:43], v[96:99]
v_mfma_f32_16x16x32_bf16 v[100:103], v[212:215], v[40:43], v[100:103]
v_mfma_f32_16x16x32_bf16 v[104:107], v[216:219], v[40:43], v[104:107]
v_mfma_f32_16x16x32_bf16 v[108:111], v[220:223], v[40:43], v[108:111]
s_waitcnt vmcnt(15) lgkmcnt(0)
buffer_load_dwordx4 v[40:43], v1, s[8:11], s24 offen offset:2048 sc1
s_barrier
v_mfma_f32_16x16x32_bf16 v[96:99], v[112:115], v[44:47], v[96:99]
ds_read_b128 v[80:83], v7
v_mfma_f32_16x16x32_bf16 v[100:103], v[116:119], v[44:47], v[100:103]
ds_read_b128 v[84:87], v7 offset:1024
v_mfma_f32_16x16x32_bf16 v[104:107], v[120:123], v[44:47], v[104:107]
ds_read_b128 v[88:91], v7 offset:2048
v_mfma_f32_16x16x32_bf16 v[108:111], v[124:127], v[44:47], v[108:111]
s_waitcnt vmcnt(15)
ds_read_b128 v[92:95], v7 offset:3072
buffer_load_dwordx4 v[44:47], v1, s[8:11], s24 offen offset:3072 sc1
v_mfma_f32_16x16x32_bf16 v[96:99], v[224:227], v[48:51], v[96:99]
ds_read_b64_tr_b16 v[112:113], v8 offset:8192
v_mfma_f32_16x16x32_bf16 v[100:103], v[228:231], v[48:51], v[100:103]
ds_read_b64_tr_b16 v[114:115], v8 offset:9216
v_mfma_f32_16x16x32_bf16 v[104:107], v[232:235], v[48:51], v[104:107]
s_add_u32 s24, s48, s36
ds_read_b64_tr_b16 v[116:117], v9 offset:8192
v_mfma_f32_16x16x32_bf16 v[108:111], v[236:239], v[48:51], v[108:111]
s_waitcnt vmcnt(15)
ds_read_b64_tr_b16 v[118:119], v9 offset:9216
buffer_load_dwordx4 v[48:51], v1, s[8:11], s24 offen sc1
v_mfma_f32_16x16x32_bf16 v[96:99], v[240:243], v[52:55], v[96:99]
ds_read_b64_tr_b16 v[120:121], v10 offset:8192
v_mfma_f32_16x16x32_bf16 v[100:103], v[244:247], v[52:55], v[100:103]
ds_read_b64_tr_b16 v[122:123], v10 offset:9216
v_mfma_f32_16x16x32_bf16 v[104:107], v[248:251], v[52:55], v[104:107]
ds_read_b64_tr_b16 v[124:125], v11 offset:8192
v_mfma_f32_16x16x32_bf16 v[108:111], v[252:255], v[52:55], v[108:111]
s_waitcnt vmcnt(15)
ds_read_b64_tr_b16 v[126:127], v11 offset:9216
buffer_load_dwordx4 v[52:55], v1, s[8:11], s24 offen offset:1024 sc1
v_mfma_f32_16x16x32_bf16 v[96:99], a[0:3], v[56:59], v[96:99]
v_mfma_f32_16x16x32_bf16 v[100:103], a[4:7], v[56:59], v[100:103]
v_mfma_f32_16x16x32_bf16 v[104:107], a[8:11], v[56:59], v[104:107]
v_mfma_f32_16x16x32_bf16 v[108:111], a[12:15], v[56:59], v[108:111]
s_waitcnt vmcnt(15) lgkmcnt(0)
buffer_load_dwordx4 v[56:59], v1, s[8:11], s24 offen offset:2048 sc1
v_mfma_f32_16x16x32_bf16 v[96:99], v[112:115], v[60:63], v[96:99]
v_add_f32 v80, v80, v84
v_add_f32 v81, v81, v85
v_mfma_f32_16x16x32_bf16 v[100:103], v[116:119], v[60:63], v[100:103]
v_add_f32 v82, v82, v86
v_add_f32 v83, v83, v87
v_mfma_f32_16x16x32_bf16 v[104:107], v[120:123], v[60:63], v[104:107]
v_add_f32 v80, v80, v88
v_add_f32 v81, v81, v89
v_mfma_f32_16x16x32_bf16 v[108:111], v[124:127], v[60:63], v[108:111]
s_waitcnt vmcnt(15)
v_add_f32 v82, v82, v90
v_add_f32 v83, v83, v91
buffer_load_dwordx4 v[60:63], v1, s[8:11], s24 offen offset:3072 sc1
v_mfma_f32_16x16x32_bf16 v[96:99], a[16:19], v[64:67], v[96:99]
ds_read_b64_tr_b16 v[112:113], v8 offset:12288
v_add_f32 v80, v80, v92
v_mfma_f32_16x16x32_bf16 v[100:103], a[20:23], v[64:67], v[100:103]
ds_read_b64_tr_b16 v[114:115], v8 offset:13312
v_add_f32 v81, v81, v93
v_mfma_f32_16x16x32_bf16 v[104:107], a[24:27], v[64:67], v[104:107]
s_add_u32 s24, s48, s37
ds_read_b64_tr_b16 v[116:117], v9 offset:12288
v_add_f32 v82, v82, v94
v_mfma_f32_16x16x32_bf16 v[108:111], a[28:31], v[64:67], v[108:111]
s_waitcnt vmcnt(15)
ds_read_b64_tr_b16 v[118:119], v9 offset:13312
v_add_f32 v83, v83, v95
buffer_load_dwordx4 v[64:67], v1, s[8:11], s24 offen sc1
v_mfma_f32_16x16x32_bf16 v[96:99], a[32:35], v[68:71], v[96:99]
ds_read_b64_tr_b16 v[120:121], v10 offset:12288
v_cvt_pk_bf16_f32 v12, v80, v81
v_mfma_f32_16x16x32_bf16 v[100:103], a[36:39], v[68:71], v[100:103]
ds_read_b64_tr_b16 v[122:123], v10 offset:13312
v_cvt_pk_bf16_f32 v13, v82, v83
v_mfma_f32_16x16x32_bf16 v[104:107], a[40:43], v[68:71], v[104:107]
ds_read_b64_tr_b16 v[124:125], v11 offset:12288
v_xor_b32 v3, 16384, v3
v_mfma_f32_16x16x32_bf16 v[108:111], a[44:47], v[68:71], v[108:111]
s_waitcnt vmcnt(15)
ds_read_b64_tr_b16 v[126:127], v11 offset:13312
v_xor_b32 v7, 16384, v7
buffer_load_dwordx4 v[68:71], v1, s[8:11], s24 offen offset:1024 sc1
buffer_store_dwordx2 v[12:13], v4, s[12:15], s53 offen
L_opl_t1:
v_mfma_f32_16x16x32_bf16 v[96:99], a[48:51], v[72:75], v[96:99]
v_mfma_f32_16x16x32_bf16 v[100:103], a[52:55], v[72:75], v[100:103]
v_mfma_f32_16x16x32_bf16 v[104:107], a[56:59], v[72:75], v[104:107]
v_mfma_f32_16x16x32_bf16 v[108:111], a[60:63], v[72:75], v[108:111]
s_waitcnt vmcnt(16) lgkmcnt(0)
buffer_load_dwordx4 v[72:75], v1, s[8:11], s24 offen offset:2048 sc1
v_mfma_f32_16x16x32_bf16 v[96:99], v[112:115], v[76:79], v[96:99]
s_waitcnt vmcnt(13)
v_cmp_ne_u32 vcc, 1, v6
v_mfma_f32_16x16x32_bf16 v[100:103], v[116:119], v[76:79], v[100:103]
v_mfma_f32_16x16x32_bf16 v[104:107], v[120:123], v[76:79], v[104:107]
s_cmp_eq_u64 vcc, 0
s_cselect_b32 s50, s52, 0
v_mfma_f32_16x16x32_bf16 v[108:111], v[124:127], v[76:79], v[108:111]
s_waitcnt vmcnt(16)
buffer_load_dwordx4 v[76:79], v1, s[8:11], s24 offen offset:3072 sc1
v_mfma_f32_16x16x32_bf16 v[96:99], a[64:67], v[16:19], v[96:99]
s_cmp_eq_u32 s50, 1
s_cselect_b32 s49, s49, 536870912
ds_read_b64_tr_b16 v[112:113], v8 offset:16384
v_mfma_f32_16x16x32_bf16 v[100:103], a[68:71], v[16:19], v[100:103]
ds_read_b64_tr_b16 v[114:115], v8 offset:17408
v_mfma_f32_16x16x32_bf16 v[104:107], a[72:75], v[16:19], v[104:107]
s_add_u32 s24, s49, s30
ds_read_b64_tr_b16 v[116:117], v9 offset:16384
v_mfma_f32_16x16x32_bf16 v[108:111], a[76:79], v[16:19], v[108:111]
s_waitcnt vmcnt(16)
ds_read_b64_tr_b16 v[118:119], v9 offset:17408
buffer_load_dwordx4 v[16:19], v1, s[8:11], s24 offen sc1
v_mfma_f32_16x16x32_bf16 v[96:99], a[80:83], v[20:23], v[96:99]
ds_read_b64_tr_b16 v[120:121], v10 offset:16384
v_mfma_f32_16x16x32_bf16 v[100:103], a[84:87], v[20:23], v[100:103]
ds_read_b64_tr_b16 v[122:123], v10 offset:17408
v_mfma_f32_16x16x32_bf16 v[104:107], a[88:91], v[20:23], v[104:107]
ds_read_b64_tr_b16 v[124:125], v11 offset:16384
v_mfma_f32_16x16x32_bf16 v[108:111], a[92:95], v[20:23], v[108:111]
s_waitcnt vmcnt(16)
ds_read_b64_tr_b16 v[126:127], v11 offset:17408
buffer_load_dwordx4 v[20:23], v1, s[8:11], s24 offen offset:1024 sc1
v_mfma_f32_16x16x32_bf16 v[96:99], a[96:99], v[24:27], v[96:99]
v_mfma_f32_16x16x32_bf16 v[100:103], a[100:103], v[24:27], v[100:103]
v_mfma_f32_16x16x32_bf16 v[104:107], a[104:107], v[24:27], v[104:107]
v_mfma_f32_16x16x32_bf16 v[108:111], a[108:111], v[24:27], v[108:111]
s_waitcnt vmcnt(15) lgkmcnt(0)
buffer_load_dwordx4 v[24:27], v1, s[8:11], s24 offen offset:2048 sc1
v_mfma_f32_16x16x32_bf16 v[96:99], v[112:115], v[28:31], v[96:99]
v_mfma_f32_16x16x32_bf16 v[100:103], v[116:119], v[28:31], v[100:103]
v_mfma_f32_16x16x32_bf16 v[104:107], v[120:123], v[28:31], v[104:107]
v_mfma_f32_16x16x32_bf16 v[108:111], v[124:127], v[28:31], v[108:111]
s_waitcnt vmcnt(15)
buffer_load_dwordx4 v[28:31], v1, s[8:11], s24 offen offset:3072 sc1
v_mfma_f32_16x16x32_bf16 v[96:99], a[112:115], v[32:35], v[96:99]
ds_read_b64_tr_b16 v[112:113], v8 offset:20480
v_mfma_f32_16x16x32_bf16 v[100:103], a[116:119], v[32:35], v[100:103]
ds_read_b64_tr_b16 v[114:115], v8 offset:21504
v_mfma_f32_16x16x32_bf16 v[104:107], a[120:123], v[32:35], v[104:107]
s_add_u32 s24, s49, s31
ds_read_b64_tr_b16 v[116:117], v9 offset:20480
v_mfma_f32_16x16x32_bf16 v[108:111], a[124:127], v[32:35], v[108:111]
s_waitcnt vmcnt(15)
ds_read_b64_tr_b16 v[118:119], v9 offset:21504
buffer_load_dwordx4 v[32:35], v1, s[8:11], s24 offen sc1
v_mfma_f32_16x16x32_bf16 v[96:99], a[128:131], v[36:39], v[96:99]
ds_read_b64_tr_b16 v[120:121], v10 offset:20480
v_mfma_f32_16x16x32_bf16 v[100:103], a[132:135], v[36:39], v[100:103]
ds_read_b64_tr_b16 v[122:123], v10 offset:21504
v_mfma_f32_16x16x32_bf16 v[104:107], a[136:139], v[36:39], v[104:107]
ds_read_b64_tr_b16 v[124:125], v11 offset:20480
v_mfma_f32_16x16x32_bf16 v[108:111], a[140:143], v[36:39], v[108:111]
s_waitcnt vmcnt(15)
ds_read_b64_tr_b16 v[126:127], v11 offset:21504
buffer_load_dwordx4 v[36:39], v1, s[8:11], s24 offen offset:1024 sc1
v_mfma_f32_16x16x32_bf16 v[96:99], a[144:147], v[40:43], v[96:99]
v_mfma_f32_16x16x32_bf16 v[100:103], a[148:151], v[40:43], v[100:103]
v_mfma_f32_16x16x32_bf16 v[104:107], a[152:155], v[40:43], v[104:107]
v_mfma_f32_16x16x32_bf16 v[108:111], a[156:159], v[40:43], v[108:111]
s_waitcnt vmcnt(15) lgkmcnt(0)
buffer_load_dwordx4 v[40:43], v1, s[8:11], s24 offen offset:2048 sc1
v_mfma_f32_16x16x32_bf16 v[96:99], v[112:115], v[44:47], v[96:99]
v_mfma_f32_16x16x32_bf16 v[100:103], v[116:119], v[44:47], v[100:103]
v_mfma_f32_16x16x32_bf16 v[104:107], v[120:123], v[44:47], v[104:107]
v_mfma_f32_16x16x32_bf16 v[108:111], v[124:127], v[44:47], v[108:111]
s_waitcnt vmcnt(15)
buffer_load_dwordx4 v[44:47], v1, s[8:11], s24 offen offset:3072 sc1
v_mfma_f32_16x16x32_bf16 v[96:99], a[160:163], v[48:51], v[96:99]
ds_read_b64_tr_b16 v[112:113], v8 offset:24576
v_mfma_f32_16x16x32_bf16 v[100:103], a[164:167], v[48:51], v[100:103]
ds_read_b64_tr_b16 v[114:115], v8 offset:25600
v_mfma_f32_16x16x32_bf16 v[104:107], a[168:171], v[48:51], v[104:107]
s_add_u32 s24, s49, s32
ds_read_b64_tr_b16 v[116:117], v9 offset:24576
v_mfma_f32_16x16x32_bf16 v[108:111], a[172:175], v[48:51], v[108:111]
s_waitcnt vmcnt(15)
ds_read_b64_tr_b16 v[118:119], v9 offset:25600
buffer_load_dwordx4 v[48:51], v1, s[8:11], s24 offen sc1
v_mfma_f32_16x16x32_bf16 v[96:99], a[176:179], v[52:55], v[96:99]
ds_read_b64_tr_b16 v[120:121], v10 offset:24576
v_mfma_f32_16x16x32_bf16 v[100:103], a[180:183], v[52:55], v[100:103]
ds_read_b64_tr_b16 v[122:123], v10 offset:25600
v_mfma_f32_16x16x32_bf16 v[104:107], a[184:187], v[52:55], v[104:107]
ds_read_b64_tr_b16 v[124:125], v11 offset:24576
v_mfma_f32_16x16x32_bf16 v[108:111], a[188:191], v[52:55], v[108:111]
s_waitcnt vmcnt(15)
ds_read_b64_tr_b16 v[126:127], v11 offset:25600
buffer_load_dwordx4 v[52:55], v1, s[8:11], s24 offen offset:1024 sc1
v_mfma_f32_16x16x32_bf16 v[96:99], a[192:195], v[56:59], v[96:99]
v_mfma_f32_16x16x32_bf16 v[100:103], a[196:199], v[56:59], v[100:103]
v_mfma_f32_16x16x32_bf16 v[104:107], a[200:203], v[56:59], v[104:107]
v_mfma_f32_16x16x32_bf16 v[108:111], a[204:207], v[56:59], v[108:111]
s_waitcnt vmcnt(15) lgkmcnt(0)
buffer_load_dwordx4 v[56:59], v1, s[8:11], s24 offen offset:2048 sc1
v_mfma_f32_16x16x32_bf16 v[96:99], v[112:115], v[60:63], v[96:99]
v_mfma_f32_16x16x32_bf16 v[100:103], v[116:119], v[60:63], v[100:103]
v_mfma_f32_16x16x32_bf16 v[104:107], v[120:123], v[60:63], v[104:107]
v_mfma_f32_16x16x32_bf16 v[108:111], v[124:127], v[60:63], v[108:111]
s_waitcnt vmcnt(15)
buffer_load_dwordx4 v[60:63], v1, s[8:11], s24 offen offset:3072 sc1
v_mfma_f32_16x16x32_bf16 v[96:99], a[208:211], v[64:67], v[96:99]
ds_read_b64_tr_b16 v[112:113], v8 offset:28672
v_mfma_f32_16x16x32_bf16 v[100:103], a[212:215], v[64:67], v[100:103]
ds_read_b64_tr_b16 v[114:115], v8 offset:29696
v_mfma_f32_16x16x32_bf16 v[104:107], a[216:219], v[64:67], v[104:107]
s_add_u32 s24, s49, s33
ds_read_b64_tr_b16 v[116:117], v9 offset:28672
v_mfma_f32_16x16x32_bf16 v[108:111], a[220:223], v[64:67], v[108:111]
s_waitcnt vmcnt(15)
ds_read_b64_tr_b16 v[118:119], v9 offset:29696
buffer_load_dwordx4 v[64:67], v1, s[8:11], s24 offen sc1
v_mfma_f32_16x16x32_bf16 v[96:99], a[224:227], v[68:71], v[96:99]
ds_read_b64_tr_b16 v[120:121], v10 offset:28672
v_mfma_f32_16x16x32_bf16 v[100:103], a[228:231], v[68:71], v[100:103]
ds_read_b64_tr_b16 v[122:123], v10 offset:29696
v_mfma_f32_16x16x32_bf16 v[104:107], a[232:235], v[68:71], v[104:107]
ds_read_b64_tr_b16 v[124:125], v11 offset:28672
v_mfma_f32_16x16x32_bf16 v[108:111], a[236:239], v[68:71], v[108:111]
s_waitcnt vmcnt(14)
ds_read_b64_tr_b16 v[126:127], v11 offset:29696
buffer_load_dwordx4 v[68:71], v1, s[8:11], s24 offen offset:1024 sc1
v_mfma_f32_16x16x32_bf16 v[96:99], a[240:243], v[72:75], v[96:99]
v_mfma_f32_16x16x32_bf16 v[100:103], a[244:247], v[72:75], v[100:103]
v_mfma_f32_16x16x32_bf16 v[104:107], a[248:251], v[72:75], v[104:107]
v_mfma_f32_16x16x32_bf16 v[108:111], a[252:255], v[72:75], v[108:111]
s_waitcnt vmcnt(14) lgkmcnt(0)
buffer_load_dwordx4 v[72:75], v1, s[8:11], s24 offen offset:2048 sc1
v_mfma_f32_16x16x32_bf16 v[96:99], v[112:115], v[76:79], v[96:99]
v_mfma_f32_16x16x32_bf16 v[100:103], v[116:119], v[76:79], v[100:103]
v_mfma_f32_16x16x32_bf16 v[104:107], v[120:123], v[76:79], v[104:107]
v_mfma_f32_16x16x32_bf16 v[108:111], v[124:127], v[76:79], v[108:111]
s_waitcnt vmcnt(14)
buffer_load_dwordx4 v[76:79], v1, s[8:11], s24 offen offset:3072 sc1
s_mul_i32 s53, s41, 36864
s_mov_b32 s41, s27
s_mov_b32 s48, s49
s_cmp_eq_u32 s50, 0
s_cbranch_scc0 L_opl_r0
L_opl_c1:
ds_write_b128 v3, v[96:99]
ds_write_b128 v3, v[100:103] offset:4096
ds_write_b128 v3, v[104:107] offset:8192
ds_write_b128 v3, v[108:111] offset:12288
s_waitcnt lgkmcnt(0)
s_barrier
ds_read_b128 v[96:99], v7
ds_read_b128 v[100:103], v7 offset:1024
ds_read_b128 v[104:107], v7 offset:2048
ds_read_b128 v[108:111], v7 offset:3072
s_waitcnt lgkmcnt(2)
v_pk_add_f32 v[96:97], v[96:97], v[100:101]
v_pk_add_f32 v[98:99], v[98:99], v[102:103]
s_waitcnt lgkmcnt(1)
v_pk_add_f32 v[96:97], v[96:97], v[104:105]
v_pk_add_f32 v[98:99], v[98:99], v[106:107]
s_waitcnt lgkmcnt(0)
v_pk_add_f32 v[96:97], v[96:97], v[108:109]
v_pk_add_f32 v[98:99], v[98:99], v[110:111]
v_cvt_pk_bf16_f32 v12, v96, v97
v_cvt_pk_bf16_f32 v13, v98, v99
buffer_store_dwordx2 v[12:13], v4, s[12:15], s53 offen
v_xor_b32 v3, 16384, v3
v_xor_b32 v7, 16384, v7
s_cmp_lg_u32 s52, 0
s_cbranch_scc1 L_opl_w
s_branch L_opl_x
L_opl_c0:
ds_write_b128 v3, v[80:83]
ds_write_b128 v3, v[84:87] offset:4096
ds_write_b128 v3, v[88:91] offset:8192
ds_write_b128 v3, v[92:95] offset:12288
s_waitcnt lgkmcnt(0)
s_barrier
ds_read_b128 v[80:83], v7
ds_read_b128 v[84:87], v7 offset:1024
ds_read_b128 v[88:91], v7 offset:2048
ds_read_b128 v[92:95], v7 offset:3072
s_waitcnt lgkmcnt(2)
v_pk_add_f32 v[80:81], v[80:81], v[84:85]
v_pk_add_f32 v[82:83], v[82:83], v[86:87]
s_waitcnt lgkmcnt(1)
v_pk_add_f32 v[80:81], v[80:81], v[88:89]
v_pk_add_f32 v[82:83], v[82:83], v[90:91]
s_waitcnt lgkmcnt(0)
v_pk_add_f32 v[80:81], v[80:81], v[92:93]
v_pk_add_f32 v[82:83], v[82:83], v[94:95]
v_cvt_pk_bf16_f32 v12, v80, v81
v_cvt_pk_bf16_f32 v13, v82, v83
buffer_store_dwordx2 v[12:13], v4, s[12:15], s53 offen
v_xor_b32 v3, 16384, v3
v_xor_b32 v7, 16384, v7
s_cmp_lg_u32 s52, 0
s_cbranch_scc1 L_opl_w
L_opl_x:
s_branch L_done
L_team:
s_load_dwordx8 s[88:95], s[0:1], 64
s_load_dwordx2 s[96:97], s[0:1], 56
v_mov_b32 v12, v0
v_and_b32 v13, 15, v0
v_bfe_u32 v14, v0, 4, 2
v_lshlrev_b32 v3, 4, v12
v_and_b32 v2, 0x3f0, v3
s_mul_i32 s20, s17, 34816
s_add_u32 s20, s20, 24576
v_add_u32 v2, s20, v2
v_and_b32 v15, 1, v12
v_mul_u32_u24 v0, 0xaaaa, v15
v_add_u32 v0, 0xffff4444, v0
v_lshrrev_b32 v18, 2, v13
v_lshl_add_u32 v18, v18, 1, v15
v_bfe_u32 v19, v13, 1, 1
v_lshrrev_b32 v16, 5, v12
v_lshlrev_b32 v16, 8, v16
v_lshl_add_u32 v16, v18, 5, v16
v_and_b32 v17, 1, v14
v_lshl_add_u32 v16, v17, 4, v16
v_and_b32 v17, 0x7f, v16
v_xor_b32 v17, 16, v17
v_add_u32 v16, 4224, v16
v_add_u32 v17, 6272, v17
v_cmp_eq_u32 vcc, 1, v19
s_nop 1
v_cndmask_b32 v7, v17, v16, vcc
v_lshrrev_b32 v16, 1, v14
v_lshlrev_b32 v16, 8, v16
v_lshl_add_u32 v16, v15, 7, v16
v_and_b32 v17, 1, v14
v_lshl_add_u32 v16, v17, 6, v16
v_lshrrev_b32 v17, 2, v13
v_lshl_add_u32 v16, v17, 4, v16
v_mul_u32_u24 v17, 2112, v19
v_add_u32 v5, v16, v17
v_bfe_u32 v16, v13, 3, 1
v_lshlrev_b32 v16, 8, v16
v_lshl_add_u32 v16, v19, 6, v16
v_lshl_add_u32 v16, v14, 4, v16
v_bfe_u32 v17, v13, 2, 1
v_lshl_add_u32 v16, v17, 3, v16
v_lshl_add_u32 v16, v15, 2, v16
s_lshl_b32 s20, s17, 9
v_add_u32 v4, s20, v16
v_lshrrev_b32 v16, 4, v12
v_xor_b32 v17, s16, v16
v_lshlrev_b32 v16, 12, v16
v_lshl_add_u32 v16, v17, 7, v16
v_lshl_add_u32 v9, v13, 3, v16
s_lshr_b32 s20, s17, 1
s_lshl_b32 s20, s20, 2
v_add_u32 v16, s20, v14
v_xor_b32 v17, s16, v16
v_lshlrev_b32 v16, 12, v16
v_lshl_add_u32 v16, v17, 7, v16
v_lshl_add_u32 v16, v13, 2, v16
s_and_b32 s20, s17, 1
s_lshl_b32 s20, s20, 6
s_add_u32 s20, s20, 262144
v_add_u32 v10, s20, v16
v_bfe_u32 v16, v13, 2, 1
v_lshlrev_b32 v16, 5, v16
v_and_b32 v17, 1, v14
v_lshl_add_u32 v16, v17, 8, v16
v_lshrrev_b32 v17, 1, v14
v_lshl_add_u32 v16, v17, 4, v16
v_and_b32 v17, 3, v13
v_lshl_add_u32 v11, v17, 2, v16
v_lshlrev_b32 v6, 7, v12
v_lshlrev_b32 v8, 2, v12
s_mov_b32 s36, 0x11111111
s_mov_b32 s37, 0x11111111
s_mov_b32 s38, 0x22222222
s_mov_b32 s39, 0x22222222
s_mov_b32 s40, 0x44444444
s_mov_b32 s41, 0x44444444
s_mov_b32 s42, 0x88888888
s_mov_b32 s43, 0x88888888
s_mov_b32 s44, 0xf0f0f0f0
s_mov_b32 s45, 0xf0f0f0f0
s_mov_b32 s18, 0x3e0293ee
s_lshl_b32 s20, s17, 5
s_add_u32 s20, s20, s16
s_cmp_lt_u32 s20, 72
s_cselect_b32 s48, 1, 0
s_lshl_b32 s23, s20, 12
s_lshl_b32 s21, s17, 10
s_sub_u32 s23, s23, s21
s_lshr_b32 s24, s20, 2
s_lshl_b32 s24, s24, 9
s_and_b32 s21, s20, 3
s_lshl_b32 s21, s21, 6
s_add_u32 s24, s24, s21
s_add_u32 s24, s24, 110100480
s_cmp_lt_u32 s20, 72
s_cselect_b32 s24, s24, 536870912
s_lshl_b32 s25, s16, 12
s_add_u32 s26, s25, 131072
s_add_u32 s27, s25, 262144
s_cmp_lt_u32 s16, 8
s_cselect_b32 s27, s27, 536870912
s_mov_b32 s28, 109051904
s_mov_b32 s29, 109346816
s_lshl_b32 s30, s16, 14
s_add_u32 s30, s30, 33554432
s_lshl_b32 s31, s16, 12
s_add_u32 s31, s31, 100663296
s_add_u32 s35, s24, 32768
s_mov_b32 s53, 0x3f803f80
s_mov_b32 s86, 0x33333333
s_mov_b32 s87, 0x33333333
s_lshl_b32 s84, s17, 13
s_sub_u32 s84, s20, s84
s_add_u32 s84, s84, 110886912
s_cmp_lt_u32 s20, 72
s_cselect_b32 s84, s84, 536870912
s_and_b32 s21, s16, 3
s_lshl_b32 s21, s21, 7
s_add_u32 s21, s21, 110886144
s_cmp_eq_u32 s17, 3
s_cselect_b32 s84, s21, s84
s_lshl_b32 s82, s16, 7
s_add_u32 s83, s82, 111152384
s_add_u32 s82, s82, 111148288
s_mov_b32 s19, 0
v_mov_b32 v64, -1
v_mov_b32 v65, -1
v_mov_b32 v66, -1
v_mov_b32 v67, -1
s_add_u32 s20, s28, s25
buffer_store_dwordx4 v[64:67], v3, s[8:11], s20 offen
s_add_u32 s20, s28, s26
buffer_store_dwordx4 v[64:67], v3, s[8:11], s20 offen
s_add_u32 s20, s28, s27
buffer_store_dwordx4 v[64:67], v3, s[8:11], s20 offen
s_add_u32 s20, s29, s25
buffer_store_dwordx4 v[64:67], v3, s[8:11], s20 offen
s_add_u32 s20, s29, s26
buffer_store_dwordx4 v[64:67], v3, s[8:11], s20 offen
s_add_u32 s20, s29, s27
buffer_store_dwordx4 v[64:67], v3, s[8:11], s20 offen
s_add_u32 s20, s24, 16384
buffer_store_dword v64, v11, s[8:11], s20 offen
s_cmp_eq_u32 s17, 3
s_cselect_b32 s20, 536870912, s84
s_mov_b64 exec, 15
buffer_store_byte v64, v6, s[8:11], s20 offen
s_mov_b64 exec, -1
v_lshrrev_b32 v0, 4, v3
s_waitcnt lgkmcnt(0)
s_mov_b32 s46, 0x05040100
s_mov_b32 s47, 0x07060302
v_and_b32 v3, 63, v0
v_lshlrev_b32 v3, 4, v3
s_mul_i32 s20, s17, 34816
s_add_u32 s20, s20, 24576
v_add_u32 v3, s20, v3
v_bfe_u32 v64, v0, 5, 1
v_bfe_u32 v65, v0, 4, 1
v_and_b32 v66, 15, v0
v_lshlrev_b32 v1, 17, v64
v_lshl_add_u32 v1, v65, 14, v1
v_lshl_add_u32 v1, v66, 2, v1
s_lshl_b32 s20, s16, 8
s_lshl_b32 s21, s17, 6
s_add_u32 s20, s20, s21
v_add_u32 v1, s20, v1
v_lshlrev_b32 v2, 4, v64
v_lshl_add_u32 v2, v65, 2, v2
v_mul_u32_u24 v2, 1152, v2
s_mul_i32 s20, s16, 147456
v_add_u32 v2, s20, v2
v_and_b32 v4, 15, v0
s_lshl_b32 s20, s17, 4
v_add_u32 v4, s20, v4
v_lshlrev_b32 v4, 1, v4
v_add_u32 v2, v2, v4
v_add_u32 v4, v2, v4
s_barrier
s_mov_b32 s12, s90
s_and_b32 s13, s91, 0xffff
s_mov_b32 s14, 4718592
s_mov_b32 s15, 0x20000
s_mov_b32 s20, 0
buffer_load_dword v6, v1, s[12:15], s20 offen
s_mov_b32 s21, 32768
buffer_load_dword v7, v1, s[12:15], s21 offen
s_mov_b32 s20, 65536
buffer_load_dword v8, v1, s[12:15], s20 offen
s_mov_b32 s21, 98304
buffer_load_dword v9, v1, s[12:15], s21 offen
s_mov_b32 s20, 8192
buffer_load_dword v10, v1, s[12:15], s20 offen
s_mov_b32 s21, 40960
buffer_load_dword v11, v1, s[12:15], s21 offen
s_mov_b32 s20, 73728
buffer_load_dword v12, v1, s[12:15], s20 offen
s_mov_b32 s21, 106496
buffer_load_dword v13, v1, s[12:15], s21 offen
s_barrier
s_mov_b32 s20, 262144
buffer_load_dword v14, v1, s[12:15], s20 offen
s_mov_b32 s21, 294912
buffer_load_dword v15, v1, s[12:15], s21 offen
s_mov_b32 s20, 327680
buffer_load_dword v16, v1, s[12:15], s20 offen
s_mov_b32 s21, 360448
buffer_load_dword v17, v1, s[12:15], s21 offen
s_mov_b32 s20, 270336
buffer_load_dword v18, v1, s[12:15], s20 offen
s_mov_b32 s21, 303104
buffer_load_dword v19, v1, s[12:15], s21 offen
s_mov_b32 s20, 335872
buffer_load_dword v20, v1, s[12:15], s20 offen
s_mov_b32 s21, 368640
buffer_load_dword v21, v1, s[12:15], s21 offen
s_barrier
s_mov_b32 s12, s92
s_and_b32 s13, s93, 0xffff
s_mov_b32 s14, 4718592
s_mov_b32 s15, 0x20000
s_mov_b32 s20, 0
buffer_load_dword v22, v1, s[12:15], s20 offen
s_mov_b32 s21, 32768
buffer_load_dword v23, v1, s[12:15], s21 offen
s_mov_b32 s20, 65536
buffer_load_dword v24, v1, s[12:15], s20 offen
s_mov_b32 s21, 98304
buffer_load_dword v25, v1, s[12:15], s21 offen
s_mov_b32 s20, 8192
buffer_load_dword v26, v1, s[12:15], s20 offen
s_mov_b32 s21, 40960
buffer_load_dword v27, v1, s[12:15], s21 offen
s_mov_b32 s20, 73728
buffer_load_dword v28, v1, s[12:15], s20 offen
s_mov_b32 s21, 106496
buffer_load_dword v29, v1, s[12:15], s21 offen
s_barrier
s_mov_b32 s20, 262144
buffer_load_dword v30, v1, s[12:15], s20 offen
s_mov_b32 s21, 294912
buffer_load_dword v31, v1, s[12:15], s21 offen
s_mov_b32 s20, 327680
buffer_load_dword v32, v1, s[12:15], s20 offen
s_mov_b32 s21, 360448
buffer_load_dword v33, v1, s[12:15], s21 offen
s_mov_b32 s20, 270336
buffer_load_dword v34, v1, s[12:15], s20 offen
s_mov_b32 s21, 303104
buffer_load_dword v35, v1, s[12:15], s21 offen
s_mov_b32 s20, 335872
buffer_load_dword v36, v1, s[12:15], s20 offen
s_mov_b32 s21, 368640
buffer_load_dword v37, v1, s[12:15], s21 offen
s_barrier
s_mov_b32 s12, s90
s_and_b32 s13, s91, 0xffff
s_mov_b32 s14, 4718592
s_mov_b32 s15, 0x20000
s_mov_b32 s20, 524288
buffer_load_dword v38, v1, s[12:15], s20 offen
s_mov_b32 s21, 557056
buffer_load_dword v39, v1, s[12:15], s21 offen
s_mov_b32 s20, 589824
buffer_load_dword v40, v1, s[12:15], s20 offen
s_mov_b32 s21, 622592
buffer_load_dword v41, v1, s[12:15], s21 offen
s_mov_b32 s20, 532480
buffer_load_dword v42, v1, s[12:15], s20 offen
s_mov_b32 s21, 565248
buffer_load_dword v43, v1, s[12:15], s21 offen
s_mov_b32 s20, 598016
buffer_load_dword v44, v1, s[12:15], s20 offen
s_mov_b32 s21, 630784
buffer_load_dword v45, v1, s[12:15], s21 offen
s_barrier
s_mov_b32 s20, 786432
buffer_load_dword v46, v1, s[12:15], s20 offen
s_mov_b32 s21, 819200
buffer_load_dword v47, v1, s[12:15], s21 offen
s_mov_b32 s20, 851968
buffer_load_dword v48, v1, s[12:15], s20 offen
s_mov_b32 s21, 884736
buffer_load_dword v49, v1, s[12:15], s21 offen
s_mov_b32 s20, 794624
buffer_load_dword v50, v1, s[12:15], s20 offen
s_mov_b32 s21, 827392
buffer_load_dword v51, v1, s[12:15], s21 offen
s_mov_b32 s20, 860160
buffer_load_dword v52, v1, s[12:15], s20 offen
s_mov_b32 s21, 892928
buffer_load_dword v53, v1, s[12:15], s21 offen
s_barrier
s_mov_b32 s12, s92
s_and_b32 s13, s93, 0xffff
s_mov_b32 s14, 4718592
s_mov_b32 s15, 0x20000
s_mov_b32 s20, 524288
buffer_load_dword v54, v1, s[12:15], s20 offen
s_mov_b32 s21, 557056
buffer_load_dword v55, v1, s[12:15], s21 offen
s_mov_b32 s20, 589824
buffer_load_dword v56, v1, s[12:15], s20 offen
s_mov_b32 s21, 622592
buffer_load_dword v57, v1, s[12:15], s21 offen
s_mov_b32 s20, 532480
buffer_load_dword v58, v1, s[12:15], s20 offen
s_mov_b32 s21, 565248
buffer_load_dword v59, v1, s[12:15], s21 offen
s_mov_b32 s20, 598016
buffer_load_dword v60, v1, s[12:15], s20 offen
s_mov_b32 s21, 630784
buffer_load_dword v61, v1, s[12:15], s21 offen
s_waitcnt vmcnt(54)
v_perm_b32 v88, v7, v6, s46
v_perm_b32 v68, v7, v6, s47
s_barrier
s_mov_b32 s20, 786432
buffer_load_dword v6, v1, s[12:15], s20 offen
s_mov_b32 s21, 819200
buffer_load_dword v7, v1, s[12:15], s21 offen
s_waitcnt vmcnt(54)
v_perm_b32 v89, v9, v8, s46
v_perm_b32 v69, v9, v8, s47
s_mov_b32 s20, 851968
buffer_load_dword v8, v1, s[12:15], s20 offen
s_mov_b32 s21, 884736
buffer_load_dword v9, v1, s[12:15], s21 offen
s_waitcnt vmcnt(54)
v_perm_b32 v90, v11, v10, s46
v_perm_b32 v70, v11, v10, s47
s_mov_b32 s20, 794624
buffer_load_dword v10, v1, s[12:15], s20 offen
s_mov_b32 s21, 827392
buffer_load_dword v11, v1, s[12:15], s21 offen
s_waitcnt vmcnt(54)
v_perm_b32 v91, v13, v12, s46
v_perm_b32 v71, v13, v12, s47
ds_write_b128 v3, v[68:71]
s_waitcnt lgkmcnt(0)
s_mov_b32 s20, 860160
buffer_load_dword v12, v1, s[12:15], s20 offen
s_mov_b32 s21, 892928
buffer_load_dword v13, v1, s[12:15], s21 offen
s_waitcnt vmcnt(54)
v_perm_b32 v92, v15, v14, s46
v_perm_b32 v68, v15, v14, s47
s_barrier
s_cmp_eq_u32 s17, 0
s_cselect_b32 s98, 64, 536870912
v_mov_b32 v5, 1
s_mov_b64 exec, 1
buffer_atomic_add v5, v0, s[56:59], s98 offen
s_mov_b64 exec, -1
s_mov_b32 s12, s90
s_and_b32 s13, s91, 0xffff
s_mov_b32 s14, 4718592
s_mov_b32 s15, 0x20000
s_mov_b32 s20, 1048576
buffer_load_dword v14, v1, s[12:15], s20 offen
s_mov_b32 s21, 1081344
buffer_load_dword v15, v1, s[12:15], s21 offen
s_waitcnt vmcnt(55)
v_perm_b32 v93, v17, v16, s46
v_perm_b32 v69, v17, v16, s47
s_mov_b32 s20, 1114112
buffer_load_dword v16, v1, s[12:15], s20 offen
s_mov_b32 s21, 1146880
buffer_load_dword v17, v1, s[12:15], s21 offen
s_waitcnt vmcnt(55)
v_perm_b32 v94, v19, v18, s46
v_perm_b32 v70, v19, v18, s47
s_mov_b32 s20, 1056768
buffer_load_dword v18, v1, s[12:15], s20 offen
s_mov_b32 s21, 1089536
buffer_load_dword v19, v1, s[12:15], s21 offen
s_waitcnt vmcnt(55)
v_perm_b32 v95, v21, v20, s46
v_perm_b32 v71, v21, v20, s47
ds_write_b128 v3, v[68:71] offset:1024
s_waitcnt lgkmcnt(0)
s_mov_b32 s20, 1122304
buffer_load_dword v20, v1, s[12:15], s20 offen
s_mov_b32 s21, 1155072
buffer_load_dword v21, v1, s[12:15], s21 offen
s_waitcnt vmcnt(55)
v_perm_b32 v64, v23, v22, s46
v_accvgpr_write_b32 a32, v64
v_perm_b32 v68, v23, v22, s47
v_accvgpr_write_b32 a40, v68
s_barrier
s_mov_b32 s20, 1310720
buffer_load_dword v22, v1, s[12:15], s20 offen
s_mov_b32 s21, 1343488
buffer_load_dword v23, v1, s[12:15], s21 offen
s_waitcnt vmcnt(55)
v_perm_b32 v65, v25, v24, s46
v_accvgpr_write_b32 a33, v65
v_perm_b32 v69, v25, v24, s47
v_accvgpr_write_b32 a41, v69
s_mov_b32 s20, 1376256
buffer_load_dword v24, v1, s[12:15], s20 offen
s_mov_b32 s21, 1409024
buffer_load_dword v25, v1, s[12:15], s21 offen
s_waitcnt vmcnt(55)
v_perm_b32 v66, v27, v26, s46
v_accvgpr_write_b32 a34, v66
v_perm_b32 v70, v27, v26, s47
v_accvgpr_write_b32 a42, v70
s_mov_b32 s20, 1318912
buffer_load_dword v26, v1, s[12:15], s20 offen
s_mov_b32 s21, 1351680
buffer_load_dword v27, v1, s[12:15], s21 offen
s_waitcnt vmcnt(55)
v_perm_b32 v67, v29, v28, s46
v_accvgpr_write_b32 a35, v67
v_perm_b32 v71, v29, v28, s47
v_accvgpr_write_b32 a43, v71
s_mov_b32 s20, 1384448
buffer_load_dword v28, v1, s[12:15], s20 offen
s_mov_b32 s21, 1417216
buffer_load_dword v29, v1, s[12:15], s21 offen
s_waitcnt vmcnt(55)
v_perm_b32 v64, v31, v30, s46
v_accvgpr_write_b32 a36, v64
v_perm_b32 v68, v31, v30, s47
v_accvgpr_write_b32 a44, v68
s_barrier
s_mov_b32 s12, s92
s_and_b32 s13, s93, 0xffff
s_mov_b32 s14, 4718592
s_mov_b32 s15, 0x20000
s_mov_b32 s20, 1048576
buffer_load_dword v30, v1, s[12:15], s20 offen
s_mov_b32 s21, 1081344
buffer_load_dword v31, v1, s[12:15], s21 offen
s_waitcnt vmcnt(55)
v_perm_b32 v65, v33, v32, s46
v_accvgpr_write_b32 a37, v65
v_perm_b32 v69, v33, v32, s47
v_accvgpr_write_b32 a45, v69
s_mov_b32 s20, 1114112
buffer_load_dword v32, v1, s[12:15], s20 offen
s_mov_b32 s21, 1146880
buffer_load_dword v33, v1, s[12:15], s21 offen
s_waitcnt vmcnt(55)
v_perm_b32 v66, v35, v34, s46
v_accvgpr_write_b32 a38, v66
v_perm_b32 v70, v35, v34, s47
v_accvgpr_write_b32 a46, v70
s_mov_b32 s20, 1056768
buffer_load_dword v34, v1, s[12:15], s20 offen
s_mov_b32 s21, 1089536
buffer_load_dword v35, v1, s[12:15], s21 offen
s_waitcnt vmcnt(55)
v_perm_b32 v67, v37, v36, s46
v_accvgpr_write_b32 a39, v67
v_perm_b32 v71, v37, v36, s47
v_accvgpr_write_b32 a47, v71
s_mov_b32 s20, 1122304
buffer_load_dword v36, v1, s[12:15], s20 offen
s_mov_b32 s21, 1155072
buffer_load_dword v37, v1, s[12:15], s21 offen
s_waitcnt vmcnt(55)
v_perm_b32 v112, v39, v38, s46
v_perm_b32 v68, v39, v38, s47
s_barrier
s_mov_b32 s20, 1310720
buffer_load_dword v38, v1, s[12:15], s20 offen
s_mov_b32 s21, 1343488
buffer_load_dword v39, v1, s[12:15], s21 offen
s_waitcnt vmcnt(55)
v_perm_b32 v113, v41, v40, s46
v_perm_b32 v69, v41, v40, s47
s_mov_b32 s20, 1376256
buffer_load_dword v40, v1, s[12:15], s20 offen
s_mov_b32 s21, 1409024
buffer_load_dword v41, v1, s[12:15], s21 offen
s_waitcnt vmcnt(55)
v_perm_b32 v114, v43, v42, s46
v_perm_b32 v70, v43, v42, s47
s_mov_b32 s20, 1318912
buffer_load_dword v42, v1, s[12:15], s20 offen
s_mov_b32 s21, 1351680
buffer_load_dword v43, v1, s[12:15], s21 offen
s_waitcnt vmcnt(55)
v_perm_b32 v115, v45, v44, s46
v_perm_b32 v71, v45, v44, s47
ds_write_b128 v3, v[68:71] offset:2048
s_waitcnt lgkmcnt(0)
s_mov_b32 s20, 1384448
buffer_load_dword v44, v1, s[12:15], s20 offen
s_mov_b32 s21, 1417216
buffer_load_dword v45, v1, s[12:15], s21 offen
s_waitcnt vmcnt(55)
v_perm_b32 v116, v47, v46, s46
v_perm_b32 v68, v47, v46, s47
s_barrier
s_mov_b32 s12, s90
s_and_b32 s13, s91, 0xffff
s_mov_b32 s14, 4718592
s_mov_b32 s15, 0x20000
s_mov_b32 s20, 1572864
buffer_load_dword v46, v1, s[12:15], s20 offen
s_mov_b32 s21, 1605632
buffer_load_dword v47, v1, s[12:15], s21 offen
s_waitcnt vmcnt(55)
v_perm_b32 v117, v49, v48, s46
v_perm_b32 v69, v49, v48, s47
s_mov_b32 s20, 1638400
buffer_load_dword v48, v1, s[12:15], s20 offen
s_mov_b32 s21, 1671168
buffer_load_dword v49, v1, s[12:15], s21 offen
s_waitcnt vmcnt(55)
v_perm_b32 v118, v51, v50, s46
v_perm_b32 v70, v51, v50, s47
s_mov_b32 s20, 1581056
buffer_load_dword v50, v1, s[12:15], s20 offen
s_mov_b32 s21, 1613824
buffer_load_dword v51, v1, s[12:15], s21 offen
s_waitcnt vmcnt(55)
v_perm_b32 v119, v53, v52, s46
v_perm_b32 v71, v53, v52, s47
ds_write_b128 v3, v[68:71] offset:3072
s_waitcnt lgkmcnt(0)
s_mov_b32 s20, 1646592
buffer_load_dword v52, v1, s[12:15], s20 offen
s_mov_b32 s21, 1679360
buffer_load_dword v53, v1, s[12:15], s21 offen
s_waitcnt vmcnt(55)
v_perm_b32 v64, v55, v54, s46
v_accvgpr_write_b32 a48, v64
v_perm_b32 v68, v55, v54, s47
v_accvgpr_write_b32 a56, v68
s_barrier
s_mov_b32 s20, 1835008
buffer_load_dword v54, v1, s[12:15], s20 offen
s_mov_b32 s21, 1867776
buffer_load_dword v55, v1, s[12:15], s21 offen
s_waitcnt vmcnt(55)
v_perm_b32 v65, v57, v56, s46
v_accvgpr_write_b32 a49, v65
v_perm_b32 v69, v57, v56, s47
v_accvgpr_write_b32 a57, v69
s_mov_b32 s20, 1900544
buffer_load_dword v56, v1, s[12:15], s20 offen
s_mov_b32 s21, 1933312
buffer_load_dword v57, v1, s[12:15], s21 offen
s_waitcnt vmcnt(55)
v_perm_b32 v66, v59, v58, s46
v_accvgpr_write_b32 a50, v66
v_perm_b32 v70, v59, v58, s47
v_accvgpr_write_b32 a58, v70
s_mov_b32 s20, 1843200
buffer_load_dword v58, v1, s[12:15], s20 offen
s_mov_b32 s21, 1875968
buffer_load_dword v59, v1, s[12:15], s21 offen
s_waitcnt vmcnt(55)
v_perm_b32 v67, v61, v60, s46
v_accvgpr_write_b32 a51, v67
v_perm_b32 v71, v61, v60, s47
v_accvgpr_write_b32 a59, v71
s_mov_b32 s20, 1908736
buffer_load_dword v60, v1, s[12:15], s20 offen
s_mov_b32 s21, 1941504
buffer_load_dword v61, v1, s[12:15], s21 offen
s_waitcnt vmcnt(55)
v_perm_b32 v64, v7, v6, s46
v_accvgpr_write_b32 a52, v64
v_perm_b32 v68, v7, v6, s47
v_accvgpr_write_b32 a60, v68
s_barrier
s_mov_b32 s12, s92
s_and_b32 s13, s93, 0xffff
s_mov_b32 s14, 4718592
s_mov_b32 s15, 0x20000
s_mov_b32 s20, 1572864
buffer_load_dword v6, v1, s[12:15], s20 offen
s_mov_b32 s21, 1605632
buffer_load_dword v7, v1, s[12:15], s21 offen
s_waitcnt vmcnt(55)
v_perm_b32 v65, v9, v8, s46
v_accvgpr_write_b32 a53, v65
v_perm_b32 v69, v9, v8, s47
v_accvgpr_write_b32 a61, v69
s_mov_b32 s20, 1638400
buffer_load_dword v8, v1, s[12:15], s20 offen
s_mov_b32 s21, 1671168
buffer_load_dword v9, v1, s[12:15], s21 offen
s_waitcnt vmcnt(55)
v_perm_b32 v66, v11, v10, s46
v_accvgpr_write_b32 a54, v66
v_perm_b32 v70, v11, v10, s47
v_accvgpr_write_b32 a62, v70
s_mov_b32 s20, 1581056
buffer_load_dword v10, v1, s[12:15], s20 offen
s_mov_b32 s21, 1613824
buffer_load_dword v11, v1, s[12:15], s21 offen
s_waitcnt vmcnt(55)
v_perm_b32 v67, v13, v12, s46
v_accvgpr_write_b32 a55, v67
v_perm_b32 v71, v13, v12, s47
v_accvgpr_write_b32 a63, v71
s_mov_b32 s20, 1646592
buffer_load_dword v12, v1, s[12:15], s20 offen
s_mov_b32 s21, 1679360
buffer_load_dword v13, v1, s[12:15], s21 offen
s_waitcnt vmcnt(54)
v_perm_b32 v136, v15, v14, s46
v_perm_b32 v68, v15, v14, s47
s_barrier
s_mov_b32 s20, 1835008
buffer_load_dword v14, v1, s[12:15], s20 offen
s_mov_b32 s21, 1867776
buffer_load_dword v15, v1, s[12:15], s21 offen
s_waitcnt vmcnt(54)
v_perm_b32 v137, v17, v16, s46
v_perm_b32 v69, v17, v16, s47
s_mov_b32 s20, 1900544
buffer_load_dword v16, v1, s[12:15], s20 offen
s_mov_b32 s21, 1933312
buffer_load_dword v17, v1, s[12:15], s21 offen
s_waitcnt vmcnt(54)
v_perm_b32 v138, v19, v18, s46
v_perm_b32 v70, v19, v18, s47
s_mov_b32 s20, 1843200
buffer_load_dword v18, v1, s[12:15], s20 offen
s_mov_b32 s21, 1875968
buffer_load_dword v19, v1, s[12:15], s21 offen
s_waitcnt vmcnt(54)
v_perm_b32 v139, v21, v20, s46
v_perm_b32 v71, v21, v20, s47
ds_write_b128 v3, v[68:71] offset:4096
s_waitcnt lgkmcnt(0)
s_mov_b32 s20, 1908736
buffer_load_dword v20, v1, s[12:15], s20 offen
s_mov_b32 s21, 1941504
buffer_load_dword v21, v1, s[12:15], s21 offen
s_waitcnt vmcnt(54)
v_perm_b32 v140, v23, v22, s46
v_perm_b32 v68, v23, v22, s47
s_barrier
s_mov_b32 s12, s90
s_and_b32 s13, s91, 0xffff
s_mov_b32 s14, 4718592
s_mov_b32 s15, 0x20000
s_mov_b32 s20, 2097152
buffer_load_dword v22, v1, s[12:15], s20 offen
s_mov_b32 s21, 2129920
buffer_load_dword v23, v1, s[12:15], s21 offen
s_waitcnt vmcnt(54)
v_perm_b32 v141, v25, v24, s46
v_perm_b32 v69, v25, v24, s47
s_mov_b32 s20, 2162688
buffer_load_dword v24, v1, s[12:15], s20 offen
s_mov_b32 s21, 2195456
buffer_load_dword v25, v1, s[12:15], s21 offen
s_waitcnt vmcnt(54)
v_perm_b32 v142, v27, v26, s46
v_perm_b32 v70, v27, v26, s47
s_mov_b32 s20, 2105344
buffer_load_dword v26, v1, s[12:15], s20 offen
s_mov_b32 s21, 2138112
buffer_load_dword v27, v1, s[12:15], s21 offen
s_waitcnt vmcnt(54)
v_perm_b32 v143, v29, v28, s46
v_perm_b32 v71, v29, v28, s47
ds_write_b128 v3, v[68:71] offset:5120
s_waitcnt lgkmcnt(0)
s_mov_b32 s20, 2170880
buffer_load_dword v28, v1, s[12:15], s20 offen
s_mov_b32 s21, 2203648
buffer_load_dword v29, v1, s[12:15], s21 offen
s_waitcnt vmcnt(54)
v_perm_b32 v64, v31, v30, s46
v_accvgpr_write_b32 a64, v64
v_perm_b32 v68, v31, v30, s47
v_accvgpr_write_b32 a72, v68
s_barrier
s_mov_b32 s20, 2359296
buffer_load_dword v30, v1, s[12:15], s20 offen
s_mov_b32 s21, 2392064
buffer_load_dword v31, v1, s[12:15], s21 offen
s_waitcnt vmcnt(54)
v_perm_b32 v65, v33, v32, s46
v_accvgpr_write_b32 a65, v65
v_perm_b32 v69, v33, v32, s47
v_accvgpr_write_b32 a73, v69
s_mov_b32 s20, 2424832
buffer_load_dword v32, v1, s[12:15], s20 offen
s_mov_b32 s21, 2457600
buffer_load_dword v33, v1, s[12:15], s21 offen
s_waitcnt vmcnt(54)
v_perm_b32 v66, v35, v34, s46
v_accvgpr_write_b32 a66, v66
v_perm_b32 v70, v35, v34, s47
v_accvgpr_write_b32 a74, v70
s_mov_b32 s20, 2367488
buffer_load_dword v34, v1, s[12:15], s20 offen
s_mov_b32 s21, 2400256
buffer_load_dword v35, v1, s[12:15], s21 offen
s_waitcnt vmcnt(54)
v_perm_b32 v67, v37, v36, s46
v_accvgpr_write_b32 a67, v67
v_perm_b32 v71, v37, v36, s47
v_accvgpr_write_b32 a75, v71
s_mov_b32 s20, 2433024
buffer_load_dword v36, v1, s[12:15], s20 offen
s_mov_b32 s21, 2465792
buffer_load_dword v37, v1, s[12:15], s21 offen
s_waitcnt vmcnt(54)
v_perm_b32 v64, v39, v38, s46
v_accvgpr_write_b32 a68, v64
v_perm_b32 v68, v39, v38, s47
v_accvgpr_write_b32 a76, v68
s_barrier
s_mov_b32 s12, s92
s_and_b32 s13, s93, 0xffff
s_mov_b32 s14, 4718592
s_mov_b32 s15, 0x20000
s_mov_b32 s20, 2097152
buffer_load_dword v38, v1, s[12:15], s20 offen
s_mov_b32 s21, 2129920
buffer_load_dword v39, v1, s[12:15], s21 offen
s_waitcnt vmcnt(54)
v_perm_b32 v65, v41, v40, s46
v_accvgpr_write_b32 a69, v65
v_perm_b32 v69, v41, v40, s47
v_accvgpr_write_b32 a77, v69
s_mov_b32 s20, 2162688
buffer_load_dword v40, v1, s[12:15], s20 offen
s_mov_b32 s21, 2195456
buffer_load_dword v41, v1, s[12:15], s21 offen
s_waitcnt vmcnt(54)
v_perm_b32 v66, v43, v42, s46
v_accvgpr_write_b32 a70, v66
v_perm_b32 v70, v43, v42, s47
v_accvgpr_write_b32 a78, v70
s_mov_b32 s20, 2105344
buffer_load_dword v42, v1, s[12:15], s20 offen
s_mov_b32 s21, 2138112
buffer_load_dword v43, v1, s[12:15], s21 offen
s_waitcnt vmcnt(54)
v_perm_b32 v67, v45, v44, s46
v_accvgpr_write_b32 a71, v67
v_perm_b32 v71, v45, v44, s47
v_accvgpr_write_b32 a79, v71
s_mov_b32 s20, 2170880
buffer_load_dword v44, v1, s[12:15], s20 offen
s_mov_b32 s21, 2203648
buffer_load_dword v45, v1, s[12:15], s21 offen
s_waitcnt vmcnt(54)
v_perm_b32 v160, v47, v46, s46
v_perm_b32 v68, v47, v46, s47
s_barrier
s_mov_b32 s20, 2359296
buffer_load_dword v46, v1, s[12:15], s20 offen
s_mov_b32 s21, 2392064
buffer_load_dword v47, v1, s[12:15], s21 offen
s_waitcnt vmcnt(54)
v_perm_b32 v161, v49, v48, s46
v_perm_b32 v69, v49, v48, s47
s_mov_b32 s20, 2424832
buffer_load_dword v48, v1, s[12:15], s20 offen
s_mov_b32 s21, 2457600
buffer_load_dword v49, v1, s[12:15], s21 offen
s_waitcnt vmcnt(54)
v_perm_b32 v162, v51, v50, s46
v_perm_b32 v70, v51, v50, s47
s_mov_b32 s20, 2367488
buffer_load_dword v50, v1, s[12:15], s20 offen
s_mov_b32 s21, 2400256
buffer_load_dword v51, v1, s[12:15], s21 offen
s_waitcnt vmcnt(54)
v_perm_b32 v163, v53, v52, s46
v_perm_b32 v71, v53, v52, s47
ds_write_b128 v3, v[68:71] offset:6144
s_waitcnt lgkmcnt(0)
s_mov_b32 s20, 2433024
buffer_load_dword v52, v1, s[12:15], s20 offen
s_mov_b32 s21, 2465792
buffer_load_dword v53, v1, s[12:15], s21 offen
s_waitcnt vmcnt(54)
v_perm_b32 v164, v55, v54, s46
v_perm_b32 v68, v55, v54, s47
s_barrier
s_mov_b32 s12, s90
s_and_b32 s13, s91, 0xffff
s_mov_b32 s14, 4718592
s_mov_b32 s15, 0x20000
s_mov_b32 s20, 2621440
buffer_load_dword v54, v1, s[12:15], s20 offen
s_mov_b32 s21, 2654208
buffer_load_dword v55, v1, s[12:15], s21 offen
s_waitcnt vmcnt(54)
v_perm_b32 v165, v57, v56, s46
v_perm_b32 v69, v57, v56, s47
s_mov_b32 s20, 2686976
buffer_load_dword v56, v1, s[12:15], s20 offen
s_mov_b32 s21, 2719744
buffer_load_dword v57, v1, s[12:15], s21 offen
s_waitcnt vmcnt(54)
v_perm_b32 v166, v59, v58, s46
v_perm_b32 v70, v59, v58, s47
s_mov_b32 s20, 2629632
buffer_load_dword v58, v1, s[12:15], s20 offen
s_mov_b32 s21, 2662400
buffer_load_dword v59, v1, s[12:15], s21 offen
s_waitcnt vmcnt(54)
v_perm_b32 v167, v61, v60, s46
v_perm_b32 v71, v61, v60, s47
ds_write_b128 v3, v[68:71] offset:7168
s_waitcnt lgkmcnt(0)
s_mov_b32 s20, 2695168
buffer_load_dword v60, v1, s[12:15], s20 offen
s_mov_b32 s21, 2727936
buffer_load_dword v61, v1, s[12:15], s21 offen
s_waitcnt vmcnt(54)
v_perm_b32 v64, v7, v6, s46
v_accvgpr_write_b32 a80, v64
v_perm_b32 v68, v7, v6, s47
v_accvgpr_write_b32 a88, v68
s_barrier
s_mov_b32 s20, 2883584
buffer_load_dword v6, v1, s[12:15], s20 offen
s_mov_b32 s21, 2916352
buffer_load_dword v7, v1, s[12:15], s21 offen
s_waitcnt vmcnt(54)
v_perm_b32 v65, v9, v8, s46
v_accvgpr_write_b32 a81, v65
v_perm_b32 v69, v9, v8, s47
v_accvgpr_write_b32 a89, v69
s_mov_b32 s20, 2949120
buffer_load_dword v8, v1, s[12:15], s20 offen
s_mov_b32 s21, 2981888
buffer_load_dword v9, v1, s[12:15], s21 offen
s_waitcnt vmcnt(54)
v_perm_b32 v66, v11, v10, s46
v_accvgpr_write_b32 a82, v66
v_perm_b32 v70, v11, v10, s47
v_accvgpr_write_b32 a90, v70
s_mov_b32 s20, 2891776
buffer_load_dword v10, v1, s[12:15], s20 offen
s_mov_b32 s21, 2924544
buffer_load_dword v11, v1, s[12:15], s21 offen
s_waitcnt vmcnt(54)
v_perm_b32 v67, v13, v12, s46
v_accvgpr_write_b32 a83, v67
v_perm_b32 v71, v13, v12, s47
v_accvgpr_write_b32 a91, v71
s_mov_b32 s20, 2957312
buffer_load_dword v12, v1, s[12:15], s20 offen
s_mov_b32 s21, 2990080
buffer_load_dword v13, v1, s[12:15], s21 offen
s_waitcnt vmcnt(54)
v_perm_b32 v64, v15, v14, s46
v_accvgpr_write_b32 a84, v64
v_perm_b32 v68, v15, v14, s47
v_accvgpr_write_b32 a92, v68
s_barrier
s_mov_b32 s12, s92
s_and_b32 s13, s93, 0xffff
s_mov_b32 s14, 4718592
s_mov_b32 s15, 0x20000
s_mov_b32 s20, 2621440
buffer_load_dword v14, v1, s[12:15], s20 offen
s_mov_b32 s21, 2654208
buffer_load_dword v15, v1, s[12:15], s21 offen
s_waitcnt vmcnt(54)
v_perm_b32 v65, v17, v16, s46
v_accvgpr_write_b32 a85, v65
v_perm_b32 v69, v17, v16, s47
v_accvgpr_write_b32 a93, v69
s_mov_b32 s20, 2686976
buffer_load_dword v16, v1, s[12:15], s20 offen
s_mov_b32 s21, 2719744
buffer_load_dword v17, v1, s[12:15], s21 offen
s_waitcnt vmcnt(54)
v_perm_b32 v66, v19, v18, s46
v_accvgpr_write_b32 a86, v66
v_perm_b32 v70, v19, v18, s47
v_accvgpr_write_b32 a94, v70
s_mov_b32 s20, 2629632
buffer_load_dword v18, v1, s[12:15], s20 offen
s_mov_b32 s21, 2662400
buffer_load_dword v19, v1, s[12:15], s21 offen
s_waitcnt vmcnt(54)
v_perm_b32 v67, v21, v20, s46
v_accvgpr_write_b32 a87, v67
v_perm_b32 v71, v21, v20, s47
v_accvgpr_write_b32 a95, v71
s_mov_b32 s20, 2695168
buffer_load_dword v20, v1, s[12:15], s20 offen
s_mov_b32 s21, 2727936
buffer_load_dword v21, v1, s[12:15], s21 offen
s_waitcnt vmcnt(54)
v_perm_b32 v184, v23, v22, s46
v_perm_b32 v68, v23, v22, s47
s_barrier
s_mov_b32 s20, 2883584
buffer_load_dword v22, v1, s[12:15], s20 offen
s_mov_b32 s21, 2916352
buffer_load_dword v23, v1, s[12:15], s21 offen
s_waitcnt vmcnt(54)
v_perm_b32 v185, v25, v24, s46
v_perm_b32 v69, v25, v24, s47
s_mov_b32 s20, 2949120
buffer_load_dword v24, v1, s[12:15], s20 offen
s_mov_b32 s21, 2981888
buffer_load_dword v25, v1, s[12:15], s21 offen
s_waitcnt vmcnt(54)
v_perm_b32 v186, v27, v26, s46
v_perm_b32 v70, v27, v26, s47
s_mov_b32 s20, 2891776
buffer_load_dword v26, v1, s[12:15], s20 offen
s_mov_b32 s21, 2924544
buffer_load_dword v27, v1, s[12:15], s21 offen
s_waitcnt vmcnt(54)
v_perm_b32 v187, v29, v28, s46
v_perm_b32 v71, v29, v28, s47
ds_write_b128 v3, v[68:71] offset:8192
s_waitcnt lgkmcnt(0)
s_mov_b32 s20, 2957312
buffer_load_dword v28, v1, s[12:15], s20 offen
s_mov_b32 s21, 2990080
buffer_load_dword v29, v1, s[12:15], s21 offen
s_waitcnt vmcnt(54)
v_perm_b32 v188, v31, v30, s46
v_perm_b32 v68, v31, v30, s47
s_barrier
s_mov_b32 s12, s90
s_and_b32 s13, s91, 0xffff
s_mov_b32 s14, 4718592
s_mov_b32 s15, 0x20000
s_mov_b32 s20, 3145728
buffer_load_dword v30, v1, s[12:15], s20 offen
s_mov_b32 s21, 3178496
buffer_load_dword v31, v1, s[12:15], s21 offen
s_waitcnt vmcnt(54)
v_perm_b32 v189, v33, v32, s46
v_perm_b32 v69, v33, v32, s47
s_mov_b32 s20, 3211264
buffer_load_dword v32, v1, s[12:15], s20 offen
s_mov_b32 s21, 3244032
buffer_load_dword v33, v1, s[12:15], s21 offen
s_waitcnt vmcnt(54)
v_perm_b32 v190, v35, v34, s46
v_perm_b32 v70, v35, v34, s47
s_mov_b32 s20, 3153920
buffer_load_dword v34, v1, s[12:15], s20 offen
s_mov_b32 s21, 3186688
buffer_load_dword v35, v1, s[12:15], s21 offen
s_waitcnt vmcnt(54)
v_perm_b32 v191, v37, v36, s46
v_perm_b32 v71, v37, v36, s47
ds_write_b128 v3, v[68:71] offset:9216
s_waitcnt lgkmcnt(0)
s_mov_b32 s20, 3219456
buffer_load_dword v36, v1, s[12:15], s20 offen
s_mov_b32 s21, 3252224
buffer_load_dword v37, v1, s[12:15], s21 offen
s_waitcnt vmcnt(54)
v_perm_b32 v64, v39, v38, s46
v_accvgpr_write_b32 a96, v64
v_perm_b32 v68, v39, v38, s47
v_accvgpr_write_b32 a104, v68
s_barrier
s_mov_b32 s20, 3407872
buffer_load_dword v38, v1, s[12:15], s20 offen
s_mov_b32 s21, 3440640
buffer_load_dword v39, v1, s[12:15], s21 offen
s_waitcnt vmcnt(54)
v_perm_b32 v65, v41, v40, s46
v_accvgpr_write_b32 a97, v65
v_perm_b32 v69, v41, v40, s47
v_accvgpr_write_b32 a105, v69
s_mov_b32 s20, 3473408
buffer_load_dword v40, v1, s[12:15], s20 offen
s_mov_b32 s21, 3506176
buffer_load_dword v41, v1, s[12:15], s21 offen
s_waitcnt vmcnt(54)
v_perm_b32 v66, v43, v42, s46
v_accvgpr_write_b32 a98, v66
v_perm_b32 v70, v43, v42, s47
v_accvgpr_write_b32 a106, v70
s_mov_b32 s20, 3416064
buffer_load_dword v42, v1, s[12:15], s20 offen
s_mov_b32 s21, 3448832
buffer_load_dword v43, v1, s[12:15], s21 offen
s_waitcnt vmcnt(54)
v_perm_b32 v67, v45, v44, s46
v_accvgpr_write_b32 a99, v67
v_perm_b32 v71, v45, v44, s47
v_accvgpr_write_b32 a107, v71
s_mov_b32 s20, 3481600
buffer_load_dword v44, v1, s[12:15], s20 offen
s_mov_b32 s21, 3514368
buffer_load_dword v45, v1, s[12:15], s21 offen
s_waitcnt vmcnt(54)
v_perm_b32 v64, v47, v46, s46
v_accvgpr_write_b32 a100, v64
v_perm_b32 v68, v47, v46, s47
v_accvgpr_write_b32 a108, v68
s_barrier
s_mov_b32 s12, s92
s_and_b32 s13, s93, 0xffff
s_mov_b32 s14, 4718592
s_mov_b32 s15, 0x20000
s_mov_b32 s20, 3145728
buffer_load_dword v46, v1, s[12:15], s20 offen
s_mov_b32 s21, 3178496
buffer_load_dword v47, v1, s[12:15], s21 offen
s_waitcnt vmcnt(54)
v_perm_b32 v65, v49, v48, s46
v_accvgpr_write_b32 a101, v65
v_perm_b32 v69, v49, v48, s47
v_accvgpr_write_b32 a109, v69
s_mov_b32 s20, 3211264
buffer_load_dword v48, v1, s[12:15], s20 offen
s_mov_b32 s21, 3244032
buffer_load_dword v49, v1, s[12:15], s21 offen
s_waitcnt vmcnt(54)
v_perm_b32 v66, v51, v50, s46
v_accvgpr_write_b32 a102, v66
v_perm_b32 v70, v51, v50, s47
v_accvgpr_write_b32 a110, v70
s_mov_b32 s20, 3153920
buffer_load_dword v50, v1, s[12:15], s20 offen
s_mov_b32 s21, 3186688
buffer_load_dword v51, v1, s[12:15], s21 offen
s_waitcnt vmcnt(54)
v_perm_b32 v67, v53, v52, s46
v_accvgpr_write_b32 a103, v67
v_perm_b32 v71, v53, v52, s47
v_accvgpr_write_b32 a111, v71
s_mov_b32 s20, 3219456
buffer_load_dword v52, v1, s[12:15], s20 offen
s_mov_b32 s21, 3252224
buffer_load_dword v53, v1, s[12:15], s21 offen
s_waitcnt vmcnt(54)
v_perm_b32 v208, v55, v54, s46
v_perm_b32 v68, v55, v54, s47
s_barrier
s_mov_b32 s20, 3407872
buffer_load_dword v54, v1, s[12:15], s20 offen
s_mov_b32 s21, 3440640
buffer_load_dword v55, v1, s[12:15], s21 offen
s_waitcnt vmcnt(54)
v_perm_b32 v209, v57, v56, s46
v_perm_b32 v69, v57, v56, s47
s_mov_b32 s20, 3473408
buffer_load_dword v56, v1, s[12:15], s20 offen
s_mov_b32 s21, 3506176
buffer_load_dword v57, v1, s[12:15], s21 offen
s_waitcnt vmcnt(54)
v_perm_b32 v210, v59, v58, s46
v_perm_b32 v70, v59, v58, s47
s_mov_b32 s20, 3416064
buffer_load_dword v58, v1, s[12:15], s20 offen
s_mov_b32 s21, 3448832
buffer_load_dword v59, v1, s[12:15], s21 offen
s_waitcnt vmcnt(54)
v_perm_b32 v211, v61, v60, s46
v_perm_b32 v71, v61, v60, s47
ds_write_b128 v3, v[68:71] offset:10240
s_waitcnt lgkmcnt(0)
s_mov_b32 s20, 3481600
buffer_load_dword v60, v1, s[12:15], s20 offen
s_mov_b32 s21, 3514368
buffer_load_dword v61, v1, s[12:15], s21 offen
s_waitcnt vmcnt(54)
v_perm_b32 v212, v7, v6, s46
v_perm_b32 v68, v7, v6, s47
s_barrier
s_mov_b32 s12, s90
s_and_b32 s13, s91, 0xffff
s_mov_b32 s14, 4718592
s_mov_b32 s15, 0x20000
s_mov_b32 s20, 3670016
buffer_load_dword v6, v1, s[12:15], s20 offen
s_mov_b32 s21, 3702784
buffer_load_dword v7, v1, s[12:15], s21 offen
s_waitcnt vmcnt(54)
v_perm_b32 v213, v9, v8, s46
v_perm_b32 v69, v9, v8, s47
s_mov_b32 s20, 3735552
buffer_load_dword v8, v1, s[12:15], s20 offen
s_mov_b32 s21, 3768320
buffer_load_dword v9, v1, s[12:15], s21 offen
s_waitcnt vmcnt(54)
v_perm_b32 v214, v11, v10, s46
v_perm_b32 v70, v11, v10, s47
s_mov_b32 s20, 3678208
buffer_load_dword v10, v1, s[12:15], s20 offen
s_mov_b32 s21, 3710976
buffer_load_dword v11, v1, s[12:15], s21 offen
s_waitcnt vmcnt(54)
v_perm_b32 v215, v13, v12, s46
v_perm_b32 v71, v13, v12, s47
ds_write_b128 v3, v[68:71] offset:11264
s_waitcnt lgkmcnt(0)
s_mov_b32 s20, 3743744
buffer_load_dword v12, v1, s[12:15], s20 offen
s_mov_b32 s21, 3776512
buffer_load_dword v13, v1, s[12:15], s21 offen
s_waitcnt vmcnt(54)
v_perm_b32 v64, v15, v14, s46
v_accvgpr_write_b32 a112, v64
v_perm_b32 v68, v15, v14, s47
v_accvgpr_write_b32 a120, v68
s_barrier
s_mov_b32 s20, 3932160
buffer_load_dword v14, v1, s[12:15], s20 offen
s_mov_b32 s21, 3964928
buffer_load_dword v15, v1, s[12:15], s21 offen
s_waitcnt vmcnt(54)
v_perm_b32 v65, v17, v16, s46
v_accvgpr_write_b32 a113, v65
v_perm_b32 v69, v17, v16, s47
v_accvgpr_write_b32 a121, v69
s_mov_b32 s20, 3997696
buffer_load_dword v16, v1, s[12:15], s20 offen
s_mov_b32 s21, 4030464
buffer_load_dword v17, v1, s[12:15], s21 offen
s_waitcnt vmcnt(54)
v_perm_b32 v66, v19, v18, s46
v_accvgpr_write_b32 a114, v66
v_perm_b32 v70, v19, v18, s47
v_accvgpr_write_b32 a122, v70
s_mov_b32 s20, 3940352
buffer_load_dword v18, v1, s[12:15], s20 offen
s_mov_b32 s21, 3973120
buffer_load_dword v19, v1, s[12:15], s21 offen
s_waitcnt vmcnt(54)
v_perm_b32 v67, v21, v20, s46
v_accvgpr_write_b32 a115, v67
v_perm_b32 v71, v21, v20, s47
v_accvgpr_write_b32 a123, v71
s_mov_b32 s20, 4005888
buffer_load_dword v20, v1, s[12:15], s20 offen
s_mov_b32 s21, 4038656
buffer_load_dword v21, v1, s[12:15], s21 offen
s_waitcnt vmcnt(54)
v_perm_b32 v64, v23, v22, s46
v_accvgpr_write_b32 a116, v64
v_perm_b32 v68, v23, v22, s47
v_accvgpr_write_b32 a124, v68
s_barrier
s_mov_b32 s12, s92
s_and_b32 s13, s93, 0xffff
s_mov_b32 s14, 4718592
s_mov_b32 s15, 0x20000
s_mov_b32 s20, 3670016
buffer_load_dword v22, v1, s[12:15], s20 offen
s_mov_b32 s21, 3702784
buffer_load_dword v23, v1, s[12:15], s21 offen
s_waitcnt vmcnt(54)
v_perm_b32 v65, v25, v24, s46
v_accvgpr_write_b32 a117, v65
v_perm_b32 v69, v25, v24, s47
v_accvgpr_write_b32 a125, v69
s_mov_b32 s20, 3735552
buffer_load_dword v24, v1, s[12:15], s20 offen
s_mov_b32 s21, 3768320
buffer_load_dword v25, v1, s[12:15], s21 offen
s_waitcnt vmcnt(54)
v_perm_b32 v66, v27, v26, s46
v_accvgpr_write_b32 a118, v66
v_perm_b32 v70, v27, v26, s47
v_accvgpr_write_b32 a126, v70
s_mov_b32 s20, 3678208
buffer_load_dword v26, v1, s[12:15], s20 offen
s_mov_b32 s21, 3710976
buffer_load_dword v27, v1, s[12:15], s21 offen
s_waitcnt vmcnt(54)
v_perm_b32 v67, v29, v28, s46
v_accvgpr_write_b32 a119, v67
v_perm_b32 v71, v29, v28, s47
v_accvgpr_write_b32 a127, v71
s_mov_b32 s20, 3743744
buffer_load_dword v28, v1, s[12:15], s20 offen
s_mov_b32 s21, 3776512
buffer_load_dword v29, v1, s[12:15], s21 offen
s_waitcnt vmcnt(54)
v_perm_b32 v232, v31, v30, s46
v_perm_b32 v68, v31, v30, s47
s_barrier
s_mov_b32 s20, 3932160
buffer_load_dword v30, v1, s[12:15], s20 offen
s_mov_b32 s21, 3964928
buffer_load_dword v31, v1, s[12:15], s21 offen
s_waitcnt vmcnt(54)
v_perm_b32 v233, v33, v32, s46
v_perm_b32 v69, v33, v32, s47
s_mov_b32 s20, 3997696
buffer_load_dword v32, v1, s[12:15], s20 offen
s_mov_b32 s21, 4030464
buffer_load_dword v33, v1, s[12:15], s21 offen
s_waitcnt vmcnt(54)
v_perm_b32 v234, v35, v34, s46
v_perm_b32 v70, v35, v34, s47
s_mov_b32 s20, 3940352
buffer_load_dword v34, v1, s[12:15], s20 offen
s_mov_b32 s21, 3973120
buffer_load_dword v35, v1, s[12:15], s21 offen
s_waitcnt vmcnt(54)
v_perm_b32 v235, v37, v36, s46
v_perm_b32 v71, v37, v36, s47
ds_write_b128 v3, v[68:71] offset:12288
s_waitcnt lgkmcnt(0)
s_mov_b32 s20, 4005888
buffer_load_dword v36, v1, s[12:15], s20 offen
s_mov_b32 s21, 4038656
buffer_load_dword v37, v1, s[12:15], s21 offen
s_waitcnt vmcnt(54)
v_perm_b32 v236, v39, v38, s46
v_perm_b32 v68, v39, v38, s47
s_barrier
s_mov_b32 s12, s90
s_and_b32 s13, s91, 0xffff
s_mov_b32 s14, 4718592
s_mov_b32 s15, 0x20000
s_mov_b32 s20, 4194304
buffer_load_dword v38, v1, s[12:15], s20 offen
s_mov_b32 s21, 4227072
buffer_load_dword v39, v1, s[12:15], s21 offen
s_waitcnt vmcnt(54)
v_perm_b32 v237, v41, v40, s46
v_perm_b32 v69, v41, v40, s47
s_mov_b32 s20, 4259840
buffer_load_dword v40, v1, s[12:15], s20 offen
s_mov_b32 s21, 4292608
buffer_load_dword v41, v1, s[12:15], s21 offen
s_waitcnt vmcnt(54)
v_perm_b32 v238, v43, v42, s46
v_perm_b32 v70, v43, v42, s47
s_mov_b32 s20, 4202496
buffer_load_dword v42, v1, s[12:15], s20 offen
s_mov_b32 s21, 4235264
buffer_load_dword v43, v1, s[12:15], s21 offen
s_waitcnt vmcnt(54)
v_perm_b32 v239, v45, v44, s46
v_perm_b32 v71, v45, v44, s47
ds_write_b128 v3, v[68:71] offset:13312
s_waitcnt lgkmcnt(0)
s_mov_b32 s20, 4268032
buffer_load_dword v44, v1, s[12:15], s20 offen
s_mov_b32 s21, 4300800
buffer_load_dword v45, v1, s[12:15], s21 offen
s_waitcnt vmcnt(54)
v_perm_b32 v64, v47, v46, s46
v_accvgpr_write_b32 a128, v64
v_perm_b32 v68, v47, v46, s47
v_accvgpr_write_b32 a136, v68
s_barrier
s_mov_b32 s20, 4456448
buffer_load_dword v46, v1, s[12:15], s20 offen
s_mov_b32 s21, 4489216
buffer_load_dword v47, v1, s[12:15], s21 offen
s_waitcnt vmcnt(54)
v_perm_b32 v65, v49, v48, s46
v_accvgpr_write_b32 a129, v65
v_perm_b32 v69, v49, v48, s47
v_accvgpr_write_b32 a137, v69
s_mov_b32 s20, 4521984
buffer_load_dword v48, v1, s[12:15], s20 offen
s_mov_b32 s21, 4554752
buffer_load_dword v49, v1, s[12:15], s21 offen
s_waitcnt vmcnt(54)
v_perm_b32 v66, v51, v50, s46
v_accvgpr_write_b32 a130, v66
v_perm_b32 v70, v51, v50, s47
v_accvgpr_write_b32 a138, v70
s_mov_b32 s20, 4464640
buffer_load_dword v50, v1, s[12:15], s20 offen
s_mov_b32 s21, 4497408
buffer_load_dword v51, v1, s[12:15], s21 offen
s_waitcnt vmcnt(54)
v_perm_b32 v67, v53, v52, s46
v_accvgpr_write_b32 a131, v67
v_perm_b32 v71, v53, v52, s47
v_accvgpr_write_b32 a139, v71
s_mov_b32 s20, 4530176
buffer_load_dword v52, v1, s[12:15], s20 offen
s_mov_b32 s21, 4562944
buffer_load_dword v53, v1, s[12:15], s21 offen
s_waitcnt vmcnt(54)
v_perm_b32 v64, v55, v54, s46
v_accvgpr_write_b32 a132, v64
v_perm_b32 v68, v55, v54, s47
v_accvgpr_write_b32 a140, v68
s_barrier
s_mov_b32 s12, s92
s_and_b32 s13, s93, 0xffff
s_mov_b32 s14, 4718592
s_mov_b32 s15, 0x20000
s_mov_b32 s20, 4194304
buffer_load_dword v54, v1, s[12:15], s20 offen
s_mov_b32 s21, 4227072
buffer_load_dword v55, v1, s[12:15], s21 offen
s_waitcnt vmcnt(54)
v_perm_b32 v65, v57, v56, s46
v_accvgpr_write_b32 a133, v65
v_perm_b32 v69, v57, v56, s47
v_accvgpr_write_b32 a141, v69
s_mov_b32 s20, 4259840
buffer_load_dword v56, v1, s[12:15], s20 offen
s_mov_b32 s21, 4292608
buffer_load_dword v57, v1, s[12:15], s21 offen
s_waitcnt vmcnt(54)
v_perm_b32 v66, v59, v58, s46
v_accvgpr_write_b32 a134, v66
v_perm_b32 v70, v59, v58, s47
v_accvgpr_write_b32 a142, v70
s_mov_b32 s20, 4202496
buffer_load_dword v58, v1, s[12:15], s20 offen
s_mov_b32 s21, 4235264
buffer_load_dword v59, v1, s[12:15], s21 offen
s_waitcnt vmcnt(54)
v_perm_b32 v67, v61, v60, s46
v_accvgpr_write_b32 a135, v67
v_perm_b32 v71, v61, v60, s47
v_accvgpr_write_b32 a143, v71
s_mov_b32 s20, 4268032
buffer_load_dword v60, v1, s[12:15], s20 offen
s_mov_b32 s21, 4300800
buffer_load_dword v61, v1, s[12:15], s21 offen
s_waitcnt vmcnt(54)
v_perm_b32 v64, v7, v6, s46
v_accvgpr_write_b32 a0, v64
v_perm_b32 v68, v7, v6, s47
s_barrier
s_mov_b32 s20, 4456448
buffer_load_dword v6, v1, s[12:15], s20 offen
s_mov_b32 s21, 4489216
buffer_load_dword v7, v1, s[12:15], s21 offen
s_waitcnt vmcnt(54)
v_perm_b32 v65, v9, v8, s46
v_accvgpr_write_b32 a1, v65
v_perm_b32 v69, v9, v8, s47
s_mov_b32 s20, 4521984
buffer_load_dword v8, v1, s[12:15], s20 offen
s_mov_b32 s21, 4554752
buffer_load_dword v9, v1, s[12:15], s21 offen
s_waitcnt vmcnt(54)
v_perm_b32 v66, v11, v10, s46
v_accvgpr_write_b32 a2, v66
v_perm_b32 v70, v11, v10, s47
s_mov_b32 s20, 4464640
buffer_load_dword v10, v1, s[12:15], s20 offen
s_mov_b32 s21, 4497408
buffer_load_dword v11, v1, s[12:15], s21 offen
s_waitcnt vmcnt(54)
v_perm_b32 v67, v13, v12, s46
v_accvgpr_write_b32 a3, v67
v_perm_b32 v71, v13, v12, s47
ds_write_b128 v3, v[68:71] offset:14336
s_waitcnt lgkmcnt(0)
s_mov_b32 s20, 4530176
buffer_load_dword v12, v1, s[12:15], s20 offen
s_mov_b32 s21, 4562944
buffer_load_dword v13, v1, s[12:15], s21 offen
s_waitcnt vmcnt(54)
v_perm_b32 v64, v15, v14, s46
v_accvgpr_write_b32 a4, v64
v_perm_b32 v68, v15, v14, s47
s_barrier
s_mov_b32 s12, s94
s_and_b32 s13, s95, 0xffff
s_mov_b32 s14, 4718592
s_mov_b32 s15, 0x20000
s_mov_b32 s20, 0
buffer_load_dword v14, v4, s[12:15], s20 offen
s_mov_b32 s21, 1152
buffer_load_dword v15, v4, s[12:15], s21 offen
s_waitcnt vmcnt(54)
v_perm_b32 v65, v17, v16, s46
v_accvgpr_write_b32 a5, v65
v_perm_b32 v69, v17, v16, s47
s_mov_b32 s20, 9216
buffer_load_dword v16, v4, s[12:15], s20 offen
s_mov_b32 s21, 10368
buffer_load_dword v17, v4, s[12:15], s21 offen
s_waitcnt vmcnt(54)
v_perm_b32 v66, v19, v18, s46
v_accvgpr_write_b32 a6, v66
v_perm_b32 v70, v19, v18, s47
s_mov_b32 s20, 2304
buffer_load_dword v18, v4, s[12:15], s20 offen
s_mov_b32 s21, 3456
buffer_load_dword v19, v4, s[12:15], s21 offen
s_waitcnt vmcnt(54)
v_perm_b32 v67, v21, v20, s46
v_accvgpr_write_b32 a7, v67
v_perm_b32 v71, v21, v20, s47
ds_write_b128 v3, v[68:71] offset:15360
s_waitcnt lgkmcnt(0)
s_mov_b32 s20, 11520
buffer_load_dword v20, v4, s[12:15], s20 offen
s_mov_b32 s21, 12672
buffer_load_dword v21, v4, s[12:15], s21 offen
s_waitcnt vmcnt(54)
v_perm_b32 v64, v23, v22, s46
v_accvgpr_write_b32 a144, v64
v_perm_b32 v68, v23, v22, s47
v_accvgpr_write_b32 a152, v68
s_barrier
s_mov_b32 s20, 36864
buffer_load_dword v22, v4, s[12:15], s20 offen
s_mov_b32 s21, 38016
buffer_load_dword v23, v4, s[12:15], s21 offen
s_waitcnt vmcnt(54)
v_perm_b32 v65, v25, v24, s46
v_accvgpr_write_b32 a145, v65
v_perm_b32 v69, v25, v24, s47
v_accvgpr_write_b32 a153, v69
s_mov_b32 s20, 46080
buffer_load_dword v24, v4, s[12:15], s20 offen
s_mov_b32 s21, 47232
buffer_load_dword v25, v4, s[12:15], s21 offen
s_waitcnt vmcnt(54)
v_perm_b32 v66, v27, v26, s46
v_accvgpr_write_b32 a146, v66
v_perm_b32 v70, v27, v26, s47
v_accvgpr_write_b32 a154, v70
s_mov_b32 s20, 39168
buffer_load_dword v26, v4, s[12:15], s20 offen
s_mov_b32 s21, 40320
buffer_load_dword v27, v4, s[12:15], s21 offen
s_waitcnt vmcnt(54)
v_perm_b32 v67, v29, v28, s46
v_accvgpr_write_b32 a147, v67
v_perm_b32 v71, v29, v28, s47
v_accvgpr_write_b32 a155, v71
s_mov_b32 s20, 48384
buffer_load_dword v28, v4, s[12:15], s20 offen
s_mov_b32 s21, 49536
buffer_load_dword v29, v4, s[12:15], s21 offen
s_waitcnt vmcnt(54)
v_perm_b32 v64, v31, v30, s46
v_accvgpr_write_b32 a148, v64
v_perm_b32 v68, v31, v30, s47
v_accvgpr_write_b32 a156, v68
s_barrier
s_mov_b32 s20, 73728
buffer_load_dword v30, v4, s[12:15], s20 offen
s_mov_b32 s21, 74880
buffer_load_dword v31, v4, s[12:15], s21 offen
s_waitcnt vmcnt(54)
v_perm_b32 v65, v33, v32, s46
v_accvgpr_write_b32 a149, v65
v_perm_b32 v69, v33, v32, s47
v_accvgpr_write_b32 a157, v69
s_mov_b32 s20, 82944
buffer_load_dword v32, v4, s[12:15], s20 offen
s_mov_b32 s21, 84096
buffer_load_dword v33, v4, s[12:15], s21 offen
s_waitcnt vmcnt(54)
v_perm_b32 v66, v35, v34, s46
v_accvgpr_write_b32 a150, v66
v_perm_b32 v70, v35, v34, s47
v_accvgpr_write_b32 a158, v70
s_mov_b32 s20, 76032
buffer_load_dword v34, v4, s[12:15], s20 offen
s_mov_b32 s21, 77184
buffer_load_dword v35, v4, s[12:15], s21 offen
s_waitcnt vmcnt(54)
v_perm_b32 v67, v37, v36, s46
v_accvgpr_write_b32 a151, v67
v_perm_b32 v71, v37, v36, s47
v_accvgpr_write_b32 a159, v71
s_mov_b32 s20, 85248
buffer_load_dword v36, v4, s[12:15], s20 offen
s_mov_b32 s21, 86400
buffer_load_dword v37, v4, s[12:15], s21 offen
s_waitcnt vmcnt(54)
v_perm_b32 v64, v39, v38, s46
v_accvgpr_write_b32 a24, v64
v_perm_b32 v68, v39, v38, s47
s_barrier
s_mov_b32 s20, 110592
buffer_load_dword v38, v4, s[12:15], s20 offen
s_mov_b32 s21, 111744
buffer_load_dword v39, v4, s[12:15], s21 offen
s_waitcnt vmcnt(54)
v_perm_b32 v65, v41, v40, s46
v_accvgpr_write_b32 a25, v65
v_perm_b32 v69, v41, v40, s47
s_mov_b32 s20, 119808
buffer_load_dword v40, v4, s[12:15], s20 offen
s_mov_b32 s21, 120960
buffer_load_dword v41, v4, s[12:15], s21 offen
s_waitcnt vmcnt(54)
v_perm_b32 v66, v43, v42, s46
v_accvgpr_write_b32 a26, v66
v_perm_b32 v70, v43, v42, s47
s_mov_b32 s20, 112896
buffer_load_dword v42, v4, s[12:15], s20 offen
s_mov_b32 s21, 114048
buffer_load_dword v43, v4, s[12:15], s21 offen
s_waitcnt vmcnt(54)
v_perm_b32 v67, v45, v44, s46
v_accvgpr_write_b32 a27, v67
v_perm_b32 v71, v45, v44, s47
ds_write_b128 v3, v[68:71] offset:16384
s_waitcnt lgkmcnt(0)
s_mov_b32 s20, 122112
buffer_load_dword v44, v4, s[12:15], s20 offen
s_mov_b32 s21, 123264
buffer_load_dword v45, v4, s[12:15], s21 offen
s_waitcnt vmcnt(54)
v_perm_b32 v64, v47, v46, s46
v_accvgpr_write_b32 a28, v64
v_perm_b32 v68, v47, v46, s47
s_barrier
s_mov_b32 s20, 256
buffer_load_dword v46, v4, s[12:15], s20 offen
s_mov_b32 s21, 1408
buffer_load_dword v47, v4, s[12:15], s21 offen
s_waitcnt vmcnt(54)
v_perm_b32 v65, v49, v48, s46
v_accvgpr_write_b32 a29, v65
v_perm_b32 v69, v49, v48, s47
s_mov_b32 s20, 9472
buffer_load_dword v48, v4, s[12:15], s20 offen
s_mov_b32 s21, 10624
buffer_load_dword v49, v4, s[12:15], s21 offen
s_waitcnt vmcnt(54)
v_perm_b32 v66, v51, v50, s46
v_accvgpr_write_b32 a30, v66
v_perm_b32 v70, v51, v50, s47
s_mov_b32 s20, 2560
buffer_load_dword v50, v4, s[12:15], s20 offen
s_mov_b32 s21, 3712
buffer_load_dword v51, v4, s[12:15], s21 offen
s_waitcnt vmcnt(54)
v_perm_b32 v67, v53, v52, s46
v_accvgpr_write_b32 a31, v67
v_perm_b32 v71, v53, v52, s47
ds_write_b128 v3, v[68:71] offset:17408
s_waitcnt lgkmcnt(0)
s_mov_b32 s20, 11776
buffer_load_dword v52, v4, s[12:15], s20 offen
s_mov_b32 s21, 12928
buffer_load_dword v53, v4, s[12:15], s21 offen
s_waitcnt vmcnt(54)
v_perm_b32 v64, v55, v54, s46
v_accvgpr_write_b32 a160, v64
v_perm_b32 v68, v55, v54, s47
v_accvgpr_write_b32 a168, v68
s_barrier
s_mov_b32 s20, 37120
buffer_load_dword v54, v4, s[12:15], s20 offen
s_mov_b32 s21, 38272
buffer_load_dword v55, v4, s[12:15], s21 offen
s_waitcnt vmcnt(54)
v_perm_b32 v65, v57, v56, s46
v_accvgpr_write_b32 a161, v65
v_perm_b32 v69, v57, v56, s47
v_accvgpr_write_b32 a169, v69
s_mov_b32 s20, 46336
buffer_load_dword v56, v4, s[12:15], s20 offen
s_mov_b32 s21, 47488
buffer_load_dword v57, v4, s[12:15], s21 offen
s_waitcnt vmcnt(54)
v_perm_b32 v66, v59, v58, s46
v_accvgpr_write_b32 a162, v66
v_perm_b32 v70, v59, v58, s47
v_accvgpr_write_b32 a170, v70
s_mov_b32 s20, 39424
buffer_load_dword v58, v4, s[12:15], s20 offen
s_mov_b32 s21, 40576
buffer_load_dword v59, v4, s[12:15], s21 offen
s_waitcnt vmcnt(54)
v_perm_b32 v67, v61, v60, s46
v_accvgpr_write_b32 a163, v67
v_perm_b32 v71, v61, v60, s47
v_accvgpr_write_b32 a171, v71
s_mov_b32 s20, 48640
buffer_load_dword v60, v4, s[12:15], s20 offen
s_mov_b32 s21, 49792
buffer_load_dword v61, v4, s[12:15], s21 offen
s_waitcnt vmcnt(54)
v_perm_b32 v64, v7, v6, s46
v_accvgpr_write_b32 a164, v64
v_perm_b32 v68, v7, v6, s47
v_accvgpr_write_b32 a172, v68
s_barrier
s_mov_b32 s20, 73984
buffer_load_dword v6, v4, s[12:15], s20 offen
s_mov_b32 s21, 75136
buffer_load_dword v7, v4, s[12:15], s21 offen
s_waitcnt vmcnt(54)
v_perm_b32 v65, v9, v8, s46
v_accvgpr_write_b32 a165, v65
v_perm_b32 v69, v9, v8, s47
v_accvgpr_write_b32 a173, v69
s_mov_b32 s20, 83200
buffer_load_dword v8, v4, s[12:15], s20 offen
s_mov_b32 s21, 84352
buffer_load_dword v9, v4, s[12:15], s21 offen
s_waitcnt vmcnt(54)
v_perm_b32 v66, v11, v10, s46
v_accvgpr_write_b32 a166, v66
v_perm_b32 v70, v11, v10, s47
v_accvgpr_write_b32 a174, v70
s_mov_b32 s20, 76288
buffer_load_dword v10, v4, s[12:15], s20 offen
s_mov_b32 s21, 77440
buffer_load_dword v11, v4, s[12:15], s21 offen
s_waitcnt vmcnt(54)
v_perm_b32 v67, v13, v12, s46
v_accvgpr_write_b32 a167, v67
v_perm_b32 v71, v13, v12, s47
v_accvgpr_write_b32 a175, v71
s_mov_b32 s20, 85504
buffer_load_dword v12, v4, s[12:15], s20 offen
s_mov_b32 s21, 86656
buffer_load_dword v13, v4, s[12:15], s21 offen
s_waitcnt vmcnt(54)
v_perm_b32 v64, v15, v14, s46
v_accvgpr_write_b32 a176, v64
v_perm_b32 v68, v15, v14, s47
v_accvgpr_write_b32 a184, v68
s_barrier
s_mov_b32 s20, 110848
buffer_load_dword v14, v4, s[12:15], s20 offen
s_mov_b32 s21, 112000
buffer_load_dword v15, v4, s[12:15], s21 offen
s_waitcnt vmcnt(54)
v_perm_b32 v65, v17, v16, s46
v_accvgpr_write_b32 a177, v65
v_perm_b32 v69, v17, v16, s47
v_accvgpr_write_b32 a185, v69
s_mov_b32 s20, 120064
buffer_load_dword v16, v4, s[12:15], s20 offen
s_mov_b32 s21, 121216
buffer_load_dword v17, v4, s[12:15], s21 offen
s_waitcnt vmcnt(54)
v_perm_b32 v66, v19, v18, s46
v_accvgpr_write_b32 a178, v66
v_perm_b32 v70, v19, v18, s47
v_accvgpr_write_b32 a186, v70
s_mov_b32 s20, 113152
buffer_load_dword v18, v4, s[12:15], s20 offen
s_mov_b32 s21, 114304
buffer_load_dword v19, v4, s[12:15], s21 offen
s_waitcnt vmcnt(54)
v_perm_b32 v67, v21, v20, s46
v_accvgpr_write_b32 a179, v67
v_perm_b32 v71, v21, v20, s47
v_accvgpr_write_b32 a187, v71
s_mov_b32 s20, 122368
buffer_load_dword v20, v4, s[12:15], s20 offen
s_mov_b32 s21, 123520
buffer_load_dword v21, v4, s[12:15], s21 offen
s_waitcnt vmcnt(54)
v_perm_b32 v64, v23, v22, s46
v_accvgpr_write_b32 a180, v64
v_perm_b32 v68, v23, v22, s47
v_accvgpr_write_b32 a188, v68
s_barrier
s_mov_b32 s20, 512
buffer_load_dword v22, v4, s[12:15], s20 offen
s_mov_b32 s21, 1664
buffer_load_dword v23, v4, s[12:15], s21 offen
s_waitcnt vmcnt(54)
v_perm_b32 v65, v25, v24, s46
v_accvgpr_write_b32 a181, v65
v_perm_b32 v69, v25, v24, s47
v_accvgpr_write_b32 a189, v69
s_mov_b32 s20, 9728
buffer_load_dword v24, v4, s[12:15], s20 offen
s_mov_b32 s21, 10880
buffer_load_dword v25, v4, s[12:15], s21 offen
s_waitcnt vmcnt(54)
v_perm_b32 v66, v27, v26, s46
v_accvgpr_write_b32 a182, v66
v_perm_b32 v70, v27, v26, s47
v_accvgpr_write_b32 a190, v70
s_mov_b32 s20, 2816
buffer_load_dword v26, v4, s[12:15], s20 offen
s_mov_b32 s21, 3968
buffer_load_dword v27, v4, s[12:15], s21 offen
s_waitcnt vmcnt(54)
v_perm_b32 v67, v29, v28, s46
v_accvgpr_write_b32 a183, v67
v_perm_b32 v71, v29, v28, s47
v_accvgpr_write_b32 a191, v71
s_mov_b32 s20, 12032
buffer_load_dword v28, v4, s[12:15], s20 offen
s_mov_b32 s21, 13184
buffer_load_dword v29, v4, s[12:15], s21 offen
s_waitcnt vmcnt(54)
v_perm_b32 v64, v31, v30, s46
v_perm_b32 v68, v31, v30, s47
s_barrier
s_mov_b32 s20, 37376
buffer_load_dword v30, v4, s[12:15], s20 offen
s_mov_b32 s21, 38528
buffer_load_dword v31, v4, s[12:15], s21 offen
s_waitcnt vmcnt(54)
v_perm_b32 v65, v33, v32, s46
v_perm_b32 v69, v33, v32, s47
s_mov_b32 s20, 46592
buffer_load_dword v32, v4, s[12:15], s20 offen
s_mov_b32 s21, 47744
buffer_load_dword v33, v4, s[12:15], s21 offen
s_waitcnt vmcnt(54)
v_perm_b32 v66, v35, v34, s46
v_perm_b32 v70, v35, v34, s47
s_mov_b32 s20, 39680
buffer_load_dword v34, v4, s[12:15], s20 offen
s_mov_b32 s21, 40832
buffer_load_dword v35, v4, s[12:15], s21 offen
s_waitcnt vmcnt(54)
v_perm_b32 v67, v37, v36, s46
ds_write_b128 v3, v[64:67] offset:20480
s_waitcnt lgkmcnt(0)
v_perm_b32 v71, v37, v36, s47
ds_write_b128 v3, v[68:71] offset:22528
s_waitcnt lgkmcnt(0)
s_mov_b32 s20, 48896
buffer_load_dword v36, v4, s[12:15], s20 offen
s_mov_b32 s21, 50048
buffer_load_dword v37, v4, s[12:15], s21 offen
s_waitcnt vmcnt(54)
v_perm_b32 v64, v39, v38, s46
v_perm_b32 v68, v39, v38, s47
s_barrier
s_mov_b32 s20, 74240
buffer_load_dword v38, v4, s[12:15], s20 offen
s_mov_b32 s21, 75392
buffer_load_dword v39, v4, s[12:15], s21 offen
s_waitcnt vmcnt(54)
v_perm_b32 v65, v41, v40, s46
v_perm_b32 v69, v41, v40, s47
s_mov_b32 s20, 83456
buffer_load_dword v40, v4, s[12:15], s20 offen
s_mov_b32 s21, 84608
buffer_load_dword v41, v4, s[12:15], s21 offen
s_waitcnt vmcnt(54)
v_perm_b32 v66, v43, v42, s46
v_perm_b32 v70, v43, v42, s47
s_mov_b32 s20, 76544
buffer_load_dword v42, v4, s[12:15], s20 offen
s_mov_b32 s21, 77696
buffer_load_dword v43, v4, s[12:15], s21 offen
s_waitcnt vmcnt(54)
v_perm_b32 v67, v45, v44, s46
ds_write_b128 v3, v[64:67] offset:21504
s_waitcnt lgkmcnt(0)
v_perm_b32 v71, v45, v44, s47
ds_write_b128 v3, v[68:71] offset:23552
s_waitcnt lgkmcnt(0)
s_mov_b32 s20, 85760
buffer_load_dword v44, v4, s[12:15], s20 offen
s_mov_b32 s21, 86912
buffer_load_dword v45, v4, s[12:15], s21 offen
s_waitcnt vmcnt(54)
v_perm_b32 v64, v47, v46, s46
v_accvgpr_write_b32 a192, v64
v_perm_b32 v68, v47, v46, s47
v_accvgpr_write_b32 a200, v68
s_barrier
s_mov_b32 s20, 111104
buffer_load_dword v46, v4, s[12:15], s20 offen
s_mov_b32 s21, 112256
buffer_load_dword v47, v4, s[12:15], s21 offen
s_waitcnt vmcnt(54)
v_perm_b32 v65, v49, v48, s46
v_accvgpr_write_b32 a193, v65
v_perm_b32 v69, v49, v48, s47
v_accvgpr_write_b32 a201, v69
s_mov_b32 s20, 120320
buffer_load_dword v48, v4, s[12:15], s20 offen
s_mov_b32 s21, 121472
buffer_load_dword v49, v4, s[12:15], s21 offen
s_waitcnt vmcnt(54)
v_perm_b32 v66, v51, v50, s46
v_accvgpr_write_b32 a194, v66
v_perm_b32 v70, v51, v50, s47
v_accvgpr_write_b32 a202, v70
s_mov_b32 s20, 113408
buffer_load_dword v50, v4, s[12:15], s20 offen
s_mov_b32 s21, 114560
buffer_load_dword v51, v4, s[12:15], s21 offen
s_waitcnt vmcnt(54)
v_perm_b32 v67, v53, v52, s46
v_accvgpr_write_b32 a195, v67
v_perm_b32 v71, v53, v52, s47
v_accvgpr_write_b32 a203, v71
s_mov_b32 s20, 122624
buffer_load_dword v52, v4, s[12:15], s20 offen
s_mov_b32 s21, 123776
buffer_load_dword v53, v4, s[12:15], s21 offen
s_waitcnt vmcnt(54)
v_perm_b32 v64, v55, v54, s46
v_accvgpr_write_b32 a196, v64
v_perm_b32 v68, v55, v54, s47
v_accvgpr_write_b32 a204, v68
s_barrier
s_mov_b32 s20, 768
buffer_load_dword v54, v4, s[12:15], s20 offen
s_mov_b32 s21, 1920
buffer_load_dword v55, v4, s[12:15], s21 offen
s_waitcnt vmcnt(54)
v_perm_b32 v65, v57, v56, s46
v_accvgpr_write_b32 a197, v65
v_perm_b32 v69, v57, v56, s47
v_accvgpr_write_b32 a205, v69
s_mov_b32 s20, 9984
buffer_load_dword v56, v4, s[12:15], s20 offen
s_mov_b32 s21, 11136
buffer_load_dword v57, v4, s[12:15], s21 offen
s_waitcnt vmcnt(54)
v_perm_b32 v66, v59, v58, s46
v_accvgpr_write_b32 a198, v66
v_perm_b32 v70, v59, v58, s47
v_accvgpr_write_b32 a206, v70
s_mov_b32 s20, 3072
buffer_load_dword v58, v4, s[12:15], s20 offen
s_mov_b32 s21, 4224
buffer_load_dword v59, v4, s[12:15], s21 offen
s_waitcnt vmcnt(54)
v_perm_b32 v67, v61, v60, s46
v_accvgpr_write_b32 a199, v67
v_perm_b32 v71, v61, v60, s47
v_accvgpr_write_b32 a207, v71
s_mov_b32 s20, 12288
buffer_load_dword v60, v4, s[12:15], s20 offen
s_mov_b32 s21, 13440
buffer_load_dword v61, v4, s[12:15], s21 offen
s_waitcnt vmcnt(54)
v_perm_b32 v64, v7, v6, s46
v_perm_b32 v68, v7, v6, s47
s_barrier
s_mov_b32 s20, 37632
buffer_load_dword v6, v4, s[12:15], s20 offen
s_mov_b32 s21, 38784
buffer_load_dword v7, v4, s[12:15], s21 offen
s_waitcnt vmcnt(54)
v_perm_b32 v65, v9, v8, s46
v_perm_b32 v69, v9, v8, s47
s_mov_b32 s20, 46848
buffer_load_dword v8, v4, s[12:15], s20 offen
s_mov_b32 s21, 48000
buffer_load_dword v9, v4, s[12:15], s21 offen
s_waitcnt vmcnt(54)
v_perm_b32 v66, v11, v10, s46
v_perm_b32 v70, v11, v10, s47
s_mov_b32 s20, 39936
buffer_load_dword v10, v4, s[12:15], s20 offen
s_mov_b32 s21, 41088
buffer_load_dword v11, v4, s[12:15], s21 offen
s_waitcnt vmcnt(54)
v_perm_b32 v67, v13, v12, s46
ds_write_b128 v3, v[64:67] offset:24576
s_waitcnt lgkmcnt(0)
v_perm_b32 v71, v13, v12, s47
ds_write_b128 v3, v[68:71] offset:26624
s_waitcnt lgkmcnt(0)
s_mov_b32 s20, 49152
buffer_load_dword v12, v4, s[12:15], s20 offen
s_mov_b32 s21, 50304
buffer_load_dword v13, v4, s[12:15], s21 offen
s_waitcnt vmcnt(54)
v_perm_b32 v64, v15, v14, s46
v_perm_b32 v68, v15, v14, s47
s_barrier
s_mov_b32 s20, 74496
buffer_load_dword v14, v4, s[12:15], s20 offen
s_mov_b32 s21, 75648
buffer_load_dword v15, v4, s[12:15], s21 offen
s_waitcnt vmcnt(54)
v_perm_b32 v65, v17, v16, s46
v_perm_b32 v69, v17, v16, s47
s_mov_b32 s20, 83712
buffer_load_dword v16, v4, s[12:15], s20 offen
s_mov_b32 s21, 84864
buffer_load_dword v17, v4, s[12:15], s21 offen
s_waitcnt vmcnt(54)
v_perm_b32 v66, v19, v18, s46
v_perm_b32 v70, v19, v18, s47
s_mov_b32 s20, 76800
buffer_load_dword v18, v4, s[12:15], s20 offen
s_mov_b32 s21, 77952
buffer_load_dword v19, v4, s[12:15], s21 offen
s_waitcnt vmcnt(54)
v_perm_b32 v67, v21, v20, s46
ds_write_b128 v3, v[64:67] offset:25600
s_waitcnt lgkmcnt(0)
v_perm_b32 v71, v21, v20, s47
ds_write_b128 v3, v[68:71] offset:27648
s_waitcnt lgkmcnt(0)
s_mov_b32 s20, 86016
buffer_load_dword v20, v4, s[12:15], s20 offen
s_mov_b32 s21, 87168
buffer_load_dword v21, v4, s[12:15], s21 offen
s_waitcnt vmcnt(54)
v_perm_b32 v64, v23, v22, s46
v_accvgpr_write_b32 a208, v64
v_perm_b32 v68, v23, v22, s47
v_accvgpr_write_b32 a216, v68
s_barrier
s_mov_b32 s20, 111360
buffer_load_dword v22, v4, s[12:15], s20 offen
s_mov_b32 s21, 112512
buffer_load_dword v23, v4, s[12:15], s21 offen
s_waitcnt vmcnt(54)
v_perm_b32 v65, v25, v24, s46
v_accvgpr_write_b32 a209, v65
v_perm_b32 v69, v25, v24, s47
v_accvgpr_write_b32 a217, v69
s_mov_b32 s20, 120576
buffer_load_dword v24, v4, s[12:15], s20 offen
s_mov_b32 s21, 121728
buffer_load_dword v25, v4, s[12:15], s21 offen
s_waitcnt vmcnt(54)
v_perm_b32 v66, v27, v26, s46
v_accvgpr_write_b32 a210, v66
v_perm_b32 v70, v27, v26, s47
v_accvgpr_write_b32 a218, v70
s_mov_b32 s20, 113664
buffer_load_dword v26, v4, s[12:15], s20 offen
s_mov_b32 s21, 114816
buffer_load_dword v27, v4, s[12:15], s21 offen
s_waitcnt vmcnt(54)
v_perm_b32 v67, v29, v28, s46
v_accvgpr_write_b32 a211, v67
v_perm_b32 v71, v29, v28, s47
v_accvgpr_write_b32 a219, v71
s_mov_b32 s20, 122880
buffer_load_dword v28, v4, s[12:15], s20 offen
s_mov_b32 s21, 124032
buffer_load_dword v29, v4, s[12:15], s21 offen
s_waitcnt vmcnt(54)
v_perm_b32 v64, v31, v30, s46
v_accvgpr_write_b32 a212, v64
v_perm_b32 v68, v31, v30, s47
v_accvgpr_write_b32 a220, v68
s_barrier
s_mov_b32 s20, 1024
buffer_load_ushort v30, v2, s[12:15], s20 offen
s_mov_b32 s21, 2176
buffer_load_ushort v31, v2, s[12:15], s21 offen
s_waitcnt vmcnt(54)
v_perm_b32 v65, v33, v32, s46
v_accvgpr_write_b32 a213, v65
v_perm_b32 v69, v33, v32, s47
v_accvgpr_write_b32 a221, v69
s_mov_b32 s20, 10240
buffer_load_ushort v32, v2, s[12:15], s20 offen
s_mov_b32 s21, 11392
buffer_load_ushort v33, v2, s[12:15], s21 offen
s_waitcnt vmcnt(54)
v_perm_b32 v66, v35, v34, s46
v_accvgpr_write_b32 a214, v66
v_perm_b32 v70, v35, v34, s47
v_accvgpr_write_b32 a222, v70
s_mov_b32 s20, 3328
buffer_load_ushort v34, v2, s[12:15], s20 offen
s_mov_b32 s21, 4480
buffer_load_ushort v35, v2, s[12:15], s21 offen
s_waitcnt vmcnt(54)
v_perm_b32 v67, v37, v36, s46
v_accvgpr_write_b32 a215, v67
v_perm_b32 v71, v37, v36, s47
v_accvgpr_write_b32 a223, v71
s_mov_b32 s20, 12544
buffer_load_ushort v36, v2, s[12:15], s20 offen
s_mov_b32 s21, 13696
buffer_load_ushort v37, v2, s[12:15], s21 offen
s_waitcnt vmcnt(54)
v_perm_b32 v64, v39, v38, s46
v_perm_b32 v68, v39, v38, s47
s_barrier
s_mov_b32 s20, 37888
buffer_load_ushort v38, v2, s[12:15], s20 offen
s_mov_b32 s21, 39040
buffer_load_ushort v39, v2, s[12:15], s21 offen
s_waitcnt vmcnt(54)
v_perm_b32 v65, v41, v40, s46
v_perm_b32 v69, v41, v40, s47
s_mov_b32 s20, 47104
buffer_load_ushort v40, v2, s[12:15], s20 offen
s_mov_b32 s21, 48256
buffer_load_ushort v41, v2, s[12:15], s21 offen
s_waitcnt vmcnt(54)
v_perm_b32 v66, v43, v42, s46
v_perm_b32 v70, v43, v42, s47
s_mov_b32 s20, 40192
buffer_load_ushort v42, v2, s[12:15], s20 offen
s_mov_b32 s21, 41344
buffer_load_ushort v43, v2, s[12:15], s21 offen
s_waitcnt vmcnt(54)
v_perm_b32 v67, v45, v44, s46
ds_write_b128 v3, v[64:67] offset:28672
s_waitcnt lgkmcnt(0)
v_perm_b32 v71, v45, v44, s47
ds_write_b128 v3, v[68:71] offset:30720
s_waitcnt lgkmcnt(0)
s_mov_b32 s20, 49408
buffer_load_ushort v44, v2, s[12:15], s20 offen
s_mov_b32 s21, 50560
buffer_load_ushort v45, v2, s[12:15], s21 offen
s_waitcnt vmcnt(54)
v_perm_b32 v64, v47, v46, s46
v_perm_b32 v68, v47, v46, s47
s_barrier
s_mov_b32 s20, 74752
buffer_load_ushort v46, v2, s[12:15], s20 offen
s_mov_b32 s21, 75904
buffer_load_ushort v47, v2, s[12:15], s21 offen
s_waitcnt vmcnt(54)
v_perm_b32 v65, v49, v48, s46
v_perm_b32 v69, v49, v48, s47
s_mov_b32 s20, 83968
buffer_load_ushort v48, v2, s[12:15], s20 offen
s_mov_b32 s21, 85120
buffer_load_ushort v49, v2, s[12:15], s21 offen
s_waitcnt vmcnt(54)
v_perm_b32 v66, v51, v50, s46
v_perm_b32 v70, v51, v50, s47
s_mov_b32 s20, 77056
buffer_load_ushort v50, v2, s[12:15], s20 offen
s_mov_b32 s21, 78208
buffer_load_ushort v51, v2, s[12:15], s21 offen
s_waitcnt vmcnt(54)
v_perm_b32 v67, v53, v52, s46
ds_write_b128 v3, v[64:67] offset:29696
s_waitcnt lgkmcnt(0)
v_perm_b32 v71, v53, v52, s47
ds_write_b128 v3, v[68:71] offset:31744
s_waitcnt lgkmcnt(0)
s_mov_b32 s20, 86272
buffer_load_ushort v52, v2, s[12:15], s20 offen
s_mov_b32 s21, 87424
buffer_load_ushort v53, v2, s[12:15], s21 offen
s_waitcnt vmcnt(54)
v_perm_b32 v64, v55, v54, s46
v_accvgpr_write_b32 a224, v64
v_perm_b32 v68, v55, v54, s47
v_accvgpr_write_b32 a232, v68
s_barrier
s_mov_b32 s20, 111616
buffer_load_ushort v54, v2, s[12:15], s20 offen
s_mov_b32 s21, 112768
buffer_load_ushort v55, v2, s[12:15], s21 offen
s_waitcnt vmcnt(54)
v_perm_b32 v65, v57, v56, s46
v_accvgpr_write_b32 a225, v65
v_perm_b32 v69, v57, v56, s47
v_accvgpr_write_b32 a233, v69
s_mov_b32 s20, 120832
buffer_load_ushort v56, v2, s[12:15], s20 offen
s_mov_b32 s21, 121984
buffer_load_ushort v57, v2, s[12:15], s21 offen
s_waitcnt vmcnt(54)
v_perm_b32 v66, v59, v58, s46
v_accvgpr_write_b32 a226, v66
v_perm_b32 v70, v59, v58, s47
v_accvgpr_write_b32 a234, v70
s_mov_b32 s20, 113920
buffer_load_ushort v58, v2, s[12:15], s20 offen
s_mov_b32 s21, 115072
buffer_load_ushort v59, v2, s[12:15], s21 offen
s_waitcnt vmcnt(54)
v_perm_b32 v67, v61, v60, s46
v_accvgpr_write_b32 a227, v67
v_perm_b32 v71, v61, v60, s47
v_accvgpr_write_b32 a235, v71
s_mov_b32 s20, 123136
buffer_load_ushort v60, v2, s[12:15], s20 offen
s_mov_b32 s21, 124288
buffer_load_ushort v61, v2, s[12:15], s21 offen
s_waitcnt vmcnt(54)
v_perm_b32 v64, v7, v6, s46
v_accvgpr_write_b32 a228, v64
v_perm_b32 v68, v7, v6, s47
v_accvgpr_write_b32 a236, v68
s_barrier
s_mov_b32 s12, s88
s_and_b32 s13, s89, 0xffff
s_mov_b32 s14, 4718592
s_mov_b32 s15, 0x20000
s_mov_b32 s20, 0
buffer_load_dword v6, v1, s[12:15], s20 offen
s_mov_b32 s21, 32768
buffer_load_dword v7, v1, s[12:15], s21 offen
s_waitcnt vmcnt(54)
v_perm_b32 v65, v9, v8, s46
v_accvgpr_write_b32 a229, v65
v_perm_b32 v69, v9, v8, s47
v_accvgpr_write_b32 a237, v69
s_mov_b32 s20, 65536
buffer_load_dword v8, v1, s[12:15], s20 offen
s_mov_b32 s21, 98304
buffer_load_dword v9, v1, s[12:15], s21 offen
s_waitcnt vmcnt(54)
v_perm_b32 v66, v11, v10, s46
v_accvgpr_write_b32 a230, v66
v_perm_b32 v70, v11, v10, s47
v_accvgpr_write_b32 a238, v70
s_mov_b32 s20, 8192
buffer_load_dword v10, v1, s[12:15], s20 offen
s_mov_b32 s21, 40960
buffer_load_dword v11, v1, s[12:15], s21 offen
s_waitcnt vmcnt(54)
v_perm_b32 v67, v13, v12, s46
v_accvgpr_write_b32 a231, v67
v_perm_b32 v71, v13, v12, s47
v_accvgpr_write_b32 a239, v71
s_mov_b32 s20, 73728
buffer_load_dword v12, v1, s[12:15], s20 offen
s_mov_b32 s21, 106496
buffer_load_dword v13, v1, s[12:15], s21 offen
s_waitcnt vmcnt(54)
v_perm_b32 v64, v15, v14, s46
v_perm_b32 v68, v15, v14, s47
v_accvgpr_write_b32 a240, v68
s_barrier
s_mov_b32 s20, 262144
buffer_load_dword v14, v1, s[12:15], s20 offen
s_mov_b32 s21, 294912
buffer_load_dword v15, v1, s[12:15], s21 offen
s_waitcnt vmcnt(54)
v_perm_b32 v65, v17, v16, s46
v_perm_b32 v69, v17, v16, s47
v_accvgpr_write_b32 a241, v69
s_mov_b32 s20, 327680
buffer_load_dword v16, v1, s[12:15], s20 offen
s_mov_b32 s21, 360448
buffer_load_dword v17, v1, s[12:15], s21 offen
s_waitcnt vmcnt(54)
v_perm_b32 v66, v19, v18, s46
v_perm_b32 v70, v19, v18, s47
v_accvgpr_write_b32 a242, v70
v_and_b32 v5, 1, v0
v_lshlrev_b32 v5, 6, v5
buffer_load_dword v5, v5, s[56:59], 0 offen offset:64 sc1
s_mov_b32 s20, 270336
buffer_load_dword v18, v1, s[12:15], s20 offen
s_mov_b32 s21, 303104
buffer_load_dword v19, v1, s[12:15], s21 offen
s_waitcnt vmcnt(55)
v_perm_b32 v67, v21, v20, s46
ds_write_b128 v3, v[64:67] offset:32768
s_waitcnt lgkmcnt(0)
v_perm_b32 v71, v21, v20, s47
v_accvgpr_write_b32 a243, v71
s_mov_b32 s20, 335872
buffer_load_dword v20, v1, s[12:15], s20 offen
s_mov_b32 s21, 368640
buffer_load_dword v21, v1, s[12:15], s21 offen
s_waitcnt vmcnt(55)
v_perm_b32 v64, v23, v22, s46
v_perm_b32 v68, v23, v22, s47
v_accvgpr_write_b32 a244, v68
s_barrier
s_mov_b32 s20, 524288
buffer_load_dword v22, v1, s[12:15], s20 offen
s_mov_b32 s21, 557056
buffer_load_dword v23, v1, s[12:15], s21 offen
s_waitcnt vmcnt(55)
v_perm_b32 v65, v25, v24, s46
v_perm_b32 v69, v25, v24, s47
v_accvgpr_write_b32 a245, v69
s_mov_b32 s20, 589824
buffer_load_dword v24, v1, s[12:15], s20 offen
s_mov_b32 s21, 622592
buffer_load_dword v25, v1, s[12:15], s21 offen
s_waitcnt vmcnt(55)
v_perm_b32 v66, v27, v26, s46
v_perm_b32 v70, v27, v26, s47
v_accvgpr_write_b32 a246, v70
s_mov_b32 s20, 532480
buffer_load_dword v26, v1, s[12:15], s20 offen
s_mov_b32 s21, 565248
buffer_load_dword v27, v1, s[12:15], s21 offen
s_waitcnt vmcnt(55)
v_perm_b32 v67, v29, v28, s46
ds_write_b128 v3, v[64:67] offset:33792
s_waitcnt lgkmcnt(0)
v_perm_b32 v71, v29, v28, s47
v_accvgpr_write_b32 a247, v71
s_mov_b32 s20, 598016
buffer_load_dword v28, v1, s[12:15], s20 offen
s_mov_b32 s21, 630784
buffer_load_dword v29, v1, s[12:15], s21 offen
s_waitcnt vmcnt(55)
v_perm_b32 v64, v31, v30, s46
v_accvgpr_write_b32 a248, v64
s_barrier
s_mov_b32 s20, 786432
buffer_load_dword v30, v1, s[12:15], s20 offen
s_mov_b32 s21, 819200
buffer_load_dword v31, v1, s[12:15], s21 offen
s_waitcnt vmcnt(55)
v_perm_b32 v65, v33, v32, s46
v_accvgpr_write_b32 a249, v65
s_mov_b32 s20, 851968
buffer_load_dword v32, v1, s[12:15], s20 offen
s_mov_b32 s21, 884736
buffer_load_dword v33, v1, s[12:15], s21 offen
s_waitcnt vmcnt(55)
v_perm_b32 v66, v35, v34, s46
v_accvgpr_write_b32 a250, v66
s_mov_b32 s20, 794624
buffer_load_dword v34, v1, s[12:15], s20 offen
s_mov_b32 s21, 827392
buffer_load_dword v35, v1, s[12:15], s21 offen
s_waitcnt vmcnt(55)
v_perm_b32 v67, v37, v36, s46
v_accvgpr_write_b32 a251, v67
s_mov_b32 s20, 860160
buffer_load_dword v36, v1, s[12:15], s20 offen
s_mov_b32 s21, 892928
buffer_load_dword v37, v1, s[12:15], s21 offen
s_waitcnt vmcnt(55)
v_perm_b32 v64, v39, v38, s46
v_accvgpr_write_b32 a252, v64
s_barrier
s_mov_b32 s20, 1048576
buffer_load_dword v38, v1, s[12:15], s20 offen
s_mov_b32 s21, 1081344
buffer_load_dword v39, v1, s[12:15], s21 offen
s_waitcnt vmcnt(55)
v_perm_b32 v65, v41, v40, s46
v_accvgpr_write_b32 a253, v65
s_mov_b32 s20, 1114112
buffer_load_dword v40, v1, s[12:15], s20 offen
s_mov_b32 s21, 1146880
buffer_load_dword v41, v1, s[12:15], s21 offen
s_waitcnt vmcnt(55)
v_perm_b32 v66, v43, v42, s46
v_accvgpr_write_b32 a254, v66
s_mov_b32 s20, 1056768
buffer_load_dword v42, v1, s[12:15], s20 offen
s_mov_b32 s21, 1089536
buffer_load_dword v43, v1, s[12:15], s21 offen
s_waitcnt vmcnt(55)
v_perm_b32 v67, v45, v44, s46
v_accvgpr_write_b32 a255, v67
s_mov_b32 s20, 1122304
buffer_load_dword v44, v1, s[12:15], s20 offen
s_mov_b32 s21, 1155072
buffer_load_dword v45, v1, s[12:15], s21 offen
s_waitcnt vmcnt(55)
v_perm_b32 v64, v47, v46, s46
s_barrier
s_mov_b32 s20, 1310720
buffer_load_dword v46, v1, s[12:15], s20 offen
s_mov_b32 s21, 1343488
buffer_load_dword v47, v1, s[12:15], s21 offen
s_waitcnt vmcnt(55)
v_perm_b32 v65, v49, v48, s46
s_mov_b32 s20, 1376256
buffer_load_dword v48, v1, s[12:15], s20 offen
s_mov_b32 s21, 1409024
buffer_load_dword v49, v1, s[12:15], s21 offen
s_waitcnt vmcnt(55)
v_perm_b32 v66, v51, v50, s46
s_mov_b32 s20, 1318912
buffer_load_dword v50, v1, s[12:15], s20 offen
s_mov_b32 s21, 1351680
buffer_load_dword v51, v1, s[12:15], s21 offen
s_waitcnt vmcnt(55)
v_perm_b32 v67, v53, v52, s46
ds_write_b128 v3, v[64:67] offset:18432
s_waitcnt lgkmcnt(0)
s_mov_b32 s20, 1384448
buffer_load_dword v52, v1, s[12:15], s20 offen
s_mov_b32 s21, 1417216
buffer_load_dword v53, v1, s[12:15], s21 offen
s_waitcnt vmcnt(55)
v_perm_b32 v64, v55, v54, s46
s_barrier
s_mov_b32 s20, 1572864
buffer_load_dword v54, v1, s[12:15], s20 offen
s_mov_b32 s21, 1605632
buffer_load_dword v55, v1, s[12:15], s21 offen
s_waitcnt vmcnt(55)
v_perm_b32 v65, v57, v56, s46
s_mov_b32 s20, 1638400
buffer_load_dword v56, v1, s[12:15], s20 offen
s_mov_b32 s21, 1671168
buffer_load_dword v57, v1, s[12:15], s21 offen
s_waitcnt vmcnt(55)
v_perm_b32 v66, v59, v58, s46
s_mov_b32 s20, 1581056
buffer_load_dword v58, v1, s[12:15], s20 offen
s_mov_b32 s21, 1613824
buffer_load_dword v59, v1, s[12:15], s21 offen
s_waitcnt vmcnt(55)
v_perm_b32 v67, v61, v60, s46
ds_write_b128 v3, v[64:67] offset:19456
s_waitcnt lgkmcnt(0)
s_mov_b32 s20, 1646592
buffer_load_dword v60, v1, s[12:15], s20 offen
s_mov_b32 s21, 1679360
buffer_load_dword v61, v1, s[12:15], s21 offen
s_waitcnt vmcnt(55)
v_perm_b32 v72, v7, v6, s46
v_perm_b32 v80, v7, v6, s47
s_barrier
s_mov_b32 s20, 1835008
buffer_load_dword v6, v1, s[12:15], s20 offen
s_mov_b32 s21, 1867776
buffer_load_dword v7, v1, s[12:15], s21 offen
s_waitcnt vmcnt(55)
v_perm_b32 v73, v9, v8, s46
v_perm_b32 v81, v9, v8, s47
s_mov_b32 s20, 1900544
buffer_load_dword v8, v1, s[12:15], s20 offen
s_mov_b32 s21, 1933312
buffer_load_dword v9, v1, s[12:15], s21 offen
s_waitcnt vmcnt(55)
v_perm_b32 v74, v11, v10, s46
v_perm_b32 v82, v11, v10, s47
s_mov_b32 s20, 1843200
buffer_load_dword v10, v1, s[12:15], s20 offen
s_mov_b32 s21, 1875968
buffer_load_dword v11, v1, s[12:15], s21 offen
s_waitcnt vmcnt(55)
v_perm_b32 v75, v13, v12, s46
v_perm_b32 v83, v13, v12, s47
s_mov_b32 s20, 1908736
buffer_load_dword v12, v1, s[12:15], s20 offen
s_mov_b32 s21, 1941504
buffer_load_dword v13, v1, s[12:15], s21 offen
s_waitcnt vmcnt(55)
v_perm_b32 v76, v15, v14, s46
v_perm_b32 v84, v15, v14, s47
s_barrier
s_mov_b32 s20, 2097152
buffer_load_dword v14, v1, s[12:15], s20 offen
s_mov_b32 s21, 2129920
buffer_load_dword v15, v1, s[12:15], s21 offen
s_waitcnt vmcnt(55)
v_perm_b32 v77, v17, v16, s46
v_perm_b32 v85, v17, v16, s47
s_mov_b32 s20, 2162688
buffer_load_dword v16, v1, s[12:15], s20 offen
s_mov_b32 s21, 2195456
buffer_load_dword v17, v1, s[12:15], s21 offen
s_waitcnt vmcnt(54)
v_perm_b32 v78, v19, v18, s46
v_perm_b32 v86, v19, v18, s47
s_mov_b32 s20, 2105344
buffer_load_dword v18, v1, s[12:15], s20 offen
s_mov_b32 s21, 2138112
buffer_load_dword v19, v1, s[12:15], s21 offen
s_waitcnt vmcnt(54)
v_perm_b32 v79, v21, v20, s46
v_perm_b32 v87, v21, v20, s47
s_mov_b32 s20, 2170880
buffer_load_dword v20, v1, s[12:15], s20 offen
s_mov_b32 s21, 2203648
buffer_load_dword v21, v1, s[12:15], s21 offen
s_waitcnt vmcnt(54)
v_perm_b32 v96, v23, v22, s46
v_perm_b32 v104, v23, v22, s47
s_barrier
s_mov_b32 s20, 2359296
buffer_load_dword v22, v1, s[12:15], s20 offen
s_mov_b32 s21, 2392064
buffer_load_dword v23, v1, s[12:15], s21 offen
s_waitcnt vmcnt(54)
v_perm_b32 v97, v25, v24, s46
v_perm_b32 v105, v25, v24, s47
s_mov_b32 s20, 2424832
buffer_load_dword v24, v1, s[12:15], s20 offen
s_mov_b32 s21, 2457600
buffer_load_dword v25, v1, s[12:15], s21 offen
s_waitcnt vmcnt(54)
v_perm_b32 v98, v27, v26, s46
v_perm_b32 v106, v27, v26, s47
v_and_b32 v62, 1, v0
v_lshlrev_b32 v63, 6, v62
v_mul_u32_u24 v62, 24, v62
v_sub_u32 v62, 32, v62
v_cmp_ne_u32 vcc, v5, v62
s_cbranch_vccz L_tok
v_add_u32 v63, 64, v63
s_mov_b32 s28, 0
L_poll_58:
buffer_load_dword v5, v63, s[56:59], 0 offen sc1
s_add_u32 s28, s28, 1
s_cmp_gt_u32 s28, 200000
s_cbranch_scc1 L_end
s_waitcnt vmcnt(0)
v_cmp_ne_u32 vcc, v5, v62
s_cbranch_vccz L_pd_59
s_sleep 1
s_branch L_poll_58
L_pd_59:
L_tok:
v_mov_b32 v5, 0
s_lshl_b32 s99, s16, 7
s_add_u32 s99, s99, 111149088
buffer_load_dword v5, v5, s[8:11], s99 offen sc1
v_lshlrev_b32 v62, 7, v0
s_getpc_b64 s[4:5]
L_pc2:
s_mov_b32 s40, s4
s_and_b32 s41, s5, 0xffff
s_mov_b32 s42, L_end-L_pc2
s_mov_b32 s43, 0x20000
buffer_load_dword v63, v62, s[40:43], 0 offen
s_mul_i32 s98, s16, 18432
s_add_u32 s98, s98, 109051904
s_lshl_b32 s100, s16, 11
s_add_u32 s100, s100, 110075904
s_cmp_eq_u32 s17, 3
s_cselect_b32 s98, s100, s98
buffer_load_dword v63, v62, s[8:11], s98 offen sc1
s_mov_b32 s40, s96
s_and_b32 s41, s97, 0xffff
s_mov_b32 s42, 9216
s_mov_b32 s43, 0x20000
buffer_load_dword v63, v62, s[40:43], 0 offen
s_mov_b32 s20, 2367488
buffer_load_dword v26, v1, s[12:15], s20 offen
s_mov_b32 s21, 2400256
buffer_load_dword v27, v1, s[12:15], s21 offen
s_waitcnt vmcnt(58)
v_perm_b32 v99, v29, v28, s46
v_perm_b32 v107, v29, v28, s47
s_mov_b32 s20, 2433024
buffer_load_dword v28, v1, s[12:15], s20 offen
s_mov_b32 s21, 2465792
buffer_load_dword v29, v1, s[12:15], s21 offen
s_waitcnt vmcnt(58)
v_perm_b32 v100, v31, v30, s46
v_perm_b32 v108, v31, v30, s47
s_barrier
s_mov_b32 s20, 2621440
buffer_load_dword v30, v1, s[12:15], s20 offen
s_mov_b32 s21, 2654208
buffer_load_dword v31, v1, s[12:15], s21 offen
s_waitcnt vmcnt(58)
v_perm_b32 v101, v33, v32, s46
v_perm_b32 v109, v33, v32, s47
s_mov_b32 s20, 2686976
buffer_load_dword v32, v1, s[12:15], s20 offen
s_mov_b32 s21, 2719744
buffer_load_dword v33, v1, s[12:15], s21 offen
s_waitcnt vmcnt(58)
v_perm_b32 v102, v35, v34, s46
v_perm_b32 v110, v35, v34, s47
s_mov_b32 s20, 2629632
buffer_load_dword v34, v1, s[12:15], s20 offen
s_mov_b32 s21, 2662400
buffer_load_dword v35, v1, s[12:15], s21 offen
s_waitcnt vmcnt(58)
v_perm_b32 v103, v37, v36, s46
v_perm_b32 v111, v37, v36, s47
s_mov_b32 s20, 2695168
buffer_load_dword v36, v1, s[12:15], s20 offen
s_mov_b32 s21, 2727936
buffer_load_dword v37, v1, s[12:15], s21 offen
s_waitcnt vmcnt(58)
v_perm_b32 v120, v39, v38, s46
v_perm_b32 v128, v39, v38, s47
s_barrier
s_mov_b32 s20, 2883584
buffer_load_dword v38, v1, s[12:15], s20 offen
s_mov_b32 s21, 2916352
buffer_load_dword v39, v1, s[12:15], s21 offen
s_waitcnt vmcnt(58)
v_perm_b32 v121, v41, v40, s46
v_perm_b32 v129, v41, v40, s47
s_mov_b32 s20, 2949120
buffer_load_dword v40, v1, s[12:15], s20 offen
s_mov_b32 s21, 2981888
buffer_load_dword v41, v1, s[12:15], s21 offen
s_waitcnt vmcnt(58)
v_perm_b32 v122, v43, v42, s46
v_perm_b32 v130, v43, v42, s47
s_mov_b32 s20, 2891776
buffer_load_dword v42, v1, s[12:15], s20 offen
s_mov_b32 s21, 2924544
buffer_load_dword v43, v1, s[12:15], s21 offen
s_waitcnt vmcnt(58)
v_perm_b32 v123, v45, v44, s46
v_perm_b32 v131, v45, v44, s47
s_mov_b32 s20, 2957312
buffer_load_dword v44, v1, s[12:15], s20 offen
s_mov_b32 s21, 2990080
buffer_load_dword v45, v1, s[12:15], s21 offen
s_waitcnt vmcnt(58)
v_perm_b32 v124, v47, v46, s46
v_perm_b32 v132, v47, v46, s47
s_barrier
s_mov_b32 s20, 3145728
buffer_load_dword v46, v1, s[12:15], s20 offen
s_mov_b32 s21, 3178496
buffer_load_dword v47, v1, s[12:15], s21 offen
s_waitcnt vmcnt(58)
v_perm_b32 v125, v49, v48, s46
v_perm_b32 v133, v49, v48, s47
s_mov_b32 s20, 3211264
buffer_load_dword v48, v1, s[12:15], s20 offen
s_mov_b32 s21, 3244032
buffer_load_dword v49, v1, s[12:15], s21 offen
s_waitcnt vmcnt(58)
v_perm_b32 v126, v51, v50, s46
v_perm_b32 v134, v51, v50, s47
s_mov_b32 s20, 3153920
buffer_load_dword v50, v1, s[12:15], s20 offen
s_mov_b32 s21, 3186688
buffer_load_dword v51, v1, s[12:15], s21 offen
s_waitcnt vmcnt(58)
v_perm_b32 v127, v53, v52, s46
v_perm_b32 v135, v53, v52, s47
s_mov_b32 s20, 3219456
buffer_load_dword v52, v1, s[12:15], s20 offen
s_mov_b32 s21, 3252224
buffer_load_dword v53, v1, s[12:15], s21 offen
s_waitcnt vmcnt(58)
v_perm_b32 v144, v55, v54, s46
v_perm_b32 v152, v55, v54, s47
s_barrier
s_mov_b32 s20, 3407872
buffer_load_dword v54, v1, s[12:15], s20 offen
s_mov_b32 s21, 3440640
buffer_load_dword v55, v1, s[12:15], s21 offen
s_waitcnt vmcnt(58)
v_perm_b32 v145, v57, v56, s46
v_perm_b32 v153, v57, v56, s47
s_mov_b32 s20, 3473408
buffer_load_dword v56, v1, s[12:15], s20 offen
s_mov_b32 s21, 3506176
buffer_load_dword v57, v1, s[12:15], s21 offen
s_waitcnt vmcnt(58)
v_perm_b32 v146, v59, v58, s46
v_perm_b32 v154, v59, v58, s47
s_mov_b32 s20, 3416064
buffer_load_dword v58, v1, s[12:15], s20 offen
s_mov_b32 s21, 3448832
buffer_load_dword v59, v1, s[12:15], s21 offen
s_waitcnt vmcnt(58)
v_perm_b32 v147, v61, v60, s46
v_perm_b32 v155, v61, v60, s47
s_mov_b32 s20, 3481600
buffer_load_dword v60, v1, s[12:15], s20 offen
s_mov_b32 s21, 3514368
buffer_load_dword v61, v1, s[12:15], s21 offen
s_waitcnt vmcnt(58)
v_perm_b32 v148, v7, v6, s46
v_perm_b32 v156, v7, v6, s47
s_barrier
s_mov_b32 s20, 3670016
buffer_load_dword v6, v1, s[12:15], s20 offen
s_mov_b32 s21, 3702784
buffer_load_dword v7, v1, s[12:15], s21 offen
s_waitcnt vmcnt(58)
v_perm_b32 v149, v9, v8, s46
v_perm_b32 v157, v9, v8, s47
s_mov_b32 s20, 3735552
buffer_load_dword v8, v1, s[12:15], s20 offen
s_mov_b32 s21, 3768320
buffer_load_dword v9, v1, s[12:15], s21 offen
s_waitcnt vmcnt(58)
v_perm_b32 v150, v11, v10, s46
v_perm_b32 v158, v11, v10, s47
s_mov_b32 s20, 3678208
buffer_load_dword v10, v1, s[12:15], s20 offen
s_mov_b32 s21, 3710976
buffer_load_dword v11, v1, s[12:15], s21 offen
s_waitcnt vmcnt(58)
v_perm_b32 v151, v13, v12, s46
v_perm_b32 v159, v13, v12, s47
s_mov_b32 s20, 3743744
buffer_load_dword v12, v1, s[12:15], s20 offen
s_mov_b32 s21, 3776512
buffer_load_dword v13, v1, s[12:15], s21 offen
s_waitcnt vmcnt(58)
v_perm_b32 v168, v15, v14, s46
v_perm_b32 v176, v15, v14, s47
s_barrier
s_mov_b32 s20, 3932160
buffer_load_dword v14, v1, s[12:15], s20 offen
s_mov_b32 s21, 3964928
buffer_load_dword v15, v1, s[12:15], s21 offen
s_waitcnt vmcnt(58)
v_perm_b32 v169, v17, v16, s46
v_perm_b32 v177, v17, v16, s47
s_mov_b32 s20, 3997696
buffer_load_dword v16, v1, s[12:15], s20 offen
s_mov_b32 s21, 4030464
buffer_load_dword v17, v1, s[12:15], s21 offen
s_waitcnt vmcnt(58)
v_perm_b32 v170, v19, v18, s46
v_perm_b32 v178, v19, v18, s47
s_mov_b32 s20, 3940352
buffer_load_dword v18, v1, s[12:15], s20 offen
s_mov_b32 s21, 3973120
buffer_load_dword v19, v1, s[12:15], s21 offen
s_waitcnt vmcnt(58)
v_perm_b32 v171, v21, v20, s46
v_perm_b32 v179, v21, v20, s47
s_mov_b32 s20, 4005888
buffer_load_dword v20, v1, s[12:15], s20 offen
s_mov_b32 s21, 4038656
buffer_load_dword v21, v1, s[12:15], s21 offen
s_waitcnt vmcnt(58)
v_perm_b32 v172, v23, v22, s46
v_perm_b32 v180, v23, v22, s47
s_barrier
s_mov_b32 s20, 4194304
buffer_load_dword v22, v1, s[12:15], s20 offen
s_mov_b32 s21, 4227072
buffer_load_dword v23, v1, s[12:15], s21 offen
s_waitcnt vmcnt(58)
v_perm_b32 v173, v25, v24, s46
v_perm_b32 v181, v25, v24, s47
s_mov_b32 s20, 4259840
buffer_load_dword v24, v1, s[12:15], s20 offen
s_mov_b32 s21, 4292608
buffer_load_dword v25, v1, s[12:15], s21 offen
s_waitcnt vmcnt(54)
v_perm_b32 v174, v27, v26, s46
v_perm_b32 v182, v27, v26, s47
s_mov_b32 s20, 4202496
buffer_load_dword v26, v1, s[12:15], s20 offen
s_mov_b32 s21, 4235264
buffer_load_dword v27, v1, s[12:15], s21 offen
s_waitcnt vmcnt(54)
v_perm_b32 v175, v29, v28, s46
v_perm_b32 v183, v29, v28, s47
s_mov_b32 s20, 4268032
buffer_load_dword v28, v1, s[12:15], s20 offen
s_mov_b32 s21, 4300800
buffer_load_dword v29, v1, s[12:15], s21 offen
s_waitcnt vmcnt(54)
v_perm_b32 v192, v31, v30, s46
v_perm_b32 v200, v31, v30, s47
s_barrier
s_mov_b32 s20, 4456448
buffer_load_dword v30, v1, s[12:15], s20 offen
s_mov_b32 s21, 4489216
buffer_load_dword v31, v1, s[12:15], s21 offen
s_waitcnt vmcnt(54)
v_perm_b32 v193, v33, v32, s46
v_perm_b32 v201, v33, v32, s47
s_mov_b32 s20, 4521984
buffer_load_dword v32, v1, s[12:15], s20 offen
s_mov_b32 s21, 4554752
buffer_load_dword v33, v1, s[12:15], s21 offen
s_waitcnt vmcnt(54)
v_perm_b32 v194, v35, v34, s46
v_perm_b32 v202, v35, v34, s47
v_readfirstlane_b32 s101, v5
s_cmp_lt_u32 s17, 2
s_cselect_b32 s98, s30, 536870912
s_cmp_eq_u32 s101, 1
s_cselect_b32 s98, s98, 536870912
buffer_load_dword v63, v62, s[8:11], s98 offen sc1
s_mov_b32 s20, 4464640
buffer_load_dword v34, v1, s[12:15], s20 offen
s_mov_b32 s21, 4497408
buffer_load_dword v35, v1, s[12:15], s21 offen
s_waitcnt vmcnt(55)
v_perm_b32 v195, v37, v36, s46
v_perm_b32 v203, v37, v36, s47
s_mov_b32 s20, 4530176
buffer_load_dword v36, v1, s[12:15], s20 offen
s_mov_b32 s21, 4562944
buffer_load_dword v37, v1, s[12:15], s21 offen
s_waitcnt vmcnt(55)
v_perm_b32 v196, v39, v38, s46
v_perm_b32 v204, v39, v38, s47
s_waitcnt vmcnt(53)
v_perm_b32 v197, v41, v40, s46
v_perm_b32 v205, v41, v40, s47
s_waitcnt vmcnt(51)
v_perm_b32 v198, v43, v42, s46
v_perm_b32 v206, v43, v42, s47
s_waitcnt vmcnt(49)
v_perm_b32 v199, v45, v44, s46
v_perm_b32 v207, v45, v44, s47
s_waitcnt vmcnt(47)
v_perm_b32 v216, v47, v46, s46
v_perm_b32 v224, v47, v46, s47
s_waitcnt vmcnt(45)
v_perm_b32 v217, v49, v48, s46
v_perm_b32 v225, v49, v48, s47
s_waitcnt vmcnt(43)
v_perm_b32 v218, v51, v50, s46
v_perm_b32 v226, v51, v50, s47
s_waitcnt vmcnt(41)
v_perm_b32 v219, v53, v52, s46
v_perm_b32 v227, v53, v52, s47
s_waitcnt vmcnt(39)
v_perm_b32 v220, v55, v54, s46
v_perm_b32 v228, v55, v54, s47
s_waitcnt vmcnt(37)
v_perm_b32 v221, v57, v56, s46
v_perm_b32 v229, v57, v56, s47
s_waitcnt vmcnt(35)
v_perm_b32 v222, v59, v58, s46
v_perm_b32 v230, v59, v58, s47
s_waitcnt vmcnt(33)
v_perm_b32 v223, v61, v60, s46
v_perm_b32 v231, v61, v60, s47
s_waitcnt vmcnt(31)
v_perm_b32 v240, v7, v6, s46
v_perm_b32 v248, v7, v6, s47
s_waitcnt vmcnt(29)
v_perm_b32 v241, v9, v8, s46
v_perm_b32 v249, v9, v8, s47
s_waitcnt vmcnt(27)
v_perm_b32 v242, v11, v10, s46
v_perm_b32 v250, v11, v10, s47
s_waitcnt vmcnt(25)
v_perm_b32 v243, v13, v12, s46
v_perm_b32 v251, v13, v12, s47
s_waitcnt vmcnt(23)
v_perm_b32 v244, v15, v14, s46
v_perm_b32 v252, v15, v14, s47
s_waitcnt vmcnt(21)
v_perm_b32 v245, v17, v16, s46
v_perm_b32 v253, v17, v16, s47
s_waitcnt vmcnt(19)
v_perm_b32 v246, v19, v18, s46
v_perm_b32 v254, v19, v18, s47
s_waitcnt vmcnt(17)
v_perm_b32 v247, v21, v20, s46
v_perm_b32 v255, v21, v20, s47
s_waitcnt vmcnt(15)
v_perm_b32 v64, v23, v22, s46
v_accvgpr_write_b32 a8, v64
v_perm_b32 v68, v23, v22, s47
v_accvgpr_write_b32 a16, v68
s_waitcnt vmcnt(13)
v_perm_b32 v65, v25, v24, s46
v_accvgpr_write_b32 a9, v65
v_perm_b32 v69, v25, v24, s47
v_accvgpr_write_b32 a17, v69
s_waitcnt vmcnt(11)
v_perm_b32 v66, v27, v26, s46
v_accvgpr_write_b32 a10, v66
v_perm_b32 v70, v27, v26, s47
v_accvgpr_write_b32 a18, v70
s_waitcnt vmcnt(9)
v_perm_b32 v67, v29, v28, s46
v_accvgpr_write_b32 a11, v67
v_perm_b32 v71, v29, v28, s47
v_accvgpr_write_b32 a19, v71
s_waitcnt vmcnt(7)
v_perm_b32 v64, v31, v30, s46
v_accvgpr_write_b32 a12, v64
v_perm_b32 v68, v31, v30, s47
v_accvgpr_write_b32 a20, v68
s_waitcnt vmcnt(5)
v_perm_b32 v65, v33, v32, s46
v_accvgpr_write_b32 a13, v65
v_perm_b32 v69, v33, v32, s47
v_accvgpr_write_b32 a21, v69
s_waitcnt vmcnt(2)
v_perm_b32 v66, v35, v34, s46
v_accvgpr_write_b32 a14, v66
v_perm_b32 v70, v35, v34, s47
v_accvgpr_write_b32 a22, v70
s_waitcnt vmcnt(0)
v_perm_b32 v67, v37, v36, s46
v_accvgpr_write_b32 a15, v67
v_perm_b32 v71, v37, v36, s47
v_accvgpr_write_b32 a23, v71
v_mov_b32 v12, v0
v_and_b32 v13, 15, v0
v_bfe_u32 v14, v0, 4, 2
v_lshlrev_b32 v3, 4, v12
v_and_b32 v2, 0x3f0, v3
s_mul_i32 s20, s17, 34816
s_add_u32 s20, s20, 24576
v_add_u32 v2, s20, v2
v_and_b32 v15, 1, v12
v_mul_u32_u24 v0, 0xaaaa, v15
v_add_u32 v0, 0xffff4444, v0
v_lshrrev_b32 v18, 2, v13
v_lshl_add_u32 v18, v18, 1, v15
v_bfe_u32 v19, v13, 1, 1
v_lshrrev_b32 v16, 5, v12
v_lshlrev_b32 v16, 8, v16
v_lshl_add_u32 v16, v18, 5, v16
v_and_b32 v17, 1, v14
v_lshl_add_u32 v16, v17, 4, v16
v_and_b32 v17, 0x7f, v16
v_xor_b32 v17, 16, v17
v_add_u32 v16, 4224, v16
v_add_u32 v17, 6272, v17
v_cmp_eq_u32 vcc, 1, v19
s_nop 1
v_cndmask_b32 v7, v17, v16, vcc
v_lshrrev_b32 v16, 1, v14
v_lshlrev_b32 v16, 8, v16
v_lshl_add_u32 v16, v15, 7, v16
v_and_b32 v17, 1, v14
v_lshl_add_u32 v16, v17, 6, v16
v_lshrrev_b32 v17, 2, v13
v_lshl_add_u32 v16, v17, 4, v16
v_mul_u32_u24 v17, 2112, v19
v_add_u32 v5, v16, v17
v_bfe_u32 v16, v13, 3, 1
v_lshlrev_b32 v16, 8, v16
v_lshl_add_u32 v16, v19, 6, v16
v_lshl_add_u32 v16, v14, 4, v16
v_bfe_u32 v17, v13, 2, 1
v_lshl_add_u32 v16, v17, 3, v16
v_lshl_add_u32 v16, v15, 2, v16
s_lshl_b32 s20, s17, 9
v_add_u32 v4, s20, v16
v_lshrrev_b32 v16, 4, v12
v_xor_b32 v17, s16, v16
v_lshlrev_b32 v16, 12, v16
v_lshl_add_u32 v16, v17, 7, v16
v_lshl_add_u32 v9, v13, 3, v16
s_lshr_b32 s20, s17, 1
s_lshl_b32 s20, s20, 2
v_add_u32 v16, s20, v14
v_xor_b32 v17, s16, v16
v_lshlrev_b32 v16, 12, v16
v_lshl_add_u32 v16, v17, 7, v16
v_lshl_add_u32 v16, v13, 2, v16
s_and_b32 s20, s17, 1
s_lshl_b32 s20, s20, 6
s_add_u32 s20, s20, 262144
v_add_u32 v10, s20, v16
v_bfe_u32 v16, v13, 2, 1
v_lshlrev_b32 v16, 5, v16
v_and_b32 v17, 1, v14
v_lshl_add_u32 v16, v17, 8, v16
v_lshrrev_b32 v17, 1, v14
v_lshl_add_u32 v16, v17, 4, v16
v_and_b32 v17, 3, v13
v_lshl_add_u32 v11, v17, 2, v16
v_lshlrev_b32 v6, 7, v12
v_lshlrev_b32 v8, 2, v12
s_mov_b32 s36, 0x11111111
s_mov_b32 s37, 0x11111111
s_mov_b32 s38, 0x22222222
s_mov_b32 s39, 0x22222222
s_mov_b32 s40, 0x44444444
s_mov_b32 s41, 0x44444444
s_mov_b32 s42, 0x88888888
s_mov_b32 s43, 0x88888888
s_mov_b32 s44, 0xf0f0f0f0
s_mov_b32 s45, 0xf0f0f0f0
s_mov_b32 s18, 0x3e0293ee
s_lshl_b32 s20, s17, 5
s_add_u32 s20, s20, s16
s_cmp_lt_u32 s20, 72
s_cselect_b32 s48, 1, 0
s_lshl_b32 s23, s20, 12
s_lshl_b32 s21, s17, 10
s_sub_u32 s23, s23, s21
s_lshr_b32 s24, s20, 2
s_lshl_b32 s24, s24, 9
s_and_b32 s21, s20, 3
s_lshl_b32 s21, s21, 6
s_add_u32 s24, s24, s21
s_add_u32 s24, s24, 110100480
s_cmp_lt_u32 s20, 72
s_cselect_b32 s24, s24, 536870912
s_lshl_b32 s25, s16, 12
s_add_u32 s26, s25, 131072
s_add_u32 s27, s25, 262144
s_cmp_lt_u32 s16, 8
s_cselect_b32 s27, s27, 536870912
s_mov_b32 s28, 109051904
s_mov_b32 s29, 109346816
s_lshl_b32 s30, s16, 14
s_add_u32 s30, s30, 33554432
s_lshl_b32 s31, s16, 12
s_add_u32 s31, s31, 100663296
s_add_u32 s35, s24, 32768
s_mov_b32 s53, 0x3f803f80
s_mov_b32 s86, 0x33333333
s_mov_b32 s87, 0x33333333
s_lshl_b32 s84, s17, 13
s_sub_u32 s84, s20, s84
s_add_u32 s84, s84, 110886912
s_cmp_lt_u32 s20, 72
s_cselect_b32 s84, s84, 536870912
s_and_b32 s21, s16, 3
s_lshl_b32 s21, s21, 7
s_add_u32 s21, s21, 110886144
s_cmp_eq_u32 s17, 3
s_cselect_b32 s84, s21, s84
s_lshl_b32 s82, s16, 7
s_add_u32 s83, s82, 111152384
s_add_u32 s82, s82, 111148288
s_mov_b32 s19, 0
s_mov_b32 s12, s96
s_and_b32 s13, s97, 0xffff
s_mov_b32 s14, 9216
s_mov_b32 s15, 0x20000
v_bfe_u32 v64, v3, 5, 3
v_mul_u32_u24 v64, 1152, v64
v_lshrrev_b32 v65, 8, v3
v_lshl_add_u32 v64, v65, 5, v64
v_and_b32 v65, 16, v3
v_add_u32 v64, v64, v65
buffer_load_dwordx4 v[24:27], v64, s[12:15], 0 offen
buffer_load_dwordx4 v[28:31], v64, s[12:15], 0 offen offset:512
buffer_load_dwordx4 v[32:35], v64, s[12:15], 0 offen offset:1024
s_cmp_eq_u32 s101, 1
s_cbranch_scc1 L_kv0
v_mov_b32 v66, 0
s_mov_b32 s22, 0
L_poll_60:
buffer_load_dword v67, v66, s[8:11], s99 offen sc1
s_add_u32 s22, s22, 1
s_cmp_gt_u32 s22, 200000
s_cbranch_scc1 L_end
s_waitcnt vmcnt(0)
v_cmp_ne_u32 vcc, 1, v67
s_cbranch_vccz L_pd_61
s_branch L_poll_60
L_pd_61:
s_cmp_lt_u32 s17, 2
s_cselect_b32 s98, s30, 536870912
buffer_load_dword v67, v6, s[8:11], s98 offen sc1
L_kv0:
s_waitcnt vmcnt(0)
v_perm_b32 v12, v26, v24, s46
v_perm_b32 v13, v26, v24, s47
v_perm_b32 v14, v27, v25, s46
v_perm_b32 v15, v27, v25, s47
v_min_u32 v12, 0xfffeffff, v12
v_min_u32 v13, 0xfffeffff, v13
v_min_u32 v14, 0xfffeffff, v14
v_min_u32 v15, 0xfffeffff, v15
v_perm_b32 v16, v30, v28, s46
v_perm_b32 v17, v30, v28, s47
v_perm_b32 v18, v31, v29, s46
v_perm_b32 v19, v31, v29, s47
v_min_u32 v16, 0xfffeffff, v16
v_min_u32 v17, 0xfffeffff, v17
v_min_u32 v18, 0xfffeffff, v18
v_min_u32 v19, 0xfffeffff, v19
v_perm_b32 v20, v34, v32, s46
v_perm_b32 v21, v34, v32, s47
v_perm_b32 v22, v35, v33, s46
v_perm_b32 v23, v35, v33, s47
v_min_u32 v20, 0xfffeffff, v20
v_min_u32 v21, 0xfffeffff, v21
v_min_u32 v22, 0xfffeffff, v22
v_min_u32 v23, 0xfffeffff, v23
s_cmp_lg_u32 s17, 0
s_cbranch_scc1 L_m0_62
ds_write_b128 v3, v[20:23] offset:14848
v_mov_b32 v64, 6528
v_mov_b32 v56, 0
v_mov_b32 v57, 0
v_mov_b32 v58, 0
v_mov_b32 v59, 0
ds_write_b128 v64, v[56:59]
L_m0_62:
s_waitcnt lgkmcnt(0)
s_barrier
ds_read_b32 v20, v8 offset:14848
s_waitcnt lgkmcnt(0)
s_mov_b32 s33, 110100480
s_mov_b32 s6, 110100480
s_mov_b32 s7, 110100480
s_mov_b32 s22, 0
s_cmp_eq_u32 s17, 0
s_cbranch_scc1 L_ent0
s_cmp_eq_u32 s17, 1
s_cbranch_scc1 L_ent1
s_cmp_eq_u32 s17, 2
s_cbranch_scc1 L_ent2
s_cmp_eq_u32 s17, 3
s_cbranch_scc1 L_ent3
s_branch L_end
L_ent0:
s_movk_i32 s4, -64
s_mov_b32 s14, s53
s_mov_b32 s15, s53
v_mov_b64 v[24:25], 0
v_mov_b64 v[26:27], 0
v_mov_b64 v[28:29], 0
v_mov_b64 v[30:31], 0
v_and_b32 v69, 0x380, v3
v_add_u32 v69, v69, v3
v_and_b32 v70, 0xf40, v3
v_add_u32 v70, v70, v3
v_bfe_u32 v71, v3, 7, 1
v_mad_i32_i24 v70, v71, s4, v70
v_mov_b64 v[64:65], -1
v_mov_b64 v[66:67], -1
v_add_u32 v1, 2112, v4
ds_read_b128 v[48:51], v2 offset:8192
ds_read_b128 v[52:55], v2 offset:9216
ds_read_b128 v[40:43], v2
ds_read_b128 v[44:47], v2 offset:1024
v_mov_b64 v[32:33], 0
v_mov_b64 v[34:35], 0
v_mov_b64 v[36:37], 0
v_mov_b64 v[38:39], 0
v_mov_b64 v[56:57], 0
v_mov_b64 v[58:59], 0
v_mov_b64 v[60:61], 0
v_mov_b64 v[62:63], 0
s_add_u32 s20, s30, 0
s_add_u32 s21, s30, 8192
s_add_u32 s49, s29, s25
s_add_u32 s50, s29, s26
s_add_u32 s51, s29, s27
s_add_u32 s52, s30, 524288
s_mov_b32 m0, 15872
s_nop 0
buffer_load_dwordx4 v69, s[8:11], s20 offen sc1 lds
s_mov_b32 m0, 16768
s_nop 0
buffer_load_dwordx4 v69, s[8:11], s20 offen offset:128 sc1 lds
s_waitcnt vmcnt(0) lgkmcnt(0)
s_branch L_step0
L_gr0:
buffer_load_dwordx4 v[12:15], v3, s[8:11], s33 offen sc1
buffer_load_dword v20, v8, s[8:11], s7 offen sc1
buffer_load_dwordx4 v[16:19], v3, s[8:11], s6 offen sc1
s_add_u32 s22, s22, 1
s_cmp_gt_u32 s22, 200000
s_cbranch_scc1 L_end
buffer_load_dwordx4 v[16:19], v3, s[8:11], s6 offen sc1
v_mov_b64 v[24:25], 0
v_mov_b64 v[26:27], 0
v_mov_b64 v[28:29], 0
v_mov_b64 v[30:31], 0
v_mov_b64 v[32:33], 0
v_mov_b64 v[34:35], 0
v_mov_b64 v[36:37], 0
v_mov_b64 v[38:39], 0
v_mov_b64 v[56:57], 0
v_mov_b64 v[58:59], 0
v_mov_b64 v[60:61], 0
v_mov_b64 v[62:63], 0
s_waitcnt lgkmcnt(0)
s_branch L_step0
.p2align 3
L_gat0:
buffer_load_dwordx4 v[12:15], v3, s[8:11], s33 offen sc1
buffer_load_dword v20, v8, s[8:11], s7 offen sc1
s_add_u32 s20, s30, 0
s_add_u32 s21, s30, 8192
s_add_u32 s49, s29, s25
s_add_u32 s50, s29, s26
s_add_u32 s51, s29, s27
s_add_u32 s52, s30, 524288
buffer_load_dwordx4 v[16:19], v3, s[8:11], s6 offen sc1
s_mov_b32 m0, 15872
s_waitcnt vmcnt(4)
ds_read_b128 v[40:43], v2
ds_read_b128 v[44:47], v2 offset:1024
v_mov_b64 v[32:33], 0
v_mov_b64 v[34:35], 0
v_mov_b64 v[36:37], 0
v_mov_b64 v[38:39], 0
v_mov_b64 v[56:57], 0
v_mov_b64 v[58:59], 0
v_mov_b64 v[60:61], 0
v_mov_b64 v[62:63], 0
s_nop 3
buffer_load_dwordx4 v[16:19], v3, s[8:11], s6 offen sc1
s_waitcnt lgkmcnt(0)
L_step0:
s_waitcnt vmcnt(3)
v_smfmac_f32_16x16x64_bf16 v[24:27], v[12:15], v[72:79], v0
ds_write_b128 v3, v[12:15] offset:6656
v_smfmac_f32_16x16x64_bf16 v[28:31], v[12:15], v[80:87], v0
s_waitcnt vmcnt(2)
v_max3_u32 v21, v12, v13, v14
v_max3_u32 v21, v21, v15, v20
v_cmp_le_u32 vcc, 0xffff0000, v21
v_smfmac_f32_16x16x64_bf16 v[32:35], v[12:15], v[88:95], v0
s_cbranch_vccnz L_gr0
s_waitcnt vmcnt(1)
v_max3_u32 v21, v16, v17, v18
v_max_u32 v21, v21, v19
v_cmp_le_u32 vcc, 0xffff0000, v21
ds_write_b32 v8, v20 offset:14848
v_smfmac_f32_16x16x64_bf16 v[56:59], v[12:15], a[32:39], v0
s_cbranch_vccnz L_g3r0
L_g30:
ds_write_b128 v3, v[16:19] offset:10752
v_smfmac_f32_16x16x64_bf16 v[60:63], v[12:15], a[40:47], v0
v_smfmac_f32_16x16x64_bf16 v[36:39], v[12:15], v[40:47], v0
v_smfmac_f32_16x16x64_bf16 v[24:27], v[16:19], v[168:175], v0
v_smfmac_f32_16x16x64_bf16 v[28:31], v[16:19], v[176:183], v0
s_waitcnt lgkmcnt(0)
s_barrier
ds_read_b128 v[20:23], v3 offset:7680
v_smfmac_f32_16x16x64_bf16 v[32:35], v[16:19], v[184:191], v0
ds_read_b128 v[12:15], v3 offset:8704
s_mov_b32 m0, 6272
buffer_store_dword v0, v11, s[8:11], s35 offen
v_smfmac_f32_16x16x64_bf16 v[56:59], v[16:19], a[96:103], v0
ds_read_b128 v[40:43], v2 offset:2048
buffer_store_dwordx4 v[64:67], v3, s[8:11], s49 offen
v_smfmac_f32_16x16x64_bf16 v[60:63], v[16:19], a[104:111], v0
ds_read_b128 v[44:47], v2 offset:3072
v_smfmac_f32_16x16x64_bf16 v[36:39], v[16:19], v[48:55], v0
s_waitcnt vmcnt(2)
ds_read_b128 v[16:19], v3 offset:9728
buffer_store_dwordx4 v[64:67], v3, s[8:11], s50 offen
s_waitcnt lgkmcnt(4)
v_smfmac_f32_16x16x64_bf16 v[24:27], v[20:23], v[96:103], v0
ds_read_b128 v[48:51], v2 offset:4096
v_smfmac_f32_16x16x64_bf16 v[28:31], v[20:23], v[104:111], v0
ds_read_b128 v[52:55], v2 offset:5120
buffer_store_dwordx4 v[64:67], v3, s[8:11], s51 offen
v_smfmac_f32_16x16x64_bf16 v[32:35], v[20:23], v[112:119], v0
s_waitcnt lgkmcnt(3)
v_smfmac_f32_16x16x64_bf16 v[36:39], v[20:23], v[40:47], v0
ds_read_b128 v[20:23], v3 offset:11776
buffer_load_dwordx4 v[64:67], v70, s[8:11], s21 offen sc1
v_smfmac_f32_16x16x64_bf16 v[24:27], v[12:15], v[120:127], v0
ds_read_b128 v[40:43], v2 offset:6144
v_smfmac_f32_16x16x64_bf16 v[28:31], v[12:15], v[128:135], v0
ds_read_b128 v[44:47], v2 offset:7168
buffer_load_dwordx4 v[68:71], v70, s[8:11], s21 offen offset:256 sc1
v_smfmac_f32_16x16x64_bf16 v[32:35], v[12:15], v[136:143], v0
s_waitcnt lgkmcnt(3)
v_smfmac_f32_16x16x64_bf16 v[36:39], v[12:15], v[48:55], v0
ds_read_b128 v[12:15], v3 offset:12800
v_smfmac_f32_16x16x64_bf16 v[24:27], v[16:19], v[144:151], v0
ds_read_b128 v[48:51], v2 offset:10240
v_smfmac_f32_16x16x64_bf16 v[28:31], v[16:19], v[152:159], v0
ds_read_b128 v[52:55], v2 offset:11264
v_smfmac_f32_16x16x64_bf16 v[32:35], v[16:19], v[160:167], v0
s_waitcnt lgkmcnt(3)
buffer_load_dword v6, s[8:11], s52 offen sc1 lds
v_smfmac_f32_16x16x64_bf16 v[36:39], v[16:19], v[40:47], v0
ds_read_b128 v[16:19], v3 offset:13824
v_smfmac_f32_16x16x64_bf16 v[24:27], v[20:23], v[192:199], v0
ds_read_b128 v[40:43], v2 offset:12288
v_smfmac_f32_16x16x64_bf16 v[28:31], v[20:23], v[200:207], v0
ds_read_b128 v[44:47], v2 offset:13312
v_smfmac_f32_16x16x64_bf16 v[32:35], v[20:23], v[208:215], v0
s_waitcnt lgkmcnt(3)
v_smfmac_f32_16x16x64_bf16 v[36:39], v[20:23], v[48:55], v0
ds_read_b128 v[20:23], v3 offset:14848
v_smfmac_f32_16x16x64_bf16 v[24:27], v[12:15], v[216:223], v0
ds_read_b128 v[48:51], v2 offset:14336
v_smfmac_f32_16x16x64_bf16 v[28:31], v[12:15], v[224:231], v0
ds_read_b128 v[52:55], v2 offset:15360
v_smfmac_f32_16x16x64_bf16 v[32:35], v[12:15], v[232:239], v0
s_waitcnt lgkmcnt(3)
v_smfmac_f32_16x16x64_bf16 v[36:39], v[12:15], v[40:47], v0
ds_read_b128 v[12:15], v3 offset:7680
v_smfmac_f32_16x16x64_bf16 v[24:27], v[16:19], v[240:247], v0
ds_read_b128 v[40:43], v2 offset:16384
v_smfmac_f32_16x16x64_bf16 v[28:31], v[16:19], v[248:255], v0
ds_read_b128 v[44:47], v2 offset:17408
v_smfmac_f32_16x16x64_bf16 v[32:35], v[16:19], a[0:7], v0
s_waitcnt lgkmcnt(3)
v_smfmac_f32_16x16x64_bf16 v[36:39], v[16:19], v[48:55], v0
ds_read_b128 v[16:19], v3 offset:8704
v_smfmac_f32_16x16x64_bf16 v[24:27], v[20:23], a[8:15], v0
ds_read_b128 v[48:51], v3 offset:19968
v_smfmac_f32_16x16x64_bf16 v[28:31], v[20:23], a[16:23], v0
ds_read_b128 v[52:55], v3 offset:22016
v_smfmac_f32_16x16x64_bf16 v[32:35], v[20:23], a[24:31], v0
s_waitcnt lgkmcnt(3)
v_smfmac_f32_16x16x64_bf16 v[36:39], v[20:23], v[40:47], v0
ds_read_b128 v[20:23], v3 offset:9728
s_nop 0
v_add_f32 v24, v24, v25
v_smfmac_f32_16x16x64_bf16 v[56:59], v[12:15], a[48:55], v0
ds_read_b128 v[40:43], v3 offset:15872
v_add_f32 v26, v26, v27
v_add_f32 v28, v28, v29
v_add_f32 v30, v30, v31
v_mul_f32 v24, s18, v24
v_smfmac_f32_16x16x64_bf16 v[60:63], v[12:15], a[56:63], v0
ds_read_b128 v[12:15], v3 offset:11776
v_mul_f32 v28, s18, v28
v_mul_f32 v26, s18, v26
v_mul_f32 v30, s18, v30
v_cvt_pk_bf16_f32 v24, v24, v28
s_waitcnt lgkmcnt(5)
v_smfmac_f32_16x16x64_bf16 v[56:59], v[16:19], a[64:71], v0
ds_read_b128 v[44:47], v3 offset:17920
v_cvt_pk_bf16_f32 v26, v26, v30
ds_write2_b32 v1, v24, v26 offset1:32
v_add_f32 v32, v32, v33
v_add_f32 v34, v34, v35
v_smfmac_f32_16x16x64_bf16 v[60:63], v[16:19], a[72:79], v0
ds_read_b128 v[16:19], v3 offset:12800
v_add_f32 v36, v36, v37
v_add_f32 v38, v38, v39
v_cvt_pk_bf16_f32 v32, v32, v36
v_cvt_pk_bf16_f32 v34, v34, v38
s_waitcnt lgkmcnt(5)
v_smfmac_f32_16x16x64_bf16 v[56:59], v[20:23], a[80:87], v0
ds_write2_b32 v4, v32, v34 offset1:32
v_smfmac_f32_16x16x64_bf16 v[60:63], v[20:23], a[88:95], v0
s_waitcnt lgkmcnt(4)
ds_read_b128 v[20:23], v3 offset:13824
buffer_store_dword v32, v4, s[8:11], s31 offen sc1
v_smfmac_f32_16x16x64_bf16 v[56:59], v[12:15], a[112:119], v0
v_smfmac_f32_16x16x64_bf16 v[60:63], v[12:15], a[120:127], v0
s_waitcnt lgkmcnt(2)
ds_read_b128 v[12:15], v3 offset:14848
buffer_store_dword v34, v4, s[8:11], s31 offen offset:128 sc1
v_smfmac_f32_16x16x64_bf16 v[56:59], v[16:19], a[128:135], v0
v_smfmac_f32_16x16x64_bf16 v[60:63], v[16:19], a[136:143], v0
s_waitcnt lgkmcnt(1)
v_smfmac_f32_16x16x64_bf16 v[56:59], v[20:23], a[144:151], v0
s_barrier
ds_read_b128 v[24:27], v5
v_smfmac_f32_16x16x64_bf16 v[60:63], v[20:23], a[152:159], v0
s_waitcnt lgkmcnt(1)
ds_read_b128 v[28:31], v5 offset:512
v_smfmac_f32_16x16x64_bf16 v[56:59], v[12:15], a[160:167], v0
ds_read_b128 v[32:35], v5 offset:1024
v_smfmac_f32_16x16x64_bf16 v[60:63], v[12:15], a[168:175], v0
s_waitcnt lgkmcnt(2)
ds_read_b128 v[36:39], v5 offset:1536
v_mfma_f32_16x16x32_bf16 v[16:19], v[40:43], v[24:27], 0
s_waitcnt lgkmcnt(2)
ds_read_b128 v[40:43], v3 offset:16896
v_mfma_f32_16x16x32_bf16 v[16:19], v[44:47], v[28:31], v[16:19]
s_waitcnt lgkmcnt(2)
ds_read_b128 v[44:47], v3 offset:18944
v_mfma_f32_16x16x32_bf16 v[16:19], v[48:51], v[32:35], v[16:19]
s_waitcnt lgkmcnt(2)
ds_read_b128 v[48:51], v3 offset:20992
v_add_f32 v56, v56, v57
v_mfma_f32_16x16x32_bf16 v[16:19], v[52:55], v[36:39], v[16:19]
ds_read_b128 v[52:55], v3 offset:23040
v_add_f32 v58, v58, v59
v_mfma_f32_16x16x32_bf16 v[20:23], v[24:27], v[24:27], 0
s_add_u32 s49, s28, s23
v_add_f32 v60, v60, v61
v_add_f32 v62, v62, v63
v_mfma_f32_16x16x32_bf16 v[20:23], v[28:31], v[28:31], v[20:23]
s_add_u32 s50, s28, 65536
v_cvt_pk_bf16_f32 v56, v56, v58
v_cvt_pk_bf16_f32 v57, v60, v62
v_mfma_f32_16x16x32_bf16 v[20:23], v[32:35], v[32:35], v[20:23]
s_add_u32 s51, s28, 131072
v_exp_f32 v16, v16
buffer_store_dword v56, v8, s[8:11], s31 offen offset:2048 sc1
v_mfma_f32_16x16x32_bf16 v[20:23], v[36:39], v[36:39], v[20:23]
s_waitcnt lgkmcnt(3)
v_exp_f32 v17, v17
v_mfma_f32_16x16x32_bf16 v[12:15], v[40:43], v[24:27], 0
s_waitcnt lgkmcnt(2)
v_exp_f32 v18, v18
buffer_store_dword v57, v8, s[8:11], s31 offen offset:3072 sc1
v_mfma_f32_16x16x32_bf16 v[12:15], v[44:47], v[28:31], v[12:15]
s_waitcnt lgkmcnt(1)
v_exp_f32 v19, v19
v_mfma_f32_16x16x32_bf16 v[12:15], v[48:51], v[32:35], v[12:15]
s_waitcnt lgkmcnt(0)
v_exp_f32 v20, v20
v_mfma_f32_16x16x32_bf16 v[12:15], v[52:55], v[36:39], v[12:15]
s_add_u32 s52, s28, 196608
v_exp_f32 v21, v21
v_mov_b64 v[60:61], s[14:15]
v_cvt_pk_bf16_f32 v23, v20, v21
v_cvt_pk_bf16_f32 v20, v20, v21
v_mov_b32 v21, 0
v_mov_b32 v22, 0
v_cvt_pk_bf16_f32 v16, v16, v17
v_cvt_pk_bf16_f32 v17, v18, v19
v_mfma_f32_16x16x16_bf16 v[24:27], v[56:57], v[20:21], 0
v_exp_f32 v12, v12
v_mfma_f32_16x16x16_bf16 v[28:31], v[56:57], v[22:23], 0
v_exp_f32 v13, v13
v_mfma_f32_16x16x16_bf16 v[32:35], v[60:61], v[20:21], 0
v_exp_f32 v14, v14
v_exp_f32 v15, v15
v_mov_b64 v[62:63], s[14:15]
v_cvt_pk_bf16_f32 v18, v12, v13
v_cvt_pk_bf16_f32 v19, v14, v15
s_waitcnt vmcnt(5)
ds_read_b128 v[40:43], v2 offset:18432
v_mfma_f32_16x16x32_bf16 v[32:35], v[60:63], v[16:19], v[32:35]
ds_read_b128 v[44:47], v2 offset:19456
v_mov_b32 v20, 0
v_mfma_f32_16x16x32_bf16 v[24:27], v[64:67], v[16:19], v[24:27]
ds_read_b128 v[48:51], v2 offset:20480
v_mov_b32 v23, 0
v_mfma_f32_16x16x32_bf16 v[28:31], v[68:71], v[16:19], v[28:31]
ds_read_b128 v[52:55], v2 offset:21504
v_mov_b32 v15, 0
v_rcp_f32 v12, v32
v_subrev_u32 v14, 0x21800000, v32
v_cmp_le_u32 vcc, 0x3c000000, v14
v_pk_mul_f32 v[24:25], v[24:25], v[12:13] op_sel_hi:[1,0]
v_pk_mul_f32 v[26:27], v[26:27], v[12:13] op_sel_hi:[1,0]
ds_read_b128 v[32:35], v2 offset:22528
v_pk_mul_f32 v[28:29], v[28:29], v[12:13] op_sel_hi:[1,0]
v_pk_mul_f32 v[30:31], v[30:31], v[12:13] op_sel_hi:[1,0]
v_cvt_pk_bf16_f32 v24, v24, v28
v_cvt_pk_bf16_f32 v25, v25, v29
v_cvt_pk_bf16_f32 v26, v26, v30
v_cvt_pk_bf16_f32 v27, v27, v31
v_mfma_f32_16x16x32_bf16 v[16:19], v[20:23], v[20:23], 0
ds_write_b128 v7, v[24:27]
v_mfma_f32_16x16x32_bf16 v[12:15], v[20:23], v[20:23], 0
s_andn2_b64 vcc, vcc, s[86:87]
ds_read_b128 v[36:39], v2 offset:23552
s_cbranch_scc1 L_sm0
L_smr0:
v_mfma_f32_16x16x32_bf16 v[56:59], v[20:23], v[20:23], 0
v_mov_b32 v1, 6528
v_and_b32 v8, 0x380, v3
v_mfma_f32_16x16x32_bf16 v[60:63], v[20:23], v[20:23], 0
s_add_u32 s20, s30, 524288
v_add_u32 v8, v8, v3
s_mov_b32 m0, 15872
s_cmp_eq_u32 s19, 63
s_cbranch_scc1 L_texit
s_waitcnt lgkmcnt(0)
s_barrier
ds_read_b128 v[24:27], v3 offset:4224
v_mfma_f32_16x16x32_bf16 v[64:67], v[20:23], v[20:23], 0
ds_read_b128 v[28:31], v3 offset:5248
s_nop 2
v_mfma_f32_16x16x32_bf16 v[68:71], v[20:23], v[20:23], 0
s_waitcnt lgkmcnt(1)
v_smfmac_f32_16x16x64_bf16 v[12:15], v[24:27], a[248:255], v0
buffer_load_dwordx4 v8, s[8:11], s20 offen sc1 lds
v_smfmac_f32_16x16x64_bf16 v[16:19], v[24:27], a[176:183], v0
s_mov_b32 m0, 16768
s_waitcnt lgkmcnt(0)
v_smfmac_f32_16x16x64_bf16 v[12:15], v[28:31], v[40:47], v0
ds_read_b128 v[40:43], v2 offset:24576
v_smfmac_f32_16x16x64_bf16 v[16:19], v[28:31], v[48:55], v0
ds_read_b128 v[44:47], v2 offset:25600
buffer_load_dwordx4 v8, s[8:11], s20 offen offset:128 sc1 lds
v_smfmac_f32_16x16x64_bf16 v[20:23], v[24:27], a[184:191], v0
ds_read_b128 v[48:51], v2 offset:26624
s_nop 1
v_add_f32 v12, v12, v13
v_add_f32 v14, v14, v15
v_cvt_pk_bf16_f32 v12, v12, v14
v_smfmac_f32_16x16x64_bf16 v[20:23], v[28:31], v[32:39], v0
ds_read_b128 v[52:55], v2 offset:27648
buffer_store_dword v12, v10, s[8:11], s28 offen
v_add_f32 v16, v16, v17
v_add_f32 v18, v18, v19
v_smfmac_f32_16x16x64_bf16 v[56:59], v[24:27], a[192:199], v0
s_waitcnt lgkmcnt(2)
ds_read_b128 v[32:35], v2 offset:28672
v_cvt_pk_bf16_f32 v16, v16, v18
v_smfmac_f32_16x16x64_bf16 v[56:59], v[28:31], v[40:47], v0
ds_read_b128 v[36:39], v2 offset:29696
v_add_f32 v20, v20, v21
v_add_f32 v22, v22, v23
v_cvt_pk_bf16_f32 v17, v20, v22
v_smfmac_f32_16x16x64_bf16 v[60:63], v[24:27], a[200:207], v0
s_waitcnt lgkmcnt(2)
ds_read_b128 v[12:15], v1
buffer_store_dwordx2 v[16:17], v9, s[8:11], s28 offen
v_smfmac_f32_16x16x64_bf16 v[60:63], v[28:31], v[48:55], v0
ds_read_b128 v[40:43], v2 offset:30720
v_add_f32 v56, v56, v57
v_add_f32 v58, v58, v59
v_cvt_pk_bf16_f32 v56, v56, v58
v_smfmac_f32_16x16x64_bf16 v[64:67], v[24:27], a[208:215], v0
s_waitcnt lgkmcnt(2)
ds_read_b128 v[44:47], v2 offset:31744
v_smfmac_f32_16x16x64_bf16 v[64:67], v[28:31], v[32:39], v0
ds_read_b128 v[20:23], v1
v_add_f32 v60, v60, v61
v_add_f32 v62, v62, v63
v_cvt_pk_bf16_f32 v57, v60, v62
v_smfmac_f32_16x16x64_bf16 v[68:71], v[24:27], a[216:223], v0
s_waitcnt lgkmcnt(1)
ds_read_b128 v[48:51], v2 offset:32768
buffer_store_dwordx2 v[56:57], v9, s[8:11], s50 offen
v_smfmac_f32_16x16x64_bf16 v[68:71], v[28:31], v[40:47], v0
ds_read_b128 v[52:55], v2 offset:33792
v_add_f32 v64, v64, v65
v_add_f32 v66, v66, v67
v_cvt_pk_bf16_f32 v64, v64, v66
v_smfmac_f32_16x16x64_bf16 v[12:15], v[24:27], a[224:231], v0
s_waitcnt lgkmcnt(0)
v_smfmac_f32_16x16x64_bf16 v[12:15], v[28:31], v[48:55], v0
s_nop 0
v_add_f32 v68, v68, v69
v_add_f32 v70, v70, v71
v_cvt_pk_bf16_f32 v65, v68, v70
v_smfmac_f32_16x16x64_bf16 v[20:23], v[24:27], a[232:239], v0
buffer_store_dwordx2 v[64:65], v9, s[8:11], s51 offen
v_smfmac_f32_16x16x64_bf16 v[20:23], v[28:31], a[240:247], v0
s_nop 0
v_add_f32 v12, v12, v13
v_add_f32 v14, v14, v15
v_cvt_pk_bf16_f32 v12, v12, v14
s_nop 3
v_add_f32 v20, v20, v21
v_add_f32 v22, v22, v23
v_cvt_pk_bf16_f32 v13, v20, v22
buffer_store_dwordx2 v[12:13], v9, s[8:11], s52 offen
L_lt0:
s_nop 15
s_nop 15
s_nop 0
buffer_load_dwordx4 v[32:35], v3, s[8:11], s49 offen sc1
buffer_load_dwordx4 v[36:39], v3, s[8:11], s49 offen offset:1024 sc1
buffer_load_dwordx4 v[40:43], v3, s[8:11], s49 offen offset:2048 sc1
buffer_load_dwordx4 v[44:47], v3, s[8:11], s49 offen offset:3072 sc1
s_add_u32 s19, s19, 1
s_mov_b32 s20, s28
s_mov_b32 s28, s29
s_mov_b32 s29, s20
s_and_b32 s20, s19, 3
s_lshl_b32 s20, s20, 14
s_add_u32 s33, s20, 110100480
s_add_u32 s34, s20, s24
s_xor_b32 s20, s20, 32768
s_add_u32 s35, s20, s24
s_add_u32 s30, s30, 524288
s_add_u32 s31, s31, 131072
s_add_u32 s6, s33, 4096
s_add_u32 s7, s33, 8192
s_mov_b32 s22, 0
buffer_load_dwordx4 v[32:35], v3, s[8:11], s49 offen sc1
buffer_load_dwordx4 v[36:39], v3, s[8:11], s49 offen offset:1024 sc1
buffer_load_dwordx4 v[40:43], v3, s[8:11], s49 offen offset:2048 sc1
buffer_load_dwordx4 v[44:47], v3, s[8:11], s49 offen offset:3072 sc1
v_mov_b64 v[24:25], 0
v_mov_b64 v[26:27], 0
v_mov_b64 v[28:29], 0
v_mov_b64 v[30:31], 0
v_and_b32 v70, 0xf40, v3
v_add_u32 v70, v70, v3
v_bfe_u32 v71, v3, 7, 1
v_mad_i32_i24 v70, v71, s4, v70
v_mov_b64 v[64:65], -1
v_mov_b64 v[66:67], -1
v_add_u32 v1, 2112, v4
ds_read_b128 v[48:51], v2 offset:8192
ds_read_b128 v[52:55], v2 offset:9216
v_lshrrev_b32 v8, 2, v3
v_mov_b32 v56, 0x3f80
v_cndmask_b32 v56, v56, 1.0, s[44:45]
v_cndmask_b32 v60, 0, v56, s[36:37]
v_cndmask_b32 v61, 0, v56, s[38:39]
v_cndmask_b32 v62, 0, v56, s[40:41]
v_cndmask_b32 v63, 0, v56, s[42:43]
s_waitcnt vmcnt(7)
v_max3_u32 v16, v32, v33, v34
v_max_u32 v16, v16, v35
v_mfma_f32_16x16x32_bf16 v[56:59], v[32:35], v[60:63], 0
s_waitcnt vmcnt(6)
v_max3_u32 v16, v16, v36, v37
v_max3_u32 v16, v16, v38, v39
v_mfma_f32_16x16x32_bf16 v[56:59], v[36:39], v[60:63], v[56:59]
s_waitcnt vmcnt(5)
v_max3_u32 v16, v16, v40, v41
v_max3_u32 v16, v16, v42, v43
v_mfma_f32_16x16x32_bf16 v[56:59], v[40:43], v[60:63], v[56:59]
s_waitcnt vmcnt(4)
v_max3_u32 v16, v16, v44, v45
v_max3_u32 v16, v16, v46, v47
v_mfma_f32_16x16x32_bf16 v[56:59], v[44:47], v[60:63], v[56:59]
v_cmp_le_u32 vcc, 0xffff0000, v16
s_cbranch_vccnz L_red0
L_redb0:
s_nop 5
v_permlane32_swap_b32 v56, v58
v_permlane32_swap_b32 v57, v59
v_pk_add_f32 v[56:57], v[56:57], v[58:59]
v_cvt_pk_bf16_f32 v56, v56, v57
buffer_store_dword v56, v11, s[8:11], s34 offen
s_add_u32 s20, s30, 0
s_add_u32 s21, s30, 8192
s_add_u32 s49, s29, s25
s_add_u32 s50, s29, s26
s_add_u32 s51, s29, s27
s_add_u32 s52, s30, 524288
s_mov_b32 m0, 15872
s_nop 9
s_barrier
s_branch L_gat0
L_red0:
s_waitcnt vmcnt(3)
v_mfma_f32_16x16x32_bf16 v[56:59], v[32:35], v[60:63], 0
v_max3_u32 v16, v32, v33, v34
v_max_u32 v16, v16, v35
s_waitcnt vmcnt(2)
v_mfma_f32_16x16x32_bf16 v[56:59], v[36:39], v[60:63], v[56:59]
v_max3_u32 v16, v16, v36, v37
v_max3_u32 v16, v16, v38, v39
s_waitcnt vmcnt(1)
v_mfma_f32_16x16x32_bf16 v[56:59], v[40:43], v[60:63], v[56:59]
v_max3_u32 v16, v16, v40, v41
v_max3_u32 v16, v16, v42, v43
s_waitcnt vmcnt(0)
v_mfma_f32_16x16x32_bf16 v[56:59], v[44:47], v[60:63], v[56:59]
v_max3_u32 v16, v16, v44, v45
v_max3_u32 v16, v16, v46, v47
v_cmp_le_u32 vcc, 0xffff0000, v16
s_cbranch_vccz L_redb0
L_red0b:
buffer_load_dwordx4 v[32:35], v3, s[8:11], s49 offen sc1
buffer_load_dwordx4 v[36:39], v3, s[8:11], s49 offen offset:1024 sc1
buffer_load_dwordx4 v[40:43], v3, s[8:11], s49 offen offset:2048 sc1
buffer_load_dwordx4 v[44:47], v3, s[8:11], s49 offen offset:3072 sc1
s_add_u32 s22, s22, 1
s_cmp_gt_u32 s22, 200000
s_cbranch_scc1 L_end
s_waitcnt vmcnt(3)
v_mfma_f32_16x16x32_bf16 v[56:59], v[32:35], v[60:63], 0
v_max3_u32 v16, v32, v33, v34
v_max_u32 v16, v16, v35
s_waitcnt vmcnt(2)
v_mfma_f32_16x16x32_bf16 v[56:59], v[36:39], v[60:63], v[56:59]
v_max3_u32 v16, v16, v36, v37
v_max3_u32 v16, v16, v38, v39
s_waitcnt vmcnt(1)
v_mfma_f32_16x16x32_bf16 v[56:59], v[40:43], v[60:63], v[56:59]
v_max3_u32 v16, v16, v40, v41
v_max3_u32 v16, v16, v42, v43
s_waitcnt vmcnt(0)
v_mfma_f32_16x16x32_bf16 v[56:59], v[44:47], v[60:63], v[56:59]
v_max3_u32 v16, v16, v44, v45
v_max3_u32 v16, v16, v46, v47
v_cmp_le_u32 vcc, 0xffff0000, v16
s_cbranch_vccz L_redb0
s_branch L_red0b
L_g3r0:
buffer_load_dwordx4 v[16:19], v3, s[8:11], s6 offen sc1
s_add_u32 s22, s22, 1
s_waitcnt vmcnt(1)
v_max3_u32 v21, v16, v17, v18
v_max_u32 v21, v21, v19
v_cmp_le_u32 vcc, 0xffff0000, v21
s_cmp_gt_u32 s22, 200000
s_cbranch_vccz L_g30
s_cbranch_scc0 L_g3r0
s_branch L_end
L_sm0:
s_waitcnt lgkmcnt(0)
ds_read_b128 v[24:27], v5
ds_read_b128 v[40:43], v3 offset:15872
ds_read_b128 v[28:31], v5 offset:512
ds_read_b128 v[44:47], v3 offset:17920
ds_read_b128 v[32:35], v5 offset:1024
ds_read_b128 v[48:51], v3 offset:19968
ds_read_b128 v[36:39], v5 offset:1536
ds_read_b128 v[52:55], v3 offset:22016
s_waitcnt lgkmcnt(0)
v_mfma_f32_16x16x32_bf16 v[16:19], v[40:43], v[24:27], 0
ds_read_b128 v[40:43], v3 offset:16896
v_mfma_f32_16x16x32_bf16 v[16:19], v[44:47], v[28:31], v[16:19]
ds_read_b128 v[44:47], v3 offset:18944
v_mfma_f32_16x16x32_bf16 v[16:19], v[48:51], v[32:35], v[16:19]
ds_read_b128 v[48:51], v3 offset:20992
v_mfma_f32_16x16x32_bf16 v[16:19], v[52:55], v[36:39], v[16:19]
ds_read_b128 v[52:55], v3 offset:23040
v_mfma_f32_16x16x32_bf16 v[20:23], v[24:27], v[24:27], 0
v_mfma_f32_16x16x32_bf16 v[20:23], v[28:31], v[28:31], v[20:23]
v_mfma_f32_16x16x32_bf16 v[20:23], v[32:35], v[32:35], v[20:23]
v_mfma_f32_16x16x32_bf16 v[20:23], v[36:39], v[36:39], v[20:23]
s_waitcnt lgkmcnt(0)
v_mfma_f32_16x16x32_bf16 v[12:15], v[40:43], v[24:27], 0
v_mfma_f32_16x16x32_bf16 v[12:15], v[44:47], v[28:31], v[12:15]
v_mfma_f32_16x16x32_bf16 v[12:15], v[48:51], v[32:35], v[12:15]
v_mfma_f32_16x16x32_bf16 v[12:15], v[52:55], v[36:39], v[12:15]
v_max3_f32 v59, v16, v17, v18
s_nop 1
v_max3_f32 v59, v59, v19, v20
s_nop 3
v_max3_f32 v59, v59, v21, v12
v_max3_f32 v59, v59, v13, v14
v_max_f32 v59, v59, v15
v_mov_b32 v22, v59
s_nop 1
v_permlane32_swap_b32 v22, v59
v_max_f32 v59, v59, v22
v_mov_b32 v22, v59
s_nop 1
v_permlane16_swap_b32 v22, v59
v_max_f32 v59, v59, v22
v_sub_f32 v20, v20, v59
v_sub_f32 v21, v21, v59
v_sub_f32 v16, v16, v59
v_sub_f32 v17, v17, v59
v_sub_f32 v18, v18, v59
v_sub_f32 v19, v19, v59
v_sub_f32 v12, v12, v59
v_sub_f32 v13, v13, v59
v_sub_f32 v14, v14, v59
v_sub_f32 v15, v15, v59
v_exp_f32 v20, v20
v_exp_f32 v21, v21
v_exp_f32 v16, v16
v_exp_f32 v17, v17
v_exp_f32 v18, v18
v_exp_f32 v19, v19
v_exp_f32 v12, v12
v_exp_f32 v13, v13
v_exp_f32 v14, v14
v_exp_f32 v15, v15
v_cvt_pk_bf16_f32 v23, v20, v21
v_cvt_pk_bf16_f32 v20, v20, v21
v_mov_b32 v21, 0
v_mov_b32 v22, 0
v_cvt_pk_bf16_f32 v16, v16, v17
v_cvt_pk_bf16_f32 v17, v18, v19
v_cvt_pk_bf16_f32 v18, v12, v13
v_cvt_pk_bf16_f32 v19, v14, v15
v_mfma_f32_16x16x16_bf16 v[24:27], v[56:57], v[20:21], 0
v_mfma_f32_16x16x16_bf16 v[28:31], v[56:57], v[22:23], 0
v_mfma_f32_16x16x16_bf16 v[32:35], v[60:61], v[20:21], 0
ds_read_b128 v[40:43], v2 offset:18432
v_mfma_f32_16x16x32_bf16 v[32:35], v[60:63], v[16:19], v[32:35]
ds_read_b128 v[44:47], v2 offset:19456
v_mov_b32 v20, 0
v_mfma_f32_16x16x32_bf16 v[24:27], v[64:67], v[16:19], v[24:27]
ds_read_b128 v[48:51], v2 offset:20480
v_mov_b32 v23, 0
v_mfma_f32_16x16x32_bf16 v[28:31], v[68:71], v[16:19], v[28:31]
ds_read_b128 v[52:55], v2 offset:21504
v_mov_b32 v15, 0
v_rcp_f32 v12, v32
v_subrev_u32 v14, 0x21800000, v32
v_cmp_le_u32 vcc, 0x3c000000, v14
v_pk_mul_f32 v[24:25], v[24:25], v[12:13] op_sel_hi:[1,0]
v_pk_mul_f32 v[26:27], v[26:27], v[12:13] op_sel_hi:[1,0]
ds_read_b128 v[32:35], v2 offset:22528
v_pk_mul_f32 v[28:29], v[28:29], v[12:13] op_sel_hi:[1,0]
v_pk_mul_f32 v[30:31], v[30:31], v[12:13] op_sel_hi:[1,0]
v_cvt_pk_bf16_f32 v24, v24, v28
v_cvt_pk_bf16_f32 v25, v25, v29
v_cvt_pk_bf16_f32 v26, v26, v30
v_cvt_pk_bf16_f32 v27, v27, v31
v_mfma_f32_16x16x32_bf16 v[16:19], v[20:23], v[20:23], 0
ds_write_b128 v7, v[24:27]
v_mfma_f32_16x16x32_bf16 v[12:15], v[20:23], v[20:23], 0
ds_read_b128 v[36:39], v2 offset:23552
s_branch L_smr0
L_ent1:
s_movk_i32 s4, -64
s_mov_b32 s14, s53
s_mov_b32 s15, s53
v_mov_b64 v[24:25], 0
v_mov_b64 v[26:27], 0
v_mov_b64 v[28:29], 0
v_mov_b64 v[30:31], 0
v_and_b32 v69, 0x380, v3
v_add_u32 v69, v69, v3
v_and_b32 v70, 0xf40, v3
v_add_u32 v70, v70, v3
v_bfe_u32 v71, v3, 7, 1
v_mad_i32_i24 v70, v71, s4, v70
v_mov_b64 v[64:65], -1
v_mov_b64 v[66:67], -1
v_add_u32 v1, 2112, v4
ds_read_b128 v[48:51], v2 offset:10240
ds_read_b128 v[52:55], v2 offset:11264
ds_read_b128 v[40:43], v2 offset:2048
ds_read_b128 v[44:47], v2 offset:3072
v_mov_b64 v[32:33], 0
v_mov_b64 v[34:35], 0
v_mov_b64 v[36:37], 0
v_mov_b64 v[38:39], 0
v_mov_b64 v[56:57], 0
v_mov_b64 v[58:59], 0
v_mov_b64 v[60:61], 0
v_mov_b64 v[62:63], 0
s_add_u32 s20, s30, 1024
s_add_u32 s21, s30, 8192
s_add_u32 s49, s29, s25
s_add_u32 s50, s29, s26
s_add_u32 s51, s29, s27
s_add_u32 s52, s30, 524288
s_mov_b32 m0, 17920
s_nop 0
buffer_load_dwordx4 v69, s[8:11], s20 offen sc1 lds
s_mov_b32 m0, 18816
s_nop 0
buffer_load_dwordx4 v69, s[8:11], s20 offen offset:128 sc1 lds
s_waitcnt vmcnt(0) lgkmcnt(0)
s_branch L_step1
L_gr1:
buffer_load_dwordx4 v[12:15], v3, s[8:11], s33 offen sc1
buffer_load_dword v20, v8, s[8:11], s7 offen sc1
buffer_load_dwordx4 v[16:19], v3, s[8:11], s6 offen sc1
s_add_u32 s22, s22, 1
s_cmp_gt_u32 s22, 200000
s_cbranch_scc1 L_end
buffer_load_dwordx4 v[16:19], v3, s[8:11], s6 offen sc1
v_mov_b64 v[24:25], 0
v_mov_b64 v[26:27], 0
v_mov_b64 v[28:29], 0
v_mov_b64 v[30:31], 0
v_mov_b64 v[32:33], 0
v_mov_b64 v[34:35], 0
v_mov_b64 v[36:37], 0
v_mov_b64 v[38:39], 0
v_mov_b64 v[56:57], 0
v_mov_b64 v[58:59], 0
v_mov_b64 v[60:61], 0
v_mov_b64 v[62:63], 0
s_waitcnt lgkmcnt(0)
s_branch L_step1
.p2align 3
L_gat1:
buffer_load_dwordx4 v[12:15], v3, s[8:11], s33 offen sc1
buffer_load_dword v20, v8, s[8:11], s7 offen sc1
s_add_u32 s20, s30, 1024
s_add_u32 s21, s30, 8192
s_add_u32 s49, s29, s25
s_add_u32 s50, s29, s26
s_add_u32 s51, s29, s27
s_add_u32 s52, s30, 524288
buffer_load_dwordx4 v[16:19], v3, s[8:11], s6 offen sc1
s_mov_b32 m0, 17920
s_waitcnt vmcnt(4)
ds_read_b128 v[40:43], v2 offset:2048
ds_read_b128 v[44:47], v2 offset:3072
v_mov_b64 v[32:33], 0
v_mov_b64 v[34:35], 0
v_mov_b64 v[36:37], 0
v_mov_b64 v[38:39], 0
v_mov_b64 v[56:57], 0
v_mov_b64 v[58:59], 0
v_mov_b64 v[60:61], 0
v_mov_b64 v[62:63], 0
s_nop 3
buffer_load_dwordx4 v[16:19], v3, s[8:11], s6 offen sc1
s_waitcnt lgkmcnt(0)
L_step1:
s_waitcnt vmcnt(3)
v_smfmac_f32_16x16x64_bf16 v[24:27], v[12:15], v[96:103], v0
ds_write_b128 v3, v[12:15] offset:6656
v_smfmac_f32_16x16x64_bf16 v[28:31], v[12:15], v[104:111], v0
s_waitcnt vmcnt(2)
v_max3_u32 v21, v12, v13, v14
v_max3_u32 v21, v21, v15, v20
v_cmp_le_u32 vcc, 0xffff0000, v21
v_smfmac_f32_16x16x64_bf16 v[32:35], v[12:15], v[112:119], v0
s_cbranch_vccnz L_gr1
s_waitcnt vmcnt(1)
v_max3_u32 v21, v16, v17, v18
v_max_u32 v21, v21, v19
v_cmp_le_u32 vcc, 0xffff0000, v21
ds_write_b32 v8, v20 offset:14848
v_smfmac_f32_16x16x64_bf16 v[56:59], v[12:15], a[48:55], v0
s_cbranch_vccnz L_g3r1
L_g31:
ds_write_b128 v3, v[16:19] offset:10752
v_smfmac_f32_16x16x64_bf16 v[60:63], v[12:15], a[56:63], v0
v_smfmac_f32_16x16x64_bf16 v[36:39], v[12:15], v[40:47], v0
v_smfmac_f32_16x16x64_bf16 v[24:27], v[16:19], v[192:199], v0
v_smfmac_f32_16x16x64_bf16 v[28:31], v[16:19], v[200:207], v0
s_waitcnt lgkmcnt(0)
s_barrier
ds_read_b128 v[20:23], v3 offset:5632
v_smfmac_f32_16x16x64_bf16 v[32:35], v[16:19], v[208:215], v0
ds_read_b128 v[12:15], v3 offset:7680
s_mov_b32 m0, 6272
buffer_store_dword v0, v11, s[8:11], s35 offen
v_smfmac_f32_16x16x64_bf16 v[56:59], v[16:19], a[112:119], v0
ds_read_b128 v[40:43], v2
v_smfmac_f32_16x16x64_bf16 v[60:63], v[16:19], a[120:127], v0
ds_read_b128 v[44:47], v2 offset:1024
buffer_store_dwordx4 v[64:67], v3, s[8:11], s49 offen
v_smfmac_f32_16x16x64_bf16 v[36:39], v[16:19], v[48:55], v0
s_waitcnt vmcnt(2)
ds_read_b128 v[16:19], v3 offset:8704
s_waitcnt lgkmcnt(4)
v_smfmac_f32_16x16x64_bf16 v[24:27], v[20:23], v[72:79], v0
ds_read_b128 v[48:51], v2 offset:4096
buffer_store_dwordx4 v[64:67], v3, s[8:11], s50 offen
v_smfmac_f32_16x16x64_bf16 v[28:31], v[20:23], v[80:87], v0
ds_read_b128 v[52:55], v2 offset:5120
v_smfmac_f32_16x16x64_bf16 v[32:35], v[20:23], v[88:95], v0
s_waitcnt lgkmcnt(3)
buffer_store_dwordx4 v[64:67], v3, s[8:11], s51 offen
v_smfmac_f32_16x16x64_bf16 v[36:39], v[20:23], v[40:47], v0
ds_read_b128 v[20:23], v3 offset:9728
buffer_load_dwordx4 v[64:67], v70, s[8:11], s21 offen sc1
v_smfmac_f32_16x16x64_bf16 v[24:27], v[12:15], v[120:127], v0
ds_read_b128 v[40:43], v2 offset:6144
v_smfmac_f32_16x16x64_bf16 v[28:31], v[12:15], v[128:135], v0
ds_read_b128 v[44:47], v2 offset:7168
buffer_load_dwordx4 v[68:71], v70, s[8:11], s21 offen offset:256 sc1
v_smfmac_f32_16x16x64_bf16 v[32:35], v[12:15], v[136:143], v0
s_waitcnt lgkmcnt(3)
v_smfmac_f32_16x16x64_bf16 v[36:39], v[12:15], v[48:55], v0
ds_read_b128 v[12:15], v3 offset:11776
v_smfmac_f32_16x16x64_bf16 v[24:27], v[16:19], v[144:151], v0
ds_read_b128 v[48:51], v2 offset:8192
v_smfmac_f32_16x16x64_bf16 v[28:31], v[16:19], v[152:159], v0
ds_read_b128 v[52:55], v2 offset:9216
v_smfmac_f32_16x16x64_bf16 v[32:35], v[16:19], v[160:167], v0
s_waitcnt lgkmcnt(3)
buffer_load_dword v6, s[8:11], s52 offen sc1 lds
v_smfmac_f32_16x16x64_bf16 v[36:39], v[16:19], v[40:47], v0
ds_read_b128 v[16:19], v3 offset:12800
v_smfmac_f32_16x16x64_bf16 v[24:27], v[20:23], v[168:175], v0
ds_read_b128 v[40:43], v2 offset:12288
v_smfmac_f32_16x16x64_bf16 v[28:31], v[20:23], v[176:183], v0
ds_read_b128 v[44:47], v2 offset:13312
v_smfmac_f32_16x16x64_bf16 v[32:35], v[20:23], v[184:191], v0
s_waitcnt lgkmcnt(3)
v_smfmac_f32_16x16x64_bf16 v[36:39], v[20:23], v[48:55], v0
ds_read_b128 v[20:23], v3 offset:13824
v_smfmac_f32_16x16x64_bf16 v[24:27], v[12:15], v[216:223], v0
ds_read_b128 v[48:51], v2 offset:14336
v_smfmac_f32_16x16x64_bf16 v[28:31], v[12:15], v[224:231], v0
ds_read_b128 v[52:55], v2 offset:15360
v_smfmac_f32_16x16x64_bf16 v[32:35], v[12:15], v[232:239], v0
s_waitcnt lgkmcnt(3)
v_smfmac_f32_16x16x64_bf16 v[36:39], v[12:15], v[40:47], v0
ds_read_b128 v[12:15], v3 offset:5632
v_smfmac_f32_16x16x64_bf16 v[24:27], v[16:19], v[240:247], v0
ds_read_b128 v[40:43], v2 offset:16384
v_smfmac_f32_16x16x64_bf16 v[28:31], v[16:19], v[248:255], v0
ds_read_b128 v[44:47], v2 offset:17408
v_smfmac_f32_16x16x64_bf16 v[32:35], v[16:19], a[0:7], v0
s_waitcnt lgkmcnt(3)
v_smfmac_f32_16x16x64_bf16 v[36:39], v[16:19], v[48:55], v0
ds_read_b128 v[16:19], v3 offset:7680
v_smfmac_f32_16x16x64_bf16 v[24:27], v[20:23], a[8:15], v0
ds_read_b128 v[48:51], v3 offset:18944
v_smfmac_f32_16x16x64_bf16 v[28:31], v[20:23], a[16:23], v0
ds_read_b128 v[52:55], v3 offset:20992
v_smfmac_f32_16x16x64_bf16 v[32:35], v[20:23], a[24:31], v0
s_waitcnt lgkmcnt(3)
v_smfmac_f32_16x16x64_bf16 v[36:39], v[20:23], v[40:47], v0
ds_read_b128 v[20:23], v3 offset:8704
s_nop 0
v_add_f32 v24, v24, v25
v_smfmac_f32_16x16x64_bf16 v[56:59], v[12:15], a[32:39], v0
ds_read_b128 v[44:47], v3 offset:16896
v_add_f32 v26, v26, v27
v_add_f32 v28, v28, v29
v_add_f32 v30, v30, v31
v_mul_f32 v24, s18, v24
v_smfmac_f32_16x16x64_bf16 v[60:63], v[12:15], a[40:47], v0
ds_read_b128 v[12:15], v3 offset:9728
v_mul_f32 v28, s18, v28
v_mul_f32 v26, s18, v26
v_mul_f32 v30, s18, v30
v_cvt_pk_bf16_f32 v24, v24, v28
s_waitcnt lgkmcnt(5)
v_smfmac_f32_16x16x64_bf16 v[56:59], v[16:19], a[64:71], v0
ds_read_b128 v[40:43], v3 offset:14848
v_cvt_pk_bf16_f32 v26, v26, v30
ds_write2_b32 v1, v24, v26 offset1:32
v_add_f32 v32, v32, v33
v_add_f32 v34, v34, v35
v_smfmac_f32_16x16x64_bf16 v[60:63], v[16:19], a[72:79], v0
ds_read_b128 v[16:19], v3 offset:11776
v_add_f32 v36, v36, v37
v_add_f32 v38, v38, v39
v_cvt_pk_bf16_f32 v32, v32, v36
v_cvt_pk_bf16_f32 v34, v34, v38
s_waitcnt lgkmcnt(5)
v_smfmac_f32_16x16x64_bf16 v[56:59], v[20:23], a[80:87], v0
ds_write2_b32 v4, v32, v34 offset1:32
v_smfmac_f32_16x16x64_bf16 v[60:63], v[20:23], a[88:95], v0
s_waitcnt lgkmcnt(4)
ds_read_b128 v[20:23], v3 offset:12800
v_smfmac_f32_16x16x64_bf16 v[56:59], v[12:15], a[96:103], v0
buffer_store_dword v32, v4, s[8:11], s31 offen sc1
v_smfmac_f32_16x16x64_bf16 v[60:63], v[12:15], a[104:111], v0
s_waitcnt lgkmcnt(2)
ds_read_b128 v[12:15], v3 offset:13824
v_smfmac_f32_16x16x64_bf16 v[56:59], v[16:19], a[128:135], v0
buffer_store_dword v34, v4, s[8:11], s31 offen offset:128 sc1
v_smfmac_f32_16x16x64_bf16 v[60:63], v[16:19], a[136:143], v0
s_waitcnt lgkmcnt(1)
v_smfmac_f32_16x16x64_bf16 v[56:59], v[20:23], a[144:151], v0
s_barrier
ds_read_b128 v[28:31], v5 offset:512
v_smfmac_f32_16x16x64_bf16 v[60:63], v[20:23], a[152:159], v0
s_waitcnt lgkmcnt(1)
ds_read_b128 v[32:35], v5 offset:1024
v_smfmac_f32_16x16x64_bf16 v[56:59], v[12:15], a[160:167], v0
ds_read_b128 v[36:39], v5 offset:1536
v_smfmac_f32_16x16x64_bf16 v[60:63], v[12:15], a[168:175], v0
s_waitcnt lgkmcnt(2)
ds_read_b128 v[24:27], v5
v_mfma_f32_16x16x32_bf16 v[16:19], v[44:47], v[28:31], 0
s_waitcnt lgkmcnt(2)
ds_read_b128 v[44:47], v3 offset:17920
v_mfma_f32_16x16x32_bf16 v[16:19], v[48:51], v[32:35], v[16:19]
s_waitcnt lgkmcnt(2)
ds_read_b128 v[48:51], v3 offset:19968
v_mfma_f32_16x16x32_bf16 v[16:19], v[52:55], v[36:39], v[16:19]
s_waitcnt lgkmcnt(2)
ds_read_b128 v[52:55], v3 offset:22016
v_add_f32 v56, v56, v57
v_mfma_f32_16x16x32_bf16 v[16:19], v[40:43], v[24:27], v[16:19]
ds_read_b128 v[40:43], v3 offset:15872
v_add_f32 v58, v58, v59
v_mfma_f32_16x16x32_bf16 v[20:23], v[28:31], v[28:31], 0
s_add_u32 s49, s28, s23
v_add_f32 v60, v60, v61
v_add_f32 v62, v62, v63
v_mfma_f32_16x16x32_bf16 v[20:23], v[32:35], v[32:35], v[20:23]
s_add_u32 s50, s28, 65536
v_cvt_pk_bf16_f32 v56, v56, v58
v_cvt_pk_bf16_f32 v57, v60, v62
v_mfma_f32_16x16x32_bf16 v[20:23], v[36:39], v[36:39], v[20:23]
s_add_u32 s51, s28, 131072
v_exp_f32 v16, v16
v_mfma_f32_16x16x32_bf16 v[20:23], v[24:27], v[24:27], v[20:23]
s_waitcnt lgkmcnt(3)
v_exp_f32 v17, v17
buffer_store_dword v56, v8, s[8:11], s31 offen offset:2048 sc1
v_mfma_f32_16x16x32_bf16 v[12:15], v[44:47], v[28:31], 0
s_waitcnt lgkmcnt(2)
v_exp_f32 v18, v18
v_mfma_f32_16x16x32_bf16 v[12:15], v[48:51], v[32:35], v[12:15]
s_waitcnt lgkmcnt(1)
v_exp_f32 v19, v19
buffer_store_dword v57, v8, s[8:11], s31 offen offset:3072 sc1
v_mfma_f32_16x16x32_bf16 v[12:15], v[52:55], v[36:39], v[12:15]
s_waitcnt lgkmcnt(0)
v_exp_f32 v20, v20
v_mfma_f32_16x16x32_bf16 v[12:15], v[40:43], v[24:27], v[12:15]
s_add_u32 s52, s28, 196608
v_exp_f32 v21, v21
v_mov_b64 v[60:61], s[14:15]
v_cvt_pk_bf16_f32 v23, v20, v21
v_cvt_pk_bf16_f32 v20, v20, v21
v_mov_b32 v21, 0
v_mov_b32 v22, 0
v_cvt_pk_bf16_f32 v16, v16, v17
v_cvt_pk_bf16_f32 v17, v18, v19
v_mfma_f32_16x16x16_bf16 v[24:27], v[56:57], v[20:21], 0
v_exp_f32 v12, v12
v_mfma_f32_16x16x16_bf16 v[28:31], v[56:57], v[22:23], 0
v_exp_f32 v13, v13
v_mfma_f32_16x16x16_bf16 v[32:35], v[60:61], v[20:21], 0
v_exp_f32 v14, v14
v_exp_f32 v15, v15
v_mov_b64 v[62:63], s[14:15]
v_cvt_pk_bf16_f32 v18, v12, v13
v_cvt_pk_bf16_f32 v19, v14, v15
s_waitcnt vmcnt(5)
ds_read_b128 v[40:43], v2 offset:18432
v_mfma_f32_16x16x32_bf16 v[32:35], v[60:63], v[16:19], v[32:35]
ds_read_b128 v[44:47], v2 offset:19456
v_mov_b32 v20, 0
v_mfma_f32_16x16x32_bf16 v[24:27], v[64:67], v[16:19], v[24:27]
ds_read_b128 v[48:51], v2 offset:20480
v_mov_b32 v23, 0
v_mfma_f32_16x16x32_bf16 v[28:31], v[68:71], v[16:19], v[28:31]
ds_read_b128 v[52:55], v2 offset:21504
v_mov_b32 v15, 0
v_rcp_f32 v12, v32
v_subrev_u32 v14, 0x21800000, v32
v_cmp_le_u32 vcc, 0x3c000000, v14
v_pk_mul_f32 v[24:25], v[24:25], v[12:13] op_sel_hi:[1,0]
v_pk_mul_f32 v[26:27], v[26:27], v[12:13] op_sel_hi:[1,0]
ds_read_b128 v[32:35], v2 offset:22528
v_pk_mul_f32 v[28:29], v[28:29], v[12:13] op_sel_hi:[1,0]
v_pk_mul_f32 v[30:31], v[30:31], v[12:13] op_sel_hi:[1,0]
v_cvt_pk_bf16_f32 v24, v24, v28
v_cvt_pk_bf16_f32 v25, v25, v29
v_cvt_pk_bf16_f32 v26, v26, v30
v_cvt_pk_bf16_f32 v27, v27, v31
v_mfma_f32_16x16x32_bf16 v[16:19], v[20:23], v[20:23], 0
ds_write_b128 v7, v[24:27]
v_mfma_f32_16x16x32_bf16 v[12:15], v[20:23], v[20:23], 0
s_andn2_b64 vcc, vcc, s[86:87]
ds_read_b128 v[36:39], v2 offset:23552
s_cbranch_scc1 L_sm1
L_smr1:
v_mfma_f32_16x16x32_bf16 v[56:59], v[20:23], v[20:23], 0
v_mov_b32 v1, 6528
v_and_b32 v8, 0x380, v3
v_mfma_f32_16x16x32_bf16 v[60:63], v[20:23], v[20:23], 0
s_add_u32 s20, s30, 525312
v_add_u32 v8, v8, v3
s_mov_b32 m0, 17920
s_cmp_eq_u32 s19, 63
s_cbranch_scc1 L_texit
s_waitcnt lgkmcnt(0)
s_barrier
ds_read_b128 v[24:27], v3 offset:3200
v_mfma_f32_16x16x32_bf16 v[64:67], v[20:23], v[20:23], 0
ds_read_b128 v[28:31], v3 offset:4224
s_nop 2
v_mfma_f32_16x16x32_bf16 v[68:71], v[20:23], v[20:23], 0
s_waitcnt lgkmcnt(1)
v_smfmac_f32_16x16x64_bf16 v[12:15], v[24:27], a[248:255], v0
buffer_load_dwordx4 v8, s[8:11], s20 offen sc1 lds
v_smfmac_f32_16x16x64_bf16 v[16:19], v[24:27], a[176:183], v0
s_mov_b32 m0, 18816
s_waitcnt lgkmcnt(0)
v_smfmac_f32_16x16x64_bf16 v[12:15], v[28:31], v[40:47], v0
ds_read_b128 v[40:43], v2 offset:24576
v_smfmac_f32_16x16x64_bf16 v[16:19], v[28:31], v[48:55], v0
ds_read_b128 v[44:47], v2 offset:25600
buffer_load_dwordx4 v8, s[8:11], s20 offen offset:128 sc1 lds
v_smfmac_f32_16x16x64_bf16 v[20:23], v[24:27], a[184:191], v0
ds_read_b128 v[48:51], v2 offset:26624
s_nop 1
v_add_f32 v12, v12, v13
v_add_f32 v14, v14, v15
v_cvt_pk_bf16_f32 v12, v12, v14
v_smfmac_f32_16x16x64_bf16 v[20:23], v[28:31], v[32:39], v0
ds_read_b128 v[52:55], v2 offset:27648
buffer_store_dword v12, v10, s[8:11], s28 offen
v_add_f32 v16, v16, v17
v_add_f32 v18, v18, v19
v_smfmac_f32_16x16x64_bf16 v[56:59], v[24:27], a[192:199], v0
s_waitcnt lgkmcnt(2)
ds_read_b128 v[32:35], v2 offset:28672
v_cvt_pk_bf16_f32 v16, v16, v18
v_smfmac_f32_16x16x64_bf16 v[56:59], v[28:31], v[40:47], v0
ds_read_b128 v[36:39], v2 offset:29696
v_add_f32 v20, v20, v21
v_add_f32 v22, v22, v23
v_cvt_pk_bf16_f32 v17, v20, v22
v_smfmac_f32_16x16x64_bf16 v[60:63], v[24:27], a[200:207], v0
s_waitcnt lgkmcnt(2)
ds_read_b128 v[12:15], v1
buffer_store_dwordx2 v[16:17], v9, s[8:11], s28 offen
v_smfmac_f32_16x16x64_bf16 v[60:63], v[28:31], v[48:55], v0
ds_read_b128 v[40:43], v2 offset:30720
v_add_f32 v56, v56, v57
v_add_f32 v58, v58, v59
v_cvt_pk_bf16_f32 v56, v56, v58
v_smfmac_f32_16x16x64_bf16 v[64:67], v[24:27], a[208:215], v0
s_waitcnt lgkmcnt(2)
ds_read_b128 v[44:47], v2 offset:31744
v_smfmac_f32_16x16x64_bf16 v[64:67], v[28:31], v[32:39], v0
ds_read_b128 v[20:23], v1
v_add_f32 v60, v60, v61
v_add_f32 v62, v62, v63
v_cvt_pk_bf16_f32 v57, v60, v62
v_smfmac_f32_16x16x64_bf16 v[68:71], v[24:27], a[216:223], v0
s_waitcnt lgkmcnt(1)
ds_read_b128 v[48:51], v2 offset:32768
buffer_store_dwordx2 v[56:57], v9, s[8:11], s50 offen
v_smfmac_f32_16x16x64_bf16 v[68:71], v[28:31], v[40:47], v0
ds_read_b128 v[52:55], v2 offset:33792
v_add_f32 v64, v64, v65
v_add_f32 v66, v66, v67
v_cvt_pk_bf16_f32 v64, v64, v66
v_smfmac_f32_16x16x64_bf16 v[12:15], v[24:27], a[224:231], v0
s_waitcnt lgkmcnt(0)
v_smfmac_f32_16x16x64_bf16 v[12:15], v[28:31], v[48:55], v0
s_nop 0
v_add_f32 v68, v68, v69
v_add_f32 v70, v70, v71
v_cvt_pk_bf16_f32 v65, v68, v70
v_smfmac_f32_16x16x64_bf16 v[20:23], v[24:27], a[232:239], v0
buffer_store_dwordx2 v[64:65], v9, s[8:11], s51 offen
v_smfmac_f32_16x16x64_bf16 v[20:23], v[28:31], a[240:247], v0
s_nop 0
v_add_f32 v12, v12, v13
v_add_f32 v14, v14, v15
v_cvt_pk_bf16_f32 v12, v12, v14
s_nop 3
v_add_f32 v20, v20, v21
v_add_f32 v22, v22, v23
v_cvt_pk_bf16_f32 v13, v20, v22
buffer_store_dwordx2 v[12:13], v9, s[8:11], s52 offen
L_lt1:
s_nop 15
s_nop 15
s_nop 15
s_nop 15
s_nop 4
buffer_load_dwordx4 v[32:35], v3, s[8:11], s49 offen sc1
buffer_load_dwordx4 v[36:39], v3, s[8:11], s49 offen offset:1024 sc1
buffer_load_dwordx4 v[40:43], v3, s[8:11], s49 offen offset:2048 sc1
buffer_load_dwordx4 v[44:47], v3, s[8:11], s49 offen offset:3072 sc1
s_add_u32 s19, s19, 1
s_mov_b32 s20, s28
s_mov_b32 s28, s29
s_mov_b32 s29, s20
s_and_b32 s20, s19, 3
s_lshl_b32 s20, s20, 14
s_add_u32 s33, s20, 110100480
s_add_u32 s34, s20, s24
s_xor_b32 s20, s20, 32768
s_add_u32 s35, s20, s24
s_add_u32 s30, s30, 524288
s_add_u32 s31, s31, 131072
s_add_u32 s6, s33, 4096
s_add_u32 s7, s33, 8192
s_mov_b32 s22, 0
v_mov_b64 v[24:25], 0
v_mov_b64 v[26:27], 0
v_mov_b64 v[28:29], 0
v_mov_b64 v[30:31], 0
buffer_load_dwordx4 v[32:35], v3, s[8:11], s49 offen sc1
buffer_load_dwordx4 v[36:39], v3, s[8:11], s49 offen offset:1024 sc1
buffer_load_dwordx4 v[40:43], v3, s[8:11], s49 offen offset:2048 sc1
buffer_load_dwordx4 v[44:47], v3, s[8:11], s49 offen offset:3072 sc1
v_and_b32 v70, 0xf40, v3
v_add_u32 v70, v70, v3
v_bfe_u32 v71, v3, 7, 1
v_mad_i32_i24 v70, v71, s4, v70
v_mov_b64 v[64:65], -1
v_mov_b64 v[66:67], -1
v_add_u32 v1, 2112, v4
ds_read_b128 v[48:51], v2 offset:10240
ds_read_b128 v[52:55], v2 offset:11264
v_lshrrev_b32 v8, 2, v3
v_mov_b32 v56, 0x3f80
v_cndmask_b32 v56, v56, 1.0, s[44:45]
v_cndmask_b32 v60, 0, v56, s[36:37]
v_cndmask_b32 v61, 0, v56, s[38:39]
v_cndmask_b32 v62, 0, v56, s[40:41]
v_cndmask_b32 v63, 0, v56, s[42:43]
s_waitcnt vmcnt(7)
v_max3_u32 v16, v32, v33, v34
v_max_u32 v16, v16, v35
v_mfma_f32_16x16x32_bf16 v[56:59], v[32:35], v[60:63], 0
s_waitcnt vmcnt(6)
v_max3_u32 v16, v16, v36, v37
v_max3_u32 v16, v16, v38, v39
v_mfma_f32_16x16x32_bf16 v[56:59], v[36:39], v[60:63], v[56:59]
s_waitcnt vmcnt(5)
v_max3_u32 v16, v16, v40, v41
v_max3_u32 v16, v16, v42, v43
v_mfma_f32_16x16x32_bf16 v[56:59], v[40:43], v[60:63], v[56:59]
s_waitcnt vmcnt(4)
v_max3_u32 v16, v16, v44, v45
v_max3_u32 v16, v16, v46, v47
v_mfma_f32_16x16x32_bf16 v[56:59], v[44:47], v[60:63], v[56:59]
v_cmp_le_u32 vcc, 0xffff0000, v16
s_cbranch_vccnz L_red1
L_redb1:
s_nop 5
v_permlane32_swap_b32 v56, v58
v_permlane32_swap_b32 v57, v59
v_pk_add_f32 v[56:57], v[56:57], v[58:59]
v_cvt_pk_bf16_f32 v56, v56, v57
buffer_store_dword v56, v11, s[8:11], s34 offen
s_add_u32 s20, s30, 1024
s_add_u32 s21, s30, 8192
s_add_u32 s49, s29, s25
s_add_u32 s50, s29, s26
s_add_u32 s51, s29, s27
s_add_u32 s52, s30, 524288
s_mov_b32 m0, 17920
s_nop 9
s_barrier
s_branch L_gat1
L_red1:
s_waitcnt vmcnt(3)
v_mfma_f32_16x16x32_bf16 v[56:59], v[32:35], v[60:63], 0
v_max3_u32 v16, v32, v33, v34
v_max_u32 v16, v16, v35
s_waitcnt vmcnt(2)
v_mfma_f32_16x16x32_bf16 v[56:59], v[36:39], v[60:63], v[56:59]
v_max3_u32 v16, v16, v36, v37
v_max3_u32 v16, v16, v38, v39
s_waitcnt vmcnt(1)
v_mfma_f32_16x16x32_bf16 v[56:59], v[40:43], v[60:63], v[56:59]
v_max3_u32 v16, v16, v40, v41
v_max3_u32 v16, v16, v42, v43
s_waitcnt vmcnt(0)
v_mfma_f32_16x16x32_bf16 v[56:59], v[44:47], v[60:63], v[56:59]
v_max3_u32 v16, v16, v44, v45
v_max3_u32 v16, v16, v46, v47
v_cmp_le_u32 vcc, 0xffff0000, v16
s_cbranch_vccz L_redb1
L_red1b:
buffer_load_dwordx4 v[32:35], v3, s[8:11], s49 offen sc1
buffer_load_dwordx4 v[36:39], v3, s[8:11], s49 offen offset:1024 sc1
buffer_load_dwordx4 v[40:43], v3, s[8:11], s49 offen offset:2048 sc1
buffer_load_dwordx4 v[44:47], v3, s[8:11], s49 offen offset:3072 sc1
s_add_u32 s22, s22, 1
s_cmp_gt_u32 s22, 200000
s_cbranch_scc1 L_end
s_waitcnt vmcnt(3)
v_mfma_f32_16x16x32_bf16 v[56:59], v[32:35], v[60:63], 0
v_max3_u32 v16, v32, v33, v34
v_max_u32 v16, v16, v35
s_waitcnt vmcnt(2)
v_mfma_f32_16x16x32_bf16 v[56:59], v[36:39], v[60:63], v[56:59]
v_max3_u32 v16, v16, v36, v37
v_max3_u32 v16, v16, v38, v39
s_waitcnt vmcnt(1)
v_mfma_f32_16x16x32_bf16 v[56:59], v[40:43], v[60:63], v[56:59]
v_max3_u32 v16, v16, v40, v41
v_max3_u32 v16, v16, v42, v43
s_waitcnt vmcnt(0)
v_mfma_f32_16x16x32_bf16 v[56:59], v[44:47], v[60:63], v[56:59]
v_max3_u32 v16, v16, v44, v45
v_max3_u32 v16, v16, v46, v47
v_cmp_le_u32 vcc, 0xffff0000, v16
s_cbranch_vccz L_redb1
s_branch L_red1b
L_g3r1:
buffer_load_dwordx4 v[16:19], v3, s[8:11], s6 offen sc1
s_add_u32 s22, s22, 1
s_waitcnt vmcnt(1)
v_max3_u32 v21, v16, v17, v18
v_max_u32 v21, v21, v19
v_cmp_le_u32 vcc, 0xffff0000, v21
s_cmp_gt_u32 s22, 200000
s_cbranch_vccz L_g31
s_cbranch_scc0 L_g3r1
s_branch L_end
L_sm1:
s_waitcnt lgkmcnt(0)
ds_read_b128 v[24:27], v5
ds_read_b128 v[40:43], v3 offset:14848
ds_read_b128 v[28:31], v5 offset:512
ds_read_b128 v[44:47], v3 offset:16896
ds_read_b128 v[32:35], v5 offset:1024
ds_read_b128 v[48:51], v3 offset:18944
ds_read_b128 v[36:39], v5 offset:1536
ds_read_b128 v[52:55], v3 offset:20992
s_waitcnt lgkmcnt(0)
v_mfma_f32_16x16x32_bf16 v[16:19], v[40:43], v[24:27], 0
ds_read_b128 v[40:43], v3 offset:15872
v_mfma_f32_16x16x32_bf16 v[16:19], v[44:47], v[28:31], v[16:19]
ds_read_b128 v[44:47], v3 offset:17920
v_mfma_f32_16x16x32_bf16 v[16:19], v[48:51], v[32:35], v[16:19]
ds_read_b128 v[48:51], v3 offset:19968
v_mfma_f32_16x16x32_bf16 v[16:19], v[52:55], v[36:39], v[16:19]
ds_read_b128 v[52:55], v3 offset:22016
v_mfma_f32_16x16x32_bf16 v[20:23], v[24:27], v[24:27], 0
v_mfma_f32_16x16x32_bf16 v[20:23], v[28:31], v[28:31], v[20:23]
v_mfma_f32_16x16x32_bf16 v[20:23], v[32:35], v[32:35], v[20:23]
v_mfma_f32_16x16x32_bf16 v[20:23], v[36:39], v[36:39], v[20:23]
s_waitcnt lgkmcnt(0)
v_mfma_f32_16x16x32_bf16 v[12:15], v[40:43], v[24:27], 0
v_mfma_f32_16x16x32_bf16 v[12:15], v[44:47], v[28:31], v[12:15]
v_mfma_f32_16x16x32_bf16 v[12:15], v[48:51], v[32:35], v[12:15]
v_mfma_f32_16x16x32_bf16 v[12:15], v[52:55], v[36:39], v[12:15]
v_max3_f32 v59, v16, v17, v18
s_nop 1
v_max3_f32 v59, v59, v19, v20
s_nop 3
v_max3_f32 v59, v59, v21, v12
v_max3_f32 v59, v59, v13, v14
v_max_f32 v59, v59, v15
v_mov_b32 v22, v59
s_nop 1
v_permlane32_swap_b32 v22, v59
v_max_f32 v59, v59, v22
v_mov_b32 v22, v59
s_nop 1
v_permlane16_swap_b32 v22, v59
v_max_f32 v59, v59, v22
v_sub_f32 v20, v20, v59
v_sub_f32 v21, v21, v59
v_sub_f32 v16, v16, v59
v_sub_f32 v17, v17, v59
v_sub_f32 v18, v18, v59
v_sub_f32 v19, v19, v59
v_sub_f32 v12, v12, v59
v_sub_f32 v13, v13, v59
v_sub_f32 v14, v14, v59
v_sub_f32 v15, v15, v59
v_exp_f32 v20, v20
v_exp_f32 v21, v21
v_exp_f32 v16, v16
v_exp_f32 v17, v17
v_exp_f32 v18, v18
v_exp_f32 v19, v19
v_exp_f32 v12, v12
v_exp_f32 v13, v13
v_exp_f32 v14, v14
v_exp_f32 v15, v15
v_cvt_pk_bf16_f32 v23, v20, v21
v_cvt_pk_bf16_f32 v20, v20, v21
v_mov_b32 v21, 0
v_mov_b32 v22, 0
v_cvt_pk_bf16_f32 v16, v16, v17
v_cvt_pk_bf16_f32 v17, v18, v19
v_cvt_pk_bf16_f32 v18, v12, v13
v_cvt_pk_bf16_f32 v19, v14, v15
v_mfma_f32_16x16x16_bf16 v[24:27], v[56:57], v[20:21], 0
v_mfma_f32_16x16x16_bf16 v[28:31], v[56:57], v[22:23], 0
v_mfma_f32_16x16x16_bf16 v[32:35], v[60:61], v[20:21], 0
ds_read_b128 v[40:43], v2 offset:18432
v_mfma_f32_16x16x32_bf16 v[32:35], v[60:63], v[16:19], v[32:35]
ds_read_b128 v[44:47], v2 offset:19456
v_mov_b32 v20, 0
v_mfma_f32_16x16x32_bf16 v[24:27], v[64:67], v[16:19], v[24:27]
ds_read_b128 v[48:51], v2 offset:20480
v_mov_b32 v23, 0
v_mfma_f32_16x16x32_bf16 v[28:31], v[68:71], v[16:19], v[28:31]
ds_read_b128 v[52:55], v2 offset:21504
v_mov_b32 v15, 0
v_rcp_f32 v12, v32
v_subrev_u32 v14, 0x21800000, v32
v_cmp_le_u32 vcc, 0x3c000000, v14
v_pk_mul_f32 v[24:25], v[24:25], v[12:13] op_sel_hi:[1,0]
v_pk_mul_f32 v[26:27], v[26:27], v[12:13] op_sel_hi:[1,0]
ds_read_b128 v[32:35], v2 offset:22528
v_pk_mul_f32 v[28:29], v[28:29], v[12:13] op_sel_hi:[1,0]
v_pk_mul_f32 v[30:31], v[30:31], v[12:13] op_sel_hi:[1,0]
v_cvt_pk_bf16_f32 v24, v24, v28
v_cvt_pk_bf16_f32 v25, v25, v29
v_cvt_pk_bf16_f32 v26, v26, v30
v_cvt_pk_bf16_f32 v27, v27, v31
v_mfma_f32_16x16x32_bf16 v[16:19], v[20:23], v[20:23], 0
ds_write_b128 v7, v[24:27]
v_mfma_f32_16x16x32_bf16 v[12:15], v[20:23], v[20:23], 0
ds_read_b128 v[36:39], v2 offset:23552
s_branch L_smr1
L_ent2:
s_movk_i32 s4, -64
s_mov_b32 s14, s53
s_mov_b32 s15, s53
v_mov_b64 v[24:25], 0
v_mov_b64 v[26:27], 0
v_mov_b64 v[28:29], 0
v_mov_b64 v[30:31], 0
v_and_b32 v69, 0x380, v3
v_add_u32 v69, v69, v3
v_and_b32 v70, 0xf40, v3
v_add_u32 v70, v70, v3
v_bfe_u32 v71, v3, 7, 1
v_mad_i32_i24 v70, v71, s4, v70
v_mov_b64 v[64:65], -1
v_mov_b64 v[66:67], -1
v_add_u32 v1, 2112, v4
ds_read_b128 v[48:51], v2 offset:12288
ds_read_b128 v[52:55], v2 offset:13312
ds_read_b128 v[40:43], v2 offset:4096
ds_read_b128 v[44:47], v2 offset:5120
v_mov_b64 v[32:33], 0
v_mov_b64 v[34:35], 0
v_mov_b64 v[36:37], 0
v_mov_b64 v[38:39], 0
v_mov_b64 v[56:57], 0
v_mov_b64 v[58:59], 0
v_mov_b64 v[60:61], 0
v_mov_b64 v[62:63], 0
s_add_u32 s20, s30, 2048
s_add_u32 s21, s30, 8192
s_add_u32 s49, s29, s25
s_add_u32 s50, s29, s26
s_add_u32 s51, s29, s27
s_add_u32 s52, s30, 524288
s_mov_b32 m0, 19968
s_nop 0
buffer_load_dwordx4 v69, s[8:11], s20 offen sc1 lds
s_mov_b32 m0, 20864
s_nop 0
buffer_load_dwordx4 v69, s[8:11], s20 offen offset:128 sc1 lds
s_waitcnt vmcnt(0) lgkmcnt(0)
s_branch L_step2
L_gr2:
buffer_load_dwordx4 v[12:15], v3, s[8:11], s33 offen sc1
buffer_load_dword v20, v8, s[8:11], s7 offen sc1
buffer_load_dwordx4 v[16:19], v3, s[8:11], s6 offen sc1
s_add_u32 s22, s22, 1
s_cmp_gt_u32 s22, 200000
s_cbranch_scc1 L_end
buffer_load_dwordx4 v[16:19], v3, s[8:11], s6 offen sc1
v_mov_b64 v[24:25], 0
v_mov_b64 v[26:27], 0
v_mov_b64 v[28:29], 0
v_mov_b64 v[30:31], 0
v_mov_b64 v[32:33], 0
v_mov_b64 v[34:35], 0
v_mov_b64 v[36:37], 0
v_mov_b64 v[38:39], 0
v_mov_b64 v[56:57], 0
v_mov_b64 v[58:59], 0
v_mov_b64 v[60:61], 0
v_mov_b64 v[62:63], 0
s_waitcnt lgkmcnt(0)
s_branch L_step2
.p2align 3
L_gat2:
buffer_load_dwordx4 v[12:15], v3, s[8:11], s33 offen sc1
buffer_load_dword v20, v8, s[8:11], s7 offen sc1
s_add_u32 s20, s30, 2048
s_add_u32 s21, s30, 8192
s_add_u32 s49, s29, s25
s_add_u32 s50, s29, s26
s_add_u32 s51, s29, s27
s_add_u32 s52, s30, 524288
buffer_load_dwordx4 v[16:19], v3, s[8:11], s6 offen sc1
s_mov_b32 m0, 19968
ds_read_b128 v[40:43], v2 offset:4096
ds_read_b128 v[44:47], v2 offset:5120
v_mov_b64 v[32:33], 0
v_mov_b64 v[34:35], 0
v_mov_b64 v[36:37], 0
v_mov_b64 v[38:39], 0
v_mov_b64 v[56:57], 0
v_mov_b64 v[58:59], 0
v_mov_b64 v[60:61], 0
v_mov_b64 v[62:63], 0
s_nop 3
buffer_load_dwordx4 v[16:19], v3, s[8:11], s6 offen sc1
s_waitcnt lgkmcnt(0)
L_step2:
s_waitcnt vmcnt(3)
v_smfmac_f32_16x16x64_bf16 v[24:27], v[12:15], v[120:127], v0
ds_write_b128 v3, v[12:15] offset:6656
v_smfmac_f32_16x16x64_bf16 v[28:31], v[12:15], v[128:135], v0
s_waitcnt vmcnt(2)
v_max3_u32 v21, v12, v13, v14
v_max3_u32 v21, v21, v15, v20
v_cmp_le_u32 vcc, 0xffff0000, v21
v_smfmac_f32_16x16x64_bf16 v[32:35], v[12:15], v[136:143], v0
s_cbranch_vccnz L_gr2
s_waitcnt vmcnt(1)
v_max3_u32 v21, v16, v17, v18
v_max_u32 v21, v21, v19
v_cmp_le_u32 vcc, 0xffff0000, v21
ds_write_b32 v8, v20 offset:14848
v_smfmac_f32_16x16x64_bf16 v[56:59], v[12:15], a[64:71], v0
s_cbranch_vccnz L_g3r2
L_g32:
ds_write_b128 v3, v[16:19] offset:10752
v_smfmac_f32_16x16x64_bf16 v[60:63], v[12:15], a[72:79], v0
v_smfmac_f32_16x16x64_bf16 v[36:39], v[12:15], v[40:47], v0
v_smfmac_f32_16x16x64_bf16 v[24:27], v[16:19], v[216:223], v0
v_smfmac_f32_16x16x64_bf16 v[28:31], v[16:19], v[224:231], v0
s_waitcnt lgkmcnt(0)
s_barrier
ds_read_b128 v[20:23], v3 offset:4608
v_smfmac_f32_16x16x64_bf16 v[32:35], v[16:19], v[232:239], v0
ds_read_b128 v[12:15], v3 offset:5632
s_mov_b32 m0, 6272
buffer_store_dword v0, v11, s[8:11], s35 offen
v_smfmac_f32_16x16x64_bf16 v[56:59], v[16:19], a[128:135], v0
ds_read_b128 v[40:43], v2
v_smfmac_f32_16x16x64_bf16 v[60:63], v[16:19], a[136:143], v0
ds_read_b128 v[44:47], v2 offset:1024
buffer_store_dwordx4 v[64:67], v3, s[8:11], s49 offen
v_smfmac_f32_16x16x64_bf16 v[36:39], v[16:19], v[48:55], v0
s_waitcnt vmcnt(2)
ds_read_b128 v[16:19], v3 offset:7680
s_waitcnt lgkmcnt(4)
v_smfmac_f32_16x16x64_bf16 v[24:27], v[20:23], v[72:79], v0
ds_read_b128 v[48:51], v2 offset:2048
buffer_store_dwordx4 v[64:67], v3, s[8:11], s50 offen
v_smfmac_f32_16x16x64_bf16 v[28:31], v[20:23], v[80:87], v0
ds_read_b128 v[52:55], v2 offset:3072
v_smfmac_f32_16x16x64_bf16 v[32:35], v[20:23], v[88:95], v0
s_waitcnt lgkmcnt(3)
buffer_store_dwordx4 v[64:67], v3, s[8:11], s51 offen
v_smfmac_f32_16x16x64_bf16 v[36:39], v[20:23], v[40:47], v0
ds_read_b128 v[20:23], v3 offset:8704
buffer_load_dwordx4 v[64:67], v70, s[8:11], s21 offen sc1
v_smfmac_f32_16x16x64_bf16 v[24:27], v[12:15], v[96:103], v0
ds_read_b128 v[40:43], v2 offset:6144
v_smfmac_f32_16x16x64_bf16 v[28:31], v[12:15], v[104:111], v0
ds_read_b128 v[44:47], v2 offset:7168
buffer_load_dwordx4 v[68:71], v70, s[8:11], s21 offen offset:256 sc1
v_smfmac_f32_16x16x64_bf16 v[32:35], v[12:15], v[112:119], v0
s_waitcnt lgkmcnt(3)
v_smfmac_f32_16x16x64_bf16 v[36:39], v[12:15], v[48:55], v0
ds_read_b128 v[12:15], v3 offset:9728
v_smfmac_f32_16x16x64_bf16 v[24:27], v[16:19], v[144:151], v0
ds_read_b128 v[48:51], v2 offset:8192
v_smfmac_f32_16x16x64_bf16 v[28:31], v[16:19], v[152:159], v0
ds_read_b128 v[52:55], v2 offset:9216
v_smfmac_f32_16x16x64_bf16 v[32:35], v[16:19], v[160:167], v0
s_waitcnt lgkmcnt(3)
v_smfmac_f32_16x16x64_bf16 v[36:39], v[16:19], v[40:47], v0
ds_read_b128 v[16:19], v3 offset:11776
v_smfmac_f32_16x16x64_bf16 v[24:27], v[20:23], v[168:175], v0
ds_read_b128 v[40:43], v2 offset:10240
v_smfmac_f32_16x16x64_bf16 v[28:31], v[20:23], v[176:183], v0
ds_read_b128 v[44:47], v2 offset:11264
v_smfmac_f32_16x16x64_bf16 v[32:35], v[20:23], v[184:191], v0
s_waitcnt lgkmcnt(3)
v_smfmac_f32_16x16x64_bf16 v[36:39], v[20:23], v[48:55], v0
ds_read_b128 v[20:23], v3 offset:12800
v_smfmac_f32_16x16x64_bf16 v[24:27], v[12:15], v[192:199], v0
ds_read_b128 v[48:51], v2 offset:14336
v_smfmac_f32_16x16x64_bf16 v[28:31], v[12:15], v[200:207], v0
ds_read_b128 v[52:55], v2 offset:15360
v_smfmac_f32_16x16x64_bf16 v[32:35], v[12:15], v[208:215], v0
s_waitcnt lgkmcnt(3)
v_smfmac_f32_16x16x64_bf16 v[36:39], v[12:15], v[40:47], v0
ds_read_b128 v[12:15], v3 offset:4608
v_smfmac_f32_16x16x64_bf16 v[24:27], v[16:19], v[240:247], v0
ds_read_b128 v[40:43], v2 offset:16384
v_smfmac_f32_16x16x64_bf16 v[28:31], v[16:19], v[248:255], v0
ds_read_b128 v[44:47], v2 offset:17408
v_smfmac_f32_16x16x64_bf16 v[32:35], v[16:19], a[0:7], v0
s_waitcnt lgkmcnt(3)
v_smfmac_f32_16x16x64_bf16 v[36:39], v[16:19], v[48:55], v0
ds_read_b128 v[16:19], v3 offset:5632
v_smfmac_f32_16x16x64_bf16 v[24:27], v[20:23], a[8:15], v0
ds_read_b128 v[48:51], v3 offset:17920
v_smfmac_f32_16x16x64_bf16 v[28:31], v[20:23], a[16:23], v0
ds_read_b128 v[52:55], v3 offset:19968
v_smfmac_f32_16x16x64_bf16 v[32:35], v[20:23], a[24:31], v0
s_waitcnt lgkmcnt(3)
v_smfmac_f32_16x16x64_bf16 v[36:39], v[20:23], v[40:47], v0
ds_read_b128 v[20:23], v3 offset:7680
s_nop 0
v_add_f32 v24, v24, v25
v_smfmac_f32_16x16x64_bf16 v[56:59], v[12:15], a[32:39], v0
ds_read_b128 v[40:43], v3 offset:13824
v_add_f32 v26, v26, v27
v_add_f32 v28, v28, v29
v_add_f32 v30, v30, v31
v_mul_f32 v24, s18, v24
v_smfmac_f32_16x16x64_bf16 v[60:63], v[12:15], a[40:47], v0
ds_read_b128 v[12:15], v3 offset:8704
v_mul_f32 v28, s18, v28
v_mul_f32 v26, s18, v26
v_mul_f32 v30, s18, v30
v_cvt_pk_bf16_f32 v24, v24, v28
s_waitcnt lgkmcnt(5)
v_smfmac_f32_16x16x64_bf16 v[56:59], v[16:19], a[48:55], v0
ds_read_b128 v[44:47], v3 offset:15872
v_cvt_pk_bf16_f32 v26, v26, v30
ds_write2_b32 v1, v24, v26 offset1:32
v_add_f32 v32, v32, v33
v_add_f32 v34, v34, v35
v_smfmac_f32_16x16x64_bf16 v[60:63], v[16:19], a[56:63], v0
ds_read_b128 v[16:19], v3 offset:9728
v_add_f32 v36, v36, v37
v_add_f32 v38, v38, v39
v_cvt_pk_bf16_f32 v32, v32, v36
v_cvt_pk_bf16_f32 v34, v34, v38
s_waitcnt lgkmcnt(5)
v_smfmac_f32_16x16x64_bf16 v[56:59], v[20:23], a[80:87], v0
ds_write2_b32 v4, v32, v34 offset1:32
v_smfmac_f32_16x16x64_bf16 v[60:63], v[20:23], a[88:95], v0
s_waitcnt lgkmcnt(4)
ds_read_b128 v[20:23], v3 offset:11776
buffer_store_dword v32, v4, s[8:11], s31 offen sc1
v_smfmac_f32_16x16x64_bf16 v[56:59], v[12:15], a[96:103], v0
v_smfmac_f32_16x16x64_bf16 v[60:63], v[12:15], a[104:111], v0
s_waitcnt lgkmcnt(2)
ds_read_b128 v[12:15], v3 offset:12800
buffer_store_dword v34, v4, s[8:11], s31 offen offset:128 sc1
v_smfmac_f32_16x16x64_bf16 v[56:59], v[16:19], a[112:119], v0
v_smfmac_f32_16x16x64_bf16 v[60:63], v[16:19], a[120:127], v0
s_waitcnt lgkmcnt(1)
v_smfmac_f32_16x16x64_bf16 v[56:59], v[20:23], a[144:151], v0
s_barrier
ds_read_b128 v[32:35], v5 offset:1024
v_smfmac_f32_16x16x64_bf16 v[60:63], v[20:23], a[152:159], v0
s_waitcnt lgkmcnt(1)
ds_read_b128 v[36:39], v5 offset:1536
v_smfmac_f32_16x16x64_bf16 v[56:59], v[12:15], a[160:167], v0
ds_read_b128 v[24:27], v5
v_smfmac_f32_16x16x64_bf16 v[60:63], v[12:15], a[168:175], v0
s_waitcnt lgkmcnt(2)
ds_read_b128 v[28:31], v5 offset:512
v_mfma_f32_16x16x32_bf16 v[16:19], v[48:51], v[32:35], 0
s_waitcnt lgkmcnt(2)
ds_read_b128 v[48:51], v3 offset:18944
v_mfma_f32_16x16x32_bf16 v[16:19], v[52:55], v[36:39], v[16:19]
s_waitcnt lgkmcnt(2)
ds_read_b128 v[52:55], v3 offset:20992
v_mfma_f32_16x16x32_bf16 v[16:19], v[40:43], v[24:27], v[16:19]
s_waitcnt lgkmcnt(2)
ds_read_b128 v[40:43], v3 offset:14848
v_add_f32 v56, v56, v57
v_mfma_f32_16x16x32_bf16 v[16:19], v[44:47], v[28:31], v[16:19]
ds_read_b128 v[44:47], v3 offset:16896
v_add_f32 v58, v58, v59
v_mfma_f32_16x16x32_bf16 v[20:23], v[32:35], v[32:35], 0
s_add_u32 s49, s28, s23
v_add_f32 v60, v60, v61
v_add_f32 v62, v62, v63
v_mfma_f32_16x16x32_bf16 v[20:23], v[36:39], v[36:39], v[20:23]
s_add_u32 s50, s28, 65536
v_cvt_pk_bf16_f32 v56, v56, v58
v_cvt_pk_bf16_f32 v57, v60, v62
v_mfma_f32_16x16x32_bf16 v[20:23], v[24:27], v[24:27], v[20:23]
s_add_u32 s51, s28, 131072
v_exp_f32 v16, v16
buffer_store_dword v56, v8, s[8:11], s31 offen offset:2048 sc1
v_mfma_f32_16x16x32_bf16 v[20:23], v[28:31], v[28:31], v[20:23]
s_waitcnt lgkmcnt(3)
v_exp_f32 v17, v17
v_mfma_f32_16x16x32_bf16 v[12:15], v[48:51], v[32:35], 0
s_waitcnt lgkmcnt(2)
v_exp_f32 v18, v18
buffer_store_dword v57, v8, s[8:11], s31 offen offset:3072 sc1
v_mfma_f32_16x16x32_bf16 v[12:15], v[52:55], v[36:39], v[12:15]
s_waitcnt lgkmcnt(1)
v_exp_f32 v19, v19
v_mfma_f32_16x16x32_bf16 v[12:15], v[40:43], v[24:27], v[12:15]
s_waitcnt lgkmcnt(0)
v_exp_f32 v20, v20
v_mfma_f32_16x16x32_bf16 v[12:15], v[44:47], v[28:31], v[12:15]
s_add_u32 s52, s28, 196608
v_exp_f32 v21, v21
v_mov_b64 v[60:61], s[14:15]
v_cvt_pk_bf16_f32 v23, v20, v21
v_cvt_pk_bf16_f32 v20, v20, v21
v_mov_b32 v21, 0
v_mov_b32 v22, 0
v_cvt_pk_bf16_f32 v16, v16, v17
v_cvt_pk_bf16_f32 v17, v18, v19
v_mfma_f32_16x16x16_bf16 v[24:27], v[56:57], v[20:21], 0
v_exp_f32 v12, v12
v_mfma_f32_16x16x16_bf16 v[28:31], v[56:57], v[22:23], 0
v_exp_f32 v13, v13
v_mfma_f32_16x16x16_bf16 v[32:35], v[60:61], v[20:21], 0
v_exp_f32 v14, v14
v_exp_f32 v15, v15
v_mov_b64 v[62:63], s[14:15]
v_cvt_pk_bf16_f32 v18, v12, v13
v_cvt_pk_bf16_f32 v19, v14, v15
s_waitcnt vmcnt(4)
ds_read_b128 v[40:43], v2 offset:18432
v_mfma_f32_16x16x32_bf16 v[32:35], v[60:63], v[16:19], v[32:35]
ds_read_b128 v[44:47], v2 offset:19456
v_mov_b32 v20, 0
v_mfma_f32_16x16x32_bf16 v[24:27], v[64:67], v[16:19], v[24:27]
ds_read_b128 v[48:51], v2 offset:20480
v_mov_b32 v23, 0
v_mfma_f32_16x16x32_bf16 v[28:31], v[68:71], v[16:19], v[28:31]
ds_read_b128 v[52:55], v2 offset:21504
v_mov_b32 v15, 0
v_rcp_f32 v12, v32
v_subrev_u32 v14, 0x21800000, v32
v_cmp_le_u32 vcc, 0x3c000000, v14
v_pk_mul_f32 v[24:25], v[24:25], v[12:13] op_sel_hi:[1,0]
v_pk_mul_f32 v[26:27], v[26:27], v[12:13] op_sel_hi:[1,0]
ds_read_b128 v[32:35], v2 offset:22528
v_pk_mul_f32 v[28:29], v[28:29], v[12:13] op_sel_hi:[1,0]
v_pk_mul_f32 v[30:31], v[30:31], v[12:13] op_sel_hi:[1,0]
v_cvt_pk_bf16_f32 v24, v24, v28
v_cvt_pk_bf16_f32 v25, v25, v29
v_cvt_pk_bf16_f32 v26, v26, v30
v_cvt_pk_bf16_f32 v27, v27, v31
v_mfma_f32_16x16x32_bf16 v[16:19], v[20:23], v[20:23], 0
ds_write_b128 v7, v[24:27]
v_mfma_f32_16x16x32_bf16 v[12:15], v[20:23], v[20:23], 0
s_andn2_b64 vcc, vcc, s[86:87]
ds_read_b128 v[36:39], v2 offset:23552
s_cbranch_scc1 L_sm2
L_smr2:
v_mfma_f32_16x16x32_bf16 v[56:59], v[20:23], v[20:23], 0
v_mov_b32 v1, 6528
v_and_b32 v8, 0x380, v3
v_mfma_f32_16x16x32_bf16 v[60:63], v[20:23], v[20:23], 0
s_add_u32 s20, s30, 526336
v_add_u32 v8, v8, v3
s_mov_b32 m0, 19968
s_cmp_eq_u32 s19, 63
s_cbranch_scc1 L_texit
s_waitcnt lgkmcnt(0)
s_barrier
ds_read_b128 v[24:27], v3 offset:2176
v_mfma_f32_16x16x32_bf16 v[64:67], v[20:23], v[20:23], 0
ds_read_b128 v[28:31], v3 offset:3200
s_nop 2
v_mfma_f32_16x16x32_bf16 v[68:71], v[20:23], v[20:23], 0
s_waitcnt lgkmcnt(1)
v_smfmac_f32_16x16x64_bf16 v[12:15], v[24:27], a[248:255], v0
buffer_load_dwordx4 v8, s[8:11], s20 offen sc1 lds
v_smfmac_f32_16x16x64_bf16 v[16:19], v[24:27], a[176:183], v0
s_mov_b32 m0, 20864
s_waitcnt lgkmcnt(0)
v_smfmac_f32_16x16x64_bf16 v[12:15], v[28:31], v[40:47], v0
ds_read_b128 v[40:43], v2 offset:24576
v_smfmac_f32_16x16x64_bf16 v[16:19], v[28:31], v[48:55], v0
ds_read_b128 v[44:47], v2 offset:25600
buffer_load_dwordx4 v8, s[8:11], s20 offen offset:128 sc1 lds
v_smfmac_f32_16x16x64_bf16 v[20:23], v[24:27], a[184:191], v0
ds_read_b128 v[48:51], v2 offset:26624
s_nop 1
v_add_f32 v12, v12, v13
v_add_f32 v14, v14, v15
v_cvt_pk_bf16_f32 v12, v12, v14
v_smfmac_f32_16x16x64_bf16 v[20:23], v[28:31], v[32:39], v0
ds_read_b128 v[52:55], v2 offset:27648
buffer_store_dword v12, v10, s[8:11], s28 offen
v_add_f32 v16, v16, v17
v_add_f32 v18, v18, v19
v_smfmac_f32_16x16x64_bf16 v[56:59], v[24:27], a[192:199], v0
s_waitcnt lgkmcnt(2)
ds_read_b128 v[32:35], v2 offset:28672
v_cvt_pk_bf16_f32 v16, v16, v18
v_smfmac_f32_16x16x64_bf16 v[56:59], v[28:31], v[40:47], v0
ds_read_b128 v[36:39], v2 offset:29696
v_add_f32 v20, v20, v21
v_add_f32 v22, v22, v23
v_cvt_pk_bf16_f32 v17, v20, v22
v_smfmac_f32_16x16x64_bf16 v[60:63], v[24:27], a[200:207], v0
s_waitcnt lgkmcnt(2)
ds_read_b128 v[12:15], v1
buffer_store_dwordx2 v[16:17], v9, s[8:11], s28 offen
v_smfmac_f32_16x16x64_bf16 v[60:63], v[28:31], v[48:55], v0
ds_read_b128 v[40:43], v2 offset:30720
v_add_f32 v56, v56, v57
v_add_f32 v58, v58, v59
v_cvt_pk_bf16_f32 v56, v56, v58
v_smfmac_f32_16x16x64_bf16 v[64:67], v[24:27], a[208:215], v0
s_waitcnt lgkmcnt(2)
ds_read_b128 v[44:47], v2 offset:31744
v_smfmac_f32_16x16x64_bf16 v[64:67], v[28:31], v[32:39], v0
ds_read_b128 v[20:23], v1
v_add_f32 v60, v60, v61
v_add_f32 v62, v62, v63
v_cvt_pk_bf16_f32 v57, v60, v62
v_smfmac_f32_16x16x64_bf16 v[68:71], v[24:27], a[216:223], v0
s_waitcnt lgkmcnt(1)
ds_read_b128 v[48:51], v2 offset:32768
buffer_store_dwordx2 v[56:57], v9, s[8:11], s50 offen
v_smfmac_f32_16x16x64_bf16 v[68:71], v[28:31], v[40:47], v0
ds_read_b128 v[52:55], v2 offset:33792
v_add_f32 v64, v64, v65
v_add_f32 v66, v66, v67
v_cvt_pk_bf16_f32 v64, v64, v66
v_smfmac_f32_16x16x64_bf16 v[12:15], v[24:27], a[224:231], v0
s_waitcnt lgkmcnt(0)
v_smfmac_f32_16x16x64_bf16 v[12:15], v[28:31], v[48:55], v0
s_nop 0
v_add_f32 v68, v68, v69
v_add_f32 v70, v70, v71
v_cvt_pk_bf16_f32 v65, v68, v70
v_smfmac_f32_16x16x64_bf16 v[20:23], v[24:27], a[232:239], v0
buffer_store_dwordx2 v[64:65], v9, s[8:11], s51 offen
v_smfmac_f32_16x16x64_bf16 v[20:23], v[28:31], a[240:247], v0
s_nop 0
v_add_f32 v12, v12, v13
v_add_f32 v14, v14, v15
v_cvt_pk_bf16_f32 v12, v12, v14
s_nop 3
v_add_f32 v20, v20, v21
v_add_f32 v22, v22, v23
v_cvt_pk_bf16_f32 v13, v20, v22
buffer_store_dwordx2 v[12:13], v9, s[8:11], s52 offen
s_cmp_eq_u32 s48, 0
s_cbranch_scc1 L_nojob2
L_lt2:
s_nop 9
buffer_load_dwordx4 v[32:35], v3, s[8:11], s49 offen sc1
buffer_load_dwordx4 v[36:39], v3, s[8:11], s49 offen offset:1024 sc1
buffer_load_dwordx4 v[40:43], v3, s[8:11], s49 offen offset:2048 sc1
buffer_load_dwordx4 v[44:47], v3, s[8:11], s49 offen offset:3072 sc1
s_add_u32 s19, s19, 1
s_mov_b32 s20, s28
s_mov_b32 s28, s29
s_mov_b32 s29, s20
s_and_b32 s20, s19, 3
s_lshl_b32 s20, s20, 14
s_add_u32 s33, s20, 110100480
s_add_u32 s34, s20, s24
s_xor_b32 s20, s20, 32768
s_add_u32 s35, s20, s24
s_add_u32 s30, s30, 524288
s_add_u32 s31, s31, 131072
s_add_u32 s6, s33, 4096
s_add_u32 s7, s33, 8192
s_mov_b32 s22, 0
v_mov_b64 v[24:25], 0
v_mov_b64 v[26:27], 0
v_mov_b64 v[28:29], 0
v_mov_b64 v[30:31], 0
v_and_b32 v70, 0xf40, v3
v_add_u32 v70, v70, v3
v_bfe_u32 v71, v3, 7, 1
v_mad_i32_i24 v70, v71, s4, v70
v_mov_b64 v[64:65], -1
v_mov_b64 v[66:67], -1
v_add_u32 v1, 2112, v4
ds_read_b128 v[48:51], v2 offset:12288
ds_read_b128 v[52:55], v2 offset:13312
v_lshrrev_b32 v8, 2, v3
v_mov_b32 v56, 0x3f80
v_cndmask_b32 v56, v56, 1.0, s[44:45]
v_cndmask_b32 v60, 0, v56, s[36:37]
v_cndmask_b32 v61, 0, v56, s[38:39]
v_cndmask_b32 v62, 0, v56, s[40:41]
v_cndmask_b32 v63, 0, v56, s[42:43]
s_waitcnt vmcnt(3)
s_nop 0
v_mfma_f32_16x16x32_bf16 v[56:59], v[32:35], v[60:63], 0
v_max3_u32 v16, v32, v33, v34
v_max_u32 v16, v16, v35
s_waitcnt vmcnt(2)
v_mfma_f32_16x16x32_bf16 v[56:59], v[36:39], v[60:63], v[56:59]
v_max3_u32 v16, v16, v36, v37
v_max3_u32 v16, v16, v38, v39
s_waitcnt vmcnt(1)
v_mfma_f32_16x16x32_bf16 v[56:59], v[40:43], v[60:63], v[56:59]
v_max3_u32 v16, v16, v40, v41
v_max3_u32 v16, v16, v42, v43
s_waitcnt vmcnt(0)
v_mfma_f32_16x16x32_bf16 v[56:59], v[44:47], v[60:63], v[56:59]
v_max3_u32 v16, v16, v44, v45
v_max3_u32 v16, v16, v46, v47
v_cmp_le_u32 vcc, 0xffff0000, v16
s_cbranch_vccnz L_red2
L_redb2:
s_nop 3
v_permlane32_swap_b32 v56, v58
v_permlane32_swap_b32 v57, v59
v_pk_add_f32 v[56:57], v[56:57], v[58:59]
v_cvt_pk_bf16_f32 v56, v56, v57
buffer_store_dword v56, v11, s[8:11], s34 offen
s_add_u32 s20, s30, 2048
s_add_u32 s21, s30, 8192
s_add_u32 s49, s29, s25
s_add_u32 s50, s29, s26
s_add_u32 s51, s29, s27
s_add_u32 s52, s30, 524288
s_mov_b32 m0, 19968
s_nop 9
s_barrier
s_branch L_gat2
L_red2:
L_red2b:
buffer_load_dwordx4 v[32:35], v3, s[8:11], s49 offen sc1
buffer_load_dwordx4 v[36:39], v3, s[8:11], s49 offen offset:1024 sc1
buffer_load_dwordx4 v[40:43], v3, s[8:11], s49 offen offset:2048 sc1
buffer_load_dwordx4 v[44:47], v3, s[8:11], s49 offen offset:3072 sc1
s_add_u32 s22, s22, 1
s_cmp_gt_u32 s22, 200000
s_cbranch_scc1 L_end
s_waitcnt vmcnt(3)
v_mfma_f32_16x16x32_bf16 v[56:59], v[32:35], v[60:63], 0
v_max3_u32 v16, v32, v33, v34
v_max_u32 v16, v16, v35
s_waitcnt vmcnt(2)
v_mfma_f32_16x16x32_bf16 v[56:59], v[36:39], v[60:63], v[56:59]
v_max3_u32 v16, v16, v36, v37
v_max3_u32 v16, v16, v38, v39
s_waitcnt vmcnt(1)
v_mfma_f32_16x16x32_bf16 v[56:59], v[40:43], v[60:63], v[56:59]
v_max3_u32 v16, v16, v40, v41
v_max3_u32 v16, v16, v42, v43
s_waitcnt vmcnt(0)
v_mfma_f32_16x16x32_bf16 v[56:59], v[44:47], v[60:63], v[56:59]
v_max3_u32 v16, v16, v44, v45
v_max3_u32 v16, v16, v46, v47
v_cmp_le_u32 vcc, 0xffff0000, v16
s_cbranch_vccz L_redb2
s_branch L_red2b
L_g3r2:
buffer_load_dwordx4 v[16:19], v3, s[8:11], s6 offen sc1
s_add_u32 s22, s22, 1
s_waitcnt vmcnt(1)
v_max3_u32 v21, v16, v17, v18
v_max_u32 v21, v21, v19
v_cmp_le_u32 vcc, 0xffff0000, v21
s_cmp_gt_u32 s22, 200000
s_cbranch_vccz L_g32
s_cbranch_scc0 L_g3r2
s_branch L_end
L_sm2:
s_waitcnt lgkmcnt(0)
ds_read_b128 v[24:27], v5
ds_read_b128 v[40:43], v3 offset:13824
ds_read_b128 v[28:31], v5 offset:512
ds_read_b128 v[44:47], v3 offset:15872
ds_read_b128 v[32:35], v5 offset:1024
ds_read_b128 v[48:51], v3 offset:17920
ds_read_b128 v[36:39], v5 offset:1536
ds_read_b128 v[52:55], v3 offset:19968
s_waitcnt lgkmcnt(0)
v_mfma_f32_16x16x32_bf16 v[16:19], v[40:43], v[24:27], 0
ds_read_b128 v[40:43], v3 offset:14848
v_mfma_f32_16x16x32_bf16 v[16:19], v[44:47], v[28:31], v[16:19]
ds_read_b128 v[44:47], v3 offset:16896
v_mfma_f32_16x16x32_bf16 v[16:19], v[48:51], v[32:35], v[16:19]
ds_read_b128 v[48:51], v3 offset:18944
v_mfma_f32_16x16x32_bf16 v[16:19], v[52:55], v[36:39], v[16:19]
ds_read_b128 v[52:55], v3 offset:20992
v_mfma_f32_16x16x32_bf16 v[20:23], v[24:27], v[24:27], 0
v_mfma_f32_16x16x32_bf16 v[20:23], v[28:31], v[28:31], v[20:23]
v_mfma_f32_16x16x32_bf16 v[20:23], v[32:35], v[32:35], v[20:23]
v_mfma_f32_16x16x32_bf16 v[20:23], v[36:39], v[36:39], v[20:23]
s_waitcnt lgkmcnt(0)
v_mfma_f32_16x16x32_bf16 v[12:15], v[40:43], v[24:27], 0
v_mfma_f32_16x16x32_bf16 v[12:15], v[44:47], v[28:31], v[12:15]
v_mfma_f32_16x16x32_bf16 v[12:15], v[48:51], v[32:35], v[12:15]
v_mfma_f32_16x16x32_bf16 v[12:15], v[52:55], v[36:39], v[12:15]
v_max3_f32 v59, v16, v17, v18
s_nop 1
v_max3_f32 v59, v59, v19, v20
s_nop 3
v_max3_f32 v59, v59, v21, v12
v_max3_f32 v59, v59, v13, v14
v_max_f32 v59, v59, v15
v_mov_b32 v22, v59
s_nop 1
v_permlane32_swap_b32 v22, v59
v_max_f32 v59, v59, v22
v_mov_b32 v22, v59
s_nop 1
v_permlane16_swap_b32 v22, v59
v_max_f32 v59, v59, v22
v_sub_f32 v20, v20, v59
v_sub_f32 v21, v21, v59
v_sub_f32 v16, v16, v59
v_sub_f32 v17, v17, v59
v_sub_f32 v18, v18, v59
v_sub_f32 v19, v19, v59
v_sub_f32 v12, v12, v59
v_sub_f32 v13, v13, v59
v_sub_f32 v14, v14, v59
v_sub_f32 v15, v15, v59
v_exp_f32 v20, v20
v_exp_f32 v21, v21
v_exp_f32 v16, v16
v_exp_f32 v17, v17
v_exp_f32 v18, v18
v_exp_f32 v19, v19
v_exp_f32 v12, v12
v_exp_f32 v13, v13
v_exp_f32 v14, v14
v_exp_f32 v15, v15
v_cvt_pk_bf16_f32 v23, v20, v21
v_cvt_pk_bf16_f32 v20, v20, v21
v_mov_b32 v21, 0
v_mov_b32 v22, 0
v_cvt_pk_bf16_f32 v16, v16, v17
v_cvt_pk_bf16_f32 v17, v18, v19
v_cvt_pk_bf16_f32 v18, v12, v13
v_cvt_pk_bf16_f32 v19, v14, v15
v_mfma_f32_16x16x16_bf16 v[24:27], v[56:57], v[20:21], 0
v_mfma_f32_16x16x16_bf16 v[28:31], v[56:57], v[22:23], 0
v_mfma_f32_16x16x16_bf16 v[32:35], v[60:61], v[20:21], 0
ds_read_b128 v[40:43], v2 offset:18432
v_mfma_f32_16x16x32_bf16 v[32:35], v[60:63], v[16:19], v[32:35]
ds_read_b128 v[44:47], v2 offset:19456
v_mov_b32 v20, 0
v_mfma_f32_16x16x32_bf16 v[24:27], v[64:67], v[16:19], v[24:27]
ds_read_b128 v[48:51], v2 offset:20480
v_mov_b32 v23, 0
v_mfma_f32_16x16x32_bf16 v[28:31], v[68:71], v[16:19], v[28:31]
ds_read_b128 v[52:55], v2 offset:21504
v_mov_b32 v15, 0
v_rcp_f32 v12, v32
v_subrev_u32 v14, 0x21800000, v32
v_cmp_le_u32 vcc, 0x3c000000, v14
v_pk_mul_f32 v[24:25], v[24:25], v[12:13] op_sel_hi:[1,0]
v_pk_mul_f32 v[26:27], v[26:27], v[12:13] op_sel_hi:[1,0]
ds_read_b128 v[32:35], v2 offset:22528
v_pk_mul_f32 v[28:29], v[28:29], v[12:13] op_sel_hi:[1,0]
v_pk_mul_f32 v[30:31], v[30:31], v[12:13] op_sel_hi:[1,0]
v_cvt_pk_bf16_f32 v24, v24, v28
v_cvt_pk_bf16_f32 v25, v25, v29
v_cvt_pk_bf16_f32 v26, v26, v30
v_cvt_pk_bf16_f32 v27, v27, v31
v_mfma_f32_16x16x32_bf16 v[16:19], v[20:23], v[20:23], 0
ds_write_b128 v7, v[24:27]
v_mfma_f32_16x16x32_bf16 v[12:15], v[20:23], v[20:23], 0
ds_read_b128 v[36:39], v2 offset:23552
s_branch L_smr2
L_nojob2:
s_add_u32 s19, s19, 1
s_mov_b32 s20, s28
s_mov_b32 s28, s29
s_mov_b32 s29, s20
s_and_b32 s20, s19, 3
s_lshl_b32 s20, s20, 14
s_add_u32 s33, s20, 110100480
s_add_u32 s34, s20, s24
s_xor_b32 s20, s20, 32768
s_add_u32 s35, s20, s24
s_add_u32 s30, s30, 524288
s_add_u32 s31, s31, 131072
s_add_u32 s6, s33, 4096
s_add_u32 s7, s33, 8192
s_mov_b32 s22, 0
v_mov_b64 v[24:25], 0
v_mov_b64 v[26:27], 0
v_mov_b64 v[28:29], 0
v_mov_b64 v[30:31], 0
v_and_b32 v70, 0xf40, v3
v_add_u32 v70, v70, v3
v_bfe_u32 v71, v3, 7, 1
v_mad_i32_i24 v70, v71, s4, v70
v_mov_b64 v[64:65], -1
v_mov_b64 v[66:67], -1
v_add_u32 v1, 2112, v4
ds_read_b128 v[48:51], v2 offset:12288
ds_read_b128 v[52:55], v2 offset:13312
v_lshrrev_b32 v8, 2, v3
s_barrier
s_branch L_gat2
L_ent3:
s_movk_i32 s4, -64
s_mov_b32 s14, s53
s_mov_b32 s15, s53
v_mov_b64 v[24:25], 0
v_mov_b64 v[26:27], 0
v_mov_b64 v[28:29], 0
v_mov_b64 v[30:31], 0
v_and_b32 v69, 0x380, v3
v_add_u32 v69, v69, v3
v_and_b32 v70, 0xf40, v3
v_add_u32 v70, v70, v3
v_bfe_u32 v71, v3, 7, 1
v_mad_i32_i24 v70, v71, s4, v70
v_mov_b64 v[64:65], -1
v_mov_b64 v[66:67], -1
v_add_u32 v1, 2112, v4
ds_read_b128 v[48:51], v2 offset:14336
ds_read_b128 v[52:55], v2 offset:15360
ds_read_b128 v[40:43], v2 offset:6144
ds_read_b128 v[44:47], v2 offset:7168
v_mov_b64 v[32:33], 0
v_mov_b64 v[34:35], 0
v_mov_b64 v[36:37], 0
v_mov_b64 v[38:39], 0
v_mov_b64 v[56:57], 0
v_mov_b64 v[58:59], 0
v_mov_b64 v[60:61], 0
v_mov_b64 v[62:63], 0
s_add_u32 s20, s30, 3072
s_add_u32 s21, s30, 8192
s_add_u32 s49, s29, s25
s_add_u32 s50, s29, s26
s_add_u32 s51, s29, s27
s_add_u32 s52, s30, 524288
s_mov_b32 m0, 22016
s_nop 0
buffer_load_dwordx4 v69, s[8:11], s20 offen sc1 lds
s_mov_b32 m0, 22912
s_nop 0
buffer_load_dwordx4 v69, s[8:11], s20 offen offset:128 sc1 lds
s_waitcnt vmcnt(0) lgkmcnt(0)
s_branch L_step3
L_gr3:
buffer_load_dwordx4 v[12:15], v3, s[8:11], s33 offen sc1
buffer_load_dword v20, v8, s[8:11], s7 offen sc1
buffer_load_dwordx4 v[16:19], v3, s[8:11], s6 offen sc1
s_add_u32 s22, s22, 1
s_cmp_gt_u32 s22, 200000
s_cbranch_scc1 L_end
buffer_load_dwordx4 v[16:19], v3, s[8:11], s6 offen sc1
v_mov_b64 v[24:25], 0
v_mov_b64 v[26:27], 0
v_mov_b64 v[28:29], 0
v_mov_b64 v[30:31], 0
v_mov_b64 v[32:33], 0
v_mov_b64 v[34:35], 0
v_mov_b64 v[36:37], 0
v_mov_b64 v[38:39], 0
v_mov_b64 v[56:57], 0
v_mov_b64 v[58:59], 0
v_mov_b64 v[60:61], 0
v_mov_b64 v[62:63], 0
s_waitcnt lgkmcnt(0)
s_branch L_step3
.p2align 3
L_gat3:
buffer_load_dwordx4 v[12:15], v3, s[8:11], s33 offen sc1
buffer_load_dword v20, v8, s[8:11], s7 offen sc1
s_add_u32 s20, s30, 3072
s_add_u32 s21, s30, 8192
s_add_u32 s49, s29, s25
s_add_u32 s50, s29, s26
s_add_u32 s51, s29, s27
s_add_u32 s52, s30, 524288
buffer_load_dwordx4 v[16:19], v3, s[8:11], s6 offen sc1
s_mov_b32 m0, 22016
ds_read_b128 v[40:43], v2 offset:6144
ds_read_b128 v[44:47], v2 offset:7168
v_mov_b64 v[32:33], 0
v_mov_b64 v[34:35], 0
v_mov_b64 v[36:37], 0
v_mov_b64 v[38:39], 0
v_mov_b64 v[56:57], 0
v_mov_b64 v[58:59], 0
v_mov_b64 v[60:61], 0
v_mov_b64 v[62:63], 0
s_nop 3
buffer_load_dwordx4 v[16:19], v3, s[8:11], s6 offen sc1
s_waitcnt lgkmcnt(0)
L_step3:
s_waitcnt vmcnt(3)
v_smfmac_f32_16x16x64_bf16 v[24:27], v[12:15], v[144:151], v0
ds_write_b128 v3, v[12:15] offset:6656
v_smfmac_f32_16x16x64_bf16 v[28:31], v[12:15], v[152:159], v0
s_waitcnt vmcnt(2)
v_max3_u32 v21, v12, v13, v14
v_max3_u32 v21, v21, v15, v20
v_cmp_le_u32 vcc, 0xffff0000, v21
v_smfmac_f32_16x16x64_bf16 v[32:35], v[12:15], v[160:167], v0
s_cbranch_vccnz L_gr3
s_waitcnt vmcnt(1)
v_max3_u32 v21, v16, v17, v18
v_max_u32 v21, v21, v19
v_cmp_le_u32 vcc, 0xffff0000, v21
ds_write_b32 v8, v20 offset:14848
v_smfmac_f32_16x16x64_bf16 v[56:59], v[12:15], a[80:87], v0
s_cbranch_vccnz L_g3r3
L_g33:
ds_write_b128 v3, v[16:19] offset:10752
v_smfmac_f32_16x16x64_bf16 v[60:63], v[12:15], a[88:95], v0
v_smfmac_f32_16x16x64_bf16 v[36:39], v[12:15], v[40:47], v0
v_smfmac_f32_16x16x64_bf16 v[24:27], v[16:19], v[240:247], v0
v_smfmac_f32_16x16x64_bf16 v[28:31], v[16:19], v[248:255], v0
s_waitcnt lgkmcnt(0)
s_barrier
ds_read_b128 v[20:23], v3 offset:3584
v_smfmac_f32_16x16x64_bf16 v[32:35], v[16:19], a[0:7], v0
ds_read_b128 v[12:15], v3 offset:4608
s_mov_b32 m0, 6272
v_smfmac_f32_16x16x64_bf16 v[56:59], v[16:19], a[144:151], v0
ds_read_b128 v[40:43], v2
v_smfmac_f32_16x16x64_bf16 v[60:63], v[16:19], a[152:159], v0
ds_read_b128 v[44:47], v2 offset:1024
buffer_store_dwordx4 v[64:67], v3, s[8:11], s49 offen
v_smfmac_f32_16x16x64_bf16 v[36:39], v[16:19], v[48:55], v0
s_waitcnt vmcnt(1)
ds_read_b128 v[16:19], v3 offset:5632
s_waitcnt lgkmcnt(4)
v_smfmac_f32_16x16x64_bf16 v[24:27], v[20:23], v[72:79], v0
ds_read_b128 v[48:51], v2 offset:2048
buffer_store_dwordx4 v[64:67], v3, s[8:11], s50 offen
v_smfmac_f32_16x16x64_bf16 v[28:31], v[20:23], v[80:87], v0
ds_read_b128 v[52:55], v2 offset:3072
v_smfmac_f32_16x16x64_bf16 v[32:35], v[20:23], v[88:95], v0
s_waitcnt lgkmcnt(3)
buffer_store_dwordx4 v[64:67], v3, s[8:11], s51 offen
v_smfmac_f32_16x16x64_bf16 v[36:39], v[20:23], v[40:47], v0
ds_read_b128 v[20:23], v3 offset:7680
buffer_load_dwordx4 v[64:67], v70, s[8:11], s21 offen sc1
v_smfmac_f32_16x16x64_bf16 v[24:27], v[12:15], v[96:103], v0
ds_read_b128 v[40:43], v2 offset:4096
v_smfmac_f32_16x16x64_bf16 v[28:31], v[12:15], v[104:111], v0
ds_read_b128 v[44:47], v2 offset:5120
buffer_load_dwordx4 v[68:71], v70, s[8:11], s21 offen offset:256 sc1
v_smfmac_f32_16x16x64_bf16 v[32:35], v[12:15], v[112:119], v0
s_waitcnt lgkmcnt(3)
v_smfmac_f32_16x16x64_bf16 v[36:39], v[12:15], v[48:55], v0
ds_read_b128 v[12:15], v3 offset:8704
v_smfmac_f32_16x16x64_bf16 v[24:27], v[16:19], v[120:127], v0
ds_read_b128 v[48:51], v2 offset:8192
v_smfmac_f32_16x16x64_bf16 v[28:31], v[16:19], v[128:135], v0
ds_read_b128 v[52:55], v2 offset:9216
v_mov_b32 v11, s19
v_smfmac_f32_16x16x64_bf16 v[32:35], v[16:19], v[136:143], v0
s_mov_b64 exec, 1
buffer_store_dword v11, v8, s[8:11], s83 offen sc1
s_mov_b64 exec, -1
s_waitcnt lgkmcnt(3)
v_smfmac_f32_16x16x64_bf16 v[36:39], v[16:19], v[40:47], v0
ds_read_b128 v[16:19], v3 offset:9728
buffer_load_dword v11, v8, s[8:11], s82 offen sc1
v_smfmac_f32_16x16x64_bf16 v[24:27], v[20:23], v[168:175], v0
ds_read_b128 v[40:43], v2 offset:10240
v_smfmac_f32_16x16x64_bf16 v[28:31], v[20:23], v[176:183], v0
ds_read_b128 v[44:47], v2 offset:11264
v_smfmac_f32_16x16x64_bf16 v[32:35], v[20:23], v[184:191], v0
s_waitcnt lgkmcnt(3)
v_smfmac_f32_16x16x64_bf16 v[36:39], v[20:23], v[48:55], v0
ds_read_b128 v[20:23], v3 offset:11776
v_smfmac_f32_16x16x64_bf16 v[24:27], v[12:15], v[192:199], v0
ds_read_b128 v[48:51], v2 offset:12288
v_smfmac_f32_16x16x64_bf16 v[28:31], v[12:15], v[200:207], v0
ds_read_b128 v[52:55], v2 offset:13312
v_smfmac_f32_16x16x64_bf16 v[32:35], v[12:15], v[208:215], v0
s_waitcnt lgkmcnt(3)
v_smfmac_f32_16x16x64_bf16 v[36:39], v[12:15], v[40:47], v0
ds_read_b128 v[12:15], v3 offset:3584
v_smfmac_f32_16x16x64_bf16 v[24:27], v[16:19], v[216:223], v0
ds_read_b128 v[40:43], v2 offset:16384
v_smfmac_f32_16x16x64_bf16 v[28:31], v[16:19], v[224:231], v0
ds_read_b128 v[44:47], v2 offset:17408
v_smfmac_f32_16x16x64_bf16 v[32:35], v[16:19], v[232:239], v0
s_waitcnt lgkmcnt(3)
v_smfmac_f32_16x16x64_bf16 v[36:39], v[16:19], v[48:55], v0
ds_read_b128 v[16:19], v3 offset:4608
v_smfmac_f32_16x16x64_bf16 v[24:27], v[20:23], a[8:15], v0
ds_read_b128 v[52:55], v3 offset:18944
v_smfmac_f32_16x16x64_bf16 v[28:31], v[20:23], a[16:23], v0
ds_read_b128 v[48:51], v3 offset:16896
v_smfmac_f32_16x16x64_bf16 v[32:35], v[20:23], a[24:31], v0
s_waitcnt lgkmcnt(3)
v_smfmac_f32_16x16x64_bf16 v[36:39], v[20:23], v[40:47], v0
ds_read_b128 v[20:23], v3 offset:5632
s_nop 0
v_add_f32 v24, v24, v25
v_smfmac_f32_16x16x64_bf16 v[56:59], v[12:15], a[32:39], v0
ds_read_b128 v[40:43], v3 offset:12800
v_add_f32 v26, v26, v27
v_add_f32 v28, v28, v29
v_add_f32 v30, v30, v31
v_mul_f32 v24, s18, v24
v_smfmac_f32_16x16x64_bf16 v[60:63], v[12:15], a[40:47], v0
ds_read_b128 v[12:15], v3 offset:7680
v_mul_f32 v28, s18, v28
v_mul_f32 v26, s18, v26
v_mul_f32 v30, s18, v30
v_cvt_pk_bf16_f32 v24, v24, v28
s_waitcnt lgkmcnt(5)
v_smfmac_f32_16x16x64_bf16 v[56:59], v[16:19], a[48:55], v0
ds_read_b128 v[44:47], v3 offset:14848
v_cvt_pk_bf16_f32 v26, v26, v30
ds_write2_b32 v1, v24, v26 offset1:32
v_add_f32 v32, v32, v33
v_add_f32 v34, v34, v35
v_smfmac_f32_16x16x64_bf16 v[60:63], v[16:19], a[56:63], v0
ds_read_b128 v[16:19], v3 offset:8704
v_add_f32 v36, v36, v37
v_add_f32 v38, v38, v39
v_cvt_pk_bf16_f32 v32, v32, v36
v_cvt_pk_bf16_f32 v34, v34, v38
s_waitcnt lgkmcnt(5)
v_smfmac_f32_16x16x64_bf16 v[56:59], v[20:23], a[64:71], v0
ds_write2_b32 v4, v32, v34 offset1:32
v_smfmac_f32_16x16x64_bf16 v[60:63], v[20:23], a[72:79], v0
s_waitcnt lgkmcnt(4)
ds_read_b128 v[20:23], v3 offset:9728
v_smfmac_f32_16x16x64_bf16 v[56:59], v[12:15], a[96:103], v0
buffer_store_dword v32, v4, s[8:11], s31 offen sc1
v_smfmac_f32_16x16x64_bf16 v[60:63], v[12:15], a[104:111], v0
s_waitcnt lgkmcnt(2)
ds_read_b128 v[12:15], v3 offset:11776
v_smfmac_f32_16x16x64_bf16 v[56:59], v[16:19], a[112:119], v0
buffer_store_dword v34, v4, s[8:11], s31 offen offset:128 sc1
v_smfmac_f32_16x16x64_bf16 v[60:63], v[16:19], a[120:127], v0
s_waitcnt lgkmcnt(1)
v_smfmac_f32_16x16x64_bf16 v[56:59], v[20:23], a[128:135], v0
s_barrier
ds_read_b128 v[36:39], v5 offset:1536
v_smfmac_f32_16x16x64_bf16 v[60:63], v[20:23], a[136:143], v0
s_waitcnt lgkmcnt(1)
ds_read_b128 v[24:27], v5
v_smfmac_f32_16x16x64_bf16 v[56:59], v[12:15], a[160:167], v0
ds_read_b128 v[28:31], v5 offset:512
v_smfmac_f32_16x16x64_bf16 v[60:63], v[12:15], a[168:175], v0
s_waitcnt lgkmcnt(2)
ds_read_b128 v[32:35], v5 offset:1024
v_mfma_f32_16x16x32_bf16 v[16:19], v[52:55], v[36:39], 0
s_waitcnt lgkmcnt(2)
ds_read_b128 v[52:55], v3 offset:19968
v_mfma_f32_16x16x32_bf16 v[16:19], v[40:43], v[24:27], v[16:19]
s_waitcnt lgkmcnt(2)
ds_read_b128 v[40:43], v3 offset:13824
v_mfma_f32_16x16x32_bf16 v[16:19], v[44:47], v[28:31], v[16:19]
s_waitcnt lgkmcnt(2)
ds_read_b128 v[44:47], v3 offset:15872
v_add_f32 v56, v56, v57
v_mfma_f32_16x16x32_bf16 v[16:19], v[48:51], v[32:35], v[16:19]
ds_read_b128 v[48:51], v3 offset:17920
v_add_f32 v58, v58, v59
v_mfma_f32_16x16x32_bf16 v[20:23], v[36:39], v[36:39], 0
s_add_u32 s49, s28, s23
v_add_f32 v60, v60, v61
v_add_f32 v62, v62, v63
v_mfma_f32_16x16x32_bf16 v[20:23], v[24:27], v[24:27], v[20:23]
s_add_u32 s50, s28, 65536
v_cvt_pk_bf16_f32 v56, v56, v58
v_cvt_pk_bf16_f32 v57, v60, v62
v_mfma_f32_16x16x32_bf16 v[20:23], v[28:31], v[28:31], v[20:23]
s_add_u32 s51, s28, 131072
v_exp_f32 v16, v16
v_mfma_f32_16x16x32_bf16 v[20:23], v[32:35], v[32:35], v[20:23]
s_waitcnt lgkmcnt(3)
v_exp_f32 v17, v17
buffer_store_dword v56, v8, s[8:11], s31 offen offset:2048 sc1
v_mfma_f32_16x16x32_bf16 v[12:15], v[52:55], v[36:39], 0
s_waitcnt lgkmcnt(2)
v_exp_f32 v18, v18
v_mfma_f32_16x16x32_bf16 v[12:15], v[40:43], v[24:27], v[12:15]
s_waitcnt lgkmcnt(1)
v_exp_f32 v19, v19
buffer_store_dword v57, v8, s[8:11], s31 offen offset:3072 sc1
v_mfma_f32_16x16x32_bf16 v[12:15], v[44:47], v[28:31], v[12:15]
s_waitcnt lgkmcnt(0)
v_exp_f32 v20, v20
v_mfma_f32_16x16x32_bf16 v[12:15], v[48:51], v[32:35], v[12:15]
s_add_u32 s52, s28, 196608
v_exp_f32 v21, v21
v_mov_b64 v[60:61], s[14:15]
v_cvt_pk_bf16_f32 v23, v20, v21
v_cvt_pk_bf16_f32 v20, v20, v21
v_mov_b32 v21, 0
v_mov_b32 v22, 0
v_cvt_pk_bf16_f32 v16, v16, v17
v_cvt_pk_bf16_f32 v17, v18, v19
v_mfma_f32_16x16x16_bf16 v[24:27], v[56:57], v[20:21], 0
v_exp_f32 v12, v12
v_mfma_f32_16x16x16_bf16 v[28:31], v[56:57], v[22:23], 0
v_exp_f32 v13, v13
v_mfma_f32_16x16x16_bf16 v[32:35], v[60:61], v[20:21], 0
v_exp_f32 v14, v14
v_exp_f32 v15, v15
v_mov_b64 v[62:63], s[14:15]
v_cvt_pk_bf16_f32 v18, v12, v13
v_cvt_pk_bf16_f32 v19, v14, v15
s_waitcnt vmcnt(6)
ds_read_b128 v[40:43], v2 offset:18432
v_mfma_f32_16x16x32_bf16 v[32:35], v[60:63], v[16:19], v[32:35]
ds_read_b128 v[44:47], v2 offset:19456
v_mov_b32 v20, 0
v_mfma_f32_16x16x32_bf16 v[24:27], v[64:67], v[16:19], v[24:27]
ds_read_b128 v[48:51], v2 offset:20480
v_mov_b32 v23, 0
v_mfma_f32_16x16x32_bf16 v[28:31], v[68:71], v[16:19], v[28:31]
ds_read_b128 v[52:55], v2 offset:21504
v_mov_b32 v15, 0
v_rcp_f32 v12, v32
v_subrev_u32 v14, 0x21800000, v32
v_cmp_le_u32 vcc, 0x3c000000, v14
v_pk_mul_f32 v[24:25], v[24:25], v[12:13] op_sel_hi:[1,0]
v_pk_mul_f32 v[26:27], v[26:27], v[12:13] op_sel_hi:[1,0]
ds_read_b128 v[32:35], v2 offset:22528
v_pk_mul_f32 v[28:29], v[28:29], v[12:13] op_sel_hi:[1,0]
v_pk_mul_f32 v[30:31], v[30:31], v[12:13] op_sel_hi:[1,0]
v_cvt_pk_bf16_f32 v24, v24, v28
v_cvt_pk_bf16_f32 v25, v25, v29
v_cvt_pk_bf16_f32 v26, v26, v30
v_cvt_pk_bf16_f32 v27, v27, v31
v_mfma_f32_16x16x32_bf16 v[16:19], v[20:23], v[20:23], 0
ds_write_b128 v7, v[24:27]
v_mfma_f32_16x16x32_bf16 v[12:15], v[20:23], v[20:23], 0
s_andn2_b64 vcc, vcc, s[86:87]
ds_read_b128 v[36:39], v2 offset:23552
s_cbranch_scc1 L_sm3
L_smr3:
v_mfma_f32_16x16x32_bf16 v[56:59], v[20:23], v[20:23], 0
v_mov_b32 v1, 6528
v_and_b32 v8, 0x380, v3
v_mfma_f32_16x16x32_bf16 v[60:63], v[20:23], v[20:23], 0
s_add_u32 s20, s30, 527360
v_add_u32 v8, v8, v3
s_mov_b32 m0, 22016
s_cmp_eq_u32 s19, 63
s_cbranch_scc1 L_texit
s_waitcnt lgkmcnt(0)
s_barrier
ds_read_b128 v[24:27], v3 offset:1152
v_mfma_f32_16x16x32_bf16 v[64:67], v[20:23], v[20:23], 0
ds_read_b128 v[28:31], v3 offset:2176
s_nop 2
v_mfma_f32_16x16x32_bf16 v[68:71], v[20:23], v[20:23], 0
s_waitcnt lgkmcnt(1)
v_smfmac_f32_16x16x64_bf16 v[12:15], v[24:27], a[248:255], v0
buffer_load_dwordx4 v8, s[8:11], s20 offen sc1 lds
v_smfmac_f32_16x16x64_bf16 v[16:19], v[24:27], a[176:183], v0
s_mov_b32 m0, 22912
s_waitcnt lgkmcnt(0)
v_smfmac_f32_16x16x64_bf16 v[12:15], v[28:31], v[40:47], v0
ds_read_b128 v[40:43], v2 offset:24576
v_smfmac_f32_16x16x64_bf16 v[16:19], v[28:31], v[48:55], v0
ds_read_b128 v[44:47], v2 offset:25600
buffer_load_dwordx4 v8, s[8:11], s20 offen offset:128 sc1 lds
v_smfmac_f32_16x16x64_bf16 v[20:23], v[24:27], a[184:191], v0
ds_read_b128 v[48:51], v2 offset:26624
s_nop 1
v_add_f32 v12, v12, v13
v_add_f32 v14, v14, v15
v_cvt_pk_bf16_f32 v12, v12, v14
v_smfmac_f32_16x16x64_bf16 v[20:23], v[28:31], v[32:39], v0
ds_read_b128 v[52:55], v2 offset:27648
buffer_store_dword v12, v10, s[8:11], s28 offen
v_add_f32 v16, v16, v17
v_add_f32 v18, v18, v19
v_smfmac_f32_16x16x64_bf16 v[56:59], v[24:27], a[192:199], v0
s_waitcnt lgkmcnt(2)
ds_read_b128 v[32:35], v2 offset:28672
v_cvt_pk_bf16_f32 v16, v16, v18
v_smfmac_f32_16x16x64_bf16 v[56:59], v[28:31], v[40:47], v0
ds_read_b128 v[36:39], v2 offset:29696
v_add_f32 v20, v20, v21
v_add_f32 v22, v22, v23
v_cvt_pk_bf16_f32 v17, v20, v22
v_smfmac_f32_16x16x64_bf16 v[60:63], v[24:27], a[200:207], v0
s_waitcnt lgkmcnt(2)
ds_read_b128 v[12:15], v1
buffer_store_dwordx2 v[16:17], v9, s[8:11], s28 offen
v_smfmac_f32_16x16x64_bf16 v[60:63], v[28:31], v[48:55], v0
ds_read_b128 v[40:43], v2 offset:30720
v_add_f32 v56, v56, v57
v_add_f32 v58, v58, v59
v_cvt_pk_bf16_f32 v56, v56, v58
v_smfmac_f32_16x16x64_bf16 v[64:67], v[24:27], a[208:215], v0
s_waitcnt lgkmcnt(2)
ds_read_b128 v[44:47], v2 offset:31744
v_smfmac_f32_16x16x64_bf16 v[64:67], v[28:31], v[32:39], v0
ds_read_b128 v[20:23], v1
v_add_f32 v60, v60, v61
v_add_f32 v62, v62, v63
v_cvt_pk_bf16_f32 v57, v60, v62
v_smfmac_f32_16x16x64_bf16 v[68:71], v[24:27], a[216:223], v0
s_waitcnt lgkmcnt(1)
ds_read_b128 v[48:51], v2 offset:32768
buffer_store_dwordx2 v[56:57], v9, s[8:11], s50 offen
v_smfmac_f32_16x16x64_bf16 v[68:71], v[28:31], v[40:47], v0
ds_read_b128 v[52:55], v2 offset:33792
v_add_f32 v64, v64, v65
v_add_f32 v66, v66, v67
v_cvt_pk_bf16_f32 v64, v64, v66
v_smfmac_f32_16x16x64_bf16 v[12:15], v[24:27], a[224:231], v0
s_waitcnt lgkmcnt(0)
v_smfmac_f32_16x16x64_bf16 v[12:15], v[28:31], v[48:55], v0
s_nop 0
v_add_f32 v68, v68, v69
v_add_f32 v70, v70, v71
v_cvt_pk_bf16_f32 v65, v68, v70
v_smfmac_f32_16x16x64_bf16 v[20:23], v[24:27], a[232:239], v0
buffer_store_dwordx2 v[64:65], v9, s[8:11], s51 offen
v_smfmac_f32_16x16x64_bf16 v[20:23], v[28:31], a[240:247], v0
s_nop 0
v_add_f32 v12, v12, v13
v_add_f32 v14, v14, v15
v_cvt_pk_bf16_f32 v12, v12, v14
s_nop 3
v_add_f32 v20, v20, v21
v_add_f32 v22, v22, v23
v_cvt_pk_bf16_f32 v13, v20, v22
buffer_store_dwordx2 v[12:13], v9, s[8:11], s52 offen
s_add_u32 s19, s19, 1
s_mov_b32 s20, s28
s_mov_b32 s28, s29
s_mov_b32 s29, s20
s_and_b32 s20, s19, 3
s_lshl_b32 s20, s20, 14
s_add_u32 s33, s20, 110100480
s_add_u32 s34, s20, s24
s_xor_b32 s20, s20, 32768
s_add_u32 s35, s20, s24
s_add_u32 s30, s30, 524288
s_add_u32 s31, s31, 131072
s_add_u32 s6, s33, 4096
s_add_u32 s7, s33, 8192
s_mov_b32 s22, 0
v_mov_b64 v[24:25], 0
v_mov_b64 v[26:27], 0
v_mov_b64 v[28:29], 0
v_mov_b64 v[30:31], 0
v_and_b32 v70, 0xf40, v3
v_add_u32 v70, v70, v3
v_bfe_u32 v71, v3, 7, 1
v_mad_i32_i24 v70, v71, s4, v70
v_mov_b64 v[64:65], -1
v_mov_b64 v[66:67], -1
v_add_u32 v1, 2112, v4
ds_read_b128 v[48:51], v2 offset:14336
ds_read_b128 v[52:55], v2 offset:15360
v_lshrrev_b32 v8, 2, v3
s_add_u32 s20, s19, 1
s_lshr_b32 s20, s20, 3
s_min_u32 s20, s20, 7
s_cmp_lt_u32 s19, 3
s_cselect_b32 s20, 8, s20
s_waitcnt vmcnt(11)
L_kvw:
v_readlane_b32 s21, v11, s20
s_nop 0
s_cmp_eq_u32 s21, 1
s_cbranch_scc0 L_kvp
s_barrier
s_branch L_gat3
L_g3r3:
buffer_load_dwordx4 v[16:19], v3, s[8:11], s6 offen sc1
s_add_u32 s22, s22, 1
s_waitcnt vmcnt(1)
v_max3_u32 v21, v16, v17, v18
v_max_u32 v21, v21, v19
v_cmp_le_u32 vcc, 0xffff0000, v21
s_cmp_gt_u32 s22, 200000
s_cbranch_vccz L_g33
s_cbranch_scc0 L_g3r3
s_branch L_end
L_sm3:
s_waitcnt lgkmcnt(0)
ds_read_b128 v[24:27], v5
ds_read_b128 v[40:43], v3 offset:12800
ds_read_b128 v[28:31], v5 offset:512
ds_read_b128 v[44:47], v3 offset:14848
ds_read_b128 v[32:35], v5 offset:1024
ds_read_b128 v[48:51], v3 offset:16896
ds_read_b128 v[36:39], v5 offset:1536
ds_read_b128 v[52:55], v3 offset:18944
s_waitcnt lgkmcnt(0)
v_mfma_f32_16x16x32_bf16 v[16:19], v[40:43], v[24:27], 0
ds_read_b128 v[40:43], v3 offset:13824
v_mfma_f32_16x16x32_bf16 v[16:19], v[44:47], v[28:31], v[16:19]
ds_read_b128 v[44:47], v3 offset:15872
v_mfma_f32_16x16x32_bf16 v[16:19], v[48:51], v[32:35], v[16:19]
ds_read_b128 v[48:51], v3 offset:17920
v_mfma_f32_16x16x32_bf16 v[16:19], v[52:55], v[36:39], v[16:19]
ds_read_b128 v[52:55], v3 offset:19968
v_mfma_f32_16x16x32_bf16 v[20:23], v[24:27], v[24:27], 0
v_mfma_f32_16x16x32_bf16 v[20:23], v[28:31], v[28:31], v[20:23]
v_mfma_f32_16x16x32_bf16 v[20:23], v[32:35], v[32:35], v[20:23]
v_mfma_f32_16x16x32_bf16 v[20:23], v[36:39], v[36:39], v[20:23]
s_waitcnt lgkmcnt(0)
v_mfma_f32_16x16x32_bf16 v[12:15], v[40:43], v[24:27], 0
v_mfma_f32_16x16x32_bf16 v[12:15], v[44:47], v[28:31], v[12:15]
v_mfma_f32_16x16x32_bf16 v[12:15], v[48:51], v[32:35], v[12:15]
v_mfma_f32_16x16x32_bf16 v[12:15], v[52:55], v[36:39], v[12:15]
v_max3_f32 v59, v16, v17, v18
s_nop 1
v_max3_f32 v59, v59, v19, v20
s_nop 3
v_max3_f32 v59, v59, v21, v12
v_max3_f32 v59, v59, v13, v14
v_max_f32 v59, v59, v15
v_mov_b32 v22, v59
s_nop 1
v_permlane32_swap_b32 v22, v59
v_max_f32 v59, v59, v22
v_mov_b32 v22, v59
s_nop 1
v_permlane16_swap_b32 v22, v59
v_max_f32 v59, v59, v22
v_sub_f32 v20, v20, v59
v_sub_f32 v21, v21, v59
v_sub_f32 v16, v16, v59
v_sub_f32 v17, v17, v59
v_sub_f32 v18, v18, v59
v_sub_f32 v19, v19, v59
v_sub_f32 v12, v12, v59
v_sub_f32 v13, v13, v59
v_sub_f32 v14, v14, v59
v_sub_f32 v15, v15, v59
v_exp_f32 v20, v20
v_exp_f32 v21, v21
v_exp_f32 v16, v16
v_exp_f32 v17, v17
v_exp_f32 v18, v18
v_exp_f32 v19, v19
v_exp_f32 v12, v12
v_exp_f32 v13, v13
v_exp_f32 v14, v14
v_exp_f32 v15, v15
v_cvt_pk_bf16_f32 v23, v20, v21
v_cvt_pk_bf16_f32 v20, v20, v21
v_mov_b32 v21, 0
v_mov_b32 v22, 0
v_cvt_pk_bf16_f32 v16, v16, v17
v_cvt_pk_bf16_f32 v17, v18, v19
v_cvt_pk_bf16_f32 v18, v12, v13
v_cvt_pk_bf16_f32 v19, v14, v15
v_mfma_f32_16x16x16_bf16 v[24:27], v[56:57], v[20:21], 0
v_mfma_f32_16x16x16_bf16 v[28:31], v[56:57], v[22:23], 0
v_mfma_f32_16x16x16_bf16 v[32:35], v[60:61], v[20:21], 0
ds_read_b128 v[40:43], v2 offset:18432
v_mfma_f32_16x16x32_bf16 v[32:35], v[60:63], v[16:19], v[32:35]
ds_read_b128 v[44:47], v2 offset:19456
v_mov_b32 v20, 0
v_mfma_f32_16x16x32_bf16 v[24:27], v[64:67], v[16:19], v[24:27]
ds_read_b128 v[48:51], v2 offset:20480
v_mov_b32 v23, 0
v_mfma_f32_16x16x32_bf16 v[28:31], v[68:71], v[16:19], v[28:31]
ds_read_b128 v[52:55], v2 offset:21504
v_mov_b32 v15, 0
v_rcp_f32 v12, v32
v_subrev_u32 v14, 0x21800000, v32
v_cmp_le_u32 vcc, 0x3c000000, v14
v_pk_mul_f32 v[24:25], v[24:25], v[12:13] op_sel_hi:[1,0]
v_pk_mul_f32 v[26:27], v[26:27], v[12:13] op_sel_hi:[1,0]
ds_read_b128 v[32:35], v2 offset:22528
v_pk_mul_f32 v[28:29], v[28:29], v[12:13] op_sel_hi:[1,0]
v_pk_mul_f32 v[30:31], v[30:31], v[12:13] op_sel_hi:[1,0]
v_cvt_pk_bf16_f32 v24, v24, v28
v_cvt_pk_bf16_f32 v25, v25, v29
v_cvt_pk_bf16_f32 v26, v26, v30
v_cvt_pk_bf16_f32 v27, v27, v31
v_mfma_f32_16x16x32_bf16 v[16:19], v[20:23], v[20:23], 0
ds_write_b128 v7, v[24:27]
v_mfma_f32_16x16x32_bf16 v[12:15], v[20:23], v[20:23], 0
ds_read_b128 v[36:39], v2 offset:23552
s_branch L_smr3
L_kvp:
buffer_load_dword v11, v8, s[8:11], s82 offen sc1
s_add_u32 s22, s22, 1
s_cmp_gt_u32 s22, 200000
s_cbranch_scc1 L_end
s_waitcnt vmcnt(0)
s_branch L_kvw
L_texit:
s_lshl_b32 s61, s16, 7
s_add_u32 s61, s61, 111153152
s_waitcnt vmcnt(0)
s_barrier
s_cmp_lg_u32 s17, 0
s_cbranch_scc1 L_sf_63
v_mov_b32 v20, 0
v_mov_b32 v21, 64
s_mov_b64 exec, 1
buffer_store_dword v21, v20, s[8:11], s61 offen sc1
s_mov_b64 exec, -1
L_sf_63:
L_done:
L_end:
s_endpgm
.section .rodata,"a"
.p2align 6
.amdhsa_kernel concat_heads__compressed_kv_cla__memory_aug_recurrent_mem_tr__prompt_kernel
  .amdhsa_next_free_vgpr 512
  .amdhsa_next_free_sgpr 102
  .amdhsa_accum_offset 256
  .amdhsa_group_segment_fixed_size 0
  .amdhsa_kernarg_size 128
  .amdhsa_user_sgpr_count 2
  .amdhsa_user_sgpr_kernarg_segment_ptr 1
  .amdhsa_system_sgpr_workgroup_id_x 1
.end_amdhsa_kernel
```

```asm
; @launch grid=(256,1,1) block=(256,1,1) lds=163840
.amdgcn_target "amdgcn-amd-amdhsa--gfx950"
.text
.globl concat_heads__compressed_kv_cla__memory_aug_recurrent_mem_tr__prompt_kernel
.p2align 8
.type concat_heads__compressed_kv_cla__memory_aug_recurrent_mem_tr__prompt_kernel,@function
concat_heads__compressed_kv_cla__memory_aug_recurrent_mem_tr__prompt_kernel:
s_cmp_lt_u32 s2, 256
s_cbranch_scc1 L_go
L_end0:
s_endpgm
L_go:
s_getreg_b32 s3, hwreg(HW_REG_XCC_ID)
s_and_b32 s3, s3, 7
s_load_dwordx2 s[4:5], s[0:1], 120
s_load_dwordx2 s[6:7], s[0:1], 112
v_lshrrev_b32 v1, 6, v0
s_nop 0
v_readfirstlane_b32 s17, v1
s_waitcnt lgkmcnt(0)
s_mov_b32 s8, s4
s_and_b32 s9, s5, 0xffff
s_mov_b32 s10, 268435456
s_mov_b32 s11, 0x20000
s_mov_b32 s56, s6
s_and_b32 s57, s7, 0xffff
s_mov_b32 s58, 256
s_mov_b32 s59, 0x20000
s_lshl_b32 s24, s3, 2
s_cmp_eq_u32 s17, 0
s_cbranch_scc0 L_tk
v_lshlrev_b32 v3, 12, v0
s_mov_b64 exec, 1
v_mov_b32 v1, 1
v_mov_b32 v2, 0
buffer_atomic_add v1, v2, s[56:59], s24 offen sc0
s_mov_b64 exec, -1
s_getpc_b64 s[4:5]
L_pc:
s_mov_b32 s12, s4
s_and_b32 s13, s5, 0xffff
s_mov_b32 s14, L_end-L_pc
s_mov_b32 s15, 0x20000
s_lshr_b32 s25, s2, 3
s_lshl_b32 s25, s25, 7
buffer_load_dword a255, v3, s[12:15], s25 offen
s_mov_b64 exec, 1
s_waitcnt vmcnt(1)
ds_write_b32 v2, v1
s_waitcnt lgkmcnt(0)
s_mov_b64 exec, -1
L_tk:
s_barrier
v_mov_b32 v2, 0
ds_read_b32 v1, v2
s_lshr_b32 s3, 0x76530142, s24
s_and_b32 s3, s3, 7
s_waitcnt lgkmcnt(0)
v_readfirstlane_b32 s16, v1
s_barrier
s_cmp_ge_u32 s16, 32
s_cbranch_scc1 L_end0
s_cmp_eq_u32 s3, 0
s_cbranch_scc1 L_team
s_cmp_eq_u32 s3, 1
s_cbranch_scc0 L_np
s_cmp_lt_u32 s16, 24
s_cbranch_scc1 L_np
v_lshlrev_b32 v1, 4, v0
v_mov_b64 v[4:5], 0
v_mov_b64 v[6:7], 0
s_sub_u32 s24, s16, 24
s_lshl_b32 s24, s24, 12
s_add_u32 s24, s24, 111149056
buffer_store_dwordx4 v[4:7], v1, s[8:11], s24 offen sc1
s_waitcnt vmcnt(0)
s_barrier
s_cmp_lg_u32 s17, 0
s_cbranch_scc1 L_np
v_mov_b32 v1, 1
v_mov_b32 v2, 128
s_mov_b64 exec, 1
buffer_atomic_add v1, v2, s[56:59], 0 offen
s_mov_b64 exec, -1
L_np:
s_cmp_lt_u32 s3, 4
s_cselect_b32 s61, 1, 0
s_cbranch_scc1 L_pb
s_load_dwordx2 s[52:53], s[0:1], 8
s_load_dwordx2 s[54:55], s[0:1], 0
s_load_dwordx2 s[6:7], s[0:1], 24
s_load_dwordx2 s[4:5], s[0:1], 32
s_load_dwordx2 s[18:19], s[0:1], 16
s_mov_b32 s45, 3
s_sub_u32 s24, s3, 4
s_lshl_b32 s24, s24, 5
s_add_u32 s24, s24, s16
s_lshr_b32 s89, s24, 2
s_lshr_b32 s90, s24, 3
s_and_b32 s24, s16, 3
s_mul_i32 s88, s24, 0x11
s_and_b32 s24, s16, 7
s_bitcmp1_b32 s16, 2
s_cselect_b32 s25, 3, 0
s_xor_b32 s24, s24, s25
s_lshl_b32 s24, s24, 8
s_add_u32 s88, s88, s24
s_add_u32 s88, s88, 0x840
s_branch L_pg
L_pb:
s_load_dwordx2 s[52:53], s[0:1], 48
s_load_dwordx2 s[54:55], s[0:1], 48
s_load_dwordx2 s[6:7], s[0:1], 72
s_load_dwordx2 s[4:5], s[0:1], 80
s_load_dwordx2 s[18:19], s[0:1], 64
s_mov_b32 s45, 6
s_sub_u32 s24, s3, 2
s_lshl_b32 s24, s24, 5
s_add_u32 s24, s24, s16
s_lshr_b32 s89, s24, 1
s_lshr_b32 s90, s24, 2
s_mov_b32 s88, 0xe6a431
s_mov_b32 s25, 0xe6c431
s_bitcmp1_b32 s16, 0
s_cselect_b32 s88, 0xf7b582, s88
s_cselect_b32 s25, 0xf7d592, s25
s_bitcmp1_b32 s16, 1
s_cselect_b32 s88, s25, s88
s_cselect_b32 s45, 5, 6
s_add_u32 s45, s3, 3
s_cmp_eq_u32 s3, 1
s_cselect_b32 s45, 1, s45
s_cselect_b32 s88, 0, s88
s_cselect_b32 s89, s16, s89
L_pg:
s_waitcnt lgkmcnt(0)
s_cmp_ge_u32 s17, 2
s_cselect_b64 s[6:7], s[4:5], s[6:7]
s_cmp_eq_u32 s61, 0
s_cselect_b32 s24, 4, 1
s_mov_b32 s14, 884736
s_cselect_b32 s14, 1048576, s14
s_sub_u32 s24, s3, s24
s_lshl_b32 s24, s24, 5
s_add_u32 s24, s24, s16
s_lshl_b32 s24, s24, 13
s_mov_b32 s12, s52
s_and_b32 s13, s53, 0xffff
s_mov_b32 s15, 0x20000
v_lshlrev_b32 v15, 5, v0
buffer_load_dword v15, v15, s[12:15], s24 offen
s_sub_u32 s24, 7, s3
s_mul_i32 s25, s16, 6
s_add_u32 s24, s24, s25
s_cmp_ge_u32 s24, 36
s_cbranch_scc1 L_pf_1
s_load_dwordx2 s[4:5], s[0:1], 88
s_sub_u32 s25, s24, 0
s_mul_i32 s25, s25, 131072
s_add_u32 s25, s25, 0
s_min_u32 s25, s25, 4718592
s_sub_u32 s98, 4718592, s25
s_mov_b32 s100, 0x0
s_branch L_pfd
L_pf_1:
s_cmp_ge_u32 s24, 72
s_cbranch_scc1 L_pf_2
s_load_dwordx2 s[4:5], s[0:1], 64
s_sub_u32 s25, s24, 36
s_mul_i32 s25, s25, 131072
s_add_u32 s25, s25, 0
s_min_u32 s25, s25, 4718592
s_sub_u32 s98, 4718592, s25
s_mov_b32 s100, 0x0
s_branch L_pfd
L_pf_2:
s_cmp_ge_u32 s24, 80
s_cbranch_scc1 L_pf_3
s_load_dwordx2 s[4:5], s[0:1], 8
s_sub_u32 s25, s24, 72
s_mul_i32 s25, s25, 131072
s_add_u32 s25, s25, 1048576
s_min_u32 s25, s25, 2097152
s_sub_u32 s98, 2097152, s25
s_mov_b32 s100, 0xfffe0000
s_branch L_pfd
L_pf_3:
s_cmp_ge_u32 s24, 92
s_cbranch_scc1 L_pf_4
s_load_dwordx2 s[4:5], s[0:1], 48
s_sub_u32 s25, s24, 80
s_mul_i32 s25, s25, 131072
s_add_u32 s25, s25, 786432
s_min_u32 s25, s25, 2359296
s_sub_u32 s98, 2359296, s25
s_mov_b32 s100, 0xfffe0000
s_branch L_pfd
L_pf_4:
s_cmp_ge_u32 s24, 110
s_cbranch_scc1 L_pf_5
s_load_dwordx2 s[4:5], s[0:1], 0
s_sub_u32 s25, s24, 92
s_mul_i32 s25, s25, 131072
s_add_u32 s25, s25, 0
s_min_u32 s25, s25, 2359296
s_sub_u32 s98, 2359296, s25
s_mov_b32 s100, 0xfffe0000
s_branch L_pfd
L_pf_5:
s_cmp_ge_u32 s24, 146
s_cbranch_scc1 L_pf_6
s_load_dwordx2 s[4:5], s[0:1], 16
s_sub_u32 s25, s24, 110
s_mul_i32 s25, s25, 131072
s_add_u32 s25, s25, 0
s_min_u32 s25, s25, 4718592
s_sub_u32 s98, 4718592, s25
s_mov_b32 s100, 0xfffe0000
s_branch L_pfd
L_pf_6:
s_load_dwordx2 s[4:5], s[0:1], 40
s_sub_u32 s25, s24, 146
s_mul_i32 s25, s25, 131072
s_add_u32 s25, s25, 0
s_min_u32 s25, s25, 4718592
s_sub_u32 s98, 4718592, s25
s_mov_b32 s100, 0xfffe0000
s_branch L_pfd
L_pf_7:
L_pfd:
s_min_u32 s98, s98, 131072
s_waitcnt lgkmcnt(0)
s_add_u32 s96, s4, s25
s_addc_u32 s5, s5, 0
s_and_b32 s97, s5, 0xffff
s_mov_b32 s99, 0x20000
s_cmp_eq_u32 s3, 1
s_cselect_b32 s100, 536870912, s100
v_lshlrev_b32 v14, 6, v0
s_cmp_eq_u32 s3, 1
s_cselect_b32 s91, 1, 0
s_andn2_b32 s95, s61, s16
v_bfe_u32 v16, v0, 4, 3
v_bfe_u32 v17, v0, 7, 1
v_lshlrev_b32 v17, 2, v17
v_xor_b32 v16, v16, v17
v_and_b32 v17, 7, v0
v_xor_b32 v16, v16, v17
v_lshlrev_b32 v1, 4, v16
v_bfe_u32 v17, v0, 4, 2
v_lshlrev_b32 v16, 2, v17
v_and_b32 v18, 15, v0
v_xor_b32 v16, v16, v18
v_bfe_u32 v18, v0, 6, 1
v_xor_b32 v16, v16, v18
v_lshlrev_b32 v16, 4, v16
v_lshl_add_u32 v16, v17, 13, v16
v_lshl_add_u32 v2, v18, 16, v16
s_and_b32 s24, s17, 1
s_lshr_b32 s25, s17, 1
s_lshl_b32 s25, s25, 13
s_lshl_b32 s33, s24, 11
s_add_u32 s33, s33, s25
s_lshl_b32 s32, s17, 10
s_add_u32 s32, s32, 65536
v_bfe_u32 v16, v0, 3, 1
v_lshlrev_b32 v16, 11, v16
v_and_b32 v18, 7, v0
v_lshl_add_u32 v16, v18, 7, v16
v_bfe_u32 v18, v0, 1, 3
v_xor_b32 v18, v18, v17
v_lshl_add_u32 v16, v18, 4, v16
s_lshl_b32 s24, s24, 14
s_add_u32 s24, s24, 65536
v_add_u32 v3, s24, v16
v_xor_b32 v4, 64, v3
v_bfe_u32 v18, v0, 2, 2
v_mul_u32_u24 v16, 320, v18
v_lshl_add_u32 v16, v17, 11, v16
v_bfe_u32 v18, v0, 1, 1
v_lshl_add_u32 v16, v18, 5, v16
v_bfe_u32 v18, v0, 4, 1
v_lshl_add_u32 v16, v18, 4, v16
v_and_b32 v18, 1, v0
v_lshl_add_u32 v16, v18, 3, v16
v_add_u32 v5, s25, v16
v_xor_b32 v6, 16, v5
v_xor_b32 v7, 64, v5
v_xor_b32 v8, 80, v5
v_xor_b32 v9, 128, v5
v_xor_b32 v10, 144, v5
v_xor_b32 v11, 192, v5
v_xor_b32 v12, 208, v5
s_mov_b32 s35, 0
s_lshr_b32 s24, s16, 1
s_cmp_eq_u32 s35, 5
s_cselect_b32 s90, s24, s90
s_lshl_b32 s24, s35, 2
s_lshr_b32 s26, s88, s24
s_bfe_u32 s2, s26, 0x10003
s_and_b32 s26, s26, 7
s_or_b32 s40, s2, s61
s_lshr_b32 s24, s17, 1
s_cmp_eq_u32 s2, 0
s_cselect_b32 s41, s24, 0
s_cselect_b32 s27, s89, s90
s_sub_u32 s25, s24, s41
s_and_b32 s51, s41, s61
s_lshl_b32 s51, s51, 1
s_or_b32 s51, s51, s41
s_lshl2_add_u32 s51, s2, s51
s_lshl_b32 s46, s27, s2
s_add_u32 s46, s46, s25
s_lshl_b32 s46, s46, 8
s_lshl_b32 s47, s40, 7
s_add_u32 s47, s47, 1024
s_mul_i32 s101, s26, s47
s_lshl_b32 s101, s101, 8
s_and_b32 s25, s17, 1
s_lshl1_add_u32 s42, s26, s25
s_lshl_b32 s42, s42, 7
s_lshr_b32 s42, s42, s2
s_add_u32 s42, s42, s27
s_lshl1_add_u32 s42, s42, s24
s_lshl_b32 s42, s42, 13
s_lshl_b32 s43, s27, 5
s_add_u32 s43, s43, s26
s_lshl_b32 s43, s43, 2
s_lshl_b32 s24, s2, 1
s_add_u32 s24, s24, s61
s_lshl_b32 s24, s24, 2
s_lshr_b32 s25, 0x8720, s24
s_and_b32 s25, s25, 15
s_lshl_b32 s25, s25, 24
s_add_u32 s42, s42, s25
s_lshr_b32 s25, 0x7604, s24
s_and_b32 s25, s25, 15
s_lshl_b32 s25, s25, 12
s_add_u32 s43, s43, s25
s_add_u32 s43, s43, 111149056
s_cmp_lt_u32 s35, s45
s_cselect_b32 s101, s101, 536870912
s_cselect_b32 s46, s46, 536870912
s_cmp_eq_u32 s2, 0
s_cselect_b64 s[4:5], s[52:53], s[54:55]
s_mov_b32 s12, s4
s_and_b32 s13, s5, 0xffff
s_lshl_b32 s14, s47, 11
s_mov_b32 s15, 0x20000
s_mov_b32 s30, s101
v_lshrrev_b32 v16, 3, v0
v_mul_lo_u32 v16, v16, s47
v_and_b32 v1, 0x70, v1
v_add_u32 v1, v1, v16
s_lshl_b32 s34, s47, 5
s_cmp_eq_u32 s2, 0
s_cselect_b64 s[4:5], s[6:7], s[18:19]
s_mov_b32 s20, s4
s_and_b32 s21, s5, 0xffff
s_lshl_b32 s22, s47, 12
s_mov_b32 s23, 0x20000
s_mov_b32 s31, s46
s_mov_b32 s48, s30
s_add_u32 m0, s32, 0
s_nop 0
buffer_load_dwordx4 v1, s[12:15], s48 offen lds
s_add_u32 s48, s48, s34
s_add_u32 m0, s32, 4096
s_nop 0
buffer_load_dwordx4 v1, s[12:15], s48 offen lds
s_add_u32 s48, s48, s34
s_add_u32 m0, s32, 8192
s_nop 0
buffer_load_dwordx4 v1, s[12:15], s48 offen lds
s_add_u32 s48, s48, s34
s_add_u32 m0, s32, 12288
s_nop 0
buffer_load_dwordx4 v1, s[12:15], s48 offen lds
s_add_u32 s48, s48, s34
s_add_u32 m0, s32, 16384
s_nop 0
buffer_load_dwordx4 v1, s[12:15], s48 offen lds
s_add_u32 s48, s48, s34
s_add_u32 m0, s32, 20480
s_nop 0
buffer_load_dwordx4 v1, s[12:15], s48 offen lds
s_add_u32 s48, s48, s34
s_add_u32 m0, s32, 24576
s_nop 0
buffer_load_dwordx4 v1, s[12:15], s48 offen lds
s_add_u32 s48, s48, s34
s_add_u32 m0, s32, 28672
s_nop 0
buffer_load_dwordx4 v1, s[12:15], s48 offen lds
s_add_u32 s30, s30, 128
s_add_u32 s32, s32, 32768
s_sub_u32 s48, s32, 98304
s_cmp_ge_u32 s32, 163840
s_cselect_b32 s32, s48, s32
s_add_u32 s37, s31, 0
s_add_u32 m0, s33, 0
s_nop 0
buffer_load_dwordx4 v2, s[20:23], s37 offen  lds
s_add_u32 s37, s31, 32768
s_add_u32 m0, s33, 1024
s_nop 0
buffer_load_dwordx4 v2, s[20:23], s37 offen  lds
s_add_u32 s37, s31, 131072
s_add_u32 m0, s33, 4096
s_nop 0
buffer_load_dwordx4 v2, s[20:23], s37 offen  lds
s_add_u32 s37, s31, 163840
s_add_u32 m0, s33, 5120
s_nop 0
buffer_load_dwordx4 v2, s[20:23], s37 offen  lds
s_add_u32 s31, s31, 262144
s_add_u32 s33, s33, 16384
s_and_b32 s33, s33, 65535
s_add_u32 s37, s31, 0
s_add_u32 m0, s33, 0
s_nop 0
buffer_load_dwordx4 v2, s[20:23], s37 offen  lds
s_add_u32 s37, s31, 32768
s_add_u32 m0, s33, 1024
s_nop 0
buffer_load_dwordx4 v2, s[20:23], s37 offen  lds
s_add_u32 s37, s31, 131072
s_add_u32 m0, s33, 4096
s_nop 0
buffer_load_dwordx4 v2, s[20:23], s37 offen  lds
s_add_u32 s37, s31, 163840
s_add_u32 m0, s33, 5120
s_nop 0
buffer_load_dwordx4 v2, s[20:23], s37 offen  lds
s_add_u32 s31, s31, 262144
s_add_u32 s33, s33, 16384
s_and_b32 s33, s33, 65535
s_mov_b32 s48, s30
s_add_u32 m0, s32, 0
s_nop 0
buffer_load_dwordx4 v1, s[12:15], s48 offen lds
s_add_u32 s48, s48, s34
s_add_u32 m0, s32, 4096
s_nop 0
buffer_load_dwordx4 v1, s[12:15], s48 offen lds
s_add_u32 s48, s48, s34
s_add_u32 m0, s32, 8192
s_nop 0
buffer_load_dwordx4 v1, s[12:15], s48 offen lds
s_add_u32 s48, s48, s34
s_add_u32 m0, s32, 12288
s_nop 0
buffer_load_dwordx4 v1, s[12:15], s48 offen lds
s_add_u32 s37, s31, 0
s_add_u32 m0, s33, 0
s_nop 0
buffer_load_dwordx4 v2, s[20:23], s37 offen  lds
s_add_u32 s37, s31, 32768
s_add_u32 m0, s33, 1024
s_nop 0
buffer_load_dwordx4 v2, s[20:23], s37 offen  lds
s_add_u32 s37, s31, 131072
s_add_u32 m0, s33, 4096
s_nop 0
buffer_load_dwordx4 v2, s[20:23], s37 offen  lds
s_add_u32 s37, s31, 163840
s_add_u32 m0, s33, 5120
s_nop 0
buffer_load_dwordx4 v2, s[20:23], s37 offen  lds
s_add_u32 s31, s31, 262144
s_add_u32 s33, s33, 16384
s_and_b32 s33, s33, 65535
s_add_u32 s48, s48, s34
s_add_u32 m0, s32, 16384
s_nop 0
buffer_load_dwordx4 v1, s[12:15], s48 offen lds
s_add_u32 s48, s48, s34
s_add_u32 m0, s32, 20480
s_nop 0
buffer_load_dwordx4 v1, s[12:15], s48 offen lds
s_add_u32 s48, s48, s34
s_add_u32 m0, s32, 24576
s_nop 0
buffer_load_dwordx4 v1, s[12:15], s48 offen lds
s_add_u32 s48, s48, s34
s_add_u32 m0, s32, 28672
s_nop 0
buffer_load_dwordx4 v1, s[12:15], s48 offen lds
s_add_u32 s30, s30, 128
s_add_u32 s32, s32, 32768
s_sub_u32 s48, s32, 98304
s_cmp_ge_u32 s32, 163840
s_cselect_b32 s32, s48, s32
s_add_u32 s37, s31, 0
s_add_u32 m0, s33, 0
s_nop 0
buffer_load_dwordx4 v2, s[20:23], s37 offen  lds
s_add_u32 s37, s31, 32768
s_add_u32 m0, s33, 1024
s_nop 0
buffer_load_dwordx4 v2, s[20:23], s37 offen  lds
s_add_u32 s37, s31, 131072
s_add_u32 m0, s33, 4096
s_nop 0
buffer_load_dwordx4 v2, s[20:23], s37 offen  lds
s_add_u32 s37, s31, 163840
s_add_u32 m0, s33, 5120
s_nop 0
buffer_load_dwordx4 v2, s[20:23], s37 offen  lds
s_add_u32 s31, s31, 262144
s_add_u32 s33, s33, 16384
s_and_b32 s33, s33, 65535
s_mov_b32 s48, s30
s_add_u32 m0, s32, 0
s_nop 0
buffer_load_dwordx4 v1, s[12:15], s48 offen lds
s_add_u32 s48, s48, s34
s_add_u32 m0, s32, 4096
s_nop 0
buffer_load_dwordx4 v1, s[12:15], s48 offen lds
s_add_u32 s48, s48, s34
s_add_u32 m0, s32, 8192
s_nop 0
buffer_load_dwordx4 v1, s[12:15], s48 offen lds
s_add_u32 s48, s48, s34
s_add_u32 m0, s32, 12288
s_nop 0
buffer_load_dwordx4 v1, s[12:15], s48 offen lds
s_mov_b32 s62, 536870912
s_mov_b32 s63, 536870912
s_mov_b32 s50, 0
s_waitcnt vmcnt(24)
s_barrier
s_cmp_eq_u32 s41, 0
s_cbranch_scc0 L_g_p1
ds_read_b64_tr_b16 a[160:161], v5 offset:0
ds_read_b64_tr_b16 a[162:163], v5 offset:1024
ds_read_b64_tr_b16 a[164:165], v6 offset:0
ds_read_b64_tr_b16 a[166:167], v6 offset:1024
ds_read_b64_tr_b16 a[168:169], v7 offset:0
ds_read_b64_tr_b16 a[170:171], v7 offset:1024
ds_read_b64_tr_b16 a[172:173], v8 offset:0
ds_read_b64_tr_b16 a[174:175], v8 offset:1024
ds_read_b64_tr_b16 a[176:177], v9 offset:0
ds_read_b64_tr_b16 a[178:179], v9 offset:1024
ds_read_b64_tr_b16 a[180:181], v10 offset:0
ds_read_b64_tr_b16 a[182:183], v10 offset:1024
ds_read_b64_tr_b16 a[184:185], v11 offset:0
ds_read_b64_tr_b16 a[186:187], v11 offset:1024
ds_read_b64_tr_b16 a[188:189], v12 offset:0
ds_read_b64_tr_b16 a[190:191], v12 offset:1024
ds_read_b128 a[192:195], v3 offset:0
ds_read_b128 a[196:199], v4 offset:1024
ds_read_b128 a[200:203], v3 offset:4096
ds_read_b128 a[204:207], v4 offset:5120
ds_read_b128 a[208:211], v3 offset:8192
ds_read_b128 a[212:215], v4 offset:9216
ds_read_b128 a[216:219], v3 offset:12288
ds_read_b128 a[220:223], v4 offset:13312
s_branch L_g_p2
L_g_p1:
ds_read_b128 a[160:163], v3 offset:0
ds_read_b128 a[164:167], v4 offset:1024
ds_read_b128 a[168:171], v3 offset:4096
ds_read_b128 a[172:175], v4 offset:5120
ds_read_b128 a[176:179], v3 offset:8192
ds_read_b128 a[180:183], v4 offset:9216
ds_read_b128 a[184:187], v3 offset:12288
ds_read_b128 a[188:191], v4 offset:13312
ds_read_b64_tr_b16 a[192:193], v5 offset:0
ds_read_b64_tr_b16 a[194:195], v5 offset:1024
ds_read_b64_tr_b16 a[196:197], v6 offset:0
ds_read_b64_tr_b16 a[198:199], v6 offset:1024
ds_read_b64_tr_b16 a[200:201], v7 offset:0
ds_read_b64_tr_b16 a[202:203], v7 offset:1024
ds_read_b64_tr_b16 a[204:205], v8 offset:0
ds_read_b64_tr_b16 a[206:207], v8 offset:1024
ds_read_b64_tr_b16 a[208:209], v9 offset:0
ds_read_b64_tr_b16 a[210:211], v9 offset:1024
ds_read_b64_tr_b16 a[212:213], v10 offset:0
ds_read_b64_tr_b16 a[214:215], v10 offset:1024
ds_read_b64_tr_b16 a[216:217], v11 offset:0
ds_read_b64_tr_b16 a[218:219], v11 offset:1024
ds_read_b64_tr_b16 a[220:221], v12 offset:0
ds_read_b64_tr_b16 a[222:223], v12 offset:1024
L_g_p2:
v_add_u32 v5, 16384, v5
v_and_b32 v5, 65535, v5
v_xor_b32 v6, 16, v5
v_xor_b32 v7, 64, v5
v_xor_b32 v8, 80, v5
v_xor_b32 v9, 128, v5
v_xor_b32 v10, 144, v5
v_xor_b32 v11, 192, v5
v_xor_b32 v12, 208, v5
L_g_tile:
s_cmp_eq_u32 s35, 1
s_cbranch_scc1 L_g_first
L_g_go:
s_cmp_eq_u32 s41, 0
s_cbranch_scc0 L_g_v
.p2align 3
L_g_k:
s_waitcnt vmcnt(16) lgkmcnt(0)
s_barrier
v_mfma_f32_16x16x32_bf16 v[160:163], a[160:163], a[192:195], 0
ds_read_b128 a[224:227], v4 offset:0
v_accvgpr_read_b32 v20, a64
v_accvgpr_read_b32 v21, a65
v_accvgpr_read_b32 v22, a66
v_mfma_f32_16x16x32_bf16 v[164:167], a[160:163], a[196:199], 0
s_add_u32 s37, s31, 0
v_accvgpr_read_b32 v23, a67
v_cvt_pk_bf16_f32 v98, v20, v21
v_cvt_pk_bf16_f32 v99, v22, v23
v_accvgpr_read_b32 v24, a68
v_mfma_f32_16x16x32_bf16 v[168:171], a[160:163], a[200:203], 0
s_add_u32 m0, s33, 0
ds_read_b128 a[228:231], v3 offset:1024
v_accvgpr_read_b32 v25, a69
v_accvgpr_read_b32 v26, a70
v_accvgpr_read_b32 v27, a71
v_mfma_f32_16x16x32_bf16 v[172:175], a[160:163], a[204:207], 0
buffer_load_dwordx4 v2, s[20:23], s37 offen  lds
v_cvt_pk_bf16_f32 v102, v24, v25
v_cvt_pk_bf16_f32 v103, v26, v27
v_accvgpr_read_b32 v20, a72
v_mfma_f32_16x16x32_bf16 v[176:179], a[160:163], a[208:211], 0
ds_read_b128 a[232:235], v4 offset:4096
v_accvgpr_read_b32 v21, a73
v_accvgpr_read_b32 v22, a74
v_accvgpr_read_b32 v23, a75
v_mfma_f32_16x16x32_bf16 v[180:183], a[160:163], a[212:215], 0
v_cvt_pk_bf16_f32 v106, v20, v21
v_cvt_pk_bf16_f32 v107, v22, v23
v_accvgpr_read_b32 v24, a76
v_accvgpr_read_b32 v25, a77
v_mfma_f32_16x16x32_bf16 v[184:187], a[160:163], a[216:219], 0
ds_read_b128 a[236:239], v3 offset:5120
v_accvgpr_read_b32 v26, a78
v_accvgpr_read_b32 v27, a79
v_cvt_pk_bf16_f32 v110, v24, v25
v_mfma_f32_16x16x32_bf16 v[188:191], a[160:163], a[220:223], 0
ds_read_b64_tr_b16 a[160:161], v5 offset:0
v_cvt_pk_bf16_f32 v111, v26, v27
v_accvgpr_read_b32 v20, a80
v_accvgpr_read_b32 v21, a81
v_mfma_f32_16x16x32_bf16 v[192:195], a[164:167], a[192:195], 0
s_add_u32 s37, s31, 32768
ds_read_b64_tr_b16 a[162:163], v5 offset:1024
v_accvgpr_read_b32 v22, a82
v_accvgpr_read_b32 v23, a83
v_cvt_pk_bf16_f32 v114, v20, v21
v_mfma_f32_16x16x32_bf16 v[196:199], a[164:167], a[196:199], 0
s_add_u32 m0, s33, 1024
ds_read_b128 a[240:243], v4 offset:8192
v_add_u32 v5, 16384, v5
v_cvt_pk_bf16_f32 v115, v22, v23
v_accvgpr_read_b32 v24, a84
v_mfma_f32_16x16x32_bf16 v[200:203], a[164:167], a[200:203], 0
buffer_load_dwordx4 v2, s[20:23], s37 offen  lds
v_and_b32 v5, 65535, v5
v_accvgpr_read_b32 v25, a85
v_accvgpr_read_b32 v26, a86
v_mfma_f32_16x16x32_bf16 v[204:207], a[164:167], a[204:207], 0
ds_read_b128 a[244:247], v3 offset:9216
v_accvgpr_read_b32 v27, a87
v_cvt_pk_bf16_f32 v118, v24, v25
v_cvt_pk_bf16_f32 v119, v26, v27
v_mfma_f32_16x16x32_bf16 v[208:211], a[164:167], a[208:211], 0
v_accvgpr_read_b32 v20, a88
v_accvgpr_read_b32 v21, a89
v_accvgpr_read_b32 v22, a90
v_accvgpr_read_b32 v23, a91
v_mfma_f32_16x16x32_bf16 v[212:215], a[164:167], a[212:215], 0
ds_read_b128 a[248:251], v4 offset:12288
v_cvt_pk_bf16_f32 v122, v20, v21
v_cvt_pk_bf16_f32 v123, v22, v23
v_accvgpr_read_b32 v24, a92
v_mfma_f32_16x16x32_bf16 v[216:219], a[164:167], a[216:219], 0
v_accvgpr_read_b32 v25, a93
v_accvgpr_read_b32 v26, a94
v_accvgpr_read_b32 v27, a95
v_cvt_pk_bf16_f32 v126, v24, v25
v_mfma_f32_16x16x32_bf16 v[220:223], a[164:167], a[220:223], 0
s_add_u32 s37, s31, 131072
ds_read_b64_tr_b16 a[164:165], v6 offset:0
v_cvt_pk_bf16_f32 v127, v26, v27
v_accvgpr_read_b32 v20, a96
v_accvgpr_read_b32 v21, a97
v_mfma_f32_16x16x32_bf16 v[224:227], a[168:171], a[192:195], 0
s_add_u32 m0, s33, 4096
ds_read_b64_tr_b16 a[166:167], v6 offset:1024
v_accvgpr_read_b32 v22, a98
v_accvgpr_read_b32 v23, a99
v_cvt_pk_bf16_f32 v128, v20, v21
v_mfma_f32_16x16x32_bf16 v[228:231], a[168:171], a[196:199], 0
buffer_load_dwordx4 v2, s[20:23], s37 offen  lds
v_xor_b32 v6, 16, v5
v_cvt_pk_bf16_f32 v129, v22, v23
v_accvgpr_read_b32 v24, a100
v_mfma_f32_16x16x32_bf16 v[232:235], a[168:171], a[200:203], 0
ds_read_b128 a[252:255], v3 offset:13312
v_accvgpr_read_b32 v25, a101
v_accvgpr_read_b32 v26, a102
v_accvgpr_read_b32 v27, a103
v_mfma_f32_16x16x32_bf16 v[236:239], a[168:171], a[204:207], 0
v_cvt_pk_bf16_f32 v132, v24, v25
v_cvt_pk_bf16_f32 v133, v26, v27
v_accvgpr_read_b32 v20, a104
v_accvgpr_read_b32 v21, a105
v_mfma_f32_16x16x32_bf16 v[240:243], a[168:171], a[208:211], 0
ds_read_b64_tr_b16 v[28:29], v12 offset:0
v_accvgpr_read_b32 v22, a106
v_accvgpr_read_b32 v23, a107
v_cvt_pk_bf16_f32 v136, v20, v21
v_mfma_f32_16x16x32_bf16 v[244:247], a[168:171], a[212:215], 0
v_cvt_pk_bf16_f32 v137, v22, v23
v_accvgpr_read_b32 v24, a108
v_accvgpr_read_b32 v25, a109
v_accvgpr_read_b32 v26, a110
v_mfma_f32_16x16x32_bf16 v[248:251], a[168:171], a[216:219], 0
s_add_u32 s37, s31, 163840
ds_read_b64_tr_b16 v[30:31], v12 offset:1024
v_accvgpr_read_b32 v27, a111
v_cvt_pk_bf16_f32 v140, v24, v25
v_cvt_pk_bf16_f32 v141, v26, v27
v_mfma_f32_16x16x32_bf16 v[252:255], a[168:171], a[220:223], 0
s_add_u32 m0, s33, 5120
ds_read_b64_tr_b16 a[168:169], v7 offset:0
v_accvgpr_read_b32 v20, a112
v_accvgpr_read_b32 v21, a113
v_accvgpr_read_b32 v22, a114
v_mfma_f32_16x16x32_bf16 a[0:3], a[172:175], a[192:195], 0
buffer_load_dwordx4 v2, s[20:23], s37 offen  lds
ds_read_b64_tr_b16 a[170:171], v7 offset:1024
v_accvgpr_read_b32 v23, a115
v_cvt_pk_bf16_f32 v144, v20, v21
v_mfma_f32_16x16x32_bf16 a[4:7], a[172:175], a[196:199], 0
s_add_u32 s31, s31, 262144
v_xor_b32 v7, 64, v5
v_xor_b32 v12, 208, v5
v_cvt_pk_bf16_f32 v145, v22, v23
v_accvgpr_read_b32 v24, a116
v_mfma_f32_16x16x32_bf16 a[8:11], a[172:175], a[200:203], 0
s_add_u32 s33, s33, 16384
v_add_u32 v3, 32768, v3
v_accvgpr_read_b32 v25, a117
v_accvgpr_read_b32 v26, a118
v_accvgpr_read_b32 v27, a119
v_mfma_f32_16x16x32_bf16 a[12:15], a[172:175], a[204:207], 0
s_and_b32 s33, s33, 65535
v_subrev_u32 v19, 98304, v3
v_cvt_pk_bf16_f32 v148, v24, v25
v_cvt_pk_bf16_f32 v149, v26, v27
v_accvgpr_read_b32 v20, a120
v_mfma_f32_16x16x32_bf16 a[16:19], a[172:175], a[208:211], 0
v_cmp_le_u32 vcc, 163840, v3
v_accvgpr_read_b32 v21, a121
v_accvgpr_read_b32 v22, a122
v_accvgpr_read_b32 v23, a123
v_mfma_f32_16x16x32_bf16 a[20:23], a[172:175], a[212:215], 0
s_add_u32 s48, s48, s34
v_cndmask_b32 v3, v3, v19, vcc
v_cvt_pk_bf16_f32 v152, v20, v21
v_cvt_pk_bf16_f32 v153, v22, v23
v_accvgpr_read_b32 v24, a124
v_mfma_f32_16x16x32_bf16 a[24:27], a[172:175], a[216:219], 0
s_add_u32 m0, s32, 16384
v_xor_b32 v4, 64, v3
v_accvgpr_read_b32 v25, a125
v_accvgpr_read_b32 v26, a126
v_accvgpr_read_b32 v27, a127
v_mfma_f32_16x16x32_bf16 a[28:31], a[172:175], a[220:223], 0
buffer_load_dwordx4 v1, s[12:15], s48 offen lds
ds_read_b64_tr_b16 a[172:173], v8 offset:0
v_cvt_pk_bf16_f32 v156, v24, v25
v_cvt_pk_bf16_f32 v157, v26, v27
v_mfma_f32_16x16x32_bf16 a[32:35], a[176:179], a[192:195], 0
ds_read_b64_tr_b16 a[174:175], v8 offset:1024
v_accvgpr_read_b32 v20, a128
v_accvgpr_read_b32 v21, a129
v_accvgpr_read_b32 v22, a130
v_mfma_f32_16x16x32_bf16 a[36:39], a[176:179], a[196:199], 0
v_xor_b32 v8, 80, v5
v_accvgpr_read_b32 v23, a131
v_cvt_pk_bf16_f32 v130, v20, v21
v_cvt_pk_bf16_f32 v131, v22, v23
v_mfma_f32_16x16x32_bf16 a[40:43], a[176:179], a[200:203], 0
v_accvgpr_read_b32 v24, a132
v_accvgpr_read_b32 v25, a133
v_accvgpr_read_b32 v26, a134
v_accvgpr_read_b32 v27, a135
v_mfma_f32_16x16x32_bf16 a[44:47], a[176:179], a[204:207], 0
v_cvt_pk_bf16_f32 v134, v24, v25
v_cvt_pk_bf16_f32 v135, v26, v27
v_accvgpr_read_b32 v20, a136
v_accvgpr_read_b32 v21, a137
v_mfma_f32_16x16x32_bf16 a[48:51], a[176:179], a[208:211], 0
s_add_u32 s48, s48, s34
v_accvgpr_read_b32 v22, a138
v_accvgpr_read_b32 v23, a139
v_cvt_pk_bf16_f32 v138, v20, v21
v_cvt_pk_bf16_f32 v139, v22, v23
s_mov_b32 s38, s62
s_mov_b32 s39, s63
v_mfma_f32_16x16x32_bf16 a[52:55], a[176:179], a[212:215], 0
s_add_u32 m0, s32, 20480
v_accvgpr_read_b32 v24, a140
v_accvgpr_read_b32 v25, a141
v_accvgpr_read_b32 v26, a142
v_accvgpr_read_b32 v27, a143
s_mov_b32 s49, s50
s_mov_b32 s62, s42
v_mfma_f32_16x16x32_bf16 a[56:59], a[176:179], a[216:219], 0
buffer_load_dwordx4 v1, s[12:15], s48 offen lds
v_cvt_pk_bf16_f32 v142, v24, v25
v_cvt_pk_bf16_f32 v143, v26, v27
v_accvgpr_read_b32 v20, a144
s_mov_b32 s63, s43
s_mov_b32 s50, s51
v_mfma_f32_16x16x32_bf16 a[60:63], a[176:179], a[220:223], 0
ds_read_b64_tr_b16 a[176:177], v9 offset:0
v_accvgpr_read_b32 v21, a145
v_accvgpr_read_b32 v22, a146
v_accvgpr_read_b32 v23, a147
s_mov_b32 s36, s40
s_add_u32 s35, s35, 1
v_mfma_f32_16x16x32_bf16 a[64:67], a[180:183], a[192:195], 0
ds_read_b64_tr_b16 a[178:179], v9 offset:1024
v_cvt_pk_bf16_f32 v146, v20, v21
v_cvt_pk_bf16_f32 v147, v22, v23
v_accvgpr_read_b32 v24, a148
v_bfe_u32 v16, v0, 3, 3
v_lshlrev_b32 v16, 4, v16
v_mfma_f32_16x16x32_bf16 a[68:71], a[180:183], a[196:199], 0
v_xor_b32 v9, 128, v5
v_accvgpr_read_b32 v25, a149
v_accvgpr_read_b32 v26, a150
v_accvgpr_read_b32 v27, a151
v_and_or_b32 v16, v0, 7, v16
v_bfe_u32 v17, v0, 4, 2
v_mfma_f32_16x16x32_bf16 a[72:75], a[180:183], a[200:203], 0
v_cvt_pk_bf16_f32 v150, v24, v25
v_cvt_pk_bf16_f32 v151, v26, v27
v_accvgpr_read_b32 v20, a152
v_accvgpr_read_b32 v21, a153
v_lshlrev_b32 v17, 5, v17
v_bfe_u32 v18, v0, 1, 3
v_mfma_f32_16x16x32_bf16 a[76:79], a[180:183], a[204:207], 0
s_add_u32 s48, s48, s34
v_accvgpr_read_b32 v22, a154
v_accvgpr_read_b32 v23, a155
v_cvt_pk_bf16_f32 v154, v20, v21
v_cvt_pk_bf16_f32 v155, v22, v23
v_or_b32 v17, v17, v18
v_and_b32 v18, 1, v0
v_mfma_f32_16x16x32_bf16 a[80:83], a[180:183], a[208:211], 0
s_add_u32 m0, s32, 24576
v_accvgpr_read_b32 v24, a156
v_accvgpr_read_b32 v25, a157
v_accvgpr_read_b32 v26, a158
v_accvgpr_read_b32 v27, a159
v_lshl_or_b32 v17, v18, 4, v17
v_mfma_f32_16x16x32_bf16 a[84:87], a[180:183], a[212:215], 0
buffer_load_dwordx4 v1, s[12:15], s48 offen lds
v_cvt_pk_bf16_f32 v158, v24, v25
v_cvt_pk_bf16_f32 v159, v26, v27
s_bitcmp1_b32 s49, 1
s_cselect_b64 vcc, -1, 0
s_movk_i32 s44, 0x80
v_mfma_f32_16x16x32_bf16 a[88:91], a[180:183], a[216:219], 0
v_cndmask_b32 v16, v16, v17, vcc
v_lshlrev_b32 v13, 4, v16
s_lshr_b32 s93, s49, 2
s_lshr_b32 s93, 0x80000, s93
v_mfma_f32_16x16x32_bf16 a[92:95], a[180:183], a[220:223], 0
ds_read_b64_tr_b16 a[180:181], v10 offset:0
s_bitcmp1_b32 s49, 0
s_cselect_b32 s92, s93, 0x800
s_cselect_b32 s93, 0x800, s93
s_sub_u32 s93, s93, s44
v_mfma_f32_16x16x32_bf16 a[96:99], a[184:187], a[192:195], 0
ds_read_b64_tr_b16 a[182:183], v10 offset:1024
v_mfma_f32_16x16x32_bf16 a[100:103], a[184:187], a[196:199], 0
v_xor_b32 v10, 144, v5
v_mfma_f32_16x16x32_bf16 a[104:107], a[184:187], a[200:203], 0
s_add_u32 s48, s48, s34
v_mfma_f32_16x16x32_bf16 a[108:111], a[184:187], a[204:207], 0
s_add_u32 m0, s32, 28672
v_mfma_f32_16x16x32_bf16 a[112:115], a[184:187], a[208:211], 0
buffer_load_dwordx4 v1, s[12:15], s48 offen lds
v_mfma_f32_16x16x32_bf16 a[116:119], a[184:187], a[212:215], 0
s_add_u32 s30, s30, 128
v_mfma_f32_16x16x32_bf16 a[120:123], a[184:187], a[216:219], 0
s_add_u32 s32, s32, 32768
v_mfma_f32_16x16x32_bf16 a[124:127], a[184:187], a[220:223], 0
s_sub_u32 s48, s32, 98304
ds_read_b64_tr_b16 a[184:185], v11 offset:0
v_mfma_f32_16x16x32_bf16 a[128:131], a[188:191], a[192:195], 0
s_cmp_ge_u32 s32, 163840
s_cselect_b32 s32, s48, s32
ds_read_b64_tr_b16 a[186:187], v11 offset:1024
v_mfma_f32_16x16x32_bf16 a[132:135], a[188:191], a[196:199], 0
v_xor_b32 v11, 192, v5
v_mfma_f32_16x16x32_bf16 a[136:139], a[188:191], a[200:203], 0
buffer_load_dword v15, v14, s[96:99], s100 offen
v_mfma_f32_16x16x32_bf16 a[140:143], a[188:191], a[204:207], 0
s_add_u32 s100, s100, 16384
v_mfma_f32_16x16x32_bf16 a[144:147], a[188:191], a[208:211], 0
v_mfma_f32_16x16x32_bf16 a[148:151], a[188:191], a[212:215], 0
v_mfma_f32_16x16x32_bf16 a[152:155], a[188:191], a[216:219], 0
v_mfma_f32_16x16x32_bf16 a[156:159], a[188:191], a[220:223], 0
s_waitcnt vmcnt(17) lgkmcnt(0)
s_barrier
v_mfma_f32_16x16x32_bf16 v[160:163], a[160:163], a[224:227], v[160:163]
ds_read_b128 a[192:195], v3 offset:0
v_mfma_f32_16x16x32_bf16 v[164:167], a[160:163], a[228:231], v[164:167]
s_add_u32 s37, s31, 0
v_mfma_f32_16x16x32_bf16 v[168:171], a[160:163], a[232:235], v[168:171]
s_add_u32 m0, s33, 0
ds_read_b128 a[196:199], v4 offset:1024
v_mfma_f32_16x16x32_bf16 v[172:175], a[160:163], a[236:239], v[172:175]
buffer_load_dwordx4 v2, s[20:23], s37 offen  lds
v_mfma_f32_16x16x32_bf16 v[176:179], a[160:163], a[240:243], v[176:179]
s_mov_b32 s60, s38
ds_read_b128 a[200:203], v3 offset:4096
v_mfma_f32_16x16x32_bf16 v[180:183], a[160:163], a[244:247], v[180:183]
s_mov_b32 s29, s38
v_mfma_f32_16x16x32_bf16 v[184:187], a[160:163], a[248:251], v[184:187]
buffer_store_dwordx4 v[32:35], v13, s[8:11], s29 offen sc1
v_mfma_f32_16x16x32_bf16 v[188:191], a[160:163], a[252:255], v[188:191]
ds_read_b64_tr_b16 a[160:161], v5 offset:0
v_mfma_f32_16x16x32_bf16 v[192:195], a[164:167], a[224:227], v[192:195]
s_add_u32 s37, s31, 32768
ds_read_b64_tr_b16 a[162:163], v5 offset:1024
v_mfma_f32_16x16x32_bf16 v[196:199], a[164:167], a[228:231], v[196:199]
s_add_u32 m0, s33, 1024
ds_read_b128 a[204:207], v4 offset:5120
v_add_u32 v5, 16384, v5
v_mfma_f32_16x16x32_bf16 v[200:203], a[164:167], a[232:235], v[200:203]
buffer_load_dwordx4 v2, s[20:23], s37 offen  lds
v_and_b32 v5, 65535, v5
v_mfma_f32_16x16x32_bf16 v[204:207], a[164:167], a[236:239], v[204:207]
ds_read_b128 a[208:211], v3 offset:8192
v_mfma_f32_16x16x32_bf16 v[208:211], a[164:167], a[240:243], v[208:211]
v_mfma_f32_16x16x32_bf16 v[212:215], a[164:167], a[244:247], v[212:215]
ds_read_b128 a[212:215], v4 offset:9216
v_mfma_f32_16x16x32_bf16 v[216:219], a[164:167], a[248:251], v[216:219]
v_mfma_f32_16x16x32_bf16 v[220:223], a[164:167], a[252:255], v[220:223]
s_add_u32 s37, s31, 131072
ds_read_b64_tr_b16 a[164:165], v6 offset:0
v_mfma_f32_16x16x32_bf16 v[224:227], a[168:171], a[224:227], v[224:227]
s_add_u32 m0, s33, 4096
ds_read_b64_tr_b16 a[166:167], v6 offset:1024
v_mfma_f32_16x16x32_bf16 v[228:231], a[168:171], a[228:231], v[228:231]
buffer_load_dwordx4 v2, s[20:23], s37 offen  lds
v_xor_b32 v6, 16, v5
v_mfma_f32_16x16x32_bf16 v[232:235], a[168:171], a[232:235], v[232:235]
ds_read_b128 a[216:219], v3 offset:12288
v_mfma_f32_16x16x32_bf16 v[236:239], a[168:171], a[236:239], v[236:239]
v_mfma_f32_16x16x32_bf16 v[240:243], a[168:171], a[240:243], v[240:243]
ds_read_b128 a[220:223], v4 offset:13312
v_mfma_f32_16x16x32_bf16 v[244:247], a[168:171], a[244:247], v[244:247]
v_mfma_f32_16x16x32_bf16 v[248:251], a[168:171], a[248:251], v[248:251]
s_add_u32 s37, s31, 163840
ds_read_b64_tr_b16 a[188:189], v12 offset:0
v_mfma_f32_16x16x32_bf16 v[252:255], a[168:171], a[252:255], v[252:255]
s_add_u32 m0, s33, 5120
ds_read_b64_tr_b16 a[168:169], v7 offset:0
v_mfma_f32_16x16x32_bf16 a[0:3], a[172:175], a[224:227], a[0:3]
buffer_load_dwordx4 v2, s[20:23], s37 offen  lds
ds_read_b64_tr_b16 a[170:171], v7 offset:1024
v_mfma_f32_16x16x32_bf16 a[4:7], a[172:175], a[228:231], a[4:7]
s_add_u32 s31, s31, 262144
s_add_u32 s29, s29, s44
v_xor_b32 v7, 64, v5
v_mfma_f32_16x16x32_bf16 a[8:11], a[172:175], a[232:235], a[8:11]
s_add_u32 s33, s33, 16384
ds_read_b64_tr_b16 a[190:191], v12 offset:1024
v_mfma_f32_16x16x32_bf16 a[12:15], a[172:175], a[236:239], a[12:15]
s_and_b32 s33, s33, 65535
buffer_store_dwordx4 v[36:39], v13, s[8:11], s29 offen sc1
v_mfma_f32_16x16x32_bf16 a[16:19], a[172:175], a[240:243], a[16:19]
v_mfma_f32_16x16x32_bf16 a[20:23], a[172:175], a[244:247], a[20:23]
s_mov_b32 s48, s30
v_xor_b32 v12, 208, v5
v_mfma_f32_16x16x32_bf16 a[24:27], a[172:175], a[248:251], a[24:27]
s_add_u32 m0, s32, 0
v_mfma_f32_16x16x32_bf16 a[28:31], a[172:175], a[252:255], a[28:31]
buffer_load_dwordx4 v1, s[12:15], s48 offen lds
ds_read_b64_tr_b16 a[172:173], v8 offset:0
v_mfma_f32_16x16x32_bf16 a[32:35], a[176:179], a[224:227], a[32:35]
ds_read_b64_tr_b16 a[174:175], v8 offset:1024
v_mfma_f32_16x16x32_bf16 a[36:39], a[176:179], a[228:231], a[36:39]
v_xor_b32 v8, 80, v5
v_mfma_f32_16x16x32_bf16 a[40:43], a[176:179], a[232:235], a[40:43]
v_mfma_f32_16x16x32_bf16 a[44:47], a[176:179], a[236:239], a[44:47]
v_mfma_f32_16x16x32_bf16 a[48:51], a[176:179], a[240:243], a[48:51]
s_add_u32 s48, s48, s34
v_mfma_f32_16x16x32_bf16 a[52:55], a[176:179], a[244:247], a[52:55]
s_add_u32 m0, s32, 4096
v_mfma_f32_16x16x32_bf16 a[56:59], a[176:179], a[248:251], a[56:59]
buffer_load_dwordx4 v1, s[12:15], s48 offen lds
v_mfma_f32_16x16x32_bf16 a[60:63], a[176:179], a[252:255], a[60:63]
ds_read_b64_tr_b16 a[176:177], v9 offset:0
v_mfma_f32_16x16x32_bf16 a[64:67], a[180:183], a[224:227], a[64:67]
ds_read_b64_tr_b16 a[178:179], v9 offset:1024
v_mfma_f32_16x16x32_bf16 a[68:71], a[180:183], a[228:231], a[68:71]
v_xor_b32 v9, 128, v5
v_mfma_f32_16x16x32_bf16 a[72:75], a[180:183], a[232:235], a[72:75]
v_mfma_f32_16x16x32_bf16 a[76:79], a[180:183], a[236:239], a[76:79]
s_add_u32 s48, s48, s34
v_mfma_f32_16x16x32_bf16 a[80:83], a[180:183], a[240:243], a[80:83]
s_add_u32 m0, s32, 8192
v_mfma_f32_16x16x32_bf16 a[84:87], a[180:183], a[244:247], a[84:87]
buffer_load_dwordx4 v1, s[12:15], s48 offen lds
v_mfma_f32_16x16x32_bf16 a[88:91], a[180:183], a[248:251], a[88:91]
s_add_u32 s29, s29, s93
v_mfma_f32_16x16x32_bf16 a[92:95], a[180:183], a[252:255], a[92:95]
ds_read_b64_tr_b16 a[180:181], v10 offset:0
v_mfma_f32_16x16x32_bf16 a[96:99], a[184:187], a[224:227], a[96:99]
buffer_store_dwordx4 v[40:43], v13, s[8:11], s29 offen sc1
ds_read_b64_tr_b16 a[182:183], v10 offset:1024
v_mfma_f32_16x16x32_bf16 a[100:103], a[184:187], a[228:231], a[100:103]
v_xor_b32 v10, 144, v5
v_mfma_f32_16x16x32_bf16 a[104:107], a[184:187], a[232:235], a[104:107]
s_add_u32 s48, s48, s34
v_mfma_f32_16x16x32_bf16 a[108:111], a[184:187], a[236:239], a[108:111]
s_add_u32 m0, s32, 12288
v_mfma_f32_16x16x32_bf16 a[112:115], a[184:187], a[240:243], a[112:115]
buffer_load_dwordx4 v1, s[12:15], s48 offen lds
v_mfma_f32_16x16x32_bf16 a[116:119], a[184:187], a[244:247], a[116:119]
v_mfma_f32_16x16x32_bf16 a[120:123], a[184:187], a[248:251], a[120:123]
v_mfma_f32_16x16x32_bf16 a[124:127], a[184:187], a[252:255], a[124:127]
ds_read_b64_tr_b16 a[184:185], v11 offset:0
v_mfma_f32_16x16x32_bf16 a[128:131], v[28:31], a[224:227], a[128:131]
ds_read_b64_tr_b16 a[186:187], v11 offset:1024
v_mfma_f32_16x16x32_bf16 a[132:135], v[28:31], a[228:231], a[132:135]
v_xor_b32 v11, 192, v5
v_mfma_f32_16x16x32_bf16 a[136:139], v[28:31], a[232:235], a[136:139]
buffer_load_dword v15, v14, s[96:99], s100 offen
v_mfma_f32_16x16x32_bf16 a[140:143], v[28:31], a[236:239], a[140:143]
s_add_u32 s100, s100, 16384
v_mfma_f32_16x16x32_bf16 a[144:147], v[28:31], a[240:243], a[144:147]
v_mfma_f32_16x16x32_bf16 a[148:151], v[28:31], a[244:247], a[148:151]
v_mfma_f32_16x16x32_bf16 a[152:155], v[28:31], a[248:251], a[152:155]
v_mfma_f32_16x16x32_bf16 a[156:159], v[28:31], a[252:255], a[156:159]
s_waitcnt vmcnt(21) lgkmcnt(0)
s_barrier
v_mfma_f32_16x16x32_bf16 v[160:163], a[160:163], a[192:195], v[160:163]
ds_read_b128 a[224:227], v4 offset:0
v_mfma_f32_16x16x32_bf16 v[164:167], a[160:163], a[196:199], v[164:167]
s_add_u32 s37, s31, 0
v_mfma_f32_16x16x32_bf16 v[168:171], a[160:163], a[200:203], v[168:171]
s_add_u32 m0, s33, 0
ds_read_b128 a[228:231], v3 offset:1024
v_mfma_f32_16x16x32_bf16 v[172:175], a[160:163], a[204:207], v[172:175]
buffer_load_dwordx4 v2, s[20:23], s37 offen  lds
v_mfma_f32_16x16x32_bf16 v[176:179], a[160:163], a[208:211], v[176:179]
s_add_u32 s29, s29, s44
ds_read_b128 a[232:235], v4 offset:4096
v_mfma_f32_16x16x32_bf16 v[180:183], a[160:163], a[212:215], v[180:183]
v_mfma_f32_16x16x32_bf16 v[184:187], a[160:163], a[216:219], v[184:187]
buffer_store_dwordx4 v[44:47], v13, s[8:11], s29 offen sc1
v_mfma_f32_16x16x32_bf16 v[188:191], a[160:163], a[220:223], v[188:191]
ds_read_b64_tr_b16 a[160:161], v5 offset:0
v_mfma_f32_16x16x32_bf16 v[192:195], a[164:167], a[192:195], v[192:195]
s_add_u32 s37, s31, 32768
ds_read_b64_tr_b16 a[162:163], v5 offset:1024
v_mfma_f32_16x16x32_bf16 v[196:199], a[164:167], a[196:199], v[196:199]
s_add_u32 m0, s33, 1024
ds_read_b128 a[236:239], v3 offset:5120
v_add_u32 v5, 16384, v5
v_mfma_f32_16x16x32_bf16 v[200:203], a[164:167], a[200:203], v[200:203]
buffer_load_dwordx4 v2, s[20:23], s37 offen  lds
v_and_b32 v5, 65535, v5
v_mfma_f32_16x16x32_bf16 v[204:207], a[164:167], a[204:207], v[204:207]
ds_read_b128 a[240:243], v4 offset:8192
v_mfma_f32_16x16x32_bf16 v[208:211], a[164:167], a[208:211], v[208:211]
v_mfma_f32_16x16x32_bf16 v[212:215], a[164:167], a[212:215], v[212:215]
ds_read_b128 a[244:247], v3 offset:9216
v_mfma_f32_16x16x32_bf16 v[216:219], a[164:167], a[216:219], v[216:219]
v_mfma_f32_16x16x32_bf16 v[220:223], a[164:167], a[220:223], v[220:223]
s_add_u32 s37, s31, 131072
ds_read_b64_tr_b16 a[164:165], v6 offset:0
v_mfma_f32_16x16x32_bf16 v[224:227], a[168:171], a[192:195], v[224:227]
s_add_u32 m0, s33, 4096
ds_read_b64_tr_b16 a[166:167], v6 offset:1024
v_mfma_f32_16x16x32_bf16 v[228:231], a[168:171], a[196:199], v[228:231]
buffer_load_dwordx4 v2, s[20:23], s37 offen  lds
v_xor_b32 v6, 16, v5
v_mfma_f32_16x16x32_bf16 v[232:235], a[168:171], a[200:203], v[232:235]
ds_read_b128 a[248:251], v4 offset:12288
v_mfma_f32_16x16x32_bf16 v[236:239], a[168:171], a[204:207], v[236:239]
v_mfma_f32_16x16x32_bf16 v[240:243], a[168:171], a[208:211], v[240:243]
ds_read_b128 a[252:255], v3 offset:13312
v_mfma_f32_16x16x32_bf16 v[244:247], a[168:171], a[212:215], v[244:247]
v_mfma_f32_16x16x32_bf16 v[248:251], a[168:171], a[216:219], v[248:251]
s_add_u32 s37, s31, 163840
ds_read_b64_tr_b16 v[28:29], v12 offset:0
v_mfma_f32_16x16x32_bf16 v[252:255], a[168:171], a[220:223], v[252:255]
s_add_u32 m0, s33, 5120
ds_read_b64_tr_b16 a[168:169], v7 offset:0
v_mfma_f32_16x16x32_bf16 a[0:3], a[172:175], a[192:195], a[0:3]
buffer_load_dwordx4 v2, s[20:23], s37 offen  lds
ds_read_b64_tr_b16 a[170:171], v7 offset:1024
v_mfma_f32_16x16x32_bf16 a[4:7], a[172:175], a[196:199], a[4:7]
s_add_u32 s31, s31, 262144
s_add_u32 s29, s29, s93
v_xor_b32 v7, 64, v5
v_mfma_f32_16x16x32_bf16 a[8:11], a[172:175], a[200:203], a[8:11]
s_add_u32 s33, s33, 16384
ds_read_b64_tr_b16 v[30:31], v12 offset:1024
v_mfma_f32_16x16x32_bf16 a[12:15], a[172:175], a[204:207], a[12:15]
s_and_b32 s33, s33, 65535
buffer_store_dwordx4 v[48:51], v13, s[8:11], s29 offen sc1
v_mfma_f32_16x16x32_bf16 a[16:19], a[172:175], a[208:211], a[16:19]
v_mfma_f32_16x16x32_bf16 a[20:23], a[172:175], a[212:215], a[20:23]
s_add_u32 s48, s48, s34
v_xor_b32 v12, 208, v5
v_mfma_f32_16x16x32_bf16 a[24:27], a[172:175], a[216:219], a[24:27]
s_add_u32 m0, s32, 16384
v_add_u32 v3, 32768, v3
v_mfma_f32_16x16x32_bf16 a[28:31], a[172:175], a[220:223], a[28:31]
buffer_load_dwordx4 v1, s[12:15], s48 offen lds
ds_read_b64_tr_b16 a[172:173], v8 offset:0
v_mfma_f32_16x16x32_bf16 a[32:35], a[176:179], a[192:195], a[32:35]
ds_read_b64_tr_b16 a[174:175], v8 offset:1024
v_subrev_u32 v19, 98304, v3
v_mfma_f32_16x16x32_bf16 a[36:39], a[176:179], a[196:199], a[36:39]
v_xor_b32 v8, 80, v5
v_cmp_le_u32 vcc, 163840, v3
v_mfma_f32_16x16x32_bf16 a[40:43], a[176:179], a[200:203], a[40:43]
s_nop 0
v_cndmask_b32 v3, v3, v19, vcc
v_mfma_f32_16x16x32_bf16 a[44:47], a[176:179], a[204:207], a[44:47]
v_xor_b32 v4, 64, v3
v_mfma_f32_16x16x32_bf16 a[48:51], a[176:179], a[208:211], a[48:51]
s_add_u32 s48, s48, s34
v_mfma_f32_16x16x32_bf16 a[52:55], a[176:179], a[212:215], a[52:55]
s_add_u32 m0, s32, 20480
v_mfma_f32_16x16x32_bf16 a[56:59], a[176:179], a[216:219], a[56:59]
buffer_load_dwordx4 v1, s[12:15], s48 offen lds
v_mfma_f32_16x16x32_bf16 a[60:63], a[176:179], a[220:223], a[60:63]
ds_read_b64_tr_b16 a[176:177], v9 offset:0
v_mfma_f32_16x16x32_bf16 a[64:67], a[180:183], a[192:195], a[64:67]
ds_read_b64_tr_b16 a[178:179], v9 offset:1024
v_mfma_f32_16x16x32_bf16 a[68:71], a[180:183], a[196:199], a[68:71]
v_xor_b32 v9, 128, v5
v_mfma_f32_16x16x32_bf16 a[72:75], a[180:183], a[200:203], a[72:75]
v_mfma_f32_16x16x32_bf16 a[76:79], a[180:183], a[204:207], a[76:79]
s_add_u32 s48, s48, s34
v_mfma_f32_16x16x32_bf16 a[80:83], a[180:183], a[208:211], a[80:83]
s_add_u32 m0, s32, 24576
v_mfma_f32_16x16x32_bf16 a[84:87], a[180:183], a[212:215], a[84:87]
buffer_load_dwordx4 v1, s[12:15], s48 offen lds
v_mfma_f32_16x16x32_bf16 a[88:91], a[180:183], a[216:219], a[88:91]
s_add_u32 s29, s29, s44
v_mfma_f32_16x16x32_bf16 a[92:95], a[180:183], a[220:223], a[92:95]
ds_read_b64_tr_b16 a[180:181], v10 offset:0
v_mfma_f32_16x16x32_bf16 a[96:99], a[184:187], a[192:195], a[96:99]
buffer_store_dwordx4 v[52:55], v13, s[8:11], s29 offen sc1
ds_read_b64_tr_b16 a[182:183], v10 offset:1024
v_mfma_f32_16x16x32_bf16 a[100:103], a[184:187], a[196:199], a[100:103]
v_xor_b32 v10, 144, v5
v_mfma_f32_16x16x32_bf16 a[104:107], a[184:187], a[200:203], a[104:107]
s_add_u32 s48, s48, s34
v_mfma_f32_16x16x32_bf16 a[108:111], a[184:187], a[204:207], a[108:111]
s_add_u32 m0, s32, 28672
v_mfma_f32_16x16x32_bf16 a[112:115], a[184:187], a[208:211], a[112:115]
buffer_load_dwordx4 v1, s[12:15], s48 offen lds
v_mfma_f32_16x16x32_bf16 a[116:119], a[184:187], a[212:215], a[116:119]
s_add_u32 s30, s30, 128
v_mfma_f32_16x16x32_bf16 a[120:123], a[184:187], a[216:219], a[120:123]
s_add_u32 s32, s32, 32768
v_mfma_f32_16x16x32_bf16 a[124:127], a[184:187], a[220:223], a[124:127]
s_sub_u32 s48, s32, 98304
ds_read_b64_tr_b16 a[184:185], v11 offset:0
v_mfma_f32_16x16x32_bf16 a[128:131], a[188:191], a[192:195], a[128:131]
s_cmp_ge_u32 s32, 163840
s_cselect_b32 s32, s48, s32
ds_read_b64_tr_b16 a[186:187], v11 offset:1024
v_mfma_f32_16x16x32_bf16 a[132:135], a[188:191], a[196:199], a[132:135]
v_xor_b32 v11, 192, v5
v_mfma_f32_16x16x32_bf16 a[136:139], a[188:191], a[200:203], a[136:139]
buffer_load_dword v15, v14, s[96:99], s100 offen
v_mfma_f32_16x16x32_bf16 a[140:143], a[188:191], a[204:207], a[140:143]
s_add_u32 s100, s100, 16384
v_mfma_f32_16x16x32_bf16 a[144:147], a[188:191], a[208:211], a[144:147]
v_mfma_f32_16x16x32_bf16 a[148:151], a[188:191], a[212:215], a[148:151]
v_mfma_f32_16x16x32_bf16 a[152:155], a[188:191], a[216:219], a[152:155]
v_mfma_f32_16x16x32_bf16 a[156:159], a[188:191], a[220:223], a[156:159]
s_waitcnt vmcnt(24) lgkmcnt(0)
s_barrier
v_mfma_f32_16x16x32_bf16 v[160:163], a[160:163], a[224:227], v[160:163]
ds_read_b128 a[192:195], v3 offset:0
v_mfma_f32_16x16x32_bf16 v[164:167], a[160:163], a[228:231], v[164:167]
s_add_u32 s37, s31, 0
v_mfma_f32_16x16x32_bf16 v[168:171], a[160:163], a[232:235], v[168:171]
s_add_u32 m0, s33, 0
ds_read_b128 a[196:199], v4 offset:1024
v_mfma_f32_16x16x32_bf16 v[172:175], a[160:163], a[236:239], v[172:175]
buffer_load_dwordx4 v2, s[20:23], s37 offen  lds
v_mfma_f32_16x16x32_bf16 v[176:179], a[160:163], a[240:243], v[176:179]
s_add_u32 s29, s29, s93
ds_read_b128 a[200:203], v3 offset:4096
v_mfma_f32_16x16x32_bf16 v[180:183], a[160:163], a[244:247], v[180:183]
v_mfma_f32_16x16x32_bf16 v[184:187], a[160:163], a[248:251], v[184:187]
buffer_store_dwordx4 v[56:59], v13, s[8:11], s29 offen sc1
v_mfma_f32_16x16x32_bf16 v[188:191], a[160:163], a[252:255], v[188:191]
ds_read_b64_tr_b16 a[160:161], v5 offset:0
v_mfma_f32_16x16x32_bf16 v[192:195], a[164:167], a[224:227], v[192:195]
s_add_u32 s37, s31, 32768
ds_read_b64_tr_b16 a[162:163], v5 offset:1024
v_mfma_f32_16x16x32_bf16 v[196:199], a[164:167], a[228:231], v[196:199]
s_add_u32 m0, s33, 1024
ds_read_b128 a[204:207], v4 offset:5120
v_add_u32 v5, 16384, v5
v_mfma_f32_16x16x32_bf16 v[200:203], a[164:167], a[232:235], v[200:203]
buffer_load_dwordx4 v2, s[20:23], s37 offen  lds
v_and_b32 v5, 65535, v5
v_mfma_f32_16x16x32_bf16 v[204:207], a[164:167], a[236:239], v[204:207]
ds_read_b128 a[208:211], v3 offset:8192
v_mfma_f32_16x16x32_bf16 v[208:211], a[164:167], a[240:243], v[208:211]
v_mfma_f32_16x16x32_bf16 v[212:215], a[164:167], a[244:247], v[212:215]
ds_read_b128 a[212:215], v4 offset:9216
v_mfma_f32_16x16x32_bf16 v[216:219], a[164:167], a[248:251], v[216:219]
v_mfma_f32_16x16x32_bf16 v[220:223], a[164:167], a[252:255], v[220:223]
s_add_u32 s37, s31, 131072
ds_read_b64_tr_b16 a[164:165], v6 offset:0
v_mfma_f32_16x16x32_bf16 v[224:227], a[168:171], a[224:227], v[224:227]
s_add_u32 m0, s33, 4096
ds_read_b64_tr_b16 a[166:167], v6 offset:1024
v_mfma_f32_16x16x32_bf16 v[228:231], a[168:171], a[228:231], v[228:231]
buffer_load_dwordx4 v2, s[20:23], s37 offen  lds
v_xor_b32 v6, 16, v5
v_mfma_f32_16x16x32_bf16 v[232:235], a[168:171], a[232:235], v[232:235]
ds_read_b128 a[216:219], v3 offset:12288
v_mfma_f32_16x16x32_bf16 v[236:239], a[168:171], a[236:239], v[236:239]
v_mfma_f32_16x16x32_bf16 v[240:243], a[168:171], a[240:243], v[240:243]
ds_read_b128 a[220:223], v4 offset:13312
v_mfma_f32_16x16x32_bf16 v[244:247], a[168:171], a[244:247], v[244:247]
v_mfma_f32_16x16x32_bf16 v[248:251], a[168:171], a[248:251], v[248:251]
s_add_u32 s37, s31, 163840
ds_read_b64_tr_b16 a[188:189], v12 offset:0
v_mfma_f32_16x16x32_bf16 v[252:255], a[168:171], a[252:255], v[252:255]
s_add_u32 m0, s33, 5120
ds_read_b64_tr_b16 a[168:169], v7 offset:0
v_mfma_f32_16x16x32_bf16 a[0:3], a[172:175], a[224:227], a[0:3]
buffer_load_dwordx4 v2, s[20:23], s37 offen  lds
ds_read_b64_tr_b16 a[170:171], v7 offset:1024
v_mfma_f32_16x16x32_bf16 a[4:7], a[172:175], a[228:231], a[4:7]
s_add_u32 s31, s31, 262144
s_add_u32 s29, s29, s44
v_xor_b32 v7, 64, v5
v_mfma_f32_16x16x32_bf16 a[8:11], a[172:175], a[232:235], a[8:11]
s_add_u32 s33, s33, 16384
ds_read_b64_tr_b16 a[190:191], v12 offset:1024
v_mfma_f32_16x16x32_bf16 a[12:15], a[172:175], a[236:239], a[12:15]
s_and_b32 s33, s33, 65535
buffer_store_dwordx4 v[60:63], v13, s[8:11], s29 offen sc1
v_mfma_f32_16x16x32_bf16 a[16:19], a[172:175], a[240:243], a[16:19]
v_mfma_f32_16x16x32_bf16 a[20:23], a[172:175], a[244:247], a[20:23]
s_mov_b32 s48, s30
v_xor_b32 v12, 208, v5
v_mfma_f32_16x16x32_bf16 a[24:27], a[172:175], a[248:251], a[24:27]
s_add_u32 m0, s32, 0
v_mfma_f32_16x16x32_bf16 a[28:31], a[172:175], a[252:255], a[28:31]
buffer_load_dwordx4 v1, s[12:15], s48 offen lds
ds_read_b64_tr_b16 a[172:173], v8 offset:0
v_mfma_f32_16x16x32_bf16 a[32:35], a[176:179], a[224:227], a[32:35]
ds_read_b64_tr_b16 a[174:175], v8 offset:1024
v_mfma_f32_16x16x32_bf16 a[36:39], a[176:179], a[228:231], a[36:39]
v_xor_b32 v8, 80, v5
v_mfma_f32_16x16x32_bf16 a[40:43], a[176:179], a[232:235], a[40:43]
v_mfma_f32_16x16x32_bf16 a[44:47], a[176:179], a[236:239], a[44:47]
v_mfma_f32_16x16x32_bf16 a[48:51], a[176:179], a[240:243], a[48:51]
s_add_u32 s48, s48, s34
v_mfma_f32_16x16x32_bf16 a[52:55], a[176:179], a[244:247], a[52:55]
s_add_u32 m0, s32, 4096
v_mfma_f32_16x16x32_bf16 a[56:59], a[176:179], a[248:251], a[56:59]
buffer_load_dwordx4 v1, s[12:15], s48 offen lds
v_mfma_f32_16x16x32_bf16 a[60:63], a[176:179], a[252:255], a[60:63]
ds_read_b64_tr_b16 a[176:177], v9 offset:0
v_mfma_f32_16x16x32_bf16 a[64:67], a[180:183], a[224:227], a[64:67]
ds_read_b64_tr_b16 a[178:179], v9 offset:1024
v_mfma_f32_16x16x32_bf16 a[68:71], a[180:183], a[228:231], a[68:71]
v_xor_b32 v9, 128, v5
v_mfma_f32_16x16x32_bf16 a[72:75], a[180:183], a[232:235], a[72:75]
v_mfma_f32_16x16x32_bf16 a[76:79], a[180:183], a[236:239], a[76:79]
s_add_u32 s48, s48, s34
v_mfma_f32_16x16x32_bf16 a[80:83], a[180:183], a[240:243], a[80:83]
s_add_u32 m0, s32, 8192
v_mfma_f32_16x16x32_bf16 a[84:87], a[180:183], a[244:247], a[84:87]
buffer_load_dwordx4 v1, s[12:15], s48 offen lds
v_mfma_f32_16x16x32_bf16 a[88:91], a[180:183], a[248:251], a[88:91]
v_mfma_f32_16x16x32_bf16 a[92:95], a[180:183], a[252:255], a[92:95]
ds_read_b64_tr_b16 a[180:181], v10 offset:0
v_mfma_f32_16x16x32_bf16 a[96:99], a[184:187], a[224:227], a[96:99]
ds_read_b64_tr_b16 a[182:183], v10 offset:1024
v_mfma_f32_16x16x32_bf16 a[100:103], a[184:187], a[228:231], a[100:103]
v_xor_b32 v10, 144, v5
v_mfma_f32_16x16x32_bf16 a[104:107], a[184:187], a[232:235], a[104:107]
s_add_u32 s48, s48, s34
v_mfma_f32_16x16x32_bf16 a[108:111], a[184:187], a[236:239], a[108:111]
s_add_u32 m0, s32, 12288
v_mfma_f32_16x16x32_bf16 a[112:115], a[184:187], a[240:243], a[112:115]
buffer_load_dwordx4 v1, s[12:15], s48 offen lds
v_mfma_f32_16x16x32_bf16 a[116:119], a[184:187], a[244:247], a[116:119]
v_mfma_f32_16x16x32_bf16 a[120:123], a[184:187], a[248:251], a[120:123]
v_mfma_f32_16x16x32_bf16 a[124:127], a[184:187], a[252:255], a[124:127]
ds_read_b64_tr_b16 a[184:185], v11 offset:0
v_mfma_f32_16x16x32_bf16 a[128:131], v[28:31], a[224:227], a[128:131]
ds_read_b64_tr_b16 a[186:187], v11 offset:1024
v_mfma_f32_16x16x32_bf16 a[132:135], v[28:31], a[228:231], a[132:135]
v_xor_b32 v11, 192, v5
v_mfma_f32_16x16x32_bf16 a[136:139], v[28:31], a[232:235], a[136:139]
buffer_load_dword v15, v14, s[96:99], s100 offen
v_mfma_f32_16x16x32_bf16 a[140:143], v[28:31], a[236:239], a[140:143]
s_add_u32 s100, s100, 16384
v_mfma_f32_16x16x32_bf16 a[144:147], v[28:31], a[240:243], a[144:147]
v_mfma_f32_16x16x32_bf16 a[148:151], v[28:31], a[244:247], a[148:151]
v_mfma_f32_16x16x32_bf16 a[152:155], v[28:31], a[248:251], a[152:155]
v_mfma_f32_16x16x32_bf16 a[156:159], v[28:31], a[252:255], a[156:159]
s_waitcnt vmcnt(23) lgkmcnt(0)
s_barrier
v_mfma_f32_16x16x32_bf16 v[160:163], a[160:163], a[192:195], v[160:163]
ds_read_b128 a[224:227], v4 offset:0
v_mfma_f32_16x16x32_bf16 v[164:167], a[160:163], a[196:199], v[164:167]
s_add_u32 s37, s31, 0
v_mfma_f32_16x16x32_bf16 v[168:171], a[160:163], a[200:203], v[168:171]
s_add_u32 m0, s33, 0
ds_read_b128 a[228:231], v3 offset:1024
v_mfma_f32_16x16x32_bf16 v[172:175], a[160:163], a[204:207], v[172:175]
buffer_load_dwordx4 v2, s[20:23], s37 offen  lds
v_mfma_f32_16x16x32_bf16 v[176:179], a[160:163], a[208:211], v[176:179]
s_add_u32 s60, s60, s92
ds_read_b128 a[232:235], v4 offset:4096
v_mfma_f32_16x16x32_bf16 v[180:183], a[160:163], a[212:215], v[180:183]
s_mov_b32 s29, s60
v_mfma_f32_16x16x32_bf16 v[184:187], a[160:163], a[216:219], v[184:187]
buffer_store_dwordx4 v[64:67], v13, s[8:11], s29 offen sc1
v_mfma_f32_16x16x32_bf16 v[188:191], a[160:163], a[220:223], v[188:191]
ds_read_b64_tr_b16 a[160:161], v5 offset:0
v_mfma_f32_16x16x32_bf16 v[192:195], a[164:167], a[192:195], v[192:195]
s_add_u32 s37, s31, 32768
ds_read_b64_tr_b16 a[162:163], v5 offset:1024
v_mfma_f32_16x16x32_bf16 v[196:199], a[164:167], a[196:199], v[196:199]
s_add_u32 m0, s33, 1024
ds_read_b128 a[236:239], v3 offset:5120
v_add_u32 v5, 16384, v5
v_mfma_f32_16x16x32_bf16 v[200:203], a[164:167], a[200:203], v[200:203]
buffer_load_dwordx4 v2, s[20:23], s37 offen  lds
v_and_b32 v5, 65535, v5
v_mfma_f32_16x16x32_bf16 v[204:207], a[164:167], a[204:207], v[204:207]
ds_read_b128 a[240:243], v4 offset:8192
v_mfma_f32_16x16x32_bf16 v[208:211], a[164:167], a[208:211], v[208:211]
v_mfma_f32_16x16x32_bf16 v[212:215], a[164:167], a[212:215], v[212:215]
ds_read_b128 a[244:247], v3 offset:9216
v_mfma_f32_16x16x32_bf16 v[216:219], a[164:167], a[216:219], v[216:219]
v_mfma_f32_16x16x32_bf16 v[220:223], a[164:167], a[220:223], v[220:223]
s_add_u32 s37, s31, 131072
ds_read_b64_tr_b16 a[164:165], v6 offset:0
v_mfma_f32_16x16x32_bf16 v[224:227], a[168:171], a[192:195], v[224:227]
s_add_u32 m0, s33, 4096
ds_read_b64_tr_b16 a[166:167], v6 offset:1024
v_mfma_f32_16x16x32_bf16 v[228:231], a[168:171], a[196:199], v[228:231]
buffer_load_dwordx4 v2, s[20:23], s37 offen  lds
v_xor_b32 v6, 16, v5
v_mfma_f32_16x16x32_bf16 v[232:235], a[168:171], a[200:203], v[232:235]
ds_read_b128 a[248:251], v4 offset:12288
v_mfma_f32_16x16x32_bf16 v[236:239], a[168:171], a[204:207], v[236:239]
v_mfma_f32_16x16x32_bf16 v[240:243], a[168:171], a[208:211], v[240:243]
ds_read_b128 a[252:255], v3 offset:13312
v_mfma_f32_16x16x32_bf16 v[244:247], a[168:171], a[212:215], v[244:247]
v_mfma_f32_16x16x32_bf16 v[248:251], a[168:171], a[216:219], v[248:251]
s_add_u32 s37, s31, 163840
ds_read_b64_tr_b16 v[28:29], v12 offset:0
v_mfma_f32_16x16x32_bf16 v[252:255], a[168:171], a[220:223], v[252:255]
s_add_u32 m0, s33, 5120
ds_read_b64_tr_b16 a[168:169], v7 offset:0
v_mfma_f32_16x16x32_bf16 a[0:3], a[172:175], a[192:195], a[0:3]
buffer_load_dwordx4 v2, s[20:23], s37 offen  lds
ds_read_b64_tr_b16 a[170:171], v7 offset:1024
v_mfma_f32_16x16x32_bf16 a[4:7], a[172:175], a[196:199], a[4:7]
s_add_u32 s31, s31, 262144
s_add_u32 s29, s29, s44
v_xor_b32 v7, 64, v5
v_mfma_f32_16x16x32_bf16 a[8:11], a[172:175], a[200:203], a[8:11]
s_add_u32 s33, s33, 16384
ds_read_b64_tr_b16 v[30:31], v12 offset:1024
v_mfma_f32_16x16x32_bf16 a[12:15], a[172:175], a[204:207], a[12:15]
s_and_b32 s33, s33, 65535
buffer_store_dwordx4 v[68:71], v13, s[8:11], s29 offen sc1
v_mfma_f32_16x16x32_bf16 a[16:19], a[172:175], a[208:211], a[16:19]
v_mfma_f32_16x16x32_bf16 a[20:23], a[172:175], a[212:215], a[20:23]
s_add_u32 s48, s48, s34
v_xor_b32 v12, 208, v5
v_mfma_f32_16x16x32_bf16 a[24:27], a[172:175], a[216:219], a[24:27]
s_add_u32 m0, s32, 16384
v_add_u32 v3, 32768, v3
v_mfma_f32_16x16x32_bf16 a[28:31], a[172:175], a[220:223], a[28:31]
buffer_load_dwordx4 v1, s[12:15], s48 offen lds
ds_read_b64_tr_b16 a[172:173], v8 offset:0
v_mfma_f32_16x16x32_bf16 a[32:35], a[176:179], a[192:195], a[32:35]
ds_read_b64_tr_b16 a[174:175], v8 offset:1024
v_subrev_u32 v19, 98304, v3
v_mfma_f32_16x16x32_bf16 a[36:39], a[176:179], a[196:199], a[36:39]
v_xor_b32 v8, 80, v5
v_cmp_le_u32 vcc, 163840, v3
v_mfma_f32_16x16x32_bf16 a[40:43], a[176:179], a[200:203], a[40:43]
s_nop 0
v_cndmask_b32 v3, v3, v19, vcc
v_mfma_f32_16x16x32_bf16 a[44:47], a[176:179], a[204:207], a[44:47]
v_xor_b32 v4, 64, v3
v_mfma_f32_16x16x32_bf16 a[48:51], a[176:179], a[208:211], a[48:51]
s_add_u32 s48, s48, s34
v_mfma_f32_16x16x32_bf16 a[52:55], a[176:179], a[212:215], a[52:55]
s_add_u32 m0, s32, 20480
v_mfma_f32_16x16x32_bf16 a[56:59], a[176:179], a[216:219], a[56:59]
buffer_load_dwordx4 v1, s[12:15], s48 offen lds
v_mfma_f32_16x16x32_bf16 a[60:63], a[176:179], a[220:223], a[60:63]
ds_read_b64_tr_b16 a[176:177], v9 offset:0
v_mfma_f32_16x16x32_bf16 a[64:67], a[180:183], a[192:195], a[64:67]
ds_read_b64_tr_b16 a[178:179], v9 offset:1024
v_mfma_f32_16x16x32_bf16 a[68:71], a[180:183], a[196:199], a[68:71]
v_xor_b32 v9, 128, v5
v_mfma_f32_16x16x32_bf16 a[72:75], a[180:183], a[200:203], a[72:75]
v_mfma_f32_16x16x32_bf16 a[76:79], a[180:183], a[204:207], a[76:79]
s_add_u32 s48, s48, s34
v_mfma_f32_16x16x32_bf16 a[80:83], a[180:183], a[208:211], a[80:83]
s_add_u32 m0, s32, 24576
v_mfma_f32_16x16x32_bf16 a[84:87], a[180:183], a[212:215], a[84:87]
buffer_load_dwordx4 v1, s[12:15], s48 offen lds
v_mfma_f32_16x16x32_bf16 a[88:91], a[180:183], a[216:219], a[88:91]
s_add_u32 s29, s29, s93
v_mfma_f32_16x16x32_bf16 a[92:95], a[180:183], a[220:223], a[92:95]
ds_read_b64_tr_b16 a[180:181], v10 offset:0
v_mfma_f32_16x16x32_bf16 a[96:99], a[184:187], a[192:195], a[96:99]
buffer_store_dwordx4 v[72:75], v13, s[8:11], s29 offen sc1
ds_read_b64_tr_b16 a[182:183], v10 offset:1024
v_mfma_f32_16x16x32_bf16 a[100:103], a[184:187], a[196:199], a[100:103]
v_xor_b32 v10, 144, v5
v_mfma_f32_16x16x32_bf16 a[104:107], a[184:187], a[200:203], a[104:107]
s_add_u32 s48, s48, s34
v_mfma_f32_16x16x32_bf16 a[108:111], a[184:187], a[204:207], a[108:111]
s_add_u32 m0, s32, 28672
v_mfma_f32_16x16x32_bf16 a[112:115], a[184:187], a[208:211], a[112:115]
buffer_load_dwordx4 v1, s[12:15], s48 offen lds
v_mfma_f32_16x16x32_bf16 a[116:119], a[184:187], a[212:215], a[116:119]
s_add_u32 s30, s30, 128
v_mfma_f32_16x16x32_bf16 a[120:123], a[184:187], a[216:219], a[120:123]
s_add_u32 s32, s32, 32768
v_mfma_f32_16x16x32_bf16 a[124:127], a[184:187], a[220:223], a[124:127]
s_sub_u32 s48, s32, 98304
ds_read_b64_tr_b16 a[184:185], v11 offset:0
v_mfma_f32_16x16x32_bf16 a[128:131], a[188:191], a[192:195], a[128:131]
s_cmp_ge_u32 s32, 163840
s_cselect_b32 s32, s48, s32
ds_read_b64_tr_b16 a[186:187], v11 offset:1024
v_mfma_f32_16x16x32_bf16 a[132:135], a[188:191], a[196:199], a[132:135]
v_xor_b32 v11, 192, v5
v_mfma_f32_16x16x32_bf16 a[136:139], a[188:191], a[200:203], a[136:139]
buffer_load_dword v15, v14, s[96:99], s100 offen
v_mfma_f32_16x16x32_bf16 a[140:143], a[188:191], a[204:207], a[140:143]
s_add_u32 s100, s100, 16384
v_mfma_f32_16x16x32_bf16 a[144:147], a[188:191], a[208:211], a[144:147]
v_mfma_f32_16x16x32_bf16 a[148:151], a[188:191], a[212:215], a[148:151]
v_mfma_f32_16x16x32_bf16 a[152:155], a[188:191], a[216:219], a[152:155]
v_mfma_f32_16x16x32_bf16 a[156:159], a[188:191], a[220:223], a[156:159]
s_waitcnt vmcnt(23) lgkmcnt(0)
s_barrier
v_mfma_f32_16x16x32_bf16 v[160:163], a[160:163], a[224:227], v[160:163]
ds_read_b128 a[192:195], v3 offset:0
v_mfma_f32_16x16x32_bf16 v[164:167], a[160:163], a[228:231], v[164:167]
s_add_u32 s37, s31, 0
v_mfma_f32_16x16x32_bf16 v[168:171], a[160:163], a[232:235], v[168:171]
s_add_u32 m0, s33, 0
ds_read_b128 a[196:199], v4 offset:1024
v_mfma_f32_16x16x32_bf16 v[172:175], a[160:163], a[236:239], v[172:175]
buffer_load_dwordx4 v2, s[20:23], s37 offen  lds
v_mfma_f32_16x16x32_bf16 v[176:179], a[160:163], a[240:243], v[176:179]
s_add_u32 s29, s29, s44
ds_read_b128 a[200:203], v3 offset:4096
v_mfma_f32_16x16x32_bf16 v[180:183], a[160:163], a[244:247], v[180:183]
v_mfma_f32_16x16x32_bf16 v[184:187], a[160:163], a[248:251], v[184:187]
buffer_store_dwordx4 v[76:79], v13, s[8:11], s29 offen sc1
v_mfma_f32_16x16x32_bf16 v[188:191], a[160:163], a[252:255], v[188:191]
ds_read_b64_tr_b16 a[160:161], v5 offset:0
v_mfma_f32_16x16x32_bf16 v[192:195], a[164:167], a[224:227], v[192:195]
s_add_u32 s37, s31, 32768
ds_read_b64_tr_b16 a[162:163], v5 offset:1024
v_mfma_f32_16x16x32_bf16 v[196:199], a[164:167], a[228:231], v[196:199]
s_add_u32 m0, s33, 1024
ds_read_b128 a[204:207], v4 offset:5120
v_add_u32 v5, 16384, v5
v_mfma_f32_16x16x32_bf16 v[200:203], a[164:167], a[232:235], v[200:203]
buffer_load_dwordx4 v2, s[20:23], s37 offen  lds
v_and_b32 v5, 65535, v5
v_mfma_f32_16x16x32_bf16 v[204:207], a[164:167], a[236:239], v[204:207]
ds_read_b128 a[208:211], v3 offset:8192
v_mfma_f32_16x16x32_bf16 v[208:211], a[164:167], a[240:243], v[208:211]
v_mfma_f32_16x16x32_bf16 v[212:215], a[164:167], a[244:247], v[212:215]
ds_read_b128 a[212:215], v4 offset:9216
v_mfma_f32_16x16x32_bf16 v[216:219], a[164:167], a[248:251], v[216:219]
v_mfma_f32_16x16x32_bf16 v[220:223], a[164:167], a[252:255], v[220:223]
s_add_u32 s37, s31, 131072
ds_read_b64_tr_b16 a[164:165], v6 offset:0
v_mfma_f32_16x16x32_bf16 v[224:227], a[168:171], a[224:227], v[224:227]
s_add_u32 m0, s33, 4096
ds_read_b64_tr_b16 a[166:167], v6 offset:1024
v_mfma_f32_16x16x32_bf16 v[228:231], a[168:171], a[228:231], v[228:231]
buffer_load_dwordx4 v2, s[20:23], s37 offen  lds
v_xor_b32 v6, 16, v5
v_mfma_f32_16x16x32_bf16 v[232:235], a[168:171], a[232:235], v[232:235]
ds_read_b128 a[216:219], v3 offset:12288
v_mfma_f32_16x16x32_bf16 v[236:239], a[168:171], a[236:239], v[236:239]
v_mfma_f32_16x16x32_bf16 v[240:243], a[168:171], a[240:243], v[240:243]
ds_read_b128 a[220:223], v4 offset:13312
v_mfma_f32_16x16x32_bf16 v[244:247], a[168:171], a[244:247], v[244:247]
v_mfma_f32_16x16x32_bf16 v[248:251], a[168:171], a[248:251], v[248:251]
s_add_u32 s37, s31, 163840
ds_read_b64_tr_b16 a[188:189], v12 offset:0
v_mfma_f32_16x16x32_bf16 v[252:255], a[168:171], a[252:255], v[252:255]
s_add_u32 m0, s33, 5120
ds_read_b64_tr_b16 a[168:169], v7 offset:0
v_mfma_f32_16x16x32_bf16 a[0:3], a[172:175], a[224:227], a[0:3]
buffer_load_dwordx4 v2, s[20:23], s37 offen  lds
ds_read_b64_tr_b16 a[170:171], v7 offset:1024
v_mfma_f32_16x16x32_bf16 a[4:7], a[172:175], a[228:231], a[4:7]
s_add_u32 s31, s31, 262144
s_add_u32 s29, s29, s93
v_xor_b32 v7, 64, v5
v_mfma_f32_16x16x32_bf16 a[8:11], a[172:175], a[232:235], a[8:11]
s_add_u32 s33, s33, 16384
ds_read_b64_tr_b16 a[190:191], v12 offset:1024
v_mfma_f32_16x16x32_bf16 a[12:15], a[172:175], a[236:239], a[12:15]
s_and_b32 s33, s33, 65535
buffer_store_dwordx4 v[80:83], v13, s[8:11], s29 offen sc1
v_mfma_f32_16x16x32_bf16 a[16:19], a[172:175], a[240:243], a[16:19]
v_mfma_f32_16x16x32_bf16 a[20:23], a[172:175], a[244:247], a[20:23]
s_mov_b32 s48, s30
v_xor_b32 v12, 208, v5
v_mfma_f32_16x16x32_bf16 a[24:27], a[172:175], a[248:251], a[24:27]
s_add_u32 m0, s32, 0
v_mfma_f32_16x16x32_bf16 a[28:31], a[172:175], a[252:255], a[28:31]
buffer_load_dwordx4 v1, s[12:15], s48 offen lds
ds_read_b64_tr_b16 a[172:173], v8 offset:0
v_mfma_f32_16x16x32_bf16 a[32:35], a[176:179], a[224:227], a[32:35]
ds_read_b64_tr_b16 a[174:175], v8 offset:1024
v_mfma_f32_16x16x32_bf16 a[36:39], a[176:179], a[228:231], a[36:39]
v_xor_b32 v8, 80, v5
v_mfma_f32_16x16x32_bf16 a[40:43], a[176:179], a[232:235], a[40:43]
v_mfma_f32_16x16x32_bf16 a[44:47], a[176:179], a[236:239], a[44:47]
v_mfma_f32_16x16x32_bf16 a[48:51], a[176:179], a[240:243], a[48:51]
s_add_u32 s48, s48, s34
v_mfma_f32_16x16x32_bf16 a[52:55], a[176:179], a[244:247], a[52:55]
s_add_u32 m0, s32, 4096
v_mfma_f32_16x16x32_bf16 a[56:59], a[176:179], a[248:251], a[56:59]
buffer_load_dwordx4 v1, s[12:15], s48 offen lds
v_mfma_f32_16x16x32_bf16 a[60:63], a[176:179], a[252:255], a[60:63]
ds_read_b64_tr_b16 a[176:177], v9 offset:0
v_mfma_f32_16x16x32_bf16 a[64:67], a[180:183], a[224:227], a[64:67]
ds_read_b64_tr_b16 a[178:179], v9 offset:1024
v_mfma_f32_16x16x32_bf16 a[68:71], a[180:183], a[228:231], a[68:71]
v_xor_b32 v9, 128, v5
v_mfma_f32_16x16x32_bf16 a[72:75], a[180:183], a[232:235], a[72:75]
v_mfma_f32_16x16x32_bf16 a[76:79], a[180:183], a[236:239], a[76:79]
s_add_u32 s48, s48, s34
v_mfma_f32_16x16x32_bf16 a[80:83], a[180:183], a[240:243], a[80:83]
s_add_u32 m0, s32, 8192
v_mfma_f32_16x16x32_bf16 a[84:87], a[180:183], a[244:247], a[84:87]
buffer_load_dwordx4 v1, s[12:15], s48 offen lds
v_mfma_f32_16x16x32_bf16 a[88:91], a[180:183], a[248:251], a[88:91]
s_add_u32 s29, s29, s44
v_mfma_f32_16x16x32_bf16 a[92:95], a[180:183], a[252:255], a[92:95]
ds_read_b64_tr_b16 a[180:181], v10 offset:0
v_mfma_f32_16x16x32_bf16 a[96:99], a[184:187], a[224:227], a[96:99]
buffer_store_dwordx4 v[84:87], v13, s[8:11], s29 offen sc1
ds_read_b64_tr_b16 a[182:183], v10 offset:1024
v_mfma_f32_16x16x32_bf16 a[100:103], a[184:187], a[228:231], a[100:103]
v_xor_b32 v10, 144, v5
v_mfma_f32_16x16x32_bf16 a[104:107], a[184:187], a[232:235], a[104:107]
s_add_u32 s48, s48, s34
v_mfma_f32_16x16x32_bf16 a[108:111], a[184:187], a[236:239], a[108:111]
s_add_u32 m0, s32, 12288
v_mfma_f32_16x16x32_bf16 a[112:115], a[184:187], a[240:243], a[112:115]
buffer_load_dwordx4 v1, s[12:15], s48 offen lds
v_mfma_f32_16x16x32_bf16 a[116:119], a[184:187], a[244:247], a[116:119]
v_mfma_f32_16x16x32_bf16 a[120:123], a[184:187], a[248:251], a[120:123]
v_mfma_f32_16x16x32_bf16 a[124:127], a[184:187], a[252:255], a[124:127]
ds_read_b64_tr_b16 a[184:185], v11 offset:0
v_mfma_f32_16x16x32_bf16 a[128:131], v[28:31], a[224:227], a[128:131]
ds_read_b64_tr_b16 a[186:187], v11 offset:1024
v_mfma_f32_16x16x32_bf16 a[132:135], v[28:31], a[228:231], a[132:135]
v_xor_b32 v11, 192, v5
v_mfma_f32_16x16x32_bf16 a[136:139], v[28:31], a[232:235], a[136:139]
buffer_load_dword v15, v14, s[96:99], s100 offen
v_mfma_f32_16x16x32_bf16 a[140:143], v[28:31], a[236:239], a[140:143]
s_add_u32 s100, s100, 16384
v_mfma_f32_16x16x32_bf16 a[144:147], v[28:31], a[240:243], a[144:147]
v_mfma_f32_16x16x32_bf16 a[148:151], v[28:31], a[244:247], a[148:151]
v_mfma_f32_16x16x32_bf16 a[152:155], v[28:31], a[248:251], a[152:155]
v_mfma_f32_16x16x32_bf16 a[156:159], v[28:31], a[252:255], a[156:159]
s_waitcnt vmcnt(24) lgkmcnt(0)
s_barrier
v_mfma_f32_16x16x32_bf16 v[160:163], a[160:163], a[192:195], v[160:163]
ds_read_b128 a[224:227], v4 offset:0
v_mfma_f32_16x16x32_bf16 v[164:167], a[160:163], a[196:199], v[164:167]
s_add_u32 s37, s31, 0
v_mfma_f32_16x16x32_bf16 v[168:171], a[160:163], a[200:203], v[168:171]
s_add_u32 m0, s33, 0
ds_read_b128 a[228:231], v3 offset:1024
v_mfma_f32_16x16x32_bf16 v[172:175], a[160:163], a[204:207], v[172:175]
buffer_load_dwordx4 v2, s[20:23], s37 offen  lds
v_mfma_f32_16x16x32_bf16 v[176:179], a[160:163], a[208:211], v[176:179]
s_add_u32 s29, s29, s93
ds_read_b128 a[232:235], v4 offset:4096
v_mfma_f32_16x16x32_bf16 v[180:183], a[160:163], a[212:215], v[180:183]
v_mfma_f32_16x16x32_bf16 v[184:187], a[160:163], a[216:219], v[184:187]
buffer_store_dwordx4 v[88:91], v13, s[8:11], s29 offen sc1
v_mfma_f32_16x16x32_bf16 v[188:191], a[160:163], a[220:223], v[188:191]
ds_read_b64_tr_b16 a[160:161], v5 offset:0
v_mfma_f32_16x16x32_bf16 v[192:195], a[164:167], a[192:195], v[192:195]
s_add_u32 s37, s31, 32768
ds_read_b64_tr_b16 a[162:163], v5 offset:1024
v_mfma_f32_16x16x32_bf16 v[196:199], a[164:167], a[196:199], v[196:199]
s_add_u32 m0, s33, 1024
ds_read_b128 a[236:239], v3 offset:5120
v_add_u32 v5, 16384, v5
v_mfma_f32_16x16x32_bf16 v[200:203], a[164:167], a[200:203], v[200:203]
buffer_load_dwordx4 v2, s[20:23], s37 offen  lds
v_and_b32 v5, 65535, v5
v_mfma_f32_16x16x32_bf16 v[204:207], a[164:167], a[204:207], v[204:207]
ds_read_b128 a[240:243], v4 offset:8192
v_mfma_f32_16x16x32_bf16 v[208:211], a[164:167], a[208:211], v[208:211]
v_mfma_f32_16x16x32_bf16 v[212:215], a[164:167], a[212:215], v[212:215]
ds_read_b128 a[244:247], v3 offset:9216
v_mfma_f32_16x16x32_bf16 v[216:219], a[164:167], a[216:219], v[216:219]
v_mfma_f32_16x16x32_bf16 v[220:223], a[164:167], a[220:223], v[220:223]
s_add_u32 s37, s31, 131072
ds_read_b64_tr_b16 a[164:165], v6 offset:0
v_mfma_f32_16x16x32_bf16 v[224:227], a[168:171], a[192:195], v[224:227]
s_add_u32 m0, s33, 4096
ds_read_b64_tr_b16 a[166:167], v6 offset:1024
v_mfma_f32_16x16x32_bf16 v[228:231], a[168:171], a[196:199], v[228:231]
buffer_load_dwordx4 v2, s[20:23], s37 offen  lds
v_xor_b32 v6, 16, v5
v_mfma_f32_16x16x32_bf16 v[232:235], a[168:171], a[200:203], v[232:235]
ds_read_b128 a[248:251], v4 offset:12288
v_mfma_f32_16x16x32_bf16 v[236:239], a[168:171], a[204:207], v[236:239]
v_mfma_f32_16x16x32_bf16 v[240:243], a[168:171], a[208:211], v[240:243]
ds_read_b128 a[252:255], v3 offset:13312
v_mfma_f32_16x16x32_bf16 v[244:247], a[168:171], a[212:215], v[244:247]
v_mfma_f32_16x16x32_bf16 v[248:251], a[168:171], a[216:219], v[248:251]
s_add_u32 s37, s31, 163840
ds_read_b64_tr_b16 v[28:29], v12 offset:0
v_mfma_f32_16x16x32_bf16 v[252:255], a[168:171], a[220:223], v[252:255]
s_add_u32 m0, s33, 5120
ds_read_b64_tr_b16 a[168:169], v7 offset:0
v_mfma_f32_16x16x32_bf16 a[0:3], a[172:175], a[192:195], a[0:3]
buffer_load_dwordx4 v2, s[20:23], s37 offen  lds
ds_read_b64_tr_b16 a[170:171], v7 offset:1024
v_mfma_f32_16x16x32_bf16 a[4:7], a[172:175], a[196:199], a[4:7]
s_add_u32 s31, s31, 262144
s_add_u32 s29, s29, s44
v_xor_b32 v7, 64, v5
v_mfma_f32_16x16x32_bf16 a[8:11], a[172:175], a[200:203], a[8:11]
s_add_u32 s33, s33, 16384
ds_read_b64_tr_b16 v[30:31], v12 offset:1024
v_mfma_f32_16x16x32_bf16 a[12:15], a[172:175], a[204:207], a[12:15]
s_and_b32 s33, s33, 65535
buffer_store_dwordx4 v[92:95], v13, s[8:11], s29 offen sc1
v_mfma_f32_16x16x32_bf16 a[16:19], a[172:175], a[208:211], a[16:19]
v_mfma_f32_16x16x32_bf16 a[20:23], a[172:175], a[212:215], a[20:23]
s_add_u32 s48, s48, s34
v_xor_b32 v12, 208, v5
v_mfma_f32_16x16x32_bf16 a[24:27], a[172:175], a[216:219], a[24:27]
s_add_u32 m0, s32, 16384
v_add_u32 v3, 32768, v3
v_mfma_f32_16x16x32_bf16 a[28:31], a[172:175], a[220:223], a[28:31]
buffer_load_dwordx4 v1, s[12:15], s48 offen lds
ds_read_b64_tr_b16 a[172:173], v8 offset:0
v_mfma_f32_16x16x32_bf16 a[32:35], a[176:179], a[192:195], a[32:35]
ds_read_b64_tr_b16 a[174:175], v8 offset:1024
v_subrev_u32 v19, 98304, v3
v_mfma_f32_16x16x32_bf16 a[36:39], a[176:179], a[196:199], a[36:39]
v_xor_b32 v8, 80, v5
v_cmp_le_u32 vcc, 163840, v3
v_mfma_f32_16x16x32_bf16 a[40:43], a[176:179], a[200:203], a[40:43]
s_nop 0
v_cndmask_b32 v3, v3, v19, vcc
v_mfma_f32_16x16x32_bf16 a[44:47], a[176:179], a[204:207], a[44:47]
v_xor_b32 v4, 64, v3
v_mfma_f32_16x16x32_bf16 a[48:51], a[176:179], a[208:211], a[48:51]
s_add_u32 s48, s48, s34
v_mfma_f32_16x16x32_bf16 a[52:55], a[176:179], a[212:215], a[52:55]
s_add_u32 m0, s32, 20480
v_mfma_f32_16x16x32_bf16 a[56:59], a[176:179], a[216:219], a[56:59]
buffer_load_dwordx4 v1, s[12:15], s48 offen lds
v_mfma_f32_16x16x32_bf16 a[60:63], a[176:179], a[220:223], a[60:63]
ds_read_b64_tr_b16 a[176:177], v9 offset:0
v_mfma_f32_16x16x32_bf16 a[64:67], a[180:183], a[192:195], a[64:67]
ds_read_b64_tr_b16 a[178:179], v9 offset:1024
v_mfma_f32_16x16x32_bf16 a[68:71], a[180:183], a[196:199], a[68:71]
v_xor_b32 v9, 128, v5
v_mfma_f32_16x16x32_bf16 a[72:75], a[180:183], a[200:203], a[72:75]
v_mfma_f32_16x16x32_bf16 a[76:79], a[180:183], a[204:207], a[76:79]
s_add_u32 s48, s48, s34
v_mfma_f32_16x16x32_bf16 a[80:83], a[180:183], a[208:211], a[80:83]
s_add_u32 m0, s32, 24576
v_mfma_f32_16x16x32_bf16 a[84:87], a[180:183], a[212:215], a[84:87]
buffer_load_dwordx4 v1, s[12:15], s48 offen lds
v_mfma_f32_16x16x32_bf16 a[88:91], a[180:183], a[216:219], a[88:91]
v_mfma_f32_16x16x32_bf16 a[92:95], a[180:183], a[220:223], a[92:95]
ds_read_b64_tr_b16 a[180:181], v10 offset:0
v_mfma_f32_16x16x32_bf16 a[96:99], a[184:187], a[192:195], a[96:99]
ds_read_b64_tr_b16 a[182:183], v10 offset:1024
v_mfma_f32_16x16x32_bf16 a[100:103], a[184:187], a[196:199], a[100:103]
v_xor_b32 v10, 144, v5
v_mfma_f32_16x16x32_bf16 a[104:107], a[184:187], a[200:203], a[104:107]
s_add_u32 s48, s48, s34
v_mfma_f32_16x16x32_bf16 a[108:111], a[184:187], a[204:207], a[108:111]
s_add_u32 m0, s32, 28672
v_mfma_f32_16x16x32_bf16 a[112:115], a[184:187], a[208:211], a[112:115]
buffer_load_dwordx4 v1, s[12:15], s48 offen lds
v_mfma_f32_16x16x32_bf16 a[116:119], a[184:187], a[212:215], a[116:119]
s_add_u32 s30, s30, 128
v_mfma_f32_16x16x32_bf16 a[120:123], a[184:187], a[216:219], a[120:123]
s_add_u32 s32, s32, 32768
v_mfma_f32_16x16x32_bf16 a[124:127], a[184:187], a[220:223], a[124:127]
s_sub_u32 s48, s32, 98304
ds_read_b64_tr_b16 a[184:185], v11 offset:0
v_mfma_f32_16x16x32_bf16 a[128:131], a[188:191], a[192:195], a[128:131]
s_cmp_ge_u32 s32, 163840
s_cselect_b32 s32, s48, s32
ds_read_b64_tr_b16 a[186:187], v11 offset:1024
v_mfma_f32_16x16x32_bf16 a[132:135], a[188:191], a[196:199], a[132:135]
v_xor_b32 v11, 192, v5
v_mfma_f32_16x16x32_bf16 a[136:139], a[188:191], a[200:203], a[136:139]
buffer_load_dword v15, v14, s[96:99], s100 offen
v_mfma_f32_16x16x32_bf16 a[140:143], a[188:191], a[204:207], a[140:143]
s_add_u32 s100, s100, 16384
v_mfma_f32_16x16x32_bf16 a[144:147], a[188:191], a[208:211], a[144:147]
v_mfma_f32_16x16x32_bf16 a[148:151], a[188:191], a[212:215], a[148:151]
v_mfma_f32_16x16x32_bf16 a[152:155], a[188:191], a[216:219], a[152:155]
v_mfma_f32_16x16x32_bf16 a[156:159], a[188:191], a[220:223], a[156:159]
s_waitcnt vmcnt(23) lgkmcnt(0)
s_barrier
v_mfma_f32_16x16x32_bf16 v[160:163], a[160:163], a[224:227], v[160:163]
ds_read_b128 a[192:195], v3 offset:0
v_mfma_f32_16x16x32_bf16 v[164:167], a[160:163], a[228:231], v[164:167]
s_add_u32 s37, s31, 0
v_mfma_f32_16x16x32_bf16 v[168:171], a[160:163], a[232:235], v[168:171]
s_add_u32 m0, s33, 0
ds_read_b128 a[196:199], v4 offset:1024
v_mfma_f32_16x16x32_bf16 v[172:175], a[160:163], a[236:239], v[172:175]
buffer_load_dwordx4 v2, s[20:23], s37 offen  lds
v_mfma_f32_16x16x32_bf16 v[176:179], a[160:163], a[240:243], v[176:179]
s_add_u32 s60, s60, s92
ds_read_b128 a[200:203], v3 offset:4096
v_mfma_f32_16x16x32_bf16 v[180:183], a[160:163], a[244:247], v[180:183]
s_mov_b32 s29, s60
v_mfma_f32_16x16x32_bf16 v[184:187], a[160:163], a[248:251], v[184:187]
buffer_store_dwordx4 v[96:99], v13, s[8:11], s29 offen sc1
v_mfma_f32_16x16x32_bf16 v[188:191], a[160:163], a[252:255], v[188:191]
ds_read_b64_tr_b16 a[160:161], v5 offset:0
v_mfma_f32_16x16x32_bf16 v[192:195], a[164:167], a[224:227], v[192:195]
s_add_u32 s37, s31, 32768
ds_read_b64_tr_b16 a[162:163], v5 offset:1024
v_mfma_f32_16x16x32_bf16 v[196:199], a[164:167], a[228:231], v[196:199]
s_add_u32 m0, s33, 1024
ds_read_b128 a[204:207], v4 offset:5120
v_add_u32 v5, 16384, v5
v_mfma_f32_16x16x32_bf16 v[200:203], a[164:167], a[232:235], v[200:203]
buffer_load_dwordx4 v2, s[20:23], s37 offen  lds
v_and_b32 v5, 65535, v5
v_mfma_f32_16x16x32_bf16 v[204:207], a[164:167], a[236:239], v[204:207]
ds_read_b128 a[208:211], v3 offset:8192
v_mfma_f32_16x16x32_bf16 v[208:211], a[164:167], a[240:243], v[208:211]
v_mfma_f32_16x16x32_bf16 v[212:215], a[164:167], a[244:247], v[212:215]
ds_read_b128 a[212:215], v4 offset:9216
v_mfma_f32_16x16x32_bf16 v[216:219], a[164:167], a[248:251], v[216:219]
v_mfma_f32_16x16x32_bf16 v[220:223], a[164:167], a[252:255], v[220:223]
s_add_u32 s37, s31, 131072
ds_read_b64_tr_b16 a[164:165], v6 offset:0
v_mfma_f32_16x16x32_bf16 v[224:227], a[168:171], a[224:227], v[224:227]
s_add_u32 m0, s33, 4096
ds_read_b64_tr_b16 a[166:167], v6 offset:1024
v_mfma_f32_16x16x32_bf16 v[228:231], a[168:171], a[228:231], v[228:231]
buffer_load_dwordx4 v2, s[20:23], s37 offen  lds
v_xor_b32 v6, 16, v5
v_mfma_f32_16x16x32_bf16 v[232:235], a[168:171], a[232:235], v[232:235]
ds_read_b128 a[216:219], v3 offset:12288
v_mfma_f32_16x16x32_bf16 v[236:239], a[168:171], a[236:239], v[236:239]
v_mfma_f32_16x16x32_bf16 v[240:243], a[168:171], a[240:243], v[240:243]
ds_read_b128 a[220:223], v4 offset:13312
v_mfma_f32_16x16x32_bf16 v[244:247], a[168:171], a[244:247], v[244:247]
v_mfma_f32_16x16x32_bf16 v[248:251], a[168:171], a[248:251], v[248:251]
s_add_u32 s37, s31, 163840
ds_read_b64_tr_b16 a[188:189], v12 offset:0
v_mfma_f32_16x16x32_bf16 v[252:255], a[168:171], a[252:255], v[252:255]
s_add_u32 m0, s33, 5120
ds_read_b64_tr_b16 a[168:169], v7 offset:0
v_mfma_f32_16x16x32_bf16 a[0:3], a[172:175], a[224:227], a[0:3]
buffer_load_dwordx4 v2, s[20:23], s37 offen  lds
ds_read_b64_tr_b16 a[170:171], v7 offset:1024
v_mfma_f32_16x16x32_bf16 a[4:7], a[172:175], a[228:231], a[4:7]
s_add_u32 s31, s31, 262144
s_add_u32 s29, s29, s44
v_xor_b32 v7, 64, v5
v_mfma_f32_16x16x32_bf16 a[8:11], a[172:175], a[232:235], a[8:11]
s_add_u32 s33, s33, 16384
ds_read_b64_tr_b16 a[190:191], v12 offset:1024
v_mfma_f32_16x16x32_bf16 a[12:15], a[172:175], a[236:239], a[12:15]
s_and_b32 s33, s33, 65535
buffer_store_dwordx4 v[100:103], v13, s[8:11], s29 offen sc1
v_mfma_f32_16x16x32_bf16 a[16:19], a[172:175], a[240:243], a[16:19]
v_mfma_f32_16x16x32_bf16 a[20:23], a[172:175], a[244:247], a[20:23]
s_mov_b32 s48, s30
v_xor_b32 v12, 208, v5
v_mfma_f32_16x16x32_bf16 a[24:27], a[172:175], a[248:251], a[24:27]
s_add_u32 m0, s32, 0
v_mfma_f32_16x16x32_bf16 a[28:31], a[172:175], a[252:255], a[28:31]
buffer_load_dwordx4 v1, s[12:15], s48 offen lds
ds_read_b64_tr_b16 a[172:173], v8 offset:0
v_mfma_f32_16x16x32_bf16 a[32:35], a[176:179], a[224:227], a[32:35]
ds_read_b64_tr_b16 a[174:175], v8 offset:1024
v_mfma_f32_16x16x32_bf16 a[36:39], a[176:179], a[228:231], a[36:39]
v_xor_b32 v8, 80, v5
v_mfma_f32_16x16x32_bf16 a[40:43], a[176:179], a[232:235], a[40:43]
v_mfma_f32_16x16x32_bf16 a[44:47], a[176:179], a[236:239], a[44:47]
v_mfma_f32_16x16x32_bf16 a[48:51], a[176:179], a[240:243], a[48:51]
s_add_u32 s48, s48, s34
v_mfma_f32_16x16x32_bf16 a[52:55], a[176:179], a[244:247], a[52:55]
s_add_u32 m0, s32, 4096
v_mfma_f32_16x16x32_bf16 a[56:59], a[176:179], a[248:251], a[56:59]
buffer_load_dwordx4 v1, s[12:15], s48 offen lds
v_mfma_f32_16x16x32_bf16 a[60:63], a[176:179], a[252:255], a[60:63]
ds_read_b64_tr_b16 a[176:177], v9 offset:0
v_mfma_f32_16x16x32_bf16 a[64:67], a[180:183], a[224:227], a[64:67]
ds_read_b64_tr_b16 a[178:179], v9 offset:1024
v_mfma_f32_16x16x32_bf16 a[68:71], a[180:183], a[228:231], a[68:71]
v_xor_b32 v9, 128, v5
v_mfma_f32_16x16x32_bf16 a[72:75], a[180:183], a[232:235], a[72:75]
v_mfma_f32_16x16x32_bf16 a[76:79], a[180:183], a[236:239], a[76:79]
s_add_u32 s48, s48, s34
v_mfma_f32_16x16x32_bf16 a[80:83], a[180:183], a[240:243], a[80:83]
s_add_u32 m0, s32, 8192
v_mfma_f32_16x16x32_bf16 a[84:87], a[180:183], a[244:247], a[84:87]
buffer_load_dwordx4 v1, s[12:15], s48 offen lds
v_mfma_f32_16x16x32_bf16 a[88:91], a[180:183], a[248:251], a[88:91]
s_add_u32 s29, s29, s93
v_mfma_f32_16x16x32_bf16 a[92:95], a[180:183], a[252:255], a[92:95]
ds_read_b64_tr_b16 a[180:181], v10 offset:0
v_mfma_f32_16x16x32_bf16 a[96:99], a[184:187], a[224:227], a[96:99]
buffer_store_dwordx4 v[104:107], v13, s[8:11], s29 offen sc1
ds_read_b64_tr_b16 a[182:183], v10 offset:1024
v_mfma_f32_16x16x32_bf16 a[100:103], a[184:187], a[228:231], a[100:103]
v_xor_b32 v10, 144, v5
v_mfma_f32_16x16x32_bf16 a[104:107], a[184:187], a[232:235], a[104:107]
s_add_u32 s48, s48, s34
v_mfma_f32_16x16x32_bf16 a[108:111], a[184:187], a[236:239], a[108:111]
s_add_u32 m0, s32, 12288
v_mfma_f32_16x16x32_bf16 a[112:115], a[184:187], a[240:243], a[112:115]
buffer_load_dwordx4 v1, s[12:15], s48 offen lds
v_mfma_f32_16x16x32_bf16 a[116:119], a[184:187], a[244:247], a[116:119]
v_mfma_f32_16x16x32_bf16 a[120:123], a[184:187], a[248:251], a[120:123]
v_mfma_f32_16x16x32_bf16 a[124:127], a[184:187], a[252:255], a[124:127]
ds_read_b64_tr_b16 a[184:185], v11 offset:0
v_mfma_f32_16x16x32_bf16 a[128:131], v[28:31], a[224:227], a[128:131]
ds_read_b64_tr_b16 a[186:187], v11 offset:1024
v_mfma_f32_16x16x32_bf16 a[132:135], v[28:31], a[228:231], a[132:135]
v_xor_b32 v11, 192, v5
v_mfma_f32_16x16x32_bf16 a[136:139], v[28:31], a[232:235], a[136:139]
buffer_load_dword v15, v14, s[96:99], s100 offen
v_mfma_f32_16x16x32_bf16 a[140:143], v[28:31], a[236:239], a[140:143]
s_add_u32 s100, s100, 16384
v_mfma_f32_16x16x32_bf16 a[144:147], v[28:31], a[240:243], a[144:147]
v_mfma_f32_16x16x32_bf16 a[148:151], v[28:31], a[244:247], a[148:151]
v_mfma_f32_16x16x32_bf16 a[152:155], v[28:31], a[248:251], a[152:155]
v_mfma_f32_16x16x32_bf16 a[156:159], v[28:31], a[252:255], a[156:159]
s_waitcnt vmcnt(23) lgkmcnt(0)
s_barrier
v_mfma_f32_16x16x32_bf16 v[160:163], a[160:163], a[192:195], v[160:163]
ds_read_b128 a[224:227], v4 offset:0
v_mfma_f32_16x16x32_bf16 v[164:167], a[160:163], a[196:199], v[164:167]
s_add_u32 s37, s31, 0
v_mfma_f32_16x16x32_bf16 v[168:171], a[160:163], a[200:203], v[168:171]
s_add_u32 m0, s33, 0
ds_read_b128 a[228:231], v3 offset:1024
v_mfma_f32_16x16x32_bf16 v[172:175], a[160:163], a[204:207], v[172:175]
buffer_load_dwordx4 v2, s[20:23], s37 offen  lds
v_mfma_f32_16x16x32_bf16 v[176:179], a[160:163], a[208:211], v[176:179]
s_add_u32 s29, s29, s44
ds_read_b128 a[232:235], v4 offset:4096
v_mfma_f32_16x16x32_bf16 v[180:183], a[160:163], a[212:215], v[180:183]
v_mfma_f32_16x16x32_bf16 v[184:187], a[160:163], a[216:219], v[184:187]
buffer_store_dwordx4 v[108:111], v13, s[8:11], s29 offen sc1
v_mfma_f32_16x16x32_bf16 v[188:191], a[160:163], a[220:223], v[188:191]
ds_read_b64_tr_b16 a[160:161], v5 offset:0
v_mfma_f32_16x16x32_bf16 v[192:195], a[164:167], a[192:195], v[192:195]
s_add_u32 s37, s31, 32768
ds_read_b64_tr_b16 a[162:163], v5 offset:1024
v_mfma_f32_16x16x32_bf16 v[196:199], a[164:167], a[196:199], v[196:199]
s_add_u32 m0, s33, 1024
ds_read_b128 a[236:239], v3 offset:5120
v_add_u32 v5, 16384, v5
v_mfma_f32_16x16x32_bf16 v[200:203], a[164:167], a[200:203], v[200:203]
buffer_load_dwordx4 v2, s[20:23], s37 offen  lds
v_and_b32 v5, 65535, v5
v_mfma_f32_16x16x32_bf16 v[204:207], a[164:167], a[204:207], v[204:207]
ds_read_b128 a[240:243], v4 offset:8192
v_mfma_f32_16x16x32_bf16 v[208:211], a[164:167], a[208:211], v[208:211]
v_mfma_f32_16x16x32_bf16 v[212:215], a[164:167], a[212:215], v[212:215]
ds_read_b128 a[244:247], v3 offset:9216
v_mfma_f32_16x16x32_bf16 v[216:219], a[164:167], a[216:219], v[216:219]
v_mfma_f32_16x16x32_bf16 v[220:223], a[164:167], a[220:223], v[220:223]
s_add_u32 s37, s31, 131072
ds_read_b64_tr_b16 a[164:165], v6 offset:0
v_mfma_f32_16x16x32_bf16 v[224:227], a[168:171], a[192:195], v[224:227]
s_add_u32 m0, s33, 4096
ds_read_b64_tr_b16 a[166:167], v6 offset:1024
v_mfma_f32_16x16x32_bf16 v[228:231], a[168:171], a[196:199], v[228:231]
buffer_load_dwordx4 v2, s[20:23], s37 offen  lds
v_xor_b32 v6, 16, v5
v_mfma_f32_16x16x32_bf16 v[232:235], a[168:171], a[200:203], v[232:235]
ds_read_b128 a[248:251], v4 offset:12288
v_mfma_f32_16x16x32_bf16 v[236:239], a[168:171], a[204:207], v[236:239]
v_mfma_f32_16x16x32_bf16 v[240:243], a[168:171], a[208:211], v[240:243]
ds_read_b128 a[252:255], v3 offset:13312
v_mfma_f32_16x16x32_bf16 v[244:247], a[168:171], a[212:215], v[244:247]
v_mfma_f32_16x16x32_bf16 v[248:251], a[168:171], a[216:219], v[248:251]
s_add_u32 s37, s31, 163840
ds_read_b64_tr_b16 v[28:29], v12 offset:0
v_mfma_f32_16x16x32_bf16 v[252:255], a[168:171], a[220:223], v[252:255]
s_add_u32 m0, s33, 5120
ds_read_b64_tr_b16 a[168:169], v7 offset:0
v_mfma_f32_16x16x32_bf16 a[0:3], a[172:175], a[192:195], a[0:3]
buffer_load_dwordx4 v2, s[20:23], s37 offen  lds
ds_read_b64_tr_b16 a[170:171], v7 offset:1024
v_mfma_f32_16x16x32_bf16 a[4:7], a[172:175], a[196:199], a[4:7]
s_add_u32 s31, s31, 262144
s_add_u32 s29, s29, s93
v_xor_b32 v7, 64, v5
v_mfma_f32_16x16x32_bf16 a[8:11], a[172:175], a[200:203], a[8:11]
s_add_u32 s33, s33, 16384
ds_read_b64_tr_b16 v[30:31], v12 offset:1024
v_mfma_f32_16x16x32_bf16 a[12:15], a[172:175], a[204:207], a[12:15]
s_and_b32 s33, s33, 65535
buffer_store_dwordx4 v[112:115], v13, s[8:11], s29 offen sc1
v_mfma_f32_16x16x32_bf16 a[16:19], a[172:175], a[208:211], a[16:19]
v_mfma_f32_16x16x32_bf16 a[20:23], a[172:175], a[212:215], a[20:23]
s_add_u32 s48, s48, s34
v_xor_b32 v12, 208, v5
v_mfma_f32_16x16x32_bf16 a[24:27], a[172:175], a[216:219], a[24:27]
s_add_u32 m0, s32, 16384
v_add_u32 v3, 32768, v3
v_mfma_f32_16x16x32_bf16 a[28:31], a[172:175], a[220:223], a[28:31]
buffer_load_dwordx4 v1, s[12:15], s48 offen lds
ds_read_b64_tr_b16 a[172:173], v8 offset:0
v_mfma_f32_16x16x32_bf16 a[32:35], a[176:179], a[192:195], a[32:35]
ds_read_b64_tr_b16 a[174:175], v8 offset:1024
v_subrev_u32 v19, 98304, v3
v_mfma_f32_16x16x32_bf16 a[36:39], a[176:179], a[196:199], a[36:39]
v_xor_b32 v8, 80, v5
v_cmp_le_u32 vcc, 163840, v3
v_mfma_f32_16x16x32_bf16 a[40:43], a[176:179], a[200:203], a[40:43]
s_nop 0
v_cndmask_b32 v3, v3, v19, vcc
v_mfma_f32_16x16x32_bf16 a[44:47], a[176:179], a[204:207], a[44:47]
v_xor_b32 v4, 64, v3
v_mfma_f32_16x16x32_bf16 a[48:51], a[176:179], a[208:211], a[48:51]
s_add_u32 s48, s48, s34
v_mfma_f32_16x16x32_bf16 a[52:55], a[176:179], a[212:215], a[52:55]
s_add_u32 m0, s32, 20480
v_mfma_f32_16x16x32_bf16 a[56:59], a[176:179], a[216:219], a[56:59]
buffer_load_dwordx4 v1, s[12:15], s48 offen lds
v_mfma_f32_16x16x32_bf16 a[60:63], a[176:179], a[220:223], a[60:63]
ds_read_b64_tr_b16 a[176:177], v9 offset:0
v_mfma_f32_16x16x32_bf16 a[64:67], a[180:183], a[192:195], a[64:67]
ds_read_b64_tr_b16 a[178:179], v9 offset:1024
v_mfma_f32_16x16x32_bf16 a[68:71], a[180:183], a[196:199], a[68:71]
v_xor_b32 v9, 128, v5
v_mfma_f32_16x16x32_bf16 a[72:75], a[180:183], a[200:203], a[72:75]
v_mfma_f32_16x16x32_bf16 a[76:79], a[180:183], a[204:207], a[76:79]
s_add_u32 s48, s48, s34
v_mfma_f32_16x16x32_bf16 a[80:83], a[180:183], a[208:211], a[80:83]
s_add_u32 m0, s32, 24576
v_mfma_f32_16x16x32_bf16 a[84:87], a[180:183], a[212:215], a[84:87]
buffer_load_dwordx4 v1, s[12:15], s48 offen lds
v_mfma_f32_16x16x32_bf16 a[88:91], a[180:183], a[216:219], a[88:91]
s_add_u32 s29, s29, s44
v_mfma_f32_16x16x32_bf16 a[92:95], a[180:183], a[220:223], a[92:95]
ds_read_b64_tr_b16 a[180:181], v10 offset:0
v_mfma_f32_16x16x32_bf16 a[96:99], a[184:187], a[192:195], a[96:99]
buffer_store_dwordx4 v[116:119], v13, s[8:11], s29 offen sc1
ds_read_b64_tr_b16 a[182:183], v10 offset:1024
v_mfma_f32_16x16x32_bf16 a[100:103], a[184:187], a[196:199], a[100:103]
v_xor_b32 v10, 144, v5
v_mfma_f32_16x16x32_bf16 a[104:107], a[184:187], a[200:203], a[104:107]
s_add_u32 s48, s48, s34
v_mfma_f32_16x16x32_bf16 a[108:111], a[184:187], a[204:207], a[108:111]
s_add_u32 m0, s32, 28672
v_mfma_f32_16x16x32_bf16 a[112:115], a[184:187], a[208:211], a[112:115]
buffer_load_dwordx4 v1, s[12:15], s48 offen lds
v_mfma_f32_16x16x32_bf16 a[116:119], a[184:187], a[212:215], a[116:119]
s_add_u32 s30, s30, 128
v_mfma_f32_16x16x32_bf16 a[120:123], a[184:187], a[216:219], a[120:123]
s_add_u32 s32, s32, 32768
v_mfma_f32_16x16x32_bf16 a[124:127], a[184:187], a[220:223], a[124:127]
s_sub_u32 s48, s32, 98304
ds_read_b64_tr_b16 a[184:185], v11 offset:0
v_mfma_f32_16x16x32_bf16 a[128:131], a[188:191], a[192:195], a[128:131]
s_cmp_ge_u32 s32, 163840
s_cselect_b32 s32, s48, s32
ds_read_b64_tr_b16 a[186:187], v11 offset:1024
v_mfma_f32_16x16x32_bf16 a[132:135], a[188:191], a[196:199], a[132:135]
v_xor_b32 v11, 192, v5
v_mfma_f32_16x16x32_bf16 a[136:139], a[188:191], a[200:203], a[136:139]
buffer_load_dword v15, v14, s[96:99], s100 offen
v_mfma_f32_16x16x32_bf16 a[140:143], a[188:191], a[204:207], a[140:143]
s_add_u32 s100, s100, 16384
v_mfma_f32_16x16x32_bf16 a[144:147], a[188:191], a[208:211], a[144:147]
v_mfma_f32_16x16x32_bf16 a[148:151], a[188:191], a[212:215], a[148:151]
v_mfma_f32_16x16x32_bf16 a[152:155], a[188:191], a[216:219], a[152:155]
v_mfma_f32_16x16x32_bf16 a[156:159], a[188:191], a[220:223], a[156:159]
s_waitcnt vmcnt(24) lgkmcnt(0)
s_barrier
v_mfma_f32_16x16x32_bf16 v[160:163], a[160:163], a[224:227], v[160:163]
ds_read_b128 a[192:195], v3 offset:0
v_mfma_f32_16x16x32_bf16 v[164:167], a[160:163], a[228:231], v[164:167]
s_add_u32 s37, s31, 0
v_mfma_f32_16x16x32_bf16 v[168:171], a[160:163], a[232:235], v[168:171]
s_add_u32 m0, s33, 0
ds_read_b128 a[196:199], v4 offset:1024
v_mfma_f32_16x16x32_bf16 v[172:175], a[160:163], a[236:239], v[172:175]
buffer_load_dwordx4 v2, s[20:23], s37 offen  lds
v_mfma_f32_16x16x32_bf16 v[176:179], a[160:163], a[240:243], v[176:179]
s_add_u32 s29, s29, s93
ds_read_b128 a[200:203], v3 offset:4096
v_mfma_f32_16x16x32_bf16 v[180:183], a[160:163], a[244:247], v[180:183]
v_mfma_f32_16x16x32_bf16 v[184:187], a[160:163], a[248:251], v[184:187]
buffer_store_dwordx4 v[120:123], v13, s[8:11], s29 offen sc1
v_mfma_f32_16x16x32_bf16 v[188:191], a[160:163], a[252:255], v[188:191]
ds_read_b64_tr_b16 a[160:161], v5 offset:0
v_mfma_f32_16x16x32_bf16 v[192:195], a[164:167], a[224:227], v[192:195]
s_add_u32 s37, s31, 32768
ds_read_b64_tr_b16 a[162:163], v5 offset:1024
v_mfma_f32_16x16x32_bf16 v[196:199], a[164:167], a[228:231], v[196:199]
s_add_u32 m0, s33, 1024
ds_read_b128 a[204:207], v4 offset:5120
v_add_u32 v5, 16384, v5
v_mfma_f32_16x16x32_bf16 v[200:203], a[164:167], a[232:235], v[200:203]
buffer_load_dwordx4 v2, s[20:23], s37 offen  lds
v_and_b32 v5, 65535, v5
v_mfma_f32_16x16x32_bf16 v[204:207], a[164:167], a[236:239], v[204:207]
ds_read_b128 a[208:211], v3 offset:8192
v_mfma_f32_16x16x32_bf16 v[208:211], a[164:167], a[240:243], v[208:211]
v_mfma_f32_16x16x32_bf16 v[212:215], a[164:167], a[244:247], v[212:215]
ds_read_b128 a[212:215], v4 offset:9216
v_mfma_f32_16x16x32_bf16 v[216:219], a[164:167], a[248:251], v[216:219]
v_mfma_f32_16x16x32_bf16 v[220:223], a[164:167], a[252:255], v[220:223]
s_add_u32 s37, s31, 131072
ds_read_b64_tr_b16 a[164:165], v6 offset:0
v_mfma_f32_16x16x32_bf16 v[224:227], a[168:171], a[224:227], v[224:227]
s_add_u32 m0, s33, 4096
ds_read_b64_tr_b16 a[166:167], v6 offset:1024
v_mfma_f32_16x16x32_bf16 v[228:231], a[168:171], a[228:231], v[228:231]
buffer_load_dwordx4 v2, s[20:23], s37 offen  lds
v_xor_b32 v6, 16, v5
v_mfma_f32_16x16x32_bf16 v[232:235], a[168:171], a[232:235], v[232:235]
ds_read_b128 a[216:219], v3 offset:12288
v_mfma_f32_16x16x32_bf16 v[236:239], a[168:171], a[236:239], v[236:239]
v_mfma_f32_16x16x32_bf16 v[240:243], a[168:171], a[240:243], v[240:243]
ds_read_b128 a[220:223], v4 offset:13312
v_mfma_f32_16x16x32_bf16 v[244:247], a[168:171], a[244:247], v[244:247]
v_mfma_f32_16x16x32_bf16 v[248:251], a[168:171], a[248:251], v[248:251]
s_add_u32 s37, s31, 163840
ds_read_b64_tr_b16 a[188:189], v12 offset:0
v_mfma_f32_16x16x32_bf16 v[252:255], a[168:171], a[252:255], v[252:255]
s_add_u32 m0, s33, 5120
ds_read_b64_tr_b16 a[168:169], v7 offset:0
v_mfma_f32_16x16x32_bf16 a[0:3], a[172:175], a[224:227], a[0:3]
buffer_load_dwordx4 v2, s[20:23], s37 offen  lds
ds_read_b64_tr_b16 a[170:171], v7 offset:1024
v_mfma_f32_16x16x32_bf16 a[4:7], a[172:175], a[228:231], a[4:7]
s_add_u32 s31, s31, 262144
s_add_u32 s29, s29, s44
v_xor_b32 v7, 64, v5
v_mfma_f32_16x16x32_bf16 a[8:11], a[172:175], a[232:235], a[8:11]
s_add_u32 s33, s33, 16384
ds_read_b64_tr_b16 a[190:191], v12 offset:1024
v_mfma_f32_16x16x32_bf16 a[12:15], a[172:175], a[236:239], a[12:15]
s_and_b32 s33, s33, 65535
buffer_store_dwordx4 v[124:127], v13, s[8:11], s29 offen sc1
v_mfma_f32_16x16x32_bf16 a[16:19], a[172:175], a[240:243], a[16:19]
v_mfma_f32_16x16x32_bf16 a[20:23], a[172:175], a[244:247], a[20:23]
s_mov_b32 s48, s30
v_xor_b32 v12, 208, v5
v_mfma_f32_16x16x32_bf16 a[24:27], a[172:175], a[248:251], a[24:27]
s_add_u32 m0, s32, 0
v_mfma_f32_16x16x32_bf16 a[28:31], a[172:175], a[252:255], a[28:31]
buffer_load_dwordx4 v1, s[12:15], s48 offen lds
ds_read_b64_tr_b16 a[172:173], v8 offset:0
v_mfma_f32_16x16x32_bf16 a[32:35], a[176:179], a[224:227], a[32:35]
ds_read_b64_tr_b16 a[174:175], v8 offset:1024
v_mfma_f32_16x16x32_bf16 a[36:39], a[176:179], a[228:231], a[36:39]
v_xor_b32 v8, 80, v5
v_mfma_f32_16x16x32_bf16 a[40:43], a[176:179], a[232:235], a[40:43]
v_mfma_f32_16x16x32_bf16 a[44:47], a[176:179], a[236:239], a[44:47]
v_mfma_f32_16x16x32_bf16 a[48:51], a[176:179], a[240:243], a[48:51]
s_add_u32 s48, s48, s34
v_mfma_f32_16x16x32_bf16 a[52:55], a[176:179], a[244:247], a[52:55]
s_add_u32 m0, s32, 4096
v_mfma_f32_16x16x32_bf16 a[56:59], a[176:179], a[248:251], a[56:59]
buffer_load_dwordx4 v1, s[12:15], s48 offen lds
v_mfma_f32_16x16x32_bf16 a[60:63], a[176:179], a[252:255], a[60:63]
ds_read_b64_tr_b16 a[176:177], v9 offset:0
v_mfma_f32_16x16x32_bf16 a[64:67], a[180:183], a[224:227], a[64:67]
ds_read_b64_tr_b16 a[178:179], v9 offset:1024
v_mfma_f32_16x16x32_bf16 a[68:71], a[180:183], a[228:231], a[68:71]
v_xor_b32 v9, 128, v5
v_mfma_f32_16x16x32_bf16 a[72:75], a[180:183], a[232:235], a[72:75]
v_mfma_f32_16x16x32_bf16 a[76:79], a[180:183], a[236:239], a[76:79]
s_add_u32 s48, s48, s34
v_mfma_f32_16x16x32_bf16 a[80:83], a[180:183], a[240:243], a[80:83]
s_add_u32 m0, s32, 8192
v_mfma_f32_16x16x32_bf16 a[84:87], a[180:183], a[244:247], a[84:87]
buffer_load_dwordx4 v1, s[12:15], s48 offen lds
v_mfma_f32_16x16x32_bf16 a[88:91], a[180:183], a[248:251], a[88:91]
v_mfma_f32_16x16x32_bf16 a[92:95], a[180:183], a[252:255], a[92:95]
ds_read_b64_tr_b16 a[180:181], v10 offset:0
v_mfma_f32_16x16x32_bf16 a[96:99], a[184:187], a[224:227], a[96:99]
ds_read_b64_tr_b16 a[182:183], v10 offset:1024
v_mfma_f32_16x16x32_bf16 a[100:103], a[184:187], a[228:231], a[100:103]
v_xor_b32 v10, 144, v5
v_mfma_f32_16x16x32_bf16 a[104:107], a[184:187], a[232:235], a[104:107]
s_add_u32 s48, s48, s34
v_mfma_f32_16x16x32_bf16 a[108:111], a[184:187], a[236:239], a[108:111]
s_add_u32 m0, s32, 12288
v_mfma_f32_16x16x32_bf16 a[112:115], a[184:187], a[240:243], a[112:115]
buffer_load_dwordx4 v1, s[12:15], s48 offen lds
v_mfma_f32_16x16x32_bf16 a[116:119], a[184:187], a[244:247], a[116:119]
v_mfma_f32_16x16x32_bf16 a[120:123], a[184:187], a[248:251], a[120:123]
v_mfma_f32_16x16x32_bf16 a[124:127], a[184:187], a[252:255], a[124:127]
ds_read_b64_tr_b16 a[184:185], v11 offset:0
v_mfma_f32_16x16x32_bf16 a[128:131], v[28:31], a[224:227], a[128:131]
ds_read_b64_tr_b16 a[186:187], v11 offset:1024
v_mfma_f32_16x16x32_bf16 a[132:135], v[28:31], a[228:231], a[132:135]
v_xor_b32 v11, 192, v5
v_mfma_f32_16x16x32_bf16 a[136:139], v[28:31], a[232:235], a[136:139]
buffer_load_dword v15, v14, s[96:99], s100 offen
v_mfma_f32_16x16x32_bf16 a[140:143], v[28:31], a[236:239], a[140:143]
s_add_u32 s100, s100, 16384
v_mfma_f32_16x16x32_bf16 a[144:147], v[28:31], a[240:243], a[144:147]
v_mfma_f32_16x16x32_bf16 a[148:151], v[28:31], a[244:247], a[148:151]
v_mfma_f32_16x16x32_bf16 a[152:155], v[28:31], a[248:251], a[152:155]
v_mfma_f32_16x16x32_bf16 a[156:159], v[28:31], a[252:255], a[156:159]
s_cmp_eq_u32 s36, 0
s_cbranch_scc1 L_g_k12
s_waitcnt vmcnt(23) lgkmcnt(0)
s_barrier
v_mfma_f32_16x16x32_bf16 v[160:163], a[160:163], a[192:195], v[160:163]
ds_read_b128 a[224:227], v4 offset:0
v_mfma_f32_16x16x32_bf16 v[164:167], a[160:163], a[196:199], v[164:167]
s_add_u32 s37, s31, 0
v_mfma_f32_16x16x32_bf16 v[168:171], a[160:163], a[200:203], v[168:171]
s_add_u32 m0, s33, 0
ds_read_b128 a[228:231], v3 offset:1024
v_mfma_f32_16x16x32_bf16 v[172:175], a[160:163], a[204:207], v[172:175]
buffer_load_dwordx4 v2, s[20:23], s37 offen  lds
v_mfma_f32_16x16x32_bf16 v[176:179], a[160:163], a[208:211], v[176:179]
ds_read_b128 a[232:235], v4 offset:4096
v_mfma_f32_16x16x32_bf16 v[180:183], a[160:163], a[212:215], v[180:183]
v_mfma_f32_16x16x32_bf16 v[184:187], a[160:163], a[216:219], v[184:187]
ds_read_b128 a[236:239], v3 offset:5120
v_mfma_f32_16x16x32_bf16 v[188:191], a[160:163], a[220:223], v[188:191]
ds_read_b64_tr_b16 a[160:161], v5 offset:0
v_mfma_f32_16x16x32_bf16 v[192:195], a[164:167], a[192:195], v[192:195]
s_add_u32 s37, s31, 32768
ds_read_b64_tr_b16 a[162:163], v5 offset:1024
v_mfma_f32_16x16x32_bf16 v[196:199], a[164:167], a[196:199], v[196:199]
s_add_u32 m0, s33, 1024
ds_read_b128 a[240:243], v4 offset:8192
v_add_u32 v5, 16384, v5
v_mfma_f32_16x16x32_bf16 v[200:203], a[164:167], a[200:203], v[200:203]
buffer_load_dwordx4 v2, s[20:23], s37 offen  lds
v_and_b32 v5, 65535, v5
v_mfma_f32_16x16x32_bf16 v[204:207], a[164:167], a[204:207], v[204:207]
ds_read_b128 a[244:247], v3 offset:9216
v_mfma_f32_16x16x32_bf16 v[208:211], a[164:167], a[208:211], v[208:211]
v_mfma_f32_16x16x32_bf16 v[212:215], a[164:167], a[212:215], v[212:215]
ds_read_b128 a[248:251], v4 offset:12288
v_mfma_f32_16x16x32_bf16 v[216:219], a[164:167], a[216:219], v[216:219]
v_mfma_f32_16x16x32_bf16 v[220:223], a[164:167], a[220:223], v[220:223]
s_add_u32 s37, s31, 131072
ds_read_b64_tr_b16 a[164:165], v6 offset:0
v_mfma_f32_16x16x32_bf16 v[224:227], a[168:171], a[192:195], v[224:227]
s_add_u32 m0, s33, 4096
ds_read_b64_tr_b16 a[166:167], v6 offset:1024
v_mfma_f32_16x16x32_bf16 v[228:231], a[168:171], a[196:199], v[228:231]
buffer_load_dwordx4 v2, s[20:23], s37 offen  lds
v_xor_b32 v6, 16, v5
v_mfma_f32_16x16x32_bf16 v[232:235], a[168:171], a[200:203], v[232:235]
ds_read_b128 a[252:255], v3 offset:13312
v_mfma_f32_16x16x32_bf16 v[236:239], a[168:171], a[204:207], v[236:239]
v_mfma_f32_16x16x32_bf16 v[240:243], a[168:171], a[208:211], v[240:243]
ds_read_b64_tr_b16 v[28:29], v12 offset:0
v_mfma_f32_16x16x32_bf16 v[244:247], a[168:171], a[212:215], v[244:247]
v_mfma_f32_16x16x32_bf16 v[248:251], a[168:171], a[216:219], v[248:251]
s_add_u32 s37, s31, 163840
ds_read_b64_tr_b16 v[30:31], v12 offset:1024
v_mfma_f32_16x16x32_bf16 v[252:255], a[168:171], a[220:223], v[252:255]
s_add_u32 m0, s33, 5120
ds_read_b64_tr_b16 a[168:169], v7 offset:0
v_mfma_f32_16x16x32_bf16 a[0:3], a[172:175], a[192:195], a[0:3]
buffer_load_dwordx4 v2, s[20:23], s37 offen  lds
ds_read_b64_tr_b16 a[170:171], v7 offset:1024
v_mfma_f32_16x16x32_bf16 a[4:7], a[172:175], a[196:199], a[4:7]
s_add_u32 s31, s31, 262144
v_xor_b32 v7, 64, v5
v_xor_b32 v12, 208, v5
v_mfma_f32_16x16x32_bf16 a[8:11], a[172:175], a[200:203], a[8:11]
s_add_u32 s33, s33, 16384
v_add_u32 v3, 32768, v3
v_mfma_f32_16x16x32_bf16 a[12:15], a[172:175], a[204:207], a[12:15]
s_and_b32 s33, s33, 65535
v_subrev_u32 v19, 98304, v3
v_mfma_f32_16x16x32_bf16 a[16:19], a[172:175], a[208:211], a[16:19]
v_cmp_le_u32 vcc, 163840, v3
v_mfma_f32_16x16x32_bf16 a[20:23], a[172:175], a[212:215], a[20:23]
s_add_u32 s48, s48, s34
v_cndmask_b32 v3, v3, v19, vcc
v_mfma_f32_16x16x32_bf16 a[24:27], a[172:175], a[216:219], a[24:27]
s_add_u32 m0, s32, 16384
v_xor_b32 v4, 64, v3
v_mfma_f32_16x16x32_bf16 a[28:31], a[172:175], a[220:223], a[28:31]
buffer_load_dwordx4 v1, s[12:15], s48 offen lds
ds_read_b64_tr_b16 a[172:173], v8 offset:0
v_mfma_f32_16x16x32_bf16 a[32:35], a[176:179], a[192:195], a[32:35]
ds_read_b64_tr_b16 a[174:175], v8 offset:1024
v_mfma_f32_16x16x32_bf16 a[36:39], a[176:179], a[196:199], a[36:39]
v_xor_b32 v8, 80, v5
v_mfma_f32_16x16x32_bf16 a[40:43], a[176:179], a[200:203], a[40:43]
v_mfma_f32_16x16x32_bf16 a[44:47], a[176:179], a[204:207], a[44:47]
v_mfma_f32_16x16x32_bf16 a[48:51], a[176:179], a[208:211], a[48:51]
s_add_u32 s48, s48, s34
v_mfma_f32_16x16x32_bf16 a[52:55], a[176:179], a[212:215], a[52:55]
s_add_u32 m0, s32, 20480
v_mfma_f32_16x16x32_bf16 a[56:59], a[176:179], a[216:219], a[56:59]
buffer_load_dwordx4 v1, s[12:15], s48 offen lds
v_mfma_f32_16x16x32_bf16 a[60:63], a[176:179], a[220:223], a[60:63]
ds_read_b64_tr_b16 a[176:177], v9 offset:0
v_mfma_f32_16x16x32_bf16 a[64:67], a[180:183], a[192:195], a[64:67]
ds_read_b64_tr_b16 a[178:179], v9 offset:1024
v_mfma_f32_16x16x32_bf16 a[68:71], a[180:183], a[196:199], a[68:71]
v_xor_b32 v9, 128, v5
v_mfma_f32_16x16x32_bf16 a[72:75], a[180:183], a[200:203], a[72:75]
v_mfma_f32_16x16x32_bf16 a[76:79], a[180:183], a[204:207], a[76:79]
s_add_u32 s48, s48, s34
v_mfma_f32_16x16x32_bf16 a[80:83], a[180:183], a[208:211], a[80:83]
s_add_u32 m0, s32, 24576
v_mfma_f32_16x16x32_bf16 a[84:87], a[180:183], a[212:215], a[84:87]
buffer_load_dwordx4 v1, s[12:15], s48 offen lds
v_mfma_f32_16x16x32_bf16 a[88:91], a[180:183], a[216:219], a[88:91]
v_mfma_f32_16x16x32_bf16 a[92:95], a[180:183], a[220:223], a[92:95]
ds_read_b64_tr_b16 a[180:181], v10 offset:0
v_mfma_f32_16x16x32_bf16 a[96:99], a[184:187], a[192:195], a[96:99]
ds_read_b64_tr_b16 a[182:183], v10 offset:1024
v_mfma_f32_16x16x32_bf16 a[100:103], a[184:187], a[196:199], a[100:103]
v_xor_b32 v10, 144, v5
v_mfma_f32_16x16x32_bf16 a[104:107], a[184:187], a[200:203], a[104:107]
s_add_u32 s48, s48, s34
v_mfma_f32_16x16x32_bf16 a[108:111], a[184:187], a[204:207], a[108:111]
s_add_u32 m0, s32, 28672
v_mfma_f32_16x16x32_bf16 a[112:115], a[184:187], a[208:211], a[112:115]
buffer_load_dwordx4 v1, s[12:15], s48 offen lds
v_mfma_f32_16x16x32_bf16 a[116:119], a[184:187], a[212:215], a[116:119]
s_add_u32 s30, s30, 128
v_mfma_f32_16x16x32_bf16 a[120:123], a[184:187], a[216:219], a[120:123]
s_add_u32 s32, s32, 32768
v_mfma_f32_16x16x32_bf16 a[124:127], a[184:187], a[220:223], a[124:127]
s_sub_u32 s48, s32, 98304
ds_read_b64_tr_b16 a[184:185], v11 offset:0
v_mfma_f32_16x16x32_bf16 a[128:131], a[188:191], a[192:195], a[128:131]
s_cmp_ge_u32 s32, 163840
s_cselect_b32 s32, s48, s32
ds_read_b64_tr_b16 a[186:187], v11 offset:1024
v_mfma_f32_16x16x32_bf16 a[132:135], a[188:191], a[196:199], a[132:135]
v_xor_b32 v11, 192, v5
v_mfma_f32_16x16x32_bf16 a[136:139], a[188:191], a[200:203], a[136:139]
v_mfma_f32_16x16x32_bf16 a[140:143], a[188:191], a[204:207], a[140:143]
v_mfma_f32_16x16x32_bf16 a[144:147], a[188:191], a[208:211], a[144:147]
v_mfma_f32_16x16x32_bf16 a[148:151], a[188:191], a[212:215], a[148:151]
v_mfma_f32_16x16x32_bf16 a[152:155], a[188:191], a[216:219], a[152:155]
v_mfma_f32_16x16x32_bf16 a[156:159], a[188:191], a[220:223], a[156:159]
s_waitcnt vmcnt(19) lgkmcnt(0)
s_barrier
v_mfma_f32_16x16x32_bf16 v[160:163], a[160:163], a[224:227], v[160:163]
ds_read_b128 a[192:195], v3 offset:0
v_mfma_f32_16x16x32_bf16 v[164:167], a[160:163], a[228:231], v[164:167]
s_add_u32 s37, s31, 0
v_mfma_f32_16x16x32_bf16 v[168:171], a[160:163], a[232:235], v[168:171]
s_add_u32 m0, s33, 0
ds_read_b128 a[196:199], v4 offset:1024
v_mfma_f32_16x16x32_bf16 v[172:175], a[160:163], a[236:239], v[172:175]
buffer_load_dwordx4 v2, s[20:23], s37 offen  lds
v_mfma_f32_16x16x32_bf16 v[176:179], a[160:163], a[240:243], v[176:179]
ds_read_b128 a[200:203], v3 offset:4096
v_mfma_f32_16x16x32_bf16 v[180:183], a[160:163], a[244:247], v[180:183]
v_mfma_f32_16x16x32_bf16 v[184:187], a[160:163], a[248:251], v[184:187]
ds_read_b128 a[204:207], v4 offset:5120
v_mfma_f32_16x16x32_bf16 v[188:191], a[160:163], a[252:255], v[188:191]
ds_read_b64_tr_b16 a[160:161], v5 offset:0
v_mfma_f32_16x16x32_bf16 v[192:195], a[164:167], a[224:227], v[192:195]
s_add_u32 s37, s31, 32768
ds_read_b64_tr_b16 a[162:163], v5 offset:1024
v_mfma_f32_16x16x32_bf16 v[196:199], a[164:167], a[228:231], v[196:199]
s_add_u32 m0, s33, 1024
ds_read_b128 a[208:211], v3 offset:8192
v_add_u32 v5, 16384, v5
v_mfma_f32_16x16x32_bf16 v[200:203], a[164:167], a[232:235], v[200:203]
buffer_load_dwordx4 v2, s[20:23], s37 offen  lds
v_and_b32 v5, 65535, v5
v_mfma_f32_16x16x32_bf16 v[204:207], a[164:167], a[236:239], v[204:207]
ds_read_b128 a[212:215], v4 offset:9216
v_mfma_f32_16x16x32_bf16 v[208:211], a[164:167], a[240:243], v[208:211]
v_mfma_f32_16x16x32_bf16 v[212:215], a[164:167], a[244:247], v[212:215]
ds_read_b128 a[216:219], v3 offset:12288
v_mfma_f32_16x16x32_bf16 v[216:219], a[164:167], a[248:251], v[216:219]
v_mfma_f32_16x16x32_bf16 v[220:223], a[164:167], a[252:255], v[220:223]
s_add_u32 s37, s31, 131072
ds_read_b64_tr_b16 a[164:165], v6 offset:0
v_mfma_f32_16x16x32_bf16 v[224:227], a[168:171], a[224:227], v[224:227]
s_add_u32 m0, s33, 4096
ds_read_b64_tr_b16 a[166:167], v6 offset:1024
v_mfma_f32_16x16x32_bf16 v[228:231], a[168:171], a[228:231], v[228:231]
buffer_load_dwordx4 v2, s[20:23], s37 offen  lds
v_xor_b32 v6, 16, v5
v_mfma_f32_16x16x32_bf16 v[232:235], a[168:171], a[232:235], v[232:235]
ds_read_b128 a[220:223], v4 offset:13312
v_mfma_f32_16x16x32_bf16 v[236:239], a[168:171], a[236:239], v[236:239]
v_mfma_f32_16x16x32_bf16 v[240:243], a[168:171], a[240:243], v[240:243]
ds_read_b64_tr_b16 a[188:189], v12 offset:0
v_mfma_f32_16x16x32_bf16 v[244:247], a[168:171], a[244:247], v[244:247]
v_mfma_f32_16x16x32_bf16 v[248:251], a[168:171], a[248:251], v[248:251]
s_add_u32 s37, s31, 163840
ds_read_b64_tr_b16 a[190:191], v12 offset:1024
v_mfma_f32_16x16x32_bf16 v[252:255], a[168:171], a[252:255], v[252:255]
s_add_u32 m0, s33, 5120
ds_read_b64_tr_b16 a[168:169], v7 offset:0
v_mfma_f32_16x16x32_bf16 a[0:3], a[172:175], a[224:227], a[0:3]
buffer_load_dwordx4 v2, s[20:23], s37 offen  lds
ds_read_b64_tr_b16 a[170:171], v7 offset:1024
v_mfma_f32_16x16x32_bf16 a[4:7], a[172:175], a[228:231], a[4:7]
s_add_u32 s31, s31, 262144
v_xor_b32 v7, 64, v5
v_xor_b32 v12, 208, v5
v_mfma_f32_16x16x32_bf16 a[8:11], a[172:175], a[232:235], a[8:11]
s_add_u32 s33, s33, 16384
v_mfma_f32_16x16x32_bf16 a[12:15], a[172:175], a[236:239], a[12:15]
s_and_b32 s33, s33, 65535
v_mfma_f32_16x16x32_bf16 a[16:19], a[172:175], a[240:243], a[16:19]
v_mfma_f32_16x16x32_bf16 a[20:23], a[172:175], a[244:247], a[20:23]
s_mov_b32 s48, s30
v_mfma_f32_16x16x32_bf16 a[24:27], a[172:175], a[248:251], a[24:27]
s_add_u32 m0, s32, 0
v_mfma_f32_16x16x32_bf16 a[28:31], a[172:175], a[252:255], a[28:31]
buffer_load_dwordx4 v1, s[12:15], s48 offen lds
ds_read_b64_tr_b16 a[172:173], v8 offset:0
v_mfma_f32_16x16x32_bf16 a[32:35], a[176:179], a[224:227], a[32:35]
ds_read_b64_tr_b16 a[174:175], v8 offset:1024
v_mfma_f32_16x16x32_bf16 a[36:39], a[176:179], a[228:231], a[36:39]
v_xor_b32 v8, 80, v5
v_mfma_f32_16x16x32_bf16 a[40:43], a[176:179], a[232:235], a[40:43]
v_mfma_f32_16x16x32_bf16 a[44:47], a[176:179], a[236:239], a[44:47]
v_mfma_f32_16x16x32_bf16 a[48:51], a[176:179], a[240:243], a[48:51]
s_add_u32 s48, s48, s34
v_mfma_f32_16x16x32_bf16 a[52:55], a[176:179], a[244:247], a[52:55]
s_add_u32 m0, s32, 4096
v_mfma_f32_16x16x32_bf16 a[56:59], a[176:179], a[248:251], a[56:59]
buffer_load_dwordx4 v1, s[12:15], s48 offen lds
v_mfma_f32_16x16x32_bf16 a[60:63], a[176:179], a[252:255], a[60:63]
ds_read_b64_tr_b16 a[176:177], v9 offset:0
v_mfma_f32_16x16x32_bf16 a[64:67], a[180:183], a[224:227], a[64:67]
ds_read_b64_tr_b16 a[178:179], v9 offset:1024
v_mfma_f32_16x16x32_bf16 a[68:71], a[180:183], a[228:231], a[68:71]
v_xor_b32 v9, 128, v5
v_mfma_f32_16x16x32_bf16 a[72:75], a[180:183], a[232:235], a[72:75]
v_mfma_f32_16x16x32_bf16 a[76:79], a[180:183], a[236:239], a[76:79]
s_add_u32 s48, s48, s34
v_mfma_f32_16x16x32_bf16 a[80:83], a[180:183], a[240:243], a[80:83]
s_add_u32 m0, s32, 8192
v_mfma_f32_16x16x32_bf16 a[84:87], a[180:183], a[244:247], a[84:87]
buffer_load_dwordx4 v1, s[12:15], s48 offen lds
v_mfma_f32_16x16x32_bf16 a[88:91], a[180:183], a[248:251], a[88:91]
v_mfma_f32_16x16x32_bf16 a[92:95], a[180:183], a[252:255], a[92:95]
ds_read_b64_tr_b16 a[180:181], v10 offset:0
v_mfma_f32_16x16x32_bf16 a[96:99], a[184:187], a[224:227], a[96:99]
ds_read_b64_tr_b16 a[182:183], v10 offset:1024
v_mfma_f32_16x16x32_bf16 a[100:103], a[184:187], a[228:231], a[100:103]
v_xor_b32 v10, 144, v5
v_mfma_f32_16x16x32_bf16 a[104:107], a[184:187], a[232:235], a[104:107]
s_add_u32 s48, s48, s34
v_mfma_f32_16x16x32_bf16 a[108:111], a[184:187], a[236:239], a[108:111]
s_add_u32 m0, s32, 12288
v_mfma_f32_16x16x32_bf16 a[112:115], a[184:187], a[240:243], a[112:115]
buffer_load_dwordx4 v1, s[12:15], s48 offen lds
v_mfma_f32_16x16x32_bf16 a[116:119], a[184:187], a[244:247], a[116:119]
v_mfma_f32_16x16x32_bf16 a[120:123], a[184:187], a[248:251], a[120:123]
v_mfma_f32_16x16x32_bf16 a[124:127], a[184:187], a[252:255], a[124:127]
ds_read_b64_tr_b16 a[184:185], v11 offset:0
v_mfma_f32_16x16x32_bf16 a[128:131], v[28:31], a[224:227], a[128:131]
ds_read_b64_tr_b16 a[186:187], v11 offset:1024
v_mfma_f32_16x16x32_bf16 a[132:135], v[28:31], a[228:231], a[132:135]
v_xor_b32 v11, 192, v5
v_mfma_f32_16x16x32_bf16 a[136:139], v[28:31], a[232:235], a[136:139]
v_mfma_f32_16x16x32_bf16 a[140:143], v[28:31], a[236:239], a[140:143]
v_mfma_f32_16x16x32_bf16 a[144:147], v[28:31], a[240:243], a[144:147]
v_mfma_f32_16x16x32_bf16 a[148:151], v[28:31], a[244:247], a[148:151]
v_mfma_f32_16x16x32_bf16 a[152:155], v[28:31], a[248:251], a[152:155]
v_mfma_f32_16x16x32_bf16 a[156:159], v[28:31], a[252:255], a[156:159]
L_g_k12:
s_waitcnt vmcnt(16) lgkmcnt(0)
s_barrier
v_mfma_f32_16x16x32_bf16 v[160:163], a[160:163], a[192:195], v[160:163]
ds_read_b128 a[224:227], v4 offset:0
s_lshr_b32 s24, s16, 1
v_mfma_f32_16x16x32_bf16 v[164:167], a[160:163], a[196:199], v[164:167]
s_add_u32 s37, s31, 0
s_cmp_eq_u32 s35, 5
s_cselect_b32 s90, s24, s90
v_mfma_f32_16x16x32_bf16 v[168:171], a[160:163], a[200:203], v[168:171]
s_add_u32 m0, s33, 0
ds_read_b128 a[228:231], v3 offset:1024
s_lshl_b32 s24, s35, 2
v_mfma_f32_16x16x32_bf16 v[172:175], a[160:163], a[204:207], v[172:175]
buffer_load_dwordx4 v2, s[20:23], s37 offen  lds
s_lshr_b32 s26, s88, s24
v_mfma_f32_16x16x32_bf16 v[176:179], a[160:163], a[208:211], v[176:179]
s_add_u32 s60, s60, s92
ds_read_b128 a[232:235], v4 offset:4096
s_bfe_u32 s2, s26, 0x10003
v_mfma_f32_16x16x32_bf16 v[180:183], a[160:163], a[212:215], v[180:183]
s_mov_b32 s29, s60
s_and_b32 s26, s26, 7
s_or_b32 s40, s2, s61
v_mfma_f32_16x16x32_bf16 v[184:187], a[160:163], a[216:219], v[184:187]
buffer_store_dwordx4 v[128:131], v13, s[8:11], s29 offen sc1
s_lshr_b32 s24, s17, 1
v_mfma_f32_16x16x32_bf16 v[188:191], a[160:163], a[220:223], v[188:191]
ds_read_b64_tr_b16 a[160:161], v5 offset:0
v_mfma_f32_16x16x32_bf16 v[192:195], a[164:167], a[192:195], v[192:195]
s_add_u32 s37, s31, 32768
ds_read_b64_tr_b16 a[162:163], v5 offset:1024
v_mfma_f32_16x16x32_bf16 v[196:199], a[164:167], a[196:199], v[196:199]
s_add_u32 m0, s33, 1024
ds_read_b128 a[236:239], v3 offset:5120
v_add_u32 v5, 16384, v5
v_mfma_f32_16x16x32_bf16 v[200:203], a[164:167], a[200:203], v[200:203]
buffer_load_dwordx4 v2, s[20:23], s37 offen  lds
v_and_b32 v5, 65535, v5
v_mfma_f32_16x16x32_bf16 v[204:207], a[164:167], a[204:207], v[204:207]
ds_read_b128 a[240:243], v4 offset:8192
v_mfma_f32_16x16x32_bf16 v[208:211], a[164:167], a[208:211], v[208:211]
s_cmp_eq_u32 s2, 0
s_cselect_b32 s41, s24, 0
s_cselect_b32 s27, s89, s90
v_mfma_f32_16x16x32_bf16 v[212:215], a[164:167], a[212:215], v[212:215]
ds_read_b128 a[244:247], v3 offset:9216
s_sub_u32 s25, s24, s41
v_mfma_f32_16x16x32_bf16 v[216:219], a[164:167], a[216:219], v[216:219]
s_and_b32 s51, s41, s61
s_lshl_b32 s51, s51, 1
s_or_b32 s51, s51, s41
v_mfma_f32_16x16x32_bf16 v[220:223], a[164:167], a[220:223], v[220:223]
s_add_u32 s37, s31, 131072
ds_read_b64_tr_b16 a[164:165], v6 offset:0
s_lshl2_add_u32 s51, s2, s51
v_mfma_f32_16x16x32_bf16 v[224:227], a[168:171], a[192:195], v[224:227]
s_add_u32 m0, s33, 4096
ds_read_b64_tr_b16 a[166:167], v6 offset:1024
s_lshl_b32 s46, s27, s2
v_mfma_f32_16x16x32_bf16 v[228:231], a[168:171], a[196:199], v[228:231]
buffer_load_dwordx4 v2, s[20:23], s37 offen  lds
s_add_u32 s46, s46, s25
v_mfma_f32_16x16x32_bf16 v[232:235], a[168:171], a[200:203], v[232:235]
ds_read_b128 a[248:251], v4 offset:12288
s_lshl_b32 s46, s46, 8
v_mfma_f32_16x16x32_bf16 v[236:239], a[168:171], a[204:207], v[236:239]
s_lshl_b32 s47, s40, 7
s_add_u32 s47, s47, 1024
s_mul_i32 s101, s26, s47
v_mfma_f32_16x16x32_bf16 v[240:243], a[168:171], a[208:211], v[240:243]
ds_read_b128 a[252:255], v3 offset:13312
s_lshl_b32 s101, s101, 8
v_mfma_f32_16x16x32_bf16 v[244:247], a[168:171], a[212:215], v[244:247]
s_and_b32 s25, s17, 1
s_lshl1_add_u32 s42, s26, s25
s_lshl_b32 s42, s42, 7
v_mfma_f32_16x16x32_bf16 v[248:251], a[168:171], a[216:219], v[248:251]
s_add_u32 s37, s31, 163840
ds_read_b64_tr_b16 v[28:29], v12 offset:0
s_lshr_b32 s42, s42, s2
v_mfma_f32_16x16x32_bf16 v[252:255], a[168:171], a[220:223], v[252:255]
s_add_u32 m0, s33, 5120
ds_read_b64_tr_b16 a[168:169], v7 offset:0
s_add_u32 s42, s42, s27
v_mfma_f32_16x16x32_bf16 a[0:3], a[172:175], a[192:195], a[0:3]
buffer_load_dwordx4 v2, s[20:23], s37 offen  lds
ds_read_b64_tr_b16 a[170:171], v7 offset:1024
v_mfma_f32_16x16x32_bf16 a[4:7], a[172:175], a[196:199], a[4:7]
s_add_u32 s31, s31, 262144
s_add_u32 s29, s29, s44
s_lshl1_add_u32 s42, s42, s24
v_mfma_f32_16x16x32_bf16 a[8:11], a[172:175], a[200:203], a[8:11]
s_add_u32 s33, s33, 16384
ds_read_b64_tr_b16 v[30:31], v12 offset:1024
s_lshl_b32 s42, s42, 13
v_mfma_f32_16x16x32_bf16 a[12:15], a[172:175], a[204:207], a[12:15]
s_and_b32 s33, s33, 65535
buffer_store_dwordx4 v[132:135], v13, s[8:11], s29 offen sc1
s_lshl_b32 s43, s27, 5
v_mfma_f32_16x16x32_bf16 a[16:19], a[172:175], a[208:211], a[16:19]
s_add_u32 s43, s43, s26
s_lshl_b32 s43, s43, 2
s_lshl_b32 s24, s2, 1
v_mfma_f32_16x16x32_bf16 a[20:23], a[172:175], a[212:215], a[20:23]
s_add_u32 s48, s48, s34
s_add_u32 s24, s24, s61
s_lshl_b32 s24, s24, 2
v_mfma_f32_16x16x32_bf16 a[24:27], a[172:175], a[216:219], a[24:27]
s_add_u32 m0, s32, 16384
s_lshr_b32 s25, 0x8720, s24
s_and_b32 s25, s25, 15
v_mfma_f32_16x16x32_bf16 a[28:31], a[172:175], a[220:223], a[28:31]
buffer_load_dwordx4 v1, s[12:15], s48 offen lds
ds_read_b64_tr_b16 a[172:173], v8 offset:0
v_mfma_f32_16x16x32_bf16 a[32:35], a[176:179], a[192:195], a[32:35]
ds_read_b64_tr_b16 a[174:175], v8 offset:1024
s_lshl_b32 s25, s25, 24
v_mfma_f32_16x16x32_bf16 a[36:39], a[176:179], a[196:199], a[36:39]
s_add_u32 s42, s42, s25
s_lshr_b32 s25, 0x7604, s24
s_and_b32 s25, s25, 15
v_mfma_f32_16x16x32_bf16 a[40:43], a[176:179], a[200:203], a[40:43]
s_lshl_b32 s25, s25, 12
s_add_u32 s43, s43, s25
s_add_u32 s43, s43, 111149056
v_mfma_f32_16x16x32_bf16 a[44:47], a[176:179], a[204:207], a[44:47]
s_cmp_lt_u32 s35, s45
s_cselect_b32 s101, s101, 536870912
s_cselect_b32 s46, s46, 536870912
v_mfma_f32_16x16x32_bf16 a[48:51], a[176:179], a[208:211], a[48:51]
s_add_u32 s48, s48, s34
v_xor_b32 v6, 16, v5
v_xor_b32 v7, 64, v5
v_mfma_f32_16x16x32_bf16 a[52:55], a[176:179], a[212:215], a[52:55]
s_add_u32 m0, s32, 20480
v_xor_b32 v8, 80, v5
v_xor_b32 v12, 208, v5
v_mfma_f32_16x16x32_bf16 a[56:59], a[176:179], a[216:219], a[56:59]
buffer_load_dwordx4 v1, s[12:15], s48 offen lds
v_add_u32 v3, 32768, v3
v_mfma_f32_16x16x32_bf16 a[60:63], a[176:179], a[220:223], a[60:63]
ds_read_b64_tr_b16 a[176:177], v9 offset:0
v_subrev_u32 v19, 98304, v3
v_mfma_f32_16x16x32_bf16 a[64:67], a[180:183], a[192:195], a[64:67]
ds_read_b64_tr_b16 a[178:179], v9 offset:1024
v_cmp_le_u32 vcc, 163840, v3
v_mfma_f32_16x16x32_bf16 a[68:71], a[180:183], a[196:199], a[68:71]
v_xor_b32 v9, 128, v5
v_cndmask_b32 v3, v3, v19, vcc
v_mfma_f32_16x16x32_bf16 a[72:75], a[180:183], a[200:203], a[72:75]
v_xor_b32 v4, 64, v3
v_mfma_f32_16x16x32_bf16 a[76:79], a[180:183], a[204:207], a[76:79]
s_add_u32 s48, s48, s34
v_mfma_f32_16x16x32_bf16 a[80:83], a[180:183], a[208:211], a[80:83]
s_add_u32 m0, s32, 24576
v_mfma_f32_16x16x32_bf16 a[84:87], a[180:183], a[212:215], a[84:87]
buffer_load_dwordx4 v1, s[12:15], s48 offen lds
v_mfma_f32_16x16x32_bf16 a[88:91], a[180:183], a[216:219], a[88:91]
s_add_u32 s29, s29, s93
v_mfma_f32_16x16x32_bf16 a[92:95], a[180:183], a[220:223], a[92:95]
ds_read_b64_tr_b16 a[180:181], v10 offset:0
v_mfma_f32_16x16x32_bf16 a[96:99], a[184:187], a[192:195], a[96:99]
buffer_store_dwordx4 v[136:139], v13, s[8:11], s29 offen sc1
ds_read_b64_tr_b16 a[182:183], v10 offset:1024
v_mfma_f32_16x16x32_bf16 a[100:103], a[184:187], a[196:199], a[100:103]
v_xor_b32 v10, 144, v5
v_mfma_f32_16x16x32_bf16 a[104:107], a[184:187], a[200:203], a[104:107]
s_add_u32 s48, s48, s34
v_mfma_f32_16x16x32_bf16 a[108:111], a[184:187], a[204:207], a[108:111]
s_add_u32 m0, s32, 28672
v_mfma_f32_16x16x32_bf16 a[112:115], a[184:187], a[208:211], a[112:115]
buffer_load_dwordx4 v1, s[12:15], s48 offen lds
v_mfma_f32_16x16x32_bf16 a[116:119], a[184:187], a[212:215], a[116:119]
s_add_u32 s30, s30, 128
v_mfma_f32_16x16x32_bf16 a[120:123], a[184:187], a[216:219], a[120:123]
s_add_u32 s32, s32, 32768
v_mfma_f32_16x16x32_bf16 a[124:127], a[184:187], a[220:223], a[124:127]
s_sub_u32 s48, s32, 98304
ds_read_b64_tr_b16 a[184:185], v11 offset:0
v_mfma_f32_16x16x32_bf16 a[128:131], a[188:191], a[192:195], a[128:131]
s_cmp_ge_u32 s32, 163840
s_cselect_b32 s32, s48, s32
ds_read_b64_tr_b16 a[186:187], v11 offset:1024
v_mfma_f32_16x16x32_bf16 a[132:135], a[188:191], a[196:199], a[132:135]
v_xor_b32 v11, 192, v5
v_mfma_f32_16x16x32_bf16 a[136:139], a[188:191], a[200:203], a[136:139]
buffer_load_dword v15, v14, s[96:99], s100 offen
v_mfma_f32_16x16x32_bf16 a[140:143], a[188:191], a[204:207], a[140:143]
s_add_u32 s100, s100, 16384
v_mfma_f32_16x16x32_bf16 a[144:147], a[188:191], a[208:211], a[144:147]
v_mfma_f32_16x16x32_bf16 a[148:151], a[188:191], a[212:215], a[148:151]
v_mfma_f32_16x16x32_bf16 a[152:155], a[188:191], a[216:219], a[152:155]
v_mfma_f32_16x16x32_bf16 a[156:159], a[188:191], a[220:223], a[156:159]
s_waitcnt vmcnt(20) lgkmcnt(0)
s_barrier
v_mfma_f32_16x16x32_bf16 v[160:163], a[160:163], a[224:227], v[160:163]
ds_read_b128 a[192:195], v3 offset:0
v_mfma_f32_16x16x32_bf16 v[164:167], a[160:163], a[228:231], v[164:167]
s_add_u32 s37, s31, 0
s_cmp_eq_u32 s2, 0
s_cselect_b64 s[4:5], s[52:53], s[54:55]
v_mfma_f32_16x16x32_bf16 v[168:171], a[160:163], a[232:235], v[168:171]
s_add_u32 m0, s33, 0
ds_read_b128 a[196:199], v4 offset:1024
s_mov_b32 s12, s4
v_mfma_f32_16x16x32_bf16 v[172:175], a[160:163], a[236:239], v[172:175]
buffer_load_dwordx4 v2, s[20:23], s37 offen  lds
s_and_b32 s13, s5, 0xffff
v_mfma_f32_16x16x32_bf16 v[176:179], a[160:163], a[240:243], v[176:179]
s_add_u32 s29, s29, s44
ds_read_b128 a[200:203], v3 offset:4096
s_lshl_b32 s14, s47, 11
v_mfma_f32_16x16x32_bf16 v[180:183], a[160:163], a[244:247], v[180:183]
s_mov_b32 s15, 0x20000
s_mov_b32 s30, s101
v_lshrrev_b32 v16, 3, v0
v_mfma_f32_16x16x32_bf16 v[184:187], a[160:163], a[248:251], v[184:187]
buffer_store_dwordx4 v[140:143], v13, s[8:11], s29 offen sc1
v_mul_lo_u32 v16, v16, s47
v_mfma_f32_16x16x32_bf16 v[188:191], a[160:163], a[252:255], v[188:191]
ds_read_b64_tr_b16 a[160:161], v5 offset:0
v_and_b32 v1, 0x70, v1
v_mfma_f32_16x16x32_bf16 v[192:195], a[164:167], a[224:227], v[192:195]
s_add_u32 s37, s31, 32768
ds_read_b64_tr_b16 a[162:163], v5 offset:1024
v_add_u32 v1, v1, v16
v_mfma_f32_16x16x32_bf16 v[196:199], a[164:167], a[228:231], v[196:199]
s_add_u32 m0, s33, 1024
ds_read_b128 a[204:207], v4 offset:5120
s_lshl_b32 s34, s47, 5
v_mfma_f32_16x16x32_bf16 v[200:203], a[164:167], a[232:235], v[200:203]
buffer_load_dwordx4 v2, s[20:23], s37 offen  lds
v_add_u32 v5, 16384, v5
v_mfma_f32_16x16x32_bf16 v[204:207], a[164:167], a[236:239], v[204:207]
ds_read_b128 a[208:211], v3 offset:8192
v_and_b32 v5, 65535, v5
v_mfma_f32_16x16x32_bf16 v[208:211], a[164:167], a[240:243], v[208:211]
v_mfma_f32_16x16x32_bf16 v[212:215], a[164:167], a[244:247], v[212:215]
ds_read_b128 a[212:215], v4 offset:9216
v_mfma_f32_16x16x32_bf16 v[216:219], a[164:167], a[248:251], v[216:219]
v_mfma_f32_16x16x32_bf16 v[220:223], a[164:167], a[252:255], v[220:223]
s_add_u32 s37, s31, 131072
ds_read_b64_tr_b16 a[164:165], v6 offset:0
v_mfma_f32_16x16x32_bf16 v[224:227], a[168:171], a[224:227], v[224:227]
s_add_u32 m0, s33, 4096
ds_read_b64_tr_b16 a[166:167], v6 offset:1024
v_mfma_f32_16x16x32_bf16 v[228:231], a[168:171], a[228:231], v[228:231]
buffer_load_dwordx4 v2, s[20:23], s37 offen  lds
v_xor_b32 v6, 16, v5
v_mfma_f32_16x16x32_bf16 v[232:235], a[168:171], a[232:235], v[232:235]
ds_read_b128 a[216:219], v3 offset:12288
v_mfma_f32_16x16x32_bf16 v[236:239], a[168:171], a[236:239], v[236:239]
v_mfma_f32_16x16x32_bf16 v[240:243], a[168:171], a[240:243], v[240:243]
ds_read_b128 a[220:223], v4 offset:13312
v_mfma_f32_16x16x32_bf16 v[244:247], a[168:171], a[244:247], v[244:247]
v_mfma_f32_16x16x32_bf16 v[248:251], a[168:171], a[248:251], v[248:251]
s_add_u32 s37, s31, 163840
ds_read_b64_tr_b16 a[188:189], v12 offset:0
v_mfma_f32_16x16x32_bf16 v[252:255], a[168:171], a[252:255], v[252:255]
s_add_u32 m0, s33, 5120
ds_read_b64_tr_b16 a[168:169], v7 offset:0
v_mfma_f32_16x16x32_bf16 a[0:3], a[172:175], a[224:227], a[0:3]
buffer_load_dwordx4 v2, s[20:23], s37 offen  lds
ds_read_b64_tr_b16 a[170:171], v7 offset:1024
v_mfma_f32_16x16x32_bf16 a[4:7], a[172:175], a[228:231], a[4:7]
s_add_u32 s31, s31, 262144
s_add_u32 s29, s29, s93
v_xor_b32 v7, 64, v5
v_mfma_f32_16x16x32_bf16 a[8:11], a[172:175], a[232:235], a[8:11]
s_add_u32 s33, s33, 16384
ds_read_b64_tr_b16 a[190:191], v12 offset:1024
v_mfma_f32_16x16x32_bf16 a[12:15], a[172:175], a[236:239], a[12:15]
s_and_b32 s33, s33, 65535
buffer_store_dwordx4 v[144:147], v13, s[8:11], s29 offen sc1
v_mfma_f32_16x16x32_bf16 a[16:19], a[172:175], a[240:243], a[16:19]
v_mfma_f32_16x16x32_bf16 a[20:23], a[172:175], a[244:247], a[20:23]
s_mov_b32 s48, s30
v_xor_b32 v12, 208, v5
v_mfma_f32_16x16x32_bf16 a[24:27], a[172:175], a[248:251], a[24:27]
s_add_u32 m0, s32, 0
v_mfma_f32_16x16x32_bf16 a[28:31], a[172:175], a[252:255], a[28:31]
buffer_load_dwordx4 v1, s[12:15], s48 offen lds
ds_read_b64_tr_b16 a[172:173], v8 offset:0
v_mfma_f32_16x16x32_bf16 a[32:35], a[176:179], a[224:227], a[32:35]
ds_read_b64_tr_b16 a[174:175], v8 offset:1024
v_mfma_f32_16x16x32_bf16 a[36:39], a[176:179], a[228:231], a[36:39]
v_xor_b32 v8, 80, v5
v_mfma_f32_16x16x32_bf16 a[40:43], a[176:179], a[232:235], a[40:43]
v_mfma_f32_16x16x32_bf16 a[44:47], a[176:179], a[236:239], a[44:47]
v_mfma_f32_16x16x32_bf16 a[48:51], a[176:179], a[240:243], a[48:51]
s_add_u32 s48, s48, s34
v_mfma_f32_16x16x32_bf16 a[52:55], a[176:179], a[244:247], a[52:55]
s_add_u32 m0, s32, 4096
v_mfma_f32_16x16x32_bf16 a[56:59], a[176:179], a[248:251], a[56:59]
buffer_load_dwordx4 v1, s[12:15], s48 offen lds
v_mfma_f32_16x16x32_bf16 a[60:63], a[176:179], a[252:255], a[60:63]
ds_read_b64_tr_b16 a[176:177], v9 offset:0
v_mfma_f32_16x16x32_bf16 a[64:67], a[180:183], a[224:227], a[64:67]
ds_read_b64_tr_b16 a[178:179], v9 offset:1024
v_mfma_f32_16x16x32_bf16 a[68:71], a[180:183], a[228:231], a[68:71]
v_xor_b32 v9, 128, v5
v_mfma_f32_16x16x32_bf16 a[72:75], a[180:183], a[232:235], a[72:75]
v_mfma_f32_16x16x32_bf16 a[76:79], a[180:183], a[236:239], a[76:79]
s_add_u32 s48, s48, s34
v_mfma_f32_16x16x32_bf16 a[80:83], a[180:183], a[240:243], a[80:83]
s_add_u32 m0, s32, 8192
s_cmp_eq_u32 s2, 0
s_cselect_b64 s[4:5], s[6:7], s[18:19]
v_mfma_f32_16x16x32_bf16 a[84:87], a[180:183], a[244:247], a[84:87]
buffer_load_dwordx4 v1, s[12:15], s48 offen lds
s_mov_b32 s20, s4
v_mfma_f32_16x16x32_bf16 a[88:91], a[180:183], a[248:251], a[88:91]
s_add_u32 s29, s29, s44
s_and_b32 s21, s5, 0xffff
s_lshl_b32 s22, s47, 12
v_mfma_f32_16x16x32_bf16 a[92:95], a[180:183], a[252:255], a[92:95]
ds_read_b64_tr_b16 a[180:181], v10 offset:0
s_mov_b32 s23, 0x20000
v_mfma_f32_16x16x32_bf16 a[96:99], a[184:187], a[224:227], a[96:99]
buffer_store_dwordx4 v[148:151], v13, s[8:11], s29 offen sc1
ds_read_b64_tr_b16 a[182:183], v10 offset:1024
v_mfma_f32_16x16x32_bf16 a[100:103], a[184:187], a[228:231], a[100:103]
s_mov_b32 s31, s46
v_xor_b32 v10, 144, v5
v_mfma_f32_16x16x32_bf16 a[104:107], a[184:187], a[232:235], a[104:107]
s_add_u32 s48, s48, s34
v_mfma_f32_16x16x32_bf16 a[108:111], a[184:187], a[236:239], a[108:111]
s_add_u32 m0, s32, 12288
v_mfma_f32_16x16x32_bf16 a[112:115], a[184:187], a[240:243], a[112:115]
buffer_load_dwordx4 v1, s[12:15], s48 offen lds
v_mfma_f32_16x16x32_bf16 a[116:119], a[184:187], a[244:247], a[116:119]
v_mfma_f32_16x16x32_bf16 a[120:123], a[184:187], a[248:251], a[120:123]
v_mfma_f32_16x16x32_bf16 a[124:127], a[184:187], a[252:255], a[124:127]
ds_read_b64_tr_b16 a[184:185], v11 offset:0
v_mfma_f32_16x16x32_bf16 a[128:131], v[28:31], a[224:227], a[128:131]
ds_read_b64_tr_b16 a[186:187], v11 offset:1024
v_mfma_f32_16x16x32_bf16 a[132:135], v[28:31], a[228:231], a[132:135]
v_xor_b32 v11, 192, v5
v_mfma_f32_16x16x32_bf16 a[136:139], v[28:31], a[232:235], a[136:139]
buffer_load_dword v15, v14, s[96:99], s100 offen
v_mfma_f32_16x16x32_bf16 a[140:143], v[28:31], a[236:239], a[140:143]
s_add_u32 s100, s100, 16384
v_mfma_f32_16x16x32_bf16 a[144:147], v[28:31], a[240:243], a[144:147]
v_mfma_f32_16x16x32_bf16 a[148:151], v[28:31], a[244:247], a[148:151]
v_mfma_f32_16x16x32_bf16 a[152:155], v[28:31], a[248:251], a[152:155]
v_mfma_f32_16x16x32_bf16 a[156:159], v[28:31], a[252:255], a[156:159]
s_waitcnt vmcnt(24) lgkmcnt(0)
s_barrier
v_mfma_f32_16x16x32_bf16 v[160:163], a[160:163], a[192:195], v[160:163]
ds_read_b128 a[224:227], v4 offset:0
v_mfma_f32_16x16x32_bf16 v[164:167], a[160:163], a[196:199], v[164:167]
s_add_u32 s37, s31, 0
v_mfma_f32_16x16x32_bf16 v[168:171], a[160:163], a[200:203], v[168:171]
s_add_u32 m0, s33, 0
ds_read_b128 a[228:231], v3 offset:1024
v_mfma_f32_16x16x32_bf16 v[172:175], a[160:163], a[204:207], v[172:175]
buffer_load_dwordx4 v2, s[20:23], s37 offen  lds
v_mfma_f32_16x16x32_bf16 v[176:179], a[160:163], a[208:211], v[176:179]
s_add_u32 s29, s29, s93
ds_read_b128 a[232:235], v4 offset:4096
v_mfma_f32_16x16x32_bf16 v[180:183], a[160:163], a[212:215], v[180:183]
v_mfma_f32_16x16x32_bf16 v[184:187], a[160:163], a[216:219], v[184:187]
buffer_store_dwordx4 v[152:155], v13, s[8:11], s29 offen sc1
v_mfma_f32_16x16x32_bf16 v[188:191], a[160:163], a[220:223], v[188:191]
ds_read_b64_tr_b16 a[160:161], v5 offset:0
v_mfma_f32_16x16x32_bf16 v[192:195], a[164:167], a[192:195], v[192:195]
s_add_u32 s37, s31, 32768
ds_read_b64_tr_b16 a[162:163], v5 offset:1024
v_mfma_f32_16x16x32_bf16 v[196:199], a[164:167], a[196:199], v[196:199]
s_add_u32 m0, s33, 1024
ds_read_b128 a[236:239], v3 offset:5120
v_add_u32 v5, 16384, v5
v_mfma_f32_16x16x32_bf16 v[200:203], a[164:167], a[200:203], v[200:203]
buffer_load_dwordx4 v2, s[20:23], s37 offen  lds
v_and_b32 v5, 65535, v5
v_mfma_f32_16x16x32_bf16 v[204:207], a[164:167], a[204:207], v[204:207]
ds_read_b128 a[240:243], v4 offset:8192
v_mfma_f32_16x16x32_bf16 v[208:211], a[164:167], a[208:211], v[208:211]
v_mfma_f32_16x16x32_bf16 v[212:215], a[164:167], a[212:215], v[212:215]
ds_read_b128 a[244:247], v3 offset:9216
v_mfma_f32_16x16x32_bf16 v[216:219], a[164:167], a[216:219], v[216:219]
v_mfma_f32_16x16x32_bf16 v[220:223], a[164:167], a[220:223], v[220:223]
s_add_u32 s37, s31, 131072
ds_read_b64_tr_b16 a[164:165], v6 offset:0
v_mfma_f32_16x16x32_bf16 v[224:227], a[168:171], a[192:195], v[224:227]
s_add_u32 m0, s33, 4096
ds_read_b64_tr_b16 a[166:167], v6 offset:1024
v_mfma_f32_16x16x32_bf16 v[228:231], a[168:171], a[196:199], v[228:231]
buffer_load_dwordx4 v2, s[20:23], s37 offen  lds
v_xor_b32 v6, 16, v5
v_mfma_f32_16x16x32_bf16 v[232:235], a[168:171], a[200:203], v[232:235]
ds_read_b128 a[248:251], v4 offset:12288
v_mfma_f32_16x16x32_bf16 v[236:239], a[168:171], a[204:207], v[236:239]
v_mfma_f32_16x16x32_bf16 v[240:243], a[168:171], a[208:211], v[240:243]
ds_read_b128 a[252:255], v3 offset:13312
v_mfma_f32_16x16x32_bf16 v[244:247], a[168:171], a[212:215], v[244:247]
v_mfma_f32_16x16x32_bf16 v[248:251], a[168:171], a[216:219], v[248:251]
s_add_u32 s37, s31, 163840
ds_read_b64_tr_b16 v[28:29], v12 offset:0
v_mfma_f32_16x16x32_bf16 v[252:255], a[168:171], a[220:223], v[252:255]
s_add_u32 m0, s33, 5120
ds_read_b64_tr_b16 a[168:169], v7 offset:0
v_mfma_f32_16x16x32_bf16 a[0:3], a[172:175], a[192:195], a[0:3]
buffer_load_dwordx4 v2, s[20:23], s37 offen  lds
ds_read_b64_tr_b16 a[170:171], v7 offset:1024
v_mfma_f32_16x16x32_bf16 a[4:7], a[172:175], a[196:199], a[4:7]
s_add_u32 s31, s31, 262144
s_add_u32 s29, s29, s44
v_xor_b32 v7, 64, v5
v_mfma_f32_16x16x32_bf16 a[8:11], a[172:175], a[200:203], a[8:11]
s_add_u32 s33, s33, 16384
ds_read_b64_tr_b16 v[30:31], v12 offset:1024
v_mfma_f32_16x16x32_bf16 a[12:15], a[172:175], a[204:207], a[12:15]
s_and_b32 s33, s33, 65535
buffer_store_dwordx4 v[156:159], v13, s[8:11], s29 offen sc1
v_mfma_f32_16x16x32_bf16 a[16:19], a[172:175], a[208:211], a[16:19]
v_mfma_f32_16x16x32_bf16 a[20:23], a[172:175], a[212:215], a[20:23]
s_add_u32 s48, s48, s34
v_xor_b32 v12, 208, v5
v_mfma_f32_16x16x32_bf16 a[24:27], a[172:175], a[216:219], a[24:27]
s_add_u32 m0, s32, 16384
v_add_u32 v3, 32768, v3
v_mfma_f32_16x16x32_bf16 a[28:31], a[172:175], a[220:223], a[28:31]
buffer_load_dwordx4 v1, s[12:15], s48 offen lds
ds_read_b64_tr_b16 a[172:173], v8 offset:0
v_mfma_f32_16x16x32_bf16 a[32:35], a[176:179], a[192:195], a[32:35]
ds_read_b64_tr_b16 a[174:175], v8 offset:1024
v_subrev_u32 v19, 98304, v3
v_mfma_f32_16x16x32_bf16 a[36:39], a[176:179], a[196:199], a[36:39]
v_xor_b32 v8, 80, v5
v_cmp_le_u32 vcc, 163840, v3
v_mfma_f32_16x16x32_bf16 a[40:43], a[176:179], a[200:203], a[40:43]
s_nop 0
v_cndmask_b32 v3, v3, v19, vcc
v_mfma_f32_16x16x32_bf16 a[44:47], a[176:179], a[204:207], a[44:47]
v_xor_b32 v4, 64, v3
v_mfma_f32_16x16x32_bf16 a[48:51], a[176:179], a[208:211], a[48:51]
s_add_u32 s48, s48, s34
v_mfma_f32_16x16x32_bf16 a[52:55], a[176:179], a[212:215], a[52:55]
s_add_u32 m0, s32, 20480
v_mfma_f32_16x16x32_bf16 a[56:59], a[176:179], a[216:219], a[56:59]
buffer_load_dwordx4 v1, s[12:15], s48 offen lds
v_mfma_f32_16x16x32_bf16 a[60:63], a[176:179], a[220:223], a[60:63]
ds_read_b64_tr_b16 a[176:177], v9 offset:0
v_mfma_f32_16x16x32_bf16 a[64:67], a[180:183], a[192:195], a[64:67]
ds_read_b64_tr_b16 a[178:179], v9 offset:1024
v_mfma_f32_16x16x32_bf16 a[68:71], a[180:183], a[196:199], a[68:71]
v_xor_b32 v9, 128, v5
v_mfma_f32_16x16x32_bf16 a[72:75], a[180:183], a[200:203], a[72:75]
v_mfma_f32_16x16x32_bf16 a[76:79], a[180:183], a[204:207], a[76:79]
s_add_u32 s48, s48, s34
v_mfma_f32_16x16x32_bf16 a[80:83], a[180:183], a[208:211], a[80:83]
s_add_u32 m0, s32, 24576
v_mfma_f32_16x16x32_bf16 a[84:87], a[180:183], a[212:215], a[84:87]
buffer_load_dwordx4 v1, s[12:15], s48 offen lds
v_mfma_f32_16x16x32_bf16 a[88:91], a[180:183], a[216:219], a[88:91]
v_mfma_f32_16x16x32_bf16 a[92:95], a[180:183], a[220:223], a[92:95]
ds_read_b64_tr_b16 a[180:181], v10 offset:0
v_mfma_f32_16x16x32_bf16 a[96:99], a[184:187], a[192:195], a[96:99]
ds_read_b64_tr_b16 a[182:183], v10 offset:1024
v_mfma_f32_16x16x32_bf16 a[100:103], a[184:187], a[196:199], a[100:103]
v_xor_b32 v10, 144, v5
v_mfma_f32_16x16x32_bf16 a[104:107], a[184:187], a[200:203], a[104:107]
s_add_u32 s48, s48, s34
v_mfma_f32_16x16x32_bf16 a[108:111], a[184:187], a[204:207], a[108:111]
s_add_u32 m0, s32, 28672
v_mfma_f32_16x16x32_bf16 a[112:115], a[184:187], a[208:211], a[112:115]
buffer_load_dwordx4 v1, s[12:15], s48 offen lds
v_mfma_f32_16x16x32_bf16 a[116:119], a[184:187], a[212:215], a[116:119]
s_add_u32 s30, s30, 128
v_mfma_f32_16x16x32_bf16 a[120:123], a[184:187], a[216:219], a[120:123]
s_add_u32 s32, s32, 32768
v_mfma_f32_16x16x32_bf16 a[124:127], a[184:187], a[220:223], a[124:127]
s_sub_u32 s48, s32, 98304
ds_read_b64_tr_b16 a[184:185], v11 offset:0
v_mfma_f32_16x16x32_bf16 a[128:131], a[188:191], a[192:195], a[128:131]
s_cmp_ge_u32 s32, 163840
s_cselect_b32 s32, s48, s32
ds_read_b64_tr_b16 a[186:187], v11 offset:1024
v_mfma_f32_16x16x32_bf16 a[132:135], a[188:191], a[196:199], a[132:135]
v_xor_b32 v11, 192, v5
v_mfma_f32_16x16x32_bf16 a[136:139], a[188:191], a[200:203], a[136:139]
buffer_load_dword v15, v14, s[96:99], s100 offen
v_mfma_f32_16x16x32_bf16 a[140:143], a[188:191], a[204:207], a[140:143]
s_add_u32 s100, s100, 16384
v_mfma_f32_16x16x32_bf16 a[144:147], a[188:191], a[208:211], a[144:147]
v_mfma_f32_16x16x32_bf16 a[148:151], a[188:191], a[212:215], a[148:151]
v_mfma_f32_16x16x32_bf16 a[152:155], a[188:191], a[216:219], a[152:155]
v_mfma_f32_16x16x32_bf16 a[156:159], a[188:191], a[220:223], a[156:159]
s_waitcnt vmcnt(23) lgkmcnt(0)
s_barrier
v_mfma_f32_16x16x32_bf16 v[160:163], a[160:163], a[224:227], v[160:163]
ds_read_b128 a[192:195], v3 offset:0
v_mfma_f32_16x16x32_bf16 v[164:167], a[160:163], a[228:231], v[164:167]
s_add_u32 s37, s31, 0
v_mfma_f32_16x16x32_bf16 v[168:171], a[160:163], a[232:235], v[168:171]
s_add_u32 m0, s33, 0
ds_read_b128 a[196:199], v4 offset:1024
v_mfma_f32_16x16x32_bf16 v[172:175], a[160:163], a[236:239], v[172:175]
buffer_load_dwordx4 v2, s[20:23], s37 offen  lds
v_mfma_f32_16x16x32_bf16 v[176:179], a[160:163], a[240:243], v[176:179]
ds_read_b128 a[200:203], v3 offset:4096
v_mfma_f32_16x16x32_bf16 v[180:183], a[160:163], a[244:247], v[180:183]
v_mfma_f32_16x16x32_bf16 v[184:187], a[160:163], a[248:251], v[184:187]
ds_read_b128 a[204:207], v4 offset:5120
v_mfma_f32_16x16x32_bf16 v[188:191], a[160:163], a[252:255], v[188:191]
ds_read_b64_tr_b16 a[160:161], v5 offset:0
v_mfma_f32_16x16x32_bf16 v[192:195], a[164:167], a[224:227], v[192:195]
s_add_u32 s37, s31, 32768
ds_read_b64_tr_b16 a[162:163], v5 offset:1024
v_mfma_f32_16x16x32_bf16 v[196:199], a[164:167], a[228:231], v[196:199]
s_add_u32 m0, s33, 1024
ds_read_b128 a[208:211], v3 offset:8192
v_add_u32 v5, 16384, v5
v_mfma_f32_16x16x32_bf16 v[200:203], a[164:167], a[232:235], v[200:203]
buffer_load_dwordx4 v2, s[20:23], s37 offen  lds
v_and_b32 v5, 65535, v5
v_mfma_f32_16x16x32_bf16 v[204:207], a[164:167], a[236:239], v[204:207]
ds_read_b128 a[212:215], v4 offset:9216
v_mfma_f32_16x16x32_bf16 v[208:211], a[164:167], a[240:243], v[208:211]
v_mfma_f32_16x16x32_bf16 v[212:215], a[164:167], a[244:247], v[212:215]
ds_read_b128 a[216:219], v3 offset:12288
v_mfma_f32_16x16x32_bf16 v[216:219], a[164:167], a[248:251], v[216:219]
v_mfma_f32_16x16x32_bf16 v[220:223], a[164:167], a[252:255], v[220:223]
s_add_u32 s37, s31, 131072
ds_read_b64_tr_b16 a[164:165], v6 offset:0
v_mfma_f32_16x16x32_bf16 v[224:227], a[168:171], a[224:227], v[224:227]
s_add_u32 m0, s33, 4096
ds_read_b64_tr_b16 a[166:167], v6 offset:1024
v_mfma_f32_16x16x32_bf16 v[228:231], a[168:171], a[228:231], v[228:231]
buffer_load_dwordx4 v2, s[20:23], s37 offen  lds
v_xor_b32 v6, 16, v5
v_mfma_f32_16x16x32_bf16 v[232:235], a[168:171], a[232:235], v[232:235]
ds_read_b128 a[220:223], v4 offset:13312
v_mfma_f32_16x16x32_bf16 v[236:239], a[168:171], a[236:239], v[236:239]
v_mfma_f32_16x16x32_bf16 v[240:243], a[168:171], a[240:243], v[240:243]
ds_read_b64_tr_b16 a[188:189], v12 offset:0
v_mfma_f32_16x16x32_bf16 v[244:247], a[168:171], a[244:247], v[244:247]
v_mfma_f32_16x16x32_bf16 v[248:251], a[168:171], a[248:251], v[248:251]
s_add_u32 s37, s31, 163840
ds_read_b64_tr_b16 a[190:191], v12 offset:1024
v_mfma_f32_16x16x32_bf16 v[252:255], a[168:171], a[252:255], v[252:255]
s_add_u32 m0, s33, 5120
ds_read_b64_tr_b16 a[168:169], v7 offset:0
v_mfma_f32_16x16x32_bf16 a[0:3], a[172:175], a[224:227], a[0:3]
buffer_load_dwordx4 v2, s[20:23], s37 offen  lds
ds_read_b64_tr_b16 a[170:171], v7 offset:1024
v_mfma_f32_16x16x32_bf16 a[4:7], a[172:175], a[228:231], a[4:7]
s_add_u32 s31, s31, 262144
v_xor_b32 v7, 64, v5
v_xor_b32 v12, 208, v5
v_mfma_f32_16x16x32_bf16 a[8:11], a[172:175], a[232:235], a[8:11]
s_add_u32 s33, s33, 16384
v_mfma_f32_16x16x32_bf16 a[12:15], a[172:175], a[236:239], a[12:15]
s_and_b32 s33, s33, 65535
v_mfma_f32_16x16x32_bf16 a[16:19], a[172:175], a[240:243], a[16:19]
v_mfma_f32_16x16x32_bf16 a[20:23], a[172:175], a[244:247], a[20:23]
s_mov_b32 s48, s30
v_mfma_f32_16x16x32_bf16 a[24:27], a[172:175], a[248:251], a[24:27]
s_add_u32 m0, s32, 0
v_mfma_f32_16x16x32_bf16 a[28:31], a[172:175], a[252:255], a[28:31]
buffer_load_dwordx4 v1, s[12:15], s48 offen lds
ds_read_b64_tr_b16 a[172:173], v8 offset:0
v_mfma_f32_16x16x32_bf16 a[32:35], a[176:179], a[224:227], a[32:35]
ds_read_b64_tr_b16 a[174:175], v8 offset:1024
v_mfma_f32_16x16x32_bf16 a[36:39], a[176:179], a[228:231], a[36:39]
v_xor_b32 v8, 80, v5
v_mfma_f32_16x16x32_bf16 a[40:43], a[176:179], a[232:235], a[40:43]
v_mfma_f32_16x16x32_bf16 a[44:47], a[176:179], a[236:239], a[44:47]
v_mfma_f32_16x16x32_bf16 a[48:51], a[176:179], a[240:243], a[48:51]
s_add_u32 s48, s48, s34
v_mfma_f32_16x16x32_bf16 a[52:55], a[176:179], a[244:247], a[52:55]
s_add_u32 m0, s32, 4096
v_mfma_f32_16x16x32_bf16 a[56:59], a[176:179], a[248:251], a[56:59]
buffer_load_dwordx4 v1, s[12:15], s48 offen lds
v_mfma_f32_16x16x32_bf16 a[60:63], a[176:179], a[252:255], a[60:63]
ds_read_b64_tr_b16 a[176:177], v9 offset:0
v_mfma_f32_16x16x32_bf16 a[64:67], a[180:183], a[224:227], a[64:67]
ds_read_b64_tr_b16 a[178:179], v9 offset:1024
v_mfma_f32_16x16x32_bf16 a[68:71], a[180:183], a[228:231], a[68:71]
v_xor_b32 v9, 128, v5
v_mfma_f32_16x16x32_bf16 a[72:75], a[180:183], a[232:235], a[72:75]
v_mfma_f32_16x16x32_bf16 a[76:79], a[180:183], a[236:239], a[76:79]
s_add_u32 s48, s48, s34
v_mfma_f32_16x16x32_bf16 a[80:83], a[180:183], a[240:243], a[80:83]
s_add_u32 m0, s32, 8192
v_mfma_f32_16x16x32_bf16 a[84:87], a[180:183], a[244:247], a[84:87]
buffer_load_dwordx4 v1, s[12:15], s48 offen lds
v_mfma_f32_16x16x32_bf16 a[88:91], a[180:183], a[248:251], a[88:91]
v_mfma_f32_16x16x32_bf16 a[92:95], a[180:183], a[252:255], a[92:95]
ds_read_b64_tr_b16 a[180:181], v10 offset:0
v_mfma_f32_16x16x32_bf16 a[96:99], a[184:187], a[224:227], a[96:99]
ds_read_b64_tr_b16 a[182:183], v10 offset:1024
v_mfma_f32_16x16x32_bf16 a[100:103], a[184:187], a[228:231], a[100:103]
v_xor_b32 v10, 144, v5
v_mfma_f32_16x16x32_bf16 a[104:107], a[184:187], a[232:235], a[104:107]
s_add_u32 s48, s48, s34
v_mfma_f32_16x16x32_bf16 a[108:111], a[184:187], a[236:239], a[108:111]
s_add_u32 m0, s32, 12288
v_mfma_f32_16x16x32_bf16 a[112:115], a[184:187], a[240:243], a[112:115]
buffer_load_dwordx4 v1, s[12:15], s48 offen lds
v_mfma_f32_16x16x32_bf16 a[116:119], a[184:187], a[244:247], a[116:119]
v_mfma_f32_16x16x32_bf16 a[120:123], a[184:187], a[248:251], a[120:123]
v_mfma_f32_16x16x32_bf16 a[124:127], a[184:187], a[252:255], a[124:127]
ds_read_b64_tr_b16 a[184:185], v11 offset:0
v_mfma_f32_16x16x32_bf16 a[128:131], v[28:31], a[224:227], a[128:131]
ds_read_b64_tr_b16 a[186:187], v11 offset:1024
v_mfma_f32_16x16x32_bf16 a[132:135], v[28:31], a[228:231], a[132:135]
v_xor_b32 v11, 192, v5
v_mfma_f32_16x16x32_bf16 a[136:139], v[28:31], a[232:235], a[136:139]
buffer_load_dword v15, v14, s[96:99], s100 offen
v_mfma_f32_16x16x32_bf16 a[140:143], v[28:31], a[236:239], a[140:143]
s_add_u32 s100, s100, 16384
v_mfma_f32_16x16x32_bf16 a[144:147], v[28:31], a[240:243], a[144:147]
v_mfma_f32_16x16x32_bf16 a[148:151], v[28:31], a[244:247], a[148:151]
v_mfma_f32_16x16x32_bf16 a[152:155], v[28:31], a[248:251], a[152:155]
v_mfma_f32_16x16x32_bf16 a[156:159], v[28:31], a[252:255], a[156:159]
s_waitcnt vmcnt(20) lgkmcnt(0)
s_barrier
v_mfma_f32_16x16x32_bf16 v[160:163], a[160:163], a[192:195], v[160:163]
ds_read_b128 a[224:227], v4 offset:0
v_mfma_f32_16x16x32_bf16 v[164:167], a[160:163], a[196:199], v[164:167]
s_add_u32 s37, s31, 0
v_mfma_f32_16x16x32_bf16 v[168:171], a[160:163], a[200:203], v[168:171]
s_add_u32 m0, s33, 0
ds_read_b128 a[228:231], v3 offset:1024
v_mfma_f32_16x16x32_bf16 v[172:175], a[160:163], a[204:207], v[172:175]
buffer_load_dwordx4 v2, s[20:23], s37 offen  lds
v_mfma_f32_16x16x32_bf16 v[176:179], a[160:163], a[208:211], v[176:179]
ds_read_b128 a[232:235], v4 offset:4096
v_mfma_f32_16x16x32_bf16 v[180:183], a[160:163], a[212:215], v[180:183]
v_mfma_f32_16x16x32_bf16 v[184:187], a[160:163], a[216:219], v[184:187]
ds_read_b128 a[236:239], v3 offset:5120
v_mfma_f32_16x16x32_bf16 v[188:191], a[160:163], a[220:223], v[188:191]
ds_read_b64_tr_b16 a[160:161], v5 offset:0
v_mfma_f32_16x16x32_bf16 v[192:195], a[164:167], a[192:195], v[192:195]
s_add_u32 s37, s31, 32768
ds_read_b64_tr_b16 a[162:163], v5 offset:1024
v_mfma_f32_16x16x32_bf16 v[196:199], a[164:167], a[196:199], v[196:199]
s_add_u32 m0, s33, 1024
ds_read_b128 a[240:243], v4 offset:8192
v_add_u32 v5, 16384, v5
v_mfma_f32_16x16x32_bf16 v[200:203], a[164:167], a[200:203], v[200:203]
buffer_load_dwordx4 v2, s[20:23], s37 offen  lds
v_and_b32 v5, 65535, v5
v_mfma_f32_16x16x32_bf16 v[204:207], a[164:167], a[204:207], v[204:207]
ds_read_b128 a[244:247], v3 offset:9216
v_mfma_f32_16x16x32_bf16 v[208:211], a[164:167], a[208:211], v[208:211]
v_mfma_f32_16x16x32_bf16 v[212:215], a[164:167], a[212:215], v[212:215]
ds_read_b128 a[248:251], v4 offset:12288
v_mfma_f32_16x16x32_bf16 v[216:219], a[164:167], a[216:219], v[216:219]
v_mfma_f32_16x16x32_bf16 v[220:223], a[164:167], a[220:223], v[220:223]
s_add_u32 s37, s31, 131072
ds_read_b64_tr_b16 a[164:165], v6 offset:0
v_mfma_f32_16x16x32_bf16 v[224:227], a[168:171], a[192:195], v[224:227]
s_add_u32 m0, s33, 4096
ds_read_b64_tr_b16 a[166:167], v6 offset:1024
v_mfma_f32_16x16x32_bf16 v[228:231], a[168:171], a[196:199], v[228:231]
buffer_load_dwordx4 v2, s[20:23], s37 offen  lds
v_xor_b32 v6, 16, v5
v_mfma_f32_16x16x32_bf16 v[232:235], a[168:171], a[200:203], v[232:235]
ds_read_b128 a[252:255], v3 offset:13312
v_mfma_f32_16x16x32_bf16 v[236:239], a[168:171], a[204:207], v[236:239]
v_mfma_f32_16x16x32_bf16 v[240:243], a[168:171], a[208:211], v[240:243]
ds_read_b64_tr_b16 v[28:29], v12 offset:0
v_mfma_f32_16x16x32_bf16 v[244:247], a[168:171], a[212:215], v[244:247]
v_mfma_f32_16x16x32_bf16 v[248:251], a[168:171], a[216:219], v[248:251]
s_add_u32 s37, s31, 163840
ds_read_b64_tr_b16 v[30:31], v12 offset:1024
v_mfma_f32_16x16x32_bf16 v[252:255], a[168:171], a[220:223], v[252:255]
s_add_u32 m0, s33, 5120
ds_read_b64_tr_b16 a[168:169], v7 offset:0
v_mfma_f32_16x16x32_bf16 a[0:3], a[172:175], a[192:195], a[0:3]
buffer_load_dwordx4 v2, s[20:23], s37 offen  lds
ds_read_b64_tr_b16 a[170:171], v7 offset:1024
v_mfma_f32_16x16x32_bf16 a[4:7], a[172:175], a[196:199], a[4:7]
s_add_u32 s31, s31, 262144
v_xor_b32 v7, 64, v5
v_xor_b32 v12, 208, v5
v_mfma_f32_16x16x32_bf16 a[8:11], a[172:175], a[200:203], a[8:11]
s_add_u32 s33, s33, 16384
v_add_u32 v3, 32768, v3
v_mfma_f32_16x16x32_bf16 a[12:15], a[172:175], a[204:207], a[12:15]
s_and_b32 s33, s33, 65535
v_subrev_u32 v19, 98304, v3
v_mfma_f32_16x16x32_bf16 a[16:19], a[172:175], a[208:211], a[16:19]
v_cmp_le_u32 vcc, 163840, v3
v_mfma_f32_16x16x32_bf16 a[20:23], a[172:175], a[212:215], a[20:23]
s_add_u32 s48, s48, s34
v_cndmask_b32 v3, v3, v19, vcc
v_mfma_f32_16x16x32_bf16 a[24:27], a[172:175], a[216:219], a[24:27]
s_add_u32 m0, s32, 16384
v_xor_b32 v4, 64, v3
v_mfma_f32_16x16x32_bf16 a[28:31], a[172:175], a[220:223], a[28:31]
buffer_load_dwordx4 v1, s[12:15], s48 offen lds
ds_read_b64_tr_b16 a[172:173], v8 offset:0
v_mfma_f32_16x16x32_bf16 a[32:35], a[176:179], a[192:195], a[32:35]
ds_read_b64_tr_b16 a[174:175], v8 offset:1024
v_mfma_f32_16x16x32_bf16 a[36:39], a[176:179], a[196:199], a[36:39]
v_xor_b32 v8, 80, v5
v_mfma_f32_16x16x32_bf16 a[40:43], a[176:179], a[200:203], a[40:43]
v_mfma_f32_16x16x32_bf16 a[44:47], a[176:179], a[204:207], a[44:47]
v_mfma_f32_16x16x32_bf16 a[48:51], a[176:179], a[208:211], a[48:51]
s_add_u32 s48, s48, s34
v_mfma_f32_16x16x32_bf16 a[52:55], a[176:179], a[212:215], a[52:55]
s_add_u32 m0, s32, 20480
v_mfma_f32_16x16x32_bf16 a[56:59], a[176:179], a[216:219], a[56:59]
buffer_load_dwordx4 v1, s[12:15], s48 offen lds
v_mfma_f32_16x16x32_bf16 a[60:63], a[176:179], a[220:223], a[60:63]
ds_read_b64_tr_b16 a[176:177], v9 offset:0
v_mfma_f32_16x16x32_bf16 a[64:67], a[180:183], a[192:195], a[64:67]
ds_read_b64_tr_b16 a[178:179], v9 offset:1024
v_mfma_f32_16x16x32_bf16 a[68:71], a[180:183], a[196:199], a[68:71]
v_xor_b32 v9, 128, v5
v_mfma_f32_16x16x32_bf16 a[72:75], a[180:183], a[200:203], a[72:75]
v_mfma_f32_16x16x32_bf16 a[76:79], a[180:183], a[204:207], a[76:79]
s_add_u32 s48, s48, s34
v_mfma_f32_16x16x32_bf16 a[80:83], a[180:183], a[208:211], a[80:83]
s_add_u32 m0, s32, 24576
v_mfma_f32_16x16x32_bf16 a[84:87], a[180:183], a[212:215], a[84:87]
buffer_load_dwordx4 v1, s[12:15], s48 offen lds
v_mfma_f32_16x16x32_bf16 a[88:91], a[180:183], a[216:219], a[88:91]
v_mfma_f32_16x16x32_bf16 a[92:95], a[180:183], a[220:223], a[92:95]
ds_read_b64_tr_b16 a[180:181], v10 offset:0
v_mfma_f32_16x16x32_bf16 a[96:99], a[184:187], a[192:195], a[96:99]
ds_read_b64_tr_b16 a[182:183], v10 offset:1024
v_mfma_f32_16x16x32_bf16 a[100:103], a[184:187], a[196:199], a[100:103]
v_xor_b32 v10, 144, v5
v_mfma_f32_16x16x32_bf16 a[104:107], a[184:187], a[200:203], a[104:107]
s_add_u32 s48, s48, s34
v_mfma_f32_16x16x32_bf16 a[108:111], a[184:187], a[204:207], a[108:111]
s_add_u32 m0, s32, 28672
v_mfma_f32_16x16x32_bf16 a[112:115], a[184:187], a[208:211], a[112:115]
buffer_load_dwordx4 v1, s[12:15], s48 offen lds
v_mfma_f32_16x16x32_bf16 a[116:119], a[184:187], a[212:215], a[116:119]
s_add_u32 s30, s30, 128
v_mfma_f32_16x16x32_bf16 a[120:123], a[184:187], a[216:219], a[120:123]
s_add_u32 s32, s32, 32768
v_mfma_f32_16x16x32_bf16 a[124:127], a[184:187], a[220:223], a[124:127]
s_sub_u32 s48, s32, 98304
ds_read_b64_tr_b16 a[184:185], v11 offset:0
v_mfma_f32_16x16x32_bf16 a[128:131], a[188:191], a[192:195], a[128:131]
s_cmp_ge_u32 s32, 163840
s_cselect_b32 s32, s48, s32
ds_read_b64_tr_b16 a[186:187], v11 offset:1024
v_mfma_f32_16x16x32_bf16 a[132:135], a[188:191], a[196:199], a[132:135]
v_xor_b32 v11, 192, v5
v_mfma_f32_16x16x32_bf16 a[136:139], a[188:191], a[200:203], a[136:139]
buffer_load_dword v15, v14, s[96:99], s100 offen
v_mfma_f32_16x16x32_bf16 a[140:143], a[188:191], a[204:207], a[140:143]
s_add_u32 s100, s100, 16384
v_mfma_f32_16x16x32_bf16 a[144:147], a[188:191], a[208:211], a[144:147]
v_mfma_f32_16x16x32_bf16 a[148:151], a[188:191], a[212:215], a[148:151]
v_mfma_f32_16x16x32_bf16 a[152:155], a[188:191], a[216:219], a[152:155]
v_mfma_f32_16x16x32_bf16 a[156:159], a[188:191], a[220:223], a[156:159]
s_cmp_eq_u32 s41, 0
s_cbranch_scc0 L_g_k17v
s_waitcnt vmcnt(18) lgkmcnt(0)
s_barrier
v_mfma_f32_16x16x32_bf16 v[160:163], a[160:163], a[224:227], v[160:163]
ds_read_b128 a[192:195], v3 offset:0
v_mfma_f32_16x16x32_bf16 v[164:167], a[160:163], a[228:231], v[164:167]
s_add_u32 s37, s31, 0
v_mfma_f32_16x16x32_bf16 v[168:171], a[160:163], a[232:235], v[168:171]
s_add_u32 m0, s33, 0
ds_read_b128 a[196:199], v4 offset:1024
v_mfma_f32_16x16x32_bf16 v[172:175], a[160:163], a[236:239], v[172:175]
buffer_load_dwordx4 v2, s[20:23], s37 offen  lds
v_mfma_f32_16x16x32_bf16 v[176:179], a[160:163], a[240:243], v[176:179]
ds_read_b128 a[200:203], v3 offset:4096
v_cvt_pk_bf16_f32 v32, v160, v161
v_cvt_pk_bf16_f32 v33, v162, v163
v_mfma_f32_16x16x32_bf16 v[180:183], a[160:163], a[244:247], v[180:183]
v_cvt_pk_bf16_f32 v36, v164, v165
v_cvt_pk_bf16_f32 v37, v166, v167
v_mfma_f32_16x16x32_bf16 v[184:187], a[160:163], a[248:251], v[184:187]
ds_read_b128 a[204:207], v4 offset:5120
v_cvt_pk_bf16_f32 v40, v168, v169
v_cvt_pk_bf16_f32 v41, v170, v171
v_mfma_f32_16x16x32_bf16 v[188:191], a[160:163], a[252:255], v[188:191]
ds_read_b64_tr_b16 a[160:161], v5 offset:0
v_cvt_pk_bf16_f32 v44, v172, v173
v_cvt_pk_bf16_f32 v45, v174, v175
v_mfma_f32_16x16x32_bf16 v[192:195], a[164:167], a[224:227], v[192:195]
s_add_u32 s37, s31, 32768
ds_read_b64_tr_b16 a[162:163], v5 offset:1024
v_cvt_pk_bf16_f32 v48, v176, v177
v_cvt_pk_bf16_f32 v49, v178, v179
v_mfma_f32_16x16x32_bf16 v[196:199], a[164:167], a[228:231], v[196:199]
s_add_u32 m0, s33, 1024
ds_read_b128 a[208:211], v3 offset:8192
v_add_u32 v5, 16384, v5
v_cvt_pk_bf16_f32 v52, v180, v181
v_cvt_pk_bf16_f32 v53, v182, v183
v_mfma_f32_16x16x32_bf16 v[200:203], a[164:167], a[232:235], v[200:203]
buffer_load_dwordx4 v2, s[20:23], s37 offen  lds
v_and_b32 v5, 65535, v5
v_cvt_pk_bf16_f32 v56, v184, v185
v_cvt_pk_bf16_f32 v57, v186, v187
v_mfma_f32_16x16x32_bf16 v[204:207], a[164:167], a[236:239], v[204:207]
ds_read_b128 a[212:215], v4 offset:9216
v_cvt_pk_bf16_f32 v60, v188, v189
v_cvt_pk_bf16_f32 v61, v190, v191
v_mfma_f32_16x16x32_bf16 v[208:211], a[164:167], a[240:243], v[208:211]
v_cvt_pk_bf16_f32 v34, v192, v193
v_cvt_pk_bf16_f32 v35, v194, v195
v_mfma_f32_16x16x32_bf16 v[212:215], a[164:167], a[244:247], v[212:215]
ds_read_b128 a[216:219], v3 offset:12288
v_cvt_pk_bf16_f32 v38, v196, v197
v_cvt_pk_bf16_f32 v39, v198, v199
v_mfma_f32_16x16x32_bf16 v[216:219], a[164:167], a[248:251], v[216:219]
v_cvt_pk_bf16_f32 v42, v200, v201
v_cvt_pk_bf16_f32 v43, v202, v203
v_mfma_f32_16x16x32_bf16 v[220:223], a[164:167], a[252:255], v[220:223]
s_add_u32 s37, s31, 131072
ds_read_b64_tr_b16 a[164:165], v6 offset:0
v_cvt_pk_bf16_f32 v46, v204, v205
v_cvt_pk_bf16_f32 v47, v206, v207
v_mfma_f32_16x16x32_bf16 v[224:227], a[168:171], a[224:227], v[224:227]
s_add_u32 m0, s33, 4096
ds_read_b64_tr_b16 a[166:167], v6 offset:1024
v_cvt_pk_bf16_f32 v50, v208, v209
v_cvt_pk_bf16_f32 v51, v210, v211
v_mfma_f32_16x16x32_bf16 v[228:231], a[168:171], a[228:231], v[228:231]
buffer_load_dwordx4 v2, s[20:23], s37 offen  lds
v_xor_b32 v6, 16, v5
v_cvt_pk_bf16_f32 v54, v212, v213
v_cvt_pk_bf16_f32 v55, v214, v215
v_mfma_f32_16x16x32_bf16 v[232:235], a[168:171], a[232:235], v[232:235]
ds_read_b128 a[220:223], v4 offset:13312
v_cvt_pk_bf16_f32 v58, v216, v217
v_cvt_pk_bf16_f32 v59, v218, v219
v_mfma_f32_16x16x32_bf16 v[236:239], a[168:171], a[236:239], v[236:239]
v_cvt_pk_bf16_f32 v62, v220, v221
v_cvt_pk_bf16_f32 v63, v222, v223
v_mfma_f32_16x16x32_bf16 v[240:243], a[168:171], a[240:243], v[240:243]
ds_read_b64_tr_b16 a[188:189], v12 offset:0
v_cvt_pk_bf16_f32 v64, v224, v225
v_cvt_pk_bf16_f32 v65, v226, v227
v_mfma_f32_16x16x32_bf16 v[244:247], a[168:171], a[244:247], v[244:247]
v_cvt_pk_bf16_f32 v68, v228, v229
v_cvt_pk_bf16_f32 v69, v230, v231
v_mfma_f32_16x16x32_bf16 v[248:251], a[168:171], a[248:251], v[248:251]
s_add_u32 s37, s31, 163840
ds_read_b64_tr_b16 a[190:191], v12 offset:1024
v_cvt_pk_bf16_f32 v72, v232, v233
v_cvt_pk_bf16_f32 v73, v234, v235
v_mfma_f32_16x16x32_bf16 v[252:255], a[168:171], a[252:255], v[252:255]
s_add_u32 m0, s33, 5120
ds_read_b64_tr_b16 a[168:169], v7 offset:0
v_cvt_pk_bf16_f32 v76, v236, v237
v_cvt_pk_bf16_f32 v77, v238, v239
v_mfma_f32_16x16x32_bf16 a[0:3], a[172:175], a[224:227], a[0:3]
buffer_load_dwordx4 v2, s[20:23], s37 offen  lds
ds_read_b64_tr_b16 a[170:171], v7 offset:1024
v_cvt_pk_bf16_f32 v80, v240, v241
v_cvt_pk_bf16_f32 v81, v242, v243
v_mfma_f32_16x16x32_bf16 a[4:7], a[172:175], a[228:231], a[4:7]
s_add_u32 s31, s31, 262144
v_xor_b32 v7, 64, v5
v_xor_b32 v12, 208, v5
v_cvt_pk_bf16_f32 v84, v244, v245
v_cvt_pk_bf16_f32 v85, v246, v247
v_mfma_f32_16x16x32_bf16 a[8:11], a[172:175], a[232:235], a[8:11]
s_add_u32 s33, s33, 16384
v_cvt_pk_bf16_f32 v88, v248, v249
v_cvt_pk_bf16_f32 v89, v250, v251
v_mfma_f32_16x16x32_bf16 a[12:15], a[172:175], a[236:239], a[12:15]
s_and_b32 s33, s33, 65535
v_cvt_pk_bf16_f32 v92, v252, v253
v_cvt_pk_bf16_f32 v93, v254, v255
v_mfma_f32_16x16x32_bf16 a[16:19], a[172:175], a[240:243], a[16:19]
v_accvgpr_read_b32 v20, a0
v_accvgpr_read_b32 v21, a1
v_accvgpr_read_b32 v22, a2
v_accvgpr_read_b32 v23, a3
v_mfma_f32_16x16x32_bf16 a[20:23], a[172:175], a[244:247], a[20:23]
s_mov_b32 s48, s30
v_cvt_pk_bf16_f32 v66, v20, v21
v_cvt_pk_bf16_f32 v67, v22, v23
v_accvgpr_read_b32 v24, a4
v_accvgpr_read_b32 v25, a5
v_mfma_f32_16x16x32_bf16 a[24:27], a[172:175], a[248:251], a[24:27]
s_add_u32 m0, s32, 0
v_accvgpr_read_b32 v26, a6
v_accvgpr_read_b32 v27, a7
v_cvt_pk_bf16_f32 v70, v24, v25
v_cvt_pk_bf16_f32 v71, v26, v27
v_mfma_f32_16x16x32_bf16 a[28:31], a[172:175], a[252:255], a[28:31]
buffer_load_dwordx4 v1, s[12:15], s48 offen lds
ds_read_b64_tr_b16 a[172:173], v8 offset:0
v_accvgpr_read_b32 v20, a8
v_accvgpr_read_b32 v21, a9
v_mfma_f32_16x16x32_bf16 a[32:35], a[176:179], a[224:227], a[32:35]
ds_read_b64_tr_b16 a[174:175], v8 offset:1024
v_mov_b32 v16, 0
v_accvgpr_read_b32 v22, a10
v_accvgpr_read_b32 v23, a11
v_mfma_f32_16x16x32_bf16 a[36:39], a[176:179], a[228:231], a[36:39]
v_mov_b32 v17, 1
v_xor_b32 v8, 80, v5
v_cvt_pk_bf16_f32 v74, v20, v21
v_cvt_pk_bf16_f32 v75, v22, v23
v_mfma_f32_16x16x32_bf16 a[40:43], a[176:179], a[232:235], a[40:43]
s_cmp_eq_u32 s17, 0
s_cselect_b32 s29, s39, 536870912
v_accvgpr_read_b32 v24, a12
v_accvgpr_read_b32 v25, a13
v_mfma_f32_16x16x32_bf16 a[44:47], a[176:179], a[236:239], a[44:47]
s_mov_b64 exec, 1
buffer_store_dword v17, v16, s[8:11], s29 offen sc1
s_mov_b64 exec, -1
v_accvgpr_read_b32 v26, a14
v_mfma_f32_16x16x32_bf16 a[48:51], a[176:179], a[240:243], a[48:51]
s_add_u32 s48, s48, s34
v_accvgpr_read_b32 v27, a15
v_cvt_pk_bf16_f32 v78, v24, v25
v_cvt_pk_bf16_f32 v79, v26, v27
v_accvgpr_read_b32 v20, a16
v_mfma_f32_16x16x32_bf16 a[52:55], a[176:179], a[244:247], a[52:55]
s_add_u32 m0, s32, 4096
v_accvgpr_read_b32 v21, a17
v_accvgpr_read_b32 v22, a18
v_accvgpr_read_b32 v23, a19
v_cvt_pk_bf16_f32 v82, v20, v21
v_mfma_f32_16x16x32_bf16 a[56:59], a[176:179], a[248:251], a[56:59]
buffer_load_dwordx4 v1, s[12:15], s48 offen lds
v_cvt_pk_bf16_f32 v83, v22, v23
v_accvgpr_read_b32 v24, a20
v_accvgpr_read_b32 v25, a21
v_mfma_f32_16x16x32_bf16 a[60:63], a[176:179], a[252:255], a[60:63]
ds_read_b64_tr_b16 a[176:177], v9 offset:0
v_accvgpr_read_b32 v26, a22
v_accvgpr_read_b32 v27, a23
v_cvt_pk_bf16_f32 v86, v24, v25
v_mfma_f32_16x16x32_bf16 a[64:67], a[180:183], a[224:227], a[64:67]
ds_read_b64_tr_b16 a[178:179], v9 offset:1024
v_cvt_pk_bf16_f32 v87, v26, v27
v_accvgpr_read_b32 v20, a24
v_accvgpr_read_b32 v21, a25
v_mfma_f32_16x16x32_bf16 a[68:71], a[180:183], a[228:231], a[68:71]
v_xor_b32 v9, 128, v5
v_accvgpr_read_b32 v22, a26
v_accvgpr_read_b32 v23, a27
v_cvt_pk_bf16_f32 v90, v20, v21
v_mfma_f32_16x16x32_bf16 a[72:75], a[180:183], a[232:235], a[72:75]
v_cvt_pk_bf16_f32 v91, v22, v23
v_accvgpr_read_b32 v24, a28
v_accvgpr_read_b32 v25, a29
v_accvgpr_read_b32 v26, a30
v_mfma_f32_16x16x32_bf16 a[76:79], a[180:183], a[236:239], a[76:79]
s_add_u32 s48, s48, s34
v_accvgpr_read_b32 v27, a31
v_cvt_pk_bf16_f32 v94, v24, v25
v_cvt_pk_bf16_f32 v95, v26, v27
v_accvgpr_read_b32 v20, a32
v_mfma_f32_16x16x32_bf16 a[80:83], a[180:183], a[240:243], a[80:83]
s_add_u32 m0, s32, 8192
v_accvgpr_read_b32 v21, a33
v_accvgpr_read_b32 v22, a34
v_accvgpr_read_b32 v23, a35
v_cvt_pk_bf16_f32 v96, v20, v21
v_mfma_f32_16x16x32_bf16 a[84:87], a[180:183], a[244:247], a[84:87]
buffer_load_dwordx4 v1, s[12:15], s48 offen lds
v_cvt_pk_bf16_f32 v97, v22, v23
v_accvgpr_read_b32 v24, a36
v_accvgpr_read_b32 v25, a37
v_mfma_f32_16x16x32_bf16 a[88:91], a[180:183], a[248:251], a[88:91]
v_accvgpr_read_b32 v26, a38
v_accvgpr_read_b32 v27, a39
v_cvt_pk_bf16_f32 v100, v24, v25
v_cvt_pk_bf16_f32 v101, v26, v27
v_mfma_f32_16x16x32_bf16 a[92:95], a[180:183], a[252:255], a[92:95]
ds_read_b64_tr_b16 a[180:181], v10 offset:0
v_accvgpr_read_b32 v20, a40
v_accvgpr_read_b32 v21, a41
v_accvgpr_read_b32 v22, a42
v_mfma_f32_16x16x32_bf16 a[96:99], a[184:187], a[224:227], a[96:99]
ds_read_b64_tr_b16 a[182:183], v10 offset:1024
v_accvgpr_read_b32 v23, a43
v_cvt_pk_bf16_f32 v104, v20, v21
v_cvt_pk_bf16_f32 v105, v22, v23
v_mfma_f32_16x16x32_bf16 a[100:103], a[184:187], a[228:231], a[100:103]
v_xor_b32 v10, 144, v5
v_accvgpr_read_b32 v24, a44
v_accvgpr_read_b32 v25, a45
v_accvgpr_read_b32 v26, a46
v_mfma_f32_16x16x32_bf16 a[104:107], a[184:187], a[232:235], a[104:107]
s_add_u32 s48, s48, s34
v_accvgpr_read_b32 v27, a47
v_cvt_pk_bf16_f32 v108, v24, v25
v_cvt_pk_bf16_f32 v109, v26, v27
v_accvgpr_read_b32 v20, a48
v_mfma_f32_16x16x32_bf16 a[108:111], a[184:187], a[236:239], a[108:111]
s_add_u32 m0, s32, 12288
v_accvgpr_read_b32 v21, a49
v_accvgpr_read_b32 v22, a50
v_accvgpr_read_b32 v23, a51
v_cvt_pk_bf16_f32 v112, v20, v21
v_mfma_f32_16x16x32_bf16 a[112:115], a[184:187], a[240:243], a[112:115]
buffer_load_dwordx4 v1, s[12:15], s48 offen lds
v_cvt_pk_bf16_f32 v113, v22, v23
v_accvgpr_read_b32 v24, a52
v_accvgpr_read_b32 v25, a53
v_mfma_f32_16x16x32_bf16 a[116:119], a[184:187], a[244:247], a[116:119]
v_accvgpr_read_b32 v26, a54
v_accvgpr_read_b32 v27, a55
v_cvt_pk_bf16_f32 v116, v24, v25
v_cvt_pk_bf16_f32 v117, v26, v27
v_mfma_f32_16x16x32_bf16 a[120:123], a[184:187], a[248:251], a[120:123]
v_accvgpr_read_b32 v20, a56
v_accvgpr_read_b32 v21, a57
v_accvgpr_read_b32 v22, a58
v_accvgpr_read_b32 v23, a59
v_mfma_f32_16x16x32_bf16 a[124:127], a[184:187], a[252:255], a[124:127]
ds_read_b64_tr_b16 a[184:185], v11 offset:0
v_cvt_pk_bf16_f32 v120, v20, v21
v_cvt_pk_bf16_f32 v121, v22, v23
v_accvgpr_read_b32 v24, a60
v_mfma_f32_16x16x32_bf16 a[128:131], v[28:31], a[224:227], a[128:131]
ds_read_b64_tr_b16 a[186:187], v11 offset:1024
v_accvgpr_read_b32 v25, a61
v_accvgpr_read_b32 v26, a62
v_accvgpr_read_b32 v27, a63
v_mfma_f32_16x16x32_bf16 a[132:135], v[28:31], a[228:231], a[132:135]
v_xor_b32 v11, 192, v5
v_cvt_pk_bf16_f32 v124, v24, v25
v_cvt_pk_bf16_f32 v125, v26, v27
v_mfma_f32_16x16x32_bf16 a[136:139], v[28:31], a[232:235], a[136:139]
buffer_load_dword v15, v14, s[96:99], s100 offen
v_mfma_f32_16x16x32_bf16 a[140:143], v[28:31], a[236:239], a[140:143]
s_add_u32 s100, s100, 16384
v_mfma_f32_16x16x32_bf16 a[144:147], v[28:31], a[240:243], a[144:147]
v_mfma_f32_16x16x32_bf16 a[148:151], v[28:31], a[244:247], a[148:151]
v_mfma_f32_16x16x32_bf16 a[152:155], v[28:31], a[248:251], a[152:155]
v_mfma_f32_16x16x32_bf16 a[156:159], v[28:31], a[252:255], a[156:159]
s_cmp_lt_u32 s35, s45
s_cbranch_scc1 L_g_tile
s_branch L_g_end
L_g_k17v:
s_waitcnt vmcnt(18) lgkmcnt(0)
s_barrier
v_mfma_f32_16x16x32_bf16 v[160:163], a[160:163], a[224:227], v[160:163]
ds_read_b64_tr_b16 a[192:193], v5 offset:0
v_mfma_f32_16x16x32_bf16 v[164:167], a[160:163], a[228:231], v[164:167]
s_add_u32 s37, s31, 0
v_mfma_f32_16x16x32_bf16 v[168:171], a[160:163], a[232:235], v[168:171]
s_add_u32 m0, s33, 0
ds_read_b64_tr_b16 a[194:195], v5 offset:1024
v_mfma_f32_16x16x32_bf16 v[172:175], a[160:163], a[236:239], v[172:175]
buffer_load_dwordx4 v2, s[20:23], s37 offen  lds
v_mfma_f32_16x16x32_bf16 v[176:179], a[160:163], a[240:243], v[176:179]
ds_read_b64_tr_b16 a[196:197], v6 offset:0
v_cvt_pk_bf16_f32 v32, v160, v161
v_cvt_pk_bf16_f32 v33, v162, v163
v_mfma_f32_16x16x32_bf16 v[180:183], a[160:163], a[244:247], v[180:183]
v_cvt_pk_bf16_f32 v36, v164, v165
v_cvt_pk_bf16_f32 v37, v166, v167
v_mfma_f32_16x16x32_bf16 v[184:187], a[160:163], a[248:251], v[184:187]
ds_read_b64_tr_b16 a[198:199], v6 offset:1024
v_cvt_pk_bf16_f32 v40, v168, v169
v_cvt_pk_bf16_f32 v41, v170, v171
v_mfma_f32_16x16x32_bf16 v[188:191], a[160:163], a[252:255], v[188:191]
ds_read_b128 a[160:163], v3 offset:0
v_cvt_pk_bf16_f32 v44, v172, v173
v_cvt_pk_bf16_f32 v45, v174, v175
v_mfma_f32_16x16x32_bf16 v[192:195], a[164:167], a[224:227], v[192:195]
s_add_u32 s37, s31, 32768
ds_read_b64_tr_b16 a[200:201], v7 offset:0
v_cvt_pk_bf16_f32 v48, v176, v177
v_cvt_pk_bf16_f32 v49, v178, v179
v_mfma_f32_16x16x32_bf16 v[196:199], a[164:167], a[228:231], v[196:199]
s_add_u32 m0, s33, 1024
v_cvt_pk_bf16_f32 v52, v180, v181
v_cvt_pk_bf16_f32 v53, v182, v183
v_mfma_f32_16x16x32_bf16 v[200:203], a[164:167], a[232:235], v[200:203]
buffer_load_dwordx4 v2, s[20:23], s37 offen  lds
v_cvt_pk_bf16_f32 v56, v184, v185
v_cvt_pk_bf16_f32 v57, v186, v187
v_mfma_f32_16x16x32_bf16 v[204:207], a[164:167], a[236:239], v[204:207]
ds_read_b64_tr_b16 a[202:203], v7 offset:1024
v_cvt_pk_bf16_f32 v60, v188, v189
v_cvt_pk_bf16_f32 v61, v190, v191
v_mfma_f32_16x16x32_bf16 v[208:211], a[164:167], a[240:243], v[208:211]
v_cvt_pk_bf16_f32 v34, v192, v193
v_cvt_pk_bf16_f32 v35, v194, v195
v_mfma_f32_16x16x32_bf16 v[212:215], a[164:167], a[244:247], v[212:215]
ds_read_b64_tr_b16 a[204:205], v8 offset:0
v_cvt_pk_bf16_f32 v38, v196, v197
v_cvt_pk_bf16_f32 v39, v198, v199
v_mfma_f32_16x16x32_bf16 v[216:219], a[164:167], a[248:251], v[216:219]
v_cvt_pk_bf16_f32 v42, v200, v201
v_cvt_pk_bf16_f32 v43, v202, v203
v_mfma_f32_16x16x32_bf16 v[220:223], a[164:167], a[252:255], v[220:223]
s_add_u32 s37, s31, 131072
ds_read_b128 a[164:167], v4 offset:1024
v_cvt_pk_bf16_f32 v46, v204, v205
v_cvt_pk_bf16_f32 v47, v206, v207
v_mfma_f32_16x16x32_bf16 v[224:227], a[168:171], a[224:227], v[224:227]
s_add_u32 m0, s33, 4096
ds_read_b64_tr_b16 a[206:207], v8 offset:1024
v_cvt_pk_bf16_f32 v50, v208, v209
v_cvt_pk_bf16_f32 v51, v210, v211
v_mfma_f32_16x16x32_bf16 v[228:231], a[168:171], a[228:231], v[228:231]
buffer_load_dwordx4 v2, s[20:23], s37 offen  lds
v_cvt_pk_bf16_f32 v54, v212, v213
v_cvt_pk_bf16_f32 v55, v214, v215
v_mfma_f32_16x16x32_bf16 v[232:235], a[168:171], a[232:235], v[232:235]
ds_read_b64_tr_b16 a[208:209], v9 offset:0
v_cvt_pk_bf16_f32 v58, v216, v217
v_cvt_pk_bf16_f32 v59, v218, v219
v_mfma_f32_16x16x32_bf16 v[236:239], a[168:171], a[236:239], v[236:239]
v_cvt_pk_bf16_f32 v62, v220, v221
v_cvt_pk_bf16_f32 v63, v222, v223
v_mfma_f32_16x16x32_bf16 v[240:243], a[168:171], a[240:243], v[240:243]
ds_read_b64_tr_b16 a[210:211], v9 offset:1024
v_cvt_pk_bf16_f32 v64, v224, v225
v_cvt_pk_bf16_f32 v65, v226, v227
v_mfma_f32_16x16x32_bf16 v[244:247], a[168:171], a[244:247], v[244:247]
v_cvt_pk_bf16_f32 v68, v228, v229
v_cvt_pk_bf16_f32 v69, v230, v231
v_mfma_f32_16x16x32_bf16 v[248:251], a[168:171], a[248:251], v[248:251]
s_add_u32 s37, s31, 163840
ds_read_b64_tr_b16 a[212:213], v10 offset:0
v_cvt_pk_bf16_f32 v72, v232, v233
v_cvt_pk_bf16_f32 v73, v234, v235
v_mfma_f32_16x16x32_bf16 v[252:255], a[168:171], a[252:255], v[252:255]
s_add_u32 m0, s33, 5120
ds_read_b128 a[168:171], v3 offset:4096
v_cvt_pk_bf16_f32 v76, v236, v237
v_cvt_pk_bf16_f32 v77, v238, v239
v_mfma_f32_16x16x32_bf16 a[0:3], a[172:175], a[224:227], a[0:3]
buffer_load_dwordx4 v2, s[20:23], s37 offen  lds
v_cvt_pk_bf16_f32 v80, v240, v241
v_cvt_pk_bf16_f32 v81, v242, v243
v_mfma_f32_16x16x32_bf16 a[4:7], a[172:175], a[228:231], a[4:7]
s_add_u32 s31, s31, 262144
ds_read_b64_tr_b16 a[214:215], v10 offset:1024
v_cvt_pk_bf16_f32 v84, v244, v245
v_cvt_pk_bf16_f32 v85, v246, v247
v_mfma_f32_16x16x32_bf16 a[8:11], a[172:175], a[232:235], a[8:11]
s_add_u32 s33, s33, 16384
v_cvt_pk_bf16_f32 v88, v248, v249
v_cvt_pk_bf16_f32 v89, v250, v251
v_mfma_f32_16x16x32_bf16 a[12:15], a[172:175], a[236:239], a[12:15]
s_and_b32 s33, s33, 65535
ds_read_b64_tr_b16 a[216:217], v11 offset:0
v_cvt_pk_bf16_f32 v92, v252, v253
v_cvt_pk_bf16_f32 v93, v254, v255
v_mfma_f32_16x16x32_bf16 a[16:19], a[172:175], a[240:243], a[16:19]
v_accvgpr_read_b32 v20, a0
v_accvgpr_read_b32 v21, a1
v_accvgpr_read_b32 v22, a2
v_accvgpr_read_b32 v23, a3
v_mfma_f32_16x16x32_bf16 a[20:23], a[172:175], a[244:247], a[20:23]
s_mov_b32 s48, s30
ds_read_b64_tr_b16 a[218:219], v11 offset:1024
v_cvt_pk_bf16_f32 v66, v20, v21
v_cvt_pk_bf16_f32 v67, v22, v23
v_accvgpr_read_b32 v24, a4
v_mfma_f32_16x16x32_bf16 a[24:27], a[172:175], a[248:251], a[24:27]
s_add_u32 m0, s32, 0
v_accvgpr_read_b32 v25, a5
v_accvgpr_read_b32 v26, a6
v_accvgpr_read_b32 v27, a7
v_cvt_pk_bf16_f32 v70, v24, v25
v_mfma_f32_16x16x32_bf16 a[28:31], a[172:175], a[252:255], a[28:31]
buffer_load_dwordx4 v1, s[12:15], s48 offen lds
ds_read_b128 a[172:175], v4 offset:5120
v_cvt_pk_bf16_f32 v71, v26, v27
v_accvgpr_read_b32 v20, a8
v_mfma_f32_16x16x32_bf16 a[32:35], a[176:179], a[224:227], a[32:35]
ds_read_b64_tr_b16 a[220:221], v12 offset:0
v_mov_b32 v16, 0
v_accvgpr_read_b32 v21, a9
v_accvgpr_read_b32 v22, a10
v_mfma_f32_16x16x32_bf16 a[36:39], a[176:179], a[228:231], a[36:39]
v_mov_b32 v17, 1
v_accvgpr_read_b32 v23, a11
v_cvt_pk_bf16_f32 v74, v20, v21
v_cvt_pk_bf16_f32 v75, v22, v23
v_mfma_f32_16x16x32_bf16 a[40:43], a[176:179], a[232:235], a[40:43]
ds_read_b64_tr_b16 a[222:223], v12 offset:1024
v_accvgpr_read_b32 v24, a12
v_accvgpr_read_b32 v25, a13
v_accvgpr_read_b32 v26, a14
v_mfma_f32_16x16x32_bf16 a[44:47], a[176:179], a[236:239], a[44:47]
s_cmp_eq_u32 s17, 0
s_cselect_b32 s29, s39, 536870912
v_accvgpr_read_b32 v27, a15
v_cvt_pk_bf16_f32 v78, v24, v25
v_mfma_f32_16x16x32_bf16 a[48:51], a[176:179], a[240:243], a[48:51]
s_add_u32 s48, s48, s34
ds_read_b128 a[188:191], v4 offset:13312
v_cvt_pk_bf16_f32 v79, v26, v27
v_accvgpr_read_b32 v20, a16
v_accvgpr_read_b32 v21, a17
v_mfma_f32_16x16x32_bf16 a[52:55], a[176:179], a[244:247], a[52:55]
s_add_u32 m0, s32, 4096
v_accvgpr_read_b32 v22, a18
v_accvgpr_read_b32 v23, a19
v_cvt_pk_bf16_f32 v82, v20, v21
v_cvt_pk_bf16_f32 v83, v22, v23
v_mfma_f32_16x16x32_bf16 a[56:59], a[176:179], a[248:251], a[56:59]
buffer_load_dwordx4 v1, s[12:15], s48 offen lds
v_accvgpr_read_b32 v24, a20
v_accvgpr_read_b32 v25, a21
v_accvgpr_read_b32 v26, a22
v_mfma_f32_16x16x32_bf16 a[60:63], a[176:179], a[252:255], a[60:63]
ds_read_b128 a[176:179], v3 offset:8192
v_add_u32 v5, 16384, v5
v_accvgpr_read_b32 v27, a23
v_cvt_pk_bf16_f32 v86, v24, v25
v_mfma_f32_16x16x32_bf16 a[64:67], a[180:183], a[224:227], a[64:67]
s_mov_b64 exec, 1
buffer_store_dword v17, v16, s[8:11], s29 offen sc1
s_mov_b64 exec, -1
v_cvt_pk_bf16_f32 v87, v26, v27
v_mfma_f32_16x16x32_bf16 a[68:71], a[180:183], a[228:231], a[68:71]
v_and_b32 v5, 65535, v5
v_xor_b32 v6, 16, v5
v_accvgpr_read_b32 v20, a24
v_accvgpr_read_b32 v21, a25
v_mfma_f32_16x16x32_bf16 a[72:75], a[180:183], a[232:235], a[72:75]
v_xor_b32 v7, 64, v5
v_xor_b32 v8, 80, v5
v_accvgpr_read_b32 v22, a26
v_accvgpr_read_b32 v23, a27
v_mfma_f32_16x16x32_bf16 a[76:79], a[180:183], a[236:239], a[76:79]
s_add_u32 s48, s48, s34
v_xor_b32 v9, 128, v5
v_xor_b32 v10, 144, v5
v_cvt_pk_bf16_f32 v90, v20, v21
v_cvt_pk_bf16_f32 v91, v22, v23
v_mfma_f32_16x16x32_bf16 a[80:83], a[180:183], a[240:243], a[80:83]
s_add_u32 m0, s32, 8192
v_xor_b32 v11, 192, v5
v_xor_b32 v12, 208, v5
v_accvgpr_read_b32 v24, a28
v_accvgpr_read_b32 v25, a29
v_mfma_f32_16x16x32_bf16 a[84:87], a[180:183], a[244:247], a[84:87]
buffer_load_dwordx4 v1, s[12:15], s48 offen lds
v_accvgpr_read_b32 v26, a30
v_accvgpr_read_b32 v27, a31
v_cvt_pk_bf16_f32 v94, v24, v25
v_mfma_f32_16x16x32_bf16 a[88:91], a[180:183], a[248:251], a[88:91]
v_cvt_pk_bf16_f32 v95, v26, v27
v_accvgpr_read_b32 v20, a32
v_accvgpr_read_b32 v21, a33
v_accvgpr_read_b32 v22, a34
v_mfma_f32_16x16x32_bf16 a[92:95], a[180:183], a[252:255], a[92:95]
ds_read_b128 a[180:183], v4 offset:9216
v_accvgpr_read_b32 v23, a35
v_cvt_pk_bf16_f32 v96, v20, v21
v_cvt_pk_bf16_f32 v97, v22, v23
v_mfma_f32_16x16x32_bf16 a[96:99], a[184:187], a[224:227], a[96:99]
v_accvgpr_read_b32 v24, a36
v_accvgpr_read_b32 v25, a37
v_accvgpr_read_b32 v26, a38
v_accvgpr_read_b32 v27, a39
v_mfma_f32_16x16x32_bf16 a[100:103], a[184:187], a[228:231], a[100:103]
v_cvt_pk_bf16_f32 v100, v24, v25
v_cvt_pk_bf16_f32 v101, v26, v27
v_accvgpr_read_b32 v20, a40
v_accvgpr_read_b32 v21, a41
v_mfma_f32_16x16x32_bf16 a[104:107], a[184:187], a[232:235], a[104:107]
s_add_u32 s48, s48, s34
v_accvgpr_read_b32 v22, a42
v_accvgpr_read_b32 v23, a43
v_cvt_pk_bf16_f32 v104, v20, v21
v_cvt_pk_bf16_f32 v105, v22, v23
v_mfma_f32_16x16x32_bf16 a[108:111], a[184:187], a[236:239], a[108:111]
s_add_u32 m0, s32, 12288
v_accvgpr_read_b32 v24, a44
v_accvgpr_read_b32 v25, a45
v_accvgpr_read_b32 v26, a46
v_accvgpr_read_b32 v27, a47
v_mfma_f32_16x16x32_bf16 a[112:115], a[184:187], a[240:243], a[112:115]
buffer_load_dwordx4 v1, s[12:15], s48 offen lds
v_cvt_pk_bf16_f32 v108, v24, v25
v_cvt_pk_bf16_f32 v109, v26, v27
v_accvgpr_read_b32 v20, a48
v_mfma_f32_16x16x32_bf16 a[116:119], a[184:187], a[244:247], a[116:119]
v_accvgpr_read_b32 v21, a49
v_accvgpr_read_b32 v22, a50
v_accvgpr_read_b32 v23, a51
v_cvt_pk_bf16_f32 v112, v20, v21
v_mfma_f32_16x16x32_bf16 a[120:123], a[184:187], a[248:251], a[120:123]
v_cvt_pk_bf16_f32 v113, v22, v23
v_accvgpr_read_b32 v24, a52
v_accvgpr_read_b32 v25, a53
v_accvgpr_read_b32 v26, a54
v_mfma_f32_16x16x32_bf16 a[124:127], a[184:187], a[252:255], a[124:127]
ds_read_b128 a[184:187], v3 offset:12288
v_accvgpr_read_b32 v27, a55
v_cvt_pk_bf16_f32 v116, v24, v25
v_cvt_pk_bf16_f32 v117, v26, v27
v_mfma_f32_16x16x32_bf16 a[128:131], v[28:31], a[224:227], a[128:131]
v_accvgpr_read_b32 v20, a56
v_accvgpr_read_b32 v21, a57
v_accvgpr_read_b32 v22, a58
v_accvgpr_read_b32 v23, a59
v_mfma_f32_16x16x32_bf16 a[132:135], v[28:31], a[228:231], a[132:135]
v_cvt_pk_bf16_f32 v120, v20, v21
v_cvt_pk_bf16_f32 v121, v22, v23
v_accvgpr_read_b32 v24, a60
v_accvgpr_read_b32 v25, a61
v_mfma_f32_16x16x32_bf16 a[136:139], v[28:31], a[232:235], a[136:139]
buffer_load_dword v15, v14, s[96:99], s100 offen
v_accvgpr_read_b32 v26, a62
v_accvgpr_read_b32 v27, a63
v_cvt_pk_bf16_f32 v124, v24, v25
v_mfma_f32_16x16x32_bf16 a[140:143], v[28:31], a[236:239], a[140:143]
s_add_u32 s100, s100, 16384
v_cvt_pk_bf16_f32 v125, v26, v27
v_mfma_f32_16x16x32_bf16 a[144:147], v[28:31], a[240:243], a[144:147]
v_mfma_f32_16x16x32_bf16 a[148:151], v[28:31], a[244:247], a[148:151]
v_mfma_f32_16x16x32_bf16 a[152:155], v[28:31], a[248:251], a[152:155]
v_mfma_f32_16x16x32_bf16 a[156:159], v[28:31], a[252:255], a[156:159]
s_cmp_lt_u32 s35, s45
s_cbranch_scc1 L_g_tile
s_branch L_g_end
.p2align 3
L_g_v:
s_waitcnt vmcnt(16) lgkmcnt(0)
s_barrier
v_mfma_f32_16x16x32_bf16 v[160:163], a[160:163], a[192:195], 0
ds_read_b64_tr_b16 a[224:225], v5 offset:0
v_accvgpr_read_b32 v20, a64
v_accvgpr_read_b32 v21, a65
v_accvgpr_read_b32 v22, a66
v_mfma_f32_16x16x32_bf16 v[164:167], a[160:163], a[196:199], 0
v_accvgpr_read_b32 v23, a67
v_cvt_pk_bf16_f32 v98, v20, v21
v_cvt_pk_bf16_f32 v99, v22, v23
v_accvgpr_read_b32 v24, a68
v_mfma_f32_16x16x32_bf16 v[168:171], a[160:163], a[200:203], 0
ds_read_b64_tr_b16 a[226:227], v5 offset:1024
v_accvgpr_read_b32 v25, a69
v_accvgpr_read_b32 v26, a70
v_accvgpr_read_b32 v27, a71
v_mfma_f32_16x16x32_bf16 v[172:175], a[160:163], a[204:207], 0
s_add_u32 s37, s31, 0
v_cvt_pk_bf16_f32 v102, v24, v25
v_cvt_pk_bf16_f32 v103, v26, v27
v_accvgpr_read_b32 v20, a72
v_accvgpr_read_b32 v21, a73
v_mfma_f32_16x16x32_bf16 v[176:179], a[160:163], a[208:211], 0
s_add_u32 m0, s33, 0
ds_read_b64_tr_b16 a[228:229], v6 offset:0
v_accvgpr_read_b32 v22, a74
v_accvgpr_read_b32 v23, a75
v_cvt_pk_bf16_f32 v106, v20, v21
v_mfma_f32_16x16x32_bf16 v[180:183], a[160:163], a[212:215], 0
buffer_load_dwordx4 v2, s[20:23], s37 offen  lds
v_cvt_pk_bf16_f32 v107, v22, v23
v_accvgpr_read_b32 v24, a76
v_accvgpr_read_b32 v25, a77
v_mfma_f32_16x16x32_bf16 v[184:187], a[160:163], a[216:219], 0
ds_read_b64_tr_b16 a[230:231], v6 offset:1024
v_accvgpr_read_b32 v26, a78
v_accvgpr_read_b32 v27, a79
v_cvt_pk_bf16_f32 v110, v24, v25
v_mfma_f32_16x16x32_bf16 v[188:191], a[160:163], a[220:223], 0
ds_read_b128 a[160:163], v4 offset:0
v_cvt_pk_bf16_f32 v111, v26, v27
v_accvgpr_read_b32 v20, a80
v_accvgpr_read_b32 v21, a81
v_mfma_f32_16x16x32_bf16 v[192:195], a[164:167], a[192:195], 0
ds_read_b64_tr_b16 a[232:233], v7 offset:0
v_accvgpr_read_b32 v22, a82
v_accvgpr_read_b32 v23, a83
v_cvt_pk_bf16_f32 v114, v20, v21
v_mfma_f32_16x16x32_bf16 v[196:199], a[164:167], a[196:199], 0
v_cvt_pk_bf16_f32 v115, v22, v23
v_accvgpr_read_b32 v24, a84
v_accvgpr_read_b32 v25, a85
v_accvgpr_read_b32 v26, a86
v_mfma_f32_16x16x32_bf16 v[200:203], a[164:167], a[200:203], 0
s_add_u32 s37, s31, 32768
ds_read_b64_tr_b16 a[234:235], v7 offset:1024
v_accvgpr_read_b32 v27, a87
v_cvt_pk_bf16_f32 v118, v24, v25
v_cvt_pk_bf16_f32 v119, v26, v27
v_mfma_f32_16x16x32_bf16 v[204:207], a[164:167], a[204:207], 0
s_add_u32 m0, s33, 1024
v_accvgpr_read_b32 v20, a88
v_accvgpr_read_b32 v21, a89
v_accvgpr_read_b32 v22, a90
v_accvgpr_read_b32 v23, a91
v_mfma_f32_16x16x32_bf16 v[208:211], a[164:167], a[208:211], 0
buffer_load_dwordx4 v2, s[20:23], s37 offen  lds
v_cvt_pk_bf16_f32 v122, v20, v21
v_cvt_pk_bf16_f32 v123, v22, v23
v_accvgpr_read_b32 v24, a92
v_mfma_f32_16x16x32_bf16 v[212:215], a[164:167], a[212:215], 0
ds_read_b64_tr_b16 a[236:237], v8 offset:0
v_accvgpr_read_b32 v25, a93
v_accvgpr_read_b32 v26, a94
v_accvgpr_read_b32 v27, a95
v_mfma_f32_16x16x32_bf16 v[216:219], a[164:167], a[216:219], 0
v_cvt_pk_bf16_f32 v126, v24, v25
v_cvt_pk_bf16_f32 v127, v26, v27
v_accvgpr_read_b32 v20, a96
v_accvgpr_read_b32 v21, a97
v_mfma_f32_16x16x32_bf16 v[220:223], a[164:167], a[220:223], 0
ds_read_b128 a[164:167], v3 offset:1024
v_accvgpr_read_b32 v22, a98
v_accvgpr_read_b32 v23, a99
v_cvt_pk_bf16_f32 v128, v20, v21
v_mfma_f32_16x16x32_bf16 v[224:227], a[168:171], a[192:195], 0
ds_read_b64_tr_b16 a[238:239], v8 offset:1024
v_cvt_pk_bf16_f32 v129, v22, v23
v_accvgpr_read_b32 v24, a100
v_accvgpr_read_b32 v25, a101
v_mfma_f32_16x16x32_bf16 v[228:231], a[168:171], a[196:199], 0
s_add_u32 s37, s31, 131072
v_accvgpr_read_b32 v26, a102
v_accvgpr_read_b32 v27, a103
v_cvt_pk_bf16_f32 v132, v24, v25
v_cvt_pk_bf16_f32 v133, v26, v27
v_mfma_f32_16x16x32_bf16 v[232:235], a[168:171], a[200:203], 0
s_add_u32 m0, s33, 4096
ds_read_b64_tr_b16 a[240:241], v9 offset:0
v_accvgpr_read_b32 v20, a104
v_accvgpr_read_b32 v21, a105
v_accvgpr_read_b32 v22, a106
v_mfma_f32_16x16x32_bf16 v[236:239], a[168:171], a[204:207], 0
buffer_load_dwordx4 v2, s[20:23], s37 offen  lds
v_accvgpr_read_b32 v23, a107
v_cvt_pk_bf16_f32 v136, v20, v21
v_cvt_pk_bf16_f32 v137, v22, v23
v_mfma_f32_16x16x32_bf16 v[240:243], a[168:171], a[208:211], 0
ds_read_b64_tr_b16 a[242:243], v9 offset:1024
v_accvgpr_read_b32 v24, a108
v_accvgpr_read_b32 v25, a109
v_accvgpr_read_b32 v26, a110
v_mfma_f32_16x16x32_bf16 v[244:247], a[168:171], a[212:215], 0
v_accvgpr_read_b32 v27, a111
v_cvt_pk_bf16_f32 v140, v24, v25
v_cvt_pk_bf16_f32 v141, v26, v27
v_accvgpr_read_b32 v20, a112
v_mfma_f32_16x16x32_bf16 v[248:251], a[168:171], a[216:219], 0
ds_read_b64_tr_b16 a[244:245], v10 offset:0
v_accvgpr_read_b32 v21, a113
v_accvgpr_read_b32 v22, a114
v_accvgpr_read_b32 v23, a115
v_mfma_f32_16x16x32_bf16 v[252:255], a[168:171], a[220:223], 0
ds_read_b128 a[168:171], v4 offset:4096
v_cvt_pk_bf16_f32 v144, v20, v21
v_cvt_pk_bf16_f32 v145, v22, v23
v_accvgpr_read_b32 v24, a116
v_mfma_f32_16x16x32_bf16 a[0:3], a[172:175], a[192:195], 0
s_add_u32 s37, s31, 163840
ds_read_b64_tr_b16 a[246:247], v10 offset:1024
v_accvgpr_read_b32 v25, a117
v_accvgpr_read_b32 v26, a118
v_accvgpr_read_b32 v27, a119
v_mfma_f32_16x16x32_bf16 a[4:7], a[172:175], a[196:199], 0
s_add_u32 m0, s33, 5120
v_cvt_pk_bf16_f32 v148, v24, v25
v_cvt_pk_bf16_f32 v149, v26, v27
v_accvgpr_read_b32 v20, a120
v_accvgpr_read_b32 v21, a121
v_mfma_f32_16x16x32_bf16 a[8:11], a[172:175], a[200:203], 0
buffer_load_dwordx4 v2, s[20:23], s37 offen  lds
v_accvgpr_read_b32 v22, a122
v_accvgpr_read_b32 v23, a123
v_cvt_pk_bf16_f32 v152, v20, v21
v_mfma_f32_16x16x32_bf16 a[12:15], a[172:175], a[204:207], 0
s_add_u32 s31, s31, 262144
ds_read_b64_tr_b16 a[248:249], v11 offset:0
v_cvt_pk_bf16_f32 v153, v22, v23
v_accvgpr_read_b32 v24, a124
v_accvgpr_read_b32 v25, a125
v_mfma_f32_16x16x32_bf16 a[16:19], a[172:175], a[208:211], 0
s_add_u32 s33, s33, 16384
v_accvgpr_read_b32 v26, a126
v_accvgpr_read_b32 v27, a127
v_cvt_pk_bf16_f32 v156, v24, v25
v_cvt_pk_bf16_f32 v157, v26, v27
v_mfma_f32_16x16x32_bf16 a[20:23], a[172:175], a[212:215], 0
s_and_b32 s33, s33, 65535
ds_read_b64_tr_b16 a[250:251], v11 offset:1024
v_accvgpr_read_b32 v20, a128
v_accvgpr_read_b32 v21, a129
v_accvgpr_read_b32 v22, a130
v_mfma_f32_16x16x32_bf16 a[24:27], a[172:175], a[216:219], 0
v_accvgpr_read_b32 v23, a131
v_cvt_pk_bf16_f32 v130, v20, v21
v_cvt_pk_bf16_f32 v131, v22, v23
v_accvgpr_read_b32 v24, a132
v_mfma_f32_16x16x32_bf16 a[28:31], a[172:175], a[220:223], 0
s_add_u32 s48, s48, s34
ds_read_b128 a[172:175], v3 offset:5120
v_accvgpr_read_b32 v25, a133
v_accvgpr_read_b32 v26, a134
v_accvgpr_read_b32 v27, a135
v_mfma_f32_16x16x32_bf16 a[32:35], a[176:179], a[192:195], 0
s_add_u32 m0, s32, 16384
ds_read_b64_tr_b16 a[252:253], v12 offset:0
v_cvt_pk_bf16_f32 v134, v24, v25
v_cvt_pk_bf16_f32 v135, v26, v27
v_accvgpr_read_b32 v20, a136
v_mfma_f32_16x16x32_bf16 a[36:39], a[176:179], a[196:199], 0
buffer_load_dwordx4 v1, s[12:15], s48 offen lds
v_accvgpr_read_b32 v21, a137
v_accvgpr_read_b32 v22, a138
v_accvgpr_read_b32 v23, a139
v_mfma_f32_16x16x32_bf16 a[40:43], a[176:179], a[200:203], 0
ds_read_b64_tr_b16 a[254:255], v12 offset:1024
v_cvt_pk_bf16_f32 v138, v20, v21
v_cvt_pk_bf16_f32 v139, v22, v23
v_accvgpr_read_b32 v24, a140
v_mfma_f32_16x16x32_bf16 a[44:47], a[176:179], a[204:207], 0
v_accvgpr_read_b32 v25, a141
v_accvgpr_read_b32 v26, a142
v_accvgpr_read_b32 v27, a143
v_cvt_pk_bf16_f32 v142, v24, v25
v_mfma_f32_16x16x32_bf16 a[48:51], a[176:179], a[208:211], 0
ds_read_b128 v[28:31], v3 offset:13312
v_cvt_pk_bf16_f32 v143, v26, v27
v_accvgpr_read_b32 v20, a144
v_accvgpr_read_b32 v21, a145
s_mov_b32 s38, s62
s_mov_b32 s39, s63
v_mfma_f32_16x16x32_bf16 a[52:55], a[176:179], a[212:215], 0
v_accvgpr_read_b32 v22, a146
v_accvgpr_read_b32 v23, a147
v_cvt_pk_bf16_f32 v146, v20, v21
v_cvt_pk_bf16_f32 v147, v22, v23
s_mov_b32 s49, s50
s_mov_b32 s62, s42
v_mfma_f32_16x16x32_bf16 a[56:59], a[176:179], a[216:219], 0
s_add_u32 s48, s48, s34
v_accvgpr_read_b32 v24, a148
v_accvgpr_read_b32 v25, a149
v_accvgpr_read_b32 v26, a150
v_accvgpr_read_b32 v27, a151
s_mov_b32 s63, s43
s_mov_b32 s50, s51
v_mfma_f32_16x16x32_bf16 a[60:63], a[176:179], a[220:223], 0
s_add_u32 m0, s32, 20480
ds_read_b128 a[176:179], v4 offset:8192
v_add_u32 v5, 16384, v5
v_cvt_pk_bf16_f32 v150, v24, v25
v_cvt_pk_bf16_f32 v151, v26, v27
s_mov_b32 s36, s40
s_add_u32 s35, s35, 1
v_mfma_f32_16x16x32_bf16 a[64:67], a[180:183], a[192:195], 0
buffer_load_dwordx4 v1, s[12:15], s48 offen lds
v_and_b32 v5, 65535, v5
v_accvgpr_read_b32 v20, a152
v_accvgpr_read_b32 v21, a153
v_bfe_u32 v16, v0, 3, 3
v_lshlrev_b32 v16, 4, v16
v_mfma_f32_16x16x32_bf16 a[68:71], a[180:183], a[196:199], 0
v_xor_b32 v6, 16, v5
v_xor_b32 v7, 64, v5
v_accvgpr_read_b32 v22, a154
v_accvgpr_read_b32 v23, a155
v_and_or_b32 v16, v0, 7, v16
v_bfe_u32 v17, v0, 4, 2
v_mfma_f32_16x16x32_bf16 a[72:75], a[180:183], a[200:203], 0
v_xor_b32 v8, 80, v5
v_xor_b32 v9, 128, v5
v_cvt_pk_bf16_f32 v154, v20, v21
v_cvt_pk_bf16_f32 v155, v22, v23
v_lshlrev_b32 v17, 5, v17
v_bfe_u32 v18, v0, 1, 3
v_mfma_f32_16x16x32_bf16 a[76:79], a[180:183], a[204:207], 0
v_xor_b32 v10, 144, v5
v_xor_b32 v11, 192, v5
v_accvgpr_read_b32 v24, a156
v_accvgpr_read_b32 v25, a157
v_or_b32 v17, v17, v18
v_and_b32 v18, 1, v0
v_mfma_f32_16x16x32_bf16 a[80:83], a[180:183], a[208:211], 0
v_xor_b32 v12, 208, v5
v_accvgpr_read_b32 v26, a158
v_accvgpr_read_b32 v27, a159
v_cvt_pk_bf16_f32 v158, v24, v25
v_lshl_or_b32 v17, v18, 4, v17
v_mfma_f32_16x16x32_bf16 a[84:87], a[180:183], a[212:215], 0
s_add_u32 s48, s48, s34
v_cvt_pk_bf16_f32 v159, v26, v27
s_bitcmp1_b32 s49, 1
s_cselect_b64 vcc, -1, 0
s_movk_i32 s44, 0x80
v_cndmask_b32 v16, v16, v17, vcc
v_lshlrev_b32 v13, 4, v16
v_mfma_f32_16x16x32_bf16 a[88:91], a[180:183], a[216:219], 0
s_add_u32 m0, s32, 24576
s_lshr_b32 s93, s49, 2
s_lshr_b32 s93, 0x80000, s93
s_bitcmp1_b32 s49, 0
s_cselect_b32 s92, s93, 0x800
s_cselect_b32 s93, 0x800, s93
s_sub_u32 s93, s93, s44
v_mfma_f32_16x16x32_bf16 a[92:95], a[180:183], a[220:223], 0
buffer_load_dwordx4 v1, s[12:15], s48 offen lds
ds_read_b128 a[180:183], v3 offset:9216
v_mfma_f32_16x16x32_bf16 a[96:99], a[184:187], a[192:195], 0
v_mfma_f32_16x16x32_bf16 a[100:103], a[184:187], a[196:199], 0
v_mfma_f32_16x16x32_bf16 a[104:107], a[184:187], a[200:203], 0
v_mfma_f32_16x16x32_bf16 a[108:111], a[184:187], a[204:207], 0
v_mfma_f32_16x16x32_bf16 a[112:115], a[184:187], a[208:211], 0
s_add_u32 s48, s48, s34
v_mfma_f32_16x16x32_bf16 a[116:119], a[184:187], a[212:215], 0
s_add_u32 m0, s32, 28672
v_mfma_f32_16x16x32_bf16 a[120:123], a[184:187], a[216:219], 0
buffer_load_dwordx4 v1, s[12:15], s48 offen lds
v_mfma_f32_16x16x32_bf16 a[124:127], a[184:187], a[220:223], 0
s_add_u32 s30, s30, 128
ds_read_b128 a[184:187], v4 offset:12288
v_mfma_f32_16x16x32_bf16 a[128:131], a[188:191], a[192:195], 0
s_add_u32 s32, s32, 32768
v_add_u32 v3, 32768, v3
v_mfma_f32_16x16x32_bf16 a[132:135], a[188:191], a[196:199], 0
s_sub_u32 s48, s32, 98304
v_subrev_u32 v19, 98304, v3
v_mfma_f32_16x16x32_bf16 a[136:139], a[188:191], a[200:203], 0
s_cmp_ge_u32 s32, 163840
s_cselect_b32 s32, s48, s32
buffer_load_dword v15, v14, s[96:99], s100 offen
v_mfma_f32_16x16x32_bf16 a[140:143], a[188:191], a[204:207], 0
s_add_u32 s100, s100, 16384
v_cmp_le_u32 vcc, 163840, v3
v_mfma_f32_16x16x32_bf16 a[144:147], a[188:191], a[208:211], 0
s_nop 0
v_cndmask_b32 v3, v3, v19, vcc
v_mfma_f32_16x16x32_bf16 a[148:151], a[188:191], a[212:215], 0
v_xor_b32 v4, 64, v3
v_mfma_f32_16x16x32_bf16 a[152:155], a[188:191], a[216:219], 0
v_mfma_f32_16x16x32_bf16 a[156:159], a[188:191], a[220:223], 0
s_waitcnt vmcnt(17) lgkmcnt(0)
s_barrier
v_mfma_f32_16x16x32_bf16 v[160:163], a[160:163], a[224:227], v[160:163]
ds_read_b64_tr_b16 a[192:193], v5 offset:0
v_mfma_f32_16x16x32_bf16 v[164:167], a[160:163], a[228:231], v[164:167]
v_mfma_f32_16x16x32_bf16 v[168:171], a[160:163], a[232:235], v[168:171]
ds_read_b64_tr_b16 a[194:195], v5 offset:1024
v_mfma_f32_16x16x32_bf16 v[172:175], a[160:163], a[236:239], v[172:175]
s_add_u32 s37, s31, 0
v_mfma_f32_16x16x32_bf16 v[176:179], a[160:163], a[240:243], v[176:179]
s_add_u32 m0, s33, 0
ds_read_b64_tr_b16 a[196:197], v6 offset:0
v_mfma_f32_16x16x32_bf16 v[180:183], a[160:163], a[244:247], v[180:183]
buffer_load_dwordx4 v2, s[20:23], s37 offen  lds
v_mfma_f32_16x16x32_bf16 v[184:187], a[160:163], a[248:251], v[184:187]
ds_read_b64_tr_b16 a[198:199], v6 offset:1024
v_mfma_f32_16x16x32_bf16 v[188:191], a[160:163], a[252:255], v[188:191]
ds_read_b128 a[160:163], v3 offset:0
v_mfma_f32_16x16x32_bf16 v[192:195], a[164:167], a[224:227], v[192:195]
ds_read_b64_tr_b16 a[200:201], v7 offset:0
v_mfma_f32_16x16x32_bf16 v[196:199], a[164:167], a[228:231], v[196:199]
v_mfma_f32_16x16x32_bf16 v[200:203], a[164:167], a[232:235], v[200:203]
s_add_u32 s37, s31, 32768
ds_read_b64_tr_b16 a[202:203], v7 offset:1024
v_mfma_f32_16x16x32_bf16 v[204:207], a[164:167], a[236:239], v[204:207]
s_add_u32 m0, s33, 1024
v_mfma_f32_16x16x32_bf16 v[208:211], a[164:167], a[240:243], v[208:211]
buffer_load_dwordx4 v2, s[20:23], s37 offen  lds
v_mfma_f32_16x16x32_bf16 v[212:215], a[164:167], a[244:247], v[212:215]
ds_read_b64_tr_b16 a[204:205], v8 offset:0
v_mfma_f32_16x16x32_bf16 v[216:219], a[164:167], a[248:251], v[216:219]
s_mov_b32 s60, s38
v_mfma_f32_16x16x32_bf16 v[220:223], a[164:167], a[252:255], v[220:223]
s_mov_b32 s29, s38
ds_read_b128 a[164:167], v4 offset:1024
v_mfma_f32_16x16x32_bf16 v[224:227], a[168:171], a[224:227], v[224:227]
buffer_store_dwordx4 v[32:35], v13, s[8:11], s29 offen sc1
v_mfma_f32_16x16x32_bf16 v[228:231], a[168:171], a[228:231], v[228:231]
s_add_u32 s37, s31, 131072
ds_read_b64_tr_b16 a[206:207], v8 offset:1024
v_mfma_f32_16x16x32_bf16 v[232:235], a[168:171], a[232:235], v[232:235]
s_add_u32 m0, s33, 4096
v_mfma_f32_16x16x32_bf16 v[236:239], a[168:171], a[236:239], v[236:239]
buffer_load_dwordx4 v2, s[20:23], s37 offen  lds
v_mfma_f32_16x16x32_bf16 v[240:243], a[168:171], a[240:243], v[240:243]
ds_read_b64_tr_b16 a[208:209], v9 offset:0
v_mfma_f32_16x16x32_bf16 v[244:247], a[168:171], a[244:247], v[244:247]
v_mfma_f32_16x16x32_bf16 v[248:251], a[168:171], a[248:251], v[248:251]
ds_read_b64_tr_b16 a[210:211], v9 offset:1024
v_mfma_f32_16x16x32_bf16 v[252:255], a[168:171], a[252:255], v[252:255]
ds_read_b128 a[168:171], v3 offset:4096
v_mfma_f32_16x16x32_bf16 a[0:3], a[172:175], a[224:227], a[0:3]
s_add_u32 s37, s31, 163840
ds_read_b64_tr_b16 a[212:213], v10 offset:0
v_mfma_f32_16x16x32_bf16 a[4:7], a[172:175], a[228:231], a[4:7]
s_add_u32 m0, s33, 5120
v_mfma_f32_16x16x32_bf16 a[8:11], a[172:175], a[232:235], a[8:11]
buffer_load_dwordx4 v2, s[20:23], s37 offen  lds
v_mfma_f32_16x16x32_bf16 a[12:15], a[172:175], a[236:239], a[12:15]
s_add_u32 s31, s31, 262144
ds_read_b64_tr_b16 a[214:215], v10 offset:1024
v_mfma_f32_16x16x32_bf16 a[16:19], a[172:175], a[240:243], a[16:19]
s_add_u32 s33, s33, 16384
v_mfma_f32_16x16x32_bf16 a[20:23], a[172:175], a[244:247], a[20:23]
s_and_b32 s33, s33, 65535
ds_read_b64_tr_b16 a[216:217], v11 offset:0
v_mfma_f32_16x16x32_bf16 a[24:27], a[172:175], a[248:251], a[24:27]
v_mfma_f32_16x16x32_bf16 a[28:31], a[172:175], a[252:255], a[28:31]
s_mov_b32 s48, s30
ds_read_b128 a[172:175], v4 offset:5120
v_mfma_f32_16x16x32_bf16 a[32:35], a[176:179], a[224:227], a[32:35]
s_add_u32 m0, s32, 0
ds_read_b64_tr_b16 a[218:219], v11 offset:1024
v_mfma_f32_16x16x32_bf16 a[36:39], a[176:179], a[228:231], a[36:39]
buffer_load_dwordx4 v1, s[12:15], s48 offen lds
v_mfma_f32_16x16x32_bf16 a[40:43], a[176:179], a[232:235], a[40:43]
ds_read_b64_tr_b16 a[220:221], v12 offset:0
v_mfma_f32_16x16x32_bf16 a[44:47], a[176:179], a[236:239], a[44:47]
s_add_u32 s29, s29, s44
v_mfma_f32_16x16x32_bf16 a[48:51], a[176:179], a[240:243], a[48:51]
ds_read_b64_tr_b16 a[222:223], v12 offset:1024
v_mfma_f32_16x16x32_bf16 a[52:55], a[176:179], a[244:247], a[52:55]
buffer_store_dwordx4 v[36:39], v13, s[8:11], s29 offen sc1
v_mfma_f32_16x16x32_bf16 a[56:59], a[176:179], a[248:251], a[56:59]
s_add_u32 s48, s48, s34
ds_read_b128 a[188:191], v4 offset:13312
v_mfma_f32_16x16x32_bf16 a[60:63], a[176:179], a[252:255], a[60:63]
s_add_u32 m0, s32, 4096
ds_read_b128 a[176:179], v3 offset:8192
v_mfma_f32_16x16x32_bf16 a[64:67], a[180:183], a[224:227], a[64:67]
buffer_load_dwordx4 v1, s[12:15], s48 offen lds
v_mfma_f32_16x16x32_bf16 a[68:71], a[180:183], a[228:231], a[68:71]
v_add_u32 v5, 16384, v5
v_and_b32 v5, 65535, v5
v_mfma_f32_16x16x32_bf16 a[72:75], a[180:183], a[232:235], a[72:75]
v_xor_b32 v6, 16, v5
v_xor_b32 v7, 64, v5
v_mfma_f32_16x16x32_bf16 a[76:79], a[180:183], a[236:239], a[76:79]
v_xor_b32 v8, 80, v5
v_xor_b32 v9, 128, v5
v_mfma_f32_16x16x32_bf16 a[80:83], a[180:183], a[240:243], a[80:83]
v_xor_b32 v10, 144, v5
v_xor_b32 v11, 192, v5
v_mfma_f32_16x16x32_bf16 a[84:87], a[180:183], a[244:247], a[84:87]
s_add_u32 s48, s48, s34
v_xor_b32 v12, 208, v5
v_mfma_f32_16x16x32_bf16 a[88:91], a[180:183], a[248:251], a[88:91]
s_add_u32 m0, s32, 8192
v_mfma_f32_16x16x32_bf16 a[92:95], a[180:183], a[252:255], a[92:95]
buffer_load_dwordx4 v1, s[12:15], s48 offen lds
ds_read_b128 a[180:183], v4 offset:9216
v_mfma_f32_16x16x32_bf16 a[96:99], a[184:187], a[224:227], a[96:99]
v_mfma_f32_16x16x32_bf16 a[100:103], a[184:187], a[228:231], a[100:103]
v_mfma_f32_16x16x32_bf16 a[104:107], a[184:187], a[232:235], a[104:107]
v_mfma_f32_16x16x32_bf16 a[108:111], a[184:187], a[236:239], a[108:111]
v_mfma_f32_16x16x32_bf16 a[112:115], a[184:187], a[240:243], a[112:115]
s_add_u32 s48, s48, s34
v_mfma_f32_16x16x32_bf16 a[116:119], a[184:187], a[244:247], a[116:119]
s_add_u32 m0, s32, 12288
v_mfma_f32_16x16x32_bf16 a[120:123], a[184:187], a[248:251], a[120:123]
buffer_load_dwordx4 v1, s[12:15], s48 offen lds
v_mfma_f32_16x16x32_bf16 a[124:127], a[184:187], a[252:255], a[124:127]
ds_read_b128 a[184:187], v3 offset:12288
v_mfma_f32_16x16x32_bf16 a[128:131], v[28:31], a[224:227], a[128:131]
s_add_u32 s29, s29, s93
v_mfma_f32_16x16x32_bf16 a[132:135], v[28:31], a[228:231], a[132:135]
v_mfma_f32_16x16x32_bf16 a[136:139], v[28:31], a[232:235], a[136:139]
buffer_store_dwordx4 v[40:43], v13, s[8:11], s29 offen sc1
buffer_load_dword v15, v14, s[96:99], s100 offen
v_mfma_f32_16x16x32_bf16 a[140:143], v[28:31], a[236:239], a[140:143]
s_add_u32 s100, s100, 16384
v_mfma_f32_16x16x32_bf16 a[144:147], v[28:31], a[240:243], a[144:147]
v_mfma_f32_16x16x32_bf16 a[148:151], v[28:31], a[244:247], a[148:151]
v_mfma_f32_16x16x32_bf16 a[152:155], v[28:31], a[248:251], a[152:155]
v_mfma_f32_16x16x32_bf16 a[156:159], v[28:31], a[252:255], a[156:159]
s_waitcnt vmcnt(21) lgkmcnt(0)
s_barrier
v_mfma_f32_16x16x32_bf16 v[160:163], a[160:163], a[192:195], v[160:163]
ds_read_b64_tr_b16 a[224:225], v5 offset:0
v_mfma_f32_16x16x32_bf16 v[164:167], a[160:163], a[196:199], v[164:167]
v_mfma_f32_16x16x32_bf16 v[168:171], a[160:163], a[200:203], v[168:171]
ds_read_b64_tr_b16 a[226:227], v5 offset:1024
v_mfma_f32_16x16x32_bf16 v[172:175], a[160:163], a[204:207], v[172:175]
s_add_u32 s37, s31, 0
v_mfma_f32_16x16x32_bf16 v[176:179], a[160:163], a[208:211], v[176:179]
s_add_u32 m0, s33, 0
ds_read_b64_tr_b16 a[228:229], v6 offset:0
v_mfma_f32_16x16x32_bf16 v[180:183], a[160:163], a[212:215], v[180:183]
buffer_load_dwordx4 v2, s[20:23], s37 offen  lds
v_mfma_f32_16x16x32_bf16 v[184:187], a[160:163], a[216:219], v[184:187]
ds_read_b64_tr_b16 a[230:231], v6 offset:1024
v_mfma_f32_16x16x32_bf16 v[188:191], a[160:163], a[220:223], v[188:191]
ds_read_b128 a[160:163], v4 offset:0
v_mfma_f32_16x16x32_bf16 v[192:195], a[164:167], a[192:195], v[192:195]
ds_read_b64_tr_b16 a[232:233], v7 offset:0
v_mfma_f32_16x16x32_bf16 v[196:199], a[164:167], a[196:199], v[196:199]
v_mfma_f32_16x16x32_bf16 v[200:203], a[164:167], a[200:203], v[200:203]
s_add_u32 s37, s31, 32768
ds_read_b64_tr_b16 a[234:235], v7 offset:1024
v_mfma_f32_16x16x32_bf16 v[204:207], a[164:167], a[204:207], v[204:207]
s_add_u32 m0, s33, 1024
v_mfma_f32_16x16x32_bf16 v[208:211], a[164:167], a[208:211], v[208:211]
buffer_load_dwordx4 v2, s[20:23], s37 offen  lds
v_mfma_f32_16x16x32_bf16 v[212:215], a[164:167], a[212:215], v[212:215]
ds_read_b64_tr_b16 a[236:237], v8 offset:0
v_mfma_f32_16x16x32_bf16 v[216:219], a[164:167], a[216:219], v[216:219]
s_add_u32 s29, s29, s44
v_mfma_f32_16x16x32_bf16 v[220:223], a[164:167], a[220:223], v[220:223]
ds_read_b128 a[164:167], v3 offset:1024
v_mfma_f32_16x16x32_bf16 v[224:227], a[168:171], a[192:195], v[224:227]
buffer_store_dwordx4 v[44:47], v13, s[8:11], s29 offen sc1
v_mfma_f32_16x16x32_bf16 v[228:231], a[168:171], a[196:199], v[228:231]
s_add_u32 s37, s31, 131072
ds_read_b64_tr_b16 a[238:239], v8 offset:1024
v_mfma_f32_16x16x32_bf16 v[232:235], a[168:171], a[200:203], v[232:235]
s_add_u32 m0, s33, 4096
v_mfma_f32_16x16x32_bf16 v[236:239], a[168:171], a[204:207], v[236:239]
buffer_load_dwordx4 v2, s[20:23], s37 offen  lds
v_mfma_f32_16x16x32_bf16 v[240:243], a[168:171], a[208:211], v[240:243]
ds_read_b64_tr_b16 a[240:241], v9 offset:0
v_mfma_f32_16x16x32_bf16 v[244:247], a[168:171], a[212:215], v[244:247]
v_mfma_f32_16x16x32_bf16 v[248:251], a[168:171], a[216:219], v[248:251]
ds_read_b64_tr_b16 a[242:243], v9 offset:1024
v_mfma_f32_16x16x32_bf16 v[252:255], a[168:171], a[220:223], v[252:255]
ds_read_b128 a[168:171], v4 offset:4096
v_mfma_f32_16x16x32_bf16 a[0:3], a[172:175], a[192:195], a[0:3]
s_add_u32 s37, s31, 163840
ds_read_b64_tr_b16 a[244:245], v10 offset:0
v_mfma_f32_16x16x32_bf16 a[4:7], a[172:175], a[196:199], a[4:7]
s_add_u32 m0, s33, 5120
v_mfma_f32_16x16x32_bf16 a[8:11], a[172:175], a[200:203], a[8:11]
buffer_load_dwordx4 v2, s[20:23], s37 offen  lds
v_mfma_f32_16x16x32_bf16 a[12:15], a[172:175], a[204:207], a[12:15]
s_add_u32 s31, s31, 262144
ds_read_b64_tr_b16 a[246:247], v10 offset:1024
v_mfma_f32_16x16x32_bf16 a[16:19], a[172:175], a[208:211], a[16:19]
s_add_u32 s33, s33, 16384
v_mfma_f32_16x16x32_bf16 a[20:23], a[172:175], a[212:215], a[20:23]
s_and_b32 s33, s33, 65535
ds_read_b64_tr_b16 a[248:249], v11 offset:0
v_mfma_f32_16x16x32_bf16 a[24:27], a[172:175], a[216:219], a[24:27]
v_mfma_f32_16x16x32_bf16 a[28:31], a[172:175], a[220:223], a[28:31]
s_add_u32 s48, s48, s34
ds_read_b128 a[172:175], v3 offset:5120
v_mfma_f32_16x16x32_bf16 a[32:35], a[176:179], a[192:195], a[32:35]
s_add_u32 m0, s32, 16384
ds_read_b64_tr_b16 a[250:251], v11 offset:1024
v_mfma_f32_16x16x32_bf16 a[36:39], a[176:179], a[196:199], a[36:39]
buffer_load_dwordx4 v1, s[12:15], s48 offen lds
v_mfma_f32_16x16x32_bf16 a[40:43], a[176:179], a[200:203], a[40:43]
ds_read_b64_tr_b16 a[252:253], v12 offset:0
v_mfma_f32_16x16x32_bf16 a[44:47], a[176:179], a[204:207], a[44:47]
s_add_u32 s29, s29, s93
v_mfma_f32_16x16x32_bf16 a[48:51], a[176:179], a[208:211], a[48:51]
ds_read_b64_tr_b16 a[254:255], v12 offset:1024
v_mfma_f32_16x16x32_bf16 a[52:55], a[176:179], a[212:215], a[52:55]
buffer_store_dwordx4 v[48:51], v13, s[8:11], s29 offen sc1
v_mfma_f32_16x16x32_bf16 a[56:59], a[176:179], a[216:219], a[56:59]
s_add_u32 s48, s48, s34
ds_read_b128 v[28:31], v3 offset:13312
v_mfma_f32_16x16x32_bf16 a[60:63], a[176:179], a[220:223], a[60:63]
s_add_u32 m0, s32, 20480
ds_read_b128 a[176:179], v4 offset:8192
v_mfma_f32_16x16x32_bf16 a[64:67], a[180:183], a[192:195], a[64:67]
buffer_load_dwordx4 v1, s[12:15], s48 offen lds
v_mfma_f32_16x16x32_bf16 a[68:71], a[180:183], a[196:199], a[68:71]
v_add_u32 v5, 16384, v5
v_and_b32 v5, 65535, v5
v_mfma_f32_16x16x32_bf16 a[72:75], a[180:183], a[200:203], a[72:75]
v_xor_b32 v6, 16, v5
v_xor_b32 v7, 64, v5
v_mfma_f32_16x16x32_bf16 a[76:79], a[180:183], a[204:207], a[76:79]
v_xor_b32 v8, 80, v5
v_xor_b32 v9, 128, v5
v_mfma_f32_16x16x32_bf16 a[80:83], a[180:183], a[208:211], a[80:83]
v_xor_b32 v10, 144, v5
v_xor_b32 v11, 192, v5
v_mfma_f32_16x16x32_bf16 a[84:87], a[180:183], a[212:215], a[84:87]
s_add_u32 s48, s48, s34
v_xor_b32 v12, 208, v5
v_mfma_f32_16x16x32_bf16 a[88:91], a[180:183], a[216:219], a[88:91]
s_add_u32 m0, s32, 24576
v_mfma_f32_16x16x32_bf16 a[92:95], a[180:183], a[220:223], a[92:95]
buffer_load_dwordx4 v1, s[12:15], s48 offen lds
ds_read_b128 a[180:183], v3 offset:9216
v_mfma_f32_16x16x32_bf16 a[96:99], a[184:187], a[192:195], a[96:99]
v_mfma_f32_16x16x32_bf16 a[100:103], a[184:187], a[196:199], a[100:103]
v_mfma_f32_16x16x32_bf16 a[104:107], a[184:187], a[200:203], a[104:107]
v_mfma_f32_16x16x32_bf16 a[108:111], a[184:187], a[204:207], a[108:111]
v_mfma_f32_16x16x32_bf16 a[112:115], a[184:187], a[208:211], a[112:115]
s_add_u32 s48, s48, s34
v_mfma_f32_16x16x32_bf16 a[116:119], a[184:187], a[212:215], a[116:119]
s_add_u32 m0, s32, 28672
v_mfma_f32_16x16x32_bf16 a[120:123], a[184:187], a[216:219], a[120:123]
buffer_load_dwordx4 v1, s[12:15], s48 offen lds
v_mfma_f32_16x16x32_bf16 a[124:127], a[184:187], a[220:223], a[124:127]
s_add_u32 s30, s30, 128
ds_read_b128 a[184:187], v4 offset:12288
v_mfma_f32_16x16x32_bf16 a[128:131], a[188:191], a[192:195], a[128:131]
s_add_u32 s32, s32, 32768
s_add_u32 s29, s29, s44
v_add_u32 v3, 32768, v3
v_mfma_f32_16x16x32_bf16 a[132:135], a[188:191], a[196:199], a[132:135]
s_sub_u32 s48, s32, 98304
v_subrev_u32 v19, 98304, v3
v_mfma_f32_16x16x32_bf16 a[136:139], a[188:191], a[200:203], a[136:139]
s_cmp_ge_u32 s32, 163840
s_cselect_b32 s32, s48, s32
buffer_store_dwordx4 v[52:55], v13, s[8:11], s29 offen sc1
buffer_load_dword v15, v14, s[96:99], s100 offen
v_mfma_f32_16x16x32_bf16 a[140:143], a[188:191], a[204:207], a[140:143]
s_add_u32 s100, s100, 16384
v_cmp_le_u32 vcc, 163840, v3
v_mfma_f32_16x16x32_bf16 a[144:147], a[188:191], a[208:211], a[144:147]
s_nop 0
v_cndmask_b32 v3, v3, v19, vcc
v_mfma_f32_16x16x32_bf16 a[148:151], a[188:191], a[212:215], a[148:151]
v_xor_b32 v4, 64, v3
v_mfma_f32_16x16x32_bf16 a[152:155], a[188:191], a[216:219], a[152:155]
v_mfma_f32_16x16x32_bf16 a[156:159], a[188:191], a[220:223], a[156:159]
s_waitcnt vmcnt(24) lgkmcnt(0)
s_barrier
v_mfma_f32_16x16x32_bf16 v[160:163], a[160:163], a[224:227], v[160:163]
ds_read_b64_tr_b16 a[192:193], v5 offset:0
v_mfma_f32_16x16x32_bf16 v[164:167], a[160:163], a[228:231], v[164:167]
v_mfma_f32_16x16x32_bf16 v[168:171], a[160:163], a[232:235], v[168:171]
ds_read_b64_tr_b16 a[194:195], v5 offset:1024
v_mfma_f32_16x16x32_bf16 v[172:175], a[160:163], a[236:239], v[172:175]
s_add_u32 s37, s31, 0
v_mfma_f32_16x16x32_bf16 v[176:179], a[160:163], a[240:243], v[176:179]
s_add_u32 m0, s33, 0
ds_read_b64_tr_b16 a[196:197], v6 offset:0
v_mfma_f32_16x16x32_bf16 v[180:183], a[160:163], a[244:247], v[180:183]
buffer_load_dwordx4 v2, s[20:23], s37 offen  lds
v_mfma_f32_16x16x32_bf16 v[184:187], a[160:163], a[248:251], v[184:187]
ds_read_b64_tr_b16 a[198:199], v6 offset:1024
v_mfma_f32_16x16x32_bf16 v[188:191], a[160:163], a[252:255], v[188:191]
ds_read_b128 a[160:163], v3 offset:0
v_mfma_f32_16x16x32_bf16 v[192:195], a[164:167], a[224:227], v[192:195]
ds_read_b64_tr_b16 a[200:201], v7 offset:0
v_mfma_f32_16x16x32_bf16 v[196:199], a[164:167], a[228:231], v[196:199]
v_mfma_f32_16x16x32_bf16 v[200:203], a[164:167], a[232:235], v[200:203]
s_add_u32 s37, s31, 32768
ds_read_b64_tr_b16 a[202:203], v7 offset:1024
v_mfma_f32_16x16x32_bf16 v[204:207], a[164:167], a[236:239], v[204:207]
s_add_u32 m0, s33, 1024
v_mfma_f32_16x16x32_bf16 v[208:211], a[164:167], a[240:243], v[208:211]
buffer_load_dwordx4 v2, s[20:23], s37 offen  lds
v_mfma_f32_16x16x32_bf16 v[212:215], a[164:167], a[244:247], v[212:215]
ds_read_b64_tr_b16 a[204:205], v8 offset:0
v_mfma_f32_16x16x32_bf16 v[216:219], a[164:167], a[248:251], v[216:219]
s_add_u32 s29, s29, s93
v_mfma_f32_16x16x32_bf16 v[220:223], a[164:167], a[252:255], v[220:223]
ds_read_b128 a[164:167], v4 offset:1024
v_mfma_f32_16x16x32_bf16 v[224:227], a[168:171], a[224:227], v[224:227]
buffer_store_dwordx4 v[56:59], v13, s[8:11], s29 offen sc1
v_mfma_f32_16x16x32_bf16 v[228:231], a[168:171], a[228:231], v[228:231]
s_add_u32 s37, s31, 131072
ds_read_b64_tr_b16 a[206:207], v8 offset:1024
v_mfma_f32_16x16x32_bf16 v[232:235], a[168:171], a[232:235], v[232:235]
s_add_u32 m0, s33, 4096
v_mfma_f32_16x16x32_bf16 v[236:239], a[168:171], a[236:239], v[236:239]
buffer_load_dwordx4 v2, s[20:23], s37 offen  lds
v_mfma_f32_16x16x32_bf16 v[240:243], a[168:171], a[240:243], v[240:243]
ds_read_b64_tr_b16 a[208:209], v9 offset:0
v_mfma_f32_16x16x32_bf16 v[244:247], a[168:171], a[244:247], v[244:247]
v_mfma_f32_16x16x32_bf16 v[248:251], a[168:171], a[248:251], v[248:251]
ds_read_b64_tr_b16 a[210:211], v9 offset:1024
v_mfma_f32_16x16x32_bf16 v[252:255], a[168:171], a[252:255], v[252:255]
ds_read_b128 a[168:171], v3 offset:4096
v_mfma_f32_16x16x32_bf16 a[0:3], a[172:175], a[224:227], a[0:3]
s_add_u32 s37, s31, 163840
ds_read_b64_tr_b16 a[212:213], v10 offset:0
v_mfma_f32_16x16x32_bf16 a[4:7], a[172:175], a[228:231], a[4:7]
s_add_u32 m0, s33, 5120
v_mfma_f32_16x16x32_bf16 a[8:11], a[172:175], a[232:235], a[8:11]
buffer_load_dwordx4 v2, s[20:23], s37 offen  lds
v_mfma_f32_16x16x32_bf16 a[12:15], a[172:175], a[236:239], a[12:15]
s_add_u32 s31, s31, 262144
ds_read_b64_tr_b16 a[214:215], v10 offset:1024
v_mfma_f32_16x16x32_bf16 a[16:19], a[172:175], a[240:243], a[16:19]
s_add_u32 s33, s33, 16384
v_mfma_f32_16x16x32_bf16 a[20:23], a[172:175], a[244:247], a[20:23]
s_and_b32 s33, s33, 65535
ds_read_b64_tr_b16 a[216:217], v11 offset:0
v_mfma_f32_16x16x32_bf16 a[24:27], a[172:175], a[248:251], a[24:27]
v_mfma_f32_16x16x32_bf16 a[28:31], a[172:175], a[252:255], a[28:31]
s_mov_b32 s48, s30
ds_read_b128 a[172:175], v4 offset:5120
v_mfma_f32_16x16x32_bf16 a[32:35], a[176:179], a[224:227], a[32:35]
s_add_u32 m0, s32, 0
ds_read_b64_tr_b16 a[218:219], v11 offset:1024
v_mfma_f32_16x16x32_bf16 a[36:39], a[176:179], a[228:231], a[36:39]
buffer_load_dwordx4 v1, s[12:15], s48 offen lds
v_mfma_f32_16x16x32_bf16 a[40:43], a[176:179], a[232:235], a[40:43]
ds_read_b64_tr_b16 a[220:221], v12 offset:0
v_mfma_f32_16x16x32_bf16 a[44:47], a[176:179], a[236:239], a[44:47]
s_add_u32 s29, s29, s44
v_mfma_f32_16x16x32_bf16 a[48:51], a[176:179], a[240:243], a[48:51]
ds_read_b64_tr_b16 a[222:223], v12 offset:1024
v_mfma_f32_16x16x32_bf16 a[52:55], a[176:179], a[244:247], a[52:55]
buffer_store_dwordx4 v[60:63], v13, s[8:11], s29 offen sc1
v_mfma_f32_16x16x32_bf16 a[56:59], a[176:179], a[248:251], a[56:59]
s_add_u32 s48, s48, s34
ds_read_b128 a[188:191], v4 offset:13312
v_mfma_f32_16x16x32_bf16 a[60:63], a[176:179], a[252:255], a[60:63]
s_add_u32 m0, s32, 4096
ds_read_b128 a[176:179], v3 offset:8192
v_mfma_f32_16x16x32_bf16 a[64:67], a[180:183], a[224:227], a[64:67]
buffer_load_dwordx4 v1, s[12:15], s48 offen lds
v_mfma_f32_16x16x32_bf16 a[68:71], a[180:183], a[228:231], a[68:71]
v_add_u32 v5, 16384, v5
v_and_b32 v5, 65535, v5
v_mfma_f32_16x16x32_bf16 a[72:75], a[180:183], a[232:235], a[72:75]
v_xor_b32 v6, 16, v5
v_xor_b32 v7, 64, v5
v_mfma_f32_16x16x32_bf16 a[76:79], a[180:183], a[236:239], a[76:79]
v_xor_b32 v8, 80, v5
v_xor_b32 v9, 128, v5
v_mfma_f32_16x16x32_bf16 a[80:83], a[180:183], a[240:243], a[80:83]
v_xor_b32 v10, 144, v5
v_xor_b32 v11, 192, v5
v_mfma_f32_16x16x32_bf16 a[84:87], a[180:183], a[244:247], a[84:87]
s_add_u32 s48, s48, s34
v_xor_b32 v12, 208, v5
v_mfma_f32_16x16x32_bf16 a[88:91], a[180:183], a[248:251], a[88:91]
s_add_u32 m0, s32, 8192
v_mfma_f32_16x16x32_bf16 a[92:95], a[180:183], a[252:255], a[92:95]
buffer_load_dwordx4 v1, s[12:15], s48 offen lds
ds_read_b128 a[180:183], v4 offset:9216
v_mfma_f32_16x16x32_bf16 a[96:99], a[184:187], a[224:227], a[96:99]
v_mfma_f32_16x16x32_bf16 a[100:103], a[184:187], a[228:231], a[100:103]
v_mfma_f32_16x16x32_bf16 a[104:107], a[184:187], a[232:235], a[104:107]
v_mfma_f32_16x16x32_bf16 a[108:111], a[184:187], a[236:239], a[108:111]
v_mfma_f32_16x16x32_bf16 a[112:115], a[184:187], a[240:243], a[112:115]
s_add_u32 s48, s48, s34
v_mfma_f32_16x16x32_bf16 a[116:119], a[184:187], a[244:247], a[116:119]
s_add_u32 m0, s32, 12288
v_mfma_f32_16x16x32_bf16 a[120:123], a[184:187], a[248:251], a[120:123]
buffer_load_dwordx4 v1, s[12:15], s48 offen lds
v_mfma_f32_16x16x32_bf16 a[124:127], a[184:187], a[252:255], a[124:127]
ds_read_b128 a[184:187], v3 offset:12288
v_mfma_f32_16x16x32_bf16 a[128:131], v[28:31], a[224:227], a[128:131]
v_mfma_f32_16x16x32_bf16 a[132:135], v[28:31], a[228:231], a[132:135]
v_mfma_f32_16x16x32_bf16 a[136:139], v[28:31], a[232:235], a[136:139]
buffer_load_dword v15, v14, s[96:99], s100 offen
v_mfma_f32_16x16x32_bf16 a[140:143], v[28:31], a[236:239], a[140:143]
s_add_u32 s100, s100, 16384
v_mfma_f32_16x16x32_bf16 a[144:147], v[28:31], a[240:243], a[144:147]
v_mfma_f32_16x16x32_bf16 a[148:151], v[28:31], a[244:247], a[148:151]
v_mfma_f32_16x16x32_bf16 a[152:155], v[28:31], a[248:251], a[152:155]
v_mfma_f32_16x16x32_bf16 a[156:159], v[28:31], a[252:255], a[156:159]
s_waitcnt vmcnt(23) lgkmcnt(0)
s_barrier
v_mfma_f32_16x16x32_bf16 v[160:163], a[160:163], a[192:195], v[160:163]
ds_read_b64_tr_b16 a[224:225], v5 offset:0
v_mfma_f32_16x16x32_bf16 v[164:167], a[160:163], a[196:199], v[164:167]
v_mfma_f32_16x16x32_bf16 v[168:171], a[160:163], a[200:203], v[168:171]
ds_read_b64_tr_b16 a[226:227], v5 offset:1024
v_mfma_f32_16x16x32_bf16 v[172:175], a[160:163], a[204:207], v[172:175]
s_add_u32 s37, s31, 0
v_mfma_f32_16x16x32_bf16 v[176:179], a[160:163], a[208:211], v[176:179]
s_add_u32 m0, s33, 0
ds_read_b64_tr_b16 a[228:229], v6 offset:0
v_mfma_f32_16x16x32_bf16 v[180:183], a[160:163], a[212:215], v[180:183]
buffer_load_dwordx4 v2, s[20:23], s37 offen  lds
v_mfma_f32_16x16x32_bf16 v[184:187], a[160:163], a[216:219], v[184:187]
ds_read_b64_tr_b16 a[230:231], v6 offset:1024
v_mfma_f32_16x16x32_bf16 v[188:191], a[160:163], a[220:223], v[188:191]
ds_read_b128 a[160:163], v4 offset:0
v_mfma_f32_16x16x32_bf16 v[192:195], a[164:167], a[192:195], v[192:195]
ds_read_b64_tr_b16 a[232:233], v7 offset:0
v_mfma_f32_16x16x32_bf16 v[196:199], a[164:167], a[196:199], v[196:199]
v_mfma_f32_16x16x32_bf16 v[200:203], a[164:167], a[200:203], v[200:203]
s_add_u32 s37, s31, 32768
ds_read_b64_tr_b16 a[234:235], v7 offset:1024
v_mfma_f32_16x16x32_bf16 v[204:207], a[164:167], a[204:207], v[204:207]
s_add_u32 m0, s33, 1024
v_mfma_f32_16x16x32_bf16 v[208:211], a[164:167], a[208:211], v[208:211]
buffer_load_dwordx4 v2, s[20:23], s37 offen  lds
v_mfma_f32_16x16x32_bf16 v[212:215], a[164:167], a[212:215], v[212:215]
ds_read_b64_tr_b16 a[236:237], v8 offset:0
v_mfma_f32_16x16x32_bf16 v[216:219], a[164:167], a[216:219], v[216:219]
s_add_u32 s60, s60, s92
v_mfma_f32_16x16x32_bf16 v[220:223], a[164:167], a[220:223], v[220:223]
s_mov_b32 s29, s60
ds_read_b128 a[164:167], v3 offset:1024
v_mfma_f32_16x16x32_bf16 v[224:227], a[168:171], a[192:195], v[224:227]
buffer_store_dwordx4 v[64:67], v13, s[8:11], s29 offen sc1
v_mfma_f32_16x16x32_bf16 v[228:231], a[168:171], a[196:199], v[228:231]
s_add_u32 s37, s31, 131072
ds_read_b64_tr_b16 a[238:239], v8 offset:1024
v_mfma_f32_16x16x32_bf16 v[232:235], a[168:171], a[200:203], v[232:235]
s_add_u32 m0, s33, 4096
v_mfma_f32_16x16x32_bf16 v[236:239], a[168:171], a[204:207], v[236:239]
buffer_load_dwordx4 v2, s[20:23], s37 offen  lds
v_mfma_f32_16x16x32_bf16 v[240:243], a[168:171], a[208:211], v[240:243]
ds_read_b64_tr_b16 a[240:241], v9 offset:0
v_mfma_f32_16x16x32_bf16 v[244:247], a[168:171], a[212:215], v[244:247]
v_mfma_f32_16x16x32_bf16 v[248:251], a[168:171], a[216:219], v[248:251]
ds_read_b64_tr_b16 a[242:243], v9 offset:1024
v_mfma_f32_16x16x32_bf16 v[252:255], a[168:171], a[220:223], v[252:255]
ds_read_b128 a[168:171], v4 offset:4096
v_mfma_f32_16x16x32_bf16 a[0:3], a[172:175], a[192:195], a[0:3]
s_add_u32 s37, s31, 163840
ds_read_b64_tr_b16 a[244:245], v10 offset:0
v_mfma_f32_16x16x32_bf16 a[4:7], a[172:175], a[196:199], a[4:7]
s_add_u32 m0, s33, 5120
v_mfma_f32_16x16x32_bf16 a[8:11], a[172:175], a[200:203], a[8:11]
buffer_load_dwordx4 v2, s[20:23], s37 offen  lds
v_mfma_f32_16x16x32_bf16 a[12:15], a[172:175], a[204:207], a[12:15]
s_add_u32 s31, s31, 262144
ds_read_b64_tr_b16 a[246:247], v10 offset:1024
v_mfma_f32_16x16x32_bf16 a[16:19], a[172:175], a[208:211], a[16:19]
s_add_u32 s33, s33, 16384
v_mfma_f32_16x16x32_bf16 a[20:23], a[172:175], a[212:215], a[20:23]
s_and_b32 s33, s33, 65535
ds_read_b64_tr_b16 a[248:249], v11 offset:0
v_mfma_f32_16x16x32_bf16 a[24:27], a[172:175], a[216:219], a[24:27]
v_mfma_f32_16x16x32_bf16 a[28:31], a[172:175], a[220:223], a[28:31]
s_add_u32 s48, s48, s34
ds_read_b128 a[172:175], v3 offset:5120
v_mfma_f32_16x16x32_bf16 a[32:35], a[176:179], a[192:195], a[32:35]
s_add_u32 m0, s32, 16384
ds_read_b64_tr_b16 a[250:251], v11 offset:1024
v_mfma_f32_16x16x32_bf16 a[36:39], a[176:179], a[196:199], a[36:39]
buffer_load_dwordx4 v1, s[12:15], s48 offen lds
v_mfma_f32_16x16x32_bf16 a[40:43], a[176:179], a[200:203], a[40:43]
ds_read_b64_tr_b16 a[252:253], v12 offset:0
v_mfma_f32_16x16x32_bf16 a[44:47], a[176:179], a[204:207], a[44:47]
s_add_u32 s29, s29, s44
v_mfma_f32_16x16x32_bf16 a[48:51], a[176:179], a[208:211], a[48:51]
ds_read_b64_tr_b16 a[254:255], v12 offset:1024
v_mfma_f32_16x16x32_bf16 a[52:55], a[176:179], a[212:215], a[52:55]
buffer_store_dwordx4 v[68:71], v13, s[8:11], s29 offen sc1
v_mfma_f32_16x16x32_bf16 a[56:59], a[176:179], a[216:219], a[56:59]
s_add_u32 s48, s48, s34
ds_read_b128 v[28:31], v3 offset:13312
v_mfma_f32_16x16x32_bf16 a[60:63], a[176:179], a[220:223], a[60:63]
s_add_u32 m0, s32, 20480
ds_read_b128 a[176:179], v4 offset:8192
v_mfma_f32_16x16x32_bf16 a[64:67], a[180:183], a[192:195], a[64:67]
buffer_load_dwordx4 v1, s[12:15], s48 offen lds
v_mfma_f32_16x16x32_bf16 a[68:71], a[180:183], a[196:199], a[68:71]
v_add_u32 v5, 16384, v5
v_and_b32 v5, 65535, v5
v_mfma_f32_16x16x32_bf16 a[72:75], a[180:183], a[200:203], a[72:75]
v_xor_b32 v6, 16, v5
v_xor_b32 v7, 64, v5
v_mfma_f32_16x16x32_bf16 a[76:79], a[180:183], a[204:207], a[76:79]
v_xor_b32 v8, 80, v5
v_xor_b32 v9, 128, v5
v_mfma_f32_16x16x32_bf16 a[80:83], a[180:183], a[208:211], a[80:83]
v_xor_b32 v10, 144, v5
v_xor_b32 v11, 192, v5
v_mfma_f32_16x16x32_bf16 a[84:87], a[180:183], a[212:215], a[84:87]
s_add_u32 s48, s48, s34
v_xor_b32 v12, 208, v5
v_mfma_f32_16x16x32_bf16 a[88:91], a[180:183], a[216:219], a[88:91]
s_add_u32 m0, s32, 24576
v_mfma_f32_16x16x32_bf16 a[92:95], a[180:183], a[220:223], a[92:95]
buffer_load_dwordx4 v1, s[12:15], s48 offen lds
ds_read_b128 a[180:183], v3 offset:9216
v_mfma_f32_16x16x32_bf16 a[96:99], a[184:187], a[192:195], a[96:99]
v_mfma_f32_16x16x32_bf16 a[100:103], a[184:187], a[196:199], a[100:103]
v_mfma_f32_16x16x32_bf16 a[104:107], a[184:187], a[200:203], a[104:107]
v_mfma_f32_16x16x32_bf16 a[108:111], a[184:187], a[204:207], a[108:111]
v_mfma_f32_16x16x32_bf16 a[112:115], a[184:187], a[208:211], a[112:115]
s_add_u32 s48, s48, s34
v_mfma_f32_16x16x32_bf16 a[116:119], a[184:187], a[212:215], a[116:119]
s_add_u32 m0, s32, 28672
v_mfma_f32_16x16x32_bf16 a[120:123], a[184:187], a[216:219], a[120:123]
buffer_load_dwordx4 v1, s[12:15], s48 offen lds
v_mfma_f32_16x16x32_bf16 a[124:127], a[184:187], a[220:223], a[124:127]
s_add_u32 s30, s30, 128
ds_read_b128 a[184:187], v4 offset:12288
v_mfma_f32_16x16x32_bf16 a[128:131], a[188:191], a[192:195], a[128:131]
s_add_u32 s32, s32, 32768
s_add_u32 s29, s29, s93
v_add_u32 v3, 32768, v3
v_mfma_f32_16x16x32_bf16 a[132:135], a[188:191], a[196:199], a[132:135]
s_sub_u32 s48, s32, 98304
v_subrev_u32 v19, 98304, v3
v_mfma_f32_16x16x32_bf16 a[136:139], a[188:191], a[200:203], a[136:139]
s_cmp_ge_u32 s32, 163840
s_cselect_b32 s32, s48, s32
buffer_store_dwordx4 v[72:75], v13, s[8:11], s29 offen sc1
buffer_load_dword v15, v14, s[96:99], s100 offen
v_mfma_f32_16x16x32_bf16 a[140:143], a[188:191], a[204:207], a[140:143]
s_add_u32 s100, s100, 16384
v_cmp_le_u32 vcc, 163840, v3
v_mfma_f32_16x16x32_bf16 a[144:147], a[188:191], a[208:211], a[144:147]
s_nop 0
v_cndmask_b32 v3, v3, v19, vcc
v_mfma_f32_16x16x32_bf16 a[148:151], a[188:191], a[212:215], a[148:151]
v_xor_b32 v4, 64, v3
v_mfma_f32_16x16x32_bf16 a[152:155], a[188:191], a[216:219], a[152:155]
v_mfma_f32_16x16x32_bf16 a[156:159], a[188:191], a[220:223], a[156:159]
s_waitcnt vmcnt(23) lgkmcnt(0)
s_barrier
v_mfma_f32_16x16x32_bf16 v[160:163], a[160:163], a[224:227], v[160:163]
ds_read_b64_tr_b16 a[192:193], v5 offset:0
v_mfma_f32_16x16x32_bf16 v[164:167], a[160:163], a[228:231], v[164:167]
v_mfma_f32_16x16x32_bf16 v[168:171], a[160:163], a[232:235], v[168:171]
ds_read_b64_tr_b16 a[194:195], v5 offset:1024
v_mfma_f32_16x16x32_bf16 v[172:175], a[160:163], a[236:239], v[172:175]
s_add_u32 s37, s31, 0
v_mfma_f32_16x16x32_bf16 v[176:179], a[160:163], a[240:243], v[176:179]
s_add_u32 m0, s33, 0
ds_read_b64_tr_b16 a[196:197], v6 offset:0
v_mfma_f32_16x16x32_bf16 v[180:183], a[160:163], a[244:247], v[180:183]
buffer_load_dwordx4 v2, s[20:23], s37 offen  lds
v_mfma_f32_16x16x32_bf16 v[184:187], a[160:163], a[248:251], v[184:187]
ds_read_b64_tr_b16 a[198:199], v6 offset:1024
v_mfma_f32_16x16x32_bf16 v[188:191], a[160:163], a[252:255], v[188:191]
ds_read_b128 a[160:163], v3 offset:0
v_mfma_f32_16x16x32_bf16 v[192:195], a[164:167], a[224:227], v[192:195]
ds_read_b64_tr_b16 a[200:201], v7 offset:0
v_mfma_f32_16x16x32_bf16 v[196:199], a[164:167], a[228:231], v[196:199]
v_mfma_f32_16x16x32_bf16 v[200:203], a[164:167], a[232:235], v[200:203]
s_add_u32 s37, s31, 32768
ds_read_b64_tr_b16 a[202:203], v7 offset:1024
v_mfma_f32_16x16x32_bf16 v[204:207], a[164:167], a[236:239], v[204:207]
s_add_u32 m0, s33, 1024
v_mfma_f32_16x16x32_bf16 v[208:211], a[164:167], a[240:243], v[208:211]
buffer_load_dwordx4 v2, s[20:23], s37 offen  lds
v_mfma_f32_16x16x32_bf16 v[212:215], a[164:167], a[244:247], v[212:215]
ds_read_b64_tr_b16 a[204:205], v8 offset:0
v_mfma_f32_16x16x32_bf16 v[216:219], a[164:167], a[248:251], v[216:219]
s_add_u32 s29, s29, s44
v_mfma_f32_16x16x32_bf16 v[220:223], a[164:167], a[252:255], v[220:223]
ds_read_b128 a[164:167], v4 offset:1024
v_mfma_f32_16x16x32_bf16 v[224:227], a[168:171], a[224:227], v[224:227]
buffer_store_dwordx4 v[76:79], v13, s[8:11], s29 offen sc1
v_mfma_f32_16x16x32_bf16 v[228:231], a[168:171], a[228:231], v[228:231]
s_add_u32 s37, s31, 131072
ds_read_b64_tr_b16 a[206:207], v8 offset:1024
v_mfma_f32_16x16x32_bf16 v[232:235], a[168:171], a[232:235], v[232:235]
s_add_u32 m0, s33, 4096
v_mfma_f32_16x16x32_bf16 v[236:239], a[168:171], a[236:239], v[236:239]
buffer_load_dwordx4 v2, s[20:23], s37 offen  lds
v_mfma_f32_16x16x32_bf16 v[240:243], a[168:171], a[240:243], v[240:243]
ds_read_b64_tr_b16 a[208:209], v9 offset:0
v_mfma_f32_16x16x32_bf16 v[244:247], a[168:171], a[244:247], v[244:247]
v_mfma_f32_16x16x32_bf16 v[248:251], a[168:171], a[248:251], v[248:251]
ds_read_b64_tr_b16 a[210:211], v9 offset:1024
v_mfma_f32_16x16x32_bf16 v[252:255], a[168:171], a[252:255], v[252:255]
ds_read_b128 a[168:171], v3 offset:4096
v_mfma_f32_16x16x32_bf16 a[0:3], a[172:175], a[224:227], a[0:3]
s_add_u32 s37, s31, 163840
ds_read_b64_tr_b16 a[212:213], v10 offset:0
v_mfma_f32_16x16x32_bf16 a[4:7], a[172:175], a[228:231], a[4:7]
s_add_u32 m0, s33, 5120
v_mfma_f32_16x16x32_bf16 a[8:11], a[172:175], a[232:235], a[8:11]
buffer_load_dwordx4 v2, s[20:23], s37 offen  lds
v_mfma_f32_16x16x32_bf16 a[12:15], a[172:175], a[236:239], a[12:15]
s_add_u32 s31, s31, 262144
ds_read_b64_tr_b16 a[214:215], v10 offset:1024
v_mfma_f32_16x16x32_bf16 a[16:19], a[172:175], a[240:243], a[16:19]
s_add_u32 s33, s33, 16384
v_mfma_f32_16x16x32_bf16 a[20:23], a[172:175], a[244:247], a[20:23]
s_and_b32 s33, s33, 65535
ds_read_b64_tr_b16 a[216:217], v11 offset:0
v_mfma_f32_16x16x32_bf16 a[24:27], a[172:175], a[248:251], a[24:27]
v_mfma_f32_16x16x32_bf16 a[28:31], a[172:175], a[252:255], a[28:31]
s_mov_b32 s48, s30
ds_read_b128 a[172:175], v4 offset:5120
v_mfma_f32_16x16x32_bf16 a[32:35], a[176:179], a[224:227], a[32:35]
s_add_u32 m0, s32, 0
ds_read_b64_tr_b16 a[218:219], v11 offset:1024
v_mfma_f32_16x16x32_bf16 a[36:39], a[176:179], a[228:231], a[36:39]
buffer_load_dwordx4 v1, s[12:15], s48 offen lds
v_mfma_f32_16x16x32_bf16 a[40:43], a[176:179], a[232:235], a[40:43]
ds_read_b64_tr_b16 a[220:221], v12 offset:0
v_mfma_f32_16x16x32_bf16 a[44:47], a[176:179], a[236:239], a[44:47]
s_add_u32 s29, s29, s93
v_mfma_f32_16x16x32_bf16 a[48:51], a[176:179], a[240:243], a[48:51]
ds_read_b64_tr_b16 a[222:223], v12 offset:1024
v_mfma_f32_16x16x32_bf16 a[52:55], a[176:179], a[244:247], a[52:55]
buffer_store_dwordx4 v[80:83], v13, s[8:11], s29 offen sc1
v_mfma_f32_16x16x32_bf16 a[56:59], a[176:179], a[248:251], a[56:59]
s_add_u32 s48, s48, s34
ds_read_b128 a[188:191], v4 offset:13312
v_mfma_f32_16x16x32_bf16 a[60:63], a[176:179], a[252:255], a[60:63]
s_add_u32 m0, s32, 4096
ds_read_b128 a[176:179], v3 offset:8192
v_mfma_f32_16x16x32_bf16 a[64:67], a[180:183], a[224:227], a[64:67]
buffer_load_dwordx4 v1, s[12:15], s48 offen lds
v_mfma_f32_16x16x32_bf16 a[68:71], a[180:183], a[228:231], a[68:71]
v_add_u32 v5, 16384, v5
v_and_b32 v5, 65535, v5
v_mfma_f32_16x16x32_bf16 a[72:75], a[180:183], a[232:235], a[72:75]
v_xor_b32 v6, 16, v5
v_xor_b32 v7, 64, v5
v_mfma_f32_16x16x32_bf16 a[76:79], a[180:183], a[236:239], a[76:79]
v_xor_b32 v8, 80, v5
v_xor_b32 v9, 128, v5
v_mfma_f32_16x16x32_bf16 a[80:83], a[180:183], a[240:243], a[80:83]
v_xor_b32 v10, 144, v5
v_xor_b32 v11, 192, v5
v_mfma_f32_16x16x32_bf16 a[84:87], a[180:183], a[244:247], a[84:87]
s_add_u32 s48, s48, s34
v_xor_b32 v12, 208, v5
v_mfma_f32_16x16x32_bf16 a[88:91], a[180:183], a[248:251], a[88:91]
s_add_u32 m0, s32, 8192
v_mfma_f32_16x16x32_bf16 a[92:95], a[180:183], a[252:255], a[92:95]
buffer_load_dwordx4 v1, s[12:15], s48 offen lds
ds_read_b128 a[180:183], v4 offset:9216
v_mfma_f32_16x16x32_bf16 a[96:99], a[184:187], a[224:227], a[96:99]
v_mfma_f32_16x16x32_bf16 a[100:103], a[184:187], a[228:231], a[100:103]
v_mfma_f32_16x16x32_bf16 a[104:107], a[184:187], a[232:235], a[104:107]
v_mfma_f32_16x16x32_bf16 a[108:111], a[184:187], a[236:239], a[108:111]
v_mfma_f32_16x16x32_bf16 a[112:115], a[184:187], a[240:243], a[112:115]
s_add_u32 s48, s48, s34
v_mfma_f32_16x16x32_bf16 a[116:119], a[184:187], a[244:247], a[116:119]
s_add_u32 m0, s32, 12288
v_mfma_f32_16x16x32_bf16 a[120:123], a[184:187], a[248:251], a[120:123]
buffer_load_dwordx4 v1, s[12:15], s48 offen lds
v_mfma_f32_16x16x32_bf16 a[124:127], a[184:187], a[252:255], a[124:127]
ds_read_b128 a[184:187], v3 offset:12288
v_mfma_f32_16x16x32_bf16 a[128:131], v[28:31], a[224:227], a[128:131]
s_add_u32 s29, s29, s44
v_mfma_f32_16x16x32_bf16 a[132:135], v[28:31], a[228:231], a[132:135]
v_mfma_f32_16x16x32_bf16 a[136:139], v[28:31], a[232:235], a[136:139]
buffer_store_dwordx4 v[84:87], v13, s[8:11], s29 offen sc1
buffer_load_dword v15, v14, s[96:99], s100 offen
v_mfma_f32_16x16x32_bf16 a[140:143], v[28:31], a[236:239], a[140:143]
s_add_u32 s100, s100, 16384
v_mfma_f32_16x16x32_bf16 a[144:147], v[28:31], a[240:243], a[144:147]
v_mfma_f32_16x16x32_bf16 a[148:151], v[28:31], a[244:247], a[148:151]
v_mfma_f32_16x16x32_bf16 a[152:155], v[28:31], a[248:251], a[152:155]
v_mfma_f32_16x16x32_bf16 a[156:159], v[28:31], a[252:255], a[156:159]
s_waitcnt vmcnt(24) lgkmcnt(0)
s_barrier
v_mfma_f32_16x16x32_bf16 v[160:163], a[160:163], a[192:195], v[160:163]
ds_read_b64_tr_b16 a[224:225], v5 offset:0
v_mfma_f32_16x16x32_bf16 v[164:167], a[160:163], a[196:199], v[164:167]
v_mfma_f32_16x16x32_bf16 v[168:171], a[160:163], a[200:203], v[168:171]
ds_read_b64_tr_b16 a[226:227], v5 offset:1024
v_mfma_f32_16x16x32_bf16 v[172:175], a[160:163], a[204:207], v[172:175]
s_add_u32 s37, s31, 0
v_mfma_f32_16x16x32_bf16 v[176:179], a[160:163], a[208:211], v[176:179]
s_add_u32 m0, s33, 0
ds_read_b64_tr_b16 a[228:229], v6 offset:0
v_mfma_f32_16x16x32_bf16 v[180:183], a[160:163], a[212:215], v[180:183]
buffer_load_dwordx4 v2, s[20:23], s37 offen  lds
v_mfma_f32_16x16x32_bf16 v[184:187], a[160:163], a[216:219], v[184:187]
ds_read_b64_tr_b16 a[230:231], v6 offset:1024
v_mfma_f32_16x16x32_bf16 v[188:191], a[160:163], a[220:223], v[188:191]
ds_read_b128 a[160:163], v4 offset:0
v_mfma_f32_16x16x32_bf16 v[192:195], a[164:167], a[192:195], v[192:195]
ds_read_b64_tr_b16 a[232:233], v7 offset:0
v_mfma_f32_16x16x32_bf16 v[196:199], a[164:167], a[196:199], v[196:199]
v_mfma_f32_16x16x32_bf16 v[200:203], a[164:167], a[200:203], v[200:203]
s_add_u32 s37, s31, 32768
ds_read_b64_tr_b16 a[234:235], v7 offset:1024
v_mfma_f32_16x16x32_bf16 v[204:207], a[164:167], a[204:207], v[204:207]
s_add_u32 m0, s33, 1024
v_mfma_f32_16x16x32_bf16 v[208:211], a[164:167], a[208:211], v[208:211]
buffer_load_dwordx4 v2, s[20:23], s37 offen  lds
v_mfma_f32_16x16x32_bf16 v[212:215], a[164:167], a[212:215], v[212:215]
ds_read_b64_tr_b16 a[236:237], v8 offset:0
v_mfma_f32_16x16x32_bf16 v[216:219], a[164:167], a[216:219], v[216:219]
s_add_u32 s29, s29, s93
v_mfma_f32_16x16x32_bf16 v[220:223], a[164:167], a[220:223], v[220:223]
ds_read_b128 a[164:167], v3 offset:1024
v_mfma_f32_16x16x32_bf16 v[224:227], a[168:171], a[192:195], v[224:227]
buffer_store_dwordx4 v[88:91], v13, s[8:11], s29 offen sc1
v_mfma_f32_16x16x32_bf16 v[228:231], a[168:171], a[196:199], v[228:231]
s_add_u32 s37, s31, 131072
ds_read_b64_tr_b16 a[238:239], v8 offset:1024
v_mfma_f32_16x16x32_bf16 v[232:235], a[168:171], a[200:203], v[232:235]
s_add_u32 m0, s33, 4096
v_mfma_f32_16x16x32_bf16 v[236:239], a[168:171], a[204:207], v[236:239]
buffer_load_dwordx4 v2, s[20:23], s37 offen  lds
v_mfma_f32_16x16x32_bf16 v[240:243], a[168:171], a[208:211], v[240:243]
ds_read_b64_tr_b16 a[240:241], v9 offset:0
v_mfma_f32_16x16x32_bf16 v[244:247], a[168:171], a[212:215], v[244:247]
v_mfma_f32_16x16x32_bf16 v[248:251], a[168:171], a[216:219], v[248:251]
ds_read_b64_tr_b16 a[242:243], v9 offset:1024
v_mfma_f32_16x16x32_bf16 v[252:255], a[168:171], a[220:223], v[252:255]
ds_read_b128 a[168:171], v4 offset:4096
v_mfma_f32_16x16x32_bf16 a[0:3], a[172:175], a[192:195], a[0:3]
s_add_u32 s37, s31, 163840
ds_read_b64_tr_b16 a[244:245], v10 offset:0
v_mfma_f32_16x16x32_bf16 a[4:7], a[172:175], a[196:199], a[4:7]
s_add_u32 m0, s33, 5120
v_mfma_f32_16x16x32_bf16 a[8:11], a[172:175], a[200:203], a[8:11]
buffer_load_dwordx4 v2, s[20:23], s37 offen  lds
v_mfma_f32_16x16x32_bf16 a[12:15], a[172:175], a[204:207], a[12:15]
s_add_u32 s31, s31, 262144
ds_read_b64_tr_b16 a[246:247], v10 offset:1024
v_mfma_f32_16x16x32_bf16 a[16:19], a[172:175], a[208:211], a[16:19]
s_add_u32 s33, s33, 16384
v_mfma_f32_16x16x32_bf16 a[20:23], a[172:175], a[212:215], a[20:23]
s_and_b32 s33, s33, 65535
ds_read_b64_tr_b16 a[248:249], v11 offset:0
v_mfma_f32_16x16x32_bf16 a[24:27], a[172:175], a[216:219], a[24:27]
v_mfma_f32_16x16x32_bf16 a[28:31], a[172:175], a[220:223], a[28:31]
s_add_u32 s48, s48, s34
ds_read_b128 a[172:175], v3 offset:5120
v_mfma_f32_16x16x32_bf16 a[32:35], a[176:179], a[192:195], a[32:35]
s_add_u32 m0, s32, 16384
ds_read_b64_tr_b16 a[250:251], v11 offset:1024
v_mfma_f32_16x16x32_bf16 a[36:39], a[176:179], a[196:199], a[36:39]
buffer_load_dwordx4 v1, s[12:15], s48 offen lds
v_mfma_f32_16x16x32_bf16 a[40:43], a[176:179], a[200:203], a[40:43]
ds_read_b64_tr_b16 a[252:253], v12 offset:0
v_mfma_f32_16x16x32_bf16 a[44:47], a[176:179], a[204:207], a[44:47]
s_add_u32 s29, s29, s44
v_mfma_f32_16x16x32_bf16 a[48:51], a[176:179], a[208:211], a[48:51]
ds_read_b64_tr_b16 a[254:255], v12 offset:1024
v_mfma_f32_16x16x32_bf16 a[52:55], a[176:179], a[212:215], a[52:55]
buffer_store_dwordx4 v[92:95], v13, s[8:11], s29 offen sc1
v_mfma_f32_16x16x32_bf16 a[56:59], a[176:179], a[216:219], a[56:59]
s_add_u32 s48, s48, s34
ds_read_b128 v[28:31], v3 offset:13312
v_mfma_f32_16x16x32_bf16 a[60:63], a[176:179], a[220:223], a[60:63]
s_add_u32 m0, s32, 20480
ds_read_b128 a[176:179], v4 offset:8192
v_mfma_f32_16x16x32_bf16 a[64:67], a[180:183], a[192:195], a[64:67]
buffer_load_dwordx4 v1, s[12:15], s48 offen lds
v_mfma_f32_16x16x32_bf16 a[68:71], a[180:183], a[196:199], a[68:71]
v_add_u32 v5, 16384, v5
v_and_b32 v5, 65535, v5
v_mfma_f32_16x16x32_bf16 a[72:75], a[180:183], a[200:203], a[72:75]
v_xor_b32 v6, 16, v5
v_xor_b32 v7, 64, v5
v_mfma_f32_16x16x32_bf16 a[76:79], a[180:183], a[204:207], a[76:79]
v_xor_b32 v8, 80, v5
v_xor_b32 v9, 128, v5
v_mfma_f32_16x16x32_bf16 a[80:83], a[180:183], a[208:211], a[80:83]
v_xor_b32 v10, 144, v5
v_xor_b32 v11, 192, v5
v_mfma_f32_16x16x32_bf16 a[84:87], a[180:183], a[212:215], a[84:87]
s_add_u32 s48, s48, s34
v_xor_b32 v12, 208, v5
v_mfma_f32_16x16x32_bf16 a[88:91], a[180:183], a[216:219], a[88:91]
s_add_u32 m0, s32, 24576
v_mfma_f32_16x16x32_bf16 a[92:95], a[180:183], a[220:223], a[92:95]
buffer_load_dwordx4 v1, s[12:15], s48 offen lds
ds_read_b128 a[180:183], v3 offset:9216
v_mfma_f32_16x16x32_bf16 a[96:99], a[184:187], a[192:195], a[96:99]
v_mfma_f32_16x16x32_bf16 a[100:103], a[184:187], a[196:199], a[100:103]
v_mfma_f32_16x16x32_bf16 a[104:107], a[184:187], a[200:203], a[104:107]
v_mfma_f32_16x16x32_bf16 a[108:111], a[184:187], a[204:207], a[108:111]
v_mfma_f32_16x16x32_bf16 a[112:115], a[184:187], a[208:211], a[112:115]
s_add_u32 s48, s48, s34
v_mfma_f32_16x16x32_bf16 a[116:119], a[184:187], a[212:215], a[116:119]
s_add_u32 m0, s32, 28672
v_mfma_f32_16x16x32_bf16 a[120:123], a[184:187], a[216:219], a[120:123]
buffer_load_dwordx4 v1, s[12:15], s48 offen lds
v_mfma_f32_16x16x32_bf16 a[124:127], a[184:187], a[220:223], a[124:127]
s_add_u32 s30, s30, 128
ds_read_b128 a[184:187], v4 offset:12288
v_mfma_f32_16x16x32_bf16 a[128:131], a[188:191], a[192:195], a[128:131]
s_add_u32 s32, s32, 32768
v_add_u32 v3, 32768, v3
v_mfma_f32_16x16x32_bf16 a[132:135], a[188:191], a[196:199], a[132:135]
s_sub_u32 s48, s32, 98304
v_subrev_u32 v19, 98304, v3
v_mfma_f32_16x16x32_bf16 a[136:139], a[188:191], a[200:203], a[136:139]
s_cmp_ge_u32 s32, 163840
s_cselect_b32 s32, s48, s32
buffer_load_dword v15, v14, s[96:99], s100 offen
v_mfma_f32_16x16x32_bf16 a[140:143], a[188:191], a[204:207], a[140:143]
s_add_u32 s100, s100, 16384
v_cmp_le_u32 vcc, 163840, v3
v_mfma_f32_16x16x32_bf16 a[144:147], a[188:191], a[208:211], a[144:147]
s_nop 0
v_cndmask_b32 v3, v3, v19, vcc
v_mfma_f32_16x16x32_bf16 a[148:151], a[188:191], a[212:215], a[148:151]
v_xor_b32 v4, 64, v3
v_mfma_f32_16x16x32_bf16 a[152:155], a[188:191], a[216:219], a[152:155]
v_mfma_f32_16x16x32_bf16 a[156:159], a[188:191], a[220:223], a[156:159]
s_waitcnt vmcnt(23) lgkmcnt(0)
s_barrier
v_mfma_f32_16x16x32_bf16 v[160:163], a[160:163], a[224:227], v[160:163]
ds_read_b64_tr_b16 a[192:193], v5 offset:0
v_mfma_f32_16x16x32_bf16 v[164:167], a[160:163], a[228:231], v[164:167]
v_mfma_f32_16x16x32_bf16 v[168:171], a[160:163], a[232:235], v[168:171]
ds_read_b64_tr_b16 a[194:195], v5 offset:1024
v_mfma_f32_16x16x32_bf16 v[172:175], a[160:163], a[236:239], v[172:175]
s_add_u32 s37, s31, 0
v_mfma_f32_16x16x32_bf16 v[176:179], a[160:163], a[240:243], v[176:179]
s_add_u32 m0, s33, 0
ds_read_b64_tr_b16 a[196:197], v6 offset:0
v_mfma_f32_16x16x32_bf16 v[180:183], a[160:163], a[244:247], v[180:183]
buffer_load_dwordx4 v2, s[20:23], s37 offen  lds
v_mfma_f32_16x16x32_bf16 v[184:187], a[160:163], a[248:251], v[184:187]
ds_read_b64_tr_b16 a[198:199], v6 offset:1024
v_mfma_f32_16x16x32_bf16 v[188:191], a[160:163], a[252:255], v[188:191]
ds_read_b128 a[160:163], v3 offset:0
v_mfma_f32_16x16x32_bf16 v[192:195], a[164:167], a[224:227], v[192:195]
ds_read_b64_tr_b16 a[200:201], v7 offset:0
v_mfma_f32_16x16x32_bf16 v[196:199], a[164:167], a[228:231], v[196:199]
v_mfma_f32_16x16x32_bf16 v[200:203], a[164:167], a[232:235], v[200:203]
s_add_u32 s37, s31, 32768
ds_read_b64_tr_b16 a[202:203], v7 offset:1024
v_mfma_f32_16x16x32_bf16 v[204:207], a[164:167], a[236:239], v[204:207]
s_add_u32 m0, s33, 1024
v_mfma_f32_16x16x32_bf16 v[208:211], a[164:167], a[240:243], v[208:211]
buffer_load_dwordx4 v2, s[20:23], s37 offen  lds
v_mfma_f32_16x16x32_bf16 v[212:215], a[164:167], a[244:247], v[212:215]
ds_read_b64_tr_b16 a[204:205], v8 offset:0
v_mfma_f32_16x16x32_bf16 v[216:219], a[164:167], a[248:251], v[216:219]
s_add_u32 s60, s60, s92
v_mfma_f32_16x16x32_bf16 v[220:223], a[164:167], a[252:255], v[220:223]
s_mov_b32 s29, s60
ds_read_b128 a[164:167], v4 offset:1024
v_mfma_f32_16x16x32_bf16 v[224:227], a[168:171], a[224:227], v[224:227]
buffer_store_dwordx4 v[96:99], v13, s[8:11], s29 offen sc1
v_mfma_f32_16x16x32_bf16 v[228:231], a[168:171], a[228:231], v[228:231]
s_add_u32 s37, s31, 131072
ds_read_b64_tr_b16 a[206:207], v8 offset:1024
v_mfma_f32_16x16x32_bf16 v[232:235], a[168:171], a[232:235], v[232:235]
s_add_u32 m0, s33, 4096
v_mfma_f32_16x16x32_bf16 v[236:239], a[168:171], a[236:239], v[236:239]
buffer_load_dwordx4 v2, s[20:23], s37 offen  lds
v_mfma_f32_16x16x32_bf16 v[240:243], a[168:171], a[240:243], v[240:243]
ds_read_b64_tr_b16 a[208:209], v9 offset:0
v_mfma_f32_16x16x32_bf16 v[244:247], a[168:171], a[244:247], v[244:247]
v_mfma_f32_16x16x32_bf16 v[248:251], a[168:171], a[248:251], v[248:251]
ds_read_b64_tr_b16 a[210:211], v9 offset:1024
v_mfma_f32_16x16x32_bf16 v[252:255], a[168:171], a[252:255], v[252:255]
ds_read_b128 a[168:171], v3 offset:4096
v_mfma_f32_16x16x32_bf16 a[0:3], a[172:175], a[224:227], a[0:3]
s_add_u32 s37, s31, 163840
ds_read_b64_tr_b16 a[212:213], v10 offset:0
v_mfma_f32_16x16x32_bf16 a[4:7], a[172:175], a[228:231], a[4:7]
s_add_u32 m0, s33, 5120
v_mfma_f32_16x16x32_bf16 a[8:11], a[172:175], a[232:235], a[8:11]
buffer_load_dwordx4 v2, s[20:23], s37 offen  lds
v_mfma_f32_16x16x32_bf16 a[12:15], a[172:175], a[236:239], a[12:15]
s_add_u32 s31, s31, 262144
ds_read_b64_tr_b16 a[214:215], v10 offset:1024
v_mfma_f32_16x16x32_bf16 a[16:19], a[172:175], a[240:243], a[16:19]
s_add_u32 s33, s33, 16384
v_mfma_f32_16x16x32_bf16 a[20:23], a[172:175], a[244:247], a[20:23]
s_and_b32 s33, s33, 65535
ds_read_b64_tr_b16 a[216:217], v11 offset:0
v_mfma_f32_16x16x32_bf16 a[24:27], a[172:175], a[248:251], a[24:27]
v_mfma_f32_16x16x32_bf16 a[28:31], a[172:175], a[252:255], a[28:31]
s_mov_b32 s48, s30
ds_read_b128 a[172:175], v4 offset:5120
v_mfma_f32_16x16x32_bf16 a[32:35], a[176:179], a[224:227], a[32:35]
s_add_u32 m0, s32, 0
ds_read_b64_tr_b16 a[218:219], v11 offset:1024
v_mfma_f32_16x16x32_bf16 a[36:39], a[176:179], a[228:231], a[36:39]
buffer_load_dwordx4 v1, s[12:15], s48 offen lds
v_mfma_f32_16x16x32_bf16 a[40:43], a[176:179], a[232:235], a[40:43]
ds_read_b64_tr_b16 a[220:221], v12 offset:0
v_mfma_f32_16x16x32_bf16 a[44:47], a[176:179], a[236:239], a[44:47]
s_add_u32 s29, s29, s44
v_mfma_f32_16x16x32_bf16 a[48:51], a[176:179], a[240:243], a[48:51]
ds_read_b64_tr_b16 a[222:223], v12 offset:1024
v_mfma_f32_16x16x32_bf16 a[52:55], a[176:179], a[244:247], a[52:55]
buffer_store_dwordx4 v[100:103], v13, s[8:11], s29 offen sc1
v_mfma_f32_16x16x32_bf16 a[56:59], a[176:179], a[248:251], a[56:59]
s_add_u32 s48, s48, s34
ds_read_b128 a[188:191], v4 offset:13312
v_mfma_f32_16x16x32_bf16 a[60:63], a[176:179], a[252:255], a[60:63]
s_add_u32 m0, s32, 4096
ds_read_b128 a[176:179], v3 offset:8192
v_mfma_f32_16x16x32_bf16 a[64:67], a[180:183], a[224:227], a[64:67]
buffer_load_dwordx4 v1, s[12:15], s48 offen lds
v_mfma_f32_16x16x32_bf16 a[68:71], a[180:183], a[228:231], a[68:71]
v_add_u32 v5, 16384, v5
v_and_b32 v5, 65535, v5
v_mfma_f32_16x16x32_bf16 a[72:75], a[180:183], a[232:235], a[72:75]
v_xor_b32 v6, 16, v5
v_xor_b32 v7, 64, v5
v_mfma_f32_16x16x32_bf16 a[76:79], a[180:183], a[236:239], a[76:79]
v_xor_b32 v8, 80, v5
v_xor_b32 v9, 128, v5
v_mfma_f32_16x16x32_bf16 a[80:83], a[180:183], a[240:243], a[80:83]
v_xor_b32 v10, 144, v5
v_xor_b32 v11, 192, v5
v_mfma_f32_16x16x32_bf16 a[84:87], a[180:183], a[244:247], a[84:87]
s_add_u32 s48, s48, s34
v_xor_b32 v12, 208, v5
v_mfma_f32_16x16x32_bf16 a[88:91], a[180:183], a[248:251], a[88:91]
s_add_u32 m0, s32, 8192
v_mfma_f32_16x16x32_bf16 a[92:95], a[180:183], a[252:255], a[92:95]
buffer_load_dwordx4 v1, s[12:15], s48 offen lds
ds_read_b128 a[180:183], v4 offset:9216
v_mfma_f32_16x16x32_bf16 a[96:99], a[184:187], a[224:227], a[96:99]
v_mfma_f32_16x16x32_bf16 a[100:103], a[184:187], a[228:231], a[100:103]
v_mfma_f32_16x16x32_bf16 a[104:107], a[184:187], a[232:235], a[104:107]
v_mfma_f32_16x16x32_bf16 a[108:111], a[184:187], a[236:239], a[108:111]
v_mfma_f32_16x16x32_bf16 a[112:115], a[184:187], a[240:243], a[112:115]
s_add_u32 s48, s48, s34
v_mfma_f32_16x16x32_bf16 a[116:119], a[184:187], a[244:247], a[116:119]
s_add_u32 m0, s32, 12288
v_mfma_f32_16x16x32_bf16 a[120:123], a[184:187], a[248:251], a[120:123]
buffer_load_dwordx4 v1, s[12:15], s48 offen lds
v_mfma_f32_16x16x32_bf16 a[124:127], a[184:187], a[252:255], a[124:127]
ds_read_b128 a[184:187], v3 offset:12288
v_mfma_f32_16x16x32_bf16 a[128:131], v[28:31], a[224:227], a[128:131]
s_add_u32 s29, s29, s93
v_mfma_f32_16x16x32_bf16 a[132:135], v[28:31], a[228:231], a[132:135]
v_mfma_f32_16x16x32_bf16 a[136:139], v[28:31], a[232:235], a[136:139]
buffer_store_dwordx4 v[104:107], v13, s[8:11], s29 offen sc1
buffer_load_dword v15, v14, s[96:99], s100 offen
v_mfma_f32_16x16x32_bf16 a[140:143], v[28:31], a[236:239], a[140:143]
s_add_u32 s100, s100, 16384
v_mfma_f32_16x16x32_bf16 a[144:147], v[28:31], a[240:243], a[144:147]
v_mfma_f32_16x16x32_bf16 a[148:151], v[28:31], a[244:247], a[148:151]
v_mfma_f32_16x16x32_bf16 a[152:155], v[28:31], a[248:251], a[152:155]
v_mfma_f32_16x16x32_bf16 a[156:159], v[28:31], a[252:255], a[156:159]
s_waitcnt vmcnt(23) lgkmcnt(0)
s_barrier
v_mfma_f32_16x16x32_bf16 v[160:163], a[160:163], a[192:195], v[160:163]
ds_read_b64_tr_b16 a[224:225], v5 offset:0
v_mfma_f32_16x16x32_bf16 v[164:167], a[160:163], a[196:199], v[164:167]
v_mfma_f32_16x16x32_bf16 v[168:171], a[160:163], a[200:203], v[168:171]
ds_read_b64_tr_b16 a[226:227], v5 offset:1024
v_mfma_f32_16x16x32_bf16 v[172:175], a[160:163], a[204:207], v[172:175]
s_add_u32 s37, s31, 0
v_mfma_f32_16x16x32_bf16 v[176:179], a[160:163], a[208:211], v[176:179]
s_add_u32 m0, s33, 0
ds_read_b64_tr_b16 a[228:229], v6 offset:0
v_mfma_f32_16x16x32_bf16 v[180:183], a[160:163], a[212:215], v[180:183]
buffer_load_dwordx4 v2, s[20:23], s37 offen  lds
v_mfma_f32_16x16x32_bf16 v[184:187], a[160:163], a[216:219], v[184:187]
ds_read_b64_tr_b16 a[230:231], v6 offset:1024
v_mfma_f32_16x16x32_bf16 v[188:191], a[160:163], a[220:223], v[188:191]
ds_read_b128 a[160:163], v4 offset:0
v_mfma_f32_16x16x32_bf16 v[192:195], a[164:167], a[192:195], v[192:195]
ds_read_b64_tr_b16 a[232:233], v7 offset:0
v_mfma_f32_16x16x32_bf16 v[196:199], a[164:167], a[196:199], v[196:199]
v_mfma_f32_16x16x32_bf16 v[200:203], a[164:167], a[200:203], v[200:203]
s_add_u32 s37, s31, 32768
ds_read_b64_tr_b16 a[234:235], v7 offset:1024
v_mfma_f32_16x16x32_bf16 v[204:207], a[164:167], a[204:207], v[204:207]
s_add_u32 m0, s33, 1024
v_mfma_f32_16x16x32_bf16 v[208:211], a[164:167], a[208:211], v[208:211]
buffer_load_dwordx4 v2, s[20:23], s37 offen  lds
v_mfma_f32_16x16x32_bf16 v[212:215], a[164:167], a[212:215], v[212:215]
ds_read_b64_tr_b16 a[236:237], v8 offset:0
v_mfma_f32_16x16x32_bf16 v[216:219], a[164:167], a[216:219], v[216:219]
s_add_u32 s29, s29, s44
v_mfma_f32_16x16x32_bf16 v[220:223], a[164:167], a[220:223], v[220:223]
ds_read_b128 a[164:167], v3 offset:1024
v_mfma_f32_16x16x32_bf16 v[224:227], a[168:171], a[192:195], v[224:227]
buffer_store_dwordx4 v[108:111], v13, s[8:11], s29 offen sc1
v_mfma_f32_16x16x32_bf16 v[228:231], a[168:171], a[196:199], v[228:231]
s_add_u32 s37, s31, 131072
ds_read_b64_tr_b16 a[238:239], v8 offset:1024
v_mfma_f32_16x16x32_bf16 v[232:235], a[168:171], a[200:203], v[232:235]
s_add_u32 m0, s33, 4096
v_mfma_f32_16x16x32_bf16 v[236:239], a[168:171], a[204:207], v[236:239]
buffer_load_dwordx4 v2, s[20:23], s37 offen  lds
v_mfma_f32_16x16x32_bf16 v[240:243], a[168:171], a[208:211], v[240:243]
ds_read_b64_tr_b16 a[240:241], v9 offset:0
v_mfma_f32_16x16x32_bf16 v[244:247], a[168:171], a[212:215], v[244:247]
v_mfma_f32_16x16x32_bf16 v[248:251], a[168:171], a[216:219], v[248:251]
ds_read_b64_tr_b16 a[242:243], v9 offset:1024
v_mfma_f32_16x16x32_bf16 v[252:255], a[168:171], a[220:223], v[252:255]
ds_read_b128 a[168:171], v4 offset:4096
v_mfma_f32_16x16x32_bf16 a[0:3], a[172:175], a[192:195], a[0:3]
s_add_u32 s37, s31, 163840
ds_read_b64_tr_b16 a[244:245], v10 offset:0
v_mfma_f32_16x16x32_bf16 a[4:7], a[172:175], a[196:199], a[4:7]
s_add_u32 m0, s33, 5120
v_mfma_f32_16x16x32_bf16 a[8:11], a[172:175], a[200:203], a[8:11]
buffer_load_dwordx4 v2, s[20:23], s37 offen  lds
v_mfma_f32_16x16x32_bf16 a[12:15], a[172:175], a[204:207], a[12:15]
s_add_u32 s31, s31, 262144
ds_read_b64_tr_b16 a[246:247], v10 offset:1024
v_mfma_f32_16x16x32_bf16 a[16:19], a[172:175], a[208:211], a[16:19]
s_add_u32 s33, s33, 16384
v_mfma_f32_16x16x32_bf16 a[20:23], a[172:175], a[212:215], a[20:23]
s_and_b32 s33, s33, 65535
ds_read_b64_tr_b16 a[248:249], v11 offset:0
v_mfma_f32_16x16x32_bf16 a[24:27], a[172:175], a[216:219], a[24:27]
v_mfma_f32_16x16x32_bf16 a[28:31], a[172:175], a[220:223], a[28:31]
s_add_u32 s48, s48, s34
ds_read_b128 a[172:175], v3 offset:5120
v_mfma_f32_16x16x32_bf16 a[32:35], a[176:179], a[192:195], a[32:35]
s_add_u32 m0, s32, 16384
ds_read_b64_tr_b16 a[250:251], v11 offset:1024
v_mfma_f32_16x16x32_bf16 a[36:39], a[176:179], a[196:199], a[36:39]
buffer_load_dwordx4 v1, s[12:15], s48 offen lds
v_mfma_f32_16x16x32_bf16 a[40:43], a[176:179], a[200:203], a[40:43]
ds_read_b64_tr_b16 a[252:253], v12 offset:0
v_mfma_f32_16x16x32_bf16 a[44:47], a[176:179], a[204:207], a[44:47]
s_add_u32 s29, s29, s93
v_mfma_f32_16x16x32_bf16 a[48:51], a[176:179], a[208:211], a[48:51]
ds_read_b64_tr_b16 a[254:255], v12 offset:1024
v_mfma_f32_16x16x32_bf16 a[52:55], a[176:179], a[212:215], a[52:55]
buffer_store_dwordx4 v[112:115], v13, s[8:11], s29 offen sc1
v_mfma_f32_16x16x32_bf16 a[56:59], a[176:179], a[216:219], a[56:59]
s_add_u32 s48, s48, s34
ds_read_b128 v[28:31], v3 offset:13312
v_mfma_f32_16x16x32_bf16 a[60:63], a[176:179], a[220:223], a[60:63]
s_add_u32 m0, s32, 20480
ds_read_b128 a[176:179], v4 offset:8192
v_mfma_f32_16x16x32_bf16 a[64:67], a[180:183], a[192:195], a[64:67]
buffer_load_dwordx4 v1, s[12:15], s48 offen lds
v_mfma_f32_16x16x32_bf16 a[68:71], a[180:183], a[196:199], a[68:71]
v_add_u32 v5, 16384, v5
v_and_b32 v5, 65535, v5
v_mfma_f32_16x16x32_bf16 a[72:75], a[180:183], a[200:203], a[72:75]
v_xor_b32 v6, 16, v5
v_xor_b32 v7, 64, v5
v_mfma_f32_16x16x32_bf16 a[76:79], a[180:183], a[204:207], a[76:79]
v_xor_b32 v8, 80, v5
v_xor_b32 v9, 128, v5
v_mfma_f32_16x16x32_bf16 a[80:83], a[180:183], a[208:211], a[80:83]
v_xor_b32 v10, 144, v5
v_xor_b32 v11, 192, v5
v_mfma_f32_16x16x32_bf16 a[84:87], a[180:183], a[212:215], a[84:87]
s_add_u32 s48, s48, s34
v_xor_b32 v12, 208, v5
v_mfma_f32_16x16x32_bf16 a[88:91], a[180:183], a[216:219], a[88:91]
s_add_u32 m0, s32, 24576
v_mfma_f32_16x16x32_bf16 a[92:95], a[180:183], a[220:223], a[92:95]
buffer_load_dwordx4 v1, s[12:15], s48 offen lds
ds_read_b128 a[180:183], v3 offset:9216
v_mfma_f32_16x16x32_bf16 a[96:99], a[184:187], a[192:195], a[96:99]
v_mfma_f32_16x16x32_bf16 a[100:103], a[184:187], a[196:199], a[100:103]
v_mfma_f32_16x16x32_bf16 a[104:107], a[184:187], a[200:203], a[104:107]
v_mfma_f32_16x16x32_bf16 a[108:111], a[184:187], a[204:207], a[108:111]
v_mfma_f32_16x16x32_bf16 a[112:115], a[184:187], a[208:211], a[112:115]
s_add_u32 s48, s48, s34
v_mfma_f32_16x16x32_bf16 a[116:119], a[184:187], a[212:215], a[116:119]
s_add_u32 m0, s32, 28672
v_mfma_f32_16x16x32_bf16 a[120:123], a[184:187], a[216:219], a[120:123]
buffer_load_dwordx4 v1, s[12:15], s48 offen lds
v_mfma_f32_16x16x32_bf16 a[124:127], a[184:187], a[220:223], a[124:127]
s_add_u32 s30, s30, 128
ds_read_b128 a[184:187], v4 offset:12288
v_mfma_f32_16x16x32_bf16 a[128:131], a[188:191], a[192:195], a[128:131]
s_add_u32 s32, s32, 32768
s_add_u32 s29, s29, s44
v_add_u32 v3, 32768, v3
v_mfma_f32_16x16x32_bf16 a[132:135], a[188:191], a[196:199], a[132:135]
s_sub_u32 s48, s32, 98304
v_subrev_u32 v19, 98304, v3
v_mfma_f32_16x16x32_bf16 a[136:139], a[188:191], a[200:203], a[136:139]
s_cmp_ge_u32 s32, 163840
s_cselect_b32 s32, s48, s32
buffer_store_dwordx4 v[116:119], v13, s[8:11], s29 offen sc1
buffer_load_dword v15, v14, s[96:99], s100 offen
v_mfma_f32_16x16x32_bf16 a[140:143], a[188:191], a[204:207], a[140:143]
s_add_u32 s100, s100, 16384
v_cmp_le_u32 vcc, 163840, v3
v_mfma_f32_16x16x32_bf16 a[144:147], a[188:191], a[208:211], a[144:147]
s_nop 0
v_cndmask_b32 v3, v3, v19, vcc
v_mfma_f32_16x16x32_bf16 a[148:151], a[188:191], a[212:215], a[148:151]
v_xor_b32 v4, 64, v3
v_mfma_f32_16x16x32_bf16 a[152:155], a[188:191], a[216:219], a[152:155]
v_mfma_f32_16x16x32_bf16 a[156:159], a[188:191], a[220:223], a[156:159]
s_waitcnt vmcnt(24) lgkmcnt(0)
s_barrier
v_mfma_f32_16x16x32_bf16 v[160:163], a[160:163], a[224:227], v[160:163]
ds_read_b64_tr_b16 a[192:193], v5 offset:0
v_mfma_f32_16x16x32_bf16 v[164:167], a[160:163], a[228:231], v[164:167]
v_mfma_f32_16x16x32_bf16 v[168:171], a[160:163], a[232:235], v[168:171]
ds_read_b64_tr_b16 a[194:195], v5 offset:1024
v_mfma_f32_16x16x32_bf16 v[172:175], a[160:163], a[236:239], v[172:175]
s_add_u32 s37, s31, 0
v_mfma_f32_16x16x32_bf16 v[176:179], a[160:163], a[240:243], v[176:179]
s_add_u32 m0, s33, 0
ds_read_b64_tr_b16 a[196:197], v6 offset:0
v_mfma_f32_16x16x32_bf16 v[180:183], a[160:163], a[244:247], v[180:183]
buffer_load_dwordx4 v2, s[20:23], s37 offen  lds
v_mfma_f32_16x16x32_bf16 v[184:187], a[160:163], a[248:251], v[184:187]
ds_read_b64_tr_b16 a[198:199], v6 offset:1024
v_mfma_f32_16x16x32_bf16 v[188:191], a[160:163], a[252:255], v[188:191]
ds_read_b128 a[160:163], v3 offset:0
v_mfma_f32_16x16x32_bf16 v[192:195], a[164:167], a[224:227], v[192:195]
ds_read_b64_tr_b16 a[200:201], v7 offset:0
v_mfma_f32_16x16x32_bf16 v[196:199], a[164:167], a[228:231], v[196:199]
v_mfma_f32_16x16x32_bf16 v[200:203], a[164:167], a[232:235], v[200:203]
s_add_u32 s37, s31, 32768
ds_read_b64_tr_b16 a[202:203], v7 offset:1024
v_mfma_f32_16x16x32_bf16 v[204:207], a[164:167], a[236:239], v[204:207]
s_add_u32 m0, s33, 1024
v_mfma_f32_16x16x32_bf16 v[208:211], a[164:167], a[240:243], v[208:211]
buffer_load_dwordx4 v2, s[20:23], s37 offen  lds
v_mfma_f32_16x16x32_bf16 v[212:215], a[164:167], a[244:247], v[212:215]
ds_read_b64_tr_b16 a[204:205], v8 offset:0
v_mfma_f32_16x16x32_bf16 v[216:219], a[164:167], a[248:251], v[216:219]
s_add_u32 s29, s29, s93
v_mfma_f32_16x16x32_bf16 v[220:223], a[164:167], a[252:255], v[220:223]
ds_read_b128 a[164:167], v4 offset:1024
v_mfma_f32_16x16x32_bf16 v[224:227], a[168:171], a[224:227], v[224:227]
buffer_store_dwordx4 v[120:123], v13, s[8:11], s29 offen sc1
v_mfma_f32_16x16x32_bf16 v[228:231], a[168:171], a[228:231], v[228:231]
s_add_u32 s37, s31, 131072
ds_read_b64_tr_b16 a[206:207], v8 offset:1024
v_mfma_f32_16x16x32_bf16 v[232:235], a[168:171], a[232:235], v[232:235]
s_add_u32 m0, s33, 4096
v_mfma_f32_16x16x32_bf16 v[236:239], a[168:171], a[236:239], v[236:239]
buffer_load_dwordx4 v2, s[20:23], s37 offen  lds
v_mfma_f32_16x16x32_bf16 v[240:243], a[168:171], a[240:243], v[240:243]
ds_read_b64_tr_b16 a[208:209], v9 offset:0
v_mfma_f32_16x16x32_bf16 v[244:247], a[168:171], a[244:247], v[244:247]
v_mfma_f32_16x16x32_bf16 v[248:251], a[168:171], a[248:251], v[248:251]
ds_read_b64_tr_b16 a[210:211], v9 offset:1024
v_mfma_f32_16x16x32_bf16 v[252:255], a[168:171], a[252:255], v[252:255]
ds_read_b128 a[168:171], v3 offset:4096
v_mfma_f32_16x16x32_bf16 a[0:3], a[172:175], a[224:227], a[0:3]
s_add_u32 s37, s31, 163840
ds_read_b64_tr_b16 a[212:213], v10 offset:0
v_mfma_f32_16x16x32_bf16 a[4:7], a[172:175], a[228:231], a[4:7]
s_add_u32 m0, s33, 5120
v_mfma_f32_16x16x32_bf16 a[8:11], a[172:175], a[232:235], a[8:11]
buffer_load_dwordx4 v2, s[20:23], s37 offen  lds
v_mfma_f32_16x16x32_bf16 a[12:15], a[172:175], a[236:239], a[12:15]
s_add_u32 s31, s31, 262144
ds_read_b64_tr_b16 a[214:215], v10 offset:1024
v_mfma_f32_16x16x32_bf16 a[16:19], a[172:175], a[240:243], a[16:19]
s_add_u32 s33, s33, 16384
v_mfma_f32_16x16x32_bf16 a[20:23], a[172:175], a[244:247], a[20:23]
s_and_b32 s33, s33, 65535
ds_read_b64_tr_b16 a[216:217], v11 offset:0
v_mfma_f32_16x16x32_bf16 a[24:27], a[172:175], a[248:251], a[24:27]
v_mfma_f32_16x16x32_bf16 a[28:31], a[172:175], a[252:255], a[28:31]
s_mov_b32 s48, s30
ds_read_b128 a[172:175], v4 offset:5120
v_mfma_f32_16x16x32_bf16 a[32:35], a[176:179], a[224:227], a[32:35]
s_add_u32 m0, s32, 0
ds_read_b64_tr_b16 a[218:219], v11 offset:1024
v_mfma_f32_16x16x32_bf16 a[36:39], a[176:179], a[228:231], a[36:39]
buffer_load_dwordx4 v1, s[12:15], s48 offen lds
v_mfma_f32_16x16x32_bf16 a[40:43], a[176:179], a[232:235], a[40:43]
ds_read_b64_tr_b16 a[220:221], v12 offset:0
v_mfma_f32_16x16x32_bf16 a[44:47], a[176:179], a[236:239], a[44:47]
s_add_u32 s29, s29, s44
v_mfma_f32_16x16x32_bf16 a[48:51], a[176:179], a[240:243], a[48:51]
ds_read_b64_tr_b16 a[222:223], v12 offset:1024
v_mfma_f32_16x16x32_bf16 a[52:55], a[176:179], a[244:247], a[52:55]
buffer_store_dwordx4 v[124:127], v13, s[8:11], s29 offen sc1
v_mfma_f32_16x16x32_bf16 a[56:59], a[176:179], a[248:251], a[56:59]
s_add_u32 s48, s48, s34
ds_read_b128 a[188:191], v4 offset:13312
v_mfma_f32_16x16x32_bf16 a[60:63], a[176:179], a[252:255], a[60:63]
s_add_u32 m0, s32, 4096
ds_read_b128 a[176:179], v3 offset:8192
v_mfma_f32_16x16x32_bf16 a[64:67], a[180:183], a[224:227], a[64:67]
buffer_load_dwordx4 v1, s[12:15], s48 offen lds
v_mfma_f32_16x16x32_bf16 a[68:71], a[180:183], a[228:231], a[68:71]
v_add_u32 v5, 16384, v5
v_and_b32 v5, 65535, v5
v_mfma_f32_16x16x32_bf16 a[72:75], a[180:183], a[232:235], a[72:75]
v_xor_b32 v6, 16, v5
v_xor_b32 v7, 64, v5
v_mfma_f32_16x16x32_bf16 a[76:79], a[180:183], a[236:239], a[76:79]
v_xor_b32 v8, 80, v5
v_xor_b32 v9, 128, v5
v_mfma_f32_16x16x32_bf16 a[80:83], a[180:183], a[240:243], a[80:83]
v_xor_b32 v10, 144, v5
v_xor_b32 v11, 192, v5
v_mfma_f32_16x16x32_bf16 a[84:87], a[180:183], a[244:247], a[84:87]
s_add_u32 s48, s48, s34
v_xor_b32 v12, 208, v5
v_mfma_f32_16x16x32_bf16 a[88:91], a[180:183], a[248:251], a[88:91]
s_add_u32 m0, s32, 8192
v_mfma_f32_16x16x32_bf16 a[92:95], a[180:183], a[252:255], a[92:95]
buffer_load_dwordx4 v1, s[12:15], s48 offen lds
ds_read_b128 a[180:183], v4 offset:9216
v_mfma_f32_16x16x32_bf16 a[96:99], a[184:187], a[224:227], a[96:99]
v_mfma_f32_16x16x32_bf16 a[100:103], a[184:187], a[228:231], a[100:103]
v_mfma_f32_16x16x32_bf16 a[104:107], a[184:187], a[232:235], a[104:107]
v_mfma_f32_16x16x32_bf16 a[108:111], a[184:187], a[236:239], a[108:111]
v_mfma_f32_16x16x32_bf16 a[112:115], a[184:187], a[240:243], a[112:115]
s_add_u32 s48, s48, s34
v_mfma_f32_16x16x32_bf16 a[116:119], a[184:187], a[244:247], a[116:119]
s_add_u32 m0, s32, 12288
v_mfma_f32_16x16x32_bf16 a[120:123], a[184:187], a[248:251], a[120:123]
buffer_load_dwordx4 v1, s[12:15], s48 offen lds
v_mfma_f32_16x16x32_bf16 a[124:127], a[184:187], a[252:255], a[124:127]
ds_read_b128 a[184:187], v3 offset:12288
v_mfma_f32_16x16x32_bf16 a[128:131], v[28:31], a[224:227], a[128:131]
v_mfma_f32_16x16x32_bf16 a[132:135], v[28:31], a[228:231], a[132:135]
v_mfma_f32_16x16x32_bf16 a[136:139], v[28:31], a[232:235], a[136:139]
buffer_load_dword v15, v14, s[96:99], s100 offen
v_mfma_f32_16x16x32_bf16 a[140:143], v[28:31], a[236:239], a[140:143]
s_add_u32 s100, s100, 16384
v_mfma_f32_16x16x32_bf16 a[144:147], v[28:31], a[240:243], a[144:147]
v_mfma_f32_16x16x32_bf16 a[148:151], v[28:31], a[244:247], a[148:151]
v_mfma_f32_16x16x32_bf16 a[152:155], v[28:31], a[248:251], a[152:155]
v_mfma_f32_16x16x32_bf16 a[156:159], v[28:31], a[252:255], a[156:159]
s_cmp_eq_u32 s36, 0
s_cbranch_scc1 L_g_v12
s_waitcnt vmcnt(23) lgkmcnt(0)
s_barrier
v_mfma_f32_16x16x32_bf16 v[160:163], a[160:163], a[192:195], v[160:163]
ds_read_b64_tr_b16 a[224:225], v5 offset:0
v_mfma_f32_16x16x32_bf16 v[164:167], a[160:163], a[196:199], v[164:167]
v_mfma_f32_16x16x32_bf16 v[168:171], a[160:163], a[200:203], v[168:171]
ds_read_b64_tr_b16 a[226:227], v5 offset:1024
v_mfma_f32_16x16x32_bf16 v[172:175], a[160:163], a[204:207], v[172:175]
s_add_u32 s37, s31, 0
v_mfma_f32_16x16x32_bf16 v[176:179], a[160:163], a[208:211], v[176:179]
s_add_u32 m0, s33, 0
ds_read_b64_tr_b16 a[228:229], v6 offset:0
v_mfma_f32_16x16x32_bf16 v[180:183], a[160:163], a[212:215], v[180:183]
buffer_load_dwordx4 v2, s[20:23], s37 offen  lds
v_mfma_f32_16x16x32_bf16 v[184:187], a[160:163], a[216:219], v[184:187]
ds_read_b64_tr_b16 a[230:231], v6 offset:1024
v_mfma_f32_16x16x32_bf16 v[188:191], a[160:163], a[220:223], v[188:191]
ds_read_b128 a[160:163], v4 offset:0
v_mfma_f32_16x16x32_bf16 v[192:195], a[164:167], a[192:195], v[192:195]
ds_read_b64_tr_b16 a[232:233], v7 offset:0
v_mfma_f32_16x16x32_bf16 v[196:199], a[164:167], a[196:199], v[196:199]
v_mfma_f32_16x16x32_bf16 v[200:203], a[164:167], a[200:203], v[200:203]
s_add_u32 s37, s31, 32768
ds_read_b64_tr_b16 a[234:235], v7 offset:1024
v_mfma_f32_16x16x32_bf16 v[204:207], a[164:167], a[204:207], v[204:207]
s_add_u32 m0, s33, 1024
v_mfma_f32_16x16x32_bf16 v[208:211], a[164:167], a[208:211], v[208:211]
buffer_load_dwordx4 v2, s[20:23], s37 offen  lds
v_mfma_f32_16x16x32_bf16 v[212:215], a[164:167], a[212:215], v[212:215]
ds_read_b64_tr_b16 a[236:237], v8 offset:0
v_mfma_f32_16x16x32_bf16 v[216:219], a[164:167], a[216:219], v[216:219]
v_mfma_f32_16x16x32_bf16 v[220:223], a[164:167], a[220:223], v[220:223]
ds_read_b128 a[164:167], v3 offset:1024
v_mfma_f32_16x16x32_bf16 v[224:227], a[168:171], a[192:195], v[224:227]
ds_read_b64_tr_b16 a[238:239], v8 offset:1024
v_mfma_f32_16x16x32_bf16 v[228:231], a[168:171], a[196:199], v[228:231]
s_add_u32 s37, s31, 131072
v_mfma_f32_16x16x32_bf16 v[232:235], a[168:171], a[200:203], v[232:235]
s_add_u32 m0, s33, 4096
ds_read_b64_tr_b16 a[240:241], v9 offset:0
v_mfma_f32_16x16x32_bf16 v[236:239], a[168:171], a[204:207], v[236:239]
buffer_load_dwordx4 v2, s[20:23], s37 offen  lds
v_mfma_f32_16x16x32_bf16 v[240:243], a[168:171], a[208:211], v[240:243]
ds_read_b64_tr_b16 a[242:243], v9 offset:1024
v_mfma_f32_16x16x32_bf16 v[244:247], a[168:171], a[212:215], v[244:247]
v_mfma_f32_16x16x32_bf16 v[248:251], a[168:171], a[216:219], v[248:251]
ds_read_b64_tr_b16 a[244:245], v10 offset:0
v_mfma_f32_16x16x32_bf16 v[252:255], a[168:171], a[220:223], v[252:255]
ds_read_b128 a[168:171], v4 offset:4096
v_mfma_f32_16x16x32_bf16 a[0:3], a[172:175], a[192:195], a[0:3]
s_add_u32 s37, s31, 163840
ds_read_b64_tr_b16 a[246:247], v10 offset:1024
v_mfma_f32_16x16x32_bf16 a[4:7], a[172:175], a[196:199], a[4:7]
s_add_u32 m0, s33, 5120
v_mfma_f32_16x16x32_bf16 a[8:11], a[172:175], a[200:203], a[8:11]
buffer_load_dwordx4 v2, s[20:23], s37 offen  lds
v_mfma_f32_16x16x32_bf16 a[12:15], a[172:175], a[204:207], a[12:15]
s_add_u32 s31, s31, 262144
ds_read_b64_tr_b16 a[248:249], v11 offset:0
v_mfma_f32_16x16x32_bf16 a[16:19], a[172:175], a[208:211], a[16:19]
s_add_u32 s33, s33, 16384
v_mfma_f32_16x16x32_bf16 a[20:23], a[172:175], a[212:215], a[20:23]
s_and_b32 s33, s33, 65535
ds_read_b64_tr_b16 a[250:251], v11 offset:1024
v_mfma_f32_16x16x32_bf16 a[24:27], a[172:175], a[216:219], a[24:27]
v_mfma_f32_16x16x32_bf16 a[28:31], a[172:175], a[220:223], a[28:31]
s_add_u32 s48, s48, s34
ds_read_b128 a[172:175], v3 offset:5120
v_mfma_f32_16x16x32_bf16 a[32:35], a[176:179], a[192:195], a[32:35]
s_add_u32 m0, s32, 16384
ds_read_b64_tr_b16 a[252:253], v12 offset:0
v_mfma_f32_16x16x32_bf16 a[36:39], a[176:179], a[196:199], a[36:39]
buffer_load_dwordx4 v1, s[12:15], s48 offen lds
v_mfma_f32_16x16x32_bf16 a[40:43], a[176:179], a[200:203], a[40:43]
ds_read_b64_tr_b16 a[254:255], v12 offset:1024
v_mfma_f32_16x16x32_bf16 a[44:47], a[176:179], a[204:207], a[44:47]
v_mfma_f32_16x16x32_bf16 a[48:51], a[176:179], a[208:211], a[48:51]
ds_read_b128 v[28:31], v3 offset:13312
v_mfma_f32_16x16x32_bf16 a[52:55], a[176:179], a[212:215], a[52:55]
v_mfma_f32_16x16x32_bf16 a[56:59], a[176:179], a[216:219], a[56:59]
s_add_u32 s48, s48, s34
v_mfma_f32_16x16x32_bf16 a[60:63], a[176:179], a[220:223], a[60:63]
s_add_u32 m0, s32, 20480
ds_read_b128 a[176:179], v4 offset:8192
v_add_u32 v5, 16384, v5
v_mfma_f32_16x16x32_bf16 a[64:67], a[180:183], a[192:195], a[64:67]
buffer_load_dwordx4 v1, s[12:15], s48 offen lds
v_and_b32 v5, 65535, v5
v_mfma_f32_16x16x32_bf16 a[68:71], a[180:183], a[196:199], a[68:71]
v_xor_b32 v6, 16, v5
v_xor_b32 v7, 64, v5
v_mfma_f32_16x16x32_bf16 a[72:75], a[180:183], a[200:203], a[72:75]
v_xor_b32 v8, 80, v5
v_xor_b32 v9, 128, v5
v_mfma_f32_16x16x32_bf16 a[76:79], a[180:183], a[204:207], a[76:79]
v_xor_b32 v10, 144, v5
v_xor_b32 v11, 192, v5
v_mfma_f32_16x16x32_bf16 a[80:83], a[180:183], a[208:211], a[80:83]
v_xor_b32 v12, 208, v5
v_mfma_f32_16x16x32_bf16 a[84:87], a[180:183], a[212:215], a[84:87]
s_add_u32 s48, s48, s34
v_mfma_f32_16x16x32_bf16 a[88:91], a[180:183], a[216:219], a[88:91]
s_add_u32 m0, s32, 24576
v_mfma_f32_16x16x32_bf16 a[92:95], a[180:183], a[220:223], a[92:95]
buffer_load_dwordx4 v1, s[12:15], s48 offen lds
ds_read_b128 a[180:183], v3 offset:9216
v_mfma_f32_16x16x32_bf16 a[96:99], a[184:187], a[192:195], a[96:99]
v_mfma_f32_16x16x32_bf16 a[100:103], a[184:187], a[196:199], a[100:103]
v_mfma_f32_16x16x32_bf16 a[104:107], a[184:187], a[200:203], a[104:107]
v_mfma_f32_16x16x32_bf16 a[108:111], a[184:187], a[204:207], a[108:111]
v_mfma_f32_16x16x32_bf16 a[112:115], a[184:187], a[208:211], a[112:115]
s_add_u32 s48, s48, s34
v_mfma_f32_16x16x32_bf16 a[116:119], a[184:187], a[212:215], a[116:119]
s_add_u32 m0, s32, 28672
v_mfma_f32_16x16x32_bf16 a[120:123], a[184:187], a[216:219], a[120:123]
buffer_load_dwordx4 v1, s[12:15], s48 offen lds
v_mfma_f32_16x16x32_bf16 a[124:127], a[184:187], a[220:223], a[124:127]
s_add_u32 s30, s30, 128
ds_read_b128 a[184:187], v4 offset:12288
v_mfma_f32_16x16x32_bf16 a[128:131], a[188:191], a[192:195], a[128:131]
s_add_u32 s32, s32, 32768
v_add_u32 v3, 32768, v3
v_mfma_f32_16x16x32_bf16 a[132:135], a[188:191], a[196:199], a[132:135]
s_sub_u32 s48, s32, 98304
v_subrev_u32 v19, 98304, v3
v_mfma_f32_16x16x32_bf16 a[136:139], a[188:191], a[200:203], a[136:139]
s_cmp_ge_u32 s32, 163840
s_cselect_b32 s32, s48, s32
v_mfma_f32_16x16x32_bf16 a[140:143], a[188:191], a[204:207], a[140:143]
v_cmp_le_u32 vcc, 163840, v3
v_mfma_f32_16x16x32_bf16 a[144:147], a[188:191], a[208:211], a[144:147]
s_nop 0
v_cndmask_b32 v3, v3, v19, vcc
v_mfma_f32_16x16x32_bf16 a[148:151], a[188:191], a[212:215], a[148:151]
v_xor_b32 v4, 64, v3
v_mfma_f32_16x16x32_bf16 a[152:155], a[188:191], a[216:219], a[152:155]
v_mfma_f32_16x16x32_bf16 a[156:159], a[188:191], a[220:223], a[156:159]
s_waitcnt vmcnt(19) lgkmcnt(0)
s_barrier
v_mfma_f32_16x16x32_bf16 v[160:163], a[160:163], a[224:227], v[160:163]
ds_read_b64_tr_b16 a[192:193], v5 offset:0
v_mfma_f32_16x16x32_bf16 v[164:167], a[160:163], a[228:231], v[164:167]
v_mfma_f32_16x16x32_bf16 v[168:171], a[160:163], a[232:235], v[168:171]
ds_read_b64_tr_b16 a[194:195], v5 offset:1024
v_mfma_f32_16x16x32_bf16 v[172:175], a[160:163], a[236:239], v[172:175]
s_add_u32 s37, s31, 0
v_mfma_f32_16x16x32_bf16 v[176:179], a[160:163], a[240:243], v[176:179]
s_add_u32 m0, s33, 0
ds_read_b64_tr_b16 a[196:197], v6 offset:0
v_mfma_f32_16x16x32_bf16 v[180:183], a[160:163], a[244:247], v[180:183]
buffer_load_dwordx4 v2, s[20:23], s37 offen  lds
v_mfma_f32_16x16x32_bf16 v[184:187], a[160:163], a[248:251], v[184:187]
ds_read_b64_tr_b16 a[198:199], v6 offset:1024
v_mfma_f32_16x16x32_bf16 v[188:191], a[160:163], a[252:255], v[188:191]
ds_read_b128 a[160:163], v3 offset:0
v_mfma_f32_16x16x32_bf16 v[192:195], a[164:167], a[224:227], v[192:195]
ds_read_b64_tr_b16 a[200:201], v7 offset:0
v_mfma_f32_16x16x32_bf16 v[196:199], a[164:167], a[228:231], v[196:199]
v_mfma_f32_16x16x32_bf16 v[200:203], a[164:167], a[232:235], v[200:203]
s_add_u32 s37, s31, 32768
ds_read_b64_tr_b16 a[202:203], v7 offset:1024
v_mfma_f32_16x16x32_bf16 v[204:207], a[164:167], a[236:239], v[204:207]
s_add_u32 m0, s33, 1024
v_mfma_f32_16x16x32_bf16 v[208:211], a[164:167], a[240:243], v[208:211]
buffer_load_dwordx4 v2, s[20:23], s37 offen  lds
v_mfma_f32_16x16x32_bf16 v[212:215], a[164:167], a[244:247], v[212:215]
ds_read_b64_tr_b16 a[204:205], v8 offset:0
v_mfma_f32_16x16x32_bf16 v[216:219], a[164:167], a[248:251], v[216:219]
v_mfma_f32_16x16x32_bf16 v[220:223], a[164:167], a[252:255], v[220:223]
ds_read_b128 a[164:167], v4 offset:1024
v_mfma_f32_16x16x32_bf16 v[224:227], a[168:171], a[224:227], v[224:227]
ds_read_b64_tr_b16 a[206:207], v8 offset:1024
v_mfma_f32_16x16x32_bf16 v[228:231], a[168:171], a[228:231], v[228:231]
s_add_u32 s37, s31, 131072
v_mfma_f32_16x16x32_bf16 v[232:235], a[168:171], a[232:235], v[232:235]
s_add_u32 m0, s33, 4096
ds_read_b64_tr_b16 a[208:209], v9 offset:0
v_mfma_f32_16x16x32_bf16 v[236:239], a[168:171], a[236:239], v[236:239]
buffer_load_dwordx4 v2, s[20:23], s37 offen  lds
v_mfma_f32_16x16x32_bf16 v[240:243], a[168:171], a[240:243], v[240:243]
ds_read_b64_tr_b16 a[210:211], v9 offset:1024
v_mfma_f32_16x16x32_bf16 v[244:247], a[168:171], a[244:247], v[244:247]
v_mfma_f32_16x16x32_bf16 v[248:251], a[168:171], a[248:251], v[248:251]
ds_read_b64_tr_b16 a[212:213], v10 offset:0
v_mfma_f32_16x16x32_bf16 v[252:255], a[168:171], a[252:255], v[252:255]
ds_read_b128 a[168:171], v3 offset:4096
v_mfma_f32_16x16x32_bf16 a[0:3], a[172:175], a[224:227], a[0:3]
s_add_u32 s37, s31, 163840
ds_read_b64_tr_b16 a[214:215], v10 offset:1024
v_mfma_f32_16x16x32_bf16 a[4:7], a[172:175], a[228:231], a[4:7]
s_add_u32 m0, s33, 5120
v_mfma_f32_16x16x32_bf16 a[8:11], a[172:175], a[232:235], a[8:11]
buffer_load_dwordx4 v2, s[20:23], s37 offen  lds
v_mfma_f32_16x16x32_bf16 a[12:15], a[172:175], a[236:239], a[12:15]
s_add_u32 s31, s31, 262144
ds_read_b64_tr_b16 a[216:217], v11 offset:0
v_mfma_f32_16x16x32_bf16 a[16:19], a[172:175], a[240:243], a[16:19]
s_add_u32 s33, s33, 16384
v_mfma_f32_16x16x32_bf16 a[20:23], a[172:175], a[244:247], a[20:23]
s_and_b32 s33, s33, 65535
ds_read_b64_tr_b16 a[218:219], v11 offset:1024
v_mfma_f32_16x16x32_bf16 a[24:27], a[172:175], a[248:251], a[24:27]
v_mfma_f32_16x16x32_bf16 a[28:31], a[172:175], a[252:255], a[28:31]
s_mov_b32 s48, s30
ds_read_b128 a[172:175], v4 offset:5120
v_mfma_f32_16x16x32_bf16 a[32:35], a[176:179], a[224:227], a[32:35]
s_add_u32 m0, s32, 0
ds_read_b64_tr_b16 a[220:221], v12 offset:0
v_mfma_f32_16x16x32_bf16 a[36:39], a[176:179], a[228:231], a[36:39]
buffer_load_dwordx4 v1, s[12:15], s48 offen lds
v_mfma_f32_16x16x32_bf16 a[40:43], a[176:179], a[232:235], a[40:43]
ds_read_b64_tr_b16 a[222:223], v12 offset:1024
v_mfma_f32_16x16x32_bf16 a[44:47], a[176:179], a[236:239], a[44:47]
v_mfma_f32_16x16x32_bf16 a[48:51], a[176:179], a[240:243], a[48:51]
ds_read_b128 a[188:191], v4 offset:13312
v_mfma_f32_16x16x32_bf16 a[52:55], a[176:179], a[244:247], a[52:55]
v_mfma_f32_16x16x32_bf16 a[56:59], a[176:179], a[248:251], a[56:59]
s_add_u32 s48, s48, s34
v_mfma_f32_16x16x32_bf16 a[60:63], a[176:179], a[252:255], a[60:63]
s_add_u32 m0, s32, 4096
ds_read_b128 a[176:179], v3 offset:8192
v_add_u32 v5, 16384, v5
v_mfma_f32_16x16x32_bf16 a[64:67], a[180:183], a[224:227], a[64:67]
buffer_load_dwordx4 v1, s[12:15], s48 offen lds
v_and_b32 v5, 65535, v5
v_mfma_f32_16x16x32_bf16 a[68:71], a[180:183], a[228:231], a[68:71]
v_xor_b32 v6, 16, v5
v_xor_b32 v7, 64, v5
v_mfma_f32_16x16x32_bf16 a[72:75], a[180:183], a[232:235], a[72:75]
v_xor_b32 v8, 80, v5
v_xor_b32 v9, 128, v5
v_mfma_f32_16x16x32_bf16 a[76:79], a[180:183], a[236:239], a[76:79]
v_xor_b32 v10, 144, v5
v_xor_b32 v11, 192, v5
v_mfma_f32_16x16x32_bf16 a[80:83], a[180:183], a[240:243], a[80:83]
v_xor_b32 v12, 208, v5
v_mfma_f32_16x16x32_bf16 a[84:87], a[180:183], a[244:247], a[84:87]
s_add_u32 s48, s48, s34
v_mfma_f32_16x16x32_bf16 a[88:91], a[180:183], a[248:251], a[88:91]
s_add_u32 m0, s32, 8192
v_mfma_f32_16x16x32_bf16 a[92:95], a[180:183], a[252:255], a[92:95]
buffer_load_dwordx4 v1, s[12:15], s48 offen lds
ds_read_b128 a[180:183], v4 offset:9216
v_mfma_f32_16x16x32_bf16 a[96:99], a[184:187], a[224:227], a[96:99]
v_mfma_f32_16x16x32_bf16 a[100:103], a[184:187], a[228:231], a[100:103]
v_mfma_f32_16x16x32_bf16 a[104:107], a[184:187], a[232:235], a[104:107]
v_mfma_f32_16x16x32_bf16 a[108:111], a[184:187], a[236:239], a[108:111]
v_mfma_f32_16x16x32_bf16 a[112:115], a[184:187], a[240:243], a[112:115]
s_add_u32 s48, s48, s34
v_mfma_f32_16x16x32_bf16 a[116:119], a[184:187], a[244:247], a[116:119]
s_add_u32 m0, s32, 12288
v_mfma_f32_16x16x32_bf16 a[120:123], a[184:187], a[248:251], a[120:123]
buffer_load_dwordx4 v1, s[12:15], s48 offen lds
v_mfma_f32_16x16x32_bf16 a[124:127], a[184:187], a[252:255], a[124:127]
ds_read_b128 a[184:187], v3 offset:12288
v_mfma_f32_16x16x32_bf16 a[128:131], v[28:31], a[224:227], a[128:131]
v_mfma_f32_16x16x32_bf16 a[132:135], v[28:31], a[228:231], a[132:135]
v_mfma_f32_16x16x32_bf16 a[136:139], v[28:31], a[232:235], a[136:139]
v_mfma_f32_16x16x32_bf16 a[140:143], v[28:31], a[236:239], a[140:143]
v_mfma_f32_16x16x32_bf16 a[144:147], v[28:31], a[240:243], a[144:147]
v_mfma_f32_16x16x32_bf16 a[148:151], v[28:31], a[244:247], a[148:151]
v_mfma_f32_16x16x32_bf16 a[152:155], v[28:31], a[248:251], a[152:155]
v_mfma_f32_16x16x32_bf16 a[156:159], v[28:31], a[252:255], a[156:159]
L_g_v12:
s_waitcnt vmcnt(16) lgkmcnt(0)
s_barrier
v_mfma_f32_16x16x32_bf16 v[160:163], a[160:163], a[192:195], v[160:163]
ds_read_b64_tr_b16 a[224:225], v5 offset:0
s_lshr_b32 s24, s16, 1
v_mfma_f32_16x16x32_bf16 v[164:167], a[160:163], a[196:199], v[164:167]
s_cmp_eq_u32 s35, 5
s_cselect_b32 s90, s24, s90
v_mfma_f32_16x16x32_bf16 v[168:171], a[160:163], a[200:203], v[168:171]
ds_read_b64_tr_b16 a[226:227], v5 offset:1024
s_lshl_b32 s24, s35, 2
v_mfma_f32_16x16x32_bf16 v[172:175], a[160:163], a[204:207], v[172:175]
s_add_u32 s37, s31, 0
s_lshr_b32 s26, s88, s24
s_bfe_u32 s2, s26, 0x10003
v_mfma_f32_16x16x32_bf16 v[176:179], a[160:163], a[208:211], v[176:179]
s_add_u32 m0, s33, 0
ds_read_b64_tr_b16 a[228:229], v6 offset:0
s_and_b32 s26, s26, 7
v_mfma_f32_16x16x32_bf16 v[180:183], a[160:163], a[212:215], v[180:183]
buffer_load_dwordx4 v2, s[20:23], s37 offen  lds
s_or_b32 s40, s2, s61
v_mfma_f32_16x16x32_bf16 v[184:187], a[160:163], a[216:219], v[184:187]
ds_read_b64_tr_b16 a[230:231], v6 offset:1024
s_lshr_b32 s24, s17, 1
v_mfma_f32_16x16x32_bf16 v[188:191], a[160:163], a[220:223], v[188:191]
ds_read_b128 a[160:163], v4 offset:0
v_mfma_f32_16x16x32_bf16 v[192:195], a[164:167], a[192:195], v[192:195]
ds_read_b64_tr_b16 a[232:233], v7 offset:0
v_mfma_f32_16x16x32_bf16 v[196:199], a[164:167], a[196:199], v[196:199]
s_cmp_eq_u32 s2, 0
s_cselect_b32 s41, s24, 0
s_cselect_b32 s27, s89, s90
v_mfma_f32_16x16x32_bf16 v[200:203], a[164:167], a[200:203], v[200:203]
s_add_u32 s37, s31, 32768
ds_read_b64_tr_b16 a[234:235], v7 offset:1024
s_sub_u32 s25, s24, s41
v_mfma_f32_16x16x32_bf16 v[204:207], a[164:167], a[204:207], v[204:207]
s_add_u32 m0, s33, 1024
s_and_b32 s51, s41, s61
s_lshl_b32 s51, s51, 1
v_mfma_f32_16x16x32_bf16 v[208:211], a[164:167], a[208:211], v[208:211]
buffer_load_dwordx4 v2, s[20:23], s37 offen  lds
s_or_b32 s51, s51, s41
v_mfma_f32_16x16x32_bf16 v[212:215], a[164:167], a[212:215], v[212:215]
ds_read_b64_tr_b16 a[236:237], v8 offset:0
s_lshl2_add_u32 s51, s2, s51
v_mfma_f32_16x16x32_bf16 v[216:219], a[164:167], a[216:219], v[216:219]
s_add_u32 s60, s60, s92
s_lshl_b32 s46, s27, s2
s_add_u32 s46, s46, s25
v_mfma_f32_16x16x32_bf16 v[220:223], a[164:167], a[220:223], v[220:223]
s_mov_b32 s29, s60
ds_read_b128 a[164:167], v3 offset:1024
s_lshl_b32 s46, s46, 8
v_mfma_f32_16x16x32_bf16 v[224:227], a[168:171], a[192:195], v[224:227]
buffer_store_dwordx4 v[128:131], v13, s[8:11], s29 offen sc1
s_lshl_b32 s47, s40, 7
v_mfma_f32_16x16x32_bf16 v[228:231], a[168:171], a[196:199], v[228:231]
s_add_u32 s37, s31, 131072
ds_read_b64_tr_b16 a[238:239], v8 offset:1024
s_add_u32 s47, s47, 1024
v_mfma_f32_16x16x32_bf16 v[232:235], a[168:171], a[200:203], v[232:235]
s_add_u32 m0, s33, 4096
s_mul_i32 s101, s26, s47
s_lshl_b32 s101, s101, 8
v_mfma_f32_16x16x32_bf16 v[236:239], a[168:171], a[204:207], v[236:239]
buffer_load_dwordx4 v2, s[20:23], s37 offen  lds
s_and_b32 s25, s17, 1
v_mfma_f32_16x16x32_bf16 v[240:243], a[168:171], a[208:211], v[240:243]
ds_read_b64_tr_b16 a[240:241], v9 offset:0
s_lshl1_add_u32 s42, s26, s25
v_mfma_f32_16x16x32_bf16 v[244:247], a[168:171], a[212:215], v[244:247]
s_lshl_b32 s42, s42, 7
s_lshr_b32 s42, s42, s2
s_add_u32 s42, s42, s27
v_mfma_f32_16x16x32_bf16 v[248:251], a[168:171], a[216:219], v[248:251]
ds_read_b64_tr_b16 a[242:243], v9 offset:1024
s_lshl1_add_u32 s42, s42, s24
v_mfma_f32_16x16x32_bf16 v[252:255], a[168:171], a[220:223], v[252:255]
ds_read_b128 a[168:171], v4 offset:4096
s_lshl_b32 s42, s42, 13
v_mfma_f32_16x16x32_bf16 a[0:3], a[172:175], a[192:195], a[0:3]
s_add_u32 s37, s31, 163840
ds_read_b64_tr_b16 a[244:245], v10 offset:0
s_lshl_b32 s43, s27, 5
v_mfma_f32_16x16x32_bf16 a[4:7], a[172:175], a[196:199], a[4:7]
s_add_u32 m0, s33, 5120
s_add_u32 s43, s43, s26
s_lshl_b32 s43, s43, 2
v_mfma_f32_16x16x32_bf16 a[8:11], a[172:175], a[200:203], a[8:11]
buffer_load_dwordx4 v2, s[20:23], s37 offen  lds
s_lshl_b32 s24, s2, 1
v_mfma_f32_16x16x32_bf16 a[12:15], a[172:175], a[204:207], a[12:15]
s_add_u32 s31, s31, 262144
ds_read_b64_tr_b16 a[246:247], v10 offset:1024
s_add_u32 s24, s24, s61
v_mfma_f32_16x16x32_bf16 a[16:19], a[172:175], a[208:211], a[16:19]
s_add_u32 s33, s33, 16384
s_lshl_b32 s24, s24, 2
s_lshr_b32 s25, 0x8720, s24
v_mfma_f32_16x16x32_bf16 a[20:23], a[172:175], a[212:215], a[20:23]
s_and_b32 s33, s33, 65535
ds_read_b64_tr_b16 a[248:249], v11 offset:0
s_and_b32 s25, s25, 15
v_mfma_f32_16x16x32_bf16 a[24:27], a[172:175], a[216:219], a[24:27]
s_lshl_b32 s25, s25, 24
s_add_u32 s42, s42, s25
s_lshr_b32 s25, 0x7604, s24
v_mfma_f32_16x16x32_bf16 a[28:31], a[172:175], a[220:223], a[28:31]
s_add_u32 s48, s48, s34
ds_read_b128 a[172:175], v3 offset:5120
s_and_b32 s25, s25, 15
v_mfma_f32_16x16x32_bf16 a[32:35], a[176:179], a[192:195], a[32:35]
s_add_u32 m0, s32, 16384
ds_read_b64_tr_b16 a[250:251], v11 offset:1024
s_lshl_b32 s25, s25, 12
v_mfma_f32_16x16x32_bf16 a[36:39], a[176:179], a[196:199], a[36:39]
buffer_load_dwordx4 v1, s[12:15], s48 offen lds
s_add_u32 s43, s43, s25
v_mfma_f32_16x16x32_bf16 a[40:43], a[176:179], a[200:203], a[40:43]
ds_read_b64_tr_b16 a[252:253], v12 offset:0
s_add_u32 s43, s43, 111149056
v_mfma_f32_16x16x32_bf16 a[44:47], a[176:179], a[204:207], a[44:47]
s_add_u32 s29, s29, s44
v_mfma_f32_16x16x32_bf16 a[48:51], a[176:179], a[208:211], a[48:51]
ds_read_b64_tr_b16 a[254:255], v12 offset:1024
v_mfma_f32_16x16x32_bf16 a[52:55], a[176:179], a[212:215], a[52:55]
buffer_store_dwordx4 v[132:135], v13, s[8:11], s29 offen sc1
v_mfma_f32_16x16x32_bf16 a[56:59], a[176:179], a[216:219], a[56:59]
s_add_u32 s48, s48, s34
ds_read_b128 v[28:31], v3 offset:13312
v_mfma_f32_16x16x32_bf16 a[60:63], a[176:179], a[220:223], a[60:63]
s_add_u32 m0, s32, 20480
ds_read_b128 a[176:179], v4 offset:8192
v_mfma_f32_16x16x32_bf16 a[64:67], a[180:183], a[192:195], a[64:67]
buffer_load_dwordx4 v1, s[12:15], s48 offen lds
v_mfma_f32_16x16x32_bf16 a[68:71], a[180:183], a[196:199], a[68:71]
s_cmp_lt_u32 s35, s45
s_cselect_b32 s101, s101, 536870912
s_cselect_b32 s46, s46, 536870912
v_mfma_f32_16x16x32_bf16 a[72:75], a[180:183], a[200:203], a[72:75]
v_add_u32 v5, 16384, v5
v_and_b32 v5, 65535, v5
v_mfma_f32_16x16x32_bf16 a[76:79], a[180:183], a[204:207], a[76:79]
v_xor_b32 v6, 16, v5
v_xor_b32 v7, 64, v5
v_mfma_f32_16x16x32_bf16 a[80:83], a[180:183], a[208:211], a[80:83]
v_xor_b32 v8, 80, v5
v_xor_b32 v9, 128, v5
v_mfma_f32_16x16x32_bf16 a[84:87], a[180:183], a[212:215], a[84:87]
s_add_u32 s48, s48, s34
v_xor_b32 v10, 144, v5
v_xor_b32 v11, 192, v5
v_mfma_f32_16x16x32_bf16 a[88:91], a[180:183], a[216:219], a[88:91]
s_add_u32 m0, s32, 24576
v_xor_b32 v12, 208, v5
v_mfma_f32_16x16x32_bf16 a[92:95], a[180:183], a[220:223], a[92:95]
buffer_load_dwordx4 v1, s[12:15], s48 offen lds
ds_read_b128 a[180:183], v3 offset:9216
v_mfma_f32_16x16x32_bf16 a[96:99], a[184:187], a[192:195], a[96:99]
v_mfma_f32_16x16x32_bf16 a[100:103], a[184:187], a[196:199], a[100:103]
v_mfma_f32_16x16x32_bf16 a[104:107], a[184:187], a[200:203], a[104:107]
v_mfma_f32_16x16x32_bf16 a[108:111], a[184:187], a[204:207], a[108:111]
v_mfma_f32_16x16x32_bf16 a[112:115], a[184:187], a[208:211], a[112:115]
s_add_u32 s48, s48, s34
v_mfma_f32_16x16x32_bf16 a[116:119], a[184:187], a[212:215], a[116:119]
s_add_u32 m0, s32, 28672
v_mfma_f32_16x16x32_bf16 a[120:123], a[184:187], a[216:219], a[120:123]
buffer_load_dwordx4 v1, s[12:15], s48 offen lds
v_mfma_f32_16x16x32_bf16 a[124:127], a[184:187], a[220:223], a[124:127]
s_add_u32 s30, s30, 128
ds_read_b128 a[184:187], v4 offset:12288
v_mfma_f32_16x16x32_bf16 a[128:131], a[188:191], a[192:195], a[128:131]
s_add_u32 s32, s32, 32768
s_add_u32 s29, s29, s93
v_add_u32 v3, 32768, v3
v_mfma_f32_16x16x32_bf16 a[132:135], a[188:191], a[196:199], a[132:135]
s_sub_u32 s48, s32, 98304
v_subrev_u32 v19, 98304, v3
v_mfma_f32_16x16x32_bf16 a[136:139], a[188:191], a[200:203], a[136:139]
s_cmp_ge_u32 s32, 163840
s_cselect_b32 s32, s48, s32
buffer_store_dwordx4 v[136:139], v13, s[8:11], s29 offen sc1
buffer_load_dword v15, v14, s[96:99], s100 offen
v_mfma_f32_16x16x32_bf16 a[140:143], a[188:191], a[204:207], a[140:143]
s_add_u32 s100, s100, 16384
v_cmp_le_u32 vcc, 163840, v3
v_mfma_f32_16x16x32_bf16 a[144:147], a[188:191], a[208:211], a[144:147]
s_nop 0
v_cndmask_b32 v3, v3, v19, vcc
v_mfma_f32_16x16x32_bf16 a[148:151], a[188:191], a[212:215], a[148:151]
v_xor_b32 v4, 64, v3
v_mfma_f32_16x16x32_bf16 a[152:155], a[188:191], a[216:219], a[152:155]
v_mfma_f32_16x16x32_bf16 a[156:159], a[188:191], a[220:223], a[156:159]
s_waitcnt vmcnt(20) lgkmcnt(0)
s_barrier
v_mfma_f32_16x16x32_bf16 v[160:163], a[160:163], a[224:227], v[160:163]
ds_read_b64_tr_b16 a[192:193], v5 offset:0
v_mfma_f32_16x16x32_bf16 v[164:167], a[160:163], a[228:231], v[164:167]
s_cmp_eq_u32 s2, 0
s_cselect_b64 s[4:5], s[52:53], s[54:55]
v_mfma_f32_16x16x32_bf16 v[168:171], a[160:163], a[232:235], v[168:171]
ds_read_b64_tr_b16 a[194:195], v5 offset:1024
s_mov_b32 s12, s4
v_mfma_f32_16x16x32_bf16 v[172:175], a[160:163], a[236:239], v[172:175]
s_add_u32 s37, s31, 0
s_and_b32 s13, s5, 0xffff
s_lshl_b32 s14, s47, 11
v_mfma_f32_16x16x32_bf16 v[176:179], a[160:163], a[240:243], v[176:179]
s_add_u32 m0, s33, 0
ds_read_b64_tr_b16 a[196:197], v6 offset:0
s_mov_b32 s15, 0x20000
v_mfma_f32_16x16x32_bf16 v[180:183], a[160:163], a[244:247], v[180:183]
buffer_load_dwordx4 v2, s[20:23], s37 offen  lds
s_mov_b32 s30, s101
v_mfma_f32_16x16x32_bf16 v[184:187], a[160:163], a[248:251], v[184:187]
ds_read_b64_tr_b16 a[198:199], v6 offset:1024
v_lshrrev_b32 v16, 3, v0
v_mfma_f32_16x16x32_bf16 v[188:191], a[160:163], a[252:255], v[188:191]
ds_read_b128 a[160:163], v3 offset:0
v_mul_lo_u32 v16, v16, s47
v_mfma_f32_16x16x32_bf16 v[192:195], a[164:167], a[224:227], v[192:195]
ds_read_b64_tr_b16 a[200:201], v7 offset:0
v_and_b32 v1, 0x70, v1
v_mfma_f32_16x16x32_bf16 v[196:199], a[164:167], a[228:231], v[196:199]
v_add_u32 v1, v1, v16
s_lshl_b32 s34, s47, 5
v_mfma_f32_16x16x32_bf16 v[200:203], a[164:167], a[232:235], v[200:203]
s_add_u32 s37, s31, 32768
ds_read_b64_tr_b16 a[202:203], v7 offset:1024
v_mfma_f32_16x16x32_bf16 v[204:207], a[164:167], a[236:239], v[204:207]
s_add_u32 m0, s33, 1024
v_mfma_f32_16x16x32_bf16 v[208:211], a[164:167], a[240:243], v[208:211]
buffer_load_dwordx4 v2, s[20:23], s37 offen  lds
v_mfma_f32_16x16x32_bf16 v[212:215], a[164:167], a[244:247], v[212:215]
ds_read_b64_tr_b16 a[204:205], v8 offset:0
v_mfma_f32_16x16x32_bf16 v[216:219], a[164:167], a[248:251], v[216:219]
s_add_u32 s29, s29, s44
v_mfma_f32_16x16x32_bf16 v[220:223], a[164:167], a[252:255], v[220:223]
ds_read_b128 a[164:167], v4 offset:1024
v_mfma_f32_16x16x32_bf16 v[224:227], a[168:171], a[224:227], v[224:227]
buffer_store_dwordx4 v[140:143], v13, s[8:11], s29 offen sc1
v_mfma_f32_16x16x32_bf16 v[228:231], a[168:171], a[228:231], v[228:231]
s_add_u32 s37, s31, 131072
ds_read_b64_tr_b16 a[206:207], v8 offset:1024
v_mfma_f32_16x16x32_bf16 v[232:235], a[168:171], a[232:235], v[232:235]
s_add_u32 m0, s33, 4096
v_mfma_f32_16x16x32_bf16 v[236:239], a[168:171], a[236:239], v[236:239]
buffer_load_dwordx4 v2, s[20:23], s37 offen  lds
v_mfma_f32_16x16x32_bf16 v[240:243], a[168:171], a[240:243], v[240:243]
ds_read_b64_tr_b16 a[208:209], v9 offset:0
v_mfma_f32_16x16x32_bf16 v[244:247], a[168:171], a[244:247], v[244:247]
v_mfma_f32_16x16x32_bf16 v[248:251], a[168:171], a[248:251], v[248:251]
ds_read_b64_tr_b16 a[210:211], v9 offset:1024
v_mfma_f32_16x16x32_bf16 v[252:255], a[168:171], a[252:255], v[252:255]
ds_read_b128 a[168:171], v3 offset:4096
v_mfma_f32_16x16x32_bf16 a[0:3], a[172:175], a[224:227], a[0:3]
s_add_u32 s37, s31, 163840
ds_read_b64_tr_b16 a[212:213], v10 offset:0
v_mfma_f32_16x16x32_bf16 a[4:7], a[172:175], a[228:231], a[4:7]
s_add_u32 m0, s33, 5120
v_mfma_f32_16x16x32_bf16 a[8:11], a[172:175], a[232:235], a[8:11]
buffer_load_dwordx4 v2, s[20:23], s37 offen  lds
v_mfma_f32_16x16x32_bf16 a[12:15], a[172:175], a[236:239], a[12:15]
s_add_u32 s31, s31, 262144
ds_read_b64_tr_b16 a[214:215], v10 offset:1024
v_mfma_f32_16x16x32_bf16 a[16:19], a[172:175], a[240:243], a[16:19]
s_add_u32 s33, s33, 16384
v_mfma_f32_16x16x32_bf16 a[20:23], a[172:175], a[244:247], a[20:23]
s_and_b32 s33, s33, 65535
ds_read_b64_tr_b16 a[216:217], v11 offset:0
v_mfma_f32_16x16x32_bf16 a[24:27], a[172:175], a[248:251], a[24:27]
v_mfma_f32_16x16x32_bf16 a[28:31], a[172:175], a[252:255], a[28:31]
s_mov_b32 s48, s30
ds_read_b128 a[172:175], v4 offset:5120
v_mfma_f32_16x16x32_bf16 a[32:35], a[176:179], a[224:227], a[32:35]
s_add_u32 m0, s32, 0
ds_read_b64_tr_b16 a[218:219], v11 offset:1024
v_mfma_f32_16x16x32_bf16 a[36:39], a[176:179], a[228:231], a[36:39]
buffer_load_dwordx4 v1, s[12:15], s48 offen lds
v_mfma_f32_16x16x32_bf16 a[40:43], a[176:179], a[232:235], a[40:43]
ds_read_b64_tr_b16 a[220:221], v12 offset:0
v_mfma_f32_16x16x32_bf16 a[44:47], a[176:179], a[236:239], a[44:47]
s_add_u32 s29, s29, s93
v_mfma_f32_16x16x32_bf16 a[48:51], a[176:179], a[240:243], a[48:51]
ds_read_b64_tr_b16 a[222:223], v12 offset:1024
v_mfma_f32_16x16x32_bf16 a[52:55], a[176:179], a[244:247], a[52:55]
buffer_store_dwordx4 v[144:147], v13, s[8:11], s29 offen sc1
v_mfma_f32_16x16x32_bf16 a[56:59], a[176:179], a[248:251], a[56:59]
s_add_u32 s48, s48, s34
ds_read_b128 a[188:191], v4 offset:13312
v_mfma_f32_16x16x32_bf16 a[60:63], a[176:179], a[252:255], a[60:63]
s_add_u32 m0, s32, 4096
ds_read_b128 a[176:179], v3 offset:8192
v_mfma_f32_16x16x32_bf16 a[64:67], a[180:183], a[224:227], a[64:67]
buffer_load_dwordx4 v1, s[12:15], s48 offen lds
v_mfma_f32_16x16x32_bf16 a[68:71], a[180:183], a[228:231], a[68:71]
v_add_u32 v5, 16384, v5
v_and_b32 v5, 65535, v5
v_mfma_f32_16x16x32_bf16 a[72:75], a[180:183], a[232:235], a[72:75]
v_xor_b32 v6, 16, v5
v_xor_b32 v7, 64, v5
v_mfma_f32_16x16x32_bf16 a[76:79], a[180:183], a[236:239], a[76:79]
v_xor_b32 v8, 80, v5
v_xor_b32 v9, 128, v5
v_mfma_f32_16x16x32_bf16 a[80:83], a[180:183], a[240:243], a[80:83]
s_cmp_eq_u32 s2, 0
s_cselect_b64 s[4:5], s[6:7], s[18:19]
v_mfma_f32_16x16x32_bf16 a[84:87], a[180:183], a[244:247], a[84:87]
s_add_u32 s48, s48, s34
s_mov_b32 s20, s4
s_and_b32 s21, s5, 0xffff
v_mfma_f32_16x16x32_bf16 a[88:91], a[180:183], a[248:251], a[88:91]
s_add_u32 m0, s32, 8192
s_lshl_b32 s22, s47, 12
s_mov_b32 s23, 0x20000
v_mfma_f32_16x16x32_bf16 a[92:95], a[180:183], a[252:255], a[92:95]
buffer_load_dwordx4 v1, s[12:15], s48 offen lds
ds_read_b128 a[180:183], v4 offset:9216
v_mfma_f32_16x16x32_bf16 a[96:99], a[184:187], a[224:227], a[96:99]
s_mov_b32 s31, s46
v_xor_b32 v10, 144, v5
v_xor_b32 v11, 192, v5
v_mfma_f32_16x16x32_bf16 a[100:103], a[184:187], a[228:231], a[100:103]
v_xor_b32 v12, 208, v5
v_mfma_f32_16x16x32_bf16 a[104:107], a[184:187], a[232:235], a[104:107]
v_mfma_f32_16x16x32_bf16 a[108:111], a[184:187], a[236:239], a[108:111]
v_mfma_f32_16x16x32_bf16 a[112:115], a[184:187], a[240:243], a[112:115]
s_add_u32 s48, s48, s34
v_mfma_f32_16x16x32_bf16 a[116:119], a[184:187], a[244:247], a[116:119]
s_add_u32 m0, s32, 12288
v_mfma_f32_16x16x32_bf16 a[120:123], a[184:187], a[248:251], a[120:123]
buffer_load_dwordx4 v1, s[12:15], s48 offen lds
v_mfma_f32_16x16x32_bf16 a[124:127], a[184:187], a[252:255], a[124:127]
ds_read_b128 a[184:187], v3 offset:12288
v_mfma_f32_16x16x32_bf16 a[128:131], v[28:31], a[224:227], a[128:131]
s_add_u32 s29, s29, s44
v_mfma_f32_16x16x32_bf16 a[132:135], v[28:31], a[228:231], a[132:135]
v_mfma_f32_16x16x32_bf16 a[136:139], v[28:31], a[232:235], a[136:139]
buffer_store_dwordx4 v[148:151], v13, s[8:11], s29 offen sc1
buffer_load_dword v15, v14, s[96:99], s100 offen
v_mfma_f32_16x16x32_bf16 a[140:143], v[28:31], a[236:239], a[140:143]
s_add_u32 s100, s100, 16384
v_mfma_f32_16x16x32_bf16 a[144:147], v[28:31], a[240:243], a[144:147]
v_mfma_f32_16x16x32_bf16 a[148:151], v[28:31], a[244:247], a[148:151]
v_mfma_f32_16x16x32_bf16 a[152:155], v[28:31], a[248:251], a[152:155]
v_mfma_f32_16x16x32_bf16 a[156:159], v[28:31], a[252:255], a[156:159]
s_waitcnt vmcnt(24) lgkmcnt(0)
s_barrier
v_mfma_f32_16x16x32_bf16 v[160:163], a[160:163], a[192:195], v[160:163]
ds_read_b64_tr_b16 a[224:225], v5 offset:0
v_mfma_f32_16x16x32_bf16 v[164:167], a[160:163], a[196:199], v[164:167]
v_mfma_f32_16x16x32_bf16 v[168:171], a[160:163], a[200:203], v[168:171]
ds_read_b64_tr_b16 a[226:227], v5 offset:1024
v_mfma_f32_16x16x32_bf16 v[172:175], a[160:163], a[204:207], v[172:175]
s_add_u32 s37, s31, 0
v_mfma_f32_16x16x32_bf16 v[176:179], a[160:163], a[208:211], v[176:179]
s_add_u32 m0, s33, 0
ds_read_b64_tr_b16 a[228:229], v6 offset:0
v_mfma_f32_16x16x32_bf16 v[180:183], a[160:163], a[212:215], v[180:183]
buffer_load_dwordx4 v2, s[20:23], s37 offen  lds
v_mfma_f32_16x16x32_bf16 v[184:187], a[160:163], a[216:219], v[184:187]
ds_read_b64_tr_b16 a[230:231], v6 offset:1024
v_mfma_f32_16x16x32_bf16 v[188:191], a[160:163], a[220:223], v[188:191]
ds_read_b128 a[160:163], v4 offset:0
v_mfma_f32_16x16x32_bf16 v[192:195], a[164:167], a[192:195], v[192:195]
ds_read_b64_tr_b16 a[232:233], v7 offset:0
v_mfma_f32_16x16x32_bf16 v[196:199], a[164:167], a[196:199], v[196:199]
v_mfma_f32_16x16x32_bf16 v[200:203], a[164:167], a[200:203], v[200:203]
s_add_u32 s37, s31, 32768
ds_read_b64_tr_b16 a[234:235], v7 offset:1024
v_mfma_f32_16x16x32_bf16 v[204:207], a[164:167], a[204:207], v[204:207]
s_add_u32 m0, s33, 1024
v_mfma_f32_16x16x32_bf16 v[208:211], a[164:167], a[208:211], v[208:211]
buffer_load_dwordx4 v2, s[20:23], s37 offen  lds
v_mfma_f32_16x16x32_bf16 v[212:215], a[164:167], a[212:215], v[212:215]
ds_read_b64_tr_b16 a[236:237], v8 offset:0
v_mfma_f32_16x16x32_bf16 v[216:219], a[164:167], a[216:219], v[216:219]
s_add_u32 s29, s29, s93
v_mfma_f32_16x16x32_bf16 v[220:223], a[164:167], a[220:223], v[220:223]
ds_read_b128 a[164:167], v3 offset:1024
v_mfma_f32_16x16x32_bf16 v[224:227], a[168:171], a[192:195], v[224:227]
buffer_store_dwordx4 v[152:155], v13, s[8:11], s29 offen sc1
v_mfma_f32_16x16x32_bf16 v[228:231], a[168:171], a[196:199], v[228:231]
s_add_u32 s37, s31, 131072
ds_read_b64_tr_b16 a[238:239], v8 offset:1024
v_mfma_f32_16x16x32_bf16 v[232:235], a[168:171], a[200:203], v[232:235]
s_add_u32 m0, s33, 4096
v_mfma_f32_16x16x32_bf16 v[236:239], a[168:171], a[204:207], v[236:239]
buffer_load_dwordx4 v2, s[20:23], s37 offen  lds
v_mfma_f32_16x16x32_bf16 v[240:243], a[168:171], a[208:211], v[240:243]
ds_read_b64_tr_b16 a[240:241], v9 offset:0
v_mfma_f32_16x16x32_bf16 v[244:247], a[168:171], a[212:215], v[244:247]
v_mfma_f32_16x16x32_bf16 v[248:251], a[168:171], a[216:219], v[248:251]
ds_read_b64_tr_b16 a[242:243], v9 offset:1024
v_mfma_f32_16x16x32_bf16 v[252:255], a[168:171], a[220:223], v[252:255]
ds_read_b128 a[168:171], v4 offset:4096
v_mfma_f32_16x16x32_bf16 a[0:3], a[172:175], a[192:195], a[0:3]
s_add_u32 s37, s31, 163840
ds_read_b64_tr_b16 a[244:245], v10 offset:0
v_mfma_f32_16x16x32_bf16 a[4:7], a[172:175], a[196:199], a[4:7]
s_add_u32 m0, s33, 5120
v_mfma_f32_16x16x32_bf16 a[8:11], a[172:175], a[200:203], a[8:11]
buffer_load_dwordx4 v2, s[20:23], s37 offen  lds
v_mfma_f32_16x16x32_bf16 a[12:15], a[172:175], a[204:207], a[12:15]
s_add_u32 s31, s31, 262144
ds_read_b64_tr_b16 a[246:247], v10 offset:1024
v_mfma_f32_16x16x32_bf16 a[16:19], a[172:175], a[208:211], a[16:19]
s_add_u32 s33, s33, 16384
v_mfma_f32_16x16x32_bf16 a[20:23], a[172:175], a[212:215], a[20:23]
s_and_b32 s33, s33, 65535
ds_read_b64_tr_b16 a[248:249], v11 offset:0
v_mfma_f32_16x16x32_bf16 a[24:27], a[172:175], a[216:219], a[24:27]
v_mfma_f32_16x16x32_bf16 a[28:31], a[172:175], a[220:223], a[28:31]
s_add_u32 s48, s48, s34
ds_read_b128 a[172:175], v3 offset:5120
v_mfma_f32_16x16x32_bf16 a[32:35], a[176:179], a[192:195], a[32:35]
s_add_u32 m0, s32, 16384
ds_read_b64_tr_b16 a[250:251], v11 offset:1024
v_mfma_f32_16x16x32_bf16 a[36:39], a[176:179], a[196:199], a[36:39]
buffer_load_dwordx4 v1, s[12:15], s48 offen lds
v_mfma_f32_16x16x32_bf16 a[40:43], a[176:179], a[200:203], a[40:43]
ds_read_b64_tr_b16 a[252:253], v12 offset:0
v_mfma_f32_16x16x32_bf16 a[44:47], a[176:179], a[204:207], a[44:47]
s_add_u32 s29, s29, s44
v_mfma_f32_16x16x32_bf16 a[48:51], a[176:179], a[208:211], a[48:51]
ds_read_b64_tr_b16 a[254:255], v12 offset:1024
v_mfma_f32_16x16x32_bf16 a[52:55], a[176:179], a[212:215], a[52:55]
buffer_store_dwordx4 v[156:159], v13, s[8:11], s29 offen sc1
v_mfma_f32_16x16x32_bf16 a[56:59], a[176:179], a[216:219], a[56:59]
s_add_u32 s48, s48, s34
ds_read_b128 v[28:31], v3 offset:13312
v_mfma_f32_16x16x32_bf16 a[60:63], a[176:179], a[220:223], a[60:63]
s_add_u32 m0, s32, 20480
ds_read_b128 a[176:179], v4 offset:8192
v_mfma_f32_16x16x32_bf16 a[64:67], a[180:183], a[192:195], a[64:67]
buffer_load_dwordx4 v1, s[12:15], s48 offen lds
v_mfma_f32_16x16x32_bf16 a[68:71], a[180:183], a[196:199], a[68:71]
v_add_u32 v5, 16384, v5
v_and_b32 v5, 65535, v5
v_mfma_f32_16x16x32_bf16 a[72:75], a[180:183], a[200:203], a[72:75]
v_xor_b32 v6, 16, v5
v_xor_b32 v7, 64, v5
v_mfma_f32_16x16x32_bf16 a[76:79], a[180:183], a[204:207], a[76:79]
v_xor_b32 v8, 80, v5
v_xor_b32 v9, 128, v5
v_mfma_f32_16x16x32_bf16 a[80:83], a[180:183], a[208:211], a[80:83]
v_xor_b32 v10, 144, v5
v_xor_b32 v11, 192, v5
v_mfma_f32_16x16x32_bf16 a[84:87], a[180:183], a[212:215], a[84:87]
s_add_u32 s48, s48, s34
v_xor_b32 v12, 208, v5
v_mfma_f32_16x16x32_bf16 a[88:91], a[180:183], a[216:219], a[88:91]
s_add_u32 m0, s32, 24576
v_mfma_f32_16x16x32_bf16 a[92:95], a[180:183], a[220:223], a[92:95]
buffer_load_dwordx4 v1, s[12:15], s48 offen lds
ds_read_b128 a[180:183], v3 offset:9216
v_mfma_f32_16x16x32_bf16 a[96:99], a[184:187], a[192:195], a[96:99]
v_mfma_f32_16x16x32_bf16 a[100:103], a[184:187], a[196:199], a[100:103]
v_mfma_f32_16x16x32_bf16 a[104:107], a[184:187], a[200:203], a[104:107]
v_mfma_f32_16x16x32_bf16 a[108:111], a[184:187], a[204:207], a[108:111]
v_mfma_f32_16x16x32_bf16 a[112:115], a[184:187], a[208:211], a[112:115]
s_add_u32 s48, s48, s34
v_mfma_f32_16x16x32_bf16 a[116:119], a[184:187], a[212:215], a[116:119]
s_add_u32 m0, s32, 28672
v_mfma_f32_16x16x32_bf16 a[120:123], a[184:187], a[216:219], a[120:123]
buffer_load_dwordx4 v1, s[12:15], s48 offen lds
v_mfma_f32_16x16x32_bf16 a[124:127], a[184:187], a[220:223], a[124:127]
s_add_u32 s30, s30, 128
ds_read_b128 a[184:187], v4 offset:12288
v_mfma_f32_16x16x32_bf16 a[128:131], a[188:191], a[192:195], a[128:131]
s_add_u32 s32, s32, 32768
v_add_u32 v3, 32768, v3
v_mfma_f32_16x16x32_bf16 a[132:135], a[188:191], a[196:199], a[132:135]
s_sub_u32 s48, s32, 98304
v_subrev_u32 v19, 98304, v3
v_mfma_f32_16x16x32_bf16 a[136:139], a[188:191], a[200:203], a[136:139]
s_cmp_ge_u32 s32, 163840
s_cselect_b32 s32, s48, s32
buffer_load_dword v15, v14, s[96:99], s100 offen
v_mfma_f32_16x16x32_bf16 a[140:143], a[188:191], a[204:207], a[140:143]
s_add_u32 s100, s100, 16384
v_cmp_le_u32 vcc, 163840, v3
v_mfma_f32_16x16x32_bf16 a[144:147], a[188:191], a[208:211], a[144:147]
s_nop 0
v_cndmask_b32 v3, v3, v19, vcc
v_mfma_f32_16x16x32_bf16 a[148:151], a[188:191], a[212:215], a[148:151]
v_xor_b32 v4, 64, v3
v_mfma_f32_16x16x32_bf16 a[152:155], a[188:191], a[216:219], a[152:155]
v_mfma_f32_16x16x32_bf16 a[156:159], a[188:191], a[220:223], a[156:159]
s_waitcnt vmcnt(23) lgkmcnt(0)
s_barrier
v_mfma_f32_16x16x32_bf16 v[160:163], a[160:163], a[224:227], v[160:163]
ds_read_b64_tr_b16 a[192:193], v5 offset:0
v_mfma_f32_16x16x32_bf16 v[164:167], a[160:163], a[228:231], v[164:167]
v_mfma_f32_16x16x32_bf16 v[168:171], a[160:163], a[232:235], v[168:171]
ds_read_b64_tr_b16 a[194:195], v5 offset:1024
v_mfma_f32_16x16x32_bf16 v[172:175], a[160:163], a[236:239], v[172:175]
s_add_u32 s37, s31, 0
v_mfma_f32_16x16x32_bf16 v[176:179], a[160:163], a[240:243], v[176:179]
s_add_u32 m0, s33, 0
ds_read_b64_tr_b16 a[196:197], v6 offset:0
v_mfma_f32_16x16x32_bf16 v[180:183], a[160:163], a[244:247], v[180:183]
buffer_load_dwordx4 v2, s[20:23], s37 offen  lds
v_mfma_f32_16x16x32_bf16 v[184:187], a[160:163], a[248:251], v[184:187]
ds_read_b64_tr_b16 a[198:199], v6 offset:1024
v_mfma_f32_16x16x32_bf16 v[188:191], a[160:163], a[252:255], v[188:191]
ds_read_b128 a[160:163], v3 offset:0
v_mfma_f32_16x16x32_bf16 v[192:195], a[164:167], a[224:227], v[192:195]
ds_read_b64_tr_b16 a[200:201], v7 offset:0
v_mfma_f32_16x16x32_bf16 v[196:199], a[164:167], a[228:231], v[196:199]
v_mfma_f32_16x16x32_bf16 v[200:203], a[164:167], a[232:235], v[200:203]
s_add_u32 s37, s31, 32768
ds_read_b64_tr_b16 a[202:203], v7 offset:1024
v_mfma_f32_16x16x32_bf16 v[204:207], a[164:167], a[236:239], v[204:207]
s_add_u32 m0, s33, 1024
v_mfma_f32_16x16x32_bf16 v[208:211], a[164:167], a[240:243], v[208:211]
buffer_load_dwordx4 v2, s[20:23], s37 offen  lds
v_mfma_f32_16x16x32_bf16 v[212:215], a[164:167], a[244:247], v[212:215]
ds_read_b64_tr_b16 a[204:205], v8 offset:0
v_mfma_f32_16x16x32_bf16 v[216:219], a[164:167], a[248:251], v[216:219]
v_mfma_f32_16x16x32_bf16 v[220:223], a[164:167], a[252:255], v[220:223]
ds_read_b128 a[164:167], v4 offset:1024
v_mfma_f32_16x16x32_bf16 v[224:227], a[168:171], a[224:227], v[224:227]
ds_read_b64_tr_b16 a[206:207], v8 offset:1024
v_mfma_f32_16x16x32_bf16 v[228:231], a[168:171], a[228:231], v[228:231]
s_add_u32 s37, s31, 131072
v_mfma_f32_16x16x32_bf16 v[232:235], a[168:171], a[232:235], v[232:235]
s_add_u32 m0, s33, 4096
ds_read_b64_tr_b16 a[208:209], v9 offset:0
v_mfma_f32_16x16x32_bf16 v[236:239], a[168:171], a[236:239], v[236:239]
buffer_load_dwordx4 v2, s[20:23], s37 offen  lds
v_mfma_f32_16x16x32_bf16 v[240:243], a[168:171], a[240:243], v[240:243]
ds_read_b64_tr_b16 a[210:211], v9 offset:1024
v_mfma_f32_16x16x32_bf16 v[244:247], a[168:171], a[244:247], v[244:247]
v_mfma_f32_16x16x32_bf16 v[248:251], a[168:171], a[248:251], v[248:251]
ds_read_b64_tr_b16 a[212:213], v10 offset:0
v_mfma_f32_16x16x32_bf16 v[252:255], a[168:171], a[252:255], v[252:255]
ds_read_b128 a[168:171], v3 offset:4096
v_mfma_f32_16x16x32_bf16 a[0:3], a[172:175], a[224:227], a[0:3]
s_add_u32 s37, s31, 163840
ds_read_b64_tr_b16 a[214:215], v10 offset:1024
v_mfma_f32_16x16x32_bf16 a[4:7], a[172:175], a[228:231], a[4:7]
s_add_u32 m0, s33, 5120
v_mfma_f32_16x16x32_bf16 a[8:11], a[172:175], a[232:235], a[8:11]
buffer_load_dwordx4 v2, s[20:23], s37 offen  lds
v_mfma_f32_16x16x32_bf16 a[12:15], a[172:175], a[236:239], a[12:15]
s_add_u32 s31, s31, 262144
ds_read_b64_tr_b16 a[216:217], v11 offset:0
v_mfma_f32_16x16x32_bf16 a[16:19], a[172:175], a[240:243], a[16:19]
s_add_u32 s33, s33, 16384
v_mfma_f32_16x16x32_bf16 a[20:23], a[172:175], a[244:247], a[20:23]
s_and_b32 s33, s33, 65535
ds_read_b64_tr_b16 a[218:219], v11 offset:1024
v_mfma_f32_16x16x32_bf16 a[24:27], a[172:175], a[248:251], a[24:27]
v_mfma_f32_16x16x32_bf16 a[28:31], a[172:175], a[252:255], a[28:31]
s_mov_b32 s48, s30
ds_read_b128 a[172:175], v4 offset:5120
v_mfma_f32_16x16x32_bf16 a[32:35], a[176:179], a[224:227], a[32:35]
s_add_u32 m0, s32, 0
ds_read_b64_tr_b16 a[220:221], v12 offset:0
v_mfma_f32_16x16x32_bf16 a[36:39], a[176:179], a[228:231], a[36:39]
buffer_load_dwordx4 v1, s[12:15], s48 offen lds
v_mfma_f32_16x16x32_bf16 a[40:43], a[176:179], a[232:235], a[40:43]
ds_read_b64_tr_b16 a[222:223], v12 offset:1024
v_mfma_f32_16x16x32_bf16 a[44:47], a[176:179], a[236:239], a[44:47]
v_mfma_f32_16x16x32_bf16 a[48:51], a[176:179], a[240:243], a[48:51]
ds_read_b128 a[188:191], v4 offset:13312
v_mfma_f32_16x16x32_bf16 a[52:55], a[176:179], a[244:247], a[52:55]
v_mfma_f32_16x16x32_bf16 a[56:59], a[176:179], a[248:251], a[56:59]
s_add_u32 s48, s48, s34
v_mfma_f32_16x16x32_bf16 a[60:63], a[176:179], a[252:255], a[60:63]
s_add_u32 m0, s32, 4096
ds_read_b128 a[176:179], v3 offset:8192
v_add_u32 v5, 16384, v5
v_mfma_f32_16x16x32_bf16 a[64:67], a[180:183], a[224:227], a[64:67]
buffer_load_dwordx4 v1, s[12:15], s48 offen lds
v_and_b32 v5, 65535, v5
v_mfma_f32_16x16x32_bf16 a[68:71], a[180:183], a[228:231], a[68:71]
v_xor_b32 v6, 16, v5
v_xor_b32 v7, 64, v5
v_mfma_f32_16x16x32_bf16 a[72:75], a[180:183], a[232:235], a[72:75]
v_xor_b32 v8, 80, v5
v_xor_b32 v9, 128, v5
v_mfma_f32_16x16x32_bf16 a[76:79], a[180:183], a[236:239], a[76:79]
v_xor_b32 v10, 144, v5
v_xor_b32 v11, 192, v5
v_mfma_f32_16x16x32_bf16 a[80:83], a[180:183], a[240:243], a[80:83]
v_xor_b32 v12, 208, v5
v_mfma_f32_16x16x32_bf16 a[84:87], a[180:183], a[244:247], a[84:87]
s_add_u32 s48, s48, s34
v_mfma_f32_16x16x32_bf16 a[88:91], a[180:183], a[248:251], a[88:91]
s_add_u32 m0, s32, 8192
v_mfma_f32_16x16x32_bf16 a[92:95], a[180:183], a[252:255], a[92:95]
buffer_load_dwordx4 v1, s[12:15], s48 offen lds
ds_read_b128 a[180:183], v4 offset:9216
v_mfma_f32_16x16x32_bf16 a[96:99], a[184:187], a[224:227], a[96:99]
v_mfma_f32_16x16x32_bf16 a[100:103], a[184:187], a[228:231], a[100:103]
v_mfma_f32_16x16x32_bf16 a[104:107], a[184:187], a[232:235], a[104:107]
v_mfma_f32_16x16x32_bf16 a[108:111], a[184:187], a[236:239], a[108:111]
v_mfma_f32_16x16x32_bf16 a[112:115], a[184:187], a[240:243], a[112:115]
s_add_u32 s48, s48, s34
v_mfma_f32_16x16x32_bf16 a[116:119], a[184:187], a[244:247], a[116:119]
s_add_u32 m0, s32, 12288
v_mfma_f32_16x16x32_bf16 a[120:123], a[184:187], a[248:251], a[120:123]
buffer_load_dwordx4 v1, s[12:15], s48 offen lds
v_mfma_f32_16x16x32_bf16 a[124:127], a[184:187], a[252:255], a[124:127]
ds_read_b128 a[184:187], v3 offset:12288
v_mfma_f32_16x16x32_bf16 a[128:131], v[28:31], a[224:227], a[128:131]
v_mfma_f32_16x16x32_bf16 a[132:135], v[28:31], a[228:231], a[132:135]
v_mfma_f32_16x16x32_bf16 a[136:139], v[28:31], a[232:235], a[136:139]
buffer_load_dword v15, v14, s[96:99], s100 offen
v_mfma_f32_16x16x32_bf16 a[140:143], v[28:31], a[236:239], a[140:143]
s_add_u32 s100, s100, 16384
v_mfma_f32_16x16x32_bf16 a[144:147], v[28:31], a[240:243], a[144:147]
v_mfma_f32_16x16x32_bf16 a[148:151], v[28:31], a[244:247], a[148:151]
v_mfma_f32_16x16x32_bf16 a[152:155], v[28:31], a[248:251], a[152:155]
v_mfma_f32_16x16x32_bf16 a[156:159], v[28:31], a[252:255], a[156:159]
s_waitcnt vmcnt(20) lgkmcnt(0)
s_barrier
v_mfma_f32_16x16x32_bf16 v[160:163], a[160:163], a[192:195], v[160:163]
ds_read_b64_tr_b16 a[224:225], v5 offset:0
v_mfma_f32_16x16x32_bf16 v[164:167], a[160:163], a[196:199], v[164:167]
v_mfma_f32_16x16x32_bf16 v[168:171], a[160:163], a[200:203], v[168:171]
ds_read_b64_tr_b16 a[226:227], v5 offset:1024
v_mfma_f32_16x16x32_bf16 v[172:175], a[160:163], a[204:207], v[172:175]
s_add_u32 s37, s31, 0
v_mfma_f32_16x16x32_bf16 v[176:179], a[160:163], a[208:211], v[176:179]
s_add_u32 m0, s33, 0
ds_read_b64_tr_b16 a[228:229], v6 offset:0
v_mfma_f32_16x16x32_bf16 v[180:183], a[160:163], a[212:215], v[180:183]
buffer_load_dwordx4 v2, s[20:23], s37 offen  lds
v_mfma_f32_16x16x32_bf16 v[184:187], a[160:163], a[216:219], v[184:187]
ds_read_b64_tr_b16 a[230:231], v6 offset:1024
v_mfma_f32_16x16x32_bf16 v[188:191], a[160:163], a[220:223], v[188:191]
ds_read_b128 a[160:163], v4 offset:0
v_mfma_f32_16x16x32_bf16 v[192:195], a[164:167], a[192:195], v[192:195]
ds_read_b64_tr_b16 a[232:233], v7 offset:0
v_mfma_f32_16x16x32_bf16 v[196:199], a[164:167], a[196:199], v[196:199]
v_mfma_f32_16x16x32_bf16 v[200:203], a[164:167], a[200:203], v[200:203]
s_add_u32 s37, s31, 32768
ds_read_b64_tr_b16 a[234:235], v7 offset:1024
v_mfma_f32_16x16x32_bf16 v[204:207], a[164:167], a[204:207], v[204:207]
s_add_u32 m0, s33, 1024
v_mfma_f32_16x16x32_bf16 v[208:211], a[164:167], a[208:211], v[208:211]
buffer_load_dwordx4 v2, s[20:23], s37 offen  lds
v_mfma_f32_16x16x32_bf16 v[212:215], a[164:167], a[212:215], v[212:215]
ds_read_b64_tr_b16 a[236:237], v8 offset:0
v_mfma_f32_16x16x32_bf16 v[216:219], a[164:167], a[216:219], v[216:219]
v_mfma_f32_16x16x32_bf16 v[220:223], a[164:167], a[220:223], v[220:223]
ds_read_b128 a[164:167], v3 offset:1024
v_mfma_f32_16x16x32_bf16 v[224:227], a[168:171], a[192:195], v[224:227]
ds_read_b64_tr_b16 a[238:239], v8 offset:1024
v_mfma_f32_16x16x32_bf16 v[228:231], a[168:171], a[196:199], v[228:231]
s_add_u32 s37, s31, 131072
v_mfma_f32_16x16x32_bf16 v[232:235], a[168:171], a[200:203], v[232:235]
s_add_u32 m0, s33, 4096
ds_read_b64_tr_b16 a[240:241], v9 offset:0
v_mfma_f32_16x16x32_bf16 v[236:239], a[168:171], a[204:207], v[236:239]
buffer_load_dwordx4 v2, s[20:23], s37 offen  lds
v_mfma_f32_16x16x32_bf16 v[240:243], a[168:171], a[208:211], v[240:243]
ds_read_b64_tr_b16 a[242:243], v9 offset:1024
v_mfma_f32_16x16x32_bf16 v[244:247], a[168:171], a[212:215], v[244:247]
v_mfma_f32_16x16x32_bf16 v[248:251], a[168:171], a[216:219], v[248:251]
ds_read_b64_tr_b16 a[244:245], v10 offset:0
v_mfma_f32_16x16x32_bf16 v[252:255], a[168:171], a[220:223], v[252:255]
ds_read_b128 a[168:171], v4 offset:4096
v_mfma_f32_16x16x32_bf16 a[0:3], a[172:175], a[192:195], a[0:3]
s_add_u32 s37, s31, 163840
ds_read_b64_tr_b16 a[246:247], v10 offset:1024
v_mfma_f32_16x16x32_bf16 a[4:7], a[172:175], a[196:199], a[4:7]
s_add_u32 m0, s33, 5120
v_mfma_f32_16x16x32_bf16 a[8:11], a[172:175], a[200:203], a[8:11]
buffer_load_dwordx4 v2, s[20:23], s37 offen  lds
v_mfma_f32_16x16x32_bf16 a[12:15], a[172:175], a[204:207], a[12:15]
s_add_u32 s31, s31, 262144
ds_read_b64_tr_b16 a[248:249], v11 offset:0
v_mfma_f32_16x16x32_bf16 a[16:19], a[172:175], a[208:211], a[16:19]
s_add_u32 s33, s33, 16384
v_mfma_f32_16x16x32_bf16 a[20:23], a[172:175], a[212:215], a[20:23]
s_and_b32 s33, s33, 65535
ds_read_b64_tr_b16 a[250:251], v11 offset:1024
v_mfma_f32_16x16x32_bf16 a[24:27], a[172:175], a[216:219], a[24:27]
v_mfma_f32_16x16x32_bf16 a[28:31], a[172:175], a[220:223], a[28:31]
s_add_u32 s48, s48, s34
ds_read_b128 a[172:175], v3 offset:5120
v_mfma_f32_16x16x32_bf16 a[32:35], a[176:179], a[192:195], a[32:35]
s_add_u32 m0, s32, 16384
ds_read_b64_tr_b16 a[252:253], v12 offset:0
v_mfma_f32_16x16x32_bf16 a[36:39], a[176:179], a[196:199], a[36:39]
buffer_load_dwordx4 v1, s[12:15], s48 offen lds
v_mfma_f32_16x16x32_bf16 a[40:43], a[176:179], a[200:203], a[40:43]
ds_read_b64_tr_b16 a[254:255], v12 offset:1024
v_mfma_f32_16x16x32_bf16 a[44:47], a[176:179], a[204:207], a[44:47]
v_mfma_f32_16x16x32_bf16 a[48:51], a[176:179], a[208:211], a[48:51]
ds_read_b128 v[28:31], v3 offset:13312
v_mfma_f32_16x16x32_bf16 a[52:55], a[176:179], a[212:215], a[52:55]
v_mfma_f32_16x16x32_bf16 a[56:59], a[176:179], a[216:219], a[56:59]
s_add_u32 s48, s48, s34
v_mfma_f32_16x16x32_bf16 a[60:63], a[176:179], a[220:223], a[60:63]
s_add_u32 m0, s32, 20480
ds_read_b128 a[176:179], v4 offset:8192
v_add_u32 v5, 16384, v5
v_mfma_f32_16x16x32_bf16 a[64:67], a[180:183], a[192:195], a[64:67]
buffer_load_dwordx4 v1, s[12:15], s48 offen lds
v_and_b32 v5, 65535, v5
v_mfma_f32_16x16x32_bf16 a[68:71], a[180:183], a[196:199], a[68:71]
v_xor_b32 v6, 16, v5
v_xor_b32 v7, 64, v5
v_mfma_f32_16x16x32_bf16 a[72:75], a[180:183], a[200:203], a[72:75]
v_xor_b32 v8, 80, v5
v_xor_b32 v9, 128, v5
v_mfma_f32_16x16x32_bf16 a[76:79], a[180:183], a[204:207], a[76:79]
v_xor_b32 v10, 144, v5
v_xor_b32 v11, 192, v5
v_mfma_f32_16x16x32_bf16 a[80:83], a[180:183], a[208:211], a[80:83]
v_xor_b32 v12, 208, v5
v_mfma_f32_16x16x32_bf16 a[84:87], a[180:183], a[212:215], a[84:87]
s_add_u32 s48, s48, s34
v_mfma_f32_16x16x32_bf16 a[88:91], a[180:183], a[216:219], a[88:91]
s_add_u32 m0, s32, 24576
v_mfma_f32_16x16x32_bf16 a[92:95], a[180:183], a[220:223], a[92:95]
buffer_load_dwordx4 v1, s[12:15], s48 offen lds
ds_read_b128 a[180:183], v3 offset:9216
v_mfma_f32_16x16x32_bf16 a[96:99], a[184:187], a[192:195], a[96:99]
v_mfma_f32_16x16x32_bf16 a[100:103], a[184:187], a[196:199], a[100:103]
v_mfma_f32_16x16x32_bf16 a[104:107], a[184:187], a[200:203], a[104:107]
v_mfma_f32_16x16x32_bf16 a[108:111], a[184:187], a[204:207], a[108:111]
v_mfma_f32_16x16x32_bf16 a[112:115], a[184:187], a[208:211], a[112:115]
s_add_u32 s48, s48, s34
v_mfma_f32_16x16x32_bf16 a[116:119], a[184:187], a[212:215], a[116:119]
s_add_u32 m0, s32, 28672
v_mfma_f32_16x16x32_bf16 a[120:123], a[184:187], a[216:219], a[120:123]
buffer_load_dwordx4 v1, s[12:15], s48 offen lds
v_mfma_f32_16x16x32_bf16 a[124:127], a[184:187], a[220:223], a[124:127]
s_add_u32 s30, s30, 128
ds_read_b128 a[184:187], v4 offset:12288
v_mfma_f32_16x16x32_bf16 a[128:131], a[188:191], a[192:195], a[128:131]
s_add_u32 s32, s32, 32768
v_add_u32 v3, 32768, v3
v_mfma_f32_16x16x32_bf16 a[132:135], a[188:191], a[196:199], a[132:135]
s_sub_u32 s48, s32, 98304
v_subrev_u32 v19, 98304, v3
v_mfma_f32_16x16x32_bf16 a[136:139], a[188:191], a[200:203], a[136:139]
s_cmp_ge_u32 s32, 163840
s_cselect_b32 s32, s48, s32
buffer_load_dword v15, v14, s[96:99], s100 offen
v_mfma_f32_16x16x32_bf16 a[140:143], a[188:191], a[204:207], a[140:143]
s_add_u32 s100, s100, 16384
v_cmp_le_u32 vcc, 163840, v3
v_mfma_f32_16x16x32_bf16 a[144:147], a[188:191], a[208:211], a[144:147]
s_nop 0
v_cndmask_b32 v3, v3, v19, vcc
v_mfma_f32_16x16x32_bf16 a[148:151], a[188:191], a[212:215], a[148:151]
v_xor_b32 v4, 64, v3
v_mfma_f32_16x16x32_bf16 a[152:155], a[188:191], a[216:219], a[152:155]
v_mfma_f32_16x16x32_bf16 a[156:159], a[188:191], a[220:223], a[156:159]
s_cmp_eq_u32 s41, 0
s_cbranch_scc0 L_g_v17v
s_waitcnt vmcnt(18) lgkmcnt(0)
s_barrier
v_mfma_f32_16x16x32_bf16 v[160:163], a[160:163], a[224:227], v[160:163]
ds_read_b128 a[192:195], v3 offset:0
v_mfma_f32_16x16x32_bf16 v[164:167], a[160:163], a[228:231], v[164:167]
v_mfma_f32_16x16x32_bf16 v[168:171], a[160:163], a[232:235], v[168:171]
ds_read_b128 a[196:199], v4 offset:1024
v_mfma_f32_16x16x32_bf16 v[172:175], a[160:163], a[236:239], v[172:175]
s_add_u32 s37, s31, 0
v_mfma_f32_16x16x32_bf16 v[176:179], a[160:163], a[240:243], v[176:179]
s_add_u32 m0, s33, 0
ds_read_b128 a[200:203], v3 offset:4096
v_cvt_pk_bf16_f32 v32, v160, v161
v_cvt_pk_bf16_f32 v33, v162, v163
v_mfma_f32_16x16x32_bf16 v[180:183], a[160:163], a[244:247], v[180:183]
buffer_load_dwordx4 v2, s[20:23], s37 offen  lds
v_cvt_pk_bf16_f32 v36, v164, v165
v_cvt_pk_bf16_f32 v37, v166, v167
v_mfma_f32_16x16x32_bf16 v[184:187], a[160:163], a[248:251], v[184:187]
ds_read_b128 a[204:207], v4 offset:5120
v_cvt_pk_bf16_f32 v40, v168, v169
v_cvt_pk_bf16_f32 v41, v170, v171
v_mfma_f32_16x16x32_bf16 v[188:191], a[160:163], a[252:255], v[188:191]
ds_read_b64_tr_b16 a[160:161], v5 offset:0
v_cvt_pk_bf16_f32 v44, v172, v173
v_cvt_pk_bf16_f32 v45, v174, v175
v_mfma_f32_16x16x32_bf16 v[192:195], a[164:167], a[224:227], v[192:195]
ds_read_b64_tr_b16 a[162:163], v5 offset:1024
v_cvt_pk_bf16_f32 v48, v176, v177
v_cvt_pk_bf16_f32 v49, v178, v179
v_mfma_f32_16x16x32_bf16 v[196:199], a[164:167], a[228:231], v[196:199]
ds_read_b128 a[208:211], v3 offset:8192
v_add_u32 v5, 16384, v5
v_cvt_pk_bf16_f32 v52, v180, v181
v_cvt_pk_bf16_f32 v53, v182, v183
v_mfma_f32_16x16x32_bf16 v[200:203], a[164:167], a[232:235], v[200:203]
s_add_u32 s37, s31, 32768
v_and_b32 v5, 65535, v5
v_cvt_pk_bf16_f32 v56, v184, v185
v_cvt_pk_bf16_f32 v57, v186, v187
v_mfma_f32_16x16x32_bf16 v[204:207], a[164:167], a[236:239], v[204:207]
s_add_u32 m0, s33, 1024
ds_read_b128 a[212:215], v4 offset:9216
v_cvt_pk_bf16_f32 v60, v188, v189
v_cvt_pk_bf16_f32 v61, v190, v191
v_mfma_f32_16x16x32_bf16 v[208:211], a[164:167], a[240:243], v[208:211]
buffer_load_dwordx4 v2, s[20:23], s37 offen  lds
v_cvt_pk_bf16_f32 v34, v192, v193
v_cvt_pk_bf16_f32 v35, v194, v195
v_mfma_f32_16x16x32_bf16 v[212:215], a[164:167], a[244:247], v[212:215]
ds_read_b128 a[216:219], v3 offset:12288
v_cvt_pk_bf16_f32 v38, v196, v197
v_cvt_pk_bf16_f32 v39, v198, v199
v_mfma_f32_16x16x32_bf16 v[216:219], a[164:167], a[248:251], v[216:219]
v_cvt_pk_bf16_f32 v42, v200, v201
v_cvt_pk_bf16_f32 v43, v202, v203
v_mfma_f32_16x16x32_bf16 v[220:223], a[164:167], a[252:255], v[220:223]
ds_read_b64_tr_b16 a[164:165], v6 offset:0
v_cvt_pk_bf16_f32 v46, v204, v205
v_cvt_pk_bf16_f32 v47, v206, v207
v_mfma_f32_16x16x32_bf16 v[224:227], a[168:171], a[224:227], v[224:227]
ds_read_b64_tr_b16 a[166:167], v6 offset:1024
v_cvt_pk_bf16_f32 v50, v208, v209
v_cvt_pk_bf16_f32 v51, v210, v211
v_mfma_f32_16x16x32_bf16 v[228:231], a[168:171], a[228:231], v[228:231]
s_add_u32 s37, s31, 131072
ds_read_b128 a[220:223], v4 offset:13312
v_xor_b32 v6, 16, v5
v_cvt_pk_bf16_f32 v54, v212, v213
v_cvt_pk_bf16_f32 v55, v214, v215
v_mfma_f32_16x16x32_bf16 v[232:235], a[168:171], a[232:235], v[232:235]
s_add_u32 m0, s33, 4096
v_cvt_pk_bf16_f32 v58, v216, v217
v_cvt_pk_bf16_f32 v59, v218, v219
v_mfma_f32_16x16x32_bf16 v[236:239], a[168:171], a[236:239], v[236:239]
buffer_load_dwordx4 v2, s[20:23], s37 offen  lds
v_cvt_pk_bf16_f32 v62, v220, v221
v_cvt_pk_bf16_f32 v63, v222, v223
v_mfma_f32_16x16x32_bf16 v[240:243], a[168:171], a[240:243], v[240:243]
ds_read_b64_tr_b16 a[188:189], v12 offset:0
v_cvt_pk_bf16_f32 v64, v224, v225
v_cvt_pk_bf16_f32 v65, v226, v227
v_mfma_f32_16x16x32_bf16 v[244:247], a[168:171], a[244:247], v[244:247]
v_cvt_pk_bf16_f32 v68, v228, v229
v_cvt_pk_bf16_f32 v69, v230, v231
v_mfma_f32_16x16x32_bf16 v[248:251], a[168:171], a[248:251], v[248:251]
ds_read_b64_tr_b16 a[190:191], v12 offset:1024
v_cvt_pk_bf16_f32 v72, v232, v233
v_cvt_pk_bf16_f32 v73, v234, v235
v_mfma_f32_16x16x32_bf16 v[252:255], a[168:171], a[252:255], v[252:255]
ds_read_b64_tr_b16 a[168:169], v7 offset:0
v_cvt_pk_bf16_f32 v76, v236, v237
v_cvt_pk_bf16_f32 v77, v238, v239
v_mfma_f32_16x16x32_bf16 a[0:3], a[172:175], a[224:227], a[0:3]
s_add_u32 s37, s31, 163840
ds_read_b64_tr_b16 a[170:171], v7 offset:1024
v_cvt_pk_bf16_f32 v80, v240, v241
v_cvt_pk_bf16_f32 v81, v242, v243
v_mfma_f32_16x16x32_bf16 a[4:7], a[172:175], a[228:231], a[4:7]
s_add_u32 m0, s33, 5120
v_xor_b32 v7, 64, v5
v_xor_b32 v12, 208, v5
v_cvt_pk_bf16_f32 v84, v244, v245
v_cvt_pk_bf16_f32 v85, v246, v247
v_mfma_f32_16x16x32_bf16 a[8:11], a[172:175], a[232:235], a[8:11]
buffer_load_dwordx4 v2, s[20:23], s37 offen  lds
v_cvt_pk_bf16_f32 v88, v248, v249
v_cvt_pk_bf16_f32 v89, v250, v251
v_mfma_f32_16x16x32_bf16 a[12:15], a[172:175], a[236:239], a[12:15]
s_add_u32 s31, s31, 262144
v_cvt_pk_bf16_f32 v92, v252, v253
v_cvt_pk_bf16_f32 v93, v254, v255
v_mfma_f32_16x16x32_bf16 a[16:19], a[172:175], a[240:243], a[16:19]
s_add_u32 s33, s33, 16384
v_accvgpr_read_b32 v20, a0
v_accvgpr_read_b32 v21, a1
v_accvgpr_read_b32 v22, a2
v_accvgpr_read_b32 v23, a3
v_mfma_f32_16x16x32_bf16 a[20:23], a[172:175], a[244:247], a[20:23]
s_and_b32 s33, s33, 65535
v_cvt_pk_bf16_f32 v66, v20, v21
v_cvt_pk_bf16_f32 v67, v22, v23
v_accvgpr_read_b32 v24, a4
v_accvgpr_read_b32 v25, a5
v_mfma_f32_16x16x32_bf16 a[24:27], a[172:175], a[248:251], a[24:27]
v_accvgpr_read_b32 v26, a6
v_accvgpr_read_b32 v27, a7
v_cvt_pk_bf16_f32 v70, v24, v25
v_cvt_pk_bf16_f32 v71, v26, v27
v_mfma_f32_16x16x32_bf16 a[28:31], a[172:175], a[252:255], a[28:31]
s_mov_b32 s48, s30
ds_read_b64_tr_b16 a[172:173], v8 offset:0
v_accvgpr_read_b32 v20, a8
v_accvgpr_read_b32 v21, a9
v_accvgpr_read_b32 v22, a10
v_mfma_f32_16x16x32_bf16 a[32:35], a[176:179], a[224:227], a[32:35]
s_add_u32 m0, s32, 0
ds_read_b64_tr_b16 a[174:175], v8 offset:1024
v_mov_b32 v16, 0
v_accvgpr_read_b32 v23, a11
v_cvt_pk_bf16_f32 v74, v20, v21
v_mfma_f32_16x16x32_bf16 a[36:39], a[176:179], a[228:231], a[36:39]
buffer_load_dwordx4 v1, s[12:15], s48 offen lds
v_mov_b32 v17, 1
v_cvt_pk_bf16_f32 v75, v22, v23
v_accvgpr_read_b32 v24, a12
v_mfma_f32_16x16x32_bf16 a[40:43], a[176:179], a[232:235], a[40:43]
s_cmp_eq_u32 s17, 0
s_cselect_b32 s29, s39, 536870912
v_accvgpr_read_b32 v25, a13
v_accvgpr_read_b32 v26, a14
v_mfma_f32_16x16x32_bf16 a[44:47], a[176:179], a[236:239], a[44:47]
s_mov_b64 exec, 1
buffer_store_dword v17, v16, s[8:11], s29 offen sc1
s_mov_b64 exec, -1
v_accvgpr_read_b32 v27, a15
v_mfma_f32_16x16x32_bf16 a[48:51], a[176:179], a[240:243], a[48:51]
v_xor_b32 v8, 80, v5
v_cvt_pk_bf16_f32 v78, v24, v25
v_cvt_pk_bf16_f32 v79, v26, v27
v_accvgpr_read_b32 v20, a16
v_mfma_f32_16x16x32_bf16 a[52:55], a[176:179], a[244:247], a[52:55]
v_accvgpr_read_b32 v21, a17
v_accvgpr_read_b32 v22, a18
v_accvgpr_read_b32 v23, a19
v_cvt_pk_bf16_f32 v82, v20, v21
v_mfma_f32_16x16x32_bf16 a[56:59], a[176:179], a[248:251], a[56:59]
s_add_u32 s48, s48, s34
v_cvt_pk_bf16_f32 v83, v22, v23
v_accvgpr_read_b32 v24, a20
v_accvgpr_read_b32 v25, a21
v_accvgpr_read_b32 v26, a22
v_mfma_f32_16x16x32_bf16 a[60:63], a[176:179], a[252:255], a[60:63]
s_add_u32 m0, s32, 4096
ds_read_b64_tr_b16 a[176:177], v9 offset:0
v_accvgpr_read_b32 v27, a23
v_cvt_pk_bf16_f32 v86, v24, v25
v_cvt_pk_bf16_f32 v87, v26, v27
v_mfma_f32_16x16x32_bf16 a[64:67], a[180:183], a[224:227], a[64:67]
buffer_load_dwordx4 v1, s[12:15], s48 offen lds
ds_read_b64_tr_b16 a[178:179], v9 offset:1024
v_accvgpr_read_b32 v20, a24
v_accvgpr_read_b32 v21, a25
v_mfma_f32_16x16x32_bf16 a[68:71], a[180:183], a[228:231], a[68:71]
v_xor_b32 v9, 128, v5
v_accvgpr_read_b32 v22, a26
v_accvgpr_read_b32 v23, a27
v_cvt_pk_bf16_f32 v90, v20, v21
v_mfma_f32_16x16x32_bf16 a[72:75], a[180:183], a[232:235], a[72:75]
v_cvt_pk_bf16_f32 v91, v22, v23
v_accvgpr_read_b32 v24, a28
v_accvgpr_read_b32 v25, a29
v_accvgpr_read_b32 v26, a30
v_mfma_f32_16x16x32_bf16 a[76:79], a[180:183], a[236:239], a[76:79]
v_accvgpr_read_b32 v27, a31
v_cvt_pk_bf16_f32 v94, v24, v25
v_cvt_pk_bf16_f32 v95, v26, v27
v_accvgpr_read_b32 v20, a32
v_mfma_f32_16x16x32_bf16 a[80:83], a[180:183], a[240:243], a[80:83]
v_accvgpr_read_b32 v21, a33
v_accvgpr_read_b32 v22, a34
v_accvgpr_read_b32 v23, a35
v_cvt_pk_bf16_f32 v96, v20, v21
v_mfma_f32_16x16x32_bf16 a[84:87], a[180:183], a[244:247], a[84:87]
s_add_u32 s48, s48, s34
v_cvt_pk_bf16_f32 v97, v22, v23
v_accvgpr_read_b32 v24, a36
v_accvgpr_read_b32 v25, a37
v_accvgpr_read_b32 v26, a38
v_mfma_f32_16x16x32_bf16 a[88:91], a[180:183], a[248:251], a[88:91]
s_add_u32 m0, s32, 8192
v_accvgpr_read_b32 v27, a39
v_cvt_pk_bf16_f32 v100, v24, v25
v_cvt_pk_bf16_f32 v101, v26, v27
v_accvgpr_read_b32 v20, a40
v_mfma_f32_16x16x32_bf16 a[92:95], a[180:183], a[252:255], a[92:95]
buffer_load_dwordx4 v1, s[12:15], s48 offen lds
ds_read_b64_tr_b16 a[180:181], v10 offset:0
v_accvgpr_read_b32 v21, a41
v_accvgpr_read_b32 v22, a42
v_mfma_f32_16x16x32_bf16 a[96:99], a[184:187], a[224:227], a[96:99]
ds_read_b64_tr_b16 a[182:183], v10 offset:1024
v_accvgpr_read_b32 v23, a43
v_cvt_pk_bf16_f32 v104, v20, v21
v_cvt_pk_bf16_f32 v105, v22, v23
v_mfma_f32_16x16x32_bf16 a[100:103], a[184:187], a[228:231], a[100:103]
v_xor_b32 v10, 144, v5
v_accvgpr_read_b32 v24, a44
v_accvgpr_read_b32 v25, a45
v_accvgpr_read_b32 v26, a46
v_mfma_f32_16x16x32_bf16 a[104:107], a[184:187], a[232:235], a[104:107]
v_accvgpr_read_b32 v27, a47
v_cvt_pk_bf16_f32 v108, v24, v25
v_cvt_pk_bf16_f32 v109, v26, v27
v_accvgpr_read_b32 v20, a48
v_mfma_f32_16x16x32_bf16 a[108:111], a[184:187], a[236:239], a[108:111]
v_accvgpr_read_b32 v21, a49
v_accvgpr_read_b32 v22, a50
v_accvgpr_read_b32 v23, a51
v_cvt_pk_bf16_f32 v112, v20, v21
v_mfma_f32_16x16x32_bf16 a[112:115], a[184:187], a[240:243], a[112:115]
s_add_u32 s48, s48, s34
v_cvt_pk_bf16_f32 v113, v22, v23
v_accvgpr_read_b32 v24, a52
v_accvgpr_read_b32 v25, a53
v_accvgpr_read_b32 v26, a54
v_mfma_f32_16x16x32_bf16 a[116:119], a[184:187], a[244:247], a[116:119]
s_add_u32 m0, s32, 12288
v_accvgpr_read_b32 v27, a55
v_cvt_pk_bf16_f32 v116, v24, v25
v_cvt_pk_bf16_f32 v117, v26, v27
v_accvgpr_read_b32 v20, a56
v_mfma_f32_16x16x32_bf16 a[120:123], a[184:187], a[248:251], a[120:123]
buffer_load_dwordx4 v1, s[12:15], s48 offen lds
v_accvgpr_read_b32 v21, a57
v_accvgpr_read_b32 v22, a58
v_accvgpr_read_b32 v23, a59
v_mfma_f32_16x16x32_bf16 a[124:127], a[184:187], a[252:255], a[124:127]
ds_read_b64_tr_b16 a[184:185], v11 offset:0
v_cvt_pk_bf16_f32 v120, v20, v21
v_cvt_pk_bf16_f32 v121, v22, v23
v_accvgpr_read_b32 v24, a60
v_mfma_f32_16x16x32_bf16 a[128:131], v[28:31], a[224:227], a[128:131]
ds_read_b64_tr_b16 a[186:187], v11 offset:1024
v_accvgpr_read_b32 v25, a61
v_accvgpr_read_b32 v26, a62
v_accvgpr_read_b32 v27, a63
v_mfma_f32_16x16x32_bf16 a[132:135], v[28:31], a[228:231], a[132:135]
v_xor_b32 v11, 192, v5
v_cvt_pk_bf16_f32 v124, v24, v25
v_cvt_pk_bf16_f32 v125, v26, v27
v_mfma_f32_16x16x32_bf16 a[136:139], v[28:31], a[232:235], a[136:139]
buffer_load_dword v15, v14, s[96:99], s100 offen
v_mfma_f32_16x16x32_bf16 a[140:143], v[28:31], a[236:239], a[140:143]
s_add_u32 s100, s100, 16384
v_mfma_f32_16x16x32_bf16 a[144:147], v[28:31], a[240:243], a[144:147]
v_mfma_f32_16x16x32_bf16 a[148:151], v[28:31], a[244:247], a[148:151]
v_mfma_f32_16x16x32_bf16 a[152:155], v[28:31], a[248:251], a[152:155]
v_mfma_f32_16x16x32_bf16 a[156:159], v[28:31], a[252:255], a[156:159]
s_cmp_lt_u32 s35, s45
s_cbranch_scc1 L_g_tile
s_branch L_g_end
L_g_v17v:
s_waitcnt vmcnt(18) lgkmcnt(0)
s_barrier
v_mfma_f32_16x16x32_bf16 v[160:163], a[160:163], a[224:227], v[160:163]
ds_read_b64_tr_b16 a[192:193], v5 offset:0
v_mfma_f32_16x16x32_bf16 v[164:167], a[160:163], a[228:231], v[164:167]
v_mfma_f32_16x16x32_bf16 v[168:171], a[160:163], a[232:235], v[168:171]
ds_read_b64_tr_b16 a[194:195], v5 offset:1024
v_mfma_f32_16x16x32_bf16 v[172:175], a[160:163], a[236:239], v[172:175]
s_add_u32 s37, s31, 0
v_mfma_f32_16x16x32_bf16 v[176:179], a[160:163], a[240:243], v[176:179]
s_add_u32 m0, s33, 0
ds_read_b64_tr_b16 a[196:197], v6 offset:0
v_cvt_pk_bf16_f32 v32, v160, v161
v_cvt_pk_bf16_f32 v33, v162, v163
v_mfma_f32_16x16x32_bf16 v[180:183], a[160:163], a[244:247], v[180:183]
buffer_load_dwordx4 v2, s[20:23], s37 offen  lds
v_cvt_pk_bf16_f32 v36, v164, v165
v_cvt_pk_bf16_f32 v37, v166, v167
v_mfma_f32_16x16x32_bf16 v[184:187], a[160:163], a[248:251], v[184:187]
ds_read_b64_tr_b16 a[198:199], v6 offset:1024
v_cvt_pk_bf16_f32 v40, v168, v169
v_cvt_pk_bf16_f32 v41, v170, v171
v_mfma_f32_16x16x32_bf16 v[188:191], a[160:163], a[252:255], v[188:191]
ds_read_b128 a[160:163], v3 offset:0
v_cvt_pk_bf16_f32 v44, v172, v173
v_cvt_pk_bf16_f32 v45, v174, v175
v_mfma_f32_16x16x32_bf16 v[192:195], a[164:167], a[224:227], v[192:195]
ds_read_b64_tr_b16 a[200:201], v7 offset:0
v_cvt_pk_bf16_f32 v48, v176, v177
v_cvt_pk_bf16_f32 v49, v178, v179
v_mfma_f32_16x16x32_bf16 v[196:199], a[164:167], a[228:231], v[196:199]
v_cvt_pk_bf16_f32 v52, v180, v181
v_cvt_pk_bf16_f32 v53, v182, v183
v_mfma_f32_16x16x32_bf16 v[200:203], a[164:167], a[232:235], v[200:203]
s_add_u32 s37, s31, 32768
ds_read_b64_tr_b16 a[202:203], v7 offset:1024
v_cvt_pk_bf16_f32 v56, v184, v185
v_cvt_pk_bf16_f32 v57, v186, v187
v_mfma_f32_16x16x32_bf16 v[204:207], a[164:167], a[236:239], v[204:207]
s_add_u32 m0, s33, 1024
v_cvt_pk_bf16_f32 v60, v188, v189
v_cvt_pk_bf16_f32 v61, v190, v191
v_mfma_f32_16x16x32_bf16 v[208:211], a[164:167], a[240:243], v[208:211]
buffer_load_dwordx4 v2, s[20:23], s37 offen  lds
v_cvt_pk_bf16_f32 v34, v192, v193
v_cvt_pk_bf16_f32 v35, v194, v195
v_mfma_f32_16x16x32_bf16 v[212:215], a[164:167], a[244:247], v[212:215]
ds_read_b64_tr_b16 a[204:205], v8 offset:0
v_cvt_pk_bf16_f32 v38, v196, v197
v_cvt_pk_bf16_f32 v39, v198, v199
v_mfma_f32_16x16x32_bf16 v[216:219], a[164:167], a[248:251], v[216:219]
v_cvt_pk_bf16_f32 v42, v200, v201
v_cvt_pk_bf16_f32 v43, v202, v203
v_mfma_f32_16x16x32_bf16 v[220:223], a[164:167], a[252:255], v[220:223]
ds_read_b128 a[164:167], v4 offset:1024
v_cvt_pk_bf16_f32 v46, v204, v205
v_cvt_pk_bf16_f32 v47, v206, v207
v_mfma_f32_16x16x32_bf16 v[224:227], a[168:171], a[224:227], v[224:227]
ds_read_b64_tr_b16 a[206:207], v8 offset:1024
v_cvt_pk_bf16_f32 v50, v208, v209
v_cvt_pk_bf16_f32 v51, v210, v211
v_mfma_f32_16x16x32_bf16 v[228:231], a[168:171], a[228:231], v[228:231]
s_add_u32 s37, s31, 131072
v_cvt_pk_bf16_f32 v54, v212, v213
v_cvt_pk_bf16_f32 v55, v214, v215
v_mfma_f32_16x16x32_bf16 v[232:235], a[168:171], a[232:235], v[232:235]
s_add_u32 m0, s33, 4096
ds_read_b64_tr_b16 a[208:209], v9 offset:0
v_cvt_pk_bf16_f32 v58, v216, v217
v_cvt_pk_bf16_f32 v59, v218, v219
v_mfma_f32_16x16x32_bf16 v[236:239], a[168:171], a[236:239], v[236:239]
buffer_load_dwordx4 v2, s[20:23], s37 offen  lds
v_cvt_pk_bf16_f32 v62, v220, v221
v_cvt_pk_bf16_f32 v63, v222, v223
v_mfma_f32_16x16x32_bf16 v[240:243], a[168:171], a[240:243], v[240:243]
ds_read_b64_tr_b16 a[210:211], v9 offset:1024
v_cvt_pk_bf16_f32 v64, v224, v225
v_cvt_pk_bf16_f32 v65, v226, v227
v_mfma_f32_16x16x32_bf16 v[244:247], a[168:171], a[244:247], v[244:247]
v_cvt_pk_bf16_f32 v68, v228, v229
v_cvt_pk_bf16_f32 v69, v230, v231
v_mfma_f32_16x16x32_bf16 v[248:251], a[168:171], a[248:251], v[248:251]
ds_read_b64_tr_b16 a[212:213], v10 offset:0
v_cvt_pk_bf16_f32 v72, v232, v233
v_cvt_pk_bf16_f32 v73, v234, v235
v_mfma_f32_16x16x32_bf16 v[252:255], a[168:171], a[252:255], v[252:255]
ds_read_b128 a[168:171], v3 offset:4096
v_cvt_pk_bf16_f32 v76, v236, v237
v_cvt_pk_bf16_f32 v77, v238, v239
v_mfma_f32_16x16x32_bf16 a[0:3], a[172:175], a[224:227], a[0:3]
s_add_u32 s37, s31, 163840
ds_read_b64_tr_b16 a[214:215], v10 offset:1024
v_cvt_pk_bf16_f32 v80, v240, v241
v_cvt_pk_bf16_f32 v81, v242, v243
v_mfma_f32_16x16x32_bf16 a[4:7], a[172:175], a[228:231], a[4:7]
s_add_u32 m0, s33, 5120
v_cvt_pk_bf16_f32 v84, v244, v245
v_cvt_pk_bf16_f32 v85, v246, v247
v_mfma_f32_16x16x32_bf16 a[8:11], a[172:175], a[232:235], a[8:11]
buffer_load_dwordx4 v2, s[20:23], s37 offen  lds
v_cvt_pk_bf16_f32 v88, v248, v249
v_cvt_pk_bf16_f32 v89, v250, v251
v_mfma_f32_16x16x32_bf16 a[12:15], a[172:175], a[236:239], a[12:15]
s_add_u32 s31, s31, 262144
ds_read_b64_tr_b16 a[216:217], v11 offset:0
v_cvt_pk_bf16_f32 v92, v252, v253
v_cvt_pk_bf16_f32 v93, v254, v255
v_mfma_f32_16x16x32_bf16 a[16:19], a[172:175], a[240:243], a[16:19]
s_add_u32 s33, s33, 16384
v_accvgpr_read_b32 v20, a0
v_accvgpr_read_b32 v21, a1
v_accvgpr_read_b32 v22, a2
v_accvgpr_read_b32 v23, a3
v_mfma_f32_16x16x32_bf16 a[20:23], a[172:175], a[244:247], a[20:23]
s_and_b32 s33, s33, 65535
ds_read_b64_tr_b16 a[218:219], v11 offset:1024
v_cvt_pk_bf16_f32 v66, v20, v21
v_cvt_pk_bf16_f32 v67, v22, v23
v_accvgpr_read_b32 v24, a4
v_mfma_f32_16x16x32_bf16 a[24:27], a[172:175], a[248:251], a[24:27]
v_accvgpr_read_b32 v25, a5
v_accvgpr_read_b32 v26, a6
v_accvgpr_read_b32 v27, a7
v_cvt_pk_bf16_f32 v70, v24, v25
v_mfma_f32_16x16x32_bf16 a[28:31], a[172:175], a[252:255], a[28:31]
s_mov_b32 s48, s30
ds_read_b128 a[172:175], v4 offset:5120
v_cvt_pk_bf16_f32 v71, v26, v27
v_accvgpr_read_b32 v20, a8
v_accvgpr_read_b32 v21, a9
v_mfma_f32_16x16x32_bf16 a[32:35], a[176:179], a[224:227], a[32:35]
s_add_u32 m0, s32, 0
ds_read_b64_tr_b16 a[220:221], v12 offset:0
v_mov_b32 v16, 0
v_accvgpr_read_b32 v22, a10
v_accvgpr_read_b32 v23, a11
v_mfma_f32_16x16x32_bf16 a[36:39], a[176:179], a[228:231], a[36:39]
buffer_load_dwordx4 v1, s[12:15], s48 offen lds
v_mov_b32 v17, 1
v_cvt_pk_bf16_f32 v74, v20, v21
v_cvt_pk_bf16_f32 v75, v22, v23
v_mfma_f32_16x16x32_bf16 a[40:43], a[176:179], a[232:235], a[40:43]
ds_read_b64_tr_b16 a[222:223], v12 offset:1024
v_accvgpr_read_b32 v24, a12
v_accvgpr_read_b32 v25, a13
v_accvgpr_read_b32 v26, a14
v_mfma_f32_16x16x32_bf16 a[44:47], a[176:179], a[236:239], a[44:47]
s_cmp_eq_u32 s17, 0
s_cselect_b32 s29, s39, 536870912
v_accvgpr_read_b32 v27, a15
v_cvt_pk_bf16_f32 v78, v24, v25
v_mfma_f32_16x16x32_bf16 a[48:51], a[176:179], a[240:243], a[48:51]
ds_read_b128 a[188:191], v4 offset:13312
v_cvt_pk_bf16_f32 v79, v26, v27
v_accvgpr_read_b32 v20, a16
v_accvgpr_read_b32 v21, a17
v_mfma_f32_16x16x32_bf16 a[52:55], a[176:179], a[244:247], a[52:55]
s_mov_b64 exec, 1
buffer_store_dword v17, v16, s[8:11], s29 offen sc1
s_mov_b64 exec, -1
v_accvgpr_read_b32 v22, a18
v_mfma_f32_16x16x32_bf16 a[56:59], a[176:179], a[248:251], a[56:59]
s_add_u32 s48, s48, s34
v_accvgpr_read_b32 v23, a19
v_cvt_pk_bf16_f32 v82, v20, v21
v_cvt_pk_bf16_f32 v83, v22, v23
v_accvgpr_read_b32 v24, a20
v_mfma_f32_16x16x32_bf16 a[60:63], a[176:179], a[252:255], a[60:63]
s_add_u32 m0, s32, 4096
ds_read_b128 a[176:179], v3 offset:8192
v_add_u32 v5, 16384, v5
v_accvgpr_read_b32 v25, a21
v_accvgpr_read_b32 v26, a22
v_mfma_f32_16x16x32_bf16 a[64:67], a[180:183], a[224:227], a[64:67]
buffer_load_dwordx4 v1, s[12:15], s48 offen lds
v_and_b32 v5, 65535, v5
v_accvgpr_read_b32 v27, a23
v_cvt_pk_bf16_f32 v86, v24, v25
v_mfma_f32_16x16x32_bf16 a[68:71], a[180:183], a[228:231], a[68:71]
v_xor_b32 v6, 16, v5
v_xor_b32 v7, 64, v5
v_cvt_pk_bf16_f32 v87, v26, v27
v_accvgpr_read_b32 v20, a24
v_mfma_f32_16x16x32_bf16 a[72:75], a[180:183], a[232:235], a[72:75]
v_xor_b32 v8, 80, v5
v_xor_b32 v9, 128, v5
v_accvgpr_read_b32 v21, a25
v_accvgpr_read_b32 v22, a26
v_mfma_f32_16x16x32_bf16 a[76:79], a[180:183], a[236:239], a[76:79]
v_xor_b32 v10, 144, v5
v_xor_b32 v11, 192, v5
v_accvgpr_read_b32 v23, a27
v_cvt_pk_bf16_f32 v90, v20, v21
v_mfma_f32_16x16x32_bf16 a[80:83], a[180:183], a[240:243], a[80:83]
v_xor_b32 v12, 208, v5
v_cvt_pk_bf16_f32 v91, v22, v23
v_accvgpr_read_b32 v24, a28
v_accvgpr_read_b32 v25, a29
v_mfma_f32_16x16x32_bf16 a[84:87], a[180:183], a[244:247], a[84:87]
s_add_u32 s48, s48, s34
v_accvgpr_read_b32 v26, a30
v_accvgpr_read_b32 v27, a31
v_cvt_pk_bf16_f32 v94, v24, v25
v_cvt_pk_bf16_f32 v95, v26, v27
v_mfma_f32_16x16x32_bf16 a[88:91], a[180:183], a[248:251], a[88:91]
s_add_u32 m0, s32, 8192
v_accvgpr_read_b32 v20, a32
v_accvgpr_read_b32 v21, a33
v_accvgpr_read_b32 v22, a34
v_accvgpr_read_b32 v23, a35
v_mfma_f32_16x16x32_bf16 a[92:95], a[180:183], a[252:255], a[92:95]
buffer_load_dwordx4 v1, s[12:15], s48 offen lds
ds_read_b128 a[180:183], v4 offset:9216
v_cvt_pk_bf16_f32 v96, v20, v21
v_cvt_pk_bf16_f32 v97, v22, v23
v_mfma_f32_16x16x32_bf16 a[96:99], a[184:187], a[224:227], a[96:99]
v_accvgpr_read_b32 v24, a36
v_accvgpr_read_b32 v25, a37
v_accvgpr_read_b32 v26, a38
v_accvgpr_read_b32 v27, a39
v_mfma_f32_16x16x32_bf16 a[100:103], a[184:187], a[228:231], a[100:103]
v_cvt_pk_bf16_f32 v100, v24, v25
v_cvt_pk_bf16_f32 v101, v26, v27
v_accvgpr_read_b32 v20, a40
v_accvgpr_read_b32 v21, a41
v_mfma_f32_16x16x32_bf16 a[104:107], a[184:187], a[232:235], a[104:107]
v_accvgpr_read_b32 v22, a42
v_accvgpr_read_b32 v23, a43
v_cvt_pk_bf16_f32 v104, v20, v21
v_cvt_pk_bf16_f32 v105, v22, v23
v_mfma_f32_16x16x32_bf16 a[108:111], a[184:187], a[236:239], a[108:111]
v_accvgpr_read_b32 v24, a44
v_accvgpr_read_b32 v25, a45
v_accvgpr_read_b32 v26, a46
v_accvgpr_read_b32 v27, a47
v_mfma_f32_16x16x32_bf16 a[112:115], a[184:187], a[240:243], a[112:115]
s_add_u32 s48, s48, s34
v_cvt_pk_bf16_f32 v108, v24, v25
v_cvt_pk_bf16_f32 v109, v26, v27
v_accvgpr_read_b32 v20, a48
v_accvgpr_read_b32 v21, a49
v_mfma_f32_16x16x32_bf16 a[116:119], a[184:187], a[244:247], a[116:119]
s_add_u32 m0, s32, 12288
v_accvgpr_read_b32 v22, a50
v_accvgpr_read_b32 v23, a51
v_cvt_pk_bf16_f32 v112, v20, v21
v_cvt_pk_bf16_f32 v113, v22, v23
v_mfma_f32_16x16x32_bf16 a[120:123], a[184:187], a[248:251], a[120:123]
buffer_load_dwordx4 v1, s[12:15], s48 offen lds
v_accvgpr_read_b32 v24, a52
v_accvgpr_read_b32 v25, a53
v_accvgpr_read_b32 v26, a54
v_mfma_f32_16x16x32_bf16 a[124:127], a[184:187], a[252:255], a[124:127]
ds_read_b128 a[184:187], v3 offset:12288
v_accvgpr_read_b32 v27, a55
v_cvt_pk_bf16_f32 v116, v24, v25
v_cvt_pk_bf16_f32 v117, v26, v27
v_mfma_f32_16x16x32_bf16 a[128:131], v[28:31], a[224:227], a[128:131]
v_accvgpr_read_b32 v20, a56
v_accvgpr_read_b32 v21, a57
v_accvgpr_read_b32 v22, a58
v_accvgpr_read_b32 v23, a59
v_mfma_f32_16x16x32_bf16 a[132:135], v[28:31], a[228:231], a[132:135]
v_cvt_pk_bf16_f32 v120, v20, v21
v_cvt_pk_bf16_f32 v121, v22, v23
v_accvgpr_read_b32 v24, a60
v_accvgpr_read_b32 v25, a61
v_mfma_f32_16x16x32_bf16 a[136:139], v[28:31], a[232:235], a[136:139]
buffer_load_dword v15, v14, s[96:99], s100 offen
v_accvgpr_read_b32 v26, a62
v_accvgpr_read_b32 v27, a63
v_cvt_pk_bf16_f32 v124, v24, v25
v_mfma_f32_16x16x32_bf16 a[140:143], v[28:31], a[236:239], a[140:143]
s_add_u32 s100, s100, 16384
v_cvt_pk_bf16_f32 v125, v26, v27
v_mfma_f32_16x16x32_bf16 a[144:147], v[28:31], a[240:243], a[144:147]
v_mfma_f32_16x16x32_bf16 a[148:151], v[28:31], a[244:247], a[148:151]
v_mfma_f32_16x16x32_bf16 a[152:155], v[28:31], a[248:251], a[152:155]
v_mfma_f32_16x16x32_bf16 a[156:159], v[28:31], a[252:255], a[156:159]
s_cmp_lt_u32 s35, s45
s_cbranch_scc1 L_g_tile
s_branch L_g_end
L_g_first:
s_mov_b32 s100, 536870912
s_cmp_eq_u32 s95, 0
s_cbranch_scc0 L_g_end
v_mov_b32 v20, 128
s_mov_b32 s28, 0
L_poll_8:
buffer_load_dword v21, v20, s[56:59], 0 offen sc1
s_add_u32 s28, s28, 1
s_cmp_gt_u32 s28, 200000
s_cbranch_scc1 L_end
s_waitcnt vmcnt(0)
v_cmp_ne_u32 vcc, 8, v21
s_cbranch_vccz L_pd_9
s_sleep 1
s_branch L_poll_8
L_pd_9:
s_branch L_g_go
L_g_end:
s_cmp_eq_u32 s61, 0
s_cbranch_scc1 L_att
v_bfe_u32 v16, v0, 3, 3
v_lshlrev_b32 v16, 4, v16
v_and_or_b32 v16, v0, 7, v16
v_bfe_u32 v17, v0, 4, 2
v_lshlrev_b32 v17, 5, v17
v_bfe_u32 v18, v0, 1, 3
v_or_b32 v17, v17, v18
v_and_b32 v18, 1, v0
v_lshl_or_b32 v17, v18, 4, v17
s_bitcmp1_b32 s50, 1
s_cselect_b64 vcc, -1, 0
s_movk_i32 s44, 0x80
v_cndmask_b32 v16, v16, v17, vcc
v_lshlrev_b32 v13, 4, v16
s_lshr_b32 s93, s50, 2
s_lshr_b32 s93, 0x80000, s93
s_bitcmp1_b32 s50, 0
s_cselect_b32 s92, s93, 0x800
s_cselect_b32 s93, 0x800, s93
s_sub_u32 s93, s93, s44
s_and_b32 s24, s17, s91
s_cbranch_scc0 L_g_h1
s_barrier
L_g_h1:
v_cvt_pk_bf16_f32 v32, v160, v161
v_cvt_pk_bf16_f32 v33, v162, v163
v_cvt_pk_bf16_f32 v34, v192, v193
v_cvt_pk_bf16_f32 v35, v194, v195
s_mov_b32 s60, s62
s_mov_b32 s29, s62
buffer_store_dwordx4 v[32:35], v13, s[8:11], s29 offen sc1
v_cvt_pk_bf16_f32 v36, v164, v165
v_cvt_pk_bf16_f32 v37, v166, v167
v_cvt_pk_bf16_f32 v38, v196, v197
v_cvt_pk_bf16_f32 v39, v198, v199
s_add_u32 s29, s29, s44
buffer_store_dwordx4 v[36:39], v13, s[8:11], s29 offen sc1
v_cvt_pk_bf16_f32 v40, v168, v169
v_cvt_pk_bf16_f32 v41, v170, v171
v_cvt_pk_bf16_f32 v42, v200, v201
v_cvt_pk_bf16_f32 v43, v202, v203
s_add_u32 s29, s29, s93
buffer_store_dwordx4 v[40:43], v13, s[8:11], s29 offen sc1
v_cvt_pk_bf16_f32 v44, v172, v173
v_cvt_pk_bf16_f32 v45, v174, v175
v_cvt_pk_bf16_f32 v46, v204, v205
v_cvt_pk_bf16_f32 v47, v206, v207
s_add_u32 s29, s29, s44
buffer_store_dwordx4 v[44:47], v13, s[8:11], s29 offen sc1
v_cvt_pk_bf16_f32 v48, v176, v177
v_cvt_pk_bf16_f32 v49, v178, v179
v_cvt_pk_bf16_f32 v50, v208, v209
v_cvt_pk_bf16_f32 v51, v210, v211
s_add_u32 s29, s29, s93
buffer_store_dwordx4 v[48:51], v13, s[8:11], s29 offen sc1
v_cvt_pk_bf16_f32 v52, v180, v181
v_cvt_pk_bf16_f32 v53, v182, v183
v_cvt_pk_bf16_f32 v54, v212, v213
v_cvt_pk_bf16_f32 v55, v214, v215
s_add_u32 s29, s29, s44
buffer_store_dwordx4 v[52:55], v13, s[8:11], s29 offen sc1
v_cvt_pk_bf16_f32 v56, v184, v185
v_cvt_pk_bf16_f32 v57, v186, v187
v_cvt_pk_bf16_f32 v58, v216, v217
v_cvt_pk_bf16_f32 v59, v218, v219
s_add_u32 s29, s29, s93
buffer_store_dwordx4 v[56:59], v13, s[8:11], s29 offen sc1
v_cvt_pk_bf16_f32 v60, v188, v189
v_cvt_pk_bf16_f32 v61, v190, v191
v_cvt_pk_bf16_f32 v62, v220, v221
v_cvt_pk_bf16_f32 v63, v222, v223
s_add_u32 s29, s29, s44
buffer_store_dwordx4 v[60:63], v13, s[8:11], s29 offen sc1
v_cvt_pk_bf16_f32 v64, v224, v225
v_cvt_pk_bf16_f32 v65, v226, v227
v_accvgpr_read_b32 v20, a0
v_accvgpr_read_b32 v21, a1
v_accvgpr_read_b32 v22, a2
v_accvgpr_read_b32 v23, a3
v_cvt_pk_bf16_f32 v66, v20, v21
v_cvt_pk_bf16_f32 v67, v22, v23
s_add_u32 s60, s60, s92
s_mov_b32 s29, s60
buffer_store_dwordx4 v[64:67], v13, s[8:11], s29 offen sc1
v_cvt_pk_bf16_f32 v68, v228, v229
v_cvt_pk_bf16_f32 v69, v230, v231
v_accvgpr_read_b32 v24, a4
v_accvgpr_read_b32 v25, a5
v_accvgpr_read_b32 v26, a6
v_accvgpr_read_b32 v27, a7
v_cvt_pk_bf16_f32 v70, v24, v25
v_cvt_pk_bf16_f32 v71, v26, v27
s_add_u32 s29, s29, s44
buffer_store_dwordx4 v[68:71], v13, s[8:11], s29 offen sc1
v_cvt_pk_bf16_f32 v72, v232, v233
v_cvt_pk_bf16_f32 v73, v234, v235
v_accvgpr_read_b32 v20, a8
v_accvgpr_read_b32 v21, a9
v_accvgpr_read_b32 v22, a10
v_accvgpr_read_b32 v23, a11
v_cvt_pk_bf16_f32 v74, v20, v21
v_cvt_pk_bf16_f32 v75, v22, v23
s_add_u32 s29, s29, s93
buffer_store_dwordx4 v[72:75], v13, s[8:11], s29 offen sc1
v_cvt_pk_bf16_f32 v76, v236, v237
v_cvt_pk_bf16_f32 v77, v238, v239
v_accvgpr_read_b32 v24, a12
v_accvgpr_read_b32 v25, a13
v_accvgpr_read_b32 v26, a14
v_accvgpr_read_b32 v27, a15
v_cvt_pk_bf16_f32 v78, v24, v25
v_cvt_pk_bf16_f32 v79, v26, v27
s_add_u32 s29, s29, s44
buffer_store_dwordx4 v[76:79], v13, s[8:11], s29 offen sc1
v_cvt_pk_bf16_f32 v80, v240, v241
v_cvt_pk_bf16_f32 v81, v242, v243
v_accvgpr_read_b32 v20, a16
v_accvgpr_read_b32 v21, a17
v_accvgpr_read_b32 v22, a18
v_accvgpr_read_b32 v23, a19
v_cvt_pk_bf16_f32 v82, v20, v21
v_cvt_pk_bf16_f32 v83, v22, v23
s_add_u32 s29, s29, s93
buffer_store_dwordx4 v[80:83], v13, s[8:11], s29 offen sc1
v_cvt_pk_bf16_f32 v84, v244, v245
v_cvt_pk_bf16_f32 v85, v246, v247
v_accvgpr_read_b32 v24, a20
v_accvgpr_read_b32 v25, a21
v_accvgpr_read_b32 v26, a22
v_accvgpr_read_b32 v27, a23
v_cvt_pk_bf16_f32 v86, v24, v25
v_cvt_pk_bf16_f32 v87, v26, v27
s_add_u32 s29, s29, s44
buffer_store_dwordx4 v[84:87], v13, s[8:11], s29 offen sc1
v_cvt_pk_bf16_f32 v88, v248, v249
v_cvt_pk_bf16_f32 v89, v250, v251
v_accvgpr_read_b32 v20, a24
v_accvgpr_read_b32 v21, a25
v_accvgpr_read_b32 v22, a26
v_accvgpr_read_b32 v23, a27
v_cvt_pk_bf16_f32 v90, v20, v21
v_cvt_pk_bf16_f32 v91, v22, v23
s_add_u32 s29, s29, s93
buffer_store_dwordx4 v[88:91], v13, s[8:11], s29 offen sc1
v_cvt_pk_bf16_f32 v92, v252, v253
v_cvt_pk_bf16_f32 v93, v254, v255
v_accvgpr_read_b32 v24, a28
v_accvgpr_read_b32 v25, a29
v_accvgpr_read_b32 v26, a30
v_accvgpr_read_b32 v27, a31
v_cvt_pk_bf16_f32 v94, v24, v25
v_cvt_pk_bf16_f32 v95, v26, v27
s_add_u32 s29, s29, s44
buffer_store_dwordx4 v[92:95], v13, s[8:11], s29 offen sc1
v_accvgpr_read_b32 v20, a32
v_accvgpr_read_b32 v21, a33
v_accvgpr_read_b32 v22, a34
v_accvgpr_read_b32 v23, a35
v_cvt_pk_bf16_f32 v96, v20, v21
v_cvt_pk_bf16_f32 v97, v22, v23
v_accvgpr_read_b32 v20, a64
v_accvgpr_read_b32 v21, a65
v_accvgpr_read_b32 v22, a66
v_accvgpr_read_b32 v23, a67
v_cvt_pk_bf16_f32 v98, v20, v21
v_cvt_pk_bf16_f32 v99, v22, v23
s_add_u32 s60, s60, s92
s_mov_b32 s29, s60
buffer_store_dwordx4 v[96:99], v13, s[8:11], s29 offen sc1
v_accvgpr_read_b32 v24, a36
v_accvgpr_read_b32 v25, a37
v_accvgpr_read_b32 v26, a38
v_accvgpr_read_b32 v27, a39
v_cvt_pk_bf16_f32 v100, v24, v25
v_cvt_pk_bf16_f32 v101, v26, v27
v_accvgpr_read_b32 v24, a68
v_accvgpr_read_b32 v25, a69
v_accvgpr_read_b32 v26, a70
v_accvgpr_read_b32 v27, a71
v_cvt_pk_bf16_f32 v102, v24, v25
v_cvt_pk_bf16_f32 v103, v26, v27
s_add_u32 s29, s29, s44
buffer_store_dwordx4 v[100:103], v13, s[8:11], s29 offen sc1
v_accvgpr_read_b32 v20, a40
v_accvgpr_read_b32 v21, a41
v_accvgpr_read_b32 v22, a42
v_accvgpr_read_b32 v23, a43
v_cvt_pk_bf16_f32 v104, v20, v21
v_cvt_pk_bf16_f32 v105, v22, v23
v_accvgpr_read_b32 v20, a72
v_accvgpr_read_b32 v21, a73
v_accvgpr_read_b32 v22, a74
v_accvgpr_read_b32 v23, a75
v_cvt_pk_bf16_f32 v106, v20, v21
v_cvt_pk_bf16_f32 v107, v22, v23
s_add_u32 s29, s29, s93
buffer_store_dwordx4 v[104:107], v13, s[8:11], s29 offen sc1
v_accvgpr_read_b32 v24, a44
v_accvgpr_read_b32 v25, a45
v_accvgpr_read_b32 v26, a46
v_accvgpr_read_b32 v27, a47
v_cvt_pk_bf16_f32 v108, v24, v25
v_cvt_pk_bf16_f32 v109, v26, v27
v_accvgpr_read_b32 v24, a76
v_accvgpr_read_b32 v25, a77
v_accvgpr_read_b32 v26, a78
v_accvgpr_read_b32 v27, a79
v_cvt_pk_bf16_f32 v110, v24, v25
v_cvt_pk_bf16_f32 v111, v26, v27
s_add_u32 s29, s29, s44
buffer_store_dwordx4 v[108:111], v13, s[8:11], s29 offen sc1
v_accvgpr_read_b32 v20, a48
v_accvgpr_read_b32 v21, a49
v_accvgpr_read_b32 v22, a50
v_accvgpr_read_b32 v23, a51
v_cvt_pk_bf16_f32 v112, v20, v21
v_cvt_pk_bf16_f32 v113, v22, v23
v_accvgpr_read_b32 v20, a80
v_accvgpr_read_b32 v21, a81
v_accvgpr_read_b32 v22, a82
v_accvgpr_read_b32 v23, a83
v_cvt_pk_bf16_f32 v114, v20, v21
v_cvt_pk_bf16_f32 v115, v22, v23
s_add_u32 s29, s29, s93
buffer_store_dwordx4 v[112:115], v13, s[8:11], s29 offen sc1
v_accvgpr_read_b32 v24, a52
v_accvgpr_read_b32 v25, a53
v_accvgpr_read_b32 v26, a54
v_accvgpr_read_b32 v27, a55
v_cvt_pk_bf16_f32 v116, v24, v25
v_cvt_pk_bf16_f32 v117, v26, v27
v_accvgpr_read_b32 v24, a84
v_accvgpr_read_b32 v25, a85
v_accvgpr_read_b32 v26, a86
v_accvgpr_read_b32 v27, a87
v_cvt_pk_bf16_f32 v118, v24, v25
v_cvt_pk_bf16_f32 v119, v26, v27
s_add_u32 s29, s29, s44
buffer_store_dwordx4 v[116:119], v13, s[8:11], s29 offen sc1
v_accvgpr_read_b32 v20, a56
v_accvgpr_read_b32 v21, a57
v_accvgpr_read_b32 v22, a58
v_accvgpr_read_b32 v23, a59
v_cvt_pk_bf16_f32 v120, v20, v21
v_cvt_pk_bf16_f32 v121, v22, v23
v_accvgpr_read_b32 v20, a88
v_accvgpr_read_b32 v21, a89
v_accvgpr_read_b32 v22, a90
v_accvgpr_read_b32 v23, a91
v_cvt_pk_bf16_f32 v122, v20, v21
v_cvt_pk_bf16_f32 v123, v22, v23
s_add_u32 s29, s29, s93
buffer_store_dwordx4 v[120:123], v13, s[8:11], s29 offen sc1
v_accvgpr_read_b32 v24, a60
v_accvgpr_read_b32 v25, a61
v_accvgpr_read_b32 v26, a62
v_accvgpr_read_b32 v27, a63
v_cvt_pk_bf16_f32 v124, v24, v25
v_cvt_pk_bf16_f32 v125, v26, v27
v_accvgpr_read_b32 v24, a92
v_accvgpr_read_b32 v25, a93
v_accvgpr_read_b32 v26, a94
v_accvgpr_read_b32 v27, a95
v_cvt_pk_bf16_f32 v126, v24, v25
v_cvt_pk_bf16_f32 v127, v26, v27
s_add_u32 s29, s29, s44
buffer_store_dwordx4 v[124:127], v13, s[8:11], s29 offen sc1
v_accvgpr_read_b32 v20, a96
v_accvgpr_read_b32 v21, a97
v_accvgpr_read_b32 v22, a98
v_accvgpr_read_b32 v23, a99
v_cvt_pk_bf16_f32 v128, v20, v21
v_cvt_pk_bf16_f32 v129, v22, v23
v_accvgpr_read_b32 v20, a128
v_accvgpr_read_b32 v21, a129
v_accvgpr_read_b32 v22, a130
v_accvgpr_read_b32 v23, a131
v_cvt_pk_bf16_f32 v130, v20, v21
v_cvt_pk_bf16_f32 v131, v22, v23
s_add_u32 s60, s60, s92
s_mov_b32 s29, s60
buffer_store_dwordx4 v[128:131], v13, s[8:11], s29 offen sc1
v_accvgpr_read_b32 v24, a100
v_accvgpr_read_b32 v25, a101
v_accvgpr_read_b32 v26, a102
v_accvgpr_read_b32 v27, a103
v_cvt_pk_bf16_f32 v132, v24, v25
v_cvt_pk_bf16_f32 v133, v26, v27
v_accvgpr_read_b32 v24, a132
v_accvgpr_read_b32 v25, a133
v_accvgpr_read_b32 v26, a134
v_accvgpr_read_b32 v27, a135
v_cvt_pk_bf16_f32 v134, v24, v25
v_cvt_pk_bf16_f32 v135, v26, v27
s_add_u32 s29, s29, s44
buffer_store_dwordx4 v[132:135], v13, s[8:11], s29 offen sc1
v_accvgpr_read_b32 v20, a104
v_accvgpr_read_b32 v21, a105
v_accvgpr_read_b32 v22, a106
v_accvgpr_read_b32 v23, a107
v_cvt_pk_bf16_f32 v136, v20, v21
v_cvt_pk_bf16_f32 v137, v22, v23
v_accvgpr_read_b32 v20, a136
v_accvgpr_read_b32 v21, a137
v_accvgpr_read_b32 v22, a138
v_accvgpr_read_b32 v23, a139
v_cvt_pk_bf16_f32 v138, v20, v21
v_cvt_pk_bf16_f32 v139, v22, v23
s_add_u32 s29, s29, s93
buffer_store_dwordx4 v[136:139], v13, s[8:11], s29 offen sc1
v_accvgpr_read_b32 v24, a108
v_accvgpr_read_b32 v25, a109
v_accvgpr_read_b32 v26, a110
v_accvgpr_read_b32 v27, a111
v_cvt_pk_bf16_f32 v140, v24, v25
v_cvt_pk_bf16_f32 v141, v26, v27
v_accvgpr_read_b32 v24, a140
v_accvgpr_read_b32 v25, a141
v_accvgpr_read_b32 v26, a142
v_accvgpr_read_b32 v27, a143
v_cvt_pk_bf16_f32 v142, v24, v25
v_cvt_pk_bf16_f32 v143, v26, v27
s_add_u32 s29, s29, s44
buffer_store_dwordx4 v[140:143], v13, s[8:11], s29 offen sc1
v_accvgpr_read_b32 v20, a112
v_accvgpr_read_b32 v21, a113
v_accvgpr_read_b32 v22, a114
v_accvgpr_read_b32 v23, a115
v_cvt_pk_bf16_f32 v144, v20, v21
v_cvt_pk_bf16_f32 v145, v22, v23
v_accvgpr_read_b32 v20, a144
v_accvgpr_read_b32 v21, a145
v_accvgpr_read_b32 v22, a146
v_accvgpr_read_b32 v23, a147
v_cvt_pk_bf16_f32 v146, v20, v21
v_cvt_pk_bf16_f32 v147, v22, v23
s_add_u32 s29, s29, s93
buffer_store_dwordx4 v[144:147], v13, s[8:11], s29 offen sc1
v_accvgpr_read_b32 v24, a116
v_accvgpr_read_b32 v25, a117
v_accvgpr_read_b32 v26, a118
v_accvgpr_read_b32 v27, a119
v_cvt_pk_bf16_f32 v148, v24, v25
v_cvt_pk_bf16_f32 v149, v26, v27
v_accvgpr_read_b32 v24, a148
v_accvgpr_read_b32 v25, a149
v_accvgpr_read_b32 v26, a150
v_accvgpr_read_b32 v27, a151
v_cvt_pk_bf16_f32 v150, v24, v25
v_cvt_pk_bf16_f32 v151, v26, v27
s_add_u32 s29, s29, s44
buffer_store_dwordx4 v[148:151], v13, s[8:11], s29 offen sc1
v_accvgpr_read_b32 v20, a120
v_accvgpr_read_b32 v21, a121
v_accvgpr_read_b32 v22, a122
v_accvgpr_read_b32 v23, a123
v_cvt_pk_bf16_f32 v152, v20, v21
v_cvt_pk_bf16_f32 v153, v22, v23
v_accvgpr_read_b32 v20, a152
v_accvgpr_read_b32 v21, a153
v_accvgpr_read_b32 v22, a154
v_accvgpr_read_b32 v23, a155
v_cvt_pk_bf16_f32 v154, v20, v21
v_cvt_pk_bf16_f32 v155, v22, v23
s_add_u32 s29, s29, s93
buffer_store_dwordx4 v[152:155], v13, s[8:11], s29 offen sc1
v_accvgpr_read_b32 v24, a124
v_accvgpr_read_b32 v25, a125
v_accvgpr_read_b32 v26, a126
v_accvgpr_read_b32 v27, a127
v_cvt_pk_bf16_f32 v156, v24, v25
v_cvt_pk_bf16_f32 v157, v26, v27
v_accvgpr_read_b32 v24, a156
v_accvgpr_read_b32 v25, a157
v_accvgpr_read_b32 v26, a158
v_accvgpr_read_b32 v27, a159
v_cvt_pk_bf16_f32 v158, v24, v25
v_cvt_pk_bf16_f32 v159, v26, v27
s_add_u32 s29, s29, s44
buffer_store_dwordx4 v[156:159], v13, s[8:11], s29 offen sc1
v_mov_b32 v20, 128
s_mov_b32 s28, 0
L_poll_10:
buffer_load_dword v21, v20, s[56:59], 0 offen sc1
s_add_u32 s28, s28, 1
s_cmp_gt_u32 s28, 200000
s_cbranch_scc1 L_end
s_waitcnt vmcnt(0)
v_cmp_ne_u32 vcc, 8, v21
s_cbranch_vccz L_pd_11
s_sleep 1
s_branch L_poll_10
L_pd_11:
s_andn2_b32 s24, s91, s17
s_cbranch_scc0 L_g_h2
s_barrier
s_add_u32 s60, s63, 32
v_mov_b32 v16, 0
v_mov_b32 v17, 1
s_cmp_eq_u32 s17, 0
s_cselect_b32 s29, s60, 536870912
s_mov_b64 exec, 1
buffer_store_dword v17, v16, s[8:11], s29 offen sc1
s_mov_b64 exec, -1
L_g_h2:
s_waitcnt vmcnt(0) lgkmcnt(0)
s_barrier
v_mov_b32 v16, 0
v_mov_b32 v17, 1
s_cmp_eq_u32 s17, 0
s_cselect_b32 s29, s63, 536870912
s_mov_b64 exec, 1
buffer_store_dword v17, v16, s[8:11], s29 offen sc1
s_mov_b64 exec, -1
s_mov_b32 s62, 536870912
s_mov_b32 s63, 536870912
s_cmp_lt_u32 s35, s45
s_cbranch_scc1 L_g_go
s_cmp_eq_u32 s3, 1
s_cbranch_scc1 L_part
s_branch L_bdie
L_att:
s_mov_b32 s96, s62
s_mov_b32 s60, s63
s_mov_b32 s42, s89
s_bfe_u32 s41, s88, 0x30008
s_sub_u32 s63, 7, s41
s_mov_b32 s40, 0x3e0293ee
s_mov_b32 s50, 0xf149f2ca
s_mov_b32 s51, 0x41a00000
s_waitcnt lgkmcnt(0)
v_and_b32 v6, 63, v0
v_lshlrev_b32 v6, 4, v6
v_and_b32 v16, 0x380, v6
s_and_b32 s24, s17, 1
s_lshl_b32 s24, s24, 13
s_lshr_b32 s25, s17, 1
s_lshl_b32 s25, s25, 19
s_add_u32 s24, s24, s25
v_add3_u32 v1, v6, v16, s24
v_and_b32 v16, 0x300, v6
s_and_b32 s24, s17, 1
s_lshl_b32 s24, s24, 8
s_lshr_b32 s25, s17, 1
s_lshl_b32 s25, s25, 18
s_add_u32 s24, s24, s25
v_add3_u32 v7, v6, v16, s24
v_and_b32 v5, 15, v0
s_lshl_b32 s24, s17, 4
v_add_u32 v5, s24, v5
v_bfe_u32 v16, v0, 5, 1
v_lshlrev_b32 v16, 4, v16
v_sub_u32 v5, v5, v16
v_bfe_u32 v16, v0, 4, 1
v_lshlrev_b32 v16, 2, v16
v_sub_u32 v5, v5, v16
v_mov_b32 v8, s50
v_mov_b32 v16, 0x3f803f80
v_accvgpr_write_b32 a240, v16
v_accvgpr_write_b32 a241, v16
v_accvgpr_write_b32 a242, v16
v_accvgpr_write_b32 a243, v16
v_cmp_le_i32 s[64:65], 0, v5
v_cmp_le_i32 s[66:67], 1, v5
v_cmp_le_i32 s[68:69], 2, v5
v_cmp_le_i32 s[70:71], 3, v5
v_cmp_le_i32 s[72:73], 8, v5
v_cmp_le_i32 s[74:75], 9, v5
v_cmp_le_i32 s[76:77], 10, v5
v_cmp_le_i32 s[78:79], 11, v5
v_cmp_le_i32 s[80:81], 32, v5
v_cmp_le_i32 s[82:83], 33, v5
v_cmp_le_i32 s[84:85], 34, v5
v_cmp_le_i32 s[86:87], 35, v5
v_cmp_le_i32 s[88:89], 40, v5
v_cmp_le_i32 s[90:91], 41, v5
v_cmp_le_i32 s[92:93], 42, v5
v_cmp_le_i32 s[94:95], 43, v5
s_lshl_b32 s47, s17, 13
s_mov_b32 s48, 0
s_cmp_eq_u32 s17, 0
s_cselect_b32 s60, s60, 536870912
v_and_b32 v20, 3, v0
v_lshlrev_b32 v20, 2, v20
s_lshl_b32 s25, s42, 7
s_add_u32 s25, s25, 111165440
s_mov_b32 s28, 0
L_poll_12:
buffer_load_dword v21, v20, s[8:11], s25 offen sc1
s_add_u32 s28, s28, 1
s_cmp_gt_u32 s28, 200000
s_cbranch_scc1 L_end
s_waitcnt vmcnt(0)
v_cmp_ne_u32 vcc, 1, v21
s_cbranch_vccz L_pd_13
s_sleep 1
s_branch L_poll_12
L_pd_13:
s_waitcnt lgkmcnt(0)
s_barrier
s_lshl_b32 s46, s42, 14
s_add_u32 s46, s46, 0
s_cmp_lt_u32 s63, 8
s_cselect_b32 s46, s46, 536870912
s_add_u32 s24, s46, 4096
s_add_u32 m0, s47, 0
s_nop 0
buffer_load_dwordx4 v1, s[8:11], s46 offen sc1 lds
buffer_load_dwordx4 v1, s[8:11], s46 offen offset:2048 sc1 lds
s_add_u32 m0, s47, 896
s_nop 0
buffer_load_dwordx4 v1, s[8:11], s46 offen offset:128 sc1 lds
buffer_load_dwordx4 v1, s[8:11], s46 offen offset:2176 sc1 lds
s_add_u32 m0, s47, 4096
s_nop 0
buffer_load_dwordx4 v1, s[8:11], s24 offen sc1 lds
buffer_load_dwordx4 v1, s[8:11], s24 offen offset:2048 sc1 lds
s_add_u32 m0, s47, 4992
s_nop 0
buffer_load_dwordx4 v1, s[8:11], s24 offen offset:128 sc1 lds
buffer_load_dwordx4 v1, s[8:11], s24 offen offset:2176 sc1 lds
s_add_u32 s46, s46, 1048576
s_add_u32 s47, s47, 32768
s_and_b32 s47, s47, 131071
s_add_u32 s24, s46, 4096
s_add_u32 m0, s47, 0
s_nop 0
buffer_load_dwordx4 v1, s[8:11], s46 offen sc1 lds
buffer_load_dwordx4 v1, s[8:11], s46 offen offset:2048 sc1 lds
s_add_u32 m0, s47, 896
s_nop 0
buffer_load_dwordx4 v1, s[8:11], s46 offen offset:128 sc1 lds
buffer_load_dwordx4 v1, s[8:11], s46 offen offset:2176 sc1 lds
s_add_u32 m0, s47, 4096
s_nop 0
buffer_load_dwordx4 v1, s[8:11], s24 offen sc1 lds
buffer_load_dwordx4 v1, s[8:11], s24 offen offset:2048 sc1 lds
s_add_u32 m0, s47, 4992
s_nop 0
buffer_load_dwordx4 v1, s[8:11], s24 offen offset:128 sc1 lds
buffer_load_dwordx4 v1, s[8:11], s24 offen offset:2176 sc1 lds
s_add_u32 s46, s46, 1048576
s_add_u32 s47, s47, 32768
s_and_b32 s47, s47, 131071
s_add_u32 s24, s46, 4096
s_add_u32 m0, s47, 0
s_nop 0
buffer_load_dwordx4 v1, s[8:11], s46 offen sc1 lds
buffer_load_dwordx4 v1, s[8:11], s46 offen offset:2048 sc1 lds
s_add_u32 m0, s47, 896
s_nop 0
buffer_load_dwordx4 v1, s[8:11], s46 offen offset:128 sc1 lds
buffer_load_dwordx4 v1, s[8:11], s46 offen offset:2176 sc1 lds
s_add_u32 m0, s47, 4096
s_nop 0
buffer_load_dwordx4 v1, s[8:11], s24 offen sc1 lds
buffer_load_dwordx4 v1, s[8:11], s24 offen offset:2048 sc1 lds
s_add_u32 m0, s47, 4992
s_nop 0
buffer_load_dwordx4 v1, s[8:11], s24 offen offset:128 sc1 lds
buffer_load_dwordx4 v1, s[8:11], s24 offen offset:2176 sc1 lds
s_add_u32 s46, s46, 1048576
s_add_u32 s47, s47, 32768
s_and_b32 s47, s47, 131071
v_and_b32 v13, 0x380, v6
v_add_u32 v13, v13, v6
s_lshr_b32 s24, s17, 1
s_xor_b32 s24, s24, s42
s_bitcmp1_b32 s24, 0
s_cbranch_scc1 L_at_qg
s_and_b32 s24, s17, 1
s_lshl_b32 s24, s24, 15
s_add_u32 s24, s24, 98304
v_add_u32 v13, s24, v13
v_pk_mul_f32 v[20:21], v[160:161], s[40:41] op_sel_hi:[1,0]
v_pk_mul_f32 v[22:23], v[162:163], s[40:41] op_sel_hi:[1,0]
v_cvt_pk_bf16_f32 v32, v20, v21
v_cvt_pk_bf16_f32 v33, v22, v23
v_pk_mul_f32 v[20:21], v[192:193], s[40:41] op_sel_hi:[1,0]
v_pk_mul_f32 v[22:23], v[194:195], s[40:41] op_sel_hi:[1,0]
v_cvt_pk_bf16_f32 v34, v20, v21
v_cvt_pk_bf16_f32 v35, v22, v23
ds_write_b128 v13, v[32:35]
v_pk_mul_f32 v[24:25], v[164:165], s[40:41] op_sel_hi:[1,0]
v_pk_mul_f32 v[26:27], v[166:167], s[40:41] op_sel_hi:[1,0]
v_cvt_pk_bf16_f32 v36, v24, v25
v_cvt_pk_bf16_f32 v37, v26, v27
v_pk_mul_f32 v[24:25], v[196:197], s[40:41] op_sel_hi:[1,0]
v_pk_mul_f32 v[26:27], v[198:199], s[40:41] op_sel_hi:[1,0]
v_cvt_pk_bf16_f32 v38, v24, v25
v_cvt_pk_bf16_f32 v39, v26, v27
ds_write_b128 v13, v[36:39] offset:128
v_pk_mul_f32 v[20:21], v[168:169], s[40:41] op_sel_hi:[1,0]
v_pk_mul_f32 v[22:23], v[170:171], s[40:41] op_sel_hi:[1,0]
v_cvt_pk_bf16_f32 v40, v20, v21
v_cvt_pk_bf16_f32 v41, v22, v23
v_pk_mul_f32 v[20:21], v[200:201], s[40:41] op_sel_hi:[1,0]
v_pk_mul_f32 v[22:23], v[202:203], s[40:41] op_sel_hi:[1,0]
v_cvt_pk_bf16_f32 v42, v20, v21
v_cvt_pk_bf16_f32 v43, v22, v23
ds_write_b128 v13, v[40:43] offset:8192
v_pk_mul_f32 v[24:25], v[172:173], s[40:41] op_sel_hi:[1,0]
v_pk_mul_f32 v[26:27], v[174:175], s[40:41] op_sel_hi:[1,0]
v_cvt_pk_bf16_f32 v44, v24, v25
v_cvt_pk_bf16_f32 v45, v26, v27
v_pk_mul_f32 v[24:25], v[204:205], s[40:41] op_sel_hi:[1,0]
v_pk_mul_f32 v[26:27], v[206:207], s[40:41] op_sel_hi:[1,0]
v_cvt_pk_bf16_f32 v46, v24, v25
v_cvt_pk_bf16_f32 v47, v26, v27
ds_write_b128 v13, v[44:47] offset:8320
v_pk_mul_f32 v[20:21], v[176:177], s[40:41] op_sel_hi:[1,0]
v_pk_mul_f32 v[22:23], v[178:179], s[40:41] op_sel_hi:[1,0]
v_cvt_pk_bf16_f32 v48, v20, v21
v_cvt_pk_bf16_f32 v49, v22, v23
v_pk_mul_f32 v[20:21], v[208:209], s[40:41] op_sel_hi:[1,0]
v_pk_mul_f32 v[22:23], v[210:211], s[40:41] op_sel_hi:[1,0]
v_cvt_pk_bf16_f32 v50, v20, v21
v_cvt_pk_bf16_f32 v51, v22, v23
ds_write_b128 v13, v[48:51] offset:16384
v_pk_mul_f32 v[24:25], v[180:181], s[40:41] op_sel_hi:[1,0]
v_pk_mul_f32 v[26:27], v[182:183], s[40:41] op_sel_hi:[1,0]
v_cvt_pk_bf16_f32 v52, v24, v25
v_cvt_pk_bf16_f32 v53, v26, v27
v_pk_mul_f32 v[24:25], v[212:213], s[40:41] op_sel_hi:[1,0]
v_pk_mul_f32 v[26:27], v[214:215], s[40:41] op_sel_hi:[1,0]
v_cvt_pk_bf16_f32 v54, v24, v25
v_cvt_pk_bf16_f32 v55, v26, v27
ds_write_b128 v13, v[52:55] offset:16512
v_pk_mul_f32 v[20:21], v[184:185], s[40:41] op_sel_hi:[1,0]
v_pk_mul_f32 v[22:23], v[186:187], s[40:41] op_sel_hi:[1,0]
v_cvt_pk_bf16_f32 v56, v20, v21
v_cvt_pk_bf16_f32 v57, v22, v23
v_pk_mul_f32 v[20:21], v[216:217], s[40:41] op_sel_hi:[1,0]
v_pk_mul_f32 v[22:23], v[218:219], s[40:41] op_sel_hi:[1,0]
v_cvt_pk_bf16_f32 v58, v20, v21
v_cvt_pk_bf16_f32 v59, v22, v23
ds_write_b128 v13, v[56:59] offset:24576
v_pk_mul_f32 v[24:25], v[188:189], s[40:41] op_sel_hi:[1,0]
v_pk_mul_f32 v[26:27], v[190:191], s[40:41] op_sel_hi:[1,0]
v_cvt_pk_bf16_f32 v60, v24, v25
v_cvt_pk_bf16_f32 v61, v26, v27
v_pk_mul_f32 v[24:25], v[220:221], s[40:41] op_sel_hi:[1,0]
v_pk_mul_f32 v[26:27], v[222:223], s[40:41] op_sel_hi:[1,0]
v_cvt_pk_bf16_f32 v62, v24, v25
v_cvt_pk_bf16_f32 v63, v26, v27
ds_write_b128 v13, v[60:63] offset:24704
v_pk_mul_f32 v[20:21], v[224:225], s[40:41] op_sel_hi:[1,0]
v_pk_mul_f32 v[22:23], v[226:227], s[40:41] op_sel_hi:[1,0]
v_cvt_pk_bf16_f32 v64, v20, v21
v_cvt_pk_bf16_f32 v65, v22, v23
v_accvgpr_read_b32 v20, a0
v_accvgpr_read_b32 v21, a1
v_accvgpr_read_b32 v22, a2
v_accvgpr_read_b32 v23, a3
v_pk_mul_f32 v[20:21], v[20:21], s[40:41] op_sel_hi:[1,0]
v_pk_mul_f32 v[22:23], v[22:23], s[40:41] op_sel_hi:[1,0]
v_cvt_pk_bf16_f32 v66, v20, v21
v_cvt_pk_bf16_f32 v67, v22, v23
ds_write_b128 v13, v[64:67] offset:2048
v_pk_mul_f32 v[24:25], v[228:229], s[40:41] op_sel_hi:[1,0]
v_pk_mul_f32 v[26:27], v[230:231], s[40:41] op_sel_hi:[1,0]
v_cvt_pk_bf16_f32 v68, v24, v25
v_cvt_pk_bf16_f32 v69, v26, v27
v_accvgpr_read_b32 v24, a4
v_accvgpr_read_b32 v25, a5
v_accvgpr_read_b32 v26, a6
v_accvgpr_read_b32 v27, a7
v_pk_mul_f32 v[24:25], v[24:25], s[40:41] op_sel_hi:[1,0]
v_pk_mul_f32 v[26:27], v[26:27], s[40:41] op_sel_hi:[1,0]
v_cvt_pk_bf16_f32 v70, v24, v25
v_cvt_pk_bf16_f32 v71, v26, v27
ds_write_b128 v13, v[68:71] offset:2176
v_pk_mul_f32 v[20:21], v[232:233], s[40:41] op_sel_hi:[1,0]
v_pk_mul_f32 v[22:23], v[234:235], s[40:41] op_sel_hi:[1,0]
v_cvt_pk_bf16_f32 v72, v20, v21
v_cvt_pk_bf16_f32 v73, v22, v23
v_accvgpr_read_b32 v20, a8
v_accvgpr_read_b32 v21, a9
v_accvgpr_read_b32 v22, a10
v_accvgpr_read_b32 v23, a11
v_pk_mul_f32 v[20:21], v[20:21], s[40:41] op_sel_hi:[1,0]
v_pk_mul_f32 v[22:23], v[22:23], s[40:41] op_sel_hi:[1,0]
v_cvt_pk_bf16_f32 v74, v20, v21
v_cvt_pk_bf16_f32 v75, v22, v23
ds_write_b128 v13, v[72:75] offset:10240
v_pk_mul_f32 v[24:25], v[236:237], s[40:41] op_sel_hi:[1,0]
v_pk_mul_f32 v[26:27], v[238:239], s[40:41] op_sel_hi:[1,0]
v_cvt_pk_bf16_f32 v76, v24, v25
v_cvt_pk_bf16_f32 v77, v26, v27
v_accvgpr_read_b32 v24, a12
v_accvgpr_read_b32 v25, a13
v_accvgpr_read_b32 v26, a14
v_accvgpr_read_b32 v27, a15
v_pk_mul_f32 v[24:25], v[24:25], s[40:41] op_sel_hi:[1,0]
v_pk_mul_f32 v[26:27], v[26:27], s[40:41] op_sel_hi:[1,0]
v_cvt_pk_bf16_f32 v78, v24, v25
v_cvt_pk_bf16_f32 v79, v26, v27
ds_write_b128 v13, v[76:79] offset:10368
v_pk_mul_f32 v[20:21], v[240:241], s[40:41] op_sel_hi:[1,0]
v_pk_mul_f32 v[22:23], v[242:243], s[40:41] op_sel_hi:[1,0]
v_cvt_pk_bf16_f32 v80, v20, v21
v_cvt_pk_bf16_f32 v81, v22, v23
v_accvgpr_read_b32 v20, a16
v_accvgpr_read_b32 v21, a17
v_accvgpr_read_b32 v22, a18
v_accvgpr_read_b32 v23, a19
v_pk_mul_f32 v[20:21], v[20:21], s[40:41] op_sel_hi:[1,0]
v_pk_mul_f32 v[22:23], v[22:23], s[40:41] op_sel_hi:[1,0]
v_cvt_pk_bf16_f32 v82, v20, v21
v_cvt_pk_bf16_f32 v83, v22, v23
ds_write_b128 v13, v[80:83] offset:18432
v_pk_mul_f32 v[24:25], v[244:245], s[40:41] op_sel_hi:[1,0]
v_pk_mul_f32 v[26:27], v[246:247], s[40:41] op_sel_hi:[1,0]
v_cvt_pk_bf16_f32 v84, v24, v25
v_cvt_pk_bf16_f32 v85, v26, v27
v_accvgpr_read_b32 v24, a20
v_accvgpr_read_b32 v25, a21
v_accvgpr_read_b32 v26, a22
v_accvgpr_read_b32 v27, a23
v_pk_mul_f32 v[24:25], v[24:25], s[40:41] op_sel_hi:[1,0]
v_pk_mul_f32 v[26:27], v[26:27], s[40:41] op_sel_hi:[1,0]
v_cvt_pk_bf16_f32 v86, v24, v25
v_cvt_pk_bf16_f32 v87, v26, v27
ds_write_b128 v13, v[84:87] offset:18560
v_pk_mul_f32 v[20:21], v[248:249], s[40:41] op_sel_hi:[1,0]
v_pk_mul_f32 v[22:23], v[250:251], s[40:41] op_sel_hi:[1,0]
v_cvt_pk_bf16_f32 v88, v20, v21
v_cvt_pk_bf16_f32 v89, v22, v23
v_accvgpr_read_b32 v20, a24
v_accvgpr_read_b32 v21, a25
v_accvgpr_read_b32 v22, a26
v_accvgpr_read_b32 v23, a27
v_pk_mul_f32 v[20:21], v[20:21], s[40:41] op_sel_hi:[1,0]
v_pk_mul_f32 v[22:23], v[22:23], s[40:41] op_sel_hi:[1,0]
v_cvt_pk_bf16_f32 v90, v20, v21
v_cvt_pk_bf16_f32 v91, v22, v23
ds_write_b128 v13, v[88:91] offset:26624
v_pk_mul_f32 v[24:25], v[252:253], s[40:41] op_sel_hi:[1,0]
v_pk_mul_f32 v[26:27], v[254:255], s[40:41] op_sel_hi:[1,0]
v_cvt_pk_bf16_f32 v92, v24, v25
v_cvt_pk_bf16_f32 v93, v26, v27
v_accvgpr_read_b32 v24, a28
v_accvgpr_read_b32 v25, a29
v_accvgpr_read_b32 v26, a30
v_accvgpr_read_b32 v27, a31
v_pk_mul_f32 v[24:25], v[24:25], s[40:41] op_sel_hi:[1,0]
v_pk_mul_f32 v[26:27], v[26:27], s[40:41] op_sel_hi:[1,0]
v_cvt_pk_bf16_f32 v94, v24, v25
v_cvt_pk_bf16_f32 v95, v26, v27
ds_write_b128 v13, v[92:95] offset:26752
v_accvgpr_read_b32 v20, a32
v_accvgpr_read_b32 v21, a33
v_accvgpr_read_b32 v22, a34
v_accvgpr_read_b32 v23, a35
v_pk_mul_f32 v[20:21], v[20:21], s[40:41] op_sel_hi:[1,0]
v_pk_mul_f32 v[22:23], v[22:23], s[40:41] op_sel_hi:[1,0]
v_cvt_pk_bf16_f32 v96, v20, v21
v_cvt_pk_bf16_f32 v97, v22, v23
v_accvgpr_read_b32 v20, a64
v_accvgpr_read_b32 v21, a65
v_accvgpr_read_b32 v22, a66
v_accvgpr_read_b32 v23, a67
v_pk_mul_f32 v[20:21], v[20:21], s[40:41] op_sel_hi:[1,0]
v_pk_mul_f32 v[22:23], v[22:23], s[40:41] op_sel_hi:[1,0]
v_cvt_pk_bf16_f32 v98, v20, v21
v_cvt_pk_bf16_f32 v99, v22, v23
ds_write_b128 v13, v[96:99] offset:4096
v_accvgpr_read_b32 v24, a36
v_accvgpr_read_b32 v25, a37
v_accvgpr_read_b32 v26, a38
v_accvgpr_read_b32 v27, a39
v_pk_mul_f32 v[24:25], v[24:25], s[40:41] op_sel_hi:[1,0]
v_pk_mul_f32 v[26:27], v[26:27], s[40:41] op_sel_hi:[1,0]
v_cvt_pk_bf16_f32 v100, v24, v25
v_cvt_pk_bf16_f32 v101, v26, v27
v_accvgpr_read_b32 v24, a68
v_accvgpr_read_b32 v25, a69
v_accvgpr_read_b32 v26, a70
v_accvgpr_read_b32 v27, a71
v_pk_mul_f32 v[24:25], v[24:25], s[40:41] op_sel_hi:[1,0]
v_pk_mul_f32 v[26:27], v[26:27], s[40:41] op_sel_hi:[1,0]
v_cvt_pk_bf16_f32 v102, v24, v25
v_cvt_pk_bf16_f32 v103, v26, v27
ds_write_b128 v13, v[100:103] offset:4224
v_accvgpr_read_b32 v20, a40
v_accvgpr_read_b32 v21, a41
v_accvgpr_read_b32 v22, a42
v_accvgpr_read_b32 v23, a43
v_pk_mul_f32 v[20:21], v[20:21], s[40:41] op_sel_hi:[1,0]
v_pk_mul_f32 v[22:23], v[22:23], s[40:41] op_sel_hi:[1,0]
v_cvt_pk_bf16_f32 v104, v20, v21
v_cvt_pk_bf16_f32 v105, v22, v23
v_accvgpr_read_b32 v20, a72
v_accvgpr_read_b32 v21, a73
v_accvgpr_read_b32 v22, a74
v_accvgpr_read_b32 v23, a75
v_pk_mul_f32 v[20:21], v[20:21], s[40:41] op_sel_hi:[1,0]
v_pk_mul_f32 v[22:23], v[22:23], s[40:41] op_sel_hi:[1,0]
v_cvt_pk_bf16_f32 v106, v20, v21
v_cvt_pk_bf16_f32 v107, v22, v23
ds_write_b128 v13, v[104:107] offset:12288
v_accvgpr_read_b32 v24, a44
v_accvgpr_read_b32 v25, a45
v_accvgpr_read_b32 v26, a46
v_accvgpr_read_b32 v27, a47
v_pk_mul_f32 v[24:25], v[24:25], s[40:41] op_sel_hi:[1,0]
v_pk_mul_f32 v[26:27], v[26:27], s[40:41] op_sel_hi:[1,0]
v_cvt_pk_bf16_f32 v108, v24, v25
v_cvt_pk_bf16_f32 v109, v26, v27
v_accvgpr_read_b32 v24, a76
v_accvgpr_read_b32 v25, a77
v_accvgpr_read_b32 v26, a78
v_accvgpr_read_b32 v27, a79
v_pk_mul_f32 v[24:25], v[24:25], s[40:41] op_sel_hi:[1,0]
v_pk_mul_f32 v[26:27], v[26:27], s[40:41] op_sel_hi:[1,0]
v_cvt_pk_bf16_f32 v110, v24, v25
v_cvt_pk_bf16_f32 v111, v26, v27
ds_write_b128 v13, v[108:111] offset:12416
v_accvgpr_read_b32 v20, a48
v_accvgpr_read_b32 v21, a49
v_accvgpr_read_b32 v22, a50
v_accvgpr_read_b32 v23, a51
v_pk_mul_f32 v[20:21], v[20:21], s[40:41] op_sel_hi:[1,0]
v_pk_mul_f32 v[22:23], v[22:23], s[40:41] op_sel_hi:[1,0]
v_cvt_pk_bf16_f32 v112, v20, v21
v_cvt_pk_bf16_f32 v113, v22, v23
v_accvgpr_read_b32 v20, a80
v_accvgpr_read_b32 v21, a81
v_accvgpr_read_b32 v22, a82
v_accvgpr_read_b32 v23, a83
v_pk_mul_f32 v[20:21], v[20:21], s[40:41] op_sel_hi:[1,0]
v_pk_mul_f32 v[22:23], v[22:23], s[40:41] op_sel_hi:[1,0]
v_cvt_pk_bf16_f32 v114, v20, v21
v_cvt_pk_bf16_f32 v115, v22, v23
ds_write_b128 v13, v[112:115] offset:20480
v_accvgpr_read_b32 v24, a52
v_accvgpr_read_b32 v25, a53
v_accvgpr_read_b32 v26, a54
v_accvgpr_read_b32 v27, a55
v_pk_mul_f32 v[24:25], v[24:25], s[40:41] op_sel_hi:[1,0]
v_pk_mul_f32 v[26:27], v[26:27], s[40:41] op_sel_hi:[1,0]
v_cvt_pk_bf16_f32 v116, v24, v25
v_cvt_pk_bf16_f32 v117, v26, v27
v_accvgpr_read_b32 v24, a84
v_accvgpr_read_b32 v25, a85
v_accvgpr_read_b32 v26, a86
v_accvgpr_read_b32 v27, a87
v_pk_mul_f32 v[24:25], v[24:25], s[40:41] op_sel_hi:[1,0]
v_pk_mul_f32 v[26:27], v[26:27], s[40:41] op_sel_hi:[1,0]
v_cvt_pk_bf16_f32 v118, v24, v25
v_cvt_pk_bf16_f32 v119, v26, v27
ds_write_b128 v13, v[116:119] offset:20608
v_accvgpr_read_b32 v20, a56
v_accvgpr_read_b32 v21, a57
v_accvgpr_read_b32 v22, a58
v_accvgpr_read_b32 v23, a59
v_pk_mul_f32 v[20:21], v[20:21], s[40:41] op_sel_hi:[1,0]
v_pk_mul_f32 v[22:23], v[22:23], s[40:41] op_sel_hi:[1,0]
v_cvt_pk_bf16_f32 v120, v20, v21
v_cvt_pk_bf16_f32 v121, v22, v23
v_accvgpr_read_b32 v20, a88
v_accvgpr_read_b32 v21, a89
v_accvgpr_read_b32 v22, a90
v_accvgpr_read_b32 v23, a91
v_pk_mul_f32 v[20:21], v[20:21], s[40:41] op_sel_hi:[1,0]
v_pk_mul_f32 v[22:23], v[22:23], s[40:41] op_sel_hi:[1,0]
v_cvt_pk_bf16_f32 v122, v20, v21
v_cvt_pk_bf16_f32 v123, v22, v23
ds_write_b128 v13, v[120:123] offset:28672
v_accvgpr_read_b32 v24, a60
v_accvgpr_read_b32 v25, a61
v_accvgpr_read_b32 v26, a62
v_accvgpr_read_b32 v27, a63
v_pk_mul_f32 v[24:25], v[24:25], s[40:41] op_sel_hi:[1,0]
v_pk_mul_f32 v[26:27], v[26:27], s[40:41] op_sel_hi:[1,0]
v_cvt_pk_bf16_f32 v124, v24, v25
v_cvt_pk_bf16_f32 v125, v26, v27
v_accvgpr_read_b32 v24, a92
v_accvgpr_read_b32 v25, a93
v_accvgpr_read_b32 v26, a94
v_accvgpr_read_b32 v27, a95
v_pk_mul_f32 v[24:25], v[24:25], s[40:41] op_sel_hi:[1,0]
v_pk_mul_f32 v[26:27], v[26:27], s[40:41] op_sel_hi:[1,0]
v_cvt_pk_bf16_f32 v126, v24, v25
v_cvt_pk_bf16_f32 v127, v26, v27
ds_write_b128 v13, v[124:127] offset:28800
v_accvgpr_read_b32 v20, a96
v_accvgpr_read_b32 v21, a97
v_accvgpr_read_b32 v22, a98
v_accvgpr_read_b32 v23, a99
v_pk_mul_f32 v[20:21], v[20:21], s[40:41] op_sel_hi:[1,0]
v_pk_mul_f32 v[22:23], v[22:23], s[40:41] op_sel_hi:[1,0]
v_cvt_pk_bf16_f32 v128, v20, v21
v_cvt_pk_bf16_f32 v129, v22, v23
v_accvgpr_read_b32 v20, a128
v_accvgpr_read_b32 v21, a129
v_accvgpr_read_b32 v22, a130
v_accvgpr_read_b32 v23, a131
v_pk_mul_f32 v[20:21], v[20:21], s[40:41] op_sel_hi:[1,0]
v_pk_mul_f32 v[22:23], v[22:23], s[40:41] op_sel_hi:[1,0]
v_cvt_pk_bf16_f32 v130, v20, v21
v_cvt_pk_bf16_f32 v131, v22, v23
ds_write_b128 v13, v[128:131] offset:6144
v_accvgpr_read_b32 v24, a100
v_accvgpr_read_b32 v25, a101
v_accvgpr_read_b32 v26, a102
v_accvgpr_read_b32 v27, a103
v_pk_mul_f32 v[24:25], v[24:25], s[40:41] op_sel_hi:[1,0]
v_pk_mul_f32 v[26:27], v[26:27], s[40:41] op_sel_hi:[1,0]
v_cvt_pk_bf16_f32 v132, v24, v25
v_cvt_pk_bf16_f32 v133, v26, v27
v_accvgpr_read_b32 v24, a132
v_accvgpr_read_b32 v25, a133
v_accvgpr_read_b32 v26, a134
v_accvgpr_read_b32 v27, a135
v_pk_mul_f32 v[24:25], v[24:25], s[40:41] op_sel_hi:[1,0]
v_pk_mul_f32 v[26:27], v[26:27], s[40:41] op_sel_hi:[1,0]
v_cvt_pk_bf16_f32 v134, v24, v25
v_cvt_pk_bf16_f32 v135, v26, v27
ds_write_b128 v13, v[132:135] offset:6272
v_accvgpr_read_b32 v20, a104
v_accvgpr_read_b32 v21, a105
v_accvgpr_read_b32 v22, a106
v_accvgpr_read_b32 v23, a107
v_pk_mul_f32 v[20:21], v[20:21], s[40:41] op_sel_hi:[1,0]
v_pk_mul_f32 v[22:23], v[22:23], s[40:41] op_sel_hi:[1,0]
v_cvt_pk_bf16_f32 v136, v20, v21
v_cvt_pk_bf16_f32 v137, v22, v23
v_accvgpr_read_b32 v20, a136
v_accvgpr_read_b32 v21, a137
v_accvgpr_read_b32 v22, a138
v_accvgpr_read_b32 v23, a139
v_pk_mul_f32 v[20:21], v[20:21], s[40:41] op_sel_hi:[1,0]
v_pk_mul_f32 v[22:23], v[22:23], s[40:41] op_sel_hi:[1,0]
v_cvt_pk_bf16_f32 v138, v20, v21
v_cvt_pk_bf16_f32 v139, v22, v23
ds_write_b128 v13, v[136:139] offset:14336
v_accvgpr_read_b32 v24, a108
v_accvgpr_read_b32 v25, a109
v_accvgpr_read_b32 v26, a110
v_accvgpr_read_b32 v27, a111
v_pk_mul_f32 v[24:25], v[24:25], s[40:41] op_sel_hi:[1,0]
v_pk_mul_f32 v[26:27], v[26:27], s[40:41] op_sel_hi:[1,0]
v_cvt_pk_bf16_f32 v140, v24, v25
v_cvt_pk_bf16_f32 v141, v26, v27
v_accvgpr_read_b32 v24, a140
v_accvgpr_read_b32 v25, a141
v_accvgpr_read_b32 v26, a142
v_accvgpr_read_b32 v27, a143
v_pk_mul_f32 v[24:25], v[24:25], s[40:41] op_sel_hi:[1,0]
v_pk_mul_f32 v[26:27], v[26:27], s[40:41] op_sel_hi:[1,0]
v_cvt_pk_bf16_f32 v142, v24, v25
v_cvt_pk_bf16_f32 v143, v26, v27
ds_write_b128 v13, v[140:143] offset:14464
v_accvgpr_read_b32 v20, a112
v_accvgpr_read_b32 v21, a113
v_accvgpr_read_b32 v22, a114
v_accvgpr_read_b32 v23, a115
v_pk_mul_f32 v[20:21], v[20:21], s[40:41] op_sel_hi:[1,0]
v_pk_mul_f32 v[22:23], v[22:23], s[40:41] op_sel_hi:[1,0]
v_cvt_pk_bf16_f32 v144, v20, v21
v_cvt_pk_bf16_f32 v145, v22, v23
v_accvgpr_read_b32 v20, a144
v_accvgpr_read_b32 v21, a145
v_accvgpr_read_b32 v22, a146
v_accvgpr_read_b32 v23, a147
v_pk_mul_f32 v[20:21], v[20:21], s[40:41] op_sel_hi:[1,0]
v_pk_mul_f32 v[22:23], v[22:23], s[40:41] op_sel_hi:[1,0]
v_cvt_pk_bf16_f32 v146, v20, v21
v_cvt_pk_bf16_f32 v147, v22, v23
ds_write_b128 v13, v[144:147] offset:22528
v_accvgpr_read_b32 v24, a116
v_accvgpr_read_b32 v25, a117
v_accvgpr_read_b32 v26, a118
v_accvgpr_read_b32 v27, a119
v_pk_mul_f32 v[24:25], v[24:25], s[40:41] op_sel_hi:[1,0]
v_pk_mul_f32 v[26:27], v[26:27], s[40:41] op_sel_hi:[1,0]
v_cvt_pk_bf16_f32 v148, v24, v25
v_cvt_pk_bf16_f32 v149, v26, v27
v_accvgpr_read_b32 v24, a148
v_accvgpr_read_b32 v25, a149
v_accvgpr_read_b32 v26, a150
v_accvgpr_read_b32 v27, a151
v_pk_mul_f32 v[24:25], v[24:25], s[40:41] op_sel_hi:[1,0]
v_pk_mul_f32 v[26:27], v[26:27], s[40:41] op_sel_hi:[1,0]
v_cvt_pk_bf16_f32 v150, v24, v25
v_cvt_pk_bf16_f32 v151, v26, v27
ds_write_b128 v13, v[148:151] offset:22656
v_accvgpr_read_b32 v20, a120
v_accvgpr_read_b32 v21, a121
v_accvgpr_read_b32 v22, a122
v_accvgpr_read_b32 v23, a123
v_pk_mul_f32 v[20:21], v[20:21], s[40:41] op_sel_hi:[1,0]
v_pk_mul_f32 v[22:23], v[22:23], s[40:41] op_sel_hi:[1,0]
v_cvt_pk_bf16_f32 v152, v20, v21
v_cvt_pk_bf16_f32 v153, v22, v23
v_accvgpr_read_b32 v20, a152
v_accvgpr_read_b32 v21, a153
v_accvgpr_read_b32 v22, a154
v_accvgpr_read_b32 v23, a155
v_pk_mul_f32 v[20:21], v[20:21], s[40:41] op_sel_hi:[1,0]
v_pk_mul_f32 v[22:23], v[22:23], s[40:41] op_sel_hi:[1,0]
v_cvt_pk_bf16_f32 v154, v20, v21
v_cvt_pk_bf16_f32 v155, v22, v23
ds_write_b128 v13, v[152:155] offset:30720
v_accvgpr_read_b32 v24, a124
v_accvgpr_read_b32 v25, a125
v_accvgpr_read_b32 v26, a126
v_accvgpr_read_b32 v27, a127
v_pk_mul_f32 v[24:25], v[24:25], s[40:41] op_sel_hi:[1,0]
v_pk_mul_f32 v[26:27], v[26:27], s[40:41] op_sel_hi:[1,0]
v_cvt_pk_bf16_f32 v156, v24, v25
v_cvt_pk_bf16_f32 v157, v26, v27
v_accvgpr_read_b32 v24, a156
v_accvgpr_read_b32 v25, a157
v_accvgpr_read_b32 v26, a158
v_accvgpr_read_b32 v27, a159
v_pk_mul_f32 v[24:25], v[24:25], s[40:41] op_sel_hi:[1,0]
v_pk_mul_f32 v[26:27], v[26:27], s[40:41] op_sel_hi:[1,0]
v_cvt_pk_bf16_f32 v158, v24, v25
v_cvt_pk_bf16_f32 v159, v26, v27
ds_write_b128 v13, v[156:159] offset:30848
s_waitcnt vmcnt(16) lgkmcnt(0)
s_branch L_at_qx
L_at_qg:
v_pk_mul_f32 v[20:21], v[160:161], s[40:41] op_sel_hi:[1,0]
v_pk_mul_f32 v[22:23], v[162:163], s[40:41] op_sel_hi:[1,0]
v_cvt_pk_bf16_f32 v32, v20, v21
v_cvt_pk_bf16_f32 v33, v22, v23
v_pk_mul_f32 v[20:21], v[192:193], s[40:41] op_sel_hi:[1,0]
v_pk_mul_f32 v[22:23], v[194:195], s[40:41] op_sel_hi:[1,0]
v_cvt_pk_bf16_f32 v34, v20, v21
v_cvt_pk_bf16_f32 v35, v22, v23
s_add_u32 s24, s96, 0
buffer_store_dwordx4 v[32:35], v13, s[8:11], s24 offen sc1
v_pk_mul_f32 v[24:25], v[164:165], s[40:41] op_sel_hi:[1,0]
v_pk_mul_f32 v[26:27], v[166:167], s[40:41] op_sel_hi:[1,0]
v_cvt_pk_bf16_f32 v36, v24, v25
v_cvt_pk_bf16_f32 v37, v26, v27
v_pk_mul_f32 v[24:25], v[196:197], s[40:41] op_sel_hi:[1,0]
v_pk_mul_f32 v[26:27], v[198:199], s[40:41] op_sel_hi:[1,0]
v_cvt_pk_bf16_f32 v38, v24, v25
v_cvt_pk_bf16_f32 v39, v26, v27
buffer_store_dwordx4 v[36:39], v13, s[8:11], s24 offen offset:128 sc1
v_pk_mul_f32 v[20:21], v[168:169], s[40:41] op_sel_hi:[1,0]
v_pk_mul_f32 v[22:23], v[170:171], s[40:41] op_sel_hi:[1,0]
v_cvt_pk_bf16_f32 v40, v20, v21
v_cvt_pk_bf16_f32 v41, v22, v23
v_pk_mul_f32 v[20:21], v[200:201], s[40:41] op_sel_hi:[1,0]
v_pk_mul_f32 v[22:23], v[202:203], s[40:41] op_sel_hi:[1,0]
v_cvt_pk_bf16_f32 v42, v20, v21
v_cvt_pk_bf16_f32 v43, v22, v23
s_add_u32 s24, s96, 262144
buffer_store_dwordx4 v[40:43], v13, s[8:11], s24 offen sc1
v_pk_mul_f32 v[24:25], v[172:173], s[40:41] op_sel_hi:[1,0]
v_pk_mul_f32 v[26:27], v[174:175], s[40:41] op_sel_hi:[1,0]
v_cvt_pk_bf16_f32 v44, v24, v25
v_cvt_pk_bf16_f32 v45, v26, v27
v_pk_mul_f32 v[24:25], v[204:205], s[40:41] op_sel_hi:[1,0]
v_pk_mul_f32 v[26:27], v[206:207], s[40:41] op_sel_hi:[1,0]
v_cvt_pk_bf16_f32 v46, v24, v25
v_cvt_pk_bf16_f32 v47, v26, v27
buffer_store_dwordx4 v[44:47], v13, s[8:11], s24 offen offset:128 sc1
v_pk_mul_f32 v[20:21], v[176:177], s[40:41] op_sel_hi:[1,0]
v_pk_mul_f32 v[22:23], v[178:179], s[40:41] op_sel_hi:[1,0]
v_cvt_pk_bf16_f32 v48, v20, v21
v_cvt_pk_bf16_f32 v49, v22, v23
v_pk_mul_f32 v[20:21], v[208:209], s[40:41] op_sel_hi:[1,0]
v_pk_mul_f32 v[22:23], v[210:211], s[40:41] op_sel_hi:[1,0]
v_cvt_pk_bf16_f32 v50, v20, v21
v_cvt_pk_bf16_f32 v51, v22, v23
s_add_u32 s24, s96, 524288
buffer_store_dwordx4 v[48:51], v13, s[8:11], s24 offen sc1
v_pk_mul_f32 v[24:25], v[180:181], s[40:41] op_sel_hi:[1,0]
v_pk_mul_f32 v[26:27], v[182:183], s[40:41] op_sel_hi:[1,0]
v_cvt_pk_bf16_f32 v52, v24, v25
v_cvt_pk_bf16_f32 v53, v26, v27
v_pk_mul_f32 v[24:25], v[212:213], s[40:41] op_sel_hi:[1,0]
v_pk_mul_f32 v[26:27], v[214:215], s[40:41] op_sel_hi:[1,0]
v_cvt_pk_bf16_f32 v54, v24, v25
v_cvt_pk_bf16_f32 v55, v26, v27
buffer_store_dwordx4 v[52:55], v13, s[8:11], s24 offen offset:128 sc1
v_pk_mul_f32 v[20:21], v[184:185], s[40:41] op_sel_hi:[1,0]
v_pk_mul_f32 v[22:23], v[186:187], s[40:41] op_sel_hi:[1,0]
v_cvt_pk_bf16_f32 v56, v20, v21
v_cvt_pk_bf16_f32 v57, v22, v23
v_pk_mul_f32 v[20:21], v[216:217], s[40:41] op_sel_hi:[1,0]
v_pk_mul_f32 v[22:23], v[218:219], s[40:41] op_sel_hi:[1,0]
v_cvt_pk_bf16_f32 v58, v20, v21
v_cvt_pk_bf16_f32 v59, v22, v23
s_add_u32 s24, s96, 786432
buffer_store_dwordx4 v[56:59], v13, s[8:11], s24 offen sc1
v_pk_mul_f32 v[24:25], v[188:189], s[40:41] op_sel_hi:[1,0]
v_pk_mul_f32 v[26:27], v[190:191], s[40:41] op_sel_hi:[1,0]
v_cvt_pk_bf16_f32 v60, v24, v25
v_cvt_pk_bf16_f32 v61, v26, v27
v_pk_mul_f32 v[24:25], v[220:221], s[40:41] op_sel_hi:[1,0]
v_pk_mul_f32 v[26:27], v[222:223], s[40:41] op_sel_hi:[1,0]
v_cvt_pk_bf16_f32 v62, v24, v25
v_cvt_pk_bf16_f32 v63, v26, v27
buffer_store_dwordx4 v[60:63], v13, s[8:11], s24 offen offset:128 sc1
v_pk_mul_f32 v[20:21], v[224:225], s[40:41] op_sel_hi:[1,0]
v_pk_mul_f32 v[22:23], v[226:227], s[40:41] op_sel_hi:[1,0]
v_cvt_pk_bf16_f32 v64, v20, v21
v_cvt_pk_bf16_f32 v65, v22, v23
v_accvgpr_read_b32 v20, a0
v_accvgpr_read_b32 v21, a1
v_accvgpr_read_b32 v22, a2
v_accvgpr_read_b32 v23, a3
v_pk_mul_f32 v[20:21], v[20:21], s[40:41] op_sel_hi:[1,0]
v_pk_mul_f32 v[22:23], v[22:23], s[40:41] op_sel_hi:[1,0]
v_cvt_pk_bf16_f32 v66, v20, v21
v_cvt_pk_bf16_f32 v67, v22, v23
s_add_u32 s24, s96, 2048
buffer_store_dwordx4 v[64:67], v13, s[8:11], s24 offen sc1
v_pk_mul_f32 v[24:25], v[228:229], s[40:41] op_sel_hi:[1,0]
v_pk_mul_f32 v[26:27], v[230:231], s[40:41] op_sel_hi:[1,0]
v_cvt_pk_bf16_f32 v68, v24, v25
v_cvt_pk_bf16_f32 v69, v26, v27
v_accvgpr_read_b32 v24, a4
v_accvgpr_read_b32 v25, a5
v_accvgpr_read_b32 v26, a6
v_accvgpr_read_b32 v27, a7
v_pk_mul_f32 v[24:25], v[24:25], s[40:41] op_sel_hi:[1,0]
v_pk_mul_f32 v[26:27], v[26:27], s[40:41] op_sel_hi:[1,0]
v_cvt_pk_bf16_f32 v70, v24, v25
v_cvt_pk_bf16_f32 v71, v26, v27
buffer_store_dwordx4 v[68:71], v13, s[8:11], s24 offen offset:128 sc1
v_pk_mul_f32 v[20:21], v[232:233], s[40:41] op_sel_hi:[1,0]
v_pk_mul_f32 v[22:23], v[234:235], s[40:41] op_sel_hi:[1,0]
v_cvt_pk_bf16_f32 v72, v20, v21
v_cvt_pk_bf16_f32 v73, v22, v23
v_accvgpr_read_b32 v20, a8
v_accvgpr_read_b32 v21, a9
v_accvgpr_read_b32 v22, a10
v_accvgpr_read_b32 v23, a11
v_pk_mul_f32 v[20:21], v[20:21], s[40:41] op_sel_hi:[1,0]
v_pk_mul_f32 v[22:23], v[22:23], s[40:41] op_sel_hi:[1,0]
v_cvt_pk_bf16_f32 v74, v20, v21
v_cvt_pk_bf16_f32 v75, v22, v23
s_add_u32 s24, s96, 264192
buffer_store_dwordx4 v[72:75], v13, s[8:11], s24 offen sc1
v_pk_mul_f32 v[24:25], v[236:237], s[40:41] op_sel_hi:[1,0]
v_pk_mul_f32 v[26:27], v[238:239], s[40:41] op_sel_hi:[1,0]
v_cvt_pk_bf16_f32 v76, v24, v25
v_cvt_pk_bf16_f32 v77, v26, v27
v_accvgpr_read_b32 v24, a12
v_accvgpr_read_b32 v25, a13
v_accvgpr_read_b32 v26, a14
v_accvgpr_read_b32 v27, a15
v_pk_mul_f32 v[24:25], v[24:25], s[40:41] op_sel_hi:[1,0]
v_pk_mul_f32 v[26:27], v[26:27], s[40:41] op_sel_hi:[1,0]
v_cvt_pk_bf16_f32 v78, v24, v25
v_cvt_pk_bf16_f32 v79, v26, v27
buffer_store_dwordx4 v[76:79], v13, s[8:11], s24 offen offset:128 sc1
v_pk_mul_f32 v[20:21], v[240:241], s[40:41] op_sel_hi:[1,0]
v_pk_mul_f32 v[22:23], v[242:243], s[40:41] op_sel_hi:[1,0]
v_cvt_pk_bf16_f32 v80, v20, v21
v_cvt_pk_bf16_f32 v81, v22, v23
v_accvgpr_read_b32 v20, a16
v_accvgpr_read_b32 v21, a17
v_accvgpr_read_b32 v22, a18
v_accvgpr_read_b32 v23, a19
v_pk_mul_f32 v[20:21], v[20:21], s[40:41] op_sel_hi:[1,0]
v_pk_mul_f32 v[22:23], v[22:23], s[40:41] op_sel_hi:[1,0]
v_cvt_pk_bf16_f32 v82, v20, v21
v_cvt_pk_bf16_f32 v83, v22, v23
s_add_u32 s24, s96, 526336
buffer_store_dwordx4 v[80:83], v13, s[8:11], s24 offen sc1
v_pk_mul_f32 v[24:25], v[244:245], s[40:41] op_sel_hi:[1,0]
v_pk_mul_f32 v[26:27], v[246:247], s[40:41] op_sel_hi:[1,0]
v_cvt_pk_bf16_f32 v84, v24, v25
v_cvt_pk_bf16_f32 v85, v26, v27
v_accvgpr_read_b32 v24, a20
v_accvgpr_read_b32 v25, a21
v_accvgpr_read_b32 v26, a22
v_accvgpr_read_b32 v27, a23
v_pk_mul_f32 v[24:25], v[24:25], s[40:41] op_sel_hi:[1,0]
v_pk_mul_f32 v[26:27], v[26:27], s[40:41] op_sel_hi:[1,0]
v_cvt_pk_bf16_f32 v86, v24, v25
v_cvt_pk_bf16_f32 v87, v26, v27
buffer_store_dwordx4 v[84:87], v13, s[8:11], s24 offen offset:128 sc1
v_pk_mul_f32 v[20:21], v[248:249], s[40:41] op_sel_hi:[1,0]
v_pk_mul_f32 v[22:23], v[250:251], s[40:41] op_sel_hi:[1,0]
v_cvt_pk_bf16_f32 v88, v20, v21
v_cvt_pk_bf16_f32 v89, v22, v23
v_accvgpr_read_b32 v20, a24
v_accvgpr_read_b32 v21, a25
v_accvgpr_read_b32 v22, a26
v_accvgpr_read_b32 v23, a27
v_pk_mul_f32 v[20:21], v[20:21], s[40:41] op_sel_hi:[1,0]
v_pk_mul_f32 v[22:23], v[22:23], s[40:41] op_sel_hi:[1,0]
v_cvt_pk_bf16_f32 v90, v20, v21
v_cvt_pk_bf16_f32 v91, v22, v23
s_add_u32 s24, s96, 788480
buffer_store_dwordx4 v[88:91], v13, s[8:11], s24 offen sc1
v_pk_mul_f32 v[24:25], v[252:253], s[40:41] op_sel_hi:[1,0]
v_pk_mul_f32 v[26:27], v[254:255], s[40:41] op_sel_hi:[1,0]
v_cvt_pk_bf16_f32 v92, v24, v25
v_cvt_pk_bf16_f32 v93, v26, v27
v_accvgpr_read_b32 v24, a28
v_accvgpr_read_b32 v25, a29
v_accvgpr_read_b32 v26, a30
v_accvgpr_read_b32 v27, a31
v_pk_mul_f32 v[24:25], v[24:25], s[40:41] op_sel_hi:[1,0]
v_pk_mul_f32 v[26:27], v[26:27], s[40:41] op_sel_hi:[1,0]
v_cvt_pk_bf16_f32 v94, v24, v25
v_cvt_pk_bf16_f32 v95, v26, v27
buffer_store_dwordx4 v[92:95], v13, s[8:11], s24 offen offset:128 sc1
v_accvgpr_read_b32 v20, a32
v_accvgpr_read_b32 v21, a33
v_accvgpr_read_b32 v22, a34
v_accvgpr_read_b32 v23, a35
v_pk_mul_f32 v[20:21], v[20:21], s[40:41] op_sel_hi:[1,0]
v_pk_mul_f32 v[22:23], v[22:23], s[40:41] op_sel_hi:[1,0]
v_cvt_pk_bf16_f32 v96, v20, v21
v_cvt_pk_bf16_f32 v97, v22, v23
v_accvgpr_read_b32 v20, a64
v_accvgpr_read_b32 v21, a65
v_accvgpr_read_b32 v22, a66
v_accvgpr_read_b32 v23, a67
v_pk_mul_f32 v[20:21], v[20:21], s[40:41] op_sel_hi:[1,0]
v_pk_mul_f32 v[22:23], v[22:23], s[40:41] op_sel_hi:[1,0]
v_cvt_pk_bf16_f32 v98, v20, v21
v_cvt_pk_bf16_f32 v99, v22, v23
s_add_u32 s24, s96, 4096
buffer_store_dwordx4 v[96:99], v13, s[8:11], s24 offen sc1
v_accvgpr_read_b32 v24, a36
v_accvgpr_read_b32 v25, a37
v_accvgpr_read_b32 v26, a38
v_accvgpr_read_b32 v27, a39
v_pk_mul_f32 v[24:25], v[24:25], s[40:41] op_sel_hi:[1,0]
v_pk_mul_f32 v[26:27], v[26:27], s[40:41] op_sel_hi:[1,0]
v_cvt_pk_bf16_f32 v100, v24, v25
v_cvt_pk_bf16_f32 v101, v26, v27
v_accvgpr_read_b32 v24, a68
v_accvgpr_read_b32 v25, a69
v_accvgpr_read_b32 v26, a70
v_accvgpr_read_b32 v27, a71
v_pk_mul_f32 v[24:25], v[24:25], s[40:41] op_sel_hi:[1,0]
v_pk_mul_f32 v[26:27], v[26:27], s[40:41] op_sel_hi:[1,0]
v_cvt_pk_bf16_f32 v102, v24, v25
v_cvt_pk_bf16_f32 v103, v26, v27
buffer_store_dwordx4 v[100:103], v13, s[8:11], s24 offen offset:128 sc1
v_accvgpr_read_b32 v20, a40
v_accvgpr_read_b32 v21, a41
v_accvgpr_read_b32 v22, a42
v_accvgpr_read_b32 v23, a43
v_pk_mul_f32 v[20:21], v[20:21], s[40:41] op_sel_hi:[1,0]
v_pk_mul_f32 v[22:23], v[22:23], s[40:41] op_sel_hi:[1,0]
v_cvt_pk_bf16_f32 v104, v20, v21
v_cvt_pk_bf16_f32 v105, v22, v23
v_accvgpr_read_b32 v20, a72
v_accvgpr_read_b32 v21, a73
v_accvgpr_read_b32 v22, a74
v_accvgpr_read_b32 v23, a75
v_pk_mul_f32 v[20:21], v[20:21], s[40:41] op_sel_hi:[1,0]
v_pk_mul_f32 v[22:23], v[22:23], s[40:41] op_sel_hi:[1,0]
v_cvt_pk_bf16_f32 v106, v20, v21
v_cvt_pk_bf16_f32 v107, v22, v23
s_add_u32 s24, s96, 266240
buffer_store_dwordx4 v[104:107], v13, s[8:11], s24 offen sc1
v_accvgpr_read_b32 v24, a44
v_accvgpr_read_b32 v25, a45
v_accvgpr_read_b32 v26, a46
v_accvgpr_read_b32 v27, a47
v_pk_mul_f32 v[24:25], v[24:25], s[40:41] op_sel_hi:[1,0]
v_pk_mul_f32 v[26:27], v[26:27], s[40:41] op_sel_hi:[1,0]
v_cvt_pk_bf16_f32 v108, v24, v25
v_cvt_pk_bf16_f32 v109, v26, v27
v_accvgpr_read_b32 v24, a76
v_accvgpr_read_b32 v25, a77
v_accvgpr_read_b32 v26, a78
v_accvgpr_read_b32 v27, a79
v_pk_mul_f32 v[24:25], v[24:25], s[40:41] op_sel_hi:[1,0]
v_pk_mul_f32 v[26:27], v[26:27], s[40:41] op_sel_hi:[1,0]
v_cvt_pk_bf16_f32 v110, v24, v25
v_cvt_pk_bf16_f32 v111, v26, v27
buffer_store_dwordx4 v[108:111], v13, s[8:11], s24 offen offset:128 sc1
v_accvgpr_read_b32 v20, a48
v_accvgpr_read_b32 v21, a49
v_accvgpr_read_b32 v22, a50
v_accvgpr_read_b32 v23, a51
v_pk_mul_f32 v[20:21], v[20:21], s[40:41] op_sel_hi:[1,0]
v_pk_mul_f32 v[22:23], v[22:23], s[40:41] op_sel_hi:[1,0]
v_cvt_pk_bf16_f32 v112, v20, v21
v_cvt_pk_bf16_f32 v113, v22, v23
v_accvgpr_read_b32 v20, a80
v_accvgpr_read_b32 v21, a81
v_accvgpr_read_b32 v22, a82
v_accvgpr_read_b32 v23, a83
v_pk_mul_f32 v[20:21], v[20:21], s[40:41] op_sel_hi:[1,0]
v_pk_mul_f32 v[22:23], v[22:23], s[40:41] op_sel_hi:[1,0]
v_cvt_pk_bf16_f32 v114, v20, v21
v_cvt_pk_bf16_f32 v115, v22, v23
s_add_u32 s24, s96, 528384
buffer_store_dwordx4 v[112:115], v13, s[8:11], s24 offen sc1
v_accvgpr_read_b32 v24, a52
v_accvgpr_read_b32 v25, a53
v_accvgpr_read_b32 v26, a54
v_accvgpr_read_b32 v27, a55
v_pk_mul_f32 v[24:25], v[24:25], s[40:41] op_sel_hi:[1,0]
v_pk_mul_f32 v[26:27], v[26:27], s[40:41] op_sel_hi:[1,0]
v_cvt_pk_bf16_f32 v116, v24, v25
v_cvt_pk_bf16_f32 v117, v26, v27
v_accvgpr_read_b32 v24, a84
v_accvgpr_read_b32 v25, a85
v_accvgpr_read_b32 v26, a86
v_accvgpr_read_b32 v27, a87
v_pk_mul_f32 v[24:25], v[24:25], s[40:41] op_sel_hi:[1,0]
v_pk_mul_f32 v[26:27], v[26:27], s[40:41] op_sel_hi:[1,0]
v_cvt_pk_bf16_f32 v118, v24, v25
v_cvt_pk_bf16_f32 v119, v26, v27
buffer_store_dwordx4 v[116:119], v13, s[8:11], s24 offen offset:128 sc1
v_accvgpr_read_b32 v20, a56
v_accvgpr_read_b32 v21, a57
v_accvgpr_read_b32 v22, a58
v_accvgpr_read_b32 v23, a59
v_pk_mul_f32 v[20:21], v[20:21], s[40:41] op_sel_hi:[1,0]
v_pk_mul_f32 v[22:23], v[22:23], s[40:41] op_sel_hi:[1,0]
v_cvt_pk_bf16_f32 v120, v20, v21
v_cvt_pk_bf16_f32 v121, v22, v23
v_accvgpr_read_b32 v20, a88
v_accvgpr_read_b32 v21, a89
v_accvgpr_read_b32 v22, a90
v_accvgpr_read_b32 v23, a91
v_pk_mul_f32 v[20:21], v[20:21], s[40:41] op_sel_hi:[1,0]
v_pk_mul_f32 v[22:23], v[22:23], s[40:41] op_sel_hi:[1,0]
v_cvt_pk_bf16_f32 v122, v20, v21
v_cvt_pk_bf16_f32 v123, v22, v23
s_add_u32 s24, s96, 790528
buffer_store_dwordx4 v[120:123], v13, s[8:11], s24 offen sc1
v_accvgpr_read_b32 v24, a60
v_accvgpr_read_b32 v25, a61
v_accvgpr_read_b32 v26, a62
v_accvgpr_read_b32 v27, a63
v_pk_mul_f32 v[24:25], v[24:25], s[40:41] op_sel_hi:[1,0]
v_pk_mul_f32 v[26:27], v[26:27], s[40:41] op_sel_hi:[1,0]
v_cvt_pk_bf16_f32 v124, v24, v25
v_cvt_pk_bf16_f32 v125, v26, v27
v_accvgpr_read_b32 v24, a92
v_accvgpr_read_b32 v25, a93
v_accvgpr_read_b32 v26, a94
v_accvgpr_read_b32 v27, a95
v_pk_mul_f32 v[24:25], v[24:25], s[40:41] op_sel_hi:[1,0]
v_pk_mul_f32 v[26:27], v[26:27], s[40:41] op_sel_hi:[1,0]
v_cvt_pk_bf16_f32 v126, v24, v25
v_cvt_pk_bf16_f32 v127, v26, v27
buffer_store_dwordx4 v[124:127], v13, s[8:11], s24 offen offset:128 sc1
v_accvgpr_read_b32 v20, a96
v_accvgpr_read_b32 v21, a97
v_accvgpr_read_b32 v22, a98
v_accvgpr_read_b32 v23, a99
v_pk_mul_f32 v[20:21], v[20:21], s[40:41] op_sel_hi:[1,0]
v_pk_mul_f32 v[22:23], v[22:23], s[40:41] op_sel_hi:[1,0]
v_cvt_pk_bf16_f32 v128, v20, v21
v_cvt_pk_bf16_f32 v129, v22, v23
v_accvgpr_read_b32 v20, a128
v_accvgpr_read_b32 v21, a129
v_accvgpr_read_b32 v22, a130
v_accvgpr_read_b32 v23, a131
v_pk_mul_f32 v[20:21], v[20:21], s[40:41] op_sel_hi:[1,0]
v_pk_mul_f32 v[22:23], v[22:23], s[40:41] op_sel_hi:[1,0]
v_cvt_pk_bf16_f32 v130, v20, v21
v_cvt_pk_bf16_f32 v131, v22, v23
s_add_u32 s24, s96, 6144
buffer_store_dwordx4 v[128:131], v13, s[8:11], s24 offen sc1
v_accvgpr_read_b32 v24, a100
v_accvgpr_read_b32 v25, a101
v_accvgpr_read_b32 v26, a102
v_accvgpr_read_b32 v27, a103
v_pk_mul_f32 v[24:25], v[24:25], s[40:41] op_sel_hi:[1,0]
v_pk_mul_f32 v[26:27], v[26:27], s[40:41] op_sel_hi:[1,0]
v_cvt_pk_bf16_f32 v132, v24, v25
v_cvt_pk_bf16_f32 v133, v26, v27
v_accvgpr_read_b32 v24, a132
v_accvgpr_read_b32 v25, a133
v_accvgpr_read_b32 v26, a134
v_accvgpr_read_b32 v27, a135
v_pk_mul_f32 v[24:25], v[24:25], s[40:41] op_sel_hi:[1,0]
v_pk_mul_f32 v[26:27], v[26:27], s[40:41] op_sel_hi:[1,0]
v_cvt_pk_bf16_f32 v134, v24, v25
v_cvt_pk_bf16_f32 v135, v26, v27
buffer_store_dwordx4 v[132:135], v13, s[8:11], s24 offen offset:128 sc1
v_accvgpr_read_b32 v20, a104
v_accvgpr_read_b32 v21, a105
v_accvgpr_read_b32 v22, a106
v_accvgpr_read_b32 v23, a107
v_pk_mul_f32 v[20:21], v[20:21], s[40:41] op_sel_hi:[1,0]
v_pk_mul_f32 v[22:23], v[22:23], s[40:41] op_sel_hi:[1,0]
v_cvt_pk_bf16_f32 v136, v20, v21
v_cvt_pk_bf16_f32 v137, v22, v23
v_accvgpr_read_b32 v20, a136
v_accvgpr_read_b32 v21, a137
v_accvgpr_read_b32 v22, a138
v_accvgpr_read_b32 v23, a139
v_pk_mul_f32 v[20:21], v[20:21], s[40:41] op_sel_hi:[1,0]
v_pk_mul_f32 v[22:23], v[22:23], s[40:41] op_sel_hi:[1,0]
v_cvt_pk_bf16_f32 v138, v20, v21
v_cvt_pk_bf16_f32 v139, v22, v23
s_add_u32 s24, s96, 268288
buffer_store_dwordx4 v[136:139], v13, s[8:11], s24 offen sc1
v_accvgpr_read_b32 v24, a108
v_accvgpr_read_b32 v25, a109
v_accvgpr_read_b32 v26, a110
v_accvgpr_read_b32 v27, a111
v_pk_mul_f32 v[24:25], v[24:25], s[40:41] op_sel_hi:[1,0]
v_pk_mul_f32 v[26:27], v[26:27], s[40:41] op_sel_hi:[1,0]
v_cvt_pk_bf16_f32 v140, v24, v25
v_cvt_pk_bf16_f32 v141, v26, v27
v_accvgpr_read_b32 v24, a140
v_accvgpr_read_b32 v25, a141
v_accvgpr_read_b32 v26, a142
v_accvgpr_read_b32 v27, a143
v_pk_mul_f32 v[24:25], v[24:25], s[40:41] op_sel_hi:[1,0]
v_pk_mul_f32 v[26:27], v[26:27], s[40:41] op_sel_hi:[1,0]
v_cvt_pk_bf16_f32 v142, v24, v25
v_cvt_pk_bf16_f32 v143, v26, v27
buffer_store_dwordx4 v[140:143], v13, s[8:11], s24 offen offset:128 sc1
v_accvgpr_read_b32 v20, a112
v_accvgpr_read_b32 v21, a113
v_accvgpr_read_b32 v22, a114
v_accvgpr_read_b32 v23, a115
v_pk_mul_f32 v[20:21], v[20:21], s[40:41] op_sel_hi:[1,0]
v_pk_mul_f32 v[22:23], v[22:23], s[40:41] op_sel_hi:[1,0]
v_cvt_pk_bf16_f32 v144, v20, v21
v_cvt_pk_bf16_f32 v145, v22, v23
v_accvgpr_read_b32 v20, a144
v_accvgpr_read_b32 v21, a145
v_accvgpr_read_b32 v22, a146
v_accvgpr_read_b32 v23, a147
v_pk_mul_f32 v[20:21], v[20:21], s[40:41] op_sel_hi:[1,0]
v_pk_mul_f32 v[22:23], v[22:23], s[40:41] op_sel_hi:[1,0]
v_cvt_pk_bf16_f32 v146, v20, v21
v_cvt_pk_bf16_f32 v147, v22, v23
s_add_u32 s24, s96, 530432
buffer_store_dwordx4 v[144:147], v13, s[8:11], s24 offen sc1
v_accvgpr_read_b32 v24, a116
v_accvgpr_read_b32 v25, a117
v_accvgpr_read_b32 v26, a118
v_accvgpr_read_b32 v27, a119
v_pk_mul_f32 v[24:25], v[24:25], s[40:41] op_sel_hi:[1,0]
v_pk_mul_f32 v[26:27], v[26:27], s[40:41] op_sel_hi:[1,0]
v_cvt_pk_bf16_f32 v148, v24, v25
v_cvt_pk_bf16_f32 v149, v26, v27
v_accvgpr_read_b32 v24, a148
v_accvgpr_read_b32 v25, a149
v_accvgpr_read_b32 v26, a150
v_accvgpr_read_b32 v27, a151
v_pk_mul_f32 v[24:25], v[24:25], s[40:41] op_sel_hi:[1,0]
v_pk_mul_f32 v[26:27], v[26:27], s[40:41] op_sel_hi:[1,0]
v_cvt_pk_bf16_f32 v150, v24, v25
v_cvt_pk_bf16_f32 v151, v26, v27
buffer_store_dwordx4 v[148:151], v13, s[8:11], s24 offen offset:128 sc1
v_accvgpr_read_b32 v20, a120
v_accvgpr_read_b32 v21, a121
v_accvgpr_read_b32 v22, a122
v_accvgpr_read_b32 v23, a123
v_pk_mul_f32 v[20:21], v[20:21], s[40:41] op_sel_hi:[1,0]
v_pk_mul_f32 v[22:23], v[22:23], s[40:41] op_sel_hi:[1,0]
v_cvt_pk_bf16_f32 v152, v20, v21
v_cvt_pk_bf16_f32 v153, v22, v23
v_accvgpr_read_b32 v20, a152
v_accvgpr_read_b32 v21, a153
v_accvgpr_read_b32 v22, a154
v_accvgpr_read_b32 v23, a155
v_pk_mul_f32 v[20:21], v[20:21], s[40:41] op_sel_hi:[1,0]
v_pk_mul_f32 v[22:23], v[22:23], s[40:41] op_sel_hi:[1,0]
v_cvt_pk_bf16_f32 v154, v20, v21
v_cvt_pk_bf16_f32 v155, v22, v23
s_add_u32 s24, s96, 792576
buffer_store_dwordx4 v[152:155], v13, s[8:11], s24 offen sc1
v_accvgpr_read_b32 v24, a124
v_accvgpr_read_b32 v25, a125
v_accvgpr_read_b32 v26, a126
v_accvgpr_read_b32 v27, a127
v_pk_mul_f32 v[24:25], v[24:25], s[40:41] op_sel_hi:[1,0]
v_pk_mul_f32 v[26:27], v[26:27], s[40:41] op_sel_hi:[1,0]
v_cvt_pk_bf16_f32 v156, v24, v25
v_cvt_pk_bf16_f32 v157, v26, v27
v_accvgpr_read_b32 v24, a156
v_accvgpr_read_b32 v25, a157
v_accvgpr_read_b32 v26, a158
v_accvgpr_read_b32 v27, a159
v_pk_mul_f32 v[24:25], v[24:25], s[40:41] op_sel_hi:[1,0]
v_pk_mul_f32 v[26:27], v[26:27], s[40:41] op_sel_hi:[1,0]
v_cvt_pk_bf16_f32 v158, v24, v25
v_cvt_pk_bf16_f32 v159, v26, v27
buffer_store_dwordx4 v[156:159], v13, s[8:11], s24 offen offset:128 sc1
s_waitcnt vmcnt(48) lgkmcnt(0)
L_at_qx:
s_barrier
v_and_b32 v13, 0x7ff, v7
s_lshr_b32 s24, s17, 1
s_lshl_b32 s24, s24, 13
s_add_u32 s24, s24, 98304
v_add_u32 v13, s24, v13
ds_read_b128 v[160:163], v13
ds_read_b128 v[164:167], v13 offset:2048
ds_read_b128 v[168:171], v13 offset:4096
ds_read_b128 v[172:175], v13 offset:6144
ds_read_b128 v[176:179], v13 offset:16384
ds_read_b128 v[180:183], v13 offset:18432
ds_read_b128 v[184:187], v13 offset:20480
ds_read_b128 v[188:191], v13 offset:22528
ds_read_b128 v[192:195], v13 offset:32768
ds_read_b128 v[196:199], v13 offset:34816
ds_read_b128 v[200:203], v13 offset:36864
ds_read_b128 v[204:207], v13 offset:38912
ds_read_b128 v[208:211], v13 offset:49152
ds_read_b128 v[212:215], v13 offset:51200
ds_read_b128 v[216:219], v13 offset:53248
ds_read_b128 v[220:223], v13 offset:55296
s_waitcnt lgkmcnt(0)
L_at_item:
s_lshl_b32 s44, s41, 2
s_mov_b32 s43, 0
s_mov_b32 s45, 2
s_mov_b32 s54, s50
s_mov_b32 s55, s50
v_mov_b32 v2, v6
v_add_u32 v3, 32768, v6
v_mov_b32 v4, v6
s_barrier
ds_read_b128 a[64:67], v2
ds_read_b128 a[68:71], v2 offset:1024
ds_read_b128 a[72:75], v2 offset:2048
v_mov_b64 v[112:113], 0
v_mov_b64 v[114:115], 0
v_mov_b64 v[116:117], 0
v_mov_b64 v[118:119], 0
v_mov_b64 v[120:121], 0
v_mov_b64 v[122:123], 0
v_mov_b64 v[124:125], 0
v_mov_b64 v[126:127], 0
v_mov_b64 v[128:129], 0
v_mov_b64 v[130:131], 0
v_mov_b64 v[132:133], 0
v_mov_b64 v[134:135], 0
v_mov_b64 v[136:137], 0
v_mov_b64 v[138:139], 0
v_mov_b64 v[140:141], 0
v_mov_b64 v[142:143], 0
v_mfma_f32_32x32x16_bf16 a[96:111], v[112:115], v[112:115], 0
v_accvgpr_write_b32 a0, v160
v_accvgpr_write_b32 a1, v161
v_accvgpr_write_b32 a2, v162
v_accvgpr_write_b32 a3, v163
v_accvgpr_write_b32 a4, v164
v_accvgpr_write_b32 a5, v165
v_accvgpr_write_b32 a6, v166
v_mfma_f32_32x32x16_bf16 a[112:127], v[112:115], v[112:115], 0
v_accvgpr_write_b32 a7, v167
v_accvgpr_write_b32 a8, v168
v_accvgpr_write_b32 a9, v169
v_accvgpr_write_b32 a10, v170
v_accvgpr_write_b32 a11, v171
v_accvgpr_write_b32 a12, v172
v_accvgpr_write_b32 a13, v173
v_mfma_f32_32x32x16_bf16 a[128:143], v[112:115], v[112:115], 0
v_accvgpr_write_b32 a14, v174
v_accvgpr_write_b32 a15, v175
v_accvgpr_write_b32 a16, v176
v_accvgpr_write_b32 a17, v177
v_accvgpr_write_b32 a18, v178
v_accvgpr_write_b32 a19, v179
v_accvgpr_write_b32 a20, v180
v_mfma_f32_32x32x16_bf16 a[144:159], v[112:115], v[112:115], 0
v_accvgpr_write_b32 a21, v181
v_accvgpr_write_b32 a22, v182
v_accvgpr_write_b32 a23, v183
v_accvgpr_write_b32 a24, v184
v_accvgpr_write_b32 a25, v185
v_accvgpr_write_b32 a26, v186
v_accvgpr_write_b32 a27, v187
v_mfma_f32_32x32x16_bf16 a[160:175], v[112:115], v[112:115], 0
v_accvgpr_write_b32 a28, v188
v_accvgpr_write_b32 a29, v189
v_accvgpr_write_b32 a30, v190
v_accvgpr_write_b32 a31, v191
v_accvgpr_write_b32 a32, v192
v_accvgpr_write_b32 a33, v193
v_accvgpr_write_b32 a34, v194
v_accvgpr_write_b32 a35, v195
v_mfma_f32_32x32x16_bf16 a[176:191], v[112:115], v[112:115], 0
v_accvgpr_write_b32 a36, v196
v_accvgpr_write_b32 a37, v197
v_accvgpr_write_b32 a38, v198
v_accvgpr_write_b32 a39, v199
v_accvgpr_write_b32 a40, v200
v_accvgpr_write_b32 a41, v201
v_accvgpr_write_b32 a42, v202
v_mfma_f32_32x32x16_bf16 a[192:207], v[112:115], v[112:115], 0
v_accvgpr_write_b32 a43, v203
v_accvgpr_write_b32 a44, v204
v_accvgpr_write_b32 a45, v205
v_accvgpr_write_b32 a46, v206
v_accvgpr_write_b32 a47, v207
v_accvgpr_write_b32 a48, v208
v_accvgpr_write_b32 a49, v209
v_mfma_f32_32x32x16_bf16 a[208:223], v[112:115], v[112:115], 0
v_accvgpr_write_b32 a50, v210
v_accvgpr_write_b32 a51, v211
v_accvgpr_write_b32 a52, v212
v_accvgpr_write_b32 a53, v213
v_accvgpr_write_b32 a54, v214
v_accvgpr_write_b32 a55, v215
v_accvgpr_write_b32 a56, v216
v_mfma_f32_32x32x16_bf16 a[224:239], v[112:115], v[112:115], 0
v_accvgpr_write_b32 a57, v217
v_accvgpr_write_b32 a58, v218
v_accvgpr_write_b32 a59, v219
v_accvgpr_write_b32 a60, v220
v_accvgpr_write_b32 a61, v221
v_accvgpr_write_b32 a62, v222
v_accvgpr_write_b32 a63, v223
s_waitcnt lgkmcnt(2)
v_mfma_f32_16x16x32_bf16 v[32:35], a[64:67], a[0:3], v[128:131]
ds_read_b128 a[76:79], v2 offset:3072
v_mfma_f32_16x16x32_bf16 v[40:43], a[64:67], a[16:19], v[132:135]
v_mfma_f32_16x16x32_bf16 v[48:51], a[64:67], a[32:35], v[136:139]
v_mfma_f32_16x16x32_bf16 v[56:59], a[64:67], a[48:51], v[140:143]
s_waitcnt lgkmcnt(2)
v_mfma_f32_16x16x32_bf16 v[36:39], a[68:71], a[0:3], v[128:131]
ds_read_b128 a[80:83], v2 offset:4096
v_mfma_f32_16x16x32_bf16 v[44:47], a[68:71], a[16:19], v[132:135]
v_mfma_f32_16x16x32_bf16 v[52:55], a[68:71], a[32:35], v[136:139]
v_mfma_f32_16x16x32_bf16 v[60:63], a[68:71], a[48:51], v[140:143]
s_waitcnt lgkmcnt(2)
v_mfma_f32_16x16x32_bf16 v[32:35], a[72:75], a[4:7], v[32:35]
ds_read_b128 a[84:87], v2 offset:5120
v_mfma_f32_16x16x32_bf16 v[40:43], a[72:75], a[20:23], v[40:43]
v_mfma_f32_16x16x32_bf16 v[48:51], a[72:75], a[36:39], v[48:51]
v_mfma_f32_16x16x32_bf16 v[56:59], a[72:75], a[52:55], v[56:59]
s_waitcnt lgkmcnt(2)
v_mfma_f32_16x16x32_bf16 v[36:39], a[76:79], a[4:7], v[36:39]
ds_read_b128 a[88:91], v2 offset:6144
v_mfma_f32_16x16x32_bf16 v[44:47], a[76:79], a[20:23], v[44:47]
v_mfma_f32_16x16x32_bf16 v[52:55], a[76:79], a[36:39], v[52:55]
v_mfma_f32_16x16x32_bf16 v[60:63], a[76:79], a[52:55], v[60:63]
s_waitcnt lgkmcnt(2)
v_mfma_f32_16x16x32_bf16 v[32:35], a[80:83], a[8:11], v[32:35]
ds_read_b128 a[92:95], v2 offset:7168
v_mfma_f32_16x16x32_bf16 v[40:43], a[80:83], a[24:27], v[40:43]
v_mfma_f32_16x16x32_bf16 v[48:51], a[80:83], a[40:43], v[48:51]
v_mfma_f32_16x16x32_bf16 v[56:59], a[80:83], a[56:59], v[56:59]
s_waitcnt lgkmcnt(2)
v_mfma_f32_16x16x32_bf16 v[36:39], a[84:87], a[8:11], v[36:39]
ds_read_b128 a[64:67], v4 offset:24576
v_mfma_f32_16x16x32_bf16 v[44:47], a[84:87], a[24:27], v[44:47]
v_mfma_f32_16x16x32_bf16 v[52:55], a[84:87], a[40:43], v[52:55]
v_mfma_f32_16x16x32_bf16 v[60:63], a[84:87], a[56:59], v[60:63]
s_waitcnt lgkmcnt(2)
v_mfma_f32_16x16x32_bf16 v[32:35], a[88:91], a[12:15], v[32:35]
ds_read_b128 a[68:71], v4 offset:25600
v_mfma_f32_16x16x32_bf16 v[40:43], a[88:91], a[28:31], v[40:43]
v_mfma_f32_16x16x32_bf16 v[48:51], a[88:91], a[44:47], v[48:51]
v_mfma_f32_16x16x32_bf16 v[56:59], a[88:91], a[60:63], v[56:59]
s_waitcnt lgkmcnt(2)
v_mfma_f32_16x16x32_bf16 v[36:39], a[92:95], a[12:15], v[36:39]
ds_read_b128 a[72:75], v4 offset:26624
v_mfma_f32_16x16x32_bf16 v[44:47], a[92:95], a[28:31], v[44:47]
v_mfma_f32_16x16x32_bf16 v[52:55], a[92:95], a[44:47], v[52:55]
v_mfma_f32_16x16x32_bf16 v[60:63], a[92:95], a[60:63], v[60:63]
s_waitcnt lgkmcnt(2)
s_cmp_eq_u32 s44, 0
s_cbranch_scc1 L_at_last
.p2align 3
L_at_loop:
v_mfma_f32_16x16x32_bf16 a[224:227], a[240:243], v[112:115], a[224:227]
s_add_u32 s43, s43, 1
v_mfma_f32_16x16x32_bf16 a[228:231], a[240:243], v[116:119], a[228:231]
v_mfma_f32_16x16x32_bf16 a[232:235], a[240:243], v[120:123], a[232:235]
v_mfma_f32_16x16x32_bf16 a[236:239], a[240:243], v[124:127], a[236:239]
v_max3_f32 v16, v32, v33, v34
v_max3_f32 v16, v16, v35, v40
v_mfma_f32_16x16x32_bf16 a[96:99], a[64:67], v[112:115], a[96:99]
ds_read_b128 a[76:79], v4 offset:27648
v_max3_f32 v16, v16, v41, v42
v_mfma_f32_16x16x32_bf16 a[100:103], a[64:67], v[116:119], a[100:103]
v_max3_f32 v16, v16, v43, v48
v_max3_f32 v16, v16, v49, v50
v_mfma_f32_16x16x32_bf16 a[104:107], a[64:67], v[120:123], a[104:107]
v_max3_f32 v16, v16, v51, v56
v_max3_f32 v16, v16, v57, v58
v_mfma_f32_16x16x32_bf16 a[108:111], a[64:67], v[124:127], a[108:111]
s_waitcnt lgkmcnt(2)
v_max3_f32 v16, v16, v59, v36
v_max3_f32 v16, v16, v37, v38
v_mfma_f32_16x16x32_bf16 a[112:115], a[68:71], v[112:115], a[112:115]
ds_read_b128 a[80:83], v4 offset:28672
v_max3_f32 v16, v16, v39, v44
v_mfma_f32_16x16x32_bf16 a[116:119], a[68:71], v[116:119], a[116:119]
v_max3_f32 v16, v16, v45, v46
v_max3_f32 v16, v16, v47, v52
v_mfma_f32_16x16x32_bf16 a[120:123], a[68:71], v[120:123], a[120:123]
v_max3_f32 v16, v16, v53, v54
v_max3_f32 v16, v16, v55, v60
v_mfma_f32_16x16x32_bf16 a[124:127], a[68:71], v[124:127], a[124:127]
s_waitcnt lgkmcnt(2)
v_max3_f32 v16, v16, v61, v62
v_max_f32 v16, v16, v63
v_mfma_f32_16x16x32_bf16 a[128:131], a[72:75], v[112:115], a[128:131]
ds_read_b128 a[84:87], v4 offset:29696
v_cmp_lt_f32 vcc, s54, v16
v_mfma_f32_16x16x32_bf16 a[132:135], a[72:75], v[116:119], a[132:135]
s_cbranch_vccnz L_at_up0
L_at_upr0:
v_mfma_f32_16x16x32_bf16 a[136:139], a[72:75], v[120:123], a[136:139]
v_exp_f32 v32, v32
v_mfma_f32_16x16x32_bf16 a[140:143], a[72:75], v[124:127], a[140:143]
s_waitcnt lgkmcnt(2)
v_exp_f32 v33, v33
v_mfma_f32_16x16x32_bf16 a[144:147], a[76:79], v[112:115], a[144:147]
ds_read_b128 a[88:91], v4 offset:30720
v_cvt_pk_bf16_f32 v96, v32, v33
v_mfma_f32_16x16x32_bf16 a[148:151], a[76:79], v[116:119], a[148:151]
v_exp_f32 v34, v34
v_mfma_f32_16x16x32_bf16 a[152:155], a[76:79], v[120:123], a[152:155]
v_exp_f32 v35, v35
v_mfma_f32_16x16x32_bf16 a[156:159], a[76:79], v[124:127], a[156:159]
s_waitcnt lgkmcnt(2)
v_exp_f32 v36, v36
v_mfma_f32_16x16x32_bf16 a[160:163], a[80:83], v[112:115], a[160:163]
ds_read_b128 a[92:95], v4 offset:31744
v_cvt_pk_bf16_f32 v97, v34, v35
v_mfma_f32_16x16x32_bf16 a[164:167], a[80:83], v[116:119], a[164:167]
v_exp_f32 v37, v37
v_mfma_f32_16x16x32_bf16 a[168:171], a[80:83], v[120:123], a[168:171]
v_exp_f32 v38, v38
v_mfma_f32_16x16x32_bf16 a[172:175], a[80:83], v[124:127], a[172:175]
s_waitcnt lgkmcnt(2)
v_exp_f32 v39, v39
v_mfma_f32_16x16x32_bf16 a[176:179], a[84:87], v[112:115], a[176:179]
ds_read_b128 a[64:67], v2 offset:16384
v_cvt_pk_bf16_f32 v98, v36, v37
v_mfma_f32_16x16x32_bf16 a[180:183], a[84:87], v[116:119], a[180:183]
v_exp_f32 v40, v40
v_mfma_f32_16x16x32_bf16 a[184:187], a[84:87], v[120:123], a[184:187]
v_exp_f32 v41, v41
v_mfma_f32_16x16x32_bf16 a[188:191], a[84:87], v[124:127], a[188:191]
s_waitcnt lgkmcnt(2)
v_exp_f32 v42, v42
v_mfma_f32_16x16x32_bf16 a[192:195], a[88:91], v[112:115], a[192:195]
ds_read_b128 a[68:71], v2 offset:17408
v_cvt_pk_bf16_f32 v99, v38, v39
v_mfma_f32_16x16x32_bf16 a[196:199], a[88:91], v[116:119], a[196:199]
v_exp_f32 v43, v43
v_mfma_f32_16x16x32_bf16 a[200:203], a[88:91], v[120:123], a[200:203]
v_exp_f32 v44, v44
v_mfma_f32_16x16x32_bf16 a[204:207], a[88:91], v[124:127], a[204:207]
s_waitcnt lgkmcnt(2)
v_exp_f32 v45, v45
v_mfma_f32_16x16x32_bf16 a[208:211], a[92:95], v[112:115], a[208:211]
ds_read_b128 a[72:75], v2 offset:18432
v_cvt_pk_bf16_f32 v100, v40, v41
v_mfma_f32_16x16x32_bf16 a[212:215], a[92:95], v[116:119], a[212:215]
v_exp_f32 v46, v46
v_mfma_f32_16x16x32_bf16 a[216:219], a[92:95], v[120:123], a[216:219]
s_cmp_eq_u32 s48, 0
v_exp_f32 v47, v47
v_mfma_f32_16x16x32_bf16 a[220:223], a[92:95], v[124:127], a[220:223]
s_waitcnt lgkmcnt(2)
s_cbranch_scc0 L_at_rs0
L_at_rsr0:
v_mfma_f32_16x16x32_bf16 v[64:67], a[64:67], a[0:3], v[128:131]
ds_read_b128 a[76:79], v2 offset:19456
v_cvt_pk_bf16_f32 v101, v42, v43
v_mfma_f32_16x16x32_bf16 v[72:75], a[64:67], a[16:19], v[132:135]
v_exp_f32 v48, v48
v_mfma_f32_16x16x32_bf16 v[80:83], a[64:67], a[32:35], v[136:139]
v_exp_f32 v49, v49
v_mfma_f32_16x16x32_bf16 v[88:91], a[64:67], a[48:51], v[140:143]
s_waitcnt lgkmcnt(2)
v_exp_f32 v50, v50
v_mfma_f32_16x16x32_bf16 v[68:71], a[68:71], a[0:3], v[128:131]
ds_read_b128 a[80:83], v2 offset:20480
v_cvt_pk_bf16_f32 v102, v44, v45
v_mfma_f32_16x16x32_bf16 v[76:79], a[68:71], a[16:19], v[132:135]
v_exp_f32 v51, v51
v_mfma_f32_16x16x32_bf16 v[84:87], a[68:71], a[32:35], v[136:139]
v_exp_f32 v52, v52
v_mfma_f32_16x16x32_bf16 v[92:95], a[68:71], a[48:51], v[140:143]
s_waitcnt lgkmcnt(2)
v_exp_f32 v53, v53
v_mfma_f32_16x16x32_bf16 v[64:67], a[72:75], a[4:7], v[64:67]
ds_read_b128 a[84:87], v2 offset:21504
v_cvt_pk_bf16_f32 v103, v46, v47
v_mfma_f32_16x16x32_bf16 v[72:75], a[72:75], a[20:23], v[72:75]
v_exp_f32 v54, v54
v_mfma_f32_16x16x32_bf16 v[80:83], a[72:75], a[36:39], v[80:83]
v_exp_f32 v55, v55
v_mfma_f32_16x16x32_bf16 v[88:91], a[72:75], a[52:55], v[88:91]
s_waitcnt lgkmcnt(2)
v_exp_f32 v56, v56
v_mfma_f32_16x16x32_bf16 v[68:71], a[76:79], a[4:7], v[68:71]
ds_read_b128 a[88:91], v2 offset:22528
v_cvt_pk_bf16_f32 v104, v48, v49
v_mfma_f32_16x16x32_bf16 v[76:79], a[76:79], a[20:23], v[76:79]
v_exp_f32 v57, v57
v_mfma_f32_16x16x32_bf16 v[84:87], a[76:79], a[36:39], v[84:87]
v_exp_f32 v58, v58
v_mfma_f32_16x16x32_bf16 v[92:95], a[76:79], a[52:55], v[92:95]
s_waitcnt lgkmcnt(2)
v_exp_f32 v59, v59
v_mfma_f32_16x16x32_bf16 v[64:67], a[80:83], a[8:11], v[64:67]
ds_read_b128 a[92:95], v2 offset:23552
v_cvt_pk_bf16_f32 v105, v50, v51
v_mfma_f32_16x16x32_bf16 v[72:75], a[80:83], a[24:27], v[72:75]
v_exp_f32 v60, v60
v_mfma_f32_16x16x32_bf16 v[80:83], a[80:83], a[40:43], v[80:83]
v_exp_f32 v61, v61
v_mfma_f32_16x16x32_bf16 v[88:91], a[80:83], a[56:59], v[88:91]
s_waitcnt lgkmcnt(2)
v_exp_f32 v62, v62
v_mfma_f32_16x16x32_bf16 v[68:71], a[84:87], a[8:11], v[68:71]
ds_read_b128 a[64:67], v2 offset:8192
v_cvt_pk_bf16_f32 v106, v52, v53
v_mfma_f32_16x16x32_bf16 v[76:79], a[84:87], a[24:27], v[76:79]
v_exp_f32 v63, v63
v_mfma_f32_16x16x32_bf16 v[84:87], a[84:87], a[40:43], v[84:87]
v_cvt_pk_bf16_f32 v107, v54, v55
v_cvt_pk_bf16_f32 v108, v56, v57
v_mfma_f32_16x16x32_bf16 v[92:95], a[84:87], a[56:59], v[92:95]
s_waitcnt lgkmcnt(2)
v_cvt_pk_bf16_f32 v109, v58, v59
v_cvt_pk_bf16_f32 v110, v60, v61
v_mfma_f32_16x16x32_bf16 v[64:67], a[88:91], a[12:15], v[64:67]
ds_read_b128 a[68:71], v2 offset:9216
v_cvt_pk_bf16_f32 v111, v62, v63
v_mfma_f32_16x16x32_bf16 v[72:75], a[88:91], a[28:31], v[72:75]
v_mfma_f32_16x16x32_bf16 v[80:83], a[88:91], a[44:47], v[80:83]
v_mfma_f32_16x16x32_bf16 v[88:91], a[88:91], a[60:63], v[88:91]
s_waitcnt lgkmcnt(2)
v_mfma_f32_16x16x32_bf16 v[68:71], a[92:95], a[12:15], v[68:71]
ds_read_b128 a[72:75], v2 offset:10240
v_mfma_f32_16x16x32_bf16 v[76:79], a[92:95], a[28:31], v[76:79]
s_cmp_eq_u32 s43, s45
v_mfma_f32_16x16x32_bf16 v[84:87], a[92:95], a[44:47], v[84:87]
v_mfma_f32_16x16x32_bf16 v[92:95], a[92:95], a[60:63], v[92:95]
s_waitcnt lgkmcnt(2)
s_waitcnt vmcnt(8)
s_barrier
s_cbranch_scc1 L_at_hk
L_at_hkr:
v_mfma_f32_16x16x32_bf16 a[224:227], a[240:243], v[96:99], a[224:227]
s_add_u32 s24, s46, 4096
s_add_u32 m0, s47, 0
v_mfma_f32_16x16x32_bf16 a[228:231], a[240:243], v[100:103], a[228:231]
buffer_load_dwordx4 v1, s[8:11], s46 offen sc1 lds
v_mfma_f32_16x16x32_bf16 a[232:235], a[240:243], v[104:107], a[232:235]
buffer_load_dwordx4 v1, s[8:11], s46 offen offset:2048 sc1 lds
v_mfma_f32_16x16x32_bf16 a[236:239], a[240:243], v[108:111], a[236:239]
v_max3_f32 v16, v64, v65, v66
v_max3_f32 v16, v16, v67, v72
v_mfma_f32_16x16x32_bf16 a[96:99], a[64:67], v[96:99], a[96:99]
ds_read_b128 a[76:79], v2 offset:11264
v_max3_f32 v16, v16, v73, v74
v_mfma_f32_16x16x32_bf16 a[100:103], a[64:67], v[100:103], a[100:103]
s_add_u32 m0, s47, 896
v_max3_f32 v16, v16, v75, v80
v_max3_f32 v16, v16, v81, v82
v_mfma_f32_16x16x32_bf16 a[104:107], a[64:67], v[104:107], a[104:107]
v_max3_f32 v16, v16, v83, v88
v_max3_f32 v16, v16, v89, v90
v_mfma_f32_16x16x32_bf16 a[108:111], a[64:67], v[108:111], a[108:111]
s_waitcnt lgkmcnt(2)
v_max3_f32 v16, v16, v91, v68
v_max3_f32 v16, v16, v69, v70
v_mfma_f32_16x16x32_bf16 a[112:115], a[68:71], v[96:99], a[112:115]
ds_read_b128 a[80:83], v2 offset:12288
v_max3_f32 v16, v16, v71, v76
v_mfma_f32_16x16x32_bf16 a[116:119], a[68:71], v[100:103], a[116:119]
buffer_load_dwordx4 v1, s[8:11], s46 offen offset:128 sc1 lds
v_max3_f32 v16, v16, v77, v78
v_mfma_f32_16x16x32_bf16 a[120:123], a[68:71], v[104:107], a[120:123]
v_max3_f32 v16, v16, v79, v84
v_max3_f32 v16, v16, v85, v86
v_mfma_f32_16x16x32_bf16 a[124:127], a[68:71], v[108:111], a[124:127]
s_waitcnt lgkmcnt(2)
v_max3_f32 v16, v16, v87, v92
v_max3_f32 v16, v16, v93, v94
v_mfma_f32_16x16x32_bf16 a[128:131], a[72:75], v[96:99], a[128:131]
ds_read_b128 a[84:87], v2 offset:13312
v_max_f32 v16, v16, v95
v_cmp_lt_f32 vcc, s54, v16
v_mfma_f32_16x16x32_bf16 a[132:135], a[72:75], v[100:103], a[132:135]
buffer_load_dwordx4 v1, s[8:11], s46 offen offset:2176 sc1 lds
s_cbranch_vccnz L_at_up1
L_at_upr1:
v_mfma_f32_16x16x32_bf16 a[136:139], a[72:75], v[104:107], a[136:139]
v_exp_f32 v64, v64
v_mfma_f32_16x16x32_bf16 a[140:143], a[72:75], v[108:111], a[140:143]
s_waitcnt lgkmcnt(2)
v_exp_f32 v65, v65
v_mfma_f32_16x16x32_bf16 a[144:147], a[76:79], v[96:99], a[144:147]
ds_read_b128 a[88:91], v2 offset:14336
v_cvt_pk_bf16_f32 v112, v64, v65
v_mfma_f32_16x16x32_bf16 a[148:151], a[76:79], v[100:103], a[148:151]
v_exp_f32 v66, v66
v_mfma_f32_16x16x32_bf16 a[152:155], a[76:79], v[104:107], a[152:155]
s_add_u32 m0, s47, 4096
v_exp_f32 v67, v67
v_mfma_f32_16x16x32_bf16 a[156:159], a[76:79], v[108:111], a[156:159]
s_waitcnt lgkmcnt(2)
v_exp_f32 v68, v68
v_mfma_f32_16x16x32_bf16 a[160:163], a[80:83], v[96:99], a[160:163]
ds_read_b128 a[92:95], v2 offset:15360
v_cvt_pk_bf16_f32 v113, v66, v67
v_mfma_f32_16x16x32_bf16 a[164:167], a[80:83], v[100:103], a[164:167]
v_exp_f32 v69, v69
v_mfma_f32_16x16x32_bf16 a[168:171], a[80:83], v[104:107], a[168:171]
buffer_load_dwordx4 v1, s[8:11], s24 offen sc1 lds
v_cvt_pk_bf16_f32 v114, v68, v69
v_mfma_f32_16x16x32_bf16 a[172:175], a[80:83], v[108:111], a[172:175]
s_waitcnt lgkmcnt(2)
v_exp_f32 v70, v70
v_mfma_f32_16x16x32_bf16 a[176:179], a[84:87], v[96:99], a[176:179]
ds_read_b128 a[64:67], v3
v_mfma_f32_16x16x32_bf16 a[180:183], a[84:87], v[100:103], a[180:183]
v_exp_f32 v71, v71
v_mfma_f32_16x16x32_bf16 a[184:187], a[84:87], v[104:107], a[184:187]
v_exp_f32 v72, v72
v_mfma_f32_16x16x32_bf16 a[188:191], a[84:87], v[108:111], a[188:191]
s_waitcnt lgkmcnt(2)
v_exp_f32 v73, v73
v_mfma_f32_16x16x32_bf16 a[192:195], a[88:91], v[96:99], a[192:195]
ds_read_b128 a[68:71], v3 offset:1024
v_cvt_pk_bf16_f32 v115, v70, v71
v_mfma_f32_16x16x32_bf16 a[196:199], a[88:91], v[100:103], a[196:199]
buffer_load_dwordx4 v1, s[8:11], s24 offen offset:2048 sc1 lds
v_cvt_pk_bf16_f32 v116, v72, v73
v_mfma_f32_16x16x32_bf16 a[200:203], a[88:91], v[104:107], a[200:203]
v_exp_f32 v74, v74
v_mfma_f32_16x16x32_bf16 a[204:207], a[88:91], v[108:111], a[204:207]
s_waitcnt lgkmcnt(2)
v_exp_f32 v75, v75
v_mfma_f32_16x16x32_bf16 a[208:211], a[92:95], v[96:99], a[208:211]
ds_read_b128 a[72:75], v3 offset:2048
v_cvt_pk_bf16_f32 v117, v74, v75
v_mfma_f32_16x16x32_bf16 a[212:215], a[92:95], v[100:103], a[212:215]
s_add_u32 m0, s47, 4992
v_exp_f32 v76, v76
v_mfma_f32_16x16x32_bf16 a[216:219], a[92:95], v[104:107], a[216:219]
s_cmp_eq_u32 s48, 0
v_exp_f32 v77, v77
v_mfma_f32_16x16x32_bf16 a[220:223], a[92:95], v[108:111], a[220:223]
s_waitcnt lgkmcnt(2)
s_cbranch_scc0 L_at_rs1
L_at_rsr1:
v_mfma_f32_16x16x32_bf16 v[32:35], a[64:67], a[0:3], v[128:131]
ds_read_b128 a[76:79], v3 offset:3072
v_cvt_pk_bf16_f32 v118, v76, v77
v_mfma_f32_16x16x32_bf16 v[40:43], a[64:67], a[16:19], v[132:135]
v_exp_f32 v78, v78
v_mfma_f32_16x16x32_bf16 v[48:51], a[64:67], a[32:35], v[136:139]
buffer_load_dwordx4 v1, s[8:11], s24 offen offset:128 sc1 lds
v_mfma_f32_16x16x32_bf16 v[56:59], a[64:67], a[48:51], v[140:143]
s_waitcnt lgkmcnt(2)
v_exp_f32 v79, v79
v_mfma_f32_16x16x32_bf16 v[36:39], a[68:71], a[0:3], v[128:131]
ds_read_b128 a[80:83], v3 offset:4096
v_cvt_pk_bf16_f32 v119, v78, v79
v_mfma_f32_16x16x32_bf16 v[44:47], a[68:71], a[16:19], v[132:135]
v_exp_f32 v80, v80
v_mfma_f32_16x16x32_bf16 v[52:55], a[68:71], a[32:35], v[136:139]
v_exp_f32 v81, v81
v_mfma_f32_16x16x32_bf16 v[60:63], a[68:71], a[48:51], v[140:143]
s_waitcnt lgkmcnt(2)
v_exp_f32 v82, v82
v_mfma_f32_16x16x32_bf16 v[32:35], a[72:75], a[4:7], v[32:35]
ds_read_b128 a[84:87], v3 offset:5120
v_cvt_pk_bf16_f32 v120, v80, v81
v_mfma_f32_16x16x32_bf16 v[40:43], a[72:75], a[20:23], v[40:43]
buffer_load_dwordx4 v1, s[8:11], s24 offen offset:2176 sc1 lds
v_mfma_f32_16x16x32_bf16 v[48:51], a[72:75], a[36:39], v[48:51]
v_exp_f32 v83, v83
v_mfma_f32_16x16x32_bf16 v[56:59], a[72:75], a[52:55], v[56:59]
s_waitcnt lgkmcnt(2)
v_exp_f32 v84, v84
v_mfma_f32_16x16x32_bf16 v[36:39], a[76:79], a[4:7], v[36:39]
ds_read_b128 a[88:91], v3 offset:6144
v_cvt_pk_bf16_f32 v121, v82, v83
v_mfma_f32_16x16x32_bf16 v[44:47], a[76:79], a[20:23], v[44:47]
s_add_u32 s46, s46, 1048576
v_exp_f32 v85, v85
v_mfma_f32_16x16x32_bf16 v[52:55], a[76:79], a[36:39], v[52:55]
v_exp_f32 v86, v86
v_mfma_f32_16x16x32_bf16 v[60:63], a[76:79], a[52:55], v[60:63]
s_waitcnt lgkmcnt(2)
v_exp_f32 v87, v87
v_mfma_f32_16x16x32_bf16 v[32:35], a[80:83], a[8:11], v[32:35]
ds_read_b128 a[92:95], v3 offset:7168
v_cvt_pk_bf16_f32 v122, v84, v85
v_mfma_f32_16x16x32_bf16 v[40:43], a[80:83], a[24:27], v[40:43]
v_exp_f32 v88, v88
v_mfma_f32_16x16x32_bf16 v[48:51], a[80:83], a[40:43], v[48:51]
s_add_u32 s47, s47, 32768
v_exp_f32 v89, v89
v_mfma_f32_16x16x32_bf16 v[56:59], a[80:83], a[56:59], v[56:59]
s_waitcnt lgkmcnt(2)
v_exp_f32 v90, v90
v_mfma_f32_16x16x32_bf16 v[36:39], a[84:87], a[8:11], v[36:39]
ds_read_b128 a[64:67], v2 offset:24576
v_cvt_pk_bf16_f32 v123, v86, v87
v_mfma_f32_16x16x32_bf16 v[44:47], a[84:87], a[24:27], v[44:47]
v_exp_f32 v91, v91
v_mfma_f32_16x16x32_bf16 v[52:55], a[84:87], a[40:43], v[52:55]
s_and_b32 s47, s47, 131071
v_exp_f32 v92, v92
v_mfma_f32_16x16x32_bf16 v[60:63], a[84:87], a[56:59], v[60:63]
s_waitcnt lgkmcnt(2)
v_exp_f32 v93, v93
v_mfma_f32_16x16x32_bf16 v[32:35], a[88:91], a[12:15], v[32:35]
ds_read_b128 a[68:71], v2 offset:25600
v_cvt_pk_bf16_f32 v124, v88, v89
v_mfma_f32_16x16x32_bf16 v[40:43], a[88:91], a[28:31], v[40:43]
v_exp_f32 v94, v94
v_mfma_f32_16x16x32_bf16 v[48:51], a[88:91], a[44:47], v[48:51]
v_exp_f32 v95, v95
v_mfma_f32_16x16x32_bf16 v[56:59], a[88:91], a[60:63], v[56:59]
s_waitcnt lgkmcnt(2)
v_cvt_pk_bf16_f32 v125, v90, v91
v_cvt_pk_bf16_f32 v126, v92, v93
v_mfma_f32_16x16x32_bf16 v[36:39], a[92:95], a[12:15], v[36:39]
ds_read_b128 a[72:75], v2 offset:26624
v_cvt_pk_bf16_f32 v127, v94, v95
v_mfma_f32_16x16x32_bf16 v[44:47], a[92:95], a[28:31], v[44:47]
s_cmp_lt_u32 s43, s44
v_mov_b32 v4, v2
v_mov_b32 v2, v3
v_mfma_f32_16x16x32_bf16 v[52:55], a[92:95], a[44:47], v[52:55]
v_add_u32 v3, 32768, v3
v_and_b32 v3, 131071, v3
v_mfma_f32_16x16x32_bf16 v[60:63], a[92:95], a[60:63], v[60:63]
s_waitcnt lgkmcnt(2)
s_cbranch_scc1 L_at_loop
L_at_last:
v_mfma_f32_16x16x32_bf16 a[224:227], a[240:243], v[112:115], a[224:227]
s_lshl_b32 s61, s41, 4
v_mfma_f32_16x16x32_bf16 a[228:231], a[240:243], v[116:119], a[228:231]
v_mfma_f32_16x16x32_bf16 a[232:235], a[240:243], v[120:123], a[232:235]
v_mfma_f32_16x16x32_bf16 a[236:239], a[240:243], v[124:127], a[236:239]
v_cndmask_b32 v32, v8, v32, s[64:65]
v_cndmask_b32 v33, v8, v33, s[66:67]
v_mfma_f32_16x16x32_bf16 a[96:99], a[64:67], v[112:115], a[96:99]
ds_read_b128 a[76:79], v4 offset:27648
v_cndmask_b32 v34, v8, v34, s[68:69]
v_mfma_f32_16x16x32_bf16 a[100:103], a[64:67], v[116:119], a[100:103]
v_cndmask_b32 v35, v8, v35, s[70:71]
v_cndmask_b32 v36, v8, v36, s[72:73]
v_mfma_f32_16x16x32_bf16 a[104:107], a[64:67], v[120:123], a[104:107]
s_add_u32 s61, s61, s17
v_cndmask_b32 v37, v8, v37, s[74:75]
v_cndmask_b32 v38, v8, v38, s[76:77]
v_mfma_f32_16x16x32_bf16 a[108:111], a[64:67], v[124:127], a[108:111]
s_waitcnt lgkmcnt(2)
v_cndmask_b32 v39, v8, v39, s[78:79]
v_max3_f32 v16, v32, v33, v34
v_mfma_f32_16x16x32_bf16 a[112:115], a[68:71], v[112:115], a[112:115]
ds_read_b128 a[80:83], v4 offset:28672
v_max3_f32 v16, v16, v35, v40
v_mfma_f32_16x16x32_bf16 a[116:119], a[68:71], v[116:119], a[116:119]
v_max3_f32 v16, v16, v41, v42
v_max3_f32 v16, v16, v43, v48
v_mfma_f32_16x16x32_bf16 a[120:123], a[68:71], v[120:123], a[120:123]
v_max3_f32 v16, v16, v49, v50
v_max3_f32 v16, v16, v51, v56
v_mfma_f32_16x16x32_bf16 a[124:127], a[68:71], v[124:127], a[124:127]
s_waitcnt lgkmcnt(2)
v_max3_f32 v16, v16, v57, v58
v_max3_f32 v16, v16, v59, v36
v_mfma_f32_16x16x32_bf16 a[128:131], a[72:75], v[112:115], a[128:131]
ds_read_b128 a[84:87], v4 offset:29696
v_max3_f32 v16, v16, v37, v38
v_mfma_f32_16x16x32_bf16 a[132:135], a[72:75], v[116:119], a[132:135]
v_max3_f32 v16, v16, v39, v44
v_max3_f32 v16, v16, v45, v46
v_mfma_f32_16x16x32_bf16 a[136:139], a[72:75], v[120:123], a[136:139]
v_max3_f32 v16, v16, v47, v52
v_max3_f32 v16, v16, v53, v54
v_mfma_f32_16x16x32_bf16 a[140:143], a[72:75], v[124:127], a[140:143]
s_waitcnt lgkmcnt(2)
v_max3_f32 v16, v16, v55, v60
v_max3_f32 v16, v16, v61, v62
v_mfma_f32_16x16x32_bf16 a[144:147], a[76:79], v[112:115], a[144:147]
ds_read_b128 a[88:91], v4 offset:30720
v_max_f32 v16, v16, v63
v_mfma_f32_16x16x32_bf16 a[148:151], a[76:79], v[116:119], a[148:151]
v_cmp_lt_f32 vcc, s54, v16
v_mfma_f32_16x16x32_bf16 a[152:155], a[76:79], v[120:123], a[152:155]
s_lshl_b32 s61, s61, 5
s_cbranch_vccnz L_at_up2
L_at_upr2:
v_mfma_f32_16x16x32_bf16 a[156:159], a[76:79], v[124:127], a[156:159]
s_waitcnt lgkmcnt(2)
v_exp_f32 v32, v32
v_mfma_f32_16x16x32_bf16 a[160:163], a[80:83], v[112:115], a[160:163]
ds_read_b128 a[92:95], v4 offset:31744
v_mfma_f32_16x16x32_bf16 a[164:167], a[80:83], v[116:119], a[164:167]
v_exp_f32 v33, v33
v_mfma_f32_16x16x32_bf16 a[168:171], a[80:83], v[120:123], a[168:171]
v_exp_f32 v34, v34
v_mfma_f32_16x16x32_bf16 a[172:175], a[80:83], v[124:127], a[172:175]
s_waitcnt lgkmcnt(2)
v_exp_f32 v35, v35
v_mfma_f32_16x16x32_bf16 a[176:179], a[84:87], v[112:115], a[176:179]
ds_read_b128 a[64:67], v2 offset:16384
v_cvt_pk_bf16_f32 v96, v32, v33
v_mfma_f32_16x16x32_bf16 a[180:183], a[84:87], v[116:119], a[180:183]
v_exp_f32 v36, v36
v_mfma_f32_16x16x32_bf16 a[184:187], a[84:87], v[120:123], a[184:187]
v_exp_f32 v37, v37
v_mfma_f32_16x16x32_bf16 a[188:191], a[84:87], v[124:127], a[188:191]
s_waitcnt lgkmcnt(2)
v_exp_f32 v38, v38
v_mfma_f32_16x16x32_bf16 a[192:195], a[88:91], v[112:115], a[192:195]
ds_read_b128 a[68:71], v2 offset:17408
v_cvt_pk_bf16_f32 v97, v34, v35
v_mfma_f32_16x16x32_bf16 a[196:199], a[88:91], v[116:119], a[196:199]
s_add_u32 s61, s61, s42
v_exp_f32 v39, v39
v_mfma_f32_16x16x32_bf16 a[200:203], a[88:91], v[120:123], a[200:203]
v_exp_f32 v40, v40
v_mfma_f32_16x16x32_bf16 a[204:207], a[88:91], v[124:127], a[204:207]
s_waitcnt lgkmcnt(2)
v_exp_f32 v41, v41
v_mfma_f32_16x16x32_bf16 a[208:211], a[92:95], v[112:115], a[208:211]
ds_read_b128 a[72:75], v2 offset:18432
v_cvt_pk_bf16_f32 v98, v36, v37
v_mfma_f32_16x16x32_bf16 a[212:215], a[92:95], v[116:119], a[212:215]
v_exp_f32 v42, v42
v_mfma_f32_16x16x32_bf16 a[216:219], a[92:95], v[120:123], a[216:219]
v_exp_f32 v43, v43
v_mfma_f32_16x16x32_bf16 a[220:223], a[92:95], v[124:127], a[220:223]
s_waitcnt lgkmcnt(2)
s_cmp_eq_u32 s48, 0
s_cbranch_scc0 L_at_rs2
L_at_rsr2:
v_mfma_f32_16x16x32_bf16 v[64:67], a[64:67], a[0:3], v[128:131]
ds_read_b128 a[76:79], v2 offset:19456
v_cvt_pk_bf16_f32 v99, v38, v39
v_mfma_f32_16x16x32_bf16 v[72:75], a[64:67], a[16:19], v[132:135]
v_exp_f32 v44, v44
v_mfma_f32_16x16x32_bf16 v[80:83], a[64:67], a[32:35], v[136:139]
v_exp_f32 v45, v45
v_mfma_f32_16x16x32_bf16 v[88:91], a[64:67], a[48:51], v[140:143]
s_waitcnt lgkmcnt(2)
v_exp_f32 v46, v46
v_mfma_f32_16x16x32_bf16 v[68:71], a[68:71], a[0:3], v[128:131]
ds_read_b128 a[80:83], v2 offset:20480
v_cvt_pk_bf16_f32 v100, v40, v41
v_mfma_f32_16x16x32_bf16 v[76:79], a[68:71], a[16:19], v[132:135]
v_exp_f32 v47, v47
v_mfma_f32_16x16x32_bf16 v[84:87], a[68:71], a[32:35], v[136:139]
s_lshl_b32 s61, s61, 12
v_exp_f32 v48, v48
v_mfma_f32_16x16x32_bf16 v[92:95], a[68:71], a[48:51], v[140:143]
s_waitcnt lgkmcnt(2)
v_exp_f32 v49, v49
v_mfma_f32_16x16x32_bf16 v[64:67], a[72:75], a[4:7], v[64:67]
ds_read_b128 a[84:87], v2 offset:21504
v_cvt_pk_bf16_f32 v101, v42, v43
v_mfma_f32_16x16x32_bf16 v[72:75], a[72:75], a[20:23], v[72:75]
v_exp_f32 v50, v50
v_mfma_f32_16x16x32_bf16 v[80:83], a[72:75], a[36:39], v[80:83]
v_exp_f32 v51, v51
v_mfma_f32_16x16x32_bf16 v[88:91], a[72:75], a[52:55], v[88:91]
s_waitcnt lgkmcnt(2)
v_exp_f32 v52, v52
v_mfma_f32_16x16x32_bf16 v[68:71], a[76:79], a[4:7], v[68:71]
ds_read_b128 a[88:91], v2 offset:22528
v_cvt_pk_bf16_f32 v102, v44, v45
v_mfma_f32_16x16x32_bf16 v[76:79], a[76:79], a[20:23], v[76:79]
v_exp_f32 v53, v53
v_mfma_f32_16x16x32_bf16 v[84:87], a[76:79], a[36:39], v[84:87]
v_exp_f32 v54, v54
v_mfma_f32_16x16x32_bf16 v[92:95], a[76:79], a[52:55], v[92:95]
s_waitcnt lgkmcnt(2)
v_exp_f32 v55, v55
v_mfma_f32_16x16x32_bf16 v[64:67], a[80:83], a[8:11], v[64:67]
ds_read_b128 a[92:95], v2 offset:23552
v_cvt_pk_bf16_f32 v103, v46, v47
v_mfma_f32_16x16x32_bf16 v[72:75], a[80:83], a[24:27], v[72:75]
s_add_u32 s61, s61, 67108864
v_exp_f32 v56, v56
v_mfma_f32_16x16x32_bf16 v[80:83], a[80:83], a[40:43], v[80:83]
v_exp_f32 v57, v57
v_mfma_f32_16x16x32_bf16 v[88:91], a[80:83], a[56:59], v[88:91]
s_waitcnt lgkmcnt(2)
v_exp_f32 v58, v58
v_mfma_f32_16x16x32_bf16 v[68:71], a[84:87], a[8:11], v[68:71]
ds_read_b128 a[64:67], v2 offset:8192
v_cvt_pk_bf16_f32 v104, v48, v49
v_mfma_f32_16x16x32_bf16 v[76:79], a[84:87], a[24:27], v[76:79]
v_exp_f32 v59, v59
v_mfma_f32_16x16x32_bf16 v[84:87], a[84:87], a[40:43], v[84:87]
v_exp_f32 v60, v60
v_mfma_f32_16x16x32_bf16 v[92:95], a[84:87], a[56:59], v[92:95]
s_waitcnt lgkmcnt(2)
v_exp_f32 v61, v61
v_mfma_f32_16x16x32_bf16 v[64:67], a[88:91], a[12:15], v[64:67]
ds_read_b128 a[68:71], v2 offset:9216
v_cvt_pk_bf16_f32 v105, v50, v51
v_mfma_f32_16x16x32_bf16 v[72:75], a[88:91], a[28:31], v[72:75]
v_exp_f32 v62, v62
v_mfma_f32_16x16x32_bf16 v[80:83], a[88:91], a[44:47], v[80:83]
v_exp_f32 v63, v63
v_mfma_f32_16x16x32_bf16 v[88:91], a[88:91], a[60:63], v[88:91]
s_waitcnt lgkmcnt(2)
v_cvt_pk_bf16_f32 v106, v52, v53
v_cvt_pk_bf16_f32 v107, v54, v55
v_mfma_f32_16x16x32_bf16 v[68:71], a[92:95], a[12:15], v[68:71]
ds_read_b128 a[72:75], v2 offset:10240
v_cvt_pk_bf16_f32 v108, v56, v57
v_mfma_f32_16x16x32_bf16 v[76:79], a[92:95], a[28:31], v[76:79]
v_cvt_pk_bf16_f32 v109, v58, v59
v_cvt_pk_bf16_f32 v110, v60, v61
v_mfma_f32_16x16x32_bf16 v[84:87], a[92:95], a[44:47], v[84:87]
v_cvt_pk_bf16_f32 v111, v62, v63
v_mfma_f32_16x16x32_bf16 v[92:95], a[92:95], a[60:63], v[92:95]
s_waitcnt lgkmcnt(2)
s_waitcnt vmcnt(8)
s_barrier
v_mfma_f32_16x16x32_bf16 a[224:227], a[240:243], v[96:99], a[224:227]
s_add_u32 s24, s46, 4096
s_add_u32 m0, s47, 0
v_mfma_f32_16x16x32_bf16 a[228:231], a[240:243], v[100:103], a[228:231]
buffer_load_dwordx4 v1, s[8:11], s46 offen sc1 lds
v_mfma_f32_16x16x32_bf16 a[232:235], a[240:243], v[104:107], a[232:235]
buffer_load_dwordx4 v1, s[8:11], s46 offen offset:2048 sc1 lds
v_mfma_f32_16x16x32_bf16 a[236:239], a[240:243], v[108:111], a[236:239]
v_cndmask_b32 v64, v8, v64, s[80:81]
v_cndmask_b32 v65, v8, v65, s[82:83]
v_mfma_f32_16x16x32_bf16 a[96:99], a[64:67], v[96:99], a[96:99]
ds_read_b128 a[76:79], v2 offset:11264
v_cndmask_b32 v66, v8, v66, s[84:85]
v_mfma_f32_16x16x32_bf16 a[100:103], a[64:67], v[100:103], a[100:103]
s_add_u32 m0, s47, 896
v_cndmask_b32 v67, v8, v67, s[86:87]
v_cndmask_b32 v68, v8, v68, s[88:89]
v_mfma_f32_16x16x32_bf16 a[104:107], a[64:67], v[104:107], a[104:107]
buffer_load_dwordx4 v1, s[8:11], s46 offen offset:128 sc1 lds
v_cndmask_b32 v69, v8, v69, s[90:91]
v_mfma_f32_16x16x32_bf16 a[108:111], a[64:67], v[108:111], a[108:111]
s_waitcnt lgkmcnt(2)
v_cndmask_b32 v70, v8, v70, s[92:93]
v_cndmask_b32 v71, v8, v71, s[94:95]
v_mfma_f32_16x16x32_bf16 a[112:115], a[68:71], v[96:99], a[112:115]
ds_read_b128 a[80:83], v2 offset:12288
v_max3_f32 v16, v64, v65, v66
v_mfma_f32_16x16x32_bf16 a[116:119], a[68:71], v[100:103], a[116:119]
v_max3_f32 v16, v16, v67, v72
v_max3_f32 v16, v16, v73, v74
v_mfma_f32_16x16x32_bf16 a[120:123], a[68:71], v[104:107], a[120:123]
buffer_load_dwordx4 v1, s[8:11], s46 offen offset:2176 sc1 lds
v_max3_f32 v16, v16, v75, v80
v_mfma_f32_16x16x32_bf16 a[124:127], a[68:71], v[108:111], a[124:127]
s_waitcnt lgkmcnt(2)
v_max3_f32 v16, v16, v81, v82
v_max3_f32 v16, v16, v83, v88
v_mfma_f32_16x16x32_bf16 a[128:131], a[72:75], v[96:99], a[128:131]
ds_read_b128 a[84:87], v2 offset:13312
v_max3_f32 v16, v16, v89, v90
v_mfma_f32_16x16x32_bf16 a[132:135], a[72:75], v[100:103], a[132:135]
v_max3_f32 v16, v16, v91, v68
v_max3_f32 v16, v16, v69, v70
v_mfma_f32_16x16x32_bf16 a[136:139], a[72:75], v[104:107], a[136:139]
s_add_u32 m0, s47, 4096
v_max3_f32 v16, v16, v71, v76
v_max3_f32 v16, v16, v77, v78
v_mfma_f32_16x16x32_bf16 a[140:143], a[72:75], v[108:111], a[140:143]
s_waitcnt lgkmcnt(2)
v_max3_f32 v16, v16, v79, v84
v_max3_f32 v16, v16, v85, v86
v_mfma_f32_16x16x32_bf16 a[144:147], a[76:79], v[96:99], a[144:147]
ds_read_b128 a[88:91], v2 offset:14336
v_max3_f32 v16, v16, v87, v92
v_mfma_f32_16x16x32_bf16 a[148:151], a[76:79], v[100:103], a[148:151]
v_max3_f32 v16, v16, v93, v94
v_max_f32 v16, v16, v95
v_cmp_lt_f32 vcc, s54, v16
v_mfma_f32_16x16x32_bf16 a[152:155], a[76:79], v[104:107], a[152:155]
buffer_load_dwordx4 v1, s[8:11], s24 offen sc1 lds
s_cbranch_vccnz L_at_up3
L_at_upr3:
v_mfma_f32_16x16x32_bf16 a[156:159], a[76:79], v[108:111], a[156:159]
s_waitcnt lgkmcnt(2)
v_exp_f32 v64, v64
v_mfma_f32_16x16x32_bf16 a[160:163], a[80:83], v[96:99], a[160:163]
ds_read_b128 a[92:95], v2 offset:15360
v_exp_f32 v65, v65
v_mfma_f32_16x16x32_bf16 a[164:167], a[80:83], v[100:103], a[164:167]
v_exp_f32 v66, v66
v_cvt_pk_bf16_f32 v112, v64, v65
v_mfma_f32_16x16x32_bf16 a[168:171], a[80:83], v[104:107], a[168:171]
buffer_load_dwordx4 v1, s[8:11], s24 offen offset:2048 sc1 lds
v_exp_f32 v67, v67
v_mfma_f32_16x16x32_bf16 a[172:175], a[80:83], v[108:111], a[172:175]
s_waitcnt lgkmcnt(2)
v_exp_f32 v68, v68
v_cvt_pk_bf16_f32 v113, v66, v67
v_mfma_f32_16x16x32_bf16 a[176:179], a[84:87], v[96:99], a[176:179]
ds_read_b128 a[64:67], v3
v_exp_f32 v69, v69
v_mfma_f32_16x16x32_bf16 a[180:183], a[84:87], v[100:103], a[180:183]
v_exp_f32 v70, v70
v_cvt_pk_bf16_f32 v114, v68, v69
v_mfma_f32_16x16x32_bf16 a[184:187], a[84:87], v[104:107], a[184:187]
s_add_u32 m0, s47, 4992
v_exp_f32 v71, v71
v_mfma_f32_16x16x32_bf16 a[188:191], a[84:87], v[108:111], a[188:191]
s_waitcnt lgkmcnt(2)
v_exp_f32 v72, v72
v_cvt_pk_bf16_f32 v115, v70, v71
v_mfma_f32_16x16x32_bf16 a[192:195], a[88:91], v[96:99], a[192:195]
ds_read_b128 a[68:71], v3 offset:1024
v_exp_f32 v73, v73
v_mfma_f32_16x16x32_bf16 a[196:199], a[88:91], v[100:103], a[196:199]
buffer_load_dwordx4 v1, s[8:11], s24 offen offset:128 sc1 lds
v_exp_f32 v74, v74
v_mfma_f32_16x16x32_bf16 a[200:203], a[88:91], v[104:107], a[200:203]
v_exp_f32 v75, v75
v_cvt_pk_bf16_f32 v116, v72, v73
v_mfma_f32_16x16x32_bf16 a[204:207], a[88:91], v[108:111], a[204:207]
s_waitcnt lgkmcnt(2)
v_exp_f32 v76, v76
v_cvt_pk_bf16_f32 v117, v74, v75
v_mfma_f32_16x16x32_bf16 a[208:211], a[92:95], v[96:99], a[208:211]
ds_read_b128 a[72:75], v3 offset:2048
v_exp_f32 v77, v77
v_mfma_f32_16x16x32_bf16 a[212:215], a[92:95], v[100:103], a[212:215]
buffer_load_dwordx4 v1, s[8:11], s24 offen offset:2176 sc1 lds
v_exp_f32 v78, v78
v_mfma_f32_16x16x32_bf16 a[216:219], a[92:95], v[104:107], a[216:219]
v_exp_f32 v79, v79
v_cvt_pk_bf16_f32 v118, v76, v77
v_mfma_f32_16x16x32_bf16 a[220:223], a[92:95], v[108:111], a[220:223]
s_waitcnt lgkmcnt(2)
s_cmp_eq_u32 s48, 0
s_cbranch_scc0 L_at_rs3
L_at_rsr3:
v_cvt_pk_bf16_f32 v119, v78, v79
v_mfma_f32_16x16x32_bf16 v[40:43], a[64:67], a[16:19], v[132:135]
ds_read_b128 a[76:79], v3 offset:3072
v_mfma_f32_16x16x32_bf16 v[48:51], a[64:67], a[32:35], v[136:139]
v_exp_f32 v80, v80
v_mfma_f32_16x16x32_bf16 v[56:59], a[64:67], a[48:51], v[140:143]
s_waitcnt lgkmcnt(2)
v_exp_f32 v81, v81
v_mfma_f32_16x16x32_bf16 v[44:47], a[68:71], a[16:19], v[132:135]
ds_read_b128 a[80:83], v3 offset:4096
v_exp_f32 v82, v82
v_mfma_f32_16x16x32_bf16 v[52:55], a[68:71], a[32:35], v[136:139]
s_add_u32 s46, s46, 1048576
v_exp_f32 v83, v83
v_mfma_f32_16x16x32_bf16 v[60:63], a[68:71], a[48:51], v[140:143]
s_waitcnt lgkmcnt(2)
v_exp_f32 v84, v84
v_mfma_f32_16x16x32_bf16 v[40:43], a[72:75], a[20:23], v[40:43]
ds_read_b128 a[84:87], v3 offset:5120
v_cvt_pk_bf16_f32 v120, v80, v81
v_mfma_f32_16x16x32_bf16 v[48:51], a[72:75], a[36:39], v[48:51]
v_exp_f32 v85, v85
v_mfma_f32_16x16x32_bf16 v[56:59], a[72:75], a[52:55], v[56:59]
s_waitcnt lgkmcnt(2)
v_exp_f32 v86, v86
v_mfma_f32_16x16x32_bf16 v[44:47], a[76:79], a[20:23], v[44:47]
ds_read_b128 a[88:91], v3 offset:6144
v_cvt_pk_bf16_f32 v121, v82, v83
v_mfma_f32_16x16x32_bf16 v[52:55], a[76:79], a[36:39], v[52:55]
s_add_u32 s47, s47, 32768
v_exp_f32 v87, v87
v_mfma_f32_16x16x32_bf16 v[60:63], a[76:79], a[52:55], v[60:63]
s_waitcnt lgkmcnt(2)
v_exp_f32 v88, v88
v_mfma_f32_16x16x32_bf16 v[40:43], a[80:83], a[24:27], v[40:43]
ds_read_b128 a[92:95], v3 offset:7168
v_cvt_pk_bf16_f32 v122, v84, v85
v_mfma_f32_16x16x32_bf16 v[48:51], a[80:83], a[40:43], v[48:51]
v_exp_f32 v89, v89
v_mfma_f32_16x16x32_bf16 v[56:59], a[80:83], a[56:59], v[56:59]
s_waitcnt lgkmcnt(2)
v_exp_f32 v90, v90
v_mfma_f32_16x16x32_bf16 v[44:47], a[84:87], a[24:27], v[44:47]
ds_read_b128 a[64:67], v2 offset:24576
v_cvt_pk_bf16_f32 v123, v86, v87
v_mfma_f32_16x16x32_bf16 v[52:55], a[84:87], a[40:43], v[52:55]
s_and_b32 s47, s47, 131071
v_exp_f32 v91, v91
v_mfma_f32_16x16x32_bf16 v[60:63], a[84:87], a[56:59], v[60:63]
s_waitcnt lgkmcnt(2)
v_exp_f32 v92, v92
v_mfma_f32_16x16x32_bf16 v[40:43], a[88:91], a[28:31], v[40:43]
ds_read_b128 a[68:71], v2 offset:25600
v_cvt_pk_bf16_f32 v124, v88, v89
v_mfma_f32_16x16x32_bf16 v[48:51], a[88:91], a[44:47], v[48:51]
v_exp_f32 v93, v93
v_mfma_f32_16x16x32_bf16 v[56:59], a[88:91], a[60:63], v[56:59]
s_waitcnt lgkmcnt(2)
v_exp_f32 v94, v94
v_mfma_f32_16x16x32_bf16 v[44:47], a[92:95], a[28:31], v[44:47]
ds_read_b128 a[72:75], v2 offset:26624
v_cvt_pk_bf16_f32 v125, v90, v91
v_mfma_f32_16x16x32_bf16 v[52:55], a[92:95], a[44:47], v[52:55]
v_exp_f32 v95, v95
v_mfma_f32_16x16x32_bf16 v[60:63], a[92:95], a[60:63], v[60:63]
s_waitcnt lgkmcnt(2)
v_cvt_pk_bf16_f32 v126, v92, v93
v_cvt_pk_bf16_f32 v127, v94, v95
v_mov_b32 v4, v2
v_mov_b32 v2, v3
v_add_u32 v3, 32768, v3
v_and_b32 v3, 131071, v3
v_mfma_f32_16x16x32_bf16 a[224:227], a[240:243], v[112:115], a[224:227]
s_lshl_b32 s46, s42, 14
v_mfma_f32_16x16x32_bf16 a[228:231], a[240:243], v[116:119], a[228:231]
v_mfma_f32_16x16x32_bf16 a[232:235], a[240:243], v[120:123], a[232:235]
v_mfma_f32_16x16x32_bf16 a[236:239], a[240:243], v[124:127], a[236:239]
v_cndmask_b32 v40, v8, v40, s[64:65]
v_cndmask_b32 v41, v8, v41, s[66:67]
v_mfma_f32_16x16x32_bf16 a[96:99], a[64:67], v[112:115], a[96:99]
ds_read_b128 a[76:79], v4 offset:27648
v_cndmask_b32 v42, v8, v42, s[68:69]
v_mfma_f32_16x16x32_bf16 a[100:103], a[64:67], v[116:119], a[100:103]
v_cndmask_b32 v43, v8, v43, s[70:71]
v_cndmask_b32 v44, v8, v44, s[72:73]
v_mfma_f32_16x16x32_bf16 a[104:107], a[64:67], v[120:123], a[104:107]
v_cndmask_b32 v45, v8, v45, s[74:75]
v_cndmask_b32 v46, v8, v46, s[76:77]
v_mfma_f32_16x16x32_bf16 a[108:111], a[64:67], v[124:127], a[108:111]
s_waitcnt lgkmcnt(2)
v_cndmask_b32 v47, v8, v47, s[78:79]
v_max3_f32 v16, v40, v41, v42
v_mfma_f32_16x16x32_bf16 a[112:115], a[68:71], v[112:115], a[112:115]
ds_read_b128 a[80:83], v4 offset:28672
v_max3_f32 v16, v16, v43, v48
v_mfma_f32_16x16x32_bf16 a[116:119], a[68:71], v[116:119], a[116:119]
v_max3_f32 v16, v16, v49, v50
v_max3_f32 v16, v16, v51, v56
v_mfma_f32_16x16x32_bf16 a[120:123], a[68:71], v[120:123], a[120:123]
v_max3_f32 v16, v16, v57, v58
v_max3_f32 v16, v16, v59, v44
v_mfma_f32_16x16x32_bf16 a[124:127], a[68:71], v[124:127], a[124:127]
s_waitcnt lgkmcnt(2)
v_max3_f32 v16, v16, v45, v46
v_max3_f32 v16, v16, v47, v52
v_mfma_f32_16x16x32_bf16 a[128:131], a[72:75], v[112:115], a[128:131]
ds_read_b128 a[84:87], v4 offset:29696
v_max3_f32 v16, v16, v53, v54
v_mfma_f32_16x16x32_bf16 a[132:135], a[72:75], v[116:119], a[132:135]
s_add_u32 s46, s46, 0
v_max3_f32 v16, v16, v55, v60
v_max3_f32 v16, v16, v61, v62
v_mfma_f32_16x16x32_bf16 a[136:139], a[72:75], v[120:123], a[136:139]
v_max_f32 v16, v16, v63
v_cmp_lt_f32 vcc, s54, v16
v_mfma_f32_16x16x32_bf16 a[140:143], a[72:75], v[124:127], a[140:143]
s_waitcnt lgkmcnt(2)
s_cbranch_vccnz L_at_up4
L_at_upr4:
v_mfma_f32_16x16x32_bf16 a[144:147], a[76:79], v[112:115], a[144:147]
ds_read_b128 a[88:91], v4 offset:30720
v_mfma_f32_16x16x32_bf16 a[148:151], a[76:79], v[116:119], a[148:151]
v_exp_f32 v40, v40
v_mfma_f32_16x16x32_bf16 a[152:155], a[76:79], v[120:123], a[152:155]
v_exp_f32 v41, v41
v_mfma_f32_16x16x32_bf16 a[156:159], a[76:79], v[124:127], a[156:159]
s_waitcnt lgkmcnt(2)
v_exp_f32 v42, v42
v_mfma_f32_16x16x32_bf16 a[160:163], a[80:83], v[112:115], a[160:163]
ds_read_b128 a[92:95], v4 offset:31744
v_cvt_pk_bf16_f32 v100, v40, v41
v_mfma_f32_16x16x32_bf16 a[164:167], a[80:83], v[116:119], a[164:167]
v_exp_f32 v43, v43
v_mfma_f32_16x16x32_bf16 a[168:171], a[80:83], v[120:123], a[168:171]
v_exp_f32 v44, v44
v_mfma_f32_16x16x32_bf16 a[172:175], a[80:83], v[124:127], a[172:175]
s_waitcnt lgkmcnt(2)
v_exp_f32 v45, v45
v_mfma_f32_16x16x32_bf16 a[176:179], a[84:87], v[112:115], a[176:179]
ds_read_b128 a[64:67], v2 offset:16384
v_cvt_pk_bf16_f32 v101, v42, v43
v_mfma_f32_16x16x32_bf16 a[180:183], a[84:87], v[116:119], a[180:183]
v_exp_f32 v46, v46
v_mfma_f32_16x16x32_bf16 a[184:187], a[84:87], v[120:123], a[184:187]
v_exp_f32 v47, v47
v_mfma_f32_16x16x32_bf16 a[188:191], a[84:87], v[124:127], a[188:191]
s_waitcnt lgkmcnt(2)
v_exp_f32 v48, v48
v_mfma_f32_16x16x32_bf16 a[192:195], a[88:91], v[112:115], a[192:195]
ds_read_b128 a[68:71], v2 offset:17408
v_cvt_pk_bf16_f32 v102, v44, v45
v_mfma_f32_16x16x32_bf16 a[196:199], a[88:91], v[116:119], a[196:199]
v_exp_f32 v49, v49
v_mfma_f32_16x16x32_bf16 a[200:203], a[88:91], v[120:123], a[200:203]
s_cmp_lt_u32 s63, 8
s_cselect_b32 s46, s46, 536870912
v_cvt_pk_bf16_f32 v103, v46, v47
v_mfma_f32_16x16x32_bf16 a[204:207], a[88:91], v[124:127], a[204:207]
s_waitcnt lgkmcnt(2)
v_exp_f32 v50, v50
v_mfma_f32_16x16x32_bf16 a[208:211], a[92:95], v[112:115], a[208:211]
ds_read_b128 a[72:75], v2 offset:18432
v_cvt_pk_bf16_f32 v104, v48, v49
v_mfma_f32_16x16x32_bf16 a[212:215], a[92:95], v[116:119], a[212:215]
v_exp_f32 v51, v51
v_mfma_f32_16x16x32_bf16 a[216:219], a[92:95], v[120:123], a[216:219]
v_exp_f32 v52, v52
v_mfma_f32_16x16x32_bf16 a[220:223], a[92:95], v[124:127], a[220:223]
s_waitcnt lgkmcnt(2)
s_cmp_eq_u32 s48, 0
s_cbranch_scc0 L_at_rs4
L_at_rsr4:
v_mfma_f32_16x16x32_bf16 v[72:75], a[64:67], a[16:19], v[132:135]
ds_read_b128 a[76:79], v2 offset:19456
v_cvt_pk_bf16_f32 v105, v50, v51
v_mfma_f32_16x16x32_bf16 v[80:83], a[64:67], a[32:35], v[136:139]
v_exp_f32 v53, v53
v_mfma_f32_16x16x32_bf16 v[88:91], a[64:67], a[48:51], v[140:143]
s_waitcnt lgkmcnt(2)
v_exp_f32 v54, v54
v_mfma_f32_16x16x32_bf16 v[76:79], a[68:71], a[16:19], v[132:135]
ds_read_b128 a[80:83], v2 offset:20480
v_cvt_pk_bf16_f32 v106, v52, v53
v_mfma_f32_16x16x32_bf16 v[84:87], a[68:71], a[32:35], v[136:139]
v_exp_f32 v55, v55
v_mfma_f32_16x16x32_bf16 v[92:95], a[68:71], a[48:51], v[140:143]
s_waitcnt lgkmcnt(2)
v_exp_f32 v56, v56
v_mfma_f32_16x16x32_bf16 v[72:75], a[72:75], a[20:23], v[72:75]
ds_read_b128 a[84:87], v2 offset:21504
v_cvt_pk_bf16_f32 v107, v54, v55
v_mfma_f32_16x16x32_bf16 v[80:83], a[72:75], a[36:39], v[80:83]
v_exp_f32 v57, v57
v_mfma_f32_16x16x32_bf16 v[88:91], a[72:75], a[52:55], v[88:91]
s_waitcnt lgkmcnt(2)
v_exp_f32 v58, v58
v_mfma_f32_16x16x32_bf16 v[76:79], a[76:79], a[20:23], v[76:79]
ds_read_b128 a[88:91], v2 offset:22528
v_cvt_pk_bf16_f32 v108, v56, v57
v_mfma_f32_16x16x32_bf16 v[84:87], a[76:79], a[36:39], v[84:87]
v_exp_f32 v59, v59
v_mfma_f32_16x16x32_bf16 v[92:95], a[76:79], a[52:55], v[92:95]
s_waitcnt lgkmcnt(2)
v_exp_f32 v60, v60
v_mfma_f32_16x16x32_bf16 v[72:75], a[80:83], a[24:27], v[72:75]
ds_read_b128 a[92:95], v2 offset:23552
v_cvt_pk_bf16_f32 v109, v58, v59
v_mfma_f32_16x16x32_bf16 v[80:83], a[80:83], a[40:43], v[80:83]
v_exp_f32 v61, v61
v_mfma_f32_16x16x32_bf16 v[88:91], a[80:83], a[56:59], v[88:91]
s_waitcnt lgkmcnt(2)
v_exp_f32 v62, v62
v_mfma_f32_16x16x32_bf16 v[76:79], a[84:87], a[24:27], v[76:79]
ds_read_b128 a[64:67], v2 offset:8192
v_cvt_pk_bf16_f32 v110, v60, v61
v_mfma_f32_16x16x32_bf16 v[84:87], a[84:87], a[40:43], v[84:87]
v_exp_f32 v63, v63
v_mfma_f32_16x16x32_bf16 v[92:95], a[84:87], a[56:59], v[92:95]
s_waitcnt lgkmcnt(2)
v_cvt_pk_bf16_f32 v111, v62, v63
v_mfma_f32_16x16x32_bf16 v[72:75], a[88:91], a[28:31], v[72:75]
ds_read_b128 a[68:71], v2 offset:9216
v_mfma_f32_16x16x32_bf16 v[80:83], a[88:91], a[44:47], v[80:83]
v_mfma_f32_16x16x32_bf16 v[88:91], a[88:91], a[60:63], v[88:91]
s_waitcnt lgkmcnt(2)
v_mfma_f32_16x16x32_bf16 v[76:79], a[92:95], a[28:31], v[76:79]
ds_read_b128 a[72:75], v2 offset:10240
v_mfma_f32_16x16x32_bf16 v[84:87], a[92:95], a[44:47], v[84:87]
v_mfma_f32_16x16x32_bf16 v[92:95], a[92:95], a[60:63], v[92:95]
s_waitcnt lgkmcnt(2)
s_waitcnt vmcnt(8)
s_barrier
s_add_u32 s25, s61, 0
v_mov_b32 v19, 1
s_mov_b64 exec, 1
buffer_store_dword v19, v6, s[8:11], s60 offen sc1
s_mov_b64 exec, -1
v_mfma_f32_16x16x32_bf16 a[228:231], a[240:243], v[100:103], a[228:231]
s_add_u32 s24, s46, 4096
v_mfma_f32_16x16x32_bf16 a[232:235], a[240:243], v[104:107], a[232:235]
v_mfma_f32_16x16x32_bf16 a[236:239], a[240:243], v[108:111], a[236:239]
s_add_u32 m0, s47, 0
v_mfma_f32_16x16x32_bf16 a[100:103], a[64:67], v[100:103], a[100:103]
ds_read_b128 a[76:79], v2 offset:11264
v_cndmask_b32 v72, v8, v72, s[80:81]
v_mfma_f32_16x16x32_bf16 a[104:107], a[64:67], v[104:107], a[104:107]
v_cndmask_b32 v73, v8, v73, s[82:83]
v_cndmask_b32 v74, v8, v74, s[84:85]
v_mfma_f32_16x16x32_bf16 a[108:111], a[64:67], v[108:111], a[108:111]
s_waitcnt lgkmcnt(2)
buffer_load_dwordx4 v1, s[8:11], s46 offen sc1 lds
v_cndmask_b32 v75, v8, v75, s[86:87]
v_mfma_f32_16x16x32_bf16 a[116:119], a[68:71], v[100:103], a[116:119]
ds_read_b128 a[80:83], v2 offset:12288
v_cndmask_b32 v76, v8, v76, s[88:89]
v_cndmask_b32 v77, v8, v77, s[90:91]
v_mfma_f32_16x16x32_bf16 a[120:123], a[68:71], v[104:107], a[120:123]
v_cndmask_b32 v78, v8, v78, s[92:93]
v_cndmask_b32 v79, v8, v79, s[94:95]
v_mfma_f32_16x16x32_bf16 a[124:127], a[68:71], v[108:111], a[124:127]
s_waitcnt lgkmcnt(2)
buffer_load_dwordx4 v1, s[8:11], s46 offen offset:2048 sc1 lds
v_max3_f32 v16, v72, v73, v74
v_mfma_f32_16x16x32_bf16 a[132:135], a[72:75], v[100:103], a[132:135]
ds_read_b128 a[84:87], v2 offset:13312
v_max3_f32 v16, v16, v75, v80
v_max3_f32 v16, v16, v81, v82
v_mfma_f32_16x16x32_bf16 a[136:139], a[72:75], v[104:107], a[136:139]
s_add_u32 m0, s47, 896
v_max3_f32 v16, v16, v83, v88
v_max3_f32 v16, v16, v89, v90
v_mfma_f32_16x16x32_bf16 a[140:143], a[72:75], v[108:111], a[140:143]
s_waitcnt lgkmcnt(2)
v_max3_f32 v16, v16, v91, v76
v_max3_f32 v16, v16, v77, v78
v_mfma_f32_16x16x32_bf16 a[148:151], a[76:79], v[100:103], a[148:151]
ds_read_b128 a[88:91], v2 offset:14336
v_max3_f32 v16, v16, v79, v84
v_mfma_f32_16x16x32_bf16 a[152:155], a[76:79], v[104:107], a[152:155]
buffer_load_dwordx4 v1, s[8:11], s46 offen offset:128 sc1 lds
v_max3_f32 v16, v16, v85, v86
v_max3_f32 v16, v16, v87, v92
v_mfma_f32_16x16x32_bf16 a[156:159], a[76:79], v[108:111], a[156:159]
s_waitcnt lgkmcnt(2)
v_max3_f32 v16, v16, v93, v94
v_max_f32 v16, v16, v95
v_cmp_lt_f32 vcc, s54, v16
v_mfma_f32_16x16x32_bf16 a[164:167], a[80:83], v[100:103], a[164:167]
ds_read_b128 a[92:95], v2 offset:15360
s_cbranch_vccnz L_at_up5
L_at_upr5:
v_exp_f32 v72, v72
v_exp_f32 v73, v73
v_accvgpr_read_b32 v18, a224
v_mfma_f32_16x16x32_bf16 a[168:171], a[80:83], v[104:107], a[168:171]
buffer_load_dwordx4 v1, s[8:11], s46 offen offset:2176 sc1 lds
v_exp_f32 v74, v74
v_exp_f32 v75, v75
v_exp_f32 v76, v76
v_mfma_f32_16x16x32_bf16 a[172:175], a[80:83], v[108:111], a[172:175]
s_waitcnt lgkmcnt(2)
v_exp_f32 v77, v77
v_exp_f32 v78, v78
v_exp_f32 v79, v79
v_cvt_pk_bf16_f32 v116, v72, v73
v_mfma_f32_16x16x32_bf16 a[180:183], a[84:87], v[100:103], a[180:183]
ds_read_b128 a[64:67], v3
s_add_u32 m0, s47, 4096
v_exp_f32 v80, v80
v_exp_f32 v81, v81
v_cvt_pk_bf16_f32 v117, v74, v75
v_mfma_f32_16x16x32_bf16 a[184:187], a[84:87], v[104:107], a[184:187]
v_exp_f32 v82, v82
v_exp_f32 v83, v83
v_exp_f32 v84, v84
v_cvt_pk_bf16_f32 v118, v76, v77
v_mfma_f32_16x16x32_bf16 a[188:191], a[84:87], v[108:111], a[188:191]
s_waitcnt lgkmcnt(2)
v_exp_f32 v85, v85
v_exp_f32 v86, v86
v_exp_f32 v87, v87
v_cvt_pk_bf16_f32 v119, v78, v79
v_mfma_f32_16x16x32_bf16 a[196:199], a[88:91], v[100:103], a[196:199]
ds_read_b128 a[68:71], v3 offset:1024
buffer_load_dwordx4 v1, s[8:11], s24 offen sc1 lds
v_exp_f32 v88, v88
v_exp_f32 v89, v89
v_cvt_pk_bf16_f32 v120, v80, v81
v_mfma_f32_16x16x32_bf16 a[200:203], a[88:91], v[104:107], a[200:203]
v_exp_f32 v90, v90
v_exp_f32 v91, v91
v_exp_f32 v92, v92
v_cvt_pk_bf16_f32 v121, v82, v83
v_mfma_f32_16x16x32_bf16 a[204:207], a[88:91], v[108:111], a[204:207]
s_waitcnt lgkmcnt(2)
v_exp_f32 v93, v93
v_exp_f32 v94, v94
v_exp_f32 v95, v95
v_cvt_pk_bf16_f32 v122, v84, v85
v_mfma_f32_16x16x32_bf16 a[212:215], a[92:95], v[100:103], a[212:215]
ds_read_b128 a[72:75], v3 offset:2048
buffer_load_dwordx4 v1, s[8:11], s24 offen offset:2048 sc1 lds
v_cvt_pk_bf16_f32 v123, v86, v87
v_cvt_pk_bf16_f32 v124, v88, v89
v_cvt_pk_bf16_f32 v125, v90, v91
v_cvt_pk_bf16_f32 v126, v92, v93
v_cvt_pk_bf16_f32 v127, v94, v95
v_mfma_f32_16x16x32_bf16 a[216:219], a[92:95], v[104:107], a[216:219]
v_rcp_f32 v18, v18
v_accvgpr_read_b32 v224, a96
v_accvgpr_read_b32 v225, a97
v_accvgpr_read_b32 v226, a98
v_accvgpr_read_b32 v227, a99
v_accvgpr_read_b32 v228, a112
v_mfma_f32_16x16x32_bf16 a[220:223], a[92:95], v[108:111], a[220:223]
s_waitcnt lgkmcnt(2)
s_add_u32 m0, s47, 4992
s_cmp_eq_u32 s48, 0
s_cbranch_scc0 L_at_rs5
L_at_rsr5:
v_accvgpr_read_b32 v229, a113
v_accvgpr_read_b32 v230, a114
v_accvgpr_read_b32 v231, a115
v_mul_f32 v224, v224, v18
v_mul_f32 v225, v225, v18
v_mfma_f32_16x16x32_bf16 v[48:51], a[64:67], a[32:35], v[136:139]
ds_read_b128 a[76:79], v3 offset:3072
v_mul_f32 v226, v226, v18
v_mul_f32 v227, v227, v18
v_mul_f32 v228, v228, v18
v_mul_f32 v229, v229, v18
v_mul_f32 v230, v230, v18
v_mul_f32 v231, v231, v18
v_mfma_f32_16x16x32_bf16 v[56:59], a[64:67], a[48:51], v[140:143]
s_waitcnt lgkmcnt(2)
v_cvt_pk_bf16_f32 v224, v224, v225
v_cvt_pk_bf16_f32 v225, v226, v227
v_cvt_pk_bf16_f32 v226, v228, v229
v_cvt_pk_bf16_f32 v227, v230, v231
buffer_store_dwordx4 v[224:227], v6, s[8:11], s25 offen sc1
v_mfma_f32_16x16x32_bf16 v[52:55], a[68:71], a[32:35], v[136:139]
ds_read_b128 a[80:83], v3 offset:4096
buffer_load_dwordx4 v1, s[8:11], s24 offen offset:128 sc1 lds
v_accvgpr_read_b32 v232, a128
v_accvgpr_read_b32 v233, a129
v_accvgpr_read_b32 v234, a130
v_accvgpr_read_b32 v235, a131
v_mfma_f32_16x16x32_bf16 v[60:63], a[68:71], a[48:51], v[140:143]
s_waitcnt lgkmcnt(2)
v_accvgpr_read_b32 v236, a144
v_accvgpr_read_b32 v237, a145
v_accvgpr_read_b32 v238, a146
v_accvgpr_read_b32 v239, a147
v_mul_f32 v232, v232, v18
v_mul_f32 v233, v233, v18
v_mfma_f32_16x16x32_bf16 v[48:51], a[72:75], a[36:39], v[48:51]
ds_read_b128 a[84:87], v3 offset:5120
v_mul_f32 v234, v234, v18
v_mul_f32 v235, v235, v18
v_mul_f32 v236, v236, v18
v_mul_f32 v237, v237, v18
v_mul_f32 v238, v238, v18
v_mfma_f32_16x16x32_bf16 v[56:59], a[72:75], a[52:55], v[56:59]
s_waitcnt lgkmcnt(2)
buffer_load_dwordx4 v1, s[8:11], s24 offen offset:2176 sc1 lds
v_mul_f32 v239, v239, v18
v_cvt_pk_bf16_f32 v232, v232, v233
v_cvt_pk_bf16_f32 v233, v234, v235
v_cvt_pk_bf16_f32 v234, v236, v237
v_cvt_pk_bf16_f32 v235, v238, v239
v_mfma_f32_16x16x32_bf16 v[52:55], a[76:79], a[36:39], v[52:55]
ds_read_b128 a[88:91], v3 offset:6144
buffer_store_dwordx4 v[232:235], v6, s[8:11], s25 offen offset:1024 sc1
v_accvgpr_read_b32 v240, a160
v_mfma_f32_16x16x32_bf16 v[60:63], a[76:79], a[52:55], v[60:63]
s_waitcnt lgkmcnt(2)
s_add_u32 s46, s46, 1048576
v_accvgpr_read_b32 v241, a161
v_accvgpr_read_b32 v242, a162
v_accvgpr_read_b32 v243, a163
v_accvgpr_read_b32 v244, a176
v_accvgpr_read_b32 v245, a177
v_mfma_f32_16x16x32_bf16 v[48:51], a[80:83], a[40:43], v[48:51]
ds_read_b128 a[92:95], v3 offset:7168
v_accvgpr_read_b32 v246, a178
v_accvgpr_read_b32 v247, a179
v_mul_f32 v240, v240, v18
v_mul_f32 v241, v241, v18
v_mul_f32 v242, v242, v18
v_mfma_f32_16x16x32_bf16 v[56:59], a[80:83], a[56:59], v[56:59]
s_waitcnt lgkmcnt(2)
v_mul_f32 v243, v243, v18
v_mul_f32 v244, v244, v18
v_mul_f32 v245, v245, v18
v_mul_f32 v246, v246, v18
v_mul_f32 v247, v247, v18
v_cvt_pk_bf16_f32 v240, v240, v241
v_mfma_f32_16x16x32_bf16 v[52:55], a[84:87], a[40:43], v[52:55]
ds_read_b128 a[64:67], v2 offset:24576
s_add_u32 s47, s47, 32768
v_cvt_pk_bf16_f32 v241, v242, v243
v_cvt_pk_bf16_f32 v242, v244, v245
v_cvt_pk_bf16_f32 v243, v246, v247
buffer_store_dwordx4 v[240:243], v6, s[8:11], s25 offen offset:2048 sc1
v_mfma_f32_16x16x32_bf16 v[60:63], a[84:87], a[56:59], v[60:63]
s_waitcnt lgkmcnt(2)
v_accvgpr_read_b32 v248, a192
v_accvgpr_read_b32 v249, a193
v_accvgpr_read_b32 v250, a194
v_accvgpr_read_b32 v251, a195
v_accvgpr_read_b32 v252, a208
v_accvgpr_read_b32 v253, a209
v_mfma_f32_16x16x32_bf16 v[48:51], a[88:91], a[44:47], v[48:51]
ds_read_b128 a[68:71], v2 offset:25600
v_accvgpr_read_b32 v254, a210
v_accvgpr_read_b32 v255, a211
v_mul_f32 v248, v248, v18
v_mul_f32 v249, v249, v18
v_mul_f32 v250, v250, v18
v_mfma_f32_16x16x32_bf16 v[56:59], a[88:91], a[60:63], v[56:59]
s_waitcnt lgkmcnt(2)
s_and_b32 s47, s47, 131071
v_mul_f32 v251, v251, v18
v_mul_f32 v252, v252, v18
v_mul_f32 v253, v253, v18
v_mul_f32 v254, v254, v18
v_mfma_f32_16x16x32_bf16 v[52:55], a[92:95], a[44:47], v[52:55]
ds_read_b128 a[72:75], v2 offset:26624
v_mul_f32 v255, v255, v18
v_cvt_pk_bf16_f32 v248, v248, v249
v_cvt_pk_bf16_f32 v249, v250, v251
v_cvt_pk_bf16_f32 v250, v252, v253
v_mfma_f32_16x16x32_bf16 v[60:63], a[92:95], a[60:63], v[60:63]
s_waitcnt lgkmcnt(2)
v_cvt_pk_bf16_f32 v251, v254, v255
buffer_store_dwordx4 v[248:251], v6, s[8:11], s25 offen offset:3072 sc1
v_mov_b32 v4, v2
v_mov_b32 v2, v3
v_add_u32 v3, 32768, v3
v_and_b32 v3, 131071, v3
s_cmp_ge_u32 s63, 8
s_cbranch_scc1 L_at_nq
v_mov_b32 v20, 0
s_lshr_b32 s25, s42, 1
s_lshl_b32 s25, s25, 5
s_add_u32 s25, s25, s63
s_lshl_b32 s25, s25, 2
s_add_u32 s25, s25, 111173632
s_mov_b32 s28, 0
L_poll_14:
buffer_load_dword v21, v20, s[8:11], s25 offen sc1
s_add_u32 s28, s28, 1
s_cmp_gt_u32 s28, 200000
s_cbranch_scc1 L_end
s_waitcnt vmcnt(0)
v_cmp_ne_u32 vcc, 1, v21
s_cbranch_vccz L_pd_15
s_sleep 1
s_branch L_poll_14
L_pd_15:
L_at_nq:
v_mfma_f32_16x16x32_bf16 a[228:231], a[240:243], v[116:119], a[228:231]
s_lshl_b32 s26, s63, 8
v_mfma_f32_16x16x32_bf16 a[232:235], a[240:243], v[120:123], a[232:235]
s_add_u32 s26, s26, s42
v_mfma_f32_16x16x32_bf16 a[236:239], a[240:243], v[124:127], a[236:239]
s_lshl_b32 s26, s26, 13
v_mfma_f32_16x16x32_bf16 a[100:103], a[64:67], v[116:119], a[100:103]
ds_read_b128 a[76:79], v4 offset:27648
v_cndmask_b32 v48, v8, v48, s[64:65]
v_mfma_f32_16x16x32_bf16 a[104:107], a[64:67], v[120:123], a[104:107]
s_add_u32 s26, s26, 117440512
v_cndmask_b32 v49, v8, v49, s[66:67]
v_cndmask_b32 v50, v8, v50, s[68:69]
v_mfma_f32_16x16x32_bf16 a[108:111], a[64:67], v[124:127], a[108:111]
s_waitcnt lgkmcnt(2)
s_cmp_lt_u32 s63, 8
s_cselect_b32 s26, s26, 536870912
v_cndmask_b32 v51, v8, v51, s[70:71]
v_mfma_f32_16x16x32_bf16 a[116:119], a[68:71], v[116:119], a[116:119]
ds_read_b128 a[80:83], v4 offset:28672
v_cndmask_b32 v52, v8, v52, s[72:73]
v_mfma_f32_16x16x32_bf16 a[120:123], a[68:71], v[120:123], a[120:123]
s_add_u32 s27, s26, 0
v_cndmask_b32 v53, v8, v53, s[74:75]
v_cndmask_b32 v54, v8, v54, s[76:77]
v_mfma_f32_16x16x32_bf16 a[124:127], a[68:71], v[124:127], a[124:127]
s_waitcnt lgkmcnt(2)
buffer_load_dwordx4 v[160:163], v7, s[8:11], s27 offen sc1
v_cndmask_b32 v55, v8, v55, s[78:79]
v_max3_f32 v16, v48, v49, v50
v_mfma_f32_16x16x32_bf16 a[132:135], a[72:75], v[116:119], a[132:135]
ds_read_b128 a[84:87], v4 offset:29696
v_max3_f32 v16, v16, v51, v56
v_mfma_f32_16x16x32_bf16 a[136:139], a[72:75], v[120:123], a[136:139]
buffer_load_dwordx4 v[164:167], v7, s[8:11], s27 offen offset:2048 sc1
v_max3_f32 v16, v16, v57, v58
v_max3_f32 v16, v16, v59, v52
v_mfma_f32_16x16x32_bf16 a[140:143], a[72:75], v[124:127], a[140:143]
s_waitcnt lgkmcnt(2)
s_add_u32 s27, s26, 4096
v_max3_f32 v16, v16, v53, v54
v_max3_f32 v16, v16, v55, v60
v_mfma_f32_16x16x32_bf16 a[148:151], a[76:79], v[116:119], a[148:151]
ds_read_b128 a[88:91], v4 offset:30720
v_max3_f32 v16, v16, v61, v62
v_max_f32 v16, v16, v63
v_cmp_lt_f32 vcc, s54, v16
v_mfma_f32_16x16x32_bf16 a[152:155], a[76:79], v[120:123], a[152:155]
buffer_load_dwordx4 v[168:171], v7, s[8:11], s27 offen sc1
s_cbranch_vccnz L_at_up6
L_at_upr6:
v_mfma_f32_16x16x32_bf16 a[156:159], a[76:79], v[124:127], a[156:159]
s_waitcnt lgkmcnt(2)
buffer_load_dwordx4 v[172:175], v7, s[8:11], s27 offen offset:2048 sc1
v_exp_f32 v48, v48
v_mfma_f32_16x16x32_bf16 a[164:167], a[80:83], v[116:119], a[164:167]
ds_read_b128 a[92:95], v4 offset:31744
v_exp_f32 v49, v49
v_mfma_f32_16x16x32_bf16 a[168:171], a[80:83], v[120:123], a[168:171]
s_add_u32 s27, s26, 524288
v_exp_f32 v50, v50
v_cvt_pk_bf16_f32 v104, v48, v49
v_mfma_f32_16x16x32_bf16 a[172:175], a[80:83], v[124:127], a[172:175]
s_waitcnt lgkmcnt(2)
buffer_load_dwordx4 v[176:179], v7, s[8:11], s27 offen sc1
v_exp_f32 v51, v51
v_mfma_f32_16x16x32_bf16 a[180:183], a[84:87], v[116:119], a[180:183]
ds_read_b128 a[64:67], v2 offset:16384
v_exp_f32 v52, v52
v_mfma_f32_16x16x32_bf16 a[184:187], a[84:87], v[120:123], a[184:187]
buffer_load_dwordx4 v[180:183], v7, s[8:11], s27 offen offset:2048 sc1
v_exp_f32 v53, v53
v_mfma_f32_16x16x32_bf16 a[188:191], a[84:87], v[124:127], a[188:191]
s_waitcnt lgkmcnt(2)
s_add_u32 s27, s26, 528384
v_exp_f32 v54, v54
v_mfma_f32_16x16x32_bf16 a[196:199], a[88:91], v[116:119], a[196:199]
ds_read_b128 a[68:71], v2 offset:17408
v_exp_f32 v55, v55
v_mfma_f32_16x16x32_bf16 a[200:203], a[88:91], v[120:123], a[200:203]
buffer_load_dwordx4 v[184:187], v7, s[8:11], s27 offen sc1
v_exp_f32 v56, v56
v_mfma_f32_16x16x32_bf16 a[204:207], a[88:91], v[124:127], a[204:207]
s_waitcnt lgkmcnt(2)
buffer_load_dwordx4 v[188:191], v7, s[8:11], s27 offen offset:2048 sc1
v_exp_f32 v57, v57
v_mfma_f32_16x16x32_bf16 a[212:215], a[92:95], v[116:119], a[212:215]
ds_read_b128 a[72:75], v2 offset:18432
v_exp_f32 v58, v58
v_mfma_f32_16x16x32_bf16 a[216:219], a[92:95], v[120:123], a[216:219]
s_add_u32 s27, s26, 1048576
v_exp_f32 v59, v59
v_cvt_pk_bf16_f32 v105, v50, v51
v_mfma_f32_16x16x32_bf16 a[220:223], a[92:95], v[124:127], a[220:223]
s_waitcnt lgkmcnt(2)
buffer_load_dwordx4 v[192:195], v7, s[8:11], s27 offen sc1
s_cmp_eq_u32 s48, 0
s_cbranch_scc0 L_at_rs6
L_at_rsr6:
v_mfma_f32_16x16x32_bf16 v[80:83], a[64:67], a[32:35], v[136:139]
ds_read_b128 a[76:79], v2 offset:19456
v_cvt_pk_bf16_f32 v106, v52, v53
v_mfma_f32_16x16x32_bf16 v[88:91], a[64:67], a[48:51], v[140:143]
s_waitcnt lgkmcnt(2)
buffer_load_dwordx4 v[196:199], v7, s[8:11], s27 offen offset:2048 sc1
v_cvt_pk_bf16_f32 v107, v54, v55
v_mfma_f32_16x16x32_bf16 v[84:87], a[68:71], a[32:35], v[136:139]
ds_read_b128 a[80:83], v2 offset:20480
s_add_u32 s27, s26, 1052672
v_mfma_f32_16x16x32_bf16 v[92:95], a[68:71], a[48:51], v[140:143]
s_waitcnt lgkmcnt(2)
v_exp_f32 v60, v60
v_mfma_f32_16x16x32_bf16 v[80:83], a[72:75], a[36:39], v[80:83]
ds_read_b128 a[84:87], v2 offset:21504
buffer_load_dwordx4 v[200:203], v7, s[8:11], s27 offen sc1
v_mfma_f32_16x16x32_bf16 v[88:91], a[72:75], a[52:55], v[88:91]
s_waitcnt lgkmcnt(2)
buffer_load_dwordx4 v[204:207], v7, s[8:11], s27 offen offset:2048 sc1
v_cvt_pk_bf16_f32 v108, v56, v57
v_mfma_f32_16x16x32_bf16 v[84:87], a[76:79], a[36:39], v[84:87]
ds_read_b128 a[88:91], v2 offset:22528
v_cvt_pk_bf16_f32 v109, v58, v59
v_mfma_f32_16x16x32_bf16 v[92:95], a[76:79], a[52:55], v[92:95]
s_waitcnt lgkmcnt(2)
s_add_u32 s27, s26, 1572864
v_mfma_f32_16x16x32_bf16 v[80:83], a[80:83], a[40:43], v[80:83]
ds_read_b128 a[92:95], v2 offset:23552
buffer_load_dwordx4 v[208:211], v7, s[8:11], s27 offen sc1
v_mfma_f32_16x16x32_bf16 v[88:91], a[80:83], a[56:59], v[88:91]
s_waitcnt lgkmcnt(2)
v_exp_f32 v61, v61
v_mfma_f32_16x16x32_bf16 v[84:87], a[84:87], a[40:43], v[84:87]
ds_read_b128 a[64:67], v2 offset:8192
buffer_load_dwordx4 v[212:215], v7, s[8:11], s27 offen offset:2048 sc1
v_cvt_pk_bf16_f32 v110, v60, v61
v_mfma_f32_16x16x32_bf16 v[92:95], a[84:87], a[56:59], v[92:95]
s_waitcnt lgkmcnt(2)
s_add_u32 s27, s26, 1576960
v_mfma_f32_16x16x32_bf16 v[80:83], a[88:91], a[44:47], v[80:83]
ds_read_b128 a[68:71], v2 offset:9216
v_exp_f32 v62, v62
v_mfma_f32_16x16x32_bf16 v[88:91], a[88:91], a[60:63], v[88:91]
s_waitcnt lgkmcnt(2)
buffer_load_dwordx4 v[216:219], v7, s[8:11], s27 offen sc1
v_mfma_f32_16x16x32_bf16 v[84:87], a[92:95], a[44:47], v[84:87]
ds_read_b128 a[72:75], v2 offset:10240
buffer_load_dwordx4 v[220:223], v7, s[8:11], s27 offen offset:2048 sc1
v_mfma_f32_16x16x32_bf16 v[92:95], a[92:95], a[60:63], v[92:95]
s_waitcnt lgkmcnt(2)
v_exp_f32 v63, v63
s_nop 0
v_cvt_pk_bf16_f32 v111, v62, v63
s_waitcnt vmcnt(28)
s_barrier
s_add_u32 s25, s61, 524288
v_mfma_f32_16x16x32_bf16 a[232:235], a[240:243], v[104:107], a[232:235]
s_add_u32 s24, s46, 4096
v_mfma_f32_16x16x32_bf16 a[236:239], a[240:243], v[108:111], a[236:239]
s_add_u32 m0, s47, 0
v_mfma_f32_16x16x32_bf16 a[104:107], a[64:67], v[104:107], a[104:107]
ds_read_b128 a[76:79], v2 offset:11264
v_mfma_f32_16x16x32_bf16 a[108:111], a[64:67], v[108:111], a[108:111]
s_waitcnt lgkmcnt(2)
buffer_load_dwordx4 v1, s[8:11], s46 offen sc1 lds
v_cndmask_b32 v80, v8, v80, s[80:81]
v_mfma_f32_16x16x32_bf16 a[120:123], a[68:71], v[104:107], a[120:123]
ds_read_b128 a[80:83], v2 offset:12288
buffer_load_dwordx4 v1, s[8:11], s46 offen offset:2048 sc1 lds
v_cndmask_b32 v81, v8, v81, s[82:83]
v_mfma_f32_16x16x32_bf16 a[124:127], a[68:71], v[108:111], a[124:127]
s_waitcnt lgkmcnt(2)
v_cndmask_b32 v82, v8, v82, s[84:85]
v_cndmask_b32 v83, v8, v83, s[86:87]
v_mfma_f32_16x16x32_bf16 a[136:139], a[72:75], v[104:107], a[136:139]
ds_read_b128 a[84:87], v2 offset:13312
s_add_u32 m0, s47, 896
v_cndmask_b32 v84, v8, v84, s[88:89]
v_mfma_f32_16x16x32_bf16 a[140:143], a[72:75], v[108:111], a[140:143]
s_waitcnt lgkmcnt(2)
v_cndmask_b32 v85, v8, v85, s[90:91]
v_cndmask_b32 v86, v8, v86, s[92:93]
v_mfma_f32_16x16x32_bf16 a[152:155], a[76:79], v[104:107], a[152:155]
ds_read_b128 a[88:91], v2 offset:14336
buffer_load_dwordx4 v1, s[8:11], s46 offen offset:128 sc1 lds
v_cndmask_b32 v87, v8, v87, s[94:95]
v_mfma_f32_16x16x32_bf16 a[156:159], a[76:79], v[108:111], a[156:159]
s_waitcnt lgkmcnt(2)
buffer_load_dwordx4 v1, s[8:11], s46 offen offset:2176 sc1 lds
v_max3_f32 v16, v80, v81, v82
v_max3_f32 v16, v16, v83, v88
v_mfma_f32_16x16x32_bf16 a[168:171], a[80:83], v[104:107], a[168:171]
ds_read_b128 a[92:95], v2 offset:15360
v_max3_f32 v16, v16, v89, v90
v_max3_f32 v16, v16, v91, v84
v_mfma_f32_16x16x32_bf16 a[172:175], a[80:83], v[108:111], a[172:175]
s_waitcnt lgkmcnt(2)
s_add_u32 m0, s47, 4096
v_max3_f32 v16, v16, v85, v86
v_max3_f32 v16, v16, v87, v92
v_mfma_f32_16x16x32_bf16 a[184:187], a[84:87], v[104:107], a[184:187]
ds_read_b128 a[64:67], v3
v_max3_f32 v16, v16, v93, v94
v_max_f32 v16, v16, v95
v_cmp_lt_f32 vcc, s54, v16
v_mfma_f32_16x16x32_bf16 a[188:191], a[84:87], v[108:111], a[188:191]
s_waitcnt lgkmcnt(2)
buffer_load_dwordx4 v1, s[8:11], s24 offen sc1 lds
s_cbranch_vccnz L_at_up7
L_at_upr7:
v_exp_f32 v80, v80
v_exp_f32 v81, v81
v_exp_f32 v82, v82
v_exp_f32 v83, v83
v_exp_f32 v84, v84
v_accvgpr_read_b32 v18, a228
v_mfma_f32_16x16x32_bf16 a[200:203], a[88:91], v[104:107], a[200:203]
ds_read_b128 a[68:71], v3 offset:1024
buffer_load_dwordx4 v1, s[8:11], s24 offen offset:2048 sc1 lds
v_exp_f32 v85, v85
v_exp_f32 v86, v86
v_exp_f32 v87, v87
v_exp_f32 v88, v88
v_exp_f32 v89, v89
v_cvt_pk_bf16_f32 v120, v80, v81
v_mfma_f32_16x16x32_bf16 a[204:207], a[88:91], v[108:111], a[204:207]
s_waitcnt lgkmcnt(2)
v_exp_f32 v90, v90
v_exp_f32 v91, v91
v_exp_f32 v92, v92
v_exp_f32 v93, v93
v_exp_f32 v94, v94
v_exp_f32 v95, v95
v_cvt_pk_bf16_f32 v121, v82, v83
v_mfma_f32_16x16x32_bf16 a[216:219], a[92:95], v[104:107], a[216:219]
ds_read_b128 a[72:75], v3 offset:2048
s_add_u32 m0, s47, 4992
v_cvt_pk_bf16_f32 v122, v84, v85
v_cvt_pk_bf16_f32 v123, v86, v87
v_cvt_pk_bf16_f32 v124, v88, v89
v_cvt_pk_bf16_f32 v125, v90, v91
v_cvt_pk_bf16_f32 v126, v92, v93
v_cvt_pk_bf16_f32 v127, v94, v95
v_rcp_f32 v18, v18
v_accvgpr_read_b32 v224, a100
v_accvgpr_read_b32 v225, a101
v_accvgpr_read_b32 v226, a102
v_mfma_f32_16x16x32_bf16 a[220:223], a[92:95], v[108:111], a[220:223]
s_waitcnt lgkmcnt(2)
buffer_load_dwordx4 v1, s[8:11], s24 offen offset:128 sc1 lds
s_cmp_eq_u32 s48, 0
s_cbranch_scc0 L_at_rs7
L_at_rsr7:
v_accvgpr_read_b32 v227, a103
v_accvgpr_read_b32 v228, a116
v_accvgpr_read_b32 v229, a117
v_accvgpr_read_b32 v230, a118
v_accvgpr_read_b32 v231, a119
v_mul_f32 v224, v224, v18
v_mul_f32 v225, v225, v18
v_mul_f32 v226, v226, v18
v_mul_f32 v227, v227, v18
v_mul_f32 v228, v228, v18
v_mul_f32 v229, v229, v18
v_mfma_f32_16x16x32_bf16 v[56:59], a[64:67], a[48:51], v[140:143]
ds_read_b128 a[76:79], v3 offset:3072
s_waitcnt lgkmcnt(2)
v_mul_f32 v230, v230, v18
v_mul_f32 v231, v231, v18
v_cvt_pk_bf16_f32 v224, v224, v225
v_cvt_pk_bf16_f32 v225, v226, v227
v_cvt_pk_bf16_f32 v226, v228, v229
v_cvt_pk_bf16_f32 v227, v230, v231
buffer_store_dwordx4 v[224:227], v6, s[8:11], s25 offen sc1
v_accvgpr_read_b32 v232, a132
v_mfma_f32_16x16x32_bf16 v[60:63], a[68:71], a[48:51], v[140:143]
ds_read_b128 a[80:83], v3 offset:4096
s_waitcnt lgkmcnt(2)
buffer_load_dwordx4 v1, s[8:11], s24 offen offset:2176 sc1 lds
v_accvgpr_read_b32 v233, a133
v_accvgpr_read_b32 v234, a134
v_accvgpr_read_b32 v235, a135
v_accvgpr_read_b32 v236, a148
v_accvgpr_read_b32 v237, a149
v_accvgpr_read_b32 v238, a150
v_accvgpr_read_b32 v239, a151
v_mul_f32 v232, v232, v18
v_mul_f32 v233, v233, v18
v_mul_f32 v234, v234, v18
v_mul_f32 v235, v235, v18
v_mfma_f32_16x16x32_bf16 v[56:59], a[72:75], a[52:55], v[56:59]
ds_read_b128 a[84:87], v3 offset:5120
s_waitcnt lgkmcnt(2)
v_mul_f32 v236, v236, v18
v_mul_f32 v237, v237, v18
v_mul_f32 v238, v238, v18
v_mul_f32 v239, v239, v18
v_cvt_pk_bf16_f32 v232, v232, v233
v_cvt_pk_bf16_f32 v233, v234, v235
v_cvt_pk_bf16_f32 v234, v236, v237
v_cvt_pk_bf16_f32 v235, v238, v239
buffer_store_dwordx4 v[232:235], v6, s[8:11], s25 offen offset:1024 sc1
v_mfma_f32_16x16x32_bf16 v[60:63], a[76:79], a[52:55], v[60:63]
ds_read_b128 a[88:91], v3 offset:6144
s_waitcnt lgkmcnt(2)
s_add_u32 s46, s46, 1048576
v_accvgpr_read_b32 v240, a164
v_accvgpr_read_b32 v241, a165
v_accvgpr_read_b32 v242, a166
v_accvgpr_read_b32 v243, a167
v_accvgpr_read_b32 v244, a180
v_accvgpr_read_b32 v245, a181
v_accvgpr_read_b32 v246, a182
v_accvgpr_read_b32 v247, a183
v_mul_f32 v240, v240, v18
v_mul_f32 v241, v241, v18
v_mfma_f32_16x16x32_bf16 v[56:59], a[80:83], a[56:59], v[56:59]
ds_read_b128 a[92:95], v3 offset:7168
s_waitcnt lgkmcnt(2)
s_add_u32 s47, s47, 32768
v_mul_f32 v242, v242, v18
v_mul_f32 v243, v243, v18
v_mul_f32 v244, v244, v18
v_mul_f32 v245, v245, v18
v_mul_f32 v246, v246, v18
v_mul_f32 v247, v247, v18
v_cvt_pk_bf16_f32 v240, v240, v241
v_cvt_pk_bf16_f32 v241, v242, v243
v_cvt_pk_bf16_f32 v242, v244, v245
v_cvt_pk_bf16_f32 v243, v246, v247
v_mfma_f32_16x16x32_bf16 v[60:63], a[84:87], a[56:59], v[60:63]
ds_read_b128 a[64:67], v2 offset:24576
s_waitcnt lgkmcnt(2)
buffer_store_dwordx4 v[240:243], v6, s[8:11], s25 offen offset:2048 sc1
v_accvgpr_read_b32 v248, a196
v_accvgpr_read_b32 v249, a197
v_accvgpr_read_b32 v250, a198
v_accvgpr_read_b32 v251, a199
v_accvgpr_read_b32 v252, a212
v_accvgpr_read_b32 v253, a213
v_mfma_f32_16x16x32_bf16 v[56:59], a[88:91], a[60:63], v[56:59]
ds_read_b128 a[68:71], v2 offset:25600
s_waitcnt lgkmcnt(2)
s_and_b32 s47, s47, 131071
v_accvgpr_read_b32 v254, a214
v_accvgpr_read_b32 v255, a215
v_mul_f32 v248, v248, v18
v_mul_f32 v249, v249, v18
v_mul_f32 v250, v250, v18
v_mul_f32 v251, v251, v18
v_mul_f32 v252, v252, v18
v_mul_f32 v253, v253, v18
v_mul_f32 v254, v254, v18
v_mfma_f32_16x16x32_bf16 v[60:63], a[92:95], a[60:63], v[60:63]
ds_read_b128 a[72:75], v2 offset:26624
s_waitcnt lgkmcnt(2)
v_mul_f32 v255, v255, v18
v_cvt_pk_bf16_f32 v248, v248, v249
v_cvt_pk_bf16_f32 v249, v250, v251
v_cvt_pk_bf16_f32 v250, v252, v253
v_cvt_pk_bf16_f32 v251, v254, v255
buffer_store_dwordx4 v[248:251], v6, s[8:11], s25 offen offset:3072 sc1
v_mov_b32 v4, v2
v_mov_b32 v2, v3
v_add_u32 v3, 32768, v3
v_and_b32 v3, 131071, v3
v_mfma_f32_16x16x32_bf16 a[232:235], a[240:243], v[120:123], a[232:235]
v_mfma_f32_16x16x32_bf16 a[236:239], a[240:243], v[124:127], a[236:239]
v_mfma_f32_16x16x32_bf16 a[104:107], a[64:67], v[120:123], a[104:107]
ds_read_b128 a[76:79], v4 offset:27648
v_mfma_f32_16x16x32_bf16 a[108:111], a[64:67], v[124:127], a[108:111]
s_waitcnt lgkmcnt(2)
v_cndmask_b32 v56, v8, v56, s[64:65]
v_cndmask_b32 v57, v8, v57, s[66:67]
v_mfma_f32_16x16x32_bf16 a[120:123], a[68:71], v[120:123], a[120:123]
ds_read_b128 a[80:83], v4 offset:28672
v_cndmask_b32 v58, v8, v58, s[68:69]
v_mfma_f32_16x16x32_bf16 a[124:127], a[68:71], v[124:127], a[124:127]
s_waitcnt lgkmcnt(2)
v_cndmask_b32 v59, v8, v59, s[70:71]
v_cndmask_b32 v60, v8, v60, s[72:73]
v_mfma_f32_16x16x32_bf16 a[136:139], a[72:75], v[120:123], a[136:139]
ds_read_b128 a[84:87], v4 offset:29696
v_cndmask_b32 v61, v8, v61, s[74:75]
v_mfma_f32_16x16x32_bf16 a[140:143], a[72:75], v[124:127], a[140:143]
s_waitcnt lgkmcnt(2)
v_cndmask_b32 v62, v8, v62, s[76:77]
v_cndmask_b32 v63, v8, v63, s[78:79]
v_mfma_f32_16x16x32_bf16 a[152:155], a[76:79], v[120:123], a[152:155]
ds_read_b128 a[88:91], v4 offset:30720
v_max3_f32 v16, v56, v57, v58
v_mfma_f32_16x16x32_bf16 a[156:159], a[76:79], v[124:127], a[156:159]
s_waitcnt lgkmcnt(2)
v_max3_f32 v16, v16, v59, v60
v_max3_f32 v16, v16, v61, v62
v_mfma_f32_16x16x32_bf16 a[168:171], a[80:83], v[120:123], a[168:171]
ds_read_b128 a[92:95], v4 offset:31744
v_max_f32 v16, v16, v63
v_cmp_lt_f32 vcc, s54, v16
v_mfma_f32_16x16x32_bf16 a[172:175], a[80:83], v[124:127], a[172:175]
s_waitcnt lgkmcnt(2)
s_cbranch_vccnz L_at_up8
L_at_upr8:
v_mfma_f32_16x16x32_bf16 a[184:187], a[84:87], v[120:123], a[184:187]
ds_read_b128 a[64:67], v2 offset:16384
v_exp_f32 v56, v56
v_mfma_f32_16x16x32_bf16 a[188:191], a[84:87], v[124:127], a[188:191]
s_waitcnt lgkmcnt(2)
v_exp_f32 v57, v57
v_mfma_f32_16x16x32_bf16 a[200:203], a[88:91], v[120:123], a[200:203]
ds_read_b128 a[68:71], v2 offset:17408
v_exp_f32 v58, v58
v_mfma_f32_16x16x32_bf16 a[204:207], a[88:91], v[124:127], a[204:207]
s_waitcnt lgkmcnt(2)
v_exp_f32 v59, v59
v_cvt_pk_bf16_f32 v108, v56, v57
v_mfma_f32_16x16x32_bf16 a[216:219], a[92:95], v[120:123], a[216:219]
ds_read_b128 a[72:75], v2 offset:18432
v_exp_f32 v60, v60
v_mfma_f32_16x16x32_bf16 a[220:223], a[92:95], v[124:127], a[220:223]
s_waitcnt lgkmcnt(2)
s_cmp_eq_u32 s48, 0
s_cbranch_scc0 L_at_rs8
L_at_rsr8:
v_cvt_pk_bf16_f32 v109, v58, v59
v_mfma_f32_16x16x32_bf16 v[88:91], a[64:67], a[48:51], v[140:143]
ds_read_b128 a[76:79], v2 offset:19456
s_waitcnt lgkmcnt(2)
v_mfma_f32_16x16x32_bf16 v[92:95], a[68:71], a[48:51], v[140:143]
ds_read_b128 a[80:83], v2 offset:20480
s_waitcnt lgkmcnt(2)
v_exp_f32 v61, v61
v_mfma_f32_16x16x32_bf16 v[88:91], a[72:75], a[52:55], v[88:91]
ds_read_b128 a[84:87], v2 offset:21504
s_waitcnt lgkmcnt(2)
v_cvt_pk_bf16_f32 v110, v60, v61
v_mfma_f32_16x16x32_bf16 v[92:95], a[76:79], a[52:55], v[92:95]
ds_read_b128 a[88:91], v2 offset:22528
s_waitcnt lgkmcnt(2)
v_mfma_f32_16x16x32_bf16 v[88:91], a[80:83], a[56:59], v[88:91]
ds_read_b128 a[92:95], v2 offset:23552
s_waitcnt lgkmcnt(2)
v_exp_f32 v62, v62
v_mfma_f32_16x16x32_bf16 v[92:95], a[84:87], a[56:59], v[92:95]
ds_read_b128 a[64:67], v2 offset:8192
s_waitcnt lgkmcnt(2)
v_mfma_f32_16x16x32_bf16 v[88:91], a[88:91], a[60:63], v[88:91]
ds_read_b128 a[68:71], v2 offset:9216
s_waitcnt lgkmcnt(2)
v_exp_f32 v63, v63
v_mfma_f32_16x16x32_bf16 v[92:95], a[92:95], a[60:63], v[92:95]
ds_read_b128 a[72:75], v2 offset:10240
s_waitcnt lgkmcnt(2)
v_cvt_pk_bf16_f32 v111, v62, v63
s_barrier
s_add_u32 s25, s61, 1048576
v_mfma_f32_16x16x32_bf16 a[236:239], a[240:243], v[108:111], a[236:239]
s_add_u32 s24, s46, 4096
s_add_u32 m0, s47, 0
v_mfma_f32_16x16x32_bf16 a[108:111], a[64:67], v[108:111], a[108:111]
ds_read_b128 a[76:79], v2 offset:11264
s_waitcnt lgkmcnt(2)
buffer_load_dwordx4 v1, s[8:11], s46 offen sc1 lds
buffer_load_dwordx4 v1, s[8:11], s46 offen offset:2048 sc1 lds
v_mfma_f32_16x16x32_bf16 a[124:127], a[68:71], v[108:111], a[124:127]
ds_read_b128 a[80:83], v2 offset:12288
s_waitcnt lgkmcnt(2)
s_add_u32 m0, s47, 896
s_nop 0
buffer_load_dwordx4 v1, s[8:11], s46 offen offset:128 sc1 lds
v_mfma_f32_16x16x32_bf16 a[140:143], a[72:75], v[108:111], a[140:143]
ds_read_b128 a[84:87], v2 offset:13312
s_waitcnt lgkmcnt(2)
buffer_load_dwordx4 v1, s[8:11], s46 offen offset:2176 sc1 lds
s_add_u32 m0, s47, 4096
v_cndmask_b32 v88, v8, v88, s[80:81]
v_cndmask_b32 v89, v8, v89, s[82:83]
v_cndmask_b32 v90, v8, v90, s[84:85]
v_mfma_f32_16x16x32_bf16 a[156:159], a[76:79], v[108:111], a[156:159]
ds_read_b128 a[88:91], v2 offset:14336
s_waitcnt lgkmcnt(2)
buffer_load_dwordx4 v1, s[8:11], s24 offen sc1 lds
v_cndmask_b32 v91, v8, v91, s[86:87]
v_cndmask_b32 v92, v8, v92, s[88:89]
v_cndmask_b32 v93, v8, v93, s[90:91]
v_cndmask_b32 v94, v8, v94, s[92:93]
v_mfma_f32_16x16x32_bf16 a[172:175], a[80:83], v[108:111], a[172:175]
ds_read_b128 a[92:95], v2 offset:15360
s_waitcnt lgkmcnt(2)
buffer_load_dwordx4 v1, s[8:11], s24 offen offset:2048 sc1 lds
s_add_u32 m0, s47, 4992
v_cndmask_b32 v95, v8, v95, s[94:95]
v_max3_f32 v16, v88, v89, v90
v_max3_f32 v16, v16, v91, v92
v_mfma_f32_16x16x32_bf16 a[188:191], a[84:87], v[108:111], a[188:191]
ds_read_b128 a[64:67], v2 offset:24576
s_waitcnt lgkmcnt(2)
buffer_load_dwordx4 v1, s[8:11], s24 offen offset:128 sc1 lds
buffer_load_dwordx4 v1, s[8:11], s24 offen offset:2176 sc1 lds
v_max3_f32 v16, v16, v93, v94
v_max_f32 v16, v16, v95
v_cmp_lt_f32 vcc, s54, v16
v_mfma_f32_16x16x32_bf16 a[204:207], a[88:91], v[108:111], a[204:207]
ds_read_b128 a[68:71], v2 offset:25600
s_waitcnt lgkmcnt(2)
s_add_u32 s46, s46, 1048576
s_add_u32 s47, s47, 32768
s_cbranch_vccnz L_at_up9
L_at_upr9:
v_exp_f32 v88, v88
v_exp_f32 v89, v89
v_exp_f32 v90, v90
v_exp_f32 v91, v91
v_exp_f32 v92, v92
v_exp_f32 v93, v93
v_exp_f32 v94, v94
v_exp_f32 v95, v95
v_accvgpr_read_b32 v18, a232
v_rcp_f32 v18, v18
v_accvgpr_read_b32 v224, a104
v_accvgpr_read_b32 v225, a105
v_accvgpr_read_b32 v226, a106
v_accvgpr_read_b32 v227, a107
v_accvgpr_read_b32 v228, a120
v_accvgpr_read_b32 v229, a121
v_accvgpr_read_b32 v230, a122
v_accvgpr_read_b32 v231, a123
v_mul_f32 v224, v224, v18
v_mul_f32 v225, v225, v18
v_mul_f32 v226, v226, v18
v_mul_f32 v227, v227, v18
v_mul_f32 v228, v228, v18
v_mul_f32 v229, v229, v18
v_mul_f32 v230, v230, v18
v_mul_f32 v231, v231, v18
v_cvt_pk_bf16_f32 v224, v224, v225
v_cvt_pk_bf16_f32 v225, v226, v227
v_cvt_pk_bf16_f32 v226, v228, v229
v_cvt_pk_bf16_f32 v227, v230, v231
buffer_store_dwordx4 v[224:227], v6, s[8:11], s25 offen sc1
v_accvgpr_read_b32 v232, a136
v_accvgpr_read_b32 v233, a137
v_accvgpr_read_b32 v234, a138
v_accvgpr_read_b32 v235, a139
v_accvgpr_read_b32 v236, a152
v_accvgpr_read_b32 v237, a153
v_accvgpr_read_b32 v238, a154
v_accvgpr_read_b32 v239, a155
v_mul_f32 v232, v232, v18
v_mul_f32 v233, v233, v18
v_mul_f32 v234, v234, v18
v_mul_f32 v235, v235, v18
v_mul_f32 v236, v236, v18
v_mul_f32 v237, v237, v18
v_mul_f32 v238, v238, v18
v_mul_f32 v239, v239, v18
v_cvt_pk_bf16_f32 v232, v232, v233
v_mfma_f32_16x16x32_bf16 a[220:223], a[92:95], v[108:111], a[220:223]
ds_read_b128 a[72:75], v2 offset:26624
s_waitcnt lgkmcnt(2)
s_and_b32 s47, s47, 131071
s_cmp_eq_u32 s48, 0
s_cbranch_scc0 L_at_rs9
L_at_rsr9:
v_cvt_pk_bf16_f32 v124, v88, v89
v_cvt_pk_bf16_f32 v125, v90, v91
v_cvt_pk_bf16_f32 v126, v92, v93
v_cvt_pk_bf16_f32 v127, v94, v95
v_cvt_pk_bf16_f32 v233, v234, v235
v_cvt_pk_bf16_f32 v234, v236, v237
v_cvt_pk_bf16_f32 v235, v238, v239
buffer_store_dwordx4 v[232:235], v6, s[8:11], s25 offen offset:1024 sc1
v_accvgpr_read_b32 v240, a168
v_accvgpr_read_b32 v241, a169
v_accvgpr_read_b32 v242, a170
v_accvgpr_read_b32 v243, a171
v_accvgpr_read_b32 v244, a184
v_accvgpr_read_b32 v245, a185
v_accvgpr_read_b32 v246, a186
v_accvgpr_read_b32 v247, a187
v_mul_f32 v240, v240, v18
v_mul_f32 v241, v241, v18
v_mul_f32 v242, v242, v18
v_mul_f32 v243, v243, v18
v_mul_f32 v244, v244, v18
v_mul_f32 v245, v245, v18
v_mul_f32 v246, v246, v18
v_mul_f32 v247, v247, v18
v_cvt_pk_bf16_f32 v240, v240, v241
v_cvt_pk_bf16_f32 v241, v242, v243
v_cvt_pk_bf16_f32 v242, v244, v245
v_cvt_pk_bf16_f32 v243, v246, v247
buffer_store_dwordx4 v[240:243], v6, s[8:11], s25 offen offset:2048 sc1
v_accvgpr_read_b32 v248, a200
v_accvgpr_read_b32 v249, a201
v_accvgpr_read_b32 v250, a202
v_accvgpr_read_b32 v251, a203
v_accvgpr_read_b32 v252, a216
v_accvgpr_read_b32 v253, a217
v_accvgpr_read_b32 v254, a218
v_accvgpr_read_b32 v255, a219
v_mul_f32 v248, v248, v18
v_mul_f32 v249, v249, v18
v_mul_f32 v250, v250, v18
v_mul_f32 v251, v251, v18
v_mul_f32 v252, v252, v18
v_mul_f32 v253, v253, v18
v_mul_f32 v254, v254, v18
v_mul_f32 v255, v255, v18
v_cvt_pk_bf16_f32 v248, v248, v249
v_cvt_pk_bf16_f32 v249, v250, v251
v_cvt_pk_bf16_f32 v250, v252, v253
v_cvt_pk_bf16_f32 v251, v254, v255
buffer_store_dwordx4 v[248:251], v6, s[8:11], s25 offen offset:3072 sc1
v_mfma_f32_16x16x32_bf16 a[236:239], a[240:243], v[124:127], a[236:239]
v_mfma_f32_16x16x32_bf16 a[108:111], a[64:67], v[124:127], a[108:111]
ds_read_b128 a[76:79], v2 offset:27648
s_waitcnt lgkmcnt(2)
v_mfma_f32_16x16x32_bf16 a[124:127], a[68:71], v[124:127], a[124:127]
ds_read_b128 a[80:83], v2 offset:28672
s_waitcnt lgkmcnt(2)
v_mfma_f32_16x16x32_bf16 a[140:143], a[72:75], v[124:127], a[140:143]
ds_read_b128 a[84:87], v2 offset:29696
s_waitcnt lgkmcnt(2)
v_mfma_f32_16x16x32_bf16 a[156:159], a[76:79], v[124:127], a[156:159]
ds_read_b128 a[88:91], v2 offset:30720
s_waitcnt lgkmcnt(2)
v_mfma_f32_16x16x32_bf16 a[172:175], a[80:83], v[124:127], a[172:175]
ds_read_b128 a[92:95], v2 offset:31744
s_waitcnt lgkmcnt(2)
v_mfma_f32_16x16x32_bf16 a[188:191], a[84:87], v[124:127], a[188:191]
s_waitcnt lgkmcnt(1)
v_mfma_f32_16x16x32_bf16 a[204:207], a[88:91], v[124:127], a[204:207]
s_waitcnt lgkmcnt(0)
v_mfma_f32_16x16x32_bf16 a[220:223], a[92:95], v[124:127], a[220:223]
s_add_u32 s25, s61, 1572864
v_accvgpr_read_b32 v18, a236
v_rcp_f32 v18, v18
v_accvgpr_read_b32 v224, a108
v_accvgpr_read_b32 v225, a109
v_accvgpr_read_b32 v226, a110
v_accvgpr_read_b32 v227, a111
v_accvgpr_read_b32 v228, a124
v_accvgpr_read_b32 v229, a125
v_accvgpr_read_b32 v230, a126
v_accvgpr_read_b32 v231, a127
v_mul_f32 v224, v224, v18
v_mul_f32 v225, v225, v18
v_mul_f32 v226, v226, v18
v_mul_f32 v227, v227, v18
v_mul_f32 v228, v228, v18
v_mul_f32 v229, v229, v18
v_mul_f32 v230, v230, v18
v_mul_f32 v231, v231, v18
v_cvt_pk_bf16_f32 v224, v224, v225
v_cvt_pk_bf16_f32 v225, v226, v227
v_cvt_pk_bf16_f32 v226, v228, v229
v_cvt_pk_bf16_f32 v227, v230, v231
buffer_store_dwordx4 v[224:227], v6, s[8:11], s25 offen sc1
v_accvgpr_read_b32 v232, a140
v_accvgpr_read_b32 v233, a141
v_accvgpr_read_b32 v234, a142
v_accvgpr_read_b32 v235, a143
v_accvgpr_read_b32 v236, a156
v_accvgpr_read_b32 v237, a157
v_accvgpr_read_b32 v238, a158
v_accvgpr_read_b32 v239, a159
v_mul_f32 v232, v232, v18
v_mul_f32 v233, v233, v18
v_mul_f32 v234, v234, v18
v_mul_f32 v235, v235, v18
v_mul_f32 v236, v236, v18
v_mul_f32 v237, v237, v18
v_mul_f32 v238, v238, v18
v_mul_f32 v239, v239, v18
v_cvt_pk_bf16_f32 v232, v232, v233
v_cvt_pk_bf16_f32 v233, v234, v235
v_cvt_pk_bf16_f32 v234, v236, v237
v_cvt_pk_bf16_f32 v235, v238, v239
buffer_store_dwordx4 v[232:235], v6, s[8:11], s25 offen offset:1024 sc1
v_accvgpr_read_b32 v240, a172
v_accvgpr_read_b32 v241, a173
v_accvgpr_read_b32 v242, a174
v_accvgpr_read_b32 v243, a175
v_accvgpr_read_b32 v244, a188
v_accvgpr_read_b32 v245, a189
v_accvgpr_read_b32 v246, a190
v_accvgpr_read_b32 v247, a191
v_mul_f32 v240, v240, v18
v_mul_f32 v241, v241, v18
v_mul_f32 v242, v242, v18
v_mul_f32 v243, v243, v18
v_mul_f32 v244, v244, v18
v_mul_f32 v245, v245, v18
v_mul_f32 v246, v246, v18
v_mul_f32 v247, v247, v18
v_cvt_pk_bf16_f32 v240, v240, v241
v_cvt_pk_bf16_f32 v241, v242, v243
v_cvt_pk_bf16_f32 v242, v244, v245
v_cvt_pk_bf16_f32 v243, v246, v247
buffer_store_dwordx4 v[240:243], v6, s[8:11], s25 offen offset:2048 sc1
v_accvgpr_read_b32 v248, a204
v_accvgpr_read_b32 v249, a205
v_accvgpr_read_b32 v250, a206
v_accvgpr_read_b32 v251, a207
v_accvgpr_read_b32 v252, a220
v_accvgpr_read_b32 v253, a221
v_accvgpr_read_b32 v254, a222
v_accvgpr_read_b32 v255, a223
v_mul_f32 v248, v248, v18
v_mul_f32 v249, v249, v18
v_mul_f32 v250, v250, v18
v_mul_f32 v251, v251, v18
v_mul_f32 v252, v252, v18
v_mul_f32 v253, v253, v18
v_mul_f32 v254, v254, v18
v_mul_f32 v255, v255, v18
v_cvt_pk_bf16_f32 v248, v248, v249
v_cvt_pk_bf16_f32 v249, v250, v251
v_cvt_pk_bf16_f32 v250, v252, v253
v_cvt_pk_bf16_f32 v251, v254, v255
buffer_store_dwordx4 v[248:251], v6, s[8:11], s25 offen offset:3072 sc1
s_lshl_b32 s60, s41, 5
s_add_u32 s60, s60, s42
s_lshl_b32 s60, s60, 2
s_add_u32 s60, s60, 111169536
s_cmp_eq_u32 s17, 0
s_cselect_b32 s60, s60, 536870912
s_mov_b32 s41, s63
s_mov_b32 s63, 8
s_waitcnt vmcnt(28)
s_cmp_lt_u32 s41, 8
s_cbranch_scc1 L_at_item
s_waitcnt vmcnt(0)
s_barrier
v_mov_b32 v19, 1
s_mov_b64 exec, 1
buffer_store_dword v19, v6, s[8:11], s60 offen sc1
s_mov_b64 exec, -1
s_branch L_at_done
L_at_hk:
s_cmp_eq_u32 s45, 2
s_cbranch_scc0 L_at_hk2
v_mov_b32 v19, 1
s_mov_b64 exec, 1
buffer_store_dword v19, v6, s[8:11], s60 offen sc1
s_mov_b64 exec, -1
s_mov_b32 s60, 536870912
s_mov_b32 s45, 13
s_branch L_at_hkr
L_at_hk2:
v_and_b32 v20, 3, v0
v_lshlrev_b32 v20, 2, v20
s_lshl_b32 s25, s42, 7
s_add_u32 s25, s25, 111165456
s_mov_b32 s28, 0
L_poll_16:
buffer_load_dword v21, v20, s[8:11], s25 offen sc1
s_add_u32 s28, s28, 1
s_cmp_gt_u32 s28, 200000
s_cbranch_scc1 L_end
s_waitcnt vmcnt(0)
v_cmp_ne_u32 vcc, 1, v21
s_cbranch_vccz L_pd_17
s_sleep 1
s_branch L_poll_16
L_pd_17:
s_branch L_at_hkr
L_at_up0:
v_max3_f32 v16, v32, v33, v34
v_max3_f32 v16, v16, v35, v36
v_max3_f32 v16, v16, v37, v38
v_max_f32 v16, v16, v39
v_mov_b32 v17, v16
s_nop 1
v_permlane32_swap_b32 v17, v16
v_max_f32 v16, v16, v17
v_mov_b32 v17, v16
s_nop 1
v_permlane16_swap_b32 v17, v16
v_max3_f32 v16, v16, v17, s55
v_exp_f32 v12, -v16
v_sub_f32 v32, v32, v16
v_sub_f32 v33, v33, v16
v_sub_f32 v34, v34, v16
v_sub_f32 v35, v35, v16
v_sub_f32 v36, v36, v16
v_sub_f32 v37, v37, v16
v_sub_f32 v38, v38, v16
v_sub_f32 v39, v39, v16
v_sub_f32 v128, v128, v16
v_sub_f32 v129, v129, v16
v_sub_f32 v130, v130, v16
v_sub_f32 v131, v131, v16
v_max3_f32 v16, v40, v41, v42
v_max3_f32 v16, v16, v43, v44
v_max3_f32 v16, v16, v45, v46
v_max_f32 v16, v16, v47
v_mov_b32 v17, v16
s_nop 1
v_permlane32_swap_b32 v17, v16
v_max_f32 v16, v16, v17
v_mov_b32 v17, v16
s_nop 1
v_permlane16_swap_b32 v17, v16
v_max3_f32 v16, v16, v17, s55
v_exp_f32 v13, -v16
v_sub_f32 v40, v40, v16
v_sub_f32 v41, v41, v16
v_sub_f32 v42, v42, v16
v_sub_f32 v43, v43, v16
v_sub_f32 v44, v44, v16
v_sub_f32 v45, v45, v16
v_sub_f32 v46, v46, v16
v_sub_f32 v47, v47, v16
v_sub_f32 v132, v132, v16
v_sub_f32 v133, v133, v16
v_sub_f32 v134, v134, v16
v_sub_f32 v135, v135, v16
v_max3_f32 v16, v48, v49, v50
v_max3_f32 v16, v16, v51, v52
v_max3_f32 v16, v16, v53, v54
v_max_f32 v16, v16, v55
v_mov_b32 v17, v16
s_nop 1
v_permlane32_swap_b32 v17, v16
v_max_f32 v16, v16, v17
v_mov_b32 v17, v16
s_nop 1
v_permlane16_swap_b32 v17, v16
v_max3_f32 v16, v16, v17, s55
v_exp_f32 v14, -v16
v_sub_f32 v48, v48, v16
v_sub_f32 v49, v49, v16
v_sub_f32 v50, v50, v16
v_sub_f32 v51, v51, v16
v_sub_f32 v52, v52, v16
v_sub_f32 v53, v53, v16
v_sub_f32 v54, v54, v16
v_sub_f32 v55, v55, v16
v_sub_f32 v136, v136, v16
v_sub_f32 v137, v137, v16
v_sub_f32 v138, v138, v16
v_sub_f32 v139, v139, v16
v_max3_f32 v16, v56, v57, v58
v_max3_f32 v16, v16, v59, v60
v_max3_f32 v16, v16, v61, v62
v_max_f32 v16, v16, v63
v_mov_b32 v17, v16
s_nop 1
v_permlane32_swap_b32 v17, v16
v_max_f32 v16, v16, v17
v_mov_b32 v17, v16
s_nop 1
v_permlane16_swap_b32 v17, v16
v_max3_f32 v16, v16, v17, s55
v_exp_f32 v15, -v16
v_sub_f32 v56, v56, v16
v_sub_f32 v57, v57, v16
v_sub_f32 v58, v58, v16
v_sub_f32 v59, v59, v16
v_sub_f32 v60, v60, v16
v_sub_f32 v61, v61, v16
v_sub_f32 v62, v62, v16
v_sub_f32 v63, v63, v16
v_sub_f32 v140, v140, v16
v_sub_f32 v141, v141, v16
v_sub_f32 v142, v142, v16
v_sub_f32 v143, v143, v16
s_cmp_eq_u32 s55, 0
s_cselect_b32 s48, 1, 0
s_mov_b32 s55, 0
s_mov_b32 s54, s51
s_branch L_at_upr0
L_at_rs0:
s_mov_b32 s52, 0
s_branch L_at_rescale
L_at_up1:
v_max3_f32 v16, v64, v65, v66
v_max3_f32 v16, v16, v67, v68
v_max3_f32 v16, v16, v69, v70
v_max_f32 v16, v16, v71
v_mov_b32 v17, v16
s_nop 1
v_permlane32_swap_b32 v17, v16
v_max_f32 v16, v16, v17
v_mov_b32 v17, v16
s_nop 1
v_permlane16_swap_b32 v17, v16
v_max3_f32 v16, v16, v17, s55
v_exp_f32 v12, -v16
v_sub_f32 v64, v64, v16
v_sub_f32 v65, v65, v16
v_sub_f32 v66, v66, v16
v_sub_f32 v67, v67, v16
v_sub_f32 v68, v68, v16
v_sub_f32 v69, v69, v16
v_sub_f32 v70, v70, v16
v_sub_f32 v71, v71, v16
v_sub_f32 v128, v128, v16
v_sub_f32 v129, v129, v16
v_sub_f32 v130, v130, v16
v_sub_f32 v131, v131, v16
v_max3_f32 v16, v72, v73, v74
v_max3_f32 v16, v16, v75, v76
v_max3_f32 v16, v16, v77, v78
v_max_f32 v16, v16, v79
v_mov_b32 v17, v16
s_nop 1
v_permlane32_swap_b32 v17, v16
v_max_f32 v16, v16, v17
v_mov_b32 v17, v16
s_nop 1
v_permlane16_swap_b32 v17, v16
v_max3_f32 v16, v16, v17, s55
v_exp_f32 v13, -v16
v_sub_f32 v72, v72, v16
v_sub_f32 v73, v73, v16
v_sub_f32 v74, v74, v16
v_sub_f32 v75, v75, v16
v_sub_f32 v76, v76, v16
v_sub_f32 v77, v77, v16
v_sub_f32 v78, v78, v16
v_sub_f32 v79, v79, v16
v_sub_f32 v132, v132, v16
v_sub_f32 v133, v133, v16
v_sub_f32 v134, v134, v16
v_sub_f32 v135, v135, v16
v_max3_f32 v16, v80, v81, v82
v_max3_f32 v16, v16, v83, v84
v_max3_f32 v16, v16, v85, v86
v_max_f32 v16, v16, v87
v_mov_b32 v17, v16
s_nop 1
v_permlane32_swap_b32 v17, v16
v_max_f32 v16, v16, v17
v_mov_b32 v17, v16
s_nop 1
v_permlane16_swap_b32 v17, v16
v_max3_f32 v16, v16, v17, s55
v_exp_f32 v14, -v16
v_sub_f32 v80, v80, v16
v_sub_f32 v81, v81, v16
v_sub_f32 v82, v82, v16
v_sub_f32 v83, v83, v16
v_sub_f32 v84, v84, v16
v_sub_f32 v85, v85, v16
v_sub_f32 v86, v86, v16
v_sub_f32 v87, v87, v16
v_sub_f32 v136, v136, v16
v_sub_f32 v137, v137, v16
v_sub_f32 v138, v138, v16
v_sub_f32 v139, v139, v16
v_max3_f32 v16, v88, v89, v90
v_max3_f32 v16, v16, v91, v92
v_max3_f32 v16, v16, v93, v94
v_max_f32 v16, v16, v95
v_mov_b32 v17, v16
s_nop 1
v_permlane32_swap_b32 v17, v16
v_max_f32 v16, v16, v17
v_mov_b32 v17, v16
s_nop 1
v_permlane16_swap_b32 v17, v16
v_max3_f32 v16, v16, v17, s55
v_exp_f32 v15, -v16
v_sub_f32 v88, v88, v16
v_sub_f32 v89, v89, v16
v_sub_f32 v90, v90, v16
v_sub_f32 v91, v91, v16
v_sub_f32 v92, v92, v16
v_sub_f32 v93, v93, v16
v_sub_f32 v94, v94, v16
v_sub_f32 v95, v95, v16
v_sub_f32 v140, v140, v16
v_sub_f32 v141, v141, v16
v_sub_f32 v142, v142, v16
v_sub_f32 v143, v143, v16
s_cmp_eq_u32 s55, 0
s_cselect_b32 s48, 1, 0
s_mov_b32 s55, 0
s_mov_b32 s54, s51
s_branch L_at_upr1
L_at_rs1:
s_mov_b32 s52, 1
s_branch L_at_rescale
L_at_up2:
v_max3_f32 v16, v32, v33, v34
v_max3_f32 v16, v16, v35, v36
v_max3_f32 v16, v16, v37, v38
v_max_f32 v16, v16, v39
v_mov_b32 v17, v16
s_nop 1
v_permlane32_swap_b32 v17, v16
v_max_f32 v16, v16, v17
v_mov_b32 v17, v16
s_nop 1
v_permlane16_swap_b32 v17, v16
v_max3_f32 v16, v16, v17, s55
v_exp_f32 v12, -v16
v_sub_f32 v32, v32, v16
v_sub_f32 v33, v33, v16
v_sub_f32 v34, v34, v16
v_sub_f32 v35, v35, v16
v_sub_f32 v36, v36, v16
v_sub_f32 v37, v37, v16
v_sub_f32 v38, v38, v16
v_sub_f32 v39, v39, v16
v_sub_f32 v128, v128, v16
v_sub_f32 v129, v129, v16
v_sub_f32 v130, v130, v16
v_sub_f32 v131, v131, v16
v_max3_f32 v16, v40, v41, v42
v_max3_f32 v16, v16, v43, v44
v_max3_f32 v16, v16, v45, v46
v_max_f32 v16, v16, v47
v_mov_b32 v17, v16
s_nop 1
v_permlane32_swap_b32 v17, v16
v_max_f32 v16, v16, v17
v_mov_b32 v17, v16
s_nop 1
v_permlane16_swap_b32 v17, v16
v_max3_f32 v16, v16, v17, s55
v_exp_f32 v13, -v16
v_sub_f32 v40, v40, v16
v_sub_f32 v41, v41, v16
v_sub_f32 v42, v42, v16
v_sub_f32 v43, v43, v16
v_sub_f32 v44, v44, v16
v_sub_f32 v45, v45, v16
v_sub_f32 v46, v46, v16
v_sub_f32 v47, v47, v16
v_sub_f32 v132, v132, v16
v_sub_f32 v133, v133, v16
v_sub_f32 v134, v134, v16
v_sub_f32 v135, v135, v16
v_max3_f32 v16, v48, v49, v50
v_max3_f32 v16, v16, v51, v52
v_max3_f32 v16, v16, v53, v54
v_max_f32 v16, v16, v55
v_mov_b32 v17, v16
s_nop 1
v_permlane32_swap_b32 v17, v16
v_max_f32 v16, v16, v17
v_mov_b32 v17, v16
s_nop 1
v_permlane16_swap_b32 v17, v16
v_max3_f32 v16, v16, v17, s55
v_exp_f32 v14, -v16
v_sub_f32 v48, v48, v16
v_sub_f32 v49, v49, v16
v_sub_f32 v50, v50, v16
v_sub_f32 v51, v51, v16
v_sub_f32 v52, v52, v16
v_sub_f32 v53, v53, v16
v_sub_f32 v54, v54, v16
v_sub_f32 v55, v55, v16
v_sub_f32 v136, v136, v16
v_sub_f32 v137, v137, v16
v_sub_f32 v138, v138, v16
v_sub_f32 v139, v139, v16
v_max3_f32 v16, v56, v57, v58
v_max3_f32 v16, v16, v59, v60
v_max3_f32 v16, v16, v61, v62
v_max_f32 v16, v16, v63
v_mov_b32 v17, v16
s_nop 1
v_permlane32_swap_b32 v17, v16
v_max_f32 v16, v16, v17
v_mov_b32 v17, v16
s_nop 1
v_permlane16_swap_b32 v17, v16
v_max3_f32 v16, v16, v17, s55
v_exp_f32 v15, -v16
v_sub_f32 v56, v56, v16
v_sub_f32 v57, v57, v16
v_sub_f32 v58, v58, v16
v_sub_f32 v59, v59, v16
v_sub_f32 v60, v60, v16
v_sub_f32 v61, v61, v16
v_sub_f32 v62, v62, v16
v_sub_f32 v63, v63, v16
v_sub_f32 v140, v140, v16
v_sub_f32 v141, v141, v16
v_sub_f32 v142, v142, v16
v_sub_f32 v143, v143, v16
s_cmp_eq_u32 s55, 0
s_cselect_b32 s48, 1, 0
s_mov_b32 s55, 0
s_mov_b32 s54, s51
s_branch L_at_upr2
L_at_rs2:
s_mov_b32 s52, 2
s_branch L_at_rescale
L_at_up3:
v_max3_f32 v16, v64, v65, v66
v_max3_f32 v16, v16, v67, v68
v_max3_f32 v16, v16, v69, v70
v_max_f32 v16, v16, v71
v_mov_b32 v17, v16
s_nop 1
v_permlane32_swap_b32 v17, v16
v_max_f32 v16, v16, v17
v_mov_b32 v17, v16
s_nop 1
v_permlane16_swap_b32 v17, v16
v_max3_f32 v16, v16, v17, s55
v_exp_f32 v12, -v16
v_sub_f32 v64, v64, v16
v_sub_f32 v65, v65, v16
v_sub_f32 v66, v66, v16
v_sub_f32 v67, v67, v16
v_sub_f32 v68, v68, v16
v_sub_f32 v69, v69, v16
v_sub_f32 v70, v70, v16
v_sub_f32 v71, v71, v16
v_sub_f32 v128, v128, v16
v_sub_f32 v129, v129, v16
v_sub_f32 v130, v130, v16
v_sub_f32 v131, v131, v16
v_max3_f32 v16, v72, v73, v74
v_max3_f32 v16, v16, v75, v76
v_max3_f32 v16, v16, v77, v78
v_max_f32 v16, v16, v79
v_mov_b32 v17, v16
s_nop 1
v_permlane32_swap_b32 v17, v16
v_max_f32 v16, v16, v17
v_mov_b32 v17, v16
s_nop 1
v_permlane16_swap_b32 v17, v16
v_max3_f32 v16, v16, v17, s55
v_exp_f32 v13, -v16
v_sub_f32 v72, v72, v16
v_sub_f32 v73, v73, v16
v_sub_f32 v74, v74, v16
v_sub_f32 v75, v75, v16
v_sub_f32 v76, v76, v16
v_sub_f32 v77, v77, v16
v_sub_f32 v78, v78, v16
v_sub_f32 v79, v79, v16
v_sub_f32 v132, v132, v16
v_sub_f32 v133, v133, v16
v_sub_f32 v134, v134, v16
v_sub_f32 v135, v135, v16
v_max3_f32 v16, v80, v81, v82
v_max3_f32 v16, v16, v83, v84
v_max3_f32 v16, v16, v85, v86
v_max_f32 v16, v16, v87
v_mov_b32 v17, v16
s_nop 1
v_permlane32_swap_b32 v17, v16
v_max_f32 v16, v16, v17
v_mov_b32 v17, v16
s_nop 1
v_permlane16_swap_b32 v17, v16
v_max3_f32 v16, v16, v17, s55
v_exp_f32 v14, -v16
v_sub_f32 v80, v80, v16
v_sub_f32 v81, v81, v16
v_sub_f32 v82, v82, v16
v_sub_f32 v83, v83, v16
v_sub_f32 v84, v84, v16
v_sub_f32 v85, v85, v16
v_sub_f32 v86, v86, v16
v_sub_f32 v87, v87, v16
v_sub_f32 v136, v136, v16
v_sub_f32 v137, v137, v16
v_sub_f32 v138, v138, v16
v_sub_f32 v139, v139, v16
v_max3_f32 v16, v88, v89, v90
v_max3_f32 v16, v16, v91, v92
v_max3_f32 v16, v16, v93, v94
v_max_f32 v16, v16, v95
v_mov_b32 v17, v16
s_nop 1
v_permlane32_swap_b32 v17, v16
v_max_f32 v16, v16, v17
v_mov_b32 v17, v16
s_nop 1
v_permlane16_swap_b32 v17, v16
v_max3_f32 v16, v16, v17, s55
v_exp_f32 v15, -v16
v_sub_f32 v88, v88, v16
v_sub_f32 v89, v89, v16
v_sub_f32 v90, v90, v16
v_sub_f32 v91, v91, v16
v_sub_f32 v92, v92, v16
v_sub_f32 v93, v93, v16
v_sub_f32 v94, v94, v16
v_sub_f32 v95, v95, v16
v_sub_f32 v140, v140, v16
v_sub_f32 v141, v141, v16
v_sub_f32 v142, v142, v16
v_sub_f32 v143, v143, v16
s_cmp_eq_u32 s55, 0
s_cselect_b32 s48, 1, 0
s_mov_b32 s55, 0
s_mov_b32 s54, s51
s_branch L_at_upr3
L_at_rs3:
s_mov_b32 s52, 3
s_branch L_at_rescale
L_at_up4:
v_mov_b32 v12, 1.0
v_max3_f32 v16, v40, v41, v42
v_max3_f32 v16, v16, v43, v44
v_max3_f32 v16, v16, v45, v46
v_max_f32 v16, v16, v47
v_mov_b32 v17, v16
s_nop 1
v_permlane32_swap_b32 v17, v16
v_max_f32 v16, v16, v17
v_mov_b32 v17, v16
s_nop 1
v_permlane16_swap_b32 v17, v16
v_max3_f32 v16, v16, v17, s55
v_exp_f32 v13, -v16
v_sub_f32 v40, v40, v16
v_sub_f32 v41, v41, v16
v_sub_f32 v42, v42, v16
v_sub_f32 v43, v43, v16
v_sub_f32 v44, v44, v16
v_sub_f32 v45, v45, v16
v_sub_f32 v46, v46, v16
v_sub_f32 v47, v47, v16
v_sub_f32 v132, v132, v16
v_sub_f32 v133, v133, v16
v_sub_f32 v134, v134, v16
v_sub_f32 v135, v135, v16
v_max3_f32 v16, v48, v49, v50
v_max3_f32 v16, v16, v51, v52
v_max3_f32 v16, v16, v53, v54
v_max_f32 v16, v16, v55
v_mov_b32 v17, v16
s_nop 1
v_permlane32_swap_b32 v17, v16
v_max_f32 v16, v16, v17
v_mov_b32 v17, v16
s_nop 1
v_permlane16_swap_b32 v17, v16
v_max3_f32 v16, v16, v17, s55
v_exp_f32 v14, -v16
v_sub_f32 v48, v48, v16
v_sub_f32 v49, v49, v16
v_sub_f32 v50, v50, v16
v_sub_f32 v51, v51, v16
v_sub_f32 v52, v52, v16
v_sub_f32 v53, v53, v16
v_sub_f32 v54, v54, v16
v_sub_f32 v55, v55, v16
v_sub_f32 v136, v136, v16
v_sub_f32 v137, v137, v16
v_sub_f32 v138, v138, v16
v_sub_f32 v139, v139, v16
v_max3_f32 v16, v56, v57, v58
v_max3_f32 v16, v16, v59, v60
v_max3_f32 v16, v16, v61, v62
v_max_f32 v16, v16, v63
v_mov_b32 v17, v16
s_nop 1
v_permlane32_swap_b32 v17, v16
v_max_f32 v16, v16, v17
v_mov_b32 v17, v16
s_nop 1
v_permlane16_swap_b32 v17, v16
v_max3_f32 v16, v16, v17, s55
v_exp_f32 v15, -v16
v_sub_f32 v56, v56, v16
v_sub_f32 v57, v57, v16
v_sub_f32 v58, v58, v16
v_sub_f32 v59, v59, v16
v_sub_f32 v60, v60, v16
v_sub_f32 v61, v61, v16
v_sub_f32 v62, v62, v16
v_sub_f32 v63, v63, v16
v_sub_f32 v140, v140, v16
v_sub_f32 v141, v141, v16
v_sub_f32 v142, v142, v16
v_sub_f32 v143, v143, v16
s_cmp_eq_u32 s55, 0
s_cselect_b32 s48, 1, 0
s_mov_b32 s55, 0
s_mov_b32 s54, s51
s_branch L_at_upr4
L_at_rs4:
s_mov_b32 s52, 4
s_branch L_at_rescale
L_at_up5:
v_mov_b32 v12, 1.0
v_max3_f32 v16, v72, v73, v74
v_max3_f32 v16, v16, v75, v76
v_max3_f32 v16, v16, v77, v78
v_max_f32 v16, v16, v79
v_mov_b32 v17, v16
s_nop 1
v_permlane32_swap_b32 v17, v16
v_max_f32 v16, v16, v17
v_mov_b32 v17, v16
s_nop 1
v_permlane16_swap_b32 v17, v16
v_max3_f32 v16, v16, v17, s55
v_exp_f32 v13, -v16
v_sub_f32 v72, v72, v16
v_sub_f32 v73, v73, v16
v_sub_f32 v74, v74, v16
v_sub_f32 v75, v75, v16
v_sub_f32 v76, v76, v16
v_sub_f32 v77, v77, v16
v_sub_f32 v78, v78, v16
v_sub_f32 v79, v79, v16
v_sub_f32 v132, v132, v16
v_sub_f32 v133, v133, v16
v_sub_f32 v134, v134, v16
v_sub_f32 v135, v135, v16
v_max3_f32 v16, v80, v81, v82
v_max3_f32 v16, v16, v83, v84
v_max3_f32 v16, v16, v85, v86
v_max_f32 v16, v16, v87
v_mov_b32 v17, v16
s_nop 1
v_permlane32_swap_b32 v17, v16
v_max_f32 v16, v16, v17
v_mov_b32 v17, v16
s_nop 1
v_permlane16_swap_b32 v17, v16
v_max3_f32 v16, v16, v17, s55
v_exp_f32 v14, -v16
v_sub_f32 v80, v80, v16
v_sub_f32 v81, v81, v16
v_sub_f32 v82, v82, v16
v_sub_f32 v83, v83, v16
v_sub_f32 v84, v84, v16
v_sub_f32 v85, v85, v16
v_sub_f32 v86, v86, v16
v_sub_f32 v87, v87, v16
v_sub_f32 v136, v136, v16
v_sub_f32 v137, v137, v16
v_sub_f32 v138, v138, v16
v_sub_f32 v139, v139, v16
v_max3_f32 v16, v88, v89, v90
v_max3_f32 v16, v16, v91, v92
v_max3_f32 v16, v16, v93, v94
v_max_f32 v16, v16, v95
v_mov_b32 v17, v16
s_nop 1
v_permlane32_swap_b32 v17, v16
v_max_f32 v16, v16, v17
v_mov_b32 v17, v16
s_nop 1
v_permlane16_swap_b32 v17, v16
v_max3_f32 v16, v16, v17, s55
v_exp_f32 v15, -v16
v_sub_f32 v88, v88, v16
v_sub_f32 v89, v89, v16
v_sub_f32 v90, v90, v16
v_sub_f32 v91, v91, v16
v_sub_f32 v92, v92, v16
v_sub_f32 v93, v93, v16
v_sub_f32 v94, v94, v16
v_sub_f32 v95, v95, v16
v_sub_f32 v140, v140, v16
v_sub_f32 v141, v141, v16
v_sub_f32 v142, v142, v16
v_sub_f32 v143, v143, v16
s_cmp_eq_u32 s55, 0
s_cselect_b32 s48, 1, 0
s_mov_b32 s55, 0
s_mov_b32 s54, s51
s_branch L_at_upr5
L_at_rs5:
s_mov_b32 s52, 5
s_branch L_at_rescale
L_at_up6:
v_mov_b32 v12, 1.0
v_mov_b32 v13, 1.0
v_max3_f32 v16, v48, v49, v50
v_max3_f32 v16, v16, v51, v52
v_max3_f32 v16, v16, v53, v54
v_max_f32 v16, v16, v55
v_mov_b32 v17, v16
s_nop 1
v_permlane32_swap_b32 v17, v16
v_max_f32 v16, v16, v17
v_mov_b32 v17, v16
s_nop 1
v_permlane16_swap_b32 v17, v16
v_max3_f32 v16, v16, v17, s55
v_exp_f32 v14, -v16
v_sub_f32 v48, v48, v16
v_sub_f32 v49, v49, v16
v_sub_f32 v50, v50, v16
v_sub_f32 v51, v51, v16
v_sub_f32 v52, v52, v16
v_sub_f32 v53, v53, v16
v_sub_f32 v54, v54, v16
v_sub_f32 v55, v55, v16
v_sub_f32 v136, v136, v16
v_sub_f32 v137, v137, v16
v_sub_f32 v138, v138, v16
v_sub_f32 v139, v139, v16
v_max3_f32 v16, v56, v57, v58
v_max3_f32 v16, v16, v59, v60
v_max3_f32 v16, v16, v61, v62
v_max_f32 v16, v16, v63
v_mov_b32 v17, v16
s_nop 1
v_permlane32_swap_b32 v17, v16
v_max_f32 v16, v16, v17
v_mov_b32 v17, v16
s_nop 1
v_permlane16_swap_b32 v17, v16
v_max3_f32 v16, v16, v17, s55
v_exp_f32 v15, -v16
v_sub_f32 v56, v56, v16
v_sub_f32 v57, v57, v16
v_sub_f32 v58, v58, v16
v_sub_f32 v59, v59, v16
v_sub_f32 v60, v60, v16
v_sub_f32 v61, v61, v16
v_sub_f32 v62, v62, v16
v_sub_f32 v63, v63, v16
v_sub_f32 v140, v140, v16
v_sub_f32 v141, v141, v16
v_sub_f32 v142, v142, v16
v_sub_f32 v143, v143, v16
s_cmp_eq_u32 s55, 0
s_cselect_b32 s48, 1, 0
s_mov_b32 s55, 0
s_mov_b32 s54, s51
s_branch L_at_upr6
L_at_rs6:
s_mov_b32 s52, 6
s_branch L_at_rescale
L_at_up7:
v_mov_b32 v12, 1.0
v_mov_b32 v13, 1.0
v_max3_f32 v16, v80, v81, v82
v_max3_f32 v16, v16, v83, v84
v_max3_f32 v16, v16, v85, v86
v_max_f32 v16, v16, v87
v_mov_b32 v17, v16
s_nop 1
v_permlane32_swap_b32 v17, v16
v_max_f32 v16, v16, v17
v_mov_b32 v17, v16
s_nop 1
v_permlane16_swap_b32 v17, v16
v_max3_f32 v16, v16, v17, s55
v_exp_f32 v14, -v16
v_sub_f32 v80, v80, v16
v_sub_f32 v81, v81, v16
v_sub_f32 v82, v82, v16
v_sub_f32 v83, v83, v16
v_sub_f32 v84, v84, v16
v_sub_f32 v85, v85, v16
v_sub_f32 v86, v86, v16
v_sub_f32 v87, v87, v16
v_sub_f32 v136, v136, v16
v_sub_f32 v137, v137, v16
v_sub_f32 v138, v138, v16
v_sub_f32 v139, v139, v16
v_max3_f32 v16, v88, v89, v90
v_max3_f32 v16, v16, v91, v92
v_max3_f32 v16, v16, v93, v94
v_max_f32 v16, v16, v95
v_mov_b32 v17, v16
s_nop 1
v_permlane32_swap_b32 v17, v16
v_max_f32 v16, v16, v17
v_mov_b32 v17, v16
s_nop 1
v_permlane16_swap_b32 v17, v16
v_max3_f32 v16, v16, v17, s55
v_exp_f32 v15, -v16
v_sub_f32 v88, v88, v16
v_sub_f32 v89, v89, v16
v_sub_f32 v90, v90, v16
v_sub_f32 v91, v91, v16
v_sub_f32 v92, v92, v16
v_sub_f32 v93, v93, v16
v_sub_f32 v94, v94, v16
v_sub_f32 v95, v95, v16
v_sub_f32 v140, v140, v16
v_sub_f32 v141, v141, v16
v_sub_f32 v142, v142, v16
v_sub_f32 v143, v143, v16
s_cmp_eq_u32 s55, 0
s_cselect_b32 s48, 1, 0
s_mov_b32 s55, 0
s_mov_b32 s54, s51
s_branch L_at_upr7
L_at_rs7:
s_mov_b32 s52, 7
s_branch L_at_rescale
L_at_up8:
v_mov_b32 v12, 1.0
v_mov_b32 v13, 1.0
v_mov_b32 v14, 1.0
v_max3_f32 v16, v56, v57, v58
v_max3_f32 v16, v16, v59, v60
v_max3_f32 v16, v16, v61, v62
v_max_f32 v16, v16, v63
v_mov_b32 v17, v16
s_nop 1
v_permlane32_swap_b32 v17, v16
v_max_f32 v16, v16, v17
v_mov_b32 v17, v16
s_nop 1
v_permlane16_swap_b32 v17, v16
v_max3_f32 v16, v16, v17, s55
v_exp_f32 v15, -v16
v_sub_f32 v56, v56, v16
v_sub_f32 v57, v57, v16
v_sub_f32 v58, v58, v16
v_sub_f32 v59, v59, v16
v_sub_f32 v60, v60, v16
v_sub_f32 v61, v61, v16
v_sub_f32 v62, v62, v16
v_sub_f32 v63, v63, v16
v_sub_f32 v140, v140, v16
v_sub_f32 v141, v141, v16
v_sub_f32 v142, v142, v16
v_sub_f32 v143, v143, v16
s_cmp_eq_u32 s55, 0
s_cselect_b32 s48, 1, 0
s_mov_b32 s55, 0
s_mov_b32 s54, s51
s_branch L_at_upr8
L_at_rs8:
s_mov_b32 s52, 8
s_branch L_at_rescale
L_at_up9:
v_mov_b32 v12, 1.0
v_mov_b32 v13, 1.0
v_mov_b32 v14, 1.0
v_max3_f32 v16, v88, v89, v90
v_max3_f32 v16, v16, v91, v92
v_max3_f32 v16, v16, v93, v94
v_max_f32 v16, v16, v95
v_mov_b32 v17, v16
s_nop 1
v_permlane32_swap_b32 v17, v16
v_max_f32 v16, v16, v17
v_mov_b32 v17, v16
s_nop 1
v_permlane16_swap_b32 v17, v16
v_max3_f32 v16, v16, v17, s55
v_exp_f32 v15, -v16
v_sub_f32 v88, v88, v16
v_sub_f32 v89, v89, v16
v_sub_f32 v90, v90, v16
v_sub_f32 v91, v91, v16
v_sub_f32 v92, v92, v16
v_sub_f32 v93, v93, v16
v_sub_f32 v94, v94, v16
v_sub_f32 v95, v95, v16
v_sub_f32 v140, v140, v16
v_sub_f32 v141, v141, v16
v_sub_f32 v142, v142, v16
v_sub_f32 v143, v143, v16
s_cmp_eq_u32 s55, 0
s_cselect_b32 s48, 1, 0
s_mov_b32 s55, 0
s_mov_b32 s54, s51
s_branch L_at_upr9
L_at_rs9:
s_mov_b32 s52, 9
s_branch L_at_rescale
L_at_rescale:
v_accvgpr_read_b32 v24, a96
v_accvgpr_read_b32 v25, a97
v_accvgpr_read_b32 v26, a98
v_accvgpr_read_b32 v27, a99
v_accvgpr_read_b32 v28, a100
v_accvgpr_read_b32 v29, a101
v_accvgpr_read_b32 v30, a102
v_accvgpr_read_b32 v31, a103
v_mul_f32 v24, v24, v12
v_mul_f32 v25, v25, v12
v_mul_f32 v26, v26, v12
v_mul_f32 v27, v27, v12
v_mul_f32 v28, v28, v13
v_mul_f32 v29, v29, v13
v_mul_f32 v30, v30, v13
v_mul_f32 v31, v31, v13
v_accvgpr_write_b32 a96, v24
v_accvgpr_write_b32 a97, v25
v_accvgpr_write_b32 a98, v26
v_accvgpr_write_b32 a99, v27
v_accvgpr_write_b32 a100, v28
v_accvgpr_write_b32 a101, v29
v_accvgpr_write_b32 a102, v30
v_accvgpr_write_b32 a103, v31
v_accvgpr_read_b32 v24, a104
v_accvgpr_read_b32 v25, a105
v_accvgpr_read_b32 v26, a106
v_accvgpr_read_b32 v27, a107
v_accvgpr_read_b32 v28, a108
v_accvgpr_read_b32 v29, a109
v_accvgpr_read_b32 v30, a110
v_accvgpr_read_b32 v31, a111
v_mul_f32 v24, v24, v14
v_mul_f32 v25, v25, v14
v_mul_f32 v26, v26, v14
v_mul_f32 v27, v27, v14
v_mul_f32 v28, v28, v15
v_mul_f32 v29, v29, v15
v_mul_f32 v30, v30, v15
v_mul_f32 v31, v31, v15
v_accvgpr_write_b32 a104, v24
v_accvgpr_write_b32 a105, v25
v_accvgpr_write_b32 a106, v26
v_accvgpr_write_b32 a107, v27
v_accvgpr_write_b32 a108, v28
v_accvgpr_write_b32 a109, v29
v_accvgpr_write_b32 a110, v30
v_accvgpr_write_b32 a111, v31
v_accvgpr_read_b32 v24, a112
v_accvgpr_read_b32 v25, a113
v_accvgpr_read_b32 v26, a114
v_accvgpr_read_b32 v27, a115
v_accvgpr_read_b32 v28, a116
v_accvgpr_read_b32 v29, a117
v_accvgpr_read_b32 v30, a118
v_accvgpr_read_b32 v31, a119
v_mul_f32 v24, v24, v12
v_mul_f32 v25, v25, v12
v_mul_f32 v26, v26, v12
v_mul_f32 v27, v27, v12
v_mul_f32 v28, v28, v13
v_mul_f32 v29, v29, v13
v_mul_f32 v30, v30, v13
v_mul_f32 v31, v31, v13
v_accvgpr_write_b32 a112, v24
v_accvgpr_write_b32 a113, v25
v_accvgpr_write_b32 a114, v26
v_accvgpr_write_b32 a115, v27
v_accvgpr_write_b32 a116, v28
v_accvgpr_write_b32 a117, v29
v_accvgpr_write_b32 a118, v30
v_accvgpr_write_b32 a119, v31
v_accvgpr_read_b32 v24, a120
v_accvgpr_read_b32 v25, a121
v_accvgpr_read_b32 v26, a122
v_accvgpr_read_b32 v27, a123
v_accvgpr_read_b32 v28, a124
v_accvgpr_read_b32 v29, a125
v_accvgpr_read_b32 v30, a126
v_accvgpr_read_b32 v31, a127
v_mul_f32 v24, v24, v14
v_mul_f32 v25, v25, v14
v_mul_f32 v26, v26, v14
v_mul_f32 v27, v27, v14
v_mul_f32 v28, v28, v15
v_mul_f32 v29, v29, v15
v_mul_f32 v30, v30, v15
v_mul_f32 v31, v31, v15
v_accvgpr_write_b32 a120, v24
v_accvgpr_write_b32 a121, v25
v_accvgpr_write_b32 a122, v26
v_accvgpr_write_b32 a123, v27
v_accvgpr_write_b32 a124, v28
v_accvgpr_write_b32 a125, v29
v_accvgpr_write_b32 a126, v30
v_accvgpr_write_b32 a127, v31
v_accvgpr_read_b32 v24, a128
v_accvgpr_read_b32 v25, a129
v_accvgpr_read_b32 v26, a130
v_accvgpr_read_b32 v27, a131
v_accvgpr_read_b32 v28, a132
v_accvgpr_read_b32 v29, a133
v_accvgpr_read_b32 v30, a134
v_accvgpr_read_b32 v31, a135
v_mul_f32 v24, v24, v12
v_mul_f32 v25, v25, v12
v_mul_f32 v26, v26, v12
v_mul_f32 v27, v27, v12
v_mul_f32 v28, v28, v13
v_mul_f32 v29, v29, v13
v_mul_f32 v30, v30, v13
v_mul_f32 v31, v31, v13
v_accvgpr_write_b32 a128, v24
v_accvgpr_write_b32 a129, v25
v_accvgpr_write_b32 a130, v26
v_accvgpr_write_b32 a131, v27
v_accvgpr_write_b32 a132, v28
v_accvgpr_write_b32 a133, v29
v_accvgpr_write_b32 a134, v30
v_accvgpr_write_b32 a135, v31
v_accvgpr_read_b32 v24, a136
v_accvgpr_read_b32 v25, a137
v_accvgpr_read_b32 v26, a138
v_accvgpr_read_b32 v27, a139
v_accvgpr_read_b32 v28, a140
v_accvgpr_read_b32 v29, a141
v_accvgpr_read_b32 v30, a142
v_accvgpr_read_b32 v31, a143
v_mul_f32 v24, v24, v14
v_mul_f32 v25, v25, v14
v_mul_f32 v26, v26, v14
v_mul_f32 v27, v27, v14
v_mul_f32 v28, v28, v15
v_mul_f32 v29, v29, v15
v_mul_f32 v30, v30, v15
v_mul_f32 v31, v31, v15
v_accvgpr_write_b32 a136, v24
v_accvgpr_write_b32 a137, v25
v_accvgpr_write_b32 a138, v26
v_accvgpr_write_b32 a139, v27
v_accvgpr_write_b32 a140, v28
v_accvgpr_write_b32 a141, v29
v_accvgpr_write_b32 a142, v30
v_accvgpr_write_b32 a143, v31
v_accvgpr_read_b32 v24, a144
v_accvgpr_read_b32 v25, a145
v_accvgpr_read_b32 v26, a146
v_accvgpr_read_b32 v27, a147
v_accvgpr_read_b32 v28, a148
v_accvgpr_read_b32 v29, a149
v_accvgpr_read_b32 v30, a150
v_accvgpr_read_b32 v31, a151
v_mul_f32 v24, v24, v12
v_mul_f32 v25, v25, v12
v_mul_f32 v26, v26, v12
v_mul_f32 v27, v27, v12
v_mul_f32 v28, v28, v13
v_mul_f32 v29, v29, v13
v_mul_f32 v30, v30, v13
v_mul_f32 v31, v31, v13
v_accvgpr_write_b32 a144, v24
v_accvgpr_write_b32 a145, v25
v_accvgpr_write_b32 a146, v26
v_accvgpr_write_b32 a147, v27
v_accvgpr_write_b32 a148, v28
v_accvgpr_write_b32 a149, v29
v_accvgpr_write_b32 a150, v30
v_accvgpr_write_b32 a151, v31
v_accvgpr_read_b32 v24, a152
v_accvgpr_read_b32 v25, a153
v_accvgpr_read_b32 v26, a154
v_accvgpr_read_b32 v27, a155
v_accvgpr_read_b32 v28, a156
v_accvgpr_read_b32 v29, a157
v_accvgpr_read_b32 v30, a158
v_accvgpr_read_b32 v31, a159
v_mul_f32 v24, v24, v14
v_mul_f32 v25, v25, v14
v_mul_f32 v26, v26, v14
v_mul_f32 v27, v27, v14
v_mul_f32 v28, v28, v15
v_mul_f32 v29, v29, v15
v_mul_f32 v30, v30, v15
v_mul_f32 v31, v31, v15
v_accvgpr_write_b32 a152, v24
v_accvgpr_write_b32 a153, v25
v_accvgpr_write_b32 a154, v26
v_accvgpr_write_b32 a155, v27
v_accvgpr_write_b32 a156, v28
v_accvgpr_write_b32 a157, v29
v_accvgpr_write_b32 a158, v30
v_accvgpr_write_b32 a159, v31
v_accvgpr_read_b32 v24, a160
v_accvgpr_read_b32 v25, a161
v_accvgpr_read_b32 v26, a162
v_accvgpr_read_b32 v27, a163
v_accvgpr_read_b32 v28, a164
v_accvgpr_read_b32 v29, a165
v_accvgpr_read_b32 v30, a166
v_accvgpr_read_b32 v31, a167
v_mul_f32 v24, v24, v12
v_mul_f32 v25, v25, v12
v_mul_f32 v26, v26, v12
v_mul_f32 v27, v27, v12
v_mul_f32 v28, v28, v13
v_mul_f32 v29, v29, v13
v_mul_f32 v30, v30, v13
v_mul_f32 v31, v31, v13
v_accvgpr_write_b32 a160, v24
v_accvgpr_write_b32 a161, v25
v_accvgpr_write_b32 a162, v26
v_accvgpr_write_b32 a163, v27
v_accvgpr_write_b32 a164, v28
v_accvgpr_write_b32 a165, v29
v_accvgpr_write_b32 a166, v30
v_accvgpr_write_b32 a167, v31
v_accvgpr_read_b32 v24, a168
v_accvgpr_read_b32 v25, a169
v_accvgpr_read_b32 v26, a170
v_accvgpr_read_b32 v27, a171
v_accvgpr_read_b32 v28, a172
v_accvgpr_read_b32 v29, a173
v_accvgpr_read_b32 v30, a174
v_accvgpr_read_b32 v31, a175
v_mul_f32 v24, v24, v14
v_mul_f32 v25, v25, v14
v_mul_f32 v26, v26, v14
v_mul_f32 v27, v27, v14
v_mul_f32 v28, v28, v15
v_mul_f32 v29, v29, v15
v_mul_f32 v30, v30, v15
v_mul_f32 v31, v31, v15
v_accvgpr_write_b32 a168, v24
v_accvgpr_write_b32 a169, v25
v_accvgpr_write_b32 a170, v26
v_accvgpr_write_b32 a171, v27
v_accvgpr_write_b32 a172, v28
v_accvgpr_write_b32 a173, v29
v_accvgpr_write_b32 a174, v30
v_accvgpr_write_b32 a175, v31
v_accvgpr_read_b32 v24, a176
v_accvgpr_read_b32 v25, a177
v_accvgpr_read_b32 v26, a178
v_accvgpr_read_b32 v27, a179
v_accvgpr_read_b32 v28, a180
v_accvgpr_read_b32 v29, a181
v_accvgpr_read_b32 v30, a182
v_accvgpr_read_b32 v31, a183
v_mul_f32 v24, v24, v12
v_mul_f32 v25, v25, v12
v_mul_f32 v26, v26, v12
v_mul_f32 v27, v27, v12
v_mul_f32 v28, v28, v13
v_mul_f32 v29, v29, v13
v_mul_f32 v30, v30, v13
v_mul_f32 v31, v31, v13
v_accvgpr_write_b32 a176, v24
v_accvgpr_write_b32 a177, v25
v_accvgpr_write_b32 a178, v26
v_accvgpr_write_b32 a179, v27
v_accvgpr_write_b32 a180, v28
v_accvgpr_write_b32 a181, v29
v_accvgpr_write_b32 a182, v30
v_accvgpr_write_b32 a183, v31
v_accvgpr_read_b32 v24, a184
v_accvgpr_read_b32 v25, a185
v_accvgpr_read_b32 v26, a186
v_accvgpr_read_b32 v27, a187
v_accvgpr_read_b32 v28, a188
v_accvgpr_read_b32 v29, a189
v_accvgpr_read_b32 v30, a190
v_accvgpr_read_b32 v31, a191
v_mul_f32 v24, v24, v14
v_mul_f32 v25, v25, v14
v_mul_f32 v26, v26, v14
v_mul_f32 v27, v27, v14
v_mul_f32 v28, v28, v15
v_mul_f32 v29, v29, v15
v_mul_f32 v30, v30, v15
v_mul_f32 v31, v31, v15
v_accvgpr_write_b32 a184, v24
v_accvgpr_write_b32 a185, v25
v_accvgpr_write_b32 a186, v26
v_accvgpr_write_b32 a187, v27
v_accvgpr_write_b32 a188, v28
v_accvgpr_write_b32 a189, v29
v_accvgpr_write_b32 a190, v30
v_accvgpr_write_b32 a191, v31
v_accvgpr_read_b32 v24, a192
v_accvgpr_read_b32 v25, a193
v_accvgpr_read_b32 v26, a194
v_accvgpr_read_b32 v27, a195
v_accvgpr_read_b32 v28, a196
v_accvgpr_read_b32 v29, a197
v_accvgpr_read_b32 v30, a198
v_accvgpr_read_b32 v31, a199
v_mul_f32 v24, v24, v12
v_mul_f32 v25, v25, v12
v_mul_f32 v26, v26, v12
v_mul_f32 v27, v27, v12
v_mul_f32 v28, v28, v13
v_mul_f32 v29, v29, v13
v_mul_f32 v30, v30, v13
v_mul_f32 v31, v31, v13
v_accvgpr_write_b32 a192, v24
v_accvgpr_write_b32 a193, v25
v_accvgpr_write_b32 a194, v26
v_accvgpr_write_b32 a195, v27
v_accvgpr_write_b32 a196, v28
v_accvgpr_write_b32 a197, v29
v_accvgpr_write_b32 a198, v30
v_accvgpr_write_b32 a199, v31
v_accvgpr_read_b32 v24, a200
v_accvgpr_read_b32 v25, a201
v_accvgpr_read_b32 v26, a202
v_accvgpr_read_b32 v27, a203
v_accvgpr_read_b32 v28, a204
v_accvgpr_read_b32 v29, a205
v_accvgpr_read_b32 v30, a206
v_accvgpr_read_b32 v31, a207
v_mul_f32 v24, v24, v14
v_mul_f32 v25, v25, v14
v_mul_f32 v26, v26, v14
v_mul_f32 v27, v27, v14
v_mul_f32 v28, v28, v15
v_mul_f32 v29, v29, v15
v_mul_f32 v30, v30, v15
v_mul_f32 v31, v31, v15
v_accvgpr_write_b32 a200, v24
v_accvgpr_write_b32 a201, v25
v_accvgpr_write_b32 a202, v26
v_accvgpr_write_b32 a203, v27
v_accvgpr_write_b32 a204, v28
v_accvgpr_write_b32 a205, v29
v_accvgpr_write_b32 a206, v30
v_accvgpr_write_b32 a207, v31
v_accvgpr_read_b32 v24, a208
v_accvgpr_read_b32 v25, a209
v_accvgpr_read_b32 v26, a210
v_accvgpr_read_b32 v27, a211
v_accvgpr_read_b32 v28, a212
v_accvgpr_read_b32 v29, a213
v_accvgpr_read_b32 v30, a214
v_accvgpr_read_b32 v31, a215
v_mul_f32 v24, v24, v12
v_mul_f32 v25, v25, v12
v_mul_f32 v26, v26, v12
v_mul_f32 v27, v27, v12
v_mul_f32 v28, v28, v13
v_mul_f32 v29, v29, v13
v_mul_f32 v30, v30, v13
v_mul_f32 v31, v31, v13
v_accvgpr_write_b32 a208, v24
v_accvgpr_write_b32 a209, v25
v_accvgpr_write_b32 a210, v26
v_accvgpr_write_b32 a211, v27
v_accvgpr_write_b32 a212, v28
v_accvgpr_write_b32 a213, v29
v_accvgpr_write_b32 a214, v30
v_accvgpr_write_b32 a215, v31
v_accvgpr_read_b32 v24, a216
v_accvgpr_read_b32 v25, a217
v_accvgpr_read_b32 v26, a218
v_accvgpr_read_b32 v27, a219
v_accvgpr_read_b32 v28, a220
v_accvgpr_read_b32 v29, a221
v_accvgpr_read_b32 v30, a222
v_accvgpr_read_b32 v31, a223
v_mul_f32 v24, v24, v14
v_mul_f32 v25, v25, v14
v_mul_f32 v26, v26, v14
v_mul_f32 v27, v27, v14
v_mul_f32 v28, v28, v15
v_mul_f32 v29, v29, v15
v_mul_f32 v30, v30, v15
v_mul_f32 v31, v31, v15
v_accvgpr_write_b32 a216, v24
v_accvgpr_write_b32 a217, v25
v_accvgpr_write_b32 a218, v26
v_accvgpr_write_b32 a219, v27
v_accvgpr_write_b32 a220, v28
v_accvgpr_write_b32 a221, v29
v_accvgpr_write_b32 a222, v30
v_accvgpr_write_b32 a223, v31
v_accvgpr_read_b32 v24, a224
v_accvgpr_read_b32 v25, a225
v_accvgpr_read_b32 v26, a226
v_accvgpr_read_b32 v27, a227
v_accvgpr_read_b32 v28, a228
v_accvgpr_read_b32 v29, a229
v_accvgpr_read_b32 v30, a230
v_accvgpr_read_b32 v31, a231
v_mul_f32 v24, v24, v12
v_mul_f32 v25, v25, v12
v_mul_f32 v26, v26, v12
v_mul_f32 v27, v27, v12
v_mul_f32 v28, v28, v13
v_mul_f32 v29, v29, v13
v_mul_f32 v30, v30, v13
v_mul_f32 v31, v31, v13
v_accvgpr_write_b32 a224, v24
v_accvgpr_write_b32 a225, v25
v_accvgpr_write_b32 a226, v26
v_accvgpr_write_b32 a227, v27
v_accvgpr_write_b32 a228, v28
v_accvgpr_write_b32 a229, v29
v_accvgpr_write_b32 a230, v30
v_accvgpr_write_b32 a231, v31
v_accvgpr_read_b32 v24, a232
v_accvgpr_read_b32 v25, a233
v_accvgpr_read_b32 v26, a234
v_accvgpr_read_b32 v27, a235
v_accvgpr_read_b32 v28, a236
v_accvgpr_read_b32 v29, a237
v_accvgpr_read_b32 v30, a238
v_accvgpr_read_b32 v31, a239
v_mul_f32 v24, v24, v14
v_mul_f32 v25, v25, v14
v_mul_f32 v26, v26, v14
v_mul_f32 v27, v27, v14
v_mul_f32 v28, v28, v15
v_mul_f32 v29, v29, v15
v_mul_f32 v30, v30, v15
v_mul_f32 v31, v31, v15
v_accvgpr_write_b32 a232, v24
v_accvgpr_write_b32 a233, v25
v_accvgpr_write_b32 a234, v26
v_accvgpr_write_b32 a235, v27
v_accvgpr_write_b32 a236, v28
v_accvgpr_write_b32 a237, v29
v_accvgpr_write_b32 a238, v30
v_accvgpr_write_b32 a239, v31
s_mov_b32 s48, 0
s_cmp_eq_u32 s52, 0
s_cbranch_scc1 L_at_rsr0
s_cmp_eq_u32 s52, 1
s_cbranch_scc1 L_at_rsr1
s_cmp_eq_u32 s52, 2
s_cbranch_scc1 L_at_rsr2
s_cmp_eq_u32 s52, 3
s_cbranch_scc1 L_at_rsr3
s_cmp_eq_u32 s52, 4
s_cbranch_scc1 L_at_rsr4
s_cmp_eq_u32 s52, 5
s_cbranch_scc1 L_at_rsr5
s_cmp_eq_u32 s52, 6
s_cbranch_scc1 L_at_rsr6
s_cmp_eq_u32 s52, 7
s_cbranch_scc1 L_at_rsr7
s_cmp_eq_u32 s52, 8
s_cbranch_scc1 L_at_rsr8
s_branch L_at_rsr9
L_at_done:
s_load_dwordx2 s[4:5], s[0:1], 40
s_waitcnt lgkmcnt(0)
s_mov_b32 s20, s4
s_and_b32 s21, s5, 0xffff
s_mov_b32 s22, 4718592
s_mov_b32 s23, 0x20000
s_sub_u32 s25, s3, 4
s_mul_i32 s24, s25, 27
s_add_u32 s24, s24, s16
s_mul_i32 s26, s25, 5
s_add_u32 s26, s26, s16
s_add_u32 s26, s26, 81
s_cmp_ge_u32 s16, 27
s_cselect_b32 s24, s26, s24
s_cmp_ge_u32 s24, 126
s_cbranch_scc1 L_done
s_mul_i32 s25, s24, 57
s_lshr_b32 s25, s25, 9
s_mul_i32 s26, s25, 9
s_sub_u32 s40, s24, s26
s_and_b32 s27, s25, 1
s_mov_b32 s26, s40
s_mov_b32 s4, 0x0
s_mov_b32 s5, 0x0
s_cmp_ge_u32 s25, 14
s_cbranch_scc1 L_bo2
s_and_b32 s51, s25, 1
s_add_u32 s51, s51, 126
s_lshr_b32 s25, s25, 1
s_cmp_eq_u32 s25, 0
s_cselect_b32 s42, 0x20408102, s42
s_cselect_b32 s43, 0x2040810, s43
s_cmp_eq_u32 s25, 1
s_cselect_b32 s42, 0x40810204, s42
s_cselect_b32 s43, 0x4081020, s43
s_cmp_eq_u32 s25, 2
s_cselect_b32 s42, 0x81020408, s42
s_cselect_b32 s43, 0x8102040, s43
s_cmp_eq_u32 s25, 3
s_cselect_b32 s42, 0x2040811, s42
s_cselect_b32 s43, 0x10204081, s43
s_cmp_eq_u32 s25, 4
s_cselect_b32 s42, 0x4081020, s42
s_cselect_b32 s43, 0x20408102, s43
s_cmp_eq_u32 s25, 5
s_cselect_b32 s42, 0x8102040, s42
s_cselect_b32 s43, 0x40810204, s43
s_cmp_eq_u32 s25, 6
s_cselect_b32 s42, 0x10204080, s42
s_cselect_b32 s43, 0x81020408, s43
s_mov_b32 s44, 67108864
s_mov_b32 s45, 111169536
s_mov_b32 s46, 4
s_mov_b32 s47, 0
s_mov_b32 s54, 536870912
s_branch L_op
L_bdie:
s_mov_b32 s4, 0x5557fe00
s_mov_b32 s5, 0x55555555
s_cmp_eq_u32 s3, 2
s_cbranch_scc1 L_cr0
s_mov_b32 s4, 0xaaa80000
s_mov_b32 s5, 0xaaaaaaaa
s_branch L_cr0
s_and_b32 s27, s3, 1
s_lshr_b32 s26, s16, 2
s_lshl_b32 s26, s26, 1
s_and_b32 s24, s16, 1
s_add_u32 s26, s26, s24
s_mov_b32 s4, 0x5557fe00
s_mov_b32 s5, 0x55555555
s_bitcmp1_b32 s16, 1
s_cbranch_scc1 L_crew
s_mov_b32 s4, 0xaaa80000
s_mov_b32 s5, 0xaaaaaaaa
s_branch L_crew
L_part:
s_mov_b32 s4, 0x1ff
s_mov_b32 s5, 0x0
L_cr0:
s_bfe_u32 s27, s16, 0x10001
s_lshr_b32 s26, s16, 2
s_bitcmp0_b32 s16, 0
s_cselect_b32 s24, 8, 0
s_add_u32 s26, s26, s24
L_crew:
s_cmp_eq_u64 s[4:5], 0
s_cbranch_scc1 L_done
s_cmp_lt_u32 s26, 9
s_cbranch_scc1 L_bo
s_mov_b64 s[52:53], s[4:5]
s_sub_u32 s41, s26, 9
s_lshl_b32 s41, s41, 1
s_add_u32 s41, s41, s27
s_mul_i32 s24, s17, 14
s_add_u32 s41, s41, s24
s_mov_b32 s40, 0x3e0293ee
s_mov_b32 s50, 0xf149f2ca
s_mov_b32 s51, 0x41a00000
s_lshl_b32 s55, s3, 7
s_add_u32 s55, s55, 111171584
v_and_b32 v5, 31, v0
v_bfe_u32 v26, v0, 5, 1
v_lshlrev_b32 v27, 2, v26
v_sub_u32 v5, v5, v27
v_bfe_u32 v27, v0, 4, 1
v_lshlrev_b32 v6, 17, v27
v_lshl_add_u32 v6, v26, 8, v6
v_and_b32 v27, 15, v0
v_lshl_add_u32 v6, v27, 4, v6
v_and_b32 v1, 63, v0
v_min_u32 v17, 47, v1
v_lshlrev_b32 v1, 4, v1
s_lshl_b32 s24, s17, 12
s_mov_b32 m0, s24
v_bfe_u32 v26, v0, 5, 1
v_and_b32 v27, 1, v0
v_lshl_add_u32 v2, v27, 2, s24
v_lshl_add_u32 v2, v26, 5, v2
v_bfe_u32 v27, v0, 1, 2
v_lshl_add_u32 v2, v27, 8, v2
v_lshl_add_u32 v3, v26, 9, s24
v_bfe_u32 v27, v0, 4, 1
v_lshl_add_u32 v3, v27, 2, v3
v_bfe_u32 v27, v0, 3, 1
v_lshl_add_u32 v3, v27, 6, v3
v_bfe_u32 v27, v0, 2, 1
v_lshl_add_u32 v3, v27, 7, v3
v_and_b32 v27, 3, v0
v_lshl_add_u32 v3, v27, 4, v3
v_mov_b32 v4, 0
v_lshlrev_b32 v17, 7, v17
v_mul_u32_u24 v26, 24576, v26
v_add_u32 v17, v17, v26
v_add_u32 v17, 111149056, v17
v_mov_b32 v31, s50
s_mov_b32 s49, 0
s_mov_b32 s62, 0
s_mov_b32 s63, 0
s_mov_b32 s45, -1
v_cmp_le_i32 s[64:65], 0, v5
v_cmp_le_i32 s[66:67], 1, v5
v_cmp_le_i32 s[68:69], 2, v5
v_cmp_le_i32 s[70:71], 3, v5
v_cmp_le_i32 s[72:73], 8, v5
v_cmp_le_i32 s[74:75], 9, v5
v_cmp_le_i32 s[76:77], 10, v5
v_cmp_le_i32 s[78:79], 11, v5
v_cmp_le_i32 s[80:81], 16, v5
v_cmp_le_i32 s[82:83], 17, v5
v_cmp_le_i32 s[84:85], 18, v5
v_cmp_le_i32 s[86:87], 19, v5
v_cmp_le_i32 s[88:89], 24, v5
v_cmp_le_i32 s[90:91], 25, v5
v_cmp_le_i32 s[92:93], 26, v5
v_cmp_le_i32 s[94:95], 27, v5
L_nb_19:
s_ff1_i32_b64 s47, s[52:53]
s_cmp_lt_u32 s41, 32
s_cbranch_scc1 L_nb_20
s_bitset0_b64 s[52:53], s47
s_sub_u32 s41, s41, 32
s_add_u32 s62, s62, 1
s_branch L_nb_19
L_nb_20:
s_lshl_b32 s47, s47, 5
s_add_u32 s47, s47, s41
s_add_u32 s41, s41, 56
s_lshl_b32 s46, s47, 14
s_add_u32 s46, s46, 33554432
s_lshl_b32 s44, s47, 13
s_add_u32 s44, s44, 134217728
s_cmp_ge_u32 s47, 2048
s_cselect_b32 s44, 536870912, s44
s_cselect_b32 s46, 536870912, s46
s_cbranch_scc1 L_nb_18
s_lshr_b32 s25, s47, 8
s_lshl_b32 s25, s25, 2
s_cmp_eq_u32 s25, s45
s_cbranch_scc1 L_nb_18
s_mov_b32 s45, s25
s_mov_b32 s28, 0
L_poll_22:
buffer_load_dword v26, v17, s[8:11], s45 offen sc1
s_add_u32 s28, s28, 1
s_cmp_gt_u32 s28, 200000
s_cbranch_scc1 L_end
s_waitcnt vmcnt(0)
v_cmp_ne_u32 vcc, 1, v26
s_cbranch_vccz L_pd_23
s_sleep 8
s_cmp_lt_u32 s28, 32
s_cbranch_scc1 L_poll_22
s_sleep 32
s_branch L_poll_22
L_pd_23:
L_nb_18:
s_cmp_ge_u32 s47, 2048
s_cbranch_scc1 L_bt_x
s_add_u32 s25, s44, 0
buffer_load_dwordx4 a[0:3], v1, s[8:11], s25 offen sc1
buffer_load_dwordx4 a[4:7], v1, s[8:11], s25 offen offset:1024 sc1
buffer_load_dwordx4 a[8:11], v1, s[8:11], s25 offen offset:2048 sc1
buffer_load_dwordx4 a[12:15], v1, s[8:11], s25 offen offset:3072 sc1
s_add_u32 s25, s44, 4096
buffer_load_dwordx4 a[16:19], v1, s[8:11], s25 offen sc1
buffer_load_dwordx4 a[20:23], v1, s[8:11], s25 offen offset:1024 sc1
buffer_load_dwordx4 a[24:27], v1, s[8:11], s25 offen offset:2048 sc1
buffer_load_dwordx4 a[28:31], v1, s[8:11], s25 offen offset:3072 sc1
s_add_u32 s25, s46, 0
buffer_load_dwordx4 a[32:35], v1, s[8:11], s25 offen sc1
buffer_load_dwordx4 a[36:39], v1, s[8:11], s25 offen offset:1024 sc1
buffer_load_dwordx4 a[40:43], v1, s[8:11], s25 offen offset:2048 sc1
buffer_load_dwordx4 a[44:47], v1, s[8:11], s25 offen offset:3072 sc1
s_add_u32 s25, s46, 4096
buffer_load_dwordx4 a[48:51], v1, s[8:11], s25 offen sc1
buffer_load_dwordx4 a[52:55], v1, s[8:11], s25 offen offset:1024 sc1
buffer_load_dwordx4 a[56:59], v1, s[8:11], s25 offen offset:2048 sc1
buffer_load_dwordx4 a[60:63], v1, s[8:11], s25 offen offset:3072 sc1
s_add_u32 s25, s46, 8192
buffer_load_dwordx4 a[64:67], v1, s[8:11], s25 offen sc1
buffer_load_dwordx4 a[68:71], v1, s[8:11], s25 offen offset:1024 sc1
buffer_load_dwordx4 a[72:75], v1, s[8:11], s25 offen offset:2048 sc1
buffer_load_dwordx4 a[76:79], v1, s[8:11], s25 offen offset:3072 sc1
s_add_u32 s25, s46, 12288
buffer_load_dwordx4 a[80:83], v1, s[8:11], s25 offen sc1
buffer_load_dwordx4 a[84:87], v1, s[8:11], s25 offen offset:1024 sc1
buffer_load_dwordx4 a[88:91], v1, s[8:11], s25 offen offset:2048 sc1
buffer_load_dwordx4 a[92:95], v1, s[8:11], s25 offen offset:3072 sc1
s_waitcnt vmcnt(0)
s_mov_b32 s54, 536870912
s_mov_b32 s60, 536870912
s_mov_b32 s30, 0x0
s_mov_b32 s31, 0x0
L_bt:
s_waitcnt vmcnt(8)
v_mfma_f32_32x32x16_bf16 v[32:47], a[32:35], a[0:3], 0
v_mfma_f32_32x32x16_bf16 v[32:47], a[36:39], a[4:7], v[32:47]
v_mfma_f32_32x32x16_bf16 v[32:47], a[40:43], a[8:11], v[32:47]
v_mfma_f32_32x32x16_bf16 v[32:47], a[44:47], a[12:15], v[32:47]
v_mfma_f32_32x32x16_bf16 v[32:47], a[48:51], a[16:19], v[32:47]
v_mfma_f32_32x32x16_bf16 v[32:47], a[52:55], a[20:23], v[32:47]
v_mfma_f32_32x32x16_bf16 v[32:47], a[56:59], a[24:27], v[32:47]
v_mfma_f32_32x32x16_bf16 v[32:47], a[60:63], a[28:31], v[32:47]
s_and_b32 s42, s47, 31
s_lshr_b32 s43, s47, 5
s_lshl_b32 s26, s47, 12
s_add_u32 s26, s26, 100663296
s_nop 7
v_cndmask_b32 v32, v31, v32, s[64:65]
v_cndmask_b32 v33, v31, v33, s[66:67]
v_cndmask_b32 v34, v31, v34, s[68:69]
v_cndmask_b32 v35, v31, v35, s[70:71]
v_cndmask_b32 v36, v31, v36, s[72:73]
v_cndmask_b32 v37, v31, v37, s[74:75]
v_cndmask_b32 v38, v31, v38, s[76:77]
v_cndmask_b32 v39, v31, v39, s[78:79]
v_cndmask_b32 v40, v31, v40, s[80:81]
v_cndmask_b32 v41, v31, v41, s[82:83]
v_cndmask_b32 v42, v31, v42, s[84:85]
v_cndmask_b32 v43, v31, v43, s[86:87]
v_cndmask_b32 v44, v31, v44, s[88:89]
v_cndmask_b32 v45, v31, v45, s[90:91]
v_cndmask_b32 v46, v31, v46, s[92:93]
v_cndmask_b32 v47, v31, v47, s[94:95]
v_max3_f32 v20, v32, v33, v34
v_max3_f32 v20, v20, v35, v36
v_max3_f32 v20, v20, v37, v38
v_max3_f32 v20, v20, v39, v40
v_max3_f32 v20, v20, v41, v42
v_max3_f32 v20, v20, v43, v44
v_max3_f32 v20, v20, v45, v46
v_max_f32 v20, v20, v47
s_cmp_lt_u32 s43, s49
s_cbranch_scc1 L_kn_24
v_mov_b32 v26, 1
s_waitcnt vmcnt(0)
s_mov_b64 exec, 1
buffer_store_dword v26, v4, s[8:11], s54 offen
s_mov_b64 exec, -1
L_nb_27:
s_ff1_i32_b64 s48, s[52:53]
s_cmp_lt_u32 s41, 32
s_cbranch_scc1 L_nb_28
s_bitset0_b64 s[52:53], s48
s_sub_u32 s41, s41, 32
s_add_u32 s62, s62, 1
s_branch L_nb_27
L_nb_28:
s_lshl_b32 s48, s48, 5
s_add_u32 s48, s48, s41
s_add_u32 s41, s41, 56
s_lshl_b32 s46, s48, 14
s_add_u32 s46, s46, 33554432
s_lshl_b32 s44, s48, 13
s_add_u32 s44, s44, 134217728
s_cmp_ge_u32 s48, 2048
s_cselect_b32 s44, 536870912, s44
s_cselect_b32 s46, 536870912, s46
s_cbranch_scc1 L_nb_26
s_lshr_b32 s25, s48, 8
s_lshl_b32 s25, s25, 2
s_cmp_eq_u32 s25, s45
s_cbranch_scc1 L_nb_26
s_mov_b32 s45, s25
s_mov_b32 s28, 0
L_poll_30:
buffer_load_dword v26, v17, s[8:11], s45 offen sc1
s_add_u32 s28, s28, 1
s_cmp_gt_u32 s28, 200000
s_cbranch_scc1 L_end
s_waitcnt vmcnt(0)
v_cmp_ne_u32 vcc, 1, v26
s_cbranch_vccz L_pd_31
s_sleep 8
s_cmp_lt_u32 s28, 32
s_cbranch_scc1 L_poll_30
s_sleep 32
s_branch L_poll_30
L_pd_31:
L_nb_26:
s_add_u32 s25, s44, 0
buffer_load_dwordx4 a[96:99], v1, s[8:11], s25 offen sc1
buffer_load_dwordx4 a[100:103], v1, s[8:11], s25 offen offset:1024 sc1
buffer_load_dwordx4 a[104:107], v1, s[8:11], s25 offen offset:2048 sc1
buffer_load_dwordx4 a[108:111], v1, s[8:11], s25 offen offset:3072 sc1
s_add_u32 s25, s44, 4096
buffer_load_dwordx4 a[112:115], v1, s[8:11], s25 offen sc1
buffer_load_dwordx4 a[116:119], v1, s[8:11], s25 offen offset:1024 sc1
buffer_load_dwordx4 a[120:123], v1, s[8:11], s25 offen offset:2048 sc1
buffer_load_dwordx4 a[124:127], v1, s[8:11], s25 offen offset:3072 sc1
s_add_u32 s25, s46, 0
buffer_load_dwordx4 a[128:131], v1, s[8:11], s25 offen sc1
buffer_load_dwordx4 a[132:135], v1, s[8:11], s25 offen offset:1024 sc1
buffer_load_dwordx4 a[136:139], v1, s[8:11], s25 offen offset:2048 sc1
buffer_load_dwordx4 a[140:143], v1, s[8:11], s25 offen offset:3072 sc1
s_add_u32 s25, s46, 4096
buffer_load_dwordx4 a[144:147], v1, s[8:11], s25 offen sc1
buffer_load_dwordx4 a[148:151], v1, s[8:11], s25 offen offset:1024 sc1
buffer_load_dwordx4 a[152:155], v1, s[8:11], s25 offen offset:2048 sc1
buffer_load_dwordx4 a[156:159], v1, s[8:11], s25 offen offset:3072 sc1
s_add_u32 s25, s46, 8192
buffer_load_dwordx4 a[160:163], v1, s[8:11], s25 offen sc1
buffer_load_dwordx4 a[164:167], v1, s[8:11], s25 offen offset:1024 sc1
buffer_load_dwordx4 a[168:171], v1, s[8:11], s25 offen offset:2048 sc1
buffer_load_dwordx4 a[172:175], v1, s[8:11], s25 offen offset:3072 sc1
s_add_u32 s25, s46, 12288
buffer_load_dwordx4 a[176:179], v1, s[8:11], s25 offen sc1
buffer_load_dwordx4 a[180:183], v1, s[8:11], s25 offen offset:1024 sc1
buffer_load_dwordx4 a[184:187], v1, s[8:11], s25 offen offset:2048 sc1
buffer_load_dwordx4 a[188:191], v1, s[8:11], s25 offen offset:3072 sc1
s_lshl_b32 s25, s42, 7
s_add_u32 s25, s25, 111153152
s_mov_b32 s28, 0
L_poll_32:
buffer_load_dword v26, v4, s[8:11], s25 offen sc1
s_add_u32 s28, s28, 1
s_cmp_gt_u32 s28, 200000
s_cbranch_scc1 L_end
s_waitcnt vmcnt(0)
v_cmp_ge_u32 vcc, s43, v26
s_cbranch_vccz L_pd_33
s_sleep 1
s_cmp_lt_u32 s28, 32
s_cbranch_scc1 L_poll_32
s_sleep 32
s_branch L_poll_32
L_pd_33:
buffer_load_dwordx4 v1, s[8:11], s26 offen sc1 lds
buffer_load_dwordx4 v1, s[8:11], s26 offen offset:1024 sc1 lds
buffer_load_dwordx4 v1, s[8:11], s26 offen offset:2048 sc1 lds
buffer_load_dwordx4 v1, s[8:11], s26 offen offset:3072 sc1 lds
v_readfirstlane_b32 s49, v26
s_nop 0
s_min_u32 s49, s49, 63
s_sub_u32 s49, s49, 1
s_waitcnt vmcnt(3)
ds_read_b32 v96, v2 offset:8
ds_read_b32 v97, v2 offset:24
ds_read_b32 v98, v2 offset:72
ds_read_b32 v99, v2 offset:88
ds_read_b32 v100, v2 offset:136
ds_read_b32 v101, v2 offset:152
ds_read_b32 v102, v2 offset:200
ds_read_b32 v103, v2 offset:216
s_waitcnt vmcnt(2)
ds_read_b32 v104, v2 offset:1032
ds_read_b32 v105, v2 offset:1048
ds_read_b32 v106, v2 offset:1096
ds_read_b32 v107, v2 offset:1112
s_waitcnt lgkmcnt(8)
v_mfma_f32_32x32x16_bf16 v[64:79], v[96:99], a[0:3], 0
ds_read_b32 v108, v2 offset:1160
ds_read_b32 v109, v2 offset:1176
ds_read_b32 v110, v2 offset:1224
ds_read_b32 v111, v2 offset:1240
s_waitcnt lgkmcnt(8)
v_mfma_f32_32x32x16_bf16 v[64:79], v[100:103], a[4:7], v[64:79]
s_waitcnt vmcnt(1)
ds_read_b32 v112, v2 offset:2056
ds_read_b32 v113, v2 offset:2072
ds_read_b32 v114, v2 offset:2120
ds_read_b32 v115, v2 offset:2136
s_waitcnt lgkmcnt(8)
v_mfma_f32_32x32x16_bf16 v[64:79], v[104:107], a[8:11], v[64:79]
ds_read_b32 v116, v2 offset:2184
ds_read_b32 v117, v2 offset:2200
ds_read_b32 v118, v2 offset:2248
ds_read_b32 v119, v2 offset:2264
s_waitcnt lgkmcnt(8)
v_mfma_f32_32x32x16_bf16 v[64:79], v[108:111], a[12:15], v[64:79]
s_waitcnt vmcnt(0)
ds_read_b32 v120, v2 offset:3080
ds_read_b32 v121, v2 offset:3096
ds_read_b32 v122, v2 offset:3144
ds_read_b32 v123, v2 offset:3160
s_waitcnt lgkmcnt(8)
v_mfma_f32_32x32x16_bf16 v[64:79], v[112:115], a[16:19], v[64:79]
ds_read_b32 v124, v2 offset:3208
ds_read_b32 v125, v2 offset:3224
ds_read_b32 v126, v2 offset:3272
ds_read_b32 v127, v2 offset:3288
s_waitcnt lgkmcnt(8)
v_mfma_f32_32x32x16_bf16 v[64:79], v[116:119], a[20:23], v[64:79]
ds_read_b32 v8, v3
ds_read_b32 v9, v3 offset:256
ds_read_b32 v10, v3 offset:1024
ds_read_b32 v11, v3 offset:1280
s_waitcnt lgkmcnt(8)
v_mfma_f32_32x32x16_bf16 v[64:79], v[120:123], a[24:27], v[64:79]
ds_read_b32 v12, v3 offset:2048
ds_read_b32 v13, v3 offset:2304
ds_read_b32 v14, v3 offset:3072
ds_read_b32 v15, v3 offset:3328
s_waitcnt lgkmcnt(8)
v_mfma_f32_32x32x16_bf16 v[64:79], v[124:127], a[28:31], v[64:79]
s_branch L_kj_25
L_kn_24:
buffer_load_dwordx4 v1, s[8:11], s26 offen sc1 lds
buffer_load_dwordx4 v1, s[8:11], s26 offen offset:1024 sc1 lds
buffer_load_dwordx4 v1, s[8:11], s26 offen offset:2048 sc1 lds
buffer_load_dwordx4 v1, s[8:11], s26 offen offset:3072 sc1 lds
v_mov_b32 v26, 1
s_waitcnt vmcnt(4)
s_mov_b64 exec, 1
buffer_store_dword v26, v4, s[8:11], s54 offen
s_mov_b64 exec, -1
L_nb_35:
s_ff1_i32_b64 s48, s[52:53]
s_cmp_lt_u32 s41, 32
s_cbranch_scc1 L_nb_36
s_bitset0_b64 s[52:53], s48
s_sub_u32 s41, s41, 32
s_add_u32 s62, s62, 1
s_branch L_nb_35
L_nb_36:
s_lshl_b32 s48, s48, 5
s_add_u32 s48, s48, s41
s_add_u32 s41, s41, 56
s_lshl_b32 s46, s48, 14
s_add_u32 s46, s46, 33554432
s_lshl_b32 s44, s48, 13
s_add_u32 s44, s44, 134217728
s_cmp_ge_u32 s48, 2048
s_cselect_b32 s44, 536870912, s44
s_cselect_b32 s46, 536870912, s46
s_cbranch_scc1 L_nb_34
s_lshr_b32 s25, s48, 8
s_lshl_b32 s25, s25, 2
s_cmp_eq_u32 s25, s45
s_cbranch_scc1 L_nb_34
s_mov_b32 s45, s25
s_mov_b32 s28, 0
L_poll_38:
buffer_load_dword v26, v17, s[8:11], s45 offen sc1
s_add_u32 s28, s28, 1
s_cmp_gt_u32 s28, 200000
s_cbranch_scc1 L_end
s_waitcnt vmcnt(0)
v_cmp_ne_u32 vcc, 1, v26
s_cbranch_vccz L_pd_39
s_sleep 8
s_cmp_lt_u32 s28, 32
s_cbranch_scc1 L_poll_38
s_sleep 32
s_branch L_poll_38
L_pd_39:
L_nb_34:
s_add_u32 s25, s44, 0
buffer_load_dwordx4 a[96:99], v1, s[8:11], s25 offen sc1
buffer_load_dwordx4 a[100:103], v1, s[8:11], s25 offen offset:1024 sc1
buffer_load_dwordx4 a[104:107], v1, s[8:11], s25 offen offset:2048 sc1
buffer_load_dwordx4 a[108:111], v1, s[8:11], s25 offen offset:3072 sc1
s_add_u32 s25, s44, 4096
buffer_load_dwordx4 a[112:115], v1, s[8:11], s25 offen sc1
buffer_load_dwordx4 a[116:119], v1, s[8:11], s25 offen offset:1024 sc1
buffer_load_dwordx4 a[120:123], v1, s[8:11], s25 offen offset:2048 sc1
buffer_load_dwordx4 a[124:127], v1, s[8:11], s25 offen offset:3072 sc1
s_waitcnt vmcnt(12)
ds_read_b32 v96, v2 offset:8
ds_read_b32 v97, v2 offset:24
ds_read_b32 v98, v2 offset:72
ds_read_b32 v99, v2 offset:88
ds_read_b32 v100, v2 offset:136
ds_read_b32 v101, v2 offset:152
ds_read_b32 v102, v2 offset:200
ds_read_b32 v103, v2 offset:216
s_waitcnt vmcnt(11)
ds_read_b32 v104, v2 offset:1032
ds_read_b32 v105, v2 offset:1048
ds_read_b32 v106, v2 offset:1096
ds_read_b32 v107, v2 offset:1112
s_waitcnt lgkmcnt(8)
v_mfma_f32_32x32x16_bf16 v[64:79], v[96:99], a[0:3], 0
s_add_u32 s25, s46, 0
buffer_load_dwordx4 a[128:131], v1, s[8:11], s25 offen sc1
buffer_load_dwordx4 a[132:135], v1, s[8:11], s25 offen offset:1024 sc1
ds_read_b32 v108, v2 offset:1160
ds_read_b32 v109, v2 offset:1176
ds_read_b32 v110, v2 offset:1224
ds_read_b32 v111, v2 offset:1240
s_waitcnt lgkmcnt(8)
v_mfma_f32_32x32x16_bf16 v[64:79], v[100:103], a[4:7], v[64:79]
buffer_load_dwordx4 a[136:139], v1, s[8:11], s25 offen offset:2048 sc1
buffer_load_dwordx4 a[140:143], v1, s[8:11], s25 offen offset:3072 sc1
s_waitcnt vmcnt(14)
ds_read_b32 v112, v2 offset:2056
ds_read_b32 v113, v2 offset:2072
ds_read_b32 v114, v2 offset:2120
ds_read_b32 v115, v2 offset:2136
s_waitcnt lgkmcnt(8)
v_mfma_f32_32x32x16_bf16 v[64:79], v[104:107], a[8:11], v[64:79]
s_add_u32 s25, s46, 4096
buffer_load_dwordx4 a[144:147], v1, s[8:11], s25 offen sc1
buffer_load_dwordx4 a[148:151], v1, s[8:11], s25 offen offset:1024 sc1
ds_read_b32 v116, v2 offset:2184
ds_read_b32 v117, v2 offset:2200
ds_read_b32 v118, v2 offset:2248
ds_read_b32 v119, v2 offset:2264
s_waitcnt lgkmcnt(8)
v_mfma_f32_32x32x16_bf16 v[64:79], v[108:111], a[12:15], v[64:79]
buffer_load_dwordx4 a[152:155], v1, s[8:11], s25 offen offset:2048 sc1
buffer_load_dwordx4 a[156:159], v1, s[8:11], s25 offen offset:3072 sc1
s_waitcnt vmcnt(17)
ds_read_b32 v120, v2 offset:3080
ds_read_b32 v121, v2 offset:3096
ds_read_b32 v122, v2 offset:3144
ds_read_b32 v123, v2 offset:3160
s_waitcnt lgkmcnt(8)
v_mfma_f32_32x32x16_bf16 v[64:79], v[112:115], a[16:19], v[64:79]
s_add_u32 s25, s46, 8192
buffer_load_dwordx4 a[160:163], v1, s[8:11], s25 offen sc1
buffer_load_dwordx4 a[164:167], v1, s[8:11], s25 offen offset:1024 sc1
ds_read_b32 v124, v2 offset:3208
ds_read_b32 v125, v2 offset:3224
ds_read_b32 v126, v2 offset:3272
ds_read_b32 v127, v2 offset:3288
s_waitcnt lgkmcnt(8)
v_mfma_f32_32x32x16_bf16 v[64:79], v[116:119], a[20:23], v[64:79]
buffer_load_dwordx4 a[168:171], v1, s[8:11], s25 offen offset:2048 sc1
buffer_load_dwordx4 a[172:175], v1, s[8:11], s25 offen offset:3072 sc1
ds_read_b32 v8, v3
ds_read_b32 v9, v3 offset:256
ds_read_b32 v10, v3 offset:1024
ds_read_b32 v11, v3 offset:1280
s_waitcnt lgkmcnt(8)
v_mfma_f32_32x32x16_bf16 v[64:79], v[120:123], a[24:27], v[64:79]
s_add_u32 s25, s46, 12288
buffer_load_dwordx4 a[176:179], v1, s[8:11], s25 offen sc1
buffer_load_dwordx4 a[180:183], v1, s[8:11], s25 offen offset:1024 sc1
ds_read_b32 v12, v3 offset:2048
ds_read_b32 v13, v3 offset:2304
ds_read_b32 v14, v3 offset:3072
ds_read_b32 v15, v3 offset:3328
s_waitcnt lgkmcnt(8)
v_mfma_f32_32x32x16_bf16 v[64:79], v[124:127], a[28:31], v[64:79]
buffer_load_dwordx4 a[184:187], v1, s[8:11], s25 offen offset:2048 sc1
buffer_load_dwordx4 a[188:191], v1, s[8:11], s25 offen offset:3072 sc1
L_kj_25:
s_nop 10
v_max3_f32 v20, v20, v64, v65
v_max3_f32 v20, v20, v66, v67
v_mov_b32 v26, v20
s_nop 1
v_permlane32_swap_b32 v26, v20
v_max_f32 v20, v20, v26
v_mul_f32 v20, s40, v20
v_pk_fma_f32 v[64:65], v[64:65], s[40:41], v[20:21] op_sel_hi:[1,0,0] neg_lo:[0,0,1] neg_hi:[0,0,1]
v_pk_fma_f32 v[66:67], v[66:67], s[40:41], v[20:21] op_sel_hi:[1,0,0] neg_lo:[0,0,1] neg_hi:[0,0,1]
v_pk_fma_f32 v[32:33], v[32:33], s[40:41], v[20:21] op_sel_hi:[1,0,0] neg_lo:[0,0,1] neg_hi:[0,0,1]
v_pk_fma_f32 v[34:35], v[34:35], s[40:41], v[20:21] op_sel_hi:[1,0,0] neg_lo:[0,0,1] neg_hi:[0,0,1]
v_pk_fma_f32 v[36:37], v[36:37], s[40:41], v[20:21] op_sel_hi:[1,0,0] neg_lo:[0,0,1] neg_hi:[0,0,1]
v_pk_fma_f32 v[38:39], v[38:39], s[40:41], v[20:21] op_sel_hi:[1,0,0] neg_lo:[0,0,1] neg_hi:[0,0,1]
v_pk_fma_f32 v[40:41], v[40:41], s[40:41], v[20:21] op_sel_hi:[1,0,0] neg_lo:[0,0,1] neg_hi:[0,0,1]
v_pk_fma_f32 v[42:43], v[42:43], s[40:41], v[20:21] op_sel_hi:[1,0,0] neg_lo:[0,0,1] neg_hi:[0,0,1]
v_pk_fma_f32 v[44:45], v[44:45], s[40:41], v[20:21] op_sel_hi:[1,0,0] neg_lo:[0,0,1] neg_hi:[0,0,1]
v_pk_fma_f32 v[46:47], v[46:47], s[40:41], v[20:21] op_sel_hi:[1,0,0] neg_lo:[0,0,1] neg_hi:[0,0,1]
v_exp_f32 v64, v64
v_exp_f32 v65, v65
v_exp_f32 v66, v66
v_exp_f32 v67, v67
v_exp_f32 v32, v32
v_exp_f32 v33, v33
v_cvt_pk_bf16_f32 v88, v64, v65
v_cvt_pk_bf16_f32 v89, v66, v67
s_waitcnt lgkmcnt(0)
s_nop 0
v_mfma_f32_32x32x8_bf16 v[128:143], v[8:9], v[88:89], 0
v_exp_f32 v34, v34
v_exp_f32 v35, v35
v_exp_f32 v36, v36
v_mfma_f32_32x32x8_bf16 v[160:175], v[10:11], v[88:89], 0
v_exp_f32 v37, v37
v_exp_f32 v38, v38
v_mfma_f32_32x32x8_bf16 v[192:207], v[12:13], v[88:89], 0
v_exp_f32 v39, v39
v_exp_f32 v40, v40
v_exp_f32 v41, v41
v_mfma_f32_32x32x8_bf16 v[224:239], v[14:15], v[88:89], 0
v_cvt_pk_bf16_f32 v80, v32, v33
v_cvt_pk_bf16_f32 v81, v34, v35
v_cvt_pk_bf16_f32 v82, v36, v37
v_cvt_pk_bf16_f32 v83, v38, v39
s_nop 1
v_mfma_f32_32x32x16_bf16 v[128:143], a[64:67], v[80:83], v[128:143]
v_exp_f32 v42, v42
v_exp_f32 v43, v43
v_exp_f32 v44, v44
v_mfma_f32_32x32x16_bf16 v[160:175], a[72:75], v[80:83], v[160:175]
v_exp_f32 v45, v45
v_exp_f32 v46, v46
v_mfma_f32_32x32x16_bf16 v[192:207], a[80:83], v[80:83], v[192:207]
v_exp_f32 v47, v47
v_add_f32 v22, v64, v65
v_add_f32 v22, v22, v66
v_add_f32 v22, v22, v67
v_add_f32 v22, v22, v32
v_mfma_f32_32x32x16_bf16 v[224:239], a[88:91], v[80:83], v[224:239]
v_add_f32 v22, v22, v33
v_cvt_pk_bf16_f32 v84, v40, v41
v_cvt_pk_bf16_f32 v85, v42, v43
v_cvt_pk_bf16_f32 v86, v44, v45
v_cvt_pk_bf16_f32 v87, v46, v47
s_nop 1
v_mfma_f32_32x32x16_bf16 v[128:143], a[68:71], v[84:87], v[128:143]
v_add_f32 v22, v22, v34
v_add_f32 v22, v22, v35
v_add_f32 v22, v22, v36
v_add_f32 v22, v22, v37
v_add_f32 v22, v22, v38
v_mfma_f32_32x32x16_bf16 v[160:175], a[76:79], v[84:87], v[160:175]
v_add_f32 v22, v22, v39
v_add_f32 v22, v22, v40
v_add_f32 v22, v22, v41
v_add_f32 v22, v22, v42
v_mfma_f32_32x32x16_bf16 v[192:207], a[84:87], v[84:87], v[192:207]
v_add_f32 v22, v22, v43
v_add_f32 v22, v22, v44
v_add_f32 v22, v22, v45
v_add_f32 v22, v22, v46
v_add_f32 v22, v22, v47
v_mfma_f32_32x32x16_bf16 v[224:239], a[92:95], v[84:87], v[224:239]
s_lshl_b32 s26, s43, 18
s_lshl_b32 s27, s42, 12
s_add_u32 s26, s26, s27
s_add_u32 s26, s26, 83886080
v_mov_b32 v26, v22
s_nop 1
v_permlane32_swap_b32 v26, v22
v_add_f32 v26, v26, v22
v_rcp_f32 v26, v26
s_nop 0
v_pk_mul_f32 v[128:129], v[128:129], v[26:27] op_sel_hi:[1,0]
v_pk_mul_f32 v[130:131], v[130:131], v[26:27] op_sel_hi:[1,0]
v_pk_mul_f32 v[132:133], v[132:133], v[26:27] op_sel_hi:[1,0]
v_pk_mul_f32 v[134:135], v[134:135], v[26:27] op_sel_hi:[1,0]
v_pk_mul_f32 v[136:137], v[136:137], v[26:27] op_sel_hi:[1,0]
v_pk_mul_f32 v[138:139], v[138:139], v[26:27] op_sel_hi:[1,0]
v_pk_mul_f32 v[140:141], v[140:141], v[26:27] op_sel_hi:[1,0]
v_pk_mul_f32 v[142:143], v[142:143], v[26:27] op_sel_hi:[1,0]
v_cvt_pk_bf16_f32 v128, v128, v129
v_cvt_pk_bf16_f32 v129, v130, v131
v_cvt_pk_bf16_f32 v130, v132, v133
v_cvt_pk_bf16_f32 v131, v134, v135
buffer_store_dwordx4 v[128:131], v6, s[8:11], s26 offen
v_cvt_pk_bf16_f32 v136, v136, v137
v_cvt_pk_bf16_f32 v137, v138, v139
v_cvt_pk_bf16_f32 v138, v140, v141
v_cvt_pk_bf16_f32 v139, v142, v143
buffer_store_dwordx4 v[136:139], v6, s[8:11], s26 offen offset:512
v_pk_mul_f32 v[160:161], v[160:161], v[26:27] op_sel_hi:[1,0]
v_pk_mul_f32 v[162:163], v[162:163], v[26:27] op_sel_hi:[1,0]
v_pk_mul_f32 v[164:165], v[164:165], v[26:27] op_sel_hi:[1,0]
v_pk_mul_f32 v[166:167], v[166:167], v[26:27] op_sel_hi:[1,0]
v_pk_mul_f32 v[168:169], v[168:169], v[26:27] op_sel_hi:[1,0]
v_pk_mul_f32 v[170:171], v[170:171], v[26:27] op_sel_hi:[1,0]
v_pk_mul_f32 v[172:173], v[172:173], v[26:27] op_sel_hi:[1,0]
v_pk_mul_f32 v[174:175], v[174:175], v[26:27] op_sel_hi:[1,0]
v_cvt_pk_bf16_f32 v160, v160, v161
v_cvt_pk_bf16_f32 v161, v162, v163
v_cvt_pk_bf16_f32 v162, v164, v165
v_cvt_pk_bf16_f32 v163, v166, v167
buffer_store_dwordx4 v[160:163], v6, s[8:11], s26 offen offset:1024
v_cvt_pk_bf16_f32 v168, v168, v169
v_cvt_pk_bf16_f32 v169, v170, v171
v_cvt_pk_bf16_f32 v170, v172, v173
v_cvt_pk_bf16_f32 v171, v174, v175
buffer_store_dwordx4 v[168:171], v6, s[8:11], s26 offen offset:1536
v_pk_mul_f32 v[192:193], v[192:193], v[26:27] op_sel_hi:[1,0]
v_pk_mul_f32 v[194:195], v[194:195], v[26:27] op_sel_hi:[1,0]
v_pk_mul_f32 v[196:197], v[196:197], v[26:27] op_sel_hi:[1,0]
v_pk_mul_f32 v[198:199], v[198:199], v[26:27] op_sel_hi:[1,0]
v_pk_mul_f32 v[200:201], v[200:201], v[26:27] op_sel_hi:[1,0]
v_pk_mul_f32 v[202:203], v[202:203], v[26:27] op_sel_hi:[1,0]
v_pk_mul_f32 v[204:205], v[204:205], v[26:27] op_sel_hi:[1,0]
v_pk_mul_f32 v[206:207], v[206:207], v[26:27] op_sel_hi:[1,0]
v_cvt_pk_bf16_f32 v192, v192, v193
v_cvt_pk_bf16_f32 v193, v194, v195
v_cvt_pk_bf16_f32 v194, v196, v197
v_cvt_pk_bf16_f32 v195, v198, v199
buffer_store_dwordx4 v[192:195], v6, s[8:11], s26 offen offset:2048
v_cvt_pk_bf16_f32 v200, v200, v201
v_cvt_pk_bf16_f32 v201, v202, v203
v_cvt_pk_bf16_f32 v202, v204, v205
v_cvt_pk_bf16_f32 v203, v206, v207
buffer_store_dwordx4 v[200:203], v6, s[8:11], s26 offen offset:2560
v_pk_mul_f32 v[224:225], v[224:225], v[26:27] op_sel_hi:[1,0]
v_pk_mul_f32 v[226:227], v[226:227], v[26:27] op_sel_hi:[1,0]
v_pk_mul_f32 v[228:229], v[228:229], v[26:27] op_sel_hi:[1,0]
v_pk_mul_f32 v[230:231], v[230:231], v[26:27] op_sel_hi:[1,0]
v_pk_mul_f32 v[232:233], v[232:233], v[26:27] op_sel_hi:[1,0]
v_pk_mul_f32 v[234:235], v[234:235], v[26:27] op_sel_hi:[1,0]
v_pk_mul_f32 v[236:237], v[236:237], v[26:27] op_sel_hi:[1,0]
v_pk_mul_f32 v[238:239], v[238:239], v[26:27] op_sel_hi:[1,0]
v_cvt_pk_bf16_f32 v224, v224, v225
v_cvt_pk_bf16_f32 v225, v226, v227
v_cvt_pk_bf16_f32 v226, v228, v229
v_cvt_pk_bf16_f32 v227, v230, v231
buffer_store_dwordx4 v[224:227], v6, s[8:11], s26 offen offset:3072
v_cvt_pk_bf16_f32 v232, v232, v233
v_cvt_pk_bf16_f32 v233, v234, v235
v_cvt_pk_bf16_f32 v234, v236, v237
v_cvt_pk_bf16_f32 v235, v238, v239
buffer_store_dwordx4 v[232:235], v6, s[8:11], s26 offen offset:3584
s_lshl_b32 s54, s47, 2
s_add_u32 s54, s54, 111157248
s_bitcmp1_b64 s[30:31], s43
s_cselect_b32 s60, s54, 536870912
s_cselect_b32 s54, 536870912, s54
s_mov_b32 s47, s48
s_cmp_lt_u32 s47, 2048
s_cbranch_scc0 L_bt_f
s_waitcnt vmcnt(8)
v_mfma_f32_32x32x16_bf16 v[32:47], a[128:131], a[96:99], 0
v_mfma_f32_32x32x16_bf16 v[32:47], a[132:135], a[100:103], v[32:47]
v_mfma_f32_32x32x16_bf16 v[32:47], a[136:139], a[104:107], v[32:47]
v_mfma_f32_32x32x16_bf16 v[32:47], a[140:143], a[108:111], v[32:47]
v_mfma_f32_32x32x16_bf16 v[32:47], a[144:147], a[112:115], v[32:47]
v_mfma_f32_32x32x16_bf16 v[32:47], a[148:151], a[116:119], v[32:47]
v_mfma_f32_32x32x16_bf16 v[32:47], a[152:155], a[120:123], v[32:47]
v_mfma_f32_32x32x16_bf16 v[32:47], a[156:159], a[124:127], v[32:47]
s_and_b32 s42, s47, 31
s_lshr_b32 s43, s47, 5
s_lshl_b32 s26, s47, 12
s_add_u32 s26, s26, 100663296
s_nop 7
v_cndmask_b32 v32, v31, v32, s[64:65]
v_cndmask_b32 v33, v31, v33, s[66:67]
v_cndmask_b32 v34, v31, v34, s[68:69]
v_cndmask_b32 v35, v31, v35, s[70:71]
v_cndmask_b32 v36, v31, v36, s[72:73]
v_cndmask_b32 v37, v31, v37, s[74:75]
v_cndmask_b32 v38, v31, v38, s[76:77]
v_cndmask_b32 v39, v31, v39, s[78:79]
v_cndmask_b32 v40, v31, v40, s[80:81]
v_cndmask_b32 v41, v31, v41, s[82:83]
v_cndmask_b32 v42, v31, v42, s[84:85]
v_cndmask_b32 v43, v31, v43, s[86:87]
v_cndmask_b32 v44, v31, v44, s[88:89]
v_cndmask_b32 v45, v31, v45, s[90:91]
v_cndmask_b32 v46, v31, v46, s[92:93]
v_cndmask_b32 v47, v31, v47, s[94:95]
v_max3_f32 v20, v32, v33, v34
v_max3_f32 v20, v20, v35, v36
v_max3_f32 v20, v20, v37, v38
v_max3_f32 v20, v20, v39, v40
v_max3_f32 v20, v20, v41, v42
v_max3_f32 v20, v20, v43, v44
v_max3_f32 v20, v20, v45, v46
v_max_f32 v20, v20, v47
s_cmp_lt_u32 s43, s49
s_cbranch_scc1 L_kn_40
v_mov_b32 v26, 1
s_waitcnt vmcnt(0)
s_mov_b64 exec, 1
buffer_store_dword v26, v4, s[8:11], s54 offen
s_mov_b64 exec, -1
L_nb_43:
s_ff1_i32_b64 s48, s[52:53]
s_cmp_lt_u32 s41, 32
s_cbranch_scc1 L_nb_44
s_bitset0_b64 s[52:53], s48
s_sub_u32 s41, s41, 32
s_add_u32 s62, s62, 1
s_branch L_nb_43
L_nb_44:
s_lshl_b32 s48, s48, 5
s_add_u32 s48, s48, s41
s_add_u32 s41, s41, 56
s_lshl_b32 s46, s48, 14
s_add_u32 s46, s46, 33554432
s_lshl_b32 s44, s48, 13
s_add_u32 s44, s44, 134217728
s_cmp_ge_u32 s48, 2048
s_cselect_b32 s44, 536870912, s44
s_cselect_b32 s46, 536870912, s46
s_cbranch_scc1 L_nb_42
s_lshr_b32 s25, s48, 8
s_lshl_b32 s25, s25, 2
s_cmp_eq_u32 s25, s45
s_cbranch_scc1 L_nb_42
s_mov_b32 s45, s25
s_mov_b32 s28, 0
L_poll_46:
buffer_load_dword v26, v17, s[8:11], s45 offen sc1
s_add_u32 s28, s28, 1
s_cmp_gt_u32 s28, 200000
s_cbranch_scc1 L_end
s_waitcnt vmcnt(0)
v_cmp_ne_u32 vcc, 1, v26
s_cbranch_vccz L_pd_47
s_sleep 8
s_cmp_lt_u32 s28, 32
s_cbranch_scc1 L_poll_46
s_sleep 32
s_branch L_poll_46
L_pd_47:
L_nb_42:
s_add_u32 s25, s44, 0
buffer_load_dwordx4 a[0:3], v1, s[8:11], s25 offen sc1
buffer_load_dwordx4 a[4:7], v1, s[8:11], s25 offen offset:1024 sc1
buffer_load_dwordx4 a[8:11], v1, s[8:11], s25 offen offset:2048 sc1
buffer_load_dwordx4 a[12:15], v1, s[8:11], s25 offen offset:3072 sc1
s_add_u32 s25, s44, 4096
buffer_load_dwordx4 a[16:19], v1, s[8:11], s25 offen sc1
buffer_load_dwordx4 a[20:23], v1, s[8:11], s25 offen offset:1024 sc1
buffer_load_dwordx4 a[24:27], v1, s[8:11], s25 offen offset:2048 sc1
buffer_load_dwordx4 a[28:31], v1, s[8:11], s25 offen offset:3072 sc1
s_add_u32 s25, s46, 0
buffer_load_dwordx4 a[32:35], v1, s[8:11], s25 offen sc1
buffer_load_dwordx4 a[36:39], v1, s[8:11], s25 offen offset:1024 sc1
buffer_load_dwordx4 a[40:43], v1, s[8:11], s25 offen offset:2048 sc1
buffer_load_dwordx4 a[44:47], v1, s[8:11], s25 offen offset:3072 sc1
s_add_u32 s25, s46, 4096
buffer_load_dwordx4 a[48:51], v1, s[8:11], s25 offen sc1
buffer_load_dwordx4 a[52:55], v1, s[8:11], s25 offen offset:1024 sc1
buffer_load_dwordx4 a[56:59], v1, s[8:11], s25 offen offset:2048 sc1
buffer_load_dwordx4 a[60:63], v1, s[8:11], s25 offen offset:3072 sc1
s_add_u32 s25, s46, 8192
buffer_load_dwordx4 a[64:67], v1, s[8:11], s25 offen sc1
buffer_load_dwordx4 a[68:71], v1, s[8:11], s25 offen offset:1024 sc1
buffer_load_dwordx4 a[72:75], v1, s[8:11], s25 offen offset:2048 sc1
buffer_load_dwordx4 a[76:79], v1, s[8:11], s25 offen offset:3072 sc1
s_add_u32 s25, s46, 12288
buffer_load_dwordx4 a[80:83], v1, s[8:11], s25 offen sc1
buffer_load_dwordx4 a[84:87], v1, s[8:11], s25 offen offset:1024 sc1
buffer_load_dwordx4 a[88:91], v1, s[8:11], s25 offen offset:2048 sc1
buffer_load_dwordx4 a[92:95], v1, s[8:11], s25 offen offset:3072 sc1
s_lshl_b32 s25, s42, 7
s_add_u32 s25, s25, 111153152
s_mov_b32 s28, 0
L_poll_48:
buffer_load_dword v26, v4, s[8:11], s25 offen sc1
s_add_u32 s28, s28, 1
s_cmp_gt_u32 s28, 200000
s_cbranch_scc1 L_end
s_waitcnt vmcnt(0)
v_cmp_ge_u32 vcc, s43, v26
s_cbranch_vccz L_pd_49
s_sleep 1
s_cmp_lt_u32 s28, 32
s_cbranch_scc1 L_poll_48
s_sleep 32
s_branch L_poll_48
L_pd_49:
buffer_load_dwordx4 v1, s[8:11], s26 offen sc1 lds
buffer_load_dwordx4 v1, s[8:11], s26 offen offset:1024 sc1 lds
buffer_load_dwordx4 v1, s[8:11], s26 offen offset:2048 sc1 lds
buffer_load_dwordx4 v1, s[8:11], s26 offen offset:3072 sc1 lds
v_readfirstlane_b32 s49, v26
s_nop 0
s_min_u32 s49, s49, 63
s_sub_u32 s49, s49, 1
s_waitcnt vmcnt(3)
ds_read_b32 v96, v2 offset:8
ds_read_b32 v97, v2 offset:24
ds_read_b32 v98, v2 offset:72
ds_read_b32 v99, v2 offset:88
ds_read_b32 v100, v2 offset:136
ds_read_b32 v101, v2 offset:152
ds_read_b32 v102, v2 offset:200
ds_read_b32 v103, v2 offset:216
s_waitcnt vmcnt(2)
ds_read_b32 v104, v2 offset:1032
ds_read_b32 v105, v2 offset:1048
ds_read_b32 v106, v2 offset:1096
ds_read_b32 v107, v2 offset:1112
s_waitcnt lgkmcnt(8)
v_mfma_f32_32x32x16_bf16 v[64:79], v[96:99], a[96:99], 0
ds_read_b32 v108, v2 offset:1160
ds_read_b32 v109, v2 offset:1176
ds_read_b32 v110, v2 offset:1224
ds_read_b32 v111, v2 offset:1240
s_waitcnt lgkmcnt(8)
v_mfma_f32_32x32x16_bf16 v[64:79], v[100:103], a[100:103], v[64:79]
s_waitcnt vmcnt(1)
ds_read_b32 v112, v2 offset:2056
ds_read_b32 v113, v2 offset:2072
ds_read_b32 v114, v2 offset:2120
ds_read_b32 v115, v2 offset:2136
s_waitcnt lgkmcnt(8)
v_mfma_f32_32x32x16_bf16 v[64:79], v[104:107], a[104:107], v[64:79]
ds_read_b32 v116, v2 offset:2184
ds_read_b32 v117, v2 offset:2200
ds_read_b32 v118, v2 offset:2248
ds_read_b32 v119, v2 offset:2264
s_waitcnt lgkmcnt(8)
v_mfma_f32_32x32x16_bf16 v[64:79], v[108:111], a[108:111], v[64:79]
s_waitcnt vmcnt(0)
ds_read_b32 v120, v2 offset:3080
ds_read_b32 v121, v2 offset:3096
ds_read_b32 v122, v2 offset:3144
ds_read_b32 v123, v2 offset:3160
s_waitcnt lgkmcnt(8)
v_mfma_f32_32x32x16_bf16 v[64:79], v[112:115], a[112:115], v[64:79]
ds_read_b32 v124, v2 offset:3208
ds_read_b32 v125, v2 offset:3224
ds_read_b32 v126, v2 offset:3272
ds_read_b32 v127, v2 offset:3288
s_waitcnt lgkmcnt(8)
v_mfma_f32_32x32x16_bf16 v[64:79], v[116:119], a[116:119], v[64:79]
ds_read_b32 v8, v3
ds_read_b32 v9, v3 offset:256
ds_read_b32 v10, v3 offset:1024
ds_read_b32 v11, v3 offset:1280
s_waitcnt lgkmcnt(8)
v_mfma_f32_32x32x16_bf16 v[64:79], v[120:123], a[120:123], v[64:79]
ds_read_b32 v12, v3 offset:2048
ds_read_b32 v13, v3 offset:2304
ds_read_b32 v14, v3 offset:3072
ds_read_b32 v15, v3 offset:3328
s_waitcnt lgkmcnt(8)
v_mfma_f32_32x32x16_bf16 v[64:79], v[124:127], a[124:127], v[64:79]
s_branch L_kj_41
L_kn_40:
buffer_load_dwordx4 v1, s[8:11], s26 offen sc1 lds
buffer_load_dwordx4 v1, s[8:11], s26 offen offset:1024 sc1 lds
buffer_load_dwordx4 v1, s[8:11], s26 offen offset:2048 sc1 lds
buffer_load_dwordx4 v1, s[8:11], s26 offen offset:3072 sc1 lds
v_mov_b32 v26, 1
s_waitcnt vmcnt(4)
s_mov_b64 exec, 1
buffer_store_dword v26, v4, s[8:11], s54 offen
s_mov_b64 exec, -1
L_nb_51:
s_ff1_i32_b64 s48, s[52:53]
s_cmp_lt_u32 s41, 32
s_cbranch_scc1 L_nb_52
s_bitset0_b64 s[52:53], s48
s_sub_u32 s41, s41, 32
s_add_u32 s62, s62, 1
s_branch L_nb_51
L_nb_52:
s_lshl_b32 s48, s48, 5
s_add_u32 s48, s48, s41
s_add_u32 s41, s41, 56
s_lshl_b32 s46, s48, 14
s_add_u32 s46, s46, 33554432
s_lshl_b32 s44, s48, 13
s_add_u32 s44, s44, 134217728
s_cmp_ge_u32 s48, 2048
s_cselect_b32 s44, 536870912, s44
s_cselect_b32 s46, 536870912, s46
s_cbranch_scc1 L_nb_50
s_lshr_b32 s25, s48, 8
s_lshl_b32 s25, s25, 2
s_cmp_eq_u32 s25, s45
s_cbranch_scc1 L_nb_50
s_mov_b32 s45, s25
s_mov_b32 s28, 0
L_poll_54:
buffer_load_dword v26, v17, s[8:11], s45 offen sc1
s_add_u32 s28, s28, 1
s_cmp_gt_u32 s28, 200000
s_cbranch_scc1 L_end
s_waitcnt vmcnt(0)
v_cmp_ne_u32 vcc, 1, v26
s_cbranch_vccz L_pd_55
s_sleep 8
s_cmp_lt_u32 s28, 32
s_cbranch_scc1 L_poll_54
s_sleep 32
s_branch L_poll_54
L_pd_55:
L_nb_50:
s_add_u32 s25, s44, 0
buffer_load_dwordx4 a[0:3], v1, s[8:11], s25 offen sc1
buffer_load_dwordx4 a[4:7], v1, s[8:11], s25 offen offset:1024 sc1
buffer_load_dwordx4 a[8:11], v1, s[8:11], s25 offen offset:2048 sc1
buffer_load_dwordx4 a[12:15], v1, s[8:11], s25 offen offset:3072 sc1
s_add_u32 s25, s44, 4096
buffer_load_dwordx4 a[16:19], v1, s[8:11], s25 offen sc1
buffer_load_dwordx4 a[20:23], v1, s[8:11], s25 offen offset:1024 sc1
buffer_load_dwordx4 a[24:27], v1, s[8:11], s25 offen offset:2048 sc1
buffer_load_dwordx4 a[28:31], v1, s[8:11], s25 offen offset:3072 sc1
s_waitcnt vmcnt(12)
ds_read_b32 v96, v2 offset:8
ds_read_b32 v97, v2 offset:24
ds_read_b32 v98, v2 offset:72
ds_read_b32 v99, v2 offset:88
ds_read_b32 v100, v2 offset:136
ds_read_b32 v101, v2 offset:152
ds_read_b32 v102, v2 offset:200
ds_read_b32 v103, v2 offset:216
s_waitcnt vmcnt(11)
ds_read_b32 v104, v2 offset:1032
ds_read_b32 v105, v2 offset:1048
ds_read_b32 v106, v2 offset:1096
ds_read_b32 v107, v2 offset:1112
s_waitcnt lgkmcnt(8)
v_mfma_f32_32x32x16_bf16 v[64:79], v[96:99], a[96:99], 0
s_add_u32 s25, s46, 0
buffer_load_dwordx4 a[32:35], v1, s[8:11], s25 offen sc1
buffer_load_dwordx4 a[36:39], v1, s[8:11], s25 offen offset:1024 sc1
ds_read_b32 v108, v2 offset:1160
ds_read_b32 v109, v2 offset:1176
ds_read_b32 v110, v2 offset:1224
ds_read_b32 v111, v2 offset:1240
s_waitcnt lgkmcnt(8)
v_mfma_f32_32x32x16_bf16 v[64:79], v[100:103], a[100:103], v[64:79]
buffer_load_dwordx4 a[40:43], v1, s[8:11], s25 offen offset:2048 sc1
buffer_load_dwordx4 a[44:47], v1, s[8:11], s25 offen offset:3072 sc1
s_waitcnt vmcnt(14)
ds_read_b32 v112, v2 offset:2056
ds_read_b32 v113, v2 offset:2072
ds_read_b32 v114, v2 offset:2120
ds_read_b32 v115, v2 offset:2136
s_waitcnt lgkmcnt(8)
v_mfma_f32_32x32x16_bf16 v[64:79], v[104:107], a[104:107], v[64:79]
s_add_u32 s25, s46, 4096
buffer_load_dwordx4 a[48:51], v1, s[8:11], s25 offen sc1
buffer_load_dwordx4 a[52:55], v1, s[8:11], s25 offen offset:1024 sc1
ds_read_b32 v116, v2 offset:2184
ds_read_b32 v117, v2 offset:2200
ds_read_b32 v118, v2 offset:2248
ds_read_b32 v119, v2 offset:2264
s_waitcnt lgkmcnt(8)
v_mfma_f32_32x32x16_bf16 v[64:79], v[108:111], a[108:111], v[64:79]
buffer_load_dwordx4 a[56:59], v1, s[8:11], s25 offen offset:2048 sc1
buffer_load_dwordx4 a[60:63], v1, s[8:11], s25 offen offset:3072 sc1
s_waitcnt vmcnt(17)
ds_read_b32 v120, v2 offset:3080
ds_read_b32 v121, v2 offset:3096
ds_read_b32 v122, v2 offset:3144
ds_read_b32 v123, v2 offset:3160
s_waitcnt lgkmcnt(8)
v_mfma_f32_32x32x16_bf16 v[64:79], v[112:115], a[112:115], v[64:79]
s_add_u32 s25, s46, 8192
buffer_load_dwordx4 a[64:67], v1, s[8:11], s25 offen sc1
buffer_load_dwordx4 a[68:71], v1, s[8:11], s25 offen offset:1024 sc1
ds_read_b32 v124, v2 offset:3208
ds_read_b32 v125, v2 offset:3224
ds_read_b32 v126, v2 offset:3272
ds_read_b32 v127, v2 offset:3288
s_waitcnt lgkmcnt(8)
v_mfma_f32_32x32x16_bf16 v[64:79], v[116:119], a[116:119], v[64:79]
buffer_load_dwordx4 a[72:75], v1, s[8:11], s25 offen offset:2048 sc1
buffer_load_dwordx4 a[76:79], v1, s[8:11], s25 offen offset:3072 sc1
ds_read_b32 v8, v3
ds_read_b32 v9, v3 offset:256
ds_read_b32 v10, v3 offset:1024
ds_read_b32 v11, v3 offset:1280
s_waitcnt lgkmcnt(8)
v_mfma_f32_32x32x16_bf16 v[64:79], v[120:123], a[120:123], v[64:79]
s_add_u32 s25, s46, 12288
buffer_load_dwordx4 a[80:83], v1, s[8:11], s25 offen sc1
buffer_load_dwordx4 a[84:87], v1, s[8:11], s25 offen offset:1024 sc1
ds_read_b32 v12, v3 offset:2048
ds_read_b32 v13, v3 offset:2304
ds_read_b32 v14, v3 offset:3072
ds_read_b32 v15, v3 offset:3328
s_waitcnt lgkmcnt(8)
v_mfma_f32_32x32x16_bf16 v[64:79], v[124:127], a[124:127], v[64:79]
buffer_load_dwordx4 a[88:91], v1, s[8:11], s25 offen offset:2048 sc1
buffer_load_dwordx4 a[92:95], v1, s[8:11], s25 offen offset:3072 sc1
L_kj_41:
s_nop 10
v_max3_f32 v20, v20, v64, v65
v_max3_f32 v20, v20, v66, v67
v_mov_b32 v26, v20
s_nop 1
v_permlane32_swap_b32 v26, v20
v_max_f32 v20, v20, v26
v_mul_f32 v20, s40, v20
v_pk_fma_f32 v[64:65], v[64:65], s[40:41], v[20:21] op_sel_hi:[1,0,0] neg_lo:[0,0,1] neg_hi:[0,0,1]
v_pk_fma_f32 v[66:67], v[66:67], s[40:41], v[20:21] op_sel_hi:[1,0,0] neg_lo:[0,0,1] neg_hi:[0,0,1]
v_pk_fma_f32 v[32:33], v[32:33], s[40:41], v[20:21] op_sel_hi:[1,0,0] neg_lo:[0,0,1] neg_hi:[0,0,1]
v_pk_fma_f32 v[34:35], v[34:35], s[40:41], v[20:21] op_sel_hi:[1,0,0] neg_lo:[0,0,1] neg_hi:[0,0,1]
v_pk_fma_f32 v[36:37], v[36:37], s[40:41], v[20:21] op_sel_hi:[1,0,0] neg_lo:[0,0,1] neg_hi:[0,0,1]
v_pk_fma_f32 v[38:39], v[38:39], s[40:41], v[20:21] op_sel_hi:[1,0,0] neg_lo:[0,0,1] neg_hi:[0,0,1]
v_pk_fma_f32 v[40:41], v[40:41], s[40:41], v[20:21] op_sel_hi:[1,0,0] neg_lo:[0,0,1] neg_hi:[0,0,1]
v_pk_fma_f32 v[42:43], v[42:43], s[40:41], v[20:21] op_sel_hi:[1,0,0] neg_lo:[0,0,1] neg_hi:[0,0,1]
v_pk_fma_f32 v[44:45], v[44:45], s[40:41], v[20:21] op_sel_hi:[1,0,0] neg_lo:[0,0,1] neg_hi:[0,0,1]
v_pk_fma_f32 v[46:47], v[46:47], s[40:41], v[20:21] op_sel_hi:[1,0,0] neg_lo:[0,0,1] neg_hi:[0,0,1]
v_exp_f32 v64, v64
v_exp_f32 v65, v65
v_exp_f32 v66, v66
v_exp_f32 v67, v67
v_exp_f32 v32, v32
v_exp_f32 v33, v33
v_cvt_pk_bf16_f32 v88, v64, v65
v_cvt_pk_bf16_f32 v89, v66, v67
s_waitcnt lgkmcnt(0)
s_nop 0
v_mfma_f32_32x32x8_bf16 v[128:143], v[8:9], v[88:89], 0
v_exp_f32 v34, v34
v_exp_f32 v35, v35
v_exp_f32 v36, v36
v_mfma_f32_32x32x8_bf16 v[160:175], v[10:11], v[88:89], 0
v_exp_f32 v37, v37
v_exp_f32 v38, v38
v_mfma_f32_32x32x8_bf16 v[192:207], v[12:13], v[88:89], 0
v_exp_f32 v39, v39
v_exp_f32 v40, v40
v_exp_f32 v41, v41
v_mfma_f32_32x32x8_bf16 v[224:239], v[14:15], v[88:89], 0
v_cvt_pk_bf16_f32 v80, v32, v33
v_cvt_pk_bf16_f32 v81, v34, v35
v_cvt_pk_bf16_f32 v82, v36, v37
v_cvt_pk_bf16_f32 v83, v38, v39
s_nop 1
v_mfma_f32_32x32x16_bf16 v[128:143], a[160:163], v[80:83], v[128:143]
v_exp_f32 v42, v42
v_exp_f32 v43, v43
v_exp_f32 v44, v44
v_mfma_f32_32x32x16_bf16 v[160:175], a[168:171], v[80:83], v[160:175]
v_exp_f32 v45, v45
v_exp_f32 v46, v46
v_mfma_f32_32x32x16_bf16 v[192:207], a[176:179], v[80:83], v[192:207]
v_exp_f32 v47, v47
v_add_f32 v22, v64, v65
v_add_f32 v22, v22, v66
v_add_f32 v22, v22, v67
v_add_f32 v22, v22, v32
v_mfma_f32_32x32x16_bf16 v[224:239], a[184:187], v[80:83], v[224:239]
v_add_f32 v22, v22, v33
v_cvt_pk_bf16_f32 v84, v40, v41
v_cvt_pk_bf16_f32 v85, v42, v43
v_cvt_pk_bf16_f32 v86, v44, v45
v_cvt_pk_bf16_f32 v87, v46, v47
s_nop 1
v_mfma_f32_32x32x16_bf16 v[128:143], a[164:167], v[84:87], v[128:143]
v_add_f32 v22, v22, v34
v_add_f32 v22, v22, v35
v_add_f32 v22, v22, v36
v_add_f32 v22, v22, v37
v_add_f32 v22, v22, v38
v_mfma_f32_32x32x16_bf16 v[160:175], a[172:175], v[84:87], v[160:175]
v_add_f32 v22, v22, v39
v_add_f32 v22, v22, v40
v_add_f32 v22, v22, v41
v_add_f32 v22, v22, v42
v_mfma_f32_32x32x16_bf16 v[192:207], a[180:183], v[84:87], v[192:207]
v_add_f32 v22, v22, v43
v_add_f32 v22, v22, v44
v_add_f32 v22, v22, v45
v_add_f32 v22, v22, v46
v_add_f32 v22, v22, v47
v_mfma_f32_32x32x16_bf16 v[224:239], a[188:191], v[84:87], v[224:239]
s_lshl_b32 s26, s43, 18
s_lshl_b32 s27, s42, 12
s_add_u32 s26, s26, s27
s_add_u32 s26, s26, 83886080
v_mov_b32 v26, v22
s_nop 1
v_permlane32_swap_b32 v26, v22
v_add_f32 v26, v26, v22
v_rcp_f32 v26, v26
s_nop 0
v_pk_mul_f32 v[128:129], v[128:129], v[26:27] op_sel_hi:[1,0]
v_pk_mul_f32 v[130:131], v[130:131], v[26:27] op_sel_hi:[1,0]
v_pk_mul_f32 v[132:133], v[132:133], v[26:27] op_sel_hi:[1,0]
v_pk_mul_f32 v[134:135], v[134:135], v[26:27] op_sel_hi:[1,0]
v_pk_mul_f32 v[136:137], v[136:137], v[26:27] op_sel_hi:[1,0]
v_pk_mul_f32 v[138:139], v[138:139], v[26:27] op_sel_hi:[1,0]
v_pk_mul_f32 v[140:141], v[140:141], v[26:27] op_sel_hi:[1,0]
v_pk_mul_f32 v[142:143], v[142:143], v[26:27] op_sel_hi:[1,0]
v_cvt_pk_bf16_f32 v128, v128, v129
v_cvt_pk_bf16_f32 v129, v130, v131
v_cvt_pk_bf16_f32 v130, v132, v133
v_cvt_pk_bf16_f32 v131, v134, v135
buffer_store_dwordx4 v[128:131], v6, s[8:11], s26 offen
v_cvt_pk_bf16_f32 v136, v136, v137
v_cvt_pk_bf16_f32 v137, v138, v139
v_cvt_pk_bf16_f32 v138, v140, v141
v_cvt_pk_bf16_f32 v139, v142, v143
buffer_store_dwordx4 v[136:139], v6, s[8:11], s26 offen offset:512
v_pk_mul_f32 v[160:161], v[160:161], v[26:27] op_sel_hi:[1,0]
v_pk_mul_f32 v[162:163], v[162:163], v[26:27] op_sel_hi:[1,0]
v_pk_mul_f32 v[164:165], v[164:165], v[26:27] op_sel_hi:[1,0]
v_pk_mul_f32 v[166:167], v[166:167], v[26:27] op_sel_hi:[1,0]
v_pk_mul_f32 v[168:169], v[168:169], v[26:27] op_sel_hi:[1,0]
v_pk_mul_f32 v[170:171], v[170:171], v[26:27] op_sel_hi:[1,0]
v_pk_mul_f32 v[172:173], v[172:173], v[26:27] op_sel_hi:[1,0]
v_pk_mul_f32 v[174:175], v[174:175], v[26:27] op_sel_hi:[1,0]
v_cvt_pk_bf16_f32 v160, v160, v161
v_cvt_pk_bf16_f32 v161, v162, v163
v_cvt_pk_bf16_f32 v162, v164, v165
v_cvt_pk_bf16_f32 v163, v166, v167
buffer_store_dwordx4 v[160:163], v6, s[8:11], s26 offen offset:1024
v_cvt_pk_bf16_f32 v168, v168, v169
v_cvt_pk_bf16_f32 v169, v170, v171
v_cvt_pk_bf16_f32 v170, v172, v173
v_cvt_pk_bf16_f32 v171, v174, v175
buffer_store_dwordx4 v[168:171], v6, s[8:11], s26 offen offset:1536
v_pk_mul_f32 v[192:193], v[192:193], v[26:27] op_sel_hi:[1,0]
v_pk_mul_f32 v[194:195], v[194:195], v[26:27] op_sel_hi:[1,0]
v_pk_mul_f32 v[196:197], v[196:197], v[26:27] op_sel_hi:[1,0]
v_pk_mul_f32 v[198:199], v[198:199], v[26:27] op_sel_hi:[1,0]
v_pk_mul_f32 v[200:201], v[200:201], v[26:27] op_sel_hi:[1,0]
v_pk_mul_f32 v[202:203], v[202:203], v[26:27] op_sel_hi:[1,0]
v_pk_mul_f32 v[204:205], v[204:205], v[26:27] op_sel_hi:[1,0]
v_pk_mul_f32 v[206:207], v[206:207], v[26:27] op_sel_hi:[1,0]
v_cvt_pk_bf16_f32 v192, v192, v193
v_cvt_pk_bf16_f32 v193, v194, v195
v_cvt_pk_bf16_f32 v194, v196, v197
v_cvt_pk_bf16_f32 v195, v198, v199
buffer_store_dwordx4 v[192:195], v6, s[8:11], s26 offen offset:2048
v_cvt_pk_bf16_f32 v200, v200, v201
v_cvt_pk_bf16_f32 v201, v202, v203
v_cvt_pk_bf16_f32 v202, v204, v205
v_cvt_pk_bf16_f32 v203, v206, v207
buffer_store_dwordx4 v[200:203], v6, s[8:11], s26 offen offset:2560
v_pk_mul_f32 v[224:225], v[224:225], v[26:27] op_sel_hi:[1,0]
v_pk_mul_f32 v[226:227], v[226:227], v[26:27] op_sel_hi:[1,0]
v_pk_mul_f32 v[228:229], v[228:229], v[26:27] op_sel_hi:[1,0]
v_pk_mul_f32 v[230:231], v[230:231], v[26:27] op_sel_hi:[1,0]
v_pk_mul_f32 v[232:233], v[232:233], v[26:27] op_sel_hi:[1,0]
v_pk_mul_f32 v[234:235], v[234:235], v[26:27] op_sel_hi:[1,0]
v_pk_mul_f32 v[236:237], v[236:237], v[26:27] op_sel_hi:[1,0]
v_pk_mul_f32 v[238:239], v[238:239], v[26:27] op_sel_hi:[1,0]
v_cvt_pk_bf16_f32 v224, v224, v225
v_cvt_pk_bf16_f32 v225, v226, v227
v_cvt_pk_bf16_f32 v226, v228, v229
v_cvt_pk_bf16_f32 v227, v230, v231
buffer_store_dwordx4 v[224:227], v6, s[8:11], s26 offen offset:3072
v_cvt_pk_bf16_f32 v232, v232, v233
v_cvt_pk_bf16_f32 v233, v234, v235
v_cvt_pk_bf16_f32 v234, v236, v237
v_cvt_pk_bf16_f32 v235, v238, v239
buffer_store_dwordx4 v[232:235], v6, s[8:11], s26 offen offset:3584
s_lshl_b32 s54, s47, 2
s_add_u32 s54, s54, 111157248
s_bitcmp1_b64 s[30:31], s43
s_cselect_b32 s60, s54, 536870912
s_cselect_b32 s54, 536870912, s54
s_mov_b32 s47, s48
s_cmp_lt_u32 s47, 2048
s_cbranch_scc1 L_bt
L_bt_f:
v_mov_b32 v26, 1
s_waitcnt vmcnt(0)
s_mov_b64 exec, 1
buffer_store_dword v26, v4, s[8:11], s54 offen
s_mov_b64 exec, -1
L_bt_x:
s_branch L_done
L_bo:
s_andn2_b32 s4, s4, 0x0
s_andn2_b32 s5, s5, 0x0
L_bo2:
s_mov_b64 s[42:43], s[4:5]
s_mov_b32 s51, s27
s_mov_b32 s40, s26
s_mov_b32 s44, 83886080
s_mov_b32 s45, 111157248
s_mov_b32 s46, 1
s_mov_b32 s47, 1152
s_lshl_b32 s54, s3, 7
s_add_u32 s54, s54, 111171584
s_lshl2_add_u32 s24, s16, s17
s_cmp_eq_u32 s24, 4
s_cselect_b32 s54, s54, 536870912
s_load_dwordx2 s[4:5], s[0:1], 88
s_waitcnt lgkmcnt(0)
s_mov_b32 s20, s4
s_and_b32 s21, s5, 0xffff
s_mov_b32 s22, 4718592
s_mov_b32 s23, 0x20000
L_op:
s_load_dwordx2 s[4:5], s[0:1], 104
s_waitcnt lgkmcnt(0)
s_mov_b32 s12, s4
s_and_b32 s13, s5, 0xffff
s_mov_b32 s14, 4718592
s_mov_b32 s15, 0x20000
v_and_b32 v1, 63, v0
v_lshlrev_b32 v1, 4, v1
v_bfe_u32 v12, v0, 3, 3
v_bfe_u32 v13, v0, 5, 1
v_lshl_add_u32 v13, v13, 3, v12
v_mul_u32_u24 v13, s47, v13
v_mul_u32_u24 v12, 1152, v12
v_add_u32 v12, v12, v13
s_mul_i32 s50, s47, 15
s_sub_u32 s50, 18432, s50
v_bfe_u32 v13, v0, 4, 2
v_lshlrev_b32 v13, 1, v13
v_and_b32 v14, 7, v0
v_xor_b32 v13, v13, v14
v_lshl_add_u32 v12, v13, 4, v12
s_mul_i32 s24, s17, 1179648
s_lshl_b32 s25, s40, 7
s_add_u32 s24, s24, s25
v_add_u32 v2, s24, v12
s_lshl_b32 s26, s17, 15
v_bfe_u32 v12, v0, 2, 3
v_lshlrev_b32 v12, 7, v12
v_bfe_u32 v13, v0, 5, 1
v_lshl_add_u32 v12, v13, 11, v12
v_bfe_u32 v13, v0, 3, 2
v_lshl_add_u32 v12, v13, 5, v12
v_and_b32 v13, 3, v0
v_lshl_add_u32 v12, v13, 3, v12
v_add_u32 v8, s26, v12
v_xor_b32 v9, 32, v8
v_xor_b32 v10, 64, v8
v_xor_b32 v11, 96, v8
s_add_u32 s24, s40, 0
s_and_b32 s24, s24, 7
s_lshl_b32 s30, s24, 12
s_add_u32 s24, s40, 1
s_and_b32 s24, s24, 7
s_lshl_b32 s31, s24, 12
s_add_u32 s24, s40, 2
s_and_b32 s24, s24, 7
s_lshl_b32 s32, s24, 12
s_add_u32 s24, s40, 3
s_and_b32 s24, s24, 7
s_lshl_b32 s33, s24, 12
s_add_u32 s24, s40, 4
s_and_b32 s24, s24, 7
s_lshl_b32 s34, s24, 12
s_add_u32 s24, s40, 5
s_and_b32 s24, s24, 7
s_lshl_b32 s35, s24, 12
s_add_u32 s24, s40, 6
s_and_b32 s24, s24, 7
s_lshl_b32 s36, s24, 12
s_add_u32 s24, s40, 7
s_and_b32 s24, s24, 7
s_lshl_b32 s37, s24, 12
s_mul_i32 s25, s30, 36
s_add_u32 m0, s26, 0
s_add_u32 s24, s25, 0
buffer_load_dwordx4 v2, s[20:23], s24 offen lds
s_add_u32 m0, s26, 1024
s_add_u32 s24, s25, 9216
buffer_load_dwordx4 v2, s[20:23], s24 offen lds
s_add_u32 s25, s25, s50
s_add_u32 m0, s26, 2048
s_add_u32 s24, s25, 0
buffer_load_dwordx4 v2, s[20:23], s24 offen lds
s_add_u32 m0, s26, 3072
s_add_u32 s24, s25, 9216
buffer_load_dwordx4 v2, s[20:23], s24 offen lds
s_mul_i32 s25, s30, 36
s_add_u32 m0, s26, 4096
s_add_u32 s24, s25, 36864
buffer_load_dwordx4 v2, s[20:23], s24 offen lds
s_add_u32 m0, s26, 5120
s_add_u32 s24, s25, 46080
buffer_load_dwordx4 v2, s[20:23], s24 offen lds
s_add_u32 s25, s25, s50
s_add_u32 m0, s26, 6144
s_add_u32 s24, s25, 36864
buffer_load_dwordx4 v2, s[20:23], s24 offen lds
s_add_u32 m0, s26, 7168
s_add_u32 s24, s25, 46080
buffer_load_dwordx4 v2, s[20:23], s24 offen lds
s_mul_i32 s25, s30, 36
s_add_u32 m0, s26, 8192
s_add_u32 s24, s25, 73728
buffer_load_dwordx4 v2, s[20:23], s24 offen lds
s_add_u32 m0, s26, 9216
s_add_u32 s24, s25, 82944
buffer_load_dwordx4 v2, s[20:23], s24 offen lds
s_add_u32 s25, s25, s50
s_add_u32 m0, s26, 10240
s_add_u32 s24, s25, 73728
buffer_load_dwordx4 v2, s[20:23], s24 offen lds
s_add_u32 m0, s26, 11264
s_add_u32 s24, s25, 82944
buffer_load_dwordx4 v2, s[20:23], s24 offen lds
s_mul_i32 s25, s31, 36
s_add_u32 m0, s26, 12288
s_add_u32 s24, s25, 0
buffer_load_dwordx4 v2, s[20:23], s24 offen lds
s_add_u32 m0, s26, 13312
s_add_u32 s24, s25, 9216
buffer_load_dwordx4 v2, s[20:23], s24 offen lds
s_add_u32 s25, s25, s50
s_add_u32 m0, s26, 14336
s_add_u32 s24, s25, 0
buffer_load_dwordx4 v2, s[20:23], s24 offen lds
s_add_u32 m0, s26, 15360
s_add_u32 s24, s25, 9216
buffer_load_dwordx4 v2, s[20:23], s24 offen lds
s_mul_i32 s25, s31, 36
s_add_u32 m0, s26, 16384
s_add_u32 s24, s25, 36864
buffer_load_dwordx4 v2, s[20:23], s24 offen lds
s_add_u32 m0, s26, 17408
s_add_u32 s24, s25, 46080
buffer_load_dwordx4 v2, s[20:23], s24 offen lds
s_add_u32 s25, s25, s50
s_add_u32 m0, s26, 18432
s_add_u32 s24, s25, 36864
buffer_load_dwordx4 v2, s[20:23], s24 offen lds
s_add_u32 m0, s26, 19456
s_add_u32 s24, s25, 46080
buffer_load_dwordx4 v2, s[20:23], s24 offen lds
s_mul_i32 s25, s31, 36
s_add_u32 m0, s26, 20480
s_add_u32 s24, s25, 73728
buffer_load_dwordx4 v2, s[20:23], s24 offen lds
s_add_u32 m0, s26, 21504
s_add_u32 s24, s25, 82944
buffer_load_dwordx4 v2, s[20:23], s24 offen lds
s_add_u32 s25, s25, s50
s_add_u32 m0, s26, 22528
s_add_u32 s24, s25, 73728
buffer_load_dwordx4 v2, s[20:23], s24 offen lds
s_add_u32 m0, s26, 23552
s_add_u32 s24, s25, 82944
buffer_load_dwordx4 v2, s[20:23], s24 offen lds
s_mul_i32 s25, s32, 36
s_add_u32 m0, s26, 24576
s_add_u32 s24, s25, 0
buffer_load_dwordx4 v2, s[20:23], s24 offen lds
s_add_u32 m0, s26, 25600
s_add_u32 s24, s25, 9216
buffer_load_dwordx4 v2, s[20:23], s24 offen lds
s_add_u32 s25, s25, s50
s_add_u32 m0, s26, 26624
s_add_u32 s24, s25, 0
buffer_load_dwordx4 v2, s[20:23], s24 offen lds
s_add_u32 m0, s26, 27648
s_add_u32 s24, s25, 9216
buffer_load_dwordx4 v2, s[20:23], s24 offen lds
s_mul_i32 s25, s32, 36
s_add_u32 m0, s26, 28672
s_add_u32 s24, s25, 36864
buffer_load_dwordx4 v2, s[20:23], s24 offen lds
s_add_u32 m0, s26, 29696
s_add_u32 s24, s25, 46080
buffer_load_dwordx4 v2, s[20:23], s24 offen lds
s_add_u32 s25, s25, s50
s_add_u32 m0, s26, 30720
s_add_u32 s24, s25, 36864
buffer_load_dwordx4 v2, s[20:23], s24 offen lds
s_add_u32 m0, s26, 31744
s_add_u32 s24, s25, 46080
buffer_load_dwordx4 v2, s[20:23], s24 offen lds
s_waitcnt vmcnt(28)
ds_read_b64_tr_b16 v[128:129], v8
ds_read_b64_tr_b16 v[130:131], v8 offset:1024
ds_read_b64_tr_b16 v[132:133], v9
ds_read_b64_tr_b16 v[134:135], v9 offset:1024
ds_read_b64_tr_b16 v[136:137], v10
ds_read_b64_tr_b16 v[138:139], v10 offset:1024
ds_read_b64_tr_b16 v[140:141], v11
ds_read_b64_tr_b16 v[142:143], v11 offset:1024
s_waitcnt lgkmcnt(0)
s_mul_i32 s25, s32, 36
s_add_u32 m0, s26, 0
s_add_u32 s24, s25, 73728
buffer_load_dwordx4 v2, s[20:23], s24 offen lds
s_add_u32 m0, s26, 1024
s_add_u32 s24, s25, 82944
buffer_load_dwordx4 v2, s[20:23], s24 offen lds
s_add_u32 s25, s25, s50
s_add_u32 m0, s26, 2048
s_add_u32 s24, s25, 73728
buffer_load_dwordx4 v2, s[20:23], s24 offen lds
s_add_u32 m0, s26, 3072
s_add_u32 s24, s25, 82944
buffer_load_dwordx4 v2, s[20:23], s24 offen lds
s_waitcnt vmcnt(28)
ds_read_b64_tr_b16 v[144:145], v8 offset:4096
ds_read_b64_tr_b16 v[146:147], v8 offset:5120
ds_read_b64_tr_b16 v[148:149], v9 offset:4096
ds_read_b64_tr_b16 v[150:151], v9 offset:5120
ds_read_b64_tr_b16 v[152:153], v10 offset:4096
ds_read_b64_tr_b16 v[154:155], v10 offset:5120
ds_read_b64_tr_b16 v[156:157], v11 offset:4096
ds_read_b64_tr_b16 v[158:159], v11 offset:5120
s_waitcnt lgkmcnt(0)
s_mul_i32 s25, s33, 36
s_add_u32 m0, s26, 4096
s_add_u32 s24, s25, 0
buffer_load_dwordx4 v2, s[20:23], s24 offen lds
s_add_u32 m0, s26, 5120
s_add_u32 s24, s25, 9216
buffer_load_dwordx4 v2, s[20:23], s24 offen lds
s_add_u32 s25, s25, s50
s_add_u32 m0, s26, 6144
s_add_u32 s24, s25, 0
buffer_load_dwordx4 v2, s[20:23], s24 offen lds
s_add_u32 m0, s26, 7168
s_add_u32 s24, s25, 9216
buffer_load_dwordx4 v2, s[20:23], s24 offen lds
s_waitcnt vmcnt(28)
ds_read_b64_tr_b16 v[160:161], v8 offset:8192
ds_read_b64_tr_b16 v[162:163], v8 offset:9216
ds_read_b64_tr_b16 v[164:165], v9 offset:8192
ds_read_b64_tr_b16 v[166:167], v9 offset:9216
ds_read_b64_tr_b16 v[168:169], v10 offset:8192
ds_read_b64_tr_b16 v[170:171], v10 offset:9216
ds_read_b64_tr_b16 v[172:173], v11 offset:8192
ds_read_b64_tr_b16 v[174:175], v11 offset:9216
s_waitcnt lgkmcnt(0)
s_mul_i32 s25, s33, 36
s_add_u32 m0, s26, 8192
s_add_u32 s24, s25, 36864
buffer_load_dwordx4 v2, s[20:23], s24 offen lds
s_add_u32 m0, s26, 9216
s_add_u32 s24, s25, 46080
buffer_load_dwordx4 v2, s[20:23], s24 offen lds
s_add_u32 s25, s25, s50
s_add_u32 m0, s26, 10240
s_add_u32 s24, s25, 36864
buffer_load_dwordx4 v2, s[20:23], s24 offen lds
s_add_u32 m0, s26, 11264
s_add_u32 s24, s25, 46080
buffer_load_dwordx4 v2, s[20:23], s24 offen lds
s_waitcnt vmcnt(28)
ds_read_b64_tr_b16 v[176:177], v8 offset:12288
ds_read_b64_tr_b16 v[178:179], v8 offset:13312
ds_read_b64_tr_b16 v[180:181], v9 offset:12288
ds_read_b64_tr_b16 v[182:183], v9 offset:13312
ds_read_b64_tr_b16 v[184:185], v10 offset:12288
ds_read_b64_tr_b16 v[186:187], v10 offset:13312
ds_read_b64_tr_b16 v[188:189], v11 offset:12288
ds_read_b64_tr_b16 v[190:191], v11 offset:13312
s_waitcnt lgkmcnt(0)
s_mul_i32 s25, s33, 36
s_add_u32 m0, s26, 12288
s_add_u32 s24, s25, 73728
buffer_load_dwordx4 v2, s[20:23], s24 offen lds
s_add_u32 m0, s26, 13312
s_add_u32 s24, s25, 82944
buffer_load_dwordx4 v2, s[20:23], s24 offen lds
s_add_u32 s25, s25, s50
s_add_u32 m0, s26, 14336
s_add_u32 s24, s25, 73728
buffer_load_dwordx4 v2, s[20:23], s24 offen lds
s_add_u32 m0, s26, 15360
s_add_u32 s24, s25, 82944
buffer_load_dwordx4 v2, s[20:23], s24 offen lds
s_waitcnt vmcnt(28)
ds_read_b64_tr_b16 v[192:193], v8 offset:16384
ds_read_b64_tr_b16 v[194:195], v8 offset:17408
ds_read_b64_tr_b16 v[196:197], v9 offset:16384
ds_read_b64_tr_b16 v[198:199], v9 offset:17408
ds_read_b64_tr_b16 v[200:201], v10 offset:16384
ds_read_b64_tr_b16 v[202:203], v10 offset:17408
ds_read_b64_tr_b16 v[204:205], v11 offset:16384
ds_read_b64_tr_b16 v[206:207], v11 offset:17408
s_waitcnt lgkmcnt(0)
s_mul_i32 s25, s34, 36
s_add_u32 m0, s26, 16384
s_add_u32 s24, s25, 0
buffer_load_dwordx4 v2, s[20:23], s24 offen lds
s_add_u32 m0, s26, 17408
s_add_u32 s24, s25, 9216
buffer_load_dwordx4 v2, s[20:23], s24 offen lds
s_add_u32 s25, s25, s50
s_add_u32 m0, s26, 18432
s_add_u32 s24, s25, 0
buffer_load_dwordx4 v2, s[20:23], s24 offen lds
s_add_u32 m0, s26, 19456
s_add_u32 s24, s25, 9216
buffer_load_dwordx4 v2, s[20:23], s24 offen lds
s_waitcnt vmcnt(28)
ds_read_b64_tr_b16 v[208:209], v8 offset:20480
ds_read_b64_tr_b16 v[210:211], v8 offset:21504
ds_read_b64_tr_b16 v[212:213], v9 offset:20480
ds_read_b64_tr_b16 v[214:215], v9 offset:21504
ds_read_b64_tr_b16 v[216:217], v10 offset:20480
ds_read_b64_tr_b16 v[218:219], v10 offset:21504
ds_read_b64_tr_b16 v[220:221], v11 offset:20480
ds_read_b64_tr_b16 v[222:223], v11 offset:21504
s_waitcnt lgkmcnt(0)
s_mul_i32 s25, s34, 36
s_add_u32 m0, s26, 20480
s_add_u32 s24, s25, 36864
buffer_load_dwordx4 v2, s[20:23], s24 offen lds
s_add_u32 m0, s26, 21504
s_add_u32 s24, s25, 46080
buffer_load_dwordx4 v2, s[20:23], s24 offen lds
s_add_u32 s25, s25, s50
s_add_u32 m0, s26, 22528
s_add_u32 s24, s25, 36864
buffer_load_dwordx4 v2, s[20:23], s24 offen lds
s_add_u32 m0, s26, 23552
s_add_u32 s24, s25, 46080
buffer_load_dwordx4 v2, s[20:23], s24 offen lds
s_waitcnt vmcnt(28)
ds_read_b64_tr_b16 v[224:225], v8 offset:24576
ds_read_b64_tr_b16 v[226:227], v8 offset:25600
ds_read_b64_tr_b16 v[228:229], v9 offset:24576
ds_read_b64_tr_b16 v[230:231], v9 offset:25600
ds_read_b64_tr_b16 v[232:233], v10 offset:24576
ds_read_b64_tr_b16 v[234:235], v10 offset:25600
ds_read_b64_tr_b16 v[236:237], v11 offset:24576
ds_read_b64_tr_b16 v[238:239], v11 offset:25600
s_waitcnt lgkmcnt(0)
s_mul_i32 s25, s34, 36
s_add_u32 m0, s26, 24576
s_add_u32 s24, s25, 73728
buffer_load_dwordx4 v2, s[20:23], s24 offen lds
s_add_u32 m0, s26, 25600
s_add_u32 s24, s25, 82944
buffer_load_dwordx4 v2, s[20:23], s24 offen lds
s_add_u32 s25, s25, s50
s_add_u32 m0, s26, 26624
s_add_u32 s24, s25, 73728
buffer_load_dwordx4 v2, s[20:23], s24 offen lds
s_add_u32 m0, s26, 27648
s_add_u32 s24, s25, 82944
buffer_load_dwordx4 v2, s[20:23], s24 offen lds
s_waitcnt vmcnt(28)
ds_read_b64_tr_b16 v[240:241], v8 offset:28672
ds_read_b64_tr_b16 v[242:243], v8 offset:29696
ds_read_b64_tr_b16 v[244:245], v9 offset:28672
ds_read_b64_tr_b16 v[246:247], v9 offset:29696
ds_read_b64_tr_b16 v[248:249], v10 offset:28672
ds_read_b64_tr_b16 v[250:251], v10 offset:29696
ds_read_b64_tr_b16 v[252:253], v11 offset:28672
ds_read_b64_tr_b16 v[254:255], v11 offset:29696
s_waitcnt lgkmcnt(0)
s_mul_i32 s25, s35, 36
s_add_u32 m0, s26, 28672
s_add_u32 s24, s25, 0
buffer_load_dwordx4 v2, s[20:23], s24 offen lds
s_add_u32 m0, s26, 29696
s_add_u32 s24, s25, 9216
buffer_load_dwordx4 v2, s[20:23], s24 offen lds
s_add_u32 s25, s25, s50
s_add_u32 m0, s26, 30720
s_add_u32 s24, s25, 0
buffer_load_dwordx4 v2, s[20:23], s24 offen lds
s_add_u32 m0, s26, 31744
s_add_u32 s24, s25, 9216
buffer_load_dwordx4 v2, s[20:23], s24 offen lds
s_waitcnt vmcnt(28)
ds_read_b64_tr_b16 a[0:1], v8
ds_read_b64_tr_b16 a[2:3], v8 offset:1024
ds_read_b64_tr_b16 a[4:5], v9
ds_read_b64_tr_b16 a[6:7], v9 offset:1024
ds_read_b64_tr_b16 a[8:9], v10
ds_read_b64_tr_b16 a[10:11], v10 offset:1024
ds_read_b64_tr_b16 a[12:13], v11
ds_read_b64_tr_b16 a[14:15], v11 offset:1024
s_waitcnt lgkmcnt(0)
s_mul_i32 s25, s35, 36
s_add_u32 m0, s26, 0
s_add_u32 s24, s25, 36864
buffer_load_dwordx4 v2, s[20:23], s24 offen lds
s_add_u32 m0, s26, 1024
s_add_u32 s24, s25, 46080
buffer_load_dwordx4 v2, s[20:23], s24 offen lds
s_add_u32 s25, s25, s50
s_add_u32 m0, s26, 2048
s_add_u32 s24, s25, 36864
buffer_load_dwordx4 v2, s[20:23], s24 offen lds
s_add_u32 m0, s26, 3072
s_add_u32 s24, s25, 46080
buffer_load_dwordx4 v2, s[20:23], s24 offen lds
s_waitcnt vmcnt(28)
ds_read_b64_tr_b16 a[16:17], v8 offset:4096
ds_read_b64_tr_b16 a[18:19], v8 offset:5120
ds_read_b64_tr_b16 a[20:21], v9 offset:4096
ds_read_b64_tr_b16 a[22:23], v9 offset:5120
ds_read_b64_tr_b16 a[24:25], v10 offset:4096
ds_read_b64_tr_b16 a[26:27], v10 offset:5120
ds_read_b64_tr_b16 a[28:29], v11 offset:4096
ds_read_b64_tr_b16 a[30:31], v11 offset:5120
s_waitcnt lgkmcnt(0)
s_mul_i32 s25, s35, 36
s_add_u32 m0, s26, 4096
s_add_u32 s24, s25, 73728
buffer_load_dwordx4 v2, s[20:23], s24 offen lds
s_add_u32 m0, s26, 5120
s_add_u32 s24, s25, 82944
buffer_load_dwordx4 v2, s[20:23], s24 offen lds
s_add_u32 s25, s25, s50
s_add_u32 m0, s26, 6144
s_add_u32 s24, s25, 73728
buffer_load_dwordx4 v2, s[20:23], s24 offen lds
s_add_u32 m0, s26, 7168
s_add_u32 s24, s25, 82944
buffer_load_dwordx4 v2, s[20:23], s24 offen lds
s_waitcnt vmcnt(28)
ds_read_b64_tr_b16 a[32:33], v8 offset:8192
ds_read_b64_tr_b16 a[34:35], v8 offset:9216
ds_read_b64_tr_b16 a[36:37], v9 offset:8192
ds_read_b64_tr_b16 a[38:39], v9 offset:9216
ds_read_b64_tr_b16 a[40:41], v10 offset:8192
ds_read_b64_tr_b16 a[42:43], v10 offset:9216
ds_read_b64_tr_b16 a[44:45], v11 offset:8192
ds_read_b64_tr_b16 a[46:47], v11 offset:9216
s_waitcnt lgkmcnt(0)
s_mul_i32 s25, s36, 36
s_add_u32 m0, s26, 8192
s_add_u32 s24, s25, 0
buffer_load_dwordx4 v2, s[20:23], s24 offen lds
s_add_u32 m0, s26, 9216
s_add_u32 s24, s25, 9216
buffer_load_dwordx4 v2, s[20:23], s24 offen lds
s_add_u32 s25, s25, s50
s_add_u32 m0, s26, 10240
s_add_u32 s24, s25, 0
buffer_load_dwordx4 v2, s[20:23], s24 offen lds
s_add_u32 m0, s26, 11264
s_add_u32 s24, s25, 9216
buffer_load_dwordx4 v2, s[20:23], s24 offen lds
s_waitcnt vmcnt(28)
ds_read_b64_tr_b16 a[48:49], v8 offset:12288
ds_read_b64_tr_b16 a[50:51], v8 offset:13312
ds_read_b64_tr_b16 a[52:53], v9 offset:12288
ds_read_b64_tr_b16 a[54:55], v9 offset:13312
ds_read_b64_tr_b16 a[56:57], v10 offset:12288
ds_read_b64_tr_b16 a[58:59], v10 offset:13312
ds_read_b64_tr_b16 a[60:61], v11 offset:12288
ds_read_b64_tr_b16 a[62:63], v11 offset:13312
s_waitcnt lgkmcnt(0)
s_mul_i32 s25, s36, 36
s_add_u32 m0, s26, 12288
s_add_u32 s24, s25, 36864
buffer_load_dwordx4 v2, s[20:23], s24 offen lds
s_add_u32 m0, s26, 13312
s_add_u32 s24, s25, 46080
buffer_load_dwordx4 v2, s[20:23], s24 offen lds
s_add_u32 s25, s25, s50
s_add_u32 m0, s26, 14336
s_add_u32 s24, s25, 36864
buffer_load_dwordx4 v2, s[20:23], s24 offen lds
s_add_u32 m0, s26, 15360
s_add_u32 s24, s25, 46080
buffer_load_dwordx4 v2, s[20:23], s24 offen lds
s_waitcnt vmcnt(28)
ds_read_b64_tr_b16 a[64:65], v8 offset:16384
ds_read_b64_tr_b16 a[66:67], v8 offset:17408
ds_read_b64_tr_b16 a[68:69], v9 offset:16384
ds_read_b64_tr_b16 a[70:71], v9 offset:17408
ds_read_b64_tr_b16 a[72:73], v10 offset:16384
ds_read_b64_tr_b16 a[74:75], v10 offset:17408
ds_read_b64_tr_b16 a[76:77], v11 offset:16384
ds_read_b64_tr_b16 a[78:79], v11 offset:17408
s_waitcnt lgkmcnt(0)
s_mul_i32 s25, s36, 36
s_add_u32 m0, s26, 16384
s_add_u32 s24, s25, 73728
buffer_load_dwordx4 v2, s[20:23], s24 offen lds
s_add_u32 m0, s26, 17408
s_add_u32 s24, s25, 82944
buffer_load_dwordx4 v2, s[20:23], s24 offen lds
s_add_u32 s25, s25, s50
s_add_u32 m0, s26, 18432
s_add_u32 s24, s25, 73728
buffer_load_dwordx4 v2, s[20:23], s24 offen lds
s_add_u32 m0, s26, 19456
s_add_u32 s24, s25, 82944
buffer_load_dwordx4 v2, s[20:23], s24 offen lds
s_waitcnt vmcnt(28)
ds_read_b64_tr_b16 a[80:81], v8 offset:20480
ds_read_b64_tr_b16 a[82:83], v8 offset:21504
ds_read_b64_tr_b16 a[84:85], v9 offset:20480
ds_read_b64_tr_b16 a[86:87], v9 offset:21504
ds_read_b64_tr_b16 a[88:89], v10 offset:20480
ds_read_b64_tr_b16 a[90:91], v10 offset:21504
ds_read_b64_tr_b16 a[92:93], v11 offset:20480
ds_read_b64_tr_b16 a[94:95], v11 offset:21504
s_waitcnt lgkmcnt(0)
s_mul_i32 s25, s37, 36
s_add_u32 m0, s26, 20480
s_add_u32 s24, s25, 0
buffer_load_dwordx4 v2, s[20:23], s24 offen lds
s_add_u32 m0, s26, 21504
s_add_u32 s24, s25, 9216
buffer_load_dwordx4 v2, s[20:23], s24 offen lds
s_add_u32 s25, s25, s50
s_add_u32 m0, s26, 22528
s_add_u32 s24, s25, 0
buffer_load_dwordx4 v2, s[20:23], s24 offen lds
s_add_u32 m0, s26, 23552
s_add_u32 s24, s25, 9216
buffer_load_dwordx4 v2, s[20:23], s24 offen lds
s_waitcnt vmcnt(28)
ds_read_b64_tr_b16 a[96:97], v8 offset:24576
ds_read_b64_tr_b16 a[98:99], v8 offset:25600
ds_read_b64_tr_b16 a[100:101], v9 offset:24576
ds_read_b64_tr_b16 a[102:103], v9 offset:25600
ds_read_b64_tr_b16 a[104:105], v10 offset:24576
ds_read_b64_tr_b16 a[106:107], v10 offset:25600
ds_read_b64_tr_b16 a[108:109], v11 offset:24576
ds_read_b64_tr_b16 a[110:111], v11 offset:25600
s_waitcnt lgkmcnt(0)
s_mul_i32 s25, s37, 36
s_add_u32 m0, s26, 24576
s_add_u32 s24, s25, 36864
buffer_load_dwordx4 v2, s[20:23], s24 offen lds
s_add_u32 m0, s26, 25600
s_add_u32 s24, s25, 46080
buffer_load_dwordx4 v2, s[20:23], s24 offen lds
s_add_u32 s25, s25, s50
s_add_u32 m0, s26, 26624
s_add_u32 s24, s25, 36864
buffer_load_dwordx4 v2, s[20:23], s24 offen lds
s_add_u32 m0, s26, 27648
s_add_u32 s24, s25, 46080
buffer_load_dwordx4 v2, s[20:23], s24 offen lds
s_waitcnt vmcnt(28)
ds_read_b64_tr_b16 a[112:113], v8 offset:28672
ds_read_b64_tr_b16 a[114:115], v8 offset:29696
ds_read_b64_tr_b16 a[116:117], v9 offset:28672
ds_read_b64_tr_b16 a[118:119], v9 offset:29696
ds_read_b64_tr_b16 a[120:121], v10 offset:28672
ds_read_b64_tr_b16 a[122:123], v10 offset:29696
ds_read_b64_tr_b16 a[124:125], v11 offset:28672
ds_read_b64_tr_b16 a[126:127], v11 offset:29696
s_waitcnt lgkmcnt(0)
s_mul_i32 s25, s37, 36
s_add_u32 m0, s26, 28672
s_add_u32 s24, s25, 73728
buffer_load_dwordx4 v2, s[20:23], s24 offen lds
s_add_u32 m0, s26, 29696
s_add_u32 s24, s25, 82944
buffer_load_dwordx4 v2, s[20:23], s24 offen lds
s_add_u32 s25, s25, s50
s_add_u32 m0, s26, 30720
s_add_u32 s24, s25, 73728
buffer_load_dwordx4 v2, s[20:23], s24 offen lds
s_add_u32 m0, s26, 31744
s_add_u32 s24, s25, 82944
buffer_load_dwordx4 v2, s[20:23], s24 offen lds
s_waitcnt vmcnt(28)
ds_read_b64_tr_b16 a[128:129], v8
ds_read_b64_tr_b16 a[130:131], v8 offset:1024
ds_read_b64_tr_b16 a[132:133], v9
ds_read_b64_tr_b16 a[134:135], v9 offset:1024
ds_read_b64_tr_b16 a[136:137], v10
ds_read_b64_tr_b16 a[138:139], v10 offset:1024
ds_read_b64_tr_b16 a[140:141], v11
ds_read_b64_tr_b16 a[142:143], v11 offset:1024
s_waitcnt lgkmcnt(0)
s_mul_i32 s25, s30, 36
s_add_u32 m0, s26, 0
s_add_u32 s24, s25, 110592
buffer_load_dwordx4 v2, s[20:23], s24 offen lds
s_add_u32 m0, s26, 1024
s_add_u32 s24, s25, 119808
buffer_load_dwordx4 v2, s[20:23], s24 offen lds
s_add_u32 s25, s25, s50
s_add_u32 m0, s26, 2048
s_add_u32 s24, s25, 110592
buffer_load_dwordx4 v2, s[20:23], s24 offen lds
s_add_u32 m0, s26, 3072
s_add_u32 s24, s25, 119808
buffer_load_dwordx4 v2, s[20:23], s24 offen lds
s_waitcnt vmcnt(28)
ds_read_b64_tr_b16 a[144:145], v8 offset:4096
ds_read_b64_tr_b16 a[146:147], v8 offset:5120
ds_read_b64_tr_b16 a[148:149], v9 offset:4096
ds_read_b64_tr_b16 a[150:151], v9 offset:5120
ds_read_b64_tr_b16 a[152:153], v10 offset:4096
ds_read_b64_tr_b16 a[154:155], v10 offset:5120
ds_read_b64_tr_b16 a[156:157], v11 offset:4096
ds_read_b64_tr_b16 a[158:159], v11 offset:5120
s_waitcnt lgkmcnt(0)
s_mul_i32 s25, s31, 36
s_add_u32 m0, s26, 4096
s_add_u32 s24, s25, 110592
buffer_load_dwordx4 v2, s[20:23], s24 offen lds
s_add_u32 m0, s26, 5120
s_add_u32 s24, s25, 119808
buffer_load_dwordx4 v2, s[20:23], s24 offen lds
s_add_u32 s25, s25, s50
s_add_u32 m0, s26, 6144
s_add_u32 s24, s25, 110592
buffer_load_dwordx4 v2, s[20:23], s24 offen lds
s_add_u32 m0, s26, 7168
s_add_u32 s24, s25, 119808
buffer_load_dwordx4 v2, s[20:23], s24 offen lds
s_waitcnt vmcnt(28)
ds_read_b64_tr_b16 a[160:161], v8 offset:8192
ds_read_b64_tr_b16 a[162:163], v8 offset:9216
ds_read_b64_tr_b16 a[164:165], v9 offset:8192
ds_read_b64_tr_b16 a[166:167], v9 offset:9216
ds_read_b64_tr_b16 a[168:169], v10 offset:8192
ds_read_b64_tr_b16 a[170:171], v10 offset:9216
ds_read_b64_tr_b16 a[172:173], v11 offset:8192
ds_read_b64_tr_b16 a[174:175], v11 offset:9216
s_waitcnt lgkmcnt(0)
s_mul_i32 s25, s32, 36
s_add_u32 m0, s26, 8192
s_add_u32 s24, s25, 110592
buffer_load_dwordx4 v2, s[20:23], s24 offen lds
s_add_u32 m0, s26, 9216
s_add_u32 s24, s25, 119808
buffer_load_dwordx4 v2, s[20:23], s24 offen lds
s_add_u32 s25, s25, s50
s_add_u32 m0, s26, 10240
s_add_u32 s24, s25, 110592
buffer_load_dwordx4 v2, s[20:23], s24 offen lds
s_add_u32 m0, s26, 11264
s_add_u32 s24, s25, 119808
buffer_load_dwordx4 v2, s[20:23], s24 offen lds
s_waitcnt vmcnt(28)
ds_read_b64_tr_b16 a[176:177], v8 offset:12288
ds_read_b64_tr_b16 a[178:179], v8 offset:13312
ds_read_b64_tr_b16 a[180:181], v9 offset:12288
ds_read_b64_tr_b16 a[182:183], v9 offset:13312
ds_read_b64_tr_b16 a[184:185], v10 offset:12288
ds_read_b64_tr_b16 a[186:187], v10 offset:13312
ds_read_b64_tr_b16 a[188:189], v11 offset:12288
ds_read_b64_tr_b16 a[190:191], v11 offset:13312
s_waitcnt lgkmcnt(0)
s_mul_i32 s25, s33, 36
s_add_u32 m0, s26, 12288
s_add_u32 s24, s25, 110592
buffer_load_dwordx4 v2, s[20:23], s24 offen lds
s_add_u32 m0, s26, 13312
s_add_u32 s24, s25, 119808
buffer_load_dwordx4 v2, s[20:23], s24 offen lds
s_add_u32 s25, s25, s50
s_add_u32 m0, s26, 14336
s_add_u32 s24, s25, 110592
buffer_load_dwordx4 v2, s[20:23], s24 offen lds
s_add_u32 m0, s26, 15360
s_add_u32 s24, s25, 119808
buffer_load_dwordx4 v2, s[20:23], s24 offen lds
s_waitcnt vmcnt(28)
ds_read_b64_tr_b16 a[192:193], v8 offset:16384
ds_read_b64_tr_b16 a[194:195], v8 offset:17408
ds_read_b64_tr_b16 a[196:197], v9 offset:16384
ds_read_b64_tr_b16 a[198:199], v9 offset:17408
ds_read_b64_tr_b16 a[200:201], v10 offset:16384
ds_read_b64_tr_b16 a[202:203], v10 offset:17408
ds_read_b64_tr_b16 a[204:205], v11 offset:16384
ds_read_b64_tr_b16 a[206:207], v11 offset:17408
s_waitcnt lgkmcnt(0)
s_mul_i32 s25, s34, 36
s_add_u32 m0, s26, 16384
s_add_u32 s24, s25, 110592
buffer_load_dwordx4 v2, s[20:23], s24 offen lds
s_add_u32 m0, s26, 17408
s_add_u32 s24, s25, 119808
buffer_load_dwordx4 v2, s[20:23], s24 offen lds
s_add_u32 s25, s25, s50
s_add_u32 m0, s26, 18432
s_add_u32 s24, s25, 110592
buffer_load_dwordx4 v2, s[20:23], s24 offen lds
s_add_u32 m0, s26, 19456
s_add_u32 s24, s25, 119808
buffer_load_dwordx4 v2, s[20:23], s24 offen lds
s_waitcnt vmcnt(28)
ds_read_b64_tr_b16 a[208:209], v8 offset:20480
ds_read_b64_tr_b16 a[210:211], v8 offset:21504
ds_read_b64_tr_b16 a[212:213], v9 offset:20480
ds_read_b64_tr_b16 a[214:215], v9 offset:21504
ds_read_b64_tr_b16 a[216:217], v10 offset:20480
ds_read_b64_tr_b16 a[218:219], v10 offset:21504
ds_read_b64_tr_b16 a[220:221], v11 offset:20480
ds_read_b64_tr_b16 a[222:223], v11 offset:21504
s_waitcnt lgkmcnt(0)
s_mul_i32 s25, s35, 36
s_add_u32 m0, s26, 20480
s_add_u32 s24, s25, 110592
buffer_load_dwordx4 v2, s[20:23], s24 offen lds
s_add_u32 m0, s26, 21504
s_add_u32 s24, s25, 119808
buffer_load_dwordx4 v2, s[20:23], s24 offen lds
s_add_u32 s25, s25, s50
s_add_u32 m0, s26, 22528
s_add_u32 s24, s25, 110592
buffer_load_dwordx4 v2, s[20:23], s24 offen lds
s_add_u32 m0, s26, 23552
s_add_u32 s24, s25, 119808
buffer_load_dwordx4 v2, s[20:23], s24 offen lds
s_waitcnt vmcnt(28)
ds_read_b64_tr_b16 a[224:225], v8 offset:24576
ds_read_b64_tr_b16 a[226:227], v8 offset:25600
ds_read_b64_tr_b16 a[228:229], v9 offset:24576
ds_read_b64_tr_b16 a[230:231], v9 offset:25600
ds_read_b64_tr_b16 a[232:233], v10 offset:24576
ds_read_b64_tr_b16 a[234:235], v10 offset:25600
ds_read_b64_tr_b16 a[236:237], v11 offset:24576
ds_read_b64_tr_b16 a[238:239], v11 offset:25600
s_waitcnt lgkmcnt(0)
s_mul_i32 s25, s36, 36
s_add_u32 m0, s26, 24576
s_add_u32 s24, s25, 110592
buffer_load_dwordx4 v2, s[20:23], s24 offen lds
s_add_u32 m0, s26, 25600
s_add_u32 s24, s25, 119808
buffer_load_dwordx4 v2, s[20:23], s24 offen lds
s_add_u32 s25, s25, s50
s_add_u32 m0, s26, 26624
s_add_u32 s24, s25, 110592
buffer_load_dwordx4 v2, s[20:23], s24 offen lds
s_add_u32 m0, s26, 27648
s_add_u32 s24, s25, 119808
buffer_load_dwordx4 v2, s[20:23], s24 offen lds
s_waitcnt vmcnt(28)
ds_read_b64_tr_b16 a[240:241], v8 offset:28672
ds_read_b64_tr_b16 a[242:243], v8 offset:29696
ds_read_b64_tr_b16 a[244:245], v9 offset:28672
ds_read_b64_tr_b16 a[246:247], v9 offset:29696
ds_read_b64_tr_b16 a[248:249], v10 offset:28672
ds_read_b64_tr_b16 a[250:251], v10 offset:29696
ds_read_b64_tr_b16 a[252:253], v11 offset:28672
ds_read_b64_tr_b16 a[254:255], v11 offset:29696
s_waitcnt lgkmcnt(0)
s_mul_i32 s25, s37, 36
s_add_u32 m0, s26, 28672
s_add_u32 s24, s25, 110592
buffer_load_dwordx4 v2, s[20:23], s24 offen lds
s_add_u32 m0, s26, 29696
s_add_u32 s24, s25, 119808
buffer_load_dwordx4 v2, s[20:23], s24 offen lds
s_add_u32 s25, s25, s50
s_add_u32 m0, s26, 30720
s_add_u32 s24, s25, 110592
buffer_load_dwordx4 v2, s[20:23], s24 offen lds
s_add_u32 m0, s26, 31744
s_add_u32 s24, s25, 119808
buffer_load_dwordx4 v2, s[20:23], s24 offen lds
s_waitcnt vmcnt(0)
v_and_b32 v12, 15, v0
v_mul_u32_u24 v12, 2304, v12
v_lshrrev_b32 v13, 4, v0
v_lshl_add_u32 v12, v13, 3, v12
s_lshl_b32 s24, s40, 7
s_add_u32 s24, s24, s47
v_add_u32 v4, s24, v12
v_and_b32 v5, 7, v0
v_lshlrev_b32 v5, 2, v5
s_lshl_b32 s24, s17, 5
v_add_u32 v5, s24, v5
v_lshlrev_b32 v3, 4, v0
v_add_u32 v3, 131072, v3
s_lshl_b32 s24, s17, 12
s_add_u32 s24, s24, 131072
v_add_u32 v7, s24, v1
s_lshl_b32 s24, s17, 15
s_add_u32 s44, s44, s24
s_ff1_i32_b64 s41, s[42:43]
s_bitset0_b64 s[42:43], s41
s_lshl_b32 s41, s41, 1
s_xor_b32 s41, s41, s51
s_and_b32 s41, s41, 127
v_mov_b32 v14, 0
v_mov_b32 v15, 0
L_opl_w:
s_lshr_b32 s25, s41, s46
s_lshl_b32 s25, s25, 7
s_add_u32 s25, s25, s45
s_mov_b32 s28, 0
L_poll_56:
buffer_load_dword v6, v5, s[8:11], s25 offen sc1
s_add_u32 s28, s28, 1
s_cmp_gt_u32 s28, 200000
s_cbranch_scc1 L_end
s_waitcnt vmcnt(0)
v_cmp_ne_u32 vcc, 1, v6
s_cbranch_vccz L_pd_57
s_sleep 1
s_cmp_lt_u32 s28, 32
s_cbranch_scc1 L_poll_56
s_sleep 32
s_branch L_poll_56
L_pd_57:
s_lshl_b32 s48, s41, 17
s_add_u32 s48, s48, s44
s_add_u32 s24, s48, s30
buffer_load_dwordx4 v[16:19], v1, s[8:11], s24 offen sc1
buffer_load_dwordx4 v[20:23], v1, s[8:11], s24 offen offset:1024 sc1
buffer_load_dwordx4 v[24:27], v1, s[8:11], s24 offen offset:2048 sc1
buffer_load_dwordx4 v[28:31], v1, s[8:11], s24 offen offset:3072 sc1
s_add_u32 s24, s48, s31
buffer_load_dwordx4 v[32:35], v1, s[8:11], s24 offen sc1
buffer_load_dwordx4 v[36:39], v1, s[8:11], s24 offen offset:1024 sc1
buffer_load_dwordx4 v[40:43], v1, s[8:11], s24 offen offset:2048 sc1
buffer_load_dwordx4 v[44:47], v1, s[8:11], s24 offen offset:3072 sc1
s_add_u32 s24, s48, s32
buffer_load_dwordx4 v[48:51], v1, s[8:11], s24 offen sc1
buffer_load_dwordx4 v[52:55], v1, s[8:11], s24 offen offset:1024 sc1
buffer_load_dwordx4 v[56:59], v1, s[8:11], s24 offen offset:2048 sc1
buffer_load_dwordx4 v[60:63], v1, s[8:11], s24 offen offset:3072 sc1
s_add_u32 s24, s48, s33
buffer_load_dwordx4 v[64:67], v1, s[8:11], s24 offen sc1
buffer_load_dwordx4 v[68:71], v1, s[8:11], s24 offen offset:1024 sc1
buffer_load_dwordx4 v[72:75], v1, s[8:11], s24 offen offset:2048 sc1
buffer_load_dwordx4 v[76:79], v1, s[8:11], s24 offen offset:3072 sc1
s_waitcnt vmcnt(15)
v_mfma_f32_16x16x32_bf16 v[80:83], v[128:131], v[16:19], 0
s_cmp_lg_u64 s[42:43], 0
s_cselect_b32 s52, 1, 0
ds_read_b64_tr_b16 v[112:113], v8
v_mfma_f32_16x16x32_bf16 v[84:87], v[132:135], v[16:19], 0
s_ff1_i32_b64 s27, s[42:43]
ds_read_b64_tr_b16 v[114:115], v8 offset:1024
v_mfma_f32_16x16x32_bf16 v[88:91], v[136:139], v[16:19], 0
s_bitset0_b64 s[42:43], s27
s_add_u32 s24, s48, s34
ds_read_b64_tr_b16 v[116:117], v9
v_mfma_f32_16x16x32_bf16 v[92:95], v[140:143], v[16:19], 0
s_waitcnt vmcnt(14)
s_lshl_b32 s27, s27, 1
ds_read_b64_tr_b16 v[118:119], v9 offset:1024
buffer_load_dwordx4 v[16:19], v1, s[8:11], s24 offen sc1
v_mfma_f32_16x16x32_bf16 v[80:83], v[144:147], v[20:23], v[80:83]
s_xor_b32 s27, s27, s51
ds_read_b64_tr_b16 v[120:121], v10
v_mfma_f32_16x16x32_bf16 v[84:87], v[148:151], v[20:23], v[84:87]
s_and_b32 s27, s27, 127
ds_read_b64_tr_b16 v[122:123], v10 offset:1024
v_mfma_f32_16x16x32_bf16 v[88:91], v[152:155], v[20:23], v[88:91]
s_lshr_b32 s25, s27, s46
ds_read_b64_tr_b16 v[124:125], v11
v_mfma_f32_16x16x32_bf16 v[92:95], v[156:159], v[20:23], v[92:95]
s_waitcnt vmcnt(14)
s_lshl_b32 s25, s25, 7
ds_read_b64_tr_b16 v[126:127], v11 offset:1024
buffer_load_dwordx4 v[20:23], v1, s[8:11], s24 offen offset:1024 sc1
v_mfma_f32_16x16x32_bf16 v[80:83], v[160:163], v[24:27], v[80:83]
s_add_u32 s25, s25, s45
v_mfma_f32_16x16x32_bf16 v[84:87], v[164:167], v[24:27], v[84:87]
s_lshl_b32 s49, s27, 17
v_mfma_f32_16x16x32_bf16 v[88:91], v[168:171], v[24:27], v[88:91]
s_add_u32 s49, s49, s44
v_mfma_f32_16x16x32_bf16 v[92:95], v[172:175], v[24:27], v[92:95]
s_waitcnt vmcnt(14) lgkmcnt(0)
buffer_load_dwordx4 v[24:27], v1, s[8:11], s24 offen offset:2048 sc1
buffer_load_dword v6, v5, s[8:11], s25 offen sc1
v_mfma_f32_16x16x32_bf16 v[80:83], v[112:115], v[28:31], v[80:83]
v_mfma_f32_16x16x32_bf16 v[84:87], v[116:119], v[28:31], v[84:87]
v_mfma_f32_16x16x32_bf16 v[88:91], v[120:123], v[28:31], v[88:91]
v_mfma_f32_16x16x32_bf16 v[92:95], v[124:127], v[28:31], v[92:95]
s_waitcnt vmcnt(15)
buffer_load_dwordx4 v[28:31], v1, s[8:11], s24 offen offset:3072 sc1
v_mfma_f32_16x16x32_bf16 v[80:83], v[176:179], v[32:35], v[80:83]
ds_read_b64_tr_b16 v[112:113], v8 offset:4096
v_mfma_f32_16x16x32_bf16 v[84:87], v[180:183], v[32:35], v[84:87]
ds_read_b64_tr_b16 v[114:115], v8 offset:5120
v_mfma_f32_16x16x32_bf16 v[88:91], v[184:187], v[32:35], v[88:91]
s_add_u32 s24, s48, s35
ds_read_b64_tr_b16 v[116:117], v9 offset:4096
v_mfma_f32_16x16x32_bf16 v[92:95], v[188:191], v[32:35], v[92:95]
s_waitcnt vmcnt(15)
ds_read_b64_tr_b16 v[118:119], v9 offset:5120
buffer_load_dwordx4 v[32:35], v1, s[8:11], s24 offen sc1
v_mfma_f32_16x16x32_bf16 v[80:83], v[192:195], v[36:39], v[80:83]
ds_read_b64_tr_b16 v[120:121], v10 offset:4096
v_mfma_f32_16x16x32_bf16 v[84:87], v[196:199], v[36:39], v[84:87]
ds_read_b64_tr_b16 v[122:123], v10 offset:5120
v_mfma_f32_16x16x32_bf16 v[88:91], v[200:203], v[36:39], v[88:91]
ds_read_b64_tr_b16 v[124:125], v11 offset:4096
v_mfma_f32_16x16x32_bf16 v[92:95], v[204:207], v[36:39], v[92:95]
s_waitcnt vmcnt(15)
ds_read_b64_tr_b16 v[126:127], v11 offset:5120
buffer_load_dwordx4 v[36:39], v1, s[8:11], s24 offen offset:1024 sc1
v_mfma_f32_16x16x32_bf16 v[80:83], v[208:211], v[40:43], v[80:83]
v_mfma_f32_16x16x32_bf16 v[84:87], v[212:215], v[40:43], v[84:87]
v_mfma_f32_16x16x32_bf16 v[88:91], v[216:219], v[40:43], v[88:91]
v_mfma_f32_16x16x32_bf16 v[92:95], v[220:223], v[40:43], v[92:95]
s_waitcnt vmcnt(15) lgkmcnt(0)
buffer_load_dwordx4 v[40:43], v1, s[8:11], s24 offen offset:2048 sc1
v_mfma_f32_16x16x32_bf16 v[80:83], v[112:115], v[44:47], v[80:83]
v_mfma_f32_16x16x32_bf16 v[84:87], v[116:119], v[44:47], v[84:87]
v_mfma_f32_16x16x32_bf16 v[88:91], v[120:123], v[44:47], v[88:91]
v_mfma_f32_16x16x32_bf16 v[92:95], v[124:127], v[44:47], v[92:95]
s_waitcnt vmcnt(15)
buffer_load_dwordx4 v[44:47], v1, s[8:11], s24 offen offset:3072 sc1
v_mfma_f32_16x16x32_bf16 v[80:83], v[224:227], v[48:51], v[80:83]
ds_read_b64_tr_b16 v[112:113], v8 offset:8192
v_mfma_f32_16x16x32_bf16 v[84:87], v[228:231], v[48:51], v[84:87]
ds_read_b64_tr_b16 v[114:115], v8 offset:9216
v_mfma_f32_16x16x32_bf16 v[88:91], v[232:235], v[48:51], v[88:91]
s_add_u32 s24, s48, s36
ds_read_b64_tr_b16 v[116:117], v9 offset:8192
v_mfma_f32_16x16x32_bf16 v[92:95], v[236:239], v[48:51], v[92:95]
s_waitcnt vmcnt(15)
ds_read_b64_tr_b16 v[118:119], v9 offset:9216
buffer_load_dwordx4 v[48:51], v1, s[8:11], s24 offen sc1
v_mfma_f32_16x16x32_bf16 v[80:83], v[240:243], v[52:55], v[80:83]
ds_read_b64_tr_b16 v[120:121], v10 offset:8192
v_mfma_f32_16x16x32_bf16 v[84:87], v[244:247], v[52:55], v[84:87]
ds_read_b64_tr_b16 v[122:123], v10 offset:9216
v_mfma_f32_16x16x32_bf16 v[88:91], v[248:251], v[52:55], v[88:91]
ds_read_b64_tr_b16 v[124:125], v11 offset:8192
v_mfma_f32_16x16x32_bf16 v[92:95], v[252:255], v[52:55], v[92:95]
s_waitcnt vmcnt(15)
ds_read_b64_tr_b16 v[126:127], v11 offset:9216
buffer_load_dwordx4 v[52:55], v1, s[8:11], s24 offen offset:1024 sc1
v_mfma_f32_16x16x32_bf16 v[80:83], a[0:3], v[56:59], v[80:83]
v_mfma_f32_16x16x32_bf16 v[84:87], a[4:7], v[56:59], v[84:87]
v_mfma_f32_16x16x32_bf16 v[88:91], a[8:11], v[56:59], v[88:91]
v_mfma_f32_16x16x32_bf16 v[92:95], a[12:15], v[56:59], v[92:95]
s_waitcnt vmcnt(15) lgkmcnt(0)
buffer_load_dwordx4 v[56:59], v1, s[8:11], s24 offen offset:2048 sc1
v_mfma_f32_16x16x32_bf16 v[80:83], v[112:115], v[60:63], v[80:83]
v_mfma_f32_16x16x32_bf16 v[84:87], v[116:119], v[60:63], v[84:87]
v_mfma_f32_16x16x32_bf16 v[88:91], v[120:123], v[60:63], v[88:91]
v_mfma_f32_16x16x32_bf16 v[92:95], v[124:127], v[60:63], v[92:95]
s_waitcnt vmcnt(15)
buffer_load_dwordx4 v[60:63], v1, s[8:11], s24 offen offset:3072 sc1
v_mfma_f32_16x16x32_bf16 v[80:83], a[16:19], v[64:67], v[80:83]
ds_read_b64_tr_b16 v[112:113], v8 offset:12288
v_mfma_f32_16x16x32_bf16 v[84:87], a[20:23], v[64:67], v[84:87]
ds_read_b64_tr_b16 v[114:115], v8 offset:13312
v_mfma_f32_16x16x32_bf16 v[88:91], a[24:27], v[64:67], v[88:91]
s_add_u32 s24, s48, s37
ds_read_b64_tr_b16 v[116:117], v9 offset:12288
v_mfma_f32_16x16x32_bf16 v[92:95], a[28:31], v[64:67], v[92:95]
s_waitcnt vmcnt(15)
ds_read_b64_tr_b16 v[118:119], v9 offset:13312
buffer_load_dwordx4 v[64:67], v1, s[8:11], s24 offen sc1
v_mfma_f32_16x16x32_bf16 v[80:83], a[32:35], v[68:71], v[80:83]
ds_read_b64_tr_b16 v[120:121], v10 offset:12288
v_mfma_f32_16x16x32_bf16 v[84:87], a[36:39], v[68:71], v[84:87]
ds_read_b64_tr_b16 v[122:123], v10 offset:13312
v_mfma_f32_16x16x32_bf16 v[88:91], a[40:43], v[68:71], v[88:91]
ds_read_b64_tr_b16 v[124:125], v11 offset:12288
v_mfma_f32_16x16x32_bf16 v[92:95], a[44:47], v[68:71], v[92:95]
s_waitcnt vmcnt(15)
ds_read_b64_tr_b16 v[126:127], v11 offset:13312
buffer_load_dwordx4 v[68:71], v1, s[8:11], s24 offen offset:1024 sc1
buffer_load_dword v6, v5, s[8:11], s25 offen sc1
s_branch L_opl_t0
L_opl_r0:
v_mfma_f32_16x16x32_bf16 v[80:83], v[128:131], v[16:19], 0
s_cmp_lg_u64 s[42:43], 0
s_cselect_b32 s52, 1, 0
ds_read_b64_tr_b16 v[112:113], v8
v_mfma_f32_16x16x32_bf16 v[84:87], v[132:135], v[16:19], 0
s_ff1_i32_b64 s27, s[42:43]
ds_read_b64_tr_b16 v[114:115], v8 offset:1024
v_mfma_f32_16x16x32_bf16 v[88:91], v[136:139], v[16:19], 0
s_bitset0_b64 s[42:43], s27
s_add_u32 s24, s48, s34
ds_read_b64_tr_b16 v[116:117], v9
v_mfma_f32_16x16x32_bf16 v[92:95], v[140:143], v[16:19], 0
s_waitcnt vmcnt(14)
s_lshl_b32 s27, s27, 1
ds_read_b64_tr_b16 v[118:119], v9 offset:1024
buffer_load_dwordx4 v[16:19], v1, s[8:11], s24 offen sc1
v_mfma_f32_16x16x32_bf16 v[80:83], v[144:147], v[20:23], v[80:83]
s_xor_b32 s27, s27, s51
ds_read_b64_tr_b16 v[120:121], v10
v_mfma_f32_16x16x32_bf16 v[84:87], v[148:151], v[20:23], v[84:87]
s_and_b32 s27, s27, 127
ds_read_b64_tr_b16 v[122:123], v10 offset:1024
v_mfma_f32_16x16x32_bf16 v[88:91], v[152:155], v[20:23], v[88:91]
s_lshr_b32 s25, s27, s46
ds_read_b64_tr_b16 v[124:125], v11
v_mfma_f32_16x16x32_bf16 v[92:95], v[156:159], v[20:23], v[92:95]
s_waitcnt vmcnt(14)
s_lshl_b32 s25, s25, 7
ds_read_b64_tr_b16 v[126:127], v11 offset:1024
buffer_load_dwordx4 v[20:23], v1, s[8:11], s24 offen offset:1024 sc1
v_mfma_f32_16x16x32_bf16 v[80:83], v[160:163], v[24:27], v[80:83]
s_add_u32 s25, s25, s45
v_mfma_f32_16x16x32_bf16 v[84:87], v[164:167], v[24:27], v[84:87]
s_lshl_b32 s49, s27, 17
v_mfma_f32_16x16x32_bf16 v[88:91], v[168:171], v[24:27], v[88:91]
s_add_u32 s49, s49, s44
v_mfma_f32_16x16x32_bf16 v[92:95], v[172:175], v[24:27], v[92:95]
s_waitcnt vmcnt(14) lgkmcnt(0)
buffer_load_dwordx4 v[24:27], v1, s[8:11], s24 offen offset:2048 sc1
buffer_load_dword v6, v5, s[8:11], s25 offen sc1
v_mfma_f32_16x16x32_bf16 v[80:83], v[112:115], v[28:31], v[80:83]
ds_write_b128 v3, v[96:99]
v_mfma_f32_16x16x32_bf16 v[84:87], v[116:119], v[28:31], v[84:87]
ds_write_b128 v3, v[100:103] offset:4096
v_mfma_f32_16x16x32_bf16 v[88:91], v[120:123], v[28:31], v[88:91]
ds_write_b128 v3, v[104:107] offset:8192
v_mfma_f32_16x16x32_bf16 v[92:95], v[124:127], v[28:31], v[92:95]
s_waitcnt vmcnt(15)
ds_write_b128 v3, v[108:111] offset:12288
buffer_load_dwordx4 v[28:31], v1, s[8:11], s24 offen offset:3072 sc1
v_mfma_f32_16x16x32_bf16 v[80:83], v[176:179], v[32:35], v[80:83]
ds_read_b64_tr_b16 v[112:113], v8 offset:4096
v_mfma_f32_16x16x32_bf16 v[84:87], v[180:183], v[32:35], v[84:87]
ds_read_b64_tr_b16 v[114:115], v8 offset:5120
v_mfma_f32_16x16x32_bf16 v[88:91], v[184:187], v[32:35], v[88:91]
s_add_u32 s24, s48, s35
ds_read_b64_tr_b16 v[116:117], v9 offset:4096
v_mfma_f32_16x16x32_bf16 v[92:95], v[188:191], v[32:35], v[92:95]
s_waitcnt vmcnt(15)
ds_read_b64_tr_b16 v[118:119], v9 offset:5120
buffer_load_dwordx4 v[32:35], v1, s[8:11], s24 offen sc1
v_mfma_f32_16x16x32_bf16 v[80:83], v[192:195], v[36:39], v[80:83]
ds_read_b64_tr_b16 v[120:121], v10 offset:4096
v_mfma_f32_16x16x32_bf16 v[84:87], v[196:199], v[36:39], v[84:87]
ds_read_b64_tr_b16 v[122:123], v10 offset:5120
v_mfma_f32_16x16x32_bf16 v[88:91], v[200:203], v[36:39], v[88:91]
ds_read_b64_tr_b16 v[124:125], v11 offset:4096
v_mfma_f32_16x16x32_bf16 v[92:95], v[204:207], v[36:39], v[92:95]
s_waitcnt vmcnt(15)
ds_read_b64_tr_b16 v[126:127], v11 offset:5120
buffer_load_dwordx4 v[36:39], v1, s[8:11], s24 offen offset:1024 sc1
v_mfma_f32_16x16x32_bf16 v[80:83], v[208:211], v[40:43], v[80:83]
v_mfma_f32_16x16x32_bf16 v[84:87], v[212:215], v[40:43], v[84:87]
v_mfma_f32_16x16x32_bf16 v[88:91], v[216:219], v[40:43], v[88:91]
v_mfma_f32_16x16x32_bf16 v[92:95], v[220:223], v[40:43], v[92:95]
s_waitcnt vmcnt(15) lgkmcnt(0)
buffer_load_dwordx4 v[40:43], v1, s[8:11], s24 offen offset:2048 sc1
s_barrier
v_mfma_f32_16x16x32_bf16 v[80:83], v[112:115], v[44:47], v[80:83]
ds_read_b128 v[96:99], v7
v_mfma_f32_16x16x32_bf16 v[84:87], v[116:119], v[44:47], v[84:87]
ds_read_b128 v[100:103], v7 offset:1024
v_mfma_f32_16x16x32_bf16 v[88:91], v[120:123], v[44:47], v[88:91]
ds_read_b128 v[104:107], v7 offset:2048
v_mfma_f32_16x16x32_bf16 v[92:95], v[124:127], v[44:47], v[92:95]
s_waitcnt vmcnt(15)
ds_read_b128 v[108:111], v7 offset:3072
buffer_load_dwordx4 v[44:47], v1, s[8:11], s24 offen offset:3072 sc1
v_mfma_f32_16x16x32_bf16 v[80:83], v[224:227], v[48:51], v[80:83]
ds_read_b64_tr_b16 v[112:113], v8 offset:8192
v_mfma_f32_16x16x32_bf16 v[84:87], v[228:231], v[48:51], v[84:87]
ds_read_b64_tr_b16 v[114:115], v8 offset:9216
v_mfma_f32_16x16x32_bf16 v[88:91], v[232:235], v[48:51], v[88:91]
s_add_u32 s24, s48, s36
ds_read_b64_tr_b16 v[116:117], v9 offset:8192
v_mfma_f32_16x16x32_bf16 v[92:95], v[236:239], v[48:51], v[92:95]
s_waitcnt vmcnt(15)
ds_read_b64_tr_b16 v[118:119], v9 offset:9216
buffer_load_dwordx4 v[48:51], v1, s[8:11], s24 offen sc1
v_mfma_f32_16x16x32_bf16 v[80:83], v[240:243], v[52:55], v[80:83]
ds_read_b64_tr_b16 v[120:121], v10 offset:8192
v_mfma_f32_16x16x32_bf16 v[84:87], v[244:247], v[52:55], v[84:87]
ds_read_b64_tr_b16 v[122:123], v10 offset:9216
v_mfma_f32_16x16x32_bf16 v[88:91], v[248:251], v[52:55], v[88:91]
ds_read_b64_tr_b16 v[124:125], v11 offset:8192
v_mfma_f32_16x16x32_bf16 v[92:95], v[252:255], v[52:55], v[92:95]
s_waitcnt vmcnt(15)
ds_read_b64_tr_b16 v[126:127], v11 offset:9216
buffer_load_dwordx4 v[52:55], v1, s[8:11], s24 offen offset:1024 sc1
v_mfma_f32_16x16x32_bf16 v[80:83], a[0:3], v[56:59], v[80:83]
v_mfma_f32_16x16x32_bf16 v[84:87], a[4:7], v[56:59], v[84:87]
v_mfma_f32_16x16x32_bf16 v[88:91], a[8:11], v[56:59], v[88:91]
v_mfma_f32_16x16x32_bf16 v[92:95], a[12:15], v[56:59], v[92:95]
s_waitcnt vmcnt(15) lgkmcnt(0)
buffer_load_dwordx4 v[56:59], v1, s[8:11], s24 offen offset:2048 sc1
v_mfma_f32_16x16x32_bf16 v[80:83], v[112:115], v[60:63], v[80:83]
v_add_f32 v96, v96, v100
v_add_f32 v97, v97, v101
v_mfma_f32_16x16x32_bf16 v[84:87], v[116:119], v[60:63], v[84:87]
v_add_f32 v98, v98, v102
v_add_f32 v99, v99, v103
v_mfma_f32_16x16x32_bf16 v[88:91], v[120:123], v[60:63], v[88:91]
v_add_f32 v96, v96, v104
v_add_f32 v97, v97, v105
v_mfma_f32_16x16x32_bf16 v[92:95], v[124:127], v[60:63], v[92:95]
s_waitcnt vmcnt(15)
v_add_f32 v98, v98, v106
v_add_f32 v99, v99, v107
buffer_load_dwordx4 v[60:63], v1, s[8:11], s24 offen offset:3072 sc1
v_mfma_f32_16x16x32_bf16 v[80:83], a[16:19], v[64:67], v[80:83]
ds_read_b64_tr_b16 v[112:113], v8 offset:12288
v_add_f32 v96, v96, v108
v_mfma_f32_16x16x32_bf16 v[84:87], a[20:23], v[64:67], v[84:87]
ds_read_b64_tr_b16 v[114:115], v8 offset:13312
v_add_f32 v97, v97, v109
v_mfma_f32_16x16x32_bf16 v[88:91], a[24:27], v[64:67], v[88:91]
s_add_u32 s24, s48, s37
ds_read_b64_tr_b16 v[116:117], v9 offset:12288
v_add_f32 v98, v98, v110
v_mfma_f32_16x16x32_bf16 v[92:95], a[28:31], v[64:67], v[92:95]
s_waitcnt vmcnt(15)
ds_read_b64_tr_b16 v[118:119], v9 offset:13312
v_add_f32 v99, v99, v111
buffer_load_dwordx4 v[64:67], v1, s[8:11], s24 offen sc1
v_mfma_f32_16x16x32_bf16 v[80:83], a[32:35], v[68:71], v[80:83]
ds_read_b64_tr_b16 v[120:121], v10 offset:12288
v_cvt_pk_bf16_f32 v12, v96, v97
v_mfma_f32_16x16x32_bf16 v[84:87], a[36:39], v[68:71], v[84:87]
ds_read_b64_tr_b16 v[122:123], v10 offset:13312
v_cvt_pk_bf16_f32 v13, v98, v99
v_mfma_f32_16x16x32_bf16 v[88:91], a[40:43], v[68:71], v[88:91]
ds_read_b64_tr_b16 v[124:125], v11 offset:12288
v_xor_b32 v3, 16384, v3
v_mfma_f32_16x16x32_bf16 v[92:95], a[44:47], v[68:71], v[92:95]
s_waitcnt vmcnt(15)
ds_read_b64_tr_b16 v[126:127], v11 offset:13312
v_xor_b32 v7, 16384, v7
buffer_load_dwordx4 v[68:71], v1, s[8:11], s24 offen offset:1024 sc1
buffer_store_dwordx2 v[12:13], v4, s[12:15], s53 offen
L_opl_t0:
v_mfma_f32_16x16x32_bf16 v[80:83], a[48:51], v[72:75], v[80:83]
v_mfma_f32_16x16x32_bf16 v[84:87], a[52:55], v[72:75], v[84:87]
v_mfma_f32_16x16x32_bf16 v[88:91], a[56:59], v[72:75], v[88:91]
v_mfma_f32_16x16x32_bf16 v[92:95], a[60:63], v[72:75], v[92:95]
s_waitcnt vmcnt(16) lgkmcnt(0)
buffer_load_dwordx4 v[72:75], v1, s[8:11], s24 offen offset:2048 sc1
v_mfma_f32_16x16x32_bf16 v[80:83], v[112:115], v[76:79], v[80:83]
s_waitcnt vmcnt(13)
v_cmp_ne_u32 vcc, 1, v6
v_mfma_f32_16x16x32_bf16 v[84:87], v[116:119], v[76:79], v[84:87]
v_mfma_f32_16x16x32_bf16 v[88:91], v[120:123], v[76:79], v[88:91]
s_cmp_eq_u64 vcc, 0
s_cselect_b32 s50, s52, 0
v_mfma_f32_16x16x32_bf16 v[92:95], v[124:127], v[76:79], v[92:95]
s_waitcnt vmcnt(16)
buffer_load_dwordx4 v[76:79], v1, s[8:11], s24 offen offset:3072 sc1
v_mfma_f32_16x16x32_bf16 v[80:83], a[64:67], v[16:19], v[80:83]
s_cmp_eq_u32 s50, 1
s_cselect_b32 s49, s49, 536870912
ds_read_b64_tr_b16 v[112:113], v8 offset:16384
v_mfma_f32_16x16x32_bf16 v[84:87], a[68:71], v[16:19], v[84:87]
ds_read_b64_tr_b16 v[114:115], v8 offset:17408
v_mfma_f32_16x16x32_bf16 v[88:91], a[72:75], v[16:19], v[88:91]
s_add_u32 s24, s49, s30
ds_read_b64_tr_b16 v[116:117], v9 offset:16384
v_mfma_f32_16x16x32_bf16 v[92:95], a[76:79], v[16:19], v[92:95]
s_waitcnt vmcnt(16)
ds_read_b64_tr_b16 v[118:119], v9 offset:17408
buffer_load_dwordx4 v[16:19], v1, s[8:11], s24 offen sc1
v_mfma_f32_16x16x32_bf16 v[80:83], a[80:83], v[20:23], v[80:83]
ds_read_b64_tr_b16 v[120:121], v10 offset:16384
v_mfma_f32_16x16x32_bf16 v[84:87], a[84:87], v[20:23], v[84:87]
ds_read_b64_tr_b16 v[122:123], v10 offset:17408
v_mfma_f32_16x16x32_bf16 v[88:91], a[88:91], v[20:23], v[88:91]
ds_read_b64_tr_b16 v[124:125], v11 offset:16384
v_mfma_f32_16x16x32_bf16 v[92:95], a[92:95], v[20:23], v[92:95]
s_waitcnt vmcnt(16)
ds_read_b64_tr_b16 v[126:127], v11 offset:17408
buffer_load_dwordx4 v[20:23], v1, s[8:11], s24 offen offset:1024 sc1
v_mfma_f32_16x16x32_bf16 v[80:83], a[96:99], v[24:27], v[80:83]
v_mfma_f32_16x16x32_bf16 v[84:87], a[100:103], v[24:27], v[84:87]
v_mfma_f32_16x16x32_bf16 v[88:91], a[104:107], v[24:27], v[88:91]
v_mfma_f32_16x16x32_bf16 v[92:95], a[108:111], v[24:27], v[92:95]
s_waitcnt vmcnt(15) lgkmcnt(0)
buffer_load_dwordx4 v[24:27], v1, s[8:11], s24 offen offset:2048 sc1
v_mfma_f32_16x16x32_bf16 v[80:83], v[112:115], v[28:31], v[80:83]
v_mfma_f32_16x16x32_bf16 v[84:87], v[116:119], v[28:31], v[84:87]
v_mfma_f32_16x16x32_bf16 v[88:91], v[120:123], v[28:31], v[88:91]
v_mfma_f32_16x16x32_bf16 v[92:95], v[124:127], v[28:31], v[92:95]
s_waitcnt vmcnt(15)
buffer_load_dwordx4 v[28:31], v1, s[8:11], s24 offen offset:3072 sc1
v_mfma_f32_16x16x32_bf16 v[80:83], a[112:115], v[32:35], v[80:83]
ds_read_b64_tr_b16 v[112:113], v8 offset:20480
v_mfma_f32_16x16x32_bf16 v[84:87], a[116:119], v[32:35], v[84:87]
ds_read_b64_tr_b16 v[114:115], v8 offset:21504
v_mfma_f32_16x16x32_bf16 v[88:91], a[120:123], v[32:35], v[88:91]
s_add_u32 s24, s49, s31
ds_read_b64_tr_b16 v[116:117], v9 offset:20480
v_mfma_f32_16x16x32_bf16 v[92:95], a[124:127], v[32:35], v[92:95]
s_waitcnt vmcnt(15)
ds_read_b64_tr_b16 v[118:119], v9 offset:21504
buffer_load_dwordx4 v[32:35], v1, s[8:11], s24 offen sc1
v_mfma_f32_16x16x32_bf16 v[80:83], a[128:131], v[36:39], v[80:83]
ds_read_b64_tr_b16 v[120:121], v10 offset:20480
v_mfma_f32_16x16x32_bf16 v[84:87], a[132:135], v[36:39], v[84:87]
ds_read_b64_tr_b16 v[122:123], v10 offset:21504
v_mfma_f32_16x16x32_bf16 v[88:91], a[136:139], v[36:39], v[88:91]
ds_read_b64_tr_b16 v[124:125], v11 offset:20480
v_mfma_f32_16x16x32_bf16 v[92:95], a[140:143], v[36:39], v[92:95]
s_waitcnt vmcnt(15)
ds_read_b64_tr_b16 v[126:127], v11 offset:21504
buffer_load_dwordx4 v[36:39], v1, s[8:11], s24 offen offset:1024 sc1
v_mfma_f32_16x16x32_bf16 v[80:83], a[144:147], v[40:43], v[80:83]
v_mfma_f32_16x16x32_bf16 v[84:87], a[148:151], v[40:43], v[84:87]
v_mfma_f32_16x16x32_bf16 v[88:91], a[152:155], v[40:43], v[88:91]
v_mfma_f32_16x16x32_bf16 v[92:95], a[156:159], v[40:43], v[92:95]
s_waitcnt vmcnt(15) lgkmcnt(0)
buffer_load_dwordx4 v[40:43], v1, s[8:11], s24 offen offset:2048 sc1
v_mfma_f32_16x16x32_bf16 v[80:83], v[112:115], v[44:47], v[80:83]
v_mfma_f32_16x16x32_bf16 v[84:87], v[116:119], v[44:47], v[84:87]
v_mfma_f32_16x16x32_bf16 v[88:91], v[120:123], v[44:47], v[88:91]
v_mfma_f32_16x16x32_bf16 v[92:95], v[124:127], v[44:47], v[92:95]
s_waitcnt vmcnt(15)
buffer_load_dwordx4 v[44:47], v1, s[8:11], s24 offen offset:3072 sc1
v_mfma_f32_16x16x32_bf16 v[80:83], a[160:163], v[48:51], v[80:83]
ds_read_b64_tr_b16 v[112:113], v8 offset:24576
v_mfma_f32_16x16x32_bf16 v[84:87], a[164:167], v[48:51], v[84:87]
ds_read_b64_tr_b16 v[114:115], v8 offset:25600
v_mfma_f32_16x16x32_bf16 v[88:91], a[168:171], v[48:51], v[88:91]
s_add_u32 s24, s49, s32
ds_read_b64_tr_b16 v[116:117], v9 offset:24576
v_mfma_f32_16x16x32_bf16 v[92:95], a[172:175], v[48:51], v[92:95]
s_waitcnt vmcnt(15)
ds_read_b64_tr_b16 v[118:119], v9 offset:25600
buffer_load_dwordx4 v[48:51], v1, s[8:11], s24 offen sc1
v_mfma_f32_16x16x32_bf16 v[80:83], a[176:179], v[52:55], v[80:83]
ds_read_b64_tr_b16 v[120:121], v10 offset:24576
v_mfma_f32_16x16x32_bf16 v[84:87], a[180:183], v[52:55], v[84:87]
ds_read_b64_tr_b16 v[122:123], v10 offset:25600
v_mfma_f32_16x16x32_bf16 v[88:91], a[184:187], v[52:55], v[88:91]
ds_read_b64_tr_b16 v[124:125], v11 offset:24576
v_mfma_f32_16x16x32_bf16 v[92:95], a[188:191], v[52:55], v[92:95]
s_waitcnt vmcnt(15)
ds_read_b64_tr_b16 v[126:127], v11 offset:25600
buffer_load_dwordx4 v[52:55], v1, s[8:11], s24 offen offset:1024 sc1
v_mfma_f32_16x16x32_bf16 v[80:83], a[192:195], v[56:59], v[80:83]
v_mfma_f32_16x16x32_bf16 v[84:87], a[196:199], v[56:59], v[84:87]
v_mfma_f32_16x16x32_bf16 v[88:91], a[200:203], v[56:59], v[88:91]
v_mfma_f32_16x16x32_bf16 v[92:95], a[204:207], v[56:59], v[92:95]
s_waitcnt vmcnt(15) lgkmcnt(0)
buffer_load_dwordx4 v[56:59], v1, s[8:11], s24 offen offset:2048 sc1
v_mfma_f32_16x16x32_bf16 v[80:83], v[112:115], v[60:63], v[80:83]
v_mfma_f32_16x16x32_bf16 v[84:87], v[116:119], v[60:63], v[84:87]
v_mfma_f32_16x16x32_bf16 v[88:91], v[120:123], v[60:63], v[88:91]
v_mfma_f32_16x16x32_bf16 v[92:95], v[124:127], v[60:63], v[92:95]
s_waitcnt vmcnt(15)
buffer_load_dwordx4 v[60:63], v1, s[8:11], s24 offen offset:3072 sc1
v_mfma_f32_16x16x32_bf16 v[80:83], a[208:211], v[64:67], v[80:83]
ds_read_b64_tr_b16 v[112:113], v8 offset:28672
v_mfma_f32_16x16x32_bf16 v[84:87], a[212:215], v[64:67], v[84:87]
ds_read_b64_tr_b16 v[114:115], v8 offset:29696
v_mfma_f32_16x16x32_bf16 v[88:91], a[216:219], v[64:67], v[88:91]
s_add_u32 s24, s49, s33
ds_read_b64_tr_b16 v[116:117], v9 offset:28672
v_mfma_f32_16x16x32_bf16 v[92:95], a[220:223], v[64:67], v[92:95]
s_waitcnt vmcnt(15)
ds_read_b64_tr_b16 v[118:119], v9 offset:29696
buffer_load_dwordx4 v[64:67], v1, s[8:11], s24 offen sc1
v_mfma_f32_16x16x32_bf16 v[80:83], a[224:227], v[68:71], v[80:83]
ds_read_b64_tr_b16 v[120:121], v10 offset:28672
v_mfma_f32_16x16x32_bf16 v[84:87], a[228:231], v[68:71], v[84:87]
ds_read_b64_tr_b16 v[122:123], v10 offset:29696
v_mfma_f32_16x16x32_bf16 v[88:91], a[232:235], v[68:71], v[88:91]
ds_read_b64_tr_b16 v[124:125], v11 offset:28672
v_mfma_f32_16x16x32_bf16 v[92:95], a[236:239], v[68:71], v[92:95]
s_waitcnt vmcnt(14)
ds_read_b64_tr_b16 v[126:127], v11 offset:29696
buffer_load_dwordx4 v[68:71], v1, s[8:11], s24 offen offset:1024 sc1
v_mfma_f32_16x16x32_bf16 v[80:83], a[240:243], v[72:75], v[80:83]
v_mfma_f32_16x16x32_bf16 v[84:87], a[244:247], v[72:75], v[84:87]
v_mfma_f32_16x16x32_bf16 v[88:91], a[248:251], v[72:75], v[88:91]
v_mfma_f32_16x16x32_bf16 v[92:95], a[252:255], v[72:75], v[92:95]
s_waitcnt vmcnt(14) lgkmcnt(0)
buffer_load_dwordx4 v[72:75], v1, s[8:11], s24 offen offset:2048 sc1
v_mfma_f32_16x16x32_bf16 v[80:83], v[112:115], v[76:79], v[80:83]
v_mfma_f32_16x16x32_bf16 v[84:87], v[116:119], v[76:79], v[84:87]
v_mfma_f32_16x16x32_bf16 v[88:91], v[120:123], v[76:79], v[88:91]
v_mfma_f32_16x16x32_bf16 v[92:95], v[124:127], v[76:79], v[92:95]
s_waitcnt vmcnt(14)
buffer_load_dwordx4 v[76:79], v1, s[8:11], s24 offen offset:3072 sc1
s_mul_i32 s53, s41, 36864
s_mov_b32 s41, s27
s_mov_b32 s48, s49
s_cmp_eq_u32 s50, 0
s_cbranch_scc1 L_opl_c0
L_opl_r1:
v_mfma_f32_16x16x32_bf16 v[96:99], v[128:131], v[16:19], 0
s_cmp_lg_u64 s[42:43], 0
s_cselect_b32 s52, 1, 0
ds_read_b64_tr_b16 v[112:113], v8
v_mfma_f32_16x16x32_bf16 v[100:103], v[132:135], v[16:19], 0
s_ff1_i32_b64 s27, s[42:43]
ds_read_b64_tr_b16 v[114:115], v8 offset:1024
v_mfma_f32_16x16x32_bf16 v[104:107], v[136:139], v[16:19], 0
s_bitset0_b64 s[42:43], s27
s_add_u32 s24, s48, s34
ds_read_b64_tr_b16 v[116:117], v9
v_mfma_f32_16x16x32_bf16 v[108:111], v[140:143], v[16:19], 0
s_waitcnt vmcnt(14)
s_lshl_b32 s27, s27, 1
ds_read_b64_tr_b16 v[118:119], v9 offset:1024
buffer_load_dwordx4 v[16:19], v1, s[8:11], s24 offen sc1
v_mfma_f32_16x16x32_bf16 v[96:99], v[144:147], v[20:23], v[96:99]
s_xor_b32 s27, s27, s51
ds_read_b64_tr_b16 v[120:121], v10
v_mfma_f32_16x16x32_bf16 v[100:103], v[148:151], v[20:23], v[100:103]
s_and_b32 s27, s27, 127
ds_read_b64_tr_b16 v[122:123], v10 offset:1024
v_mfma_f32_16x16x32_bf16 v[104:107], v[152:155], v[20:23], v[104:107]
s_lshr_b32 s25, s27, s46
ds_read_b64_tr_b16 v[124:125], v11
v_mfma_f32_16x16x32_bf16 v[108:111], v[156:159], v[20:23], v[108:111]
s_waitcnt vmcnt(14)
s_lshl_b32 s25, s25, 7
ds_read_b64_tr_b16 v[126:127], v11 offset:1024
buffer_load_dwordx4 v[20:23], v1, s[8:11], s24 offen offset:1024 sc1
v_mfma_f32_16x16x32_bf16 v[96:99], v[160:163], v[24:27], v[96:99]
s_add_u32 s25, s25, s45
v_mfma_f32_16x16x32_bf16 v[100:103], v[164:167], v[24:27], v[100:103]
s_lshl_b32 s49, s27, 17
v_mfma_f32_16x16x32_bf16 v[104:107], v[168:171], v[24:27], v[104:107]
s_add_u32 s49, s49, s44
v_mfma_f32_16x16x32_bf16 v[108:111], v[172:175], v[24:27], v[108:111]
s_waitcnt vmcnt(14) lgkmcnt(0)
buffer_load_dwordx4 v[24:27], v1, s[8:11], s24 offen offset:2048 sc1
buffer_load_dword v6, v5, s[8:11], s25 offen sc1
v_mfma_f32_16x16x32_bf16 v[96:99], v[112:115], v[28:31], v[96:99]
ds_write_b128 v3, v[80:83]
v_mfma_f32_16x16x32_bf16 v[100:103], v[116:119], v[28:31], v[100:103]
ds_write_b128 v3, v[84:87] offset:4096
v_mfma_f32_16x16x32_bf16 v[104:107], v[120:123], v[28:31], v[104:107]
ds_write_b128 v3, v[88:91] offset:8192
v_mfma_f32_16x16x32_bf16 v[108:111], v[124:127], v[28:31], v[108:111]
s_waitcnt vmcnt(15)
ds_write_b128 v3, v[92:95] offset:12288
buffer_load_dwordx4 v[28:31], v1, s[8:11], s24 offen offset:3072 sc1
v_mfma_f32_16x16x32_bf16 v[96:99], v[176:179], v[32:35], v[96:99]
ds_read_b64_tr_b16 v[112:113], v8 offset:4096
v_mfma_f32_16x16x32_bf16 v[100:103], v[180:183], v[32:35], v[100:103]
ds_read_b64_tr_b16 v[114:115], v8 offset:5120
v_mfma_f32_16x16x32_bf16 v[104:107], v[184:187], v[32:35], v[104:107]
s_add_u32 s24, s48, s35
ds_read_b64_tr_b16 v[116:117], v9 offset:4096
v_mfma_f32_16x16x32_bf16 v[108:111], v[188:191], v[32:35], v[108:111]
s_waitcnt vmcnt(15)
ds_read_b64_tr_b16 v[118:119], v9 offset:5120
buffer_load_dwordx4 v[32:35], v1, s[8:11], s24 offen sc1
v_mfma_f32_16x16x32_bf16 v[96:99], v[192:195], v[36:39], v[96:99]
ds_read_b64_tr_b16 v[120:121], v10 offset:4096
v_mfma_f32_16x16x32_bf16 v[100:103], v[196:199], v[36:39], v[100:103]
ds_read_b64_tr_b16 v[122:123], v10 offset:5120
v_mfma_f32_16x16x32_bf16 v[104:107], v[200:203], v[36:39], v[104:107]
ds_read_b64_tr_b16 v[124:125], v11 offset:4096
v_mfma_f32_16x16x32_bf16 v[108:111], v[204:207], v[36:39], v[108:111]
s_waitcnt vmcnt(15)
ds_read_b64_tr_b16 v[126:127], v11 offset:5120
buffer_load_dwordx4 v[36:39], v1, s[8:11], s24 offen offset:1024 sc1
v_mfma_f32_16x16x32_bf16 v[96:99], v[208:211], v[40:43], v[96:99]
v_mfma_f32_16x16x32_bf16 v[100:103], v[212:215], v[40:43], v[100:103]
v_mfma_f32_16x16x32_bf16 v[104:107], v[216:219], v[40:43], v[104:107]
v_mfma_f32_16x16x32_bf16 v[108:111], v[220:223], v[40:43], v[108:111]
s_waitcnt vmcnt(15) lgkmcnt(0)
buffer_load_dwordx4 v[40:43], v1, s[8:11], s24 offen offset:2048 sc1
s_barrier
v_mfma_f32_16x16x32_bf16 v[96:99], v[112:115], v[44:47], v[96:99]
ds_read_b128 v[80:83], v7
v_mfma_f32_16x16x32_bf16 v[100:103], v[116:119], v[44:47], v[100:103]
ds_read_b128 v[84:87], v7 offset:1024
v_mfma_f32_16x16x32_bf16 v[104:107], v[120:123], v[44:47], v[104:107]
ds_read_b128 v[88:91], v7 offset:2048
v_mfma_f32_16x16x32_bf16 v[108:111], v[124:127], v[44:47], v[108:111]
s_waitcnt vmcnt(15)
ds_read_b128 v[92:95], v7 offset:3072
buffer_load_dwordx4 v[44:47], v1, s[8:11], s24 offen offset:3072 sc1
v_mfma_f32_16x16x32_bf16 v[96:99], v[224:227], v[48:51], v[96:99]
ds_read_b64_tr_b16 v[112:113], v8 offset:8192
v_mfma_f32_16x16x32_bf16 v[100:103], v[228:231], v[48:51], v[100:103]
ds_read_b64_tr_b16 v[114:115], v8 offset:9216
v_mfma_f32_16x16x32_bf16 v[104:107], v[232:235], v[48:51], v[104:107]
s_add_u32 s24, s48, s36
ds_read_b64_tr_b16 v[116:117], v9 offset:8192
v_mfma_f32_16x16x32_bf16 v[108:111], v[236:239], v[48:51], v[108:111]
s_waitcnt vmcnt(15)
ds_read_b64_tr_b16 v[118:119], v9 offset:9216
buffer_load_dwordx4 v[48:51], v1, s[8:11], s24 offen sc1
v_mfma_f32_16x16x32_bf16 v[96:99], v[240:243], v[52:55], v[96:99]
ds_read_b64_tr_b16 v[120:121], v10 offset:8192
v_mfma_f32_16x16x32_bf16 v[100:103], v[244:247], v[52:55], v[100:103]
ds_read_b64_tr_b16 v[122:123], v10 offset:9216
v_mfma_f32_16x16x32_bf16 v[104:107], v[248:251], v[52:55], v[104:107]
ds_read_b64_tr_b16 v[124:125], v11 offset:8192
v_mfma_f32_16x16x32_bf16 v[108:111], v[252:255], v[52:55], v[108:111]
s_waitcnt vmcnt(15)
ds_read_b64_tr_b16 v[126:127], v11 offset:9216
buffer_load_dwordx4 v[52:55], v1, s[8:11], s24 offen offset:1024 sc1
v_mfma_f32_16x16x32_bf16 v[96:99], a[0:3], v[56:59], v[96:99]
v_mfma_f32_16x16x32_bf16 v[100:103], a[4:7], v[56:59], v[100:103]
v_mfma_f32_16x16x32_bf16 v[104:107], a[8:11], v[56:59], v[104:107]
v_mfma_f32_16x16x32_bf16 v[108:111], a[12:15], v[56:59], v[108:111]
s_waitcnt vmcnt(15) lgkmcnt(0)
buffer_load_dwordx4 v[56:59], v1, s[8:11], s24 offen offset:2048 sc1
v_mfma_f32_16x16x32_bf16 v[96:99], v[112:115], v[60:63], v[96:99]
v_add_f32 v80, v80, v84
v_add_f32 v81, v81, v85
v_mfma_f32_16x16x32_bf16 v[100:103], v[116:119], v[60:63], v[100:103]
v_add_f32 v82, v82, v86
v_add_f32 v83, v83, v87
v_mfma_f32_16x16x32_bf16 v[104:107], v[120:123], v[60:63], v[104:107]
v_add_f32 v80, v80, v88
v_add_f32 v81, v81, v89
v_mfma_f32_16x16x32_bf16 v[108:111], v[124:127], v[60:63], v[108:111]
s_waitcnt vmcnt(15)
v_add_f32 v82, v82, v90
v_add_f32 v83, v83, v91
buffer_load_dwordx4 v[60:63], v1, s[8:11], s24 offen offset:3072 sc1
v_mfma_f32_16x16x32_bf16 v[96:99], a[16:19], v[64:67], v[96:99]
ds_read_b64_tr_b16 v[112:113], v8 offset:12288
v_add_f32 v80, v80, v92
v_mfma_f32_16x16x32_bf16 v[100:103], a[20:23], v[64:67], v[100:103]
ds_read_b64_tr_b16 v[114:115], v8 offset:13312
v_add_f32 v81, v81, v93
v_mfma_f32_16x16x32_bf16 v[104:107], a[24:27], v[64:67], v[104:107]
s_add_u32 s24, s48, s37
ds_read_b64_tr_b16 v[116:117], v9 offset:12288
v_add_f32 v82, v82, v94
v_mfma_f32_16x16x32_bf16 v[108:111], a[28:31], v[64:67], v[108:111]
s_waitcnt vmcnt(15)
ds_read_b64_tr_b16 v[118:119], v9 offset:13312
v_add_f32 v83, v83, v95
buffer_load_dwordx4 v[64:67], v1, s[8:11], s24 offen sc1
v_mfma_f32_16x16x32_bf16 v[96:99], a[32:35], v[68:71], v[96:99]
ds_read_b64_tr_b16 v[120:121], v10 offset:12288
v_cvt_pk_bf16_f32 v12, v80, v81
v_mfma_f32_16x16x32_bf16 v[100:103], a[36:39], v[68:71], v[100:103]
ds_read_b64_tr_b16 v[122:123], v10 offset:13312
v_cvt_pk_bf16_f32 v13, v82, v83
v_mfma_f32_16x16x32_bf16 v[104:107], a[40:43], v[68:71], v[104:107]
ds_read_b64_tr_b16 v[124:125], v11 offset:12288
v_xor_b32 v3, 16384, v3
v_mfma_f32_16x16x32_bf16 v[108:111], a[44:47], v[68:71], v[108:111]
s_waitcnt vmcnt(15)
ds_read_b64_tr_b16 v[126:127], v11 offset:13312
v_xor_b32 v7, 16384, v7
buffer_load_dwordx4 v[68:71], v1, s[8:11], s24 offen offset:1024 sc1
buffer_store_dwordx2 v[12:13], v4, s[12:15], s53 offen
L_opl_t1:
v_mfma_f32_16x16x32_bf16 v[96:99], a[48:51], v[72:75], v[96:99]
v_mfma_f32_16x16x32_bf16 v[100:103], a[52:55], v[72:75], v[100:103]
v_mfma_f32_16x16x32_bf16 v[104:107], a[56:59], v[72:75], v[104:107]
v_mfma_f32_16x16x32_bf16 v[108:111], a[60:63], v[72:75], v[108:111]
s_waitcnt vmcnt(16) lgkmcnt(0)
buffer_load_dwordx4 v[72:75], v1, s[8:11], s24 offen offset:2048 sc1
v_mfma_f32_16x16x32_bf16 v[96:99], v[112:115], v[76:79], v[96:99]
s_waitcnt vmcnt(13)
v_cmp_ne_u32 vcc, 1, v6
v_mfma_f32_16x16x32_bf16 v[100:103], v[116:119], v[76:79], v[100:103]
v_mfma_f32_16x16x32_bf16 v[104:107], v[120:123], v[76:79], v[104:107]
s_cmp_eq_u64 vcc, 0
s_cselect_b32 s50, s52, 0
v_mfma_f32_16x16x32_bf16 v[108:111], v[124:127], v[76:79], v[108:111]
s_waitcnt vmcnt(16)
buffer_load_dwordx4 v[76:79], v1, s[8:11], s24 offen offset:3072 sc1
v_mfma_f32_16x16x32_bf16 v[96:99], a[64:67], v[16:19], v[96:99]
s_cmp_eq_u32 s50, 1
s_cselect_b32 s49, s49, 536870912
ds_read_b64_tr_b16 v[112:113], v8 offset:16384
v_mfma_f32_16x16x32_bf16 v[100:103], a[68:71], v[16:19], v[100:103]
ds_read_b64_tr_b16 v[114:115], v8 offset:17408
v_mfma_f32_16x16x32_bf16 v[104:107], a[72:75], v[16:19], v[104:107]
s_add_u32 s24, s49, s30
ds_read_b64_tr_b16 v[116:117], v9 offset:16384
v_mfma_f32_16x16x32_bf16 v[108:111], a[76:79], v[16:19], v[108:111]
s_waitcnt vmcnt(16)
ds_read_b64_tr_b16 v[118:119], v9 offset:17408
buffer_load_dwordx4 v[16:19], v1, s[8:11], s24 offen sc1
v_mfma_f32_16x16x32_bf16 v[96:99], a[80:83], v[20:23], v[96:99]
ds_read_b64_tr_b16 v[120:121], v10 offset:16384
v_mfma_f32_16x16x32_bf16 v[100:103], a[84:87], v[20:23], v[100:103]
ds_read_b64_tr_b16 v[122:123], v10 offset:17408
v_mfma_f32_16x16x32_bf16 v[104:107], a[88:91], v[20:23], v[104:107]
ds_read_b64_tr_b16 v[124:125], v11 offset:16384
v_mfma_f32_16x16x32_bf16 v[108:111], a[92:95], v[20:23], v[108:111]
s_waitcnt vmcnt(16)
ds_read_b64_tr_b16 v[126:127], v11 offset:17408
buffer_load_dwordx4 v[20:23], v1, s[8:11], s24 offen offset:1024 sc1
v_mfma_f32_16x16x32_bf16 v[96:99], a[96:99], v[24:27], v[96:99]
v_mfma_f32_16x16x32_bf16 v[100:103], a[100:103], v[24:27], v[100:103]
v_mfma_f32_16x16x32_bf16 v[104:107], a[104:107], v[24:27], v[104:107]
v_mfma_f32_16x16x32_bf16 v[108:111], a[108:111], v[24:27], v[108:111]
s_waitcnt vmcnt(15) lgkmcnt(0)
buffer_load_dwordx4 v[24:27], v1, s[8:11], s24 offen offset:2048 sc1
v_mfma_f32_16x16x32_bf16 v[96:99], v[112:115], v[28:31], v[96:99]
v_mfma_f32_16x16x32_bf16 v[100:103], v[116:119], v[28:31], v[100:103]
v_mfma_f32_16x16x32_bf16 v[104:107], v[120:123], v[28:31], v[104:107]
v_mfma_f32_16x16x32_bf16 v[108:111], v[124:127], v[28:31], v[108:111]
s_waitcnt vmcnt(15)
buffer_load_dwordx4 v[28:31], v1, s[8:11], s24 offen offset:3072 sc1
v_mfma_f32_16x16x32_bf16 v[96:99], a[112:115], v[32:35], v[96:99]
ds_read_b64_tr_b16 v[112:113], v8 offset:20480
v_mfma_f32_16x16x32_bf16 v[100:103], a[116:119], v[32:35], v[100:103]
ds_read_b64_tr_b16 v[114:115], v8 offset:21504
v_mfma_f32_16x16x32_bf16 v[104:107], a[120:123], v[32:35], v[104:107]
s_add_u32 s24, s49, s31
ds_read_b64_tr_b16 v[116:117], v9 offset:20480
v_mfma_f32_16x16x32_bf16 v[108:111], a[124:127], v[32:35], v[108:111]
s_waitcnt vmcnt(15)
ds_read_b64_tr_b16 v[118:119], v9 offset:21504
buffer_load_dwordx4 v[32:35], v1, s[8:11], s24 offen sc1
v_mfma_f32_16x16x32_bf16 v[96:99], a[128:131], v[36:39], v[96:99]
ds_read_b64_tr_b16 v[120:121], v10 offset:20480
v_mfma_f32_16x16x32_bf16 v[100:103], a[132:135], v[36:39], v[100:103]
ds_read_b64_tr_b16 v[122:123], v10 offset:21504
v_mfma_f32_16x16x32_bf16 v[104:107], a[136:139], v[36:39], v[104:107]
ds_read_b64_tr_b16 v[124:125], v11 offset:20480
v_mfma_f32_16x16x32_bf16 v[108:111], a[140:143], v[36:39], v[108:111]
s_waitcnt vmcnt(15)
ds_read_b64_tr_b16 v[126:127], v11 offset:21504
buffer_load_dwordx4 v[36:39], v1, s[8:11], s24 offen offset:1024 sc1
v_mfma_f32_16x16x32_bf16 v[96:99], a[144:147], v[40:43], v[96:99]
v_mfma_f32_16x16x32_bf16 v[100:103], a[148:151], v[40:43], v[100:103]
v_mfma_f32_16x16x32_bf16 v[104:107], a[152:155], v[40:43], v[104:107]
v_mfma_f32_16x16x32_bf16 v[108:111], a[156:159], v[40:43], v[108:111]
s_waitcnt vmcnt(15) lgkmcnt(0)
buffer_load_dwordx4 v[40:43], v1, s[8:11], s24 offen offset:2048 sc1
v_mfma_f32_16x16x32_bf16 v[96:99], v[112:115], v[44:47], v[96:99]
v_mfma_f32_16x16x32_bf16 v[100:103], v[116:119], v[44:47], v[100:103]
v_mfma_f32_16x16x32_bf16 v[104:107], v[120:123], v[44:47], v[104:107]
v_mfma_f32_16x16x32_bf16 v[108:111], v[124:127], v[44:47], v[108:111]
s_waitcnt vmcnt(15)
buffer_load_dwordx4 v[44:47], v1, s[8:11], s24 offen offset:3072 sc1
v_mfma_f32_16x16x32_bf16 v[96:99], a[160:163], v[48:51], v[96:99]
ds_read_b64_tr_b16 v[112:113], v8 offset:24576
v_mfma_f32_16x16x32_bf16 v[100:103], a[164:167], v[48:51], v[100:103]
ds_read_b64_tr_b16 v[114:115], v8 offset:25600
v_mfma_f32_16x16x32_bf16 v[104:107], a[168:171], v[48:51], v[104:107]
s_add_u32 s24, s49, s32
ds_read_b64_tr_b16 v[116:117], v9 offset:24576
v_mfma_f32_16x16x32_bf16 v[108:111], a[172:175], v[48:51], v[108:111]
s_waitcnt vmcnt(15)
ds_read_b64_tr_b16 v[118:119], v9 offset:25600
buffer_load_dwordx4 v[48:51], v1, s[8:11], s24 offen sc1
v_mfma_f32_16x16x32_bf16 v[96:99], a[176:179], v[52:55], v[96:99]
ds_read_b64_tr_b16 v[120:121], v10 offset:24576
v_mfma_f32_16x16x32_bf16 v[100:103], a[180:183], v[52:55], v[100:103]
ds_read_b64_tr_b16 v[122:123], v10 offset:25600
v_mfma_f32_16x16x32_bf16 v[104:107], a[184:187], v[52:55], v[104:107]
ds_read_b64_tr_b16 v[124:125], v11 offset:24576
v_mfma_f32_16x16x32_bf16 v[108:111], a[188:191], v[52:55], v[108:111]
s_waitcnt vmcnt(15)
ds_read_b64_tr_b16 v[126:127], v11 offset:25600
buffer_load_dwordx4 v[52:55], v1, s[8:11], s24 offen offset:1024 sc1
v_mfma_f32_16x16x32_bf16 v[96:99], a[192:195], v[56:59], v[96:99]
v_mfma_f32_16x16x32_bf16 v[100:103], a[196:199], v[56:59], v[100:103]
v_mfma_f32_16x16x32_bf16 v[104:107], a[200:203], v[56:59], v[104:107]
v_mfma_f32_16x16x32_bf16 v[108:111], a[204:207], v[56:59], v[108:111]
s_waitcnt vmcnt(15) lgkmcnt(0)
buffer_load_dwordx4 v[56:59], v1, s[8:11], s24 offen offset:2048 sc1
v_mfma_f32_16x16x32_bf16 v[96:99], v[112:115], v[60:63], v[96:99]
v_mfma_f32_16x16x32_bf16 v[100:103], v[116:119], v[60:63], v[100:103]
v_mfma_f32_16x16x32_bf16 v[104:107], v[120:123], v[60:63], v[104:107]
v_mfma_f32_16x16x32_bf16 v[108:111], v[124:127], v[60:63], v[108:111]
s_waitcnt vmcnt(15)
buffer_load_dwordx4 v[60:63], v1, s[8:11], s24 offen offset:3072 sc1
v_mfma_f32_16x16x32_bf16 v[96:99], a[208:211], v[64:67], v[96:99]
ds_read_b64_tr_b16 v[112:113], v8 offset:28672
v_mfma_f32_16x16x32_bf16 v[100:103], a[212:215], v[64:67], v[100:103]
ds_read_b64_tr_b16 v[114:115], v8 offset:29696
v_mfma_f32_16x16x32_bf16 v[104:107], a[216:219], v[64:67], v[104:107]
s_add_u32 s24, s49, s33
ds_read_b64_tr_b16 v[116:117], v9 offset:28672
v_mfma_f32_16x16x32_bf16 v[108:111], a[220:223], v[64:67], v[108:111]
s_waitcnt vmcnt(15)
ds_read_b64_tr_b16 v[118:119], v9 offset:29696
buffer_load_dwordx4 v[64:67], v1, s[8:11], s24 offen sc1
v_mfma_f32_16x16x32_bf16 v[96:99], a[224:227], v[68:71], v[96:99]
ds_read_b64_tr_b16 v[120:121], v10 offset:28672
v_mfma_f32_16x16x32_bf16 v[100:103], a[228:231], v[68:71], v[100:103]
ds_read_b64_tr_b16 v[122:123], v10 offset:29696
v_mfma_f32_16x16x32_bf16 v[104:107], a[232:235], v[68:71], v[104:107]
ds_read_b64_tr_b16 v[124:125], v11 offset:28672
v_mfma_f32_16x16x32_bf16 v[108:111], a[236:239], v[68:71], v[108:111]
s_waitcnt vmcnt(14)
ds_read_b64_tr_b16 v[126:127], v11 offset:29696
buffer_load_dwordx4 v[68:71], v1, s[8:11], s24 offen offset:1024 sc1
v_mfma_f32_16x16x32_bf16 v[96:99], a[240:243], v[72:75], v[96:99]
v_mfma_f32_16x16x32_bf16 v[100:103], a[244:247], v[72:75], v[100:103]
v_mfma_f32_16x16x32_bf16 v[104:107], a[248:251], v[72:75], v[104:107]
v_mfma_f32_16x16x32_bf16 v[108:111], a[252:255], v[72:75], v[108:111]
s_waitcnt vmcnt(14) lgkmcnt(0)
buffer_load_dwordx4 v[72:75], v1, s[8:11], s24 offen offset:2048 sc1
v_mfma_f32_16x16x32_bf16 v[96:99], v[112:115], v[76:79], v[96:99]
v_mfma_f32_16x16x32_bf16 v[100:103], v[116:119], v[76:79], v[100:103]
v_mfma_f32_16x16x32_bf16 v[104:107], v[120:123], v[76:79], v[104:107]
v_mfma_f32_16x16x32_bf16 v[108:111], v[124:127], v[76:79], v[108:111]
s_waitcnt vmcnt(14)
buffer_load_dwordx4 v[76:79], v1, s[8:11], s24 offen offset:3072 sc1
s_mul_i32 s53, s41, 36864
s_mov_b32 s41, s27
s_mov_b32 s48, s49
s_cmp_eq_u32 s50, 0
s_cbranch_scc0 L_opl_r0
L_opl_c1:
ds_write_b128 v3, v[96:99]
ds_write_b128 v3, v[100:103] offset:4096
ds_write_b128 v3, v[104:107] offset:8192
ds_write_b128 v3, v[108:111] offset:12288
s_waitcnt lgkmcnt(0)
s_barrier
ds_read_b128 v[96:99], v7
ds_read_b128 v[100:103], v7 offset:1024
ds_read_b128 v[104:107], v7 offset:2048
ds_read_b128 v[108:111], v7 offset:3072
s_waitcnt lgkmcnt(2)
v_pk_add_f32 v[96:97], v[96:97], v[100:101]
v_pk_add_f32 v[98:99], v[98:99], v[102:103]
s_waitcnt lgkmcnt(1)
v_pk_add_f32 v[96:97], v[96:97], v[104:105]
v_pk_add_f32 v[98:99], v[98:99], v[106:107]
s_waitcnt lgkmcnt(0)
v_pk_add_f32 v[96:97], v[96:97], v[108:109]
v_pk_add_f32 v[98:99], v[98:99], v[110:111]
v_cvt_pk_bf16_f32 v12, v96, v97
v_cvt_pk_bf16_f32 v13, v98, v99
buffer_store_dwordx2 v[12:13], v4, s[12:15], s53 offen
v_xor_b32 v3, 16384, v3
v_xor_b32 v7, 16384, v7
s_cmp_lg_u32 s52, 0
s_cbranch_scc1 L_opl_w
s_branch L_opl_x
L_opl_c0:
ds_write_b128 v3, v[80:83]
ds_write_b128 v3, v[84:87] offset:4096
ds_write_b128 v3, v[88:91] offset:8192
ds_write_b128 v3, v[92:95] offset:12288
s_waitcnt lgkmcnt(0)
s_barrier
ds_read_b128 v[80:83], v7
ds_read_b128 v[84:87], v7 offset:1024
ds_read_b128 v[88:91], v7 offset:2048
ds_read_b128 v[92:95], v7 offset:3072
s_waitcnt lgkmcnt(2)
v_pk_add_f32 v[80:81], v[80:81], v[84:85]
v_pk_add_f32 v[82:83], v[82:83], v[86:87]
s_waitcnt lgkmcnt(1)
v_pk_add_f32 v[80:81], v[80:81], v[88:89]
v_pk_add_f32 v[82:83], v[82:83], v[90:91]
s_waitcnt lgkmcnt(0)
v_pk_add_f32 v[80:81], v[80:81], v[92:93]
v_pk_add_f32 v[82:83], v[82:83], v[94:95]
v_cvt_pk_bf16_f32 v12, v80, v81
v_cvt_pk_bf16_f32 v13, v82, v83
buffer_store_dwordx2 v[12:13], v4, s[12:15], s53 offen
v_xor_b32 v3, 16384, v3
v_xor_b32 v7, 16384, v7
s_cmp_lg_u32 s52, 0
s_cbranch_scc1 L_opl_w
L_opl_x:
s_branch L_done
L_team:
s_load_dwordx8 s[88:95], s[0:1], 64
s_load_dwordx2 s[96:97], s[0:1], 56
v_mov_b32 v12, v0
v_and_b32 v13, 15, v0
v_bfe_u32 v14, v0, 4, 2
v_lshlrev_b32 v3, 4, v12
v_and_b32 v2, 0x3f0, v3
s_mul_i32 s20, s17, 34816
s_add_u32 s20, s20, 24576
v_add_u32 v2, s20, v2
v_and_b32 v15, 1, v12
v_mul_u32_u24 v0, 0xaaaa, v15
v_add_u32 v0, 0xffff4444, v0
v_lshrrev_b32 v18, 2, v13
v_lshl_add_u32 v18, v18, 1, v15
v_bfe_u32 v19, v13, 1, 1
v_lshrrev_b32 v16, 5, v12
v_lshlrev_b32 v16, 8, v16
v_lshl_add_u32 v16, v18, 5, v16
v_and_b32 v17, 1, v14
v_lshl_add_u32 v16, v17, 4, v16
v_and_b32 v17, 0x7f, v16
v_xor_b32 v17, 16, v17
v_add_u32 v16, 4224, v16
v_add_u32 v17, 6272, v17
v_cmp_eq_u32 vcc, 1, v19
s_nop 1
v_cndmask_b32 v7, v17, v16, vcc
v_lshrrev_b32 v16, 1, v14
v_lshlrev_b32 v16, 8, v16
v_lshl_add_u32 v16, v15, 7, v16
v_and_b32 v17, 1, v14
v_lshl_add_u32 v16, v17, 6, v16
v_lshrrev_b32 v17, 2, v13
v_lshl_add_u32 v16, v17, 4, v16
v_mul_u32_u24 v17, 2112, v19
v_add_u32 v5, v16, v17
v_bfe_u32 v16, v13, 3, 1
v_lshlrev_b32 v16, 8, v16
v_lshl_add_u32 v16, v19, 6, v16
v_lshl_add_u32 v16, v14, 4, v16
v_bfe_u32 v17, v13, 2, 1
v_lshl_add_u32 v16, v17, 3, v16
v_lshl_add_u32 v16, v15, 2, v16
s_lshl_b32 s20, s17, 9
v_add_u32 v4, s20, v16
v_lshrrev_b32 v16, 4, v12
v_xor_b32 v17, s16, v16
v_lshlrev_b32 v16, 12, v16
v_lshl_add_u32 v16, v17, 7, v16
v_lshl_add_u32 v9, v13, 3, v16
s_lshr_b32 s20, s17, 1
s_lshl_b32 s20, s20, 2
v_add_u32 v16, s20, v14
v_xor_b32 v17, s16, v16
v_lshlrev_b32 v16, 12, v16
v_lshl_add_u32 v16, v17, 7, v16
v_lshl_add_u32 v16, v13, 2, v16
s_and_b32 s20, s17, 1
s_lshl_b32 s20, s20, 6
s_add_u32 s20, s20, 262144
v_add_u32 v10, s20, v16
v_bfe_u32 v16, v13, 2, 1
v_lshlrev_b32 v16, 5, v16
v_and_b32 v17, 1, v14
v_lshl_add_u32 v16, v17, 8, v16
v_lshrrev_b32 v17, 1, v14
v_lshl_add_u32 v16, v17, 4, v16
v_and_b32 v17, 3, v13
v_lshl_add_u32 v11, v17, 2, v16
v_lshlrev_b32 v6, 7, v12
v_lshlrev_b32 v8, 2, v12
s_mov_b32 s36, 0x11111111
s_mov_b32 s37, 0x11111111
s_mov_b32 s38, 0x22222222
s_mov_b32 s39, 0x22222222
s_mov_b32 s40, 0x44444444
s_mov_b32 s41, 0x44444444
s_mov_b32 s42, 0x88888888
s_mov_b32 s43, 0x88888888
s_mov_b32 s44, 0xf0f0f0f0
s_mov_b32 s45, 0xf0f0f0f0
s_mov_b32 s18, 0x3e0293ee
s_lshl_b32 s20, s17, 5
s_add_u32 s20, s20, s16
s_cmp_lt_u32 s20, 72
s_cselect_b32 s48, 1, 0
s_lshl_b32 s23, s20, 12
s_lshl_b32 s21, s17, 10
s_sub_u32 s23, s23, s21
s_lshr_b32 s24, s20, 2
s_lshl_b32 s24, s24, 9
s_and_b32 s21, s20, 3
s_lshl_b32 s21, s21, 6
s_add_u32 s24, s24, s21
s_add_u32 s24, s24, 110100480
s_cmp_lt_u32 s20, 72
s_cselect_b32 s24, s24, 536870912
s_lshl_b32 s25, s16, 12
s_add_u32 s26, s25, 131072
s_add_u32 s27, s25, 262144
s_cmp_lt_u32 s16, 8
s_cselect_b32 s27, s27, 536870912
s_mov_b32 s28, 109051904
s_mov_b32 s29, 109346816
s_lshl_b32 s30, s16, 14
s_add_u32 s30, s30, 33554432
s_lshl_b32 s31, s16, 12
s_add_u32 s31, s31, 100663296
s_add_u32 s35, s24, 32768
s_mov_b32 s53, 0x3f803f80
s_mov_b32 s86, 0x33333333
s_mov_b32 s87, 0x33333333
s_lshl_b32 s84, s17, 13
s_sub_u32 s84, s20, s84
s_add_u32 s84, s84, 110886912
s_cmp_lt_u32 s20, 72
s_cselect_b32 s84, s84, 536870912
s_and_b32 s21, s16, 3
s_lshl_b32 s21, s21, 7
s_add_u32 s21, s21, 110886144
s_cmp_eq_u32 s17, 3
s_cselect_b32 s84, s21, s84
s_lshl_b32 s82, s16, 7
s_add_u32 s83, s82, 111152384
s_add_u32 s82, s82, 111148288
s_mov_b32 s19, 0
v_mov_b32 v64, -1
v_mov_b32 v65, -1
v_mov_b32 v66, -1
v_mov_b32 v67, -1
s_add_u32 s20, s28, s25
buffer_store_dwordx4 v[64:67], v3, s[8:11], s20 offen
s_add_u32 s20, s28, s26
buffer_store_dwordx4 v[64:67], v3, s[8:11], s20 offen
s_add_u32 s20, s28, s27
buffer_store_dwordx4 v[64:67], v3, s[8:11], s20 offen
s_add_u32 s20, s29, s25
buffer_store_dwordx4 v[64:67], v3, s[8:11], s20 offen
s_add_u32 s20, s29, s26
buffer_store_dwordx4 v[64:67], v3, s[8:11], s20 offen
s_add_u32 s20, s29, s27
buffer_store_dwordx4 v[64:67], v3, s[8:11], s20 offen
s_add_u32 s20, s24, 16384
buffer_store_dword v64, v11, s[8:11], s20 offen
s_cmp_eq_u32 s17, 3
s_cselect_b32 s20, 536870912, s84
s_mov_b64 exec, 15
buffer_store_byte v64, v6, s[8:11], s20 offen
s_mov_b64 exec, -1
v_lshrrev_b32 v0, 4, v3
s_waitcnt lgkmcnt(0)
s_mov_b32 s46, 0x05040100
s_mov_b32 s47, 0x07060302
v_and_b32 v3, 63, v0
v_lshlrev_b32 v3, 4, v3
s_mul_i32 s20, s17, 34816
s_add_u32 s20, s20, 24576
v_add_u32 v3, s20, v3
v_bfe_u32 v64, v0, 5, 1
v_bfe_u32 v65, v0, 4, 1
v_and_b32 v66, 15, v0
v_lshlrev_b32 v1, 17, v64
v_lshl_add_u32 v1, v65, 14, v1
v_lshl_add_u32 v1, v66, 2, v1
s_lshl_b32 s20, s16, 8
s_lshl_b32 s21, s17, 6
s_add_u32 s20, s20, s21
v_add_u32 v1, s20, v1
v_lshlrev_b32 v2, 4, v64
v_lshl_add_u32 v2, v65, 2, v2
v_mul_u32_u24 v2, 1152, v2
s_mul_i32 s20, s16, 147456
v_add_u32 v2, s20, v2
v_and_b32 v4, 15, v0
s_lshl_b32 s20, s17, 4
v_add_u32 v4, s20, v4
v_lshlrev_b32 v4, 1, v4
v_add_u32 v2, v2, v4
v_add_u32 v4, v2, v4
s_barrier
s_mov_b32 s12, s90
s_and_b32 s13, s91, 0xffff
s_mov_b32 s14, 4718592
s_mov_b32 s15, 0x20000
s_mov_b32 s20, 0
buffer_load_dword v6, v1, s[12:15], s20 offen
s_mov_b32 s21, 32768
buffer_load_dword v7, v1, s[12:15], s21 offen
s_mov_b32 s20, 65536
buffer_load_dword v8, v1, s[12:15], s20 offen
s_mov_b32 s21, 98304
buffer_load_dword v9, v1, s[12:15], s21 offen
s_mov_b32 s20, 8192
buffer_load_dword v10, v1, s[12:15], s20 offen
s_mov_b32 s21, 40960
buffer_load_dword v11, v1, s[12:15], s21 offen
s_mov_b32 s20, 73728
buffer_load_dword v12, v1, s[12:15], s20 offen
s_mov_b32 s21, 106496
buffer_load_dword v13, v1, s[12:15], s21 offen
s_barrier
s_mov_b32 s20, 262144
buffer_load_dword v14, v1, s[12:15], s20 offen
s_mov_b32 s21, 294912
buffer_load_dword v15, v1, s[12:15], s21 offen
s_mov_b32 s20, 327680
buffer_load_dword v16, v1, s[12:15], s20 offen
s_mov_b32 s21, 360448
buffer_load_dword v17, v1, s[12:15], s21 offen
s_mov_b32 s20, 270336
buffer_load_dword v18, v1, s[12:15], s20 offen
s_mov_b32 s21, 303104
buffer_load_dword v19, v1, s[12:15], s21 offen
s_mov_b32 s20, 335872
buffer_load_dword v20, v1, s[12:15], s20 offen
s_mov_b32 s21, 368640
buffer_load_dword v21, v1, s[12:15], s21 offen
s_barrier
s_mov_b32 s12, s92
s_and_b32 s13, s93, 0xffff
s_mov_b32 s14, 4718592
s_mov_b32 s15, 0x20000
s_mov_b32 s20, 0
buffer_load_dword v22, v1, s[12:15], s20 offen
s_mov_b32 s21, 32768
buffer_load_dword v23, v1, s[12:15], s21 offen
s_mov_b32 s20, 65536
buffer_load_dword v24, v1, s[12:15], s20 offen
s_mov_b32 s21, 98304
buffer_load_dword v25, v1, s[12:15], s21 offen
s_mov_b32 s20, 8192
buffer_load_dword v26, v1, s[12:15], s20 offen
s_mov_b32 s21, 40960
buffer_load_dword v27, v1, s[12:15], s21 offen
s_mov_b32 s20, 73728
buffer_load_dword v28, v1, s[12:15], s20 offen
s_mov_b32 s21, 106496
buffer_load_dword v29, v1, s[12:15], s21 offen
s_barrier
s_mov_b32 s20, 262144
buffer_load_dword v30, v1, s[12:15], s20 offen
s_mov_b32 s21, 294912
buffer_load_dword v31, v1, s[12:15], s21 offen
s_mov_b32 s20, 327680
buffer_load_dword v32, v1, s[12:15], s20 offen
s_mov_b32 s21, 360448
buffer_load_dword v33, v1, s[12:15], s21 offen
s_mov_b32 s20, 270336
buffer_load_dword v34, v1, s[12:15], s20 offen
s_mov_b32 s21, 303104
buffer_load_dword v35, v1, s[12:15], s21 offen
s_mov_b32 s20, 335872
buffer_load_dword v36, v1, s[12:15], s20 offen
s_mov_b32 s21, 368640
buffer_load_dword v37, v1, s[12:15], s21 offen
s_barrier
s_mov_b32 s12, s90
s_and_b32 s13, s91, 0xffff
s_mov_b32 s14, 4718592
s_mov_b32 s15, 0x20000
s_mov_b32 s20, 524288
buffer_load_dword v38, v1, s[12:15], s20 offen
s_mov_b32 s21, 557056
buffer_load_dword v39, v1, s[12:15], s21 offen
s_mov_b32 s20, 589824
buffer_load_dword v40, v1, s[12:15], s20 offen
s_mov_b32 s21, 622592
buffer_load_dword v41, v1, s[12:15], s21 offen
s_mov_b32 s20, 532480
buffer_load_dword v42, v1, s[12:15], s20 offen
s_mov_b32 s21, 565248
buffer_load_dword v43, v1, s[12:15], s21 offen
s_mov_b32 s20, 598016
buffer_load_dword v44, v1, s[12:15], s20 offen
s_mov_b32 s21, 630784
buffer_load_dword v45, v1, s[12:15], s21 offen
s_barrier
s_mov_b32 s20, 786432
buffer_load_dword v46, v1, s[12:15], s20 offen
s_mov_b32 s21, 819200
buffer_load_dword v47, v1, s[12:15], s21 offen
s_mov_b32 s20, 851968
buffer_load_dword v48, v1, s[12:15], s20 offen
s_mov_b32 s21, 884736
buffer_load_dword v49, v1, s[12:15], s21 offen
s_mov_b32 s20, 794624
buffer_load_dword v50, v1, s[12:15], s20 offen
s_mov_b32 s21, 827392
buffer_load_dword v51, v1, s[12:15], s21 offen
s_mov_b32 s20, 860160
buffer_load_dword v52, v1, s[12:15], s20 offen
s_mov_b32 s21, 892928
buffer_load_dword v53, v1, s[12:15], s21 offen
s_barrier
s_mov_b32 s12, s92
s_and_b32 s13, s93, 0xffff
s_mov_b32 s14, 4718592
s_mov_b32 s15, 0x20000
s_mov_b32 s20, 524288
buffer_load_dword v54, v1, s[12:15], s20 offen
s_mov_b32 s21, 557056
buffer_load_dword v55, v1, s[12:15], s21 offen
s_mov_b32 s20, 589824
buffer_load_dword v56, v1, s[12:15], s20 offen
s_mov_b32 s21, 622592
buffer_load_dword v57, v1, s[12:15], s21 offen
s_mov_b32 s20, 532480
buffer_load_dword v58, v1, s[12:15], s20 offen
s_mov_b32 s21, 565248
buffer_load_dword v59, v1, s[12:15], s21 offen
s_mov_b32 s20, 598016
buffer_load_dword v60, v1, s[12:15], s20 offen
s_mov_b32 s21, 630784
buffer_load_dword v61, v1, s[12:15], s21 offen
s_waitcnt vmcnt(54)
v_perm_b32 v88, v7, v6, s46
v_perm_b32 v68, v7, v6, s47
s_barrier
s_mov_b32 s20, 786432
buffer_load_dword v6, v1, s[12:15], s20 offen
s_mov_b32 s21, 819200
buffer_load_dword v7, v1, s[12:15], s21 offen
s_waitcnt vmcnt(54)
v_perm_b32 v89, v9, v8, s46
v_perm_b32 v69, v9, v8, s47
s_mov_b32 s20, 851968
buffer_load_dword v8, v1, s[12:15], s20 offen
s_mov_b32 s21, 884736
buffer_load_dword v9, v1, s[12:15], s21 offen
s_waitcnt vmcnt(54)
v_perm_b32 v90, v11, v10, s46
v_perm_b32 v70, v11, v10, s47
s_mov_b32 s20, 794624
buffer_load_dword v10, v1, s[12:15], s20 offen
s_mov_b32 s21, 827392
buffer_load_dword v11, v1, s[12:15], s21 offen
s_waitcnt vmcnt(54)
v_perm_b32 v91, v13, v12, s46
v_perm_b32 v71, v13, v12, s47
ds_write_b128 v3, v[68:71]
s_waitcnt lgkmcnt(0)
s_mov_b32 s20, 860160
buffer_load_dword v12, v1, s[12:15], s20 offen
s_mov_b32 s21, 892928
buffer_load_dword v13, v1, s[12:15], s21 offen
s_waitcnt vmcnt(54)
v_perm_b32 v92, v15, v14, s46
v_perm_b32 v68, v15, v14, s47
s_barrier
s_cmp_eq_u32 s17, 0
s_cselect_b32 s98, 64, 536870912
v_mov_b32 v5, 1
s_mov_b64 exec, 1
buffer_atomic_add v5, v0, s[56:59], s98 offen
s_mov_b64 exec, -1
s_mov_b32 s12, s90
s_and_b32 s13, s91, 0xffff
s_mov_b32 s14, 4718592
s_mov_b32 s15, 0x20000
s_mov_b32 s20, 1048576
buffer_load_dword v14, v1, s[12:15], s20 offen
s_mov_b32 s21, 1081344
buffer_load_dword v15, v1, s[12:15], s21 offen
s_waitcnt vmcnt(55)
v_perm_b32 v93, v17, v16, s46
v_perm_b32 v69, v17, v16, s47
s_mov_b32 s20, 1114112
buffer_load_dword v16, v1, s[12:15], s20 offen
s_mov_b32 s21, 1146880
buffer_load_dword v17, v1, s[12:15], s21 offen
s_waitcnt vmcnt(55)
v_perm_b32 v94, v19, v18, s46
v_perm_b32 v70, v19, v18, s47
s_mov_b32 s20, 1056768
buffer_load_dword v18, v1, s[12:15], s20 offen
s_mov_b32 s21, 1089536
buffer_load_dword v19, v1, s[12:15], s21 offen
s_waitcnt vmcnt(55)
v_perm_b32 v95, v21, v20, s46
v_perm_b32 v71, v21, v20, s47
ds_write_b128 v3, v[68:71] offset:1024
s_waitcnt lgkmcnt(0)
s_mov_b32 s20, 1122304
buffer_load_dword v20, v1, s[12:15], s20 offen
s_mov_b32 s21, 1155072
buffer_load_dword v21, v1, s[12:15], s21 offen
s_waitcnt vmcnt(55)
v_perm_b32 v64, v23, v22, s46
v_accvgpr_write_b32 a32, v64
v_perm_b32 v68, v23, v22, s47
v_accvgpr_write_b32 a40, v68
s_barrier
s_mov_b32 s20, 1310720
buffer_load_dword v22, v1, s[12:15], s20 offen
s_mov_b32 s21, 1343488
buffer_load_dword v23, v1, s[12:15], s21 offen
s_waitcnt vmcnt(55)
v_perm_b32 v65, v25, v24, s46
v_accvgpr_write_b32 a33, v65
v_perm_b32 v69, v25, v24, s47
v_accvgpr_write_b32 a41, v69
s_mov_b32 s20, 1376256
buffer_load_dword v24, v1, s[12:15], s20 offen
s_mov_b32 s21, 1409024
buffer_load_dword v25, v1, s[12:15], s21 offen
s_waitcnt vmcnt(55)
v_perm_b32 v66, v27, v26, s46
v_accvgpr_write_b32 a34, v66
v_perm_b32 v70, v27, v26, s47
v_accvgpr_write_b32 a42, v70
s_mov_b32 s20, 1318912
buffer_load_dword v26, v1, s[12:15], s20 offen
s_mov_b32 s21, 1351680
buffer_load_dword v27, v1, s[12:15], s21 offen
s_waitcnt vmcnt(55)
v_perm_b32 v67, v29, v28, s46
v_accvgpr_write_b32 a35, v67
v_perm_b32 v71, v29, v28, s47
v_accvgpr_write_b32 a43, v71
s_mov_b32 s20, 1384448
buffer_load_dword v28, v1, s[12:15], s20 offen
s_mov_b32 s21, 1417216
buffer_load_dword v29, v1, s[12:15], s21 offen
s_waitcnt vmcnt(55)
v_perm_b32 v64, v31, v30, s46
v_accvgpr_write_b32 a36, v64
v_perm_b32 v68, v31, v30, s47
v_accvgpr_write_b32 a44, v68
s_barrier
s_mov_b32 s12, s92
s_and_b32 s13, s93, 0xffff
s_mov_b32 s14, 4718592
s_mov_b32 s15, 0x20000
s_mov_b32 s20, 1048576
buffer_load_dword v30, v1, s[12:15], s20 offen
s_mov_b32 s21, 1081344
buffer_load_dword v31, v1, s[12:15], s21 offen
s_waitcnt vmcnt(55)
v_perm_b32 v65, v33, v32, s46
v_accvgpr_write_b32 a37, v65
v_perm_b32 v69, v33, v32, s47
v_accvgpr_write_b32 a45, v69
s_mov_b32 s20, 1114112
buffer_load_dword v32, v1, s[12:15], s20 offen
s_mov_b32 s21, 1146880
buffer_load_dword v33, v1, s[12:15], s21 offen
s_waitcnt vmcnt(55)
v_perm_b32 v66, v35, v34, s46
v_accvgpr_write_b32 a38, v66
v_perm_b32 v70, v35, v34, s47
v_accvgpr_write_b32 a46, v70
s_mov_b32 s20, 1056768
buffer_load_dword v34, v1, s[12:15], s20 offen
s_mov_b32 s21, 1089536
buffer_load_dword v35, v1, s[12:15], s21 offen
s_waitcnt vmcnt(55)
v_perm_b32 v67, v37, v36, s46
v_accvgpr_write_b32 a39, v67
v_perm_b32 v71, v37, v36, s47
v_accvgpr_write_b32 a47, v71
s_mov_b32 s20, 1122304
buffer_load_dword v36, v1, s[12:15], s20 offen
s_mov_b32 s21, 1155072
buffer_load_dword v37, v1, s[12:15], s21 offen
s_waitcnt vmcnt(55)
v_perm_b32 v112, v39, v38, s46
v_perm_b32 v68, v39, v38, s47
s_barrier
s_mov_b32 s20, 1310720
buffer_load_dword v38, v1, s[12:15], s20 offen
s_mov_b32 s21, 1343488
buffer_load_dword v39, v1, s[12:15], s21 offen
s_waitcnt vmcnt(55)
v_perm_b32 v113, v41, v40, s46
v_perm_b32 v69, v41, v40, s47
s_mov_b32 s20, 1376256
buffer_load_dword v40, v1, s[12:15], s20 offen
s_mov_b32 s21, 1409024
buffer_load_dword v41, v1, s[12:15], s21 offen
s_waitcnt vmcnt(55)
v_perm_b32 v114, v43, v42, s46
v_perm_b32 v70, v43, v42, s47
s_mov_b32 s20, 1318912
buffer_load_dword v42, v1, s[12:15], s20 offen
s_mov_b32 s21, 1351680
buffer_load_dword v43, v1, s[12:15], s21 offen
s_waitcnt vmcnt(55)
v_perm_b32 v115, v45, v44, s46
v_perm_b32 v71, v45, v44, s47
ds_write_b128 v3, v[68:71] offset:2048
s_waitcnt lgkmcnt(0)
s_mov_b32 s20, 1384448
buffer_load_dword v44, v1, s[12:15], s20 offen
s_mov_b32 s21, 1417216
buffer_load_dword v45, v1, s[12:15], s21 offen
s_waitcnt vmcnt(55)
v_perm_b32 v116, v47, v46, s46
v_perm_b32 v68, v47, v46, s47
s_barrier
s_mov_b32 s12, s90
s_and_b32 s13, s91, 0xffff
s_mov_b32 s14, 4718592
s_mov_b32 s15, 0x20000
s_mov_b32 s20, 1572864
buffer_load_dword v46, v1, s[12:15], s20 offen
s_mov_b32 s21, 1605632
buffer_load_dword v47, v1, s[12:15], s21 offen
s_waitcnt vmcnt(55)
v_perm_b32 v117, v49, v48, s46
v_perm_b32 v69, v49, v48, s47
s_mov_b32 s20, 1638400
buffer_load_dword v48, v1, s[12:15], s20 offen
s_mov_b32 s21, 1671168
buffer_load_dword v49, v1, s[12:15], s21 offen
s_waitcnt vmcnt(55)
v_perm_b32 v118, v51, v50, s46
v_perm_b32 v70, v51, v50, s47
s_mov_b32 s20, 1581056
buffer_load_dword v50, v1, s[12:15], s20 offen
s_mov_b32 s21, 1613824
buffer_load_dword v51, v1, s[12:15], s21 offen
s_waitcnt vmcnt(55)
v_perm_b32 v119, v53, v52, s46
v_perm_b32 v71, v53, v52, s47
ds_write_b128 v3, v[68:71] offset:3072
s_waitcnt lgkmcnt(0)
s_mov_b32 s20, 1646592
buffer_load_dword v52, v1, s[12:15], s20 offen
s_mov_b32 s21, 1679360
buffer_load_dword v53, v1, s[12:15], s21 offen
s_waitcnt vmcnt(55)
v_perm_b32 v64, v55, v54, s46
v_accvgpr_write_b32 a48, v64
v_perm_b32 v68, v55, v54, s47
v_accvgpr_write_b32 a56, v68
s_barrier
s_mov_b32 s20, 1835008
buffer_load_dword v54, v1, s[12:15], s20 offen
s_mov_b32 s21, 1867776
buffer_load_dword v55, v1, s[12:15], s21 offen
s_waitcnt vmcnt(55)
v_perm_b32 v65, v57, v56, s46
v_accvgpr_write_b32 a49, v65
v_perm_b32 v69, v57, v56, s47
v_accvgpr_write_b32 a57, v69
s_mov_b32 s20, 1900544
buffer_load_dword v56, v1, s[12:15], s20 offen
s_mov_b32 s21, 1933312
buffer_load_dword v57, v1, s[12:15], s21 offen
s_waitcnt vmcnt(55)
v_perm_b32 v66, v59, v58, s46
v_accvgpr_write_b32 a50, v66
v_perm_b32 v70, v59, v58, s47
v_accvgpr_write_b32 a58, v70
s_mov_b32 s20, 1843200
buffer_load_dword v58, v1, s[12:15], s20 offen
s_mov_b32 s21, 1875968
buffer_load_dword v59, v1, s[12:15], s21 offen
s_waitcnt vmcnt(55)
v_perm_b32 v67, v61, v60, s46
v_accvgpr_write_b32 a51, v67
v_perm_b32 v71, v61, v60, s47
v_accvgpr_write_b32 a59, v71
s_mov_b32 s20, 1908736
buffer_load_dword v60, v1, s[12:15], s20 offen
s_mov_b32 s21, 1941504
buffer_load_dword v61, v1, s[12:15], s21 offen
s_waitcnt vmcnt(55)
v_perm_b32 v64, v7, v6, s46
v_accvgpr_write_b32 a52, v64
v_perm_b32 v68, v7, v6, s47
v_accvgpr_write_b32 a60, v68
s_barrier
s_mov_b32 s12, s92
s_and_b32 s13, s93, 0xffff
s_mov_b32 s14, 4718592
s_mov_b32 s15, 0x20000
s_mov_b32 s20, 1572864
buffer_load_dword v6, v1, s[12:15], s20 offen
s_mov_b32 s21, 1605632
buffer_load_dword v7, v1, s[12:15], s21 offen
s_waitcnt vmcnt(55)
v_perm_b32 v65, v9, v8, s46
v_accvgpr_write_b32 a53, v65
v_perm_b32 v69, v9, v8, s47
v_accvgpr_write_b32 a61, v69
s_mov_b32 s20, 1638400
buffer_load_dword v8, v1, s[12:15], s20 offen
s_mov_b32 s21, 1671168
buffer_load_dword v9, v1, s[12:15], s21 offen
s_waitcnt vmcnt(55)
v_perm_b32 v66, v11, v10, s46
v_accvgpr_write_b32 a54, v66
v_perm_b32 v70, v11, v10, s47
v_accvgpr_write_b32 a62, v70
s_mov_b32 s20, 1581056
buffer_load_dword v10, v1, s[12:15], s20 offen
s_mov_b32 s21, 1613824
buffer_load_dword v11, v1, s[12:15], s21 offen
s_waitcnt vmcnt(55)
v_perm_b32 v67, v13, v12, s46
v_accvgpr_write_b32 a55, v67
v_perm_b32 v71, v13, v12, s47
v_accvgpr_write_b32 a63, v71
s_mov_b32 s20, 1646592
buffer_load_dword v12, v1, s[12:15], s20 offen
s_mov_b32 s21, 1679360
buffer_load_dword v13, v1, s[12:15], s21 offen
s_waitcnt vmcnt(54)
v_perm_b32 v136, v15, v14, s46
v_perm_b32 v68, v15, v14, s47
s_barrier
s_mov_b32 s20, 1835008
buffer_load_dword v14, v1, s[12:15], s20 offen
s_mov_b32 s21, 1867776
buffer_load_dword v15, v1, s[12:15], s21 offen
s_waitcnt vmcnt(54)
v_perm_b32 v137, v17, v16, s46
v_perm_b32 v69, v17, v16, s47
s_mov_b32 s20, 1900544
buffer_load_dword v16, v1, s[12:15], s20 offen
s_mov_b32 s21, 1933312
buffer_load_dword v17, v1, s[12:15], s21 offen
s_waitcnt vmcnt(54)
v_perm_b32 v138, v19, v18, s46
v_perm_b32 v70, v19, v18, s47
s_mov_b32 s20, 1843200
buffer_load_dword v18, v1, s[12:15], s20 offen
s_mov_b32 s21, 1875968
buffer_load_dword v19, v1, s[12:15], s21 offen
s_waitcnt vmcnt(54)
v_perm_b32 v139, v21, v20, s46
v_perm_b32 v71, v21, v20, s47
ds_write_b128 v3, v[68:71] offset:4096
s_waitcnt lgkmcnt(0)
s_mov_b32 s20, 1908736
buffer_load_dword v20, v1, s[12:15], s20 offen
s_mov_b32 s21, 1941504
buffer_load_dword v21, v1, s[12:15], s21 offen
s_waitcnt vmcnt(54)
v_perm_b32 v140, v23, v22, s46
v_perm_b32 v68, v23, v22, s47
s_barrier
s_mov_b32 s12, s90
s_and_b32 s13, s91, 0xffff
s_mov_b32 s14, 4718592
s_mov_b32 s15, 0x20000
s_mov_b32 s20, 2097152
buffer_load_dword v22, v1, s[12:15], s20 offen
s_mov_b32 s21, 2129920
buffer_load_dword v23, v1, s[12:15], s21 offen
s_waitcnt vmcnt(54)
v_perm_b32 v141, v25, v24, s46
v_perm_b32 v69, v25, v24, s47
s_mov_b32 s20, 2162688
buffer_load_dword v24, v1, s[12:15], s20 offen
s_mov_b32 s21, 2195456
buffer_load_dword v25, v1, s[12:15], s21 offen
s_waitcnt vmcnt(54)
v_perm_b32 v142, v27, v26, s46
v_perm_b32 v70, v27, v26, s47
s_mov_b32 s20, 2105344
buffer_load_dword v26, v1, s[12:15], s20 offen
s_mov_b32 s21, 2138112
buffer_load_dword v27, v1, s[12:15], s21 offen
s_waitcnt vmcnt(54)
v_perm_b32 v143, v29, v28, s46
v_perm_b32 v71, v29, v28, s47
ds_write_b128 v3, v[68:71] offset:5120
s_waitcnt lgkmcnt(0)
s_mov_b32 s20, 2170880
buffer_load_dword v28, v1, s[12:15], s20 offen
s_mov_b32 s21, 2203648
buffer_load_dword v29, v1, s[12:15], s21 offen
s_waitcnt vmcnt(54)
v_perm_b32 v64, v31, v30, s46
v_accvgpr_write_b32 a64, v64
v_perm_b32 v68, v31, v30, s47
v_accvgpr_write_b32 a72, v68
s_barrier
s_mov_b32 s20, 2359296
buffer_load_dword v30, v1, s[12:15], s20 offen
s_mov_b32 s21, 2392064
buffer_load_dword v31, v1, s[12:15], s21 offen
s_waitcnt vmcnt(54)
v_perm_b32 v65, v33, v32, s46
v_accvgpr_write_b32 a65, v65
v_perm_b32 v69, v33, v32, s47
v_accvgpr_write_b32 a73, v69
s_mov_b32 s20, 2424832
buffer_load_dword v32, v1, s[12:15], s20 offen
s_mov_b32 s21, 2457600
buffer_load_dword v33, v1, s[12:15], s21 offen
s_waitcnt vmcnt(54)
v_perm_b32 v66, v35, v34, s46
v_accvgpr_write_b32 a66, v66
v_perm_b32 v70, v35, v34, s47
v_accvgpr_write_b32 a74, v70
s_mov_b32 s20, 2367488
buffer_load_dword v34, v1, s[12:15], s20 offen
s_mov_b32 s21, 2400256
buffer_load_dword v35, v1, s[12:15], s21 offen
s_waitcnt vmcnt(54)
v_perm_b32 v67, v37, v36, s46
v_accvgpr_write_b32 a67, v67
v_perm_b32 v71, v37, v36, s47
v_accvgpr_write_b32 a75, v71
s_mov_b32 s20, 2433024
buffer_load_dword v36, v1, s[12:15], s20 offen
s_mov_b32 s21, 2465792
buffer_load_dword v37, v1, s[12:15], s21 offen
s_waitcnt vmcnt(54)
v_perm_b32 v64, v39, v38, s46
v_accvgpr_write_b32 a68, v64
v_perm_b32 v68, v39, v38, s47
v_accvgpr_write_b32 a76, v68
s_barrier
s_mov_b32 s12, s92
s_and_b32 s13, s93, 0xffff
s_mov_b32 s14, 4718592
s_mov_b32 s15, 0x20000
s_mov_b32 s20, 2097152
buffer_load_dword v38, v1, s[12:15], s20 offen
s_mov_b32 s21, 2129920
buffer_load_dword v39, v1, s[12:15], s21 offen
s_waitcnt vmcnt(54)
v_perm_b32 v65, v41, v40, s46
v_accvgpr_write_b32 a69, v65
v_perm_b32 v69, v41, v40, s47
v_accvgpr_write_b32 a77, v69
s_mov_b32 s20, 2162688
buffer_load_dword v40, v1, s[12:15], s20 offen
s_mov_b32 s21, 2195456
buffer_load_dword v41, v1, s[12:15], s21 offen
s_waitcnt vmcnt(54)
v_perm_b32 v66, v43, v42, s46
v_accvgpr_write_b32 a70, v66
v_perm_b32 v70, v43, v42, s47
v_accvgpr_write_b32 a78, v70
s_mov_b32 s20, 2105344
buffer_load_dword v42, v1, s[12:15], s20 offen
s_mov_b32 s21, 2138112
buffer_load_dword v43, v1, s[12:15], s21 offen
s_waitcnt vmcnt(54)
v_perm_b32 v67, v45, v44, s46
v_accvgpr_write_b32 a71, v67
v_perm_b32 v71, v45, v44, s47
v_accvgpr_write_b32 a79, v71
s_mov_b32 s20, 2170880
buffer_load_dword v44, v1, s[12:15], s20 offen
s_mov_b32 s21, 2203648
buffer_load_dword v45, v1, s[12:15], s21 offen
s_waitcnt vmcnt(54)
v_perm_b32 v160, v47, v46, s46
v_perm_b32 v68, v47, v46, s47
s_barrier
s_mov_b32 s20, 2359296
buffer_load_dword v46, v1, s[12:15], s20 offen
s_mov_b32 s21, 2392064
buffer_load_dword v47, v1, s[12:15], s21 offen
s_waitcnt vmcnt(54)
v_perm_b32 v161, v49, v48, s46
v_perm_b32 v69, v49, v48, s47
s_mov_b32 s20, 2424832
buffer_load_dword v48, v1, s[12:15], s20 offen
s_mov_b32 s21, 2457600
buffer_load_dword v49, v1, s[12:15], s21 offen
s_waitcnt vmcnt(54)
v_perm_b32 v162, v51, v50, s46
v_perm_b32 v70, v51, v50, s47
s_mov_b32 s20, 2367488
buffer_load_dword v50, v1, s[12:15], s20 offen
s_mov_b32 s21, 2400256
buffer_load_dword v51, v1, s[12:15], s21 offen
s_waitcnt vmcnt(54)
v_perm_b32 v163, v53, v52, s46
v_perm_b32 v71, v53, v52, s47
ds_write_b128 v3, v[68:71] offset:6144
s_waitcnt lgkmcnt(0)
s_mov_b32 s20, 2433024
buffer_load_dword v52, v1, s[12:15], s20 offen
s_mov_b32 s21, 2465792
buffer_load_dword v53, v1, s[12:15], s21 offen
s_waitcnt vmcnt(54)
v_perm_b32 v164, v55, v54, s46
v_perm_b32 v68, v55, v54, s47
s_barrier
s_mov_b32 s12, s90
s_and_b32 s13, s91, 0xffff
s_mov_b32 s14, 4718592
s_mov_b32 s15, 0x20000
s_mov_b32 s20, 2621440
buffer_load_dword v54, v1, s[12:15], s20 offen
s_mov_b32 s21, 2654208
buffer_load_dword v55, v1, s[12:15], s21 offen
s_waitcnt vmcnt(54)
v_perm_b32 v165, v57, v56, s46
v_perm_b32 v69, v57, v56, s47
s_mov_b32 s20, 2686976
buffer_load_dword v56, v1, s[12:15], s20 offen
s_mov_b32 s21, 2719744
buffer_load_dword v57, v1, s[12:15], s21 offen
s_waitcnt vmcnt(54)
v_perm_b32 v166, v59, v58, s46
v_perm_b32 v70, v59, v58, s47
s_mov_b32 s20, 2629632
buffer_load_dword v58, v1, s[12:15], s20 offen
s_mov_b32 s21, 2662400
buffer_load_dword v59, v1, s[12:15], s21 offen
s_waitcnt vmcnt(54)
v_perm_b32 v167, v61, v60, s46
v_perm_b32 v71, v61, v60, s47
ds_write_b128 v3, v[68:71] offset:7168
s_waitcnt lgkmcnt(0)
s_mov_b32 s20, 2695168
buffer_load_dword v60, v1, s[12:15], s20 offen
s_mov_b32 s21, 2727936
buffer_load_dword v61, v1, s[12:15], s21 offen
s_waitcnt vmcnt(54)
v_perm_b32 v64, v7, v6, s46
v_accvgpr_write_b32 a80, v64
v_perm_b32 v68, v7, v6, s47
v_accvgpr_write_b32 a88, v68
s_barrier
s_mov_b32 s20, 2883584
buffer_load_dword v6, v1, s[12:15], s20 offen
s_mov_b32 s21, 2916352
buffer_load_dword v7, v1, s[12:15], s21 offen
s_waitcnt vmcnt(54)
v_perm_b32 v65, v9, v8, s46
v_accvgpr_write_b32 a81, v65
v_perm_b32 v69, v9, v8, s47
v_accvgpr_write_b32 a89, v69
s_mov_b32 s20, 2949120
buffer_load_dword v8, v1, s[12:15], s20 offen
s_mov_b32 s21, 2981888
buffer_load_dword v9, v1, s[12:15], s21 offen
s_waitcnt vmcnt(54)
v_perm_b32 v66, v11, v10, s46
v_accvgpr_write_b32 a82, v66
v_perm_b32 v70, v11, v10, s47
v_accvgpr_write_b32 a90, v70
s_mov_b32 s20, 2891776
buffer_load_dword v10, v1, s[12:15], s20 offen
s_mov_b32 s21, 2924544
buffer_load_dword v11, v1, s[12:15], s21 offen
s_waitcnt vmcnt(54)
v_perm_b32 v67, v13, v12, s46
v_accvgpr_write_b32 a83, v67
v_perm_b32 v71, v13, v12, s47
v_accvgpr_write_b32 a91, v71
s_mov_b32 s20, 2957312
buffer_load_dword v12, v1, s[12:15], s20 offen
s_mov_b32 s21, 2990080
buffer_load_dword v13, v1, s[12:15], s21 offen
s_waitcnt vmcnt(54)
v_perm_b32 v64, v15, v14, s46
v_accvgpr_write_b32 a84, v64
v_perm_b32 v68, v15, v14, s47
v_accvgpr_write_b32 a92, v68
s_barrier
s_mov_b32 s12, s92
s_and_b32 s13, s93, 0xffff
s_mov_b32 s14, 4718592
s_mov_b32 s15, 0x20000
s_mov_b32 s20, 2621440
buffer_load_dword v14, v1, s[12:15], s20 offen
s_mov_b32 s21, 2654208
buffer_load_dword v15, v1, s[12:15], s21 offen
s_waitcnt vmcnt(54)
v_perm_b32 v65, v17, v16, s46
v_accvgpr_write_b32 a85, v65
v_perm_b32 v69, v17, v16, s47
v_accvgpr_write_b32 a93, v69
s_mov_b32 s20, 2686976
buffer_load_dword v16, v1, s[12:15], s20 offen
s_mov_b32 s21, 2719744
buffer_load_dword v17, v1, s[12:15], s21 offen
s_waitcnt vmcnt(54)
v_perm_b32 v66, v19, v18, s46
v_accvgpr_write_b32 a86, v66
v_perm_b32 v70, v19, v18, s47
v_accvgpr_write_b32 a94, v70
s_mov_b32 s20, 2629632
buffer_load_dword v18, v1, s[12:15], s20 offen
s_mov_b32 s21, 2662400
buffer_load_dword v19, v1, s[12:15], s21 offen
s_waitcnt vmcnt(54)
v_perm_b32 v67, v21, v20, s46
v_accvgpr_write_b32 a87, v67
v_perm_b32 v71, v21, v20, s47
v_accvgpr_write_b32 a95, v71
s_mov_b32 s20, 2695168
buffer_load_dword v20, v1, s[12:15], s20 offen
s_mov_b32 s21, 2727936
buffer_load_dword v21, v1, s[12:15], s21 offen
s_waitcnt vmcnt(54)
v_perm_b32 v184, v23, v22, s46
v_perm_b32 v68, v23, v22, s47
s_barrier
s_mov_b32 s20, 2883584
buffer_load_dword v22, v1, s[12:15], s20 offen
s_mov_b32 s21, 2916352
buffer_load_dword v23, v1, s[12:15], s21 offen
s_waitcnt vmcnt(54)
v_perm_b32 v185, v25, v24, s46
v_perm_b32 v69, v25, v24, s47
s_mov_b32 s20, 2949120
buffer_load_dword v24, v1, s[12:15], s20 offen
s_mov_b32 s21, 2981888
buffer_load_dword v25, v1, s[12:15], s21 offen
s_waitcnt vmcnt(54)
v_perm_b32 v186, v27, v26, s46
v_perm_b32 v70, v27, v26, s47
s_mov_b32 s20, 2891776
buffer_load_dword v26, v1, s[12:15], s20 offen
s_mov_b32 s21, 2924544
buffer_load_dword v27, v1, s[12:15], s21 offen
s_waitcnt vmcnt(54)
v_perm_b32 v187, v29, v28, s46
v_perm_b32 v71, v29, v28, s47
ds_write_b128 v3, v[68:71] offset:8192
s_waitcnt lgkmcnt(0)
s_mov_b32 s20, 2957312
buffer_load_dword v28, v1, s[12:15], s20 offen
s_mov_b32 s21, 2990080
buffer_load_dword v29, v1, s[12:15], s21 offen
s_waitcnt vmcnt(54)
v_perm_b32 v188, v31, v30, s46
v_perm_b32 v68, v31, v30, s47
s_barrier
s_mov_b32 s12, s90
s_and_b32 s13, s91, 0xffff
s_mov_b32 s14, 4718592
s_mov_b32 s15, 0x20000
s_mov_b32 s20, 3145728
buffer_load_dword v30, v1, s[12:15], s20 offen
s_mov_b32 s21, 3178496
buffer_load_dword v31, v1, s[12:15], s21 offen
s_waitcnt vmcnt(54)
v_perm_b32 v189, v33, v32, s46
v_perm_b32 v69, v33, v32, s47
s_mov_b32 s20, 3211264
buffer_load_dword v32, v1, s[12:15], s20 offen
s_mov_b32 s21, 3244032
buffer_load_dword v33, v1, s[12:15], s21 offen
s_waitcnt vmcnt(54)
v_perm_b32 v190, v35, v34, s46
v_perm_b32 v70, v35, v34, s47
s_mov_b32 s20, 3153920
buffer_load_dword v34, v1, s[12:15], s20 offen
s_mov_b32 s21, 3186688
buffer_load_dword v35, v1, s[12:15], s21 offen
s_waitcnt vmcnt(54)
v_perm_b32 v191, v37, v36, s46
v_perm_b32 v71, v37, v36, s47
ds_write_b128 v3, v[68:71] offset:9216
s_waitcnt lgkmcnt(0)
s_mov_b32 s20, 3219456
buffer_load_dword v36, v1, s[12:15], s20 offen
s_mov_b32 s21, 3252224
buffer_load_dword v37, v1, s[12:15], s21 offen
s_waitcnt vmcnt(54)
v_perm_b32 v64, v39, v38, s46
v_accvgpr_write_b32 a96, v64
v_perm_b32 v68, v39, v38, s47
v_accvgpr_write_b32 a104, v68
s_barrier
s_mov_b32 s20, 3407872
buffer_load_dword v38, v1, s[12:15], s20 offen
s_mov_b32 s21, 3440640
buffer_load_dword v39, v1, s[12:15], s21 offen
s_waitcnt vmcnt(54)
v_perm_b32 v65, v41, v40, s46
v_accvgpr_write_b32 a97, v65
v_perm_b32 v69, v41, v40, s47
v_accvgpr_write_b32 a105, v69
s_mov_b32 s20, 3473408
buffer_load_dword v40, v1, s[12:15], s20 offen
s_mov_b32 s21, 3506176
buffer_load_dword v41, v1, s[12:15], s21 offen
s_waitcnt vmcnt(54)
v_perm_b32 v66, v43, v42, s46
v_accvgpr_write_b32 a98, v66
v_perm_b32 v70, v43, v42, s47
v_accvgpr_write_b32 a106, v70
s_mov_b32 s20, 3416064
buffer_load_dword v42, v1, s[12:15], s20 offen
s_mov_b32 s21, 3448832
buffer_load_dword v43, v1, s[12:15], s21 offen
s_waitcnt vmcnt(54)
v_perm_b32 v67, v45, v44, s46
v_accvgpr_write_b32 a99, v67
v_perm_b32 v71, v45, v44, s47
v_accvgpr_write_b32 a107, v71
s_mov_b32 s20, 3481600
buffer_load_dword v44, v1, s[12:15], s20 offen
s_mov_b32 s21, 3514368
buffer_load_dword v45, v1, s[12:15], s21 offen
s_waitcnt vmcnt(54)
v_perm_b32 v64, v47, v46, s46
v_accvgpr_write_b32 a100, v64
v_perm_b32 v68, v47, v46, s47
v_accvgpr_write_b32 a108, v68
s_barrier
s_mov_b32 s12, s92
s_and_b32 s13, s93, 0xffff
s_mov_b32 s14, 4718592
s_mov_b32 s15, 0x20000
s_mov_b32 s20, 3145728
buffer_load_dword v46, v1, s[12:15], s20 offen
s_mov_b32 s21, 3178496
buffer_load_dword v47, v1, s[12:15], s21 offen
s_waitcnt vmcnt(54)
v_perm_b32 v65, v49, v48, s46
v_accvgpr_write_b32 a101, v65
v_perm_b32 v69, v49, v48, s47
v_accvgpr_write_b32 a109, v69
s_mov_b32 s20, 3211264
buffer_load_dword v48, v1, s[12:15], s20 offen
s_mov_b32 s21, 3244032
buffer_load_dword v49, v1, s[12:15], s21 offen
s_waitcnt vmcnt(54)
v_perm_b32 v66, v51, v50, s46
v_accvgpr_write_b32 a102, v66
v_perm_b32 v70, v51, v50, s47
v_accvgpr_write_b32 a110, v70
s_mov_b32 s20, 3153920
buffer_load_dword v50, v1, s[12:15], s20 offen
s_mov_b32 s21, 3186688
buffer_load_dword v51, v1, s[12:15], s21 offen
s_waitcnt vmcnt(54)
v_perm_b32 v67, v53, v52, s46
v_accvgpr_write_b32 a103, v67
v_perm_b32 v71, v53, v52, s47
v_accvgpr_write_b32 a111, v71
s_mov_b32 s20, 3219456
buffer_load_dword v52, v1, s[12:15], s20 offen
s_mov_b32 s21, 3252224
buffer_load_dword v53, v1, s[12:15], s21 offen
s_waitcnt vmcnt(54)
v_perm_b32 v208, v55, v54, s46
v_perm_b32 v68, v55, v54, s47
s_barrier
s_mov_b32 s20, 3407872
buffer_load_dword v54, v1, s[12:15], s20 offen
s_mov_b32 s21, 3440640
buffer_load_dword v55, v1, s[12:15], s21 offen
s_waitcnt vmcnt(54)
v_perm_b32 v209, v57, v56, s46
v_perm_b32 v69, v57, v56, s47
s_mov_b32 s20, 3473408
buffer_load_dword v56, v1, s[12:15], s20 offen
s_mov_b32 s21, 3506176
buffer_load_dword v57, v1, s[12:15], s21 offen
s_waitcnt vmcnt(54)
v_perm_b32 v210, v59, v58, s46
v_perm_b32 v70, v59, v58, s47
s_mov_b32 s20, 3416064
buffer_load_dword v58, v1, s[12:15], s20 offen
s_mov_b32 s21, 3448832
buffer_load_dword v59, v1, s[12:15], s21 offen
s_waitcnt vmcnt(54)
v_perm_b32 v211, v61, v60, s46
v_perm_b32 v71, v61, v60, s47
ds_write_b128 v3, v[68:71] offset:10240
s_waitcnt lgkmcnt(0)
s_mov_b32 s20, 3481600
buffer_load_dword v60, v1, s[12:15], s20 offen
s_mov_b32 s21, 3514368
buffer_load_dword v61, v1, s[12:15], s21 offen
s_waitcnt vmcnt(54)
v_perm_b32 v212, v7, v6, s46
v_perm_b32 v68, v7, v6, s47
s_barrier
s_mov_b32 s12, s90
s_and_b32 s13, s91, 0xffff
s_mov_b32 s14, 4718592
s_mov_b32 s15, 0x20000
s_mov_b32 s20, 3670016
buffer_load_dword v6, v1, s[12:15], s20 offen
s_mov_b32 s21, 3702784
buffer_load_dword v7, v1, s[12:15], s21 offen
s_waitcnt vmcnt(54)
v_perm_b32 v213, v9, v8, s46
v_perm_b32 v69, v9, v8, s47
s_mov_b32 s20, 3735552
buffer_load_dword v8, v1, s[12:15], s20 offen
s_mov_b32 s21, 3768320
buffer_load_dword v9, v1, s[12:15], s21 offen
s_waitcnt vmcnt(54)
v_perm_b32 v214, v11, v10, s46
v_perm_b32 v70, v11, v10, s47
s_mov_b32 s20, 3678208
buffer_load_dword v10, v1, s[12:15], s20 offen
s_mov_b32 s21, 3710976
buffer_load_dword v11, v1, s[12:15], s21 offen
s_waitcnt vmcnt(54)
v_perm_b32 v215, v13, v12, s46
v_perm_b32 v71, v13, v12, s47
ds_write_b128 v3, v[68:71] offset:11264
s_waitcnt lgkmcnt(0)
s_mov_b32 s20, 3743744
buffer_load_dword v12, v1, s[12:15], s20 offen
s_mov_b32 s21, 3776512
buffer_load_dword v13, v1, s[12:15], s21 offen
s_waitcnt vmcnt(54)
v_perm_b32 v64, v15, v14, s46
v_accvgpr_write_b32 a112, v64
v_perm_b32 v68, v15, v14, s47
v_accvgpr_write_b32 a120, v68
s_barrier
s_mov_b32 s20, 3932160
buffer_load_dword v14, v1, s[12:15], s20 offen
s_mov_b32 s21, 3964928
buffer_load_dword v15, v1, s[12:15], s21 offen
s_waitcnt vmcnt(54)
v_perm_b32 v65, v17, v16, s46
v_accvgpr_write_b32 a113, v65
v_perm_b32 v69, v17, v16, s47
v_accvgpr_write_b32 a121, v69
s_mov_b32 s20, 3997696
buffer_load_dword v16, v1, s[12:15], s20 offen
s_mov_b32 s21, 4030464
buffer_load_dword v17, v1, s[12:15], s21 offen
s_waitcnt vmcnt(54)
v_perm_b32 v66, v19, v18, s46
v_accvgpr_write_b32 a114, v66
v_perm_b32 v70, v19, v18, s47
v_accvgpr_write_b32 a122, v70
s_mov_b32 s20, 3940352
buffer_load_dword v18, v1, s[12:15], s20 offen
s_mov_b32 s21, 3973120
buffer_load_dword v19, v1, s[12:15], s21 offen
s_waitcnt vmcnt(54)
v_perm_b32 v67, v21, v20, s46
v_accvgpr_write_b32 a115, v67
v_perm_b32 v71, v21, v20, s47
v_accvgpr_write_b32 a123, v71
s_mov_b32 s20, 4005888
buffer_load_dword v20, v1, s[12:15], s20 offen
s_mov_b32 s21, 4038656
buffer_load_dword v21, v1, s[12:15], s21 offen
s_waitcnt vmcnt(54)
v_perm_b32 v64, v23, v22, s46
v_accvgpr_write_b32 a116, v64
v_perm_b32 v68, v23, v22, s47
v_accvgpr_write_b32 a124, v68
s_barrier
s_mov_b32 s12, s92
s_and_b32 s13, s93, 0xffff
s_mov_b32 s14, 4718592
s_mov_b32 s15, 0x20000
s_mov_b32 s20, 3670016
buffer_load_dword v22, v1, s[12:15], s20 offen
s_mov_b32 s21, 3702784
buffer_load_dword v23, v1, s[12:15], s21 offen
s_waitcnt vmcnt(54)
v_perm_b32 v65, v25, v24, s46
v_accvgpr_write_b32 a117, v65
v_perm_b32 v69, v25, v24, s47
v_accvgpr_write_b32 a125, v69
s_mov_b32 s20, 3735552
buffer_load_dword v24, v1, s[12:15], s20 offen
s_mov_b32 s21, 3768320
buffer_load_dword v25, v1, s[12:15], s21 offen
s_waitcnt vmcnt(54)
v_perm_b32 v66, v27, v26, s46
v_accvgpr_write_b32 a118, v66
v_perm_b32 v70, v27, v26, s47
v_accvgpr_write_b32 a126, v70
s_mov_b32 s20, 3678208
buffer_load_dword v26, v1, s[12:15], s20 offen
s_mov_b32 s21, 3710976
buffer_load_dword v27, v1, s[12:15], s21 offen
s_waitcnt vmcnt(54)
v_perm_b32 v67, v29, v28, s46
v_accvgpr_write_b32 a119, v67
v_perm_b32 v71, v29, v28, s47
v_accvgpr_write_b32 a127, v71
s_mov_b32 s20, 3743744
buffer_load_dword v28, v1, s[12:15], s20 offen
s_mov_b32 s21, 3776512
buffer_load_dword v29, v1, s[12:15], s21 offen
s_waitcnt vmcnt(54)
v_perm_b32 v232, v31, v30, s46
v_perm_b32 v68, v31, v30, s47
s_barrier
s_mov_b32 s20, 3932160
buffer_load_dword v30, v1, s[12:15], s20 offen
s_mov_b32 s21, 3964928
buffer_load_dword v31, v1, s[12:15], s21 offen
s_waitcnt vmcnt(54)
v_perm_b32 v233, v33, v32, s46
v_perm_b32 v69, v33, v32, s47
s_mov_b32 s20, 3997696
buffer_load_dword v32, v1, s[12:15], s20 offen
s_mov_b32 s21, 4030464
buffer_load_dword v33, v1, s[12:15], s21 offen
s_waitcnt vmcnt(54)
v_perm_b32 v234, v35, v34, s46
v_perm_b32 v70, v35, v34, s47
s_mov_b32 s20, 3940352
buffer_load_dword v34, v1, s[12:15], s20 offen
s_mov_b32 s21, 3973120
buffer_load_dword v35, v1, s[12:15], s21 offen
s_waitcnt vmcnt(54)
v_perm_b32 v235, v37, v36, s46
v_perm_b32 v71, v37, v36, s47
ds_write_b128 v3, v[68:71] offset:12288
s_waitcnt lgkmcnt(0)
s_mov_b32 s20, 4005888
buffer_load_dword v36, v1, s[12:15], s20 offen
s_mov_b32 s21, 4038656
buffer_load_dword v37, v1, s[12:15], s21 offen
s_waitcnt vmcnt(54)
v_perm_b32 v236, v39, v38, s46
v_perm_b32 v68, v39, v38, s47
s_barrier
s_mov_b32 s12, s90
s_and_b32 s13, s91, 0xffff
s_mov_b32 s14, 4718592
s_mov_b32 s15, 0x20000
s_mov_b32 s20, 4194304
buffer_load_dword v38, v1, s[12:15], s20 offen
s_mov_b32 s21, 4227072
buffer_load_dword v39, v1, s[12:15], s21 offen
s_waitcnt vmcnt(54)
v_perm_b32 v237, v41, v40, s46
v_perm_b32 v69, v41, v40, s47
s_mov_b32 s20, 4259840
buffer_load_dword v40, v1, s[12:15], s20 offen
s_mov_b32 s21, 4292608
buffer_load_dword v41, v1, s[12:15], s21 offen
s_waitcnt vmcnt(54)
v_perm_b32 v238, v43, v42, s46
v_perm_b32 v70, v43, v42, s47
s_mov_b32 s20, 4202496
buffer_load_dword v42, v1, s[12:15], s20 offen
s_mov_b32 s21, 4235264
buffer_load_dword v43, v1, s[12:15], s21 offen
s_waitcnt vmcnt(54)
v_perm_b32 v239, v45, v44, s46
v_perm_b32 v71, v45, v44, s47
ds_write_b128 v3, v[68:71] offset:13312
s_waitcnt lgkmcnt(0)
s_mov_b32 s20, 4268032
buffer_load_dword v44, v1, s[12:15], s20 offen
s_mov_b32 s21, 4300800
buffer_load_dword v45, v1, s[12:15], s21 offen
s_waitcnt vmcnt(54)
v_perm_b32 v64, v47, v46, s46
v_accvgpr_write_b32 a128, v64
v_perm_b32 v68, v47, v46, s47
v_accvgpr_write_b32 a136, v68
s_barrier
s_mov_b32 s20, 4456448
buffer_load_dword v46, v1, s[12:15], s20 offen
s_mov_b32 s21, 4489216
buffer_load_dword v47, v1, s[12:15], s21 offen
s_waitcnt vmcnt(54)
v_perm_b32 v65, v49, v48, s46
v_accvgpr_write_b32 a129, v65
v_perm_b32 v69, v49, v48, s47
v_accvgpr_write_b32 a137, v69
s_mov_b32 s20, 4521984
buffer_load_dword v48, v1, s[12:15], s20 offen
s_mov_b32 s21, 4554752
buffer_load_dword v49, v1, s[12:15], s21 offen
s_waitcnt vmcnt(54)
v_perm_b32 v66, v51, v50, s46
v_accvgpr_write_b32 a130, v66
v_perm_b32 v70, v51, v50, s47
v_accvgpr_write_b32 a138, v70
s_mov_b32 s20, 4464640
buffer_load_dword v50, v1, s[12:15], s20 offen
s_mov_b32 s21, 4497408
buffer_load_dword v51, v1, s[12:15], s21 offen
s_waitcnt vmcnt(54)
v_perm_b32 v67, v53, v52, s46
v_accvgpr_write_b32 a131, v67
v_perm_b32 v71, v53, v52, s47
v_accvgpr_write_b32 a139, v71
s_mov_b32 s20, 4530176
buffer_load_dword v52, v1, s[12:15], s20 offen
s_mov_b32 s21, 4562944
buffer_load_dword v53, v1, s[12:15], s21 offen
s_waitcnt vmcnt(54)
v_perm_b32 v64, v55, v54, s46
v_accvgpr_write_b32 a132, v64
v_perm_b32 v68, v55, v54, s47
v_accvgpr_write_b32 a140, v68
s_barrier
s_mov_b32 s12, s92
s_and_b32 s13, s93, 0xffff
s_mov_b32 s14, 4718592
s_mov_b32 s15, 0x20000
s_mov_b32 s20, 4194304
buffer_load_dword v54, v1, s[12:15], s20 offen
s_mov_b32 s21, 4227072
buffer_load_dword v55, v1, s[12:15], s21 offen
s_waitcnt vmcnt(54)
v_perm_b32 v65, v57, v56, s46
v_accvgpr_write_b32 a133, v65
v_perm_b32 v69, v57, v56, s47
v_accvgpr_write_b32 a141, v69
s_mov_b32 s20, 4259840
buffer_load_dword v56, v1, s[12:15], s20 offen
s_mov_b32 s21, 4292608
buffer_load_dword v57, v1, s[12:15], s21 offen
s_waitcnt vmcnt(54)
v_perm_b32 v66, v59, v58, s46
v_accvgpr_write_b32 a134, v66
v_perm_b32 v70, v59, v58, s47
v_accvgpr_write_b32 a142, v70
s_mov_b32 s20, 4202496
buffer_load_dword v58, v1, s[12:15], s20 offen
s_mov_b32 s21, 4235264
buffer_load_dword v59, v1, s[12:15], s21 offen
s_waitcnt vmcnt(54)
v_perm_b32 v67, v61, v60, s46
v_accvgpr_write_b32 a135, v67
v_perm_b32 v71, v61, v60, s47
v_accvgpr_write_b32 a143, v71
s_mov_b32 s20, 4268032
buffer_load_dword v60, v1, s[12:15], s20 offen
s_mov_b32 s21, 4300800
buffer_load_dword v61, v1, s[12:15], s21 offen
s_waitcnt vmcnt(54)
v_perm_b32 v64, v7, v6, s46
v_accvgpr_write_b32 a0, v64
v_perm_b32 v68, v7, v6, s47
s_barrier
s_mov_b32 s20, 4456448
buffer_load_dword v6, v1, s[12:15], s20 offen
s_mov_b32 s21, 4489216
buffer_load_dword v7, v1, s[12:15], s21 offen
s_waitcnt vmcnt(54)
v_perm_b32 v65, v9, v8, s46
v_accvgpr_write_b32 a1, v65
v_perm_b32 v69, v9, v8, s47
s_mov_b32 s20, 4521984
buffer_load_dword v8, v1, s[12:15], s20 offen
s_mov_b32 s21, 4554752
buffer_load_dword v9, v1, s[12:15], s21 offen
s_waitcnt vmcnt(54)
v_perm_b32 v66, v11, v10, s46
v_accvgpr_write_b32 a2, v66
v_perm_b32 v70, v11, v10, s47
s_mov_b32 s20, 4464640
buffer_load_dword v10, v1, s[12:15], s20 offen
s_mov_b32 s21, 4497408
buffer_load_dword v11, v1, s[12:15], s21 offen
s_waitcnt vmcnt(54)
v_perm_b32 v67, v13, v12, s46
v_accvgpr_write_b32 a3, v67
v_perm_b32 v71, v13, v12, s47
ds_write_b128 v3, v[68:71] offset:14336
s_waitcnt lgkmcnt(0)
s_mov_b32 s20, 4530176
buffer_load_dword v12, v1, s[12:15], s20 offen
s_mov_b32 s21, 4562944
buffer_load_dword v13, v1, s[12:15], s21 offen
s_waitcnt vmcnt(54)
v_perm_b32 v64, v15, v14, s46
v_accvgpr_write_b32 a4, v64
v_perm_b32 v68, v15, v14, s47
s_barrier
s_mov_b32 s12, s94
s_and_b32 s13, s95, 0xffff
s_mov_b32 s14, 4718592
s_mov_b32 s15, 0x20000
s_mov_b32 s20, 0
buffer_load_dword v14, v4, s[12:15], s20 offen
s_mov_b32 s21, 1152
buffer_load_dword v15, v4, s[12:15], s21 offen
s_waitcnt vmcnt(54)
v_perm_b32 v65, v17, v16, s46
v_accvgpr_write_b32 a5, v65
v_perm_b32 v69, v17, v16, s47
s_mov_b32 s20, 9216
buffer_load_dword v16, v4, s[12:15], s20 offen
s_mov_b32 s21, 10368
buffer_load_dword v17, v4, s[12:15], s21 offen
s_waitcnt vmcnt(54)
v_perm_b32 v66, v19, v18, s46
v_accvgpr_write_b32 a6, v66
v_perm_b32 v70, v19, v18, s47
s_mov_b32 s20, 2304
buffer_load_dword v18, v4, s[12:15], s20 offen
s_mov_b32 s21, 3456
buffer_load_dword v19, v4, s[12:15], s21 offen
s_waitcnt vmcnt(54)
v_perm_b32 v67, v21, v20, s46
v_accvgpr_write_b32 a7, v67
v_perm_b32 v71, v21, v20, s47
ds_write_b128 v3, v[68:71] offset:15360
s_waitcnt lgkmcnt(0)
s_mov_b32 s20, 11520
buffer_load_dword v20, v4, s[12:15], s20 offen
s_mov_b32 s21, 12672
buffer_load_dword v21, v4, s[12:15], s21 offen
s_waitcnt vmcnt(54)
v_perm_b32 v64, v23, v22, s46
v_accvgpr_write_b32 a144, v64
v_perm_b32 v68, v23, v22, s47
v_accvgpr_write_b32 a152, v68
s_barrier
s_mov_b32 s20, 36864
buffer_load_dword v22, v4, s[12:15], s20 offen
s_mov_b32 s21, 38016
buffer_load_dword v23, v4, s[12:15], s21 offen
s_waitcnt vmcnt(54)
v_perm_b32 v65, v25, v24, s46
v_accvgpr_write_b32 a145, v65
v_perm_b32 v69, v25, v24, s47
v_accvgpr_write_b32 a153, v69
s_mov_b32 s20, 46080
buffer_load_dword v24, v4, s[12:15], s20 offen
s_mov_b32 s21, 47232
buffer_load_dword v25, v4, s[12:15], s21 offen
s_waitcnt vmcnt(54)
v_perm_b32 v66, v27, v26, s46
v_accvgpr_write_b32 a146, v66
v_perm_b32 v70, v27, v26, s47
v_accvgpr_write_b32 a154, v70
s_mov_b32 s20, 39168
buffer_load_dword v26, v4, s[12:15], s20 offen
s_mov_b32 s21, 40320
buffer_load_dword v27, v4, s[12:15], s21 offen
s_waitcnt vmcnt(54)
v_perm_b32 v67, v29, v28, s46
v_accvgpr_write_b32 a147, v67
v_perm_b32 v71, v29, v28, s47
v_accvgpr_write_b32 a155, v71
s_mov_b32 s20, 48384
buffer_load_dword v28, v4, s[12:15], s20 offen
s_mov_b32 s21, 49536
buffer_load_dword v29, v4, s[12:15], s21 offen
s_waitcnt vmcnt(54)
v_perm_b32 v64, v31, v30, s46
v_accvgpr_write_b32 a148, v64
v_perm_b32 v68, v31, v30, s47
v_accvgpr_write_b32 a156, v68
s_barrier
s_mov_b32 s20, 73728
buffer_load_dword v30, v4, s[12:15], s20 offen
s_mov_b32 s21, 74880
buffer_load_dword v31, v4, s[12:15], s21 offen
s_waitcnt vmcnt(54)
v_perm_b32 v65, v33, v32, s46
v_accvgpr_write_b32 a149, v65
v_perm_b32 v69, v33, v32, s47
v_accvgpr_write_b32 a157, v69
s_mov_b32 s20, 82944
buffer_load_dword v32, v4, s[12:15], s20 offen
s_mov_b32 s21, 84096
buffer_load_dword v33, v4, s[12:15], s21 offen
s_waitcnt vmcnt(54)
v_perm_b32 v66, v35, v34, s46
v_accvgpr_write_b32 a150, v66
v_perm_b32 v70, v35, v34, s47
v_accvgpr_write_b32 a158, v70
s_mov_b32 s20, 76032
buffer_load_dword v34, v4, s[12:15], s20 offen
s_mov_b32 s21, 77184
buffer_load_dword v35, v4, s[12:15], s21 offen
s_waitcnt vmcnt(54)
v_perm_b32 v67, v37, v36, s46
v_accvgpr_write_b32 a151, v67
v_perm_b32 v71, v37, v36, s47
v_accvgpr_write_b32 a159, v71
s_mov_b32 s20, 85248
buffer_load_dword v36, v4, s[12:15], s20 offen
s_mov_b32 s21, 86400
buffer_load_dword v37, v4, s[12:15], s21 offen
s_waitcnt vmcnt(54)
v_perm_b32 v64, v39, v38, s46
v_accvgpr_write_b32 a24, v64
v_perm_b32 v68, v39, v38, s47
s_barrier
s_mov_b32 s20, 110592
buffer_load_dword v38, v4, s[12:15], s20 offen
s_mov_b32 s21, 111744
buffer_load_dword v39, v4, s[12:15], s21 offen
s_waitcnt vmcnt(54)
v_perm_b32 v65, v41, v40, s46
v_accvgpr_write_b32 a25, v65
v_perm_b32 v69, v41, v40, s47
s_mov_b32 s20, 119808
buffer_load_dword v40, v4, s[12:15], s20 offen
s_mov_b32 s21, 120960
buffer_load_dword v41, v4, s[12:15], s21 offen
s_waitcnt vmcnt(54)
v_perm_b32 v66, v43, v42, s46
v_accvgpr_write_b32 a26, v66
v_perm_b32 v70, v43, v42, s47
s_mov_b32 s20, 112896
buffer_load_dword v42, v4, s[12:15], s20 offen
s_mov_b32 s21, 114048
buffer_load_dword v43, v4, s[12:15], s21 offen
s_waitcnt vmcnt(54)
v_perm_b32 v67, v45, v44, s46
v_accvgpr_write_b32 a27, v67
v_perm_b32 v71, v45, v44, s47
ds_write_b128 v3, v[68:71] offset:16384
s_waitcnt lgkmcnt(0)
s_mov_b32 s20, 122112
buffer_load_dword v44, v4, s[12:15], s20 offen
s_mov_b32 s21, 123264
buffer_load_dword v45, v4, s[12:15], s21 offen
s_waitcnt vmcnt(54)
v_perm_b32 v64, v47, v46, s46
v_accvgpr_write_b32 a28, v64
v_perm_b32 v68, v47, v46, s47
s_barrier
s_mov_b32 s20, 256
buffer_load_dword v46, v4, s[12:15], s20 offen
s_mov_b32 s21, 1408
buffer_load_dword v47, v4, s[12:15], s21 offen
s_waitcnt vmcnt(54)
v_perm_b32 v65, v49, v48, s46
v_accvgpr_write_b32 a29, v65
v_perm_b32 v69, v49, v48, s47
s_mov_b32 s20, 9472
buffer_load_dword v48, v4, s[12:15], s20 offen
s_mov_b32 s21, 10624
buffer_load_dword v49, v4, s[12:15], s21 offen
s_waitcnt vmcnt(54)
v_perm_b32 v66, v51, v50, s46
v_accvgpr_write_b32 a30, v66
v_perm_b32 v70, v51, v50, s47
s_mov_b32 s20, 2560
buffer_load_dword v50, v4, s[12:15], s20 offen
s_mov_b32 s21, 3712
buffer_load_dword v51, v4, s[12:15], s21 offen
s_waitcnt vmcnt(54)
v_perm_b32 v67, v53, v52, s46
v_accvgpr_write_b32 a31, v67
v_perm_b32 v71, v53, v52, s47
ds_write_b128 v3, v[68:71] offset:17408
s_waitcnt lgkmcnt(0)
s_mov_b32 s20, 11776
buffer_load_dword v52, v4, s[12:15], s20 offen
s_mov_b32 s21, 12928
buffer_load_dword v53, v4, s[12:15], s21 offen
s_waitcnt vmcnt(54)
v_perm_b32 v64, v55, v54, s46
v_accvgpr_write_b32 a160, v64
v_perm_b32 v68, v55, v54, s47
v_accvgpr_write_b32 a168, v68
s_barrier
s_mov_b32 s20, 37120
buffer_load_dword v54, v4, s[12:15], s20 offen
s_mov_b32 s21, 38272
buffer_load_dword v55, v4, s[12:15], s21 offen
s_waitcnt vmcnt(54)
v_perm_b32 v65, v57, v56, s46
v_accvgpr_write_b32 a161, v65
v_perm_b32 v69, v57, v56, s47
v_accvgpr_write_b32 a169, v69
s_mov_b32 s20, 46336
buffer_load_dword v56, v4, s[12:15], s20 offen
s_mov_b32 s21, 47488
buffer_load_dword v57, v4, s[12:15], s21 offen
s_waitcnt vmcnt(54)
v_perm_b32 v66, v59, v58, s46
v_accvgpr_write_b32 a162, v66
v_perm_b32 v70, v59, v58, s47
v_accvgpr_write_b32 a170, v70
s_mov_b32 s20, 39424
buffer_load_dword v58, v4, s[12:15], s20 offen
s_mov_b32 s21, 40576
buffer_load_dword v59, v4, s[12:15], s21 offen
s_waitcnt vmcnt(54)
v_perm_b32 v67, v61, v60, s46
v_accvgpr_write_b32 a163, v67
v_perm_b32 v71, v61, v60, s47
v_accvgpr_write_b32 a171, v71
s_mov_b32 s20, 48640
buffer_load_dword v60, v4, s[12:15], s20 offen
s_mov_b32 s21, 49792
buffer_load_dword v61, v4, s[12:15], s21 offen
s_waitcnt vmcnt(54)
v_perm_b32 v64, v7, v6, s46
v_accvgpr_write_b32 a164, v64
v_perm_b32 v68, v7, v6, s47
v_accvgpr_write_b32 a172, v68
s_barrier
s_mov_b32 s20, 73984
buffer_load_dword v6, v4, s[12:15], s20 offen
s_mov_b32 s21, 75136
buffer_load_dword v7, v4, s[12:15], s21 offen
s_waitcnt vmcnt(54)
v_perm_b32 v65, v9, v8, s46
v_accvgpr_write_b32 a165, v65
v_perm_b32 v69, v9, v8, s47
v_accvgpr_write_b32 a173, v69
s_mov_b32 s20, 83200
buffer_load_dword v8, v4, s[12:15], s20 offen
s_mov_b32 s21, 84352
buffer_load_dword v9, v4, s[12:15], s21 offen
s_waitcnt vmcnt(54)
v_perm_b32 v66, v11, v10, s46
v_accvgpr_write_b32 a166, v66
v_perm_b32 v70, v11, v10, s47
v_accvgpr_write_b32 a174, v70
s_mov_b32 s20, 76288
buffer_load_dword v10, v4, s[12:15], s20 offen
s_mov_b32 s21, 77440
buffer_load_dword v11, v4, s[12:15], s21 offen
s_waitcnt vmcnt(54)
v_perm_b32 v67, v13, v12, s46
v_accvgpr_write_b32 a167, v67
v_perm_b32 v71, v13, v12, s47
v_accvgpr_write_b32 a175, v71
s_mov_b32 s20, 85504
buffer_load_dword v12, v4, s[12:15], s20 offen
s_mov_b32 s21, 86656
buffer_load_dword v13, v4, s[12:15], s21 offen
s_waitcnt vmcnt(54)
v_perm_b32 v64, v15, v14, s46
v_accvgpr_write_b32 a176, v64
v_perm_b32 v68, v15, v14, s47
v_accvgpr_write_b32 a184, v68
s_barrier
s_mov_b32 s20, 110848
buffer_load_dword v14, v4, s[12:15], s20 offen
s_mov_b32 s21, 112000
buffer_load_dword v15, v4, s[12:15], s21 offen
s_waitcnt vmcnt(54)
v_perm_b32 v65, v17, v16, s46
v_accvgpr_write_b32 a177, v65
v_perm_b32 v69, v17, v16, s47
v_accvgpr_write_b32 a185, v69
s_mov_b32 s20, 120064
buffer_load_dword v16, v4, s[12:15], s20 offen
s_mov_b32 s21, 121216
buffer_load_dword v17, v4, s[12:15], s21 offen
s_waitcnt vmcnt(54)
v_perm_b32 v66, v19, v18, s46
v_accvgpr_write_b32 a178, v66
v_perm_b32 v70, v19, v18, s47
v_accvgpr_write_b32 a186, v70
s_mov_b32 s20, 113152
buffer_load_dword v18, v4, s[12:15], s20 offen
s_mov_b32 s21, 114304
buffer_load_dword v19, v4, s[12:15], s21 offen
s_waitcnt vmcnt(54)
v_perm_b32 v67, v21, v20, s46
v_accvgpr_write_b32 a179, v67
v_perm_b32 v71, v21, v20, s47
v_accvgpr_write_b32 a187, v71
s_mov_b32 s20, 122368
buffer_load_dword v20, v4, s[12:15], s20 offen
s_mov_b32 s21, 123520
buffer_load_dword v21, v4, s[12:15], s21 offen
s_waitcnt vmcnt(54)
v_perm_b32 v64, v23, v22, s46
v_accvgpr_write_b32 a180, v64
v_perm_b32 v68, v23, v22, s47
v_accvgpr_write_b32 a188, v68
s_barrier
s_mov_b32 s20, 512
buffer_load_dword v22, v4, s[12:15], s20 offen
s_mov_b32 s21, 1664
buffer_load_dword v23, v4, s[12:15], s21 offen
s_waitcnt vmcnt(54)
v_perm_b32 v65, v25, v24, s46
v_accvgpr_write_b32 a181, v65
v_perm_b32 v69, v25, v24, s47
v_accvgpr_write_b32 a189, v69
s_mov_b32 s20, 9728
buffer_load_dword v24, v4, s[12:15], s20 offen
s_mov_b32 s21, 10880
buffer_load_dword v25, v4, s[12:15], s21 offen
s_waitcnt vmcnt(54)
v_perm_b32 v66, v27, v26, s46
v_accvgpr_write_b32 a182, v66
v_perm_b32 v70, v27, v26, s47
v_accvgpr_write_b32 a190, v70
s_mov_b32 s20, 2816
buffer_load_dword v26, v4, s[12:15], s20 offen
s_mov_b32 s21, 3968
buffer_load_dword v27, v4, s[12:15], s21 offen
s_waitcnt vmcnt(54)
v_perm_b32 v67, v29, v28, s46
v_accvgpr_write_b32 a183, v67
v_perm_b32 v71, v29, v28, s47
v_accvgpr_write_b32 a191, v71
s_mov_b32 s20, 12032
buffer_load_dword v28, v4, s[12:15], s20 offen
s_mov_b32 s21, 13184
buffer_load_dword v29, v4, s[12:15], s21 offen
s_waitcnt vmcnt(54)
v_perm_b32 v64, v31, v30, s46
v_perm_b32 v68, v31, v30, s47
s_barrier
s_mov_b32 s20, 37376
buffer_load_dword v30, v4, s[12:15], s20 offen
s_mov_b32 s21, 38528
buffer_load_dword v31, v4, s[12:15], s21 offen
s_waitcnt vmcnt(54)
v_perm_b32 v65, v33, v32, s46
v_perm_b32 v69, v33, v32, s47
s_mov_b32 s20, 46592
buffer_load_dword v32, v4, s[12:15], s20 offen
s_mov_b32 s21, 47744
buffer_load_dword v33, v4, s[12:15], s21 offen
s_waitcnt vmcnt(54)
v_perm_b32 v66, v35, v34, s46
v_perm_b32 v70, v35, v34, s47
s_mov_b32 s20, 39680
buffer_load_dword v34, v4, s[12:15], s20 offen
s_mov_b32 s21, 40832
buffer_load_dword v35, v4, s[12:15], s21 offen
s_waitcnt vmcnt(54)
v_perm_b32 v67, v37, v36, s46
ds_write_b128 v3, v[64:67] offset:20480
s_waitcnt lgkmcnt(0)
v_perm_b32 v71, v37, v36, s47
ds_write_b128 v3, v[68:71] offset:22528
s_waitcnt lgkmcnt(0)
s_mov_b32 s20, 48896
buffer_load_dword v36, v4, s[12:15], s20 offen
s_mov_b32 s21, 50048
buffer_load_dword v37, v4, s[12:15], s21 offen
s_waitcnt vmcnt(54)
v_perm_b32 v64, v39, v38, s46
v_perm_b32 v68, v39, v38, s47
s_barrier
s_mov_b32 s20, 74240
buffer_load_dword v38, v4, s[12:15], s20 offen
s_mov_b32 s21, 75392
buffer_load_dword v39, v4, s[12:15], s21 offen
s_waitcnt vmcnt(54)
v_perm_b32 v65, v41, v40, s46
v_perm_b32 v69, v41, v40, s47
s_mov_b32 s20, 83456
buffer_load_dword v40, v4, s[12:15], s20 offen
s_mov_b32 s21, 84608
buffer_load_dword v41, v4, s[12:15], s21 offen
s_waitcnt vmcnt(54)
v_perm_b32 v66, v43, v42, s46
v_perm_b32 v70, v43, v42, s47
s_mov_b32 s20, 76544
buffer_load_dword v42, v4, s[12:15], s20 offen
s_mov_b32 s21, 77696
buffer_load_dword v43, v4, s[12:15], s21 offen
s_waitcnt vmcnt(54)
v_perm_b32 v67, v45, v44, s46
ds_write_b128 v3, v[64:67] offset:21504
s_waitcnt lgkmcnt(0)
v_perm_b32 v71, v45, v44, s47
ds_write_b128 v3, v[68:71] offset:23552
s_waitcnt lgkmcnt(0)
s_mov_b32 s20, 85760
buffer_load_dword v44, v4, s[12:15], s20 offen
s_mov_b32 s21, 86912
buffer_load_dword v45, v4, s[12:15], s21 offen
s_waitcnt vmcnt(54)
v_perm_b32 v64, v47, v46, s46
v_accvgpr_write_b32 a192, v64
v_perm_b32 v68, v47, v46, s47
v_accvgpr_write_b32 a200, v68
s_barrier
s_mov_b32 s20, 111104
buffer_load_dword v46, v4, s[12:15], s20 offen
s_mov_b32 s21, 112256
buffer_load_dword v47, v4, s[12:15], s21 offen
s_waitcnt vmcnt(54)
v_perm_b32 v65, v49, v48, s46
v_accvgpr_write_b32 a193, v65
v_perm_b32 v69, v49, v48, s47
v_accvgpr_write_b32 a201, v69
s_mov_b32 s20, 120320
buffer_load_dword v48, v4, s[12:15], s20 offen
s_mov_b32 s21, 121472
buffer_load_dword v49, v4, s[12:15], s21 offen
s_waitcnt vmcnt(54)
v_perm_b32 v66, v51, v50, s46
v_accvgpr_write_b32 a194, v66
v_perm_b32 v70, v51, v50, s47
v_accvgpr_write_b32 a202, v70
s_mov_b32 s20, 113408
buffer_load_dword v50, v4, s[12:15], s20 offen
s_mov_b32 s21, 114560
buffer_load_dword v51, v4, s[12:15], s21 offen
s_waitcnt vmcnt(54)
v_perm_b32 v67, v53, v52, s46
v_accvgpr_write_b32 a195, v67
v_perm_b32 v71, v53, v52, s47
v_accvgpr_write_b32 a203, v71
s_mov_b32 s20, 122624
buffer_load_dword v52, v4, s[12:15], s20 offen
s_mov_b32 s21, 123776
buffer_load_dword v53, v4, s[12:15], s21 offen
s_waitcnt vmcnt(54)
v_perm_b32 v64, v55, v54, s46
v_accvgpr_write_b32 a196, v64
v_perm_b32 v68, v55, v54, s47
v_accvgpr_write_b32 a204, v68
s_barrier
s_mov_b32 s20, 768
buffer_load_dword v54, v4, s[12:15], s20 offen
s_mov_b32 s21, 1920
buffer_load_dword v55, v4, s[12:15], s21 offen
s_waitcnt vmcnt(54)
v_perm_b32 v65, v57, v56, s46
v_accvgpr_write_b32 a197, v65
v_perm_b32 v69, v57, v56, s47
v_accvgpr_write_b32 a205, v69
s_mov_b32 s20, 9984
buffer_load_dword v56, v4, s[12:15], s20 offen
s_mov_b32 s21, 11136
buffer_load_dword v57, v4, s[12:15], s21 offen
s_waitcnt vmcnt(54)
v_perm_b32 v66, v59, v58, s46
v_accvgpr_write_b32 a198, v66
v_perm_b32 v70, v59, v58, s47
v_accvgpr_write_b32 a206, v70
s_mov_b32 s20, 3072
buffer_load_dword v58, v4, s[12:15], s20 offen
s_mov_b32 s21, 4224
buffer_load_dword v59, v4, s[12:15], s21 offen
s_waitcnt vmcnt(54)
v_perm_b32 v67, v61, v60, s46
v_accvgpr_write_b32 a199, v67
v_perm_b32 v71, v61, v60, s47
v_accvgpr_write_b32 a207, v71
s_mov_b32 s20, 12288
buffer_load_dword v60, v4, s[12:15], s20 offen
s_mov_b32 s21, 13440
buffer_load_dword v61, v4, s[12:15], s21 offen
s_waitcnt vmcnt(54)
v_perm_b32 v64, v7, v6, s46
v_perm_b32 v68, v7, v6, s47
s_barrier
s_mov_b32 s20, 37632
buffer_load_dword v6, v4, s[12:15], s20 offen
s_mov_b32 s21, 38784
buffer_load_dword v7, v4, s[12:15], s21 offen
s_waitcnt vmcnt(54)
v_perm_b32 v65, v9, v8, s46
v_perm_b32 v69, v9, v8, s47
s_mov_b32 s20, 46848
buffer_load_dword v8, v4, s[12:15], s20 offen
s_mov_b32 s21, 48000
buffer_load_dword v9, v4, s[12:15], s21 offen
s_waitcnt vmcnt(54)
v_perm_b32 v66, v11, v10, s46
v_perm_b32 v70, v11, v10, s47
s_mov_b32 s20, 39936
buffer_load_dword v10, v4, s[12:15], s20 offen
s_mov_b32 s21, 41088
buffer_load_dword v11, v4, s[12:15], s21 offen
s_waitcnt vmcnt(54)
v_perm_b32 v67, v13, v12, s46
ds_write_b128 v3, v[64:67] offset:24576
s_waitcnt lgkmcnt(0)
v_perm_b32 v71, v13, v12, s47
ds_write_b128 v3, v[68:71] offset:26624
s_waitcnt lgkmcnt(0)
s_mov_b32 s20, 49152
buffer_load_dword v12, v4, s[12:15], s20 offen
s_mov_b32 s21, 50304
buffer_load_dword v13, v4, s[12:15], s21 offen
s_waitcnt vmcnt(54)
v_perm_b32 v64, v15, v14, s46
v_perm_b32 v68, v15, v14, s47
s_barrier
s_mov_b32 s20, 74496
buffer_load_dword v14, v4, s[12:15], s20 offen
s_mov_b32 s21, 75648
buffer_load_dword v15, v4, s[12:15], s21 offen
s_waitcnt vmcnt(54)
v_perm_b32 v65, v17, v16, s46
v_perm_b32 v69, v17, v16, s47
s_mov_b32 s20, 83712
buffer_load_dword v16, v4, s[12:15], s20 offen
s_mov_b32 s21, 84864
buffer_load_dword v17, v4, s[12:15], s21 offen
s_waitcnt vmcnt(54)
v_perm_b32 v66, v19, v18, s46
v_perm_b32 v70, v19, v18, s47
s_mov_b32 s20, 76800
buffer_load_dword v18, v4, s[12:15], s20 offen
s_mov_b32 s21, 77952
buffer_load_dword v19, v4, s[12:15], s21 offen
s_waitcnt vmcnt(54)
v_perm_b32 v67, v21, v20, s46
ds_write_b128 v3, v[64:67] offset:25600
s_waitcnt lgkmcnt(0)
v_perm_b32 v71, v21, v20, s47
ds_write_b128 v3, v[68:71] offset:27648
s_waitcnt lgkmcnt(0)
s_mov_b32 s20, 86016
buffer_load_dword v20, v4, s[12:15], s20 offen
s_mov_b32 s21, 87168
buffer_load_dword v21, v4, s[12:15], s21 offen
s_waitcnt vmcnt(54)
v_perm_b32 v64, v23, v22, s46
v_accvgpr_write_b32 a208, v64
v_perm_b32 v68, v23, v22, s47
v_accvgpr_write_b32 a216, v68
s_barrier
s_mov_b32 s20, 111360
buffer_load_dword v22, v4, s[12:15], s20 offen
s_mov_b32 s21, 112512
buffer_load_dword v23, v4, s[12:15], s21 offen
s_waitcnt vmcnt(54)
v_perm_b32 v65, v25, v24, s46
v_accvgpr_write_b32 a209, v65
v_perm_b32 v69, v25, v24, s47
v_accvgpr_write_b32 a217, v69
s_mov_b32 s20, 120576
buffer_load_dword v24, v4, s[12:15], s20 offen
s_mov_b32 s21, 121728
buffer_load_dword v25, v4, s[12:15], s21 offen
s_waitcnt vmcnt(54)
v_perm_b32 v66, v27, v26, s46
v_accvgpr_write_b32 a210, v66
v_perm_b32 v70, v27, v26, s47
v_accvgpr_write_b32 a218, v70
s_mov_b32 s20, 113664
buffer_load_dword v26, v4, s[12:15], s20 offen
s_mov_b32 s21, 114816
buffer_load_dword v27, v4, s[12:15], s21 offen
s_waitcnt vmcnt(54)
v_perm_b32 v67, v29, v28, s46
v_accvgpr_write_b32 a211, v67
v_perm_b32 v71, v29, v28, s47
v_accvgpr_write_b32 a219, v71
s_mov_b32 s20, 122880
buffer_load_dword v28, v4, s[12:15], s20 offen
s_mov_b32 s21, 124032
buffer_load_dword v29, v4, s[12:15], s21 offen
s_waitcnt vmcnt(54)
v_perm_b32 v64, v31, v30, s46
v_accvgpr_write_b32 a212, v64
v_perm_b32 v68, v31, v30, s47
v_accvgpr_write_b32 a220, v68
s_barrier
s_mov_b32 s20, 1024
buffer_load_ushort v30, v2, s[12:15], s20 offen
s_mov_b32 s21, 2176
buffer_load_ushort v31, v2, s[12:15], s21 offen
s_waitcnt vmcnt(54)
v_perm_b32 v65, v33, v32, s46
v_accvgpr_write_b32 a213, v65
v_perm_b32 v69, v33, v32, s47
v_accvgpr_write_b32 a221, v69
s_mov_b32 s20, 10240
buffer_load_ushort v32, v2, s[12:15], s20 offen
s_mov_b32 s21, 11392
buffer_load_ushort v33, v2, s[12:15], s21 offen
s_waitcnt vmcnt(54)
v_perm_b32 v66, v35, v34, s46
v_accvgpr_write_b32 a214, v66
v_perm_b32 v70, v35, v34, s47
v_accvgpr_write_b32 a222, v70
s_mov_b32 s20, 3328
buffer_load_ushort v34, v2, s[12:15], s20 offen
s_mov_b32 s21, 4480
buffer_load_ushort v35, v2, s[12:15], s21 offen
s_waitcnt vmcnt(54)
v_perm_b32 v67, v37, v36, s46
v_accvgpr_write_b32 a215, v67
v_perm_b32 v71, v37, v36, s47
v_accvgpr_write_b32 a223, v71
s_mov_b32 s20, 12544
buffer_load_ushort v36, v2, s[12:15], s20 offen
s_mov_b32 s21, 13696
buffer_load_ushort v37, v2, s[12:15], s21 offen
s_waitcnt vmcnt(54)
v_perm_b32 v64, v39, v38, s46
v_perm_b32 v68, v39, v38, s47
s_barrier
s_mov_b32 s20, 37888
buffer_load_ushort v38, v2, s[12:15], s20 offen
s_mov_b32 s21, 39040
buffer_load_ushort v39, v2, s[12:15], s21 offen
s_waitcnt vmcnt(54)
v_perm_b32 v65, v41, v40, s46
v_perm_b32 v69, v41, v40, s47
s_mov_b32 s20, 47104
buffer_load_ushort v40, v2, s[12:15], s20 offen
s_mov_b32 s21, 48256
buffer_load_ushort v41, v2, s[12:15], s21 offen
s_waitcnt vmcnt(54)
v_perm_b32 v66, v43, v42, s46
v_perm_b32 v70, v43, v42, s47
s_mov_b32 s20, 40192
buffer_load_ushort v42, v2, s[12:15], s20 offen
s_mov_b32 s21, 41344
buffer_load_ushort v43, v2, s[12:15], s21 offen
s_waitcnt vmcnt(54)
v_perm_b32 v67, v45, v44, s46
ds_write_b128 v3, v[64:67] offset:28672
s_waitcnt lgkmcnt(0)
v_perm_b32 v71, v45, v44, s47
ds_write_b128 v3, v[68:71] offset:30720
s_waitcnt lgkmcnt(0)
s_mov_b32 s20, 49408
buffer_load_ushort v44, v2, s[12:15], s20 offen
s_mov_b32 s21, 50560
buffer_load_ushort v45, v2, s[12:15], s21 offen
s_waitcnt vmcnt(54)
v_perm_b32 v64, v47, v46, s46
v_perm_b32 v68, v47, v46, s47
s_barrier
s_mov_b32 s20, 74752
buffer_load_ushort v46, v2, s[12:15], s20 offen
s_mov_b32 s21, 75904
buffer_load_ushort v47, v2, s[12:15], s21 offen
s_waitcnt vmcnt(54)
v_perm_b32 v65, v49, v48, s46
v_perm_b32 v69, v49, v48, s47
s_mov_b32 s20, 83968
buffer_load_ushort v48, v2, s[12:15], s20 offen
s_mov_b32 s21, 85120
buffer_load_ushort v49, v2, s[12:15], s21 offen
s_waitcnt vmcnt(54)
v_perm_b32 v66, v51, v50, s46
v_perm_b32 v70, v51, v50, s47
s_mov_b32 s20, 77056
buffer_load_ushort v50, v2, s[12:15], s20 offen
s_mov_b32 s21, 78208
buffer_load_ushort v51, v2, s[12:15], s21 offen
s_waitcnt vmcnt(54)
v_perm_b32 v67, v53, v52, s46
ds_write_b128 v3, v[64:67] offset:29696
s_waitcnt lgkmcnt(0)
v_perm_b32 v71, v53, v52, s47
ds_write_b128 v3, v[68:71] offset:31744
s_waitcnt lgkmcnt(0)
s_mov_b32 s20, 86272
buffer_load_ushort v52, v2, s[12:15], s20 offen
s_mov_b32 s21, 87424
buffer_load_ushort v53, v2, s[12:15], s21 offen
s_waitcnt vmcnt(54)
v_perm_b32 v64, v55, v54, s46
v_accvgpr_write_b32 a224, v64
v_perm_b32 v68, v55, v54, s47
v_accvgpr_write_b32 a232, v68
s_barrier
s_mov_b32 s20, 111616
buffer_load_ushort v54, v2, s[12:15], s20 offen
s_mov_b32 s21, 112768
buffer_load_ushort v55, v2, s[12:15], s21 offen
s_waitcnt vmcnt(54)
v_perm_b32 v65, v57, v56, s46
v_accvgpr_write_b32 a225, v65
v_perm_b32 v69, v57, v56, s47
v_accvgpr_write_b32 a233, v69
s_mov_b32 s20, 120832
buffer_load_ushort v56, v2, s[12:15], s20 offen
s_mov_b32 s21, 121984
buffer_load_ushort v57, v2, s[12:15], s21 offen
s_waitcnt vmcnt(54)
v_perm_b32 v66, v59, v58, s46
v_accvgpr_write_b32 a226, v66
v_perm_b32 v70, v59, v58, s47
v_accvgpr_write_b32 a234, v70
s_mov_b32 s20, 113920
buffer_load_ushort v58, v2, s[12:15], s20 offen
s_mov_b32 s21, 115072
buffer_load_ushort v59, v2, s[12:15], s21 offen
s_waitcnt vmcnt(54)
v_perm_b32 v67, v61, v60, s46
v_accvgpr_write_b32 a227, v67
v_perm_b32 v71, v61, v60, s47
v_accvgpr_write_b32 a235, v71
s_mov_b32 s20, 123136
buffer_load_ushort v60, v2, s[12:15], s20 offen
s_mov_b32 s21, 124288
buffer_load_ushort v61, v2, s[12:15], s21 offen
s_waitcnt vmcnt(54)
v_perm_b32 v64, v7, v6, s46
v_accvgpr_write_b32 a228, v64
v_perm_b32 v68, v7, v6, s47
v_accvgpr_write_b32 a236, v68
s_barrier
s_mov_b32 s12, s88
s_and_b32 s13, s89, 0xffff
s_mov_b32 s14, 4718592
s_mov_b32 s15, 0x20000
s_mov_b32 s20, 0
buffer_load_dword v6, v1, s[12:15], s20 offen
s_mov_b32 s21, 32768
buffer_load_dword v7, v1, s[12:15], s21 offen
s_waitcnt vmcnt(54)
v_perm_b32 v65, v9, v8, s46
v_accvgpr_write_b32 a229, v65
v_perm_b32 v69, v9, v8, s47
v_accvgpr_write_b32 a237, v69
s_mov_b32 s20, 65536
buffer_load_dword v8, v1, s[12:15], s20 offen
s_mov_b32 s21, 98304
buffer_load_dword v9, v1, s[12:15], s21 offen
s_waitcnt vmcnt(54)
v_perm_b32 v66, v11, v10, s46
v_accvgpr_write_b32 a230, v66
v_perm_b32 v70, v11, v10, s47
v_accvgpr_write_b32 a238, v70
s_mov_b32 s20, 8192
buffer_load_dword v10, v1, s[12:15], s20 offen
s_mov_b32 s21, 40960
buffer_load_dword v11, v1, s[12:15], s21 offen
s_waitcnt vmcnt(54)
v_perm_b32 v67, v13, v12, s46
v_accvgpr_write_b32 a231, v67
v_perm_b32 v71, v13, v12, s47
v_accvgpr_write_b32 a239, v71
s_mov_b32 s20, 73728
buffer_load_dword v12, v1, s[12:15], s20 offen
s_mov_b32 s21, 106496
buffer_load_dword v13, v1, s[12:15], s21 offen
s_waitcnt vmcnt(54)
v_perm_b32 v64, v15, v14, s46
v_perm_b32 v68, v15, v14, s47
v_accvgpr_write_b32 a240, v68
s_barrier
s_mov_b32 s20, 262144
buffer_load_dword v14, v1, s[12:15], s20 offen
s_mov_b32 s21, 294912
buffer_load_dword v15, v1, s[12:15], s21 offen
s_waitcnt vmcnt(54)
v_perm_b32 v65, v17, v16, s46
v_perm_b32 v69, v17, v16, s47
v_accvgpr_write_b32 a241, v69
s_mov_b32 s20, 327680
buffer_load_dword v16, v1, s[12:15], s20 offen
s_mov_b32 s21, 360448
buffer_load_dword v17, v1, s[12:15], s21 offen
s_waitcnt vmcnt(54)
v_perm_b32 v66, v19, v18, s46
v_perm_b32 v70, v19, v18, s47
v_accvgpr_write_b32 a242, v70
v_and_b32 v5, 1, v0
v_lshlrev_b32 v5, 6, v5
buffer_load_dword v5, v5, s[56:59], 0 offen offset:64 sc1
s_mov_b32 s20, 270336
buffer_load_dword v18, v1, s[12:15], s20 offen
s_mov_b32 s21, 303104
buffer_load_dword v19, v1, s[12:15], s21 offen
s_waitcnt vmcnt(55)
v_perm_b32 v67, v21, v20, s46
ds_write_b128 v3, v[64:67] offset:32768
s_waitcnt lgkmcnt(0)
v_perm_b32 v71, v21, v20, s47
v_accvgpr_write_b32 a243, v71
s_mov_b32 s20, 335872
buffer_load_dword v20, v1, s[12:15], s20 offen
s_mov_b32 s21, 368640
buffer_load_dword v21, v1, s[12:15], s21 offen
s_waitcnt vmcnt(55)
v_perm_b32 v64, v23, v22, s46
v_perm_b32 v68, v23, v22, s47
v_accvgpr_write_b32 a244, v68
s_barrier
s_mov_b32 s20, 524288
buffer_load_dword v22, v1, s[12:15], s20 offen
s_mov_b32 s21, 557056
buffer_load_dword v23, v1, s[12:15], s21 offen
s_waitcnt vmcnt(55)
v_perm_b32 v65, v25, v24, s46
v_perm_b32 v69, v25, v24, s47
v_accvgpr_write_b32 a245, v69
s_mov_b32 s20, 589824
buffer_load_dword v24, v1, s[12:15], s20 offen
s_mov_b32 s21, 622592
buffer_load_dword v25, v1, s[12:15], s21 offen
s_waitcnt vmcnt(55)
v_perm_b32 v66, v27, v26, s46
v_perm_b32 v70, v27, v26, s47
v_accvgpr_write_b32 a246, v70
s_mov_b32 s20, 532480
buffer_load_dword v26, v1, s[12:15], s20 offen
s_mov_b32 s21, 565248
buffer_load_dword v27, v1, s[12:15], s21 offen
s_waitcnt vmcnt(55)
v_perm_b32 v67, v29, v28, s46
ds_write_b128 v3, v[64:67] offset:33792
s_waitcnt lgkmcnt(0)
v_perm_b32 v71, v29, v28, s47
v_accvgpr_write_b32 a247, v71
s_mov_b32 s20, 598016
buffer_load_dword v28, v1, s[12:15], s20 offen
s_mov_b32 s21, 630784
buffer_load_dword v29, v1, s[12:15], s21 offen
s_waitcnt vmcnt(55)
v_perm_b32 v64, v31, v30, s46
v_accvgpr_write_b32 a248, v64
s_barrier
s_mov_b32 s20, 786432
buffer_load_dword v30, v1, s[12:15], s20 offen
s_mov_b32 s21, 819200
buffer_load_dword v31, v1, s[12:15], s21 offen
s_waitcnt vmcnt(55)
v_perm_b32 v65, v33, v32, s46
v_accvgpr_write_b32 a249, v65
s_mov_b32 s20, 851968
buffer_load_dword v32, v1, s[12:15], s20 offen
s_mov_b32 s21, 884736
buffer_load_dword v33, v1, s[12:15], s21 offen
s_waitcnt vmcnt(55)
v_perm_b32 v66, v35, v34, s46
v_accvgpr_write_b32 a250, v66
s_mov_b32 s20, 794624
buffer_load_dword v34, v1, s[12:15], s20 offen
s_mov_b32 s21, 827392
buffer_load_dword v35, v1, s[12:15], s21 offen
s_waitcnt vmcnt(55)
v_perm_b32 v67, v37, v36, s46
v_accvgpr_write_b32 a251, v67
s_mov_b32 s20, 860160
buffer_load_dword v36, v1, s[12:15], s20 offen
s_mov_b32 s21, 892928
buffer_load_dword v37, v1, s[12:15], s21 offen
s_waitcnt vmcnt(55)
v_perm_b32 v64, v39, v38, s46
v_accvgpr_write_b32 a252, v64
s_barrier
s_mov_b32 s20, 1048576
buffer_load_dword v38, v1, s[12:15], s20 offen
s_mov_b32 s21, 1081344
buffer_load_dword v39, v1, s[12:15], s21 offen
s_waitcnt vmcnt(55)
v_perm_b32 v65, v41, v40, s46
v_accvgpr_write_b32 a253, v65
s_mov_b32 s20, 1114112
buffer_load_dword v40, v1, s[12:15], s20 offen
s_mov_b32 s21, 1146880
buffer_load_dword v41, v1, s[12:15], s21 offen
s_waitcnt vmcnt(55)
v_perm_b32 v66, v43, v42, s46
v_accvgpr_write_b32 a254, v66
s_mov_b32 s20, 1056768
buffer_load_dword v42, v1, s[12:15], s20 offen
s_mov_b32 s21, 1089536
buffer_load_dword v43, v1, s[12:15], s21 offen
s_waitcnt vmcnt(55)
v_perm_b32 v67, v45, v44, s46
v_accvgpr_write_b32 a255, v67
s_mov_b32 s20, 1122304
buffer_load_dword v44, v1, s[12:15], s20 offen
s_mov_b32 s21, 1155072
buffer_load_dword v45, v1, s[12:15], s21 offen
s_waitcnt vmcnt(55)
v_perm_b32 v64, v47, v46, s46
s_barrier
s_mov_b32 s20, 1310720
buffer_load_dword v46, v1, s[12:15], s20 offen
s_mov_b32 s21, 1343488
buffer_load_dword v47, v1, s[12:15], s21 offen
s_waitcnt vmcnt(55)
v_perm_b32 v65, v49, v48, s46
s_mov_b32 s20, 1376256
buffer_load_dword v48, v1, s[12:15], s20 offen
s_mov_b32 s21, 1409024
buffer_load_dword v49, v1, s[12:15], s21 offen
s_waitcnt vmcnt(55)
v_perm_b32 v66, v51, v50, s46
s_mov_b32 s20, 1318912
buffer_load_dword v50, v1, s[12:15], s20 offen
s_mov_b32 s21, 1351680
buffer_load_dword v51, v1, s[12:15], s21 offen
s_waitcnt vmcnt(55)
v_perm_b32 v67, v53, v52, s46
ds_write_b128 v3, v[64:67] offset:18432
s_waitcnt lgkmcnt(0)
s_mov_b32 s20, 1384448
buffer_load_dword v52, v1, s[12:15], s20 offen
s_mov_b32 s21, 1417216
buffer_load_dword v53, v1, s[12:15], s21 offen
s_waitcnt vmcnt(55)
v_perm_b32 v64, v55, v54, s46
s_barrier
s_mov_b32 s20, 1572864
buffer_load_dword v54, v1, s[12:15], s20 offen
s_mov_b32 s21, 1605632
buffer_load_dword v55, v1, s[12:15], s21 offen
s_waitcnt vmcnt(55)
v_perm_b32 v65, v57, v56, s46
s_mov_b32 s20, 1638400
buffer_load_dword v56, v1, s[12:15], s20 offen
s_mov_b32 s21, 1671168
buffer_load_dword v57, v1, s[12:15], s21 offen
s_waitcnt vmcnt(55)
v_perm_b32 v66, v59, v58, s46
s_mov_b32 s20, 1581056
buffer_load_dword v58, v1, s[12:15], s20 offen
s_mov_b32 s21, 1613824
buffer_load_dword v59, v1, s[12:15], s21 offen
s_waitcnt vmcnt(55)
v_perm_b32 v67, v61, v60, s46
ds_write_b128 v3, v[64:67] offset:19456
s_waitcnt lgkmcnt(0)
s_mov_b32 s20, 1646592
buffer_load_dword v60, v1, s[12:15], s20 offen
s_mov_b32 s21, 1679360
buffer_load_dword v61, v1, s[12:15], s21 offen
s_waitcnt vmcnt(55)
v_perm_b32 v72, v7, v6, s46
v_perm_b32 v80, v7, v6, s47
s_barrier
s_mov_b32 s20, 1835008
buffer_load_dword v6, v1, s[12:15], s20 offen
s_mov_b32 s21, 1867776
buffer_load_dword v7, v1, s[12:15], s21 offen
s_waitcnt vmcnt(55)
v_perm_b32 v73, v9, v8, s46
v_perm_b32 v81, v9, v8, s47
s_mov_b32 s20, 1900544
buffer_load_dword v8, v1, s[12:15], s20 offen
s_mov_b32 s21, 1933312
buffer_load_dword v9, v1, s[12:15], s21 offen
s_waitcnt vmcnt(55)
v_perm_b32 v74, v11, v10, s46
v_perm_b32 v82, v11, v10, s47
s_mov_b32 s20, 1843200
buffer_load_dword v10, v1, s[12:15], s20 offen
s_mov_b32 s21, 1875968
buffer_load_dword v11, v1, s[12:15], s21 offen
s_waitcnt vmcnt(55)
v_perm_b32 v75, v13, v12, s46
v_perm_b32 v83, v13, v12, s47
s_mov_b32 s20, 1908736
buffer_load_dword v12, v1, s[12:15], s20 offen
s_mov_b32 s21, 1941504
buffer_load_dword v13, v1, s[12:15], s21 offen
s_waitcnt vmcnt(55)
v_perm_b32 v76, v15, v14, s46
v_perm_b32 v84, v15, v14, s47
s_barrier
s_mov_b32 s20, 2097152
buffer_load_dword v14, v1, s[12:15], s20 offen
s_mov_b32 s21, 2129920
buffer_load_dword v15, v1, s[12:15], s21 offen
s_waitcnt vmcnt(55)
v_perm_b32 v77, v17, v16, s46
v_perm_b32 v85, v17, v16, s47
s_mov_b32 s20, 2162688
buffer_load_dword v16, v1, s[12:15], s20 offen
s_mov_b32 s21, 2195456
buffer_load_dword v17, v1, s[12:15], s21 offen
s_waitcnt vmcnt(54)
v_perm_b32 v78, v19, v18, s46
v_perm_b32 v86, v19, v18, s47
s_mov_b32 s20, 2105344
buffer_load_dword v18, v1, s[12:15], s20 offen
s_mov_b32 s21, 2138112
buffer_load_dword v19, v1, s[12:15], s21 offen
s_waitcnt vmcnt(54)
v_perm_b32 v79, v21, v20, s46
v_perm_b32 v87, v21, v20, s47
s_mov_b32 s20, 2170880
buffer_load_dword v20, v1, s[12:15], s20 offen
s_mov_b32 s21, 2203648
buffer_load_dword v21, v1, s[12:15], s21 offen
s_waitcnt vmcnt(54)
v_perm_b32 v96, v23, v22, s46
v_perm_b32 v104, v23, v22, s47
s_barrier
s_mov_b32 s20, 2359296
buffer_load_dword v22, v1, s[12:15], s20 offen
s_mov_b32 s21, 2392064
buffer_load_dword v23, v1, s[12:15], s21 offen
s_waitcnt vmcnt(54)
v_perm_b32 v97, v25, v24, s46
v_perm_b32 v105, v25, v24, s47
s_mov_b32 s20, 2424832
buffer_load_dword v24, v1, s[12:15], s20 offen
s_mov_b32 s21, 2457600
buffer_load_dword v25, v1, s[12:15], s21 offen
s_waitcnt vmcnt(54)
v_perm_b32 v98, v27, v26, s46
v_perm_b32 v106, v27, v26, s47
v_and_b32 v62, 1, v0
v_lshlrev_b32 v63, 6, v62
v_mul_u32_u24 v62, 24, v62
v_sub_u32 v62, 32, v62
v_cmp_ne_u32 vcc, v5, v62
s_cbranch_vccz L_tok
v_add_u32 v63, 64, v63
s_mov_b32 s28, 0
L_poll_58:
buffer_load_dword v5, v63, s[56:59], 0 offen sc1
s_add_u32 s28, s28, 1
s_cmp_gt_u32 s28, 200000
s_cbranch_scc1 L_end
s_waitcnt vmcnt(0)
v_cmp_ne_u32 vcc, v5, v62
s_cbranch_vccz L_pd_59
s_sleep 1
s_branch L_poll_58
L_pd_59:
L_tok:
v_mov_b32 v5, 0
s_lshl_b32 s99, s16, 7
s_add_u32 s99, s99, 111149088
buffer_load_dword v5, v5, s[8:11], s99 offen sc1
v_lshlrev_b32 v62, 7, v0
s_getpc_b64 s[4:5]
L_pc2:
s_mov_b32 s40, s4
s_and_b32 s41, s5, 0xffff
s_mov_b32 s42, L_end-L_pc2
s_mov_b32 s43, 0x20000
buffer_load_dword v63, v62, s[40:43], 0 offen
s_mul_i32 s98, s16, 18432
s_add_u32 s98, s98, 109051904
s_lshl_b32 s100, s16, 11
s_add_u32 s100, s100, 110075904
s_cmp_eq_u32 s17, 3
s_cselect_b32 s98, s100, s98
buffer_load_dword v63, v62, s[8:11], s98 offen sc1
s_mov_b32 s40, s96
s_and_b32 s41, s97, 0xffff
s_mov_b32 s42, 9216
s_mov_b32 s43, 0x20000
buffer_load_dword v63, v62, s[40:43], 0 offen
s_mov_b32 s20, 2367488
buffer_load_dword v26, v1, s[12:15], s20 offen
s_mov_b32 s21, 2400256
buffer_load_dword v27, v1, s[12:15], s21 offen
s_waitcnt vmcnt(58)
v_perm_b32 v99, v29, v28, s46
v_perm_b32 v107, v29, v28, s47
s_mov_b32 s20, 2433024
buffer_load_dword v28, v1, s[12:15], s20 offen
s_mov_b32 s21, 2465792
buffer_load_dword v29, v1, s[12:15], s21 offen
s_waitcnt vmcnt(58)
v_perm_b32 v100, v31, v30, s46
v_perm_b32 v108, v31, v30, s47
s_barrier
s_mov_b32 s20, 2621440
buffer_load_dword v30, v1, s[12:15], s20 offen
s_mov_b32 s21, 2654208
buffer_load_dword v31, v1, s[12:15], s21 offen
s_waitcnt vmcnt(58)
v_perm_b32 v101, v33, v32, s46
v_perm_b32 v109, v33, v32, s47
s_mov_b32 s20, 2686976
buffer_load_dword v32, v1, s[12:15], s20 offen
s_mov_b32 s21, 2719744
buffer_load_dword v33, v1, s[12:15], s21 offen
s_waitcnt vmcnt(58)
v_perm_b32 v102, v35, v34, s46
v_perm_b32 v110, v35, v34, s47
s_mov_b32 s20, 2629632
buffer_load_dword v34, v1, s[12:15], s20 offen
s_mov_b32 s21, 2662400
buffer_load_dword v35, v1, s[12:15], s21 offen
s_waitcnt vmcnt(58)
v_perm_b32 v103, v37, v36, s46
v_perm_b32 v111, v37, v36, s47
s_mov_b32 s20, 2695168
buffer_load_dword v36, v1, s[12:15], s20 offen
s_mov_b32 s21, 2727936
buffer_load_dword v37, v1, s[12:15], s21 offen
s_waitcnt vmcnt(58)
v_perm_b32 v120, v39, v38, s46
v_perm_b32 v128, v39, v38, s47
s_barrier
s_mov_b32 s20, 2883584
buffer_load_dword v38, v1, s[12:15], s20 offen
s_mov_b32 s21, 2916352
buffer_load_dword v39, v1, s[12:15], s21 offen
s_waitcnt vmcnt(58)
v_perm_b32 v121, v41, v40, s46
v_perm_b32 v129, v41, v40, s47
s_mov_b32 s20, 2949120
buffer_load_dword v40, v1, s[12:15], s20 offen
s_mov_b32 s21, 2981888
buffer_load_dword v41, v1, s[12:15], s21 offen
s_waitcnt vmcnt(58)
v_perm_b32 v122, v43, v42, s46
v_perm_b32 v130, v43, v42, s47
s_mov_b32 s20, 2891776
buffer_load_dword v42, v1, s[12:15], s20 offen
s_mov_b32 s21, 2924544
buffer_load_dword v43, v1, s[12:15], s21 offen
s_waitcnt vmcnt(58)
v_perm_b32 v123, v45, v44, s46
v_perm_b32 v131, v45, v44, s47
s_mov_b32 s20, 2957312
buffer_load_dword v44, v1, s[12:15], s20 offen
s_mov_b32 s21, 2990080
buffer_load_dword v45, v1, s[12:15], s21 offen
s_waitcnt vmcnt(58)
v_perm_b32 v124, v47, v46, s46
v_perm_b32 v132, v47, v46, s47
s_barrier
s_mov_b32 s20, 3145728
buffer_load_dword v46, v1, s[12:15], s20 offen
s_mov_b32 s21, 3178496
buffer_load_dword v47, v1, s[12:15], s21 offen
s_waitcnt vmcnt(58)
v_perm_b32 v125, v49, v48, s46
v_perm_b32 v133, v49, v48, s47
s_mov_b32 s20, 3211264
buffer_load_dword v48, v1, s[12:15], s20 offen
s_mov_b32 s21, 3244032
buffer_load_dword v49, v1, s[12:15], s21 offen
s_waitcnt vmcnt(58)
v_perm_b32 v126, v51, v50, s46
v_perm_b32 v134, v51, v50, s47
s_mov_b32 s20, 3153920
buffer_load_dword v50, v1, s[12:15], s20 offen
s_mov_b32 s21, 3186688
buffer_load_dword v51, v1, s[12:15], s21 offen
s_waitcnt vmcnt(58)
v_perm_b32 v127, v53, v52, s46
v_perm_b32 v135, v53, v52, s47
s_mov_b32 s20, 3219456
buffer_load_dword v52, v1, s[12:15], s20 offen
s_mov_b32 s21, 3252224
buffer_load_dword v53, v1, s[12:15], s21 offen
s_waitcnt vmcnt(58)
v_perm_b32 v144, v55, v54, s46
v_perm_b32 v152, v55, v54, s47
s_barrier
s_mov_b32 s20, 3407872
buffer_load_dword v54, v1, s[12:15], s20 offen
s_mov_b32 s21, 3440640
buffer_load_dword v55, v1, s[12:15], s21 offen
s_waitcnt vmcnt(58)
v_perm_b32 v145, v57, v56, s46
v_perm_b32 v153, v57, v56, s47
s_mov_b32 s20, 3473408
buffer_load_dword v56, v1, s[12:15], s20 offen
s_mov_b32 s21, 3506176
buffer_load_dword v57, v1, s[12:15], s21 offen
s_waitcnt vmcnt(58)
v_perm_b32 v146, v59, v58, s46
v_perm_b32 v154, v59, v58, s47
s_mov_b32 s20, 3416064
buffer_load_dword v58, v1, s[12:15], s20 offen
s_mov_b32 s21, 3448832
buffer_load_dword v59, v1, s[12:15], s21 offen
s_waitcnt vmcnt(58)
v_perm_b32 v147, v61, v60, s46
v_perm_b32 v155, v61, v60, s47
s_mov_b32 s20, 3481600
buffer_load_dword v60, v1, s[12:15], s20 offen
s_mov_b32 s21, 3514368
buffer_load_dword v61, v1, s[12:15], s21 offen
s_waitcnt vmcnt(58)
v_perm_b32 v148, v7, v6, s46
v_perm_b32 v156, v7, v6, s47
s_barrier
s_mov_b32 s20, 3670016
buffer_load_dword v6, v1, s[12:15], s20 offen
s_mov_b32 s21, 3702784
buffer_load_dword v7, v1, s[12:15], s21 offen
s_waitcnt vmcnt(58)
v_perm_b32 v149, v9, v8, s46
v_perm_b32 v157, v9, v8, s47
s_mov_b32 s20, 3735552
buffer_load_dword v8, v1, s[12:15], s20 offen
s_mov_b32 s21, 3768320
buffer_load_dword v9, v1, s[12:15], s21 offen
s_waitcnt vmcnt(58)
v_perm_b32 v150, v11, v10, s46
v_perm_b32 v158, v11, v10, s47
s_mov_b32 s20, 3678208
buffer_load_dword v10, v1, s[12:15], s20 offen
s_mov_b32 s21, 3710976
buffer_load_dword v11, v1, s[12:15], s21 offen
s_waitcnt vmcnt(58)
v_perm_b32 v151, v13, v12, s46
v_perm_b32 v159, v13, v12, s47
s_mov_b32 s20, 3743744
buffer_load_dword v12, v1, s[12:15], s20 offen
s_mov_b32 s21, 3776512
buffer_load_dword v13, v1, s[12:15], s21 offen
s_waitcnt vmcnt(58)
v_perm_b32 v168, v15, v14, s46
v_perm_b32 v176, v15, v14, s47
s_barrier
s_mov_b32 s20, 3932160
buffer_load_dword v14, v1, s[12:15], s20 offen
s_mov_b32 s21, 3964928
buffer_load_dword v15, v1, s[12:15], s21 offen
s_waitcnt vmcnt(58)
v_perm_b32 v169, v17, v16, s46
v_perm_b32 v177, v17, v16, s47
s_mov_b32 s20, 3997696
buffer_load_dword v16, v1, s[12:15], s20 offen
s_mov_b32 s21, 4030464
buffer_load_dword v17, v1, s[12:15], s21 offen
s_waitcnt vmcnt(58)
v_perm_b32 v170, v19, v18, s46
v_perm_b32 v178, v19, v18, s47
s_mov_b32 s20, 3940352
buffer_load_dword v18, v1, s[12:15], s20 offen
s_mov_b32 s21, 3973120
buffer_load_dword v19, v1, s[12:15], s21 offen
s_waitcnt vmcnt(58)
v_perm_b32 v171, v21, v20, s46
v_perm_b32 v179, v21, v20, s47
s_mov_b32 s20, 4005888
buffer_load_dword v20, v1, s[12:15], s20 offen
s_mov_b32 s21, 4038656
buffer_load_dword v21, v1, s[12:15], s21 offen
s_waitcnt vmcnt(58)
v_perm_b32 v172, v23, v22, s46
v_perm_b32 v180, v23, v22, s47
s_barrier
s_mov_b32 s20, 4194304
buffer_load_dword v22, v1, s[12:15], s20 offen
s_mov_b32 s21, 4227072
buffer_load_dword v23, v1, s[12:15], s21 offen
s_waitcnt vmcnt(58)
v_perm_b32 v173, v25, v24, s46
v_perm_b32 v181, v25, v24, s47
s_mov_b32 s20, 4259840
buffer_load_dword v24, v1, s[12:15], s20 offen
s_mov_b32 s21, 4292608
buffer_load_dword v25, v1, s[12:15], s21 offen
s_waitcnt vmcnt(54)
v_perm_b32 v174, v27, v26, s46
v_perm_b32 v182, v27, v26, s47
s_mov_b32 s20, 4202496
buffer_load_dword v26, v1, s[12:15], s20 offen
s_mov_b32 s21, 4235264
buffer_load_dword v27, v1, s[12:15], s21 offen
s_waitcnt vmcnt(54)
v_perm_b32 v175, v29, v28, s46
v_perm_b32 v183, v29, v28, s47
s_mov_b32 s20, 4268032
buffer_load_dword v28, v1, s[12:15], s20 offen
s_mov_b32 s21, 4300800
buffer_load_dword v29, v1, s[12:15], s21 offen
s_waitcnt vmcnt(54)
v_perm_b32 v192, v31, v30, s46
v_perm_b32 v200, v31, v30, s47
s_barrier
s_mov_b32 s20, 4456448
buffer_load_dword v30, v1, s[12:15], s20 offen
s_mov_b32 s21, 4489216
buffer_load_dword v31, v1, s[12:15], s21 offen
s_waitcnt vmcnt(54)
v_perm_b32 v193, v33, v32, s46
v_perm_b32 v201, v33, v32, s47
s_mov_b32 s20, 4521984
buffer_load_dword v32, v1, s[12:15], s20 offen
s_mov_b32 s21, 4554752
buffer_load_dword v33, v1, s[12:15], s21 offen
s_waitcnt vmcnt(54)
v_perm_b32 v194, v35, v34, s46
v_perm_b32 v202, v35, v34, s47
v_readfirstlane_b32 s101, v5
s_cmp_lt_u32 s17, 2
s_cselect_b32 s98, s30, 536870912
s_cmp_eq_u32 s101, 1
s_cselect_b32 s98, s98, 536870912
buffer_load_dword v63, v62, s[8:11], s98 offen sc1
s_mov_b32 s20, 4464640
buffer_load_dword v34, v1, s[12:15], s20 offen
s_mov_b32 s21, 4497408
buffer_load_dword v35, v1, s[12:15], s21 offen
s_waitcnt vmcnt(55)
v_perm_b32 v195, v37, v36, s46
v_perm_b32 v203, v37, v36, s47
s_mov_b32 s20, 4530176
buffer_load_dword v36, v1, s[12:15], s20 offen
s_mov_b32 s21, 4562944
buffer_load_dword v37, v1, s[12:15], s21 offen
s_waitcnt vmcnt(55)
v_perm_b32 v196, v39, v38, s46
v_perm_b32 v204, v39, v38, s47
s_waitcnt vmcnt(53)
v_perm_b32 v197, v41, v40, s46
v_perm_b32 v205, v41, v40, s47
s_waitcnt vmcnt(51)
v_perm_b32 v198, v43, v42, s46
v_perm_b32 v206, v43, v42, s47
s_waitcnt vmcnt(49)
v_perm_b32 v199, v45, v44, s46
v_perm_b32 v207, v45, v44, s47
s_waitcnt vmcnt(47)
v_perm_b32 v216, v47, v46, s46
v_perm_b32 v224, v47, v46, s47
s_waitcnt vmcnt(45)
v_perm_b32 v217, v49, v48, s46
v_perm_b32 v225, v49, v48, s47
s_waitcnt vmcnt(43)
v_perm_b32 v218, v51, v50, s46
v_perm_b32 v226, v51, v50, s47
s_waitcnt vmcnt(41)
v_perm_b32 v219, v53, v52, s46
v_perm_b32 v227, v53, v52, s47
s_waitcnt vmcnt(39)
v_perm_b32 v220, v55, v54, s46
v_perm_b32 v228, v55, v54, s47
s_waitcnt vmcnt(37)
v_perm_b32 v221, v57, v56, s46
v_perm_b32 v229, v57, v56, s47
s_waitcnt vmcnt(35)
v_perm_b32 v222, v59, v58, s46
v_perm_b32 v230, v59, v58, s47
s_waitcnt vmcnt(33)
v_perm_b32 v223, v61, v60, s46
v_perm_b32 v231, v61, v60, s47
s_waitcnt vmcnt(31)
v_perm_b32 v240, v7, v6, s46
v_perm_b32 v248, v7, v6, s47
s_waitcnt vmcnt(29)
v_perm_b32 v241, v9, v8, s46
v_perm_b32 v249, v9, v8, s47
s_waitcnt vmcnt(27)
v_perm_b32 v242, v11, v10, s46
v_perm_b32 v250, v11, v10, s47
s_waitcnt vmcnt(25)
v_perm_b32 v243, v13, v12, s46
v_perm_b32 v251, v13, v12, s47
s_waitcnt vmcnt(23)
v_perm_b32 v244, v15, v14, s46
v_perm_b32 v252, v15, v14, s47
s_waitcnt vmcnt(21)
v_perm_b32 v245, v17, v16, s46
v_perm_b32 v253, v17, v16, s47
s_waitcnt vmcnt(19)
v_perm_b32 v246, v19, v18, s46
v_perm_b32 v254, v19, v18, s47
s_waitcnt vmcnt(17)
v_perm_b32 v247, v21, v20, s46
v_perm_b32 v255, v21, v20, s47
s_waitcnt vmcnt(15)
v_perm_b32 v64, v23, v22, s46
v_accvgpr_write_b32 a8, v64
v_perm_b32 v68, v23, v22, s47
v_accvgpr_write_b32 a16, v68
s_waitcnt vmcnt(13)
v_perm_b32 v65, v25, v24, s46
v_accvgpr_write_b32 a9, v65
v_perm_b32 v69, v25, v24, s47
v_accvgpr_write_b32 a17, v69
s_waitcnt vmcnt(11)
v_perm_b32 v66, v27, v26, s46
v_accvgpr_write_b32 a10, v66
v_perm_b32 v70, v27, v26, s47
v_accvgpr_write_b32 a18, v70
s_waitcnt vmcnt(9)
v_perm_b32 v67, v29, v28, s46
v_accvgpr_write_b32 a11, v67
v_perm_b32 v71, v29, v28, s47
v_accvgpr_write_b32 a19, v71
s_waitcnt vmcnt(7)
v_perm_b32 v64, v31, v30, s46
v_accvgpr_write_b32 a12, v64
v_perm_b32 v68, v31, v30, s47
v_accvgpr_write_b32 a20, v68
s_waitcnt vmcnt(5)
v_perm_b32 v65, v33, v32, s46
v_accvgpr_write_b32 a13, v65
v_perm_b32 v69, v33, v32, s47
v_accvgpr_write_b32 a21, v69
s_waitcnt vmcnt(2)
v_perm_b32 v66, v35, v34, s46
v_accvgpr_write_b32 a14, v66
v_perm_b32 v70, v35, v34, s47
v_accvgpr_write_b32 a22, v70
s_waitcnt vmcnt(0)
v_perm_b32 v67, v37, v36, s46
v_accvgpr_write_b32 a15, v67
v_perm_b32 v71, v37, v36, s47
v_accvgpr_write_b32 a23, v71
v_mov_b32 v12, v0
v_and_b32 v13, 15, v0
v_bfe_u32 v14, v0, 4, 2
v_lshlrev_b32 v3, 4, v12
v_and_b32 v2, 0x3f0, v3
s_mul_i32 s20, s17, 34816
s_add_u32 s20, s20, 24576
v_add_u32 v2, s20, v2
v_and_b32 v15, 1, v12
v_mul_u32_u24 v0, 0xaaaa, v15
v_add_u32 v0, 0xffff4444, v0
v_lshrrev_b32 v18, 2, v13
v_lshl_add_u32 v18, v18, 1, v15
v_bfe_u32 v19, v13, 1, 1
v_lshrrev_b32 v16, 5, v12
v_lshlrev_b32 v16, 8, v16
v_lshl_add_u32 v16, v18, 5, v16
v_and_b32 v17, 1, v14
v_lshl_add_u32 v16, v17, 4, v16
v_and_b32 v17, 0x7f, v16
v_xor_b32 v17, 16, v17
v_add_u32 v16, 4224, v16
v_add_u32 v17, 6272, v17
v_cmp_eq_u32 vcc, 1, v19
s_nop 1
v_cndmask_b32 v7, v17, v16, vcc
v_lshrrev_b32 v16, 1, v14
v_lshlrev_b32 v16, 8, v16
v_lshl_add_u32 v16, v15, 7, v16
v_and_b32 v17, 1, v14
v_lshl_add_u32 v16, v17, 6, v16
v_lshrrev_b32 v17, 2, v13
v_lshl_add_u32 v16, v17, 4, v16
v_mul_u32_u24 v17, 2112, v19
v_add_u32 v5, v16, v17
v_bfe_u32 v16, v13, 3, 1
v_lshlrev_b32 v16, 8, v16
v_lshl_add_u32 v16, v19, 6, v16
v_lshl_add_u32 v16, v14, 4, v16
v_bfe_u32 v17, v13, 2, 1
v_lshl_add_u32 v16, v17, 3, v16
v_lshl_add_u32 v16, v15, 2, v16
s_lshl_b32 s20, s17, 9
v_add_u32 v4, s20, v16
v_lshrrev_b32 v16, 4, v12
v_xor_b32 v17, s16, v16
v_lshlrev_b32 v16, 12, v16
v_lshl_add_u32 v16, v17, 7, v16
v_lshl_add_u32 v9, v13, 3, v16
s_lshr_b32 s20, s17, 1
s_lshl_b32 s20, s20, 2
v_add_u32 v16, s20, v14
v_xor_b32 v17, s16, v16
v_lshlrev_b32 v16, 12, v16
v_lshl_add_u32 v16, v17, 7, v16
v_lshl_add_u32 v16, v13, 2, v16
s_and_b32 s20, s17, 1
s_lshl_b32 s20, s20, 6
s_add_u32 s20, s20, 262144
v_add_u32 v10, s20, v16
v_bfe_u32 v16, v13, 2, 1
v_lshlrev_b32 v16, 5, v16
v_and_b32 v17, 1, v14
v_lshl_add_u32 v16, v17, 8, v16
v_lshrrev_b32 v17, 1, v14
v_lshl_add_u32 v16, v17, 4, v16
v_and_b32 v17, 3, v13
v_lshl_add_u32 v11, v17, 2, v16
v_lshlrev_b32 v6, 7, v12
v_lshlrev_b32 v8, 2, v12
s_mov_b32 s36, 0x11111111
s_mov_b32 s37, 0x11111111
s_mov_b32 s38, 0x22222222
s_mov_b32 s39, 0x22222222
s_mov_b32 s40, 0x44444444
s_mov_b32 s41, 0x44444444
s_mov_b32 s42, 0x88888888
s_mov_b32 s43, 0x88888888
s_mov_b32 s44, 0xf0f0f0f0
s_mov_b32 s45, 0xf0f0f0f0
s_mov_b32 s18, 0x3e0293ee
s_lshl_b32 s20, s17, 5
s_add_u32 s20, s20, s16
s_cmp_lt_u32 s20, 72
s_cselect_b32 s48, 1, 0
s_lshl_b32 s23, s20, 12
s_lshl_b32 s21, s17, 10
s_sub_u32 s23, s23, s21
s_lshr_b32 s24, s20, 2
s_lshl_b32 s24, s24, 9
s_and_b32 s21, s20, 3
s_lshl_b32 s21, s21, 6
s_add_u32 s24, s24, s21
s_add_u32 s24, s24, 110100480
s_cmp_lt_u32 s20, 72
s_cselect_b32 s24, s24, 536870912
s_lshl_b32 s25, s16, 12
s_add_u32 s26, s25, 131072
s_add_u32 s27, s25, 262144
s_cmp_lt_u32 s16, 8
s_cselect_b32 s27, s27, 536870912
s_mov_b32 s28, 109051904
s_mov_b32 s29, 109346816
s_lshl_b32 s30, s16, 14
s_add_u32 s30, s30, 33554432
s_lshl_b32 s31, s16, 12
s_add_u32 s31, s31, 100663296
s_add_u32 s35, s24, 32768
s_mov_b32 s53, 0x3f803f80
s_mov_b32 s86, 0x33333333
s_mov_b32 s87, 0x33333333
s_lshl_b32 s84, s17, 13
s_sub_u32 s84, s20, s84
s_add_u32 s84, s84, 110886912
s_cmp_lt_u32 s20, 72
s_cselect_b32 s84, s84, 536870912
s_and_b32 s21, s16, 3
s_lshl_b32 s21, s21, 7
s_add_u32 s21, s21, 110886144
s_cmp_eq_u32 s17, 3
s_cselect_b32 s84, s21, s84
s_lshl_b32 s82, s16, 7
s_add_u32 s83, s82, 111152384
s_add_u32 s82, s82, 111148288
s_mov_b32 s19, 0
s_mov_b32 s12, s96
s_and_b32 s13, s97, 0xffff
s_mov_b32 s14, 9216
s_mov_b32 s15, 0x20000
v_bfe_u32 v64, v3, 5, 3
v_mul_u32_u24 v64, 1152, v64
v_lshrrev_b32 v65, 8, v3
v_lshl_add_u32 v64, v65, 5, v64
v_and_b32 v65, 16, v3
v_add_u32 v64, v64, v65
buffer_load_dwordx4 v[24:27], v64, s[12:15], 0 offen
buffer_load_dwordx4 v[28:31], v64, s[12:15], 0 offen offset:512
buffer_load_dwordx4 v[32:35], v64, s[12:15], 0 offen offset:1024
s_cmp_eq_u32 s101, 1
s_cbranch_scc1 L_kv0
v_mov_b32 v66, 0
s_mov_b32 s22, 0
L_poll_60:
buffer_load_dword v67, v66, s[8:11], s99 offen sc1
s_add_u32 s22, s22, 1
s_cmp_gt_u32 s22, 200000
s_cbranch_scc1 L_end
s_waitcnt vmcnt(0)
v_cmp_ne_u32 vcc, 1, v67
s_cbranch_vccz L_pd_61
s_branch L_poll_60
L_pd_61:
s_cmp_lt_u32 s17, 2
s_cselect_b32 s98, s30, 536870912
buffer_load_dword v67, v6, s[8:11], s98 offen sc1
L_kv0:
s_waitcnt vmcnt(0)
v_perm_b32 v12, v26, v24, s46
v_perm_b32 v13, v26, v24, s47
v_perm_b32 v14, v27, v25, s46
v_perm_b32 v15, v27, v25, s47
v_min_u32 v12, 0xfffeffff, v12
v_min_u32 v13, 0xfffeffff, v13
v_min_u32 v14, 0xfffeffff, v14
v_min_u32 v15, 0xfffeffff, v15
v_perm_b32 v16, v30, v28, s46
v_perm_b32 v17, v30, v28, s47
v_perm_b32 v18, v31, v29, s46
v_perm_b32 v19, v31, v29, s47
v_min_u32 v16, 0xfffeffff, v16
v_min_u32 v17, 0xfffeffff, v17
v_min_u32 v18, 0xfffeffff, v18
v_min_u32 v19, 0xfffeffff, v19
v_perm_b32 v20, v34, v32, s46
v_perm_b32 v21, v34, v32, s47
v_perm_b32 v22, v35, v33, s46
v_perm_b32 v23, v35, v33, s47
v_min_u32 v20, 0xfffeffff, v20
v_min_u32 v21, 0xfffeffff, v21
v_min_u32 v22, 0xfffeffff, v22
v_min_u32 v23, 0xfffeffff, v23
s_cmp_lg_u32 s17, 0
s_cbranch_scc1 L_m0_62
ds_write_b128 v3, v[20:23] offset:14848
v_mov_b32 v64, 6528
v_mov_b32 v56, 0
v_mov_b32 v57, 0
v_mov_b32 v58, 0
v_mov_b32 v59, 0
ds_write_b128 v64, v[56:59]
L_m0_62:
s_waitcnt lgkmcnt(0)
s_barrier
ds_read_b32 v20, v8 offset:14848
s_waitcnt lgkmcnt(0)
s_mov_b32 s33, 110100480
s_mov_b32 s6, 110100480
s_mov_b32 s7, 110100480
s_mov_b32 s22, 0
s_cmp_eq_u32 s17, 0
s_cbranch_scc1 L_ent0
s_cmp_eq_u32 s17, 1
s_cbranch_scc1 L_ent1
s_cmp_eq_u32 s17, 2
s_cbranch_scc1 L_ent2
s_cmp_eq_u32 s17, 3
s_cbranch_scc1 L_ent3
s_branch L_end
L_ent0:
s_movk_i32 s4, -64
s_mov_b32 s14, s53
s_mov_b32 s15, s53
v_mov_b64 v[24:25], 0
v_mov_b64 v[26:27], 0
v_mov_b64 v[28:29], 0
v_mov_b64 v[30:31], 0
v_and_b32 v69, 0x380, v3
v_add_u32 v69, v69, v3
v_and_b32 v70, 0xf40, v3
v_add_u32 v70, v70, v3
v_bfe_u32 v71, v3, 7, 1
v_mad_i32_i24 v70, v71, s4, v70
v_mov_b64 v[64:65], -1
v_mov_b64 v[66:67], -1
v_add_u32 v1, 2112, v4
ds_read_b128 v[48:51], v2 offset:8192
ds_read_b128 v[52:55], v2 offset:9216
ds_read_b128 v[40:43], v2
ds_read_b128 v[44:47], v2 offset:1024
v_mov_b64 v[32:33], 0
v_mov_b64 v[34:35], 0
v_mov_b64 v[36:37], 0
v_mov_b64 v[38:39], 0
v_mov_b64 v[56:57], 0
v_mov_b64 v[58:59], 0
v_mov_b64 v[60:61], 0
v_mov_b64 v[62:63], 0
s_add_u32 s20, s30, 0
s_add_u32 s21, s30, 8192
s_add_u32 s49, s29, s25
s_add_u32 s50, s29, s26
s_add_u32 s51, s29, s27
s_add_u32 s52, s30, 524288
s_mov_b32 m0, 15872
s_nop 0
buffer_load_dwordx4 v69, s[8:11], s20 offen sc1 lds
s_mov_b32 m0, 16768
s_nop 0
buffer_load_dwordx4 v69, s[8:11], s20 offen offset:128 sc1 lds
s_waitcnt vmcnt(0) lgkmcnt(0)
s_branch L_step0
L_gr0:
buffer_load_dwordx4 v[12:15], v3, s[8:11], s33 offen sc1
buffer_load_dword v20, v8, s[8:11], s7 offen sc1
buffer_load_dwordx4 v[16:19], v3, s[8:11], s6 offen sc1
s_add_u32 s22, s22, 1
s_cmp_gt_u32 s22, 200000
s_cbranch_scc1 L_end
buffer_load_dwordx4 v[16:19], v3, s[8:11], s6 offen sc1
v_mov_b64 v[24:25], 0
v_mov_b64 v[26:27], 0
v_mov_b64 v[28:29], 0
v_mov_b64 v[30:31], 0
v_mov_b64 v[32:33], 0
v_mov_b64 v[34:35], 0
v_mov_b64 v[36:37], 0
v_mov_b64 v[38:39], 0
v_mov_b64 v[56:57], 0
v_mov_b64 v[58:59], 0
v_mov_b64 v[60:61], 0
v_mov_b64 v[62:63], 0
s_waitcnt lgkmcnt(0)
s_branch L_step0
.p2align 3
L_gat0:
buffer_load_dwordx4 v[12:15], v3, s[8:11], s33 offen sc1
buffer_load_dword v20, v8, s[8:11], s7 offen sc1
s_add_u32 s20, s30, 0
s_add_u32 s21, s30, 8192
s_add_u32 s49, s29, s25
s_add_u32 s50, s29, s26
s_add_u32 s51, s29, s27
s_add_u32 s52, s30, 524288
buffer_load_dwordx4 v[16:19], v3, s[8:11], s6 offen sc1
s_mov_b32 m0, 15872
s_waitcnt vmcnt(4)
ds_read_b128 v[40:43], v2
ds_read_b128 v[44:47], v2 offset:1024
v_mov_b64 v[32:33], 0
v_mov_b64 v[34:35], 0
v_mov_b64 v[36:37], 0
v_mov_b64 v[38:39], 0
v_mov_b64 v[56:57], 0
v_mov_b64 v[58:59], 0
v_mov_b64 v[60:61], 0
v_mov_b64 v[62:63], 0
s_nop 3
buffer_load_dwordx4 v[16:19], v3, s[8:11], s6 offen sc1
s_waitcnt lgkmcnt(0)
L_step0:
s_waitcnt vmcnt(3)
v_smfmac_f32_16x16x64_bf16 v[24:27], v[12:15], v[72:79], v0
ds_write_b128 v3, v[12:15] offset:6656
v_smfmac_f32_16x16x64_bf16 v[28:31], v[12:15], v[80:87], v0
s_waitcnt vmcnt(2)
v_max3_u32 v21, v12, v13, v14
v_max3_u32 v21, v21, v15, v20
v_cmp_le_u32 vcc, 0xffff0000, v21
v_smfmac_f32_16x16x64_bf16 v[32:35], v[12:15], v[88:95], v0
s_cbranch_vccnz L_gr0
s_waitcnt vmcnt(1)
v_max3_u32 v21, v16, v17, v18
v_max_u32 v21, v21, v19
v_cmp_le_u32 vcc, 0xffff0000, v21
ds_write_b32 v8, v20 offset:14848
v_smfmac_f32_16x16x64_bf16 v[56:59], v[12:15], a[32:39], v0
s_cbranch_vccnz L_g3r0
L_g30:
ds_write_b128 v3, v[16:19] offset:10752
v_smfmac_f32_16x16x64_bf16 v[60:63], v[12:15], a[40:47], v0
v_smfmac_f32_16x16x64_bf16 v[36:39], v[12:15], v[40:47], v0
v_smfmac_f32_16x16x64_bf16 v[24:27], v[16:19], v[168:175], v0
v_smfmac_f32_16x16x64_bf16 v[28:31], v[16:19], v[176:183], v0
s_waitcnt lgkmcnt(0)
s_barrier
ds_read_b128 v[20:23], v3 offset:7680
v_smfmac_f32_16x16x64_bf16 v[32:35], v[16:19], v[184:191], v0
ds_read_b128 v[12:15], v3 offset:8704
s_mov_b32 m0, 6272
buffer_store_dword v0, v11, s[8:11], s35 offen
v_smfmac_f32_16x16x64_bf16 v[56:59], v[16:19], a[96:103], v0
ds_read_b128 v[40:43], v2 offset:2048
buffer_store_dwordx4 v[64:67], v3, s[8:11], s49 offen
v_smfmac_f32_16x16x64_bf16 v[60:63], v[16:19], a[104:111], v0
ds_read_b128 v[44:47], v2 offset:3072
v_smfmac_f32_16x16x64_bf16 v[36:39], v[16:19], v[48:55], v0
s_waitcnt vmcnt(2)
ds_read_b128 v[16:19], v3 offset:9728
buffer_store_dwordx4 v[64:67], v3, s[8:11], s50 offen
s_waitcnt lgkmcnt(4)
v_smfmac_f32_16x16x64_bf16 v[24:27], v[20:23], v[96:103], v0
ds_read_b128 v[48:51], v2 offset:4096
v_smfmac_f32_16x16x64_bf16 v[28:31], v[20:23], v[104:111], v0
ds_read_b128 v[52:55], v2 offset:5120
buffer_store_dwordx4 v[64:67], v3, s[8:11], s51 offen
v_smfmac_f32_16x16x64_bf16 v[32:35], v[20:23], v[112:119], v0
s_waitcnt lgkmcnt(3)
v_smfmac_f32_16x16x64_bf16 v[36:39], v[20:23], v[40:47], v0
ds_read_b128 v[20:23], v3 offset:11776
buffer_load_dwordx4 v[64:67], v70, s[8:11], s21 offen sc1
v_smfmac_f32_16x16x64_bf16 v[24:27], v[12:15], v[120:127], v0
ds_read_b128 v[40:43], v2 offset:6144
v_smfmac_f32_16x16x64_bf16 v[28:31], v[12:15], v[128:135], v0
ds_read_b128 v[44:47], v2 offset:7168
buffer_load_dwordx4 v[68:71], v70, s[8:11], s21 offen offset:256 sc1
v_smfmac_f32_16x16x64_bf16 v[32:35], v[12:15], v[136:143], v0
s_waitcnt lgkmcnt(3)
v_smfmac_f32_16x16x64_bf16 v[36:39], v[12:15], v[48:55], v0
ds_read_b128 v[12:15], v3 offset:12800
v_smfmac_f32_16x16x64_bf16 v[24:27], v[16:19], v[144:151], v0
ds_read_b128 v[48:51], v2 offset:10240
v_smfmac_f32_16x16x64_bf16 v[28:31], v[16:19], v[152:159], v0
ds_read_b128 v[52:55], v2 offset:11264
v_smfmac_f32_16x16x64_bf16 v[32:35], v[16:19], v[160:167], v0
s_waitcnt lgkmcnt(3)
buffer_load_dword v6, s[8:11], s52 offen sc1 lds
v_smfmac_f32_16x16x64_bf16 v[36:39], v[16:19], v[40:47], v0
ds_read_b128 v[16:19], v3 offset:13824
v_smfmac_f32_16x16x64_bf16 v[24:27], v[20:23], v[192:199], v0
ds_read_b128 v[40:43], v2 offset:12288
v_smfmac_f32_16x16x64_bf16 v[28:31], v[20:23], v[200:207], v0
ds_read_b128 v[44:47], v2 offset:13312
v_smfmac_f32_16x16x64_bf16 v[32:35], v[20:23], v[208:215], v0
s_waitcnt lgkmcnt(3)
v_smfmac_f32_16x16x64_bf16 v[36:39], v[20:23], v[48:55], v0
ds_read_b128 v[20:23], v3 offset:14848
v_smfmac_f32_16x16x64_bf16 v[24:27], v[12:15], v[216:223], v0
ds_read_b128 v[48:51], v2 offset:14336
v_smfmac_f32_16x16x64_bf16 v[28:31], v[12:15], v[224:231], v0
ds_read_b128 v[52:55], v2 offset:15360
v_smfmac_f32_16x16x64_bf16 v[32:35], v[12:15], v[232:239], v0
s_waitcnt lgkmcnt(3)
v_smfmac_f32_16x16x64_bf16 v[36:39], v[12:15], v[40:47], v0
ds_read_b128 v[12:15], v3 offset:7680
v_smfmac_f32_16x16x64_bf16 v[24:27], v[16:19], v[240:247], v0
ds_read_b128 v[40:43], v2 offset:16384
v_smfmac_f32_16x16x64_bf16 v[28:31], v[16:19], v[248:255], v0
ds_read_b128 v[44:47], v2 offset:17408
v_smfmac_f32_16x16x64_bf16 v[32:35], v[16:19], a[0:7], v0
s_waitcnt lgkmcnt(3)
v_smfmac_f32_16x16x64_bf16 v[36:39], v[16:19], v[48:55], v0
ds_read_b128 v[16:19], v3 offset:8704
v_smfmac_f32_16x16x64_bf16 v[24:27], v[20:23], a[8:15], v0
ds_read_b128 v[48:51], v3 offset:19968
v_smfmac_f32_16x16x64_bf16 v[28:31], v[20:23], a[16:23], v0
ds_read_b128 v[52:55], v3 offset:22016
v_smfmac_f32_16x16x64_bf16 v[32:35], v[20:23], a[24:31], v0
s_waitcnt lgkmcnt(3)
v_smfmac_f32_16x16x64_bf16 v[36:39], v[20:23], v[40:47], v0
ds_read_b128 v[20:23], v3 offset:9728
s_nop 0
v_add_f32 v24, v24, v25
v_smfmac_f32_16x16x64_bf16 v[56:59], v[12:15], a[48:55], v0
ds_read_b128 v[40:43], v3 offset:15872
v_add_f32 v26, v26, v27
v_add_f32 v28, v28, v29
v_add_f32 v30, v30, v31
v_mul_f32 v24, s18, v24
v_smfmac_f32_16x16x64_bf16 v[60:63], v[12:15], a[56:63], v0
ds_read_b128 v[12:15], v3 offset:11776
v_mul_f32 v28, s18, v28
v_mul_f32 v26, s18, v26
v_mul_f32 v30, s18, v30
v_cvt_pk_bf16_f32 v24, v24, v28
s_waitcnt lgkmcnt(5)
v_smfmac_f32_16x16x64_bf16 v[56:59], v[16:19], a[64:71], v0
ds_read_b128 v[44:47], v3 offset:17920
v_cvt_pk_bf16_f32 v26, v26, v30
ds_write2_b32 v1, v24, v26 offset1:32
v_add_f32 v32, v32, v33
v_add_f32 v34, v34, v35
v_smfmac_f32_16x16x64_bf16 v[60:63], v[16:19], a[72:79], v0
ds_read_b128 v[16:19], v3 offset:12800
v_add_f32 v36, v36, v37
v_add_f32 v38, v38, v39
v_cvt_pk_bf16_f32 v1, v32, v36
v_cvt_pk_bf16_f32 v8, v34, v38
s_waitcnt lgkmcnt(5)
v_smfmac_f32_16x16x64_bf16 v[56:59], v[20:23], a[80:87], v0
ds_write2_b32 v4, v1, v8 offset1:32
v_smfmac_f32_16x16x64_bf16 v[60:63], v[20:23], a[88:95], v0
s_waitcnt lgkmcnt(4)
ds_read_b128 v[20:23], v3 offset:13824
v_smfmac_f32_16x16x64_bf16 v[56:59], v[12:15], a[112:119], v0
v_smfmac_f32_16x16x64_bf16 v[60:63], v[12:15], a[120:127], v0
s_waitcnt lgkmcnt(2)
ds_read_b128 v[12:15], v3 offset:14848
v_smfmac_f32_16x16x64_bf16 v[56:59], v[16:19], a[128:135], v0
v_smfmac_f32_16x16x64_bf16 v[60:63], v[16:19], a[136:143], v0
s_waitcnt lgkmcnt(2)
s_barrier
ds_read_b128 v[24:27], v5
s_waitcnt lgkmcnt(2)
v_smfmac_f32_16x16x64_bf16 v[56:59], v[20:23], a[144:151], v0
ds_read_b128 v[28:31], v5 offset:512
v_smfmac_f32_16x16x64_bf16 v[60:63], v[20:23], a[152:159], v0
s_waitcnt lgkmcnt(2)
ds_read_b128 v[32:35], v5 offset:1024
v_smfmac_f32_16x16x64_bf16 v[56:59], v[12:15], a[160:167], v0
ds_read_b128 v[36:39], v5 offset:1536
v_smfmac_f32_16x16x64_bf16 v[60:63], v[12:15], a[168:175], v0
s_waitcnt lgkmcnt(3)
v_mfma_f32_16x16x32_bf16 v[16:19], v[40:43], v[24:27], 0
s_waitcnt lgkmcnt(2)
ds_read_b128 v[40:43], v3 offset:16896
v_mfma_f32_16x16x32_bf16 v[16:19], v[44:47], v[28:31], v[16:19]
s_waitcnt lgkmcnt(2)
ds_read_b128 v[44:47], v3 offset:18944
v_mfma_f32_16x16x32_bf16 v[16:19], v[48:51], v[32:35], v[16:19]
s_waitcnt lgkmcnt(2)
ds_read_b128 v[48:51], v3 offset:20992
v_add_f32 v56, v56, v57
v_mfma_f32_16x16x32_bf16 v[16:19], v[52:55], v[36:39], v[16:19]
ds_read_b128 v[52:55], v3 offset:23040
v_add_f32 v58, v58, v59
v_mfma_f32_16x16x32_bf16 v[20:23], v[24:27], v[24:27], 0
s_add_u32 s49, s28, s23
v_add_f32 v60, v60, v61
v_add_f32 v62, v62, v63
v_mfma_f32_16x16x32_bf16 v[20:23], v[28:31], v[28:31], v[20:23]
s_add_u32 s50, s28, 65536
v_cvt_pk_bf16_f32 v56, v56, v58
v_cvt_pk_bf16_f32 v57, v60, v62
v_mfma_f32_16x16x32_bf16 v[20:23], v[32:35], v[32:35], v[20:23]
s_add_u32 s51, s28, 131072
v_mov_b32 v58, v1
v_mov_b32 v59, v8
v_exp_f32 v16, v16
buffer_store_dwordx4 v[56:59], v3, s[8:11], s31 offen sc1
v_mfma_f32_16x16x32_bf16 v[20:23], v[36:39], v[36:39], v[20:23]
s_waitcnt lgkmcnt(3)
v_exp_f32 v17, v17
v_mfma_f32_16x16x32_bf16 v[12:15], v[40:43], v[24:27], 0
s_waitcnt lgkmcnt(2)
v_exp_f32 v18, v18
v_mfma_f32_16x16x32_bf16 v[12:15], v[44:47], v[28:31], v[12:15]
s_waitcnt lgkmcnt(1)
v_exp_f32 v19, v19
v_mfma_f32_16x16x32_bf16 v[12:15], v[48:51], v[32:35], v[12:15]
s_waitcnt lgkmcnt(0)
v_exp_f32 v20, v20
v_mfma_f32_16x16x32_bf16 v[12:15], v[52:55], v[36:39], v[12:15]
s_add_u32 s52, s28, 196608
v_exp_f32 v21, v21
v_mov_b64 v[60:61], s[14:15]
v_cvt_pk_bf16_f32 v23, v20, v21
v_cvt_pk_bf16_f32 v20, v20, v21
v_mov_b32 v21, 0
v_mov_b32 v22, 0
v_cvt_pk_bf16_f32 v16, v16, v17
v_cvt_pk_bf16_f32 v17, v18, v19
v_mfma_f32_16x16x16_bf16 v[24:27], v[56:57], v[20:21], 0
v_exp_f32 v12, v12
v_mfma_f32_16x16x16_bf16 v[28:31], v[56:57], v[22:23], 0
v_exp_f32 v13, v13
v_mfma_f32_16x16x16_bf16 v[32:35], v[60:61], v[20:21], 0
v_exp_f32 v14, v14
v_exp_f32 v15, v15
v_mov_b64 v[62:63], s[14:15]
v_cvt_pk_bf16_f32 v18, v12, v13
v_cvt_pk_bf16_f32 v19, v14, v15
s_waitcnt vmcnt(2)
ds_read_b128 v[40:43], v2 offset:18432
v_mfma_f32_16x16x32_bf16 v[32:35], v[60:63], v[16:19], v[32:35]
ds_read_b128 v[44:47], v2 offset:19456
v_mov_b32 v20, 0
v_mfma_f32_16x16x32_bf16 v[24:27], v[64:67], v[16:19], v[24:27]
ds_read_b128 v[48:51], v2 offset:20480
v_mov_b32 v23, 0
v_mfma_f32_16x16x32_bf16 v[28:31], v[68:71], v[16:19], v[28:31]
ds_read_b128 v[52:55], v2 offset:21504
v_mov_b32 v15, 0
v_rcp_f32 v12, v32
v_subrev_u32 v14, 0x21800000, v32
v_cmp_le_u32 vcc, 0x3c000000, v14
v_pk_mul_f32 v[24:25], v[24:25], v[12:13] op_sel_hi:[1,0]
v_pk_mul_f32 v[26:27], v[26:27], v[12:13] op_sel_hi:[1,0]
ds_read_b128 v[32:35], v2 offset:22528
v_pk_mul_f32 v[28:29], v[28:29], v[12:13] op_sel_hi:[1,0]
v_pk_mul_f32 v[30:31], v[30:31], v[12:13] op_sel_hi:[1,0]
v_cvt_pk_bf16_f32 v24, v24, v28
v_cvt_pk_bf16_f32 v25, v25, v29
v_cvt_pk_bf16_f32 v26, v26, v30
v_cvt_pk_bf16_f32 v27, v27, v31
v_mfma_f32_16x16x32_bf16 v[16:19], v[20:23], v[20:23], 0
ds_write_b128 v7, v[24:27]
v_mfma_f32_16x16x32_bf16 v[12:15], v[20:23], v[20:23], 0
s_andn2_b64 vcc, vcc, s[86:87]
ds_read_b128 v[36:39], v2 offset:23552
s_cbranch_scc1 L_sm0
L_smr0:
v_mfma_f32_16x16x32_bf16 v[56:59], v[20:23], v[20:23], 0
v_mov_b32 v1, 6528
v_and_b32 v8, 0x380, v3
s_add_u32 s20, s30, 524288
v_add_u32 v8, v8, v3
s_mov_b32 m0, 15872
s_cmp_eq_u32 s19, 63
s_cbranch_scc1 L_texit
s_waitcnt lgkmcnt(0)
s_barrier
ds_read_b128 v[24:27], v3 offset:4224
v_mfma_f32_16x16x32_bf16 v[64:67], v[20:23], v[20:23], 0
ds_read_b128 v[28:31], v3 offset:5248
v_mfma_f32_16x16x32_bf16 v[60:63], v[20:23], v[20:23], 0
v_mfma_f32_16x16x32_bf16 v[68:71], v[20:23], v[20:23], 0
s_waitcnt lgkmcnt(1)
v_smfmac_f32_16x16x64_bf16 v[12:15], v[24:27], a[248:255], v0
buffer_load_dwordx4 v8, s[8:11], s20 offen sc1 lds
v_smfmac_f32_16x16x64_bf16 v[16:19], v[24:27], a[176:183], v0
s_mov_b32 m0, 16768
s_waitcnt lgkmcnt(0)
v_smfmac_f32_16x16x64_bf16 v[12:15], v[28:31], v[40:47], v0
ds_read_b128 v[40:43], v2 offset:24576
v_smfmac_f32_16x16x64_bf16 v[16:19], v[28:31], v[48:55], v0
ds_read_b128 v[44:47], v2 offset:25600
buffer_load_dwordx4 v8, s[8:11], s20 offen offset:128 sc1 lds
v_smfmac_f32_16x16x64_bf16 v[20:23], v[24:27], a[184:191], v0
ds_read_b128 v[48:51], v2 offset:26624
s_nop 1
v_add_f32 v12, v12, v13
v_add_f32 v14, v14, v15
v_cvt_pk_bf16_f32 v12, v12, v14
v_smfmac_f32_16x16x64_bf16 v[20:23], v[28:31], v[32:39], v0
ds_read_b128 v[52:55], v2 offset:27648
buffer_store_dword v12, v10, s[8:11], s28 offen
v_add_f32 v16, v16, v17
v_add_f32 v18, v18, v19
v_smfmac_f32_16x16x64_bf16 v[56:59], v[24:27], a[192:199], v0
s_waitcnt lgkmcnt(2)
ds_read_b128 v[32:35], v2 offset:28672
v_cvt_pk_bf16_f32 v16, v16, v18
v_smfmac_f32_16x16x64_bf16 v[56:59], v[28:31], v[40:47], v0
ds_read_b128 v[36:39], v2 offset:29696
v_add_f32 v20, v20, v21
v_add_f32 v22, v22, v23
v_cvt_pk_bf16_f32 v17, v20, v22
v_smfmac_f32_16x16x64_bf16 v[60:63], v[24:27], a[200:207], v0
s_waitcnt lgkmcnt(2)
ds_read_b128 v[12:15], v1
buffer_store_dwordx2 v[16:17], v9, s[8:11], s28 offen
v_smfmac_f32_16x16x64_bf16 v[60:63], v[28:31], v[48:55], v0
ds_read_b128 v[40:43], v2 offset:30720
v_add_f32 v56, v56, v57
v_add_f32 v58, v58, v59
v_cvt_pk_bf16_f32 v56, v56, v58
v_smfmac_f32_16x16x64_bf16 v[64:67], v[24:27], a[208:215], v0
s_waitcnt lgkmcnt(2)
ds_read_b128 v[44:47], v2 offset:31744
v_smfmac_f32_16x16x64_bf16 v[64:67], v[28:31], v[32:39], v0
ds_read_b128 v[20:23], v1
v_add_f32 v60, v60, v61
v_add_f32 v62, v62, v63
v_cvt_pk_bf16_f32 v57, v60, v62
v_smfmac_f32_16x16x64_bf16 v[68:71], v[24:27], a[216:223], v0
s_waitcnt lgkmcnt(1)
ds_read_b128 v[48:51], v2 offset:32768
buffer_store_dwordx2 v[56:57], v9, s[8:11], s50 offen
v_smfmac_f32_16x16x64_bf16 v[68:71], v[28:31], v[40:47], v0
ds_read_b128 v[52:55], v2 offset:33792
v_add_f32 v64, v64, v65
v_add_f32 v66, v66, v67
v_cvt_pk_bf16_f32 v64, v64, v66
v_smfmac_f32_16x16x64_bf16 v[12:15], v[24:27], a[224:231], v0
s_waitcnt lgkmcnt(0)
v_smfmac_f32_16x16x64_bf16 v[12:15], v[28:31], v[48:55], v0
s_nop 0
v_add_f32 v68, v68, v69
v_add_f32 v70, v70, v71
v_cvt_pk_bf16_f32 v65, v68, v70
v_smfmac_f32_16x16x64_bf16 v[20:23], v[24:27], a[232:239], v0
buffer_store_dwordx2 v[64:65], v9, s[8:11], s51 offen
v_smfmac_f32_16x16x64_bf16 v[20:23], v[28:31], a[240:247], v0
s_nop 0
v_add_f32 v12, v12, v13
v_add_f32 v14, v14, v15
v_cvt_pk_bf16_f32 v12, v12, v14
s_nop 3
v_add_f32 v20, v20, v21
v_add_f32 v22, v22, v23
v_cvt_pk_bf16_f32 v13, v20, v22
buffer_store_dwordx2 v[12:13], v9, s[8:11], s52 offen
L_lt0:
s_nop 15
s_nop 15
s_nop 0
buffer_load_dwordx4 v[32:35], v3, s[8:11], s49 offen sc1
buffer_load_dwordx4 v[36:39], v3, s[8:11], s49 offen offset:1024 sc1
buffer_load_dwordx4 v[40:43], v3, s[8:11], s49 offen offset:2048 sc1
buffer_load_dwordx4 v[44:47], v3, s[8:11], s49 offen offset:3072 sc1
s_add_u32 s19, s19, 1
s_mov_b32 s20, s28
s_mov_b32 s28, s29
s_mov_b32 s29, s20
s_and_b32 s20, s19, 3
s_lshl_b32 s20, s20, 14
s_add_u32 s33, s20, 110100480
s_add_u32 s34, s20, s24
s_xor_b32 s20, s20, 32768
s_add_u32 s35, s20, s24
s_add_u32 s30, s30, 524288
s_add_u32 s31, s31, 131072
s_add_u32 s6, s33, 4096
s_add_u32 s7, s33, 8192
s_mov_b32 s22, 0
buffer_load_dwordx4 v[32:35], v3, s[8:11], s49 offen sc1
buffer_load_dwordx4 v[36:39], v3, s[8:11], s49 offen offset:1024 sc1
buffer_load_dwordx4 v[40:43], v3, s[8:11], s49 offen offset:2048 sc1
buffer_load_dwordx4 v[44:47], v3, s[8:11], s49 offen offset:3072 sc1
v_mov_b64 v[24:25], 0
v_mov_b64 v[26:27], 0
v_mov_b64 v[28:29], 0
v_mov_b64 v[30:31], 0
v_and_b32 v70, 0xf40, v3
v_add_u32 v70, v70, v3
v_bfe_u32 v71, v3, 7, 1
v_mad_i32_i24 v70, v71, s4, v70
v_mov_b64 v[64:65], -1
v_mov_b64 v[66:67], -1
v_add_u32 v1, 2112, v4
ds_read_b128 v[48:51], v2 offset:8192
ds_read_b128 v[52:55], v2 offset:9216
v_lshrrev_b32 v8, 2, v3
v_mov_b32 v56, 0x3f80
v_cndmask_b32 v56, v56, 1.0, s[44:45]
v_cndmask_b32 v60, 0, v56, s[36:37]
v_cndmask_b32 v61, 0, v56, s[38:39]
v_cndmask_b32 v62, 0, v56, s[40:41]
v_cndmask_b32 v63, 0, v56, s[42:43]
s_waitcnt vmcnt(7)
v_max3_u32 v16, v32, v33, v34
v_max_u32 v16, v16, v35
v_mfma_f32_16x16x32_bf16 v[56:59], v[32:35], v[60:63], 0
s_waitcnt vmcnt(6)
v_max3_u32 v16, v16, v36, v37
v_max3_u32 v16, v16, v38, v39
v_mfma_f32_16x16x32_bf16 v[56:59], v[36:39], v[60:63], v[56:59]
s_waitcnt vmcnt(5)
v_max3_u32 v16, v16, v40, v41
v_max3_u32 v16, v16, v42, v43
v_mfma_f32_16x16x32_bf16 v[56:59], v[40:43], v[60:63], v[56:59]
s_waitcnt vmcnt(4)
v_max3_u32 v16, v16, v44, v45
v_max3_u32 v16, v16, v46, v47
v_mfma_f32_16x16x32_bf16 v[56:59], v[44:47], v[60:63], v[56:59]
v_cmp_le_u32 vcc, 0xffff0000, v16
s_cbranch_vccnz L_red0
L_redb0:
s_nop 5
v_permlane32_swap_b32 v56, v58
v_permlane32_swap_b32 v57, v59
v_pk_add_f32 v[56:57], v[56:57], v[58:59]
v_cvt_pk_bf16_f32 v56, v56, v57
buffer_store_dword v56, v11, s[8:11], s34 offen
s_add_u32 s20, s30, 0
s_add_u32 s21, s30, 8192
s_add_u32 s49, s29, s25
s_add_u32 s50, s29, s26
s_add_u32 s51, s29, s27
s_add_u32 s52, s30, 524288
s_mov_b32 m0, 15872
s_nop 9
s_barrier
s_branch L_gat0
L_red0:
s_waitcnt vmcnt(3)
v_mfma_f32_16x16x32_bf16 v[56:59], v[32:35], v[60:63], 0
v_max3_u32 v16, v32, v33, v34
v_max_u32 v16, v16, v35
s_waitcnt vmcnt(2)
v_mfma_f32_16x16x32_bf16 v[56:59], v[36:39], v[60:63], v[56:59]
v_max3_u32 v16, v16, v36, v37
v_max3_u32 v16, v16, v38, v39
s_waitcnt vmcnt(1)
v_mfma_f32_16x16x32_bf16 v[56:59], v[40:43], v[60:63], v[56:59]
v_max3_u32 v16, v16, v40, v41
v_max3_u32 v16, v16, v42, v43
s_waitcnt vmcnt(0)
v_mfma_f32_16x16x32_bf16 v[56:59], v[44:47], v[60:63], v[56:59]
v_max3_u32 v16, v16, v44, v45
v_max3_u32 v16, v16, v46, v47
v_cmp_le_u32 vcc, 0xffff0000, v16
s_cbranch_vccz L_redb0
L_red0b:
buffer_load_dwordx4 v[32:35], v3, s[8:11], s49 offen sc1
buffer_load_dwordx4 v[36:39], v3, s[8:11], s49 offen offset:1024 sc1
buffer_load_dwordx4 v[40:43], v3, s[8:11], s49 offen offset:2048 sc1
buffer_load_dwordx4 v[44:47], v3, s[8:11], s49 offen offset:3072 sc1
s_add_u32 s22, s22, 1
s_cmp_gt_u32 s22, 200000
s_cbranch_scc1 L_end
s_waitcnt vmcnt(3)
v_mfma_f32_16x16x32_bf16 v[56:59], v[32:35], v[60:63], 0
v_max3_u32 v16, v32, v33, v34
v_max_u32 v16, v16, v35
s_waitcnt vmcnt(2)
v_mfma_f32_16x16x32_bf16 v[56:59], v[36:39], v[60:63], v[56:59]
v_max3_u32 v16, v16, v36, v37
v_max3_u32 v16, v16, v38, v39
s_waitcnt vmcnt(1)
v_mfma_f32_16x16x32_bf16 v[56:59], v[40:43], v[60:63], v[56:59]
v_max3_u32 v16, v16, v40, v41
v_max3_u32 v16, v16, v42, v43
s_waitcnt vmcnt(0)
v_mfma_f32_16x16x32_bf16 v[56:59], v[44:47], v[60:63], v[56:59]
v_max3_u32 v16, v16, v44, v45
v_max3_u32 v16, v16, v46, v47
v_cmp_le_u32 vcc, 0xffff0000, v16
s_cbranch_vccz L_redb0
s_branch L_red0b
L_g3r0:
buffer_load_dwordx4 v[16:19], v3, s[8:11], s6 offen sc1
s_add_u32 s22, s22, 1
s_waitcnt vmcnt(1)
v_max3_u32 v21, v16, v17, v18
v_max_u32 v21, v21, v19
v_cmp_le_u32 vcc, 0xffff0000, v21
s_cmp_gt_u32 s22, 200000
s_cbranch_vccz L_g30
s_cbranch_scc0 L_g3r0
s_branch L_end
L_sm0:
s_waitcnt lgkmcnt(0)
ds_read_b128 v[24:27], v5
ds_read_b128 v[40:43], v3 offset:15872
ds_read_b128 v[28:31], v5 offset:512
ds_read_b128 v[44:47], v3 offset:17920
ds_read_b128 v[32:35], v5 offset:1024
ds_read_b128 v[48:51], v3 offset:19968
ds_read_b128 v[36:39], v5 offset:1536
ds_read_b128 v[52:55], v3 offset:22016
s_waitcnt lgkmcnt(0)
v_mfma_f32_16x16x32_bf16 v[16:19], v[40:43], v[24:27], 0
ds_read_b128 v[40:43], v3 offset:16896
v_mfma_f32_16x16x32_bf16 v[16:19], v[44:47], v[28:31], v[16:19]
ds_read_b128 v[44:47], v3 offset:18944
v_mfma_f32_16x16x32_bf16 v[16:19], v[48:51], v[32:35], v[16:19]
ds_read_b128 v[48:51], v3 offset:20992
v_mfma_f32_16x16x32_bf16 v[16:19], v[52:55], v[36:39], v[16:19]
ds_read_b128 v[52:55], v3 offset:23040
v_mfma_f32_16x16x32_bf16 v[20:23], v[24:27], v[24:27], 0
v_mfma_f32_16x16x32_bf16 v[20:23], v[28:31], v[28:31], v[20:23]
v_mfma_f32_16x16x32_bf16 v[20:23], v[32:35], v[32:35], v[20:23]
v_mfma_f32_16x16x32_bf16 v[20:23], v[36:39], v[36:39], v[20:23]
s_waitcnt lgkmcnt(0)
v_mfma_f32_16x16x32_bf16 v[12:15], v[40:43], v[24:27], 0
v_mfma_f32_16x16x32_bf16 v[12:15], v[44:47], v[28:31], v[12:15]
v_mfma_f32_16x16x32_bf16 v[12:15], v[48:51], v[32:35], v[12:15]
v_mfma_f32_16x16x32_bf16 v[12:15], v[52:55], v[36:39], v[12:15]
v_max3_f32 v59, v16, v17, v18
s_nop 1
v_max3_f32 v59, v59, v19, v20
s_nop 3
v_max3_f32 v59, v59, v21, v12
v_max3_f32 v59, v59, v13, v14
v_max_f32 v59, v59, v15
v_mov_b32 v22, v59
s_nop 1
v_permlane32_swap_b32 v22, v59
v_max_f32 v59, v59, v22
v_mov_b32 v22, v59
s_nop 1
v_permlane16_swap_b32 v22, v59
v_max_f32 v59, v59, v22
v_sub_f32 v20, v20, v59
v_sub_f32 v21, v21, v59
v_sub_f32 v16, v16, v59
v_sub_f32 v17, v17, v59
v_sub_f32 v18, v18, v59
v_sub_f32 v19, v19, v59
v_sub_f32 v12, v12, v59
v_sub_f32 v13, v13, v59
v_sub_f32 v14, v14, v59
v_sub_f32 v15, v15, v59
v_exp_f32 v20, v20
v_exp_f32 v21, v21
v_exp_f32 v16, v16
v_exp_f32 v17, v17
v_exp_f32 v18, v18
v_exp_f32 v19, v19
v_exp_f32 v12, v12
v_exp_f32 v13, v13
v_exp_f32 v14, v14
v_exp_f32 v15, v15
v_cvt_pk_bf16_f32 v23, v20, v21
v_cvt_pk_bf16_f32 v20, v20, v21
v_mov_b32 v21, 0
v_mov_b32 v22, 0
v_cvt_pk_bf16_f32 v16, v16, v17
v_cvt_pk_bf16_f32 v17, v18, v19
v_cvt_pk_bf16_f32 v18, v12, v13
v_cvt_pk_bf16_f32 v19, v14, v15
v_mfma_f32_16x16x16_bf16 v[24:27], v[56:57], v[20:21], 0
v_mfma_f32_16x16x16_bf16 v[28:31], v[56:57], v[22:23], 0
v_mfma_f32_16x16x16_bf16 v[32:35], v[60:61], v[20:21], 0
ds_read_b128 v[40:43], v2 offset:18432
v_mfma_f32_16x16x32_bf16 v[32:35], v[60:63], v[16:19], v[32:35]
ds_read_b128 v[44:47], v2 offset:19456
v_mov_b32 v20, 0
v_mfma_f32_16x16x32_bf16 v[24:27], v[64:67], v[16:19], v[24:27]
ds_read_b128 v[48:51], v2 offset:20480
v_mov_b32 v23, 0
v_mfma_f32_16x16x32_bf16 v[28:31], v[68:71], v[16:19], v[28:31]
ds_read_b128 v[52:55], v2 offset:21504
v_mov_b32 v15, 0
v_rcp_f32 v12, v32
v_subrev_u32 v14, 0x21800000, v32
v_cmp_le_u32 vcc, 0x3c000000, v14
v_pk_mul_f32 v[24:25], v[24:25], v[12:13] op_sel_hi:[1,0]
v_pk_mul_f32 v[26:27], v[26:27], v[12:13] op_sel_hi:[1,0]
ds_read_b128 v[32:35], v2 offset:22528
v_pk_mul_f32 v[28:29], v[28:29], v[12:13] op_sel_hi:[1,0]
v_pk_mul_f32 v[30:31], v[30:31], v[12:13] op_sel_hi:[1,0]
v_cvt_pk_bf16_f32 v24, v24, v28
v_cvt_pk_bf16_f32 v25, v25, v29
v_cvt_pk_bf16_f32 v26, v26, v30
v_cvt_pk_bf16_f32 v27, v27, v31
v_mfma_f32_16x16x32_bf16 v[16:19], v[20:23], v[20:23], 0
ds_write_b128 v7, v[24:27]
v_mfma_f32_16x16x32_bf16 v[12:15], v[20:23], v[20:23], 0
ds_read_b128 v[36:39], v2 offset:23552
s_branch L_smr0
L_ent1:
s_movk_i32 s4, -64
s_mov_b32 s14, s53
s_mov_b32 s15, s53
v_mov_b64 v[24:25], 0
v_mov_b64 v[26:27], 0
v_mov_b64 v[28:29], 0
v_mov_b64 v[30:31], 0
v_and_b32 v69, 0x380, v3
v_add_u32 v69, v69, v3
v_and_b32 v70, 0xf40, v3
v_add_u32 v70, v70, v3
v_bfe_u32 v71, v3, 7, 1
v_mad_i32_i24 v70, v71, s4, v70
v_mov_b64 v[64:65], -1
v_mov_b64 v[66:67], -1
v_add_u32 v1, 2112, v4
ds_read_b128 v[48:51], v2 offset:10240
ds_read_b128 v[52:55], v2 offset:11264
ds_read_b128 v[40:43], v2 offset:2048
ds_read_b128 v[44:47], v2 offset:3072
v_mov_b64 v[32:33], 0
v_mov_b64 v[34:35], 0
v_mov_b64 v[36:37], 0
v_mov_b64 v[38:39], 0
v_mov_b64 v[56:57], 0
v_mov_b64 v[58:59], 0
v_mov_b64 v[60:61], 0
v_mov_b64 v[62:63], 0
s_add_u32 s20, s30, 1024
s_add_u32 s21, s30, 8192
s_add_u32 s49, s29, s25
s_add_u32 s50, s29, s26
s_add_u32 s51, s29, s27
s_add_u32 s52, s30, 524288
s_mov_b32 m0, 17920
s_nop 0
buffer_load_dwordx4 v69, s[8:11], s20 offen sc1 lds
s_mov_b32 m0, 18816
s_nop 0
buffer_load_dwordx4 v69, s[8:11], s20 offen offset:128 sc1 lds
s_waitcnt vmcnt(0) lgkmcnt(0)
s_branch L_step1
L_gr1:
buffer_load_dwordx4 v[12:15], v3, s[8:11], s33 offen sc1
buffer_load_dword v20, v8, s[8:11], s7 offen sc1
buffer_load_dwordx4 v[16:19], v3, s[8:11], s6 offen sc1
s_add_u32 s22, s22, 1
s_cmp_gt_u32 s22, 200000
s_cbranch_scc1 L_end
buffer_load_dwordx4 v[16:19], v3, s[8:11], s6 offen sc1
v_mov_b64 v[24:25], 0
v_mov_b64 v[26:27], 0
v_mov_b64 v[28:29], 0
v_mov_b64 v[30:31], 0
v_mov_b64 v[32:33], 0
v_mov_b64 v[34:35], 0
v_mov_b64 v[36:37], 0
v_mov_b64 v[38:39], 0
v_mov_b64 v[56:57], 0
v_mov_b64 v[58:59], 0
v_mov_b64 v[60:61], 0
v_mov_b64 v[62:63], 0
s_waitcnt lgkmcnt(0)
s_branch L_step1
.p2align 3
L_gat1:
buffer_load_dwordx4 v[12:15], v3, s[8:11], s33 offen sc1
buffer_load_dword v20, v8, s[8:11], s7 offen sc1
s_add_u32 s20, s30, 1024
s_add_u32 s21, s30, 8192
s_add_u32 s49, s29, s25
s_add_u32 s50, s29, s26
s_add_u32 s51, s29, s27
s_add_u32 s52, s30, 524288
buffer_load_dwordx4 v[16:19], v3, s[8:11], s6 offen sc1
s_mov_b32 m0, 17920
s_waitcnt vmcnt(4)
ds_read_b128 v[40:43], v2 offset:2048
ds_read_b128 v[44:47], v2 offset:3072
v_mov_b64 v[32:33], 0
v_mov_b64 v[34:35], 0
v_mov_b64 v[36:37], 0
v_mov_b64 v[38:39], 0
v_mov_b64 v[56:57], 0
v_mov_b64 v[58:59], 0
v_mov_b64 v[60:61], 0
v_mov_b64 v[62:63], 0
s_nop 3
buffer_load_dwordx4 v[16:19], v3, s[8:11], s6 offen sc1
s_waitcnt lgkmcnt(0)
L_step1:
s_waitcnt vmcnt(3)
v_smfmac_f32_16x16x64_bf16 v[24:27], v[12:15], v[96:103], v0
ds_write_b128 v3, v[12:15] offset:6656
v_smfmac_f32_16x16x64_bf16 v[28:31], v[12:15], v[104:111], v0
s_waitcnt vmcnt(2)
v_max3_u32 v21, v12, v13, v14
v_max3_u32 v21, v21, v15, v20
v_cmp_le_u32 vcc, 0xffff0000, v21
v_smfmac_f32_16x16x64_bf16 v[32:35], v[12:15], v[112:119], v0
s_cbranch_vccnz L_gr1
s_waitcnt vmcnt(1)
v_max3_u32 v21, v16, v17, v18
v_max_u32 v21, v21, v19
v_cmp_le_u32 vcc, 0xffff0000, v21
ds_write_b32 v8, v20 offset:14848
v_smfmac_f32_16x16x64_bf16 v[56:59], v[12:15], a[48:55], v0
s_cbranch_vccnz L_g3r1
L_g31:
ds_write_b128 v3, v[16:19] offset:10752
v_smfmac_f32_16x16x64_bf16 v[60:63], v[12:15], a[56:63], v0
v_smfmac_f32_16x16x64_bf16 v[36:39], v[12:15], v[40:47], v0
v_smfmac_f32_16x16x64_bf16 v[24:27], v[16:19], v[192:199], v0
v_smfmac_f32_16x16x64_bf16 v[28:31], v[16:19], v[200:207], v0
s_waitcnt lgkmcnt(0)
s_barrier
ds_read_b128 v[20:23], v3 offset:5632
v_smfmac_f32_16x16x64_bf16 v[32:35], v[16:19], v[208:215], v0
ds_read_b128 v[12:15], v3 offset:7680
s_mov_b32 m0, 6272
buffer_store_dword v0, v11, s[8:11], s35 offen
v_smfmac_f32_16x16x64_bf16 v[56:59], v[16:19], a[112:119], v0
ds_read_b128 v[40:43], v2
v_smfmac_f32_16x16x64_bf16 v[60:63], v[16:19], a[120:127], v0
ds_read_b128 v[44:47], v2 offset:1024
buffer_store_dwordx4 v[64:67], v3, s[8:11], s49 offen
v_smfmac_f32_16x16x64_bf16 v[36:39], v[16:19], v[48:55], v0
s_waitcnt vmcnt(2)
ds_read_b128 v[16:19], v3 offset:8704
s_waitcnt lgkmcnt(4)
v_smfmac_f32_16x16x64_bf16 v[24:27], v[20:23], v[72:79], v0
ds_read_b128 v[48:51], v2 offset:4096
buffer_store_dwordx4 v[64:67], v3, s[8:11], s50 offen
v_smfmac_f32_16x16x64_bf16 v[28:31], v[20:23], v[80:87], v0
ds_read_b128 v[52:55], v2 offset:5120
v_smfmac_f32_16x16x64_bf16 v[32:35], v[20:23], v[88:95], v0
s_waitcnt lgkmcnt(3)
buffer_store_dwordx4 v[64:67], v3, s[8:11], s51 offen
v_smfmac_f32_16x16x64_bf16 v[36:39], v[20:23], v[40:47], v0
ds_read_b128 v[20:23], v3 offset:9728
buffer_load_dwordx4 v[64:67], v70, s[8:11], s21 offen sc1
v_smfmac_f32_16x16x64_bf16 v[24:27], v[12:15], v[120:127], v0
ds_read_b128 v[40:43], v2 offset:6144
v_smfmac_f32_16x16x64_bf16 v[28:31], v[12:15], v[128:135], v0
ds_read_b128 v[44:47], v2 offset:7168
buffer_load_dwordx4 v[68:71], v70, s[8:11], s21 offen offset:256 sc1
v_smfmac_f32_16x16x64_bf16 v[32:35], v[12:15], v[136:143], v0
s_waitcnt lgkmcnt(3)
v_smfmac_f32_16x16x64_bf16 v[36:39], v[12:15], v[48:55], v0
ds_read_b128 v[12:15], v3 offset:11776
v_smfmac_f32_16x16x64_bf16 v[24:27], v[16:19], v[144:151], v0
ds_read_b128 v[48:51], v2 offset:8192
v_smfmac_f32_16x16x64_bf16 v[28:31], v[16:19], v[152:159], v0
ds_read_b128 v[52:55], v2 offset:9216
v_smfmac_f32_16x16x64_bf16 v[32:35], v[16:19], v[160:167], v0
s_waitcnt lgkmcnt(3)
buffer_load_dword v6, s[8:11], s52 offen sc1 lds
v_smfmac_f32_16x16x64_bf16 v[36:39], v[16:19], v[40:47], v0
ds_read_b128 v[16:19], v3 offset:12800
v_smfmac_f32_16x16x64_bf16 v[24:27], v[20:23], v[168:175], v0
ds_read_b128 v[40:43], v2 offset:12288
v_smfmac_f32_16x16x64_bf16 v[28:31], v[20:23], v[176:183], v0
ds_read_b128 v[44:47], v2 offset:13312
v_smfmac_f32_16x16x64_bf16 v[32:35], v[20:23], v[184:191], v0
s_waitcnt lgkmcnt(3)
v_smfmac_f32_16x16x64_bf16 v[36:39], v[20:23], v[48:55], v0
ds_read_b128 v[20:23], v3 offset:13824
v_smfmac_f32_16x16x64_bf16 v[24:27], v[12:15], v[216:223], v0
ds_read_b128 v[48:51], v2 offset:14336
v_smfmac_f32_16x16x64_bf16 v[28:31], v[12:15], v[224:231], v0
ds_read_b128 v[52:55], v2 offset:15360
v_smfmac_f32_16x16x64_bf16 v[32:35], v[12:15], v[232:239], v0
s_waitcnt lgkmcnt(3)
v_smfmac_f32_16x16x64_bf16 v[36:39], v[12:15], v[40:47], v0
ds_read_b128 v[12:15], v3 offset:5632
v_smfmac_f32_16x16x64_bf16 v[24:27], v[16:19], v[240:247], v0
ds_read_b128 v[40:43], v2 offset:16384
v_smfmac_f32_16x16x64_bf16 v[28:31], v[16:19], v[248:255], v0
ds_read_b128 v[44:47], v2 offset:17408
v_smfmac_f32_16x16x64_bf16 v[32:35], v[16:19], a[0:7], v0
s_waitcnt lgkmcnt(3)
v_smfmac_f32_16x16x64_bf16 v[36:39], v[16:19], v[48:55], v0
ds_read_b128 v[16:19], v3 offset:7680
v_smfmac_f32_16x16x64_bf16 v[24:27], v[20:23], a[8:15], v0
ds_read_b128 v[48:51], v3 offset:18944
v_smfmac_f32_16x16x64_bf16 v[28:31], v[20:23], a[16:23], v0
ds_read_b128 v[52:55], v3 offset:20992
v_smfmac_f32_16x16x64_bf16 v[32:35], v[20:23], a[24:31], v0
s_waitcnt lgkmcnt(3)
v_smfmac_f32_16x16x64_bf16 v[36:39], v[20:23], v[40:47], v0
ds_read_b128 v[20:23], v3 offset:8704
s_nop 0
v_add_f32 v24, v24, v25
v_smfmac_f32_16x16x64_bf16 v[56:59], v[12:15], a[32:39], v0
ds_read_b128 v[44:47], v3 offset:16896
v_add_f32 v26, v26, v27
v_add_f32 v28, v28, v29
v_add_f32 v30, v30, v31
v_mul_f32 v24, s18, v24
v_smfmac_f32_16x16x64_bf16 v[60:63], v[12:15], a[40:47], v0
ds_read_b128 v[12:15], v3 offset:9728
v_mul_f32 v28, s18, v28
v_mul_f32 v26, s18, v26
v_mul_f32 v30, s18, v30
v_cvt_pk_bf16_f32 v24, v24, v28
s_waitcnt lgkmcnt(5)
v_smfmac_f32_16x16x64_bf16 v[56:59], v[16:19], a[64:71], v0
ds_read_b128 v[40:43], v3 offset:14848
v_cvt_pk_bf16_f32 v26, v26, v30
ds_write2_b32 v1, v24, v26 offset1:32
v_add_f32 v32, v32, v33
v_add_f32 v34, v34, v35
v_smfmac_f32_16x16x64_bf16 v[60:63], v[16:19], a[72:79], v0
ds_read_b128 v[16:19], v3 offset:11776
v_add_f32 v36, v36, v37
v_add_f32 v38, v38, v39
v_cvt_pk_bf16_f32 v1, v32, v36
v_cvt_pk_bf16_f32 v8, v34, v38
s_waitcnt lgkmcnt(5)
v_smfmac_f32_16x16x64_bf16 v[56:59], v[20:23], a[80:87], v0
ds_write2_b32 v4, v1, v8 offset1:32
v_smfmac_f32_16x16x64_bf16 v[60:63], v[20:23], a[88:95], v0
s_waitcnt lgkmcnt(4)
ds_read_b128 v[20:23], v3 offset:12800
v_smfmac_f32_16x16x64_bf16 v[56:59], v[12:15], a[96:103], v0
v_smfmac_f32_16x16x64_bf16 v[60:63], v[12:15], a[104:111], v0
s_waitcnt lgkmcnt(2)
ds_read_b128 v[12:15], v3 offset:13824
v_smfmac_f32_16x16x64_bf16 v[56:59], v[16:19], a[128:135], v0
v_smfmac_f32_16x16x64_bf16 v[60:63], v[16:19], a[136:143], v0
s_waitcnt lgkmcnt(2)
s_barrier
ds_read_b128 v[28:31], v5 offset:512
s_waitcnt lgkmcnt(2)
v_smfmac_f32_16x16x64_bf16 v[56:59], v[20:23], a[144:151], v0
ds_read_b128 v[32:35], v5 offset:1024
v_smfmac_f32_16x16x64_bf16 v[60:63], v[20:23], a[152:159], v0
s_waitcnt lgkmcnt(2)
ds_read_b128 v[36:39], v5 offset:1536
v_smfmac_f32_16x16x64_bf16 v[56:59], v[12:15], a[160:167], v0
ds_read_b128 v[24:27], v5
v_smfmac_f32_16x16x64_bf16 v[60:63], v[12:15], a[168:175], v0
s_waitcnt lgkmcnt(3)
v_mfma_f32_16x16x32_bf16 v[16:19], v[44:47], v[28:31], 0
s_waitcnt lgkmcnt(2)
ds_read_b128 v[44:47], v3 offset:17920
v_mfma_f32_16x16x32_bf16 v[16:19], v[48:51], v[32:35], v[16:19]
s_waitcnt lgkmcnt(2)
ds_read_b128 v[48:51], v3 offset:19968
v_mfma_f32_16x16x32_bf16 v[16:19], v[52:55], v[36:39], v[16:19]
s_waitcnt lgkmcnt(2)
ds_read_b128 v[52:55], v3 offset:22016
v_add_f32 v56, v56, v57
v_mfma_f32_16x16x32_bf16 v[16:19], v[40:43], v[24:27], v[16:19]
ds_read_b128 v[40:43], v3 offset:15872
v_add_f32 v58, v58, v59
v_mfma_f32_16x16x32_bf16 v[20:23], v[28:31], v[28:31], 0
s_add_u32 s49, s28, s23
v_add_f32 v60, v60, v61
v_add_f32 v62, v62, v63
v_mfma_f32_16x16x32_bf16 v[20:23], v[32:35], v[32:35], v[20:23]
s_add_u32 s50, s28, 65536
v_cvt_pk_bf16_f32 v56, v56, v58
v_cvt_pk_bf16_f32 v57, v60, v62
v_mfma_f32_16x16x32_bf16 v[20:23], v[36:39], v[36:39], v[20:23]
s_add_u32 s51, s28, 131072
v_mov_b32 v58, v1
v_mov_b32 v59, v8
v_exp_f32 v16, v16
v_mfma_f32_16x16x32_bf16 v[20:23], v[24:27], v[24:27], v[20:23]
s_waitcnt lgkmcnt(3)
v_exp_f32 v17, v17
buffer_store_dwordx4 v[56:59], v3, s[8:11], s31 offen sc1
v_mfma_f32_16x16x32_bf16 v[12:15], v[44:47], v[28:31], 0
s_waitcnt lgkmcnt(2)
v_exp_f32 v18, v18
v_mfma_f32_16x16x32_bf16 v[12:15], v[48:51], v[32:35], v[12:15]
s_waitcnt lgkmcnt(1)
v_exp_f32 v19, v19
v_mfma_f32_16x16x32_bf16 v[12:15], v[52:55], v[36:39], v[12:15]
s_waitcnt lgkmcnt(0)
v_exp_f32 v20, v20
v_mfma_f32_16x16x32_bf16 v[12:15], v[40:43], v[24:27], v[12:15]
s_add_u32 s52, s28, 196608
v_exp_f32 v21, v21
v_mov_b64 v[60:61], s[14:15]
v_cvt_pk_bf16_f32 v23, v20, v21
v_cvt_pk_bf16_f32 v20, v20, v21
v_mov_b32 v21, 0
v_mov_b32 v22, 0
v_cvt_pk_bf16_f32 v16, v16, v17
v_cvt_pk_bf16_f32 v17, v18, v19
v_mfma_f32_16x16x16_bf16 v[24:27], v[56:57], v[20:21], 0
v_exp_f32 v12, v12
v_mfma_f32_16x16x16_bf16 v[28:31], v[56:57], v[22:23], 0
v_exp_f32 v13, v13
v_mfma_f32_16x16x16_bf16 v[32:35], v[60:61], v[20:21], 0
v_exp_f32 v14, v14
v_exp_f32 v15, v15
v_mov_b64 v[62:63], s[14:15]
v_cvt_pk_bf16_f32 v18, v12, v13
v_cvt_pk_bf16_f32 v19, v14, v15
s_waitcnt vmcnt(2)
ds_read_b128 v[40:43], v2 offset:18432
v_mfma_f32_16x16x32_bf16 v[32:35], v[60:63], v[16:19], v[32:35]
ds_read_b128 v[44:47], v2 offset:19456
v_mov_b32 v20, 0
v_mfma_f32_16x16x32_bf16 v[24:27], v[64:67], v[16:19], v[24:27]
ds_read_b128 v[48:51], v2 offset:20480
v_mov_b32 v23, 0
v_mfma_f32_16x16x32_bf16 v[28:31], v[68:71], v[16:19], v[28:31]
ds_read_b128 v[52:55], v2 offset:21504
v_mov_b32 v15, 0
v_rcp_f32 v12, v32
v_subrev_u32 v14, 0x21800000, v32
v_cmp_le_u32 vcc, 0x3c000000, v14
v_pk_mul_f32 v[24:25], v[24:25], v[12:13] op_sel_hi:[1,0]
v_pk_mul_f32 v[26:27], v[26:27], v[12:13] op_sel_hi:[1,0]
ds_read_b128 v[32:35], v2 offset:22528
v_pk_mul_f32 v[28:29], v[28:29], v[12:13] op_sel_hi:[1,0]
v_pk_mul_f32 v[30:31], v[30:31], v[12:13] op_sel_hi:[1,0]
v_cvt_pk_bf16_f32 v24, v24, v28
v_cvt_pk_bf16_f32 v25, v25, v29
v_cvt_pk_bf16_f32 v26, v26, v30
v_cvt_pk_bf16_f32 v27, v27, v31
v_mfma_f32_16x16x32_bf16 v[16:19], v[20:23], v[20:23], 0
ds_write_b128 v7, v[24:27]
v_mfma_f32_16x16x32_bf16 v[12:15], v[20:23], v[20:23], 0
s_andn2_b64 vcc, vcc, s[86:87]
ds_read_b128 v[36:39], v2 offset:23552
s_cbranch_scc1 L_sm1
L_smr1:
v_mfma_f32_16x16x32_bf16 v[56:59], v[20:23], v[20:23], 0
v_mov_b32 v1, 6528
v_and_b32 v8, 0x380, v3
s_add_u32 s20, s30, 525312
v_add_u32 v8, v8, v3
s_mov_b32 m0, 17920
s_cmp_eq_u32 s19, 63
s_cbranch_scc1 L_texit
s_waitcnt lgkmcnt(0)
s_barrier
ds_read_b128 v[24:27], v3 offset:3200
v_mfma_f32_16x16x32_bf16 v[64:67], v[20:23], v[20:23], 0
ds_read_b128 v[28:31], v3 offset:4224
v_mfma_f32_16x16x32_bf16 v[60:63], v[20:23], v[20:23], 0
v_mfma_f32_16x16x32_bf16 v[68:71], v[20:23], v[20:23], 0
s_waitcnt lgkmcnt(1)
v_smfmac_f32_16x16x64_bf16 v[12:15], v[24:27], a[248:255], v0
buffer_load_dwordx4 v8, s[8:11], s20 offen sc1 lds
v_smfmac_f32_16x16x64_bf16 v[16:19], v[24:27], a[176:183], v0
s_mov_b32 m0, 18816
s_waitcnt lgkmcnt(0)
v_smfmac_f32_16x16x64_bf16 v[12:15], v[28:31], v[40:47], v0
ds_read_b128 v[40:43], v2 offset:24576
v_smfmac_f32_16x16x64_bf16 v[16:19], v[28:31], v[48:55], v0
ds_read_b128 v[44:47], v2 offset:25600
buffer_load_dwordx4 v8, s[8:11], s20 offen offset:128 sc1 lds
v_smfmac_f32_16x16x64_bf16 v[20:23], v[24:27], a[184:191], v0
ds_read_b128 v[48:51], v2 offset:26624
s_nop 1
v_add_f32 v12, v12, v13
v_add_f32 v14, v14, v15
v_cvt_pk_bf16_f32 v12, v12, v14
v_smfmac_f32_16x16x64_bf16 v[20:23], v[28:31], v[32:39], v0
ds_read_b128 v[52:55], v2 offset:27648
buffer_store_dword v12, v10, s[8:11], s28 offen
v_add_f32 v16, v16, v17
v_add_f32 v18, v18, v19
v_smfmac_f32_16x16x64_bf16 v[56:59], v[24:27], a[192:199], v0
s_waitcnt lgkmcnt(2)
ds_read_b128 v[32:35], v2 offset:28672
v_cvt_pk_bf16_f32 v16, v16, v18
v_smfmac_f32_16x16x64_bf16 v[56:59], v[28:31], v[40:47], v0
ds_read_b128 v[36:39], v2 offset:29696
v_add_f32 v20, v20, v21
v_add_f32 v22, v22, v23
v_cvt_pk_bf16_f32 v17, v20, v22
v_smfmac_f32_16x16x64_bf16 v[60:63], v[24:27], a[200:207], v0
s_waitcnt lgkmcnt(2)
ds_read_b128 v[12:15], v1
buffer_store_dwordx2 v[16:17], v9, s[8:11], s28 offen
v_smfmac_f32_16x16x64_bf16 v[60:63], v[28:31], v[48:55], v0
ds_read_b128 v[40:43], v2 offset:30720
v_add_f32 v56, v56, v57
v_add_f32 v58, v58, v59
v_cvt_pk_bf16_f32 v56, v56, v58
v_smfmac_f32_16x16x64_bf16 v[64:67], v[24:27], a[208:215], v0
s_waitcnt lgkmcnt(2)
ds_read_b128 v[44:47], v2 offset:31744
v_smfmac_f32_16x16x64_bf16 v[64:67], v[28:31], v[32:39], v0
ds_read_b128 v[20:23], v1
v_add_f32 v60, v60, v61
v_add_f32 v62, v62, v63
v_cvt_pk_bf16_f32 v57, v60, v62
v_smfmac_f32_16x16x64_bf16 v[68:71], v[24:27], a[216:223], v0
s_waitcnt lgkmcnt(1)
ds_read_b128 v[48:51], v2 offset:32768
buffer_store_dwordx2 v[56:57], v9, s[8:11], s50 offen
v_smfmac_f32_16x16x64_bf16 v[68:71], v[28:31], v[40:47], v0
ds_read_b128 v[52:55], v2 offset:33792
v_add_f32 v64, v64, v65
v_add_f32 v66, v66, v67
v_cvt_pk_bf16_f32 v64, v64, v66
v_smfmac_f32_16x16x64_bf16 v[12:15], v[24:27], a[224:231], v0
s_waitcnt lgkmcnt(0)
v_smfmac_f32_16x16x64_bf16 v[12:15], v[28:31], v[48:55], v0
s_nop 0
v_add_f32 v68, v68, v69
v_add_f32 v70, v70, v71
v_cvt_pk_bf16_f32 v65, v68, v70
v_smfmac_f32_16x16x64_bf16 v[20:23], v[24:27], a[232:239], v0
buffer_store_dwordx2 v[64:65], v9, s[8:11], s51 offen
v_smfmac_f32_16x16x64_bf16 v[20:23], v[28:31], a[240:247], v0
s_nop 0
v_add_f32 v12, v12, v13
v_add_f32 v14, v14, v15
v_cvt_pk_bf16_f32 v12, v12, v14
s_nop 3
v_add_f32 v20, v20, v21
v_add_f32 v22, v22, v23
v_cvt_pk_bf16_f32 v13, v20, v22
buffer_store_dwordx2 v[12:13], v9, s[8:11], s52 offen
L_lt1:
s_nop 15
s_nop 15
s_nop 15
s_nop 15
s_nop 4
buffer_load_dwordx4 v[32:35], v3, s[8:11], s49 offen sc1
buffer_load_dwordx4 v[36:39], v3, s[8:11], s49 offen offset:1024 sc1
buffer_load_dwordx4 v[40:43], v3, s[8:11], s49 offen offset:2048 sc1
buffer_load_dwordx4 v[44:47], v3, s[8:11], s49 offen offset:3072 sc1
s_add_u32 s19, s19, 1
s_mov_b32 s20, s28
s_mov_b32 s28, s29
s_mov_b32 s29, s20
s_and_b32 s20, s19, 3
s_lshl_b32 s20, s20, 14
s_add_u32 s33, s20, 110100480
s_add_u32 s34, s20, s24
s_xor_b32 s20, s20, 32768
s_add_u32 s35, s20, s24
s_add_u32 s30, s30, 524288
s_add_u32 s31, s31, 131072
s_add_u32 s6, s33, 4096
s_add_u32 s7, s33, 8192
s_mov_b32 s22, 0
v_mov_b64 v[24:25], 0
v_mov_b64 v[26:27], 0
v_mov_b64 v[28:29], 0
v_mov_b64 v[30:31], 0
buffer_load_dwordx4 v[32:35], v3, s[8:11], s49 offen sc1
buffer_load_dwordx4 v[36:39], v3, s[8:11], s49 offen offset:1024 sc1
buffer_load_dwordx4 v[40:43], v3, s[8:11], s49 offen offset:2048 sc1
buffer_load_dwordx4 v[44:47], v3, s[8:11], s49 offen offset:3072 sc1
v_and_b32 v70, 0xf40, v3
v_add_u32 v70, v70, v3
v_bfe_u32 v71, v3, 7, 1
v_mad_i32_i24 v70, v71, s4, v70
v_mov_b64 v[64:65], -1
v_mov_b64 v[66:67], -1
v_add_u32 v1, 2112, v4
ds_read_b128 v[48:51], v2 offset:10240
ds_read_b128 v[52:55], v2 offset:11264
v_lshrrev_b32 v8, 2, v3
v_mov_b32 v56, 0x3f80
v_cndmask_b32 v56, v56, 1.0, s[44:45]
v_cndmask_b32 v60, 0, v56, s[36:37]
v_cndmask_b32 v61, 0, v56, s[38:39]
v_cndmask_b32 v62, 0, v56, s[40:41]
v_cndmask_b32 v63, 0, v56, s[42:43]
s_waitcnt vmcnt(7)
v_max3_u32 v16, v32, v33, v34
v_max_u32 v16, v16, v35
v_mfma_f32_16x16x32_bf16 v[56:59], v[32:35], v[60:63], 0
s_waitcnt vmcnt(6)
v_max3_u32 v16, v16, v36, v37
v_max3_u32 v16, v16, v38, v39
v_mfma_f32_16x16x32_bf16 v[56:59], v[36:39], v[60:63], v[56:59]
s_waitcnt vmcnt(5)
v_max3_u32 v16, v16, v40, v41
v_max3_u32 v16, v16, v42, v43
v_mfma_f32_16x16x32_bf16 v[56:59], v[40:43], v[60:63], v[56:59]
s_waitcnt vmcnt(4)
v_max3_u32 v16, v16, v44, v45
v_max3_u32 v16, v16, v46, v47
v_mfma_f32_16x16x32_bf16 v[56:59], v[44:47], v[60:63], v[56:59]
v_cmp_le_u32 vcc, 0xffff0000, v16
s_cbranch_vccnz L_red1
L_redb1:
s_nop 5
v_permlane32_swap_b32 v56, v58
v_permlane32_swap_b32 v57, v59
v_pk_add_f32 v[56:57], v[56:57], v[58:59]
v_cvt_pk_bf16_f32 v56, v56, v57
buffer_store_dword v56, v11, s[8:11], s34 offen
s_add_u32 s20, s30, 1024
s_add_u32 s21, s30, 8192
s_add_u32 s49, s29, s25
s_add_u32 s50, s29, s26
s_add_u32 s51, s29, s27
s_add_u32 s52, s30, 524288
s_mov_b32 m0, 17920
s_nop 9
s_barrier
s_branch L_gat1
L_red1:
s_waitcnt vmcnt(3)
v_mfma_f32_16x16x32_bf16 v[56:59], v[32:35], v[60:63], 0
v_max3_u32 v16, v32, v33, v34
v_max_u32 v16, v16, v35
s_waitcnt vmcnt(2)
v_mfma_f32_16x16x32_bf16 v[56:59], v[36:39], v[60:63], v[56:59]
v_max3_u32 v16, v16, v36, v37
v_max3_u32 v16, v16, v38, v39
s_waitcnt vmcnt(1)
v_mfma_f32_16x16x32_bf16 v[56:59], v[40:43], v[60:63], v[56:59]
v_max3_u32 v16, v16, v40, v41
v_max3_u32 v16, v16, v42, v43
s_waitcnt vmcnt(0)
v_mfma_f32_16x16x32_bf16 v[56:59], v[44:47], v[60:63], v[56:59]
v_max3_u32 v16, v16, v44, v45
v_max3_u32 v16, v16, v46, v47
v_cmp_le_u32 vcc, 0xffff0000, v16
s_cbranch_vccz L_redb1
L_red1b:
buffer_load_dwordx4 v[32:35], v3, s[8:11], s49 offen sc1
buffer_load_dwordx4 v[36:39], v3, s[8:11], s49 offen offset:1024 sc1
buffer_load_dwordx4 v[40:43], v3, s[8:11], s49 offen offset:2048 sc1
buffer_load_dwordx4 v[44:47], v3, s[8:11], s49 offen offset:3072 sc1
s_add_u32 s22, s22, 1
s_cmp_gt_u32 s22, 200000
s_cbranch_scc1 L_end
s_waitcnt vmcnt(3)
v_mfma_f32_16x16x32_bf16 v[56:59], v[32:35], v[60:63], 0
v_max3_u32 v16, v32, v33, v34
v_max_u32 v16, v16, v35
s_waitcnt vmcnt(2)
v_mfma_f32_16x16x32_bf16 v[56:59], v[36:39], v[60:63], v[56:59]
v_max3_u32 v16, v16, v36, v37
v_max3_u32 v16, v16, v38, v39
s_waitcnt vmcnt(1)
v_mfma_f32_16x16x32_bf16 v[56:59], v[40:43], v[60:63], v[56:59]
v_max3_u32 v16, v16, v40, v41
v_max3_u32 v16, v16, v42, v43
s_waitcnt vmcnt(0)
v_mfma_f32_16x16x32_bf16 v[56:59], v[44:47], v[60:63], v[56:59]
v_max3_u32 v16, v16, v44, v45
v_max3_u32 v16, v16, v46, v47
v_cmp_le_u32 vcc, 0xffff0000, v16
s_cbranch_vccz L_redb1
s_branch L_red1b
L_g3r1:
buffer_load_dwordx4 v[16:19], v3, s[8:11], s6 offen sc1
s_add_u32 s22, s22, 1
s_waitcnt vmcnt(1)
v_max3_u32 v21, v16, v17, v18
v_max_u32 v21, v21, v19
v_cmp_le_u32 vcc, 0xffff0000, v21
s_cmp_gt_u32 s22, 200000
s_cbranch_vccz L_g31
s_cbranch_scc0 L_g3r1
s_branch L_end
L_sm1:
s_waitcnt lgkmcnt(0)
ds_read_b128 v[24:27], v5
ds_read_b128 v[40:43], v3 offset:14848
ds_read_b128 v[28:31], v5 offset:512
ds_read_b128 v[44:47], v3 offset:16896
ds_read_b128 v[32:35], v5 offset:1024
ds_read_b128 v[48:51], v3 offset:18944
ds_read_b128 v[36:39], v5 offset:1536
ds_read_b128 v[52:55], v3 offset:20992
s_waitcnt lgkmcnt(0)
v_mfma_f32_16x16x32_bf16 v[16:19], v[40:43], v[24:27], 0
ds_read_b128 v[40:43], v3 offset:15872
v_mfma_f32_16x16x32_bf16 v[16:19], v[44:47], v[28:31], v[16:19]
ds_read_b128 v[44:47], v3 offset:17920
v_mfma_f32_16x16x32_bf16 v[16:19], v[48:51], v[32:35], v[16:19]
ds_read_b128 v[48:51], v3 offset:19968
v_mfma_f32_16x16x32_bf16 v[16:19], v[52:55], v[36:39], v[16:19]
ds_read_b128 v[52:55], v3 offset:22016
v_mfma_f32_16x16x32_bf16 v[20:23], v[24:27], v[24:27], 0
v_mfma_f32_16x16x32_bf16 v[20:23], v[28:31], v[28:31], v[20:23]
v_mfma_f32_16x16x32_bf16 v[20:23], v[32:35], v[32:35], v[20:23]
v_mfma_f32_16x16x32_bf16 v[20:23], v[36:39], v[36:39], v[20:23]
s_waitcnt lgkmcnt(0)
v_mfma_f32_16x16x32_bf16 v[12:15], v[40:43], v[24:27], 0
v_mfma_f32_16x16x32_bf16 v[12:15], v[44:47], v[28:31], v[12:15]
v_mfma_f32_16x16x32_bf16 v[12:15], v[48:51], v[32:35], v[12:15]
v_mfma_f32_16x16x32_bf16 v[12:15], v[52:55], v[36:39], v[12:15]
v_max3_f32 v59, v16, v17, v18
s_nop 1
v_max3_f32 v59, v59, v19, v20
s_nop 3
v_max3_f32 v59, v59, v21, v12
v_max3_f32 v59, v59, v13, v14
v_max_f32 v59, v59, v15
v_mov_b32 v22, v59
s_nop 1
v_permlane32_swap_b32 v22, v59
v_max_f32 v59, v59, v22
v_mov_b32 v22, v59
s_nop 1
v_permlane16_swap_b32 v22, v59
v_max_f32 v59, v59, v22
v_sub_f32 v20, v20, v59
v_sub_f32 v21, v21, v59
v_sub_f32 v16, v16, v59
v_sub_f32 v17, v17, v59
v_sub_f32 v18, v18, v59
v_sub_f32 v19, v19, v59
v_sub_f32 v12, v12, v59
v_sub_f32 v13, v13, v59
v_sub_f32 v14, v14, v59
v_sub_f32 v15, v15, v59
v_exp_f32 v20, v20
v_exp_f32 v21, v21
v_exp_f32 v16, v16
v_exp_f32 v17, v17
v_exp_f32 v18, v18
v_exp_f32 v19, v19
v_exp_f32 v12, v12
v_exp_f32 v13, v13
v_exp_f32 v14, v14
v_exp_f32 v15, v15
v_cvt_pk_bf16_f32 v23, v20, v21
v_cvt_pk_bf16_f32 v20, v20, v21
v_mov_b32 v21, 0
v_mov_b32 v22, 0
v_cvt_pk_bf16_f32 v16, v16, v17
v_cvt_pk_bf16_f32 v17, v18, v19
v_cvt_pk_bf16_f32 v18, v12, v13
v_cvt_pk_bf16_f32 v19, v14, v15
v_mfma_f32_16x16x16_bf16 v[24:27], v[56:57], v[20:21], 0
v_mfma_f32_16x16x16_bf16 v[28:31], v[56:57], v[22:23], 0
v_mfma_f32_16x16x16_bf16 v[32:35], v[60:61], v[20:21], 0
ds_read_b128 v[40:43], v2 offset:18432
v_mfma_f32_16x16x32_bf16 v[32:35], v[60:63], v[16:19], v[32:35]
ds_read_b128 v[44:47], v2 offset:19456
v_mov_b32 v20, 0
v_mfma_f32_16x16x32_bf16 v[24:27], v[64:67], v[16:19], v[24:27]
ds_read_b128 v[48:51], v2 offset:20480
v_mov_b32 v23, 0
v_mfma_f32_16x16x32_bf16 v[28:31], v[68:71], v[16:19], v[28:31]
ds_read_b128 v[52:55], v2 offset:21504
v_mov_b32 v15, 0
v_rcp_f32 v12, v32
v_subrev_u32 v14, 0x21800000, v32
v_cmp_le_u32 vcc, 0x3c000000, v14
v_pk_mul_f32 v[24:25], v[24:25], v[12:13] op_sel_hi:[1,0]
v_pk_mul_f32 v[26:27], v[26:27], v[12:13] op_sel_hi:[1,0]
ds_read_b128 v[32:35], v2 offset:22528
v_pk_mul_f32 v[28:29], v[28:29], v[12:13] op_sel_hi:[1,0]
v_pk_mul_f32 v[30:31], v[30:31], v[12:13] op_sel_hi:[1,0]
v_cvt_pk_bf16_f32 v24, v24, v28
v_cvt_pk_bf16_f32 v25, v25, v29
v_cvt_pk_bf16_f32 v26, v26, v30
v_cvt_pk_bf16_f32 v27, v27, v31
v_mfma_f32_16x16x32_bf16 v[16:19], v[20:23], v[20:23], 0
ds_write_b128 v7, v[24:27]
v_mfma_f32_16x16x32_bf16 v[12:15], v[20:23], v[20:23], 0
ds_read_b128 v[36:39], v2 offset:23552
s_branch L_smr1
L_ent2:
s_movk_i32 s4, -64
s_mov_b32 s14, s53
s_mov_b32 s15, s53
v_mov_b64 v[24:25], 0
v_mov_b64 v[26:27], 0
v_mov_b64 v[28:29], 0
v_mov_b64 v[30:31], 0
v_and_b32 v69, 0x380, v3
v_add_u32 v69, v69, v3
v_and_b32 v70, 0xf40, v3
v_add_u32 v70, v70, v3
v_bfe_u32 v71, v3, 7, 1
v_mad_i32_i24 v70, v71, s4, v70
v_mov_b64 v[64:65], -1
v_mov_b64 v[66:67], -1
v_add_u32 v1, 2112, v4
ds_read_b128 v[48:51], v2 offset:12288
ds_read_b128 v[52:55], v2 offset:13312
ds_read_b128 v[40:43], v2 offset:4096
ds_read_b128 v[44:47], v2 offset:5120
v_mov_b64 v[32:33], 0
v_mov_b64 v[34:35], 0
v_mov_b64 v[36:37], 0
v_mov_b64 v[38:39], 0
v_mov_b64 v[56:57], 0
v_mov_b64 v[58:59], 0
v_mov_b64 v[60:61], 0
v_mov_b64 v[62:63], 0
s_add_u32 s20, s30, 2048
s_add_u32 s21, s30, 8192
s_add_u32 s49, s29, s25
s_add_u32 s50, s29, s26
s_add_u32 s51, s29, s27
s_add_u32 s52, s30, 524288
s_mov_b32 m0, 19968
s_nop 0
buffer_load_dwordx4 v69, s[8:11], s20 offen sc1 lds
s_mov_b32 m0, 20864
s_nop 0
buffer_load_dwordx4 v69, s[8:11], s20 offen offset:128 sc1 lds
s_waitcnt vmcnt(0) lgkmcnt(0)
s_branch L_step2
L_gr2:
buffer_load_dwordx4 v[12:15], v3, s[8:11], s33 offen sc1
buffer_load_dword v20, v8, s[8:11], s7 offen sc1
buffer_load_dwordx4 v[16:19], v3, s[8:11], s6 offen sc1
s_add_u32 s22, s22, 1
s_cmp_gt_u32 s22, 200000
s_cbranch_scc1 L_end
buffer_load_dwordx4 v[16:19], v3, s[8:11], s6 offen sc1
v_mov_b64 v[24:25], 0
v_mov_b64 v[26:27], 0
v_mov_b64 v[28:29], 0
v_mov_b64 v[30:31], 0
v_mov_b64 v[32:33], 0
v_mov_b64 v[34:35], 0
v_mov_b64 v[36:37], 0
v_mov_b64 v[38:39], 0
v_mov_b64 v[56:57], 0
v_mov_b64 v[58:59], 0
v_mov_b64 v[60:61], 0
v_mov_b64 v[62:63], 0
s_waitcnt lgkmcnt(0)
s_branch L_step2
.p2align 3
L_gat2:
buffer_load_dwordx4 v[12:15], v3, s[8:11], s33 offen sc1
buffer_load_dword v20, v8, s[8:11], s7 offen sc1
s_add_u32 s20, s30, 2048
s_add_u32 s21, s30, 8192
s_add_u32 s49, s29, s25
s_add_u32 s50, s29, s26
s_add_u32 s51, s29, s27
s_add_u32 s52, s30, 524288
buffer_load_dwordx4 v[16:19], v3, s[8:11], s6 offen sc1
s_mov_b32 m0, 19968
ds_read_b128 v[40:43], v2 offset:4096
ds_read_b128 v[44:47], v2 offset:5120
v_mov_b64 v[32:33], 0
v_mov_b64 v[34:35], 0
v_mov_b64 v[36:37], 0
v_mov_b64 v[38:39], 0
v_mov_b64 v[56:57], 0
v_mov_b64 v[58:59], 0
v_mov_b64 v[60:61], 0
v_mov_b64 v[62:63], 0
s_nop 3
buffer_load_dwordx4 v[16:19], v3, s[8:11], s6 offen sc1
s_waitcnt lgkmcnt(0)
L_step2:
s_waitcnt vmcnt(3)
v_smfmac_f32_16x16x64_bf16 v[24:27], v[12:15], v[120:127], v0
ds_write_b128 v3, v[12:15] offset:6656
v_smfmac_f32_16x16x64_bf16 v[28:31], v[12:15], v[128:135], v0
s_waitcnt vmcnt(2)
v_max3_u32 v21, v12, v13, v14
v_max3_u32 v21, v21, v15, v20
v_cmp_le_u32 vcc, 0xffff0000, v21
v_smfmac_f32_16x16x64_bf16 v[32:35], v[12:15], v[136:143], v0
s_cbranch_vccnz L_gr2
s_waitcnt vmcnt(1)
v_max3_u32 v21, v16, v17, v18
v_max_u32 v21, v21, v19
v_cmp_le_u32 vcc, 0xffff0000, v21
ds_write_b32 v8, v20 offset:14848
v_smfmac_f32_16x16x64_bf16 v[56:59], v[12:15], a[64:71], v0
s_cbranch_vccnz L_g3r2
L_g32:
ds_write_b128 v3, v[16:19] offset:10752
v_smfmac_f32_16x16x64_bf16 v[60:63], v[12:15], a[72:79], v0
v_smfmac_f32_16x16x64_bf16 v[36:39], v[12:15], v[40:47], v0
v_smfmac_f32_16x16x64_bf16 v[24:27], v[16:19], v[216:223], v0
v_smfmac_f32_16x16x64_bf16 v[28:31], v[16:19], v[224:231], v0
s_waitcnt lgkmcnt(0)
s_barrier
ds_read_b128 v[20:23], v3 offset:4608
v_smfmac_f32_16x16x64_bf16 v[32:35], v[16:19], v[232:239], v0
ds_read_b128 v[12:15], v3 offset:5632
s_mov_b32 m0, 6272
buffer_store_dword v0, v11, s[8:11], s35 offen
v_smfmac_f32_16x16x64_bf16 v[56:59], v[16:19], a[128:135], v0
ds_read_b128 v[40:43], v2
v_smfmac_f32_16x16x64_bf16 v[60:63], v[16:19], a[136:143], v0
ds_read_b128 v[44:47], v2 offset:1024
buffer_store_dwordx4 v[64:67], v3, s[8:11], s49 offen
v_smfmac_f32_16x16x64_bf16 v[36:39], v[16:19], v[48:55], v0
s_waitcnt vmcnt(2)
ds_read_b128 v[16:19], v3 offset:7680
s_waitcnt lgkmcnt(4)
v_smfmac_f32_16x16x64_bf16 v[24:27], v[20:23], v[72:79], v0
ds_read_b128 v[48:51], v2 offset:2048
buffer_store_dwordx4 v[64:67], v3, s[8:11], s50 offen
v_smfmac_f32_16x16x64_bf16 v[28:31], v[20:23], v[80:87], v0
ds_read_b128 v[52:55], v2 offset:3072
v_smfmac_f32_16x16x64_bf16 v[32:35], v[20:23], v[88:95], v0
s_waitcnt lgkmcnt(3)
buffer_store_dwordx4 v[64:67], v3, s[8:11], s51 offen
v_smfmac_f32_16x16x64_bf16 v[36:39], v[20:23], v[40:47], v0
ds_read_b128 v[20:23], v3 offset:8704
buffer_load_dwordx4 v[64:67], v70, s[8:11], s21 offen sc1
v_smfmac_f32_16x16x64_bf16 v[24:27], v[12:15], v[96:103], v0
ds_read_b128 v[40:43], v2 offset:6144
v_smfmac_f32_16x16x64_bf16 v[28:31], v[12:15], v[104:111], v0
ds_read_b128 v[44:47], v2 offset:7168
buffer_load_dwordx4 v[68:71], v70, s[8:11], s21 offen offset:256 sc1
v_smfmac_f32_16x16x64_bf16 v[32:35], v[12:15], v[112:119], v0
s_waitcnt lgkmcnt(3)
v_smfmac_f32_16x16x64_bf16 v[36:39], v[12:15], v[48:55], v0
ds_read_b128 v[12:15], v3 offset:9728
v_smfmac_f32_16x16x64_bf16 v[24:27], v[16:19], v[144:151], v0
ds_read_b128 v[48:51], v2 offset:8192
v_smfmac_f32_16x16x64_bf16 v[28:31], v[16:19], v[152:159], v0
ds_read_b128 v[52:55], v2 offset:9216
v_smfmac_f32_16x16x64_bf16 v[32:35], v[16:19], v[160:167], v0
s_waitcnt lgkmcnt(3)
v_smfmac_f32_16x16x64_bf16 v[36:39], v[16:19], v[40:47], v0
ds_read_b128 v[16:19], v3 offset:11776
v_smfmac_f32_16x16x64_bf16 v[24:27], v[20:23], v[168:175], v0
ds_read_b128 v[40:43], v2 offset:10240
v_smfmac_f32_16x16x64_bf16 v[28:31], v[20:23], v[176:183], v0
ds_read_b128 v[44:47], v2 offset:11264
v_smfmac_f32_16x16x64_bf16 v[32:35], v[20:23], v[184:191], v0
s_waitcnt lgkmcnt(3)
v_smfmac_f32_16x16x64_bf16 v[36:39], v[20:23], v[48:55], v0
ds_read_b128 v[20:23], v3 offset:12800
v_smfmac_f32_16x16x64_bf16 v[24:27], v[12:15], v[192:199], v0
ds_read_b128 v[48:51], v2 offset:14336
v_smfmac_f32_16x16x64_bf16 v[28:31], v[12:15], v[200:207], v0
ds_read_b128 v[52:55], v2 offset:15360
v_smfmac_f32_16x16x64_bf16 v[32:35], v[12:15], v[208:215], v0
s_waitcnt lgkmcnt(3)
v_smfmac_f32_16x16x64_bf16 v[36:39], v[12:15], v[40:47], v0
ds_read_b128 v[12:15], v3 offset:4608
v_smfmac_f32_16x16x64_bf16 v[24:27], v[16:19], v[240:247], v0
ds_read_b128 v[40:43], v2 offset:16384
v_smfmac_f32_16x16x64_bf16 v[28:31], v[16:19], v[248:255], v0
ds_read_b128 v[44:47], v2 offset:17408
v_smfmac_f32_16x16x64_bf16 v[32:35], v[16:19], a[0:7], v0
s_waitcnt lgkmcnt(3)
v_smfmac_f32_16x16x64_bf16 v[36:39], v[16:19], v[48:55], v0
ds_read_b128 v[16:19], v3 offset:5632
v_smfmac_f32_16x16x64_bf16 v[24:27], v[20:23], a[8:15], v0
ds_read_b128 v[48:51], v3 offset:17920
v_smfmac_f32_16x16x64_bf16 v[28:31], v[20:23], a[16:23], v0
ds_read_b128 v[52:55], v3 offset:19968
v_smfmac_f32_16x16x64_bf16 v[32:35], v[20:23], a[24:31], v0
s_waitcnt lgkmcnt(3)
v_smfmac_f32_16x16x64_bf16 v[36:39], v[20:23], v[40:47], v0
ds_read_b128 v[20:23], v3 offset:7680
s_nop 0
v_add_f32 v24, v24, v25
v_smfmac_f32_16x16x64_bf16 v[56:59], v[12:15], a[32:39], v0
ds_read_b128 v[40:43], v3 offset:13824
v_add_f32 v26, v26, v27
v_add_f32 v28, v28, v29
v_add_f32 v30, v30, v31
v_mul_f32 v24, s18, v24
v_smfmac_f32_16x16x64_bf16 v[60:63], v[12:15], a[40:47], v0
ds_read_b128 v[12:15], v3 offset:8704
v_mul_f32 v28, s18, v28
v_mul_f32 v26, s18, v26
v_mul_f32 v30, s18, v30
v_cvt_pk_bf16_f32 v24, v24, v28
s_waitcnt lgkmcnt(5)
v_smfmac_f32_16x16x64_bf16 v[56:59], v[16:19], a[48:55], v0
ds_read_b128 v[44:47], v3 offset:15872
v_cvt_pk_bf16_f32 v26, v26, v30
ds_write2_b32 v1, v24, v26 offset1:32
v_add_f32 v32, v32, v33
v_add_f32 v34, v34, v35
v_smfmac_f32_16x16x64_bf16 v[60:63], v[16:19], a[56:63], v0
ds_read_b128 v[16:19], v3 offset:9728
v_add_f32 v36, v36, v37
v_add_f32 v38, v38, v39
v_cvt_pk_bf16_f32 v1, v32, v36
v_cvt_pk_bf16_f32 v8, v34, v38
s_waitcnt lgkmcnt(5)
v_smfmac_f32_16x16x64_bf16 v[56:59], v[20:23], a[80:87], v0
ds_write2_b32 v4, v1, v8 offset1:32
v_smfmac_f32_16x16x64_bf16 v[60:63], v[20:23], a[88:95], v0
s_waitcnt lgkmcnt(4)
ds_read_b128 v[20:23], v3 offset:11776
v_smfmac_f32_16x16x64_bf16 v[56:59], v[12:15], a[96:103], v0
v_smfmac_f32_16x16x64_bf16 v[60:63], v[12:15], a[104:111], v0
s_waitcnt lgkmcnt(2)
ds_read_b128 v[12:15], v3 offset:12800
v_smfmac_f32_16x16x64_bf16 v[56:59], v[16:19], a[112:119], v0
v_smfmac_f32_16x16x64_bf16 v[60:63], v[16:19], a[120:127], v0
s_waitcnt lgkmcnt(2)
s_barrier
ds_read_b128 v[32:35], v5 offset:1024
s_waitcnt lgkmcnt(2)
v_smfmac_f32_16x16x64_bf16 v[56:59], v[20:23], a[144:151], v0
ds_read_b128 v[36:39], v5 offset:1536
v_smfmac_f32_16x16x64_bf16 v[60:63], v[20:23], a[152:159], v0
s_waitcnt lgkmcnt(2)
ds_read_b128 v[24:27], v5
v_smfmac_f32_16x16x64_bf16 v[56:59], v[12:15], a[160:167], v0
ds_read_b128 v[28:31], v5 offset:512
v_smfmac_f32_16x16x64_bf16 v[60:63], v[12:15], a[168:175], v0
s_waitcnt lgkmcnt(3)
v_mfma_f32_16x16x32_bf16 v[16:19], v[48:51], v[32:35], 0
s_waitcnt lgkmcnt(2)
ds_read_b128 v[48:51], v3 offset:18944
v_mfma_f32_16x16x32_bf16 v[16:19], v[52:55], v[36:39], v[16:19]
s_waitcnt lgkmcnt(2)
ds_read_b128 v[52:55], v3 offset:20992
v_mfma_f32_16x16x32_bf16 v[16:19], v[40:43], v[24:27], v[16:19]
s_waitcnt lgkmcnt(2)
ds_read_b128 v[40:43], v3 offset:14848
v_add_f32 v56, v56, v57
v_mfma_f32_16x16x32_bf16 v[16:19], v[44:47], v[28:31], v[16:19]
ds_read_b128 v[44:47], v3 offset:16896
v_add_f32 v58, v58, v59
v_mfma_f32_16x16x32_bf16 v[20:23], v[32:35], v[32:35], 0
s_add_u32 s49, s28, s23
v_add_f32 v60, v60, v61
v_add_f32 v62, v62, v63
v_mfma_f32_16x16x32_bf16 v[20:23], v[36:39], v[36:39], v[20:23]
s_add_u32 s50, s28, 65536
v_cvt_pk_bf16_f32 v56, v56, v58
v_cvt_pk_bf16_f32 v57, v60, v62
v_mfma_f32_16x16x32_bf16 v[20:23], v[24:27], v[24:27], v[20:23]
s_add_u32 s51, s28, 131072
v_mov_b32 v58, v1
v_mov_b32 v59, v8
v_exp_f32 v16, v16
v_mfma_f32_16x16x32_bf16 v[20:23], v[28:31], v[28:31], v[20:23]
s_waitcnt lgkmcnt(3)
v_exp_f32 v17, v17
v_mfma_f32_16x16x32_bf16 v[12:15], v[48:51], v[32:35], 0
s_waitcnt lgkmcnt(2)
v_exp_f32 v18, v18
buffer_store_dwordx4 v[56:59], v3, s[8:11], s31 offen sc1
v_mfma_f32_16x16x32_bf16 v[12:15], v[52:55], v[36:39], v[12:15]
s_waitcnt lgkmcnt(1)
v_exp_f32 v19, v19
v_mfma_f32_16x16x32_bf16 v[12:15], v[40:43], v[24:27], v[12:15]
s_waitcnt lgkmcnt(0)
v_exp_f32 v20, v20
v_mfma_f32_16x16x32_bf16 v[12:15], v[44:47], v[28:31], v[12:15]
s_add_u32 s52, s28, 196608
v_exp_f32 v21, v21
v_mov_b64 v[60:61], s[14:15]
v_cvt_pk_bf16_f32 v23, v20, v21
v_cvt_pk_bf16_f32 v20, v20, v21
v_mov_b32 v21, 0
v_mov_b32 v22, 0
v_cvt_pk_bf16_f32 v16, v16, v17
v_cvt_pk_bf16_f32 v17, v18, v19
v_mfma_f32_16x16x16_bf16 v[24:27], v[56:57], v[20:21], 0
v_exp_f32 v12, v12
v_mfma_f32_16x16x16_bf16 v[28:31], v[56:57], v[22:23], 0
v_exp_f32 v13, v13
v_mfma_f32_16x16x16_bf16 v[32:35], v[60:61], v[20:21], 0
v_exp_f32 v14, v14
v_exp_f32 v15, v15
v_mov_b64 v[62:63], s[14:15]
v_cvt_pk_bf16_f32 v18, v12, v13
v_cvt_pk_bf16_f32 v19, v14, v15
s_waitcnt vmcnt(1)
ds_read_b128 v[40:43], v2 offset:18432
v_mfma_f32_16x16x32_bf16 v[32:35], v[60:63], v[16:19], v[32:35]
ds_read_b128 v[44:47], v2 offset:19456
v_mov_b32 v20, 0
v_mfma_f32_16x16x32_bf16 v[24:27], v[64:67], v[16:19], v[24:27]
ds_read_b128 v[48:51], v2 offset:20480
v_mov_b32 v23, 0
v_mfma_f32_16x16x32_bf16 v[28:31], v[68:71], v[16:19], v[28:31]
ds_read_b128 v[52:55], v2 offset:21504
v_mov_b32 v15, 0
v_rcp_f32 v12, v32
v_subrev_u32 v14, 0x21800000, v32
v_cmp_le_u32 vcc, 0x3c000000, v14
v_pk_mul_f32 v[24:25], v[24:25], v[12:13] op_sel_hi:[1,0]
v_pk_mul_f32 v[26:27], v[26:27], v[12:13] op_sel_hi:[1,0]
ds_read_b128 v[32:35], v2 offset:22528
v_pk_mul_f32 v[28:29], v[28:29], v[12:13] op_sel_hi:[1,0]
v_pk_mul_f32 v[30:31], v[30:31], v[12:13] op_sel_hi:[1,0]
v_cvt_pk_bf16_f32 v24, v24, v28
v_cvt_pk_bf16_f32 v25, v25, v29
v_cvt_pk_bf16_f32 v26, v26, v30
v_cvt_pk_bf16_f32 v27, v27, v31
v_mfma_f32_16x16x32_bf16 v[16:19], v[20:23], v[20:23], 0
ds_write_b128 v7, v[24:27]
v_mfma_f32_16x16x32_bf16 v[12:15], v[20:23], v[20:23], 0
s_andn2_b64 vcc, vcc, s[86:87]
ds_read_b128 v[36:39], v2 offset:23552
s_cbranch_scc1 L_sm2
L_smr2:
v_mfma_f32_16x16x32_bf16 v[56:59], v[20:23], v[20:23], 0
v_mov_b32 v1, 6528
v_and_b32 v8, 0x380, v3
s_add_u32 s20, s30, 526336
v_add_u32 v8, v8, v3
s_mov_b32 m0, 19968
s_cmp_eq_u32 s19, 63
s_cbranch_scc1 L_texit
s_waitcnt lgkmcnt(0)
s_barrier
ds_read_b128 v[24:27], v3 offset:2176
v_mfma_f32_16x16x32_bf16 v[64:67], v[20:23], v[20:23], 0
ds_read_b128 v[28:31], v3 offset:3200
v_mfma_f32_16x16x32_bf16 v[60:63], v[20:23], v[20:23], 0
v_mfma_f32_16x16x32_bf16 v[68:71], v[20:23], v[20:23], 0
s_waitcnt lgkmcnt(1)
v_smfmac_f32_16x16x64_bf16 v[12:15], v[24:27], a[248:255], v0
buffer_load_dwordx4 v8, s[8:11], s20 offen sc1 lds
v_smfmac_f32_16x16x64_bf16 v[16:19], v[24:27], a[176:183], v0
s_mov_b32 m0, 20864
s_waitcnt lgkmcnt(0)
v_smfmac_f32_16x16x64_bf16 v[12:15], v[28:31], v[40:47], v0
ds_read_b128 v[40:43], v2 offset:24576
v_smfmac_f32_16x16x64_bf16 v[16:19], v[28:31], v[48:55], v0
ds_read_b128 v[44:47], v2 offset:25600
buffer_load_dwordx4 v8, s[8:11], s20 offen offset:128 sc1 lds
v_smfmac_f32_16x16x64_bf16 v[20:23], v[24:27], a[184:191], v0
ds_read_b128 v[48:51], v2 offset:26624
s_nop 1
v_add_f32 v12, v12, v13
v_add_f32 v14, v14, v15
v_cvt_pk_bf16_f32 v12, v12, v14
v_smfmac_f32_16x16x64_bf16 v[20:23], v[28:31], v[32:39], v0
ds_read_b128 v[52:55], v2 offset:27648
buffer_store_dword v12, v10, s[8:11], s28 offen
v_add_f32 v16, v16, v17
v_add_f32 v18, v18, v19
v_smfmac_f32_16x16x64_bf16 v[56:59], v[24:27], a[192:199], v0
s_waitcnt lgkmcnt(2)
ds_read_b128 v[32:35], v2 offset:28672
v_cvt_pk_bf16_f32 v16, v16, v18
v_smfmac_f32_16x16x64_bf16 v[56:59], v[28:31], v[40:47], v0
ds_read_b128 v[36:39], v2 offset:29696
v_add_f32 v20, v20, v21
v_add_f32 v22, v22, v23
v_cvt_pk_bf16_f32 v17, v20, v22
v_smfmac_f32_16x16x64_bf16 v[60:63], v[24:27], a[200:207], v0
s_waitcnt lgkmcnt(2)
ds_read_b128 v[12:15], v1
buffer_store_dwordx2 v[16:17], v9, s[8:11], s28 offen
v_smfmac_f32_16x16x64_bf16 v[60:63], v[28:31], v[48:55], v0
ds_read_b128 v[40:43], v2 offset:30720
v_add_f32 v56, v56, v57
v_add_f32 v58, v58, v59
v_cvt_pk_bf16_f32 v56, v56, v58
v_smfmac_f32_16x16x64_bf16 v[64:67], v[24:27], a[208:215], v0
s_waitcnt lgkmcnt(2)
ds_read_b128 v[44:47], v2 offset:31744
v_smfmac_f32_16x16x64_bf16 v[64:67], v[28:31], v[32:39], v0
ds_read_b128 v[20:23], v1
v_add_f32 v60, v60, v61
v_add_f32 v62, v62, v63
v_cvt_pk_bf16_f32 v57, v60, v62
v_smfmac_f32_16x16x64_bf16 v[68:71], v[24:27], a[216:223], v0
s_waitcnt lgkmcnt(1)
ds_read_b128 v[48:51], v2 offset:32768
buffer_store_dwordx2 v[56:57], v9, s[8:11], s50 offen
v_smfmac_f32_16x16x64_bf16 v[68:71], v[28:31], v[40:47], v0
ds_read_b128 v[52:55], v2 offset:33792
v_add_f32 v64, v64, v65
v_add_f32 v66, v66, v67
v_cvt_pk_bf16_f32 v64, v64, v66
v_smfmac_f32_16x16x64_bf16 v[12:15], v[24:27], a[224:231], v0
s_waitcnt lgkmcnt(0)
v_smfmac_f32_16x16x64_bf16 v[12:15], v[28:31], v[48:55], v0
s_nop 0
v_add_f32 v68, v68, v69
v_add_f32 v70, v70, v71
v_cvt_pk_bf16_f32 v65, v68, v70
v_smfmac_f32_16x16x64_bf16 v[20:23], v[24:27], a[232:239], v0
buffer_store_dwordx2 v[64:65], v9, s[8:11], s51 offen
v_smfmac_f32_16x16x64_bf16 v[20:23], v[28:31], a[240:247], v0
s_nop 0
v_add_f32 v12, v12, v13
v_add_f32 v14, v14, v15
v_cvt_pk_bf16_f32 v12, v12, v14
s_nop 3
v_add_f32 v20, v20, v21
v_add_f32 v22, v22, v23
v_cvt_pk_bf16_f32 v13, v20, v22
buffer_store_dwordx2 v[12:13], v9, s[8:11], s52 offen
s_cmp_eq_u32 s48, 0
s_cbranch_scc1 L_nojob2
L_lt2:
s_nop 9
buffer_load_dwordx4 v[32:35], v3, s[8:11], s49 offen sc1
buffer_load_dwordx4 v[36:39], v3, s[8:11], s49 offen offset:1024 sc1
buffer_load_dwordx4 v[40:43], v3, s[8:11], s49 offen offset:2048 sc1
buffer_load_dwordx4 v[44:47], v3, s[8:11], s49 offen offset:3072 sc1
s_add_u32 s19, s19, 1
s_mov_b32 s20, s28
s_mov_b32 s28, s29
s_mov_b32 s29, s20
s_and_b32 s20, s19, 3
s_lshl_b32 s20, s20, 14
s_add_u32 s33, s20, 110100480
s_add_u32 s34, s20, s24
s_xor_b32 s20, s20, 32768
s_add_u32 s35, s20, s24
s_add_u32 s30, s30, 524288
s_add_u32 s31, s31, 131072
s_add_u32 s6, s33, 4096
s_add_u32 s7, s33, 8192
s_mov_b32 s22, 0
v_mov_b64 v[24:25], 0
v_mov_b64 v[26:27], 0
v_mov_b64 v[28:29], 0
v_mov_b64 v[30:31], 0
v_and_b32 v70, 0xf40, v3
v_add_u32 v70, v70, v3
v_bfe_u32 v71, v3, 7, 1
v_mad_i32_i24 v70, v71, s4, v70
v_mov_b64 v[64:65], -1
v_mov_b64 v[66:67], -1
v_add_u32 v1, 2112, v4
ds_read_b128 v[48:51], v2 offset:12288
ds_read_b128 v[52:55], v2 offset:13312
v_lshrrev_b32 v8, 2, v3
v_mov_b32 v56, 0x3f80
v_cndmask_b32 v56, v56, 1.0, s[44:45]
v_cndmask_b32 v60, 0, v56, s[36:37]
v_cndmask_b32 v61, 0, v56, s[38:39]
v_cndmask_b32 v62, 0, v56, s[40:41]
v_cndmask_b32 v63, 0, v56, s[42:43]
s_waitcnt vmcnt(3)
s_nop 0
v_mfma_f32_16x16x32_bf16 v[56:59], v[32:35], v[60:63], 0
v_max3_u32 v16, v32, v33, v34
v_max_u32 v16, v16, v35
s_waitcnt vmcnt(2)
v_mfma_f32_16x16x32_bf16 v[56:59], v[36:39], v[60:63], v[56:59]
v_max3_u32 v16, v16, v36, v37
v_max3_u32 v16, v16, v38, v39
s_waitcnt vmcnt(1)
v_mfma_f32_16x16x32_bf16 v[56:59], v[40:43], v[60:63], v[56:59]
v_max3_u32 v16, v16, v40, v41
v_max3_u32 v16, v16, v42, v43
s_waitcnt vmcnt(0)
v_mfma_f32_16x16x32_bf16 v[56:59], v[44:47], v[60:63], v[56:59]
v_max3_u32 v16, v16, v44, v45
v_max3_u32 v16, v16, v46, v47
v_cmp_le_u32 vcc, 0xffff0000, v16
s_cbranch_vccnz L_red2
L_redb2:
s_nop 3
v_permlane32_swap_b32 v56, v58
v_permlane32_swap_b32 v57, v59
v_pk_add_f32 v[56:57], v[56:57], v[58:59]
v_cvt_pk_bf16_f32 v56, v56, v57
buffer_store_dword v56, v11, s[8:11], s34 offen
s_add_u32 s20, s30, 2048
s_add_u32 s21, s30, 8192
s_add_u32 s49, s29, s25
s_add_u32 s50, s29, s26
s_add_u32 s51, s29, s27
s_add_u32 s52, s30, 524288
s_mov_b32 m0, 19968
s_nop 9
s_barrier
s_branch L_gat2
L_red2:
L_red2b:
buffer_load_dwordx4 v[32:35], v3, s[8:11], s49 offen sc1
buffer_load_dwordx4 v[36:39], v3, s[8:11], s49 offen offset:1024 sc1
buffer_load_dwordx4 v[40:43], v3, s[8:11], s49 offen offset:2048 sc1
buffer_load_dwordx4 v[44:47], v3, s[8:11], s49 offen offset:3072 sc1
s_add_u32 s22, s22, 1
s_cmp_gt_u32 s22, 200000
s_cbranch_scc1 L_end
s_waitcnt vmcnt(3)
v_mfma_f32_16x16x32_bf16 v[56:59], v[32:35], v[60:63], 0
v_max3_u32 v16, v32, v33, v34
v_max_u32 v16, v16, v35
s_waitcnt vmcnt(2)
v_mfma_f32_16x16x32_bf16 v[56:59], v[36:39], v[60:63], v[56:59]
v_max3_u32 v16, v16, v36, v37
v_max3_u32 v16, v16, v38, v39
s_waitcnt vmcnt(1)
v_mfma_f32_16x16x32_bf16 v[56:59], v[40:43], v[60:63], v[56:59]
v_max3_u32 v16, v16, v40, v41
v_max3_u32 v16, v16, v42, v43
s_waitcnt vmcnt(0)
v_mfma_f32_16x16x32_bf16 v[56:59], v[44:47], v[60:63], v[56:59]
v_max3_u32 v16, v16, v44, v45
v_max3_u32 v16, v16, v46, v47
v_cmp_le_u32 vcc, 0xffff0000, v16
s_cbranch_vccz L_redb2
s_branch L_red2b
L_g3r2:
buffer_load_dwordx4 v[16:19], v3, s[8:11], s6 offen sc1
s_add_u32 s22, s22, 1
s_waitcnt vmcnt(1)
v_max3_u32 v21, v16, v17, v18
v_max_u32 v21, v21, v19
v_cmp_le_u32 vcc, 0xffff0000, v21
s_cmp_gt_u32 s22, 200000
s_cbranch_vccz L_g32
s_cbranch_scc0 L_g3r2
s_branch L_end
L_sm2:
s_waitcnt lgkmcnt(0)
ds_read_b128 v[24:27], v5
ds_read_b128 v[40:43], v3 offset:13824
ds_read_b128 v[28:31], v5 offset:512
ds_read_b128 v[44:47], v3 offset:15872
ds_read_b128 v[32:35], v5 offset:1024
ds_read_b128 v[48:51], v3 offset:17920
ds_read_b128 v[36:39], v5 offset:1536
ds_read_b128 v[52:55], v3 offset:19968
s_waitcnt lgkmcnt(0)
v_mfma_f32_16x16x32_bf16 v[16:19], v[40:43], v[24:27], 0
ds_read_b128 v[40:43], v3 offset:14848
v_mfma_f32_16x16x32_bf16 v[16:19], v[44:47], v[28:31], v[16:19]
ds_read_b128 v[44:47], v3 offset:16896
v_mfma_f32_16x16x32_bf16 v[16:19], v[48:51], v[32:35], v[16:19]
ds_read_b128 v[48:51], v3 offset:18944
v_mfma_f32_16x16x32_bf16 v[16:19], v[52:55], v[36:39], v[16:19]
ds_read_b128 v[52:55], v3 offset:20992
v_mfma_f32_16x16x32_bf16 v[20:23], v[24:27], v[24:27], 0
v_mfma_f32_16x16x32_bf16 v[20:23], v[28:31], v[28:31], v[20:23]
v_mfma_f32_16x16x32_bf16 v[20:23], v[32:35], v[32:35], v[20:23]
v_mfma_f32_16x16x32_bf16 v[20:23], v[36:39], v[36:39], v[20:23]
s_waitcnt lgkmcnt(0)
v_mfma_f32_16x16x32_bf16 v[12:15], v[40:43], v[24:27], 0
v_mfma_f32_16x16x32_bf16 v[12:15], v[44:47], v[28:31], v[12:15]
v_mfma_f32_16x16x32_bf16 v[12:15], v[48:51], v[32:35], v[12:15]
v_mfma_f32_16x16x32_bf16 v[12:15], v[52:55], v[36:39], v[12:15]
v_max3_f32 v59, v16, v17, v18
s_nop 1
v_max3_f32 v59, v59, v19, v20
s_nop 3
v_max3_f32 v59, v59, v21, v12
v_max3_f32 v59, v59, v13, v14
v_max_f32 v59, v59, v15
v_mov_b32 v22, v59
s_nop 1
v_permlane32_swap_b32 v22, v59
v_max_f32 v59, v59, v22
v_mov_b32 v22, v59
s_nop 1
v_permlane16_swap_b32 v22, v59
v_max_f32 v59, v59, v22
v_sub_f32 v20, v20, v59
v_sub_f32 v21, v21, v59
v_sub_f32 v16, v16, v59
v_sub_f32 v17, v17, v59
v_sub_f32 v18, v18, v59
v_sub_f32 v19, v19, v59
v_sub_f32 v12, v12, v59
v_sub_f32 v13, v13, v59
v_sub_f32 v14, v14, v59
v_sub_f32 v15, v15, v59
v_exp_f32 v20, v20
v_exp_f32 v21, v21
v_exp_f32 v16, v16
v_exp_f32 v17, v17
v_exp_f32 v18, v18
v_exp_f32 v19, v19
v_exp_f32 v12, v12
v_exp_f32 v13, v13
v_exp_f32 v14, v14
v_exp_f32 v15, v15
v_cvt_pk_bf16_f32 v23, v20, v21
v_cvt_pk_bf16_f32 v20, v20, v21
v_mov_b32 v21, 0
v_mov_b32 v22, 0
v_cvt_pk_bf16_f32 v16, v16, v17
v_cvt_pk_bf16_f32 v17, v18, v19
v_cvt_pk_bf16_f32 v18, v12, v13
v_cvt_pk_bf16_f32 v19, v14, v15
v_mfma_f32_16x16x16_bf16 v[24:27], v[56:57], v[20:21], 0
v_mfma_f32_16x16x16_bf16 v[28:31], v[56:57], v[22:23], 0
v_mfma_f32_16x16x16_bf16 v[32:35], v[60:61], v[20:21], 0
ds_read_b128 v[40:43], v2 offset:18432
v_mfma_f32_16x16x32_bf16 v[32:35], v[60:63], v[16:19], v[32:35]
ds_read_b128 v[44:47], v2 offset:19456
v_mov_b32 v20, 0
v_mfma_f32_16x16x32_bf16 v[24:27], v[64:67], v[16:19], v[24:27]
ds_read_b128 v[48:51], v2 offset:20480
v_mov_b32 v23, 0
v_mfma_f32_16x16x32_bf16 v[28:31], v[68:71], v[16:19], v[28:31]
ds_read_b128 v[52:55], v2 offset:21504
v_mov_b32 v15, 0
v_rcp_f32 v12, v32
v_subrev_u32 v14, 0x21800000, v32
v_cmp_le_u32 vcc, 0x3c000000, v14
v_pk_mul_f32 v[24:25], v[24:25], v[12:13] op_sel_hi:[1,0]
v_pk_mul_f32 v[26:27], v[26:27], v[12:13] op_sel_hi:[1,0]
ds_read_b128 v[32:35], v2 offset:22528
v_pk_mul_f32 v[28:29], v[28:29], v[12:13] op_sel_hi:[1,0]
v_pk_mul_f32 v[30:31], v[30:31], v[12:13] op_sel_hi:[1,0]
v_cvt_pk_bf16_f32 v24, v24, v28
v_cvt_pk_bf16_f32 v25, v25, v29
v_cvt_pk_bf16_f32 v26, v26, v30
v_cvt_pk_bf16_f32 v27, v27, v31
v_mfma_f32_16x16x32_bf16 v[16:19], v[20:23], v[20:23], 0
ds_write_b128 v7, v[24:27]
v_mfma_f32_16x16x32_bf16 v[12:15], v[20:23], v[20:23], 0
ds_read_b128 v[36:39], v2 offset:23552
s_branch L_smr2
L_nojob2:
s_add_u32 s19, s19, 1
s_mov_b32 s20, s28
s_mov_b32 s28, s29
s_mov_b32 s29, s20
s_and_b32 s20, s19, 3
s_lshl_b32 s20, s20, 14
s_add_u32 s33, s20, 110100480
s_add_u32 s34, s20, s24
s_xor_b32 s20, s20, 32768
s_add_u32 s35, s20, s24
s_add_u32 s30, s30, 524288
s_add_u32 s31, s31, 131072
s_add_u32 s6, s33, 4096
s_add_u32 s7, s33, 8192
s_mov_b32 s22, 0
v_mov_b64 v[24:25], 0
v_mov_b64 v[26:27], 0
v_mov_b64 v[28:29], 0
v_mov_b64 v[30:31], 0
v_and_b32 v70, 0xf40, v3
v_add_u32 v70, v70, v3
v_bfe_u32 v71, v3, 7, 1
v_mad_i32_i24 v70, v71, s4, v70
v_mov_b64 v[64:65], -1
v_mov_b64 v[66:67], -1
v_add_u32 v1, 2112, v4
ds_read_b128 v[48:51], v2 offset:12288
ds_read_b128 v[52:55], v2 offset:13312
v_lshrrev_b32 v8, 2, v3
s_barrier
s_branch L_gat2
L_ent3:
s_movk_i32 s4, -64
s_mov_b32 s14, s53
s_mov_b32 s15, s53
v_mov_b64 v[24:25], 0
v_mov_b64 v[26:27], 0
v_mov_b64 v[28:29], 0
v_mov_b64 v[30:31], 0
v_and_b32 v69, 0x380, v3
v_add_u32 v69, v69, v3
v_and_b32 v70, 0xf40, v3
v_add_u32 v70, v70, v3
v_bfe_u32 v71, v3, 7, 1
v_mad_i32_i24 v70, v71, s4, v70
v_mov_b64 v[64:65], -1
v_mov_b64 v[66:67], -1
v_add_u32 v1, 2112, v4
ds_read_b128 v[48:51], v2 offset:14336
ds_read_b128 v[52:55], v2 offset:15360
ds_read_b128 v[40:43], v2 offset:6144
ds_read_b128 v[44:47], v2 offset:7168
v_mov_b64 v[32:33], 0
v_mov_b64 v[34:35], 0
v_mov_b64 v[36:37], 0
v_mov_b64 v[38:39], 0
v_mov_b64 v[56:57], 0
v_mov_b64 v[58:59], 0
v_mov_b64 v[60:61], 0
v_mov_b64 v[62:63], 0
s_add_u32 s20, s30, 3072
s_add_u32 s21, s30, 8192
s_add_u32 s49, s29, s25
s_add_u32 s50, s29, s26
s_add_u32 s51, s29, s27
s_add_u32 s52, s30, 524288
s_mov_b32 m0, 22016
s_nop 0
buffer_load_dwordx4 v69, s[8:11], s20 offen sc1 lds
s_mov_b32 m0, 22912
s_nop 0
buffer_load_dwordx4 v69, s[8:11], s20 offen offset:128 sc1 lds
s_waitcnt vmcnt(0) lgkmcnt(0)
s_branch L_step3
L_gr3:
buffer_load_dwordx4 v[12:15], v3, s[8:11], s33 offen sc1
buffer_load_dword v20, v8, s[8:11], s7 offen sc1
buffer_load_dwordx4 v[16:19], v3, s[8:11], s6 offen sc1
s_add_u32 s22, s22, 1
s_cmp_gt_u32 s22, 200000
s_cbranch_scc1 L_end
buffer_load_dwordx4 v[16:19], v3, s[8:11], s6 offen sc1
v_mov_b64 v[24:25], 0
v_mov_b64 v[26:27], 0
v_mov_b64 v[28:29], 0
v_mov_b64 v[30:31], 0
v_mov_b64 v[32:33], 0
v_mov_b64 v[34:35], 0
v_mov_b64 v[36:37], 0
v_mov_b64 v[38:39], 0
v_mov_b64 v[56:57], 0
v_mov_b64 v[58:59], 0
v_mov_b64 v[60:61], 0
v_mov_b64 v[62:63], 0
s_waitcnt lgkmcnt(0)
s_branch L_step3
.p2align 3
L_gat3:
buffer_load_dwordx4 v[12:15], v3, s[8:11], s33 offen sc1
buffer_load_dword v20, v8, s[8:11], s7 offen sc1
s_add_u32 s20, s30, 3072
s_add_u32 s21, s30, 8192
s_add_u32 s49, s29, s25
s_add_u32 s50, s29, s26
s_add_u32 s51, s29, s27
s_add_u32 s52, s30, 524288
buffer_load_dwordx4 v[16:19], v3, s[8:11], s6 offen sc1
s_mov_b32 m0, 22016
ds_read_b128 v[40:43], v2 offset:6144
ds_read_b128 v[44:47], v2 offset:7168
v_mov_b64 v[32:33], 0
v_mov_b64 v[34:35], 0
v_mov_b64 v[36:37], 0
v_mov_b64 v[38:39], 0
v_mov_b64 v[56:57], 0
v_mov_b64 v[58:59], 0
v_mov_b64 v[60:61], 0
v_mov_b64 v[62:63], 0
s_nop 3
buffer_load_dwordx4 v[16:19], v3, s[8:11], s6 offen sc1
s_waitcnt lgkmcnt(0)
L_step3:
s_waitcnt vmcnt(3)
v_smfmac_f32_16x16x64_bf16 v[24:27], v[12:15], v[144:151], v0
ds_write_b128 v3, v[12:15] offset:6656
v_smfmac_f32_16x16x64_bf16 v[28:31], v[12:15], v[152:159], v0
s_waitcnt vmcnt(2)
v_max3_u32 v21, v12, v13, v14
v_max3_u32 v21, v21, v15, v20
v_cmp_le_u32 vcc, 0xffff0000, v21
v_smfmac_f32_16x16x64_bf16 v[32:35], v[12:15], v[160:167], v0
s_cbranch_vccnz L_gr3
s_waitcnt vmcnt(1)
v_max3_u32 v21, v16, v17, v18
v_max_u32 v21, v21, v19
v_cmp_le_u32 vcc, 0xffff0000, v21
ds_write_b32 v8, v20 offset:14848
v_smfmac_f32_16x16x64_bf16 v[56:59], v[12:15], a[80:87], v0
s_cbranch_vccnz L_g3r3
L_g33:
ds_write_b128 v3, v[16:19] offset:10752
v_smfmac_f32_16x16x64_bf16 v[60:63], v[12:15], a[88:95], v0
v_smfmac_f32_16x16x64_bf16 v[36:39], v[12:15], v[40:47], v0
v_smfmac_f32_16x16x64_bf16 v[24:27], v[16:19], v[240:247], v0
v_smfmac_f32_16x16x64_bf16 v[28:31], v[16:19], v[248:255], v0
s_waitcnt lgkmcnt(0)
s_barrier
ds_read_b128 v[20:23], v3 offset:3584
v_smfmac_f32_16x16x64_bf16 v[32:35], v[16:19], a[0:7], v0
ds_read_b128 v[12:15], v3 offset:4608
s_mov_b32 m0, 6272
v_smfmac_f32_16x16x64_bf16 v[56:59], v[16:19], a[144:151], v0
ds_read_b128 v[40:43], v2
v_smfmac_f32_16x16x64_bf16 v[60:63], v[16:19], a[152:159], v0
ds_read_b128 v[44:47], v2 offset:1024
buffer_store_dwordx4 v[64:67], v3, s[8:11], s49 offen
v_smfmac_f32_16x16x64_bf16 v[36:39], v[16:19], v[48:55], v0
s_waitcnt vmcnt(1)
ds_read_b128 v[16:19], v3 offset:5632
s_waitcnt lgkmcnt(4)
v_smfmac_f32_16x16x64_bf16 v[24:27], v[20:23], v[72:79], v0
ds_read_b128 v[48:51], v2 offset:2048
buffer_store_dwordx4 v[64:67], v3, s[8:11], s50 offen
v_smfmac_f32_16x16x64_bf16 v[28:31], v[20:23], v[80:87], v0
ds_read_b128 v[52:55], v2 offset:3072
v_smfmac_f32_16x16x64_bf16 v[32:35], v[20:23], v[88:95], v0
s_waitcnt lgkmcnt(3)
buffer_store_dwordx4 v[64:67], v3, s[8:11], s51 offen
v_smfmac_f32_16x16x64_bf16 v[36:39], v[20:23], v[40:47], v0
ds_read_b128 v[20:23], v3 offset:7680
buffer_load_dwordx4 v[64:67], v70, s[8:11], s21 offen sc1
v_smfmac_f32_16x16x64_bf16 v[24:27], v[12:15], v[96:103], v0
ds_read_b128 v[40:43], v2 offset:4096
v_smfmac_f32_16x16x64_bf16 v[28:31], v[12:15], v[104:111], v0
ds_read_b128 v[44:47], v2 offset:5120
buffer_load_dwordx4 v[68:71], v70, s[8:11], s21 offen offset:256 sc1
v_smfmac_f32_16x16x64_bf16 v[32:35], v[12:15], v[112:119], v0
s_waitcnt lgkmcnt(3)
v_smfmac_f32_16x16x64_bf16 v[36:39], v[12:15], v[48:55], v0
ds_read_b128 v[12:15], v3 offset:8704
v_smfmac_f32_16x16x64_bf16 v[24:27], v[16:19], v[120:127], v0
ds_read_b128 v[48:51], v2 offset:8192
v_smfmac_f32_16x16x64_bf16 v[28:31], v[16:19], v[128:135], v0
ds_read_b128 v[52:55], v2 offset:9216
v_mov_b32 v11, s19
v_smfmac_f32_16x16x64_bf16 v[32:35], v[16:19], v[136:143], v0
s_mov_b64 exec, 1
buffer_store_dword v11, v8, s[8:11], s83 offen sc1
s_mov_b64 exec, -1
s_waitcnt lgkmcnt(3)
v_smfmac_f32_16x16x64_bf16 v[36:39], v[16:19], v[40:47], v0
ds_read_b128 v[16:19], v3 offset:9728
buffer_load_dword v11, v8, s[8:11], s82 offen sc1
v_smfmac_f32_16x16x64_bf16 v[24:27], v[20:23], v[168:175], v0
ds_read_b128 v[40:43], v2 offset:10240
v_smfmac_f32_16x16x64_bf16 v[28:31], v[20:23], v[176:183], v0
ds_read_b128 v[44:47], v2 offset:11264
v_smfmac_f32_16x16x64_bf16 v[32:35], v[20:23], v[184:191], v0
s_waitcnt lgkmcnt(3)
v_smfmac_f32_16x16x64_bf16 v[36:39], v[20:23], v[48:55], v0
ds_read_b128 v[20:23], v3 offset:11776
v_smfmac_f32_16x16x64_bf16 v[24:27], v[12:15], v[192:199], v0
ds_read_b128 v[48:51], v2 offset:12288
v_smfmac_f32_16x16x64_bf16 v[28:31], v[12:15], v[200:207], v0
ds_read_b128 v[52:55], v2 offset:13312
v_smfmac_f32_16x16x64_bf16 v[32:35], v[12:15], v[208:215], v0
s_waitcnt lgkmcnt(3)
v_smfmac_f32_16x16x64_bf16 v[36:39], v[12:15], v[40:47], v0
ds_read_b128 v[12:15], v3 offset:3584
v_smfmac_f32_16x16x64_bf16 v[24:27], v[16:19], v[216:223], v0
ds_read_b128 v[40:43], v2 offset:16384
v_smfmac_f32_16x16x64_bf16 v[28:31], v[16:19], v[224:231], v0
ds_read_b128 v[44:47], v2 offset:17408
v_smfmac_f32_16x16x64_bf16 v[32:35], v[16:19], v[232:239], v0
s_waitcnt lgkmcnt(3)
v_smfmac_f32_16x16x64_bf16 v[36:39], v[16:19], v[48:55], v0
ds_read_b128 v[16:19], v3 offset:4608
v_smfmac_f32_16x16x64_bf16 v[24:27], v[20:23], a[8:15], v0
ds_read_b128 v[52:55], v3 offset:18944
v_smfmac_f32_16x16x64_bf16 v[28:31], v[20:23], a[16:23], v0
ds_read_b128 v[48:51], v3 offset:16896
v_smfmac_f32_16x16x64_bf16 v[32:35], v[20:23], a[24:31], v0
s_waitcnt lgkmcnt(3)
v_smfmac_f32_16x16x64_bf16 v[36:39], v[20:23], v[40:47], v0
ds_read_b128 v[20:23], v3 offset:5632
s_nop 0
v_add_f32 v24, v24, v25
v_smfmac_f32_16x16x64_bf16 v[56:59], v[12:15], a[32:39], v0
ds_read_b128 v[40:43], v3 offset:12800
v_add_f32 v26, v26, v27
v_add_f32 v28, v28, v29
v_add_f32 v30, v30, v31
v_mul_f32 v24, s18, v24
v_smfmac_f32_16x16x64_bf16 v[60:63], v[12:15], a[40:47], v0
ds_read_b128 v[12:15], v3 offset:7680
v_mul_f32 v28, s18, v28
v_mul_f32 v26, s18, v26
v_mul_f32 v30, s18, v30
v_cvt_pk_bf16_f32 v24, v24, v28
s_waitcnt lgkmcnt(5)
v_smfmac_f32_16x16x64_bf16 v[56:59], v[16:19], a[48:55], v0
ds_read_b128 v[44:47], v3 offset:14848
v_cvt_pk_bf16_f32 v26, v26, v30
ds_write2_b32 v1, v24, v26 offset1:32
v_add_f32 v32, v32, v33
v_add_f32 v34, v34, v35
v_smfmac_f32_16x16x64_bf16 v[60:63], v[16:19], a[56:63], v0
ds_read_b128 v[16:19], v3 offset:8704
v_add_f32 v36, v36, v37
v_add_f32 v38, v38, v39
v_cvt_pk_bf16_f32 v1, v32, v36
v_cvt_pk_bf16_f32 v8, v34, v38
s_waitcnt lgkmcnt(5)
v_smfmac_f32_16x16x64_bf16 v[56:59], v[20:23], a[64:71], v0
ds_write2_b32 v4, v1, v8 offset1:32
v_smfmac_f32_16x16x64_bf16 v[60:63], v[20:23], a[72:79], v0
s_waitcnt lgkmcnt(4)
ds_read_b128 v[20:23], v3 offset:9728
v_smfmac_f32_16x16x64_bf16 v[56:59], v[12:15], a[96:103], v0
v_smfmac_f32_16x16x64_bf16 v[60:63], v[12:15], a[104:111], v0
s_waitcnt lgkmcnt(2)
ds_read_b128 v[12:15], v3 offset:11776
v_smfmac_f32_16x16x64_bf16 v[56:59], v[16:19], a[112:119], v0
v_smfmac_f32_16x16x64_bf16 v[60:63], v[16:19], a[120:127], v0
s_waitcnt lgkmcnt(2)
s_barrier
ds_read_b128 v[36:39], v5 offset:1536
s_waitcnt lgkmcnt(2)
v_smfmac_f32_16x16x64_bf16 v[56:59], v[20:23], a[128:135], v0
ds_read_b128 v[24:27], v5
v_smfmac_f32_16x16x64_bf16 v[60:63], v[20:23], a[136:143], v0
s_waitcnt lgkmcnt(2)
ds_read_b128 v[28:31], v5 offset:512
v_smfmac_f32_16x16x64_bf16 v[56:59], v[12:15], a[160:167], v0
ds_read_b128 v[32:35], v5 offset:1024
v_smfmac_f32_16x16x64_bf16 v[60:63], v[12:15], a[168:175], v0
s_waitcnt lgkmcnt(3)
v_mfma_f32_16x16x32_bf16 v[16:19], v[52:55], v[36:39], 0
s_waitcnt lgkmcnt(2)
ds_read_b128 v[52:55], v3 offset:19968
v_mfma_f32_16x16x32_bf16 v[16:19], v[40:43], v[24:27], v[16:19]
s_waitcnt lgkmcnt(2)
ds_read_b128 v[40:43], v3 offset:13824
v_mfma_f32_16x16x32_bf16 v[16:19], v[44:47], v[28:31], v[16:19]
s_waitcnt lgkmcnt(2)
ds_read_b128 v[44:47], v3 offset:15872
v_add_f32 v56, v56, v57
v_mfma_f32_16x16x32_bf16 v[16:19], v[48:51], v[32:35], v[16:19]
ds_read_b128 v[48:51], v3 offset:17920
v_add_f32 v58, v58, v59
v_mfma_f32_16x16x32_bf16 v[20:23], v[36:39], v[36:39], 0
s_add_u32 s49, s28, s23
v_add_f32 v60, v60, v61
v_add_f32 v62, v62, v63
v_mfma_f32_16x16x32_bf16 v[20:23], v[24:27], v[24:27], v[20:23]
s_add_u32 s50, s28, 65536
v_cvt_pk_bf16_f32 v56, v56, v58
v_cvt_pk_bf16_f32 v57, v60, v62
v_mfma_f32_16x16x32_bf16 v[20:23], v[28:31], v[28:31], v[20:23]
s_add_u32 s51, s28, 131072
v_mov_b32 v58, v1
v_mov_b32 v59, v8
v_exp_f32 v16, v16
v_mfma_f32_16x16x32_bf16 v[20:23], v[32:35], v[32:35], v[20:23]
s_waitcnt lgkmcnt(3)
v_exp_f32 v17, v17
v_mfma_f32_16x16x32_bf16 v[12:15], v[52:55], v[36:39], 0
s_waitcnt lgkmcnt(2)
v_exp_f32 v18, v18
v_mfma_f32_16x16x32_bf16 v[12:15], v[40:43], v[24:27], v[12:15]
s_waitcnt lgkmcnt(1)
v_exp_f32 v19, v19
buffer_store_dwordx4 v[56:59], v3, s[8:11], s31 offen sc1
v_mfma_f32_16x16x32_bf16 v[12:15], v[44:47], v[28:31], v[12:15]
s_waitcnt lgkmcnt(0)
v_exp_f32 v20, v20
v_mfma_f32_16x16x32_bf16 v[12:15], v[48:51], v[32:35], v[12:15]
s_add_u32 s52, s28, 196608
v_exp_f32 v21, v21
v_mov_b64 v[60:61], s[14:15]
v_cvt_pk_bf16_f32 v23, v20, v21
v_cvt_pk_bf16_f32 v20, v20, v21
v_mov_b32 v21, 0
v_mov_b32 v22, 0
v_cvt_pk_bf16_f32 v16, v16, v17
v_cvt_pk_bf16_f32 v17, v18, v19
v_mfma_f32_16x16x16_bf16 v[24:27], v[56:57], v[20:21], 0
v_exp_f32 v12, v12
v_mfma_f32_16x16x16_bf16 v[28:31], v[56:57], v[22:23], 0
v_exp_f32 v13, v13
v_mfma_f32_16x16x16_bf16 v[32:35], v[60:61], v[20:21], 0
v_exp_f32 v14, v14
v_exp_f32 v15, v15
v_mov_b64 v[62:63], s[14:15]
v_cvt_pk_bf16_f32 v18, v12, v13
v_cvt_pk_bf16_f32 v19, v14, v15
s_waitcnt vmcnt(3)
ds_read_b128 v[40:43], v2 offset:18432
v_mfma_f32_16x16x32_bf16 v[32:35], v[60:63], v[16:19], v[32:35]
ds_read_b128 v[44:47], v2 offset:19456
v_mov_b32 v20, 0
v_mfma_f32_16x16x32_bf16 v[24:27], v[64:67], v[16:19], v[24:27]
ds_read_b128 v[48:51], v2 offset:20480
v_mov_b32 v23, 0
v_mfma_f32_16x16x32_bf16 v[28:31], v[68:71], v[16:19], v[28:31]
ds_read_b128 v[52:55], v2 offset:21504
v_mov_b32 v15, 0
v_rcp_f32 v12, v32
v_subrev_u32 v14, 0x21800000, v32
v_cmp_le_u32 vcc, 0x3c000000, v14
v_pk_mul_f32 v[24:25], v[24:25], v[12:13] op_sel_hi:[1,0]
v_pk_mul_f32 v[26:27], v[26:27], v[12:13] op_sel_hi:[1,0]
ds_read_b128 v[32:35], v2 offset:22528
v_pk_mul_f32 v[28:29], v[28:29], v[12:13] op_sel_hi:[1,0]
v_pk_mul_f32 v[30:31], v[30:31], v[12:13] op_sel_hi:[1,0]
v_cvt_pk_bf16_f32 v24, v24, v28
v_cvt_pk_bf16_f32 v25, v25, v29
v_cvt_pk_bf16_f32 v26, v26, v30
v_cvt_pk_bf16_f32 v27, v27, v31
v_mfma_f32_16x16x32_bf16 v[16:19], v[20:23], v[20:23], 0
ds_write_b128 v7, v[24:27]
v_mfma_f32_16x16x32_bf16 v[12:15], v[20:23], v[20:23], 0
s_andn2_b64 vcc, vcc, s[86:87]
ds_read_b128 v[36:39], v2 offset:23552
s_cbranch_scc1 L_sm3
L_smr3:
v_mfma_f32_16x16x32_bf16 v[56:59], v[20:23], v[20:23], 0
v_mov_b32 v1, 6528
v_and_b32 v8, 0x380, v3
s_add_u32 s20, s30, 527360
v_add_u32 v8, v8, v3
s_mov_b32 m0, 22016
s_cmp_eq_u32 s19, 63
s_cbranch_scc1 L_texit
s_waitcnt lgkmcnt(0)
s_barrier
ds_read_b128 v[24:27], v3 offset:1152
v_mfma_f32_16x16x32_bf16 v[64:67], v[20:23], v[20:23], 0
ds_read_b128 v[28:31], v3 offset:2176
v_mfma_f32_16x16x32_bf16 v[60:63], v[20:23], v[20:23], 0
v_mfma_f32_16x16x32_bf16 v[68:71], v[20:23], v[20:23], 0
s_waitcnt lgkmcnt(1)
v_smfmac_f32_16x16x64_bf16 v[12:15], v[24:27], a[248:255], v0
buffer_load_dwordx4 v8, s[8:11], s20 offen sc1 lds
v_smfmac_f32_16x16x64_bf16 v[16:19], v[24:27], a[176:183], v0
s_mov_b32 m0, 22912
s_waitcnt lgkmcnt(0)
v_smfmac_f32_16x16x64_bf16 v[12:15], v[28:31], v[40:47], v0
ds_read_b128 v[40:43], v2 offset:24576
v_smfmac_f32_16x16x64_bf16 v[16:19], v[28:31], v[48:55], v0
ds_read_b128 v[44:47], v2 offset:25600
buffer_load_dwordx4 v8, s[8:11], s20 offen offset:128 sc1 lds
v_smfmac_f32_16x16x64_bf16 v[20:23], v[24:27], a[184:191], v0
ds_read_b128 v[48:51], v2 offset:26624
s_nop 1
v_add_f32 v12, v12, v13
v_add_f32 v14, v14, v15
v_cvt_pk_bf16_f32 v12, v12, v14
v_smfmac_f32_16x16x64_bf16 v[20:23], v[28:31], v[32:39], v0
ds_read_b128 v[52:55], v2 offset:27648
buffer_store_dword v12, v10, s[8:11], s28 offen
v_add_f32 v16, v16, v17
v_add_f32 v18, v18, v19
v_smfmac_f32_16x16x64_bf16 v[56:59], v[24:27], a[192:199], v0
s_waitcnt lgkmcnt(2)
ds_read_b128 v[32:35], v2 offset:28672
v_cvt_pk_bf16_f32 v16, v16, v18
v_smfmac_f32_16x16x64_bf16 v[56:59], v[28:31], v[40:47], v0
ds_read_b128 v[36:39], v2 offset:29696
v_add_f32 v20, v20, v21
v_add_f32 v22, v22, v23
v_cvt_pk_bf16_f32 v17, v20, v22
v_smfmac_f32_16x16x64_bf16 v[60:63], v[24:27], a[200:207], v0
s_waitcnt lgkmcnt(2)
ds_read_b128 v[12:15], v1
buffer_store_dwordx2 v[16:17], v9, s[8:11], s28 offen
v_smfmac_f32_16x16x64_bf16 v[60:63], v[28:31], v[48:55], v0
ds_read_b128 v[40:43], v2 offset:30720
v_add_f32 v56, v56, v57
v_add_f32 v58, v58, v59
v_cvt_pk_bf16_f32 v56, v56, v58
v_smfmac_f32_16x16x64_bf16 v[64:67], v[24:27], a[208:215], v0
s_waitcnt lgkmcnt(2)
ds_read_b128 v[44:47], v2 offset:31744
v_smfmac_f32_16x16x64_bf16 v[64:67], v[28:31], v[32:39], v0
ds_read_b128 v[20:23], v1
v_add_f32 v60, v60, v61
v_add_f32 v62, v62, v63
v_cvt_pk_bf16_f32 v57, v60, v62
v_smfmac_f32_16x16x64_bf16 v[68:71], v[24:27], a[216:223], v0
s_waitcnt lgkmcnt(1)
ds_read_b128 v[48:51], v2 offset:32768
buffer_store_dwordx2 v[56:57], v9, s[8:11], s50 offen
v_smfmac_f32_16x16x64_bf16 v[68:71], v[28:31], v[40:47], v0
ds_read_b128 v[52:55], v2 offset:33792
v_add_f32 v64, v64, v65
v_add_f32 v66, v66, v67
v_cvt_pk_bf16_f32 v64, v64, v66
v_smfmac_f32_16x16x64_bf16 v[12:15], v[24:27], a[224:231], v0
s_waitcnt lgkmcnt(0)
v_smfmac_f32_16x16x64_bf16 v[12:15], v[28:31], v[48:55], v0
s_nop 0
v_add_f32 v68, v68, v69
v_add_f32 v70, v70, v71
v_cvt_pk_bf16_f32 v65, v68, v70
v_smfmac_f32_16x16x64_bf16 v[20:23], v[24:27], a[232:239], v0
buffer_store_dwordx2 v[64:65], v9, s[8:11], s51 offen
v_smfmac_f32_16x16x64_bf16 v[20:23], v[28:31], a[240:247], v0
s_nop 0
v_add_f32 v12, v12, v13
v_add_f32 v14, v14, v15
v_cvt_pk_bf16_f32 v12, v12, v14
s_nop 3
v_add_f32 v20, v20, v21
v_add_f32 v22, v22, v23
v_cvt_pk_bf16_f32 v13, v20, v22
buffer_store_dwordx2 v[12:13], v9, s[8:11], s52 offen
s_add_u32 s19, s19, 1
s_mov_b32 s20, s28
s_mov_b32 s28, s29
s_mov_b32 s29, s20
s_and_b32 s20, s19, 3
s_lshl_b32 s20, s20, 14
s_add_u32 s33, s20, 110100480
s_add_u32 s34, s20, s24
s_xor_b32 s20, s20, 32768
s_add_u32 s35, s20, s24
s_add_u32 s30, s30, 524288
s_add_u32 s31, s31, 131072
s_add_u32 s6, s33, 4096
s_add_u32 s7, s33, 8192
s_mov_b32 s22, 0
v_mov_b64 v[24:25], 0
v_mov_b64 v[26:27], 0
v_mov_b64 v[28:29], 0
v_mov_b64 v[30:31], 0
v_and_b32 v70, 0xf40, v3
v_add_u32 v70, v70, v3
v_bfe_u32 v71, v3, 7, 1
v_mad_i32_i24 v70, v71, s4, v70
v_mov_b64 v[64:65], -1
v_mov_b64 v[66:67], -1
v_add_u32 v1, 2112, v4
ds_read_b128 v[48:51], v2 offset:14336
ds_read_b128 v[52:55], v2 offset:15360
v_lshrrev_b32 v8, 2, v3
s_add_u32 s20, s19, 1
s_lshr_b32 s20, s20, 3
s_min_u32 s20, s20, 7
s_cmp_lt_u32 s19, 3
s_cselect_b32 s20, 8, s20
s_waitcnt vmcnt(8)
L_kvw:
v_readlane_b32 s21, v11, s20
s_nop 0
s_cmp_eq_u32 s21, 1
s_cbranch_scc0 L_kvp
s_barrier
s_branch L_gat3
L_g3r3:
buffer_load_dwordx4 v[16:19], v3, s[8:11], s6 offen sc1
s_add_u32 s22, s22, 1
s_waitcnt vmcnt(1)
v_max3_u32 v21, v16, v17, v18
v_max_u32 v21, v21, v19
v_cmp_le_u32 vcc, 0xffff0000, v21
s_cmp_gt_u32 s22, 200000
s_cbranch_vccz L_g33
s_cbranch_scc0 L_g3r3
s_branch L_end
L_sm3:
s_waitcnt lgkmcnt(0)
ds_read_b128 v[24:27], v5
ds_read_b128 v[40:43], v3 offset:12800
ds_read_b128 v[28:31], v5 offset:512
ds_read_b128 v[44:47], v3 offset:14848
ds_read_b128 v[32:35], v5 offset:1024
ds_read_b128 v[48:51], v3 offset:16896
ds_read_b128 v[36:39], v5 offset:1536
ds_read_b128 v[52:55], v3 offset:18944
s_waitcnt lgkmcnt(0)
v_mfma_f32_16x16x32_bf16 v[16:19], v[40:43], v[24:27], 0
ds_read_b128 v[40:43], v3 offset:13824
v_mfma_f32_16x16x32_bf16 v[16:19], v[44:47], v[28:31], v[16:19]
ds_read_b128 v[44:47], v3 offset:15872
v_mfma_f32_16x16x32_bf16 v[16:19], v[48:51], v[32:35], v[16:19]
ds_read_b128 v[48:51], v3 offset:17920
v_mfma_f32_16x16x32_bf16 v[16:19], v[52:55], v[36:39], v[16:19]
ds_read_b128 v[52:55], v3 offset:19968
v_mfma_f32_16x16x32_bf16 v[20:23], v[24:27], v[24:27], 0
v_mfma_f32_16x16x32_bf16 v[20:23], v[28:31], v[28:31], v[20:23]
v_mfma_f32_16x16x32_bf16 v[20:23], v[32:35], v[32:35], v[20:23]
v_mfma_f32_16x16x32_bf16 v[20:23], v[36:39], v[36:39], v[20:23]
s_waitcnt lgkmcnt(0)
v_mfma_f32_16x16x32_bf16 v[12:15], v[40:43], v[24:27], 0
v_mfma_f32_16x16x32_bf16 v[12:15], v[44:47], v[28:31], v[12:15]
v_mfma_f32_16x16x32_bf16 v[12:15], v[48:51], v[32:35], v[12:15]
v_mfma_f32_16x16x32_bf16 v[12:15], v[52:55], v[36:39], v[12:15]
v_max3_f32 v59, v16, v17, v18
s_nop 1
v_max3_f32 v59, v59, v19, v20
s_nop 3
v_max3_f32 v59, v59, v21, v12
v_max3_f32 v59, v59, v13, v14
v_max_f32 v59, v59, v15
v_mov_b32 v22, v59
s_nop 1
v_permlane32_swap_b32 v22, v59
v_max_f32 v59, v59, v22
v_mov_b32 v22, v59
s_nop 1
v_permlane16_swap_b32 v22, v59
v_max_f32 v59, v59, v22
v_sub_f32 v20, v20, v59
v_sub_f32 v21, v21, v59
v_sub_f32 v16, v16, v59
v_sub_f32 v17, v17, v59
v_sub_f32 v18, v18, v59
v_sub_f32 v19, v19, v59
v_sub_f32 v12, v12, v59
v_sub_f32 v13, v13, v59
v_sub_f32 v14, v14, v59
v_sub_f32 v15, v15, v59
v_exp_f32 v20, v20
v_exp_f32 v21, v21
v_exp_f32 v16, v16
v_exp_f32 v17, v17
v_exp_f32 v18, v18
v_exp_f32 v19, v19
v_exp_f32 v12, v12
v_exp_f32 v13, v13
v_exp_f32 v14, v14
v_exp_f32 v15, v15
v_cvt_pk_bf16_f32 v23, v20, v21
v_cvt_pk_bf16_f32 v20, v20, v21
v_mov_b32 v21, 0
v_mov_b32 v22, 0
v_cvt_pk_bf16_f32 v16, v16, v17
v_cvt_pk_bf16_f32 v17, v18, v19
v_cvt_pk_bf16_f32 v18, v12, v13
v_cvt_pk_bf16_f32 v19, v14, v15
v_mfma_f32_16x16x16_bf16 v[24:27], v[56:57], v[20:21], 0
v_mfma_f32_16x16x16_bf16 v[28:31], v[56:57], v[22:23], 0
v_mfma_f32_16x16x16_bf16 v[32:35], v[60:61], v[20:21], 0
ds_read_b128 v[40:43], v2 offset:18432
v_mfma_f32_16x16x32_bf16 v[32:35], v[60:63], v[16:19], v[32:35]
ds_read_b128 v[44:47], v2 offset:19456
v_mov_b32 v20, 0
v_mfma_f32_16x16x32_bf16 v[24:27], v[64:67], v[16:19], v[24:27]
ds_read_b128 v[48:51], v2 offset:20480
v_mov_b32 v23, 0
v_mfma_f32_16x16x32_bf16 v[28:31], v[68:71], v[16:19], v[28:31]
ds_read_b128 v[52:55], v2 offset:21504
v_mov_b32 v15, 0
v_rcp_f32 v12, v32
v_subrev_u32 v14, 0x21800000, v32
v_cmp_le_u32 vcc, 0x3c000000, v14
v_pk_mul_f32 v[24:25], v[24:25], v[12:13] op_sel_hi:[1,0]
v_pk_mul_f32 v[26:27], v[26:27], v[12:13] op_sel_hi:[1,0]
ds_read_b128 v[32:35], v2 offset:22528
v_pk_mul_f32 v[28:29], v[28:29], v[12:13] op_sel_hi:[1,0]
v_pk_mul_f32 v[30:31], v[30:31], v[12:13] op_sel_hi:[1,0]
v_cvt_pk_bf16_f32 v24, v24, v28
v_cvt_pk_bf16_f32 v25, v25, v29
v_cvt_pk_bf16_f32 v26, v26, v30
v_cvt_pk_bf16_f32 v27, v27, v31
v_mfma_f32_16x16x32_bf16 v[16:19], v[20:23], v[20:23], 0
ds_write_b128 v7, v[24:27]
v_mfma_f32_16x16x32_bf16 v[12:15], v[20:23], v[20:23], 0
ds_read_b128 v[36:39], v2 offset:23552
s_branch L_smr3
L_kvp:
buffer_load_dword v11, v8, s[8:11], s82 offen sc1
s_add_u32 s22, s22, 1
s_cmp_gt_u32 s22, 200000
s_cbranch_scc1 L_end
s_waitcnt vmcnt(0)
s_branch L_kvw
L_texit:
s_lshl_b32 s61, s16, 7
s_add_u32 s61, s61, 111153152
s_waitcnt vmcnt(0)
s_barrier
s_cmp_lg_u32 s17, 0
s_cbranch_scc1 L_sf_63
v_mov_b32 v20, 0
v_mov_b32 v21, 64
s_mov_b64 exec, 1
buffer_store_dword v21, v20, s[8:11], s61 offen sc1
s_mov_b64 exec, -1
L_sf_63:
L_done:
L_end:
s_endpgm
.section .rodata,"a"
.p2align 6
.amdhsa_kernel concat_heads__compressed_kv_cla__memory_aug_recurrent_mem_tr__prompt_kernel
  .amdhsa_next_free_vgpr 512
  .amdhsa_next_free_sgpr 102
  .amdhsa_accum_offset 256
  .amdhsa_group_segment_fixed_size 0
  .amdhsa_kernarg_size 128
  .amdhsa_user_sgpr_count 2
  .amdhsa_user_sgpr_kernarg_segment_ptr 1
  .amdhsa_system_sgpr_workgroup_id_x 1
.end_amdhsa_kernel
```

```asm
; @launch grid=(256,1,1) block=(256,1,1) lds=163840
.amdgcn_target "amdgcn-amd-amdhsa--gfx950"
.text
.globl concat_heads__compressed_kv_cla__memory_aug_recurrent_mem_tr__prompt_kernel
.p2align 8
.type concat_heads__compressed_kv_cla__memory_aug_recurrent_mem_tr__prompt_kernel,@function
concat_heads__compressed_kv_cla__memory_aug_recurrent_mem_tr__prompt_kernel:
s_cmp_lt_u32 s2, 256
s_cbranch_scc1 L_go
L_end0:
s_endpgm
L_go:
s_getreg_b32 s3, hwreg(HW_REG_XCC_ID)
s_and_b32 s3, s3, 7
s_load_dwordx2 s[4:5], s[0:1], 120
s_load_dwordx2 s[6:7], s[0:1], 112
v_lshrrev_b32 v1, 6, v0
s_nop 0
v_readfirstlane_b32 s17, v1
s_waitcnt lgkmcnt(0)
s_mov_b32 s8, s4
s_and_b32 s9, s5, 0xffff
s_mov_b32 s10, 268435456
s_mov_b32 s11, 0x20000
s_mov_b32 s56, s6
s_and_b32 s57, s7, 0xffff
s_mov_b32 s58, 256
s_mov_b32 s59, 0x20000
s_lshl_b32 s24, s3, 2
s_cmp_eq_u32 s17, 0
s_cbranch_scc0 L_tk
v_lshlrev_b32 v3, 12, v0
s_mov_b64 exec, 1
v_mov_b32 v1, 1
v_mov_b32 v2, 0
buffer_atomic_add v1, v2, s[56:59], s24 offen sc0
s_mov_b64 exec, -1
s_getpc_b64 s[4:5]
L_pc:
s_mov_b32 s12, s4
s_and_b32 s13, s5, 0xffff
s_mov_b32 s14, L_end-L_pc
s_mov_b32 s15, 0x20000
s_lshr_b32 s25, s2, 3
s_lshl_b32 s25, s25, 7
buffer_load_dword a255, v3, s[12:15], s25 offen
s_mov_b64 exec, 1
s_waitcnt vmcnt(1)
ds_write_b32 v2, v1
s_waitcnt lgkmcnt(0)
s_mov_b64 exec, -1
L_tk:
s_barrier
v_mov_b32 v2, 0
ds_read_b32 v1, v2
s_lshr_b32 s3, 0x76530142, s24
s_and_b32 s3, s3, 7
s_waitcnt lgkmcnt(0)
v_readfirstlane_b32 s16, v1
s_barrier
s_cmp_ge_u32 s16, 32
s_cbranch_scc1 L_end0
s_cmp_eq_u32 s3, 0
s_cbranch_scc1 L_team
s_cmp_eq_u32 s3, 1
s_cbranch_scc0 L_np
s_cmp_lt_u32 s16, 24
s_cbranch_scc1 L_np
v_lshlrev_b32 v1, 4, v0
v_mov_b64 v[4:5], 0
v_mov_b64 v[6:7], 0
s_sub_u32 s24, s16, 24
s_lshl_b32 s24, s24, 12
s_add_u32 s24, s24, 111149056
buffer_store_dwordx4 v[4:7], v1, s[8:11], s24 offen sc1
s_waitcnt vmcnt(0)
s_barrier
s_cmp_lg_u32 s17, 0
s_cbranch_scc1 L_np
v_mov_b32 v1, 1
v_mov_b32 v2, 128
s_mov_b64 exec, 1
buffer_atomic_add v1, v2, s[56:59], 0 offen
s_mov_b64 exec, -1
L_np:
s_cmp_lt_u32 s3, 4
s_cselect_b32 s61, 1, 0
s_cbranch_scc1 L_pb
s_load_dwordx2 s[52:53], s[0:1], 8
s_load_dwordx2 s[54:55], s[0:1], 0
s_load_dwordx2 s[6:7], s[0:1], 24
s_load_dwordx2 s[4:5], s[0:1], 32
s_load_dwordx2 s[18:19], s[0:1], 16
s_mov_b32 s45, 3
s_sub_u32 s24, s3, 4
s_lshl_b32 s24, s24, 5
s_add_u32 s24, s24, s16
s_lshr_b32 s89, s24, 2
s_lshr_b32 s90, s24, 3
s_and_b32 s24, s16, 3
s_mul_i32 s88, s24, 0x11
s_and_b32 s24, s16, 7
s_bitcmp1_b32 s16, 2
s_cselect_b32 s25, 3, 0
s_xor_b32 s24, s24, s25
s_lshl_b32 s24, s24, 8
s_add_u32 s88, s88, s24
s_add_u32 s88, s88, 0x840
s_branch L_pg
L_pb:
s_load_dwordx2 s[52:53], s[0:1], 48
s_load_dwordx2 s[54:55], s[0:1], 48
s_load_dwordx2 s[6:7], s[0:1], 72
s_load_dwordx2 s[4:5], s[0:1], 80
s_load_dwordx2 s[18:19], s[0:1], 64
s_mov_b32 s45, 6
s_sub_u32 s24, s3, 2
s_lshl_b32 s24, s24, 5
s_add_u32 s24, s24, s16
s_lshr_b32 s89, s24, 1
s_lshr_b32 s90, s24, 2
s_mov_b32 s88, 0xe6a431
s_mov_b32 s25, 0xe6c431
s_bitcmp1_b32 s16, 0
s_cselect_b32 s88, 0xf7b582, s88
s_cselect_b32 s25, 0xf7d592, s25
s_bitcmp1_b32 s16, 1
s_cselect_b32 s88, s25, s88
s_cselect_b32 s45, 5, 6
s_add_u32 s45, s3, 3
s_cmp_eq_u32 s3, 1
s_cselect_b32 s45, 1, s45
s_cselect_b32 s88, 0, s88
s_cselect_b32 s89, s16, s89
L_pg:
s_waitcnt lgkmcnt(0)
s_cmp_ge_u32 s17, 2
s_cselect_b64 s[6:7], s[4:5], s[6:7]
s_cmp_eq_u32 s61, 0
s_cselect_b32 s24, 4, 1
s_mov_b32 s14, 884736
s_cselect_b32 s14, 1048576, s14
s_sub_u32 s24, s3, s24
s_lshl_b32 s24, s24, 5
s_add_u32 s24, s24, s16
s_lshl_b32 s24, s24, 13
s_mov_b32 s12, s52
s_and_b32 s13, s53, 0xffff
s_mov_b32 s15, 0x20000
v_lshlrev_b32 v15, 5, v0
buffer_load_dword v15, v15, s[12:15], s24 offen
s_sub_u32 s24, 7, s3
s_mul_i32 s25, s16, 6
s_add_u32 s24, s24, s25
s_cmp_ge_u32 s24, 36
s_cbranch_scc1 L_pf_1
s_load_dwordx2 s[4:5], s[0:1], 88
s_sub_u32 s25, s24, 0
s_mul_i32 s25, s25, 131072
s_add_u32 s25, s25, 0
s_min_u32 s25, s25, 4718592
s_sub_u32 s98, 4718592, s25
s_mov_b32 s100, 0x0
s_branch L_pfd
L_pf_1:
s_cmp_ge_u32 s24, 72
s_cbranch_scc1 L_pf_2
s_load_dwordx2 s[4:5], s[0:1], 64
s_sub_u32 s25, s24, 36
s_mul_i32 s25, s25, 131072
s_add_u32 s25, s25, 0
s_min_u32 s25, s25, 4718592
s_sub_u32 s98, 4718592, s25
s_mov_b32 s100, 0x0
s_branch L_pfd
L_pf_2:
s_cmp_ge_u32 s24, 80
s_cbranch_scc1 L_pf_3
s_load_dwordx2 s[4:5], s[0:1], 8
s_sub_u32 s25, s24, 72
s_mul_i32 s25, s25, 131072
s_add_u32 s25, s25, 1048576
s_min_u32 s25, s25, 2097152
s_sub_u32 s98, 2097152, s25
s_mov_b32 s100, 0xfffe0000
s_branch L_pfd
L_pf_3:
s_cmp_ge_u32 s24, 92
s_cbranch_scc1 L_pf_4
s_load_dwordx2 s[4:5], s[0:1], 48
s_sub_u32 s25, s24, 80
s_mul_i32 s25, s25, 131072
s_add_u32 s25, s25, 786432
s_min_u32 s25, s25, 2359296
s_sub_u32 s98, 2359296, s25
s_mov_b32 s100, 0xfffe0000
s_branch L_pfd
L_pf_4:
s_cmp_ge_u32 s24, 110
s_cbranch_scc1 L_pf_5
s_load_dwordx2 s[4:5], s[0:1], 0
s_sub_u32 s25, s24, 92
s_mul_i32 s25, s25, 131072
s_add_u32 s25, s25, 0
s_min_u32 s25, s25, 2359296
s_sub_u32 s98, 2359296, s25
s_mov_b32 s100, 0xfffe0000
s_branch L_pfd
L_pf_5:
s_cmp_ge_u32 s24, 146
s_cbranch_scc1 L_pf_6
s_load_dwordx2 s[4:5], s[0:1], 16
s_sub_u32 s25, s24, 110
s_mul_i32 s25, s25, 131072
s_add_u32 s25, s25, 0
s_min_u32 s25, s25, 4718592
s_sub_u32 s98, 4718592, s25
s_mov_b32 s100, 0xfffe0000
s_branch L_pfd
L_pf_6:
s_load_dwordx2 s[4:5], s[0:1], 40
s_sub_u32 s25, s24, 146
s_mul_i32 s25, s25, 131072
s_add_u32 s25, s25, 0
s_min_u32 s25, s25, 4718592
s_sub_u32 s98, 4718592, s25
s_mov_b32 s100, 0xfffe0000
s_branch L_pfd
L_pf_7:
L_pfd:
s_min_u32 s98, s98, 131072
s_waitcnt lgkmcnt(0)
s_add_u32 s96, s4, s25
s_addc_u32 s5, s5, 0
s_and_b32 s97, s5, 0xffff
s_mov_b32 s99, 0x20000
s_cmp_eq_u32 s3, 1
s_cselect_b32 s100, 536870912, s100
v_lshlrev_b32 v14, 6, v0
s_cmp_eq_u32 s3, 1
s_cselect_b32 s91, 1, 0
s_andn2_b32 s95, s61, s16
v_bfe_u32 v16, v0, 4, 3
v_bfe_u32 v17, v0, 7, 1
v_lshlrev_b32 v17, 2, v17
v_xor_b32 v16, v16, v17
v_and_b32 v17, 7, v0
v_xor_b32 v16, v16, v17
v_lshlrev_b32 v1, 4, v16
v_bfe_u32 v17, v0, 4, 2
v_lshlrev_b32 v16, 2, v17
v_and_b32 v18, 15, v0
v_xor_b32 v16, v16, v18
v_bfe_u32 v18, v0, 6, 1
v_xor_b32 v16, v16, v18
v_lshlrev_b32 v16, 4, v16
v_lshl_add_u32 v16, v17, 13, v16
v_lshl_add_u32 v2, v18, 16, v16
s_and_b32 s24, s17, 1
s_lshr_b32 s25, s17, 1
s_lshl_b32 s25, s25, 13
s_lshl_b32 s33, s24, 11
s_add_u32 s33, s33, s25
s_lshl_b32 s32, s17, 10
s_add_u32 s32, s32, 65536
v_bfe_u32 v16, v0, 3, 1
v_lshlrev_b32 v16, 11, v16
v_and_b32 v18, 7, v0
v_lshl_add_u32 v16, v18, 7, v16
v_bfe_u32 v18, v0, 1, 3
v_xor_b32 v18, v18, v17
v_lshl_add_u32 v16, v18, 4, v16
s_lshl_b32 s24, s24, 14
s_add_u32 s24, s24, 65536
v_add_u32 v3, s24, v16
v_xor_b32 v4, 64, v3
v_bfe_u32 v18, v0, 2, 2
v_mul_u32_u24 v16, 320, v18
v_lshl_add_u32 v16, v17, 11, v16
v_bfe_u32 v18, v0, 1, 1
v_lshl_add_u32 v16, v18, 5, v16
v_bfe_u32 v18, v0, 4, 1
v_lshl_add_u32 v16, v18, 4, v16
v_and_b32 v18, 1, v0
v_lshl_add_u32 v16, v18, 3, v16
v_add_u32 v5, s25, v16
v_xor_b32 v6, 16, v5
v_xor_b32 v7, 64, v5
v_xor_b32 v8, 80, v5
v_xor_b32 v9, 128, v5
v_xor_b32 v10, 144, v5
v_xor_b32 v11, 192, v5
v_xor_b32 v12, 208, v5
s_mov_b32 s35, 0
s_lshr_b32 s24, s16, 1
s_cmp_eq_u32 s35, 5
s_cselect_b32 s90, s24, s90
s_lshl_b32 s24, s35, 2
s_lshr_b32 s26, s88, s24
s_bfe_u32 s2, s26, 0x10003
s_and_b32 s26, s26, 7
s_or_b32 s40, s2, s61
s_lshr_b32 s24, s17, 1
s_cmp_eq_u32 s2, 0
s_cselect_b32 s41, s24, 0
s_cselect_b32 s27, s89, s90
s_sub_u32 s25, s24, s41
s_and_b32 s51, s41, s61
s_lshl_b32 s51, s51, 1
s_or_b32 s51, s51, s41
s_lshl2_add_u32 s51, s2, s51
s_lshl_b32 s46, s27, s2
s_add_u32 s46, s46, s25
s_lshl_b32 s46, s46, 8
s_lshl_b32 s47, s40, 7
s_add_u32 s47, s47, 1024
s_mul_i32 s101, s26, s47
s_lshl_b32 s101, s101, 8
s_and_b32 s25, s17, 1
s_lshl1_add_u32 s42, s26, s25
s_lshl_b32 s42, s42, 7
s_lshr_b32 s42, s42, s2
s_add_u32 s42, s42, s27
s_lshl1_add_u32 s42, s42, s24
s_lshl_b32 s42, s42, 13
s_lshl_b32 s43, s27, 5
s_add_u32 s43, s43, s26
s_lshl_b32 s43, s43, 2
s_lshl_b32 s24, s2, 1
s_add_u32 s24, s24, s61
s_lshl_b32 s24, s24, 2
s_lshr_b32 s25, 0x8720, s24
s_and_b32 s25, s25, 15
s_lshl_b32 s25, s25, 24
s_add_u32 s42, s42, s25
s_lshr_b32 s25, 0x7604, s24
s_and_b32 s25, s25, 15
s_lshl_b32 s25, s25, 12
s_add_u32 s43, s43, s25
s_add_u32 s43, s43, 111149056
s_cmp_lt_u32 s35, s45
s_cselect_b32 s101, s101, 536870912
s_cselect_b32 s46, s46, 536870912
s_cmp_eq_u32 s2, 0
s_cselect_b64 s[4:5], s[52:53], s[54:55]
s_mov_b32 s12, s4
s_and_b32 s13, s5, 0xffff
s_lshl_b32 s14, s47, 11
s_mov_b32 s15, 0x20000
s_mov_b32 s30, s101
v_lshrrev_b32 v16, 3, v0
v_mul_lo_u32 v16, v16, s47
v_and_b32 v1, 0x70, v1
v_add_u32 v1, v1, v16
s_lshl_b32 s34, s47, 5
s_cmp_eq_u32 s2, 0
s_cselect_b64 s[4:5], s[6:7], s[18:19]
s_mov_b32 s20, s4
s_and_b32 s21, s5, 0xffff
s_lshl_b32 s22, s47, 12
s_mov_b32 s23, 0x20000
s_mov_b32 s31, s46
s_mov_b32 s48, s30
s_add_u32 m0, s32, 0
s_nop 0
buffer_load_dwordx4 v1, s[12:15], s48 offen lds
s_add_u32 s48, s48, s34
s_add_u32 m0, s32, 4096
s_nop 0
buffer_load_dwordx4 v1, s[12:15], s48 offen lds
s_add_u32 s48, s48, s34
s_add_u32 m0, s32, 8192
s_nop 0
buffer_load_dwordx4 v1, s[12:15], s48 offen lds
s_add_u32 s48, s48, s34
s_add_u32 m0, s32, 12288
s_nop 0
buffer_load_dwordx4 v1, s[12:15], s48 offen lds
s_add_u32 s48, s48, s34
s_add_u32 m0, s32, 16384
s_nop 0
buffer_load_dwordx4 v1, s[12:15], s48 offen lds
s_add_u32 s48, s48, s34
s_add_u32 m0, s32, 20480
s_nop 0
buffer_load_dwordx4 v1, s[12:15], s48 offen lds
s_add_u32 s48, s48, s34
s_add_u32 m0, s32, 24576
s_nop 0
buffer_load_dwordx4 v1, s[12:15], s48 offen lds
s_add_u32 s48, s48, s34
s_add_u32 m0, s32, 28672
s_nop 0
buffer_load_dwordx4 v1, s[12:15], s48 offen lds
s_add_u32 s30, s30, 128
s_add_u32 s32, s32, 32768
s_sub_u32 s48, s32, 98304
s_cmp_ge_u32 s32, 163840
s_cselect_b32 s32, s48, s32
s_add_u32 s37, s31, 0
s_add_u32 m0, s33, 0
s_nop 0
buffer_load_dwordx4 v2, s[20:23], s37 offen  lds
s_add_u32 s37, s31, 32768
s_add_u32 m0, s33, 1024
s_nop 0
buffer_load_dwordx4 v2, s[20:23], s37 offen  lds
s_add_u32 s37, s31, 131072
s_add_u32 m0, s33, 4096
s_nop 0
buffer_load_dwordx4 v2, s[20:23], s37 offen  lds
s_add_u32 s37, s31, 163840
s_add_u32 m0, s33, 5120
s_nop 0
buffer_load_dwordx4 v2, s[20:23], s37 offen  lds
s_add_u32 s31, s31, 262144
s_add_u32 s33, s33, 16384
s_and_b32 s33, s33, 65535
s_add_u32 s37, s31, 0
s_add_u32 m0, s33, 0
s_nop 0
buffer_load_dwordx4 v2, s[20:23], s37 offen  lds
s_add_u32 s37, s31, 32768
s_add_u32 m0, s33, 1024
s_nop 0
buffer_load_dwordx4 v2, s[20:23], s37 offen  lds
s_add_u32 s37, s31, 131072
s_add_u32 m0, s33, 4096
s_nop 0
buffer_load_dwordx4 v2, s[20:23], s37 offen  lds
s_add_u32 s37, s31, 163840
s_add_u32 m0, s33, 5120
s_nop 0
buffer_load_dwordx4 v2, s[20:23], s37 offen  lds
s_add_u32 s31, s31, 262144
s_add_u32 s33, s33, 16384
s_and_b32 s33, s33, 65535
s_mov_b32 s48, s30
s_add_u32 m0, s32, 0
s_nop 0
buffer_load_dwordx4 v1, s[12:15], s48 offen lds
s_add_u32 s48, s48, s34
s_add_u32 m0, s32, 4096
s_nop 0
buffer_load_dwordx4 v1, s[12:15], s48 offen lds
s_add_u32 s48, s48, s34
s_add_u32 m0, s32, 8192
s_nop 0
buffer_load_dwordx4 v1, s[12:15], s48 offen lds
s_add_u32 s48, s48, s34
s_add_u32 m0, s32, 12288
s_nop 0
buffer_load_dwordx4 v1, s[12:15], s48 offen lds
s_add_u32 s37, s31, 0
s_add_u32 m0, s33, 0
s_nop 0
buffer_load_dwordx4 v2, s[20:23], s37 offen  lds
s_add_u32 s37, s31, 32768
s_add_u32 m0, s33, 1024
s_nop 0
buffer_load_dwordx4 v2, s[20:23], s37 offen  lds
s_add_u32 s37, s31, 131072
s_add_u32 m0, s33, 4096
s_nop 0
buffer_load_dwordx4 v2, s[20:23], s37 offen  lds
s_add_u32 s37, s31, 163840
s_add_u32 m0, s33, 5120
s_nop 0
buffer_load_dwordx4 v2, s[20:23], s37 offen  lds
s_add_u32 s31, s31, 262144
s_add_u32 s33, s33, 16384
s_and_b32 s33, s33, 65535
s_add_u32 s48, s48, s34
s_add_u32 m0, s32, 16384
s_nop 0
buffer_load_dwordx4 v1, s[12:15], s48 offen lds
s_add_u32 s48, s48, s34
s_add_u32 m0, s32, 20480
s_nop 0
buffer_load_dwordx4 v1, s[12:15], s48 offen lds
s_add_u32 s48, s48, s34
s_add_u32 m0, s32, 24576
s_nop 0
buffer_load_dwordx4 v1, s[12:15], s48 offen lds
s_add_u32 s48, s48, s34
s_add_u32 m0, s32, 28672
s_nop 0
buffer_load_dwordx4 v1, s[12:15], s48 offen lds
s_add_u32 s30, s30, 128
s_add_u32 s32, s32, 32768
s_sub_u32 s48, s32, 98304
s_cmp_ge_u32 s32, 163840
s_cselect_b32 s32, s48, s32
s_add_u32 s37, s31, 0
s_add_u32 m0, s33, 0
s_nop 0
buffer_load_dwordx4 v2, s[20:23], s37 offen  lds
s_add_u32 s37, s31, 32768
s_add_u32 m0, s33, 1024
s_nop 0
buffer_load_dwordx4 v2, s[20:23], s37 offen  lds
s_add_u32 s37, s31, 131072
s_add_u32 m0, s33, 4096
s_nop 0
buffer_load_dwordx4 v2, s[20:23], s37 offen  lds
s_add_u32 s37, s31, 163840
s_add_u32 m0, s33, 5120
s_nop 0
buffer_load_dwordx4 v2, s[20:23], s37 offen  lds
s_add_u32 s31, s31, 262144
s_add_u32 s33, s33, 16384
s_and_b32 s33, s33, 65535
s_mov_b32 s48, s30
s_add_u32 m0, s32, 0
s_nop 0
buffer_load_dwordx4 v1, s[12:15], s48 offen lds
s_add_u32 s48, s48, s34
s_add_u32 m0, s32, 4096
s_nop 0
buffer_load_dwordx4 v1, s[12:15], s48 offen lds
s_add_u32 s48, s48, s34
s_add_u32 m0, s32, 8192
s_nop 0
buffer_load_dwordx4 v1, s[12:15], s48 offen lds
s_add_u32 s48, s48, s34
s_add_u32 m0, s32, 12288
s_nop 0
buffer_load_dwordx4 v1, s[12:15], s48 offen lds
s_mov_b32 s62, 536870912
s_mov_b32 s63, 536870912
s_mov_b32 s50, 0
s_waitcnt vmcnt(24)
s_barrier
s_cmp_eq_u32 s41, 0
s_cbranch_scc0 L_g_p1
ds_read_b64_tr_b16 a[160:161], v5 offset:0
ds_read_b64_tr_b16 a[162:163], v5 offset:1024
ds_read_b64_tr_b16 a[164:165], v6 offset:0
ds_read_b64_tr_b16 a[166:167], v6 offset:1024
ds_read_b64_tr_b16 a[168:169], v7 offset:0
ds_read_b64_tr_b16 a[170:171], v7 offset:1024
ds_read_b64_tr_b16 a[172:173], v8 offset:0
ds_read_b64_tr_b16 a[174:175], v8 offset:1024
ds_read_b64_tr_b16 a[176:177], v9 offset:0
ds_read_b64_tr_b16 a[178:179], v9 offset:1024
ds_read_b64_tr_b16 a[180:181], v10 offset:0
ds_read_b64_tr_b16 a[182:183], v10 offset:1024
ds_read_b64_tr_b16 a[184:185], v11 offset:0
ds_read_b64_tr_b16 a[186:187], v11 offset:1024
ds_read_b64_tr_b16 a[188:189], v12 offset:0
ds_read_b64_tr_b16 a[190:191], v12 offset:1024
ds_read_b128 a[192:195], v3 offset:0
ds_read_b128 a[196:199], v4 offset:1024
ds_read_b128 a[200:203], v3 offset:4096
ds_read_b128 a[204:207], v4 offset:5120
ds_read_b128 a[208:211], v3 offset:8192
ds_read_b128 a[212:215], v4 offset:9216
ds_read_b128 a[216:219], v3 offset:12288
ds_read_b128 a[220:223], v4 offset:13312
s_branch L_g_p2
L_g_p1:
ds_read_b128 a[160:163], v3 offset:0
ds_read_b128 a[164:167], v4 offset:1024
ds_read_b128 a[168:171], v3 offset:4096
ds_read_b128 a[172:175], v4 offset:5120
ds_read_b128 a[176:179], v3 offset:8192
ds_read_b128 a[180:183], v4 offset:9216
ds_read_b128 a[184:187], v3 offset:12288
ds_read_b128 a[188:191], v4 offset:13312
ds_read_b64_tr_b16 a[192:193], v5 offset:0
ds_read_b64_tr_b16 a[194:195], v5 offset:1024
ds_read_b64_tr_b16 a[196:197], v6 offset:0
ds_read_b64_tr_b16 a[198:199], v6 offset:1024
ds_read_b64_tr_b16 a[200:201], v7 offset:0
ds_read_b64_tr_b16 a[202:203], v7 offset:1024
ds_read_b64_tr_b16 a[204:205], v8 offset:0
ds_read_b64_tr_b16 a[206:207], v8 offset:1024
ds_read_b64_tr_b16 a[208:209], v9 offset:0
ds_read_b64_tr_b16 a[210:211], v9 offset:1024
ds_read_b64_tr_b16 a[212:213], v10 offset:0
ds_read_b64_tr_b16 a[214:215], v10 offset:1024
ds_read_b64_tr_b16 a[216:217], v11 offset:0
ds_read_b64_tr_b16 a[218:219], v11 offset:1024
ds_read_b64_tr_b16 a[220:221], v12 offset:0
ds_read_b64_tr_b16 a[222:223], v12 offset:1024
L_g_p2:
v_add_u32 v5, 16384, v5
v_and_b32 v5, 65535, v5
v_xor_b32 v6, 16, v5
v_xor_b32 v7, 64, v5
v_xor_b32 v8, 80, v5
v_xor_b32 v9, 128, v5
v_xor_b32 v10, 144, v5
v_xor_b32 v11, 192, v5
v_xor_b32 v12, 208, v5
L_g_tile:
s_cmp_eq_u32 s35, 1
s_cbranch_scc1 L_g_first
L_g_go:
s_cmp_eq_u32 s41, 0
s_cbranch_scc0 L_g_v
.p2align 3
L_g_k:
s_waitcnt vmcnt(16) lgkmcnt(0)
s_barrier
v_mfma_f32_16x16x32_bf16 v[160:163], a[160:163], a[192:195], 0
ds_read_b128 a[224:227], v4 offset:0
v_accvgpr_read_b32 v20, a64
v_accvgpr_read_b32 v21, a65
v_accvgpr_read_b32 v22, a66
v_mfma_f32_16x16x32_bf16 v[164:167], a[160:163], a[196:199], 0
s_add_u32 s37, s31, 0
v_accvgpr_read_b32 v23, a67
v_cvt_pk_bf16_f32 v98, v20, v21
v_cvt_pk_bf16_f32 v99, v22, v23
v_accvgpr_read_b32 v24, a68
v_mfma_f32_16x16x32_bf16 v[168:171], a[160:163], a[200:203], 0
s_add_u32 m0, s33, 0
ds_read_b128 a[228:231], v3 offset:1024
v_accvgpr_read_b32 v25, a69
v_accvgpr_read_b32 v26, a70
v_accvgpr_read_b32 v27, a71
v_mfma_f32_16x16x32_bf16 v[172:175], a[160:163], a[204:207], 0
buffer_load_dwordx4 v2, s[20:23], s37 offen  lds
v_cvt_pk_bf16_f32 v102, v24, v25
v_cvt_pk_bf16_f32 v103, v26, v27
v_accvgpr_read_b32 v20, a72
v_mfma_f32_16x16x32_bf16 v[176:179], a[160:163], a[208:211], 0
ds_read_b128 a[232:235], v4 offset:4096
v_accvgpr_read_b32 v21, a73
v_accvgpr_read_b32 v22, a74
v_accvgpr_read_b32 v23, a75
v_mfma_f32_16x16x32_bf16 v[180:183], a[160:163], a[212:215], 0
v_cvt_pk_bf16_f32 v106, v20, v21
v_cvt_pk_bf16_f32 v107, v22, v23
v_accvgpr_read_b32 v24, a76
v_accvgpr_read_b32 v25, a77
v_mfma_f32_16x16x32_bf16 v[184:187], a[160:163], a[216:219], 0
ds_read_b128 a[236:239], v3 offset:5120
v_accvgpr_read_b32 v26, a78
v_accvgpr_read_b32 v27, a79
v_cvt_pk_bf16_f32 v110, v24, v25
v_mfma_f32_16x16x32_bf16 v[188:191], a[160:163], a[220:223], 0
ds_read_b64_tr_b16 a[160:161], v5 offset:0
v_cvt_pk_bf16_f32 v111, v26, v27
v_accvgpr_read_b32 v20, a80
v_accvgpr_read_b32 v21, a81
v_mfma_f32_16x16x32_bf16 v[192:195], a[164:167], a[192:195], 0
s_add_u32 s37, s31, 32768
ds_read_b64_tr_b16 a[162:163], v5 offset:1024
v_accvgpr_read_b32 v22, a82
v_accvgpr_read_b32 v23, a83
v_cvt_pk_bf16_f32 v114, v20, v21
v_mfma_f32_16x16x32_bf16 v[196:199], a[164:167], a[196:199], 0
s_add_u32 m0, s33, 1024
ds_read_b128 a[240:243], v4 offset:8192
v_add_u32 v5, 16384, v5
v_cvt_pk_bf16_f32 v115, v22, v23
v_accvgpr_read_b32 v24, a84
v_mfma_f32_16x16x32_bf16 v[200:203], a[164:167], a[200:203], 0
buffer_load_dwordx4 v2, s[20:23], s37 offen  lds
v_and_b32 v5, 65535, v5
v_accvgpr_read_b32 v25, a85
v_accvgpr_read_b32 v26, a86
v_mfma_f32_16x16x32_bf16 v[204:207], a[164:167], a[204:207], 0
ds_read_b128 a[244:247], v3 offset:9216
v_accvgpr_read_b32 v27, a87
v_cvt_pk_bf16_f32 v118, v24, v25
v_cvt_pk_bf16_f32 v119, v26, v27
v_mfma_f32_16x16x32_bf16 v[208:211], a[164:167], a[208:211], 0
v_accvgpr_read_b32 v20, a88
v_accvgpr_read_b32 v21, a89
v_accvgpr_read_b32 v22, a90
v_accvgpr_read_b32 v23, a91
v_mfma_f32_16x16x32_bf16 v[212:215], a[164:167], a[212:215], 0
ds_read_b128 a[248:251], v4 offset:12288
v_cvt_pk_bf16_f32 v122, v20, v21
v_cvt_pk_bf16_f32 v123, v22, v23
v_accvgpr_read_b32 v24, a92
v_mfma_f32_16x16x32_bf16 v[216:219], a[164:167], a[216:219], 0
v_accvgpr_read_b32 v25, a93
v_accvgpr_read_b32 v26, a94
v_accvgpr_read_b32 v27, a95
v_cvt_pk_bf16_f32 v126, v24, v25
v_mfma_f32_16x16x32_bf16 v[220:223], a[164:167], a[220:223], 0
s_add_u32 s37, s31, 131072
ds_read_b64_tr_b16 a[164:165], v6 offset:0
v_cvt_pk_bf16_f32 v127, v26, v27
v_accvgpr_read_b32 v20, a96
v_accvgpr_read_b32 v21, a97
v_mfma_f32_16x16x32_bf16 v[224:227], a[168:171], a[192:195], 0
s_add_u32 m0, s33, 4096
ds_read_b64_tr_b16 a[166:167], v6 offset:1024
v_accvgpr_read_b32 v22, a98
v_accvgpr_read_b32 v23, a99
v_cvt_pk_bf16_f32 v128, v20, v21
v_mfma_f32_16x16x32_bf16 v[228:231], a[168:171], a[196:199], 0
buffer_load_dwordx4 v2, s[20:23], s37 offen  lds
v_xor_b32 v6, 16, v5
v_cvt_pk_bf16_f32 v129, v22, v23
v_accvgpr_read_b32 v24, a100
v_mfma_f32_16x16x32_bf16 v[232:235], a[168:171], a[200:203], 0
ds_read_b128 a[252:255], v3 offset:13312
v_accvgpr_read_b32 v25, a101
v_accvgpr_read_b32 v26, a102
v_accvgpr_read_b32 v27, a103
v_mfma_f32_16x16x32_bf16 v[236:239], a[168:171], a[204:207], 0
v_cvt_pk_bf16_f32 v132, v24, v25
v_cvt_pk_bf16_f32 v133, v26, v27
v_accvgpr_read_b32 v20, a104
v_accvgpr_read_b32 v21, a105
v_mfma_f32_16x16x32_bf16 v[240:243], a[168:171], a[208:211], 0
ds_read_b64_tr_b16 v[28:29], v12 offset:0
v_accvgpr_read_b32 v22, a106
v_accvgpr_read_b32 v23, a107
v_cvt_pk_bf16_f32 v136, v20, v21
v_mfma_f32_16x16x32_bf16 v[244:247], a[168:171], a[212:215], 0
v_cvt_pk_bf16_f32 v137, v22, v23
v_accvgpr_read_b32 v24, a108
v_accvgpr_read_b32 v25, a109
v_accvgpr_read_b32 v26, a110
v_mfma_f32_16x16x32_bf16 v[248:251], a[168:171], a[216:219], 0
s_add_u32 s37, s31, 163840
ds_read_b64_tr_b16 v[30:31], v12 offset:1024
v_accvgpr_read_b32 v27, a111
v_cvt_pk_bf16_f32 v140, v24, v25
v_cvt_pk_bf16_f32 v141, v26, v27
v_mfma_f32_16x16x32_bf16 v[252:255], a[168:171], a[220:223], 0
s_add_u32 m0, s33, 5120
ds_read_b64_tr_b16 a[168:169], v7 offset:0
v_accvgpr_read_b32 v20, a112
v_accvgpr_read_b32 v21, a113
v_accvgpr_read_b32 v22, a114
v_mfma_f32_16x16x32_bf16 a[0:3], a[172:175], a[192:195], 0
buffer_load_dwordx4 v2, s[20:23], s37 offen  lds
ds_read_b64_tr_b16 a[170:171], v7 offset:1024
v_accvgpr_read_b32 v23, a115
v_cvt_pk_bf16_f32 v144, v20, v21
v_mfma_f32_16x16x32_bf16 a[4:7], a[172:175], a[196:199], 0
s_add_u32 s31, s31, 262144
v_xor_b32 v7, 64, v5
v_xor_b32 v12, 208, v5
v_cvt_pk_bf16_f32 v145, v22, v23
v_accvgpr_read_b32 v24, a116
v_mfma_f32_16x16x32_bf16 a[8:11], a[172:175], a[200:203], 0
s_add_u32 s33, s33, 16384
v_add_u32 v3, 32768, v3
v_accvgpr_read_b32 v25, a117
v_accvgpr_read_b32 v26, a118
v_accvgpr_read_b32 v27, a119
v_mfma_f32_16x16x32_bf16 a[12:15], a[172:175], a[204:207], 0
s_and_b32 s33, s33, 65535
v_subrev_u32 v19, 98304, v3
v_cvt_pk_bf16_f32 v148, v24, v25
v_cvt_pk_bf16_f32 v149, v26, v27
v_accvgpr_read_b32 v20, a120
v_mfma_f32_16x16x32_bf16 a[16:19], a[172:175], a[208:211], 0
v_cmp_le_u32 vcc, 163840, v3
v_accvgpr_read_b32 v21, a121
v_accvgpr_read_b32 v22, a122
v_accvgpr_read_b32 v23, a123
v_mfma_f32_16x16x32_bf16 a[20:23], a[172:175], a[212:215], 0
s_add_u32 s48, s48, s34
v_cndmask_b32 v3, v3, v19, vcc
v_cvt_pk_bf16_f32 v152, v20, v21
v_cvt_pk_bf16_f32 v153, v22, v23
v_accvgpr_read_b32 v24, a124
v_mfma_f32_16x16x32_bf16 a[24:27], a[172:175], a[216:219], 0
s_add_u32 m0, s32, 16384
v_xor_b32 v4, 64, v3
v_accvgpr_read_b32 v25, a125
v_accvgpr_read_b32 v26, a126
v_accvgpr_read_b32 v27, a127
v_mfma_f32_16x16x32_bf16 a[28:31], a[172:175], a[220:223], 0
buffer_load_dwordx4 v1, s[12:15], s48 offen lds
ds_read_b64_tr_b16 a[172:173], v8 offset:0
v_cvt_pk_bf16_f32 v156, v24, v25
v_cvt_pk_bf16_f32 v157, v26, v27
v_mfma_f32_16x16x32_bf16 a[32:35], a[176:179], a[192:195], 0
ds_read_b64_tr_b16 a[174:175], v8 offset:1024
v_accvgpr_read_b32 v20, a128
v_accvgpr_read_b32 v21, a129
v_accvgpr_read_b32 v22, a130
v_mfma_f32_16x16x32_bf16 a[36:39], a[176:179], a[196:199], 0
v_xor_b32 v8, 80, v5
v_accvgpr_read_b32 v23, a131
v_cvt_pk_bf16_f32 v130, v20, v21
v_cvt_pk_bf16_f32 v131, v22, v23
v_mfma_f32_16x16x32_bf16 a[40:43], a[176:179], a[200:203], 0
v_accvgpr_read_b32 v24, a132
v_accvgpr_read_b32 v25, a133
v_accvgpr_read_b32 v26, a134
v_accvgpr_read_b32 v27, a135
v_mfma_f32_16x16x32_bf16 a[44:47], a[176:179], a[204:207], 0
v_cvt_pk_bf16_f32 v134, v24, v25
v_cvt_pk_bf16_f32 v135, v26, v27
v_accvgpr_read_b32 v20, a136
v_accvgpr_read_b32 v21, a137
v_mfma_f32_16x16x32_bf16 a[48:51], a[176:179], a[208:211], 0
s_add_u32 s48, s48, s34
v_accvgpr_read_b32 v22, a138
v_accvgpr_read_b32 v23, a139
v_cvt_pk_bf16_f32 v138, v20, v21
v_cvt_pk_bf16_f32 v139, v22, v23
s_mov_b32 s38, s62
s_mov_b32 s39, s63
v_mfma_f32_16x16x32_bf16 a[52:55], a[176:179], a[212:215], 0
s_add_u32 m0, s32, 20480
v_accvgpr_read_b32 v24, a140
v_accvgpr_read_b32 v25, a141
v_accvgpr_read_b32 v26, a142
v_accvgpr_read_b32 v27, a143
s_mov_b32 s49, s50
s_mov_b32 s62, s42
v_mfma_f32_16x16x32_bf16 a[56:59], a[176:179], a[216:219], 0
buffer_load_dwordx4 v1, s[12:15], s48 offen lds
v_cvt_pk_bf16_f32 v142, v24, v25
v_cvt_pk_bf16_f32 v143, v26, v27
v_accvgpr_read_b32 v20, a144
s_mov_b32 s63, s43
s_mov_b32 s50, s51
v_mfma_f32_16x16x32_bf16 a[60:63], a[176:179], a[220:223], 0
ds_read_b64_tr_b16 a[176:177], v9 offset:0
v_accvgpr_read_b32 v21, a145
v_accvgpr_read_b32 v22, a146
v_accvgpr_read_b32 v23, a147
s_mov_b32 s36, s40
s_add_u32 s35, s35, 1
v_mfma_f32_16x16x32_bf16 a[64:67], a[180:183], a[192:195], 0
ds_read_b64_tr_b16 a[178:179], v9 offset:1024
v_cvt_pk_bf16_f32 v146, v20, v21
v_cvt_pk_bf16_f32 v147, v22, v23
v_accvgpr_read_b32 v24, a148
v_bfe_u32 v16, v0, 3, 3
v_lshlrev_b32 v16, 4, v16
v_mfma_f32_16x16x32_bf16 a[68:71], a[180:183], a[196:199], 0
v_xor_b32 v9, 128, v5
v_accvgpr_read_b32 v25, a149
v_accvgpr_read_b32 v26, a150
v_accvgpr_read_b32 v27, a151
v_and_or_b32 v16, v0, 7, v16
v_bfe_u32 v17, v0, 4, 2
v_mfma_f32_16x16x32_bf16 a[72:75], a[180:183], a[200:203], 0
v_cvt_pk_bf16_f32 v150, v24, v25
v_cvt_pk_bf16_f32 v151, v26, v27
v_accvgpr_read_b32 v20, a152
v_accvgpr_read_b32 v21, a153
v_lshlrev_b32 v17, 5, v17
v_bfe_u32 v18, v0, 1, 3
v_mfma_f32_16x16x32_bf16 a[76:79], a[180:183], a[204:207], 0
s_add_u32 s48, s48, s34
v_accvgpr_read_b32 v22, a154
v_accvgpr_read_b32 v23, a155
v_cvt_pk_bf16_f32 v154, v20, v21
v_cvt_pk_bf16_f32 v155, v22, v23
v_or_b32 v17, v17, v18
v_and_b32 v18, 1, v0
v_mfma_f32_16x16x32_bf16 a[80:83], a[180:183], a[208:211], 0
s_add_u32 m0, s32, 24576
v_accvgpr_read_b32 v24, a156
v_accvgpr_read_b32 v25, a157
v_accvgpr_read_b32 v26, a158
v_accvgpr_read_b32 v27, a159
v_lshl_or_b32 v17, v18, 4, v17
v_mfma_f32_16x16x32_bf16 a[84:87], a[180:183], a[212:215], 0
buffer_load_dwordx4 v1, s[12:15], s48 offen lds
v_cvt_pk_bf16_f32 v158, v24, v25
v_cvt_pk_bf16_f32 v159, v26, v27
s_bitcmp1_b32 s49, 1
s_cselect_b64 vcc, -1, 0
s_movk_i32 s44, 0x80
v_mfma_f32_16x16x32_bf16 a[88:91], a[180:183], a[216:219], 0
v_cndmask_b32 v16, v16, v17, vcc
v_lshlrev_b32 v13, 4, v16
s_lshr_b32 s93, s49, 2
s_lshr_b32 s93, 0x80000, s93
v_mfma_f32_16x16x32_bf16 a[92:95], a[180:183], a[220:223], 0
ds_read_b64_tr_b16 a[180:181], v10 offset:0
s_bitcmp1_b32 s49, 0
s_cselect_b32 s92, s93, 0x800
s_cselect_b32 s93, 0x800, s93
s_sub_u32 s93, s93, s44
v_mfma_f32_16x16x32_bf16 a[96:99], a[184:187], a[192:195], 0
ds_read_b64_tr_b16 a[182:183], v10 offset:1024
v_mfma_f32_16x16x32_bf16 a[100:103], a[184:187], a[196:199], 0
v_xor_b32 v10, 144, v5
v_mfma_f32_16x16x32_bf16 a[104:107], a[184:187], a[200:203], 0
s_add_u32 s48, s48, s34
v_mfma_f32_16x16x32_bf16 a[108:111], a[184:187], a[204:207], 0
s_add_u32 m0, s32, 28672
v_mfma_f32_16x16x32_bf16 a[112:115], a[184:187], a[208:211], 0
buffer_load_dwordx4 v1, s[12:15], s48 offen lds
v_mfma_f32_16x16x32_bf16 a[116:119], a[184:187], a[212:215], 0
s_add_u32 s30, s30, 128
v_mfma_f32_16x16x32_bf16 a[120:123], a[184:187], a[216:219], 0
s_add_u32 s32, s32, 32768
v_mfma_f32_16x16x32_bf16 a[124:127], a[184:187], a[220:223], 0
s_sub_u32 s48, s32, 98304
ds_read_b64_tr_b16 a[184:185], v11 offset:0
v_mfma_f32_16x16x32_bf16 a[128:131], a[188:191], a[192:195], 0
s_cmp_ge_u32 s32, 163840
s_cselect_b32 s32, s48, s32
ds_read_b64_tr_b16 a[186:187], v11 offset:1024
v_mfma_f32_16x16x32_bf16 a[132:135], a[188:191], a[196:199], 0
v_xor_b32 v11, 192, v5
v_mfma_f32_16x16x32_bf16 a[136:139], a[188:191], a[200:203], 0
buffer_load_dword v15, v14, s[96:99], s100 offen
v_mfma_f32_16x16x32_bf16 a[140:143], a[188:191], a[204:207], 0
s_add_u32 s100, s100, 16384
v_mfma_f32_16x16x32_bf16 a[144:147], a[188:191], a[208:211], 0
v_mfma_f32_16x16x32_bf16 a[148:151], a[188:191], a[212:215], 0
v_mfma_f32_16x16x32_bf16 a[152:155], a[188:191], a[216:219], 0
v_mfma_f32_16x16x32_bf16 a[156:159], a[188:191], a[220:223], 0
s_waitcnt vmcnt(17) lgkmcnt(0)
s_barrier
v_mfma_f32_16x16x32_bf16 v[160:163], a[160:163], a[224:227], v[160:163]
ds_read_b128 a[192:195], v3 offset:0
v_mfma_f32_16x16x32_bf16 v[164:167], a[160:163], a[228:231], v[164:167]
s_add_u32 s37, s31, 0
v_mfma_f32_16x16x32_bf16 v[168:171], a[160:163], a[232:235], v[168:171]
s_add_u32 m0, s33, 0
ds_read_b128 a[196:199], v4 offset:1024
v_mfma_f32_16x16x32_bf16 v[172:175], a[160:163], a[236:239], v[172:175]
buffer_load_dwordx4 v2, s[20:23], s37 offen  lds
v_mfma_f32_16x16x32_bf16 v[176:179], a[160:163], a[240:243], v[176:179]
s_mov_b32 s60, s38
ds_read_b128 a[200:203], v3 offset:4096
v_mfma_f32_16x16x32_bf16 v[180:183], a[160:163], a[244:247], v[180:183]
s_mov_b32 s29, s38
v_mfma_f32_16x16x32_bf16 v[184:187], a[160:163], a[248:251], v[184:187]
buffer_store_dwordx4 v[32:35], v13, s[8:11], s29 offen sc1
v_mfma_f32_16x16x32_bf16 v[188:191], a[160:163], a[252:255], v[188:191]
ds_read_b64_tr_b16 a[160:161], v5 offset:0
v_mfma_f32_16x16x32_bf16 v[192:195], a[164:167], a[224:227], v[192:195]
s_add_u32 s37, s31, 32768
ds_read_b64_tr_b16 a[162:163], v5 offset:1024
v_mfma_f32_16x16x32_bf16 v[196:199], a[164:167], a[228:231], v[196:199]
s_add_u32 m0, s33, 1024
ds_read_b128 a[204:207], v4 offset:5120
v_add_u32 v5, 16384, v5
v_mfma_f32_16x16x32_bf16 v[200:203], a[164:167], a[232:235], v[200:203]
buffer_load_dwordx4 v2, s[20:23], s37 offen  lds
v_and_b32 v5, 65535, v5
v_mfma_f32_16x16x32_bf16 v[204:207], a[164:167], a[236:239], v[204:207]
ds_read_b128 a[208:211], v3 offset:8192
v_mfma_f32_16x16x32_bf16 v[208:211], a[164:167], a[240:243], v[208:211]
v_mfma_f32_16x16x32_bf16 v[212:215], a[164:167], a[244:247], v[212:215]
ds_read_b128 a[212:215], v4 offset:9216
v_mfma_f32_16x16x32_bf16 v[216:219], a[164:167], a[248:251], v[216:219]
v_mfma_f32_16x16x32_bf16 v[220:223], a[164:167], a[252:255], v[220:223]
s_add_u32 s37, s31, 131072
ds_read_b64_tr_b16 a[164:165], v6 offset:0
v_mfma_f32_16x16x32_bf16 v[224:227], a[168:171], a[224:227], v[224:227]
s_add_u32 m0, s33, 4096
ds_read_b64_tr_b16 a[166:167], v6 offset:1024
v_mfma_f32_16x16x32_bf16 v[228:231], a[168:171], a[228:231], v[228:231]
buffer_load_dwordx4 v2, s[20:23], s37 offen  lds
v_xor_b32 v6, 16, v5
v_mfma_f32_16x16x32_bf16 v[232:235], a[168:171], a[232:235], v[232:235]
ds_read_b128 a[216:219], v3 offset:12288
v_mfma_f32_16x16x32_bf16 v[236:239], a[168:171], a[236:239], v[236:239]
v_mfma_f32_16x16x32_bf16 v[240:243], a[168:171], a[240:243], v[240:243]
ds_read_b128 a[220:223], v4 offset:13312
v_mfma_f32_16x16x32_bf16 v[244:247], a[168:171], a[244:247], v[244:247]
v_mfma_f32_16x16x32_bf16 v[248:251], a[168:171], a[248:251], v[248:251]
s_add_u32 s37, s31, 163840
ds_read_b64_tr_b16 a[188:189], v12 offset:0
v_mfma_f32_16x16x32_bf16 v[252:255], a[168:171], a[252:255], v[252:255]
s_add_u32 m0, s33, 5120
ds_read_b64_tr_b16 a[168:169], v7 offset:0
v_mfma_f32_16x16x32_bf16 a[0:3], a[172:175], a[224:227], a[0:3]
buffer_load_dwordx4 v2, s[20:23], s37 offen  lds
ds_read_b64_tr_b16 a[170:171], v7 offset:1024
v_mfma_f32_16x16x32_bf16 a[4:7], a[172:175], a[228:231], a[4:7]
s_add_u32 s31, s31, 262144
s_add_u32 s29, s29, s44
v_xor_b32 v7, 64, v5
v_mfma_f32_16x16x32_bf16 a[8:11], a[172:175], a[232:235], a[8:11]
s_add_u32 s33, s33, 16384
ds_read_b64_tr_b16 a[190:191], v12 offset:1024
v_mfma_f32_16x16x32_bf16 a[12:15], a[172:175], a[236:239], a[12:15]
s_and_b32 s33, s33, 65535
buffer_store_dwordx4 v[36:39], v13, s[8:11], s29 offen sc1
v_mfma_f32_16x16x32_bf16 a[16:19], a[172:175], a[240:243], a[16:19]
v_mfma_f32_16x16x32_bf16 a[20:23], a[172:175], a[244:247], a[20:23]
s_mov_b32 s48, s30
v_xor_b32 v12, 208, v5
v_mfma_f32_16x16x32_bf16 a[24:27], a[172:175], a[248:251], a[24:27]
s_add_u32 m0, s32, 0
v_mfma_f32_16x16x32_bf16 a[28:31], a[172:175], a[252:255], a[28:31]
buffer_load_dwordx4 v1, s[12:15], s48 offen lds
ds_read_b64_tr_b16 a[172:173], v8 offset:0
v_mfma_f32_16x16x32_bf16 a[32:35], a[176:179], a[224:227], a[32:35]
ds_read_b64_tr_b16 a[174:175], v8 offset:1024
v_mfma_f32_16x16x32_bf16 a[36:39], a[176:179], a[228:231], a[36:39]
v_xor_b32 v8, 80, v5
v_mfma_f32_16x16x32_bf16 a[40:43], a[176:179], a[232:235], a[40:43]
v_mfma_f32_16x16x32_bf16 a[44:47], a[176:179], a[236:239], a[44:47]
v_mfma_f32_16x16x32_bf16 a[48:51], a[176:179], a[240:243], a[48:51]
s_add_u32 s48, s48, s34
v_mfma_f32_16x16x32_bf16 a[52:55], a[176:179], a[244:247], a[52:55]
s_add_u32 m0, s32, 4096
v_mfma_f32_16x16x32_bf16 a[56:59], a[176:179], a[248:251], a[56:59]
buffer_load_dwordx4 v1, s[12:15], s48 offen lds
v_mfma_f32_16x16x32_bf16 a[60:63], a[176:179], a[252:255], a[60:63]
ds_read_b64_tr_b16 a[176:177], v9 offset:0
v_mfma_f32_16x16x32_bf16 a[64:67], a[180:183], a[224:227], a[64:67]
ds_read_b64_tr_b16 a[178:179], v9 offset:1024
v_mfma_f32_16x16x32_bf16 a[68:71], a[180:183], a[228:231], a[68:71]
v_xor_b32 v9, 128, v5
v_mfma_f32_16x16x32_bf16 a[72:75], a[180:183], a[232:235], a[72:75]
v_mfma_f32_16x16x32_bf16 a[76:79], a[180:183], a[236:239], a[76:79]
s_add_u32 s48, s48, s34
v_mfma_f32_16x16x32_bf16 a[80:83], a[180:183], a[240:243], a[80:83]
s_add_u32 m0, s32, 8192
v_mfma_f32_16x16x32_bf16 a[84:87], a[180:183], a[244:247], a[84:87]
buffer_load_dwordx4 v1, s[12:15], s48 offen lds
v_mfma_f32_16x16x32_bf16 a[88:91], a[180:183], a[248:251], a[88:91]
s_add_u32 s29, s29, s93
v_mfma_f32_16x16x32_bf16 a[92:95], a[180:183], a[252:255], a[92:95]
ds_read_b64_tr_b16 a[180:181], v10 offset:0
v_mfma_f32_16x16x32_bf16 a[96:99], a[184:187], a[224:227], a[96:99]
buffer_store_dwordx4 v[40:43], v13, s[8:11], s29 offen sc1
ds_read_b64_tr_b16 a[182:183], v10 offset:1024
v_mfma_f32_16x16x32_bf16 a[100:103], a[184:187], a[228:231], a[100:103]
v_xor_b32 v10, 144, v5
v_mfma_f32_16x16x32_bf16 a[104:107], a[184:187], a[232:235], a[104:107]
s_add_u32 s48, s48, s34
v_mfma_f32_16x16x32_bf16 a[108:111], a[184:187], a[236:239], a[108:111]
s_add_u32 m0, s32, 12288
v_mfma_f32_16x16x32_bf16 a[112:115], a[184:187], a[240:243], a[112:115]
buffer_load_dwordx4 v1, s[12:15], s48 offen lds
v_mfma_f32_16x16x32_bf16 a[116:119], a[184:187], a[244:247], a[116:119]
v_mfma_f32_16x16x32_bf16 a[120:123], a[184:187], a[248:251], a[120:123]
v_mfma_f32_16x16x32_bf16 a[124:127], a[184:187], a[252:255], a[124:127]
ds_read_b64_tr_b16 a[184:185], v11 offset:0
v_mfma_f32_16x16x32_bf16 a[128:131], v[28:31], a[224:227], a[128:131]
ds_read_b64_tr_b16 a[186:187], v11 offset:1024
v_mfma_f32_16x16x32_bf16 a[132:135], v[28:31], a[228:231], a[132:135]
v_xor_b32 v11, 192, v5
v_mfma_f32_16x16x32_bf16 a[136:139], v[28:31], a[232:235], a[136:139]
buffer_load_dword v15, v14, s[96:99], s100 offen
v_mfma_f32_16x16x32_bf16 a[140:143], v[28:31], a[236:239], a[140:143]
s_add_u32 s100, s100, 16384
v_mfma_f32_16x16x32_bf16 a[144:147], v[28:31], a[240:243], a[144:147]
v_mfma_f32_16x16x32_bf16 a[148:151], v[28:31], a[244:247], a[148:151]
v_mfma_f32_16x16x32_bf16 a[152:155], v[28:31], a[248:251], a[152:155]
v_mfma_f32_16x16x32_bf16 a[156:159], v[28:31], a[252:255], a[156:159]
s_waitcnt vmcnt(21) lgkmcnt(0)
s_barrier
v_mfma_f32_16x16x32_bf16 v[160:163], a[160:163], a[192:195], v[160:163]
ds_read_b128 a[224:227], v4 offset:0
v_mfma_f32_16x16x32_bf16 v[164:167], a[160:163], a[196:199], v[164:167]
s_add_u32 s37, s31, 0
v_mfma_f32_16x16x32_bf16 v[168:171], a[160:163], a[200:203], v[168:171]
s_add_u32 m0, s33, 0
ds_read_b128 a[228:231], v3 offset:1024
v_mfma_f32_16x16x32_bf16 v[172:175], a[160:163], a[204:207], v[172:175]
buffer_load_dwordx4 v2, s[20:23], s37 offen  lds
v_mfma_f32_16x16x32_bf16 v[176:179], a[160:163], a[208:211], v[176:179]
s_add_u32 s29, s29, s44
ds_read_b128 a[232:235], v4 offset:4096
v_mfma_f32_16x16x32_bf16 v[180:183], a[160:163], a[212:215], v[180:183]
v_mfma_f32_16x16x32_bf16 v[184:187], a[160:163], a[216:219], v[184:187]
buffer_store_dwordx4 v[44:47], v13, s[8:11], s29 offen sc1
v_mfma_f32_16x16x32_bf16 v[188:191], a[160:163], a[220:223], v[188:191]
ds_read_b64_tr_b16 a[160:161], v5 offset:0
v_mfma_f32_16x16x32_bf16 v[192:195], a[164:167], a[192:195], v[192:195]
s_add_u32 s37, s31, 32768
ds_read_b64_tr_b16 a[162:163], v5 offset:1024
v_mfma_f32_16x16x32_bf16 v[196:199], a[164:167], a[196:199], v[196:199]
s_add_u32 m0, s33, 1024
ds_read_b128 a[236:239], v3 offset:5120
v_add_u32 v5, 16384, v5
v_mfma_f32_16x16x32_bf16 v[200:203], a[164:167], a[200:203], v[200:203]
buffer_load_dwordx4 v2, s[20:23], s37 offen  lds
v_and_b32 v5, 65535, v5
v_mfma_f32_16x16x32_bf16 v[204:207], a[164:167], a[204:207], v[204:207]
ds_read_b128 a[240:243], v4 offset:8192
v_mfma_f32_16x16x32_bf16 v[208:211], a[164:167], a[208:211], v[208:211]
v_mfma_f32_16x16x32_bf16 v[212:215], a[164:167], a[212:215], v[212:215]
ds_read_b128 a[244:247], v3 offset:9216
v_mfma_f32_16x16x32_bf16 v[216:219], a[164:167], a[216:219], v[216:219]
v_mfma_f32_16x16x32_bf16 v[220:223], a[164:167], a[220:223], v[220:223]
s_add_u32 s37, s31, 131072
ds_read_b64_tr_b16 a[164:165], v6 offset:0
v_mfma_f32_16x16x32_bf16 v[224:227], a[168:171], a[192:195], v[224:227]
s_add_u32 m0, s33, 4096
ds_read_b64_tr_b16 a[166:167], v6 offset:1024
v_mfma_f32_16x16x32_bf16 v[228:231], a[168:171], a[196:199], v[228:231]
buffer_load_dwordx4 v2, s[20:23], s37 offen  lds
v_xor_b32 v6, 16, v5
v_mfma_f32_16x16x32_bf16 v[232:235], a[168:171], a[200:203], v[232:235]
ds_read_b128 a[248:251], v4 offset:12288
v_mfma_f32_16x16x32_bf16 v[236:239], a[168:171], a[204:207], v[236:239]
v_mfma_f32_16x16x32_bf16 v[240:243], a[168:171], a[208:211], v[240:243]
ds_read_b128 a[252:255], v3 offset:13312
v_mfma_f32_16x16x32_bf16 v[244:247], a[168:171], a[212:215], v[244:247]
v_mfma_f32_16x16x32_bf16 v[248:251], a[168:171], a[216:219], v[248:251]
s_add_u32 s37, s31, 163840
ds_read_b64_tr_b16 v[28:29], v12 offset:0
v_mfma_f32_16x16x32_bf16 v[252:255], a[168:171], a[220:223], v[252:255]
s_add_u32 m0, s33, 5120
ds_read_b64_tr_b16 a[168:169], v7 offset:0
v_mfma_f32_16x16x32_bf16 a[0:3], a[172:175], a[192:195], a[0:3]
buffer_load_dwordx4 v2, s[20:23], s37 offen  lds
ds_read_b64_tr_b16 a[170:171], v7 offset:1024
v_mfma_f32_16x16x32_bf16 a[4:7], a[172:175], a[196:199], a[4:7]
s_add_u32 s31, s31, 262144
s_add_u32 s29, s29, s93
v_xor_b32 v7, 64, v5
v_mfma_f32_16x16x32_bf16 a[8:11], a[172:175], a[200:203], a[8:11]
s_add_u32 s33, s33, 16384
ds_read_b64_tr_b16 v[30:31], v12 offset:1024
v_mfma_f32_16x16x32_bf16 a[12:15], a[172:175], a[204:207], a[12:15]
s_and_b32 s33, s33, 65535
buffer_store_dwordx4 v[48:51], v13, s[8:11], s29 offen sc1
v_mfma_f32_16x16x32_bf16 a[16:19], a[172:175], a[208:211], a[16:19]
v_mfma_f32_16x16x32_bf16 a[20:23], a[172:175], a[212:215], a[20:23]
s_add_u32 s48, s48, s34
v_xor_b32 v12, 208, v5
v_mfma_f32_16x16x32_bf16 a[24:27], a[172:175], a[216:219], a[24:27]
s_add_u32 m0, s32, 16384
v_add_u32 v3, 32768, v3
v_mfma_f32_16x16x32_bf16 a[28:31], a[172:175], a[220:223], a[28:31]
buffer_load_dwordx4 v1, s[12:15], s48 offen lds
ds_read_b64_tr_b16 a[172:173], v8 offset:0
v_mfma_f32_16x16x32_bf16 a[32:35], a[176:179], a[192:195], a[32:35]
ds_read_b64_tr_b16 a[174:175], v8 offset:1024
v_subrev_u32 v19, 98304, v3
v_mfma_f32_16x16x32_bf16 a[36:39], a[176:179], a[196:199], a[36:39]
v_xor_b32 v8, 80, v5
v_cmp_le_u32 vcc, 163840, v3
v_mfma_f32_16x16x32_bf16 a[40:43], a[176:179], a[200:203], a[40:43]
s_nop 0
v_cndmask_b32 v3, v3, v19, vcc
v_mfma_f32_16x16x32_bf16 a[44:47], a[176:179], a[204:207], a[44:47]
v_xor_b32 v4, 64, v3
v_mfma_f32_16x16x32_bf16 a[48:51], a[176:179], a[208:211], a[48:51]
s_add_u32 s48, s48, s34
v_mfma_f32_16x16x32_bf16 a[52:55], a[176:179], a[212:215], a[52:55]
s_add_u32 m0, s32, 20480
v_mfma_f32_16x16x32_bf16 a[56:59], a[176:179], a[216:219], a[56:59]
buffer_load_dwordx4 v1, s[12:15], s48 offen lds
v_mfma_f32_16x16x32_bf16 a[60:63], a[176:179], a[220:223], a[60:63]
ds_read_b64_tr_b16 a[176:177], v9 offset:0
v_mfma_f32_16x16x32_bf16 a[64:67], a[180:183], a[192:195], a[64:67]
ds_read_b64_tr_b16 a[178:179], v9 offset:1024
v_mfma_f32_16x16x32_bf16 a[68:71], a[180:183], a[196:199], a[68:71]
v_xor_b32 v9, 128, v5
v_mfma_f32_16x16x32_bf16 a[72:75], a[180:183], a[200:203], a[72:75]
v_mfma_f32_16x16x32_bf16 a[76:79], a[180:183], a[204:207], a[76:79]
s_add_u32 s48, s48, s34
v_mfma_f32_16x16x32_bf16 a[80:83], a[180:183], a[208:211], a[80:83]
s_add_u32 m0, s32, 24576
v_mfma_f32_16x16x32_bf16 a[84:87], a[180:183], a[212:215], a[84:87]
buffer_load_dwordx4 v1, s[12:15], s48 offen lds
v_mfma_f32_16x16x32_bf16 a[88:91], a[180:183], a[216:219], a[88:91]
s_add_u32 s29, s29, s44
v_mfma_f32_16x16x32_bf16 a[92:95], a[180:183], a[220:223], a[92:95]
ds_read_b64_tr_b16 a[180:181], v10 offset:0
v_mfma_f32_16x16x32_bf16 a[96:99], a[184:187], a[192:195], a[96:99]
buffer_store_dwordx4 v[52:55], v13, s[8:11], s29 offen sc1
ds_read_b64_tr_b16 a[182:183], v10 offset:1024
v_mfma_f32_16x16x32_bf16 a[100:103], a[184:187], a[196:199], a[100:103]
v_xor_b32 v10, 144, v5
v_mfma_f32_16x16x32_bf16 a[104:107], a[184:187], a[200:203], a[104:107]
s_add_u32 s48, s48, s34
v_mfma_f32_16x16x32_bf16 a[108:111], a[184:187], a[204:207], a[108:111]
s_add_u32 m0, s32, 28672
v_mfma_f32_16x16x32_bf16 a[112:115], a[184:187], a[208:211], a[112:115]
buffer_load_dwordx4 v1, s[12:15], s48 offen lds
v_mfma_f32_16x16x32_bf16 a[116:119], a[184:187], a[212:215], a[116:119]
s_add_u32 s30, s30, 128
v_mfma_f32_16x16x32_bf16 a[120:123], a[184:187], a[216:219], a[120:123]
s_add_u32 s32, s32, 32768
v_mfma_f32_16x16x32_bf16 a[124:127], a[184:187], a[220:223], a[124:127]
s_sub_u32 s48, s32, 98304
ds_read_b64_tr_b16 a[184:185], v11 offset:0
v_mfma_f32_16x16x32_bf16 a[128:131], a[188:191], a[192:195], a[128:131]
s_cmp_ge_u32 s32, 163840
s_cselect_b32 s32, s48, s32
ds_read_b64_tr_b16 a[186:187], v11 offset:1024
v_mfma_f32_16x16x32_bf16 a[132:135], a[188:191], a[196:199], a[132:135]
v_xor_b32 v11, 192, v5
v_mfma_f32_16x16x32_bf16 a[136:139], a[188:191], a[200:203], a[136:139]
buffer_load_dword v15, v14, s[96:99], s100 offen
v_mfma_f32_16x16x32_bf16 a[140:143], a[188:191], a[204:207], a[140:143]
s_add_u32 s100, s100, 16384
v_mfma_f32_16x16x32_bf16 a[144:147], a[188:191], a[208:211], a[144:147]
v_mfma_f32_16x16x32_bf16 a[148:151], a[188:191], a[212:215], a[148:151]
v_mfma_f32_16x16x32_bf16 a[152:155], a[188:191], a[216:219], a[152:155]
v_mfma_f32_16x16x32_bf16 a[156:159], a[188:191], a[220:223], a[156:159]
s_waitcnt vmcnt(24) lgkmcnt(0)
s_barrier
v_mfma_f32_16x16x32_bf16 v[160:163], a[160:163], a[224:227], v[160:163]
ds_read_b128 a[192:195], v3 offset:0
v_mfma_f32_16x16x32_bf16 v[164:167], a[160:163], a[228:231], v[164:167]
s_add_u32 s37, s31, 0
v_mfma_f32_16x16x32_bf16 v[168:171], a[160:163], a[232:235], v[168:171]
s_add_u32 m0, s33, 0
ds_read_b128 a[196:199], v4 offset:1024
v_mfma_f32_16x16x32_bf16 v[172:175], a[160:163], a[236:239], v[172:175]
buffer_load_dwordx4 v2, s[20:23], s37 offen  lds
v_mfma_f32_16x16x32_bf16 v[176:179], a[160:163], a[240:243], v[176:179]
s_add_u32 s29, s29, s93
ds_read_b128 a[200:203], v3 offset:4096
v_mfma_f32_16x16x32_bf16 v[180:183], a[160:163], a[244:247], v[180:183]
v_mfma_f32_16x16x32_bf16 v[184:187], a[160:163], a[248:251], v[184:187]
buffer_store_dwordx4 v[56:59], v13, s[8:11], s29 offen sc1
v_mfma_f32_16x16x32_bf16 v[188:191], a[160:163], a[252:255], v[188:191]
ds_read_b64_tr_b16 a[160:161], v5 offset:0
v_mfma_f32_16x16x32_bf16 v[192:195], a[164:167], a[224:227], v[192:195]
s_add_u32 s37, s31, 32768
ds_read_b64_tr_b16 a[162:163], v5 offset:1024
v_mfma_f32_16x16x32_bf16 v[196:199], a[164:167], a[228:231], v[196:199]
s_add_u32 m0, s33, 1024
ds_read_b128 a[204:207], v4 offset:5120
v_add_u32 v5, 16384, v5
v_mfma_f32_16x16x32_bf16 v[200:203], a[164:167], a[232:235], v[200:203]
buffer_load_dwordx4 v2, s[20:23], s37 offen  lds
v_and_b32 v5, 65535, v5
v_mfma_f32_16x16x32_bf16 v[204:207], a[164:167], a[236:239], v[204:207]
ds_read_b128 a[208:211], v3 offset:8192
v_mfma_f32_16x16x32_bf16 v[208:211], a[164:167], a[240:243], v[208:211]
v_mfma_f32_16x16x32_bf16 v[212:215], a[164:167], a[244:247], v[212:215]
ds_read_b128 a[212:215], v4 offset:9216
v_mfma_f32_16x16x32_bf16 v[216:219], a[164:167], a[248:251], v[216:219]
v_mfma_f32_16x16x32_bf16 v[220:223], a[164:167], a[252:255], v[220:223]
s_add_u32 s37, s31, 131072
ds_read_b64_tr_b16 a[164:165], v6 offset:0
v_mfma_f32_16x16x32_bf16 v[224:227], a[168:171], a[224:227], v[224:227]
s_add_u32 m0, s33, 4096
ds_read_b64_tr_b16 a[166:167], v6 offset:1024
v_mfma_f32_16x16x32_bf16 v[228:231], a[168:171], a[228:231], v[228:231]
buffer_load_dwordx4 v2, s[20:23], s37 offen  lds
v_xor_b32 v6, 16, v5
v_mfma_f32_16x16x32_bf16 v[232:235], a[168:171], a[232:235], v[232:235]
ds_read_b128 a[216:219], v3 offset:12288
v_mfma_f32_16x16x32_bf16 v[236:239], a[168:171], a[236:239], v[236:239]
v_mfma_f32_16x16x32_bf16 v[240:243], a[168:171], a[240:243], v[240:243]
ds_read_b128 a[220:223], v4 offset:13312
v_mfma_f32_16x16x32_bf16 v[244:247], a[168:171], a[244:247], v[244:247]
v_mfma_f32_16x16x32_bf16 v[248:251], a[168:171], a[248:251], v[248:251]
s_add_u32 s37, s31, 163840
ds_read_b64_tr_b16 a[188:189], v12 offset:0
v_mfma_f32_16x16x32_bf16 v[252:255], a[168:171], a[252:255], v[252:255]
s_add_u32 m0, s33, 5120
ds_read_b64_tr_b16 a[168:169], v7 offset:0
v_mfma_f32_16x16x32_bf16 a[0:3], a[172:175], a[224:227], a[0:3]
buffer_load_dwordx4 v2, s[20:23], s37 offen  lds
ds_read_b64_tr_b16 a[170:171], v7 offset:1024
v_mfma_f32_16x16x32_bf16 a[4:7], a[172:175], a[228:231], a[4:7]
s_add_u32 s31, s31, 262144
s_add_u32 s29, s29, s44
v_xor_b32 v7, 64, v5
v_mfma_f32_16x16x32_bf16 a[8:11], a[172:175], a[232:235], a[8:11]
s_add_u32 s33, s33, 16384
ds_read_b64_tr_b16 a[190:191], v12 offset:1024
v_mfma_f32_16x16x32_bf16 a[12:15], a[172:175], a[236:239], a[12:15]
s_and_b32 s33, s33, 65535
buffer_store_dwordx4 v[60:63], v13, s[8:11], s29 offen sc1
v_mfma_f32_16x16x32_bf16 a[16:19], a[172:175], a[240:243], a[16:19]
v_mfma_f32_16x16x32_bf16 a[20:23], a[172:175], a[244:247], a[20:23]
s_mov_b32 s48, s30
v_xor_b32 v12, 208, v5
v_mfma_f32_16x16x32_bf16 a[24:27], a[172:175], a[248:251], a[24:27]
s_add_u32 m0, s32, 0
v_mfma_f32_16x16x32_bf16 a[28:31], a[172:175], a[252:255], a[28:31]
buffer_load_dwordx4 v1, s[12:15], s48 offen lds
ds_read_b64_tr_b16 a[172:173], v8 offset:0
v_mfma_f32_16x16x32_bf16 a[32:35], a[176:179], a[224:227], a[32:35]
ds_read_b64_tr_b16 a[174:175], v8 offset:1024
v_mfma_f32_16x16x32_bf16 a[36:39], a[176:179], a[228:231], a[36:39]
v_xor_b32 v8, 80, v5
v_mfma_f32_16x16x32_bf16 a[40:43], a[176:179], a[232:235], a[40:43]
v_mfma_f32_16x16x32_bf16 a[44:47], a[176:179], a[236:239], a[44:47]
v_mfma_f32_16x16x32_bf16 a[48:51], a[176:179], a[240:243], a[48:51]
s_add_u32 s48, s48, s34
v_mfma_f32_16x16x32_bf16 a[52:55], a[176:179], a[244:247], a[52:55]
s_add_u32 m0, s32, 4096
v_mfma_f32_16x16x32_bf16 a[56:59], a[176:179], a[248:251], a[56:59]
buffer_load_dwordx4 v1, s[12:15], s48 offen lds
v_mfma_f32_16x16x32_bf16 a[60:63], a[176:179], a[252:255], a[60:63]
ds_read_b64_tr_b16 a[176:177], v9 offset:0
v_mfma_f32_16x16x32_bf16 a[64:67], a[180:183], a[224:227], a[64:67]
ds_read_b64_tr_b16 a[178:179], v9 offset:1024
v_mfma_f32_16x16x32_bf16 a[68:71], a[180:183], a[228:231], a[68:71]
v_xor_b32 v9, 128, v5
v_mfma_f32_16x16x32_bf16 a[72:75], a[180:183], a[232:235], a[72:75]
v_mfma_f32_16x16x32_bf16 a[76:79], a[180:183], a[236:239], a[76:79]
s_add_u32 s48, s48, s34
v_mfma_f32_16x16x32_bf16 a[80:83], a[180:183], a[240:243], a[80:83]
s_add_u32 m0, s32, 8192
v_mfma_f32_16x16x32_bf16 a[84:87], a[180:183], a[244:247], a[84:87]
buffer_load_dwordx4 v1, s[12:15], s48 offen lds
v_mfma_f32_16x16x32_bf16 a[88:91], a[180:183], a[248:251], a[88:91]
v_mfma_f32_16x16x32_bf16 a[92:95], a[180:183], a[252:255], a[92:95]
ds_read_b64_tr_b16 a[180:181], v10 offset:0
v_mfma_f32_16x16x32_bf16 a[96:99], a[184:187], a[224:227], a[96:99]
ds_read_b64_tr_b16 a[182:183], v10 offset:1024
v_mfma_f32_16x16x32_bf16 a[100:103], a[184:187], a[228:231], a[100:103]
v_xor_b32 v10, 144, v5
v_mfma_f32_16x16x32_bf16 a[104:107], a[184:187], a[232:235], a[104:107]
s_add_u32 s48, s48, s34
v_mfma_f32_16x16x32_bf16 a[108:111], a[184:187], a[236:239], a[108:111]
s_add_u32 m0, s32, 12288
v_mfma_f32_16x16x32_bf16 a[112:115], a[184:187], a[240:243], a[112:115]
buffer_load_dwordx4 v1, s[12:15], s48 offen lds
v_mfma_f32_16x16x32_bf16 a[116:119], a[184:187], a[244:247], a[116:119]
v_mfma_f32_16x16x32_bf16 a[120:123], a[184:187], a[248:251], a[120:123]
v_mfma_f32_16x16x32_bf16 a[124:127], a[184:187], a[252:255], a[124:127]
ds_read_b64_tr_b16 a[184:185], v11 offset:0
v_mfma_f32_16x16x32_bf16 a[128:131], v[28:31], a[224:227], a[128:131]
ds_read_b64_tr_b16 a[186:187], v11 offset:1024
v_mfma_f32_16x16x32_bf16 a[132:135], v[28:31], a[228:231], a[132:135]
v_xor_b32 v11, 192, v5
v_mfma_f32_16x16x32_bf16 a[136:139], v[28:31], a[232:235], a[136:139]
buffer_load_dword v15, v14, s[96:99], s100 offen
v_mfma_f32_16x16x32_bf16 a[140:143], v[28:31], a[236:239], a[140:143]
s_add_u32 s100, s100, 16384
v_mfma_f32_16x16x32_bf16 a[144:147], v[28:31], a[240:243], a[144:147]
v_mfma_f32_16x16x32_bf16 a[148:151], v[28:31], a[244:247], a[148:151]
v_mfma_f32_16x16x32_bf16 a[152:155], v[28:31], a[248:251], a[152:155]
v_mfma_f32_16x16x32_bf16 a[156:159], v[28:31], a[252:255], a[156:159]
s_waitcnt vmcnt(23) lgkmcnt(0)
s_barrier
v_mfma_f32_16x16x32_bf16 v[160:163], a[160:163], a[192:195], v[160:163]
ds_read_b128 a[224:227], v4 offset:0
v_mfma_f32_16x16x32_bf16 v[164:167], a[160:163], a[196:199], v[164:167]
s_add_u32 s37, s31, 0
v_mfma_f32_16x16x32_bf16 v[168:171], a[160:163], a[200:203], v[168:171]
s_add_u32 m0, s33, 0
ds_read_b128 a[228:231], v3 offset:1024
v_mfma_f32_16x16x32_bf16 v[172:175], a[160:163], a[204:207], v[172:175]
buffer_load_dwordx4 v2, s[20:23], s37 offen  lds
v_mfma_f32_16x16x32_bf16 v[176:179], a[160:163], a[208:211], v[176:179]
s_add_u32 s60, s60, s92
ds_read_b128 a[232:235], v4 offset:4096
v_mfma_f32_16x16x32_bf16 v[180:183], a[160:163], a[212:215], v[180:183]
s_mov_b32 s29, s60
v_mfma_f32_16x16x32_bf16 v[184:187], a[160:163], a[216:219], v[184:187]
buffer_store_dwordx4 v[64:67], v13, s[8:11], s29 offen sc1
v_mfma_f32_16x16x32_bf16 v[188:191], a[160:163], a[220:223], v[188:191]
ds_read_b64_tr_b16 a[160:161], v5 offset:0
v_mfma_f32_16x16x32_bf16 v[192:195], a[164:167], a[192:195], v[192:195]
s_add_u32 s37, s31, 32768
ds_read_b64_tr_b16 a[162:163], v5 offset:1024
v_mfma_f32_16x16x32_bf16 v[196:199], a[164:167], a[196:199], v[196:199]
s_add_u32 m0, s33, 1024
ds_read_b128 a[236:239], v3 offset:5120
v_add_u32 v5, 16384, v5
v_mfma_f32_16x16x32_bf16 v[200:203], a[164:167], a[200:203], v[200:203]
buffer_load_dwordx4 v2, s[20:23], s37 offen  lds
v_and_b32 v5, 65535, v5
v_mfma_f32_16x16x32_bf16 v[204:207], a[164:167], a[204:207], v[204:207]
ds_read_b128 a[240:243], v4 offset:8192
v_mfma_f32_16x16x32_bf16 v[208:211], a[164:167], a[208:211], v[208:211]
v_mfma_f32_16x16x32_bf16 v[212:215], a[164:167], a[212:215], v[212:215]
ds_read_b128 a[244:247], v3 offset:9216
v_mfma_f32_16x16x32_bf16 v[216:219], a[164:167], a[216:219], v[216:219]
v_mfma_f32_16x16x32_bf16 v[220:223], a[164:167], a[220:223], v[220:223]
s_add_u32 s37, s31, 131072
ds_read_b64_tr_b16 a[164:165], v6 offset:0
v_mfma_f32_16x16x32_bf16 v[224:227], a[168:171], a[192:195], v[224:227]
s_add_u32 m0, s33, 4096
ds_read_b64_tr_b16 a[166:167], v6 offset:1024
v_mfma_f32_16x16x32_bf16 v[228:231], a[168:171], a[196:199], v[228:231]
buffer_load_dwordx4 v2, s[20:23], s37 offen  lds
v_xor_b32 v6, 16, v5
v_mfma_f32_16x16x32_bf16 v[232:235], a[168:171], a[200:203], v[232:235]
ds_read_b128 a[248:251], v4 offset:12288
v_mfma_f32_16x16x32_bf16 v[236:239], a[168:171], a[204:207], v[236:239]
v_mfma_f32_16x16x32_bf16 v[240:243], a[168:171], a[208:211], v[240:243]
ds_read_b128 a[252:255], v3 offset:13312
v_mfma_f32_16x16x32_bf16 v[244:247], a[168:171], a[212:215], v[244:247]
v_mfma_f32_16x16x32_bf16 v[248:251], a[168:171], a[216:219], v[248:251]
s_add_u32 s37, s31, 163840
ds_read_b64_tr_b16 v[28:29], v12 offset:0
v_mfma_f32_16x16x32_bf16 v[252:255], a[168:171], a[220:223], v[252:255]
s_add_u32 m0, s33, 5120
ds_read_b64_tr_b16 a[168:169], v7 offset:0
v_mfma_f32_16x16x32_bf16 a[0:3], a[172:175], a[192:195], a[0:3]
buffer_load_dwordx4 v2, s[20:23], s37 offen  lds
ds_read_b64_tr_b16 a[170:171], v7 offset:1024
v_mfma_f32_16x16x32_bf16 a[4:7], a[172:175], a[196:199], a[4:7]
s_add_u32 s31, s31, 262144
s_add_u32 s29, s29, s44
v_xor_b32 v7, 64, v5
v_mfma_f32_16x16x32_bf16 a[8:11], a[172:175], a[200:203], a[8:11]
s_add_u32 s33, s33, 16384
ds_read_b64_tr_b16 v[30:31], v12 offset:1024
v_mfma_f32_16x16x32_bf16 a[12:15], a[172:175], a[204:207], a[12:15]
s_and_b32 s33, s33, 65535
buffer_store_dwordx4 v[68:71], v13, s[8:11], s29 offen sc1
v_mfma_f32_16x16x32_bf16 a[16:19], a[172:175], a[208:211], a[16:19]
v_mfma_f32_16x16x32_bf16 a[20:23], a[172:175], a[212:215], a[20:23]
s_add_u32 s48, s48, s34
v_xor_b32 v12, 208, v5
v_mfma_f32_16x16x32_bf16 a[24:27], a[172:175], a[216:219], a[24:27]
s_add_u32 m0, s32, 16384
v_add_u32 v3, 32768, v3
v_mfma_f32_16x16x32_bf16 a[28:31], a[172:175], a[220:223], a[28:31]
buffer_load_dwordx4 v1, s[12:15], s48 offen lds
ds_read_b64_tr_b16 a[172:173], v8 offset:0
v_mfma_f32_16x16x32_bf16 a[32:35], a[176:179], a[192:195], a[32:35]
ds_read_b64_tr_b16 a[174:175], v8 offset:1024
v_subrev_u32 v19, 98304, v3
v_mfma_f32_16x16x32_bf16 a[36:39], a[176:179], a[196:199], a[36:39]
v_xor_b32 v8, 80, v5
v_cmp_le_u32 vcc, 163840, v3
v_mfma_f32_16x16x32_bf16 a[40:43], a[176:179], a[200:203], a[40:43]
s_nop 0
v_cndmask_b32 v3, v3, v19, vcc
v_mfma_f32_16x16x32_bf16 a[44:47], a[176:179], a[204:207], a[44:47]
v_xor_b32 v4, 64, v3
v_mfma_f32_16x16x32_bf16 a[48:51], a[176:179], a[208:211], a[48:51]
s_add_u32 s48, s48, s34
v_mfma_f32_16x16x32_bf16 a[52:55], a[176:179], a[212:215], a[52:55]
s_add_u32 m0, s32, 20480
v_mfma_f32_16x16x32_bf16 a[56:59], a[176:179], a[216:219], a[56:59]
buffer_load_dwordx4 v1, s[12:15], s48 offen lds
v_mfma_f32_16x16x32_bf16 a[60:63], a[176:179], a[220:223], a[60:63]
ds_read_b64_tr_b16 a[176:177], v9 offset:0
v_mfma_f32_16x16x32_bf16 a[64:67], a[180:183], a[192:195], a[64:67]
ds_read_b64_tr_b16 a[178:179], v9 offset:1024
v_mfma_f32_16x16x32_bf16 a[68:71], a[180:183], a[196:199], a[68:71]
v_xor_b32 v9, 128, v5
v_mfma_f32_16x16x32_bf16 a[72:75], a[180:183], a[200:203], a[72:75]
v_mfma_f32_16x16x32_bf16 a[76:79], a[180:183], a[204:207], a[76:79]
s_add_u32 s48, s48, s34
v_mfma_f32_16x16x32_bf16 a[80:83], a[180:183], a[208:211], a[80:83]
s_add_u32 m0, s32, 24576
v_mfma_f32_16x16x32_bf16 a[84:87], a[180:183], a[212:215], a[84:87]
buffer_load_dwordx4 v1, s[12:15], s48 offen lds
v_mfma_f32_16x16x32_bf16 a[88:91], a[180:183], a[216:219], a[88:91]
s_add_u32 s29, s29, s93
v_mfma_f32_16x16x32_bf16 a[92:95], a[180:183], a[220:223], a[92:95]
ds_read_b64_tr_b16 a[180:181], v10 offset:0
v_mfma_f32_16x16x32_bf16 a[96:99], a[184:187], a[192:195], a[96:99]
buffer_store_dwordx4 v[72:75], v13, s[8:11], s29 offen sc1
ds_read_b64_tr_b16 a[182:183], v10 offset:1024
v_mfma_f32_16x16x32_bf16 a[100:103], a[184:187], a[196:199], a[100:103]
v_xor_b32 v10, 144, v5
v_mfma_f32_16x16x32_bf16 a[104:107], a[184:187], a[200:203], a[104:107]
s_add_u32 s48, s48, s34
v_mfma_f32_16x16x32_bf16 a[108:111], a[184:187], a[204:207], a[108:111]
s_add_u32 m0, s32, 28672
v_mfma_f32_16x16x32_bf16 a[112:115], a[184:187], a[208:211], a[112:115]
buffer_load_dwordx4 v1, s[12:15], s48 offen lds
v_mfma_f32_16x16x32_bf16 a[116:119], a[184:187], a[212:215], a[116:119]
s_add_u32 s30, s30, 128
v_mfma_f32_16x16x32_bf16 a[120:123], a[184:187], a[216:219], a[120:123]
s_add_u32 s32, s32, 32768
v_mfma_f32_16x16x32_bf16 a[124:127], a[184:187], a[220:223], a[124:127]
s_sub_u32 s48, s32, 98304
ds_read_b64_tr_b16 a[184:185], v11 offset:0
v_mfma_f32_16x16x32_bf16 a[128:131], a[188:191], a[192:195], a[128:131]
s_cmp_ge_u32 s32, 163840
s_cselect_b32 s32, s48, s32
ds_read_b64_tr_b16 a[186:187], v11 offset:1024
v_mfma_f32_16x16x32_bf16 a[132:135], a[188:191], a[196:199], a[132:135]
v_xor_b32 v11, 192, v5
v_mfma_f32_16x16x32_bf16 a[136:139], a[188:191], a[200:203], a[136:139]
buffer_load_dword v15, v14, s[96:99], s100 offen
v_mfma_f32_16x16x32_bf16 a[140:143], a[188:191], a[204:207], a[140:143]
s_add_u32 s100, s100, 16384
v_mfma_f32_16x16x32_bf16 a[144:147], a[188:191], a[208:211], a[144:147]
v_mfma_f32_16x16x32_bf16 a[148:151], a[188:191], a[212:215], a[148:151]
v_mfma_f32_16x16x32_bf16 a[152:155], a[188:191], a[216:219], a[152:155]
v_mfma_f32_16x16x32_bf16 a[156:159], a[188:191], a[220:223], a[156:159]
s_waitcnt vmcnt(23) lgkmcnt(0)
s_barrier
v_mfma_f32_16x16x32_bf16 v[160:163], a[160:163], a[224:227], v[160:163]
ds_read_b128 a[192:195], v3 offset:0
v_mfma_f32_16x16x32_bf16 v[164:167], a[160:163], a[228:231], v[164:167]
s_add_u32 s37, s31, 0
v_mfma_f32_16x16x32_bf16 v[168:171], a[160:163], a[232:235], v[168:171]
s_add_u32 m0, s33, 0
ds_read_b128 a[196:199], v4 offset:1024
v_mfma_f32_16x16x32_bf16 v[172:175], a[160:163], a[236:239], v[172:175]
buffer_load_dwordx4 v2, s[20:23], s37 offen  lds
v_mfma_f32_16x16x32_bf16 v[176:179], a[160:163], a[240:243], v[176:179]
s_add_u32 s29, s29, s44
ds_read_b128 a[200:203], v3 offset:4096
v_mfma_f32_16x16x32_bf16 v[180:183], a[160:163], a[244:247], v[180:183]
v_mfma_f32_16x16x32_bf16 v[184:187], a[160:163], a[248:251], v[184:187]
buffer_store_dwordx4 v[76:79], v13, s[8:11], s29 offen sc1
v_mfma_f32_16x16x32_bf16 v[188:191], a[160:163], a[252:255], v[188:191]
ds_read_b64_tr_b16 a[160:161], v5 offset:0
v_mfma_f32_16x16x32_bf16 v[192:195], a[164:167], a[224:227], v[192:195]
s_add_u32 s37, s31, 32768
ds_read_b64_tr_b16 a[162:163], v5 offset:1024
v_mfma_f32_16x16x32_bf16 v[196:199], a[164:167], a[228:231], v[196:199]
s_add_u32 m0, s33, 1024
ds_read_b128 a[204:207], v4 offset:5120
v_add_u32 v5, 16384, v5
v_mfma_f32_16x16x32_bf16 v[200:203], a[164:167], a[232:235], v[200:203]
buffer_load_dwordx4 v2, s[20:23], s37 offen  lds
v_and_b32 v5, 65535, v5
v_mfma_f32_16x16x32_bf16 v[204:207], a[164:167], a[236:239], v[204:207]
ds_read_b128 a[208:211], v3 offset:8192
v_mfma_f32_16x16x32_bf16 v[208:211], a[164:167], a[240:243], v[208:211]
v_mfma_f32_16x16x32_bf16 v[212:215], a[164:167], a[244:247], v[212:215]
ds_read_b128 a[212:215], v4 offset:9216
v_mfma_f32_16x16x32_bf16 v[216:219], a[164:167], a[248:251], v[216:219]
v_mfma_f32_16x16x32_bf16 v[220:223], a[164:167], a[252:255], v[220:223]
s_add_u32 s37, s31, 131072
ds_read_b64_tr_b16 a[164:165], v6 offset:0
v_mfma_f32_16x16x32_bf16 v[224:227], a[168:171], a[224:227], v[224:227]
s_add_u32 m0, s33, 4096
ds_read_b64_tr_b16 a[166:167], v6 offset:1024
v_mfma_f32_16x16x32_bf16 v[228:231], a[168:171], a[228:231], v[228:231]
buffer_load_dwordx4 v2, s[20:23], s37 offen  lds
v_xor_b32 v6, 16, v5
v_mfma_f32_16x16x32_bf16 v[232:235], a[168:171], a[232:235], v[232:235]
ds_read_b128 a[216:219], v3 offset:12288
v_mfma_f32_16x16x32_bf16 v[236:239], a[168:171], a[236:239], v[236:239]
v_mfma_f32_16x16x32_bf16 v[240:243], a[168:171], a[240:243], v[240:243]
ds_read_b128 a[220:223], v4 offset:13312
v_mfma_f32_16x16x32_bf16 v[244:247], a[168:171], a[244:247], v[244:247]
v_mfma_f32_16x16x32_bf16 v[248:251], a[168:171], a[248:251], v[248:251]
s_add_u32 s37, s31, 163840
ds_read_b64_tr_b16 a[188:189], v12 offset:0
v_mfma_f32_16x16x32_bf16 v[252:255], a[168:171], a[252:255], v[252:255]
s_add_u32 m0, s33, 5120
ds_read_b64_tr_b16 a[168:169], v7 offset:0
v_mfma_f32_16x16x32_bf16 a[0:3], a[172:175], a[224:227], a[0:3]
buffer_load_dwordx4 v2, s[20:23], s37 offen  lds
ds_read_b64_tr_b16 a[170:171], v7 offset:1024
v_mfma_f32_16x16x32_bf16 a[4:7], a[172:175], a[228:231], a[4:7]
s_add_u32 s31, s31, 262144
s_add_u32 s29, s29, s93
v_xor_b32 v7, 64, v5
v_mfma_f32_16x16x32_bf16 a[8:11], a[172:175], a[232:235], a[8:11]
s_add_u32 s33, s33, 16384
ds_read_b64_tr_b16 a[190:191], v12 offset:1024
v_mfma_f32_16x16x32_bf16 a[12:15], a[172:175], a[236:239], a[12:15]
s_and_b32 s33, s33, 65535
buffer_store_dwordx4 v[80:83], v13, s[8:11], s29 offen sc1
v_mfma_f32_16x16x32_bf16 a[16:19], a[172:175], a[240:243], a[16:19]
v_mfma_f32_16x16x32_bf16 a[20:23], a[172:175], a[244:247], a[20:23]
s_mov_b32 s48, s30
v_xor_b32 v12, 208, v5
v_mfma_f32_16x16x32_bf16 a[24:27], a[172:175], a[248:251], a[24:27]
s_add_u32 m0, s32, 0
v_mfma_f32_16x16x32_bf16 a[28:31], a[172:175], a[252:255], a[28:31]
buffer_load_dwordx4 v1, s[12:15], s48 offen lds
ds_read_b64_tr_b16 a[172:173], v8 offset:0
v_mfma_f32_16x16x32_bf16 a[32:35], a[176:179], a[224:227], a[32:35]
ds_read_b64_tr_b16 a[174:175], v8 offset:1024
v_mfma_f32_16x16x32_bf16 a[36:39], a[176:179], a[228:231], a[36:39]
v_xor_b32 v8, 80, v5
v_mfma_f32_16x16x32_bf16 a[40:43], a[176:179], a[232:235], a[40:43]
v_mfma_f32_16x16x32_bf16 a[44:47], a[176:179], a[236:239], a[44:47]
v_mfma_f32_16x16x32_bf16 a[48:51], a[176:179], a[240:243], a[48:51]
s_add_u32 s48, s48, s34
v_mfma_f32_16x16x32_bf16 a[52:55], a[176:179], a[244:247], a[52:55]
s_add_u32 m0, s32, 4096
v_mfma_f32_16x16x32_bf16 a[56:59], a[176:179], a[248:251], a[56:59]
buffer_load_dwordx4 v1, s[12:15], s48 offen lds
v_mfma_f32_16x16x32_bf16 a[60:63], a[176:179], a[252:255], a[60:63]
ds_read_b64_tr_b16 a[176:177], v9 offset:0
v_mfma_f32_16x16x32_bf16 a[64:67], a[180:183], a[224:227], a[64:67]
ds_read_b64_tr_b16 a[178:179], v9 offset:1024
v_mfma_f32_16x16x32_bf16 a[68:71], a[180:183], a[228:231], a[68:71]
v_xor_b32 v9, 128, v5
v_mfma_f32_16x16x32_bf16 a[72:75], a[180:183], a[232:235], a[72:75]
v_mfma_f32_16x16x32_bf16 a[76:79], a[180:183], a[236:239], a[76:79]
s_add_u32 s48, s48, s34
v_mfma_f32_16x16x32_bf16 a[80:83], a[180:183], a[240:243], a[80:83]
s_add_u32 m0, s32, 8192
v_mfma_f32_16x16x32_bf16 a[84:87], a[180:183], a[244:247], a[84:87]
buffer_load_dwordx4 v1, s[12:15], s48 offen lds
v_mfma_f32_16x16x32_bf16 a[88:91], a[180:183], a[248:251], a[88:91]
s_add_u32 s29, s29, s44
v_mfma_f32_16x16x32_bf16 a[92:95], a[180:183], a[252:255], a[92:95]
ds_read_b64_tr_b16 a[180:181], v10 offset:0
v_mfma_f32_16x16x32_bf16 a[96:99], a[184:187], a[224:227], a[96:99]
buffer_store_dwordx4 v[84:87], v13, s[8:11], s29 offen sc1
ds_read_b64_tr_b16 a[182:183], v10 offset:1024
v_mfma_f32_16x16x32_bf16 a[100:103], a[184:187], a[228:231], a[100:103]
v_xor_b32 v10, 144, v5
v_mfma_f32_16x16x32_bf16 a[104:107], a[184:187], a[232:235], a[104:107]
s_add_u32 s48, s48, s34
v_mfma_f32_16x16x32_bf16 a[108:111], a[184:187], a[236:239], a[108:111]
s_add_u32 m0, s32, 12288
v_mfma_f32_16x16x32_bf16 a[112:115], a[184:187], a[240:243], a[112:115]
buffer_load_dwordx4 v1, s[12:15], s48 offen lds
v_mfma_f32_16x16x32_bf16 a[116:119], a[184:187], a[244:247], a[116:119]
v_mfma_f32_16x16x32_bf16 a[120:123], a[184:187], a[248:251], a[120:123]
v_mfma_f32_16x16x32_bf16 a[124:127], a[184:187], a[252:255], a[124:127]
ds_read_b64_tr_b16 a[184:185], v11 offset:0
v_mfma_f32_16x16x32_bf16 a[128:131], v[28:31], a[224:227], a[128:131]
ds_read_b64_tr_b16 a[186:187], v11 offset:1024
v_mfma_f32_16x16x32_bf16 a[132:135], v[28:31], a[228:231], a[132:135]
v_xor_b32 v11, 192, v5
v_mfma_f32_16x16x32_bf16 a[136:139], v[28:31], a[232:235], a[136:139]
buffer_load_dword v15, v14, s[96:99], s100 offen
v_mfma_f32_16x16x32_bf16 a[140:143], v[28:31], a[236:239], a[140:143]
s_add_u32 s100, s100, 16384
v_mfma_f32_16x16x32_bf16 a[144:147], v[28:31], a[240:243], a[144:147]
v_mfma_f32_16x16x32_bf16 a[148:151], v[28:31], a[244:247], a[148:151]
v_mfma_f32_16x16x32_bf16 a[152:155], v[28:31], a[248:251], a[152:155]
v_mfma_f32_16x16x32_bf16 a[156:159], v[28:31], a[252:255], a[156:159]
s_waitcnt vmcnt(24) lgkmcnt(0)
s_barrier
v_mfma_f32_16x16x32_bf16 v[160:163], a[160:163], a[192:195], v[160:163]
ds_read_b128 a[224:227], v4 offset:0
v_mfma_f32_16x16x32_bf16 v[164:167], a[160:163], a[196:199], v[164:167]
s_add_u32 s37, s31, 0
v_mfma_f32_16x16x32_bf16 v[168:171], a[160:163], a[200:203], v[168:171]
s_add_u32 m0, s33, 0
ds_read_b128 a[228:231], v3 offset:1024
v_mfma_f32_16x16x32_bf16 v[172:175], a[160:163], a[204:207], v[172:175]
buffer_load_dwordx4 v2, s[20:23], s37 offen  lds
v_mfma_f32_16x16x32_bf16 v[176:179], a[160:163], a[208:211], v[176:179]
s_add_u32 s29, s29, s93
ds_read_b128 a[232:235], v4 offset:4096
v_mfma_f32_16x16x32_bf16 v[180:183], a[160:163], a[212:215], v[180:183]
v_mfma_f32_16x16x32_bf16 v[184:187], a[160:163], a[216:219], v[184:187]
buffer_store_dwordx4 v[88:91], v13, s[8:11], s29 offen sc1
v_mfma_f32_16x16x32_bf16 v[188:191], a[160:163], a[220:223], v[188:191]
ds_read_b64_tr_b16 a[160:161], v5 offset:0
v_mfma_f32_16x16x32_bf16 v[192:195], a[164:167], a[192:195], v[192:195]
s_add_u32 s37, s31, 32768
ds_read_b64_tr_b16 a[162:163], v5 offset:1024
v_mfma_f32_16x16x32_bf16 v[196:199], a[164:167], a[196:199], v[196:199]
s_add_u32 m0, s33, 1024
ds_read_b128 a[236:239], v3 offset:5120
v_add_u32 v5, 16384, v5
v_mfma_f32_16x16x32_bf16 v[200:203], a[164:167], a[200:203], v[200:203]
buffer_load_dwordx4 v2, s[20:23], s37 offen  lds
v_and_b32 v5, 65535, v5
v_mfma_f32_16x16x32_bf16 v[204:207], a[164:167], a[204:207], v[204:207]
ds_read_b128 a[240:243], v4 offset:8192
v_mfma_f32_16x16x32_bf16 v[208:211], a[164:167], a[208:211], v[208:211]
v_mfma_f32_16x16x32_bf16 v[212:215], a[164:167], a[212:215], v[212:215]
ds_read_b128 a[244:247], v3 offset:9216
v_mfma_f32_16x16x32_bf16 v[216:219], a[164:167], a[216:219], v[216:219]
v_mfma_f32_16x16x32_bf16 v[220:223], a[164:167], a[220:223], v[220:223]
s_add_u32 s37, s31, 131072
ds_read_b64_tr_b16 a[164:165], v6 offset:0
v_mfma_f32_16x16x32_bf16 v[224:227], a[168:171], a[192:195], v[224:227]
s_add_u32 m0, s33, 4096
ds_read_b64_tr_b16 a[166:167], v6 offset:1024
v_mfma_f32_16x16x32_bf16 v[228:231], a[168:171], a[196:199], v[228:231]
buffer_load_dwordx4 v2, s[20:23], s37 offen  lds
v_xor_b32 v6, 16, v5
v_mfma_f32_16x16x32_bf16 v[232:235], a[168:171], a[200:203], v[232:235]
ds_read_b128 a[248:251], v4 offset:12288
v_mfma_f32_16x16x32_bf16 v[236:239], a[168:171], a[204:207], v[236:239]
v_mfma_f32_16x16x32_bf16 v[240:243], a[168:171], a[208:211], v[240:243]
ds_read_b128 a[252:255], v3 offset:13312
v_mfma_f32_16x16x32_bf16 v[244:247], a[168:171], a[212:215], v[244:247]
v_mfma_f32_16x16x32_bf16 v[248:251], a[168:171], a[216:219], v[248:251]
s_add_u32 s37, s31, 163840
ds_read_b64_tr_b16 v[28:29], v12 offset:0
v_mfma_f32_16x16x32_bf16 v[252:255], a[168:171], a[220:223], v[252:255]
s_add_u32 m0, s33, 5120
ds_read_b64_tr_b16 a[168:169], v7 offset:0
v_mfma_f32_16x16x32_bf16 a[0:3], a[172:175], a[192:195], a[0:3]
buffer_load_dwordx4 v2, s[20:23], s37 offen  lds
ds_read_b64_tr_b16 a[170:171], v7 offset:1024
v_mfma_f32_16x16x32_bf16 a[4:7], a[172:175], a[196:199], a[4:7]
s_add_u32 s31, s31, 262144
s_add_u32 s29, s29, s44
v_xor_b32 v7, 64, v5
v_mfma_f32_16x16x32_bf16 a[8:11], a[172:175], a[200:203], a[8:11]
s_add_u32 s33, s33, 16384
ds_read_b64_tr_b16 v[30:31], v12 offset:1024
v_mfma_f32_16x16x32_bf16 a[12:15], a[172:175], a[204:207], a[12:15]
s_and_b32 s33, s33, 65535
buffer_store_dwordx4 v[92:95], v13, s[8:11], s29 offen sc1
v_mfma_f32_16x16x32_bf16 a[16:19], a[172:175], a[208:211], a[16:19]
v_mfma_f32_16x16x32_bf16 a[20:23], a[172:175], a[212:215], a[20:23]
s_add_u32 s48, s48, s34
v_xor_b32 v12, 208, v5
v_mfma_f32_16x16x32_bf16 a[24:27], a[172:175], a[216:219], a[24:27]
s_add_u32 m0, s32, 16384
v_add_u32 v3, 32768, v3
v_mfma_f32_16x16x32_bf16 a[28:31], a[172:175], a[220:223], a[28:31]
buffer_load_dwordx4 v1, s[12:15], s48 offen lds
ds_read_b64_tr_b16 a[172:173], v8 offset:0
v_mfma_f32_16x16x32_bf16 a[32:35], a[176:179], a[192:195], a[32:35]
ds_read_b64_tr_b16 a[174:175], v8 offset:1024
v_subrev_u32 v19, 98304, v3
v_mfma_f32_16x16x32_bf16 a[36:39], a[176:179], a[196:199], a[36:39]
v_xor_b32 v8, 80, v5
v_cmp_le_u32 vcc, 163840, v3
v_mfma_f32_16x16x32_bf16 a[40:43], a[176:179], a[200:203], a[40:43]
s_nop 0
v_cndmask_b32 v3, v3, v19, vcc
v_mfma_f32_16x16x32_bf16 a[44:47], a[176:179], a[204:207], a[44:47]
v_xor_b32 v4, 64, v3
v_mfma_f32_16x16x32_bf16 a[48:51], a[176:179], a[208:211], a[48:51]
s_add_u32 s48, s48, s34
v_mfma_f32_16x16x32_bf16 a[52:55], a[176:179], a[212:215], a[52:55]
s_add_u32 m0, s32, 20480
v_mfma_f32_16x16x32_bf16 a[56:59], a[176:179], a[216:219], a[56:59]
buffer_load_dwordx4 v1, s[12:15], s48 offen lds
v_mfma_f32_16x16x32_bf16 a[60:63], a[176:179], a[220:223], a[60:63]
ds_read_b64_tr_b16 a[176:177], v9 offset:0
v_mfma_f32_16x16x32_bf16 a[64:67], a[180:183], a[192:195], a[64:67]
ds_read_b64_tr_b16 a[178:179], v9 offset:1024
v_mfma_f32_16x16x32_bf16 a[68:71], a[180:183], a[196:199], a[68:71]
v_xor_b32 v9, 128, v5
v_mfma_f32_16x16x32_bf16 a[72:75], a[180:183], a[200:203], a[72:75]
v_mfma_f32_16x16x32_bf16 a[76:79], a[180:183], a[204:207], a[76:79]
s_add_u32 s48, s48, s34
v_mfma_f32_16x16x32_bf16 a[80:83], a[180:183], a[208:211], a[80:83]
s_add_u32 m0, s32, 24576
v_mfma_f32_16x16x32_bf16 a[84:87], a[180:183], a[212:215], a[84:87]
buffer_load_dwordx4 v1, s[12:15], s48 offen lds
v_mfma_f32_16x16x32_bf16 a[88:91], a[180:183], a[216:219], a[88:91]
v_mfma_f32_16x16x32_bf16 a[92:95], a[180:183], a[220:223], a[92:95]
ds_read_b64_tr_b16 a[180:181], v10 offset:0
v_mfma_f32_16x16x32_bf16 a[96:99], a[184:187], a[192:195], a[96:99]
ds_read_b64_tr_b16 a[182:183], v10 offset:1024
v_mfma_f32_16x16x32_bf16 a[100:103], a[184:187], a[196:199], a[100:103]
v_xor_b32 v10, 144, v5
v_mfma_f32_16x16x32_bf16 a[104:107], a[184:187], a[200:203], a[104:107]
s_add_u32 s48, s48, s34
v_mfma_f32_16x16x32_bf16 a[108:111], a[184:187], a[204:207], a[108:111]
s_add_u32 m0, s32, 28672
v_mfma_f32_16x16x32_bf16 a[112:115], a[184:187], a[208:211], a[112:115]
buffer_load_dwordx4 v1, s[12:15], s48 offen lds
v_mfma_f32_16x16x32_bf16 a[116:119], a[184:187], a[212:215], a[116:119]
s_add_u32 s30, s30, 128
v_mfma_f32_16x16x32_bf16 a[120:123], a[184:187], a[216:219], a[120:123]
s_add_u32 s32, s32, 32768
v_mfma_f32_16x16x32_bf16 a[124:127], a[184:187], a[220:223], a[124:127]
s_sub_u32 s48, s32, 98304
ds_read_b64_tr_b16 a[184:185], v11 offset:0
v_mfma_f32_16x16x32_bf16 a[128:131], a[188:191], a[192:195], a[128:131]
s_cmp_ge_u32 s32, 163840
s_cselect_b32 s32, s48, s32
ds_read_b64_tr_b16 a[186:187], v11 offset:1024
v_mfma_f32_16x16x32_bf16 a[132:135], a[188:191], a[196:199], a[132:135]
v_xor_b32 v11, 192, v5
v_mfma_f32_16x16x32_bf16 a[136:139], a[188:191], a[200:203], a[136:139]
buffer_load_dword v15, v14, s[96:99], s100 offen
v_mfma_f32_16x16x32_bf16 a[140:143], a[188:191], a[204:207], a[140:143]
s_add_u32 s100, s100, 16384
v_mfma_f32_16x16x32_bf16 a[144:147], a[188:191], a[208:211], a[144:147]
v_mfma_f32_16x16x32_bf16 a[148:151], a[188:191], a[212:215], a[148:151]
v_mfma_f32_16x16x32_bf16 a[152:155], a[188:191], a[216:219], a[152:155]
v_mfma_f32_16x16x32_bf16 a[156:159], a[188:191], a[220:223], a[156:159]
s_waitcnt vmcnt(23) lgkmcnt(0)
s_barrier
v_mfma_f32_16x16x32_bf16 v[160:163], a[160:163], a[224:227], v[160:163]
ds_read_b128 a[192:195], v3 offset:0
v_mfma_f32_16x16x32_bf16 v[164:167], a[160:163], a[228:231], v[164:167]
s_add_u32 s37, s31, 0
v_mfma_f32_16x16x32_bf16 v[168:171], a[160:163], a[232:235], v[168:171]
s_add_u32 m0, s33, 0
ds_read_b128 a[196:199], v4 offset:1024
v_mfma_f32_16x16x32_bf16 v[172:175], a[160:163], a[236:239], v[172:175]
buffer_load_dwordx4 v2, s[20:23], s37 offen  lds
v_mfma_f32_16x16x32_bf16 v[176:179], a[160:163], a[240:243], v[176:179]
s_add_u32 s60, s60, s92
ds_read_b128 a[200:203], v3 offset:4096
v_mfma_f32_16x16x32_bf16 v[180:183], a[160:163], a[244:247], v[180:183]
s_mov_b32 s29, s60
v_mfma_f32_16x16x32_bf16 v[184:187], a[160:163], a[248:251], v[184:187]
buffer_store_dwordx4 v[96:99], v13, s[8:11], s29 offen sc1
v_mfma_f32_16x16x32_bf16 v[188:191], a[160:163], a[252:255], v[188:191]
ds_read_b64_tr_b16 a[160:161], v5 offset:0
v_mfma_f32_16x16x32_bf16 v[192:195], a[164:167], a[224:227], v[192:195]
s_add_u32 s37, s31, 32768
ds_read_b64_tr_b16 a[162:163], v5 offset:1024
v_mfma_f32_16x16x32_bf16 v[196:199], a[164:167], a[228:231], v[196:199]
s_add_u32 m0, s33, 1024
ds_read_b128 a[204:207], v4 offset:5120
v_add_u32 v5, 16384, v5
v_mfma_f32_16x16x32_bf16 v[200:203], a[164:167], a[232:235], v[200:203]
buffer_load_dwordx4 v2, s[20:23], s37 offen  lds
v_and_b32 v5, 65535, v5
v_mfma_f32_16x16x32_bf16 v[204:207], a[164:167], a[236:239], v[204:207]
ds_read_b128 a[208:211], v3 offset:8192
v_mfma_f32_16x16x32_bf16 v[208:211], a[164:167], a[240:243], v[208:211]
v_mfma_f32_16x16x32_bf16 v[212:215], a[164:167], a[244:247], v[212:215]
ds_read_b128 a[212:215], v4 offset:9216
v_mfma_f32_16x16x32_bf16 v[216:219], a[164:167], a[248:251], v[216:219]
v_mfma_f32_16x16x32_bf16 v[220:223], a[164:167], a[252:255], v[220:223]
s_add_u32 s37, s31, 131072
ds_read_b64_tr_b16 a[164:165], v6 offset:0
v_mfma_f32_16x16x32_bf16 v[224:227], a[168:171], a[224:227], v[224:227]
s_add_u32 m0, s33, 4096
ds_read_b64_tr_b16 a[166:167], v6 offset:1024
v_mfma_f32_16x16x32_bf16 v[228:231], a[168:171], a[228:231], v[228:231]
buffer_load_dwordx4 v2, s[20:23], s37 offen  lds
v_xor_b32 v6, 16, v5
v_mfma_f32_16x16x32_bf16 v[232:235], a[168:171], a[232:235], v[232:235]
ds_read_b128 a[216:219], v3 offset:12288
v_mfma_f32_16x16x32_bf16 v[236:239], a[168:171], a[236:239], v[236:239]
v_mfma_f32_16x16x32_bf16 v[240:243], a[168:171], a[240:243], v[240:243]
ds_read_b128 a[220:223], v4 offset:13312
v_mfma_f32_16x16x32_bf16 v[244:247], a[168:171], a[244:247], v[244:247]
v_mfma_f32_16x16x32_bf16 v[248:251], a[168:171], a[248:251], v[248:251]
s_add_u32 s37, s31, 163840
ds_read_b64_tr_b16 a[188:189], v12 offset:0
v_mfma_f32_16x16x32_bf16 v[252:255], a[168:171], a[252:255], v[252:255]
s_add_u32 m0, s33, 5120
ds_read_b64_tr_b16 a[168:169], v7 offset:0
v_mfma_f32_16x16x32_bf16 a[0:3], a[172:175], a[224:227], a[0:3]
buffer_load_dwordx4 v2, s[20:23], s37 offen  lds
ds_read_b64_tr_b16 a[170:171], v7 offset:1024
v_mfma_f32_16x16x32_bf16 a[4:7], a[172:175], a[228:231], a[4:7]
s_add_u32 s31, s31, 262144
s_add_u32 s29, s29, s44
v_xor_b32 v7, 64, v5
v_mfma_f32_16x16x32_bf16 a[8:11], a[172:175], a[232:235], a[8:11]
s_add_u32 s33, s33, 16384
ds_read_b64_tr_b16 a[190:191], v12 offset:1024
v_mfma_f32_16x16x32_bf16 a[12:15], a[172:175], a[236:239], a[12:15]
s_and_b32 s33, s33, 65535
buffer_store_dwordx4 v[100:103], v13, s[8:11], s29 offen sc1
v_mfma_f32_16x16x32_bf16 a[16:19], a[172:175], a[240:243], a[16:19]
v_mfma_f32_16x16x32_bf16 a[20:23], a[172:175], a[244:247], a[20:23]
s_mov_b32 s48, s30
v_xor_b32 v12, 208, v5
v_mfma_f32_16x16x32_bf16 a[24:27], a[172:175], a[248:251], a[24:27]
s_add_u32 m0, s32, 0
v_mfma_f32_16x16x32_bf16 a[28:31], a[172:175], a[252:255], a[28:31]
buffer_load_dwordx4 v1, s[12:15], s48 offen lds
ds_read_b64_tr_b16 a[172:173], v8 offset:0
v_mfma_f32_16x16x32_bf16 a[32:35], a[176:179], a[224:227], a[32:35]
ds_read_b64_tr_b16 a[174:175], v8 offset:1024
v_mfma_f32_16x16x32_bf16 a[36:39], a[176:179], a[228:231], a[36:39]
v_xor_b32 v8, 80, v5
v_mfma_f32_16x16x32_bf16 a[40:43], a[176:179], a[232:235], a[40:43]
v_mfma_f32_16x16x32_bf16 a[44:47], a[176:179], a[236:239], a[44:47]
v_mfma_f32_16x16x32_bf16 a[48:51], a[176:179], a[240:243], a[48:51]
s_add_u32 s48, s48, s34
v_mfma_f32_16x16x32_bf16 a[52:55], a[176:179], a[244:247], a[52:55]
s_add_u32 m0, s32, 4096
v_mfma_f32_16x16x32_bf16 a[56:59], a[176:179], a[248:251], a[56:59]
buffer_load_dwordx4 v1, s[12:15], s48 offen lds
v_mfma_f32_16x16x32_bf16 a[60:63], a[176:179], a[252:255], a[60:63]
ds_read_b64_tr_b16 a[176:177], v9 offset:0
v_mfma_f32_16x16x32_bf16 a[64:67], a[180:183], a[224:227], a[64:67]
ds_read_b64_tr_b16 a[178:179], v9 offset:1024
v_mfma_f32_16x16x32_bf16 a[68:71], a[180:183], a[228:231], a[68:71]
v_xor_b32 v9, 128, v5
v_mfma_f32_16x16x32_bf16 a[72:75], a[180:183], a[232:235], a[72:75]
v_mfma_f32_16x16x32_bf16 a[76:79], a[180:183], a[236:239], a[76:79]
s_add_u32 s48, s48, s34
v_mfma_f32_16x16x32_bf16 a[80:83], a[180:183], a[240:243], a[80:83]
s_add_u32 m0, s32, 8192
v_mfma_f32_16x16x32_bf16 a[84:87], a[180:183], a[244:247], a[84:87]
buffer_load_dwordx4 v1, s[12:15], s48 offen lds
v_mfma_f32_16x16x32_bf16 a[88:91], a[180:183], a[248:251], a[88:91]
s_add_u32 s29, s29, s93
v_mfma_f32_16x16x32_bf16 a[92:95], a[180:183], a[252:255], a[92:95]
ds_read_b64_tr_b16 a[180:181], v10 offset:0
v_mfma_f32_16x16x32_bf16 a[96:99], a[184:187], a[224:227], a[96:99]
buffer_store_dwordx4 v[104:107], v13, s[8:11], s29 offen sc1
ds_read_b64_tr_b16 a[182:183], v10 offset:1024
v_mfma_f32_16x16x32_bf16 a[100:103], a[184:187], a[228:231], a[100:103]
v_xor_b32 v10, 144, v5
v_mfma_f32_16x16x32_bf16 a[104:107], a[184:187], a[232:235], a[104:107]
s_add_u32 s48, s48, s34
v_mfma_f32_16x16x32_bf16 a[108:111], a[184:187], a[236:239], a[108:111]
s_add_u32 m0, s32, 12288
v_mfma_f32_16x16x32_bf16 a[112:115], a[184:187], a[240:243], a[112:115]
buffer_load_dwordx4 v1, s[12:15], s48 offen lds
v_mfma_f32_16x16x32_bf16 a[116:119], a[184:187], a[244:247], a[116:119]
v_mfma_f32_16x16x32_bf16 a[120:123], a[184:187], a[248:251], a[120:123]
v_mfma_f32_16x16x32_bf16 a[124:127], a[184:187], a[252:255], a[124:127]
ds_read_b64_tr_b16 a[184:185], v11 offset:0
v_mfma_f32_16x16x32_bf16 a[128:131], v[28:31], a[224:227], a[128:131]
ds_read_b64_tr_b16 a[186:187], v11 offset:1024
v_mfma_f32_16x16x32_bf16 a[132:135], v[28:31], a[228:231], a[132:135]
v_xor_b32 v11, 192, v5
v_mfma_f32_16x16x32_bf16 a[136:139], v[28:31], a[232:235], a[136:139]
buffer_load_dword v15, v14, s[96:99], s100 offen
v_mfma_f32_16x16x32_bf16 a[140:143], v[28:31], a[236:239], a[140:143]
s_add_u32 s100, s100, 16384
v_mfma_f32_16x16x32_bf16 a[144:147], v[28:31], a[240:243], a[144:147]
v_mfma_f32_16x16x32_bf16 a[148:151], v[28:31], a[244:247], a[148:151]
v_mfma_f32_16x16x32_bf16 a[152:155], v[28:31], a[248:251], a[152:155]
v_mfma_f32_16x16x32_bf16 a[156:159], v[28:31], a[252:255], a[156:159]
s_waitcnt vmcnt(23) lgkmcnt(0)
s_barrier
v_mfma_f32_16x16x32_bf16 v[160:163], a[160:163], a[192:195], v[160:163]
ds_read_b128 a[224:227], v4 offset:0
v_mfma_f32_16x16x32_bf16 v[164:167], a[160:163], a[196:199], v[164:167]
s_add_u32 s37, s31, 0
v_mfma_f32_16x16x32_bf16 v[168:171], a[160:163], a[200:203], v[168:171]
s_add_u32 m0, s33, 0
ds_read_b128 a[228:231], v3 offset:1024
v_mfma_f32_16x16x32_bf16 v[172:175], a[160:163], a[204:207], v[172:175]
buffer_load_dwordx4 v2, s[20:23], s37 offen  lds
v_mfma_f32_16x16x32_bf16 v[176:179], a[160:163], a[208:211], v[176:179]
s_add_u32 s29, s29, s44
ds_read_b128 a[232:235], v4 offset:4096
v_mfma_f32_16x16x32_bf16 v[180:183], a[160:163], a[212:215], v[180:183]
v_mfma_f32_16x16x32_bf16 v[184:187], a[160:163], a[216:219], v[184:187]
buffer_store_dwordx4 v[108:111], v13, s[8:11], s29 offen sc1
v_mfma_f32_16x16x32_bf16 v[188:191], a[160:163], a[220:223], v[188:191]
ds_read_b64_tr_b16 a[160:161], v5 offset:0
v_mfma_f32_16x16x32_bf16 v[192:195], a[164:167], a[192:195], v[192:195]
s_add_u32 s37, s31, 32768
ds_read_b64_tr_b16 a[162:163], v5 offset:1024
v_mfma_f32_16x16x32_bf16 v[196:199], a[164:167], a[196:199], v[196:199]
s_add_u32 m0, s33, 1024
ds_read_b128 a[236:239], v3 offset:5120
v_add_u32 v5, 16384, v5
v_mfma_f32_16x16x32_bf16 v[200:203], a[164:167], a[200:203], v[200:203]
buffer_load_dwordx4 v2, s[20:23], s37 offen  lds
v_and_b32 v5, 65535, v5
v_mfma_f32_16x16x32_bf16 v[204:207], a[164:167], a[204:207], v[204:207]
ds_read_b128 a[240:243], v4 offset:8192
v_mfma_f32_16x16x32_bf16 v[208:211], a[164:167], a[208:211], v[208:211]
v_mfma_f32_16x16x32_bf16 v[212:215], a[164:167], a[212:215], v[212:215]
ds_read_b128 a[244:247], v3 offset:9216
v_mfma_f32_16x16x32_bf16 v[216:219], a[164:167], a[216:219], v[216:219]
v_mfma_f32_16x16x32_bf16 v[220:223], a[164:167], a[220:223], v[220:223]
s_add_u32 s37, s31, 131072
ds_read_b64_tr_b16 a[164:165], v6 offset:0
v_mfma_f32_16x16x32_bf16 v[224:227], a[168:171], a[192:195], v[224:227]
s_add_u32 m0, s33, 4096
ds_read_b64_tr_b16 a[166:167], v6 offset:1024
v_mfma_f32_16x16x32_bf16 v[228:231], a[168:171], a[196:199], v[228:231]
buffer_load_dwordx4 v2, s[20:23], s37 offen  lds
v_xor_b32 v6, 16, v5
v_mfma_f32_16x16x32_bf16 v[232:235], a[168:171], a[200:203], v[232:235]
ds_read_b128 a[248:251], v4 offset:12288
v_mfma_f32_16x16x32_bf16 v[236:239], a[168:171], a[204:207], v[236:239]
v_mfma_f32_16x16x32_bf16 v[240:243], a[168:171], a[208:211], v[240:243]
ds_read_b128 a[252:255], v3 offset:13312
v_mfma_f32_16x16x32_bf16 v[244:247], a[168:171], a[212:215], v[244:247]
v_mfma_f32_16x16x32_bf16 v[248:251], a[168:171], a[216:219], v[248:251]
s_add_u32 s37, s31, 163840
ds_read_b64_tr_b16 v[28:29], v12 offset:0
v_mfma_f32_16x16x32_bf16 v[252:255], a[168:171], a[220:223], v[252:255]
s_add_u32 m0, s33, 5120
ds_read_b64_tr_b16 a[168:169], v7 offset:0
v_mfma_f32_16x16x32_bf16 a[0:3], a[172:175], a[192:195], a[0:3]
buffer_load_dwordx4 v2, s[20:23], s37 offen  lds
ds_read_b64_tr_b16 a[170:171], v7 offset:1024
v_mfma_f32_16x16x32_bf16 a[4:7], a[172:175], a[196:199], a[4:7]
s_add_u32 s31, s31, 262144
s_add_u32 s29, s29, s93
v_xor_b32 v7, 64, v5
v_mfma_f32_16x16x32_bf16 a[8:11], a[172:175], a[200:203], a[8:11]
s_add_u32 s33, s33, 16384
ds_read_b64_tr_b16 v[30:31], v12 offset:1024
v_mfma_f32_16x16x32_bf16 a[12:15], a[172:175], a[204:207], a[12:15]
s_and_b32 s33, s33, 65535
buffer_store_dwordx4 v[112:115], v13, s[8:11], s29 offen sc1
v_mfma_f32_16x16x32_bf16 a[16:19], a[172:175], a[208:211], a[16:19]
v_mfma_f32_16x16x32_bf16 a[20:23], a[172:175], a[212:215], a[20:23]
s_add_u32 s48, s48, s34
v_xor_b32 v12, 208, v5
v_mfma_f32_16x16x32_bf16 a[24:27], a[172:175], a[216:219], a[24:27]
s_add_u32 m0, s32, 16384
v_add_u32 v3, 32768, v3
v_mfma_f32_16x16x32_bf16 a[28:31], a[172:175], a[220:223], a[28:31]
buffer_load_dwordx4 v1, s[12:15], s48 offen lds
ds_read_b64_tr_b16 a[172:173], v8 offset:0
v_mfma_f32_16x16x32_bf16 a[32:35], a[176:179], a[192:195], a[32:35]
ds_read_b64_tr_b16 a[174:175], v8 offset:1024
v_subrev_u32 v19, 98304, v3
v_mfma_f32_16x16x32_bf16 a[36:39], a[176:179], a[196:199], a[36:39]
v_xor_b32 v8, 80, v5
v_cmp_le_u32 vcc, 163840, v3
v_mfma_f32_16x16x32_bf16 a[40:43], a[176:179], a[200:203], a[40:43]
s_nop 0
v_cndmask_b32 v3, v3, v19, vcc
v_mfma_f32_16x16x32_bf16 a[44:47], a[176:179], a[204:207], a[44:47]
v_xor_b32 v4, 64, v3
v_mfma_f32_16x16x32_bf16 a[48:51], a[176:179], a[208:211], a[48:51]
s_add_u32 s48, s48, s34
v_mfma_f32_16x16x32_bf16 a[52:55], a[176:179], a[212:215], a[52:55]
s_add_u32 m0, s32, 20480
v_mfma_f32_16x16x32_bf16 a[56:59], a[176:179], a[216:219], a[56:59]
buffer_load_dwordx4 v1, s[12:15], s48 offen lds
v_mfma_f32_16x16x32_bf16 a[60:63], a[176:179], a[220:223], a[60:63]
ds_read_b64_tr_b16 a[176:177], v9 offset:0
v_mfma_f32_16x16x32_bf16 a[64:67], a[180:183], a[192:195], a[64:67]
ds_read_b64_tr_b16 a[178:179], v9 offset:1024
v_mfma_f32_16x16x32_bf16 a[68:71], a[180:183], a[196:199], a[68:71]
v_xor_b32 v9, 128, v5
v_mfma_f32_16x16x32_bf16 a[72:75], a[180:183], a[200:203], a[72:75]
v_mfma_f32_16x16x32_bf16 a[76:79], a[180:183], a[204:207], a[76:79]
s_add_u32 s48, s48, s34
v_mfma_f32_16x16x32_bf16 a[80:83], a[180:183], a[208:211], a[80:83]
s_add_u32 m0, s32, 24576
v_mfma_f32_16x16x32_bf16 a[84:87], a[180:183], a[212:215], a[84:87]
buffer_load_dwordx4 v1, s[12:15], s48 offen lds
v_mfma_f32_16x16x32_bf16 a[88:91], a[180:183], a[216:219], a[88:91]
s_add_u32 s29, s29, s44
v_mfma_f32_16x16x32_bf16 a[92:95], a[180:183], a[220:223], a[92:95]
ds_read_b64_tr_b16 a[180:181], v10 offset:0
v_mfma_f32_16x16x32_bf16 a[96:99], a[184:187], a[192:195], a[96:99]
buffer_store_dwordx4 v[116:119], v13, s[8:11], s29 offen sc1
ds_read_b64_tr_b16 a[182:183], v10 offset:1024
v_mfma_f32_16x16x32_bf16 a[100:103], a[184:187], a[196:199], a[100:103]
v_xor_b32 v10, 144, v5
v_mfma_f32_16x16x32_bf16 a[104:107], a[184:187], a[200:203], a[104:107]
s_add_u32 s48, s48, s34
v_mfma_f32_16x16x32_bf16 a[108:111], a[184:187], a[204:207], a[108:111]
s_add_u32 m0, s32, 28672
v_mfma_f32_16x16x32_bf16 a[112:115], a[184:187], a[208:211], a[112:115]
buffer_load_dwordx4 v1, s[12:15], s48 offen lds
v_mfma_f32_16x16x32_bf16 a[116:119], a[184:187], a[212:215], a[116:119]
s_add_u32 s30, s30, 128
v_mfma_f32_16x16x32_bf16 a[120:123], a[184:187], a[216:219], a[120:123]
s_add_u32 s32, s32, 32768
v_mfma_f32_16x16x32_bf16 a[124:127], a[184:187], a[220:223], a[124:127]
s_sub_u32 s48, s32, 98304
ds_read_b64_tr_b16 a[184:185], v11 offset:0
v_mfma_f32_16x16x32_bf16 a[128:131], a[188:191], a[192:195], a[128:131]
s_cmp_ge_u32 s32, 163840
s_cselect_b32 s32, s48, s32
ds_read_b64_tr_b16 a[186:187], v11 offset:1024
v_mfma_f32_16x16x32_bf16 a[132:135], a[188:191], a[196:199], a[132:135]
v_xor_b32 v11, 192, v5
v_mfma_f32_16x16x32_bf16 a[136:139], a[188:191], a[200:203], a[136:139]
buffer_load_dword v15, v14, s[96:99], s100 offen
v_mfma_f32_16x16x32_bf16 a[140:143], a[188:191], a[204:207], a[140:143]
s_add_u32 s100, s100, 16384
v_mfma_f32_16x16x32_bf16 a[144:147], a[188:191], a[208:211], a[144:147]
v_mfma_f32_16x16x32_bf16 a[148:151], a[188:191], a[212:215], a[148:151]
v_mfma_f32_16x16x32_bf16 a[152:155], a[188:191], a[216:219], a[152:155]
v_mfma_f32_16x16x32_bf16 a[156:159], a[188:191], a[220:223], a[156:159]
s_waitcnt vmcnt(24) lgkmcnt(0)
s_barrier
v_mfma_f32_16x16x32_bf16 v[160:163], a[160:163], a[224:227], v[160:163]
ds_read_b128 a[192:195], v3 offset:0
v_mfma_f32_16x16x32_bf16 v[164:167], a[160:163], a[228:231], v[164:167]
s_add_u32 s37, s31, 0
v_mfma_f32_16x16x32_bf16 v[168:171], a[160:163], a[232:235], v[168:171]
s_add_u32 m0, s33, 0
ds_read_b128 a[196:199], v4 offset:1024
v_mfma_f32_16x16x32_bf16 v[172:175], a[160:163], a[236:239], v[172:175]
buffer_load_dwordx4 v2, s[20:23], s37 offen  lds
v_mfma_f32_16x16x32_bf16 v[176:179], a[160:163], a[240:243], v[176:179]
s_add_u32 s29, s29, s93
ds_read_b128 a[200:203], v3 offset:4096
v_mfma_f32_16x16x32_bf16 v[180:183], a[160:163], a[244:247], v[180:183]
v_mfma_f32_16x16x32_bf16 v[184:187], a[160:163], a[248:251], v[184:187]
buffer_store_dwordx4 v[120:123], v13, s[8:11], s29 offen sc1
v_mfma_f32_16x16x32_bf16 v[188:191], a[160:163], a[252:255], v[188:191]
ds_read_b64_tr_b16 a[160:161], v5 offset:0
v_mfma_f32_16x16x32_bf16 v[192:195], a[164:167], a[224:227], v[192:195]
s_add_u32 s37, s31, 32768
ds_read_b64_tr_b16 a[162:163], v5 offset:1024
v_mfma_f32_16x16x32_bf16 v[196:199], a[164:167], a[228:231], v[196:199]
s_add_u32 m0, s33, 1024
ds_read_b128 a[204:207], v4 offset:5120
v_add_u32 v5, 16384, v5
v_mfma_f32_16x16x32_bf16 v[200:203], a[164:167], a[232:235], v[200:203]
buffer_load_dwordx4 v2, s[20:23], s37 offen  lds
v_and_b32 v5, 65535, v5
v_mfma_f32_16x16x32_bf16 v[204:207], a[164:167], a[236:239], v[204:207]
ds_read_b128 a[208:211], v3 offset:8192
v_mfma_f32_16x16x32_bf16 v[208:211], a[164:167], a[240:243], v[208:211]
v_mfma_f32_16x16x32_bf16 v[212:215], a[164:167], a[244:247], v[212:215]
ds_read_b128 a[212:215], v4 offset:9216
v_mfma_f32_16x16x32_bf16 v[216:219], a[164:167], a[248:251], v[216:219]
v_mfma_f32_16x16x32_bf16 v[220:223], a[164:167], a[252:255], v[220:223]
s_add_u32 s37, s31, 131072
ds_read_b64_tr_b16 a[164:165], v6 offset:0
v_mfma_f32_16x16x32_bf16 v[224:227], a[168:171], a[224:227], v[224:227]
s_add_u32 m0, s33, 4096
ds_read_b64_tr_b16 a[166:167], v6 offset:1024
v_mfma_f32_16x16x32_bf16 v[228:231], a[168:171], a[228:231], v[228:231]
buffer_load_dwordx4 v2, s[20:23], s37 offen  lds
v_xor_b32 v6, 16, v5
v_mfma_f32_16x16x32_bf16 v[232:235], a[168:171], a[232:235], v[232:235]
ds_read_b128 a[216:219], v3 offset:12288
v_mfma_f32_16x16x32_bf16 v[236:239], a[168:171], a[236:239], v[236:239]
v_mfma_f32_16x16x32_bf16 v[240:243], a[168:171], a[240:243], v[240:243]
ds_read_b128 a[220:223], v4 offset:13312
v_mfma_f32_16x16x32_bf16 v[244:247], a[168:171], a[244:247], v[244:247]
v_mfma_f32_16x16x32_bf16 v[248:251], a[168:171], a[248:251], v[248:251]
s_add_u32 s37, s31, 163840
ds_read_b64_tr_b16 a[188:189], v12 offset:0
v_mfma_f32_16x16x32_bf16 v[252:255], a[168:171], a[252:255], v[252:255]
s_add_u32 m0, s33, 5120
ds_read_b64_tr_b16 a[168:169], v7 offset:0
v_mfma_f32_16x16x32_bf16 a[0:3], a[172:175], a[224:227], a[0:3]
buffer_load_dwordx4 v2, s[20:23], s37 offen  lds
ds_read_b64_tr_b16 a[170:171], v7 offset:1024
v_mfma_f32_16x16x32_bf16 a[4:7], a[172:175], a[228:231], a[4:7]
s_add_u32 s31, s31, 262144
s_add_u32 s29, s29, s44
v_xor_b32 v7, 64, v5
v_mfma_f32_16x16x32_bf16 a[8:11], a[172:175], a[232:235], a[8:11]
s_add_u32 s33, s33, 16384
ds_read_b64_tr_b16 a[190:191], v12 offset:1024
v_mfma_f32_16x16x32_bf16 a[12:15], a[172:175], a[236:239], a[12:15]
s_and_b32 s33, s33, 65535
buffer_store_dwordx4 v[124:127], v13, s[8:11], s29 offen sc1
v_mfma_f32_16x16x32_bf16 a[16:19], a[172:175], a[240:243], a[16:19]
v_mfma_f32_16x16x32_bf16 a[20:23], a[172:175], a[244:247], a[20:23]
s_mov_b32 s48, s30
v_xor_b32 v12, 208, v5
v_mfma_f32_16x16x32_bf16 a[24:27], a[172:175], a[248:251], a[24:27]
s_add_u32 m0, s32, 0
v_mfma_f32_16x16x32_bf16 a[28:31], a[172:175], a[252:255], a[28:31]
buffer_load_dwordx4 v1, s[12:15], s48 offen lds
ds_read_b64_tr_b16 a[172:173], v8 offset:0
v_mfma_f32_16x16x32_bf16 a[32:35], a[176:179], a[224:227], a[32:35]
ds_read_b64_tr_b16 a[174:175], v8 offset:1024
v_mfma_f32_16x16x32_bf16 a[36:39], a[176:179], a[228:231], a[36:39]
v_xor_b32 v8, 80, v5
v_mfma_f32_16x16x32_bf16 a[40:43], a[176:179], a[232:235], a[40:43]
v_mfma_f32_16x16x32_bf16 a[44:47], a[176:179], a[236:239], a[44:47]
v_mfma_f32_16x16x32_bf16 a[48:51], a[176:179], a[240:243], a[48:51]
s_add_u32 s48, s48, s34
v_mfma_f32_16x16x32_bf16 a[52:55], a[176:179], a[244:247], a[52:55]
s_add_u32 m0, s32, 4096
v_mfma_f32_16x16x32_bf16 a[56:59], a[176:179], a[248:251], a[56:59]
buffer_load_dwordx4 v1, s[12:15], s48 offen lds
v_mfma_f32_16x16x32_bf16 a[60:63], a[176:179], a[252:255], a[60:63]
ds_read_b64_tr_b16 a[176:177], v9 offset:0
v_mfma_f32_16x16x32_bf16 a[64:67], a[180:183], a[224:227], a[64:67]
ds_read_b64_tr_b16 a[178:179], v9 offset:1024
v_mfma_f32_16x16x32_bf16 a[68:71], a[180:183], a[228:231], a[68:71]
v_xor_b32 v9, 128, v5
v_mfma_f32_16x16x32_bf16 a[72:75], a[180:183], a[232:235], a[72:75]
v_mfma_f32_16x16x32_bf16 a[76:79], a[180:183], a[236:239], a[76:79]
s_add_u32 s48, s48, s34
v_mfma_f32_16x16x32_bf16 a[80:83], a[180:183], a[240:243], a[80:83]
s_add_u32 m0, s32, 8192
v_mfma_f32_16x16x32_bf16 a[84:87], a[180:183], a[244:247], a[84:87]
buffer_load_dwordx4 v1, s[12:15], s48 offen lds
v_mfma_f32_16x16x32_bf16 a[88:91], a[180:183], a[248:251], a[88:91]
v_mfma_f32_16x16x32_bf16 a[92:95], a[180:183], a[252:255], a[92:95]
ds_read_b64_tr_b16 a[180:181], v10 offset:0
v_mfma_f32_16x16x32_bf16 a[96:99], a[184:187], a[224:227], a[96:99]
ds_read_b64_tr_b16 a[182:183], v10 offset:1024
v_mfma_f32_16x16x32_bf16 a[100:103], a[184:187], a[228:231], a[100:103]
v_xor_b32 v10, 144, v5
v_mfma_f32_16x16x32_bf16 a[104:107], a[184:187], a[232:235], a[104:107]
s_add_u32 s48, s48, s34
v_mfma_f32_16x16x32_bf16 a[108:111], a[184:187], a[236:239], a[108:111]
s_add_u32 m0, s32, 12288
v_mfma_f32_16x16x32_bf16 a[112:115], a[184:187], a[240:243], a[112:115]
buffer_load_dwordx4 v1, s[12:15], s48 offen lds
v_mfma_f32_16x16x32_bf16 a[116:119], a[184:187], a[244:247], a[116:119]
v_mfma_f32_16x16x32_bf16 a[120:123], a[184:187], a[248:251], a[120:123]
v_mfma_f32_16x16x32_bf16 a[124:127], a[184:187], a[252:255], a[124:127]
ds_read_b64_tr_b16 a[184:185], v11 offset:0
v_mfma_f32_16x16x32_bf16 a[128:131], v[28:31], a[224:227], a[128:131]
ds_read_b64_tr_b16 a[186:187], v11 offset:1024
v_mfma_f32_16x16x32_bf16 a[132:135], v[28:31], a[228:231], a[132:135]
v_xor_b32 v11, 192, v5
v_mfma_f32_16x16x32_bf16 a[136:139], v[28:31], a[232:235], a[136:139]
buffer_load_dword v15, v14, s[96:99], s100 offen
v_mfma_f32_16x16x32_bf16 a[140:143], v[28:31], a[236:239], a[140:143]
s_add_u32 s100, s100, 16384
v_mfma_f32_16x16x32_bf16 a[144:147], v[28:31], a[240:243], a[144:147]
v_mfma_f32_16x16x32_bf16 a[148:151], v[28:31], a[244:247], a[148:151]
v_mfma_f32_16x16x32_bf16 a[152:155], v[28:31], a[248:251], a[152:155]
v_mfma_f32_16x16x32_bf16 a[156:159], v[28:31], a[252:255], a[156:159]
s_cmp_eq_u32 s36, 0
s_cbranch_scc1 L_g_k12
s_waitcnt vmcnt(23) lgkmcnt(0)
s_barrier
v_mfma_f32_16x16x32_bf16 v[160:163], a[160:163], a[192:195], v[160:163]
ds_read_b128 a[224:227], v4 offset:0
v_mfma_f32_16x16x32_bf16 v[164:167], a[160:163], a[196:199], v[164:167]
s_add_u32 s37, s31, 0
v_mfma_f32_16x16x32_bf16 v[168:171], a[160:163], a[200:203], v[168:171]
s_add_u32 m0, s33, 0
ds_read_b128 a[228:231], v3 offset:1024
v_mfma_f32_16x16x32_bf16 v[172:175], a[160:163], a[204:207], v[172:175]
buffer_load_dwordx4 v2, s[20:23], s37 offen  lds
v_mfma_f32_16x16x32_bf16 v[176:179], a[160:163], a[208:211], v[176:179]
ds_read_b128 a[232:235], v4 offset:4096
v_mfma_f32_16x16x32_bf16 v[180:183], a[160:163], a[212:215], v[180:183]
v_mfma_f32_16x16x32_bf16 v[184:187], a[160:163], a[216:219], v[184:187]
ds_read_b128 a[236:239], v3 offset:5120
v_mfma_f32_16x16x32_bf16 v[188:191], a[160:163], a[220:223], v[188:191]
ds_read_b64_tr_b16 a[160:161], v5 offset:0
v_mfma_f32_16x16x32_bf16 v[192:195], a[164:167], a[192:195], v[192:195]
s_add_u32 s37, s31, 32768
ds_read_b64_tr_b16 a[162:163], v5 offset:1024
v_mfma_f32_16x16x32_bf16 v[196:199], a[164:167], a[196:199], v[196:199]
s_add_u32 m0, s33, 1024
ds_read_b128 a[240:243], v4 offset:8192
v_add_u32 v5, 16384, v5
v_mfma_f32_16x16x32_bf16 v[200:203], a[164:167], a[200:203], v[200:203]
buffer_load_dwordx4 v2, s[20:23], s37 offen  lds
v_and_b32 v5, 65535, v5
v_mfma_f32_16x16x32_bf16 v[204:207], a[164:167], a[204:207], v[204:207]
ds_read_b128 a[244:247], v3 offset:9216
v_mfma_f32_16x16x32_bf16 v[208:211], a[164:167], a[208:211], v[208:211]
v_mfma_f32_16x16x32_bf16 v[212:215], a[164:167], a[212:215], v[212:215]
ds_read_b128 a[248:251], v4 offset:12288
v_mfma_f32_16x16x32_bf16 v[216:219], a[164:167], a[216:219], v[216:219]
v_mfma_f32_16x16x32_bf16 v[220:223], a[164:167], a[220:223], v[220:223]
s_add_u32 s37, s31, 131072
ds_read_b64_tr_b16 a[164:165], v6 offset:0
v_mfma_f32_16x16x32_bf16 v[224:227], a[168:171], a[192:195], v[224:227]
s_add_u32 m0, s33, 4096
ds_read_b64_tr_b16 a[166:167], v6 offset:1024
v_mfma_f32_16x16x32_bf16 v[228:231], a[168:171], a[196:199], v[228:231]
buffer_load_dwordx4 v2, s[20:23], s37 offen  lds
v_xor_b32 v6, 16, v5
v_mfma_f32_16x16x32_bf16 v[232:235], a[168:171], a[200:203], v[232:235]
ds_read_b128 a[252:255], v3 offset:13312
v_mfma_f32_16x16x32_bf16 v[236:239], a[168:171], a[204:207], v[236:239]
v_mfma_f32_16x16x32_bf16 v[240:243], a[168:171], a[208:211], v[240:243]
ds_read_b64_tr_b16 v[28:29], v12 offset:0
v_mfma_f32_16x16x32_bf16 v[244:247], a[168:171], a[212:215], v[244:247]
v_mfma_f32_16x16x32_bf16 v[248:251], a[168:171], a[216:219], v[248:251]
s_add_u32 s37, s31, 163840
ds_read_b64_tr_b16 v[30:31], v12 offset:1024
v_mfma_f32_16x16x32_bf16 v[252:255], a[168:171], a[220:223], v[252:255]
s_add_u32 m0, s33, 5120
ds_read_b64_tr_b16 a[168:169], v7 offset:0
v_mfma_f32_16x16x32_bf16 a[0:3], a[172:175], a[192:195], a[0:3]
buffer_load_dwordx4 v2, s[20:23], s37 offen  lds
ds_read_b64_tr_b16 a[170:171], v7 offset:1024
v_mfma_f32_16x16x32_bf16 a[4:7], a[172:175], a[196:199], a[4:7]
s_add_u32 s31, s31, 262144
v_xor_b32 v7, 64, v5
v_xor_b32 v12, 208, v5
v_mfma_f32_16x16x32_bf16 a[8:11], a[172:175], a[200:203], a[8:11]
s_add_u32 s33, s33, 16384
v_add_u32 v3, 32768, v3
v_mfma_f32_16x16x32_bf16 a[12:15], a[172:175], a[204:207], a[12:15]
s_and_b32 s33, s33, 65535
v_subrev_u32 v19, 98304, v3
v_mfma_f32_16x16x32_bf16 a[16:19], a[172:175], a[208:211], a[16:19]
v_cmp_le_u32 vcc, 163840, v3
v_mfma_f32_16x16x32_bf16 a[20:23], a[172:175], a[212:215], a[20:23]
s_add_u32 s48, s48, s34
v_cndmask_b32 v3, v3, v19, vcc
v_mfma_f32_16x16x32_bf16 a[24:27], a[172:175], a[216:219], a[24:27]
s_add_u32 m0, s32, 16384
v_xor_b32 v4, 64, v3
v_mfma_f32_16x16x32_bf16 a[28:31], a[172:175], a[220:223], a[28:31]
buffer_load_dwordx4 v1, s[12:15], s48 offen lds
ds_read_b64_tr_b16 a[172:173], v8 offset:0
v_mfma_f32_16x16x32_bf16 a[32:35], a[176:179], a[192:195], a[32:35]
ds_read_b64_tr_b16 a[174:175], v8 offset:1024
v_mfma_f32_16x16x32_bf16 a[36:39], a[176:179], a[196:199], a[36:39]
v_xor_b32 v8, 80, v5
v_mfma_f32_16x16x32_bf16 a[40:43], a[176:179], a[200:203], a[40:43]
v_mfma_f32_16x16x32_bf16 a[44:47], a[176:179], a[204:207], a[44:47]
v_mfma_f32_16x16x32_bf16 a[48:51], a[176:179], a[208:211], a[48:51]
s_add_u32 s48, s48, s34
v_mfma_f32_16x16x32_bf16 a[52:55], a[176:179], a[212:215], a[52:55]
s_add_u32 m0, s32, 20480
v_mfma_f32_16x16x32_bf16 a[56:59], a[176:179], a[216:219], a[56:59]
buffer_load_dwordx4 v1, s[12:15], s48 offen lds
v_mfma_f32_16x16x32_bf16 a[60:63], a[176:179], a[220:223], a[60:63]
ds_read_b64_tr_b16 a[176:177], v9 offset:0
v_mfma_f32_16x16x32_bf16 a[64:67], a[180:183], a[192:195], a[64:67]
ds_read_b64_tr_b16 a[178:179], v9 offset:1024
v_mfma_f32_16x16x32_bf16 a[68:71], a[180:183], a[196:199], a[68:71]
v_xor_b32 v9, 128, v5
v_mfma_f32_16x16x32_bf16 a[72:75], a[180:183], a[200:203], a[72:75]
v_mfma_f32_16x16x32_bf16 a[76:79], a[180:183], a[204:207], a[76:79]
s_add_u32 s48, s48, s34
v_mfma_f32_16x16x32_bf16 a[80:83], a[180:183], a[208:211], a[80:83]
s_add_u32 m0, s32, 24576
v_mfma_f32_16x16x32_bf16 a[84:87], a[180:183], a[212:215], a[84:87]
buffer_load_dwordx4 v1, s[12:15], s48 offen lds
v_mfma_f32_16x16x32_bf16 a[88:91], a[180:183], a[216:219], a[88:91]
v_mfma_f32_16x16x32_bf16 a[92:95], a[180:183], a[220:223], a[92:95]
ds_read_b64_tr_b16 a[180:181], v10 offset:0
v_mfma_f32_16x16x32_bf16 a[96:99], a[184:187], a[192:195], a[96:99]
ds_read_b64_tr_b16 a[182:183], v10 offset:1024
v_mfma_f32_16x16x32_bf16 a[100:103], a[184:187], a[196:199], a[100:103]
v_xor_b32 v10, 144, v5
v_mfma_f32_16x16x32_bf16 a[104:107], a[184:187], a[200:203], a[104:107]
s_add_u32 s48, s48, s34
v_mfma_f32_16x16x32_bf16 a[108:111], a[184:187], a[204:207], a[108:111]
s_add_u32 m0, s32, 28672
v_mfma_f32_16x16x32_bf16 a[112:115], a[184:187], a[208:211], a[112:115]
buffer_load_dwordx4 v1, s[12:15], s48 offen lds
v_mfma_f32_16x16x32_bf16 a[116:119], a[184:187], a[212:215], a[116:119]
s_add_u32 s30, s30, 128
v_mfma_f32_16x16x32_bf16 a[120:123], a[184:187], a[216:219], a[120:123]
s_add_u32 s32, s32, 32768
v_mfma_f32_16x16x32_bf16 a[124:127], a[184:187], a[220:223], a[124:127]
s_sub_u32 s48, s32, 98304
ds_read_b64_tr_b16 a[184:185], v11 offset:0
v_mfma_f32_16x16x32_bf16 a[128:131], a[188:191], a[192:195], a[128:131]
s_cmp_ge_u32 s32, 163840
s_cselect_b32 s32, s48, s32
ds_read_b64_tr_b16 a[186:187], v11 offset:1024
v_mfma_f32_16x16x32_bf16 a[132:135], a[188:191], a[196:199], a[132:135]
v_xor_b32 v11, 192, v5
v_mfma_f32_16x16x32_bf16 a[136:139], a[188:191], a[200:203], a[136:139]
v_mfma_f32_16x16x32_bf16 a[140:143], a[188:191], a[204:207], a[140:143]
v_mfma_f32_16x16x32_bf16 a[144:147], a[188:191], a[208:211], a[144:147]
v_mfma_f32_16x16x32_bf16 a[148:151], a[188:191], a[212:215], a[148:151]
v_mfma_f32_16x16x32_bf16 a[152:155], a[188:191], a[216:219], a[152:155]
v_mfma_f32_16x16x32_bf16 a[156:159], a[188:191], a[220:223], a[156:159]
s_waitcnt vmcnt(19) lgkmcnt(0)
s_barrier
v_mfma_f32_16x16x32_bf16 v[160:163], a[160:163], a[224:227], v[160:163]
ds_read_b128 a[192:195], v3 offset:0
v_mfma_f32_16x16x32_bf16 v[164:167], a[160:163], a[228:231], v[164:167]
s_add_u32 s37, s31, 0
v_mfma_f32_16x16x32_bf16 v[168:171], a[160:163], a[232:235], v[168:171]
s_add_u32 m0, s33, 0
ds_read_b128 a[196:199], v4 offset:1024
v_mfma_f32_16x16x32_bf16 v[172:175], a[160:163], a[236:239], v[172:175]
buffer_load_dwordx4 v2, s[20:23], s37 offen  lds
v_mfma_f32_16x16x32_bf16 v[176:179], a[160:163], a[240:243], v[176:179]
ds_read_b128 a[200:203], v3 offset:4096
v_mfma_f32_16x16x32_bf16 v[180:183], a[160:163], a[244:247], v[180:183]
v_mfma_f32_16x16x32_bf16 v[184:187], a[160:163], a[248:251], v[184:187]
ds_read_b128 a[204:207], v4 offset:5120
v_mfma_f32_16x16x32_bf16 v[188:191], a[160:163], a[252:255], v[188:191]
ds_read_b64_tr_b16 a[160:161], v5 offset:0
v_mfma_f32_16x16x32_bf16 v[192:195], a[164:167], a[224:227], v[192:195]
s_add_u32 s37, s31, 32768
ds_read_b64_tr_b16 a[162:163], v5 offset:1024
v_mfma_f32_16x16x32_bf16 v[196:199], a[164:167], a[228:231], v[196:199]
s_add_u32 m0, s33, 1024
ds_read_b128 a[208:211], v3 offset:8192
v_add_u32 v5, 16384, v5
v_mfma_f32_16x16x32_bf16 v[200:203], a[164:167], a[232:235], v[200:203]
buffer_load_dwordx4 v2, s[20:23], s37 offen  lds
v_and_b32 v5, 65535, v5
v_mfma_f32_16x16x32_bf16 v[204:207], a[164:167], a[236:239], v[204:207]
ds_read_b128 a[212:215], v4 offset:9216
v_mfma_f32_16x16x32_bf16 v[208:211], a[164:167], a[240:243], v[208:211]
v_mfma_f32_16x16x32_bf16 v[212:215], a[164:167], a[244:247], v[212:215]
ds_read_b128 a[216:219], v3 offset:12288
v_mfma_f32_16x16x32_bf16 v[216:219], a[164:167], a[248:251], v[216:219]
v_mfma_f32_16x16x32_bf16 v[220:223], a[164:167], a[252:255], v[220:223]
s_add_u32 s37, s31, 131072
ds_read_b64_tr_b16 a[164:165], v6 offset:0
v_mfma_f32_16x16x32_bf16 v[224:227], a[168:171], a[224:227], v[224:227]
s_add_u32 m0, s33, 4096
ds_read_b64_tr_b16 a[166:167], v6 offset:1024
v_mfma_f32_16x16x32_bf16 v[228:231], a[168:171], a[228:231], v[228:231]
buffer_load_dwordx4 v2, s[20:23], s37 offen  lds
v_xor_b32 v6, 16, v5
v_mfma_f32_16x16x32_bf16 v[232:235], a[168:171], a[232:235], v[232:235]
ds_read_b128 a[220:223], v4 offset:13312
v_mfma_f32_16x16x32_bf16 v[236:239], a[168:171], a[236:239], v[236:239]
v_mfma_f32_16x16x32_bf16 v[240:243], a[168:171], a[240:243], v[240:243]
ds_read_b64_tr_b16 a[188:189], v12 offset:0
v_mfma_f32_16x16x32_bf16 v[244:247], a[168:171], a[244:247], v[244:247]
v_mfma_f32_16x16x32_bf16 v[248:251], a[168:171], a[248:251], v[248:251]
s_add_u32 s37, s31, 163840
ds_read_b64_tr_b16 a[190:191], v12 offset:1024
v_mfma_f32_16x16x32_bf16 v[252:255], a[168:171], a[252:255], v[252:255]
s_add_u32 m0, s33, 5120
ds_read_b64_tr_b16 a[168:169], v7 offset:0
v_mfma_f32_16x16x32_bf16 a[0:3], a[172:175], a[224:227], a[0:3]
buffer_load_dwordx4 v2, s[20:23], s37 offen  lds
ds_read_b64_tr_b16 a[170:171], v7 offset:1024
v_mfma_f32_16x16x32_bf16 a[4:7], a[172:175], a[228:231], a[4:7]
s_add_u32 s31, s31, 262144
v_xor_b32 v7, 64, v5
v_xor_b32 v12, 208, v5
v_mfma_f32_16x16x32_bf16 a[8:11], a[172:175], a[232:235], a[8:11]
s_add_u32 s33, s33, 16384
v_mfma_f32_16x16x32_bf16 a[12:15], a[172:175], a[236:239], a[12:15]
s_and_b32 s33, s33, 65535
v_mfma_f32_16x16x32_bf16 a[16:19], a[172:175], a[240:243], a[16:19]
v_mfma_f32_16x16x32_bf16 a[20:23], a[172:175], a[244:247], a[20:23]
s_mov_b32 s48, s30
v_mfma_f32_16x16x32_bf16 a[24:27], a[172:175], a[248:251], a[24:27]
s_add_u32 m0, s32, 0
v_mfma_f32_16x16x32_bf16 a[28:31], a[172:175], a[252:255], a[28:31]
buffer_load_dwordx4 v1, s[12:15], s48 offen lds
ds_read_b64_tr_b16 a[172:173], v8 offset:0
v_mfma_f32_16x16x32_bf16 a[32:35], a[176:179], a[224:227], a[32:35]
ds_read_b64_tr_b16 a[174:175], v8 offset:1024
v_mfma_f32_16x16x32_bf16 a[36:39], a[176:179], a[228:231], a[36:39]
v_xor_b32 v8, 80, v5
v_mfma_f32_16x16x32_bf16 a[40:43], a[176:179], a[232:235], a[40:43]
v_mfma_f32_16x16x32_bf16 a[44:47], a[176:179], a[236:239], a[44:47]
v_mfma_f32_16x16x32_bf16 a[48:51], a[176:179], a[240:243], a[48:51]
s_add_u32 s48, s48, s34
v_mfma_f32_16x16x32_bf16 a[52:55], a[176:179], a[244:247], a[52:55]
s_add_u32 m0, s32, 4096
v_mfma_f32_16x16x32_bf16 a[56:59], a[176:179], a[248:251], a[56:59]
buffer_load_dwordx4 v1, s[12:15], s48 offen lds
v_mfma_f32_16x16x32_bf16 a[60:63], a[176:179], a[252:255], a[60:63]
ds_read_b64_tr_b16 a[176:177], v9 offset:0
v_mfma_f32_16x16x32_bf16 a[64:67], a[180:183], a[224:227], a[64:67]
ds_read_b64_tr_b16 a[178:179], v9 offset:1024
v_mfma_f32_16x16x32_bf16 a[68:71], a[180:183], a[228:231], a[68:71]
v_xor_b32 v9, 128, v5
v_mfma_f32_16x16x32_bf16 a[72:75], a[180:183], a[232:235], a[72:75]
v_mfma_f32_16x16x32_bf16 a[76:79], a[180:183], a[236:239], a[76:79]
s_add_u32 s48, s48, s34
v_mfma_f32_16x16x32_bf16 a[80:83], a[180:183], a[240:243], a[80:83]
s_add_u32 m0, s32, 8192
v_mfma_f32_16x16x32_bf16 a[84:87], a[180:183], a[244:247], a[84:87]
buffer_load_dwordx4 v1, s[12:15], s48 offen lds
v_mfma_f32_16x16x32_bf16 a[88:91], a[180:183], a[248:251], a[88:91]
v_mfma_f32_16x16x32_bf16 a[92:95], a[180:183], a[252:255], a[92:95]
ds_read_b64_tr_b16 a[180:181], v10 offset:0
v_mfma_f32_16x16x32_bf16 a[96:99], a[184:187], a[224:227], a[96:99]
ds_read_b64_tr_b16 a[182:183], v10 offset:1024
v_mfma_f32_16x16x32_bf16 a[100:103], a[184:187], a[228:231], a[100:103]
v_xor_b32 v10, 144, v5
v_mfma_f32_16x16x32_bf16 a[104:107], a[184:187], a[232:235], a[104:107]
s_add_u32 s48, s48, s34
v_mfma_f32_16x16x32_bf16 a[108:111], a[184:187], a[236:239], a[108:111]
s_add_u32 m0, s32, 12288
v_mfma_f32_16x16x32_bf16 a[112:115], a[184:187], a[240:243], a[112:115]
buffer_load_dwordx4 v1, s[12:15], s48 offen lds
v_mfma_f32_16x16x32_bf16 a[116:119], a[184:187], a[244:247], a[116:119]
v_mfma_f32_16x16x32_bf16 a[120:123], a[184:187], a[248:251], a[120:123]
v_mfma_f32_16x16x32_bf16 a[124:127], a[184:187], a[252:255], a[124:127]
ds_read_b64_tr_b16 a[184:185], v11 offset:0
v_mfma_f32_16x16x32_bf16 a[128:131], v[28:31], a[224:227], a[128:131]
ds_read_b64_tr_b16 a[186:187], v11 offset:1024
v_mfma_f32_16x16x32_bf16 a[132:135], v[28:31], a[228:231], a[132:135]
v_xor_b32 v11, 192, v5
v_mfma_f32_16x16x32_bf16 a[136:139], v[28:31], a[232:235], a[136:139]
v_mfma_f32_16x16x32_bf16 a[140:143], v[28:31], a[236:239], a[140:143]
v_mfma_f32_16x16x32_bf16 a[144:147], v[28:31], a[240:243], a[144:147]
v_mfma_f32_16x16x32_bf16 a[148:151], v[28:31], a[244:247], a[148:151]
v_mfma_f32_16x16x32_bf16 a[152:155], v[28:31], a[248:251], a[152:155]
v_mfma_f32_16x16x32_bf16 a[156:159], v[28:31], a[252:255], a[156:159]
L_g_k12:
s_waitcnt vmcnt(16) lgkmcnt(0)
s_barrier
v_mfma_f32_16x16x32_bf16 v[160:163], a[160:163], a[192:195], v[160:163]
ds_read_b128 a[224:227], v4 offset:0
s_lshr_b32 s24, s16, 1
v_mfma_f32_16x16x32_bf16 v[164:167], a[160:163], a[196:199], v[164:167]
s_add_u32 s37, s31, 0
s_cmp_eq_u32 s35, 5
s_cselect_b32 s90, s24, s90
v_mfma_f32_16x16x32_bf16 v[168:171], a[160:163], a[200:203], v[168:171]
s_add_u32 m0, s33, 0
ds_read_b128 a[228:231], v3 offset:1024
s_lshl_b32 s24, s35, 2
v_mfma_f32_16x16x32_bf16 v[172:175], a[160:163], a[204:207], v[172:175]
buffer_load_dwordx4 v2, s[20:23], s37 offen  lds
s_lshr_b32 s26, s88, s24
v_mfma_f32_16x16x32_bf16 v[176:179], a[160:163], a[208:211], v[176:179]
s_add_u32 s60, s60, s92
ds_read_b128 a[232:235], v4 offset:4096
s_bfe_u32 s2, s26, 0x10003
v_mfma_f32_16x16x32_bf16 v[180:183], a[160:163], a[212:215], v[180:183]
s_mov_b32 s29, s60
s_and_b32 s26, s26, 7
s_or_b32 s40, s2, s61
v_mfma_f32_16x16x32_bf16 v[184:187], a[160:163], a[216:219], v[184:187]
buffer_store_dwordx4 v[128:131], v13, s[8:11], s29 offen sc1
s_lshr_b32 s24, s17, 1
v_mfma_f32_16x16x32_bf16 v[188:191], a[160:163], a[220:223], v[188:191]
ds_read_b64_tr_b16 a[160:161], v5 offset:0
v_mfma_f32_16x16x32_bf16 v[192:195], a[164:167], a[192:195], v[192:195]
s_add_u32 s37, s31, 32768
ds_read_b64_tr_b16 a[162:163], v5 offset:1024
v_mfma_f32_16x16x32_bf16 v[196:199], a[164:167], a[196:199], v[196:199]
s_add_u32 m0, s33, 1024
ds_read_b128 a[236:239], v3 offset:5120
v_add_u32 v5, 16384, v5
v_mfma_f32_16x16x32_bf16 v[200:203], a[164:167], a[200:203], v[200:203]
buffer_load_dwordx4 v2, s[20:23], s37 offen  lds
v_and_b32 v5, 65535, v5
v_mfma_f32_16x16x32_bf16 v[204:207], a[164:167], a[204:207], v[204:207]
ds_read_b128 a[240:243], v4 offset:8192
v_mfma_f32_16x16x32_bf16 v[208:211], a[164:167], a[208:211], v[208:211]
s_cmp_eq_u32 s2, 0
s_cselect_b32 s41, s24, 0
s_cselect_b32 s27, s89, s90
v_mfma_f32_16x16x32_bf16 v[212:215], a[164:167], a[212:215], v[212:215]
ds_read_b128 a[244:247], v3 offset:9216
s_sub_u32 s25, s24, s41
v_mfma_f32_16x16x32_bf16 v[216:219], a[164:167], a[216:219], v[216:219]
s_and_b32 s51, s41, s61
s_lshl_b32 s51, s51, 1
s_or_b32 s51, s51, s41
v_mfma_f32_16x16x32_bf16 v[220:223], a[164:167], a[220:223], v[220:223]
s_add_u32 s37, s31, 131072
ds_read_b64_tr_b16 a[164:165], v6 offset:0
s_lshl2_add_u32 s51, s2, s51
v_mfma_f32_16x16x32_bf16 v[224:227], a[168:171], a[192:195], v[224:227]
s_add_u32 m0, s33, 4096
ds_read_b64_tr_b16 a[166:167], v6 offset:1024
s_lshl_b32 s46, s27, s2
v_mfma_f32_16x16x32_bf16 v[228:231], a[168:171], a[196:199], v[228:231]
buffer_load_dwordx4 v2, s[20:23], s37 offen  lds
s_add_u32 s46, s46, s25
v_mfma_f32_16x16x32_bf16 v[232:235], a[168:171], a[200:203], v[232:235]
ds_read_b128 a[248:251], v4 offset:12288
s_lshl_b32 s46, s46, 8
v_mfma_f32_16x16x32_bf16 v[236:239], a[168:171], a[204:207], v[236:239]
s_lshl_b32 s47, s40, 7
s_add_u32 s47, s47, 1024
s_mul_i32 s101, s26, s47
v_mfma_f32_16x16x32_bf16 v[240:243], a[168:171], a[208:211], v[240:243]
ds_read_b128 a[252:255], v3 offset:13312
s_lshl_b32 s101, s101, 8
v_mfma_f32_16x16x32_bf16 v[244:247], a[168:171], a[212:215], v[244:247]
s_and_b32 s25, s17, 1
s_lshl1_add_u32 s42, s26, s25
s_lshl_b32 s42, s42, 7
v_mfma_f32_16x16x32_bf16 v[248:251], a[168:171], a[216:219], v[248:251]
s_add_u32 s37, s31, 163840
ds_read_b64_tr_b16 v[28:29], v12 offset:0
s_lshr_b32 s42, s42, s2
v_mfma_f32_16x16x32_bf16 v[252:255], a[168:171], a[220:223], v[252:255]
s_add_u32 m0, s33, 5120
ds_read_b64_tr_b16 a[168:169], v7 offset:0
s_add_u32 s42, s42, s27
v_mfma_f32_16x16x32_bf16 a[0:3], a[172:175], a[192:195], a[0:3]
buffer_load_dwordx4 v2, s[20:23], s37 offen  lds
ds_read_b64_tr_b16 a[170:171], v7 offset:1024
v_mfma_f32_16x16x32_bf16 a[4:7], a[172:175], a[196:199], a[4:7]
s_add_u32 s31, s31, 262144
s_add_u32 s29, s29, s44
s_lshl1_add_u32 s42, s42, s24
v_mfma_f32_16x16x32_bf16 a[8:11], a[172:175], a[200:203], a[8:11]
s_add_u32 s33, s33, 16384
ds_read_b64_tr_b16 v[30:31], v12 offset:1024
s_lshl_b32 s42, s42, 13
v_mfma_f32_16x16x32_bf16 a[12:15], a[172:175], a[204:207], a[12:15]
s_and_b32 s33, s33, 65535
buffer_store_dwordx4 v[132:135], v13, s[8:11], s29 offen sc1
s_lshl_b32 s43, s27, 5
v_mfma_f32_16x16x32_bf16 a[16:19], a[172:175], a[208:211], a[16:19]
s_add_u32 s43, s43, s26
s_lshl_b32 s43, s43, 2
s_lshl_b32 s24, s2, 1
v_mfma_f32_16x16x32_bf16 a[20:23], a[172:175], a[212:215], a[20:23]
s_add_u32 s48, s48, s34
s_add_u32 s24, s24, s61
s_lshl_b32 s24, s24, 2
v_mfma_f32_16x16x32_bf16 a[24:27], a[172:175], a[216:219], a[24:27]
s_add_u32 m0, s32, 16384
s_lshr_b32 s25, 0x8720, s24
s_and_b32 s25, s25, 15
v_mfma_f32_16x16x32_bf16 a[28:31], a[172:175], a[220:223], a[28:31]
buffer_load_dwordx4 v1, s[12:15], s48 offen lds
ds_read_b64_tr_b16 a[172:173], v8 offset:0
v_mfma_f32_16x16x32_bf16 a[32:35], a[176:179], a[192:195], a[32:35]
ds_read_b64_tr_b16 a[174:175], v8 offset:1024
s_lshl_b32 s25, s25, 24
v_mfma_f32_16x16x32_bf16 a[36:39], a[176:179], a[196:199], a[36:39]
s_add_u32 s42, s42, s25
s_lshr_b32 s25, 0x7604, s24
s_and_b32 s25, s25, 15
v_mfma_f32_16x16x32_bf16 a[40:43], a[176:179], a[200:203], a[40:43]
s_lshl_b32 s25, s25, 12
s_add_u32 s43, s43, s25
s_add_u32 s43, s43, 111149056
v_mfma_f32_16x16x32_bf16 a[44:47], a[176:179], a[204:207], a[44:47]
s_cmp_lt_u32 s35, s45
s_cselect_b32 s101, s101, 536870912
s_cselect_b32 s46, s46, 536870912
v_mfma_f32_16x16x32_bf16 a[48:51], a[176:179], a[208:211], a[48:51]
s_add_u32 s48, s48, s34
v_xor_b32 v6, 16, v5
v_xor_b32 v7, 64, v5
v_mfma_f32_16x16x32_bf16 a[52:55], a[176:179], a[212:215], a[52:55]
s_add_u32 m0, s32, 20480
v_xor_b32 v8, 80, v5
v_xor_b32 v12, 208, v5
v_mfma_f32_16x16x32_bf16 a[56:59], a[176:179], a[216:219], a[56:59]
buffer_load_dwordx4 v1, s[12:15], s48 offen lds
v_add_u32 v3, 32768, v3
v_mfma_f32_16x16x32_bf16 a[60:63], a[176:179], a[220:223], a[60:63]
ds_read_b64_tr_b16 a[176:177], v9 offset:0
v_subrev_u32 v19, 98304, v3
v_mfma_f32_16x16x32_bf16 a[64:67], a[180:183], a[192:195], a[64:67]
ds_read_b64_tr_b16 a[178:179], v9 offset:1024
v_cmp_le_u32 vcc, 163840, v3
v_mfma_f32_16x16x32_bf16 a[68:71], a[180:183], a[196:199], a[68:71]
v_xor_b32 v9, 128, v5
v_cndmask_b32 v3, v3, v19, vcc
v_mfma_f32_16x16x32_bf16 a[72:75], a[180:183], a[200:203], a[72:75]
v_xor_b32 v4, 64, v3
v_mfma_f32_16x16x32_bf16 a[76:79], a[180:183], a[204:207], a[76:79]
s_add_u32 s48, s48, s34
v_mfma_f32_16x16x32_bf16 a[80:83], a[180:183], a[208:211], a[80:83]
s_add_u32 m0, s32, 24576
v_mfma_f32_16x16x32_bf16 a[84:87], a[180:183], a[212:215], a[84:87]
buffer_load_dwordx4 v1, s[12:15], s48 offen lds
v_mfma_f32_16x16x32_bf16 a[88:91], a[180:183], a[216:219], a[88:91]
s_add_u32 s29, s29, s93
v_mfma_f32_16x16x32_bf16 a[92:95], a[180:183], a[220:223], a[92:95]
ds_read_b64_tr_b16 a[180:181], v10 offset:0
v_mfma_f32_16x16x32_bf16 a[96:99], a[184:187], a[192:195], a[96:99]
buffer_store_dwordx4 v[136:139], v13, s[8:11], s29 offen sc1
ds_read_b64_tr_b16 a[182:183], v10 offset:1024
v_mfma_f32_16x16x32_bf16 a[100:103], a[184:187], a[196:199], a[100:103]
v_xor_b32 v10, 144, v5
v_mfma_f32_16x16x32_bf16 a[104:107], a[184:187], a[200:203], a[104:107]
s_add_u32 s48, s48, s34
v_mfma_f32_16x16x32_bf16 a[108:111], a[184:187], a[204:207], a[108:111]
s_add_u32 m0, s32, 28672
v_mfma_f32_16x16x32_bf16 a[112:115], a[184:187], a[208:211], a[112:115]
buffer_load_dwordx4 v1, s[12:15], s48 offen lds
v_mfma_f32_16x16x32_bf16 a[116:119], a[184:187], a[212:215], a[116:119]
s_add_u32 s30, s30, 128
v_mfma_f32_16x16x32_bf16 a[120:123], a[184:187], a[216:219], a[120:123]
s_add_u32 s32, s32, 32768
v_mfma_f32_16x16x32_bf16 a[124:127], a[184:187], a[220:223], a[124:127]
s_sub_u32 s48, s32, 98304
ds_read_b64_tr_b16 a[184:185], v11 offset:0
v_mfma_f32_16x16x32_bf16 a[128:131], a[188:191], a[192:195], a[128:131]
s_cmp_ge_u32 s32, 163840
s_cselect_b32 s32, s48, s32
ds_read_b64_tr_b16 a[186:187], v11 offset:1024
v_mfma_f32_16x16x32_bf16 a[132:135], a[188:191], a[196:199], a[132:135]
v_xor_b32 v11, 192, v5
v_mfma_f32_16x16x32_bf16 a[136:139], a[188:191], a[200:203], a[136:139]
buffer_load_dword v15, v14, s[96:99], s100 offen
v_mfma_f32_16x16x32_bf16 a[140:143], a[188:191], a[204:207], a[140:143]
s_add_u32 s100, s100, 16384
v_mfma_f32_16x16x32_bf16 a[144:147], a[188:191], a[208:211], a[144:147]
v_mfma_f32_16x16x32_bf16 a[148:151], a[188:191], a[212:215], a[148:151]
v_mfma_f32_16x16x32_bf16 a[152:155], a[188:191], a[216:219], a[152:155]
v_mfma_f32_16x16x32_bf16 a[156:159], a[188:191], a[220:223], a[156:159]
s_waitcnt vmcnt(20) lgkmcnt(0)
s_barrier
v_mfma_f32_16x16x32_bf16 v[160:163], a[160:163], a[224:227], v[160:163]
ds_read_b128 a[192:195], v3 offset:0
v_mfma_f32_16x16x32_bf16 v[164:167], a[160:163], a[228:231], v[164:167]
s_add_u32 s37, s31, 0
s_cmp_eq_u32 s2, 0
s_cselect_b64 s[4:5], s[52:53], s[54:55]
v_mfma_f32_16x16x32_bf16 v[168:171], a[160:163], a[232:235], v[168:171]
s_add_u32 m0, s33, 0
ds_read_b128 a[196:199], v4 offset:1024
s_mov_b32 s12, s4
v_mfma_f32_16x16x32_bf16 v[172:175], a[160:163], a[236:239], v[172:175]
buffer_load_dwordx4 v2, s[20:23], s37 offen  lds
s_and_b32 s13, s5, 0xffff
v_mfma_f32_16x16x32_bf16 v[176:179], a[160:163], a[240:243], v[176:179]
s_add_u32 s29, s29, s44
ds_read_b128 a[200:203], v3 offset:4096
s_lshl_b32 s14, s47, 11
v_mfma_f32_16x16x32_bf16 v[180:183], a[160:163], a[244:247], v[180:183]
s_mov_b32 s15, 0x20000
s_mov_b32 s30, s101
v_lshrrev_b32 v16, 3, v0
v_mfma_f32_16x16x32_bf16 v[184:187], a[160:163], a[248:251], v[184:187]
buffer_store_dwordx4 v[140:143], v13, s[8:11], s29 offen sc1
v_mul_lo_u32 v16, v16, s47
v_mfma_f32_16x16x32_bf16 v[188:191], a[160:163], a[252:255], v[188:191]
ds_read_b64_tr_b16 a[160:161], v5 offset:0
v_and_b32 v1, 0x70, v1
v_mfma_f32_16x16x32_bf16 v[192:195], a[164:167], a[224:227], v[192:195]
s_add_u32 s37, s31, 32768
ds_read_b64_tr_b16 a[162:163], v5 offset:1024
v_add_u32 v1, v1, v16
v_mfma_f32_16x16x32_bf16 v[196:199], a[164:167], a[228:231], v[196:199]
s_add_u32 m0, s33, 1024
ds_read_b128 a[204:207], v4 offset:5120
s_lshl_b32 s34, s47, 5
v_mfma_f32_16x16x32_bf16 v[200:203], a[164:167], a[232:235], v[200:203]
buffer_load_dwordx4 v2, s[20:23], s37 offen  lds
v_add_u32 v5, 16384, v5
v_mfma_f32_16x16x32_bf16 v[204:207], a[164:167], a[236:239], v[204:207]
ds_read_b128 a[208:211], v3 offset:8192
v_and_b32 v5, 65535, v5
v_mfma_f32_16x16x32_bf16 v[208:211], a[164:167], a[240:243], v[208:211]
v_mfma_f32_16x16x32_bf16 v[212:215], a[164:167], a[244:247], v[212:215]
ds_read_b128 a[212:215], v4 offset:9216
v_mfma_f32_16x16x32_bf16 v[216:219], a[164:167], a[248:251], v[216:219]
v_mfma_f32_16x16x32_bf16 v[220:223], a[164:167], a[252:255], v[220:223]
s_add_u32 s37, s31, 131072
ds_read_b64_tr_b16 a[164:165], v6 offset:0
v_mfma_f32_16x16x32_bf16 v[224:227], a[168:171], a[224:227], v[224:227]
s_add_u32 m0, s33, 4096
ds_read_b64_tr_b16 a[166:167], v6 offset:1024
v_mfma_f32_16x16x32_bf16 v[228:231], a[168:171], a[228:231], v[228:231]
buffer_load_dwordx4 v2, s[20:23], s37 offen  lds
v_xor_b32 v6, 16, v5
v_mfma_f32_16x16x32_bf16 v[232:235], a[168:171], a[232:235], v[232:235]
ds_read_b128 a[216:219], v3 offset:12288
v_mfma_f32_16x16x32_bf16 v[236:239], a[168:171], a[236:239], v[236:239]
v_mfma_f32_16x16x32_bf16 v[240:243], a[168:171], a[240:243], v[240:243]
ds_read_b128 a[220:223], v4 offset:13312
v_mfma_f32_16x16x32_bf16 v[244:247], a[168:171], a[244:247], v[244:247]
v_mfma_f32_16x16x32_bf16 v[248:251], a[168:171], a[248:251], v[248:251]
s_add_u32 s37, s31, 163840
ds_read_b64_tr_b16 a[188:189], v12 offset:0
v_mfma_f32_16x16x32_bf16 v[252:255], a[168:171], a[252:255], v[252:255]
s_add_u32 m0, s33, 5120
ds_read_b64_tr_b16 a[168:169], v7 offset:0
v_mfma_f32_16x16x32_bf16 a[0:3], a[172:175], a[224:227], a[0:3]
buffer_load_dwordx4 v2, s[20:23], s37 offen  lds
ds_read_b64_tr_b16 a[170:171], v7 offset:1024
v_mfma_f32_16x16x32_bf16 a[4:7], a[172:175], a[228:231], a[4:7]
s_add_u32 s31, s31, 262144
s_add_u32 s29, s29, s93
v_xor_b32 v7, 64, v5
v_mfma_f32_16x16x32_bf16 a[8:11], a[172:175], a[232:235], a[8:11]
s_add_u32 s33, s33, 16384
ds_read_b64_tr_b16 a[190:191], v12 offset:1024
v_mfma_f32_16x16x32_bf16 a[12:15], a[172:175], a[236:239], a[12:15]
s_and_b32 s33, s33, 65535
buffer_store_dwordx4 v[144:147], v13, s[8:11], s29 offen sc1
v_mfma_f32_16x16x32_bf16 a[16:19], a[172:175], a[240:243], a[16:19]
v_mfma_f32_16x16x32_bf16 a[20:23], a[172:175], a[244:247], a[20:23]
s_mov_b32 s48, s30
v_xor_b32 v12, 208, v5
v_mfma_f32_16x16x32_bf16 a[24:27], a[172:175], a[248:251], a[24:27]
s_add_u32 m0, s32, 0
v_mfma_f32_16x16x32_bf16 a[28:31], a[172:175], a[252:255], a[28:31]
buffer_load_dwordx4 v1, s[12:15], s48 offen lds
ds_read_b64_tr_b16 a[172:173], v8 offset:0
v_mfma_f32_16x16x32_bf16 a[32:35], a[176:179], a[224:227], a[32:35]
ds_read_b64_tr_b16 a[174:175], v8 offset:1024
v_mfma_f32_16x16x32_bf16 a[36:39], a[176:179], a[228:231], a[36:39]
v_xor_b32 v8, 80, v5
v_mfma_f32_16x16x32_bf16 a[40:43], a[176:179], a[232:235], a[40:43]
v_mfma_f32_16x16x32_bf16 a[44:47], a[176:179], a[236:239], a[44:47]
v_mfma_f32_16x16x32_bf16 a[48:51], a[176:179], a[240:243], a[48:51]
s_add_u32 s48, s48, s34
v_mfma_f32_16x16x32_bf16 a[52:55], a[176:179], a[244:247], a[52:55]
s_add_u32 m0, s32, 4096
v_mfma_f32_16x16x32_bf16 a[56:59], a[176:179], a[248:251], a[56:59]
buffer_load_dwordx4 v1, s[12:15], s48 offen lds
v_mfma_f32_16x16x32_bf16 a[60:63], a[176:179], a[252:255], a[60:63]
ds_read_b64_tr_b16 a[176:177], v9 offset:0
v_mfma_f32_16x16x32_bf16 a[64:67], a[180:183], a[224:227], a[64:67]
ds_read_b64_tr_b16 a[178:179], v9 offset:1024
v_mfma_f32_16x16x32_bf16 a[68:71], a[180:183], a[228:231], a[68:71]
v_xor_b32 v9, 128, v5
v_mfma_f32_16x16x32_bf16 a[72:75], a[180:183], a[232:235], a[72:75]
v_mfma_f32_16x16x32_bf16 a[76:79], a[180:183], a[236:239], a[76:79]
s_add_u32 s48, s48, s34
v_mfma_f32_16x16x32_bf16 a[80:83], a[180:183], a[240:243], a[80:83]
s_add_u32 m0, s32, 8192
s_cmp_eq_u32 s2, 0
s_cselect_b64 s[4:5], s[6:7], s[18:19]
v_mfma_f32_16x16x32_bf16 a[84:87], a[180:183], a[244:247], a[84:87]
buffer_load_dwordx4 v1, s[12:15], s48 offen lds
s_mov_b32 s20, s4
v_mfma_f32_16x16x32_bf16 a[88:91], a[180:183], a[248:251], a[88:91]
s_add_u32 s29, s29, s44
s_and_b32 s21, s5, 0xffff
s_lshl_b32 s22, s47, 12
v_mfma_f32_16x16x32_bf16 a[92:95], a[180:183], a[252:255], a[92:95]
ds_read_b64_tr_b16 a[180:181], v10 offset:0
s_mov_b32 s23, 0x20000
v_mfma_f32_16x16x32_bf16 a[96:99], a[184:187], a[224:227], a[96:99]
buffer_store_dwordx4 v[148:151], v13, s[8:11], s29 offen sc1
ds_read_b64_tr_b16 a[182:183], v10 offset:1024
v_mfma_f32_16x16x32_bf16 a[100:103], a[184:187], a[228:231], a[100:103]
s_mov_b32 s31, s46
v_xor_b32 v10, 144, v5
v_mfma_f32_16x16x32_bf16 a[104:107], a[184:187], a[232:235], a[104:107]
s_add_u32 s48, s48, s34
v_mfma_f32_16x16x32_bf16 a[108:111], a[184:187], a[236:239], a[108:111]
s_add_u32 m0, s32, 12288
v_mfma_f32_16x16x32_bf16 a[112:115], a[184:187], a[240:243], a[112:115]
buffer_load_dwordx4 v1, s[12:15], s48 offen lds
v_mfma_f32_16x16x32_bf16 a[116:119], a[184:187], a[244:247], a[116:119]
v_mfma_f32_16x16x32_bf16 a[120:123], a[184:187], a[248:251], a[120:123]
v_mfma_f32_16x16x32_bf16 a[124:127], a[184:187], a[252:255], a[124:127]
ds_read_b64_tr_b16 a[184:185], v11 offset:0
v_mfma_f32_16x16x32_bf16 a[128:131], v[28:31], a[224:227], a[128:131]
ds_read_b64_tr_b16 a[186:187], v11 offset:1024
v_mfma_f32_16x16x32_bf16 a[132:135], v[28:31], a[228:231], a[132:135]
v_xor_b32 v11, 192, v5
v_mfma_f32_16x16x32_bf16 a[136:139], v[28:31], a[232:235], a[136:139]
buffer_load_dword v15, v14, s[96:99], s100 offen
v_mfma_f32_16x16x32_bf16 a[140:143], v[28:31], a[236:239], a[140:143]
s_add_u32 s100, s100, 16384
v_mfma_f32_16x16x32_bf16 a[144:147], v[28:31], a[240:243], a[144:147]
v_mfma_f32_16x16x32_bf16 a[148:151], v[28:31], a[244:247], a[148:151]
v_mfma_f32_16x16x32_bf16 a[152:155], v[28:31], a[248:251], a[152:155]
v_mfma_f32_16x16x32_bf16 a[156:159], v[28:31], a[252:255], a[156:159]
s_waitcnt vmcnt(24) lgkmcnt(0)
s_barrier
v_mfma_f32_16x16x32_bf16 v[160:163], a[160:163], a[192:195], v[160:163]
ds_read_b128 a[224:227], v4 offset:0
v_mfma_f32_16x16x32_bf16 v[164:167], a[160:163], a[196:199], v[164:167]
s_add_u32 s37, s31, 0
v_mfma_f32_16x16x32_bf16 v[168:171], a[160:163], a[200:203], v[168:171]
s_add_u32 m0, s33, 0
ds_read_b128 a[228:231], v3 offset:1024
v_mfma_f32_16x16x32_bf16 v[172:175], a[160:163], a[204:207], v[172:175]
buffer_load_dwordx4 v2, s[20:23], s37 offen  lds
v_mfma_f32_16x16x32_bf16 v[176:179], a[160:163], a[208:211], v[176:179]
s_add_u32 s29, s29, s93
ds_read_b128 a[232:235], v4 offset:4096
v_mfma_f32_16x16x32_bf16 v[180:183], a[160:163], a[212:215], v[180:183]
v_mfma_f32_16x16x32_bf16 v[184:187], a[160:163], a[216:219], v[184:187]
buffer_store_dwordx4 v[152:155], v13, s[8:11], s29 offen sc1
v_mfma_f32_16x16x32_bf16 v[188:191], a[160:163], a[220:223], v[188:191]
ds_read_b64_tr_b16 a[160:161], v5 offset:0
v_mfma_f32_16x16x32_bf16 v[192:195], a[164:167], a[192:195], v[192:195]
s_add_u32 s37, s31, 32768
ds_read_b64_tr_b16 a[162:163], v5 offset:1024
v_mfma_f32_16x16x32_bf16 v[196:199], a[164:167], a[196:199], v[196:199]
s_add_u32 m0, s33, 1024
ds_read_b128 a[236:239], v3 offset:5120
v_add_u32 v5, 16384, v5
v_mfma_f32_16x16x32_bf16 v[200:203], a[164:167], a[200:203], v[200:203]
buffer_load_dwordx4 v2, s[20:23], s37 offen  lds
v_and_b32 v5, 65535, v5
v_mfma_f32_16x16x32_bf16 v[204:207], a[164:167], a[204:207], v[204:207]
ds_read_b128 a[240:243], v4 offset:8192
v_mfma_f32_16x16x32_bf16 v[208:211], a[164:167], a[208:211], v[208:211]
v_mfma_f32_16x16x32_bf16 v[212:215], a[164:167], a[212:215], v[212:215]
ds_read_b128 a[244:247], v3 offset:9216
v_mfma_f32_16x16x32_bf16 v[216:219], a[164:167], a[216:219], v[216:219]
v_mfma_f32_16x16x32_bf16 v[220:223], a[164:167], a[220:223], v[220:223]
s_add_u32 s37, s31, 131072
ds_read_b64_tr_b16 a[164:165], v6 offset:0
v_mfma_f32_16x16x32_bf16 v[224:227], a[168:171], a[192:195], v[224:227]
s_add_u32 m0, s33, 4096
ds_read_b64_tr_b16 a[166:167], v6 offset:1024
v_mfma_f32_16x16x32_bf16 v[228:231], a[168:171], a[196:199], v[228:231]
buffer_load_dwordx4 v2, s[20:23], s37 offen  lds
v_xor_b32 v6, 16, v5
v_mfma_f32_16x16x32_bf16 v[232:235], a[168:171], a[200:203], v[232:235]
ds_read_b128 a[248:251], v4 offset:12288
v_mfma_f32_16x16x32_bf16 v[236:239], a[168:171], a[204:207], v[236:239]
v_mfma_f32_16x16x32_bf16 v[240:243], a[168:171], a[208:211], v[240:243]
ds_read_b128 a[252:255], v3 offset:13312
v_mfma_f32_16x16x32_bf16 v[244:247], a[168:171], a[212:215], v[244:247]
v_mfma_f32_16x16x32_bf16 v[248:251], a[168:171], a[216:219], v[248:251]
s_add_u32 s37, s31, 163840
ds_read_b64_tr_b16 v[28:29], v12 offset:0
v_mfma_f32_16x16x32_bf16 v[252:255], a[168:171], a[220:223], v[252:255]
s_add_u32 m0, s33, 5120
ds_read_b64_tr_b16 a[168:169], v7 offset:0
v_mfma_f32_16x16x32_bf16 a[0:3], a[172:175], a[192:195], a[0:3]
buffer_load_dwordx4 v2, s[20:23], s37 offen  lds
ds_read_b64_tr_b16 a[170:171], v7 offset:1024
v_mfma_f32_16x16x32_bf16 a[4:7], a[172:175], a[196:199], a[4:7]
s_add_u32 s31, s31, 262144
s_add_u32 s29, s29, s44
v_xor_b32 v7, 64, v5
v_mfma_f32_16x16x32_bf16 a[8:11], a[172:175], a[200:203], a[8:11]
s_add_u32 s33, s33, 16384
ds_read_b64_tr_b16 v[30:31], v12 offset:1024
v_mfma_f32_16x16x32_bf16 a[12:15], a[172:175], a[204:207], a[12:15]
s_and_b32 s33, s33, 65535
buffer_store_dwordx4 v[156:159], v13, s[8:11], s29 offen sc1
v_mfma_f32_16x16x32_bf16 a[16:19], a[172:175], a[208:211], a[16:19]
v_mfma_f32_16x16x32_bf16 a[20:23], a[172:175], a[212:215], a[20:23]
s_add_u32 s48, s48, s34
v_xor_b32 v12, 208, v5
v_mfma_f32_16x16x32_bf16 a[24:27], a[172:175], a[216:219], a[24:27]
s_add_u32 m0, s32, 16384
v_add_u32 v3, 32768, v3
v_mfma_f32_16x16x32_bf16 a[28:31], a[172:175], a[220:223], a[28:31]
buffer_load_dwordx4 v1, s[12:15], s48 offen lds
ds_read_b64_tr_b16 a[172:173], v8 offset:0
v_mfma_f32_16x16x32_bf16 a[32:35], a[176:179], a[192:195], a[32:35]
ds_read_b64_tr_b16 a[174:175], v8 offset:1024
v_subrev_u32 v19, 98304, v3
v_mfma_f32_16x16x32_bf16 a[36:39], a[176:179], a[196:199], a[36:39]
v_xor_b32 v8, 80, v5
v_cmp_le_u32 vcc, 163840, v3
v_mfma_f32_16x16x32_bf16 a[40:43], a[176:179], a[200:203], a[40:43]
s_nop 0
v_cndmask_b32 v3, v3, v19, vcc
v_mfma_f32_16x16x32_bf16 a[44:47], a[176:179], a[204:207], a[44:47]
v_xor_b32 v4, 64, v3
v_mfma_f32_16x16x32_bf16 a[48:51], a[176:179], a[208:211], a[48:51]
s_add_u32 s48, s48, s34
v_mfma_f32_16x16x32_bf16 a[52:55], a[176:179], a[212:215], a[52:55]
s_add_u32 m0, s32, 20480
v_mfma_f32_16x16x32_bf16 a[56:59], a[176:179], a[216:219], a[56:59]
buffer_load_dwordx4 v1, s[12:15], s48 offen lds
v_mfma_f32_16x16x32_bf16 a[60:63], a[176:179], a[220:223], a[60:63]
ds_read_b64_tr_b16 a[176:177], v9 offset:0
v_mfma_f32_16x16x32_bf16 a[64:67], a[180:183], a[192:195], a[64:67]
ds_read_b64_tr_b16 a[178:179], v9 offset:1024
v_mfma_f32_16x16x32_bf16 a[68:71], a[180:183], a[196:199], a[68:71]
v_xor_b32 v9, 128, v5
v_mfma_f32_16x16x32_bf16 a[72:75], a[180:183], a[200:203], a[72:75]
v_mfma_f32_16x16x32_bf16 a[76:79], a[180:183], a[204:207], a[76:79]
s_add_u32 s48, s48, s34
v_mfma_f32_16x16x32_bf16 a[80:83], a[180:183], a[208:211], a[80:83]
s_add_u32 m0, s32, 24576
v_mfma_f32_16x16x32_bf16 a[84:87], a[180:183], a[212:215], a[84:87]
buffer_load_dwordx4 v1, s[12:15], s48 offen lds
v_mfma_f32_16x16x32_bf16 a[88:91], a[180:183], a[216:219], a[88:91]
v_mfma_f32_16x16x32_bf16 a[92:95], a[180:183], a[220:223], a[92:95]
ds_read_b64_tr_b16 a[180:181], v10 offset:0
v_mfma_f32_16x16x32_bf16 a[96:99], a[184:187], a[192:195], a[96:99]
ds_read_b64_tr_b16 a[182:183], v10 offset:1024
v_mfma_f32_16x16x32_bf16 a[100:103], a[184:187], a[196:199], a[100:103]
v_xor_b32 v10, 144, v5
v_mfma_f32_16x16x32_bf16 a[104:107], a[184:187], a[200:203], a[104:107]
s_add_u32 s48, s48, s34
v_mfma_f32_16x16x32_bf16 a[108:111], a[184:187], a[204:207], a[108:111]
s_add_u32 m0, s32, 28672
v_mfma_f32_16x16x32_bf16 a[112:115], a[184:187], a[208:211], a[112:115]
buffer_load_dwordx4 v1, s[12:15], s48 offen lds
v_mfma_f32_16x16x32_bf16 a[116:119], a[184:187], a[212:215], a[116:119]
s_add_u32 s30, s30, 128
v_mfma_f32_16x16x32_bf16 a[120:123], a[184:187], a[216:219], a[120:123]
s_add_u32 s32, s32, 32768
v_mfma_f32_16x16x32_bf16 a[124:127], a[184:187], a[220:223], a[124:127]
s_sub_u32 s48, s32, 98304
ds_read_b64_tr_b16 a[184:185], v11 offset:0
v_mfma_f32_16x16x32_bf16 a[128:131], a[188:191], a[192:195], a[128:131]
s_cmp_ge_u32 s32, 163840
s_cselect_b32 s32, s48, s32
ds_read_b64_tr_b16 a[186:187], v11 offset:1024
v_mfma_f32_16x16x32_bf16 a[132:135], a[188:191], a[196:199], a[132:135]
v_xor_b32 v11, 192, v5
v_mfma_f32_16x16x32_bf16 a[136:139], a[188:191], a[200:203], a[136:139]
buffer_load_dword v15, v14, s[96:99], s100 offen
v_mfma_f32_16x16x32_bf16 a[140:143], a[188:191], a[204:207], a[140:143]
s_add_u32 s100, s100, 16384
v_mfma_f32_16x16x32_bf16 a[144:147], a[188:191], a[208:211], a[144:147]
v_mfma_f32_16x16x32_bf16 a[148:151], a[188:191], a[212:215], a[148:151]
v_mfma_f32_16x16x32_bf16 a[152:155], a[188:191], a[216:219], a[152:155]
v_mfma_f32_16x16x32_bf16 a[156:159], a[188:191], a[220:223], a[156:159]
s_waitcnt vmcnt(23) lgkmcnt(0)
s_barrier
v_mfma_f32_16x16x32_bf16 v[160:163], a[160:163], a[224:227], v[160:163]
ds_read_b128 a[192:195], v3 offset:0
v_mfma_f32_16x16x32_bf16 v[164:167], a[160:163], a[228:231], v[164:167]
s_add_u32 s37, s31, 0
v_mfma_f32_16x16x32_bf16 v[168:171], a[160:163], a[232:235], v[168:171]
s_add_u32 m0, s33, 0
ds_read_b128 a[196:199], v4 offset:1024
v_mfma_f32_16x16x32_bf16 v[172:175], a[160:163], a[236:239], v[172:175]
buffer_load_dwordx4 v2, s[20:23], s37 offen  lds
v_mfma_f32_16x16x32_bf16 v[176:179], a[160:163], a[240:243], v[176:179]
ds_read_b128 a[200:203], v3 offset:4096
v_mfma_f32_16x16x32_bf16 v[180:183], a[160:163], a[244:247], v[180:183]
v_mfma_f32_16x16x32_bf16 v[184:187], a[160:163], a[248:251], v[184:187]
ds_read_b128 a[204:207], v4 offset:5120
v_mfma_f32_16x16x32_bf16 v[188:191], a[160:163], a[252:255], v[188:191]
ds_read_b64_tr_b16 a[160:161], v5 offset:0
v_mfma_f32_16x16x32_bf16 v[192:195], a[164:167], a[224:227], v[192:195]
s_add_u32 s37, s31, 32768
ds_read_b64_tr_b16 a[162:163], v5 offset:1024
v_mfma_f32_16x16x32_bf16 v[196:199], a[164:167], a[228:231], v[196:199]
s_add_u32 m0, s33, 1024
ds_read_b128 a[208:211], v3 offset:8192
v_add_u32 v5, 16384, v5
v_mfma_f32_16x16x32_bf16 v[200:203], a[164:167], a[232:235], v[200:203]
buffer_load_dwordx4 v2, s[20:23], s37 offen  lds
v_and_b32 v5, 65535, v5
v_mfma_f32_16x16x32_bf16 v[204:207], a[164:167], a[236:239], v[204:207]
ds_read_b128 a[212:215], v4 offset:9216
v_mfma_f32_16x16x32_bf16 v[208:211], a[164:167], a[240:243], v[208:211]
v_mfma_f32_16x16x32_bf16 v[212:215], a[164:167], a[244:247], v[212:215]
ds_read_b128 a[216:219], v3 offset:12288
v_mfma_f32_16x16x32_bf16 v[216:219], a[164:167], a[248:251], v[216:219]
v_mfma_f32_16x16x32_bf16 v[220:223], a[164:167], a[252:255], v[220:223]
s_add_u32 s37, s31, 131072
ds_read_b64_tr_b16 a[164:165], v6 offset:0
v_mfma_f32_16x16x32_bf16 v[224:227], a[168:171], a[224:227], v[224:227]
s_add_u32 m0, s33, 4096
ds_read_b64_tr_b16 a[166:167], v6 offset:1024
v_mfma_f32_16x16x32_bf16 v[228:231], a[168:171], a[228:231], v[228:231]
buffer_load_dwordx4 v2, s[20:23], s37 offen  lds
v_xor_b32 v6, 16, v5
v_mfma_f32_16x16x32_bf16 v[232:235], a[168:171], a[232:235], v[232:235]
ds_read_b128 a[220:223], v4 offset:13312
v_mfma_f32_16x16x32_bf16 v[236:239], a[168:171], a[236:239], v[236:239]
v_mfma_f32_16x16x32_bf16 v[240:243], a[168:171], a[240:243], v[240:243]
ds_read_b64_tr_b16 a[188:189], v12 offset:0
v_mfma_f32_16x16x32_bf16 v[244:247], a[168:171], a[244:247], v[244:247]
v_mfma_f32_16x16x32_bf16 v[248:251], a[168:171], a[248:251], v[248:251]
s_add_u32 s37, s31, 163840
ds_read_b64_tr_b16 a[190:191], v12 offset:1024
v_mfma_f32_16x16x32_bf16 v[252:255], a[168:171], a[252:255], v[252:255]
s_add_u32 m0, s33, 5120
ds_read_b64_tr_b16 a[168:169], v7 offset:0
v_mfma_f32_16x16x32_bf16 a[0:3], a[172:175], a[224:227], a[0:3]
buffer_load_dwordx4 v2, s[20:23], s37 offen  lds
ds_read_b64_tr_b16 a[170:171], v7 offset:1024
v_mfma_f32_16x16x32_bf16 a[4:7], a[172:175], a[228:231], a[4:7]
s_add_u32 s31, s31, 262144
v_xor_b32 v7, 64, v5
v_xor_b32 v12, 208, v5
v_mfma_f32_16x16x32_bf16 a[8:11], a[172:175], a[232:235], a[8:11]
s_add_u32 s33, s33, 16384
v_mfma_f32_16x16x32_bf16 a[12:15], a[172:175], a[236:239], a[12:15]
s_and_b32 s33, s33, 65535
v_mfma_f32_16x16x32_bf16 a[16:19], a[172:175], a[240:243], a[16:19]
v_mfma_f32_16x16x32_bf16 a[20:23], a[172:175], a[244:247], a[20:23]
s_mov_b32 s48, s30
v_mfma_f32_16x16x32_bf16 a[24:27], a[172:175], a[248:251], a[24:27]
s_add_u32 m0, s32, 0
v_mfma_f32_16x16x32_bf16 a[28:31], a[172:175], a[252:255], a[28:31]
buffer_load_dwordx4 v1, s[12:15], s48 offen lds
ds_read_b64_tr_b16 a[172:173], v8 offset:0
v_mfma_f32_16x16x32_bf16 a[32:35], a[176:179], a[224:227], a[32:35]
ds_read_b64_tr_b16 a[174:175], v8 offset:1024
v_mfma_f32_16x16x32_bf16 a[36:39], a[176:179], a[228:231], a[36:39]
v_xor_b32 v8, 80, v5
v_mfma_f32_16x16x32_bf16 a[40:43], a[176:179], a[232:235], a[40:43]
v_mfma_f32_16x16x32_bf16 a[44:47], a[176:179], a[236:239], a[44:47]
v_mfma_f32_16x16x32_bf16 a[48:51], a[176:179], a[240:243], a[48:51]
s_add_u32 s48, s48, s34
v_mfma_f32_16x16x32_bf16 a[52:55], a[176:179], a[244:247], a[52:55]
s_add_u32 m0, s32, 4096
v_mfma_f32_16x16x32_bf16 a[56:59], a[176:179], a[248:251], a[56:59]
buffer_load_dwordx4 v1, s[12:15], s48 offen lds
v_mfma_f32_16x16x32_bf16 a[60:63], a[176:179], a[252:255], a[60:63]
ds_read_b64_tr_b16 a[176:177], v9 offset:0
v_mfma_f32_16x16x32_bf16 a[64:67], a[180:183], a[224:227], a[64:67]
ds_read_b64_tr_b16 a[178:179], v9 offset:1024
v_mfma_f32_16x16x32_bf16 a[68:71], a[180:183], a[228:231], a[68:71]
v_xor_b32 v9, 128, v5
v_mfma_f32_16x16x32_bf16 a[72:75], a[180:183], a[232:235], a[72:75]
v_mfma_f32_16x16x32_bf16 a[76:79], a[180:183], a[236:239], a[76:79]
s_add_u32 s48, s48, s34
v_mfma_f32_16x16x32_bf16 a[80:83], a[180:183], a[240:243], a[80:83]
s_add_u32 m0, s32, 8192
v_mfma_f32_16x16x32_bf16 a[84:87], a[180:183], a[244:247], a[84:87]
buffer_load_dwordx4 v1, s[12:15], s48 offen lds
v_mfma_f32_16x16x32_bf16 a[88:91], a[180:183], a[248:251], a[88:91]
v_mfma_f32_16x16x32_bf16 a[92:95], a[180:183], a[252:255], a[92:95]
ds_read_b64_tr_b16 a[180:181], v10 offset:0
v_mfma_f32_16x16x32_bf16 a[96:99], a[184:187], a[224:227], a[96:99]
ds_read_b64_tr_b16 a[182:183], v10 offset:1024
v_mfma_f32_16x16x32_bf16 a[100:103], a[184:187], a[228:231], a[100:103]
v_xor_b32 v10, 144, v5
v_mfma_f32_16x16x32_bf16 a[104:107], a[184:187], a[232:235], a[104:107]
s_add_u32 s48, s48, s34
v_mfma_f32_16x16x32_bf16 a[108:111], a[184:187], a[236:239], a[108:111]
s_add_u32 m0, s32, 12288
v_mfma_f32_16x16x32_bf16 a[112:115], a[184:187], a[240:243], a[112:115]
buffer_load_dwordx4 v1, s[12:15], s48 offen lds
v_mfma_f32_16x16x32_bf16 a[116:119], a[184:187], a[244:247], a[116:119]
v_mfma_f32_16x16x32_bf16 a[120:123], a[184:187], a[248:251], a[120:123]
v_mfma_f32_16x16x32_bf16 a[124:127], a[184:187], a[252:255], a[124:127]
ds_read_b64_tr_b16 a[184:185], v11 offset:0
v_mfma_f32_16x16x32_bf16 a[128:131], v[28:31], a[224:227], a[128:131]
ds_read_b64_tr_b16 a[186:187], v11 offset:1024
v_mfma_f32_16x16x32_bf16 a[132:135], v[28:31], a[228:231], a[132:135]
v_xor_b32 v11, 192, v5
v_mfma_f32_16x16x32_bf16 a[136:139], v[28:31], a[232:235], a[136:139]
buffer_load_dword v15, v14, s[96:99], s100 offen
v_mfma_f32_16x16x32_bf16 a[140:143], v[28:31], a[236:239], a[140:143]
s_add_u32 s100, s100, 16384
v_mfma_f32_16x16x32_bf16 a[144:147], v[28:31], a[240:243], a[144:147]
v_mfma_f32_16x16x32_bf16 a[148:151], v[28:31], a[244:247], a[148:151]
v_mfma_f32_16x16x32_bf16 a[152:155], v[28:31], a[248:251], a[152:155]
v_mfma_f32_16x16x32_bf16 a[156:159], v[28:31], a[252:255], a[156:159]
s_waitcnt vmcnt(20) lgkmcnt(0)
s_barrier
v_mfma_f32_16x16x32_bf16 v[160:163], a[160:163], a[192:195], v[160:163]
ds_read_b128 a[224:227], v4 offset:0
v_mfma_f32_16x16x32_bf16 v[164:167], a[160:163], a[196:199], v[164:167]
s_add_u32 s37, s31, 0
v_mfma_f32_16x16x32_bf16 v[168:171], a[160:163], a[200:203], v[168:171]
s_add_u32 m0, s33, 0
ds_read_b128 a[228:231], v3 offset:1024
v_mfma_f32_16x16x32_bf16 v[172:175], a[160:163], a[204:207], v[172:175]
buffer_load_dwordx4 v2, s[20:23], s37 offen  lds
v_mfma_f32_16x16x32_bf16 v[176:179], a[160:163], a[208:211], v[176:179]
ds_read_b128 a[232:235], v4 offset:4096
v_mfma_f32_16x16x32_bf16 v[180:183], a[160:163], a[212:215], v[180:183]
v_mfma_f32_16x16x32_bf16 v[184:187], a[160:163], a[216:219], v[184:187]
ds_read_b128 a[236:239], v3 offset:5120
v_mfma_f32_16x16x32_bf16 v[188:191], a[160:163], a[220:223], v[188:191]
ds_read_b64_tr_b16 a[160:161], v5 offset:0
v_mfma_f32_16x16x32_bf16 v[192:195], a[164:167], a[192:195], v[192:195]
s_add_u32 s37, s31, 32768
ds_read_b64_tr_b16 a[162:163], v5 offset:1024
v_mfma_f32_16x16x32_bf16 v[196:199], a[164:167], a[196:199], v[196:199]
s_add_u32 m0, s33, 1024
ds_read_b128 a[240:243], v4 offset:8192
v_add_u32 v5, 16384, v5
v_mfma_f32_16x16x32_bf16 v[200:203], a[164:167], a[200:203], v[200:203]
buffer_load_dwordx4 v2, s[20:23], s37 offen  lds
v_and_b32 v5, 65535, v5
v_mfma_f32_16x16x32_bf16 v[204:207], a[164:167], a[204:207], v[204:207]
ds_read_b128 a[244:247], v3 offset:9216
v_mfma_f32_16x16x32_bf16 v[208:211], a[164:167], a[208:211], v[208:211]
v_mfma_f32_16x16x32_bf16 v[212:215], a[164:167], a[212:215], v[212:215]
ds_read_b128 a[248:251], v4 offset:12288
v_mfma_f32_16x16x32_bf16 v[216:219], a[164:167], a[216:219], v[216:219]
v_mfma_f32_16x16x32_bf16 v[220:223], a[164:167], a[220:223], v[220:223]
s_add_u32 s37, s31, 131072
ds_read_b64_tr_b16 a[164:165], v6 offset:0
v_mfma_f32_16x16x32_bf16 v[224:227], a[168:171], a[192:195], v[224:227]
s_add_u32 m0, s33, 4096
ds_read_b64_tr_b16 a[166:167], v6 offset:1024
v_mfma_f32_16x16x32_bf16 v[228:231], a[168:171], a[196:199], v[228:231]
buffer_load_dwordx4 v2, s[20:23], s37 offen  lds
v_xor_b32 v6, 16, v5
v_mfma_f32_16x16x32_bf16 v[232:235], a[168:171], a[200:203], v[232:235]
ds_read_b128 a[252:255], v3 offset:13312
v_mfma_f32_16x16x32_bf16 v[236:239], a[168:171], a[204:207], v[236:239]
v_mfma_f32_16x16x32_bf16 v[240:243], a[168:171], a[208:211], v[240:243]
ds_read_b64_tr_b16 v[28:29], v12 offset:0
v_mfma_f32_16x16x32_bf16 v[244:247], a[168:171], a[212:215], v[244:247]
v_mfma_f32_16x16x32_bf16 v[248:251], a[168:171], a[216:219], v[248:251]
s_add_u32 s37, s31, 163840
ds_read_b64_tr_b16 v[30:31], v12 offset:1024
v_mfma_f32_16x16x32_bf16 v[252:255], a[168:171], a[220:223], v[252:255]
s_add_u32 m0, s33, 5120
ds_read_b64_tr_b16 a[168:169], v7 offset:0
v_mfma_f32_16x16x32_bf16 a[0:3], a[172:175], a[192:195], a[0:3]
buffer_load_dwordx4 v2, s[20:23], s37 offen  lds
ds_read_b64_tr_b16 a[170:171], v7 offset:1024
v_mfma_f32_16x16x32_bf16 a[4:7], a[172:175], a[196:199], a[4:7]
s_add_u32 s31, s31, 262144
v_xor_b32 v7, 64, v5
v_xor_b32 v12, 208, v5
v_mfma_f32_16x16x32_bf16 a[8:11], a[172:175], a[200:203], a[8:11]
s_add_u32 s33, s33, 16384
v_add_u32 v3, 32768, v3
v_mfma_f32_16x16x32_bf16 a[12:15], a[172:175], a[204:207], a[12:15]
s_and_b32 s33, s33, 65535
v_subrev_u32 v19, 98304, v3
v_mfma_f32_16x16x32_bf16 a[16:19], a[172:175], a[208:211], a[16:19]
v_cmp_le_u32 vcc, 163840, v3
v_mfma_f32_16x16x32_bf16 a[20:23], a[172:175], a[212:215], a[20:23]
s_add_u32 s48, s48, s34
v_cndmask_b32 v3, v3, v19, vcc
v_mfma_f32_16x16x32_bf16 a[24:27], a[172:175], a[216:219], a[24:27]
s_add_u32 m0, s32, 16384
v_xor_b32 v4, 64, v3
v_mfma_f32_16x16x32_bf16 a[28:31], a[172:175], a[220:223], a[28:31]
buffer_load_dwordx4 v1, s[12:15], s48 offen lds
ds_read_b64_tr_b16 a[172:173], v8 offset:0
v_mfma_f32_16x16x32_bf16 a[32:35], a[176:179], a[192:195], a[32:35]
ds_read_b64_tr_b16 a[174:175], v8 offset:1024
v_mfma_f32_16x16x32_bf16 a[36:39], a[176:179], a[196:199], a[36:39]
v_xor_b32 v8, 80, v5
v_mfma_f32_16x16x32_bf16 a[40:43], a[176:179], a[200:203], a[40:43]
v_mfma_f32_16x16x32_bf16 a[44:47], a[176:179], a[204:207], a[44:47]
v_mfma_f32_16x16x32_bf16 a[48:51], a[176:179], a[208:211], a[48:51]
s_add_u32 s48, s48, s34
v_mfma_f32_16x16x32_bf16 a[52:55], a[176:179], a[212:215], a[52:55]
s_add_u32 m0, s32, 20480
v_mfma_f32_16x16x32_bf16 a[56:59], a[176:179], a[216:219], a[56:59]
buffer_load_dwordx4 v1, s[12:15], s48 offen lds
v_mfma_f32_16x16x32_bf16 a[60:63], a[176:179], a[220:223], a[60:63]
ds_read_b64_tr_b16 a[176:177], v9 offset:0
v_mfma_f32_16x16x32_bf16 a[64:67], a[180:183], a[192:195], a[64:67]
ds_read_b64_tr_b16 a[178:179], v9 offset:1024
v_mfma_f32_16x16x32_bf16 a[68:71], a[180:183], a[196:199], a[68:71]
v_xor_b32 v9, 128, v5
v_mfma_f32_16x16x32_bf16 a[72:75], a[180:183], a[200:203], a[72:75]
v_mfma_f32_16x16x32_bf16 a[76:79], a[180:183], a[204:207], a[76:79]
s_add_u32 s48, s48, s34
v_mfma_f32_16x16x32_bf16 a[80:83], a[180:183], a[208:211], a[80:83]
s_add_u32 m0, s32, 24576
v_mfma_f32_16x16x32_bf16 a[84:87], a[180:183], a[212:215], a[84:87]
buffer_load_dwordx4 v1, s[12:15], s48 offen lds
v_mfma_f32_16x16x32_bf16 a[88:91], a[180:183], a[216:219], a[88:91]
v_mfma_f32_16x16x32_bf16 a[92:95], a[180:183], a[220:223], a[92:95]
ds_read_b64_tr_b16 a[180:181], v10 offset:0
v_mfma_f32_16x16x32_bf16 a[96:99], a[184:187], a[192:195], a[96:99]
ds_read_b64_tr_b16 a[182:183], v10 offset:1024
v_mfma_f32_16x16x32_bf16 a[100:103], a[184:187], a[196:199], a[100:103]
v_xor_b32 v10, 144, v5
v_mfma_f32_16x16x32_bf16 a[104:107], a[184:187], a[200:203], a[104:107]
s_add_u32 s48, s48, s34
v_mfma_f32_16x16x32_bf16 a[108:111], a[184:187], a[204:207], a[108:111]
s_add_u32 m0, s32, 28672
v_mfma_f32_16x16x32_bf16 a[112:115], a[184:187], a[208:211], a[112:115]
buffer_load_dwordx4 v1, s[12:15], s48 offen lds
v_mfma_f32_16x16x32_bf16 a[116:119], a[184:187], a[212:215], a[116:119]
s_add_u32 s30, s30, 128
v_mfma_f32_16x16x32_bf16 a[120:123], a[184:187], a[216:219], a[120:123]
s_add_u32 s32, s32, 32768
v_mfma_f32_16x16x32_bf16 a[124:127], a[184:187], a[220:223], a[124:127]
s_sub_u32 s48, s32, 98304
ds_read_b64_tr_b16 a[184:185], v11 offset:0
v_mfma_f32_16x16x32_bf16 a[128:131], a[188:191], a[192:195], a[128:131]
s_cmp_ge_u32 s32, 163840
s_cselect_b32 s32, s48, s32
ds_read_b64_tr_b16 a[186:187], v11 offset:1024
v_mfma_f32_16x16x32_bf16 a[132:135], a[188:191], a[196:199], a[132:135]
v_xor_b32 v11, 192, v5
v_mfma_f32_16x16x32_bf16 a[136:139], a[188:191], a[200:203], a[136:139]
buffer_load_dword v15, v14, s[96:99], s100 offen
v_mfma_f32_16x16x32_bf16 a[140:143], a[188:191], a[204:207], a[140:143]
s_add_u32 s100, s100, 16384
v_mfma_f32_16x16x32_bf16 a[144:147], a[188:191], a[208:211], a[144:147]
v_mfma_f32_16x16x32_bf16 a[148:151], a[188:191], a[212:215], a[148:151]
v_mfma_f32_16x16x32_bf16 a[152:155], a[188:191], a[216:219], a[152:155]
v_mfma_f32_16x16x32_bf16 a[156:159], a[188:191], a[220:223], a[156:159]
s_cmp_eq_u32 s41, 0
s_cbranch_scc0 L_g_k17v
s_waitcnt vmcnt(18) lgkmcnt(0)
s_barrier
v_mfma_f32_16x16x32_bf16 v[160:163], a[160:163], a[224:227], v[160:163]
ds_read_b128 a[192:195], v3 offset:0
v_mfma_f32_16x16x32_bf16 v[164:167], a[160:163], a[228:231], v[164:167]
s_add_u32 s37, s31, 0
v_mfma_f32_16x16x32_bf16 v[168:171], a[160:163], a[232:235], v[168:171]
s_add_u32 m0, s33, 0
ds_read_b128 a[196:199], v4 offset:1024
v_mfma_f32_16x16x32_bf16 v[172:175], a[160:163], a[236:239], v[172:175]
buffer_load_dwordx4 v2, s[20:23], s37 offen  lds
v_mfma_f32_16x16x32_bf16 v[176:179], a[160:163], a[240:243], v[176:179]
ds_read_b128 a[200:203], v3 offset:4096
v_cvt_pk_bf16_f32 v32, v160, v161
v_cvt_pk_bf16_f32 v33, v162, v163
v_mfma_f32_16x16x32_bf16 v[180:183], a[160:163], a[244:247], v[180:183]
v_cvt_pk_bf16_f32 v36, v164, v165
v_cvt_pk_bf16_f32 v37, v166, v167
v_mfma_f32_16x16x32_bf16 v[184:187], a[160:163], a[248:251], v[184:187]
ds_read_b128 a[204:207], v4 offset:5120
v_cvt_pk_bf16_f32 v40, v168, v169
v_cvt_pk_bf16_f32 v41, v170, v171
v_mfma_f32_16x16x32_bf16 v[188:191], a[160:163], a[252:255], v[188:191]
ds_read_b64_tr_b16 a[160:161], v5 offset:0
v_cvt_pk_bf16_f32 v44, v172, v173
v_cvt_pk_bf16_f32 v45, v174, v175
v_mfma_f32_16x16x32_bf16 v[192:195], a[164:167], a[224:227], v[192:195]
s_add_u32 s37, s31, 32768
ds_read_b64_tr_b16 a[162:163], v5 offset:1024
v_cvt_pk_bf16_f32 v48, v176, v177
v_cvt_pk_bf16_f32 v49, v178, v179
v_mfma_f32_16x16x32_bf16 v[196:199], a[164:167], a[228:231], v[196:199]
s_add_u32 m0, s33, 1024
ds_read_b128 a[208:211], v3 offset:8192
v_add_u32 v5, 16384, v5
v_cvt_pk_bf16_f32 v52, v180, v181
v_cvt_pk_bf16_f32 v53, v182, v183
v_mfma_f32_16x16x32_bf16 v[200:203], a[164:167], a[232:235], v[200:203]
buffer_load_dwordx4 v2, s[20:23], s37 offen  lds
v_and_b32 v5, 65535, v5
v_cvt_pk_bf16_f32 v56, v184, v185
v_cvt_pk_bf16_f32 v57, v186, v187
v_mfma_f32_16x16x32_bf16 v[204:207], a[164:167], a[236:239], v[204:207]
ds_read_b128 a[212:215], v4 offset:9216
v_cvt_pk_bf16_f32 v60, v188, v189
v_cvt_pk_bf16_f32 v61, v190, v191
v_mfma_f32_16x16x32_bf16 v[208:211], a[164:167], a[240:243], v[208:211]
v_cvt_pk_bf16_f32 v34, v192, v193
v_cvt_pk_bf16_f32 v35, v194, v195
v_mfma_f32_16x16x32_bf16 v[212:215], a[164:167], a[244:247], v[212:215]
ds_read_b128 a[216:219], v3 offset:12288
v_cvt_pk_bf16_f32 v38, v196, v197
v_cvt_pk_bf16_f32 v39, v198, v199
v_mfma_f32_16x16x32_bf16 v[216:219], a[164:167], a[248:251], v[216:219]
v_cvt_pk_bf16_f32 v42, v200, v201
v_cvt_pk_bf16_f32 v43, v202, v203
v_mfma_f32_16x16x32_bf16 v[220:223], a[164:167], a[252:255], v[220:223]
s_add_u32 s37, s31, 131072
ds_read_b64_tr_b16 a[164:165], v6 offset:0
v_cvt_pk_bf16_f32 v46, v204, v205
v_cvt_pk_bf16_f32 v47, v206, v207
v_mfma_f32_16x16x32_bf16 v[224:227], a[168:171], a[224:227], v[224:227]
s_add_u32 m0, s33, 4096
ds_read_b64_tr_b16 a[166:167], v6 offset:1024
v_cvt_pk_bf16_f32 v50, v208, v209
v_cvt_pk_bf16_f32 v51, v210, v211
v_mfma_f32_16x16x32_bf16 v[228:231], a[168:171], a[228:231], v[228:231]
buffer_load_dwordx4 v2, s[20:23], s37 offen  lds
v_xor_b32 v6, 16, v5
v_cvt_pk_bf16_f32 v54, v212, v213
v_cvt_pk_bf16_f32 v55, v214, v215
v_mfma_f32_16x16x32_bf16 v[232:235], a[168:171], a[232:235], v[232:235]
ds_read_b128 a[220:223], v4 offset:13312
v_cvt_pk_bf16_f32 v58, v216, v217
v_cvt_pk_bf16_f32 v59, v218, v219
v_mfma_f32_16x16x32_bf16 v[236:239], a[168:171], a[236:239], v[236:239]
v_cvt_pk_bf16_f32 v62, v220, v221
v_cvt_pk_bf16_f32 v63, v222, v223
v_mfma_f32_16x16x32_bf16 v[240:243], a[168:171], a[240:243], v[240:243]
ds_read_b64_tr_b16 a[188:189], v12 offset:0
v_cvt_pk_bf16_f32 v64, v224, v225
v_cvt_pk_bf16_f32 v65, v226, v227
v_mfma_f32_16x16x32_bf16 v[244:247], a[168:171], a[244:247], v[244:247]
v_cvt_pk_bf16_f32 v68, v228, v229
v_cvt_pk_bf16_f32 v69, v230, v231
v_mfma_f32_16x16x32_bf16 v[248:251], a[168:171], a[248:251], v[248:251]
s_add_u32 s37, s31, 163840
ds_read_b64_tr_b16 a[190:191], v12 offset:1024
v_cvt_pk_bf16_f32 v72, v232, v233
v_cvt_pk_bf16_f32 v73, v234, v235
v_mfma_f32_16x16x32_bf16 v[252:255], a[168:171], a[252:255], v[252:255]
s_add_u32 m0, s33, 5120
ds_read_b64_tr_b16 a[168:169], v7 offset:0
v_cvt_pk_bf16_f32 v76, v236, v237
v_cvt_pk_bf16_f32 v77, v238, v239
v_mfma_f32_16x16x32_bf16 a[0:3], a[172:175], a[224:227], a[0:3]
buffer_load_dwordx4 v2, s[20:23], s37 offen  lds
ds_read_b64_tr_b16 a[170:171], v7 offset:1024
v_cvt_pk_bf16_f32 v80, v240, v241
v_cvt_pk_bf16_f32 v81, v242, v243
v_mfma_f32_16x16x32_bf16 a[4:7], a[172:175], a[228:231], a[4:7]
s_add_u32 s31, s31, 262144
v_xor_b32 v7, 64, v5
v_xor_b32 v12, 208, v5
v_cvt_pk_bf16_f32 v84, v244, v245
v_cvt_pk_bf16_f32 v85, v246, v247
v_mfma_f32_16x16x32_bf16 a[8:11], a[172:175], a[232:235], a[8:11]
s_add_u32 s33, s33, 16384
v_cvt_pk_bf16_f32 v88, v248, v249
v_cvt_pk_bf16_f32 v89, v250, v251
v_mfma_f32_16x16x32_bf16 a[12:15], a[172:175], a[236:239], a[12:15]
s_and_b32 s33, s33, 65535
v_cvt_pk_bf16_f32 v92, v252, v253
v_cvt_pk_bf16_f32 v93, v254, v255
v_mfma_f32_16x16x32_bf16 a[16:19], a[172:175], a[240:243], a[16:19]
v_accvgpr_read_b32 v20, a0
v_accvgpr_read_b32 v21, a1
v_accvgpr_read_b32 v22, a2
v_accvgpr_read_b32 v23, a3
v_mfma_f32_16x16x32_bf16 a[20:23], a[172:175], a[244:247], a[20:23]
s_mov_b32 s48, s30
v_cvt_pk_bf16_f32 v66, v20, v21
v_cvt_pk_bf16_f32 v67, v22, v23
v_accvgpr_read_b32 v24, a4
v_accvgpr_read_b32 v25, a5
v_mfma_f32_16x16x32_bf16 a[24:27], a[172:175], a[248:251], a[24:27]
s_add_u32 m0, s32, 0
v_accvgpr_read_b32 v26, a6
v_accvgpr_read_b32 v27, a7
v_cvt_pk_bf16_f32 v70, v24, v25
v_cvt_pk_bf16_f32 v71, v26, v27
v_mfma_f32_16x16x32_bf16 a[28:31], a[172:175], a[252:255], a[28:31]
buffer_load_dwordx4 v1, s[12:15], s48 offen lds
ds_read_b64_tr_b16 a[172:173], v8 offset:0
v_accvgpr_read_b32 v20, a8
v_accvgpr_read_b32 v21, a9
v_mfma_f32_16x16x32_bf16 a[32:35], a[176:179], a[224:227], a[32:35]
ds_read_b64_tr_b16 a[174:175], v8 offset:1024
v_mov_b32 v16, 0
v_accvgpr_read_b32 v22, a10
v_accvgpr_read_b32 v23, a11
v_mfma_f32_16x16x32_bf16 a[36:39], a[176:179], a[228:231], a[36:39]
v_mov_b32 v17, 1
v_xor_b32 v8, 80, v5
v_cvt_pk_bf16_f32 v74, v20, v21
v_cvt_pk_bf16_f32 v75, v22, v23
v_mfma_f32_16x16x32_bf16 a[40:43], a[176:179], a[232:235], a[40:43]
s_cmp_eq_u32 s17, 0
s_cselect_b32 s29, s39, 536870912
v_accvgpr_read_b32 v24, a12
v_accvgpr_read_b32 v25, a13
v_mfma_f32_16x16x32_bf16 a[44:47], a[176:179], a[236:239], a[44:47]
s_mov_b64 exec, 1
buffer_store_dword v17, v16, s[8:11], s29 offen sc1
s_mov_b64 exec, -1
v_accvgpr_read_b32 v26, a14
v_mfma_f32_16x16x32_bf16 a[48:51], a[176:179], a[240:243], a[48:51]
s_add_u32 s48, s48, s34
v_accvgpr_read_b32 v27, a15
v_cvt_pk_bf16_f32 v78, v24, v25
v_cvt_pk_bf16_f32 v79, v26, v27
v_accvgpr_read_b32 v20, a16
v_mfma_f32_16x16x32_bf16 a[52:55], a[176:179], a[244:247], a[52:55]
s_add_u32 m0, s32, 4096
v_accvgpr_read_b32 v21, a17
v_accvgpr_read_b32 v22, a18
v_accvgpr_read_b32 v23, a19
v_cvt_pk_bf16_f32 v82, v20, v21
v_mfma_f32_16x16x32_bf16 a[56:59], a[176:179], a[248:251], a[56:59]
buffer_load_dwordx4 v1, s[12:15], s48 offen lds
v_cvt_pk_bf16_f32 v83, v22, v23
v_accvgpr_read_b32 v24, a20
v_accvgpr_read_b32 v25, a21
v_mfma_f32_16x16x32_bf16 a[60:63], a[176:179], a[252:255], a[60:63]
ds_read_b64_tr_b16 a[176:177], v9 offset:0
v_accvgpr_read_b32 v26, a22
v_accvgpr_read_b32 v27, a23
v_cvt_pk_bf16_f32 v86, v24, v25
v_mfma_f32_16x16x32_bf16 a[64:67], a[180:183], a[224:227], a[64:67]
ds_read_b64_tr_b16 a[178:179], v9 offset:1024
v_cvt_pk_bf16_f32 v87, v26, v27
v_accvgpr_read_b32 v20, a24
v_accvgpr_read_b32 v21, a25
v_mfma_f32_16x16x32_bf16 a[68:71], a[180:183], a[228:231], a[68:71]
v_xor_b32 v9, 128, v5
v_accvgpr_read_b32 v22, a26
v_accvgpr_read_b32 v23, a27
v_cvt_pk_bf16_f32 v90, v20, v21
v_mfma_f32_16x16x32_bf16 a[72:75], a[180:183], a[232:235], a[72:75]
v_cvt_pk_bf16_f32 v91, v22, v23
v_accvgpr_read_b32 v24, a28
v_accvgpr_read_b32 v25, a29
v_accvgpr_read_b32 v26, a30
v_mfma_f32_16x16x32_bf16 a[76:79], a[180:183], a[236:239], a[76:79]
s_add_u32 s48, s48, s34
v_accvgpr_read_b32 v27, a31
v_cvt_pk_bf16_f32 v94, v24, v25
v_cvt_pk_bf16_f32 v95, v26, v27
v_accvgpr_read_b32 v20, a32
v_mfma_f32_16x16x32_bf16 a[80:83], a[180:183], a[240:243], a[80:83]
s_add_u32 m0, s32, 8192
v_accvgpr_read_b32 v21, a33
v_accvgpr_read_b32 v22, a34
v_accvgpr_read_b32 v23, a35
v_cvt_pk_bf16_f32 v96, v20, v21
v_mfma_f32_16x16x32_bf16 a[84:87], a[180:183], a[244:247], a[84:87]
buffer_load_dwordx4 v1, s[12:15], s48 offen lds
v_cvt_pk_bf16_f32 v97, v22, v23
v_accvgpr_read_b32 v24, a36
v_accvgpr_read_b32 v25, a37
v_mfma_f32_16x16x32_bf16 a[88:91], a[180:183], a[248:251], a[88:91]
v_accvgpr_read_b32 v26, a38
v_accvgpr_read_b32 v27, a39
v_cvt_pk_bf16_f32 v100, v24, v25
v_cvt_pk_bf16_f32 v101, v26, v27
v_mfma_f32_16x16x32_bf16 a[92:95], a[180:183], a[252:255], a[92:95]
ds_read_b64_tr_b16 a[180:181], v10 offset:0
v_accvgpr_read_b32 v20, a40
v_accvgpr_read_b32 v21, a41
v_accvgpr_read_b32 v22, a42
v_mfma_f32_16x16x32_bf16 a[96:99], a[184:187], a[224:227], a[96:99]
ds_read_b64_tr_b16 a[182:183], v10 offset:1024
v_accvgpr_read_b32 v23, a43
v_cvt_pk_bf16_f32 v104, v20, v21
v_cvt_pk_bf16_f32 v105, v22, v23
v_mfma_f32_16x16x32_bf16 a[100:103], a[184:187], a[228:231], a[100:103]
v_xor_b32 v10, 144, v5
v_accvgpr_read_b32 v24, a44
v_accvgpr_read_b32 v25, a45
v_accvgpr_read_b32 v26, a46
v_mfma_f32_16x16x32_bf16 a[104:107], a[184:187], a[232:235], a[104:107]
s_add_u32 s48, s48, s34
v_accvgpr_read_b32 v27, a47
v_cvt_pk_bf16_f32 v108, v24, v25
v_cvt_pk_bf16_f32 v109, v26, v27
v_accvgpr_read_b32 v20, a48
v_mfma_f32_16x16x32_bf16 a[108:111], a[184:187], a[236:239], a[108:111]
s_add_u32 m0, s32, 12288
v_accvgpr_read_b32 v21, a49
v_accvgpr_read_b32 v22, a50
v_accvgpr_read_b32 v23, a51
v_cvt_pk_bf16_f32 v112, v20, v21
v_mfma_f32_16x16x32_bf16 a[112:115], a[184:187], a[240:243], a[112:115]
buffer_load_dwordx4 v1, s[12:15], s48 offen lds
v_cvt_pk_bf16_f32 v113, v22, v23
v_accvgpr_read_b32 v24, a52
v_accvgpr_read_b32 v25, a53
v_mfma_f32_16x16x32_bf16 a[116:119], a[184:187], a[244:247], a[116:119]
v_accvgpr_read_b32 v26, a54
v_accvgpr_read_b32 v27, a55
v_cvt_pk_bf16_f32 v116, v24, v25
v_cvt_pk_bf16_f32 v117, v26, v27
v_mfma_f32_16x16x32_bf16 a[120:123], a[184:187], a[248:251], a[120:123]
v_accvgpr_read_b32 v20, a56
v_accvgpr_read_b32 v21, a57
v_accvgpr_read_b32 v22, a58
v_accvgpr_read_b32 v23, a59
v_mfma_f32_16x16x32_bf16 a[124:127], a[184:187], a[252:255], a[124:127]
ds_read_b64_tr_b16 a[184:185], v11 offset:0
v_cvt_pk_bf16_f32 v120, v20, v21
v_cvt_pk_bf16_f32 v121, v22, v23
v_accvgpr_read_b32 v24, a60
v_mfma_f32_16x16x32_bf16 a[128:131], v[28:31], a[224:227], a[128:131]
ds_read_b64_tr_b16 a[186:187], v11 offset:1024
v_accvgpr_read_b32 v25, a61
v_accvgpr_read_b32 v26, a62
v_accvgpr_read_b32 v27, a63
v_mfma_f32_16x16x32_bf16 a[132:135], v[28:31], a[228:231], a[132:135]
v_xor_b32 v11, 192, v5
v_cvt_pk_bf16_f32 v124, v24, v25
v_cvt_pk_bf16_f32 v125, v26, v27
v_mfma_f32_16x16x32_bf16 a[136:139], v[28:31], a[232:235], a[136:139]
buffer_load_dword v15, v14, s[96:99], s100 offen
v_mfma_f32_16x16x32_bf16 a[140:143], v[28:31], a[236:239], a[140:143]
s_add_u32 s100, s100, 16384
v_mfma_f32_16x16x32_bf16 a[144:147], v[28:31], a[240:243], a[144:147]
v_mfma_f32_16x16x32_bf16 a[148:151], v[28:31], a[244:247], a[148:151]
v_mfma_f32_16x16x32_bf16 a[152:155], v[28:31], a[248:251], a[152:155]
v_mfma_f32_16x16x32_bf16 a[156:159], v[28:31], a[252:255], a[156:159]
s_cmp_lt_u32 s35, s45
s_cbranch_scc1 L_g_tile
s_branch L_g_end
L_g_k17v:
s_waitcnt vmcnt(18) lgkmcnt(0)
s_barrier
v_mfma_f32_16x16x32_bf16 v[160:163], a[160:163], a[224:227], v[160:163]
ds_read_b64_tr_b16 a[192:193], v5 offset:0
v_mfma_f32_16x16x32_bf16 v[164:167], a[160:163], a[228:231], v[164:167]
s_add_u32 s37, s31, 0
v_mfma_f32_16x16x32_bf16 v[168:171], a[160:163], a[232:235], v[168:171]
s_add_u32 m0, s33, 0
ds_read_b64_tr_b16 a[194:195], v5 offset:1024
v_mfma_f32_16x16x32_bf16 v[172:175], a[160:163], a[236:239], v[172:175]
buffer_load_dwordx4 v2, s[20:23], s37 offen  lds
v_mfma_f32_16x16x32_bf16 v[176:179], a[160:163], a[240:243], v[176:179]
ds_read_b64_tr_b16 a[196:197], v6 offset:0
v_cvt_pk_bf16_f32 v32, v160, v161
v_cvt_pk_bf16_f32 v33, v162, v163
v_mfma_f32_16x16x32_bf16 v[180:183], a[160:163], a[244:247], v[180:183]
v_cvt_pk_bf16_f32 v36, v164, v165
v_cvt_pk_bf16_f32 v37, v166, v167
v_mfma_f32_16x16x32_bf16 v[184:187], a[160:163], a[248:251], v[184:187]
ds_read_b64_tr_b16 a[198:199], v6 offset:1024
v_cvt_pk_bf16_f32 v40, v168, v169
v_cvt_pk_bf16_f32 v41, v170, v171
v_mfma_f32_16x16x32_bf16 v[188:191], a[160:163], a[252:255], v[188:191]
ds_read_b128 a[160:163], v3 offset:0
v_cvt_pk_bf16_f32 v44, v172, v173
v_cvt_pk_bf16_f32 v45, v174, v175
v_mfma_f32_16x16x32_bf16 v[192:195], a[164:167], a[224:227], v[192:195]
s_add_u32 s37, s31, 32768
ds_read_b64_tr_b16 a[200:201], v7 offset:0
v_cvt_pk_bf16_f32 v48, v176, v177
v_cvt_pk_bf16_f32 v49, v178, v179
v_mfma_f32_16x16x32_bf16 v[196:199], a[164:167], a[228:231], v[196:199]
s_add_u32 m0, s33, 1024
v_cvt_pk_bf16_f32 v52, v180, v181
v_cvt_pk_bf16_f32 v53, v182, v183
v_mfma_f32_16x16x32_bf16 v[200:203], a[164:167], a[232:235], v[200:203]
buffer_load_dwordx4 v2, s[20:23], s37 offen  lds
v_cvt_pk_bf16_f32 v56, v184, v185
v_cvt_pk_bf16_f32 v57, v186, v187
v_mfma_f32_16x16x32_bf16 v[204:207], a[164:167], a[236:239], v[204:207]
ds_read_b64_tr_b16 a[202:203], v7 offset:1024
v_cvt_pk_bf16_f32 v60, v188, v189
v_cvt_pk_bf16_f32 v61, v190, v191
v_mfma_f32_16x16x32_bf16 v[208:211], a[164:167], a[240:243], v[208:211]
v_cvt_pk_bf16_f32 v34, v192, v193
v_cvt_pk_bf16_f32 v35, v194, v195
v_mfma_f32_16x16x32_bf16 v[212:215], a[164:167], a[244:247], v[212:215]
ds_read_b64_tr_b16 a[204:205], v8 offset:0
v_cvt_pk_bf16_f32 v38, v196, v197
v_cvt_pk_bf16_f32 v39, v198, v199
v_mfma_f32_16x16x32_bf16 v[216:219], a[164:167], a[248:251], v[216:219]
v_cvt_pk_bf16_f32 v42, v200, v201
v_cvt_pk_bf16_f32 v43, v202, v203
v_mfma_f32_16x16x32_bf16 v[220:223], a[164:167], a[252:255], v[220:223]
s_add_u32 s37, s31, 131072
ds_read_b128 a[164:167], v4 offset:1024
v_cvt_pk_bf16_f32 v46, v204, v205
v_cvt_pk_bf16_f32 v47, v206, v207
v_mfma_f32_16x16x32_bf16 v[224:227], a[168:171], a[224:227], v[224:227]
s_add_u32 m0, s33, 4096
ds_read_b64_tr_b16 a[206:207], v8 offset:1024
v_cvt_pk_bf16_f32 v50, v208, v209
v_cvt_pk_bf16_f32 v51, v210, v211
v_mfma_f32_16x16x32_bf16 v[228:231], a[168:171], a[228:231], v[228:231]
buffer_load_dwordx4 v2, s[20:23], s37 offen  lds
v_cvt_pk_bf16_f32 v54, v212, v213
v_cvt_pk_bf16_f32 v55, v214, v215
v_mfma_f32_16x16x32_bf16 v[232:235], a[168:171], a[232:235], v[232:235]
ds_read_b64_tr_b16 a[208:209], v9 offset:0
v_cvt_pk_bf16_f32 v58, v216, v217
v_cvt_pk_bf16_f32 v59, v218, v219
v_mfma_f32_16x16x32_bf16 v[236:239], a[168:171], a[236:239], v[236:239]
v_cvt_pk_bf16_f32 v62, v220, v221
v_cvt_pk_bf16_f32 v63, v222, v223
v_mfma_f32_16x16x32_bf16 v[240:243], a[168:171], a[240:243], v[240:243]
ds_read_b64_tr_b16 a[210:211], v9 offset:1024
v_cvt_pk_bf16_f32 v64, v224, v225
v_cvt_pk_bf16_f32 v65, v226, v227
v_mfma_f32_16x16x32_bf16 v[244:247], a[168:171], a[244:247], v[244:247]
v_cvt_pk_bf16_f32 v68, v228, v229
v_cvt_pk_bf16_f32 v69, v230, v231
v_mfma_f32_16x16x32_bf16 v[248:251], a[168:171], a[248:251], v[248:251]
s_add_u32 s37, s31, 163840
ds_read_b64_tr_b16 a[212:213], v10 offset:0
v_cvt_pk_bf16_f32 v72, v232, v233
v_cvt_pk_bf16_f32 v73, v234, v235
v_mfma_f32_16x16x32_bf16 v[252:255], a[168:171], a[252:255], v[252:255]
s_add_u32 m0, s33, 5120
ds_read_b128 a[168:171], v3 offset:4096
v_cvt_pk_bf16_f32 v76, v236, v237
v_cvt_pk_bf16_f32 v77, v238, v239
v_mfma_f32_16x16x32_bf16 a[0:3], a[172:175], a[224:227], a[0:3]
buffer_load_dwordx4 v2, s[20:23], s37 offen  lds
v_cvt_pk_bf16_f32 v80, v240, v241
v_cvt_pk_bf16_f32 v81, v242, v243
v_mfma_f32_16x16x32_bf16 a[4:7], a[172:175], a[228:231], a[4:7]
s_add_u32 s31, s31, 262144
ds_read_b64_tr_b16 a[214:215], v10 offset:1024
v_cvt_pk_bf16_f32 v84, v244, v245
v_cvt_pk_bf16_f32 v85, v246, v247
v_mfma_f32_16x16x32_bf16 a[8:11], a[172:175], a[232:235], a[8:11]
s_add_u32 s33, s33, 16384
v_cvt_pk_bf16_f32 v88, v248, v249
v_cvt_pk_bf16_f32 v89, v250, v251
v_mfma_f32_16x16x32_bf16 a[12:15], a[172:175], a[236:239], a[12:15]
s_and_b32 s33, s33, 65535
ds_read_b64_tr_b16 a[216:217], v11 offset:0
v_cvt_pk_bf16_f32 v92, v252, v253
v_cvt_pk_bf16_f32 v93, v254, v255
v_mfma_f32_16x16x32_bf16 a[16:19], a[172:175], a[240:243], a[16:19]
v_accvgpr_read_b32 v20, a0
v_accvgpr_read_b32 v21, a1
v_accvgpr_read_b32 v22, a2
v_accvgpr_read_b32 v23, a3
v_mfma_f32_16x16x32_bf16 a[20:23], a[172:175], a[244:247], a[20:23]
s_mov_b32 s48, s30
ds_read_b64_tr_b16 a[218:219], v11 offset:1024
v_cvt_pk_bf16_f32 v66, v20, v21
v_cvt_pk_bf16_f32 v67, v22, v23
v_accvgpr_read_b32 v24, a4
v_mfma_f32_16x16x32_bf16 a[24:27], a[172:175], a[248:251], a[24:27]
s_add_u32 m0, s32, 0
v_accvgpr_read_b32 v25, a5
v_accvgpr_read_b32 v26, a6
v_accvgpr_read_b32 v27, a7
v_cvt_pk_bf16_f32 v70, v24, v25
v_mfma_f32_16x16x32_bf16 a[28:31], a[172:175], a[252:255], a[28:31]
buffer_load_dwordx4 v1, s[12:15], s48 offen lds
ds_read_b128 a[172:175], v4 offset:5120
v_cvt_pk_bf16_f32 v71, v26, v27
v_accvgpr_read_b32 v20, a8
v_mfma_f32_16x16x32_bf16 a[32:35], a[176:179], a[224:227], a[32:35]
ds_read_b64_tr_b16 a[220:221], v12 offset:0
v_mov_b32 v16, 0
v_accvgpr_read_b32 v21, a9
v_accvgpr_read_b32 v22, a10
v_mfma_f32_16x16x32_bf16 a[36:39], a[176:179], a[228:231], a[36:39]
v_mov_b32 v17, 1
v_accvgpr_read_b32 v23, a11
v_cvt_pk_bf16_f32 v74, v20, v21
v_cvt_pk_bf16_f32 v75, v22, v23
v_mfma_f32_16x16x32_bf16 a[40:43], a[176:179], a[232:235], a[40:43]
ds_read_b64_tr_b16 a[222:223], v12 offset:1024
v_accvgpr_read_b32 v24, a12
v_accvgpr_read_b32 v25, a13
v_accvgpr_read_b32 v26, a14
v_mfma_f32_16x16x32_bf16 a[44:47], a[176:179], a[236:239], a[44:47]
s_cmp_eq_u32 s17, 0
s_cselect_b32 s29, s39, 536870912
v_accvgpr_read_b32 v27, a15
v_cvt_pk_bf16_f32 v78, v24, v25
v_mfma_f32_16x16x32_bf16 a[48:51], a[176:179], a[240:243], a[48:51]
s_add_u32 s48, s48, s34
ds_read_b128 a[188:191], v4 offset:13312
v_cvt_pk_bf16_f32 v79, v26, v27
v_accvgpr_read_b32 v20, a16
v_accvgpr_read_b32 v21, a17
v_mfma_f32_16x16x32_bf16 a[52:55], a[176:179], a[244:247], a[52:55]
s_add_u32 m0, s32, 4096
v_accvgpr_read_b32 v22, a18
v_accvgpr_read_b32 v23, a19
v_cvt_pk_bf16_f32 v82, v20, v21
v_cvt_pk_bf16_f32 v83, v22, v23
v_mfma_f32_16x16x32_bf16 a[56:59], a[176:179], a[248:251], a[56:59]
buffer_load_dwordx4 v1, s[12:15], s48 offen lds
v_accvgpr_read_b32 v24, a20
v_accvgpr_read_b32 v25, a21
v_accvgpr_read_b32 v26, a22
v_mfma_f32_16x16x32_bf16 a[60:63], a[176:179], a[252:255], a[60:63]
ds_read_b128 a[176:179], v3 offset:8192
v_add_u32 v5, 16384, v5
v_accvgpr_read_b32 v27, a23
v_cvt_pk_bf16_f32 v86, v24, v25
v_mfma_f32_16x16x32_bf16 a[64:67], a[180:183], a[224:227], a[64:67]
s_mov_b64 exec, 1
buffer_store_dword v17, v16, s[8:11], s29 offen sc1
s_mov_b64 exec, -1
v_cvt_pk_bf16_f32 v87, v26, v27
v_mfma_f32_16x16x32_bf16 a[68:71], a[180:183], a[228:231], a[68:71]
v_and_b32 v5, 65535, v5
v_xor_b32 v6, 16, v5
v_accvgpr_read_b32 v20, a24
v_accvgpr_read_b32 v21, a25
v_mfma_f32_16x16x32_bf16 a[72:75], a[180:183], a[232:235], a[72:75]
v_xor_b32 v7, 64, v5
v_xor_b32 v8, 80, v5
v_accvgpr_read_b32 v22, a26
v_accvgpr_read_b32 v23, a27
v_mfma_f32_16x16x32_bf16 a[76:79], a[180:183], a[236:239], a[76:79]
s_add_u32 s48, s48, s34
v_xor_b32 v9, 128, v5
v_xor_b32 v10, 144, v5
v_cvt_pk_bf16_f32 v90, v20, v21
v_cvt_pk_bf16_f32 v91, v22, v23
v_mfma_f32_16x16x32_bf16 a[80:83], a[180:183], a[240:243], a[80:83]
s_add_u32 m0, s32, 8192
v_xor_b32 v11, 192, v5
v_xor_b32 v12, 208, v5
v_accvgpr_read_b32 v24, a28
v_accvgpr_read_b32 v25, a29
v_mfma_f32_16x16x32_bf16 a[84:87], a[180:183], a[244:247], a[84:87]
buffer_load_dwordx4 v1, s[12:15], s48 offen lds
v_accvgpr_read_b32 v26, a30
v_accvgpr_read_b32 v27, a31
v_cvt_pk_bf16_f32 v94, v24, v25
v_mfma_f32_16x16x32_bf16 a[88:91], a[180:183], a[248:251], a[88:91]
v_cvt_pk_bf16_f32 v95, v26, v27
v_accvgpr_read_b32 v20, a32
v_accvgpr_read_b32 v21, a33
v_accvgpr_read_b32 v22, a34
v_mfma_f32_16x16x32_bf16 a[92:95], a[180:183], a[252:255], a[92:95]
ds_read_b128 a[180:183], v4 offset:9216
v_accvgpr_read_b32 v23, a35
v_cvt_pk_bf16_f32 v96, v20, v21
v_cvt_pk_bf16_f32 v97, v22, v23
v_mfma_f32_16x16x32_bf16 a[96:99], a[184:187], a[224:227], a[96:99]
v_accvgpr_read_b32 v24, a36
v_accvgpr_read_b32 v25, a37
v_accvgpr_read_b32 v26, a38
v_accvgpr_read_b32 v27, a39
v_mfma_f32_16x16x32_bf16 a[100:103], a[184:187], a[228:231], a[100:103]
v_cvt_pk_bf16_f32 v100, v24, v25
v_cvt_pk_bf16_f32 v101, v26, v27
v_accvgpr_read_b32 v20, a40
v_accvgpr_read_b32 v21, a41
v_mfma_f32_16x16x32_bf16 a[104:107], a[184:187], a[232:235], a[104:107]
s_add_u32 s48, s48, s34
v_accvgpr_read_b32 v22, a42
v_accvgpr_read_b32 v23, a43
v_cvt_pk_bf16_f32 v104, v20, v21
v_cvt_pk_bf16_f32 v105, v22, v23
v_mfma_f32_16x16x32_bf16 a[108:111], a[184:187], a[236:239], a[108:111]
s_add_u32 m0, s32, 12288
v_accvgpr_read_b32 v24, a44
v_accvgpr_read_b32 v25, a45
v_accvgpr_read_b32 v26, a46
v_accvgpr_read_b32 v27, a47
v_mfma_f32_16x16x32_bf16 a[112:115], a[184:187], a[240:243], a[112:115]
buffer_load_dwordx4 v1, s[12:15], s48 offen lds
v_cvt_pk_bf16_f32 v108, v24, v25
v_cvt_pk_bf16_f32 v109, v26, v27
v_accvgpr_read_b32 v20, a48
v_mfma_f32_16x16x32_bf16 a[116:119], a[184:187], a[244:247], a[116:119]
v_accvgpr_read_b32 v21, a49
v_accvgpr_read_b32 v22, a50
v_accvgpr_read_b32 v23, a51
v_cvt_pk_bf16_f32 v112, v20, v21
v_mfma_f32_16x16x32_bf16 a[120:123], a[184:187], a[248:251], a[120:123]
v_cvt_pk_bf16_f32 v113, v22, v23
v_accvgpr_read_b32 v24, a52
v_accvgpr_read_b32 v25, a53
v_accvgpr_read_b32 v26, a54
v_mfma_f32_16x16x32_bf16 a[124:127], a[184:187], a[252:255], a[124:127]
ds_read_b128 a[184:187], v3 offset:12288
v_accvgpr_read_b32 v27, a55
v_cvt_pk_bf16_f32 v116, v24, v25
v_cvt_pk_bf16_f32 v117, v26, v27
v_mfma_f32_16x16x32_bf16 a[128:131], v[28:31], a[224:227], a[128:131]
v_accvgpr_read_b32 v20, a56
v_accvgpr_read_b32 v21, a57
v_accvgpr_read_b32 v22, a58
v_accvgpr_read_b32 v23, a59
v_mfma_f32_16x16x32_bf16 a[132:135], v[28:31], a[228:231], a[132:135]
v_cvt_pk_bf16_f32 v120, v20, v21
v_cvt_pk_bf16_f32 v121, v22, v23
v_accvgpr_read_b32 v24, a60
v_accvgpr_read_b32 v25, a61
v_mfma_f32_16x16x32_bf16 a[136:139], v[28:31], a[232:235], a[136:139]
buffer_load_dword v15, v14, s[96:99], s100 offen
v_accvgpr_read_b32 v26, a62
v_accvgpr_read_b32 v27, a63
v_cvt_pk_bf16_f32 v124, v24, v25
v_mfma_f32_16x16x32_bf16 a[140:143], v[28:31], a[236:239], a[140:143]
s_add_u32 s100, s100, 16384
v_cvt_pk_bf16_f32 v125, v26, v27
v_mfma_f32_16x16x32_bf16 a[144:147], v[28:31], a[240:243], a[144:147]
v_mfma_f32_16x16x32_bf16 a[148:151], v[28:31], a[244:247], a[148:151]
v_mfma_f32_16x16x32_bf16 a[152:155], v[28:31], a[248:251], a[152:155]
v_mfma_f32_16x16x32_bf16 a[156:159], v[28:31], a[252:255], a[156:159]
s_cmp_lt_u32 s35, s45
s_cbranch_scc1 L_g_tile
s_branch L_g_end
.p2align 3
L_g_v:
s_waitcnt vmcnt(16) lgkmcnt(0)
s_barrier
v_mfma_f32_16x16x32_bf16 v[160:163], a[160:163], a[192:195], 0
ds_read_b64_tr_b16 a[224:225], v5 offset:0
v_accvgpr_read_b32 v20, a64
v_accvgpr_read_b32 v21, a65
v_accvgpr_read_b32 v22, a66
v_mfma_f32_16x16x32_bf16 v[164:167], a[160:163], a[196:199], 0
v_accvgpr_read_b32 v23, a67
v_cvt_pk_bf16_f32 v98, v20, v21
v_cvt_pk_bf16_f32 v99, v22, v23
v_accvgpr_read_b32 v24, a68
v_mfma_f32_16x16x32_bf16 v[168:171], a[160:163], a[200:203], 0
ds_read_b64_tr_b16 a[226:227], v5 offset:1024
v_accvgpr_read_b32 v25, a69
v_accvgpr_read_b32 v26, a70
v_accvgpr_read_b32 v27, a71
v_mfma_f32_16x16x32_bf16 v[172:175], a[160:163], a[204:207], 0
s_add_u32 s37, s31, 0
v_cvt_pk_bf16_f32 v102, v24, v25
v_cvt_pk_bf16_f32 v103, v26, v27
v_accvgpr_read_b32 v20, a72
v_accvgpr_read_b32 v21, a73
v_mfma_f32_16x16x32_bf16 v[176:179], a[160:163], a[208:211], 0
s_add_u32 m0, s33, 0
ds_read_b64_tr_b16 a[228:229], v6 offset:0
v_accvgpr_read_b32 v22, a74
v_accvgpr_read_b32 v23, a75
v_cvt_pk_bf16_f32 v106, v20, v21
v_mfma_f32_16x16x32_bf16 v[180:183], a[160:163], a[212:215], 0
buffer_load_dwordx4 v2, s[20:23], s37 offen  lds
v_cvt_pk_bf16_f32 v107, v22, v23
v_accvgpr_read_b32 v24, a76
v_accvgpr_read_b32 v25, a77
v_mfma_f32_16x16x32_bf16 v[184:187], a[160:163], a[216:219], 0
ds_read_b64_tr_b16 a[230:231], v6 offset:1024
v_accvgpr_read_b32 v26, a78
v_accvgpr_read_b32 v27, a79
v_cvt_pk_bf16_f32 v110, v24, v25
v_mfma_f32_16x16x32_bf16 v[188:191], a[160:163], a[220:223], 0
ds_read_b128 a[160:163], v4 offset:0
v_cvt_pk_bf16_f32 v111, v26, v27
v_accvgpr_read_b32 v20, a80
v_accvgpr_read_b32 v21, a81
v_mfma_f32_16x16x32_bf16 v[192:195], a[164:167], a[192:195], 0
ds_read_b64_tr_b16 a[232:233], v7 offset:0
v_accvgpr_read_b32 v22, a82
v_accvgpr_read_b32 v23, a83
v_cvt_pk_bf16_f32 v114, v20, v21
v_mfma_f32_16x16x32_bf16 v[196:199], a[164:167], a[196:199], 0
v_cvt_pk_bf16_f32 v115, v22, v23
v_accvgpr_read_b32 v24, a84
v_accvgpr_read_b32 v25, a85
v_accvgpr_read_b32 v26, a86
v_mfma_f32_16x16x32_bf16 v[200:203], a[164:167], a[200:203], 0
s_add_u32 s37, s31, 32768
ds_read_b64_tr_b16 a[234:235], v7 offset:1024
v_accvgpr_read_b32 v27, a87
v_cvt_pk_bf16_f32 v118, v24, v25
v_cvt_pk_bf16_f32 v119, v26, v27
v_mfma_f32_16x16x32_bf16 v[204:207], a[164:167], a[204:207], 0
s_add_u32 m0, s33, 1024
v_accvgpr_read_b32 v20, a88
v_accvgpr_read_b32 v21, a89
v_accvgpr_read_b32 v22, a90
v_accvgpr_read_b32 v23, a91
v_mfma_f32_16x16x32_bf16 v[208:211], a[164:167], a[208:211], 0
buffer_load_dwordx4 v2, s[20:23], s37 offen  lds
v_cvt_pk_bf16_f32 v122, v20, v21
v_cvt_pk_bf16_f32 v123, v22, v23
v_accvgpr_read_b32 v24, a92
v_mfma_f32_16x16x32_bf16 v[212:215], a[164:167], a[212:215], 0
ds_read_b64_tr_b16 a[236:237], v8 offset:0
v_accvgpr_read_b32 v25, a93
v_accvgpr_read_b32 v26, a94
v_accvgpr_read_b32 v27, a95
v_mfma_f32_16x16x32_bf16 v[216:219], a[164:167], a[216:219], 0
v_cvt_pk_bf16_f32 v126, v24, v25
v_cvt_pk_bf16_f32 v127, v26, v27
v_accvgpr_read_b32 v20, a96
v_accvgpr_read_b32 v21, a97
v_mfma_f32_16x16x32_bf16 v[220:223], a[164:167], a[220:223], 0
ds_read_b128 a[164:167], v3 offset:1024
v_accvgpr_read_b32 v22, a98
v_accvgpr_read_b32 v23, a99
v_cvt_pk_bf16_f32 v128, v20, v21
v_mfma_f32_16x16x32_bf16 v[224:227], a[168:171], a[192:195], 0
ds_read_b64_tr_b16 a[238:239], v8 offset:1024
v_cvt_pk_bf16_f32 v129, v22, v23
v_accvgpr_read_b32 v24, a100
v_accvgpr_read_b32 v25, a101
v_mfma_f32_16x16x32_bf16 v[228:231], a[168:171], a[196:199], 0
s_add_u32 s37, s31, 131072
v_accvgpr_read_b32 v26, a102
v_accvgpr_read_b32 v27, a103
v_cvt_pk_bf16_f32 v132, v24, v25
v_cvt_pk_bf16_f32 v133, v26, v27
v_mfma_f32_16x16x32_bf16 v[232:235], a[168:171], a[200:203], 0
s_add_u32 m0, s33, 4096
ds_read_b64_tr_b16 a[240:241], v9 offset:0
v_accvgpr_read_b32 v20, a104
v_accvgpr_read_b32 v21, a105
v_accvgpr_read_b32 v22, a106
v_mfma_f32_16x16x32_bf16 v[236:239], a[168:171], a[204:207], 0
buffer_load_dwordx4 v2, s[20:23], s37 offen  lds
v_accvgpr_read_b32 v23, a107
v_cvt_pk_bf16_f32 v136, v20, v21
v_cvt_pk_bf16_f32 v137, v22, v23
v_mfma_f32_16x16x32_bf16 v[240:243], a[168:171], a[208:211], 0
ds_read_b64_tr_b16 a[242:243], v9 offset:1024
v_accvgpr_read_b32 v24, a108
v_accvgpr_read_b32 v25, a109
v_accvgpr_read_b32 v26, a110
v_mfma_f32_16x16x32_bf16 v[244:247], a[168:171], a[212:215], 0
v_accvgpr_read_b32 v27, a111
v_cvt_pk_bf16_f32 v140, v24, v25
v_cvt_pk_bf16_f32 v141, v26, v27
v_accvgpr_read_b32 v20, a112
v_mfma_f32_16x16x32_bf16 v[248:251], a[168:171], a[216:219], 0
ds_read_b64_tr_b16 a[244:245], v10 offset:0
v_accvgpr_read_b32 v21, a113
v_accvgpr_read_b32 v22, a114
v_accvgpr_read_b32 v23, a115
v_mfma_f32_16x16x32_bf16 v[252:255], a[168:171], a[220:223], 0
ds_read_b128 a[168:171], v4 offset:4096
v_cvt_pk_bf16_f32 v144, v20, v21
v_cvt_pk_bf16_f32 v145, v22, v23
v_accvgpr_read_b32 v24, a116
v_mfma_f32_16x16x32_bf16 a[0:3], a[172:175], a[192:195], 0
s_add_u32 s37, s31, 163840
ds_read_b64_tr_b16 a[246:247], v10 offset:1024
v_accvgpr_read_b32 v25, a117
v_accvgpr_read_b32 v26, a118
v_accvgpr_read_b32 v27, a119
v_mfma_f32_16x16x32_bf16 a[4:7], a[172:175], a[196:199], 0
s_add_u32 m0, s33, 5120
v_cvt_pk_bf16_f32 v148, v24, v25
v_cvt_pk_bf16_f32 v149, v26, v27
v_accvgpr_read_b32 v20, a120
v_accvgpr_read_b32 v21, a121
v_mfma_f32_16x16x32_bf16 a[8:11], a[172:175], a[200:203], 0
buffer_load_dwordx4 v2, s[20:23], s37 offen  lds
v_accvgpr_read_b32 v22, a122
v_accvgpr_read_b32 v23, a123
v_cvt_pk_bf16_f32 v152, v20, v21
v_mfma_f32_16x16x32_bf16 a[12:15], a[172:175], a[204:207], 0
s_add_u32 s31, s31, 262144
ds_read_b64_tr_b16 a[248:249], v11 offset:0
v_cvt_pk_bf16_f32 v153, v22, v23
v_accvgpr_read_b32 v24, a124
v_accvgpr_read_b32 v25, a125
v_mfma_f32_16x16x32_bf16 a[16:19], a[172:175], a[208:211], 0
s_add_u32 s33, s33, 16384
v_accvgpr_read_b32 v26, a126
v_accvgpr_read_b32 v27, a127
v_cvt_pk_bf16_f32 v156, v24, v25
v_cvt_pk_bf16_f32 v157, v26, v27
v_mfma_f32_16x16x32_bf16 a[20:23], a[172:175], a[212:215], 0
s_and_b32 s33, s33, 65535
ds_read_b64_tr_b16 a[250:251], v11 offset:1024
v_accvgpr_read_b32 v20, a128
v_accvgpr_read_b32 v21, a129
v_accvgpr_read_b32 v22, a130
v_mfma_f32_16x16x32_bf16 a[24:27], a[172:175], a[216:219], 0
v_accvgpr_read_b32 v23, a131
v_cvt_pk_bf16_f32 v130, v20, v21
v_cvt_pk_bf16_f32 v131, v22, v23
v_accvgpr_read_b32 v24, a132
v_mfma_f32_16x16x32_bf16 a[28:31], a[172:175], a[220:223], 0
s_add_u32 s48, s48, s34
ds_read_b128 a[172:175], v3 offset:5120
v_accvgpr_read_b32 v25, a133
v_accvgpr_read_b32 v26, a134
v_accvgpr_read_b32 v27, a135
v_mfma_f32_16x16x32_bf16 a[32:35], a[176:179], a[192:195], 0
s_add_u32 m0, s32, 16384
ds_read_b64_tr_b16 a[252:253], v12 offset:0
v_cvt_pk_bf16_f32 v134, v24, v25
v_cvt_pk_bf16_f32 v135, v26, v27
v_accvgpr_read_b32 v20, a136
v_mfma_f32_16x16x32_bf16 a[36:39], a[176:179], a[196:199], 0
buffer_load_dwordx4 v1, s[12:15], s48 offen lds
v_accvgpr_read_b32 v21, a137
v_accvgpr_read_b32 v22, a138
v_accvgpr_read_b32 v23, a139
v_mfma_f32_16x16x32_bf16 a[40:43], a[176:179], a[200:203], 0
ds_read_b64_tr_b16 a[254:255], v12 offset:1024
v_cvt_pk_bf16_f32 v138, v20, v21
v_cvt_pk_bf16_f32 v139, v22, v23
v_accvgpr_read_b32 v24, a140
v_mfma_f32_16x16x32_bf16 a[44:47], a[176:179], a[204:207], 0
v_accvgpr_read_b32 v25, a141
v_accvgpr_read_b32 v26, a142
v_accvgpr_read_b32 v27, a143
v_cvt_pk_bf16_f32 v142, v24, v25
v_mfma_f32_16x16x32_bf16 a[48:51], a[176:179], a[208:211], 0
ds_read_b128 v[28:31], v3 offset:13312
v_cvt_pk_bf16_f32 v143, v26, v27
v_accvgpr_read_b32 v20, a144
v_accvgpr_read_b32 v21, a145
s_mov_b32 s38, s62
s_mov_b32 s39, s63
v_mfma_f32_16x16x32_bf16 a[52:55], a[176:179], a[212:215], 0
v_accvgpr_read_b32 v22, a146
v_accvgpr_read_b32 v23, a147
v_cvt_pk_bf16_f32 v146, v20, v21
v_cvt_pk_bf16_f32 v147, v22, v23
s_mov_b32 s49, s50
s_mov_b32 s62, s42
v_mfma_f32_16x16x32_bf16 a[56:59], a[176:179], a[216:219], 0
s_add_u32 s48, s48, s34
v_accvgpr_read_b32 v24, a148
v_accvgpr_read_b32 v25, a149
v_accvgpr_read_b32 v26, a150
v_accvgpr_read_b32 v27, a151
s_mov_b32 s63, s43
s_mov_b32 s50, s51
v_mfma_f32_16x16x32_bf16 a[60:63], a[176:179], a[220:223], 0
s_add_u32 m0, s32, 20480
ds_read_b128 a[176:179], v4 offset:8192
v_add_u32 v5, 16384, v5
v_cvt_pk_bf16_f32 v150, v24, v25
v_cvt_pk_bf16_f32 v151, v26, v27
s_mov_b32 s36, s40
s_add_u32 s35, s35, 1
v_mfma_f32_16x16x32_bf16 a[64:67], a[180:183], a[192:195], 0
buffer_load_dwordx4 v1, s[12:15], s48 offen lds
v_and_b32 v5, 65535, v5
v_accvgpr_read_b32 v20, a152
v_accvgpr_read_b32 v21, a153
v_bfe_u32 v16, v0, 3, 3
v_lshlrev_b32 v16, 4, v16
v_mfma_f32_16x16x32_bf16 a[68:71], a[180:183], a[196:199], 0
v_xor_b32 v6, 16, v5
v_xor_b32 v7, 64, v5
v_accvgpr_read_b32 v22, a154
v_accvgpr_read_b32 v23, a155
v_and_or_b32 v16, v0, 7, v16
v_bfe_u32 v17, v0, 4, 2
v_mfma_f32_16x16x32_bf16 a[72:75], a[180:183], a[200:203], 0
v_xor_b32 v8, 80, v5
v_xor_b32 v9, 128, v5
v_cvt_pk_bf16_f32 v154, v20, v21
v_cvt_pk_bf16_f32 v155, v22, v23
v_lshlrev_b32 v17, 5, v17
v_bfe_u32 v18, v0, 1, 3
v_mfma_f32_16x16x32_bf16 a[76:79], a[180:183], a[204:207], 0
v_xor_b32 v10, 144, v5
v_xor_b32 v11, 192, v5
v_accvgpr_read_b32 v24, a156
v_accvgpr_read_b32 v25, a157
v_or_b32 v17, v17, v18
v_and_b32 v18, 1, v0
v_mfma_f32_16x16x32_bf16 a[80:83], a[180:183], a[208:211], 0
v_xor_b32 v12, 208, v5
v_accvgpr_read_b32 v26, a158
v_accvgpr_read_b32 v27, a159
v_cvt_pk_bf16_f32 v158, v24, v25
v_lshl_or_b32 v17, v18, 4, v17
v_mfma_f32_16x16x32_bf16 a[84:87], a[180:183], a[212:215], 0
s_add_u32 s48, s48, s34
v_cvt_pk_bf16_f32 v159, v26, v27
s_bitcmp1_b32 s49, 1
s_cselect_b64 vcc, -1, 0
s_movk_i32 s44, 0x80
v_cndmask_b32 v16, v16, v17, vcc
v_lshlrev_b32 v13, 4, v16
v_mfma_f32_16x16x32_bf16 a[88:91], a[180:183], a[216:219], 0
s_add_u32 m0, s32, 24576
s_lshr_b32 s93, s49, 2
s_lshr_b32 s93, 0x80000, s93
s_bitcmp1_b32 s49, 0
s_cselect_b32 s92, s93, 0x800
s_cselect_b32 s93, 0x800, s93
s_sub_u32 s93, s93, s44
v_mfma_f32_16x16x32_bf16 a[92:95], a[180:183], a[220:223], 0
buffer_load_dwordx4 v1, s[12:15], s48 offen lds
ds_read_b128 a[180:183], v3 offset:9216
v_mfma_f32_16x16x32_bf16 a[96:99], a[184:187], a[192:195], 0
v_mfma_f32_16x16x32_bf16 a[100:103], a[184:187], a[196:199], 0
v_mfma_f32_16x16x32_bf16 a[104:107], a[184:187], a[200:203], 0
v_mfma_f32_16x16x32_bf16 a[108:111], a[184:187], a[204:207], 0
v_mfma_f32_16x16x32_bf16 a[112:115], a[184:187], a[208:211], 0
s_add_u32 s48, s48, s34
v_mfma_f32_16x16x32_bf16 a[116:119], a[184:187], a[212:215], 0
s_add_u32 m0, s32, 28672
v_mfma_f32_16x16x32_bf16 a[120:123], a[184:187], a[216:219], 0
buffer_load_dwordx4 v1, s[12:15], s48 offen lds
v_mfma_f32_16x16x32_bf16 a[124:127], a[184:187], a[220:223], 0
s_add_u32 s30, s30, 128
ds_read_b128 a[184:187], v4 offset:12288
v_mfma_f32_16x16x32_bf16 a[128:131], a[188:191], a[192:195], 0
s_add_u32 s32, s32, 32768
v_add_u32 v3, 32768, v3
v_mfma_f32_16x16x32_bf16 a[132:135], a[188:191], a[196:199], 0
s_sub_u32 s48, s32, 98304
v_subrev_u32 v19, 98304, v3
v_mfma_f32_16x16x32_bf16 a[136:139], a[188:191], a[200:203], 0
s_cmp_ge_u32 s32, 163840
s_cselect_b32 s32, s48, s32
buffer_load_dword v15, v14, s[96:99], s100 offen
v_mfma_f32_16x16x32_bf16 a[140:143], a[188:191], a[204:207], 0
s_add_u32 s100, s100, 16384
v_cmp_le_u32 vcc, 163840, v3
v_mfma_f32_16x16x32_bf16 a[144:147], a[188:191], a[208:211], 0
s_nop 0
v_cndmask_b32 v3, v3, v19, vcc
v_mfma_f32_16x16x32_bf16 a[148:151], a[188:191], a[212:215], 0
v_xor_b32 v4, 64, v3
v_mfma_f32_16x16x32_bf16 a[152:155], a[188:191], a[216:219], 0
v_mfma_f32_16x16x32_bf16 a[156:159], a[188:191], a[220:223], 0
s_waitcnt vmcnt(17) lgkmcnt(0)
s_barrier
v_mfma_f32_16x16x32_bf16 v[160:163], a[160:163], a[224:227], v[160:163]
ds_read_b64_tr_b16 a[192:193], v5 offset:0
v_mfma_f32_16x16x32_bf16 v[164:167], a[160:163], a[228:231], v[164:167]
v_mfma_f32_16x16x32_bf16 v[168:171], a[160:163], a[232:235], v[168:171]
ds_read_b64_tr_b16 a[194:195], v5 offset:1024
v_mfma_f32_16x16x32_bf16 v[172:175], a[160:163], a[236:239], v[172:175]
s_add_u32 s37, s31, 0
v_mfma_f32_16x16x32_bf16 v[176:179], a[160:163], a[240:243], v[176:179]
s_add_u32 m0, s33, 0
ds_read_b64_tr_b16 a[196:197], v6 offset:0
v_mfma_f32_16x16x32_bf16 v[180:183], a[160:163], a[244:247], v[180:183]
buffer_load_dwordx4 v2, s[20:23], s37 offen  lds
v_mfma_f32_16x16x32_bf16 v[184:187], a[160:163], a[248:251], v[184:187]
ds_read_b64_tr_b16 a[198:199], v6 offset:1024
v_mfma_f32_16x16x32_bf16 v[188:191], a[160:163], a[252:255], v[188:191]
ds_read_b128 a[160:163], v3 offset:0
v_mfma_f32_16x16x32_bf16 v[192:195], a[164:167], a[224:227], v[192:195]
ds_read_b64_tr_b16 a[200:201], v7 offset:0
v_mfma_f32_16x16x32_bf16 v[196:199], a[164:167], a[228:231], v[196:199]
v_mfma_f32_16x16x32_bf16 v[200:203], a[164:167], a[232:235], v[200:203]
s_add_u32 s37, s31, 32768
ds_read_b64_tr_b16 a[202:203], v7 offset:1024
v_mfma_f32_16x16x32_bf16 v[204:207], a[164:167], a[236:239], v[204:207]
s_add_u32 m0, s33, 1024
v_mfma_f32_16x16x32_bf16 v[208:211], a[164:167], a[240:243], v[208:211]
buffer_load_dwordx4 v2, s[20:23], s37 offen  lds
v_mfma_f32_16x16x32_bf16 v[212:215], a[164:167], a[244:247], v[212:215]
ds_read_b64_tr_b16 a[204:205], v8 offset:0
v_mfma_f32_16x16x32_bf16 v[216:219], a[164:167], a[248:251], v[216:219]
s_mov_b32 s60, s38
v_mfma_f32_16x16x32_bf16 v[220:223], a[164:167], a[252:255], v[220:223]
s_mov_b32 s29, s38
ds_read_b128 a[164:167], v4 offset:1024
v_mfma_f32_16x16x32_bf16 v[224:227], a[168:171], a[224:227], v[224:227]
buffer_store_dwordx4 v[32:35], v13, s[8:11], s29 offen sc1
v_mfma_f32_16x16x32_bf16 v[228:231], a[168:171], a[228:231], v[228:231]
s_add_u32 s37, s31, 131072
ds_read_b64_tr_b16 a[206:207], v8 offset:1024
v_mfma_f32_16x16x32_bf16 v[232:235], a[168:171], a[232:235], v[232:235]
s_add_u32 m0, s33, 4096
v_mfma_f32_16x16x32_bf16 v[236:239], a[168:171], a[236:239], v[236:239]
buffer_load_dwordx4 v2, s[20:23], s37 offen  lds
v_mfma_f32_16x16x32_bf16 v[240:243], a[168:171], a[240:243], v[240:243]
ds_read_b64_tr_b16 a[208:209], v9 offset:0
v_mfma_f32_16x16x32_bf16 v[244:247], a[168:171], a[244:247], v[244:247]
v_mfma_f32_16x16x32_bf16 v[248:251], a[168:171], a[248:251], v[248:251]
ds_read_b64_tr_b16 a[210:211], v9 offset:1024
v_mfma_f32_16x16x32_bf16 v[252:255], a[168:171], a[252:255], v[252:255]
ds_read_b128 a[168:171], v3 offset:4096
v_mfma_f32_16x16x32_bf16 a[0:3], a[172:175], a[224:227], a[0:3]
s_add_u32 s37, s31, 163840
ds_read_b64_tr_b16 a[212:213], v10 offset:0
v_mfma_f32_16x16x32_bf16 a[4:7], a[172:175], a[228:231], a[4:7]
s_add_u32 m0, s33, 5120
v_mfma_f32_16x16x32_bf16 a[8:11], a[172:175], a[232:235], a[8:11]
buffer_load_dwordx4 v2, s[20:23], s37 offen  lds
v_mfma_f32_16x16x32_bf16 a[12:15], a[172:175], a[236:239], a[12:15]
s_add_u32 s31, s31, 262144
ds_read_b64_tr_b16 a[214:215], v10 offset:1024
v_mfma_f32_16x16x32_bf16 a[16:19], a[172:175], a[240:243], a[16:19]
s_add_u32 s33, s33, 16384
v_mfma_f32_16x16x32_bf16 a[20:23], a[172:175], a[244:247], a[20:23]
s_and_b32 s33, s33, 65535
ds_read_b64_tr_b16 a[216:217], v11 offset:0
v_mfma_f32_16x16x32_bf16 a[24:27], a[172:175], a[248:251], a[24:27]
v_mfma_f32_16x16x32_bf16 a[28:31], a[172:175], a[252:255], a[28:31]
s_mov_b32 s48, s30
ds_read_b128 a[172:175], v4 offset:5120
v_mfma_f32_16x16x32_bf16 a[32:35], a[176:179], a[224:227], a[32:35]
s_add_u32 m0, s32, 0
ds_read_b64_tr_b16 a[218:219], v11 offset:1024
v_mfma_f32_16x16x32_bf16 a[36:39], a[176:179], a[228:231], a[36:39]
buffer_load_dwordx4 v1, s[12:15], s48 offen lds
v_mfma_f32_16x16x32_bf16 a[40:43], a[176:179], a[232:235], a[40:43]
ds_read_b64_tr_b16 a[220:221], v12 offset:0
v_mfma_f32_16x16x32_bf16 a[44:47], a[176:179], a[236:239], a[44:47]
s_add_u32 s29, s29, s44
v_mfma_f32_16x16x32_bf16 a[48:51], a[176:179], a[240:243], a[48:51]
ds_read_b64_tr_b16 a[222:223], v12 offset:1024
v_mfma_f32_16x16x32_bf16 a[52:55], a[176:179], a[244:247], a[52:55]
buffer_store_dwordx4 v[36:39], v13, s[8:11], s29 offen sc1
v_mfma_f32_16x16x32_bf16 a[56:59], a[176:179], a[248:251], a[56:59]
s_add_u32 s48, s48, s34
ds_read_b128 a[188:191], v4 offset:13312
v_mfma_f32_16x16x32_bf16 a[60:63], a[176:179], a[252:255], a[60:63]
s_add_u32 m0, s32, 4096
ds_read_b128 a[176:179], v3 offset:8192
v_mfma_f32_16x16x32_bf16 a[64:67], a[180:183], a[224:227], a[64:67]
buffer_load_dwordx4 v1, s[12:15], s48 offen lds
v_mfma_f32_16x16x32_bf16 a[68:71], a[180:183], a[228:231], a[68:71]
v_add_u32 v5, 16384, v5
v_and_b32 v5, 65535, v5
v_mfma_f32_16x16x32_bf16 a[72:75], a[180:183], a[232:235], a[72:75]
v_xor_b32 v6, 16, v5
v_xor_b32 v7, 64, v5
v_mfma_f32_16x16x32_bf16 a[76:79], a[180:183], a[236:239], a[76:79]
v_xor_b32 v8, 80, v5
v_xor_b32 v9, 128, v5
v_mfma_f32_16x16x32_bf16 a[80:83], a[180:183], a[240:243], a[80:83]
v_xor_b32 v10, 144, v5
v_xor_b32 v11, 192, v5
v_mfma_f32_16x16x32_bf16 a[84:87], a[180:183], a[244:247], a[84:87]
s_add_u32 s48, s48, s34
v_xor_b32 v12, 208, v5
v_mfma_f32_16x16x32_bf16 a[88:91], a[180:183], a[248:251], a[88:91]
s_add_u32 m0, s32, 8192
v_mfma_f32_16x16x32_bf16 a[92:95], a[180:183], a[252:255], a[92:95]
buffer_load_dwordx4 v1, s[12:15], s48 offen lds
ds_read_b128 a[180:183], v4 offset:9216
v_mfma_f32_16x16x32_bf16 a[96:99], a[184:187], a[224:227], a[96:99]
v_mfma_f32_16x16x32_bf16 a[100:103], a[184:187], a[228:231], a[100:103]
v_mfma_f32_16x16x32_bf16 a[104:107], a[184:187], a[232:235], a[104:107]
v_mfma_f32_16x16x32_bf16 a[108:111], a[184:187], a[236:239], a[108:111]
v_mfma_f32_16x16x32_bf16 a[112:115], a[184:187], a[240:243], a[112:115]
s_add_u32 s48, s48, s34
v_mfma_f32_16x16x32_bf16 a[116:119], a[184:187], a[244:247], a[116:119]
s_add_u32 m0, s32, 12288
v_mfma_f32_16x16x32_bf16 a[120:123], a[184:187], a[248:251], a[120:123]
buffer_load_dwordx4 v1, s[12:15], s48 offen lds
v_mfma_f32_16x16x32_bf16 a[124:127], a[184:187], a[252:255], a[124:127]
ds_read_b128 a[184:187], v3 offset:12288
v_mfma_f32_16x16x32_bf16 a[128:131], v[28:31], a[224:227], a[128:131]
s_add_u32 s29, s29, s93
v_mfma_f32_16x16x32_bf16 a[132:135], v[28:31], a[228:231], a[132:135]
v_mfma_f32_16x16x32_bf16 a[136:139], v[28:31], a[232:235], a[136:139]
buffer_store_dwordx4 v[40:43], v13, s[8:11], s29 offen sc1
buffer_load_dword v15, v14, s[96:99], s100 offen
v_mfma_f32_16x16x32_bf16 a[140:143], v[28:31], a[236:239], a[140:143]
s_add_u32 s100, s100, 16384
v_mfma_f32_16x16x32_bf16 a[144:147], v[28:31], a[240:243], a[144:147]
v_mfma_f32_16x16x32_bf16 a[148:151], v[28:31], a[244:247], a[148:151]
v_mfma_f32_16x16x32_bf16 a[152:155], v[28:31], a[248:251], a[152:155]
v_mfma_f32_16x16x32_bf16 a[156:159], v[28:31], a[252:255], a[156:159]
s_waitcnt vmcnt(21) lgkmcnt(0)
s_barrier
v_mfma_f32_16x16x32_bf16 v[160:163], a[160:163], a[192:195], v[160:163]
ds_read_b64_tr_b16 a[224:225], v5 offset:0
v_mfma_f32_16x16x32_bf16 v[164:167], a[160:163], a[196:199], v[164:167]
v_mfma_f32_16x16x32_bf16 v[168:171], a[160:163], a[200:203], v[168:171]
ds_read_b64_tr_b16 a[226:227], v5 offset:1024
v_mfma_f32_16x16x32_bf16 v[172:175], a[160:163], a[204:207], v[172:175]
s_add_u32 s37, s31, 0
v_mfma_f32_16x16x32_bf16 v[176:179], a[160:163], a[208:211], v[176:179]
s_add_u32 m0, s33, 0
ds_read_b64_tr_b16 a[228:229], v6 offset:0
v_mfma_f32_16x16x32_bf16 v[180:183], a[160:163], a[212:215], v[180:183]
buffer_load_dwordx4 v2, s[20:23], s37 offen  lds
v_mfma_f32_16x16x32_bf16 v[184:187], a[160:163], a[216:219], v[184:187]
ds_read_b64_tr_b16 a[230:231], v6 offset:1024
v_mfma_f32_16x16x32_bf16 v[188:191], a[160:163], a[220:223], v[188:191]
ds_read_b128 a[160:163], v4 offset:0
v_mfma_f32_16x16x32_bf16 v[192:195], a[164:167], a[192:195], v[192:195]
ds_read_b64_tr_b16 a[232:233], v7 offset:0
v_mfma_f32_16x16x32_bf16 v[196:199], a[164:167], a[196:199], v[196:199]
v_mfma_f32_16x16x32_bf16 v[200:203], a[164:167], a[200:203], v[200:203]
s_add_u32 s37, s31, 32768
ds_read_b64_tr_b16 a[234:235], v7 offset:1024
v_mfma_f32_16x16x32_bf16 v[204:207], a[164:167], a[204:207], v[204:207]
s_add_u32 m0, s33, 1024
v_mfma_f32_16x16x32_bf16 v[208:211], a[164:167], a[208:211], v[208:211]
buffer_load_dwordx4 v2, s[20:23], s37 offen  lds
v_mfma_f32_16x16x32_bf16 v[212:215], a[164:167], a[212:215], v[212:215]
ds_read_b64_tr_b16 a[236:237], v8 offset:0
v_mfma_f32_16x16x32_bf16 v[216:219], a[164:167], a[216:219], v[216:219]
s_add_u32 s29, s29, s44
v_mfma_f32_16x16x32_bf16 v[220:223], a[164:167], a[220:223], v[220:223]
ds_read_b128 a[164:167], v3 offset:1024
v_mfma_f32_16x16x32_bf16 v[224:227], a[168:171], a[192:195], v[224:227]
buffer_store_dwordx4 v[44:47], v13, s[8:11], s29 offen sc1
v_mfma_f32_16x16x32_bf16 v[228:231], a[168:171], a[196:199], v[228:231]
s_add_u32 s37, s31, 131072
ds_read_b64_tr_b16 a[238:239], v8 offset:1024
v_mfma_f32_16x16x32_bf16 v[232:235], a[168:171], a[200:203], v[232:235]
s_add_u32 m0, s33, 4096
v_mfma_f32_16x16x32_bf16 v[236:239], a[168:171], a[204:207], v[236:239]
buffer_load_dwordx4 v2, s[20:23], s37 offen  lds
v_mfma_f32_16x16x32_bf16 v[240:243], a[168:171], a[208:211], v[240:243]
ds_read_b64_tr_b16 a[240:241], v9 offset:0
v_mfma_f32_16x16x32_bf16 v[244:247], a[168:171], a[212:215], v[244:247]
v_mfma_f32_16x16x32_bf16 v[248:251], a[168:171], a[216:219], v[248:251]
ds_read_b64_tr_b16 a[242:243], v9 offset:1024
v_mfma_f32_16x16x32_bf16 v[252:255], a[168:171], a[220:223], v[252:255]
ds_read_b128 a[168:171], v4 offset:4096
v_mfma_f32_16x16x32_bf16 a[0:3], a[172:175], a[192:195], a[0:3]
s_add_u32 s37, s31, 163840
ds_read_b64_tr_b16 a[244:245], v10 offset:0
v_mfma_f32_16x16x32_bf16 a[4:7], a[172:175], a[196:199], a[4:7]
s_add_u32 m0, s33, 5120
v_mfma_f32_16x16x32_bf16 a[8:11], a[172:175], a[200:203], a[8:11]
buffer_load_dwordx4 v2, s[20:23], s37 offen  lds
v_mfma_f32_16x16x32_bf16 a[12:15], a[172:175], a[204:207], a[12:15]
s_add_u32 s31, s31, 262144
ds_read_b64_tr_b16 a[246:247], v10 offset:1024
v_mfma_f32_16x16x32_bf16 a[16:19], a[172:175], a[208:211], a[16:19]
s_add_u32 s33, s33, 16384
v_mfma_f32_16x16x32_bf16 a[20:23], a[172:175], a[212:215], a[20:23]
s_and_b32 s33, s33, 65535
ds_read_b64_tr_b16 a[248:249], v11 offset:0
v_mfma_f32_16x16x32_bf16 a[24:27], a[172:175], a[216:219], a[24:27]
v_mfma_f32_16x16x32_bf16 a[28:31], a[172:175], a[220:223], a[28:31]
s_add_u32 s48, s48, s34
ds_read_b128 a[172:175], v3 offset:5120
v_mfma_f32_16x16x32_bf16 a[32:35], a[176:179], a[192:195], a[32:35]
s_add_u32 m0, s32, 16384
ds_read_b64_tr_b16 a[250:251], v11 offset:1024
v_mfma_f32_16x16x32_bf16 a[36:39], a[176:179], a[196:199], a[36:39]
buffer_load_dwordx4 v1, s[12:15], s48 offen lds
v_mfma_f32_16x16x32_bf16 a[40:43], a[176:179], a[200:203], a[40:43]
ds_read_b64_tr_b16 a[252:253], v12 offset:0
v_mfma_f32_16x16x32_bf16 a[44:47], a[176:179], a[204:207], a[44:47]
s_add_u32 s29, s29, s93
v_mfma_f32_16x16x32_bf16 a[48:51], a[176:179], a[208:211], a[48:51]
ds_read_b64_tr_b16 a[254:255], v12 offset:1024
v_mfma_f32_16x16x32_bf16 a[52:55], a[176:179], a[212:215], a[52:55]
buffer_store_dwordx4 v[48:51], v13, s[8:11], s29 offen sc1
v_mfma_f32_16x16x32_bf16 a[56:59], a[176:179], a[216:219], a[56:59]
s_add_u32 s48, s48, s34
ds_read_b128 v[28:31], v3 offset:13312
v_mfma_f32_16x16x32_bf16 a[60:63], a[176:179], a[220:223], a[60:63]
s_add_u32 m0, s32, 20480
ds_read_b128 a[176:179], v4 offset:8192
v_mfma_f32_16x16x32_bf16 a[64:67], a[180:183], a[192:195], a[64:67]
buffer_load_dwordx4 v1, s[12:15], s48 offen lds
v_mfma_f32_16x16x32_bf16 a[68:71], a[180:183], a[196:199], a[68:71]
v_add_u32 v5, 16384, v5
v_and_b32 v5, 65535, v5
v_mfma_f32_16x16x32_bf16 a[72:75], a[180:183], a[200:203], a[72:75]
v_xor_b32 v6, 16, v5
v_xor_b32 v7, 64, v5
v_mfma_f32_16x16x32_bf16 a[76:79], a[180:183], a[204:207], a[76:79]
v_xor_b32 v8, 80, v5
v_xor_b32 v9, 128, v5
v_mfma_f32_16x16x32_bf16 a[80:83], a[180:183], a[208:211], a[80:83]
v_xor_b32 v10, 144, v5
v_xor_b32 v11, 192, v5
v_mfma_f32_16x16x32_bf16 a[84:87], a[180:183], a[212:215], a[84:87]
s_add_u32 s48, s48, s34
v_xor_b32 v12, 208, v5
v_mfma_f32_16x16x32_bf16 a[88:91], a[180:183], a[216:219], a[88:91]
s_add_u32 m0, s32, 24576
v_mfma_f32_16x16x32_bf16 a[92:95], a[180:183], a[220:223], a[92:95]
buffer_load_dwordx4 v1, s[12:15], s48 offen lds
ds_read_b128 a[180:183], v3 offset:9216
v_mfma_f32_16x16x32_bf16 a[96:99], a[184:187], a[192:195], a[96:99]
v_mfma_f32_16x16x32_bf16 a[100:103], a[184:187], a[196:199], a[100:103]
v_mfma_f32_16x16x32_bf16 a[104:107], a[184:187], a[200:203], a[104:107]
v_mfma_f32_16x16x32_bf16 a[108:111], a[184:187], a[204:207], a[108:111]
v_mfma_f32_16x16x32_bf16 a[112:115], a[184:187], a[208:211], a[112:115]
s_add_u32 s48, s48, s34
v_mfma_f32_16x16x32_bf16 a[116:119], a[184:187], a[212:215], a[116:119]
s_add_u32 m0, s32, 28672
v_mfma_f32_16x16x32_bf16 a[120:123], a[184:187], a[216:219], a[120:123]
buffer_load_dwordx4 v1, s[12:15], s48 offen lds
v_mfma_f32_16x16x32_bf16 a[124:127], a[184:187], a[220:223], a[124:127]
s_add_u32 s30, s30, 128
ds_read_b128 a[184:187], v4 offset:12288
v_mfma_f32_16x16x32_bf16 a[128:131], a[188:191], a[192:195], a[128:131]
s_add_u32 s32, s32, 32768
s_add_u32 s29, s29, s44
v_add_u32 v3, 32768, v3
v_mfma_f32_16x16x32_bf16 a[132:135], a[188:191], a[196:199], a[132:135]
s_sub_u32 s48, s32, 98304
v_subrev_u32 v19, 98304, v3
v_mfma_f32_16x16x32_bf16 a[136:139], a[188:191], a[200:203], a[136:139]
s_cmp_ge_u32 s32, 163840
s_cselect_b32 s32, s48, s32
buffer_store_dwordx4 v[52:55], v13, s[8:11], s29 offen sc1
buffer_load_dword v15, v14, s[96:99], s100 offen
v_mfma_f32_16x16x32_bf16 a[140:143], a[188:191], a[204:207], a[140:143]
s_add_u32 s100, s100, 16384
v_cmp_le_u32 vcc, 163840, v3
v_mfma_f32_16x16x32_bf16 a[144:147], a[188:191], a[208:211], a[144:147]
s_nop 0
v_cndmask_b32 v3, v3, v19, vcc
v_mfma_f32_16x16x32_bf16 a[148:151], a[188:191], a[212:215], a[148:151]
v_xor_b32 v4, 64, v3
v_mfma_f32_16x16x32_bf16 a[152:155], a[188:191], a[216:219], a[152:155]
v_mfma_f32_16x16x32_bf16 a[156:159], a[188:191], a[220:223], a[156:159]
s_waitcnt vmcnt(24) lgkmcnt(0)
s_barrier
v_mfma_f32_16x16x32_bf16 v[160:163], a[160:163], a[224:227], v[160:163]
ds_read_b64_tr_b16 a[192:193], v5 offset:0
v_mfma_f32_16x16x32_bf16 v[164:167], a[160:163], a[228:231], v[164:167]
v_mfma_f32_16x16x32_bf16 v[168:171], a[160:163], a[232:235], v[168:171]
ds_read_b64_tr_b16 a[194:195], v5 offset:1024
v_mfma_f32_16x16x32_bf16 v[172:175], a[160:163], a[236:239], v[172:175]
s_add_u32 s37, s31, 0
v_mfma_f32_16x16x32_bf16 v[176:179], a[160:163], a[240:243], v[176:179]
s_add_u32 m0, s33, 0
ds_read_b64_tr_b16 a[196:197], v6 offset:0
v_mfma_f32_16x16x32_bf16 v[180:183], a[160:163], a[244:247], v[180:183]
buffer_load_dwordx4 v2, s[20:23], s37 offen  lds
v_mfma_f32_16x16x32_bf16 v[184:187], a[160:163], a[248:251], v[184:187]
ds_read_b64_tr_b16 a[198:199], v6 offset:1024
v_mfma_f32_16x16x32_bf16 v[188:191], a[160:163], a[252:255], v[188:191]
ds_read_b128 a[160:163], v3 offset:0
v_mfma_f32_16x16x32_bf16 v[192:195], a[164:167], a[224:227], v[192:195]
ds_read_b64_tr_b16 a[200:201], v7 offset:0
v_mfma_f32_16x16x32_bf16 v[196:199], a[164:167], a[228:231], v[196:199]
v_mfma_f32_16x16x32_bf16 v[200:203], a[164:167], a[232:235], v[200:203]
s_add_u32 s37, s31, 32768
ds_read_b64_tr_b16 a[202:203], v7 offset:1024
v_mfma_f32_16x16x32_bf16 v[204:207], a[164:167], a[236:239], v[204:207]
s_add_u32 m0, s33, 1024
v_mfma_f32_16x16x32_bf16 v[208:211], a[164:167], a[240:243], v[208:211]
buffer_load_dwordx4 v2, s[20:23], s37 offen  lds
v_mfma_f32_16x16x32_bf16 v[212:215], a[164:167], a[244:247], v[212:215]
ds_read_b64_tr_b16 a[204:205], v8 offset:0
v_mfma_f32_16x16x32_bf16 v[216:219], a[164:167], a[248:251], v[216:219]
s_add_u32 s29, s29, s93
v_mfma_f32_16x16x32_bf16 v[220:223], a[164:167], a[252:255], v[220:223]
ds_read_b128 a[164:167], v4 offset:1024
v_mfma_f32_16x16x32_bf16 v[224:227], a[168:171], a[224:227], v[224:227]
buffer_store_dwordx4 v[56:59], v13, s[8:11], s29 offen sc1
v_mfma_f32_16x16x32_bf16 v[228:231], a[168:171], a[228:231], v[228:231]
s_add_u32 s37, s31, 131072
ds_read_b64_tr_b16 a[206:207], v8 offset:1024
v_mfma_f32_16x16x32_bf16 v[232:235], a[168:171], a[232:235], v[232:235]
s_add_u32 m0, s33, 4096
v_mfma_f32_16x16x32_bf16 v[236:239], a[168:171], a[236:239], v[236:239]
buffer_load_dwordx4 v2, s[20:23], s37 offen  lds
v_mfma_f32_16x16x32_bf16 v[240:243], a[168:171], a[240:243], v[240:243]
ds_read_b64_tr_b16 a[208:209], v9 offset:0
v_mfma_f32_16x16x32_bf16 v[244:247], a[168:171], a[244:247], v[244:247]
v_mfma_f32_16x16x32_bf16 v[248:251], a[168:171], a[248:251], v[248:251]
ds_read_b64_tr_b16 a[210:211], v9 offset:1024
v_mfma_f32_16x16x32_bf16 v[252:255], a[168:171], a[252:255], v[252:255]
ds_read_b128 a[168:171], v3 offset:4096
v_mfma_f32_16x16x32_bf16 a[0:3], a[172:175], a[224:227], a[0:3]
s_add_u32 s37, s31, 163840
ds_read_b64_tr_b16 a[212:213], v10 offset:0
v_mfma_f32_16x16x32_bf16 a[4:7], a[172:175], a[228:231], a[4:7]
s_add_u32 m0, s33, 5120
v_mfma_f32_16x16x32_bf16 a[8:11], a[172:175], a[232:235], a[8:11]
buffer_load_dwordx4 v2, s[20:23], s37 offen  lds
v_mfma_f32_16x16x32_bf16 a[12:15], a[172:175], a[236:239], a[12:15]
s_add_u32 s31, s31, 262144
ds_read_b64_tr_b16 a[214:215], v10 offset:1024
v_mfma_f32_16x16x32_bf16 a[16:19], a[172:175], a[240:243], a[16:19]
s_add_u32 s33, s33, 16384
v_mfma_f32_16x16x32_bf16 a[20:23], a[172:175], a[244:247], a[20:23]
s_and_b32 s33, s33, 65535
ds_read_b64_tr_b16 a[216:217], v11 offset:0
v_mfma_f32_16x16x32_bf16 a[24:27], a[172:175], a[248:251], a[24:27]
v_mfma_f32_16x16x32_bf16 a[28:31], a[172:175], a[252:255], a[28:31]
s_mov_b32 s48, s30
ds_read_b128 a[172:175], v4 offset:5120
v_mfma_f32_16x16x32_bf16 a[32:35], a[176:179], a[224:227], a[32:35]
s_add_u32 m0, s32, 0
ds_read_b64_tr_b16 a[218:219], v11 offset:1024
v_mfma_f32_16x16x32_bf16 a[36:39], a[176:179], a[228:231], a[36:39]
buffer_load_dwordx4 v1, s[12:15], s48 offen lds
v_mfma_f32_16x16x32_bf16 a[40:43], a[176:179], a[232:235], a[40:43]
ds_read_b64_tr_b16 a[220:221], v12 offset:0
v_mfma_f32_16x16x32_bf16 a[44:47], a[176:179], a[236:239], a[44:47]
s_add_u32 s29, s29, s44
v_mfma_f32_16x16x32_bf16 a[48:51], a[176:179], a[240:243], a[48:51]
ds_read_b64_tr_b16 a[222:223], v12 offset:1024
v_mfma_f32_16x16x32_bf16 a[52:55], a[176:179], a[244:247], a[52:55]
buffer_store_dwordx4 v[60:63], v13, s[8:11], s29 offen sc1
v_mfma_f32_16x16x32_bf16 a[56:59], a[176:179], a[248:251], a[56:59]
s_add_u32 s48, s48, s34
ds_read_b128 a[188:191], v4 offset:13312
v_mfma_f32_16x16x32_bf16 a[60:63], a[176:179], a[252:255], a[60:63]
s_add_u32 m0, s32, 4096
ds_read_b128 a[176:179], v3 offset:8192
v_mfma_f32_16x16x32_bf16 a[64:67], a[180:183], a[224:227], a[64:67]
buffer_load_dwordx4 v1, s[12:15], s48 offen lds
v_mfma_f32_16x16x32_bf16 a[68:71], a[180:183], a[228:231], a[68:71]
v_add_u32 v5, 16384, v5
v_and_b32 v5, 65535, v5
v_mfma_f32_16x16x32_bf16 a[72:75], a[180:183], a[232:235], a[72:75]
v_xor_b32 v6, 16, v5
v_xor_b32 v7, 64, v5
v_mfma_f32_16x16x32_bf16 a[76:79], a[180:183], a[236:239], a[76:79]
v_xor_b32 v8, 80, v5
v_xor_b32 v9, 128, v5
v_mfma_f32_16x16x32_bf16 a[80:83], a[180:183], a[240:243], a[80:83]
v_xor_b32 v10, 144, v5
v_xor_b32 v11, 192, v5
v_mfma_f32_16x16x32_bf16 a[84:87], a[180:183], a[244:247], a[84:87]
s_add_u32 s48, s48, s34
v_xor_b32 v12, 208, v5
v_mfma_f32_16x16x32_bf16 a[88:91], a[180:183], a[248:251], a[88:91]
s_add_u32 m0, s32, 8192
v_mfma_f32_16x16x32_bf16 a[92:95], a[180:183], a[252:255], a[92:95]
buffer_load_dwordx4 v1, s[12:15], s48 offen lds
ds_read_b128 a[180:183], v4 offset:9216
v_mfma_f32_16x16x32_bf16 a[96:99], a[184:187], a[224:227], a[96:99]
v_mfma_f32_16x16x32_bf16 a[100:103], a[184:187], a[228:231], a[100:103]
v_mfma_f32_16x16x32_bf16 a[104:107], a[184:187], a[232:235], a[104:107]
v_mfma_f32_16x16x32_bf16 a[108:111], a[184:187], a[236:239], a[108:111]
v_mfma_f32_16x16x32_bf16 a[112:115], a[184:187], a[240:243], a[112:115]
s_add_u32 s48, s48, s34
v_mfma_f32_16x16x32_bf16 a[116:119], a[184:187], a[244:247], a[116:119]
s_add_u32 m0, s32, 12288
v_mfma_f32_16x16x32_bf16 a[120:123], a[184:187], a[248:251], a[120:123]
buffer_load_dwordx4 v1, s[12:15], s48 offen lds
v_mfma_f32_16x16x32_bf16 a[124:127], a[184:187], a[252:255], a[124:127]
ds_read_b128 a[184:187], v3 offset:12288
v_mfma_f32_16x16x32_bf16 a[128:131], v[28:31], a[224:227], a[128:131]
v_mfma_f32_16x16x32_bf16 a[132:135], v[28:31], a[228:231], a[132:135]
v_mfma_f32_16x16x32_bf16 a[136:139], v[28:31], a[232:235], a[136:139]
buffer_load_dword v15, v14, s[96:99], s100 offen
v_mfma_f32_16x16x32_bf16 a[140:143], v[28:31], a[236:239], a[140:143]
s_add_u32 s100, s100, 16384
v_mfma_f32_16x16x32_bf16 a[144:147], v[28:31], a[240:243], a[144:147]
v_mfma_f32_16x16x32_bf16 a[148:151], v[28:31], a[244:247], a[148:151]
v_mfma_f32_16x16x32_bf16 a[152:155], v[28:31], a[248:251], a[152:155]
v_mfma_f32_16x16x32_bf16 a[156:159], v[28:31], a[252:255], a[156:159]
s_waitcnt vmcnt(23) lgkmcnt(0)
s_barrier
v_mfma_f32_16x16x32_bf16 v[160:163], a[160:163], a[192:195], v[160:163]
ds_read_b64_tr_b16 a[224:225], v5 offset:0
v_mfma_f32_16x16x32_bf16 v[164:167], a[160:163], a[196:199], v[164:167]
v_mfma_f32_16x16x32_bf16 v[168:171], a[160:163], a[200:203], v[168:171]
ds_read_b64_tr_b16 a[226:227], v5 offset:1024
v_mfma_f32_16x16x32_bf16 v[172:175], a[160:163], a[204:207], v[172:175]
s_add_u32 s37, s31, 0
v_mfma_f32_16x16x32_bf16 v[176:179], a[160:163], a[208:211], v[176:179]
s_add_u32 m0, s33, 0
ds_read_b64_tr_b16 a[228:229], v6 offset:0
v_mfma_f32_16x16x32_bf16 v[180:183], a[160:163], a[212:215], v[180:183]
buffer_load_dwordx4 v2, s[20:23], s37 offen  lds
v_mfma_f32_16x16x32_bf16 v[184:187], a[160:163], a[216:219], v[184:187]
ds_read_b64_tr_b16 a[230:231], v6 offset:1024
v_mfma_f32_16x16x32_bf16 v[188:191], a[160:163], a[220:223], v[188:191]
ds_read_b128 a[160:163], v4 offset:0
v_mfma_f32_16x16x32_bf16 v[192:195], a[164:167], a[192:195], v[192:195]
ds_read_b64_tr_b16 a[232:233], v7 offset:0
v_mfma_f32_16x16x32_bf16 v[196:199], a[164:167], a[196:199], v[196:199]
v_mfma_f32_16x16x32_bf16 v[200:203], a[164:167], a[200:203], v[200:203]
s_add_u32 s37, s31, 32768
ds_read_b64_tr_b16 a[234:235], v7 offset:1024
v_mfma_f32_16x16x32_bf16 v[204:207], a[164:167], a[204:207], v[204:207]
s_add_u32 m0, s33, 1024
v_mfma_f32_16x16x32_bf16 v[208:211], a[164:167], a[208:211], v[208:211]
buffer_load_dwordx4 v2, s[20:23], s37 offen  lds
v_mfma_f32_16x16x32_bf16 v[212:215], a[164:167], a[212:215], v[212:215]
ds_read_b64_tr_b16 a[236:237], v8 offset:0
v_mfma_f32_16x16x32_bf16 v[216:219], a[164:167], a[216:219], v[216:219]
s_add_u32 s60, s60, s92
v_mfma_f32_16x16x32_bf16 v[220:223], a[164:167], a[220:223], v[220:223]
s_mov_b32 s29, s60
ds_read_b128 a[164:167], v3 offset:1024
v_mfma_f32_16x16x32_bf16 v[224:227], a[168:171], a[192:195], v[224:227]
buffer_store_dwordx4 v[64:67], v13, s[8:11], s29 offen sc1
v_mfma_f32_16x16x32_bf16 v[228:231], a[168:171], a[196:199], v[228:231]
s_add_u32 s37, s31, 131072
ds_read_b64_tr_b16 a[238:239], v8 offset:1024
v_mfma_f32_16x16x32_bf16 v[232:235], a[168:171], a[200:203], v[232:235]
s_add_u32 m0, s33, 4096
v_mfma_f32_16x16x32_bf16 v[236:239], a[168:171], a[204:207], v[236:239]
buffer_load_dwordx4 v2, s[20:23], s37 offen  lds
v_mfma_f32_16x16x32_bf16 v[240:243], a[168:171], a[208:211], v[240:243]
ds_read_b64_tr_b16 a[240:241], v9 offset:0
v_mfma_f32_16x16x32_bf16 v[244:247], a[168:171], a[212:215], v[244:247]
v_mfma_f32_16x16x32_bf16 v[248:251], a[168:171], a[216:219], v[248:251]
ds_read_b64_tr_b16 a[242:243], v9 offset:1024
v_mfma_f32_16x16x32_bf16 v[252:255], a[168:171], a[220:223], v[252:255]
ds_read_b128 a[168:171], v4 offset:4096
v_mfma_f32_16x16x32_bf16 a[0:3], a[172:175], a[192:195], a[0:3]
s_add_u32 s37, s31, 163840
ds_read_b64_tr_b16 a[244:245], v10 offset:0
v_mfma_f32_16x16x32_bf16 a[4:7], a[172:175], a[196:199], a[4:7]
s_add_u32 m0, s33, 5120
v_mfma_f32_16x16x32_bf16 a[8:11], a[172:175], a[200:203], a[8:11]
buffer_load_dwordx4 v2, s[20:23], s37 offen  lds
v_mfma_f32_16x16x32_bf16 a[12:15], a[172:175], a[204:207], a[12:15]
s_add_u32 s31, s31, 262144
ds_read_b64_tr_b16 a[246:247], v10 offset:1024
v_mfma_f32_16x16x32_bf16 a[16:19], a[172:175], a[208:211], a[16:19]
s_add_u32 s33, s33, 16384
v_mfma_f32_16x16x32_bf16 a[20:23], a[172:175], a[212:215], a[20:23]
s_and_b32 s33, s33, 65535
ds_read_b64_tr_b16 a[248:249], v11 offset:0
v_mfma_f32_16x16x32_bf16 a[24:27], a[172:175], a[216:219], a[24:27]
v_mfma_f32_16x16x32_bf16 a[28:31], a[172:175], a[220:223], a[28:31]
s_add_u32 s48, s48, s34
ds_read_b128 a[172:175], v3 offset:5120
v_mfma_f32_16x16x32_bf16 a[32:35], a[176:179], a[192:195], a[32:35]
s_add_u32 m0, s32, 16384
ds_read_b64_tr_b16 a[250:251], v11 offset:1024
v_mfma_f32_16x16x32_bf16 a[36:39], a[176:179], a[196:199], a[36:39]
buffer_load_dwordx4 v1, s[12:15], s48 offen lds
v_mfma_f32_16x16x32_bf16 a[40:43], a[176:179], a[200:203], a[40:43]
ds_read_b64_tr_b16 a[252:253], v12 offset:0
v_mfma_f32_16x16x32_bf16 a[44:47], a[176:179], a[204:207], a[44:47]
s_add_u32 s29, s29, s44
v_mfma_f32_16x16x32_bf16 a[48:51], a[176:179], a[208:211], a[48:51]
ds_read_b64_tr_b16 a[254:255], v12 offset:1024
v_mfma_f32_16x16x32_bf16 a[52:55], a[176:179], a[212:215], a[52:55]
buffer_store_dwordx4 v[68:71], v13, s[8:11], s29 offen sc1
v_mfma_f32_16x16x32_bf16 a[56:59], a[176:179], a[216:219], a[56:59]
s_add_u32 s48, s48, s34
ds_read_b128 v[28:31], v3 offset:13312
v_mfma_f32_16x16x32_bf16 a[60:63], a[176:179], a[220:223], a[60:63]
s_add_u32 m0, s32, 20480
ds_read_b128 a[176:179], v4 offset:8192
v_mfma_f32_16x16x32_bf16 a[64:67], a[180:183], a[192:195], a[64:67]
buffer_load_dwordx4 v1, s[12:15], s48 offen lds
v_mfma_f32_16x16x32_bf16 a[68:71], a[180:183], a[196:199], a[68:71]
v_add_u32 v5, 16384, v5
v_and_b32 v5, 65535, v5
v_mfma_f32_16x16x32_bf16 a[72:75], a[180:183], a[200:203], a[72:75]
v_xor_b32 v6, 16, v5
v_xor_b32 v7, 64, v5
v_mfma_f32_16x16x32_bf16 a[76:79], a[180:183], a[204:207], a[76:79]
v_xor_b32 v8, 80, v5
v_xor_b32 v9, 128, v5
v_mfma_f32_16x16x32_bf16 a[80:83], a[180:183], a[208:211], a[80:83]
v_xor_b32 v10, 144, v5
v_xor_b32 v11, 192, v5
v_mfma_f32_16x16x32_bf16 a[84:87], a[180:183], a[212:215], a[84:87]
s_add_u32 s48, s48, s34
v_xor_b32 v12, 208, v5
v_mfma_f32_16x16x32_bf16 a[88:91], a[180:183], a[216:219], a[88:91]
s_add_u32 m0, s32, 24576
v_mfma_f32_16x16x32_bf16 a[92:95], a[180:183], a[220:223], a[92:95]
buffer_load_dwordx4 v1, s[12:15], s48 offen lds
ds_read_b128 a[180:183], v3 offset:9216
v_mfma_f32_16x16x32_bf16 a[96:99], a[184:187], a[192:195], a[96:99]
v_mfma_f32_16x16x32_bf16 a[100:103], a[184:187], a[196:199], a[100:103]
v_mfma_f32_16x16x32_bf16 a[104:107], a[184:187], a[200:203], a[104:107]
v_mfma_f32_16x16x32_bf16 a[108:111], a[184:187], a[204:207], a[108:111]
v_mfma_f32_16x16x32_bf16 a[112:115], a[184:187], a[208:211], a[112:115]
s_add_u32 s48, s48, s34
v_mfma_f32_16x16x32_bf16 a[116:119], a[184:187], a[212:215], a[116:119]
s_add_u32 m0, s32, 28672
v_mfma_f32_16x16x32_bf16 a[120:123], a[184:187], a[216:219], a[120:123]
buffer_load_dwordx4 v1, s[12:15], s48 offen lds
v_mfma_f32_16x16x32_bf16 a[124:127], a[184:187], a[220:223], a[124:127]
s_add_u32 s30, s30, 128
ds_read_b128 a[184:187], v4 offset:12288
v_mfma_f32_16x16x32_bf16 a[128:131], a[188:191], a[192:195], a[128:131]
s_add_u32 s32, s32, 32768
s_add_u32 s29, s29, s93
v_add_u32 v3, 32768, v3
v_mfma_f32_16x16x32_bf16 a[132:135], a[188:191], a[196:199], a[132:135]
s_sub_u32 s48, s32, 98304
v_subrev_u32 v19, 98304, v3
v_mfma_f32_16x16x32_bf16 a[136:139], a[188:191], a[200:203], a[136:139]
s_cmp_ge_u32 s32, 163840
s_cselect_b32 s32, s48, s32
buffer_store_dwordx4 v[72:75], v13, s[8:11], s29 offen sc1
buffer_load_dword v15, v14, s[96:99], s100 offen
v_mfma_f32_16x16x32_bf16 a[140:143], a[188:191], a[204:207], a[140:143]
s_add_u32 s100, s100, 16384
v_cmp_le_u32 vcc, 163840, v3
v_mfma_f32_16x16x32_bf16 a[144:147], a[188:191], a[208:211], a[144:147]
s_nop 0
v_cndmask_b32 v3, v3, v19, vcc
v_mfma_f32_16x16x32_bf16 a[148:151], a[188:191], a[212:215], a[148:151]
v_xor_b32 v4, 64, v3
v_mfma_f32_16x16x32_bf16 a[152:155], a[188:191], a[216:219], a[152:155]
v_mfma_f32_16x16x32_bf16 a[156:159], a[188:191], a[220:223], a[156:159]
s_waitcnt vmcnt(23) lgkmcnt(0)
s_barrier
v_mfma_f32_16x16x32_bf16 v[160:163], a[160:163], a[224:227], v[160:163]
ds_read_b64_tr_b16 a[192:193], v5 offset:0
v_mfma_f32_16x16x32_bf16 v[164:167], a[160:163], a[228:231], v[164:167]
v_mfma_f32_16x16x32_bf16 v[168:171], a[160:163], a[232:235], v[168:171]
ds_read_b64_tr_b16 a[194:195], v5 offset:1024
v_mfma_f32_16x16x32_bf16 v[172:175], a[160:163], a[236:239], v[172:175]
s_add_u32 s37, s31, 0
v_mfma_f32_16x16x32_bf16 v[176:179], a[160:163], a[240:243], v[176:179]
s_add_u32 m0, s33, 0
ds_read_b64_tr_b16 a[196:197], v6 offset:0
v_mfma_f32_16x16x32_bf16 v[180:183], a[160:163], a[244:247], v[180:183]
buffer_load_dwordx4 v2, s[20:23], s37 offen  lds
v_mfma_f32_16x16x32_bf16 v[184:187], a[160:163], a[248:251], v[184:187]
ds_read_b64_tr_b16 a[198:199], v6 offset:1024
v_mfma_f32_16x16x32_bf16 v[188:191], a[160:163], a[252:255], v[188:191]
ds_read_b128 a[160:163], v3 offset:0
v_mfma_f32_16x16x32_bf16 v[192:195], a[164:167], a[224:227], v[192:195]
ds_read_b64_tr_b16 a[200:201], v7 offset:0
v_mfma_f32_16x16x32_bf16 v[196:199], a[164:167], a[228:231], v[196:199]
v_mfma_f32_16x16x32_bf16 v[200:203], a[164:167], a[232:235], v[200:203]
s_add_u32 s37, s31, 32768
ds_read_b64_tr_b16 a[202:203], v7 offset:1024
v_mfma_f32_16x16x32_bf16 v[204:207], a[164:167], a[236:239], v[204:207]
s_add_u32 m0, s33, 1024
v_mfma_f32_16x16x32_bf16 v[208:211], a[164:167], a[240:243], v[208:211]
buffer_load_dwordx4 v2, s[20:23], s37 offen  lds
v_mfma_f32_16x16x32_bf16 v[212:215], a[164:167], a[244:247], v[212:215]
ds_read_b64_tr_b16 a[204:205], v8 offset:0
v_mfma_f32_16x16x32_bf16 v[216:219], a[164:167], a[248:251], v[216:219]
s_add_u32 s29, s29, s44
v_mfma_f32_16x16x32_bf16 v[220:223], a[164:167], a[252:255], v[220:223]
ds_read_b128 a[164:167], v4 offset:1024
v_mfma_f32_16x16x32_bf16 v[224:227], a[168:171], a[224:227], v[224:227]
buffer_store_dwordx4 v[76:79], v13, s[8:11], s29 offen sc1
v_mfma_f32_16x16x32_bf16 v[228:231], a[168:171], a[228:231], v[228:231]
s_add_u32 s37, s31, 131072
ds_read_b64_tr_b16 a[206:207], v8 offset:1024
v_mfma_f32_16x16x32_bf16 v[232:235], a[168:171], a[232:235], v[232:235]
s_add_u32 m0, s33, 4096
v_mfma_f32_16x16x32_bf16 v[236:239], a[168:171], a[236:239], v[236:239]
buffer_load_dwordx4 v2, s[20:23], s37 offen  lds
v_mfma_f32_16x16x32_bf16 v[240:243], a[168:171], a[240:243], v[240:243]
ds_read_b64_tr_b16 a[208:209], v9 offset:0
v_mfma_f32_16x16x32_bf16 v[244:247], a[168:171], a[244:247], v[244:247]
v_mfma_f32_16x16x32_bf16 v[248:251], a[168:171], a[248:251], v[248:251]
ds_read_b64_tr_b16 a[210:211], v9 offset:1024
v_mfma_f32_16x16x32_bf16 v[252:255], a[168:171], a[252:255], v[252:255]
ds_read_b128 a[168:171], v3 offset:4096
v_mfma_f32_16x16x32_bf16 a[0:3], a[172:175], a[224:227], a[0:3]
s_add_u32 s37, s31, 163840
ds_read_b64_tr_b16 a[212:213], v10 offset:0
v_mfma_f32_16x16x32_bf16 a[4:7], a[172:175], a[228:231], a[4:7]
s_add_u32 m0, s33, 5120
v_mfma_f32_16x16x32_bf16 a[8:11], a[172:175], a[232:235], a[8:11]
buffer_load_dwordx4 v2, s[20:23], s37 offen  lds
v_mfma_f32_16x16x32_bf16 a[12:15], a[172:175], a[236:239], a[12:15]
s_add_u32 s31, s31, 262144
ds_read_b64_tr_b16 a[214:215], v10 offset:1024
v_mfma_f32_16x16x32_bf16 a[16:19], a[172:175], a[240:243], a[16:19]
s_add_u32 s33, s33, 16384
v_mfma_f32_16x16x32_bf16 a[20:23], a[172:175], a[244:247], a[20:23]
s_and_b32 s33, s33, 65535
ds_read_b64_tr_b16 a[216:217], v11 offset:0
v_mfma_f32_16x16x32_bf16 a[24:27], a[172:175], a[248:251], a[24:27]
v_mfma_f32_16x16x32_bf16 a[28:31], a[172:175], a[252:255], a[28:31]
s_mov_b32 s48, s30
ds_read_b128 a[172:175], v4 offset:5120
v_mfma_f32_16x16x32_bf16 a[32:35], a[176:179], a[224:227], a[32:35]
s_add_u32 m0, s32, 0
ds_read_b64_tr_b16 a[218:219], v11 offset:1024
v_mfma_f32_16x16x32_bf16 a[36:39], a[176:179], a[228:231], a[36:39]
buffer_load_dwordx4 v1, s[12:15], s48 offen lds
v_mfma_f32_16x16x32_bf16 a[40:43], a[176:179], a[232:235], a[40:43]
ds_read_b64_tr_b16 a[220:221], v12 offset:0
v_mfma_f32_16x16x32_bf16 a[44:47], a[176:179], a[236:239], a[44:47]
s_add_u32 s29, s29, s93
v_mfma_f32_16x16x32_bf16 a[48:51], a[176:179], a[240:243], a[48:51]
ds_read_b64_tr_b16 a[222:223], v12 offset:1024
v_mfma_f32_16x16x32_bf16 a[52:55], a[176:179], a[244:247], a[52:55]
buffer_store_dwordx4 v[80:83], v13, s[8:11], s29 offen sc1
v_mfma_f32_16x16x32_bf16 a[56:59], a[176:179], a[248:251], a[56:59]
s_add_u32 s48, s48, s34
ds_read_b128 a[188:191], v4 offset:13312
v_mfma_f32_16x16x32_bf16 a[60:63], a[176:179], a[252:255], a[60:63]
s_add_u32 m0, s32, 4096
ds_read_b128 a[176:179], v3 offset:8192
v_mfma_f32_16x16x32_bf16 a[64:67], a[180:183], a[224:227], a[64:67]
buffer_load_dwordx4 v1, s[12:15], s48 offen lds
v_mfma_f32_16x16x32_bf16 a[68:71], a[180:183], a[228:231], a[68:71]
v_add_u32 v5, 16384, v5
v_and_b32 v5, 65535, v5
v_mfma_f32_16x16x32_bf16 a[72:75], a[180:183], a[232:235], a[72:75]
v_xor_b32 v6, 16, v5
v_xor_b32 v7, 64, v5
v_mfma_f32_16x16x32_bf16 a[76:79], a[180:183], a[236:239], a[76:79]
v_xor_b32 v8, 80, v5
v_xor_b32 v9, 128, v5
v_mfma_f32_16x16x32_bf16 a[80:83], a[180:183], a[240:243], a[80:83]
v_xor_b32 v10, 144, v5
v_xor_b32 v11, 192, v5
v_mfma_f32_16x16x32_bf16 a[84:87], a[180:183], a[244:247], a[84:87]
s_add_u32 s48, s48, s34
v_xor_b32 v12, 208, v5
v_mfma_f32_16x16x32_bf16 a[88:91], a[180:183], a[248:251], a[88:91]
s_add_u32 m0, s32, 8192
v_mfma_f32_16x16x32_bf16 a[92:95], a[180:183], a[252:255], a[92:95]
buffer_load_dwordx4 v1, s[12:15], s48 offen lds
ds_read_b128 a[180:183], v4 offset:9216
v_mfma_f32_16x16x32_bf16 a[96:99], a[184:187], a[224:227], a[96:99]
v_mfma_f32_16x16x32_bf16 a[100:103], a[184:187], a[228:231], a[100:103]
v_mfma_f32_16x16x32_bf16 a[104:107], a[184:187], a[232:235], a[104:107]
v_mfma_f32_16x16x32_bf16 a[108:111], a[184:187], a[236:239], a[108:111]
v_mfma_f32_16x16x32_bf16 a[112:115], a[184:187], a[240:243], a[112:115]
s_add_u32 s48, s48, s34
v_mfma_f32_16x16x32_bf16 a[116:119], a[184:187], a[244:247], a[116:119]
s_add_u32 m0, s32, 12288
v_mfma_f32_16x16x32_bf16 a[120:123], a[184:187], a[248:251], a[120:123]
buffer_load_dwordx4 v1, s[12:15], s48 offen lds
v_mfma_f32_16x16x32_bf16 a[124:127], a[184:187], a[252:255], a[124:127]
ds_read_b128 a[184:187], v3 offset:12288
v_mfma_f32_16x16x32_bf16 a[128:131], v[28:31], a[224:227], a[128:131]
s_add_u32 s29, s29, s44
v_mfma_f32_16x16x32_bf16 a[132:135], v[28:31], a[228:231], a[132:135]
v_mfma_f32_16x16x32_bf16 a[136:139], v[28:31], a[232:235], a[136:139]
buffer_store_dwordx4 v[84:87], v13, s[8:11], s29 offen sc1
buffer_load_dword v15, v14, s[96:99], s100 offen
v_mfma_f32_16x16x32_bf16 a[140:143], v[28:31], a[236:239], a[140:143]
s_add_u32 s100, s100, 16384
v_mfma_f32_16x16x32_bf16 a[144:147], v[28:31], a[240:243], a[144:147]
v_mfma_f32_16x16x32_bf16 a[148:151], v[28:31], a[244:247], a[148:151]
v_mfma_f32_16x16x32_bf16 a[152:155], v[28:31], a[248:251], a[152:155]
v_mfma_f32_16x16x32_bf16 a[156:159], v[28:31], a[252:255], a[156:159]
s_waitcnt vmcnt(24) lgkmcnt(0)
s_barrier
v_mfma_f32_16x16x32_bf16 v[160:163], a[160:163], a[192:195], v[160:163]
ds_read_b64_tr_b16 a[224:225], v5 offset:0
v_mfma_f32_16x16x32_bf16 v[164:167], a[160:163], a[196:199], v[164:167]
v_mfma_f32_16x16x32_bf16 v[168:171], a[160:163], a[200:203], v[168:171]
ds_read_b64_tr_b16 a[226:227], v5 offset:1024
v_mfma_f32_16x16x32_bf16 v[172:175], a[160:163], a[204:207], v[172:175]
s_add_u32 s37, s31, 0
v_mfma_f32_16x16x32_bf16 v[176:179], a[160:163], a[208:211], v[176:179]
s_add_u32 m0, s33, 0
ds_read_b64_tr_b16 a[228:229], v6 offset:0
v_mfma_f32_16x16x32_bf16 v[180:183], a[160:163], a[212:215], v[180:183]
buffer_load_dwordx4 v2, s[20:23], s37 offen  lds
v_mfma_f32_16x16x32_bf16 v[184:187], a[160:163], a[216:219], v[184:187]
ds_read_b64_tr_b16 a[230:231], v6 offset:1024
v_mfma_f32_16x16x32_bf16 v[188:191], a[160:163], a[220:223], v[188:191]
ds_read_b128 a[160:163], v4 offset:0
v_mfma_f32_16x16x32_bf16 v[192:195], a[164:167], a[192:195], v[192:195]
ds_read_b64_tr_b16 a[232:233], v7 offset:0
v_mfma_f32_16x16x32_bf16 v[196:199], a[164:167], a[196:199], v[196:199]
v_mfma_f32_16x16x32_bf16 v[200:203], a[164:167], a[200:203], v[200:203]
s_add_u32 s37, s31, 32768
ds_read_b64_tr_b16 a[234:235], v7 offset:1024
v_mfma_f32_16x16x32_bf16 v[204:207], a[164:167], a[204:207], v[204:207]
s_add_u32 m0, s33, 1024
v_mfma_f32_16x16x32_bf16 v[208:211], a[164:167], a[208:211], v[208:211]
buffer_load_dwordx4 v2, s[20:23], s37 offen  lds
v_mfma_f32_16x16x32_bf16 v[212:215], a[164:167], a[212:215], v[212:215]
ds_read_b64_tr_b16 a[236:237], v8 offset:0
v_mfma_f32_16x16x32_bf16 v[216:219], a[164:167], a[216:219], v[216:219]
s_add_u32 s29, s29, s93
v_mfma_f32_16x16x32_bf16 v[220:223], a[164:167], a[220:223], v[220:223]
ds_read_b128 a[164:167], v3 offset:1024
v_mfma_f32_16x16x32_bf16 v[224:227], a[168:171], a[192:195], v[224:227]
buffer_store_dwordx4 v[88:91], v13, s[8:11], s29 offen sc1
v_mfma_f32_16x16x32_bf16 v[228:231], a[168:171], a[196:199], v[228:231]
s_add_u32 s37, s31, 131072
ds_read_b64_tr_b16 a[238:239], v8 offset:1024
v_mfma_f32_16x16x32_bf16 v[232:235], a[168:171], a[200:203], v[232:235]
s_add_u32 m0, s33, 4096
v_mfma_f32_16x16x32_bf16 v[236:239], a[168:171], a[204:207], v[236:239]
buffer_load_dwordx4 v2, s[20:23], s37 offen  lds
v_mfma_f32_16x16x32_bf16 v[240:243], a[168:171], a[208:211], v[240:243]
ds_read_b64_tr_b16 a[240:241], v9 offset:0
v_mfma_f32_16x16x32_bf16 v[244:247], a[168:171], a[212:215], v[244:247]
v_mfma_f32_16x16x32_bf16 v[248:251], a[168:171], a[216:219], v[248:251]
ds_read_b64_tr_b16 a[242:243], v9 offset:1024
v_mfma_f32_16x16x32_bf16 v[252:255], a[168:171], a[220:223], v[252:255]
ds_read_b128 a[168:171], v4 offset:4096
v_mfma_f32_16x16x32_bf16 a[0:3], a[172:175], a[192:195], a[0:3]
s_add_u32 s37, s31, 163840
ds_read_b64_tr_b16 a[244:245], v10 offset:0
v_mfma_f32_16x16x32_bf16 a[4:7], a[172:175], a[196:199], a[4:7]
s_add_u32 m0, s33, 5120
v_mfma_f32_16x16x32_bf16 a[8:11], a[172:175], a[200:203], a[8:11]
buffer_load_dwordx4 v2, s[20:23], s37 offen  lds
v_mfma_f32_16x16x32_bf16 a[12:15], a[172:175], a[204:207], a[12:15]
s_add_u32 s31, s31, 262144
ds_read_b64_tr_b16 a[246:247], v10 offset:1024
v_mfma_f32_16x16x32_bf16 a[16:19], a[172:175], a[208:211], a[16:19]
s_add_u32 s33, s33, 16384
v_mfma_f32_16x16x32_bf16 a[20:23], a[172:175], a[212:215], a[20:23]
s_and_b32 s33, s33, 65535
ds_read_b64_tr_b16 a[248:249], v11 offset:0
v_mfma_f32_16x16x32_bf16 a[24:27], a[172:175], a[216:219], a[24:27]
v_mfma_f32_16x16x32_bf16 a[28:31], a[172:175], a[220:223], a[28:31]
s_add_u32 s48, s48, s34
ds_read_b128 a[172:175], v3 offset:5120
v_mfma_f32_16x16x32_bf16 a[32:35], a[176:179], a[192:195], a[32:35]
s_add_u32 m0, s32, 16384
ds_read_b64_tr_b16 a[250:251], v11 offset:1024
v_mfma_f32_16x16x32_bf16 a[36:39], a[176:179], a[196:199], a[36:39]
buffer_load_dwordx4 v1, s[12:15], s48 offen lds
v_mfma_f32_16x16x32_bf16 a[40:43], a[176:179], a[200:203], a[40:43]
ds_read_b64_tr_b16 a[252:253], v12 offset:0
v_mfma_f32_16x16x32_bf16 a[44:47], a[176:179], a[204:207], a[44:47]
s_add_u32 s29, s29, s44
v_mfma_f32_16x16x32_bf16 a[48:51], a[176:179], a[208:211], a[48:51]
ds_read_b64_tr_b16 a[254:255], v12 offset:1024
v_mfma_f32_16x16x32_bf16 a[52:55], a[176:179], a[212:215], a[52:55]
buffer_store_dwordx4 v[92:95], v13, s[8:11], s29 offen sc1
v_mfma_f32_16x16x32_bf16 a[56:59], a[176:179], a[216:219], a[56:59]
s_add_u32 s48, s48, s34
ds_read_b128 v[28:31], v3 offset:13312
v_mfma_f32_16x16x32_bf16 a[60:63], a[176:179], a[220:223], a[60:63]
s_add_u32 m0, s32, 20480
ds_read_b128 a[176:179], v4 offset:8192
v_mfma_f32_16x16x32_bf16 a[64:67], a[180:183], a[192:195], a[64:67]
buffer_load_dwordx4 v1, s[12:15], s48 offen lds
v_mfma_f32_16x16x32_bf16 a[68:71], a[180:183], a[196:199], a[68:71]
v_add_u32 v5, 16384, v5
v_and_b32 v5, 65535, v5
v_mfma_f32_16x16x32_bf16 a[72:75], a[180:183], a[200:203], a[72:75]
v_xor_b32 v6, 16, v5
v_xor_b32 v7, 64, v5
v_mfma_f32_16x16x32_bf16 a[76:79], a[180:183], a[204:207], a[76:79]
v_xor_b32 v8, 80, v5
v_xor_b32 v9, 128, v5
v_mfma_f32_16x16x32_bf16 a[80:83], a[180:183], a[208:211], a[80:83]
v_xor_b32 v10, 144, v5
v_xor_b32 v11, 192, v5
v_mfma_f32_16x16x32_bf16 a[84:87], a[180:183], a[212:215], a[84:87]
s_add_u32 s48, s48, s34
v_xor_b32 v12, 208, v5
v_mfma_f32_16x16x32_bf16 a[88:91], a[180:183], a[216:219], a[88:91]
s_add_u32 m0, s32, 24576
v_mfma_f32_16x16x32_bf16 a[92:95], a[180:183], a[220:223], a[92:95]
buffer_load_dwordx4 v1, s[12:15], s48 offen lds
ds_read_b128 a[180:183], v3 offset:9216
v_mfma_f32_16x16x32_bf16 a[96:99], a[184:187], a[192:195], a[96:99]
v_mfma_f32_16x16x32_bf16 a[100:103], a[184:187], a[196:199], a[100:103]
v_mfma_f32_16x16x32_bf16 a[104:107], a[184:187], a[200:203], a[104:107]
v_mfma_f32_16x16x32_bf16 a[108:111], a[184:187], a[204:207], a[108:111]
v_mfma_f32_16x16x32_bf16 a[112:115], a[184:187], a[208:211], a[112:115]
s_add_u32 s48, s48, s34
v_mfma_f32_16x16x32_bf16 a[116:119], a[184:187], a[212:215], a[116:119]
s_add_u32 m0, s32, 28672
v_mfma_f32_16x16x32_bf16 a[120:123], a[184:187], a[216:219], a[120:123]
buffer_load_dwordx4 v1, s[12:15], s48 offen lds
v_mfma_f32_16x16x32_bf16 a[124:127], a[184:187], a[220:223], a[124:127]
s_add_u32 s30, s30, 128
ds_read_b128 a[184:187], v4 offset:12288
v_mfma_f32_16x16x32_bf16 a[128:131], a[188:191], a[192:195], a[128:131]
s_add_u32 s32, s32, 32768
v_add_u32 v3, 32768, v3
v_mfma_f32_16x16x32_bf16 a[132:135], a[188:191], a[196:199], a[132:135]
s_sub_u32 s48, s32, 98304
v_subrev_u32 v19, 98304, v3
v_mfma_f32_16x16x32_bf16 a[136:139], a[188:191], a[200:203], a[136:139]
s_cmp_ge_u32 s32, 163840
s_cselect_b32 s32, s48, s32
buffer_load_dword v15, v14, s[96:99], s100 offen
v_mfma_f32_16x16x32_bf16 a[140:143], a[188:191], a[204:207], a[140:143]
s_add_u32 s100, s100, 16384
v_cmp_le_u32 vcc, 163840, v3
v_mfma_f32_16x16x32_bf16 a[144:147], a[188:191], a[208:211], a[144:147]
s_nop 0
v_cndmask_b32 v3, v3, v19, vcc
v_mfma_f32_16x16x32_bf16 a[148:151], a[188:191], a[212:215], a[148:151]
v_xor_b32 v4, 64, v3
v_mfma_f32_16x16x32_bf16 a[152:155], a[188:191], a[216:219], a[152:155]
v_mfma_f32_16x16x32_bf16 a[156:159], a[188:191], a[220:223], a[156:159]
s_waitcnt vmcnt(23) lgkmcnt(0)
s_barrier
v_mfma_f32_16x16x32_bf16 v[160:163], a[160:163], a[224:227], v[160:163]
ds_read_b64_tr_b16 a[192:193], v5 offset:0
v_mfma_f32_16x16x32_bf16 v[164:167], a[160:163], a[228:231], v[164:167]
v_mfma_f32_16x16x32_bf16 v[168:171], a[160:163], a[232:235], v[168:171]
ds_read_b64_tr_b16 a[194:195], v5 offset:1024
v_mfma_f32_16x16x32_bf16 v[172:175], a[160:163], a[236:239], v[172:175]
s_add_u32 s37, s31, 0
v_mfma_f32_16x16x32_bf16 v[176:179], a[160:163], a[240:243], v[176:179]
s_add_u32 m0, s33, 0
ds_read_b64_tr_b16 a[196:197], v6 offset:0
v_mfma_f32_16x16x32_bf16 v[180:183], a[160:163], a[244:247], v[180:183]
buffer_load_dwordx4 v2, s[20:23], s37 offen  lds
v_mfma_f32_16x16x32_bf16 v[184:187], a[160:163], a[248:251], v[184:187]
ds_read_b64_tr_b16 a[198:199], v6 offset:1024
v_mfma_f32_16x16x32_bf16 v[188:191], a[160:163], a[252:255], v[188:191]
ds_read_b128 a[160:163], v3 offset:0
v_mfma_f32_16x16x32_bf16 v[192:195], a[164:167], a[224:227], v[192:195]
ds_read_b64_tr_b16 a[200:201], v7 offset:0
v_mfma_f32_16x16x32_bf16 v[196:199], a[164:167], a[228:231], v[196:199]
v_mfma_f32_16x16x32_bf16 v[200:203], a[164:167], a[232:235], v[200:203]
s_add_u32 s37, s31, 32768
ds_read_b64_tr_b16 a[202:203], v7 offset:1024
v_mfma_f32_16x16x32_bf16 v[204:207], a[164:167], a[236:239], v[204:207]
s_add_u32 m0, s33, 1024
v_mfma_f32_16x16x32_bf16 v[208:211], a[164:167], a[240:243], v[208:211]
buffer_load_dwordx4 v2, s[20:23], s37 offen  lds
v_mfma_f32_16x16x32_bf16 v[212:215], a[164:167], a[244:247], v[212:215]
ds_read_b64_tr_b16 a[204:205], v8 offset:0
v_mfma_f32_16x16x32_bf16 v[216:219], a[164:167], a[248:251], v[216:219]
s_add_u32 s60, s60, s92
v_mfma_f32_16x16x32_bf16 v[220:223], a[164:167], a[252:255], v[220:223]
s_mov_b32 s29, s60
ds_read_b128 a[164:167], v4 offset:1024
v_mfma_f32_16x16x32_bf16 v[224:227], a[168:171], a[224:227], v[224:227]
buffer_store_dwordx4 v[96:99], v13, s[8:11], s29 offen sc1
v_mfma_f32_16x16x32_bf16 v[228:231], a[168:171], a[228:231], v[228:231]
s_add_u32 s37, s31, 131072
ds_read_b64_tr_b16 a[206:207], v8 offset:1024
v_mfma_f32_16x16x32_bf16 v[232:235], a[168:171], a[232:235], v[232:235]
s_add_u32 m0, s33, 4096
v_mfma_f32_16x16x32_bf16 v[236:239], a[168:171], a[236:239], v[236:239]
buffer_load_dwordx4 v2, s[20:23], s37 offen  lds
v_mfma_f32_16x16x32_bf16 v[240:243], a[168:171], a[240:243], v[240:243]
ds_read_b64_tr_b16 a[208:209], v9 offset:0
v_mfma_f32_16x16x32_bf16 v[244:247], a[168:171], a[244:247], v[244:247]
v_mfma_f32_16x16x32_bf16 v[248:251], a[168:171], a[248:251], v[248:251]
ds_read_b64_tr_b16 a[210:211], v9 offset:1024
v_mfma_f32_16x16x32_bf16 v[252:255], a[168:171], a[252:255], v[252:255]
ds_read_b128 a[168:171], v3 offset:4096
v_mfma_f32_16x16x32_bf16 a[0:3], a[172:175], a[224:227], a[0:3]
s_add_u32 s37, s31, 163840
ds_read_b64_tr_b16 a[212:213], v10 offset:0
v_mfma_f32_16x16x32_bf16 a[4:7], a[172:175], a[228:231], a[4:7]
s_add_u32 m0, s33, 5120
v_mfma_f32_16x16x32_bf16 a[8:11], a[172:175], a[232:235], a[8:11]
buffer_load_dwordx4 v2, s[20:23], s37 offen  lds
v_mfma_f32_16x16x32_bf16 a[12:15], a[172:175], a[236:239], a[12:15]
s_add_u32 s31, s31, 262144
ds_read_b64_tr_b16 a[214:215], v10 offset:1024
v_mfma_f32_16x16x32_bf16 a[16:19], a[172:175], a[240:243], a[16:19]
s_add_u32 s33, s33, 16384
v_mfma_f32_16x16x32_bf16 a[20:23], a[172:175], a[244:247], a[20:23]
s_and_b32 s33, s33, 65535
ds_read_b64_tr_b16 a[216:217], v11 offset:0
v_mfma_f32_16x16x32_bf16 a[24:27], a[172:175], a[248:251], a[24:27]
v_mfma_f32_16x16x32_bf16 a[28:31], a[172:175], a[252:255], a[28:31]
s_mov_b32 s48, s30
ds_read_b128 a[172:175], v4 offset:5120
v_mfma_f32_16x16x32_bf16 a[32:35], a[176:179], a[224:227], a[32:35]
s_add_u32 m0, s32, 0
ds_read_b64_tr_b16 a[218:219], v11 offset:1024
v_mfma_f32_16x16x32_bf16 a[36:39], a[176:179], a[228:231], a[36:39]
buffer_load_dwordx4 v1, s[12:15], s48 offen lds
v_mfma_f32_16x16x32_bf16 a[40:43], a[176:179], a[232:235], a[40:43]
ds_read_b64_tr_b16 a[220:221], v12 offset:0
v_mfma_f32_16x16x32_bf16 a[44:47], a[176:179], a[236:239], a[44:47]
s_add_u32 s29, s29, s44
v_mfma_f32_16x16x32_bf16 a[48:51], a[176:179], a[240:243], a[48:51]
ds_read_b64_tr_b16 a[222:223], v12 offset:1024
v_mfma_f32_16x16x32_bf16 a[52:55], a[176:179], a[244:247], a[52:55]
buffer_store_dwordx4 v[100:103], v13, s[8:11], s29 offen sc1
v_mfma_f32_16x16x32_bf16 a[56:59], a[176:179], a[248:251], a[56:59]
s_add_u32 s48, s48, s34
ds_read_b128 a[188:191], v4 offset:13312
v_mfma_f32_16x16x32_bf16 a[60:63], a[176:179], a[252:255], a[60:63]
s_add_u32 m0, s32, 4096
ds_read_b128 a[176:179], v3 offset:8192
v_mfma_f32_16x16x32_bf16 a[64:67], a[180:183], a[224:227], a[64:67]
buffer_load_dwordx4 v1, s[12:15], s48 offen lds
v_mfma_f32_16x16x32_bf16 a[68:71], a[180:183], a[228:231], a[68:71]
v_add_u32 v5, 16384, v5
v_and_b32 v5, 65535, v5
v_mfma_f32_16x16x32_bf16 a[72:75], a[180:183], a[232:235], a[72:75]
v_xor_b32 v6, 16, v5
v_xor_b32 v7, 64, v5
v_mfma_f32_16x16x32_bf16 a[76:79], a[180:183], a[236:239], a[76:79]
v_xor_b32 v8, 80, v5
v_xor_b32 v9, 128, v5
v_mfma_f32_16x16x32_bf16 a[80:83], a[180:183], a[240:243], a[80:83]
v_xor_b32 v10, 144, v5
v_xor_b32 v11, 192, v5
v_mfma_f32_16x16x32_bf16 a[84:87], a[180:183], a[244:247], a[84:87]
s_add_u32 s48, s48, s34
v_xor_b32 v12, 208, v5
v_mfma_f32_16x16x32_bf16 a[88:91], a[180:183], a[248:251], a[88:91]
s_add_u32 m0, s32, 8192
v_mfma_f32_16x16x32_bf16 a[92:95], a[180:183], a[252:255], a[92:95]
buffer_load_dwordx4 v1, s[12:15], s48 offen lds
ds_read_b128 a[180:183], v4 offset:9216
v_mfma_f32_16x16x32_bf16 a[96:99], a[184:187], a[224:227], a[96:99]
v_mfma_f32_16x16x32_bf16 a[100:103], a[184:187], a[228:231], a[100:103]
v_mfma_f32_16x16x32_bf16 a[104:107], a[184:187], a[232:235], a[104:107]
v_mfma_f32_16x16x32_bf16 a[108:111], a[184:187], a[236:239], a[108:111]
v_mfma_f32_16x16x32_bf16 a[112:115], a[184:187], a[240:243], a[112:115]
s_add_u32 s48, s48, s34
v_mfma_f32_16x16x32_bf16 a[116:119], a[184:187], a[244:247], a[116:119]
s_add_u32 m0, s32, 12288
v_mfma_f32_16x16x32_bf16 a[120:123], a[184:187], a[248:251], a[120:123]
buffer_load_dwordx4 v1, s[12:15], s48 offen lds
v_mfma_f32_16x16x32_bf16 a[124:127], a[184:187], a[252:255], a[124:127]
ds_read_b128 a[184:187], v3 offset:12288
v_mfma_f32_16x16x32_bf16 a[128:131], v[28:31], a[224:227], a[128:131]
s_add_u32 s29, s29, s93
v_mfma_f32_16x16x32_bf16 a[132:135], v[28:31], a[228:231], a[132:135]
v_mfma_f32_16x16x32_bf16 a[136:139], v[28:31], a[232:235], a[136:139]
buffer_store_dwordx4 v[104:107], v13, s[8:11], s29 offen sc1
buffer_load_dword v15, v14, s[96:99], s100 offen
v_mfma_f32_16x16x32_bf16 a[140:143], v[28:31], a[236:239], a[140:143]
s_add_u32 s100, s100, 16384
v_mfma_f32_16x16x32_bf16 a[144:147], v[28:31], a[240:243], a[144:147]
v_mfma_f32_16x16x32_bf16 a[148:151], v[28:31], a[244:247], a[148:151]
v_mfma_f32_16x16x32_bf16 a[152:155], v[28:31], a[248:251], a[152:155]
v_mfma_f32_16x16x32_bf16 a[156:159], v[28:31], a[252:255], a[156:159]
s_waitcnt vmcnt(23) lgkmcnt(0)
s_barrier
v_mfma_f32_16x16x32_bf16 v[160:163], a[160:163], a[192:195], v[160:163]
ds_read_b64_tr_b16 a[224:225], v5 offset:0
v_mfma_f32_16x16x32_bf16 v[164:167], a[160:163], a[196:199], v[164:167]
v_mfma_f32_16x16x32_bf16 v[168:171], a[160:163], a[200:203], v[168:171]
ds_read_b64_tr_b16 a[226:227], v5 offset:1024
v_mfma_f32_16x16x32_bf16 v[172:175], a[160:163], a[204:207], v[172:175]
s_add_u32 s37, s31, 0
v_mfma_f32_16x16x32_bf16 v[176:179], a[160:163], a[208:211], v[176:179]
s_add_u32 m0, s33, 0
ds_read_b64_tr_b16 a[228:229], v6 offset:0
v_mfma_f32_16x16x32_bf16 v[180:183], a[160:163], a[212:215], v[180:183]
buffer_load_dwordx4 v2, s[20:23], s37 offen  lds
v_mfma_f32_16x16x32_bf16 v[184:187], a[160:163], a[216:219], v[184:187]
ds_read_b64_tr_b16 a[230:231], v6 offset:1024
v_mfma_f32_16x16x32_bf16 v[188:191], a[160:163], a[220:223], v[188:191]
ds_read_b128 a[160:163], v4 offset:0
v_mfma_f32_16x16x32_bf16 v[192:195], a[164:167], a[192:195], v[192:195]
ds_read_b64_tr_b16 a[232:233], v7 offset:0
v_mfma_f32_16x16x32_bf16 v[196:199], a[164:167], a[196:199], v[196:199]
v_mfma_f32_16x16x32_bf16 v[200:203], a[164:167], a[200:203], v[200:203]
s_add_u32 s37, s31, 32768
ds_read_b64_tr_b16 a[234:235], v7 offset:1024
v_mfma_f32_16x16x32_bf16 v[204:207], a[164:167], a[204:207], v[204:207]
s_add_u32 m0, s33, 1024
v_mfma_f32_16x16x32_bf16 v[208:211], a[164:167], a[208:211], v[208:211]
buffer_load_dwordx4 v2, s[20:23], s37 offen  lds
v_mfma_f32_16x16x32_bf16 v[212:215], a[164:167], a[212:215], v[212:215]
ds_read_b64_tr_b16 a[236:237], v8 offset:0
v_mfma_f32_16x16x32_bf16 v[216:219], a[164:167], a[216:219], v[216:219]
s_add_u32 s29, s29, s44
v_mfma_f32_16x16x32_bf16 v[220:223], a[164:167], a[220:223], v[220:223]
ds_read_b128 a[164:167], v3 offset:1024
v_mfma_f32_16x16x32_bf16 v[224:227], a[168:171], a[192:195], v[224:227]
buffer_store_dwordx4 v[108:111], v13, s[8:11], s29 offen sc1
v_mfma_f32_16x16x32_bf16 v[228:231], a[168:171], a[196:199], v[228:231]
s_add_u32 s37, s31, 131072
ds_read_b64_tr_b16 a[238:239], v8 offset:1024
v_mfma_f32_16x16x32_bf16 v[232:235], a[168:171], a[200:203], v[232:235]
s_add_u32 m0, s33, 4096
v_mfma_f32_16x16x32_bf16 v[236:239], a[168:171], a[204:207], v[236:239]
buffer_load_dwordx4 v2, s[20:23], s37 offen  lds
v_mfma_f32_16x16x32_bf16 v[240:243], a[168:171], a[208:211], v[240:243]
ds_read_b64_tr_b16 a[240:241], v9 offset:0
v_mfma_f32_16x16x32_bf16 v[244:247], a[168:171], a[212:215], v[244:247]
v_mfma_f32_16x16x32_bf16 v[248:251], a[168:171], a[216:219], v[248:251]
ds_read_b64_tr_b16 a[242:243], v9 offset:1024
v_mfma_f32_16x16x32_bf16 v[252:255], a[168:171], a[220:223], v[252:255]
ds_read_b128 a[168:171], v4 offset:4096
v_mfma_f32_16x16x32_bf16 a[0:3], a[172:175], a[192:195], a[0:3]
s_add_u32 s37, s31, 163840
ds_read_b64_tr_b16 a[244:245], v10 offset:0
v_mfma_f32_16x16x32_bf16 a[4:7], a[172:175], a[196:199], a[4:7]
s_add_u32 m0, s33, 5120
v_mfma_f32_16x16x32_bf16 a[8:11], a[172:175], a[200:203], a[8:11]
buffer_load_dwordx4 v2, s[20:23], s37 offen  lds
v_mfma_f32_16x16x32_bf16 a[12:15], a[172:175], a[204:207], a[12:15]
s_add_u32 s31, s31, 262144
ds_read_b64_tr_b16 a[246:247], v10 offset:1024
v_mfma_f32_16x16x32_bf16 a[16:19], a[172:175], a[208:211], a[16:19]
s_add_u32 s33, s33, 16384
v_mfma_f32_16x16x32_bf16 a[20:23], a[172:175], a[212:215], a[20:23]
s_and_b32 s33, s33, 65535
ds_read_b64_tr_b16 a[248:249], v11 offset:0
v_mfma_f32_16x16x32_bf16 a[24:27], a[172:175], a[216:219], a[24:27]
v_mfma_f32_16x16x32_bf16 a[28:31], a[172:175], a[220:223], a[28:31]
s_add_u32 s48, s48, s34
ds_read_b128 a[172:175], v3 offset:5120
v_mfma_f32_16x16x32_bf16 a[32:35], a[176:179], a[192:195], a[32:35]
s_add_u32 m0, s32, 16384
ds_read_b64_tr_b16 a[250:251], v11 offset:1024
v_mfma_f32_16x16x32_bf16 a[36:39], a[176:179], a[196:199], a[36:39]
buffer_load_dwordx4 v1, s[12:15], s48 offen lds
v_mfma_f32_16x16x32_bf16 a[40:43], a[176:179], a[200:203], a[40:43]
ds_read_b64_tr_b16 a[252:253], v12 offset:0
v_mfma_f32_16x16x32_bf16 a[44:47], a[176:179], a[204:207], a[44:47]
s_add_u32 s29, s29, s93
v_mfma_f32_16x16x32_bf16 a[48:51], a[176:179], a[208:211], a[48:51]
ds_read_b64_tr_b16 a[254:255], v12 offset:1024
v_mfma_f32_16x16x32_bf16 a[52:55], a[176:179], a[212:215], a[52:55]
buffer_store_dwordx4 v[112:115], v13, s[8:11], s29 offen sc1
v_mfma_f32_16x16x32_bf16 a[56:59], a[176:179], a[216:219], a[56:59]
s_add_u32 s48, s48, s34
ds_read_b128 v[28:31], v3 offset:13312
v_mfma_f32_16x16x32_bf16 a[60:63], a[176:179], a[220:223], a[60:63]
s_add_u32 m0, s32, 20480
ds_read_b128 a[176:179], v4 offset:8192
v_mfma_f32_16x16x32_bf16 a[64:67], a[180:183], a[192:195], a[64:67]
buffer_load_dwordx4 v1, s[12:15], s48 offen lds
v_mfma_f32_16x16x32_bf16 a[68:71], a[180:183], a[196:199], a[68:71]
v_add_u32 v5, 16384, v5
v_and_b32 v5, 65535, v5
v_mfma_f32_16x16x32_bf16 a[72:75], a[180:183], a[200:203], a[72:75]
v_xor_b32 v6, 16, v5
v_xor_b32 v7, 64, v5
v_mfma_f32_16x16x32_bf16 a[76:79], a[180:183], a[204:207], a[76:79]
v_xor_b32 v8, 80, v5
v_xor_b32 v9, 128, v5
v_mfma_f32_16x16x32_bf16 a[80:83], a[180:183], a[208:211], a[80:83]
v_xor_b32 v10, 144, v5
v_xor_b32 v11, 192, v5
v_mfma_f32_16x16x32_bf16 a[84:87], a[180:183], a[212:215], a[84:87]
s_add_u32 s48, s48, s34
v_xor_b32 v12, 208, v5
v_mfma_f32_16x16x32_bf16 a[88:91], a[180:183], a[216:219], a[88:91]
s_add_u32 m0, s32, 24576
v_mfma_f32_16x16x32_bf16 a[92:95], a[180:183], a[220:223], a[92:95]
buffer_load_dwordx4 v1, s[12:15], s48 offen lds
ds_read_b128 a[180:183], v3 offset:9216
v_mfma_f32_16x16x32_bf16 a[96:99], a[184:187], a[192:195], a[96:99]
v_mfma_f32_16x16x32_bf16 a[100:103], a[184:187], a[196:199], a[100:103]
v_mfma_f32_16x16x32_bf16 a[104:107], a[184:187], a[200:203], a[104:107]
v_mfma_f32_16x16x32_bf16 a[108:111], a[184:187], a[204:207], a[108:111]
v_mfma_f32_16x16x32_bf16 a[112:115], a[184:187], a[208:211], a[112:115]
s_add_u32 s48, s48, s34
v_mfma_f32_16x16x32_bf16 a[116:119], a[184:187], a[212:215], a[116:119]
s_add_u32 m0, s32, 28672
v_mfma_f32_16x16x32_bf16 a[120:123], a[184:187], a[216:219], a[120:123]
buffer_load_dwordx4 v1, s[12:15], s48 offen lds
v_mfma_f32_16x16x32_bf16 a[124:127], a[184:187], a[220:223], a[124:127]
s_add_u32 s30, s30, 128
ds_read_b128 a[184:187], v4 offset:12288
v_mfma_f32_16x16x32_bf16 a[128:131], a[188:191], a[192:195], a[128:131]
s_add_u32 s32, s32, 32768
s_add_u32 s29, s29, s44
v_add_u32 v3, 32768, v3
v_mfma_f32_16x16x32_bf16 a[132:135], a[188:191], a[196:199], a[132:135]
s_sub_u32 s48, s32, 98304
v_subrev_u32 v19, 98304, v3
v_mfma_f32_16x16x32_bf16 a[136:139], a[188:191], a[200:203], a[136:139]
s_cmp_ge_u32 s32, 163840
s_cselect_b32 s32, s48, s32
buffer_store_dwordx4 v[116:119], v13, s[8:11], s29 offen sc1
buffer_load_dword v15, v14, s[96:99], s100 offen
v_mfma_f32_16x16x32_bf16 a[140:143], a[188:191], a[204:207], a[140:143]
s_add_u32 s100, s100, 16384
v_cmp_le_u32 vcc, 163840, v3
v_mfma_f32_16x16x32_bf16 a[144:147], a[188:191], a[208:211], a[144:147]
s_nop 0
v_cndmask_b32 v3, v3, v19, vcc
v_mfma_f32_16x16x32_bf16 a[148:151], a[188:191], a[212:215], a[148:151]
v_xor_b32 v4, 64, v3
v_mfma_f32_16x16x32_bf16 a[152:155], a[188:191], a[216:219], a[152:155]
v_mfma_f32_16x16x32_bf16 a[156:159], a[188:191], a[220:223], a[156:159]
s_waitcnt vmcnt(24) lgkmcnt(0)
s_barrier
v_mfma_f32_16x16x32_bf16 v[160:163], a[160:163], a[224:227], v[160:163]
ds_read_b64_tr_b16 a[192:193], v5 offset:0
v_mfma_f32_16x16x32_bf16 v[164:167], a[160:163], a[228:231], v[164:167]
v_mfma_f32_16x16x32_bf16 v[168:171], a[160:163], a[232:235], v[168:171]
ds_read_b64_tr_b16 a[194:195], v5 offset:1024
v_mfma_f32_16x16x32_bf16 v[172:175], a[160:163], a[236:239], v[172:175]
s_add_u32 s37, s31, 0
v_mfma_f32_16x16x32_bf16 v[176:179], a[160:163], a[240:243], v[176:179]
s_add_u32 m0, s33, 0
ds_read_b64_tr_b16 a[196:197], v6 offset:0
v_mfma_f32_16x16x32_bf16 v[180:183], a[160:163], a[244:247], v[180:183]
buffer_load_dwordx4 v2, s[20:23], s37 offen  lds
v_mfma_f32_16x16x32_bf16 v[184:187], a[160:163], a[248:251], v[184:187]
ds_read_b64_tr_b16 a[198:199], v6 offset:1024
v_mfma_f32_16x16x32_bf16 v[188:191], a[160:163], a[252:255], v[188:191]
ds_read_b128 a[160:163], v3 offset:0
v_mfma_f32_16x16x32_bf16 v[192:195], a[164:167], a[224:227], v[192:195]
ds_read_b64_tr_b16 a[200:201], v7 offset:0
v_mfma_f32_16x16x32_bf16 v[196:199], a[164:167], a[228:231], v[196:199]
v_mfma_f32_16x16x32_bf16 v[200:203], a[164:167], a[232:235], v[200:203]
s_add_u32 s37, s31, 32768
ds_read_b64_tr_b16 a[202:203], v7 offset:1024
v_mfma_f32_16x16x32_bf16 v[204:207], a[164:167], a[236:239], v[204:207]
s_add_u32 m0, s33, 1024
v_mfma_f32_16x16x32_bf16 v[208:211], a[164:167], a[240:243], v[208:211]
buffer_load_dwordx4 v2, s[20:23], s37 offen  lds
v_mfma_f32_16x16x32_bf16 v[212:215], a[164:167], a[244:247], v[212:215]
ds_read_b64_tr_b16 a[204:205], v8 offset:0
v_mfma_f32_16x16x32_bf16 v[216:219], a[164:167], a[248:251], v[216:219]
s_add_u32 s29, s29, s93
v_mfma_f32_16x16x32_bf16 v[220:223], a[164:167], a[252:255], v[220:223]
ds_read_b128 a[164:167], v4 offset:1024
v_mfma_f32_16x16x32_bf16 v[224:227], a[168:171], a[224:227], v[224:227]
buffer_store_dwordx4 v[120:123], v13, s[8:11], s29 offen sc1
v_mfma_f32_16x16x32_bf16 v[228:231], a[168:171], a[228:231], v[228:231]
s_add_u32 s37, s31, 131072
ds_read_b64_tr_b16 a[206:207], v8 offset:1024
v_mfma_f32_16x16x32_bf16 v[232:235], a[168:171], a[232:235], v[232:235]
s_add_u32 m0, s33, 4096
v_mfma_f32_16x16x32_bf16 v[236:239], a[168:171], a[236:239], v[236:239]
buffer_load_dwordx4 v2, s[20:23], s37 offen  lds
v_mfma_f32_16x16x32_bf16 v[240:243], a[168:171], a[240:243], v[240:243]
ds_read_b64_tr_b16 a[208:209], v9 offset:0
v_mfma_f32_16x16x32_bf16 v[244:247], a[168:171], a[244:247], v[244:247]
v_mfma_f32_16x16x32_bf16 v[248:251], a[168:171], a[248:251], v[248:251]
ds_read_b64_tr_b16 a[210:211], v9 offset:1024
v_mfma_f32_16x16x32_bf16 v[252:255], a[168:171], a[252:255], v[252:255]
ds_read_b128 a[168:171], v3 offset:4096
v_mfma_f32_16x16x32_bf16 a[0:3], a[172:175], a[224:227], a[0:3]
s_add_u32 s37, s31, 163840
ds_read_b64_tr_b16 a[212:213], v10 offset:0
v_mfma_f32_16x16x32_bf16 a[4:7], a[172:175], a[228:231], a[4:7]
s_add_u32 m0, s33, 5120
v_mfma_f32_16x16x32_bf16 a[8:11], a[172:175], a[232:235], a[8:11]
buffer_load_dwordx4 v2, s[20:23], s37 offen  lds
v_mfma_f32_16x16x32_bf16 a[12:15], a[172:175], a[236:239], a[12:15]
s_add_u32 s31, s31, 262144
ds_read_b64_tr_b16 a[214:215], v10 offset:1024
v_mfma_f32_16x16x32_bf16 a[16:19], a[172:175], a[240:243], a[16:19]
s_add_u32 s33, s33, 16384
v_mfma_f32_16x16x32_bf16 a[20:23], a[172:175], a[244:247], a[20:23]
s_and_b32 s33, s33, 65535
ds_read_b64_tr_b16 a[216:217], v11 offset:0
v_mfma_f32_16x16x32_bf16 a[24:27], a[172:175], a[248:251], a[24:27]
v_mfma_f32_16x16x32_bf16 a[28:31], a[172:175], a[252:255], a[28:31]
s_mov_b32 s48, s30
ds_read_b128 a[172:175], v4 offset:5120
v_mfma_f32_16x16x32_bf16 a[32:35], a[176:179], a[224:227], a[32:35]
s_add_u32 m0, s32, 0
ds_read_b64_tr_b16 a[218:219], v11 offset:1024
v_mfma_f32_16x16x32_bf16 a[36:39], a[176:179], a[228:231], a[36:39]
buffer_load_dwordx4 v1, s[12:15], s48 offen lds
v_mfma_f32_16x16x32_bf16 a[40:43], a[176:179], a[232:235], a[40:43]
ds_read_b64_tr_b16 a[220:221], v12 offset:0
v_mfma_f32_16x16x32_bf16 a[44:47], a[176:179], a[236:239], a[44:47]
s_add_u32 s29, s29, s44
v_mfma_f32_16x16x32_bf16 a[48:51], a[176:179], a[240:243], a[48:51]
ds_read_b64_tr_b16 a[222:223], v12 offset:1024
v_mfma_f32_16x16x32_bf16 a[52:55], a[176:179], a[244:247], a[52:55]
buffer_store_dwordx4 v[124:127], v13, s[8:11], s29 offen sc1
v_mfma_f32_16x16x32_bf16 a[56:59], a[176:179], a[248:251], a[56:59]
s_add_u32 s48, s48, s34
ds_read_b128 a[188:191], v4 offset:13312
v_mfma_f32_16x16x32_bf16 a[60:63], a[176:179], a[252:255], a[60:63]
s_add_u32 m0, s32, 4096
ds_read_b128 a[176:179], v3 offset:8192
v_mfma_f32_16x16x32_bf16 a[64:67], a[180:183], a[224:227], a[64:67]
buffer_load_dwordx4 v1, s[12:15], s48 offen lds
v_mfma_f32_16x16x32_bf16 a[68:71], a[180:183], a[228:231], a[68:71]
v_add_u32 v5, 16384, v5
v_and_b32 v5, 65535, v5
v_mfma_f32_16x16x32_bf16 a[72:75], a[180:183], a[232:235], a[72:75]
v_xor_b32 v6, 16, v5
v_xor_b32 v7, 64, v5
v_mfma_f32_16x16x32_bf16 a[76:79], a[180:183], a[236:239], a[76:79]
v_xor_b32 v8, 80, v5
v_xor_b32 v9, 128, v5
v_mfma_f32_16x16x32_bf16 a[80:83], a[180:183], a[240:243], a[80:83]
v_xor_b32 v10, 144, v5
v_xor_b32 v11, 192, v5
v_mfma_f32_16x16x32_bf16 a[84:87], a[180:183], a[244:247], a[84:87]
s_add_u32 s48, s48, s34
v_xor_b32 v12, 208, v5
v_mfma_f32_16x16x32_bf16 a[88:91], a[180:183], a[248:251], a[88:91]
s_add_u32 m0, s32, 8192
v_mfma_f32_16x16x32_bf16 a[92:95], a[180:183], a[252:255], a[92:95]
buffer_load_dwordx4 v1, s[12:15], s48 offen lds
ds_read_b128 a[180:183], v4 offset:9216
v_mfma_f32_16x16x32_bf16 a[96:99], a[184:187], a[224:227], a[96:99]
v_mfma_f32_16x16x32_bf16 a[100:103], a[184:187], a[228:231], a[100:103]
v_mfma_f32_16x16x32_bf16 a[104:107], a[184:187], a[232:235], a[104:107]
v_mfma_f32_16x16x32_bf16 a[108:111], a[184:187], a[236:239], a[108:111]
v_mfma_f32_16x16x32_bf16 a[112:115], a[184:187], a[240:243], a[112:115]
s_add_u32 s48, s48, s34
v_mfma_f32_16x16x32_bf16 a[116:119], a[184:187], a[244:247], a[116:119]
s_add_u32 m0, s32, 12288
v_mfma_f32_16x16x32_bf16 a[120:123], a[184:187], a[248:251], a[120:123]
buffer_load_dwordx4 v1, s[12:15], s48 offen lds
v_mfma_f32_16x16x32_bf16 a[124:127], a[184:187], a[252:255], a[124:127]
ds_read_b128 a[184:187], v3 offset:12288
v_mfma_f32_16x16x32_bf16 a[128:131], v[28:31], a[224:227], a[128:131]
v_mfma_f32_16x16x32_bf16 a[132:135], v[28:31], a[228:231], a[132:135]
v_mfma_f32_16x16x32_bf16 a[136:139], v[28:31], a[232:235], a[136:139]
buffer_load_dword v15, v14, s[96:99], s100 offen
v_mfma_f32_16x16x32_bf16 a[140:143], v[28:31], a[236:239], a[140:143]
s_add_u32 s100, s100, 16384
v_mfma_f32_16x16x32_bf16 a[144:147], v[28:31], a[240:243], a[144:147]
v_mfma_f32_16x16x32_bf16 a[148:151], v[28:31], a[244:247], a[148:151]
v_mfma_f32_16x16x32_bf16 a[152:155], v[28:31], a[248:251], a[152:155]
v_mfma_f32_16x16x32_bf16 a[156:159], v[28:31], a[252:255], a[156:159]
s_cmp_eq_u32 s36, 0
s_cbranch_scc1 L_g_v12
s_waitcnt vmcnt(23) lgkmcnt(0)
s_barrier
v_mfma_f32_16x16x32_bf16 v[160:163], a[160:163], a[192:195], v[160:163]
ds_read_b64_tr_b16 a[224:225], v5 offset:0
v_mfma_f32_16x16x32_bf16 v[164:167], a[160:163], a[196:199], v[164:167]
v_mfma_f32_16x16x32_bf16 v[168:171], a[160:163], a[200:203], v[168:171]
ds_read_b64_tr_b16 a[226:227], v5 offset:1024
v_mfma_f32_16x16x32_bf16 v[172:175], a[160:163], a[204:207], v[172:175]
s_add_u32 s37, s31, 0
v_mfma_f32_16x16x32_bf16 v[176:179], a[160:163], a[208:211], v[176:179]
s_add_u32 m0, s33, 0
ds_read_b64_tr_b16 a[228:229], v6 offset:0
v_mfma_f32_16x16x32_bf16 v[180:183], a[160:163], a[212:215], v[180:183]
buffer_load_dwordx4 v2, s[20:23], s37 offen  lds
v_mfma_f32_16x16x32_bf16 v[184:187], a[160:163], a[216:219], v[184:187]
ds_read_b64_tr_b16 a[230:231], v6 offset:1024
v_mfma_f32_16x16x32_bf16 v[188:191], a[160:163], a[220:223], v[188:191]
ds_read_b128 a[160:163], v4 offset:0
v_mfma_f32_16x16x32_bf16 v[192:195], a[164:167], a[192:195], v[192:195]
ds_read_b64_tr_b16 a[232:233], v7 offset:0
v_mfma_f32_16x16x32_bf16 v[196:199], a[164:167], a[196:199], v[196:199]
v_mfma_f32_16x16x32_bf16 v[200:203], a[164:167], a[200:203], v[200:203]
s_add_u32 s37, s31, 32768
ds_read_b64_tr_b16 a[234:235], v7 offset:1024
v_mfma_f32_16x16x32_bf16 v[204:207], a[164:167], a[204:207], v[204:207]
s_add_u32 m0, s33, 1024
v_mfma_f32_16x16x32_bf16 v[208:211], a[164:167], a[208:211], v[208:211]
buffer_load_dwordx4 v2, s[20:23], s37 offen  lds
v_mfma_f32_16x16x32_bf16 v[212:215], a[164:167], a[212:215], v[212:215]
ds_read_b64_tr_b16 a[236:237], v8 offset:0
v_mfma_f32_16x16x32_bf16 v[216:219], a[164:167], a[216:219], v[216:219]
v_mfma_f32_16x16x32_bf16 v[220:223], a[164:167], a[220:223], v[220:223]
ds_read_b128 a[164:167], v3 offset:1024
v_mfma_f32_16x16x32_bf16 v[224:227], a[168:171], a[192:195], v[224:227]
ds_read_b64_tr_b16 a[238:239], v8 offset:1024
v_mfma_f32_16x16x32_bf16 v[228:231], a[168:171], a[196:199], v[228:231]
s_add_u32 s37, s31, 131072
v_mfma_f32_16x16x32_bf16 v[232:235], a[168:171], a[200:203], v[232:235]
s_add_u32 m0, s33, 4096
ds_read_b64_tr_b16 a[240:241], v9 offset:0
v_mfma_f32_16x16x32_bf16 v[236:239], a[168:171], a[204:207], v[236:239]
buffer_load_dwordx4 v2, s[20:23], s37 offen  lds
v_mfma_f32_16x16x32_bf16 v[240:243], a[168:171], a[208:211], v[240:243]
ds_read_b64_tr_b16 a[242:243], v9 offset:1024
v_mfma_f32_16x16x32_bf16 v[244:247], a[168:171], a[212:215], v[244:247]
v_mfma_f32_16x16x32_bf16 v[248:251], a[168:171], a[216:219], v[248:251]
ds_read_b64_tr_b16 a[244:245], v10 offset:0
v_mfma_f32_16x16x32_bf16 v[252:255], a[168:171], a[220:223], v[252:255]
ds_read_b128 a[168:171], v4 offset:4096
v_mfma_f32_16x16x32_bf16 a[0:3], a[172:175], a[192:195], a[0:3]
s_add_u32 s37, s31, 163840
ds_read_b64_tr_b16 a[246:247], v10 offset:1024
v_mfma_f32_16x16x32_bf16 a[4:7], a[172:175], a[196:199], a[4:7]
s_add_u32 m0, s33, 5120
v_mfma_f32_16x16x32_bf16 a[8:11], a[172:175], a[200:203], a[8:11]
buffer_load_dwordx4 v2, s[20:23], s37 offen  lds
v_mfma_f32_16x16x32_bf16 a[12:15], a[172:175], a[204:207], a[12:15]
s_add_u32 s31, s31, 262144
ds_read_b64_tr_b16 a[248:249], v11 offset:0
v_mfma_f32_16x16x32_bf16 a[16:19], a[172:175], a[208:211], a[16:19]
s_add_u32 s33, s33, 16384
v_mfma_f32_16x16x32_bf16 a[20:23], a[172:175], a[212:215], a[20:23]
s_and_b32 s33, s33, 65535
ds_read_b64_tr_b16 a[250:251], v11 offset:1024
v_mfma_f32_16x16x32_bf16 a[24:27], a[172:175], a[216:219], a[24:27]
v_mfma_f32_16x16x32_bf16 a[28:31], a[172:175], a[220:223], a[28:31]
s_add_u32 s48, s48, s34
ds_read_b128 a[172:175], v3 offset:5120
v_mfma_f32_16x16x32_bf16 a[32:35], a[176:179], a[192:195], a[32:35]
s_add_u32 m0, s32, 16384
ds_read_b64_tr_b16 a[252:253], v12 offset:0
v_mfma_f32_16x16x32_bf16 a[36:39], a[176:179], a[196:199], a[36:39]
buffer_load_dwordx4 v1, s[12:15], s48 offen lds
v_mfma_f32_16x16x32_bf16 a[40:43], a[176:179], a[200:203], a[40:43]
ds_read_b64_tr_b16 a[254:255], v12 offset:1024
v_mfma_f32_16x16x32_bf16 a[44:47], a[176:179], a[204:207], a[44:47]
v_mfma_f32_16x16x32_bf16 a[48:51], a[176:179], a[208:211], a[48:51]
ds_read_b128 v[28:31], v3 offset:13312
v_mfma_f32_16x16x32_bf16 a[52:55], a[176:179], a[212:215], a[52:55]
v_mfma_f32_16x16x32_bf16 a[56:59], a[176:179], a[216:219], a[56:59]
s_add_u32 s48, s48, s34
v_mfma_f32_16x16x32_bf16 a[60:63], a[176:179], a[220:223], a[60:63]
s_add_u32 m0, s32, 20480
ds_read_b128 a[176:179], v4 offset:8192
v_add_u32 v5, 16384, v5
v_mfma_f32_16x16x32_bf16 a[64:67], a[180:183], a[192:195], a[64:67]
buffer_load_dwordx4 v1, s[12:15], s48 offen lds
v_and_b32 v5, 65535, v5
v_mfma_f32_16x16x32_bf16 a[68:71], a[180:183], a[196:199], a[68:71]
v_xor_b32 v6, 16, v5
v_xor_b32 v7, 64, v5
v_mfma_f32_16x16x32_bf16 a[72:75], a[180:183], a[200:203], a[72:75]
v_xor_b32 v8, 80, v5
v_xor_b32 v9, 128, v5
v_mfma_f32_16x16x32_bf16 a[76:79], a[180:183], a[204:207], a[76:79]
v_xor_b32 v10, 144, v5
v_xor_b32 v11, 192, v5
v_mfma_f32_16x16x32_bf16 a[80:83], a[180:183], a[208:211], a[80:83]
v_xor_b32 v12, 208, v5
v_mfma_f32_16x16x32_bf16 a[84:87], a[180:183], a[212:215], a[84:87]
s_add_u32 s48, s48, s34
v_mfma_f32_16x16x32_bf16 a[88:91], a[180:183], a[216:219], a[88:91]
s_add_u32 m0, s32, 24576
v_mfma_f32_16x16x32_bf16 a[92:95], a[180:183], a[220:223], a[92:95]
buffer_load_dwordx4 v1, s[12:15], s48 offen lds
ds_read_b128 a[180:183], v3 offset:9216
v_mfma_f32_16x16x32_bf16 a[96:99], a[184:187], a[192:195], a[96:99]
v_mfma_f32_16x16x32_bf16 a[100:103], a[184:187], a[196:199], a[100:103]
v_mfma_f32_16x16x32_bf16 a[104:107], a[184:187], a[200:203], a[104:107]
v_mfma_f32_16x16x32_bf16 a[108:111], a[184:187], a[204:207], a[108:111]
v_mfma_f32_16x16x32_bf16 a[112:115], a[184:187], a[208:211], a[112:115]
s_add_u32 s48, s48, s34
v_mfma_f32_16x16x32_bf16 a[116:119], a[184:187], a[212:215], a[116:119]
s_add_u32 m0, s32, 28672
v_mfma_f32_16x16x32_bf16 a[120:123], a[184:187], a[216:219], a[120:123]
buffer_load_dwordx4 v1, s[12:15], s48 offen lds
v_mfma_f32_16x16x32_bf16 a[124:127], a[184:187], a[220:223], a[124:127]
s_add_u32 s30, s30, 128
ds_read_b128 a[184:187], v4 offset:12288
v_mfma_f32_16x16x32_bf16 a[128:131], a[188:191], a[192:195], a[128:131]
s_add_u32 s32, s32, 32768
v_add_u32 v3, 32768, v3
v_mfma_f32_16x16x32_bf16 a[132:135], a[188:191], a[196:199], a[132:135]
s_sub_u32 s48, s32, 98304
v_subrev_u32 v19, 98304, v3
v_mfma_f32_16x16x32_bf16 a[136:139], a[188:191], a[200:203], a[136:139]
s_cmp_ge_u32 s32, 163840
s_cselect_b32 s32, s48, s32
v_mfma_f32_16x16x32_bf16 a[140:143], a[188:191], a[204:207], a[140:143]
v_cmp_le_u32 vcc, 163840, v3
v_mfma_f32_16x16x32_bf16 a[144:147], a[188:191], a[208:211], a[144:147]
s_nop 0
v_cndmask_b32 v3, v3, v19, vcc
v_mfma_f32_16x16x32_bf16 a[148:151], a[188:191], a[212:215], a[148:151]
v_xor_b32 v4, 64, v3
v_mfma_f32_16x16x32_bf16 a[152:155], a[188:191], a[216:219], a[152:155]
v_mfma_f32_16x16x32_bf16 a[156:159], a[188:191], a[220:223], a[156:159]
s_waitcnt vmcnt(19) lgkmcnt(0)
s_barrier
v_mfma_f32_16x16x32_bf16 v[160:163], a[160:163], a[224:227], v[160:163]
ds_read_b64_tr_b16 a[192:193], v5 offset:0
v_mfma_f32_16x16x32_bf16 v[164:167], a[160:163], a[228:231], v[164:167]
v_mfma_f32_16x16x32_bf16 v[168:171], a[160:163], a[232:235], v[168:171]
ds_read_b64_tr_b16 a[194:195], v5 offset:1024
v_mfma_f32_16x16x32_bf16 v[172:175], a[160:163], a[236:239], v[172:175]
s_add_u32 s37, s31, 0
v_mfma_f32_16x16x32_bf16 v[176:179], a[160:163], a[240:243], v[176:179]
s_add_u32 m0, s33, 0
ds_read_b64_tr_b16 a[196:197], v6 offset:0
v_mfma_f32_16x16x32_bf16 v[180:183], a[160:163], a[244:247], v[180:183]
buffer_load_dwordx4 v2, s[20:23], s37 offen  lds
v_mfma_f32_16x16x32_bf16 v[184:187], a[160:163], a[248:251], v[184:187]
ds_read_b64_tr_b16 a[198:199], v6 offset:1024
v_mfma_f32_16x16x32_bf16 v[188:191], a[160:163], a[252:255], v[188:191]
ds_read_b128 a[160:163], v3 offset:0
v_mfma_f32_16x16x32_bf16 v[192:195], a[164:167], a[224:227], v[192:195]
ds_read_b64_tr_b16 a[200:201], v7 offset:0
v_mfma_f32_16x16x32_bf16 v[196:199], a[164:167], a[228:231], v[196:199]
v_mfma_f32_16x16x32_bf16 v[200:203], a[164:167], a[232:235], v[200:203]
s_add_u32 s37, s31, 32768
ds_read_b64_tr_b16 a[202:203], v7 offset:1024
v_mfma_f32_16x16x32_bf16 v[204:207], a[164:167], a[236:239], v[204:207]
s_add_u32 m0, s33, 1024
v_mfma_f32_16x16x32_bf16 v[208:211], a[164:167], a[240:243], v[208:211]
buffer_load_dwordx4 v2, s[20:23], s37 offen  lds
v_mfma_f32_16x16x32_bf16 v[212:215], a[164:167], a[244:247], v[212:215]
ds_read_b64_tr_b16 a[204:205], v8 offset:0
v_mfma_f32_16x16x32_bf16 v[216:219], a[164:167], a[248:251], v[216:219]
v_mfma_f32_16x16x32_bf16 v[220:223], a[164:167], a[252:255], v[220:223]
ds_read_b128 a[164:167], v4 offset:1024
v_mfma_f32_16x16x32_bf16 v[224:227], a[168:171], a[224:227], v[224:227]
ds_read_b64_tr_b16 a[206:207], v8 offset:1024
v_mfma_f32_16x16x32_bf16 v[228:231], a[168:171], a[228:231], v[228:231]
s_add_u32 s37, s31, 131072
v_mfma_f32_16x16x32_bf16 v[232:235], a[168:171], a[232:235], v[232:235]
s_add_u32 m0, s33, 4096
ds_read_b64_tr_b16 a[208:209], v9 offset:0
v_mfma_f32_16x16x32_bf16 v[236:239], a[168:171], a[236:239], v[236:239]
buffer_load_dwordx4 v2, s[20:23], s37 offen  lds
v_mfma_f32_16x16x32_bf16 v[240:243], a[168:171], a[240:243], v[240:243]
ds_read_b64_tr_b16 a[210:211], v9 offset:1024
v_mfma_f32_16x16x32_bf16 v[244:247], a[168:171], a[244:247], v[244:247]
v_mfma_f32_16x16x32_bf16 v[248:251], a[168:171], a[248:251], v[248:251]
ds_read_b64_tr_b16 a[212:213], v10 offset:0
v_mfma_f32_16x16x32_bf16 v[252:255], a[168:171], a[252:255], v[252:255]
ds_read_b128 a[168:171], v3 offset:4096
v_mfma_f32_16x16x32_bf16 a[0:3], a[172:175], a[224:227], a[0:3]
s_add_u32 s37, s31, 163840
ds_read_b64_tr_b16 a[214:215], v10 offset:1024
v_mfma_f32_16x16x32_bf16 a[4:7], a[172:175], a[228:231], a[4:7]
s_add_u32 m0, s33, 5120
v_mfma_f32_16x16x32_bf16 a[8:11], a[172:175], a[232:235], a[8:11]
buffer_load_dwordx4 v2, s[20:23], s37 offen  lds
v_mfma_f32_16x16x32_bf16 a[12:15], a[172:175], a[236:239], a[12:15]
s_add_u32 s31, s31, 262144
ds_read_b64_tr_b16 a[216:217], v11 offset:0
v_mfma_f32_16x16x32_bf16 a[16:19], a[172:175], a[240:243], a[16:19]
s_add_u32 s33, s33, 16384
v_mfma_f32_16x16x32_bf16 a[20:23], a[172:175], a[244:247], a[20:23]
s_and_b32 s33, s33, 65535
ds_read_b64_tr_b16 a[218:219], v11 offset:1024
v_mfma_f32_16x16x32_bf16 a[24:27], a[172:175], a[248:251], a[24:27]
v_mfma_f32_16x16x32_bf16 a[28:31], a[172:175], a[252:255], a[28:31]
s_mov_b32 s48, s30
ds_read_b128 a[172:175], v4 offset:5120
v_mfma_f32_16x16x32_bf16 a[32:35], a[176:179], a[224:227], a[32:35]
s_add_u32 m0, s32, 0
ds_read_b64_tr_b16 a[220:221], v12 offset:0
v_mfma_f32_16x16x32_bf16 a[36:39], a[176:179], a[228:231], a[36:39]
buffer_load_dwordx4 v1, s[12:15], s48 offen lds
v_mfma_f32_16x16x32_bf16 a[40:43], a[176:179], a[232:235], a[40:43]
ds_read_b64_tr_b16 a[222:223], v12 offset:1024
v_mfma_f32_16x16x32_bf16 a[44:47], a[176:179], a[236:239], a[44:47]
v_mfma_f32_16x16x32_bf16 a[48:51], a[176:179], a[240:243], a[48:51]
ds_read_b128 a[188:191], v4 offset:13312
v_mfma_f32_16x16x32_bf16 a[52:55], a[176:179], a[244:247], a[52:55]
v_mfma_f32_16x16x32_bf16 a[56:59], a[176:179], a[248:251], a[56:59]
s_add_u32 s48, s48, s34
v_mfma_f32_16x16x32_bf16 a[60:63], a[176:179], a[252:255], a[60:63]
s_add_u32 m0, s32, 4096
ds_read_b128 a[176:179], v3 offset:8192
v_add_u32 v5, 16384, v5
v_mfma_f32_16x16x32_bf16 a[64:67], a[180:183], a[224:227], a[64:67]
buffer_load_dwordx4 v1, s[12:15], s48 offen lds
v_and_b32 v5, 65535, v5
v_mfma_f32_16x16x32_bf16 a[68:71], a[180:183], a[228:231], a[68:71]
v_xor_b32 v6, 16, v5
v_xor_b32 v7, 64, v5
v_mfma_f32_16x16x32_bf16 a[72:75], a[180:183], a[232:235], a[72:75]
v_xor_b32 v8, 80, v5
v_xor_b32 v9, 128, v5
v_mfma_f32_16x16x32_bf16 a[76:79], a[180:183], a[236:239], a[76:79]
v_xor_b32 v10, 144, v5
v_xor_b32 v11, 192, v5
v_mfma_f32_16x16x32_bf16 a[80:83], a[180:183], a[240:243], a[80:83]
v_xor_b32 v12, 208, v5
v_mfma_f32_16x16x32_bf16 a[84:87], a[180:183], a[244:247], a[84:87]
s_add_u32 s48, s48, s34
v_mfma_f32_16x16x32_bf16 a[88:91], a[180:183], a[248:251], a[88:91]
s_add_u32 m0, s32, 8192
v_mfma_f32_16x16x32_bf16 a[92:95], a[180:183], a[252:255], a[92:95]
buffer_load_dwordx4 v1, s[12:15], s48 offen lds
ds_read_b128 a[180:183], v4 offset:9216
v_mfma_f32_16x16x32_bf16 a[96:99], a[184:187], a[224:227], a[96:99]
v_mfma_f32_16x16x32_bf16 a[100:103], a[184:187], a[228:231], a[100:103]
v_mfma_f32_16x16x32_bf16 a[104:107], a[184:187], a[232:235], a[104:107]
v_mfma_f32_16x16x32_bf16 a[108:111], a[184:187], a[236:239], a[108:111]
v_mfma_f32_16x16x32_bf16 a[112:115], a[184:187], a[240:243], a[112:115]
s_add_u32 s48, s48, s34
v_mfma_f32_16x16x32_bf16 a[116:119], a[184:187], a[244:247], a[116:119]
s_add_u32 m0, s32, 12288
v_mfma_f32_16x16x32_bf16 a[120:123], a[184:187], a[248:251], a[120:123]
buffer_load_dwordx4 v1, s[12:15], s48 offen lds
v_mfma_f32_16x16x32_bf16 a[124:127], a[184:187], a[252:255], a[124:127]
ds_read_b128 a[184:187], v3 offset:12288
v_mfma_f32_16x16x32_bf16 a[128:131], v[28:31], a[224:227], a[128:131]
v_mfma_f32_16x16x32_bf16 a[132:135], v[28:31], a[228:231], a[132:135]
v_mfma_f32_16x16x32_bf16 a[136:139], v[28:31], a[232:235], a[136:139]
v_mfma_f32_16x16x32_bf16 a[140:143], v[28:31], a[236:239], a[140:143]
v_mfma_f32_16x16x32_bf16 a[144:147], v[28:31], a[240:243], a[144:147]
v_mfma_f32_16x16x32_bf16 a[148:151], v[28:31], a[244:247], a[148:151]
v_mfma_f32_16x16x32_bf16 a[152:155], v[28:31], a[248:251], a[152:155]
v_mfma_f32_16x16x32_bf16 a[156:159], v[28:31], a[252:255], a[156:159]
L_g_v12:
s_waitcnt vmcnt(16) lgkmcnt(0)
s_barrier
v_mfma_f32_16x16x32_bf16 v[160:163], a[160:163], a[192:195], v[160:163]
ds_read_b64_tr_b16 a[224:225], v5 offset:0
s_lshr_b32 s24, s16, 1
v_mfma_f32_16x16x32_bf16 v[164:167], a[160:163], a[196:199], v[164:167]
s_cmp_eq_u32 s35, 5
s_cselect_b32 s90, s24, s90
v_mfma_f32_16x16x32_bf16 v[168:171], a[160:163], a[200:203], v[168:171]
ds_read_b64_tr_b16 a[226:227], v5 offset:1024
s_lshl_b32 s24, s35, 2
v_mfma_f32_16x16x32_bf16 v[172:175], a[160:163], a[204:207], v[172:175]
s_add_u32 s37, s31, 0
s_lshr_b32 s26, s88, s24
s_bfe_u32 s2, s26, 0x10003
v_mfma_f32_16x16x32_bf16 v[176:179], a[160:163], a[208:211], v[176:179]
s_add_u32 m0, s33, 0
ds_read_b64_tr_b16 a[228:229], v6 offset:0
s_and_b32 s26, s26, 7
v_mfma_f32_16x16x32_bf16 v[180:183], a[160:163], a[212:215], v[180:183]
buffer_load_dwordx4 v2, s[20:23], s37 offen  lds
s_or_b32 s40, s2, s61
v_mfma_f32_16x16x32_bf16 v[184:187], a[160:163], a[216:219], v[184:187]
ds_read_b64_tr_b16 a[230:231], v6 offset:1024
s_lshr_b32 s24, s17, 1
v_mfma_f32_16x16x32_bf16 v[188:191], a[160:163], a[220:223], v[188:191]
ds_read_b128 a[160:163], v4 offset:0
v_mfma_f32_16x16x32_bf16 v[192:195], a[164:167], a[192:195], v[192:195]
ds_read_b64_tr_b16 a[232:233], v7 offset:0
v_mfma_f32_16x16x32_bf16 v[196:199], a[164:167], a[196:199], v[196:199]
s_cmp_eq_u32 s2, 0
s_cselect_b32 s41, s24, 0
s_cselect_b32 s27, s89, s90
v_mfma_f32_16x16x32_bf16 v[200:203], a[164:167], a[200:203], v[200:203]
s_add_u32 s37, s31, 32768
ds_read_b64_tr_b16 a[234:235], v7 offset:1024
s_sub_u32 s25, s24, s41
v_mfma_f32_16x16x32_bf16 v[204:207], a[164:167], a[204:207], v[204:207]
s_add_u32 m0, s33, 1024
s_and_b32 s51, s41, s61
s_lshl_b32 s51, s51, 1
v_mfma_f32_16x16x32_bf16 v[208:211], a[164:167], a[208:211], v[208:211]
buffer_load_dwordx4 v2, s[20:23], s37 offen  lds
s_or_b32 s51, s51, s41
v_mfma_f32_16x16x32_bf16 v[212:215], a[164:167], a[212:215], v[212:215]
ds_read_b64_tr_b16 a[236:237], v8 offset:0
s_lshl2_add_u32 s51, s2, s51
v_mfma_f32_16x16x32_bf16 v[216:219], a[164:167], a[216:219], v[216:219]
s_add_u32 s60, s60, s92
s_lshl_b32 s46, s27, s2
s_add_u32 s46, s46, s25
v_mfma_f32_16x16x32_bf16 v[220:223], a[164:167], a[220:223], v[220:223]
s_mov_b32 s29, s60
ds_read_b128 a[164:167], v3 offset:1024
s_lshl_b32 s46, s46, 8
v_mfma_f32_16x16x32_bf16 v[224:227], a[168:171], a[192:195], v[224:227]
buffer_store_dwordx4 v[128:131], v13, s[8:11], s29 offen sc1
s_lshl_b32 s47, s40, 7
v_mfma_f32_16x16x32_bf16 v[228:231], a[168:171], a[196:199], v[228:231]
s_add_u32 s37, s31, 131072
ds_read_b64_tr_b16 a[238:239], v8 offset:1024
s_add_u32 s47, s47, 1024
v_mfma_f32_16x16x32_bf16 v[232:235], a[168:171], a[200:203], v[232:235]
s_add_u32 m0, s33, 4096
s_mul_i32 s101, s26, s47
s_lshl_b32 s101, s101, 8
v_mfma_f32_16x16x32_bf16 v[236:239], a[168:171], a[204:207], v[236:239]
buffer_load_dwordx4 v2, s[20:23], s37 offen  lds
s_and_b32 s25, s17, 1
v_mfma_f32_16x16x32_bf16 v[240:243], a[168:171], a[208:211], v[240:243]
ds_read_b64_tr_b16 a[240:241], v9 offset:0
s_lshl1_add_u32 s42, s26, s25
v_mfma_f32_16x16x32_bf16 v[244:247], a[168:171], a[212:215], v[244:247]
s_lshl_b32 s42, s42, 7
s_lshr_b32 s42, s42, s2
s_add_u32 s42, s42, s27
v_mfma_f32_16x16x32_bf16 v[248:251], a[168:171], a[216:219], v[248:251]
ds_read_b64_tr_b16 a[242:243], v9 offset:1024
s_lshl1_add_u32 s42, s42, s24
v_mfma_f32_16x16x32_bf16 v[252:255], a[168:171], a[220:223], v[252:255]
ds_read_b128 a[168:171], v4 offset:4096
s_lshl_b32 s42, s42, 13
v_mfma_f32_16x16x32_bf16 a[0:3], a[172:175], a[192:195], a[0:3]
s_add_u32 s37, s31, 163840
ds_read_b64_tr_b16 a[244:245], v10 offset:0
s_lshl_b32 s43, s27, 5
v_mfma_f32_16x16x32_bf16 a[4:7], a[172:175], a[196:199], a[4:7]
s_add_u32 m0, s33, 5120
s_add_u32 s43, s43, s26
s_lshl_b32 s43, s43, 2
v_mfma_f32_16x16x32_bf16 a[8:11], a[172:175], a[200:203], a[8:11]
buffer_load_dwordx4 v2, s[20:23], s37 offen  lds
s_lshl_b32 s24, s2, 1
v_mfma_f32_16x16x32_bf16 a[12:15], a[172:175], a[204:207], a[12:15]
s_add_u32 s31, s31, 262144
ds_read_b64_tr_b16 a[246:247], v10 offset:1024
s_add_u32 s24, s24, s61
v_mfma_f32_16x16x32_bf16 a[16:19], a[172:175], a[208:211], a[16:19]
s_add_u32 s33, s33, 16384
s_lshl_b32 s24, s24, 2
s_lshr_b32 s25, 0x8720, s24
v_mfma_f32_16x16x32_bf16 a[20:23], a[172:175], a[212:215], a[20:23]
s_and_b32 s33, s33, 65535
ds_read_b64_tr_b16 a[248:249], v11 offset:0
s_and_b32 s25, s25, 15
v_mfma_f32_16x16x32_bf16 a[24:27], a[172:175], a[216:219], a[24:27]
s_lshl_b32 s25, s25, 24
s_add_u32 s42, s42, s25
s_lshr_b32 s25, 0x7604, s24
v_mfma_f32_16x16x32_bf16 a[28:31], a[172:175], a[220:223], a[28:31]
s_add_u32 s48, s48, s34
ds_read_b128 a[172:175], v3 offset:5120
s_and_b32 s25, s25, 15
v_mfma_f32_16x16x32_bf16 a[32:35], a[176:179], a[192:195], a[32:35]
s_add_u32 m0, s32, 16384
ds_read_b64_tr_b16 a[250:251], v11 offset:1024
s_lshl_b32 s25, s25, 12
v_mfma_f32_16x16x32_bf16 a[36:39], a[176:179], a[196:199], a[36:39]
buffer_load_dwordx4 v1, s[12:15], s48 offen lds
s_add_u32 s43, s43, s25
v_mfma_f32_16x16x32_bf16 a[40:43], a[176:179], a[200:203], a[40:43]
ds_read_b64_tr_b16 a[252:253], v12 offset:0
s_add_u32 s43, s43, 111149056
v_mfma_f32_16x16x32_bf16 a[44:47], a[176:179], a[204:207], a[44:47]
s_add_u32 s29, s29, s44
v_mfma_f32_16x16x32_bf16 a[48:51], a[176:179], a[208:211], a[48:51]
ds_read_b64_tr_b16 a[254:255], v12 offset:1024
v_mfma_f32_16x16x32_bf16 a[52:55], a[176:179], a[212:215], a[52:55]
buffer_store_dwordx4 v[132:135], v13, s[8:11], s29 offen sc1
v_mfma_f32_16x16x32_bf16 a[56:59], a[176:179], a[216:219], a[56:59]
s_add_u32 s48, s48, s34
ds_read_b128 v[28:31], v3 offset:13312
v_mfma_f32_16x16x32_bf16 a[60:63], a[176:179], a[220:223], a[60:63]
s_add_u32 m0, s32, 20480
ds_read_b128 a[176:179], v4 offset:8192
v_mfma_f32_16x16x32_bf16 a[64:67], a[180:183], a[192:195], a[64:67]
buffer_load_dwordx4 v1, s[12:15], s48 offen lds
v_mfma_f32_16x16x32_bf16 a[68:71], a[180:183], a[196:199], a[68:71]
s_cmp_lt_u32 s35, s45
s_cselect_b32 s101, s101, 536870912
s_cselect_b32 s46, s46, 536870912
v_mfma_f32_16x16x32_bf16 a[72:75], a[180:183], a[200:203], a[72:75]
v_add_u32 v5, 16384, v5
v_and_b32 v5, 65535, v5
v_mfma_f32_16x16x32_bf16 a[76:79], a[180:183], a[204:207], a[76:79]
v_xor_b32 v6, 16, v5
v_xor_b32 v7, 64, v5
v_mfma_f32_16x16x32_bf16 a[80:83], a[180:183], a[208:211], a[80:83]
v_xor_b32 v8, 80, v5
v_xor_b32 v9, 128, v5
v_mfma_f32_16x16x32_bf16 a[84:87], a[180:183], a[212:215], a[84:87]
s_add_u32 s48, s48, s34
v_xor_b32 v10, 144, v5
v_xor_b32 v11, 192, v5
v_mfma_f32_16x16x32_bf16 a[88:91], a[180:183], a[216:219], a[88:91]
s_add_u32 m0, s32, 24576
v_xor_b32 v12, 208, v5
v_mfma_f32_16x16x32_bf16 a[92:95], a[180:183], a[220:223], a[92:95]
buffer_load_dwordx4 v1, s[12:15], s48 offen lds
ds_read_b128 a[180:183], v3 offset:9216
v_mfma_f32_16x16x32_bf16 a[96:99], a[184:187], a[192:195], a[96:99]
v_mfma_f32_16x16x32_bf16 a[100:103], a[184:187], a[196:199], a[100:103]
v_mfma_f32_16x16x32_bf16 a[104:107], a[184:187], a[200:203], a[104:107]
v_mfma_f32_16x16x32_bf16 a[108:111], a[184:187], a[204:207], a[108:111]
v_mfma_f32_16x16x32_bf16 a[112:115], a[184:187], a[208:211], a[112:115]
s_add_u32 s48, s48, s34
v_mfma_f32_16x16x32_bf16 a[116:119], a[184:187], a[212:215], a[116:119]
s_add_u32 m0, s32, 28672
v_mfma_f32_16x16x32_bf16 a[120:123], a[184:187], a[216:219], a[120:123]
buffer_load_dwordx4 v1, s[12:15], s48 offen lds
v_mfma_f32_16x16x32_bf16 a[124:127], a[184:187], a[220:223], a[124:127]
s_add_u32 s30, s30, 128
ds_read_b128 a[184:187], v4 offset:12288
v_mfma_f32_16x16x32_bf16 a[128:131], a[188:191], a[192:195], a[128:131]
s_add_u32 s32, s32, 32768
s_add_u32 s29, s29, s93
v_add_u32 v3, 32768, v3
v_mfma_f32_16x16x32_bf16 a[132:135], a[188:191], a[196:199], a[132:135]
s_sub_u32 s48, s32, 98304
v_subrev_u32 v19, 98304, v3
v_mfma_f32_16x16x32_bf16 a[136:139], a[188:191], a[200:203], a[136:139]
s_cmp_ge_u32 s32, 163840
s_cselect_b32 s32, s48, s32
buffer_store_dwordx4 v[136:139], v13, s[8:11], s29 offen sc1
buffer_load_dword v15, v14, s[96:99], s100 offen
v_mfma_f32_16x16x32_bf16 a[140:143], a[188:191], a[204:207], a[140:143]
s_add_u32 s100, s100, 16384
v_cmp_le_u32 vcc, 163840, v3
v_mfma_f32_16x16x32_bf16 a[144:147], a[188:191], a[208:211], a[144:147]
s_nop 0
v_cndmask_b32 v3, v3, v19, vcc
v_mfma_f32_16x16x32_bf16 a[148:151], a[188:191], a[212:215], a[148:151]
v_xor_b32 v4, 64, v3
v_mfma_f32_16x16x32_bf16 a[152:155], a[188:191], a[216:219], a[152:155]
v_mfma_f32_16x16x32_bf16 a[156:159], a[188:191], a[220:223], a[156:159]
s_waitcnt vmcnt(20) lgkmcnt(0)
s_barrier
v_mfma_f32_16x16x32_bf16 v[160:163], a[160:163], a[224:227], v[160:163]
ds_read_b64_tr_b16 a[192:193], v5 offset:0
v_mfma_f32_16x16x32_bf16 v[164:167], a[160:163], a[228:231], v[164:167]
s_cmp_eq_u32 s2, 0
s_cselect_b64 s[4:5], s[52:53], s[54:55]
v_mfma_f32_16x16x32_bf16 v[168:171], a[160:163], a[232:235], v[168:171]
ds_read_b64_tr_b16 a[194:195], v5 offset:1024
s_mov_b32 s12, s4
v_mfma_f32_16x16x32_bf16 v[172:175], a[160:163], a[236:239], v[172:175]
s_add_u32 s37, s31, 0
s_and_b32 s13, s5, 0xffff
s_lshl_b32 s14, s47, 11
v_mfma_f32_16x16x32_bf16 v[176:179], a[160:163], a[240:243], v[176:179]
s_add_u32 m0, s33, 0
ds_read_b64_tr_b16 a[196:197], v6 offset:0
s_mov_b32 s15, 0x20000
v_mfma_f32_16x16x32_bf16 v[180:183], a[160:163], a[244:247], v[180:183]
buffer_load_dwordx4 v2, s[20:23], s37 offen  lds
s_mov_b32 s30, s101
v_mfma_f32_16x16x32_bf16 v[184:187], a[160:163], a[248:251], v[184:187]
ds_read_b64_tr_b16 a[198:199], v6 offset:1024
v_lshrrev_b32 v16, 3, v0
v_mfma_f32_16x16x32_bf16 v[188:191], a[160:163], a[252:255], v[188:191]
ds_read_b128 a[160:163], v3 offset:0
v_mul_lo_u32 v16, v16, s47
v_mfma_f32_16x16x32_bf16 v[192:195], a[164:167], a[224:227], v[192:195]
ds_read_b64_tr_b16 a[200:201], v7 offset:0
v_and_b32 v1, 0x70, v1
v_mfma_f32_16x16x32_bf16 v[196:199], a[164:167], a[228:231], v[196:199]
v_add_u32 v1, v1, v16
s_lshl_b32 s34, s47, 5
v_mfma_f32_16x16x32_bf16 v[200:203], a[164:167], a[232:235], v[200:203]
s_add_u32 s37, s31, 32768
ds_read_b64_tr_b16 a[202:203], v7 offset:1024
v_mfma_f32_16x16x32_bf16 v[204:207], a[164:167], a[236:239], v[204:207]
s_add_u32 m0, s33, 1024
v_mfma_f32_16x16x32_bf16 v[208:211], a[164:167], a[240:243], v[208:211]
buffer_load_dwordx4 v2, s[20:23], s37 offen  lds
v_mfma_f32_16x16x32_bf16 v[212:215], a[164:167], a[244:247], v[212:215]
ds_read_b64_tr_b16 a[204:205], v8 offset:0
v_mfma_f32_16x16x32_bf16 v[216:219], a[164:167], a[248:251], v[216:219]
s_add_u32 s29, s29, s44
v_mfma_f32_16x16x32_bf16 v[220:223], a[164:167], a[252:255], v[220:223]
ds_read_b128 a[164:167], v4 offset:1024
v_mfma_f32_16x16x32_bf16 v[224:227], a[168:171], a[224:227], v[224:227]
buffer_store_dwordx4 v[140:143], v13, s[8:11], s29 offen sc1
v_mfma_f32_16x16x32_bf16 v[228:231], a[168:171], a[228:231], v[228:231]
s_add_u32 s37, s31, 131072
ds_read_b64_tr_b16 a[206:207], v8 offset:1024
v_mfma_f32_16x16x32_bf16 v[232:235], a[168:171], a[232:235], v[232:235]
s_add_u32 m0, s33, 4096
v_mfma_f32_16x16x32_bf16 v[236:239], a[168:171], a[236:239], v[236:239]
buffer_load_dwordx4 v2, s[20:23], s37 offen  lds
v_mfma_f32_16x16x32_bf16 v[240:243], a[168:171], a[240:243], v[240:243]
ds_read_b64_tr_b16 a[208:209], v9 offset:0
v_mfma_f32_16x16x32_bf16 v[244:247], a[168:171], a[244:247], v[244:247]
v_mfma_f32_16x16x32_bf16 v[248:251], a[168:171], a[248:251], v[248:251]
ds_read_b64_tr_b16 a[210:211], v9 offset:1024
v_mfma_f32_16x16x32_bf16 v[252:255], a[168:171], a[252:255], v[252:255]
ds_read_b128 a[168:171], v3 offset:4096
v_mfma_f32_16x16x32_bf16 a[0:3], a[172:175], a[224:227], a[0:3]
s_add_u32 s37, s31, 163840
ds_read_b64_tr_b16 a[212:213], v10 offset:0
v_mfma_f32_16x16x32_bf16 a[4:7], a[172:175], a[228:231], a[4:7]
s_add_u32 m0, s33, 5120
v_mfma_f32_16x16x32_bf16 a[8:11], a[172:175], a[232:235], a[8:11]
buffer_load_dwordx4 v2, s[20:23], s37 offen  lds
v_mfma_f32_16x16x32_bf16 a[12:15], a[172:175], a[236:239], a[12:15]
s_add_u32 s31, s31, 262144
ds_read_b64_tr_b16 a[214:215], v10 offset:1024
v_mfma_f32_16x16x32_bf16 a[16:19], a[172:175], a[240:243], a[16:19]
s_add_u32 s33, s33, 16384
v_mfma_f32_16x16x32_bf16 a[20:23], a[172:175], a[244:247], a[20:23]
s_and_b32 s33, s33, 65535
ds_read_b64_tr_b16 a[216:217], v11 offset:0
v_mfma_f32_16x16x32_bf16 a[24:27], a[172:175], a[248:251], a[24:27]
v_mfma_f32_16x16x32_bf16 a[28:31], a[172:175], a[252:255], a[28:31]
s_mov_b32 s48, s30
ds_read_b128 a[172:175], v4 offset:5120
v_mfma_f32_16x16x32_bf16 a[32:35], a[176:179], a[224:227], a[32:35]
s_add_u32 m0, s32, 0
ds_read_b64_tr_b16 a[218:219], v11 offset:1024
v_mfma_f32_16x16x32_bf16 a[36:39], a[176:179], a[228:231], a[36:39]
buffer_load_dwordx4 v1, s[12:15], s48 offen lds
v_mfma_f32_16x16x32_bf16 a[40:43], a[176:179], a[232:235], a[40:43]
ds_read_b64_tr_b16 a[220:221], v12 offset:0
v_mfma_f32_16x16x32_bf16 a[44:47], a[176:179], a[236:239], a[44:47]
s_add_u32 s29, s29, s93
v_mfma_f32_16x16x32_bf16 a[48:51], a[176:179], a[240:243], a[48:51]
ds_read_b64_tr_b16 a[222:223], v12 offset:1024
v_mfma_f32_16x16x32_bf16 a[52:55], a[176:179], a[244:247], a[52:55]
buffer_store_dwordx4 v[144:147], v13, s[8:11], s29 offen sc1
v_mfma_f32_16x16x32_bf16 a[56:59], a[176:179], a[248:251], a[56:59]
s_add_u32 s48, s48, s34
ds_read_b128 a[188:191], v4 offset:13312
v_mfma_f32_16x16x32_bf16 a[60:63], a[176:179], a[252:255], a[60:63]
s_add_u32 m0, s32, 4096
ds_read_b128 a[176:179], v3 offset:8192
v_mfma_f32_16x16x32_bf16 a[64:67], a[180:183], a[224:227], a[64:67]
buffer_load_dwordx4 v1, s[12:15], s48 offen lds
v_mfma_f32_16x16x32_bf16 a[68:71], a[180:183], a[228:231], a[68:71]
v_add_u32 v5, 16384, v5
v_and_b32 v5, 65535, v5
v_mfma_f32_16x16x32_bf16 a[72:75], a[180:183], a[232:235], a[72:75]
v_xor_b32 v6, 16, v5
v_xor_b32 v7, 64, v5
v_mfma_f32_16x16x32_bf16 a[76:79], a[180:183], a[236:239], a[76:79]
v_xor_b32 v8, 80, v5
v_xor_b32 v9, 128, v5
v_mfma_f32_16x16x32_bf16 a[80:83], a[180:183], a[240:243], a[80:83]
s_cmp_eq_u32 s2, 0
s_cselect_b64 s[4:5], s[6:7], s[18:19]
v_mfma_f32_16x16x32_bf16 a[84:87], a[180:183], a[244:247], a[84:87]
s_add_u32 s48, s48, s34
s_mov_b32 s20, s4
s_and_b32 s21, s5, 0xffff
v_mfma_f32_16x16x32_bf16 a[88:91], a[180:183], a[248:251], a[88:91]
s_add_u32 m0, s32, 8192
s_lshl_b32 s22, s47, 12
s_mov_b32 s23, 0x20000
v_mfma_f32_16x16x32_bf16 a[92:95], a[180:183], a[252:255], a[92:95]
buffer_load_dwordx4 v1, s[12:15], s48 offen lds
ds_read_b128 a[180:183], v4 offset:9216
v_mfma_f32_16x16x32_bf16 a[96:99], a[184:187], a[224:227], a[96:99]
s_mov_b32 s31, s46
v_xor_b32 v10, 144, v5
v_xor_b32 v11, 192, v5
v_mfma_f32_16x16x32_bf16 a[100:103], a[184:187], a[228:231], a[100:103]
v_xor_b32 v12, 208, v5
v_mfma_f32_16x16x32_bf16 a[104:107], a[184:187], a[232:235], a[104:107]
v_mfma_f32_16x16x32_bf16 a[108:111], a[184:187], a[236:239], a[108:111]
v_mfma_f32_16x16x32_bf16 a[112:115], a[184:187], a[240:243], a[112:115]
s_add_u32 s48, s48, s34
v_mfma_f32_16x16x32_bf16 a[116:119], a[184:187], a[244:247], a[116:119]
s_add_u32 m0, s32, 12288
v_mfma_f32_16x16x32_bf16 a[120:123], a[184:187], a[248:251], a[120:123]
buffer_load_dwordx4 v1, s[12:15], s48 offen lds
v_mfma_f32_16x16x32_bf16 a[124:127], a[184:187], a[252:255], a[124:127]
ds_read_b128 a[184:187], v3 offset:12288
v_mfma_f32_16x16x32_bf16 a[128:131], v[28:31], a[224:227], a[128:131]
s_add_u32 s29, s29, s44
v_mfma_f32_16x16x32_bf16 a[132:135], v[28:31], a[228:231], a[132:135]
v_mfma_f32_16x16x32_bf16 a[136:139], v[28:31], a[232:235], a[136:139]
buffer_store_dwordx4 v[148:151], v13, s[8:11], s29 offen sc1
buffer_load_dword v15, v14, s[96:99], s100 offen
v_mfma_f32_16x16x32_bf16 a[140:143], v[28:31], a[236:239], a[140:143]
s_add_u32 s100, s100, 16384
v_mfma_f32_16x16x32_bf16 a[144:147], v[28:31], a[240:243], a[144:147]
v_mfma_f32_16x16x32_bf16 a[148:151], v[28:31], a[244:247], a[148:151]
v_mfma_f32_16x16x32_bf16 a[152:155], v[28:31], a[248:251], a[152:155]
v_mfma_f32_16x16x32_bf16 a[156:159], v[28:31], a[252:255], a[156:159]
s_waitcnt vmcnt(24) lgkmcnt(0)
s_barrier
v_mfma_f32_16x16x32_bf16 v[160:163], a[160:163], a[192:195], v[160:163]
ds_read_b64_tr_b16 a[224:225], v5 offset:0
v_mfma_f32_16x16x32_bf16 v[164:167], a[160:163], a[196:199], v[164:167]
v_mfma_f32_16x16x32_bf16 v[168:171], a[160:163], a[200:203], v[168:171]
ds_read_b64_tr_b16 a[226:227], v5 offset:1024
v_mfma_f32_16x16x32_bf16 v[172:175], a[160:163], a[204:207], v[172:175]
s_add_u32 s37, s31, 0
v_mfma_f32_16x16x32_bf16 v[176:179], a[160:163], a[208:211], v[176:179]
s_add_u32 m0, s33, 0
ds_read_b64_tr_b16 a[228:229], v6 offset:0
v_mfma_f32_16x16x32_bf16 v[180:183], a[160:163], a[212:215], v[180:183]
buffer_load_dwordx4 v2, s[20:23], s37 offen  lds
v_mfma_f32_16x16x32_bf16 v[184:187], a[160:163], a[216:219], v[184:187]
ds_read_b64_tr_b16 a[230:231], v6 offset:1024
v_mfma_f32_16x16x32_bf16 v[188:191], a[160:163], a[220:223], v[188:191]
ds_read_b128 a[160:163], v4 offset:0
v_mfma_f32_16x16x32_bf16 v[192:195], a[164:167], a[192:195], v[192:195]
ds_read_b64_tr_b16 a[232:233], v7 offset:0
v_mfma_f32_16x16x32_bf16 v[196:199], a[164:167], a[196:199], v[196:199]
v_mfma_f32_16x16x32_bf16 v[200:203], a[164:167], a[200:203], v[200:203]
s_add_u32 s37, s31, 32768
ds_read_b64_tr_b16 a[234:235], v7 offset:1024
v_mfma_f32_16x16x32_bf16 v[204:207], a[164:167], a[204:207], v[204:207]
s_add_u32 m0, s33, 1024
v_mfma_f32_16x16x32_bf16 v[208:211], a[164:167], a[208:211], v[208:211]
buffer_load_dwordx4 v2, s[20:23], s37 offen  lds
v_mfma_f32_16x16x32_bf16 v[212:215], a[164:167], a[212:215], v[212:215]
ds_read_b64_tr_b16 a[236:237], v8 offset:0
v_mfma_f32_16x16x32_bf16 v[216:219], a[164:167], a[216:219], v[216:219]
s_add_u32 s29, s29, s93
v_mfma_f32_16x16x32_bf16 v[220:223], a[164:167], a[220:223], v[220:223]
ds_read_b128 a[164:167], v3 offset:1024
v_mfma_f32_16x16x32_bf16 v[224:227], a[168:171], a[192:195], v[224:227]
buffer_store_dwordx4 v[152:155], v13, s[8:11], s29 offen sc1
v_mfma_f32_16x16x32_bf16 v[228:231], a[168:171], a[196:199], v[228:231]
s_add_u32 s37, s31, 131072
ds_read_b64_tr_b16 a[238:239], v8 offset:1024
v_mfma_f32_16x16x32_bf16 v[232:235], a[168:171], a[200:203], v[232:235]
s_add_u32 m0, s33, 4096
v_mfma_f32_16x16x32_bf16 v[236:239], a[168:171], a[204:207], v[236:239]
buffer_load_dwordx4 v2, s[20:23], s37 offen  lds
v_mfma_f32_16x16x32_bf16 v[240:243], a[168:171], a[208:211], v[240:243]
ds_read_b64_tr_b16 a[240:241], v9 offset:0
v_mfma_f32_16x16x32_bf16 v[244:247], a[168:171], a[212:215], v[244:247]
v_mfma_f32_16x16x32_bf16 v[248:251], a[168:171], a[216:219], v[248:251]
ds_read_b64_tr_b16 a[242:243], v9 offset:1024
v_mfma_f32_16x16x32_bf16 v[252:255], a[168:171], a[220:223], v[252:255]
ds_read_b128 a[168:171], v4 offset:4096
v_mfma_f32_16x16x32_bf16 a[0:3], a[172:175], a[192:195], a[0:3]
s_add_u32 s37, s31, 163840
ds_read_b64_tr_b16 a[244:245], v10 offset:0
v_mfma_f32_16x16x32_bf16 a[4:7], a[172:175], a[196:199], a[4:7]
s_add_u32 m0, s33, 5120
v_mfma_f32_16x16x32_bf16 a[8:11], a[172:175], a[200:203], a[8:11]
buffer_load_dwordx4 v2, s[20:23], s37 offen  lds
v_mfma_f32_16x16x32_bf16 a[12:15], a[172:175], a[204:207], a[12:15]
s_add_u32 s31, s31, 262144
ds_read_b64_tr_b16 a[246:247], v10 offset:1024
v_mfma_f32_16x16x32_bf16 a[16:19], a[172:175], a[208:211], a[16:19]
s_add_u32 s33, s33, 16384
v_mfma_f32_16x16x32_bf16 a[20:23], a[172:175], a[212:215], a[20:23]
s_and_b32 s33, s33, 65535
ds_read_b64_tr_b16 a[248:249], v11 offset:0
v_mfma_f32_16x16x32_bf16 a[24:27], a[172:175], a[216:219], a[24:27]
v_mfma_f32_16x16x32_bf16 a[28:31], a[172:175], a[220:223], a[28:31]
s_add_u32 s48, s48, s34
ds_read_b128 a[172:175], v3 offset:5120
v_mfma_f32_16x16x32_bf16 a[32:35], a[176:179], a[192:195], a[32:35]
s_add_u32 m0, s32, 16384
ds_read_b64_tr_b16 a[250:251], v11 offset:1024
v_mfma_f32_16x16x32_bf16 a[36:39], a[176:179], a[196:199], a[36:39]
buffer_load_dwordx4 v1, s[12:15], s48 offen lds
v_mfma_f32_16x16x32_bf16 a[40:43], a[176:179], a[200:203], a[40:43]
ds_read_b64_tr_b16 a[252:253], v12 offset:0
v_mfma_f32_16x16x32_bf16 a[44:47], a[176:179], a[204:207], a[44:47]
s_add_u32 s29, s29, s44
v_mfma_f32_16x16x32_bf16 a[48:51], a[176:179], a[208:211], a[48:51]
ds_read_b64_tr_b16 a[254:255], v12 offset:1024
v_mfma_f32_16x16x32_bf16 a[52:55], a[176:179], a[212:215], a[52:55]
buffer_store_dwordx4 v[156:159], v13, s[8:11], s29 offen sc1
v_mfma_f32_16x16x32_bf16 a[56:59], a[176:179], a[216:219], a[56:59]
s_add_u32 s48, s48, s34
ds_read_b128 v[28:31], v3 offset:13312
v_mfma_f32_16x16x32_bf16 a[60:63], a[176:179], a[220:223], a[60:63]
s_add_u32 m0, s32, 20480
ds_read_b128 a[176:179], v4 offset:8192
v_mfma_f32_16x16x32_bf16 a[64:67], a[180:183], a[192:195], a[64:67]
buffer_load_dwordx4 v1, s[12:15], s48 offen lds
v_mfma_f32_16x16x32_bf16 a[68:71], a[180:183], a[196:199], a[68:71]
v_add_u32 v5, 16384, v5
v_and_b32 v5, 65535, v5
v_mfma_f32_16x16x32_bf16 a[72:75], a[180:183], a[200:203], a[72:75]
v_xor_b32 v6, 16, v5
v_xor_b32 v7, 64, v5
v_mfma_f32_16x16x32_bf16 a[76:79], a[180:183], a[204:207], a[76:79]
v_xor_b32 v8, 80, v5
v_xor_b32 v9, 128, v5
v_mfma_f32_16x16x32_bf16 a[80:83], a[180:183], a[208:211], a[80:83]
v_xor_b32 v10, 144, v5
v_xor_b32 v11, 192, v5
v_mfma_f32_16x16x32_bf16 a[84:87], a[180:183], a[212:215], a[84:87]
s_add_u32 s48, s48, s34
v_xor_b32 v12, 208, v5
v_mfma_f32_16x16x32_bf16 a[88:91], a[180:183], a[216:219], a[88:91]
s_add_u32 m0, s32, 24576
v_mfma_f32_16x16x32_bf16 a[92:95], a[180:183], a[220:223], a[92:95]
buffer_load_dwordx4 v1, s[12:15], s48 offen lds
ds_read_b128 a[180:183], v3 offset:9216
v_mfma_f32_16x16x32_bf16 a[96:99], a[184:187], a[192:195], a[96:99]
v_mfma_f32_16x16x32_bf16 a[100:103], a[184:187], a[196:199], a[100:103]
v_mfma_f32_16x16x32_bf16 a[104:107], a[184:187], a[200:203], a[104:107]
v_mfma_f32_16x16x32_bf16 a[108:111], a[184:187], a[204:207], a[108:111]
v_mfma_f32_16x16x32_bf16 a[112:115], a[184:187], a[208:211], a[112:115]
s_add_u32 s48, s48, s34
v_mfma_f32_16x16x32_bf16 a[116:119], a[184:187], a[212:215], a[116:119]
s_add_u32 m0, s32, 28672
v_mfma_f32_16x16x32_bf16 a[120:123], a[184:187], a[216:219], a[120:123]
buffer_load_dwordx4 v1, s[12:15], s48 offen lds
v_mfma_f32_16x16x32_bf16 a[124:127], a[184:187], a[220:223], a[124:127]
s_add_u32 s30, s30, 128
ds_read_b128 a[184:187], v4 offset:12288
v_mfma_f32_16x16x32_bf16 a[128:131], a[188:191], a[192:195], a[128:131]
s_add_u32 s32, s32, 32768
v_add_u32 v3, 32768, v3
v_mfma_f32_16x16x32_bf16 a[132:135], a[188:191], a[196:199], a[132:135]
s_sub_u32 s48, s32, 98304
v_subrev_u32 v19, 98304, v3
v_mfma_f32_16x16x32_bf16 a[136:139], a[188:191], a[200:203], a[136:139]
s_cmp_ge_u32 s32, 163840
s_cselect_b32 s32, s48, s32
buffer_load_dword v15, v14, s[96:99], s100 offen
v_mfma_f32_16x16x32_bf16 a[140:143], a[188:191], a[204:207], a[140:143]
s_add_u32 s100, s100, 16384
v_cmp_le_u32 vcc, 163840, v3
v_mfma_f32_16x16x32_bf16 a[144:147], a[188:191], a[208:211], a[144:147]
s_nop 0
v_cndmask_b32 v3, v3, v19, vcc
v_mfma_f32_16x16x32_bf16 a[148:151], a[188:191], a[212:215], a[148:151]
v_xor_b32 v4, 64, v3
v_mfma_f32_16x16x32_bf16 a[152:155], a[188:191], a[216:219], a[152:155]
v_mfma_f32_16x16x32_bf16 a[156:159], a[188:191], a[220:223], a[156:159]
s_waitcnt vmcnt(23) lgkmcnt(0)
s_barrier
v_mfma_f32_16x16x32_bf16 v[160:163], a[160:163], a[224:227], v[160:163]
ds_read_b64_tr_b16 a[192:193], v5 offset:0
v_mfma_f32_16x16x32_bf16 v[164:167], a[160:163], a[228:231], v[164:167]
v_mfma_f32_16x16x32_bf16 v[168:171], a[160:163], a[232:235], v[168:171]
ds_read_b64_tr_b16 a[194:195], v5 offset:1024
v_mfma_f32_16x16x32_bf16 v[172:175], a[160:163], a[236:239], v[172:175]
s_add_u32 s37, s31, 0
v_mfma_f32_16x16x32_bf16 v[176:179], a[160:163], a[240:243], v[176:179]
s_add_u32 m0, s33, 0
ds_read_b64_tr_b16 a[196:197], v6 offset:0
v_mfma_f32_16x16x32_bf16 v[180:183], a[160:163], a[244:247], v[180:183]
buffer_load_dwordx4 v2, s[20:23], s37 offen  lds
v_mfma_f32_16x16x32_bf16 v[184:187], a[160:163], a[248:251], v[184:187]
ds_read_b64_tr_b16 a[198:199], v6 offset:1024
v_mfma_f32_16x16x32_bf16 v[188:191], a[160:163], a[252:255], v[188:191]
ds_read_b128 a[160:163], v3 offset:0
v_mfma_f32_16x16x32_bf16 v[192:195], a[164:167], a[224:227], v[192:195]
ds_read_b64_tr_b16 a[200:201], v7 offset:0
v_mfma_f32_16x16x32_bf16 v[196:199], a[164:167], a[228:231], v[196:199]
v_mfma_f32_16x16x32_bf16 v[200:203], a[164:167], a[232:235], v[200:203]
s_add_u32 s37, s31, 32768
ds_read_b64_tr_b16 a[202:203], v7 offset:1024
v_mfma_f32_16x16x32_bf16 v[204:207], a[164:167], a[236:239], v[204:207]
s_add_u32 m0, s33, 1024
v_mfma_f32_16x16x32_bf16 v[208:211], a[164:167], a[240:243], v[208:211]
buffer_load_dwordx4 v2, s[20:23], s37 offen  lds
v_mfma_f32_16x16x32_bf16 v[212:215], a[164:167], a[244:247], v[212:215]
ds_read_b64_tr_b16 a[204:205], v8 offset:0
v_mfma_f32_16x16x32_bf16 v[216:219], a[164:167], a[248:251], v[216:219]
v_mfma_f32_16x16x32_bf16 v[220:223], a[164:167], a[252:255], v[220:223]
ds_read_b128 a[164:167], v4 offset:1024
v_mfma_f32_16x16x32_bf16 v[224:227], a[168:171], a[224:227], v[224:227]
ds_read_b64_tr_b16 a[206:207], v8 offset:1024
v_mfma_f32_16x16x32_bf16 v[228:231], a[168:171], a[228:231], v[228:231]
s_add_u32 s37, s31, 131072
v_mfma_f32_16x16x32_bf16 v[232:235], a[168:171], a[232:235], v[232:235]
s_add_u32 m0, s33, 4096
ds_read_b64_tr_b16 a[208:209], v9 offset:0
v_mfma_f32_16x16x32_bf16 v[236:239], a[168:171], a[236:239], v[236:239]
buffer_load_dwordx4 v2, s[20:23], s37 offen  lds
v_mfma_f32_16x16x32_bf16 v[240:243], a[168:171], a[240:243], v[240:243]
ds_read_b64_tr_b16 a[210:211], v9 offset:1024
v_mfma_f32_16x16x32_bf16 v[244:247], a[168:171], a[244:247], v[244:247]
v_mfma_f32_16x16x32_bf16 v[248:251], a[168:171], a[248:251], v[248:251]
ds_read_b64_tr_b16 a[212:213], v10 offset:0
v_mfma_f32_16x16x32_bf16 v[252:255], a[168:171], a[252:255], v[252:255]
ds_read_b128 a[168:171], v3 offset:4096
v_mfma_f32_16x16x32_bf16 a[0:3], a[172:175], a[224:227], a[0:3]
s_add_u32 s37, s31, 163840
ds_read_b64_tr_b16 a[214:215], v10 offset:1024
v_mfma_f32_16x16x32_bf16 a[4:7], a[172:175], a[228:231], a[4:7]
s_add_u32 m0, s33, 5120
v_mfma_f32_16x16x32_bf16 a[8:11], a[172:175], a[232:235], a[8:11]
buffer_load_dwordx4 v2, s[20:23], s37 offen  lds
v_mfma_f32_16x16x32_bf16 a[12:15], a[172:175], a[236:239], a[12:15]
s_add_u32 s31, s31, 262144
ds_read_b64_tr_b16 a[216:217], v11 offset:0
v_mfma_f32_16x16x32_bf16 a[16:19], a[172:175], a[240:243], a[16:19]
s_add_u32 s33, s33, 16384
v_mfma_f32_16x16x32_bf16 a[20:23], a[172:175], a[244:247], a[20:23]
s_and_b32 s33, s33, 65535
ds_read_b64_tr_b16 a[218:219], v11 offset:1024
v_mfma_f32_16x16x32_bf16 a[24:27], a[172:175], a[248:251], a[24:27]
v_mfma_f32_16x16x32_bf16 a[28:31], a[172:175], a[252:255], a[28:31]
s_mov_b32 s48, s30
ds_read_b128 a[172:175], v4 offset:5120
v_mfma_f32_16x16x32_bf16 a[32:35], a[176:179], a[224:227], a[32:35]
s_add_u32 m0, s32, 0
ds_read_b64_tr_b16 a[220:221], v12 offset:0
v_mfma_f32_16x16x32_bf16 a[36:39], a[176:179], a[228:231], a[36:39]
buffer_load_dwordx4 v1, s[12:15], s48 offen lds
v_mfma_f32_16x16x32_bf16 a[40:43], a[176:179], a[232:235], a[40:43]
ds_read_b64_tr_b16 a[222:223], v12 offset:1024
v_mfma_f32_16x16x32_bf16 a[44:47], a[176:179], a[236:239], a[44:47]
v_mfma_f32_16x16x32_bf16 a[48:51], a[176:179], a[240:243], a[48:51]
ds_read_b128 a[188:191], v4 offset:13312
v_mfma_f32_16x16x32_bf16 a[52:55], a[176:179], a[244:247], a[52:55]
v_mfma_f32_16x16x32_bf16 a[56:59], a[176:179], a[248:251], a[56:59]
s_add_u32 s48, s48, s34
v_mfma_f32_16x16x32_bf16 a[60:63], a[176:179], a[252:255], a[60:63]
s_add_u32 m0, s32, 4096
ds_read_b128 a[176:179], v3 offset:8192
v_add_u32 v5, 16384, v5
v_mfma_f32_16x16x32_bf16 a[64:67], a[180:183], a[224:227], a[64:67]
buffer_load_dwordx4 v1, s[12:15], s48 offen lds
v_and_b32 v5, 65535, v5
v_mfma_f32_16x16x32_bf16 a[68:71], a[180:183], a[228:231], a[68:71]
v_xor_b32 v6, 16, v5
v_xor_b32 v7, 64, v5
v_mfma_f32_16x16x32_bf16 a[72:75], a[180:183], a[232:235], a[72:75]
v_xor_b32 v8, 80, v5
v_xor_b32 v9, 128, v5
v_mfma_f32_16x16x32_bf16 a[76:79], a[180:183], a[236:239], a[76:79]
v_xor_b32 v10, 144, v5
v_xor_b32 v11, 192, v5
v_mfma_f32_16x16x32_bf16 a[80:83], a[180:183], a[240:243], a[80:83]
v_xor_b32 v12, 208, v5
v_mfma_f32_16x16x32_bf16 a[84:87], a[180:183], a[244:247], a[84:87]
s_add_u32 s48, s48, s34
v_mfma_f32_16x16x32_bf16 a[88:91], a[180:183], a[248:251], a[88:91]
s_add_u32 m0, s32, 8192
v_mfma_f32_16x16x32_bf16 a[92:95], a[180:183], a[252:255], a[92:95]
buffer_load_dwordx4 v1, s[12:15], s48 offen lds
ds_read_b128 a[180:183], v4 offset:9216
v_mfma_f32_16x16x32_bf16 a[96:99], a[184:187], a[224:227], a[96:99]
v_mfma_f32_16x16x32_bf16 a[100:103], a[184:187], a[228:231], a[100:103]
v_mfma_f32_16x16x32_bf16 a[104:107], a[184:187], a[232:235], a[104:107]
v_mfma_f32_16x16x32_bf16 a[108:111], a[184:187], a[236:239], a[108:111]
v_mfma_f32_16x16x32_bf16 a[112:115], a[184:187], a[240:243], a[112:115]
s_add_u32 s48, s48, s34
v_mfma_f32_16x16x32_bf16 a[116:119], a[184:187], a[244:247], a[116:119]
s_add_u32 m0, s32, 12288
v_mfma_f32_16x16x32_bf16 a[120:123], a[184:187], a[248:251], a[120:123]
buffer_load_dwordx4 v1, s[12:15], s48 offen lds
v_mfma_f32_16x16x32_bf16 a[124:127], a[184:187], a[252:255], a[124:127]
ds_read_b128 a[184:187], v3 offset:12288
v_mfma_f32_16x16x32_bf16 a[128:131], v[28:31], a[224:227], a[128:131]
v_mfma_f32_16x16x32_bf16 a[132:135], v[28:31], a[228:231], a[132:135]
v_mfma_f32_16x16x32_bf16 a[136:139], v[28:31], a[232:235], a[136:139]
buffer_load_dword v15, v14, s[96:99], s100 offen
v_mfma_f32_16x16x32_bf16 a[140:143], v[28:31], a[236:239], a[140:143]
s_add_u32 s100, s100, 16384
v_mfma_f32_16x16x32_bf16 a[144:147], v[28:31], a[240:243], a[144:147]
v_mfma_f32_16x16x32_bf16 a[148:151], v[28:31], a[244:247], a[148:151]
v_mfma_f32_16x16x32_bf16 a[152:155], v[28:31], a[248:251], a[152:155]
v_mfma_f32_16x16x32_bf16 a[156:159], v[28:31], a[252:255], a[156:159]
s_waitcnt vmcnt(20) lgkmcnt(0)
s_barrier
v_mfma_f32_16x16x32_bf16 v[160:163], a[160:163], a[192:195], v[160:163]
ds_read_b64_tr_b16 a[224:225], v5 offset:0
v_mfma_f32_16x16x32_bf16 v[164:167], a[160:163], a[196:199], v[164:167]
v_mfma_f32_16x16x32_bf16 v[168:171], a[160:163], a[200:203], v[168:171]
ds_read_b64_tr_b16 a[226:227], v5 offset:1024
v_mfma_f32_16x16x32_bf16 v[172:175], a[160:163], a[204:207], v[172:175]
s_add_u32 s37, s31, 0
v_mfma_f32_16x16x32_bf16 v[176:179], a[160:163], a[208:211], v[176:179]
s_add_u32 m0, s33, 0
ds_read_b64_tr_b16 a[228:229], v6 offset:0
v_mfma_f32_16x16x32_bf16 v[180:183], a[160:163], a[212:215], v[180:183]
buffer_load_dwordx4 v2, s[20:23], s37 offen  lds
v_mfma_f32_16x16x32_bf16 v[184:187], a[160:163], a[216:219], v[184:187]
ds_read_b64_tr_b16 a[230:231], v6 offset:1024
v_mfma_f32_16x16x32_bf16 v[188:191], a[160:163], a[220:223], v[188:191]
ds_read_b128 a[160:163], v4 offset:0
v_mfma_f32_16x16x32_bf16 v[192:195], a[164:167], a[192:195], v[192:195]
ds_read_b64_tr_b16 a[232:233], v7 offset:0
v_mfma_f32_16x16x32_bf16 v[196:199], a[164:167], a[196:199], v[196:199]
v_mfma_f32_16x16x32_bf16 v[200:203], a[164:167], a[200:203], v[200:203]
s_add_u32 s37, s31, 32768
ds_read_b64_tr_b16 a[234:235], v7 offset:1024
v_mfma_f32_16x16x32_bf16 v[204:207], a[164:167], a[204:207], v[204:207]
s_add_u32 m0, s33, 1024
v_mfma_f32_16x16x32_bf16 v[208:211], a[164:167], a[208:211], v[208:211]
buffer_load_dwordx4 v2, s[20:23], s37 offen  lds
v_mfma_f32_16x16x32_bf16 v[212:215], a[164:167], a[212:215], v[212:215]
ds_read_b64_tr_b16 a[236:237], v8 offset:0
v_mfma_f32_16x16x32_bf16 v[216:219], a[164:167], a[216:219], v[216:219]
v_mfma_f32_16x16x32_bf16 v[220:223], a[164:167], a[220:223], v[220:223]
ds_read_b128 a[164:167], v3 offset:1024
v_mfma_f32_16x16x32_bf16 v[224:227], a[168:171], a[192:195], v[224:227]
ds_read_b64_tr_b16 a[238:239], v8 offset:1024
v_mfma_f32_16x16x32_bf16 v[228:231], a[168:171], a[196:199], v[228:231]
s_add_u32 s37, s31, 131072
v_mfma_f32_16x16x32_bf16 v[232:235], a[168:171], a[200:203], v[232:235]
s_add_u32 m0, s33, 4096
ds_read_b64_tr_b16 a[240:241], v9 offset:0
v_mfma_f32_16x16x32_bf16 v[236:239], a[168:171], a[204:207], v[236:239]
buffer_load_dwordx4 v2, s[20:23], s37 offen  lds
v_mfma_f32_16x16x32_bf16 v[240:243], a[168:171], a[208:211], v[240:243]
ds_read_b64_tr_b16 a[242:243], v9 offset:1024
v_mfma_f32_16x16x32_bf16 v[244:247], a[168:171], a[212:215], v[244:247]
v_mfma_f32_16x16x32_bf16 v[248:251], a[168:171], a[216:219], v[248:251]
ds_read_b64_tr_b16 a[244:245], v10 offset:0
v_mfma_f32_16x16x32_bf16 v[252:255], a[168:171], a[220:223], v[252:255]
ds_read_b128 a[168:171], v4 offset:4096
v_mfma_f32_16x16x32_bf16 a[0:3], a[172:175], a[192:195], a[0:3]
s_add_u32 s37, s31, 163840
ds_read_b64_tr_b16 a[246:247], v10 offset:1024
v_mfma_f32_16x16x32_bf16 a[4:7], a[172:175], a[196:199], a[4:7]
s_add_u32 m0, s33, 5120
v_mfma_f32_16x16x32_bf16 a[8:11], a[172:175], a[200:203], a[8:11]
buffer_load_dwordx4 v2, s[20:23], s37 offen  lds
v_mfma_f32_16x16x32_bf16 a[12:15], a[172:175], a[204:207], a[12:15]
s_add_u32 s31, s31, 262144
ds_read_b64_tr_b16 a[248:249], v11 offset:0
v_mfma_f32_16x16x32_bf16 a[16:19], a[172:175], a[208:211], a[16:19]
s_add_u32 s33, s33, 16384
v_mfma_f32_16x16x32_bf16 a[20:23], a[172:175], a[212:215], a[20:23]
s_and_b32 s33, s33, 65535
ds_read_b64_tr_b16 a[250:251], v11 offset:1024
v_mfma_f32_16x16x32_bf16 a[24:27], a[172:175], a[216:219], a[24:27]
v_mfma_f32_16x16x32_bf16 a[28:31], a[172:175], a[220:223], a[28:31]
s_add_u32 s48, s48, s34
ds_read_b128 a[172:175], v3 offset:5120
v_mfma_f32_16x16x32_bf16 a[32:35], a[176:179], a[192:195], a[32:35]
s_add_u32 m0, s32, 16384
ds_read_b64_tr_b16 a[252:253], v12 offset:0
v_mfma_f32_16x16x32_bf16 a[36:39], a[176:179], a[196:199], a[36:39]
buffer_load_dwordx4 v1, s[12:15], s48 offen lds
v_mfma_f32_16x16x32_bf16 a[40:43], a[176:179], a[200:203], a[40:43]
ds_read_b64_tr_b16 a[254:255], v12 offset:1024
v_mfma_f32_16x16x32_bf16 a[44:47], a[176:179], a[204:207], a[44:47]
v_mfma_f32_16x16x32_bf16 a[48:51], a[176:179], a[208:211], a[48:51]
ds_read_b128 v[28:31], v3 offset:13312
v_mfma_f32_16x16x32_bf16 a[52:55], a[176:179], a[212:215], a[52:55]
v_mfma_f32_16x16x32_bf16 a[56:59], a[176:179], a[216:219], a[56:59]
s_add_u32 s48, s48, s34
v_mfma_f32_16x16x32_bf16 a[60:63], a[176:179], a[220:223], a[60:63]
s_add_u32 m0, s32, 20480
ds_read_b128 a[176:179], v4 offset:8192
v_add_u32 v5, 16384, v5
v_mfma_f32_16x16x32_bf16 a[64:67], a[180:183], a[192:195], a[64:67]
buffer_load_dwordx4 v1, s[12:15], s48 offen lds
v_and_b32 v5, 65535, v5
v_mfma_f32_16x16x32_bf16 a[68:71], a[180:183], a[196:199], a[68:71]
v_xor_b32 v6, 16, v5
v_xor_b32 v7, 64, v5
v_mfma_f32_16x16x32_bf16 a[72:75], a[180:183], a[200:203], a[72:75]
v_xor_b32 v8, 80, v5
v_xor_b32 v9, 128, v5
v_mfma_f32_16x16x32_bf16 a[76:79], a[180:183], a[204:207], a[76:79]
v_xor_b32 v10, 144, v5
v_xor_b32 v11, 192, v5
v_mfma_f32_16x16x32_bf16 a[80:83], a[180:183], a[208:211], a[80:83]
v_xor_b32 v12, 208, v5
v_mfma_f32_16x16x32_bf16 a[84:87], a[180:183], a[212:215], a[84:87]
s_add_u32 s48, s48, s34
v_mfma_f32_16x16x32_bf16 a[88:91], a[180:183], a[216:219], a[88:91]
s_add_u32 m0, s32, 24576
v_mfma_f32_16x16x32_bf16 a[92:95], a[180:183], a[220:223], a[92:95]
buffer_load_dwordx4 v1, s[12:15], s48 offen lds
ds_read_b128 a[180:183], v3 offset:9216
v_mfma_f32_16x16x32_bf16 a[96:99], a[184:187], a[192:195], a[96:99]
v_mfma_f32_16x16x32_bf16 a[100:103], a[184:187], a[196:199], a[100:103]
v_mfma_f32_16x16x32_bf16 a[104:107], a[184:187], a[200:203], a[104:107]
v_mfma_f32_16x16x32_bf16 a[108:111], a[184:187], a[204:207], a[108:111]
v_mfma_f32_16x16x32_bf16 a[112:115], a[184:187], a[208:211], a[112:115]
s_add_u32 s48, s48, s34
v_mfma_f32_16x16x32_bf16 a[116:119], a[184:187], a[212:215], a[116:119]
s_add_u32 m0, s32, 28672
v_mfma_f32_16x16x32_bf16 a[120:123], a[184:187], a[216:219], a[120:123]
buffer_load_dwordx4 v1, s[12:15], s48 offen lds
v_mfma_f32_16x16x32_bf16 a[124:127], a[184:187], a[220:223], a[124:127]
s_add_u32 s30, s30, 128
ds_read_b128 a[184:187], v4 offset:12288
v_mfma_f32_16x16x32_bf16 a[128:131], a[188:191], a[192:195], a[128:131]
s_add_u32 s32, s32, 32768
v_add_u32 v3, 32768, v3
v_mfma_f32_16x16x32_bf16 a[132:135], a[188:191], a[196:199], a[132:135]
s_sub_u32 s48, s32, 98304
v_subrev_u32 v19, 98304, v3
v_mfma_f32_16x16x32_bf16 a[136:139], a[188:191], a[200:203], a[136:139]
s_cmp_ge_u32 s32, 163840
s_cselect_b32 s32, s48, s32
buffer_load_dword v15, v14, s[96:99], s100 offen
v_mfma_f32_16x16x32_bf16 a[140:143], a[188:191], a[204:207], a[140:143]
s_add_u32 s100, s100, 16384
v_cmp_le_u32 vcc, 163840, v3
v_mfma_f32_16x16x32_bf16 a[144:147], a[188:191], a[208:211], a[144:147]
s_nop 0
v_cndmask_b32 v3, v3, v19, vcc
v_mfma_f32_16x16x32_bf16 a[148:151], a[188:191], a[212:215], a[148:151]
v_xor_b32 v4, 64, v3
v_mfma_f32_16x16x32_bf16 a[152:155], a[188:191], a[216:219], a[152:155]
v_mfma_f32_16x16x32_bf16 a[156:159], a[188:191], a[220:223], a[156:159]
s_cmp_eq_u32 s41, 0
s_cbranch_scc0 L_g_v17v
s_waitcnt vmcnt(18) lgkmcnt(0)
s_barrier
v_mfma_f32_16x16x32_bf16 v[160:163], a[160:163], a[224:227], v[160:163]
ds_read_b128 a[192:195], v3 offset:0
v_mfma_f32_16x16x32_bf16 v[164:167], a[160:163], a[228:231], v[164:167]
v_mfma_f32_16x16x32_bf16 v[168:171], a[160:163], a[232:235], v[168:171]
ds_read_b128 a[196:199], v4 offset:1024
v_mfma_f32_16x16x32_bf16 v[172:175], a[160:163], a[236:239], v[172:175]
s_add_u32 s37, s31, 0
v_mfma_f32_16x16x32_bf16 v[176:179], a[160:163], a[240:243], v[176:179]
s_add_u32 m0, s33, 0
ds_read_b128 a[200:203], v3 offset:4096
v_cvt_pk_bf16_f32 v32, v160, v161
v_cvt_pk_bf16_f32 v33, v162, v163
v_mfma_f32_16x16x32_bf16 v[180:183], a[160:163], a[244:247], v[180:183]
buffer_load_dwordx4 v2, s[20:23], s37 offen  lds
v_cvt_pk_bf16_f32 v36, v164, v165
v_cvt_pk_bf16_f32 v37, v166, v167
v_mfma_f32_16x16x32_bf16 v[184:187], a[160:163], a[248:251], v[184:187]
ds_read_b128 a[204:207], v4 offset:5120
v_cvt_pk_bf16_f32 v40, v168, v169
v_cvt_pk_bf16_f32 v41, v170, v171
v_mfma_f32_16x16x32_bf16 v[188:191], a[160:163], a[252:255], v[188:191]
ds_read_b64_tr_b16 a[160:161], v5 offset:0
v_cvt_pk_bf16_f32 v44, v172, v173
v_cvt_pk_bf16_f32 v45, v174, v175
v_mfma_f32_16x16x32_bf16 v[192:195], a[164:167], a[224:227], v[192:195]
ds_read_b64_tr_b16 a[162:163], v5 offset:1024
v_cvt_pk_bf16_f32 v48, v176, v177
v_cvt_pk_bf16_f32 v49, v178, v179
v_mfma_f32_16x16x32_bf16 v[196:199], a[164:167], a[228:231], v[196:199]
ds_read_b128 a[208:211], v3 offset:8192
v_add_u32 v5, 16384, v5
v_cvt_pk_bf16_f32 v52, v180, v181
v_cvt_pk_bf16_f32 v53, v182, v183
v_mfma_f32_16x16x32_bf16 v[200:203], a[164:167], a[232:235], v[200:203]
s_add_u32 s37, s31, 32768
v_and_b32 v5, 65535, v5
v_cvt_pk_bf16_f32 v56, v184, v185
v_cvt_pk_bf16_f32 v57, v186, v187
v_mfma_f32_16x16x32_bf16 v[204:207], a[164:167], a[236:239], v[204:207]
s_add_u32 m0, s33, 1024
ds_read_b128 a[212:215], v4 offset:9216
v_cvt_pk_bf16_f32 v60, v188, v189
v_cvt_pk_bf16_f32 v61, v190, v191
v_mfma_f32_16x16x32_bf16 v[208:211], a[164:167], a[240:243], v[208:211]
buffer_load_dwordx4 v2, s[20:23], s37 offen  lds
v_cvt_pk_bf16_f32 v34, v192, v193
v_cvt_pk_bf16_f32 v35, v194, v195
v_mfma_f32_16x16x32_bf16 v[212:215], a[164:167], a[244:247], v[212:215]
ds_read_b128 a[216:219], v3 offset:12288
v_cvt_pk_bf16_f32 v38, v196, v197
v_cvt_pk_bf16_f32 v39, v198, v199
v_mfma_f32_16x16x32_bf16 v[216:219], a[164:167], a[248:251], v[216:219]
v_cvt_pk_bf16_f32 v42, v200, v201
v_cvt_pk_bf16_f32 v43, v202, v203
v_mfma_f32_16x16x32_bf16 v[220:223], a[164:167], a[252:255], v[220:223]
ds_read_b64_tr_b16 a[164:165], v6 offset:0
v_cvt_pk_bf16_f32 v46, v204, v205
v_cvt_pk_bf16_f32 v47, v206, v207
v_mfma_f32_16x16x32_bf16 v[224:227], a[168:171], a[224:227], v[224:227]
ds_read_b64_tr_b16 a[166:167], v6 offset:1024
v_cvt_pk_bf16_f32 v50, v208, v209
v_cvt_pk_bf16_f32 v51, v210, v211
v_mfma_f32_16x16x32_bf16 v[228:231], a[168:171], a[228:231], v[228:231]
s_add_u32 s37, s31, 131072
ds_read_b128 a[220:223], v4 offset:13312
v_xor_b32 v6, 16, v5
v_cvt_pk_bf16_f32 v54, v212, v213
v_cvt_pk_bf16_f32 v55, v214, v215
v_mfma_f32_16x16x32_bf16 v[232:235], a[168:171], a[232:235], v[232:235]
s_add_u32 m0, s33, 4096
v_cvt_pk_bf16_f32 v58, v216, v217
v_cvt_pk_bf16_f32 v59, v218, v219
v_mfma_f32_16x16x32_bf16 v[236:239], a[168:171], a[236:239], v[236:239]
buffer_load_dwordx4 v2, s[20:23], s37 offen  lds
v_cvt_pk_bf16_f32 v62, v220, v221
v_cvt_pk_bf16_f32 v63, v222, v223
v_mfma_f32_16x16x32_bf16 v[240:243], a[168:171], a[240:243], v[240:243]
ds_read_b64_tr_b16 a[188:189], v12 offset:0
v_cvt_pk_bf16_f32 v64, v224, v225
v_cvt_pk_bf16_f32 v65, v226, v227
v_mfma_f32_16x16x32_bf16 v[244:247], a[168:171], a[244:247], v[244:247]
v_cvt_pk_bf16_f32 v68, v228, v229
v_cvt_pk_bf16_f32 v69, v230, v231
v_mfma_f32_16x16x32_bf16 v[248:251], a[168:171], a[248:251], v[248:251]
ds_read_b64_tr_b16 a[190:191], v12 offset:1024
v_cvt_pk_bf16_f32 v72, v232, v233
v_cvt_pk_bf16_f32 v73, v234, v235
v_mfma_f32_16x16x32_bf16 v[252:255], a[168:171], a[252:255], v[252:255]
ds_read_b64_tr_b16 a[168:169], v7 offset:0
v_cvt_pk_bf16_f32 v76, v236, v237
v_cvt_pk_bf16_f32 v77, v238, v239
v_mfma_f32_16x16x32_bf16 a[0:3], a[172:175], a[224:227], a[0:3]
s_add_u32 s37, s31, 163840
ds_read_b64_tr_b16 a[170:171], v7 offset:1024
v_cvt_pk_bf16_f32 v80, v240, v241
v_cvt_pk_bf16_f32 v81, v242, v243
v_mfma_f32_16x16x32_bf16 a[4:7], a[172:175], a[228:231], a[4:7]
s_add_u32 m0, s33, 5120
v_xor_b32 v7, 64, v5
v_xor_b32 v12, 208, v5
v_cvt_pk_bf16_f32 v84, v244, v245
v_cvt_pk_bf16_f32 v85, v246, v247
v_mfma_f32_16x16x32_bf16 a[8:11], a[172:175], a[232:235], a[8:11]
buffer_load_dwordx4 v2, s[20:23], s37 offen  lds
v_cvt_pk_bf16_f32 v88, v248, v249
v_cvt_pk_bf16_f32 v89, v250, v251
v_mfma_f32_16x16x32_bf16 a[12:15], a[172:175], a[236:239], a[12:15]
s_add_u32 s31, s31, 262144
v_cvt_pk_bf16_f32 v92, v252, v253
v_cvt_pk_bf16_f32 v93, v254, v255
v_mfma_f32_16x16x32_bf16 a[16:19], a[172:175], a[240:243], a[16:19]
s_add_u32 s33, s33, 16384
v_accvgpr_read_b32 v20, a0
v_accvgpr_read_b32 v21, a1
v_accvgpr_read_b32 v22, a2
v_accvgpr_read_b32 v23, a3
v_mfma_f32_16x16x32_bf16 a[20:23], a[172:175], a[244:247], a[20:23]
s_and_b32 s33, s33, 65535
v_cvt_pk_bf16_f32 v66, v20, v21
v_cvt_pk_bf16_f32 v67, v22, v23
v_accvgpr_read_b32 v24, a4
v_accvgpr_read_b32 v25, a5
v_mfma_f32_16x16x32_bf16 a[24:27], a[172:175], a[248:251], a[24:27]
v_accvgpr_read_b32 v26, a6
v_accvgpr_read_b32 v27, a7
v_cvt_pk_bf16_f32 v70, v24, v25
v_cvt_pk_bf16_f32 v71, v26, v27
v_mfma_f32_16x16x32_bf16 a[28:31], a[172:175], a[252:255], a[28:31]
s_mov_b32 s48, s30
ds_read_b64_tr_b16 a[172:173], v8 offset:0
v_accvgpr_read_b32 v20, a8
v_accvgpr_read_b32 v21, a9
v_accvgpr_read_b32 v22, a10
v_mfma_f32_16x16x32_bf16 a[32:35], a[176:179], a[224:227], a[32:35]
s_add_u32 m0, s32, 0
ds_read_b64_tr_b16 a[174:175], v8 offset:1024
v_mov_b32 v16, 0
v_accvgpr_read_b32 v23, a11
v_cvt_pk_bf16_f32 v74, v20, v21
v_mfma_f32_16x16x32_bf16 a[36:39], a[176:179], a[228:231], a[36:39]
buffer_load_dwordx4 v1, s[12:15], s48 offen lds
v_mov_b32 v17, 1
v_cvt_pk_bf16_f32 v75, v22, v23
v_accvgpr_read_b32 v24, a12
v_mfma_f32_16x16x32_bf16 a[40:43], a[176:179], a[232:235], a[40:43]
s_cmp_eq_u32 s17, 0
s_cselect_b32 s29, s39, 536870912
v_accvgpr_read_b32 v25, a13
v_accvgpr_read_b32 v26, a14
v_mfma_f32_16x16x32_bf16 a[44:47], a[176:179], a[236:239], a[44:47]
s_mov_b64 exec, 1
buffer_store_dword v17, v16, s[8:11], s29 offen sc1
s_mov_b64 exec, -1
v_accvgpr_read_b32 v27, a15
v_mfma_f32_16x16x32_bf16 a[48:51], a[176:179], a[240:243], a[48:51]
v_xor_b32 v8, 80, v5
v_cvt_pk_bf16_f32 v78, v24, v25
v_cvt_pk_bf16_f32 v79, v26, v27
v_accvgpr_read_b32 v20, a16
v_mfma_f32_16x16x32_bf16 a[52:55], a[176:179], a[244:247], a[52:55]
v_accvgpr_read_b32 v21, a17
v_accvgpr_read_b32 v22, a18
v_accvgpr_read_b32 v23, a19
v_cvt_pk_bf16_f32 v82, v20, v21
v_mfma_f32_16x16x32_bf16 a[56:59], a[176:179], a[248:251], a[56:59]
s_add_u32 s48, s48, s34
v_cvt_pk_bf16_f32 v83, v22, v23
v_accvgpr_read_b32 v24, a20
v_accvgpr_read_b32 v25, a21
v_accvgpr_read_b32 v26, a22
v_mfma_f32_16x16x32_bf16 a[60:63], a[176:179], a[252:255], a[60:63]
s_add_u32 m0, s32, 4096
ds_read_b64_tr_b16 a[176:177], v9 offset:0
v_accvgpr_read_b32 v27, a23
v_cvt_pk_bf16_f32 v86, v24, v25
v_cvt_pk_bf16_f32 v87, v26, v27
v_mfma_f32_16x16x32_bf16 a[64:67], a[180:183], a[224:227], a[64:67]
buffer_load_dwordx4 v1, s[12:15], s48 offen lds
ds_read_b64_tr_b16 a[178:179], v9 offset:1024
v_accvgpr_read_b32 v20, a24
v_accvgpr_read_b32 v21, a25
v_mfma_f32_16x16x32_bf16 a[68:71], a[180:183], a[228:231], a[68:71]
v_xor_b32 v9, 128, v5
v_accvgpr_read_b32 v22, a26
v_accvgpr_read_b32 v23, a27
v_cvt_pk_bf16_f32 v90, v20, v21
v_mfma_f32_16x16x32_bf16 a[72:75], a[180:183], a[232:235], a[72:75]
v_cvt_pk_bf16_f32 v91, v22, v23
v_accvgpr_read_b32 v24, a28
v_accvgpr_read_b32 v25, a29
v_accvgpr_read_b32 v26, a30
v_mfma_f32_16x16x32_bf16 a[76:79], a[180:183], a[236:239], a[76:79]
v_accvgpr_read_b32 v27, a31
v_cvt_pk_bf16_f32 v94, v24, v25
v_cvt_pk_bf16_f32 v95, v26, v27
v_accvgpr_read_b32 v20, a32
v_mfma_f32_16x16x32_bf16 a[80:83], a[180:183], a[240:243], a[80:83]
v_accvgpr_read_b32 v21, a33
v_accvgpr_read_b32 v22, a34
v_accvgpr_read_b32 v23, a35
v_cvt_pk_bf16_f32 v96, v20, v21
v_mfma_f32_16x16x32_bf16 a[84:87], a[180:183], a[244:247], a[84:87]
s_add_u32 s48, s48, s34
v_cvt_pk_bf16_f32 v97, v22, v23
v_accvgpr_read_b32 v24, a36
v_accvgpr_read_b32 v25, a37
v_accvgpr_read_b32 v26, a38
v_mfma_f32_16x16x32_bf16 a[88:91], a[180:183], a[248:251], a[88:91]
s_add_u32 m0, s32, 8192
v_accvgpr_read_b32 v27, a39
v_cvt_pk_bf16_f32 v100, v24, v25
v_cvt_pk_bf16_f32 v101, v26, v27
v_accvgpr_read_b32 v20, a40
v_mfma_f32_16x16x32_bf16 a[92:95], a[180:183], a[252:255], a[92:95]
buffer_load_dwordx4 v1, s[12:15], s48 offen lds
ds_read_b64_tr_b16 a[180:181], v10 offset:0
v_accvgpr_read_b32 v21, a41
v_accvgpr_read_b32 v22, a42
v_mfma_f32_16x16x32_bf16 a[96:99], a[184:187], a[224:227], a[96:99]
ds_read_b64_tr_b16 a[182:183], v10 offset:1024
v_accvgpr_read_b32 v23, a43
v_cvt_pk_bf16_f32 v104, v20, v21
v_cvt_pk_bf16_f32 v105, v22, v23
v_mfma_f32_16x16x32_bf16 a[100:103], a[184:187], a[228:231], a[100:103]
v_xor_b32 v10, 144, v5
v_accvgpr_read_b32 v24, a44
v_accvgpr_read_b32 v25, a45
v_accvgpr_read_b32 v26, a46
v_mfma_f32_16x16x32_bf16 a[104:107], a[184:187], a[232:235], a[104:107]
v_accvgpr_read_b32 v27, a47
v_cvt_pk_bf16_f32 v108, v24, v25
v_cvt_pk_bf16_f32 v109, v26, v27
v_accvgpr_read_b32 v20, a48
v_mfma_f32_16x16x32_bf16 a[108:111], a[184:187], a[236:239], a[108:111]
v_accvgpr_read_b32 v21, a49
v_accvgpr_read_b32 v22, a50
v_accvgpr_read_b32 v23, a51
v_cvt_pk_bf16_f32 v112, v20, v21
v_mfma_f32_16x16x32_bf16 a[112:115], a[184:187], a[240:243], a[112:115]
s_add_u32 s48, s48, s34
v_cvt_pk_bf16_f32 v113, v22, v23
v_accvgpr_read_b32 v24, a52
v_accvgpr_read_b32 v25, a53
v_accvgpr_read_b32 v26, a54
v_mfma_f32_16x16x32_bf16 a[116:119], a[184:187], a[244:247], a[116:119]
s_add_u32 m0, s32, 12288
v_accvgpr_read_b32 v27, a55
v_cvt_pk_bf16_f32 v116, v24, v25
v_cvt_pk_bf16_f32 v117, v26, v27
v_accvgpr_read_b32 v20, a56
v_mfma_f32_16x16x32_bf16 a[120:123], a[184:187], a[248:251], a[120:123]
buffer_load_dwordx4 v1, s[12:15], s48 offen lds
v_accvgpr_read_b32 v21, a57
v_accvgpr_read_b32 v22, a58
v_accvgpr_read_b32 v23, a59
v_mfma_f32_16x16x32_bf16 a[124:127], a[184:187], a[252:255], a[124:127]
ds_read_b64_tr_b16 a[184:185], v11 offset:0
v_cvt_pk_bf16_f32 v120, v20, v21
v_cvt_pk_bf16_f32 v121, v22, v23
v_accvgpr_read_b32 v24, a60
v_mfma_f32_16x16x32_bf16 a[128:131], v[28:31], a[224:227], a[128:131]
ds_read_b64_tr_b16 a[186:187], v11 offset:1024
v_accvgpr_read_b32 v25, a61
v_accvgpr_read_b32 v26, a62
v_accvgpr_read_b32 v27, a63
v_mfma_f32_16x16x32_bf16 a[132:135], v[28:31], a[228:231], a[132:135]
v_xor_b32 v11, 192, v5
v_cvt_pk_bf16_f32 v124, v24, v25
v_cvt_pk_bf16_f32 v125, v26, v27
v_mfma_f32_16x16x32_bf16 a[136:139], v[28:31], a[232:235], a[136:139]
buffer_load_dword v15, v14, s[96:99], s100 offen
v_mfma_f32_16x16x32_bf16 a[140:143], v[28:31], a[236:239], a[140:143]
s_add_u32 s100, s100, 16384
v_mfma_f32_16x16x32_bf16 a[144:147], v[28:31], a[240:243], a[144:147]
v_mfma_f32_16x16x32_bf16 a[148:151], v[28:31], a[244:247], a[148:151]
v_mfma_f32_16x16x32_bf16 a[152:155], v[28:31], a[248:251], a[152:155]
v_mfma_f32_16x16x32_bf16 a[156:159], v[28:31], a[252:255], a[156:159]
s_cmp_lt_u32 s35, s45
s_cbranch_scc1 L_g_tile
s_branch L_g_end
L_g_v17v:
s_waitcnt vmcnt(18) lgkmcnt(0)
s_barrier
v_mfma_f32_16x16x32_bf16 v[160:163], a[160:163], a[224:227], v[160:163]
ds_read_b64_tr_b16 a[192:193], v5 offset:0
v_mfma_f32_16x16x32_bf16 v[164:167], a[160:163], a[228:231], v[164:167]
v_mfma_f32_16x16x32_bf16 v[168:171], a[160:163], a[232:235], v[168:171]
ds_read_b64_tr_b16 a[194:195], v5 offset:1024
v_mfma_f32_16x16x32_bf16 v[172:175], a[160:163], a[236:239], v[172:175]
s_add_u32 s37, s31, 0
v_mfma_f32_16x16x32_bf16 v[176:179], a[160:163], a[240:243], v[176:179]
s_add_u32 m0, s33, 0
ds_read_b64_tr_b16 a[196:197], v6 offset:0
v_cvt_pk_bf16_f32 v32, v160, v161
v_cvt_pk_bf16_f32 v33, v162, v163
v_mfma_f32_16x16x32_bf16 v[180:183], a[160:163], a[244:247], v[180:183]
buffer_load_dwordx4 v2, s[20:23], s37 offen  lds
v_cvt_pk_bf16_f32 v36, v164, v165
v_cvt_pk_bf16_f32 v37, v166, v167
v_mfma_f32_16x16x32_bf16 v[184:187], a[160:163], a[248:251], v[184:187]
ds_read_b64_tr_b16 a[198:199], v6 offset:1024
v_cvt_pk_bf16_f32 v40, v168, v169
v_cvt_pk_bf16_f32 v41, v170, v171
v_mfma_f32_16x16x32_bf16 v[188:191], a[160:163], a[252:255], v[188:191]
ds_read_b128 a[160:163], v3 offset:0
v_cvt_pk_bf16_f32 v44, v172, v173
v_cvt_pk_bf16_f32 v45, v174, v175
v_mfma_f32_16x16x32_bf16 v[192:195], a[164:167], a[224:227], v[192:195]
ds_read_b64_tr_b16 a[200:201], v7 offset:0
v_cvt_pk_bf16_f32 v48, v176, v177
v_cvt_pk_bf16_f32 v49, v178, v179
v_mfma_f32_16x16x32_bf16 v[196:199], a[164:167], a[228:231], v[196:199]
v_cvt_pk_bf16_f32 v52, v180, v181
v_cvt_pk_bf16_f32 v53, v182, v183
v_mfma_f32_16x16x32_bf16 v[200:203], a[164:167], a[232:235], v[200:203]
s_add_u32 s37, s31, 32768
ds_read_b64_tr_b16 a[202:203], v7 offset:1024
v_cvt_pk_bf16_f32 v56, v184, v185
v_cvt_pk_bf16_f32 v57, v186, v187
v_mfma_f32_16x16x32_bf16 v[204:207], a[164:167], a[236:239], v[204:207]
s_add_u32 m0, s33, 1024
v_cvt_pk_bf16_f32 v60, v188, v189
v_cvt_pk_bf16_f32 v61, v190, v191
v_mfma_f32_16x16x32_bf16 v[208:211], a[164:167], a[240:243], v[208:211]
buffer_load_dwordx4 v2, s[20:23], s37 offen  lds
v_cvt_pk_bf16_f32 v34, v192, v193
v_cvt_pk_bf16_f32 v35, v194, v195
v_mfma_f32_16x16x32_bf16 v[212:215], a[164:167], a[244:247], v[212:215]
ds_read_b64_tr_b16 a[204:205], v8 offset:0
v_cvt_pk_bf16_f32 v38, v196, v197
v_cvt_pk_bf16_f32 v39, v198, v199
v_mfma_f32_16x16x32_bf16 v[216:219], a[164:167], a[248:251], v[216:219]
v_cvt_pk_bf16_f32 v42, v200, v201
v_cvt_pk_bf16_f32 v43, v202, v203
v_mfma_f32_16x16x32_bf16 v[220:223], a[164:167], a[252:255], v[220:223]
ds_read_b128 a[164:167], v4 offset:1024
v_cvt_pk_bf16_f32 v46, v204, v205
v_cvt_pk_bf16_f32 v47, v206, v207
v_mfma_f32_16x16x32_bf16 v[224:227], a[168:171], a[224:227], v[224:227]
ds_read_b64_tr_b16 a[206:207], v8 offset:1024
v_cvt_pk_bf16_f32 v50, v208, v209
v_cvt_pk_bf16_f32 v51, v210, v211
v_mfma_f32_16x16x32_bf16 v[228:231], a[168:171], a[228:231], v[228:231]
s_add_u32 s37, s31, 131072
v_cvt_pk_bf16_f32 v54, v212, v213
v_cvt_pk_bf16_f32 v55, v214, v215
v_mfma_f32_16x16x32_bf16 v[232:235], a[168:171], a[232:235], v[232:235]
s_add_u32 m0, s33, 4096
ds_read_b64_tr_b16 a[208:209], v9 offset:0
v_cvt_pk_bf16_f32 v58, v216, v217
v_cvt_pk_bf16_f32 v59, v218, v219
v_mfma_f32_16x16x32_bf16 v[236:239], a[168:171], a[236:239], v[236:239]
buffer_load_dwordx4 v2, s[20:23], s37 offen  lds
v_cvt_pk_bf16_f32 v62, v220, v221
v_cvt_pk_bf16_f32 v63, v222, v223
v_mfma_f32_16x16x32_bf16 v[240:243], a[168:171], a[240:243], v[240:243]
ds_read_b64_tr_b16 a[210:211], v9 offset:1024
v_cvt_pk_bf16_f32 v64, v224, v225
v_cvt_pk_bf16_f32 v65, v226, v227
v_mfma_f32_16x16x32_bf16 v[244:247], a[168:171], a[244:247], v[244:247]
v_cvt_pk_bf16_f32 v68, v228, v229
v_cvt_pk_bf16_f32 v69, v230, v231
v_mfma_f32_16x16x32_bf16 v[248:251], a[168:171], a[248:251], v[248:251]
ds_read_b64_tr_b16 a[212:213], v10 offset:0
v_cvt_pk_bf16_f32 v72, v232, v233
v_cvt_pk_bf16_f32 v73, v234, v235
v_mfma_f32_16x16x32_bf16 v[252:255], a[168:171], a[252:255], v[252:255]
ds_read_b128 a[168:171], v3 offset:4096
v_cvt_pk_bf16_f32 v76, v236, v237
v_cvt_pk_bf16_f32 v77, v238, v239
v_mfma_f32_16x16x32_bf16 a[0:3], a[172:175], a[224:227], a[0:3]
s_add_u32 s37, s31, 163840
ds_read_b64_tr_b16 a[214:215], v10 offset:1024
v_cvt_pk_bf16_f32 v80, v240, v241
v_cvt_pk_bf16_f32 v81, v242, v243
v_mfma_f32_16x16x32_bf16 a[4:7], a[172:175], a[228:231], a[4:7]
s_add_u32 m0, s33, 5120
v_cvt_pk_bf16_f32 v84, v244, v245
v_cvt_pk_bf16_f32 v85, v246, v247
v_mfma_f32_16x16x32_bf16 a[8:11], a[172:175], a[232:235], a[8:11]
buffer_load_dwordx4 v2, s[20:23], s37 offen  lds
v_cvt_pk_bf16_f32 v88, v248, v249
v_cvt_pk_bf16_f32 v89, v250, v251
v_mfma_f32_16x16x32_bf16 a[12:15], a[172:175], a[236:239], a[12:15]
s_add_u32 s31, s31, 262144
ds_read_b64_tr_b16 a[216:217], v11 offset:0
v_cvt_pk_bf16_f32 v92, v252, v253
v_cvt_pk_bf16_f32 v93, v254, v255
v_mfma_f32_16x16x32_bf16 a[16:19], a[172:175], a[240:243], a[16:19]
s_add_u32 s33, s33, 16384
v_accvgpr_read_b32 v20, a0
v_accvgpr_read_b32 v21, a1
v_accvgpr_read_b32 v22, a2
v_accvgpr_read_b32 v23, a3
v_mfma_f32_16x16x32_bf16 a[20:23], a[172:175], a[244:247], a[20:23]
s_and_b32 s33, s33, 65535
ds_read_b64_tr_b16 a[218:219], v11 offset:1024
v_cvt_pk_bf16_f32 v66, v20, v21
v_cvt_pk_bf16_f32 v67, v22, v23
v_accvgpr_read_b32 v24, a4
v_mfma_f32_16x16x32_bf16 a[24:27], a[172:175], a[248:251], a[24:27]
v_accvgpr_read_b32 v25, a5
v_accvgpr_read_b32 v26, a6
v_accvgpr_read_b32 v27, a7
v_cvt_pk_bf16_f32 v70, v24, v25
v_mfma_f32_16x16x32_bf16 a[28:31], a[172:175], a[252:255], a[28:31]
s_mov_b32 s48, s30
ds_read_b128 a[172:175], v4 offset:5120
v_cvt_pk_bf16_f32 v71, v26, v27
v_accvgpr_read_b32 v20, a8
v_accvgpr_read_b32 v21, a9
v_mfma_f32_16x16x32_bf16 a[32:35], a[176:179], a[224:227], a[32:35]
s_add_u32 m0, s32, 0
ds_read_b64_tr_b16 a[220:221], v12 offset:0
v_mov_b32 v16, 0
v_accvgpr_read_b32 v22, a10
v_accvgpr_read_b32 v23, a11
v_mfma_f32_16x16x32_bf16 a[36:39], a[176:179], a[228:231], a[36:39]
buffer_load_dwordx4 v1, s[12:15], s48 offen lds
v_mov_b32 v17, 1
v_cvt_pk_bf16_f32 v74, v20, v21
v_cvt_pk_bf16_f32 v75, v22, v23
v_mfma_f32_16x16x32_bf16 a[40:43], a[176:179], a[232:235], a[40:43]
ds_read_b64_tr_b16 a[222:223], v12 offset:1024
v_accvgpr_read_b32 v24, a12
v_accvgpr_read_b32 v25, a13
v_accvgpr_read_b32 v26, a14
v_mfma_f32_16x16x32_bf16 a[44:47], a[176:179], a[236:239], a[44:47]
s_cmp_eq_u32 s17, 0
s_cselect_b32 s29, s39, 536870912
v_accvgpr_read_b32 v27, a15
v_cvt_pk_bf16_f32 v78, v24, v25
v_mfma_f32_16x16x32_bf16 a[48:51], a[176:179], a[240:243], a[48:51]
ds_read_b128 a[188:191], v4 offset:13312
v_cvt_pk_bf16_f32 v79, v26, v27
v_accvgpr_read_b32 v20, a16
v_accvgpr_read_b32 v21, a17
v_mfma_f32_16x16x32_bf16 a[52:55], a[176:179], a[244:247], a[52:55]
s_mov_b64 exec, 1
buffer_store_dword v17, v16, s[8:11], s29 offen sc1
s_mov_b64 exec, -1
v_accvgpr_read_b32 v22, a18
v_mfma_f32_16x16x32_bf16 a[56:59], a[176:179], a[248:251], a[56:59]
s_add_u32 s48, s48, s34
v_accvgpr_read_b32 v23, a19
v_cvt_pk_bf16_f32 v82, v20, v21
v_cvt_pk_bf16_f32 v83, v22, v23
v_accvgpr_read_b32 v24, a20
v_mfma_f32_16x16x32_bf16 a[60:63], a[176:179], a[252:255], a[60:63]
s_add_u32 m0, s32, 4096
ds_read_b128 a[176:179], v3 offset:8192
v_add_u32 v5, 16384, v5
v_accvgpr_read_b32 v25, a21
v_accvgpr_read_b32 v26, a22
v_mfma_f32_16x16x32_bf16 a[64:67], a[180:183], a[224:227], a[64:67]
buffer_load_dwordx4 v1, s[12:15], s48 offen lds
v_and_b32 v5, 65535, v5
v_accvgpr_read_b32 v27, a23
v_cvt_pk_bf16_f32 v86, v24, v25
v_mfma_f32_16x16x32_bf16 a[68:71], a[180:183], a[228:231], a[68:71]
v_xor_b32 v6, 16, v5
v_xor_b32 v7, 64, v5
v_cvt_pk_bf16_f32 v87, v26, v27
v_accvgpr_read_b32 v20, a24
v_mfma_f32_16x16x32_bf16 a[72:75], a[180:183], a[232:235], a[72:75]
v_xor_b32 v8, 80, v5
v_xor_b32 v9, 128, v5
v_accvgpr_read_b32 v21, a25
v_accvgpr_read_b32 v22, a26
v_mfma_f32_16x16x32_bf16 a[76:79], a[180:183], a[236:239], a[76:79]
v_xor_b32 v10, 144, v5
v_xor_b32 v11, 192, v5
v_accvgpr_read_b32 v23, a27
v_cvt_pk_bf16_f32 v90, v20, v21
v_mfma_f32_16x16x32_bf16 a[80:83], a[180:183], a[240:243], a[80:83]
v_xor_b32 v12, 208, v5
v_cvt_pk_bf16_f32 v91, v22, v23
v_accvgpr_read_b32 v24, a28
v_accvgpr_read_b32 v25, a29
v_mfma_f32_16x16x32_bf16 a[84:87], a[180:183], a[244:247], a[84:87]
s_add_u32 s48, s48, s34
v_accvgpr_read_b32 v26, a30
v_accvgpr_read_b32 v27, a31
v_cvt_pk_bf16_f32 v94, v24, v25
v_cvt_pk_bf16_f32 v95, v26, v27
v_mfma_f32_16x16x32_bf16 a[88:91], a[180:183], a[248:251], a[88:91]
s_add_u32 m0, s32, 8192
v_accvgpr_read_b32 v20, a32
v_accvgpr_read_b32 v21, a33
v_accvgpr_read_b32 v22, a34
v_accvgpr_read_b32 v23, a35
v_mfma_f32_16x16x32_bf16 a[92:95], a[180:183], a[252:255], a[92:95]
buffer_load_dwordx4 v1, s[12:15], s48 offen lds
ds_read_b128 a[180:183], v4 offset:9216
v_cvt_pk_bf16_f32 v96, v20, v21
v_cvt_pk_bf16_f32 v97, v22, v23
v_mfma_f32_16x16x32_bf16 a[96:99], a[184:187], a[224:227], a[96:99]
v_accvgpr_read_b32 v24, a36
v_accvgpr_read_b32 v25, a37
v_accvgpr_read_b32 v26, a38
v_accvgpr_read_b32 v27, a39
v_mfma_f32_16x16x32_bf16 a[100:103], a[184:187], a[228:231], a[100:103]
v_cvt_pk_bf16_f32 v100, v24, v25
v_cvt_pk_bf16_f32 v101, v26, v27
v_accvgpr_read_b32 v20, a40
v_accvgpr_read_b32 v21, a41
v_mfma_f32_16x16x32_bf16 a[104:107], a[184:187], a[232:235], a[104:107]
v_accvgpr_read_b32 v22, a42
v_accvgpr_read_b32 v23, a43
v_cvt_pk_bf16_f32 v104, v20, v21
v_cvt_pk_bf16_f32 v105, v22, v23
v_mfma_f32_16x16x32_bf16 a[108:111], a[184:187], a[236:239], a[108:111]
v_accvgpr_read_b32 v24, a44
v_accvgpr_read_b32 v25, a45
v_accvgpr_read_b32 v26, a46
v_accvgpr_read_b32 v27, a47
v_mfma_f32_16x16x32_bf16 a[112:115], a[184:187], a[240:243], a[112:115]
s_add_u32 s48, s48, s34
v_cvt_pk_bf16_f32 v108, v24, v25
v_cvt_pk_bf16_f32 v109, v26, v27
v_accvgpr_read_b32 v20, a48
v_accvgpr_read_b32 v21, a49
v_mfma_f32_16x16x32_bf16 a[116:119], a[184:187], a[244:247], a[116:119]
s_add_u32 m0, s32, 12288
v_accvgpr_read_b32 v22, a50
v_accvgpr_read_b32 v23, a51
v_cvt_pk_bf16_f32 v112, v20, v21
v_cvt_pk_bf16_f32 v113, v22, v23
v_mfma_f32_16x16x32_bf16 a[120:123], a[184:187], a[248:251], a[120:123]
buffer_load_dwordx4 v1, s[12:15], s48 offen lds
v_accvgpr_read_b32 v24, a52
v_accvgpr_read_b32 v25, a53
v_accvgpr_read_b32 v26, a54
v_mfma_f32_16x16x32_bf16 a[124:127], a[184:187], a[252:255], a[124:127]
ds_read_b128 a[184:187], v3 offset:12288
v_accvgpr_read_b32 v27, a55
v_cvt_pk_bf16_f32 v116, v24, v25
v_cvt_pk_bf16_f32 v117, v26, v27
v_mfma_f32_16x16x32_bf16 a[128:131], v[28:31], a[224:227], a[128:131]
v_accvgpr_read_b32 v20, a56
v_accvgpr_read_b32 v21, a57
v_accvgpr_read_b32 v22, a58
v_accvgpr_read_b32 v23, a59
v_mfma_f32_16x16x32_bf16 a[132:135], v[28:31], a[228:231], a[132:135]
v_cvt_pk_bf16_f32 v120, v20, v21
v_cvt_pk_bf16_f32 v121, v22, v23
v_accvgpr_read_b32 v24, a60
v_accvgpr_read_b32 v25, a61
v_mfma_f32_16x16x32_bf16 a[136:139], v[28:31], a[232:235], a[136:139]
buffer_load_dword v15, v14, s[96:99], s100 offen
v_accvgpr_read_b32 v26, a62
v_accvgpr_read_b32 v27, a63
v_cvt_pk_bf16_f32 v124, v24, v25
v_mfma_f32_16x16x32_bf16 a[140:143], v[28:31], a[236:239], a[140:143]
s_add_u32 s100, s100, 16384
v_cvt_pk_bf16_f32 v125, v26, v27
v_mfma_f32_16x16x32_bf16 a[144:147], v[28:31], a[240:243], a[144:147]
v_mfma_f32_16x16x32_bf16 a[148:151], v[28:31], a[244:247], a[148:151]
v_mfma_f32_16x16x32_bf16 a[152:155], v[28:31], a[248:251], a[152:155]
v_mfma_f32_16x16x32_bf16 a[156:159], v[28:31], a[252:255], a[156:159]
s_cmp_lt_u32 s35, s45
s_cbranch_scc1 L_g_tile
s_branch L_g_end
L_g_first:
s_mov_b32 s100, 536870912
s_cmp_eq_u32 s95, 0
s_cbranch_scc0 L_g_end
v_mov_b32 v20, 128
s_mov_b32 s28, 0
L_poll_8:
buffer_load_dword v21, v20, s[56:59], 0 offen sc1
s_add_u32 s28, s28, 1
s_cmp_gt_u32 s28, 200000
s_cbranch_scc1 L_end
s_waitcnt vmcnt(0)
v_cmp_ne_u32 vcc, 8, v21
s_cbranch_vccz L_pd_9
s_sleep 1
s_branch L_poll_8
L_pd_9:
s_branch L_g_go
L_g_end:
s_cmp_eq_u32 s61, 0
s_cbranch_scc1 L_att
v_bfe_u32 v16, v0, 3, 3
v_lshlrev_b32 v16, 4, v16
v_and_or_b32 v16, v0, 7, v16
v_bfe_u32 v17, v0, 4, 2
v_lshlrev_b32 v17, 5, v17
v_bfe_u32 v18, v0, 1, 3
v_or_b32 v17, v17, v18
v_and_b32 v18, 1, v0
v_lshl_or_b32 v17, v18, 4, v17
s_bitcmp1_b32 s50, 1
s_cselect_b64 vcc, -1, 0
s_movk_i32 s44, 0x80
v_cndmask_b32 v16, v16, v17, vcc
v_lshlrev_b32 v13, 4, v16
s_lshr_b32 s93, s50, 2
s_lshr_b32 s93, 0x80000, s93
s_bitcmp1_b32 s50, 0
s_cselect_b32 s92, s93, 0x800
s_cselect_b32 s93, 0x800, s93
s_sub_u32 s93, s93, s44
s_and_b32 s24, s17, s91
s_cbranch_scc0 L_g_h1
s_barrier
L_g_h1:
v_cvt_pk_bf16_f32 v32, v160, v161
v_cvt_pk_bf16_f32 v33, v162, v163
v_cvt_pk_bf16_f32 v34, v192, v193
v_cvt_pk_bf16_f32 v35, v194, v195
s_mov_b32 s60, s62
s_mov_b32 s29, s62
buffer_store_dwordx4 v[32:35], v13, s[8:11], s29 offen sc1
v_cvt_pk_bf16_f32 v36, v164, v165
v_cvt_pk_bf16_f32 v37, v166, v167
v_cvt_pk_bf16_f32 v38, v196, v197
v_cvt_pk_bf16_f32 v39, v198, v199
s_add_u32 s29, s29, s44
buffer_store_dwordx4 v[36:39], v13, s[8:11], s29 offen sc1
v_cvt_pk_bf16_f32 v40, v168, v169
v_cvt_pk_bf16_f32 v41, v170, v171
v_cvt_pk_bf16_f32 v42, v200, v201
v_cvt_pk_bf16_f32 v43, v202, v203
s_add_u32 s29, s29, s93
buffer_store_dwordx4 v[40:43], v13, s[8:11], s29 offen sc1
v_cvt_pk_bf16_f32 v44, v172, v173
v_cvt_pk_bf16_f32 v45, v174, v175
v_cvt_pk_bf16_f32 v46, v204, v205
v_cvt_pk_bf16_f32 v47, v206, v207
s_add_u32 s29, s29, s44
buffer_store_dwordx4 v[44:47], v13, s[8:11], s29 offen sc1
v_cvt_pk_bf16_f32 v48, v176, v177
v_cvt_pk_bf16_f32 v49, v178, v179
v_cvt_pk_bf16_f32 v50, v208, v209
v_cvt_pk_bf16_f32 v51, v210, v211
s_add_u32 s29, s29, s93
buffer_store_dwordx4 v[48:51], v13, s[8:11], s29 offen sc1
v_cvt_pk_bf16_f32 v52, v180, v181
v_cvt_pk_bf16_f32 v53, v182, v183
v_cvt_pk_bf16_f32 v54, v212, v213
v_cvt_pk_bf16_f32 v55, v214, v215
s_add_u32 s29, s29, s44
buffer_store_dwordx4 v[52:55], v13, s[8:11], s29 offen sc1
v_cvt_pk_bf16_f32 v56, v184, v185
v_cvt_pk_bf16_f32 v57, v186, v187
v_cvt_pk_bf16_f32 v58, v216, v217
v_cvt_pk_bf16_f32 v59, v218, v219
s_add_u32 s29, s29, s93
buffer_store_dwordx4 v[56:59], v13, s[8:11], s29 offen sc1
v_cvt_pk_bf16_f32 v60, v188, v189
v_cvt_pk_bf16_f32 v61, v190, v191
v_cvt_pk_bf16_f32 v62, v220, v221
v_cvt_pk_bf16_f32 v63, v222, v223
s_add_u32 s29, s29, s44
buffer_store_dwordx4 v[60:63], v13, s[8:11], s29 offen sc1
v_cvt_pk_bf16_f32 v64, v224, v225
v_cvt_pk_bf16_f32 v65, v226, v227
v_accvgpr_read_b32 v20, a0
v_accvgpr_read_b32 v21, a1
v_accvgpr_read_b32 v22, a2
v_accvgpr_read_b32 v23, a3
v_cvt_pk_bf16_f32 v66, v20, v21
v_cvt_pk_bf16_f32 v67, v22, v23
s_add_u32 s60, s60, s92
s_mov_b32 s29, s60
buffer_store_dwordx4 v[64:67], v13, s[8:11], s29 offen sc1
v_cvt_pk_bf16_f32 v68, v228, v229
v_cvt_pk_bf16_f32 v69, v230, v231
v_accvgpr_read_b32 v24, a4
v_accvgpr_read_b32 v25, a5
v_accvgpr_read_b32 v26, a6
v_accvgpr_read_b32 v27, a7
v_cvt_pk_bf16_f32 v70, v24, v25
v_cvt_pk_bf16_f32 v71, v26, v27
s_add_u32 s29, s29, s44
buffer_store_dwordx4 v[68:71], v13, s[8:11], s29 offen sc1
v_cvt_pk_bf16_f32 v72, v232, v233
v_cvt_pk_bf16_f32 v73, v234, v235
v_accvgpr_read_b32 v20, a8
v_accvgpr_read_b32 v21, a9
v_accvgpr_read_b32 v22, a10
v_accvgpr_read_b32 v23, a11
v_cvt_pk_bf16_f32 v74, v20, v21
v_cvt_pk_bf16_f32 v75, v22, v23
s_add_u32 s29, s29, s93
buffer_store_dwordx4 v[72:75], v13, s[8:11], s29 offen sc1
v_cvt_pk_bf16_f32 v76, v236, v237
v_cvt_pk_bf16_f32 v77, v238, v239
v_accvgpr_read_b32 v24, a12
v_accvgpr_read_b32 v25, a13
v_accvgpr_read_b32 v26, a14
v_accvgpr_read_b32 v27, a15
v_cvt_pk_bf16_f32 v78, v24, v25
v_cvt_pk_bf16_f32 v79, v26, v27
s_add_u32 s29, s29, s44
buffer_store_dwordx4 v[76:79], v13, s[8:11], s29 offen sc1
v_cvt_pk_bf16_f32 v80, v240, v241
v_cvt_pk_bf16_f32 v81, v242, v243
v_accvgpr_read_b32 v20, a16
v_accvgpr_read_b32 v21, a17
v_accvgpr_read_b32 v22, a18
v_accvgpr_read_b32 v23, a19
v_cvt_pk_bf16_f32 v82, v20, v21
v_cvt_pk_bf16_f32 v83, v22, v23
s_add_u32 s29, s29, s93
buffer_store_dwordx4 v[80:83], v13, s[8:11], s29 offen sc1
v_cvt_pk_bf16_f32 v84, v244, v245
v_cvt_pk_bf16_f32 v85, v246, v247
v_accvgpr_read_b32 v24, a20
v_accvgpr_read_b32 v25, a21
v_accvgpr_read_b32 v26, a22
v_accvgpr_read_b32 v27, a23
v_cvt_pk_bf16_f32 v86, v24, v25
v_cvt_pk_bf16_f32 v87, v26, v27
s_add_u32 s29, s29, s44
buffer_store_dwordx4 v[84:87], v13, s[8:11], s29 offen sc1
v_cvt_pk_bf16_f32 v88, v248, v249
v_cvt_pk_bf16_f32 v89, v250, v251
v_accvgpr_read_b32 v20, a24
v_accvgpr_read_b32 v21, a25
v_accvgpr_read_b32 v22, a26
v_accvgpr_read_b32 v23, a27
v_cvt_pk_bf16_f32 v90, v20, v21
v_cvt_pk_bf16_f32 v91, v22, v23
s_add_u32 s29, s29, s93
buffer_store_dwordx4 v[88:91], v13, s[8:11], s29 offen sc1
v_cvt_pk_bf16_f32 v92, v252, v253
v_cvt_pk_bf16_f32 v93, v254, v255
v_accvgpr_read_b32 v24, a28
v_accvgpr_read_b32 v25, a29
v_accvgpr_read_b32 v26, a30
v_accvgpr_read_b32 v27, a31
v_cvt_pk_bf16_f32 v94, v24, v25
v_cvt_pk_bf16_f32 v95, v26, v27
s_add_u32 s29, s29, s44
buffer_store_dwordx4 v[92:95], v13, s[8:11], s29 offen sc1
v_accvgpr_read_b32 v20, a32
v_accvgpr_read_b32 v21, a33
v_accvgpr_read_b32 v22, a34
v_accvgpr_read_b32 v23, a35
v_cvt_pk_bf16_f32 v96, v20, v21
v_cvt_pk_bf16_f32 v97, v22, v23
v_accvgpr_read_b32 v20, a64
v_accvgpr_read_b32 v21, a65
v_accvgpr_read_b32 v22, a66
v_accvgpr_read_b32 v23, a67
v_cvt_pk_bf16_f32 v98, v20, v21
v_cvt_pk_bf16_f32 v99, v22, v23
s_add_u32 s60, s60, s92
s_mov_b32 s29, s60
buffer_store_dwordx4 v[96:99], v13, s[8:11], s29 offen sc1
v_accvgpr_read_b32 v24, a36
v_accvgpr_read_b32 v25, a37
v_accvgpr_read_b32 v26, a38
v_accvgpr_read_b32 v27, a39
v_cvt_pk_bf16_f32 v100, v24, v25
v_cvt_pk_bf16_f32 v101, v26, v27
v_accvgpr_read_b32 v24, a68
v_accvgpr_read_b32 v25, a69
v_accvgpr_read_b32 v26, a70
v_accvgpr_read_b32 v27, a71
v_cvt_pk_bf16_f32 v102, v24, v25
v_cvt_pk_bf16_f32 v103, v26, v27
s_add_u32 s29, s29, s44
buffer_store_dwordx4 v[100:103], v13, s[8:11], s29 offen sc1
v_accvgpr_read_b32 v20, a40
v_accvgpr_read_b32 v21, a41
v_accvgpr_read_b32 v22, a42
v_accvgpr_read_b32 v23, a43
v_cvt_pk_bf16_f32 v104, v20, v21
v_cvt_pk_bf16_f32 v105, v22, v23
v_accvgpr_read_b32 v20, a72
v_accvgpr_read_b32 v21, a73
v_accvgpr_read_b32 v22, a74
v_accvgpr_read_b32 v23, a75
v_cvt_pk_bf16_f32 v106, v20, v21
v_cvt_pk_bf16_f32 v107, v22, v23
s_add_u32 s29, s29, s93
buffer_store_dwordx4 v[104:107], v13, s[8:11], s29 offen sc1
v_accvgpr_read_b32 v24, a44
v_accvgpr_read_b32 v25, a45
v_accvgpr_read_b32 v26, a46
v_accvgpr_read_b32 v27, a47
v_cvt_pk_bf16_f32 v108, v24, v25
v_cvt_pk_bf16_f32 v109, v26, v27
v_accvgpr_read_b32 v24, a76
v_accvgpr_read_b32 v25, a77
v_accvgpr_read_b32 v26, a78
v_accvgpr_read_b32 v27, a79
v_cvt_pk_bf16_f32 v110, v24, v25
v_cvt_pk_bf16_f32 v111, v26, v27
s_add_u32 s29, s29, s44
buffer_store_dwordx4 v[108:111], v13, s[8:11], s29 offen sc1
v_accvgpr_read_b32 v20, a48
v_accvgpr_read_b32 v21, a49
v_accvgpr_read_b32 v22, a50
v_accvgpr_read_b32 v23, a51
v_cvt_pk_bf16_f32 v112, v20, v21
v_cvt_pk_bf16_f32 v113, v22, v23
v_accvgpr_read_b32 v20, a80
v_accvgpr_read_b32 v21, a81
v_accvgpr_read_b32 v22, a82
v_accvgpr_read_b32 v23, a83
v_cvt_pk_bf16_f32 v114, v20, v21
v_cvt_pk_bf16_f32 v115, v22, v23
s_add_u32 s29, s29, s93
buffer_store_dwordx4 v[112:115], v13, s[8:11], s29 offen sc1
v_accvgpr_read_b32 v24, a52
v_accvgpr_read_b32 v25, a53
v_accvgpr_read_b32 v26, a54
v_accvgpr_read_b32 v27, a55
v_cvt_pk_bf16_f32 v116, v24, v25
v_cvt_pk_bf16_f32 v117, v26, v27
v_accvgpr_read_b32 v24, a84
v_accvgpr_read_b32 v25, a85
v_accvgpr_read_b32 v26, a86
v_accvgpr_read_b32 v27, a87
v_cvt_pk_bf16_f32 v118, v24, v25
v_cvt_pk_bf16_f32 v119, v26, v27
s_add_u32 s29, s29, s44
buffer_store_dwordx4 v[116:119], v13, s[8:11], s29 offen sc1
v_accvgpr_read_b32 v20, a56
v_accvgpr_read_b32 v21, a57
v_accvgpr_read_b32 v22, a58
v_accvgpr_read_b32 v23, a59
v_cvt_pk_bf16_f32 v120, v20, v21
v_cvt_pk_bf16_f32 v121, v22, v23
v_accvgpr_read_b32 v20, a88
v_accvgpr_read_b32 v21, a89
v_accvgpr_read_b32 v22, a90
v_accvgpr_read_b32 v23, a91
v_cvt_pk_bf16_f32 v122, v20, v21
v_cvt_pk_bf16_f32 v123, v22, v23
s_add_u32 s29, s29, s93
buffer_store_dwordx4 v[120:123], v13, s[8:11], s29 offen sc1
v_accvgpr_read_b32 v24, a60
v_accvgpr_read_b32 v25, a61
v_accvgpr_read_b32 v26, a62
v_accvgpr_read_b32 v27, a63
v_cvt_pk_bf16_f32 v124, v24, v25
v_cvt_pk_bf16_f32 v125, v26, v27
v_accvgpr_read_b32 v24, a92
v_accvgpr_read_b32 v25, a93
v_accvgpr_read_b32 v26, a94
v_accvgpr_read_b32 v27, a95
v_cvt_pk_bf16_f32 v126, v24, v25
v_cvt_pk_bf16_f32 v127, v26, v27
s_add_u32 s29, s29, s44
buffer_store_dwordx4 v[124:127], v13, s[8:11], s29 offen sc1
v_accvgpr_read_b32 v20, a96
v_accvgpr_read_b32 v21, a97
v_accvgpr_read_b32 v22, a98
v_accvgpr_read_b32 v23, a99
v_cvt_pk_bf16_f32 v128, v20, v21
v_cvt_pk_bf16_f32 v129, v22, v23
v_accvgpr_read_b32 v20, a128
v_accvgpr_read_b32 v21, a129
v_accvgpr_read_b32 v22, a130
v_accvgpr_read_b32 v23, a131
v_cvt_pk_bf16_f32 v130, v20, v21
v_cvt_pk_bf16_f32 v131, v22, v23
s_add_u32 s60, s60, s92
s_mov_b32 s29, s60
buffer_store_dwordx4 v[128:131], v13, s[8:11], s29 offen sc1
v_accvgpr_read_b32 v24, a100
v_accvgpr_read_b32 v25, a101
v_accvgpr_read_b32 v26, a102
v_accvgpr_read_b32 v27, a103
v_cvt_pk_bf16_f32 v132, v24, v25
v_cvt_pk_bf16_f32 v133, v26, v27
v_accvgpr_read_b32 v24, a132
v_accvgpr_read_b32 v25, a133
v_accvgpr_read_b32 v26, a134
v_accvgpr_read_b32 v27, a135
v_cvt_pk_bf16_f32 v134, v24, v25
v_cvt_pk_bf16_f32 v135, v26, v27
s_add_u32 s29, s29, s44
buffer_store_dwordx4 v[132:135], v13, s[8:11], s29 offen sc1
v_accvgpr_read_b32 v20, a104
v_accvgpr_read_b32 v21, a105
v_accvgpr_read_b32 v22, a106
v_accvgpr_read_b32 v23, a107
v_cvt_pk_bf16_f32 v136, v20, v21
v_cvt_pk_bf16_f32 v137, v22, v23
v_accvgpr_read_b32 v20, a136
v_accvgpr_read_b32 v21, a137
v_accvgpr_read_b32 v22, a138
v_accvgpr_read_b32 v23, a139
v_cvt_pk_bf16_f32 v138, v20, v21
v_cvt_pk_bf16_f32 v139, v22, v23
s_add_u32 s29, s29, s93
buffer_store_dwordx4 v[136:139], v13, s[8:11], s29 offen sc1
v_accvgpr_read_b32 v24, a108
v_accvgpr_read_b32 v25, a109
v_accvgpr_read_b32 v26, a110
v_accvgpr_read_b32 v27, a111
v_cvt_pk_bf16_f32 v140, v24, v25
v_cvt_pk_bf16_f32 v141, v26, v27
v_accvgpr_read_b32 v24, a140
v_accvgpr_read_b32 v25, a141
v_accvgpr_read_b32 v26, a142
v_accvgpr_read_b32 v27, a143
v_cvt_pk_bf16_f32 v142, v24, v25
v_cvt_pk_bf16_f32 v143, v26, v27
s_add_u32 s29, s29, s44
buffer_store_dwordx4 v[140:143], v13, s[8:11], s29 offen sc1
v_accvgpr_read_b32 v20, a112
v_accvgpr_read_b32 v21, a113
v_accvgpr_read_b32 v22, a114
v_accvgpr_read_b32 v23, a115
v_cvt_pk_bf16_f32 v144, v20, v21
v_cvt_pk_bf16_f32 v145, v22, v23
v_accvgpr_read_b32 v20, a144
v_accvgpr_read_b32 v21, a145
v_accvgpr_read_b32 v22, a146
v_accvgpr_read_b32 v23, a147
v_cvt_pk_bf16_f32 v146, v20, v21
v_cvt_pk_bf16_f32 v147, v22, v23
s_add_u32 s29, s29, s93
buffer_store_dwordx4 v[144:147], v13, s[8:11], s29 offen sc1
v_accvgpr_read_b32 v24, a116
v_accvgpr_read_b32 v25, a117
v_accvgpr_read_b32 v26, a118
v_accvgpr_read_b32 v27, a119
v_cvt_pk_bf16_f32 v148, v24, v25
v_cvt_pk_bf16_f32 v149, v26, v27
v_accvgpr_read_b32 v24, a148
v_accvgpr_read_b32 v25, a149
v_accvgpr_read_b32 v26, a150
v_accvgpr_read_b32 v27, a151
v_cvt_pk_bf16_f32 v150, v24, v25
v_cvt_pk_bf16_f32 v151, v26, v27
s_add_u32 s29, s29, s44
buffer_store_dwordx4 v[148:151], v13, s[8:11], s29 offen sc1
v_accvgpr_read_b32 v20, a120
v_accvgpr_read_b32 v21, a121
v_accvgpr_read_b32 v22, a122
v_accvgpr_read_b32 v23, a123
v_cvt_pk_bf16_f32 v152, v20, v21
v_cvt_pk_bf16_f32 v153, v22, v23
v_accvgpr_read_b32 v20, a152
v_accvgpr_read_b32 v21, a153
v_accvgpr_read_b32 v22, a154
v_accvgpr_read_b32 v23, a155
v_cvt_pk_bf16_f32 v154, v20, v21
v_cvt_pk_bf16_f32 v155, v22, v23
s_add_u32 s29, s29, s93
buffer_store_dwordx4 v[152:155], v13, s[8:11], s29 offen sc1
v_accvgpr_read_b32 v24, a124
v_accvgpr_read_b32 v25, a125
v_accvgpr_read_b32 v26, a126
v_accvgpr_read_b32 v27, a127
v_cvt_pk_bf16_f32 v156, v24, v25
v_cvt_pk_bf16_f32 v157, v26, v27
v_accvgpr_read_b32 v24, a156
v_accvgpr_read_b32 v25, a157
v_accvgpr_read_b32 v26, a158
v_accvgpr_read_b32 v27, a159
v_cvt_pk_bf16_f32 v158, v24, v25
v_cvt_pk_bf16_f32 v159, v26, v27
s_add_u32 s29, s29, s44
buffer_store_dwordx4 v[156:159], v13, s[8:11], s29 offen sc1
v_mov_b32 v20, 128
s_mov_b32 s28, 0
L_poll_10:
buffer_load_dword v21, v20, s[56:59], 0 offen sc1
s_add_u32 s28, s28, 1
s_cmp_gt_u32 s28, 200000
s_cbranch_scc1 L_end
s_waitcnt vmcnt(0)
v_cmp_ne_u32 vcc, 8, v21
s_cbranch_vccz L_pd_11
s_sleep 1
s_branch L_poll_10
L_pd_11:
s_andn2_b32 s24, s91, s17
s_cbranch_scc0 L_g_h2
s_barrier
s_add_u32 s60, s63, 32
v_mov_b32 v16, 0
v_mov_b32 v17, 1
s_cmp_eq_u32 s17, 0
s_cselect_b32 s29, s60, 536870912
s_mov_b64 exec, 1
buffer_store_dword v17, v16, s[8:11], s29 offen sc1
s_mov_b64 exec, -1
L_g_h2:
s_waitcnt vmcnt(0) lgkmcnt(0)
s_barrier
v_mov_b32 v16, 0
v_mov_b32 v17, 1
s_cmp_eq_u32 s17, 0
s_cselect_b32 s29, s63, 536870912
s_mov_b64 exec, 1
buffer_store_dword v17, v16, s[8:11], s29 offen sc1
s_mov_b64 exec, -1
s_mov_b32 s62, 536870912
s_mov_b32 s63, 536870912
s_cmp_lt_u32 s35, s45
s_cbranch_scc1 L_g_go
s_cmp_eq_u32 s3, 1
s_cbranch_scc1 L_part
s_branch L_bdie
L_att:
s_mov_b32 s96, s62
s_mov_b32 s60, s63
s_mov_b32 s42, s89
s_bfe_u32 s41, s88, 0x30008
s_sub_u32 s63, 7, s41
s_mov_b32 s40, 0x3e0293ee
s_mov_b32 s50, 0xf149f2ca
s_mov_b32 s51, 0x41a00000
s_waitcnt lgkmcnt(0)
v_and_b32 v6, 63, v0
v_lshlrev_b32 v6, 4, v6
v_and_b32 v16, 0x380, v6
s_and_b32 s24, s17, 1
s_lshl_b32 s24, s24, 13
s_lshr_b32 s25, s17, 1
s_lshl_b32 s25, s25, 19
s_add_u32 s24, s24, s25
v_add3_u32 v1, v6, v16, s24
v_and_b32 v16, 0x300, v6
s_and_b32 s24, s17, 1
s_lshl_b32 s24, s24, 8
s_lshr_b32 s25, s17, 1
s_lshl_b32 s25, s25, 18
s_add_u32 s24, s24, s25
v_add3_u32 v7, v6, v16, s24
v_and_b32 v5, 15, v0
s_lshl_b32 s24, s17, 4
v_add_u32 v5, s24, v5
v_bfe_u32 v16, v0, 5, 1
v_lshlrev_b32 v16, 4, v16
v_sub_u32 v5, v5, v16
v_bfe_u32 v16, v0, 4, 1
v_lshlrev_b32 v16, 2, v16
v_sub_u32 v5, v5, v16
v_mov_b32 v8, s50
v_mov_b32 v16, 0x3f803f80
v_accvgpr_write_b32 a240, v16
v_accvgpr_write_b32 a241, v16
v_accvgpr_write_b32 a242, v16
v_accvgpr_write_b32 a243, v16
v_cmp_le_i32 s[64:65], 0, v5
v_cmp_le_i32 s[66:67], 1, v5
v_cmp_le_i32 s[68:69], 2, v5
v_cmp_le_i32 s[70:71], 3, v5
v_cmp_le_i32 s[72:73], 8, v5
v_cmp_le_i32 s[74:75], 9, v5
v_cmp_le_i32 s[76:77], 10, v5
v_cmp_le_i32 s[78:79], 11, v5
v_cmp_le_i32 s[80:81], 32, v5
v_cmp_le_i32 s[82:83], 33, v5
v_cmp_le_i32 s[84:85], 34, v5
v_cmp_le_i32 s[86:87], 35, v5
v_cmp_le_i32 s[88:89], 40, v5
v_cmp_le_i32 s[90:91], 41, v5
v_cmp_le_i32 s[92:93], 42, v5
v_cmp_le_i32 s[94:95], 43, v5
s_lshl_b32 s47, s17, 13
s_mov_b32 s48, 0
s_cmp_eq_u32 s17, 0
s_cselect_b32 s60, s60, 536870912
v_and_b32 v20, 3, v0
v_lshlrev_b32 v20, 2, v20
s_lshl_b32 s25, s42, 7
s_add_u32 s25, s25, 111165440
s_mov_b32 s28, 0
L_poll_12:
buffer_load_dword v21, v20, s[8:11], s25 offen sc1
s_add_u32 s28, s28, 1
s_cmp_gt_u32 s28, 200000
s_cbranch_scc1 L_end
s_waitcnt vmcnt(0)
v_cmp_ne_u32 vcc, 1, v21
s_cbranch_vccz L_pd_13
s_sleep 1
s_branch L_poll_12
L_pd_13:
s_waitcnt lgkmcnt(0)
s_barrier
s_lshl_b32 s46, s42, 14
s_add_u32 s46, s46, 0
s_cmp_lt_u32 s63, 8
s_cselect_b32 s46, s46, 536870912
s_add_u32 s24, s46, 4096
s_add_u32 m0, s47, 0
s_nop 0
buffer_load_dwordx4 v1, s[8:11], s46 offen sc1 lds
buffer_load_dwordx4 v1, s[8:11], s46 offen offset:2048 sc1 lds
s_add_u32 m0, s47, 896
s_nop 0
buffer_load_dwordx4 v1, s[8:11], s46 offen offset:128 sc1 lds
buffer_load_dwordx4 v1, s[8:11], s46 offen offset:2176 sc1 lds
s_add_u32 m0, s47, 4096
s_nop 0
buffer_load_dwordx4 v1, s[8:11], s24 offen sc1 lds
buffer_load_dwordx4 v1, s[8:11], s24 offen offset:2048 sc1 lds
s_add_u32 m0, s47, 4992
s_nop 0
buffer_load_dwordx4 v1, s[8:11], s24 offen offset:128 sc1 lds
buffer_load_dwordx4 v1, s[8:11], s24 offen offset:2176 sc1 lds
s_add_u32 s46, s46, 1048576
s_add_u32 s47, s47, 32768
s_and_b32 s47, s47, 131071
s_add_u32 s24, s46, 4096
s_add_u32 m0, s47, 0
s_nop 0
buffer_load_dwordx4 v1, s[8:11], s46 offen sc1 lds
buffer_load_dwordx4 v1, s[8:11], s46 offen offset:2048 sc1 lds
s_add_u32 m0, s47, 896
s_nop 0
buffer_load_dwordx4 v1, s[8:11], s46 offen offset:128 sc1 lds
buffer_load_dwordx4 v1, s[8:11], s46 offen offset:2176 sc1 lds
s_add_u32 m0, s47, 4096
s_nop 0
buffer_load_dwordx4 v1, s[8:11], s24 offen sc1 lds
buffer_load_dwordx4 v1, s[8:11], s24 offen offset:2048 sc1 lds
s_add_u32 m0, s47, 4992
s_nop 0
buffer_load_dwordx4 v1, s[8:11], s24 offen offset:128 sc1 lds
buffer_load_dwordx4 v1, s[8:11], s24 offen offset:2176 sc1 lds
s_add_u32 s46, s46, 1048576
s_add_u32 s47, s47, 32768
s_and_b32 s47, s47, 131071
s_add_u32 s24, s46, 4096
s_add_u32 m0, s47, 0
s_nop 0
buffer_load_dwordx4 v1, s[8:11], s46 offen sc1 lds
buffer_load_dwordx4 v1, s[8:11], s46 offen offset:2048 sc1 lds
s_add_u32 m0, s47, 896
s_nop 0
buffer_load_dwordx4 v1, s[8:11], s46 offen offset:128 sc1 lds
buffer_load_dwordx4 v1, s[8:11], s46 offen offset:2176 sc1 lds
s_add_u32 m0, s47, 4096
s_nop 0
buffer_load_dwordx4 v1, s[8:11], s24 offen sc1 lds
buffer_load_dwordx4 v1, s[8:11], s24 offen offset:2048 sc1 lds
s_add_u32 m0, s47, 4992
s_nop 0
buffer_load_dwordx4 v1, s[8:11], s24 offen offset:128 sc1 lds
buffer_load_dwordx4 v1, s[8:11], s24 offen offset:2176 sc1 lds
s_add_u32 s46, s46, 1048576
s_add_u32 s47, s47, 32768
s_and_b32 s47, s47, 131071
v_and_b32 v13, 0x380, v6
v_add_u32 v13, v13, v6
s_lshr_b32 s24, s17, 1
s_xor_b32 s24, s24, s42
s_bitcmp1_b32 s24, 0
s_cbranch_scc1 L_at_qg
s_and_b32 s24, s17, 1
s_lshl_b32 s24, s24, 15
s_add_u32 s24, s24, 98304
v_add_u32 v13, s24, v13
v_pk_mul_f32 v[20:21], v[160:161], s[40:41] op_sel_hi:[1,0]
v_pk_mul_f32 v[22:23], v[162:163], s[40:41] op_sel_hi:[1,0]
v_cvt_pk_bf16_f32 v32, v20, v21
v_cvt_pk_bf16_f32 v33, v22, v23
v_pk_mul_f32 v[20:21], v[192:193], s[40:41] op_sel_hi:[1,0]
v_pk_mul_f32 v[22:23], v[194:195], s[40:41] op_sel_hi:[1,0]
v_cvt_pk_bf16_f32 v34, v20, v21
v_cvt_pk_bf16_f32 v35, v22, v23
ds_write_b128 v13, v[32:35]
v_pk_mul_f32 v[24:25], v[164:165], s[40:41] op_sel_hi:[1,0]
v_pk_mul_f32 v[26:27], v[166:167], s[40:41] op_sel_hi:[1,0]
v_cvt_pk_bf16_f32 v36, v24, v25
v_cvt_pk_bf16_f32 v37, v26, v27
v_pk_mul_f32 v[24:25], v[196:197], s[40:41] op_sel_hi:[1,0]
v_pk_mul_f32 v[26:27], v[198:199], s[40:41] op_sel_hi:[1,0]
v_cvt_pk_bf16_f32 v38, v24, v25
v_cvt_pk_bf16_f32 v39, v26, v27
ds_write_b128 v13, v[36:39] offset:128
v_pk_mul_f32 v[20:21], v[168:169], s[40:41] op_sel_hi:[1,0]
v_pk_mul_f32 v[22:23], v[170:171], s[40:41] op_sel_hi:[1,0]
v_cvt_pk_bf16_f32 v40, v20, v21
v_cvt_pk_bf16_f32 v41, v22, v23
v_pk_mul_f32 v[20:21], v[200:201], s[40:41] op_sel_hi:[1,0]
v_pk_mul_f32 v[22:23], v[202:203], s[40:41] op_sel_hi:[1,0]
v_cvt_pk_bf16_f32 v42, v20, v21
v_cvt_pk_bf16_f32 v43, v22, v23
ds_write_b128 v13, v[40:43] offset:8192
v_pk_mul_f32 v[24:25], v[172:173], s[40:41] op_sel_hi:[1,0]
v_pk_mul_f32 v[26:27], v[174:175], s[40:41] op_sel_hi:[1,0]
v_cvt_pk_bf16_f32 v44, v24, v25
v_cvt_pk_bf16_f32 v45, v26, v27
v_pk_mul_f32 v[24:25], v[204:205], s[40:41] op_sel_hi:[1,0]
v_pk_mul_f32 v[26:27], v[206:207], s[40:41] op_sel_hi:[1,0]
v_cvt_pk_bf16_f32 v46, v24, v25
v_cvt_pk_bf16_f32 v47, v26, v27
ds_write_b128 v13, v[44:47] offset:8320
v_pk_mul_f32 v[20:21], v[176:177], s[40:41] op_sel_hi:[1,0]
v_pk_mul_f32 v[22:23], v[178:179], s[40:41] op_sel_hi:[1,0]
v_cvt_pk_bf16_f32 v48, v20, v21
v_cvt_pk_bf16_f32 v49, v22, v23
v_pk_mul_f32 v[20:21], v[208:209], s[40:41] op_sel_hi:[1,0]
v_pk_mul_f32 v[22:23], v[210:211], s[40:41] op_sel_hi:[1,0]
v_cvt_pk_bf16_f32 v50, v20, v21
v_cvt_pk_bf16_f32 v51, v22, v23
ds_write_b128 v13, v[48:51] offset:16384
v_pk_mul_f32 v[24:25], v[180:181], s[40:41] op_sel_hi:[1,0]
v_pk_mul_f32 v[26:27], v[182:183], s[40:41] op_sel_hi:[1,0]
v_cvt_pk_bf16_f32 v52, v24, v25
v_cvt_pk_bf16_f32 v53, v26, v27
v_pk_mul_f32 v[24:25], v[212:213], s[40:41] op_sel_hi:[1,0]
v_pk_mul_f32 v[26:27], v[214:215], s[40:41] op_sel_hi:[1,0]
v_cvt_pk_bf16_f32 v54, v24, v25
v_cvt_pk_bf16_f32 v55, v26, v27
ds_write_b128 v13, v[52:55] offset:16512
v_pk_mul_f32 v[20:21], v[184:185], s[40:41] op_sel_hi:[1,0]
v_pk_mul_f32 v[22:23], v[186:187], s[40:41] op_sel_hi:[1,0]
v_cvt_pk_bf16_f32 v56, v20, v21
v_cvt_pk_bf16_f32 v57, v22, v23
v_pk_mul_f32 v[20:21], v[216:217], s[40:41] op_sel_hi:[1,0]
v_pk_mul_f32 v[22:23], v[218:219], s[40:41] op_sel_hi:[1,0]
v_cvt_pk_bf16_f32 v58, v20, v21
v_cvt_pk_bf16_f32 v59, v22, v23
ds_write_b128 v13, v[56:59] offset:24576
v_pk_mul_f32 v[24:25], v[188:189], s[40:41] op_sel_hi:[1,0]
v_pk_mul_f32 v[26:27], v[190:191], s[40:41] op_sel_hi:[1,0]
v_cvt_pk_bf16_f32 v60, v24, v25
v_cvt_pk_bf16_f32 v61, v26, v27
v_pk_mul_f32 v[24:25], v[220:221], s[40:41] op_sel_hi:[1,0]
v_pk_mul_f32 v[26:27], v[222:223], s[40:41] op_sel_hi:[1,0]
v_cvt_pk_bf16_f32 v62, v24, v25
v_cvt_pk_bf16_f32 v63, v26, v27
ds_write_b128 v13, v[60:63] offset:24704
v_pk_mul_f32 v[20:21], v[224:225], s[40:41] op_sel_hi:[1,0]
v_pk_mul_f32 v[22:23], v[226:227], s[40:41] op_sel_hi:[1,0]
v_cvt_pk_bf16_f32 v64, v20, v21
v_cvt_pk_bf16_f32 v65, v22, v23
v_accvgpr_read_b32 v20, a0
v_accvgpr_read_b32 v21, a1
v_accvgpr_read_b32 v22, a2
v_accvgpr_read_b32 v23, a3
v_pk_mul_f32 v[20:21], v[20:21], s[40:41] op_sel_hi:[1,0]
v_pk_mul_f32 v[22:23], v[22:23], s[40:41] op_sel_hi:[1,0]
v_cvt_pk_bf16_f32 v66, v20, v21
v_cvt_pk_bf16_f32 v67, v22, v23
ds_write_b128 v13, v[64:67] offset:2048
v_pk_mul_f32 v[24:25], v[228:229], s[40:41] op_sel_hi:[1,0]
v_pk_mul_f32 v[26:27], v[230:231], s[40:41] op_sel_hi:[1,0]
v_cvt_pk_bf16_f32 v68, v24, v25
v_cvt_pk_bf16_f32 v69, v26, v27
v_accvgpr_read_b32 v24, a4
v_accvgpr_read_b32 v25, a5
v_accvgpr_read_b32 v26, a6
v_accvgpr_read_b32 v27, a7
v_pk_mul_f32 v[24:25], v[24:25], s[40:41] op_sel_hi:[1,0]
v_pk_mul_f32 v[26:27], v[26:27], s[40:41] op_sel_hi:[1,0]
v_cvt_pk_bf16_f32 v70, v24, v25
v_cvt_pk_bf16_f32 v71, v26, v27
ds_write_b128 v13, v[68:71] offset:2176
v_pk_mul_f32 v[20:21], v[232:233], s[40:41] op_sel_hi:[1,0]
v_pk_mul_f32 v[22:23], v[234:235], s[40:41] op_sel_hi:[1,0]
v_cvt_pk_bf16_f32 v72, v20, v21
v_cvt_pk_bf16_f32 v73, v22, v23
v_accvgpr_read_b32 v20, a8
v_accvgpr_read_b32 v21, a9
v_accvgpr_read_b32 v22, a10
v_accvgpr_read_b32 v23, a11
v_pk_mul_f32 v[20:21], v[20:21], s[40:41] op_sel_hi:[1,0]
v_pk_mul_f32 v[22:23], v[22:23], s[40:41] op_sel_hi:[1,0]
v_cvt_pk_bf16_f32 v74, v20, v21
v_cvt_pk_bf16_f32 v75, v22, v23
ds_write_b128 v13, v[72:75] offset:10240
v_pk_mul_f32 v[24:25], v[236:237], s[40:41] op_sel_hi:[1,0]
v_pk_mul_f32 v[26:27], v[238:239], s[40:41] op_sel_hi:[1,0]
v_cvt_pk_bf16_f32 v76, v24, v25
v_cvt_pk_bf16_f32 v77, v26, v27
v_accvgpr_read_b32 v24, a12
v_accvgpr_read_b32 v25, a13
v_accvgpr_read_b32 v26, a14
v_accvgpr_read_b32 v27, a15
v_pk_mul_f32 v[24:25], v[24:25], s[40:41] op_sel_hi:[1,0]
v_pk_mul_f32 v[26:27], v[26:27], s[40:41] op_sel_hi:[1,0]
v_cvt_pk_bf16_f32 v78, v24, v25
v_cvt_pk_bf16_f32 v79, v26, v27
ds_write_b128 v13, v[76:79] offset:10368
v_pk_mul_f32 v[20:21], v[240:241], s[40:41] op_sel_hi:[1,0]
v_pk_mul_f32 v[22:23], v[242:243], s[40:41] op_sel_hi:[1,0]
v_cvt_pk_bf16_f32 v80, v20, v21
v_cvt_pk_bf16_f32 v81, v22, v23
v_accvgpr_read_b32 v20, a16
v_accvgpr_read_b32 v21, a17
v_accvgpr_read_b32 v22, a18
v_accvgpr_read_b32 v23, a19
v_pk_mul_f32 v[20:21], v[20:21], s[40:41] op_sel_hi:[1,0]
v_pk_mul_f32 v[22:23], v[22:23], s[40:41] op_sel_hi:[1,0]
v_cvt_pk_bf16_f32 v82, v20, v21
v_cvt_pk_bf16_f32 v83, v22, v23
ds_write_b128 v13, v[80:83] offset:18432
v_pk_mul_f32 v[24:25], v[244:245], s[40:41] op_sel_hi:[1,0]
v_pk_mul_f32 v[26:27], v[246:247], s[40:41] op_sel_hi:[1,0]
v_cvt_pk_bf16_f32 v84, v24, v25
v_cvt_pk_bf16_f32 v85, v26, v27
v_accvgpr_read_b32 v24, a20
v_accvgpr_read_b32 v25, a21
v_accvgpr_read_b32 v26, a22
v_accvgpr_read_b32 v27, a23
v_pk_mul_f32 v[24:25], v[24:25], s[40:41] op_sel_hi:[1,0]
v_pk_mul_f32 v[26:27], v[26:27], s[40:41] op_sel_hi:[1,0]
v_cvt_pk_bf16_f32 v86, v24, v25
v_cvt_pk_bf16_f32 v87, v26, v27
ds_write_b128 v13, v[84:87] offset:18560
v_pk_mul_f32 v[20:21], v[248:249], s[40:41] op_sel_hi:[1,0]
v_pk_mul_f32 v[22:23], v[250:251], s[40:41] op_sel_hi:[1,0]
v_cvt_pk_bf16_f32 v88, v20, v21
v_cvt_pk_bf16_f32 v89, v22, v23
v_accvgpr_read_b32 v20, a24
v_accvgpr_read_b32 v21, a25
v_accvgpr_read_b32 v22, a26
v_accvgpr_read_b32 v23, a27
v_pk_mul_f32 v[20:21], v[20:21], s[40:41] op_sel_hi:[1,0]
v_pk_mul_f32 v[22:23], v[22:23], s[40:41] op_sel_hi:[1,0]
v_cvt_pk_bf16_f32 v90, v20, v21
v_cvt_pk_bf16_f32 v91, v22, v23
ds_write_b128 v13, v[88:91] offset:26624
v_pk_mul_f32 v[24:25], v[252:253], s[40:41] op_sel_hi:[1,0]
v_pk_mul_f32 v[26:27], v[254:255], s[40:41] op_sel_hi:[1,0]
v_cvt_pk_bf16_f32 v92, v24, v25
v_cvt_pk_bf16_f32 v93, v26, v27
v_accvgpr_read_b32 v24, a28
v_accvgpr_read_b32 v25, a29
v_accvgpr_read_b32 v26, a30
v_accvgpr_read_b32 v27, a31
v_pk_mul_f32 v[24:25], v[24:25], s[40:41] op_sel_hi:[1,0]
v_pk_mul_f32 v[26:27], v[26:27], s[40:41] op_sel_hi:[1,0]
v_cvt_pk_bf16_f32 v94, v24, v25
v_cvt_pk_bf16_f32 v95, v26, v27
ds_write_b128 v13, v[92:95] offset:26752
v_accvgpr_read_b32 v20, a32
v_accvgpr_read_b32 v21, a33
v_accvgpr_read_b32 v22, a34
v_accvgpr_read_b32 v23, a35
v_pk_mul_f32 v[20:21], v[20:21], s[40:41] op_sel_hi:[1,0]
v_pk_mul_f32 v[22:23], v[22:23], s[40:41] op_sel_hi:[1,0]
v_cvt_pk_bf16_f32 v96, v20, v21
v_cvt_pk_bf16_f32 v97, v22, v23
v_accvgpr_read_b32 v20, a64
v_accvgpr_read_b32 v21, a65
v_accvgpr_read_b32 v22, a66
v_accvgpr_read_b32 v23, a67
v_pk_mul_f32 v[20:21], v[20:21], s[40:41] op_sel_hi:[1,0]
v_pk_mul_f32 v[22:23], v[22:23], s[40:41] op_sel_hi:[1,0]
v_cvt_pk_bf16_f32 v98, v20, v21
v_cvt_pk_bf16_f32 v99, v22, v23
ds_write_b128 v13, v[96:99] offset:4096
v_accvgpr_read_b32 v24, a36
v_accvgpr_read_b32 v25, a37
v_accvgpr_read_b32 v26, a38
v_accvgpr_read_b32 v27, a39
v_pk_mul_f32 v[24:25], v[24:25], s[40:41] op_sel_hi:[1,0]
v_pk_mul_f32 v[26:27], v[26:27], s[40:41] op_sel_hi:[1,0]
v_cvt_pk_bf16_f32 v100, v24, v25
v_cvt_pk_bf16_f32 v101, v26, v27
v_accvgpr_read_b32 v24, a68
v_accvgpr_read_b32 v25, a69
v_accvgpr_read_b32 v26, a70
v_accvgpr_read_b32 v27, a71
v_pk_mul_f32 v[24:25], v[24:25], s[40:41] op_sel_hi:[1,0]
v_pk_mul_f32 v[26:27], v[26:27], s[40:41] op_sel_hi:[1,0]
v_cvt_pk_bf16_f32 v102, v24, v25
v_cvt_pk_bf16_f32 v103, v26, v27
ds_write_b128 v13, v[100:103] offset:4224
v_accvgpr_read_b32 v20, a40
v_accvgpr_read_b32 v21, a41
v_accvgpr_read_b32 v22, a42
v_accvgpr_read_b32 v23, a43
v_pk_mul_f32 v[20:21], v[20:21], s[40:41] op_sel_hi:[1,0]
v_pk_mul_f32 v[22:23], v[22:23], s[40:41] op_sel_hi:[1,0]
v_cvt_pk_bf16_f32 v104, v20, v21
v_cvt_pk_bf16_f32 v105, v22, v23
v_accvgpr_read_b32 v20, a72
v_accvgpr_read_b32 v21, a73
v_accvgpr_read_b32 v22, a74
v_accvgpr_read_b32 v23, a75
v_pk_mul_f32 v[20:21], v[20:21], s[40:41] op_sel_hi:[1,0]
v_pk_mul_f32 v[22:23], v[22:23], s[40:41] op_sel_hi:[1,0]
v_cvt_pk_bf16_f32 v106, v20, v21
v_cvt_pk_bf16_f32 v107, v22, v23
ds_write_b128 v13, v[104:107] offset:12288
v_accvgpr_read_b32 v24, a44
v_accvgpr_read_b32 v25, a45
v_accvgpr_read_b32 v26, a46
v_accvgpr_read_b32 v27, a47
v_pk_mul_f32 v[24:25], v[24:25], s[40:41] op_sel_hi:[1,0]
v_pk_mul_f32 v[26:27], v[26:27], s[40:41] op_sel_hi:[1,0]
v_cvt_pk_bf16_f32 v108, v24, v25
v_cvt_pk_bf16_f32 v109, v26, v27
v_accvgpr_read_b32 v24, a76
v_accvgpr_read_b32 v25, a77
v_accvgpr_read_b32 v26, a78
v_accvgpr_read_b32 v27, a79
v_pk_mul_f32 v[24:25], v[24:25], s[40:41] op_sel_hi:[1,0]
v_pk_mul_f32 v[26:27], v[26:27], s[40:41] op_sel_hi:[1,0]
v_cvt_pk_bf16_f32 v110, v24, v25
v_cvt_pk_bf16_f32 v111, v26, v27
ds_write_b128 v13, v[108:111] offset:12416
v_accvgpr_read_b32 v20, a48
v_accvgpr_read_b32 v21, a49
v_accvgpr_read_b32 v22, a50
v_accvgpr_read_b32 v23, a51
v_pk_mul_f32 v[20:21], v[20:21], s[40:41] op_sel_hi:[1,0]
v_pk_mul_f32 v[22:23], v[22:23], s[40:41] op_sel_hi:[1,0]
v_cvt_pk_bf16_f32 v112, v20, v21
v_cvt_pk_bf16_f32 v113, v22, v23
v_accvgpr_read_b32 v20, a80
v_accvgpr_read_b32 v21, a81
v_accvgpr_read_b32 v22, a82
v_accvgpr_read_b32 v23, a83
v_pk_mul_f32 v[20:21], v[20:21], s[40:41] op_sel_hi:[1,0]
v_pk_mul_f32 v[22:23], v[22:23], s[40:41] op_sel_hi:[1,0]
v_cvt_pk_bf16_f32 v114, v20, v21
v_cvt_pk_bf16_f32 v115, v22, v23
ds_write_b128 v13, v[112:115] offset:20480
v_accvgpr_read_b32 v24, a52
v_accvgpr_read_b32 v25, a53
v_accvgpr_read_b32 v26, a54
v_accvgpr_read_b32 v27, a55
v_pk_mul_f32 v[24:25], v[24:25], s[40:41] op_sel_hi:[1,0]
v_pk_mul_f32 v[26:27], v[26:27], s[40:41] op_sel_hi:[1,0]
v_cvt_pk_bf16_f32 v116, v24, v25
v_cvt_pk_bf16_f32 v117, v26, v27
v_accvgpr_read_b32 v24, a84
v_accvgpr_read_b32 v25, a85
v_accvgpr_read_b32 v26, a86
v_accvgpr_read_b32 v27, a87
v_pk_mul_f32 v[24:25], v[24:25], s[40:41] op_sel_hi:[1,0]
v_pk_mul_f32 v[26:27], v[26:27], s[40:41] op_sel_hi:[1,0]
v_cvt_pk_bf16_f32 v118, v24, v25
v_cvt_pk_bf16_f32 v119, v26, v27
ds_write_b128 v13, v[116:119] offset:20608
v_accvgpr_read_b32 v20, a56
v_accvgpr_read_b32 v21, a57
v_accvgpr_read_b32 v22, a58
v_accvgpr_read_b32 v23, a59
v_pk_mul_f32 v[20:21], v[20:21], s[40:41] op_sel_hi:[1,0]
v_pk_mul_f32 v[22:23], v[22:23], s[40:41] op_sel_hi:[1,0]
v_cvt_pk_bf16_f32 v120, v20, v21
v_cvt_pk_bf16_f32 v121, v22, v23
v_accvgpr_read_b32 v20, a88
v_accvgpr_read_b32 v21, a89
v_accvgpr_read_b32 v22, a90
v_accvgpr_read_b32 v23, a91
v_pk_mul_f32 v[20:21], v[20:21], s[40:41] op_sel_hi:[1,0]
v_pk_mul_f32 v[22:23], v[22:23], s[40:41] op_sel_hi:[1,0]
v_cvt_pk_bf16_f32 v122, v20, v21
v_cvt_pk_bf16_f32 v123, v22, v23
ds_write_b128 v13, v[120:123] offset:28672
v_accvgpr_read_b32 v24, a60
v_accvgpr_read_b32 v25, a61
v_accvgpr_read_b32 v26, a62
v_accvgpr_read_b32 v27, a63
v_pk_mul_f32 v[24:25], v[24:25], s[40:41] op_sel_hi:[1,0]
v_pk_mul_f32 v[26:27], v[26:27], s[40:41] op_sel_hi:[1,0]
v_cvt_pk_bf16_f32 v124, v24, v25
v_cvt_pk_bf16_f32 v125, v26, v27
v_accvgpr_read_b32 v24, a92
v_accvgpr_read_b32 v25, a93
v_accvgpr_read_b32 v26, a94
v_accvgpr_read_b32 v27, a95
v_pk_mul_f32 v[24:25], v[24:25], s[40:41] op_sel_hi:[1,0]
v_pk_mul_f32 v[26:27], v[26:27], s[40:41] op_sel_hi:[1,0]
v_cvt_pk_bf16_f32 v126, v24, v25
v_cvt_pk_bf16_f32 v127, v26, v27
ds_write_b128 v13, v[124:127] offset:28800
v_accvgpr_read_b32 v20, a96
v_accvgpr_read_b32 v21, a97
v_accvgpr_read_b32 v22, a98
v_accvgpr_read_b32 v23, a99
v_pk_mul_f32 v[20:21], v[20:21], s[40:41] op_sel_hi:[1,0]
v_pk_mul_f32 v[22:23], v[22:23], s[40:41] op_sel_hi:[1,0]
v_cvt_pk_bf16_f32 v128, v20, v21
v_cvt_pk_bf16_f32 v129, v22, v23
v_accvgpr_read_b32 v20, a128
v_accvgpr_read_b32 v21, a129
v_accvgpr_read_b32 v22, a130
v_accvgpr_read_b32 v23, a131
v_pk_mul_f32 v[20:21], v[20:21], s[40:41] op_sel_hi:[1,0]
v_pk_mul_f32 v[22:23], v[22:23], s[40:41] op_sel_hi:[1,0]
v_cvt_pk_bf16_f32 v130, v20, v21
v_cvt_pk_bf16_f32 v131, v22, v23
ds_write_b128 v13, v[128:131] offset:6144
v_accvgpr_read_b32 v24, a100
v_accvgpr_read_b32 v25, a101
v_accvgpr_read_b32 v26, a102
v_accvgpr_read_b32 v27, a103
v_pk_mul_f32 v[24:25], v[24:25], s[40:41] op_sel_hi:[1,0]
v_pk_mul_f32 v[26:27], v[26:27], s[40:41] op_sel_hi:[1,0]
v_cvt_pk_bf16_f32 v132, v24, v25
v_cvt_pk_bf16_f32 v133, v26, v27
v_accvgpr_read_b32 v24, a132
v_accvgpr_read_b32 v25, a133
v_accvgpr_read_b32 v26, a134
v_accvgpr_read_b32 v27, a135
v_pk_mul_f32 v[24:25], v[24:25], s[40:41] op_sel_hi:[1,0]
v_pk_mul_f32 v[26:27], v[26:27], s[40:41] op_sel_hi:[1,0]
v_cvt_pk_bf16_f32 v134, v24, v25
v_cvt_pk_bf16_f32 v135, v26, v27
ds_write_b128 v13, v[132:135] offset:6272
v_accvgpr_read_b32 v20, a104
v_accvgpr_read_b32 v21, a105
v_accvgpr_read_b32 v22, a106
v_accvgpr_read_b32 v23, a107
v_pk_mul_f32 v[20:21], v[20:21], s[40:41] op_sel_hi:[1,0]
v_pk_mul_f32 v[22:23], v[22:23], s[40:41] op_sel_hi:[1,0]
v_cvt_pk_bf16_f32 v136, v20, v21
v_cvt_pk_bf16_f32 v137, v22, v23
v_accvgpr_read_b32 v20, a136
v_accvgpr_read_b32 v21, a137
v_accvgpr_read_b32 v22, a138
v_accvgpr_read_b32 v23, a139
v_pk_mul_f32 v[20:21], v[20:21], s[40:41] op_sel_hi:[1,0]
v_pk_mul_f32 v[22:23], v[22:23], s[40:41] op_sel_hi:[1,0]
v_cvt_pk_bf16_f32 v138, v20, v21
v_cvt_pk_bf16_f32 v139, v22, v23
ds_write_b128 v13, v[136:139] offset:14336
v_accvgpr_read_b32 v24, a108
v_accvgpr_read_b32 v25, a109
v_accvgpr_read_b32 v26, a110
v_accvgpr_read_b32 v27, a111
v_pk_mul_f32 v[24:25], v[24:25], s[40:41] op_sel_hi:[1,0]
v_pk_mul_f32 v[26:27], v[26:27], s[40:41] op_sel_hi:[1,0]
v_cvt_pk_bf16_f32 v140, v24, v25
v_cvt_pk_bf16_f32 v141, v26, v27
v_accvgpr_read_b32 v24, a140
v_accvgpr_read_b32 v25, a141
v_accvgpr_read_b32 v26, a142
v_accvgpr_read_b32 v27, a143
v_pk_mul_f32 v[24:25], v[24:25], s[40:41] op_sel_hi:[1,0]
v_pk_mul_f32 v[26:27], v[26:27], s[40:41] op_sel_hi:[1,0]
v_cvt_pk_bf16_f32 v142, v24, v25
v_cvt_pk_bf16_f32 v143, v26, v27
ds_write_b128 v13, v[140:143] offset:14464
v_accvgpr_read_b32 v20, a112
v_accvgpr_read_b32 v21, a113
v_accvgpr_read_b32 v22, a114
v_accvgpr_read_b32 v23, a115
v_pk_mul_f32 v[20:21], v[20:21], s[40:41] op_sel_hi:[1,0]
v_pk_mul_f32 v[22:23], v[22:23], s[40:41] op_sel_hi:[1,0]
v_cvt_pk_bf16_f32 v144, v20, v21
v_cvt_pk_bf16_f32 v145, v22, v23
v_accvgpr_read_b32 v20, a144
v_accvgpr_read_b32 v21, a145
v_accvgpr_read_b32 v22, a146
v_accvgpr_read_b32 v23, a147
v_pk_mul_f32 v[20:21], v[20:21], s[40:41] op_sel_hi:[1,0]
v_pk_mul_f32 v[22:23], v[22:23], s[40:41] op_sel_hi:[1,0]
v_cvt_pk_bf16_f32 v146, v20, v21
v_cvt_pk_bf16_f32 v147, v22, v23
ds_write_b128 v13, v[144:147] offset:22528
v_accvgpr_read_b32 v24, a116
v_accvgpr_read_b32 v25, a117
v_accvgpr_read_b32 v26, a118
v_accvgpr_read_b32 v27, a119
v_pk_mul_f32 v[24:25], v[24:25], s[40:41] op_sel_hi:[1,0]
v_pk_mul_f32 v[26:27], v[26:27], s[40:41] op_sel_hi:[1,0]
v_cvt_pk_bf16_f32 v148, v24, v25
v_cvt_pk_bf16_f32 v149, v26, v27
v_accvgpr_read_b32 v24, a148
v_accvgpr_read_b32 v25, a149
v_accvgpr_read_b32 v26, a150
v_accvgpr_read_b32 v27, a151
v_pk_mul_f32 v[24:25], v[24:25], s[40:41] op_sel_hi:[1,0]
v_pk_mul_f32 v[26:27], v[26:27], s[40:41] op_sel_hi:[1,0]
v_cvt_pk_bf16_f32 v150, v24, v25
v_cvt_pk_bf16_f32 v151, v26, v27
ds_write_b128 v13, v[148:151] offset:22656
v_accvgpr_read_b32 v20, a120
v_accvgpr_read_b32 v21, a121
v_accvgpr_read_b32 v22, a122
v_accvgpr_read_b32 v23, a123
v_pk_mul_f32 v[20:21], v[20:21], s[40:41] op_sel_hi:[1,0]
v_pk_mul_f32 v[22:23], v[22:23], s[40:41] op_sel_hi:[1,0]
v_cvt_pk_bf16_f32 v152, v20, v21
v_cvt_pk_bf16_f32 v153, v22, v23
v_accvgpr_read_b32 v20, a152
v_accvgpr_read_b32 v21, a153
v_accvgpr_read_b32 v22, a154
v_accvgpr_read_b32 v23, a155
v_pk_mul_f32 v[20:21], v[20:21], s[40:41] op_sel_hi:[1,0]
v_pk_mul_f32 v[22:23], v[22:23], s[40:41] op_sel_hi:[1,0]
v_cvt_pk_bf16_f32 v154, v20, v21
v_cvt_pk_bf16_f32 v155, v22, v23
ds_write_b128 v13, v[152:155] offset:30720
v_accvgpr_read_b32 v24, a124
v_accvgpr_read_b32 v25, a125
v_accvgpr_read_b32 v26, a126
v_accvgpr_read_b32 v27, a127
v_pk_mul_f32 v[24:25], v[24:25], s[40:41] op_sel_hi:[1,0]
v_pk_mul_f32 v[26:27], v[26:27], s[40:41] op_sel_hi:[1,0]
v_cvt_pk_bf16_f32 v156, v24, v25
v_cvt_pk_bf16_f32 v157, v26, v27
v_accvgpr_read_b32 v24, a156
v_accvgpr_read_b32 v25, a157
v_accvgpr_read_b32 v26, a158
v_accvgpr_read_b32 v27, a159
v_pk_mul_f32 v[24:25], v[24:25], s[40:41] op_sel_hi:[1,0]
v_pk_mul_f32 v[26:27], v[26:27], s[40:41] op_sel_hi:[1,0]
v_cvt_pk_bf16_f32 v158, v24, v25
v_cvt_pk_bf16_f32 v159, v26, v27
ds_write_b128 v13, v[156:159] offset:30848
s_waitcnt vmcnt(16) lgkmcnt(0)
s_branch L_at_qx
L_at_qg:
v_pk_mul_f32 v[20:21], v[160:161], s[40:41] op_sel_hi:[1,0]
v_pk_mul_f32 v[22:23], v[162:163], s[40:41] op_sel_hi:[1,0]
v_cvt_pk_bf16_f32 v32, v20, v21
v_cvt_pk_bf16_f32 v33, v22, v23
v_pk_mul_f32 v[20:21], v[192:193], s[40:41] op_sel_hi:[1,0]
v_pk_mul_f32 v[22:23], v[194:195], s[40:41] op_sel_hi:[1,0]
v_cvt_pk_bf16_f32 v34, v20, v21
v_cvt_pk_bf16_f32 v35, v22, v23
s_add_u32 s24, s96, 0
buffer_store_dwordx4 v[32:35], v13, s[8:11], s24 offen sc1
v_pk_mul_f32 v[24:25], v[164:165], s[40:41] op_sel_hi:[1,0]
v_pk_mul_f32 v[26:27], v[166:167], s[40:41] op_sel_hi:[1,0]
v_cvt_pk_bf16_f32 v36, v24, v25
v_cvt_pk_bf16_f32 v37, v26, v27
v_pk_mul_f32 v[24:25], v[196:197], s[40:41] op_sel_hi:[1,0]
v_pk_mul_f32 v[26:27], v[198:199], s[40:41] op_sel_hi:[1,0]
v_cvt_pk_bf16_f32 v38, v24, v25
v_cvt_pk_bf16_f32 v39, v26, v27
buffer_store_dwordx4 v[36:39], v13, s[8:11], s24 offen offset:128 sc1
v_pk_mul_f32 v[20:21], v[168:169], s[40:41] op_sel_hi:[1,0]
v_pk_mul_f32 v[22:23], v[170:171], s[40:41] op_sel_hi:[1,0]
v_cvt_pk_bf16_f32 v40, v20, v21
v_cvt_pk_bf16_f32 v41, v22, v23
v_pk_mul_f32 v[20:21], v[200:201], s[40:41] op_sel_hi:[1,0]
v_pk_mul_f32 v[22:23], v[202:203], s[40:41] op_sel_hi:[1,0]
v_cvt_pk_bf16_f32 v42, v20, v21
v_cvt_pk_bf16_f32 v43, v22, v23
s_add_u32 s24, s96, 262144
buffer_store_dwordx4 v[40:43], v13, s[8:11], s24 offen sc1
v_pk_mul_f32 v[24:25], v[172:173], s[40:41] op_sel_hi:[1,0]
v_pk_mul_f32 v[26:27], v[174:175], s[40:41] op_sel_hi:[1,0]
v_cvt_pk_bf16_f32 v44, v24, v25
v_cvt_pk_bf16_f32 v45, v26, v27
v_pk_mul_f32 v[24:25], v[204:205], s[40:41] op_sel_hi:[1,0]
v_pk_mul_f32 v[26:27], v[206:207], s[40:41] op_sel_hi:[1,0]
v_cvt_pk_bf16_f32 v46, v24, v25
v_cvt_pk_bf16_f32 v47, v26, v27
buffer_store_dwordx4 v[44:47], v13, s[8:11], s24 offen offset:128 sc1
v_pk_mul_f32 v[20:21], v[176:177], s[40:41] op_sel_hi:[1,0]
v_pk_mul_f32 v[22:23], v[178:179], s[40:41] op_sel_hi:[1,0]
v_cvt_pk_bf16_f32 v48, v20, v21
v_cvt_pk_bf16_f32 v49, v22, v23
v_pk_mul_f32 v[20:21], v[208:209], s[40:41] op_sel_hi:[1,0]
v_pk_mul_f32 v[22:23], v[210:211], s[40:41] op_sel_hi:[1,0]
v_cvt_pk_bf16_f32 v50, v20, v21
v_cvt_pk_bf16_f32 v51, v22, v23
s_add_u32 s24, s96, 524288
buffer_store_dwordx4 v[48:51], v13, s[8:11], s24 offen sc1
v_pk_mul_f32 v[24:25], v[180:181], s[40:41] op_sel_hi:[1,0]
v_pk_mul_f32 v[26:27], v[182:183], s[40:41] op_sel_hi:[1,0]
v_cvt_pk_bf16_f32 v52, v24, v25
v_cvt_pk_bf16_f32 v53, v26, v27
v_pk_mul_f32 v[24:25], v[212:213], s[40:41] op_sel_hi:[1,0]
v_pk_mul_f32 v[26:27], v[214:215], s[40:41] op_sel_hi:[1,0]
v_cvt_pk_bf16_f32 v54, v24, v25
v_cvt_pk_bf16_f32 v55, v26, v27
buffer_store_dwordx4 v[52:55], v13, s[8:11], s24 offen offset:128 sc1
v_pk_mul_f32 v[20:21], v[184:185], s[40:41] op_sel_hi:[1,0]
v_pk_mul_f32 v[22:23], v[186:187], s[40:41] op_sel_hi:[1,0]
v_cvt_pk_bf16_f32 v56, v20, v21
v_cvt_pk_bf16_f32 v57, v22, v23
v_pk_mul_f32 v[20:21], v[216:217], s[40:41] op_sel_hi:[1,0]
v_pk_mul_f32 v[22:23], v[218:219], s[40:41] op_sel_hi:[1,0]
v_cvt_pk_bf16_f32 v58, v20, v21
v_cvt_pk_bf16_f32 v59, v22, v23
s_add_u32 s24, s96, 786432
buffer_store_dwordx4 v[56:59], v13, s[8:11], s24 offen sc1
v_pk_mul_f32 v[24:25], v[188:189], s[40:41] op_sel_hi:[1,0]
v_pk_mul_f32 v[26:27], v[190:191], s[40:41] op_sel_hi:[1,0]
v_cvt_pk_bf16_f32 v60, v24, v25
v_cvt_pk_bf16_f32 v61, v26, v27
v_pk_mul_f32 v[24:25], v[220:221], s[40:41] op_sel_hi:[1,0]
v_pk_mul_f32 v[26:27], v[222:223], s[40:41] op_sel_hi:[1,0]
v_cvt_pk_bf16_f32 v62, v24, v25
v_cvt_pk_bf16_f32 v63, v26, v27
buffer_store_dwordx4 v[60:63], v13, s[8:11], s24 offen offset:128 sc1
v_pk_mul_f32 v[20:21], v[224:225], s[40:41] op_sel_hi:[1,0]
v_pk_mul_f32 v[22:23], v[226:227], s[40:41] op_sel_hi:[1,0]
v_cvt_pk_bf16_f32 v64, v20, v21
v_cvt_pk_bf16_f32 v65, v22, v23
v_accvgpr_read_b32 v20, a0
v_accvgpr_read_b32 v21, a1
v_accvgpr_read_b32 v22, a2
v_accvgpr_read_b32 v23, a3
v_pk_mul_f32 v[20:21], v[20:21], s[40:41] op_sel_hi:[1,0]
v_pk_mul_f32 v[22:23], v[22:23], s[40:41] op_sel_hi:[1,0]
v_cvt_pk_bf16_f32 v66, v20, v21
v_cvt_pk_bf16_f32 v67, v22, v23
s_add_u32 s24, s96, 2048
buffer_store_dwordx4 v[64:67], v13, s[8:11], s24 offen sc1
v_pk_mul_f32 v[24:25], v[228:229], s[40:41] op_sel_hi:[1,0]
v_pk_mul_f32 v[26:27], v[230:231], s[40:41] op_sel_hi:[1,0]
v_cvt_pk_bf16_f32 v68, v24, v25
v_cvt_pk_bf16_f32 v69, v26, v27
v_accvgpr_read_b32 v24, a4
v_accvgpr_read_b32 v25, a5
v_accvgpr_read_b32 v26, a6
v_accvgpr_read_b32 v27, a7
v_pk_mul_f32 v[24:25], v[24:25], s[40:41] op_sel_hi:[1,0]
v_pk_mul_f32 v[26:27], v[26:27], s[40:41] op_sel_hi:[1,0]
v_cvt_pk_bf16_f32 v70, v24, v25
v_cvt_pk_bf16_f32 v71, v26, v27
buffer_store_dwordx4 v[68:71], v13, s[8:11], s24 offen offset:128 sc1
v_pk_mul_f32 v[20:21], v[232:233], s[40:41] op_sel_hi:[1,0]
v_pk_mul_f32 v[22:23], v[234:235], s[40:41] op_sel_hi:[1,0]
v_cvt_pk_bf16_f32 v72, v20, v21
v_cvt_pk_bf16_f32 v73, v22, v23
v_accvgpr_read_b32 v20, a8
v_accvgpr_read_b32 v21, a9
v_accvgpr_read_b32 v22, a10
v_accvgpr_read_b32 v23, a11
v_pk_mul_f32 v[20:21], v[20:21], s[40:41] op_sel_hi:[1,0]
v_pk_mul_f32 v[22:23], v[22:23], s[40:41] op_sel_hi:[1,0]
v_cvt_pk_bf16_f32 v74, v20, v21
v_cvt_pk_bf16_f32 v75, v22, v23
s_add_u32 s24, s96, 264192
buffer_store_dwordx4 v[72:75], v13, s[8:11], s24 offen sc1
v_pk_mul_f32 v[24:25], v[236:237], s[40:41] op_sel_hi:[1,0]
v_pk_mul_f32 v[26:27], v[238:239], s[40:41] op_sel_hi:[1,0]
v_cvt_pk_bf16_f32 v76, v24, v25
v_cvt_pk_bf16_f32 v77, v26, v27
v_accvgpr_read_b32 v24, a12
v_accvgpr_read_b32 v25, a13
v_accvgpr_read_b32 v26, a14
v_accvgpr_read_b32 v27, a15
v_pk_mul_f32 v[24:25], v[24:25], s[40:41] op_sel_hi:[1,0]
v_pk_mul_f32 v[26:27], v[26:27], s[40:41] op_sel_hi:[1,0]
v_cvt_pk_bf16_f32 v78, v24, v25
v_cvt_pk_bf16_f32 v79, v26, v27
buffer_store_dwordx4 v[76:79], v13, s[8:11], s24 offen offset:128 sc1
v_pk_mul_f32 v[20:21], v[240:241], s[40:41] op_sel_hi:[1,0]
v_pk_mul_f32 v[22:23], v[242:243], s[40:41] op_sel_hi:[1,0]
v_cvt_pk_bf16_f32 v80, v20, v21
v_cvt_pk_bf16_f32 v81, v22, v23
v_accvgpr_read_b32 v20, a16
v_accvgpr_read_b32 v21, a17
v_accvgpr_read_b32 v22, a18
v_accvgpr_read_b32 v23, a19
v_pk_mul_f32 v[20:21], v[20:21], s[40:41] op_sel_hi:[1,0]
v_pk_mul_f32 v[22:23], v[22:23], s[40:41] op_sel_hi:[1,0]
v_cvt_pk_bf16_f32 v82, v20, v21
v_cvt_pk_bf16_f32 v83, v22, v23
s_add_u32 s24, s96, 526336
buffer_store_dwordx4 v[80:83], v13, s[8:11], s24 offen sc1
v_pk_mul_f32 v[24:25], v[244:245], s[40:41] op_sel_hi:[1,0]
v_pk_mul_f32 v[26:27], v[246:247], s[40:41] op_sel_hi:[1,0]
v_cvt_pk_bf16_f32 v84, v24, v25
v_cvt_pk_bf16_f32 v85, v26, v27
v_accvgpr_read_b32 v24, a20
v_accvgpr_read_b32 v25, a21
v_accvgpr_read_b32 v26, a22
v_accvgpr_read_b32 v27, a23
v_pk_mul_f32 v[24:25], v[24:25], s[40:41] op_sel_hi:[1,0]
v_pk_mul_f32 v[26:27], v[26:27], s[40:41] op_sel_hi:[1,0]
v_cvt_pk_bf16_f32 v86, v24, v25
v_cvt_pk_bf16_f32 v87, v26, v27
buffer_store_dwordx4 v[84:87], v13, s[8:11], s24 offen offset:128 sc1
v_pk_mul_f32 v[20:21], v[248:249], s[40:41] op_sel_hi:[1,0]
v_pk_mul_f32 v[22:23], v[250:251], s[40:41] op_sel_hi:[1,0]
v_cvt_pk_bf16_f32 v88, v20, v21
v_cvt_pk_bf16_f32 v89, v22, v23
v_accvgpr_read_b32 v20, a24
v_accvgpr_read_b32 v21, a25
v_accvgpr_read_b32 v22, a26
v_accvgpr_read_b32 v23, a27
v_pk_mul_f32 v[20:21], v[20:21], s[40:41] op_sel_hi:[1,0]
v_pk_mul_f32 v[22:23], v[22:23], s[40:41] op_sel_hi:[1,0]
v_cvt_pk_bf16_f32 v90, v20, v21
v_cvt_pk_bf16_f32 v91, v22, v23
s_add_u32 s24, s96, 788480
buffer_store_dwordx4 v[88:91], v13, s[8:11], s24 offen sc1
v_pk_mul_f32 v[24:25], v[252:253], s[40:41] op_sel_hi:[1,0]
v_pk_mul_f32 v[26:27], v[254:255], s[40:41] op_sel_hi:[1,0]
v_cvt_pk_bf16_f32 v92, v24, v25
v_cvt_pk_bf16_f32 v93, v26, v27
v_accvgpr_read_b32 v24, a28
v_accvgpr_read_b32 v25, a29
v_accvgpr_read_b32 v26, a30
v_accvgpr_read_b32 v27, a31
v_pk_mul_f32 v[24:25], v[24:25], s[40:41] op_sel_hi:[1,0]
v_pk_mul_f32 v[26:27], v[26:27], s[40:41] op_sel_hi:[1,0]
v_cvt_pk_bf16_f32 v94, v24, v25
v_cvt_pk_bf16_f32 v95, v26, v27
buffer_store_dwordx4 v[92:95], v13, s[8:11], s24 offen offset:128 sc1
v_accvgpr_read_b32 v20, a32
v_accvgpr_read_b32 v21, a33
v_accvgpr_read_b32 v22, a34
v_accvgpr_read_b32 v23, a35
v_pk_mul_f32 v[20:21], v[20:21], s[40:41] op_sel_hi:[1,0]
v_pk_mul_f32 v[22:23], v[22:23], s[40:41] op_sel_hi:[1,0]
v_cvt_pk_bf16_f32 v96, v20, v21
v_cvt_pk_bf16_f32 v97, v22, v23
v_accvgpr_read_b32 v20, a64
v_accvgpr_read_b32 v21, a65
v_accvgpr_read_b32 v22, a66
v_accvgpr_read_b32 v23, a67
v_pk_mul_f32 v[20:21], v[20:21], s[40:41] op_sel_hi:[1,0]
v_pk_mul_f32 v[22:23], v[22:23], s[40:41] op_sel_hi:[1,0]
v_cvt_pk_bf16_f32 v98, v20, v21
v_cvt_pk_bf16_f32 v99, v22, v23
s_add_u32 s24, s96, 4096
buffer_store_dwordx4 v[96:99], v13, s[8:11], s24 offen sc1
v_accvgpr_read_b32 v24, a36
v_accvgpr_read_b32 v25, a37
v_accvgpr_read_b32 v26, a38
v_accvgpr_read_b32 v27, a39
v_pk_mul_f32 v[24:25], v[24:25], s[40:41] op_sel_hi:[1,0]
v_pk_mul_f32 v[26:27], v[26:27], s[40:41] op_sel_hi:[1,0]
v_cvt_pk_bf16_f32 v100, v24, v25
v_cvt_pk_bf16_f32 v101, v26, v27
v_accvgpr_read_b32 v24, a68
v_accvgpr_read_b32 v25, a69
v_accvgpr_read_b32 v26, a70
v_accvgpr_read_b32 v27, a71
v_pk_mul_f32 v[24:25], v[24:25], s[40:41] op_sel_hi:[1,0]
v_pk_mul_f32 v[26:27], v[26:27], s[40:41] op_sel_hi:[1,0]
v_cvt_pk_bf16_f32 v102, v24, v25
v_cvt_pk_bf16_f32 v103, v26, v27
buffer_store_dwordx4 v[100:103], v13, s[8:11], s24 offen offset:128 sc1
v_accvgpr_read_b32 v20, a40
v_accvgpr_read_b32 v21, a41
v_accvgpr_read_b32 v22, a42
v_accvgpr_read_b32 v23, a43
v_pk_mul_f32 v[20:21], v[20:21], s[40:41] op_sel_hi:[1,0]
v_pk_mul_f32 v[22:23], v[22:23], s[40:41] op_sel_hi:[1,0]
v_cvt_pk_bf16_f32 v104, v20, v21
v_cvt_pk_bf16_f32 v105, v22, v23
v_accvgpr_read_b32 v20, a72
v_accvgpr_read_b32 v21, a73
v_accvgpr_read_b32 v22, a74
v_accvgpr_read_b32 v23, a75
v_pk_mul_f32 v[20:21], v[20:21], s[40:41] op_sel_hi:[1,0]
v_pk_mul_f32 v[22:23], v[22:23], s[40:41] op_sel_hi:[1,0]
v_cvt_pk_bf16_f32 v106, v20, v21
v_cvt_pk_bf16_f32 v107, v22, v23
s_add_u32 s24, s96, 266240
buffer_store_dwordx4 v[104:107], v13, s[8:11], s24 offen sc1
v_accvgpr_read_b32 v24, a44
v_accvgpr_read_b32 v25, a45
v_accvgpr_read_b32 v26, a46
v_accvgpr_read_b32 v27, a47
v_pk_mul_f32 v[24:25], v[24:25], s[40:41] op_sel_hi:[1,0]
v_pk_mul_f32 v[26:27], v[26:27], s[40:41] op_sel_hi:[1,0]
v_cvt_pk_bf16_f32 v108, v24, v25
v_cvt_pk_bf16_f32 v109, v26, v27
v_accvgpr_read_b32 v24, a76
v_accvgpr_read_b32 v25, a77
v_accvgpr_read_b32 v26, a78
v_accvgpr_read_b32 v27, a79
v_pk_mul_f32 v[24:25], v[24:25], s[40:41] op_sel_hi:[1,0]
v_pk_mul_f32 v[26:27], v[26:27], s[40:41] op_sel_hi:[1,0]
v_cvt_pk_bf16_f32 v110, v24, v25
v_cvt_pk_bf16_f32 v111, v26, v27
buffer_store_dwordx4 v[108:111], v13, s[8:11], s24 offen offset:128 sc1
v_accvgpr_read_b32 v20, a48
v_accvgpr_read_b32 v21, a49
v_accvgpr_read_b32 v22, a50
v_accvgpr_read_b32 v23, a51
v_pk_mul_f32 v[20:21], v[20:21], s[40:41] op_sel_hi:[1,0]
v_pk_mul_f32 v[22:23], v[22:23], s[40:41] op_sel_hi:[1,0]
v_cvt_pk_bf16_f32 v112, v20, v21
v_cvt_pk_bf16_f32 v113, v22, v23
v_accvgpr_read_b32 v20, a80
v_accvgpr_read_b32 v21, a81
v_accvgpr_read_b32 v22, a82
v_accvgpr_read_b32 v23, a83
v_pk_mul_f32 v[20:21], v[20:21], s[40:41] op_sel_hi:[1,0]
v_pk_mul_f32 v[22:23], v[22:23], s[40:41] op_sel_hi:[1,0]
v_cvt_pk_bf16_f32 v114, v20, v21
v_cvt_pk_bf16_f32 v115, v22, v23
s_add_u32 s24, s96, 528384
buffer_store_dwordx4 v[112:115], v13, s[8:11], s24 offen sc1
v_accvgpr_read_b32 v24, a52
v_accvgpr_read_b32 v25, a53
v_accvgpr_read_b32 v26, a54
v_accvgpr_read_b32 v27, a55
v_pk_mul_f32 v[24:25], v[24:25], s[40:41] op_sel_hi:[1,0]
v_pk_mul_f32 v[26:27], v[26:27], s[40:41] op_sel_hi:[1,0]
v_cvt_pk_bf16_f32 v116, v24, v25
v_cvt_pk_bf16_f32 v117, v26, v27
v_accvgpr_read_b32 v24, a84
v_accvgpr_read_b32 v25, a85
v_accvgpr_read_b32 v26, a86
v_accvgpr_read_b32 v27, a87
v_pk_mul_f32 v[24:25], v[24:25], s[40:41] op_sel_hi:[1,0]
v_pk_mul_f32 v[26:27], v[26:27], s[40:41] op_sel_hi:[1,0]
v_cvt_pk_bf16_f32 v118, v24, v25
v_cvt_pk_bf16_f32 v119, v26, v27
buffer_store_dwordx4 v[116:119], v13, s[8:11], s24 offen offset:128 sc1
v_accvgpr_read_b32 v20, a56
v_accvgpr_read_b32 v21, a57
v_accvgpr_read_b32 v22, a58
v_accvgpr_read_b32 v23, a59
v_pk_mul_f32 v[20:21], v[20:21], s[40:41] op_sel_hi:[1,0]
v_pk_mul_f32 v[22:23], v[22:23], s[40:41] op_sel_hi:[1,0]
v_cvt_pk_bf16_f32 v120, v20, v21
v_cvt_pk_bf16_f32 v121, v22, v23
v_accvgpr_read_b32 v20, a88
v_accvgpr_read_b32 v21, a89
v_accvgpr_read_b32 v22, a90
v_accvgpr_read_b32 v23, a91
v_pk_mul_f32 v[20:21], v[20:21], s[40:41] op_sel_hi:[1,0]
v_pk_mul_f32 v[22:23], v[22:23], s[40:41] op_sel_hi:[1,0]
v_cvt_pk_bf16_f32 v122, v20, v21
v_cvt_pk_bf16_f32 v123, v22, v23
s_add_u32 s24, s96, 790528
buffer_store_dwordx4 v[120:123], v13, s[8:11], s24 offen sc1
v_accvgpr_read_b32 v24, a60
v_accvgpr_read_b32 v25, a61
v_accvgpr_read_b32 v26, a62
v_accvgpr_read_b32 v27, a63
v_pk_mul_f32 v[24:25], v[24:25], s[40:41] op_sel_hi:[1,0]
v_pk_mul_f32 v[26:27], v[26:27], s[40:41] op_sel_hi:[1,0]
v_cvt_pk_bf16_f32 v124, v24, v25
v_cvt_pk_bf16_f32 v125, v26, v27
v_accvgpr_read_b32 v24, a92
v_accvgpr_read_b32 v25, a93
v_accvgpr_read_b32 v26, a94
v_accvgpr_read_b32 v27, a95
v_pk_mul_f32 v[24:25], v[24:25], s[40:41] op_sel_hi:[1,0]
v_pk_mul_f32 v[26:27], v[26:27], s[40:41] op_sel_hi:[1,0]
v_cvt_pk_bf16_f32 v126, v24, v25
v_cvt_pk_bf16_f32 v127, v26, v27
buffer_store_dwordx4 v[124:127], v13, s[8:11], s24 offen offset:128 sc1
v_accvgpr_read_b32 v20, a96
v_accvgpr_read_b32 v21, a97
v_accvgpr_read_b32 v22, a98
v_accvgpr_read_b32 v23, a99
v_pk_mul_f32 v[20:21], v[20:21], s[40:41] op_sel_hi:[1,0]
v_pk_mul_f32 v[22:23], v[22:23], s[40:41] op_sel_hi:[1,0]
v_cvt_pk_bf16_f32 v128, v20, v21
v_cvt_pk_bf16_f32 v129, v22, v23
v_accvgpr_read_b32 v20, a128
v_accvgpr_read_b32 v21, a129
v_accvgpr_read_b32 v22, a130
v_accvgpr_read_b32 v23, a131
v_pk_mul_f32 v[20:21], v[20:21], s[40:41] op_sel_hi:[1,0]
v_pk_mul_f32 v[22:23], v[22:23], s[40:41] op_sel_hi:[1,0]
v_cvt_pk_bf16_f32 v130, v20, v21
v_cvt_pk_bf16_f32 v131, v22, v23
s_add_u32 s24, s96, 6144
buffer_store_dwordx4 v[128:131], v13, s[8:11], s24 offen sc1
v_accvgpr_read_b32 v24, a100
v_accvgpr_read_b32 v25, a101
v_accvgpr_read_b32 v26, a102
v_accvgpr_read_b32 v27, a103
v_pk_mul_f32 v[24:25], v[24:25], s[40:41] op_sel_hi:[1,0]
v_pk_mul_f32 v[26:27], v[26:27], s[40:41] op_sel_hi:[1,0]
v_cvt_pk_bf16_f32 v132, v24, v25
v_cvt_pk_bf16_f32 v133, v26, v27
v_accvgpr_read_b32 v24, a132
v_accvgpr_read_b32 v25, a133
v_accvgpr_read_b32 v26, a134
v_accvgpr_read_b32 v27, a135
v_pk_mul_f32 v[24:25], v[24:25], s[40:41] op_sel_hi:[1,0]
v_pk_mul_f32 v[26:27], v[26:27], s[40:41] op_sel_hi:[1,0]
v_cvt_pk_bf16_f32 v134, v24, v25
v_cvt_pk_bf16_f32 v135, v26, v27
buffer_store_dwordx4 v[132:135], v13, s[8:11], s24 offen offset:128 sc1
v_accvgpr_read_b32 v20, a104
v_accvgpr_read_b32 v21, a105
v_accvgpr_read_b32 v22, a106
v_accvgpr_read_b32 v23, a107
v_pk_mul_f32 v[20:21], v[20:21], s[40:41] op_sel_hi:[1,0]
v_pk_mul_f32 v[22:23], v[22:23], s[40:41] op_sel_hi:[1,0]
v_cvt_pk_bf16_f32 v136, v20, v21
v_cvt_pk_bf16_f32 v137, v22, v23
v_accvgpr_read_b32 v20, a136
v_accvgpr_read_b32 v21, a137
v_accvgpr_read_b32 v22, a138
v_accvgpr_read_b32 v23, a139
v_pk_mul_f32 v[20:21], v[20:21], s[40:41] op_sel_hi:[1,0]
v_pk_mul_f32 v[22:23], v[22:23], s[40:41] op_sel_hi:[1,0]
v_cvt_pk_bf16_f32 v138, v20, v21
v_cvt_pk_bf16_f32 v139, v22, v23
s_add_u32 s24, s96, 268288
buffer_store_dwordx4 v[136:139], v13, s[8:11], s24 offen sc1
v_accvgpr_read_b32 v24, a108
v_accvgpr_read_b32 v25, a109
v_accvgpr_read_b32 v26, a110
v_accvgpr_read_b32 v27, a111
v_pk_mul_f32 v[24:25], v[24:25], s[40:41] op_sel_hi:[1,0]
v_pk_mul_f32 v[26:27], v[26:27], s[40:41] op_sel_hi:[1,0]
v_cvt_pk_bf16_f32 v140, v24, v25
v_cvt_pk_bf16_f32 v141, v26, v27
v_accvgpr_read_b32 v24, a140
v_accvgpr_read_b32 v25, a141
v_accvgpr_read_b32 v26, a142
v_accvgpr_read_b32 v27, a143
v_pk_mul_f32 v[24:25], v[24:25], s[40:41] op_sel_hi:[1,0]
v_pk_mul_f32 v[26:27], v[26:27], s[40:41] op_sel_hi:[1,0]
v_cvt_pk_bf16_f32 v142, v24, v25
v_cvt_pk_bf16_f32 v143, v26, v27
buffer_store_dwordx4 v[140:143], v13, s[8:11], s24 offen offset:128 sc1
v_accvgpr_read_b32 v20, a112
v_accvgpr_read_b32 v21, a113
v_accvgpr_read_b32 v22, a114
v_accvgpr_read_b32 v23, a115
v_pk_mul_f32 v[20:21], v[20:21], s[40:41] op_sel_hi:[1,0]
v_pk_mul_f32 v[22:23], v[22:23], s[40:41] op_sel_hi:[1,0]
v_cvt_pk_bf16_f32 v144, v20, v21
v_cvt_pk_bf16_f32 v145, v22, v23
v_accvgpr_read_b32 v20, a144
v_accvgpr_read_b32 v21, a145
v_accvgpr_read_b32 v22, a146
v_accvgpr_read_b32 v23, a147
v_pk_mul_f32 v[20:21], v[20:21], s[40:41] op_sel_hi:[1,0]
v_pk_mul_f32 v[22:23], v[22:23], s[40:41] op_sel_hi:[1,0]
v_cvt_pk_bf16_f32 v146, v20, v21
v_cvt_pk_bf16_f32 v147, v22, v23
s_add_u32 s24, s96, 530432
buffer_store_dwordx4 v[144:147], v13, s[8:11], s24 offen sc1
v_accvgpr_read_b32 v24, a116
v_accvgpr_read_b32 v25, a117
v_accvgpr_read_b32 v26, a118
v_accvgpr_read_b32 v27, a119
v_pk_mul_f32 v[24:25], v[24:25], s[40:41] op_sel_hi:[1,0]
v_pk_mul_f32 v[26:27], v[26:27], s[40:41] op_sel_hi:[1,0]
v_cvt_pk_bf16_f32 v148, v24, v25
v_cvt_pk_bf16_f32 v149, v26, v27
v_accvgpr_read_b32 v24, a148
v_accvgpr_read_b32 v25, a149
v_accvgpr_read_b32 v26, a150
v_accvgpr_read_b32 v27, a151
v_pk_mul_f32 v[24:25], v[24:25], s[40:41] op_sel_hi:[1,0]
v_pk_mul_f32 v[26:27], v[26:27], s[40:41] op_sel_hi:[1,0]
v_cvt_pk_bf16_f32 v150, v24, v25
v_cvt_pk_bf16_f32 v151, v26, v27
buffer_store_dwordx4 v[148:151], v13, s[8:11], s24 offen offset:128 sc1
v_accvgpr_read_b32 v20, a120
v_accvgpr_read_b32 v21, a121
v_accvgpr_read_b32 v22, a122
v_accvgpr_read_b32 v23, a123
v_pk_mul_f32 v[20:21], v[20:21], s[40:41] op_sel_hi:[1,0]
v_pk_mul_f32 v[22:23], v[22:23], s[40:41] op_sel_hi:[1,0]
v_cvt_pk_bf16_f32 v152, v20, v21
v_cvt_pk_bf16_f32 v153, v22, v23
v_accvgpr_read_b32 v20, a152
v_accvgpr_read_b32 v21, a153
v_accvgpr_read_b32 v22, a154
v_accvgpr_read_b32 v23, a155
v_pk_mul_f32 v[20:21], v[20:21], s[40:41] op_sel_hi:[1,0]
v_pk_mul_f32 v[22:23], v[22:23], s[40:41] op_sel_hi:[1,0]
v_cvt_pk_bf16_f32 v154, v20, v21
v_cvt_pk_bf16_f32 v155, v22, v23
s_add_u32 s24, s96, 792576
buffer_store_dwordx4 v[152:155], v13, s[8:11], s24 offen sc1
v_accvgpr_read_b32 v24, a124
v_accvgpr_read_b32 v25, a125
v_accvgpr_read_b32 v26, a126
v_accvgpr_read_b32 v27, a127
v_pk_mul_f32 v[24:25], v[24:25], s[40:41] op_sel_hi:[1,0]
v_pk_mul_f32 v[26:27], v[26:27], s[40:41] op_sel_hi:[1,0]
v_cvt_pk_bf16_f32 v156, v24, v25
v_cvt_pk_bf16_f32 v157, v26, v27
v_accvgpr_read_b32 v24, a156
v_accvgpr_read_b32 v25, a157
v_accvgpr_read_b32 v26, a158
v_accvgpr_read_b32 v27, a159
v_pk_mul_f32 v[24:25], v[24:25], s[40:41] op_sel_hi:[1,0]
v_pk_mul_f32 v[26:27], v[26:27], s[40:41] op_sel_hi:[1,0]
v_cvt_pk_bf16_f32 v158, v24, v25
v_cvt_pk_bf16_f32 v159, v26, v27
buffer_store_dwordx4 v[156:159], v13, s[8:11], s24 offen offset:128 sc1
s_waitcnt vmcnt(48) lgkmcnt(0)
L_at_qx:
s_barrier
v_and_b32 v13, 0x7ff, v7
s_lshr_b32 s24, s17, 1
s_lshl_b32 s24, s24, 13
s_add_u32 s24, s24, 98304
v_add_u32 v13, s24, v13
ds_read_b128 v[160:163], v13
ds_read_b128 v[164:167], v13 offset:2048
ds_read_b128 v[168:171], v13 offset:4096
ds_read_b128 v[172:175], v13 offset:6144
ds_read_b128 v[176:179], v13 offset:16384
ds_read_b128 v[180:183], v13 offset:18432
ds_read_b128 v[184:187], v13 offset:20480
ds_read_b128 v[188:191], v13 offset:22528
ds_read_b128 v[192:195], v13 offset:32768
ds_read_b128 v[196:199], v13 offset:34816
ds_read_b128 v[200:203], v13 offset:36864
ds_read_b128 v[204:207], v13 offset:38912
ds_read_b128 v[208:211], v13 offset:49152
ds_read_b128 v[212:215], v13 offset:51200
ds_read_b128 v[216:219], v13 offset:53248
ds_read_b128 v[220:223], v13 offset:55296
s_waitcnt lgkmcnt(0)
L_at_item:
s_lshl_b32 s44, s41, 2
s_mov_b32 s43, 0
s_mov_b32 s45, 2
s_mov_b32 s54, s50
s_mov_b32 s55, s50
v_mov_b32 v2, v6
v_add_u32 v3, 32768, v6
v_mov_b32 v4, v6
s_barrier
ds_read_b128 a[64:67], v2
ds_read_b128 a[68:71], v2 offset:1024
ds_read_b128 a[72:75], v2 offset:2048
v_mov_b64 v[112:113], 0
v_mov_b64 v[114:115], 0
v_mov_b64 v[116:117], 0
v_mov_b64 v[118:119], 0
v_mov_b64 v[120:121], 0
v_mov_b64 v[122:123], 0
v_mov_b64 v[124:125], 0
v_mov_b64 v[126:127], 0
v_mov_b64 v[128:129], 0
v_mov_b64 v[130:131], 0
v_mov_b64 v[132:133], 0
v_mov_b64 v[134:135], 0
v_mov_b64 v[136:137], 0
v_mov_b64 v[138:139], 0
v_mov_b64 v[140:141], 0
v_mov_b64 v[142:143], 0
v_mfma_f32_32x32x16_bf16 a[96:111], v[112:115], v[112:115], 0
v_accvgpr_write_b32 a0, v160
v_accvgpr_write_b32 a1, v161
v_accvgpr_write_b32 a2, v162
v_accvgpr_write_b32 a3, v163
v_accvgpr_write_b32 a4, v164
v_accvgpr_write_b32 a5, v165
v_accvgpr_write_b32 a6, v166
v_mfma_f32_32x32x16_bf16 a[112:127], v[112:115], v[112:115], 0
v_accvgpr_write_b32 a7, v167
v_accvgpr_write_b32 a8, v168
v_accvgpr_write_b32 a9, v169
v_accvgpr_write_b32 a10, v170
v_accvgpr_write_b32 a11, v171
v_accvgpr_write_b32 a12, v172
v_accvgpr_write_b32 a13, v173
v_mfma_f32_32x32x16_bf16 a[128:143], v[112:115], v[112:115], 0
v_accvgpr_write_b32 a14, v174
v_accvgpr_write_b32 a15, v175
v_accvgpr_write_b32 a16, v176
v_accvgpr_write_b32 a17, v177
v_accvgpr_write_b32 a18, v178
v_accvgpr_write_b32 a19, v179
v_accvgpr_write_b32 a20, v180
v_mfma_f32_32x32x16_bf16 a[144:159], v[112:115], v[112:115], 0
v_accvgpr_write_b32 a21, v181
v_accvgpr_write_b32 a22, v182
v_accvgpr_write_b32 a23, v183
v_accvgpr_write_b32 a24, v184
v_accvgpr_write_b32 a25, v185
v_accvgpr_write_b32 a26, v186
v_accvgpr_write_b32 a27, v187
v_mfma_f32_32x32x16_bf16 a[160:175], v[112:115], v[112:115], 0
v_accvgpr_write_b32 a28, v188
v_accvgpr_write_b32 a29, v189
v_accvgpr_write_b32 a30, v190
v_accvgpr_write_b32 a31, v191
v_accvgpr_write_b32 a32, v192
v_accvgpr_write_b32 a33, v193
v_accvgpr_write_b32 a34, v194
v_accvgpr_write_b32 a35, v195
v_mfma_f32_32x32x16_bf16 a[176:191], v[112:115], v[112:115], 0
v_accvgpr_write_b32 a36, v196
v_accvgpr_write_b32 a37, v197
v_accvgpr_write_b32 a38, v198
v_accvgpr_write_b32 a39, v199
v_accvgpr_write_b32 a40, v200
v_accvgpr_write_b32 a41, v201
v_accvgpr_write_b32 a42, v202
v_mfma_f32_32x32x16_bf16 a[192:207], v[112:115], v[112:115], 0
v_accvgpr_write_b32 a43, v203
v_accvgpr_write_b32 a44, v204
v_accvgpr_write_b32 a45, v205
v_accvgpr_write_b32 a46, v206
v_accvgpr_write_b32 a47, v207
v_accvgpr_write_b32 a48, v208
v_accvgpr_write_b32 a49, v209
v_mfma_f32_32x32x16_bf16 a[208:223], v[112:115], v[112:115], 0
v_accvgpr_write_b32 a50, v210
v_accvgpr_write_b32 a51, v211
v_accvgpr_write_b32 a52, v212
v_accvgpr_write_b32 a53, v213
v_accvgpr_write_b32 a54, v214
v_accvgpr_write_b32 a55, v215
v_accvgpr_write_b32 a56, v216
v_mfma_f32_32x32x16_bf16 a[224:239], v[112:115], v[112:115], 0
v_accvgpr_write_b32 a57, v217
v_accvgpr_write_b32 a58, v218
v_accvgpr_write_b32 a59, v219
v_accvgpr_write_b32 a60, v220
v_accvgpr_write_b32 a61, v221
v_accvgpr_write_b32 a62, v222
v_accvgpr_write_b32 a63, v223
s_waitcnt lgkmcnt(2)
v_mfma_f32_16x16x32_bf16 v[32:35], a[64:67], a[0:3], v[128:131]
ds_read_b128 a[76:79], v2 offset:3072
v_mfma_f32_16x16x32_bf16 v[40:43], a[64:67], a[16:19], v[132:135]
v_mfma_f32_16x16x32_bf16 v[48:51], a[64:67], a[32:35], v[136:139]
v_mfma_f32_16x16x32_bf16 v[56:59], a[64:67], a[48:51], v[140:143]
s_waitcnt lgkmcnt(2)
v_mfma_f32_16x16x32_bf16 v[36:39], a[68:71], a[0:3], v[128:131]
ds_read_b128 a[80:83], v2 offset:4096
v_mfma_f32_16x16x32_bf16 v[44:47], a[68:71], a[16:19], v[132:135]
v_mfma_f32_16x16x32_bf16 v[52:55], a[68:71], a[32:35], v[136:139]
v_mfma_f32_16x16x32_bf16 v[60:63], a[68:71], a[48:51], v[140:143]
s_waitcnt lgkmcnt(2)
v_mfma_f32_16x16x32_bf16 v[32:35], a[72:75], a[4:7], v[32:35]
ds_read_b128 a[84:87], v2 offset:5120
v_mfma_f32_16x16x32_bf16 v[40:43], a[72:75], a[20:23], v[40:43]
v_mfma_f32_16x16x32_bf16 v[48:51], a[72:75], a[36:39], v[48:51]
v_mfma_f32_16x16x32_bf16 v[56:59], a[72:75], a[52:55], v[56:59]
s_waitcnt lgkmcnt(2)
v_mfma_f32_16x16x32_bf16 v[36:39], a[76:79], a[4:7], v[36:39]
ds_read_b128 a[88:91], v2 offset:6144
v_mfma_f32_16x16x32_bf16 v[44:47], a[76:79], a[20:23], v[44:47]
v_mfma_f32_16x16x32_bf16 v[52:55], a[76:79], a[36:39], v[52:55]
v_mfma_f32_16x16x32_bf16 v[60:63], a[76:79], a[52:55], v[60:63]
s_waitcnt lgkmcnt(2)
v_mfma_f32_16x16x32_bf16 v[32:35], a[80:83], a[8:11], v[32:35]
ds_read_b128 a[92:95], v2 offset:7168
v_mfma_f32_16x16x32_bf16 v[40:43], a[80:83], a[24:27], v[40:43]
v_mfma_f32_16x16x32_bf16 v[48:51], a[80:83], a[40:43], v[48:51]
v_mfma_f32_16x16x32_bf16 v[56:59], a[80:83], a[56:59], v[56:59]
s_waitcnt lgkmcnt(2)
v_mfma_f32_16x16x32_bf16 v[36:39], a[84:87], a[8:11], v[36:39]
ds_read_b128 a[64:67], v4 offset:24576
v_mfma_f32_16x16x32_bf16 v[44:47], a[84:87], a[24:27], v[44:47]
v_mfma_f32_16x16x32_bf16 v[52:55], a[84:87], a[40:43], v[52:55]
v_mfma_f32_16x16x32_bf16 v[60:63], a[84:87], a[56:59], v[60:63]
s_waitcnt lgkmcnt(2)
v_mfma_f32_16x16x32_bf16 v[32:35], a[88:91], a[12:15], v[32:35]
ds_read_b128 a[68:71], v4 offset:25600
v_mfma_f32_16x16x32_bf16 v[40:43], a[88:91], a[28:31], v[40:43]
v_mfma_f32_16x16x32_bf16 v[48:51], a[88:91], a[44:47], v[48:51]
v_mfma_f32_16x16x32_bf16 v[56:59], a[88:91], a[60:63], v[56:59]
s_waitcnt lgkmcnt(2)
v_mfma_f32_16x16x32_bf16 v[36:39], a[92:95], a[12:15], v[36:39]
ds_read_b128 a[72:75], v4 offset:26624
v_mfma_f32_16x16x32_bf16 v[44:47], a[92:95], a[28:31], v[44:47]
v_mfma_f32_16x16x32_bf16 v[52:55], a[92:95], a[44:47], v[52:55]
v_mfma_f32_16x16x32_bf16 v[60:63], a[92:95], a[60:63], v[60:63]
s_waitcnt lgkmcnt(2)
s_cmp_eq_u32 s44, 0
s_cbranch_scc1 L_at_last
.p2align 3
L_at_loop:
v_mfma_f32_16x16x32_bf16 a[224:227], a[240:243], v[112:115], a[224:227]
s_add_u32 s43, s43, 1
v_mfma_f32_16x16x32_bf16 a[228:231], a[240:243], v[116:119], a[228:231]
v_mfma_f32_16x16x32_bf16 a[232:235], a[240:243], v[120:123], a[232:235]
v_mfma_f32_16x16x32_bf16 a[236:239], a[240:243], v[124:127], a[236:239]
v_max3_f32 v16, v32, v33, v34
v_max3_f32 v16, v16, v35, v40
v_mfma_f32_16x16x32_bf16 a[96:99], a[64:67], v[112:115], a[96:99]
ds_read_b128 a[76:79], v4 offset:27648
v_max3_f32 v16, v16, v41, v42
v_mfma_f32_16x16x32_bf16 a[100:103], a[64:67], v[116:119], a[100:103]
v_max3_f32 v16, v16, v43, v48
v_max3_f32 v16, v16, v49, v50
v_mfma_f32_16x16x32_bf16 a[104:107], a[64:67], v[120:123], a[104:107]
v_max3_f32 v16, v16, v51, v56
v_max3_f32 v16, v16, v57, v58
v_mfma_f32_16x16x32_bf16 a[108:111], a[64:67], v[124:127], a[108:111]
s_waitcnt lgkmcnt(2)
v_max3_f32 v16, v16, v59, v36
v_max3_f32 v16, v16, v37, v38
v_mfma_f32_16x16x32_bf16 a[112:115], a[68:71], v[112:115], a[112:115]
ds_read_b128 a[80:83], v4 offset:28672
v_max3_f32 v16, v16, v39, v44
v_mfma_f32_16x16x32_bf16 a[116:119], a[68:71], v[116:119], a[116:119]
v_max3_f32 v16, v16, v45, v46
v_max3_f32 v16, v16, v47, v52
v_mfma_f32_16x16x32_bf16 a[120:123], a[68:71], v[120:123], a[120:123]
v_max3_f32 v16, v16, v53, v54
v_max3_f32 v16, v16, v55, v60
v_mfma_f32_16x16x32_bf16 a[124:127], a[68:71], v[124:127], a[124:127]
s_waitcnt lgkmcnt(2)
v_max3_f32 v16, v16, v61, v62
v_max_f32 v16, v16, v63
v_mfma_f32_16x16x32_bf16 a[128:131], a[72:75], v[112:115], a[128:131]
ds_read_b128 a[84:87], v4 offset:29696
v_cmp_lt_f32 vcc, s54, v16
v_mfma_f32_16x16x32_bf16 a[132:135], a[72:75], v[116:119], a[132:135]
s_cbranch_vccnz L_at_up0
L_at_upr0:
v_mfma_f32_16x16x32_bf16 a[136:139], a[72:75], v[120:123], a[136:139]
v_exp_f32 v32, v32
v_mfma_f32_16x16x32_bf16 a[140:143], a[72:75], v[124:127], a[140:143]
s_waitcnt lgkmcnt(2)
v_exp_f32 v33, v33
v_mfma_f32_16x16x32_bf16 a[144:147], a[76:79], v[112:115], a[144:147]
ds_read_b128 a[88:91], v4 offset:30720
v_cvt_pk_bf16_f32 v96, v32, v33
v_mfma_f32_16x16x32_bf16 a[148:151], a[76:79], v[116:119], a[148:151]
v_exp_f32 v34, v34
v_mfma_f32_16x16x32_bf16 a[152:155], a[76:79], v[120:123], a[152:155]
v_exp_f32 v35, v35
v_mfma_f32_16x16x32_bf16 a[156:159], a[76:79], v[124:127], a[156:159]
s_waitcnt lgkmcnt(2)
v_exp_f32 v36, v36
v_mfma_f32_16x16x32_bf16 a[160:163], a[80:83], v[112:115], a[160:163]
ds_read_b128 a[92:95], v4 offset:31744
v_cvt_pk_bf16_f32 v97, v34, v35
v_mfma_f32_16x16x32_bf16 a[164:167], a[80:83], v[116:119], a[164:167]
v_exp_f32 v37, v37
v_mfma_f32_16x16x32_bf16 a[168:171], a[80:83], v[120:123], a[168:171]
v_exp_f32 v38, v38
v_mfma_f32_16x16x32_bf16 a[172:175], a[80:83], v[124:127], a[172:175]
s_waitcnt lgkmcnt(2)
v_exp_f32 v39, v39
v_mfma_f32_16x16x32_bf16 a[176:179], a[84:87], v[112:115], a[176:179]
ds_read_b128 a[64:67], v2 offset:16384
v_cvt_pk_bf16_f32 v98, v36, v37
v_mfma_f32_16x16x32_bf16 a[180:183], a[84:87], v[116:119], a[180:183]
v_exp_f32 v40, v40
v_mfma_f32_16x16x32_bf16 a[184:187], a[84:87], v[120:123], a[184:187]
v_exp_f32 v41, v41
v_mfma_f32_16x16x32_bf16 a[188:191], a[84:87], v[124:127], a[188:191]
s_waitcnt lgkmcnt(2)
v_exp_f32 v42, v42
v_mfma_f32_16x16x32_bf16 a[192:195], a[88:91], v[112:115], a[192:195]
ds_read_b128 a[68:71], v2 offset:17408
v_cvt_pk_bf16_f32 v99, v38, v39
v_mfma_f32_16x16x32_bf16 a[196:199], a[88:91], v[116:119], a[196:199]
v_exp_f32 v43, v43
v_mfma_f32_16x16x32_bf16 a[200:203], a[88:91], v[120:123], a[200:203]
v_exp_f32 v44, v44
v_mfma_f32_16x16x32_bf16 a[204:207], a[88:91], v[124:127], a[204:207]
s_waitcnt lgkmcnt(2)
v_exp_f32 v45, v45
v_mfma_f32_16x16x32_bf16 a[208:211], a[92:95], v[112:115], a[208:211]
ds_read_b128 a[72:75], v2 offset:18432
v_cvt_pk_bf16_f32 v100, v40, v41
v_mfma_f32_16x16x32_bf16 a[212:215], a[92:95], v[116:119], a[212:215]
v_exp_f32 v46, v46
v_mfma_f32_16x16x32_bf16 a[216:219], a[92:95], v[120:123], a[216:219]
s_cmp_eq_u32 s48, 0
v_exp_f32 v47, v47
v_mfma_f32_16x16x32_bf16 a[220:223], a[92:95], v[124:127], a[220:223]
s_waitcnt lgkmcnt(2)
s_cbranch_scc0 L_at_rs0
L_at_rsr0:
v_mfma_f32_16x16x32_bf16 v[64:67], a[64:67], a[0:3], v[128:131]
ds_read_b128 a[76:79], v2 offset:19456
v_cvt_pk_bf16_f32 v101, v42, v43
v_mfma_f32_16x16x32_bf16 v[72:75], a[64:67], a[16:19], v[132:135]
v_exp_f32 v48, v48
v_mfma_f32_16x16x32_bf16 v[80:83], a[64:67], a[32:35], v[136:139]
v_exp_f32 v49, v49
v_mfma_f32_16x16x32_bf16 v[88:91], a[64:67], a[48:51], v[140:143]
s_waitcnt lgkmcnt(2)
v_exp_f32 v50, v50
v_mfma_f32_16x16x32_bf16 v[68:71], a[68:71], a[0:3], v[128:131]
ds_read_b128 a[80:83], v2 offset:20480
v_cvt_pk_bf16_f32 v102, v44, v45
v_mfma_f32_16x16x32_bf16 v[76:79], a[68:71], a[16:19], v[132:135]
v_exp_f32 v51, v51
v_mfma_f32_16x16x32_bf16 v[84:87], a[68:71], a[32:35], v[136:139]
v_exp_f32 v52, v52
v_mfma_f32_16x16x32_bf16 v[92:95], a[68:71], a[48:51], v[140:143]
s_waitcnt lgkmcnt(2)
v_exp_f32 v53, v53
v_mfma_f32_16x16x32_bf16 v[64:67], a[72:75], a[4:7], v[64:67]
ds_read_b128 a[84:87], v2 offset:21504
v_cvt_pk_bf16_f32 v103, v46, v47
v_mfma_f32_16x16x32_bf16 v[72:75], a[72:75], a[20:23], v[72:75]
v_exp_f32 v54, v54
v_mfma_f32_16x16x32_bf16 v[80:83], a[72:75], a[36:39], v[80:83]
v_exp_f32 v55, v55
v_mfma_f32_16x16x32_bf16 v[88:91], a[72:75], a[52:55], v[88:91]
s_waitcnt lgkmcnt(2)
v_exp_f32 v56, v56
v_mfma_f32_16x16x32_bf16 v[68:71], a[76:79], a[4:7], v[68:71]
ds_read_b128 a[88:91], v2 offset:22528
v_cvt_pk_bf16_f32 v104, v48, v49
v_mfma_f32_16x16x32_bf16 v[76:79], a[76:79], a[20:23], v[76:79]
v_exp_f32 v57, v57
v_mfma_f32_16x16x32_bf16 v[84:87], a[76:79], a[36:39], v[84:87]
v_exp_f32 v58, v58
v_mfma_f32_16x16x32_bf16 v[92:95], a[76:79], a[52:55], v[92:95]
s_waitcnt lgkmcnt(2)
v_exp_f32 v59, v59
v_mfma_f32_16x16x32_bf16 v[64:67], a[80:83], a[8:11], v[64:67]
ds_read_b128 a[92:95], v2 offset:23552
v_cvt_pk_bf16_f32 v105, v50, v51
v_mfma_f32_16x16x32_bf16 v[72:75], a[80:83], a[24:27], v[72:75]
v_exp_f32 v60, v60
v_mfma_f32_16x16x32_bf16 v[80:83], a[80:83], a[40:43], v[80:83]
v_exp_f32 v61, v61
v_mfma_f32_16x16x32_bf16 v[88:91], a[80:83], a[56:59], v[88:91]
s_waitcnt lgkmcnt(2)
v_exp_f32 v62, v62
v_mfma_f32_16x16x32_bf16 v[68:71], a[84:87], a[8:11], v[68:71]
ds_read_b128 a[64:67], v2 offset:8192
v_cvt_pk_bf16_f32 v106, v52, v53
v_mfma_f32_16x16x32_bf16 v[76:79], a[84:87], a[24:27], v[76:79]
v_exp_f32 v63, v63
v_mfma_f32_16x16x32_bf16 v[84:87], a[84:87], a[40:43], v[84:87]
v_cvt_pk_bf16_f32 v107, v54, v55
v_cvt_pk_bf16_f32 v108, v56, v57
v_mfma_f32_16x16x32_bf16 v[92:95], a[84:87], a[56:59], v[92:95]
s_waitcnt lgkmcnt(2)
v_cvt_pk_bf16_f32 v109, v58, v59
v_cvt_pk_bf16_f32 v110, v60, v61
v_mfma_f32_16x16x32_bf16 v[64:67], a[88:91], a[12:15], v[64:67]
ds_read_b128 a[68:71], v2 offset:9216
v_cvt_pk_bf16_f32 v111, v62, v63
v_mfma_f32_16x16x32_bf16 v[72:75], a[88:91], a[28:31], v[72:75]
v_mfma_f32_16x16x32_bf16 v[80:83], a[88:91], a[44:47], v[80:83]
v_mfma_f32_16x16x32_bf16 v[88:91], a[88:91], a[60:63], v[88:91]
s_waitcnt lgkmcnt(2)
v_mfma_f32_16x16x32_bf16 v[68:71], a[92:95], a[12:15], v[68:71]
ds_read_b128 a[72:75], v2 offset:10240
v_mfma_f32_16x16x32_bf16 v[76:79], a[92:95], a[28:31], v[76:79]
s_cmp_eq_u32 s43, s45
v_mfma_f32_16x16x32_bf16 v[84:87], a[92:95], a[44:47], v[84:87]
v_mfma_f32_16x16x32_bf16 v[92:95], a[92:95], a[60:63], v[92:95]
s_waitcnt lgkmcnt(2)
s_waitcnt vmcnt(8)
s_barrier
s_cbranch_scc1 L_at_hk
L_at_hkr:
v_mfma_f32_16x16x32_bf16 a[224:227], a[240:243], v[96:99], a[224:227]
s_add_u32 s24, s46, 4096
s_add_u32 m0, s47, 0
v_mfma_f32_16x16x32_bf16 a[228:231], a[240:243], v[100:103], a[228:231]
buffer_load_dwordx4 v1, s[8:11], s46 offen sc1 lds
v_mfma_f32_16x16x32_bf16 a[232:235], a[240:243], v[104:107], a[232:235]
buffer_load_dwordx4 v1, s[8:11], s46 offen offset:2048 sc1 lds
v_mfma_f32_16x16x32_bf16 a[236:239], a[240:243], v[108:111], a[236:239]
v_max3_f32 v16, v64, v65, v66
v_max3_f32 v16, v16, v67, v72
v_mfma_f32_16x16x32_bf16 a[96:99], a[64:67], v[96:99], a[96:99]
ds_read_b128 a[76:79], v2 offset:11264
v_max3_f32 v16, v16, v73, v74
v_mfma_f32_16x16x32_bf16 a[100:103], a[64:67], v[100:103], a[100:103]
s_add_u32 m0, s47, 896
v_max3_f32 v16, v16, v75, v80
v_max3_f32 v16, v16, v81, v82
v_mfma_f32_16x16x32_bf16 a[104:107], a[64:67], v[104:107], a[104:107]
v_max3_f32 v16, v16, v83, v88
v_max3_f32 v16, v16, v89, v90
v_mfma_f32_16x16x32_bf16 a[108:111], a[64:67], v[108:111], a[108:111]
s_waitcnt lgkmcnt(2)
v_max3_f32 v16, v16, v91, v68
v_max3_f32 v16, v16, v69, v70
v_mfma_f32_16x16x32_bf16 a[112:115], a[68:71], v[96:99], a[112:115]
ds_read_b128 a[80:83], v2 offset:12288
v_max3_f32 v16, v16, v71, v76
v_mfma_f32_16x16x32_bf16 a[116:119], a[68:71], v[100:103], a[116:119]
buffer_load_dwordx4 v1, s[8:11], s46 offen offset:128 sc1 lds
v_max3_f32 v16, v16, v77, v78
v_mfma_f32_16x16x32_bf16 a[120:123], a[68:71], v[104:107], a[120:123]
v_max3_f32 v16, v16, v79, v84
v_max3_f32 v16, v16, v85, v86
v_mfma_f32_16x16x32_bf16 a[124:127], a[68:71], v[108:111], a[124:127]
s_waitcnt lgkmcnt(2)
v_max3_f32 v16, v16, v87, v92
v_max3_f32 v16, v16, v93, v94
v_mfma_f32_16x16x32_bf16 a[128:131], a[72:75], v[96:99], a[128:131]
ds_read_b128 a[84:87], v2 offset:13312
v_max_f32 v16, v16, v95
v_cmp_lt_f32 vcc, s54, v16
v_mfma_f32_16x16x32_bf16 a[132:135], a[72:75], v[100:103], a[132:135]
buffer_load_dwordx4 v1, s[8:11], s46 offen offset:2176 sc1 lds
s_cbranch_vccnz L_at_up1
L_at_upr1:
v_mfma_f32_16x16x32_bf16 a[136:139], a[72:75], v[104:107], a[136:139]
v_exp_f32 v64, v64
v_mfma_f32_16x16x32_bf16 a[140:143], a[72:75], v[108:111], a[140:143]
s_waitcnt lgkmcnt(2)
v_exp_f32 v65, v65
v_mfma_f32_16x16x32_bf16 a[144:147], a[76:79], v[96:99], a[144:147]
ds_read_b128 a[88:91], v2 offset:14336
v_cvt_pk_bf16_f32 v112, v64, v65
v_mfma_f32_16x16x32_bf16 a[148:151], a[76:79], v[100:103], a[148:151]
v_exp_f32 v66, v66
v_mfma_f32_16x16x32_bf16 a[152:155], a[76:79], v[104:107], a[152:155]
s_add_u32 m0, s47, 4096
v_exp_f32 v67, v67
v_mfma_f32_16x16x32_bf16 a[156:159], a[76:79], v[108:111], a[156:159]
s_waitcnt lgkmcnt(2)
v_exp_f32 v68, v68
v_mfma_f32_16x16x32_bf16 a[160:163], a[80:83], v[96:99], a[160:163]
ds_read_b128 a[92:95], v2 offset:15360
v_cvt_pk_bf16_f32 v113, v66, v67
v_mfma_f32_16x16x32_bf16 a[164:167], a[80:83], v[100:103], a[164:167]
v_exp_f32 v69, v69
v_mfma_f32_16x16x32_bf16 a[168:171], a[80:83], v[104:107], a[168:171]
buffer_load_dwordx4 v1, s[8:11], s24 offen sc1 lds
v_cvt_pk_bf16_f32 v114, v68, v69
v_mfma_f32_16x16x32_bf16 a[172:175], a[80:83], v[108:111], a[172:175]
s_waitcnt lgkmcnt(2)
v_exp_f32 v70, v70
v_mfma_f32_16x16x32_bf16 a[176:179], a[84:87], v[96:99], a[176:179]
ds_read_b128 a[64:67], v3
v_mfma_f32_16x16x32_bf16 a[180:183], a[84:87], v[100:103], a[180:183]
v_exp_f32 v71, v71
v_mfma_f32_16x16x32_bf16 a[184:187], a[84:87], v[104:107], a[184:187]
v_exp_f32 v72, v72
v_mfma_f32_16x16x32_bf16 a[188:191], a[84:87], v[108:111], a[188:191]
s_waitcnt lgkmcnt(2)
v_exp_f32 v73, v73
v_mfma_f32_16x16x32_bf16 a[192:195], a[88:91], v[96:99], a[192:195]
ds_read_b128 a[68:71], v3 offset:1024
v_cvt_pk_bf16_f32 v115, v70, v71
v_mfma_f32_16x16x32_bf16 a[196:199], a[88:91], v[100:103], a[196:199]
buffer_load_dwordx4 v1, s[8:11], s24 offen offset:2048 sc1 lds
v_cvt_pk_bf16_f32 v116, v72, v73
v_mfma_f32_16x16x32_bf16 a[200:203], a[88:91], v[104:107], a[200:203]
v_exp_f32 v74, v74
v_mfma_f32_16x16x32_bf16 a[204:207], a[88:91], v[108:111], a[204:207]
s_waitcnt lgkmcnt(2)
v_exp_f32 v75, v75
v_mfma_f32_16x16x32_bf16 a[208:211], a[92:95], v[96:99], a[208:211]
ds_read_b128 a[72:75], v3 offset:2048
v_cvt_pk_bf16_f32 v117, v74, v75
v_mfma_f32_16x16x32_bf16 a[212:215], a[92:95], v[100:103], a[212:215]
s_add_u32 m0, s47, 4992
v_exp_f32 v76, v76
v_mfma_f32_16x16x32_bf16 a[216:219], a[92:95], v[104:107], a[216:219]
s_cmp_eq_u32 s48, 0
v_exp_f32 v77, v77
v_mfma_f32_16x16x32_bf16 a[220:223], a[92:95], v[108:111], a[220:223]
s_waitcnt lgkmcnt(2)
s_cbranch_scc0 L_at_rs1
L_at_rsr1:
v_mfma_f32_16x16x32_bf16 v[32:35], a[64:67], a[0:3], v[128:131]
ds_read_b128 a[76:79], v3 offset:3072
v_cvt_pk_bf16_f32 v118, v76, v77
v_mfma_f32_16x16x32_bf16 v[40:43], a[64:67], a[16:19], v[132:135]
v_exp_f32 v78, v78
v_mfma_f32_16x16x32_bf16 v[48:51], a[64:67], a[32:35], v[136:139]
buffer_load_dwordx4 v1, s[8:11], s24 offen offset:128 sc1 lds
v_mfma_f32_16x16x32_bf16 v[56:59], a[64:67], a[48:51], v[140:143]
s_waitcnt lgkmcnt(2)
v_exp_f32 v79, v79
v_mfma_f32_16x16x32_bf16 v[36:39], a[68:71], a[0:3], v[128:131]
ds_read_b128 a[80:83], v3 offset:4096
v_cvt_pk_bf16_f32 v119, v78, v79
v_mfma_f32_16x16x32_bf16 v[44:47], a[68:71], a[16:19], v[132:135]
v_exp_f32 v80, v80
v_mfma_f32_16x16x32_bf16 v[52:55], a[68:71], a[32:35], v[136:139]
v_exp_f32 v81, v81
v_mfma_f32_16x16x32_bf16 v[60:63], a[68:71], a[48:51], v[140:143]
s_waitcnt lgkmcnt(2)
v_exp_f32 v82, v82
v_mfma_f32_16x16x32_bf16 v[32:35], a[72:75], a[4:7], v[32:35]
ds_read_b128 a[84:87], v3 offset:5120
v_cvt_pk_bf16_f32 v120, v80, v81
v_mfma_f32_16x16x32_bf16 v[40:43], a[72:75], a[20:23], v[40:43]
buffer_load_dwordx4 v1, s[8:11], s24 offen offset:2176 sc1 lds
v_mfma_f32_16x16x32_bf16 v[48:51], a[72:75], a[36:39], v[48:51]
v_exp_f32 v83, v83
v_mfma_f32_16x16x32_bf16 v[56:59], a[72:75], a[52:55], v[56:59]
s_waitcnt lgkmcnt(2)
v_exp_f32 v84, v84
v_mfma_f32_16x16x32_bf16 v[36:39], a[76:79], a[4:7], v[36:39]
ds_read_b128 a[88:91], v3 offset:6144
v_cvt_pk_bf16_f32 v121, v82, v83
v_mfma_f32_16x16x32_bf16 v[44:47], a[76:79], a[20:23], v[44:47]
s_add_u32 s46, s46, 1048576
v_exp_f32 v85, v85
v_mfma_f32_16x16x32_bf16 v[52:55], a[76:79], a[36:39], v[52:55]
v_exp_f32 v86, v86
v_mfma_f32_16x16x32_bf16 v[60:63], a[76:79], a[52:55], v[60:63]
s_waitcnt lgkmcnt(2)
v_exp_f32 v87, v87
v_mfma_f32_16x16x32_bf16 v[32:35], a[80:83], a[8:11], v[32:35]
ds_read_b128 a[92:95], v3 offset:7168
v_cvt_pk_bf16_f32 v122, v84, v85
v_mfma_f32_16x16x32_bf16 v[40:43], a[80:83], a[24:27], v[40:43]
v_exp_f32 v88, v88
v_mfma_f32_16x16x32_bf16 v[48:51], a[80:83], a[40:43], v[48:51]
s_add_u32 s47, s47, 32768
v_exp_f32 v89, v89
v_mfma_f32_16x16x32_bf16 v[56:59], a[80:83], a[56:59], v[56:59]
s_waitcnt lgkmcnt(2)
v_exp_f32 v90, v90
v_mfma_f32_16x16x32_bf16 v[36:39], a[84:87], a[8:11], v[36:39]
ds_read_b128 a[64:67], v2 offset:24576
v_cvt_pk_bf16_f32 v123, v86, v87
v_mfma_f32_16x16x32_bf16 v[44:47], a[84:87], a[24:27], v[44:47]
v_exp_f32 v91, v91
v_mfma_f32_16x16x32_bf16 v[52:55], a[84:87], a[40:43], v[52:55]
s_and_b32 s47, s47, 131071
v_exp_f32 v92, v92
v_mfma_f32_16x16x32_bf16 v[60:63], a[84:87], a[56:59], v[60:63]
s_waitcnt lgkmcnt(2)
v_exp_f32 v93, v93
v_mfma_f32_16x16x32_bf16 v[32:35], a[88:91], a[12:15], v[32:35]
ds_read_b128 a[68:71], v2 offset:25600
v_cvt_pk_bf16_f32 v124, v88, v89
v_mfma_f32_16x16x32_bf16 v[40:43], a[88:91], a[28:31], v[40:43]
v_exp_f32 v94, v94
v_mfma_f32_16x16x32_bf16 v[48:51], a[88:91], a[44:47], v[48:51]
v_exp_f32 v95, v95
v_mfma_f32_16x16x32_bf16 v[56:59], a[88:91], a[60:63], v[56:59]
s_waitcnt lgkmcnt(2)
v_cvt_pk_bf16_f32 v125, v90, v91
v_cvt_pk_bf16_f32 v126, v92, v93
v_mfma_f32_16x16x32_bf16 v[36:39], a[92:95], a[12:15], v[36:39]
ds_read_b128 a[72:75], v2 offset:26624
v_cvt_pk_bf16_f32 v127, v94, v95
v_mfma_f32_16x16x32_bf16 v[44:47], a[92:95], a[28:31], v[44:47]
s_cmp_lt_u32 s43, s44
v_mov_b32 v4, v2
v_mov_b32 v2, v3
v_mfma_f32_16x16x32_bf16 v[52:55], a[92:95], a[44:47], v[52:55]
v_add_u32 v3, 32768, v3
v_and_b32 v3, 131071, v3
v_mfma_f32_16x16x32_bf16 v[60:63], a[92:95], a[60:63], v[60:63]
s_waitcnt lgkmcnt(2)
s_cbranch_scc1 L_at_loop
L_at_last:
v_mfma_f32_16x16x32_bf16 a[224:227], a[240:243], v[112:115], a[224:227]
s_lshl_b32 s61, s41, 4
v_mfma_f32_16x16x32_bf16 a[228:231], a[240:243], v[116:119], a[228:231]
v_mfma_f32_16x16x32_bf16 a[232:235], a[240:243], v[120:123], a[232:235]
v_mfma_f32_16x16x32_bf16 a[236:239], a[240:243], v[124:127], a[236:239]
v_cndmask_b32 v32, v8, v32, s[64:65]
v_cndmask_b32 v33, v8, v33, s[66:67]
v_mfma_f32_16x16x32_bf16 a[96:99], a[64:67], v[112:115], a[96:99]
ds_read_b128 a[76:79], v4 offset:27648
v_cndmask_b32 v34, v8, v34, s[68:69]
v_mfma_f32_16x16x32_bf16 a[100:103], a[64:67], v[116:119], a[100:103]
v_cndmask_b32 v35, v8, v35, s[70:71]
v_cndmask_b32 v36, v8, v36, s[72:73]
v_mfma_f32_16x16x32_bf16 a[104:107], a[64:67], v[120:123], a[104:107]
s_add_u32 s61, s61, s17
v_cndmask_b32 v37, v8, v37, s[74:75]
v_cndmask_b32 v38, v8, v38, s[76:77]
v_mfma_f32_16x16x32_bf16 a[108:111], a[64:67], v[124:127], a[108:111]
s_waitcnt lgkmcnt(2)
v_cndmask_b32 v39, v8, v39, s[78:79]
v_max3_f32 v16, v32, v33, v34
v_mfma_f32_16x16x32_bf16 a[112:115], a[68:71], v[112:115], a[112:115]
ds_read_b128 a[80:83], v4 offset:28672
v_max3_f32 v16, v16, v35, v40
v_mfma_f32_16x16x32_bf16 a[116:119], a[68:71], v[116:119], a[116:119]
v_max3_f32 v16, v16, v41, v42
v_max3_f32 v16, v16, v43, v48
v_mfma_f32_16x16x32_bf16 a[120:123], a[68:71], v[120:123], a[120:123]
v_max3_f32 v16, v16, v49, v50
v_max3_f32 v16, v16, v51, v56
v_mfma_f32_16x16x32_bf16 a[124:127], a[68:71], v[124:127], a[124:127]
s_waitcnt lgkmcnt(2)
v_max3_f32 v16, v16, v57, v58
v_max3_f32 v16, v16, v59, v36
v_mfma_f32_16x16x32_bf16 a[128:131], a[72:75], v[112:115], a[128:131]
ds_read_b128 a[84:87], v4 offset:29696
v_max3_f32 v16, v16, v37, v38
v_mfma_f32_16x16x32_bf16 a[132:135], a[72:75], v[116:119], a[132:135]
v_max3_f32 v16, v16, v39, v44
v_max3_f32 v16, v16, v45, v46
v_mfma_f32_16x16x32_bf16 a[136:139], a[72:75], v[120:123], a[136:139]
v_max3_f32 v16, v16, v47, v52
v_max3_f32 v16, v16, v53, v54
v_mfma_f32_16x16x32_bf16 a[140:143], a[72:75], v[124:127], a[140:143]
s_waitcnt lgkmcnt(2)
v_max3_f32 v16, v16, v55, v60
v_max3_f32 v16, v16, v61, v62
v_mfma_f32_16x16x32_bf16 a[144:147], a[76:79], v[112:115], a[144:147]
ds_read_b128 a[88:91], v4 offset:30720
v_max_f32 v16, v16, v63
v_mfma_f32_16x16x32_bf16 a[148:151], a[76:79], v[116:119], a[148:151]
v_cmp_lt_f32 vcc, s54, v16
v_mfma_f32_16x16x32_bf16 a[152:155], a[76:79], v[120:123], a[152:155]
s_lshl_b32 s61, s61, 5
s_cbranch_vccnz L_at_up2
L_at_upr2:
v_mfma_f32_16x16x32_bf16 a[156:159], a[76:79], v[124:127], a[156:159]
s_waitcnt lgkmcnt(2)
v_exp_f32 v32, v32
v_mfma_f32_16x16x32_bf16 a[160:163], a[80:83], v[112:115], a[160:163]
ds_read_b128 a[92:95], v4 offset:31744
v_mfma_f32_16x16x32_bf16 a[164:167], a[80:83], v[116:119], a[164:167]
v_exp_f32 v33, v33
v_mfma_f32_16x16x32_bf16 a[168:171], a[80:83], v[120:123], a[168:171]
v_exp_f32 v34, v34
v_mfma_f32_16x16x32_bf16 a[172:175], a[80:83], v[124:127], a[172:175]
s_waitcnt lgkmcnt(2)
v_exp_f32 v35, v35
v_mfma_f32_16x16x32_bf16 a[176:179], a[84:87], v[112:115], a[176:179]
ds_read_b128 a[64:67], v2 offset:16384
v_cvt_pk_bf16_f32 v96, v32, v33
v_mfma_f32_16x16x32_bf16 a[180:183], a[84:87], v[116:119], a[180:183]
v_exp_f32 v36, v36
v_mfma_f32_16x16x32_bf16 a[184:187], a[84:87], v[120:123], a[184:187]
v_exp_f32 v37, v37
v_mfma_f32_16x16x32_bf16 a[188:191], a[84:87], v[124:127], a[188:191]
s_waitcnt lgkmcnt(2)
v_exp_f32 v38, v38
v_mfma_f32_16x16x32_bf16 a[192:195], a[88:91], v[112:115], a[192:195]
ds_read_b128 a[68:71], v2 offset:17408
v_cvt_pk_bf16_f32 v97, v34, v35
v_mfma_f32_16x16x32_bf16 a[196:199], a[88:91], v[116:119], a[196:199]
s_add_u32 s61, s61, s42
v_exp_f32 v39, v39
v_mfma_f32_16x16x32_bf16 a[200:203], a[88:91], v[120:123], a[200:203]
v_exp_f32 v40, v40
v_mfma_f32_16x16x32_bf16 a[204:207], a[88:91], v[124:127], a[204:207]
s_waitcnt lgkmcnt(2)
v_exp_f32 v41, v41
v_mfma_f32_16x16x32_bf16 a[208:211], a[92:95], v[112:115], a[208:211]
ds_read_b128 a[72:75], v2 offset:18432
v_cvt_pk_bf16_f32 v98, v36, v37
v_mfma_f32_16x16x32_bf16 a[212:215], a[92:95], v[116:119], a[212:215]
v_exp_f32 v42, v42
v_mfma_f32_16x16x32_bf16 a[216:219], a[92:95], v[120:123], a[216:219]
v_exp_f32 v43, v43
v_mfma_f32_16x16x32_bf16 a[220:223], a[92:95], v[124:127], a[220:223]
s_waitcnt lgkmcnt(2)
s_cmp_eq_u32 s48, 0
s_cbranch_scc0 L_at_rs2
L_at_rsr2:
v_mfma_f32_16x16x32_bf16 v[64:67], a[64:67], a[0:3], v[128:131]
ds_read_b128 a[76:79], v2 offset:19456
v_cvt_pk_bf16_f32 v99, v38, v39
v_mfma_f32_16x16x32_bf16 v[72:75], a[64:67], a[16:19], v[132:135]
v_exp_f32 v44, v44
v_mfma_f32_16x16x32_bf16 v[80:83], a[64:67], a[32:35], v[136:139]
v_exp_f32 v45, v45
v_mfma_f32_16x16x32_bf16 v[88:91], a[64:67], a[48:51], v[140:143]
s_waitcnt lgkmcnt(2)
v_exp_f32 v46, v46
v_mfma_f32_16x16x32_bf16 v[68:71], a[68:71], a[0:3], v[128:131]
ds_read_b128 a[80:83], v2 offset:20480
v_cvt_pk_bf16_f32 v100, v40, v41
v_mfma_f32_16x16x32_bf16 v[76:79], a[68:71], a[16:19], v[132:135]
v_exp_f32 v47, v47
v_mfma_f32_16x16x32_bf16 v[84:87], a[68:71], a[32:35], v[136:139]
s_lshl_b32 s61, s61, 12
v_exp_f32 v48, v48
v_mfma_f32_16x16x32_bf16 v[92:95], a[68:71], a[48:51], v[140:143]
s_waitcnt lgkmcnt(2)
v_exp_f32 v49, v49
v_mfma_f32_16x16x32_bf16 v[64:67], a[72:75], a[4:7], v[64:67]
ds_read_b128 a[84:87], v2 offset:21504
v_cvt_pk_bf16_f32 v101, v42, v43
v_mfma_f32_16x16x32_bf16 v[72:75], a[72:75], a[20:23], v[72:75]
v_exp_f32 v50, v50
v_mfma_f32_16x16x32_bf16 v[80:83], a[72:75], a[36:39], v[80:83]
v_exp_f32 v51, v51
v_mfma_f32_16x16x32_bf16 v[88:91], a[72:75], a[52:55], v[88:91]
s_waitcnt lgkmcnt(2)
v_exp_f32 v52, v52
v_mfma_f32_16x16x32_bf16 v[68:71], a[76:79], a[4:7], v[68:71]
ds_read_b128 a[88:91], v2 offset:22528
v_cvt_pk_bf16_f32 v102, v44, v45
v_mfma_f32_16x16x32_bf16 v[76:79], a[76:79], a[20:23], v[76:79]
v_exp_f32 v53, v53
v_mfma_f32_16x16x32_bf16 v[84:87], a[76:79], a[36:39], v[84:87]
v_exp_f32 v54, v54
v_mfma_f32_16x16x32_bf16 v[92:95], a[76:79], a[52:55], v[92:95]
s_waitcnt lgkmcnt(2)
v_exp_f32 v55, v55
v_mfma_f32_16x16x32_bf16 v[64:67], a[80:83], a[8:11], v[64:67]
ds_read_b128 a[92:95], v2 offset:23552
v_cvt_pk_bf16_f32 v103, v46, v47
v_mfma_f32_16x16x32_bf16 v[72:75], a[80:83], a[24:27], v[72:75]
s_add_u32 s61, s61, 67108864
v_exp_f32 v56, v56
v_mfma_f32_16x16x32_bf16 v[80:83], a[80:83], a[40:43], v[80:83]
v_exp_f32 v57, v57
v_mfma_f32_16x16x32_bf16 v[88:91], a[80:83], a[56:59], v[88:91]
s_waitcnt lgkmcnt(2)
v_exp_f32 v58, v58
v_mfma_f32_16x16x32_bf16 v[68:71], a[84:87], a[8:11], v[68:71]
ds_read_b128 a[64:67], v2 offset:8192
v_cvt_pk_bf16_f32 v104, v48, v49
v_mfma_f32_16x16x32_bf16 v[76:79], a[84:87], a[24:27], v[76:79]
v_exp_f32 v59, v59
v_mfma_f32_16x16x32_bf16 v[84:87], a[84:87], a[40:43], v[84:87]
v_exp_f32 v60, v60
v_mfma_f32_16x16x32_bf16 v[92:95], a[84:87], a[56:59], v[92:95]
s_waitcnt lgkmcnt(2)
v_exp_f32 v61, v61
v_mfma_f32_16x16x32_bf16 v[64:67], a[88:91], a[12:15], v[64:67]
ds_read_b128 a[68:71], v2 offset:9216
v_cvt_pk_bf16_f32 v105, v50, v51
v_mfma_f32_16x16x32_bf16 v[72:75], a[88:91], a[28:31], v[72:75]
v_exp_f32 v62, v62
v_mfma_f32_16x16x32_bf16 v[80:83], a[88:91], a[44:47], v[80:83]
v_exp_f32 v63, v63
v_mfma_f32_16x16x32_bf16 v[88:91], a[88:91], a[60:63], v[88:91]
s_waitcnt lgkmcnt(2)
v_cvt_pk_bf16_f32 v106, v52, v53
v_cvt_pk_bf16_f32 v107, v54, v55
v_mfma_f32_16x16x32_bf16 v[68:71], a[92:95], a[12:15], v[68:71]
ds_read_b128 a[72:75], v2 offset:10240
v_cvt_pk_bf16_f32 v108, v56, v57
v_mfma_f32_16x16x32_bf16 v[76:79], a[92:95], a[28:31], v[76:79]
v_cvt_pk_bf16_f32 v109, v58, v59
v_cvt_pk_bf16_f32 v110, v60, v61
v_mfma_f32_16x16x32_bf16 v[84:87], a[92:95], a[44:47], v[84:87]
v_cvt_pk_bf16_f32 v111, v62, v63
v_mfma_f32_16x16x32_bf16 v[92:95], a[92:95], a[60:63], v[92:95]
s_waitcnt lgkmcnt(2)
s_waitcnt vmcnt(8)
s_barrier
v_mfma_f32_16x16x32_bf16 a[224:227], a[240:243], v[96:99], a[224:227]
s_add_u32 s24, s46, 4096
s_add_u32 m0, s47, 0
v_mfma_f32_16x16x32_bf16 a[228:231], a[240:243], v[100:103], a[228:231]
buffer_load_dwordx4 v1, s[8:11], s46 offen sc1 lds
v_mfma_f32_16x16x32_bf16 a[232:235], a[240:243], v[104:107], a[232:235]
buffer_load_dwordx4 v1, s[8:11], s46 offen offset:2048 sc1 lds
v_mfma_f32_16x16x32_bf16 a[236:239], a[240:243], v[108:111], a[236:239]
v_cndmask_b32 v64, v8, v64, s[80:81]
v_cndmask_b32 v65, v8, v65, s[82:83]
v_mfma_f32_16x16x32_bf16 a[96:99], a[64:67], v[96:99], a[96:99]
ds_read_b128 a[76:79], v2 offset:11264
v_cndmask_b32 v66, v8, v66, s[84:85]
v_mfma_f32_16x16x32_bf16 a[100:103], a[64:67], v[100:103], a[100:103]
s_add_u32 m0, s47, 896
v_cndmask_b32 v67, v8, v67, s[86:87]
v_cndmask_b32 v68, v8, v68, s[88:89]
v_mfma_f32_16x16x32_bf16 a[104:107], a[64:67], v[104:107], a[104:107]
buffer_load_dwordx4 v1, s[8:11], s46 offen offset:128 sc1 lds
v_cndmask_b32 v69, v8, v69, s[90:91]
v_mfma_f32_16x16x32_bf16 a[108:111], a[64:67], v[108:111], a[108:111]
s_waitcnt lgkmcnt(2)
v_cndmask_b32 v70, v8, v70, s[92:93]
v_cndmask_b32 v71, v8, v71, s[94:95]
v_mfma_f32_16x16x32_bf16 a[112:115], a[68:71], v[96:99], a[112:115]
ds_read_b128 a[80:83], v2 offset:12288
v_max3_f32 v16, v64, v65, v66
v_mfma_f32_16x16x32_bf16 a[116:119], a[68:71], v[100:103], a[116:119]
v_max3_f32 v16, v16, v67, v72
v_max3_f32 v16, v16, v73, v74
v_mfma_f32_16x16x32_bf16 a[120:123], a[68:71], v[104:107], a[120:123]
buffer_load_dwordx4 v1, s[8:11], s46 offen offset:2176 sc1 lds
v_max3_f32 v16, v16, v75, v80
v_mfma_f32_16x16x32_bf16 a[124:127], a[68:71], v[108:111], a[124:127]
s_waitcnt lgkmcnt(2)
v_max3_f32 v16, v16, v81, v82
v_max3_f32 v16, v16, v83, v88
v_mfma_f32_16x16x32_bf16 a[128:131], a[72:75], v[96:99], a[128:131]
ds_read_b128 a[84:87], v2 offset:13312
v_max3_f32 v16, v16, v89, v90
v_mfma_f32_16x16x32_bf16 a[132:135], a[72:75], v[100:103], a[132:135]
v_max3_f32 v16, v16, v91, v68
v_max3_f32 v16, v16, v69, v70
v_mfma_f32_16x16x32_bf16 a[136:139], a[72:75], v[104:107], a[136:139]
s_add_u32 m0, s47, 4096
v_max3_f32 v16, v16, v71, v76
v_max3_f32 v16, v16, v77, v78
v_mfma_f32_16x16x32_bf16 a[140:143], a[72:75], v[108:111], a[140:143]
s_waitcnt lgkmcnt(2)
v_max3_f32 v16, v16, v79, v84
v_max3_f32 v16, v16, v85, v86
v_mfma_f32_16x16x32_bf16 a[144:147], a[76:79], v[96:99], a[144:147]
ds_read_b128 a[88:91], v2 offset:14336
v_max3_f32 v16, v16, v87, v92
v_mfma_f32_16x16x32_bf16 a[148:151], a[76:79], v[100:103], a[148:151]
v_max3_f32 v16, v16, v93, v94
v_max_f32 v16, v16, v95
v_cmp_lt_f32 vcc, s54, v16
v_mfma_f32_16x16x32_bf16 a[152:155], a[76:79], v[104:107], a[152:155]
buffer_load_dwordx4 v1, s[8:11], s24 offen sc1 lds
s_cbranch_vccnz L_at_up3
L_at_upr3:
v_mfma_f32_16x16x32_bf16 a[156:159], a[76:79], v[108:111], a[156:159]
s_waitcnt lgkmcnt(2)
v_exp_f32 v64, v64
v_mfma_f32_16x16x32_bf16 a[160:163], a[80:83], v[96:99], a[160:163]
ds_read_b128 a[92:95], v2 offset:15360
v_exp_f32 v65, v65
v_mfma_f32_16x16x32_bf16 a[164:167], a[80:83], v[100:103], a[164:167]
v_exp_f32 v66, v66
v_cvt_pk_bf16_f32 v112, v64, v65
v_mfma_f32_16x16x32_bf16 a[168:171], a[80:83], v[104:107], a[168:171]
buffer_load_dwordx4 v1, s[8:11], s24 offen offset:2048 sc1 lds
v_exp_f32 v67, v67
v_mfma_f32_16x16x32_bf16 a[172:175], a[80:83], v[108:111], a[172:175]
s_waitcnt lgkmcnt(2)
v_exp_f32 v68, v68
v_cvt_pk_bf16_f32 v113, v66, v67
v_mfma_f32_16x16x32_bf16 a[176:179], a[84:87], v[96:99], a[176:179]
ds_read_b128 a[64:67], v3
v_exp_f32 v69, v69
v_mfma_f32_16x16x32_bf16 a[180:183], a[84:87], v[100:103], a[180:183]
v_exp_f32 v70, v70
v_cvt_pk_bf16_f32 v114, v68, v69
v_mfma_f32_16x16x32_bf16 a[184:187], a[84:87], v[104:107], a[184:187]
s_add_u32 m0, s47, 4992
v_exp_f32 v71, v71
v_mfma_f32_16x16x32_bf16 a[188:191], a[84:87], v[108:111], a[188:191]
s_waitcnt lgkmcnt(2)
v_exp_f32 v72, v72
v_cvt_pk_bf16_f32 v115, v70, v71
v_mfma_f32_16x16x32_bf16 a[192:195], a[88:91], v[96:99], a[192:195]
ds_read_b128 a[68:71], v3 offset:1024
v_exp_f32 v73, v73
v_mfma_f32_16x16x32_bf16 a[196:199], a[88:91], v[100:103], a[196:199]
buffer_load_dwordx4 v1, s[8:11], s24 offen offset:128 sc1 lds
v_exp_f32 v74, v74
v_mfma_f32_16x16x32_bf16 a[200:203], a[88:91], v[104:107], a[200:203]
v_exp_f32 v75, v75
v_cvt_pk_bf16_f32 v116, v72, v73
v_mfma_f32_16x16x32_bf16 a[204:207], a[88:91], v[108:111], a[204:207]
s_waitcnt lgkmcnt(2)
v_exp_f32 v76, v76
v_cvt_pk_bf16_f32 v117, v74, v75
v_mfma_f32_16x16x32_bf16 a[208:211], a[92:95], v[96:99], a[208:211]
ds_read_b128 a[72:75], v3 offset:2048
v_exp_f32 v77, v77
v_mfma_f32_16x16x32_bf16 a[212:215], a[92:95], v[100:103], a[212:215]
buffer_load_dwordx4 v1, s[8:11], s24 offen offset:2176 sc1 lds
v_exp_f32 v78, v78
v_mfma_f32_16x16x32_bf16 a[216:219], a[92:95], v[104:107], a[216:219]
v_exp_f32 v79, v79
v_cvt_pk_bf16_f32 v118, v76, v77
v_mfma_f32_16x16x32_bf16 a[220:223], a[92:95], v[108:111], a[220:223]
s_waitcnt lgkmcnt(2)
s_cmp_eq_u32 s48, 0
s_cbranch_scc0 L_at_rs3
L_at_rsr3:
v_cvt_pk_bf16_f32 v119, v78, v79
v_mfma_f32_16x16x32_bf16 v[40:43], a[64:67], a[16:19], v[132:135]
ds_read_b128 a[76:79], v3 offset:3072
v_mfma_f32_16x16x32_bf16 v[48:51], a[64:67], a[32:35], v[136:139]
v_exp_f32 v80, v80
v_mfma_f32_16x16x32_bf16 v[56:59], a[64:67], a[48:51], v[140:143]
s_waitcnt lgkmcnt(2)
v_exp_f32 v81, v81
v_mfma_f32_16x16x32_bf16 v[44:47], a[68:71], a[16:19], v[132:135]
ds_read_b128 a[80:83], v3 offset:4096
v_exp_f32 v82, v82
v_mfma_f32_16x16x32_bf16 v[52:55], a[68:71], a[32:35], v[136:139]
s_add_u32 s46, s46, 1048576
v_exp_f32 v83, v83
v_mfma_f32_16x16x32_bf16 v[60:63], a[68:71], a[48:51], v[140:143]
s_waitcnt lgkmcnt(2)
v_exp_f32 v84, v84
v_mfma_f32_16x16x32_bf16 v[40:43], a[72:75], a[20:23], v[40:43]
ds_read_b128 a[84:87], v3 offset:5120
v_cvt_pk_bf16_f32 v120, v80, v81
v_mfma_f32_16x16x32_bf16 v[48:51], a[72:75], a[36:39], v[48:51]
v_exp_f32 v85, v85
v_mfma_f32_16x16x32_bf16 v[56:59], a[72:75], a[52:55], v[56:59]
s_waitcnt lgkmcnt(2)
v_exp_f32 v86, v86
v_mfma_f32_16x16x32_bf16 v[44:47], a[76:79], a[20:23], v[44:47]
ds_read_b128 a[88:91], v3 offset:6144
v_cvt_pk_bf16_f32 v121, v82, v83
v_mfma_f32_16x16x32_bf16 v[52:55], a[76:79], a[36:39], v[52:55]
s_add_u32 s47, s47, 32768
v_exp_f32 v87, v87
v_mfma_f32_16x16x32_bf16 v[60:63], a[76:79], a[52:55], v[60:63]
s_waitcnt lgkmcnt(2)
v_exp_f32 v88, v88
v_mfma_f32_16x16x32_bf16 v[40:43], a[80:83], a[24:27], v[40:43]
ds_read_b128 a[92:95], v3 offset:7168
v_cvt_pk_bf16_f32 v122, v84, v85
v_mfma_f32_16x16x32_bf16 v[48:51], a[80:83], a[40:43], v[48:51]
v_exp_f32 v89, v89
v_mfma_f32_16x16x32_bf16 v[56:59], a[80:83], a[56:59], v[56:59]
s_waitcnt lgkmcnt(2)
v_exp_f32 v90, v90
v_mfma_f32_16x16x32_bf16 v[44:47], a[84:87], a[24:27], v[44:47]
ds_read_b128 a[64:67], v2 offset:24576
v_cvt_pk_bf16_f32 v123, v86, v87
v_mfma_f32_16x16x32_bf16 v[52:55], a[84:87], a[40:43], v[52:55]
s_and_b32 s47, s47, 131071
v_exp_f32 v91, v91
v_mfma_f32_16x16x32_bf16 v[60:63], a[84:87], a[56:59], v[60:63]
s_waitcnt lgkmcnt(2)
v_exp_f32 v92, v92
v_mfma_f32_16x16x32_bf16 v[40:43], a[88:91], a[28:31], v[40:43]
ds_read_b128 a[68:71], v2 offset:25600
v_cvt_pk_bf16_f32 v124, v88, v89
v_mfma_f32_16x16x32_bf16 v[48:51], a[88:91], a[44:47], v[48:51]
v_exp_f32 v93, v93
v_mfma_f32_16x16x32_bf16 v[56:59], a[88:91], a[60:63], v[56:59]
s_waitcnt lgkmcnt(2)
v_exp_f32 v94, v94
v_mfma_f32_16x16x32_bf16 v[44:47], a[92:95], a[28:31], v[44:47]
ds_read_b128 a[72:75], v2 offset:26624
v_cvt_pk_bf16_f32 v125, v90, v91
v_mfma_f32_16x16x32_bf16 v[52:55], a[92:95], a[44:47], v[52:55]
v_exp_f32 v95, v95
v_mfma_f32_16x16x32_bf16 v[60:63], a[92:95], a[60:63], v[60:63]
s_waitcnt lgkmcnt(2)
v_cvt_pk_bf16_f32 v126, v92, v93
v_cvt_pk_bf16_f32 v127, v94, v95
v_mov_b32 v4, v2
v_mov_b32 v2, v3
v_add_u32 v3, 32768, v3
v_and_b32 v3, 131071, v3
v_mfma_f32_16x16x32_bf16 a[224:227], a[240:243], v[112:115], a[224:227]
s_lshl_b32 s46, s42, 14
v_mfma_f32_16x16x32_bf16 a[228:231], a[240:243], v[116:119], a[228:231]
v_mfma_f32_16x16x32_bf16 a[232:235], a[240:243], v[120:123], a[232:235]
v_mfma_f32_16x16x32_bf16 a[236:239], a[240:243], v[124:127], a[236:239]
v_cndmask_b32 v40, v8, v40, s[64:65]
v_cndmask_b32 v41, v8, v41, s[66:67]
v_mfma_f32_16x16x32_bf16 a[96:99], a[64:67], v[112:115], a[96:99]
ds_read_b128 a[76:79], v4 offset:27648
v_cndmask_b32 v42, v8, v42, s[68:69]
v_mfma_f32_16x16x32_bf16 a[100:103], a[64:67], v[116:119], a[100:103]
v_cndmask_b32 v43, v8, v43, s[70:71]
v_cndmask_b32 v44, v8, v44, s[72:73]
v_mfma_f32_16x16x32_bf16 a[104:107], a[64:67], v[120:123], a[104:107]
v_cndmask_b32 v45, v8, v45, s[74:75]
v_cndmask_b32 v46, v8, v46, s[76:77]
v_mfma_f32_16x16x32_bf16 a[108:111], a[64:67], v[124:127], a[108:111]
s_waitcnt lgkmcnt(2)
v_cndmask_b32 v47, v8, v47, s[78:79]
v_max3_f32 v16, v40, v41, v42
v_mfma_f32_16x16x32_bf16 a[112:115], a[68:71], v[112:115], a[112:115]
ds_read_b128 a[80:83], v4 offset:28672
v_max3_f32 v16, v16, v43, v48
v_mfma_f32_16x16x32_bf16 a[116:119], a[68:71], v[116:119], a[116:119]
v_max3_f32 v16, v16, v49, v50
v_max3_f32 v16, v16, v51, v56
v_mfma_f32_16x16x32_bf16 a[120:123], a[68:71], v[120:123], a[120:123]
v_max3_f32 v16, v16, v57, v58
v_max3_f32 v16, v16, v59, v44
v_mfma_f32_16x16x32_bf16 a[124:127], a[68:71], v[124:127], a[124:127]
s_waitcnt lgkmcnt(2)
v_max3_f32 v16, v16, v45, v46
v_max3_f32 v16, v16, v47, v52
v_mfma_f32_16x16x32_bf16 a[128:131], a[72:75], v[112:115], a[128:131]
ds_read_b128 a[84:87], v4 offset:29696
v_max3_f32 v16, v16, v53, v54
v_mfma_f32_16x16x32_bf16 a[132:135], a[72:75], v[116:119], a[132:135]
s_add_u32 s46, s46, 0
v_max3_f32 v16, v16, v55, v60
v_max3_f32 v16, v16, v61, v62
v_mfma_f32_16x16x32_bf16 a[136:139], a[72:75], v[120:123], a[136:139]
v_max_f32 v16, v16, v63
v_cmp_lt_f32 vcc, s54, v16
v_mfma_f32_16x16x32_bf16 a[140:143], a[72:75], v[124:127], a[140:143]
s_waitcnt lgkmcnt(2)
s_cbranch_vccnz L_at_up4
L_at_upr4:
v_mfma_f32_16x16x32_bf16 a[144:147], a[76:79], v[112:115], a[144:147]
ds_read_b128 a[88:91], v4 offset:30720
v_mfma_f32_16x16x32_bf16 a[148:151], a[76:79], v[116:119], a[148:151]
v_exp_f32 v40, v40
v_mfma_f32_16x16x32_bf16 a[152:155], a[76:79], v[120:123], a[152:155]
v_exp_f32 v41, v41
v_mfma_f32_16x16x32_bf16 a[156:159], a[76:79], v[124:127], a[156:159]
s_waitcnt lgkmcnt(2)
v_exp_f32 v42, v42
v_mfma_f32_16x16x32_bf16 a[160:163], a[80:83], v[112:115], a[160:163]
ds_read_b128 a[92:95], v4 offset:31744
v_cvt_pk_bf16_f32 v100, v40, v41
v_mfma_f32_16x16x32_bf16 a[164:167], a[80:83], v[116:119], a[164:167]
v_exp_f32 v43, v43
v_mfma_f32_16x16x32_bf16 a[168:171], a[80:83], v[120:123], a[168:171]
v_exp_f32 v44, v44
v_mfma_f32_16x16x32_bf16 a[172:175], a[80:83], v[124:127], a[172:175]
s_waitcnt lgkmcnt(2)
v_exp_f32 v45, v45
v_mfma_f32_16x16x32_bf16 a[176:179], a[84:87], v[112:115], a[176:179]
ds_read_b128 a[64:67], v2 offset:16384
v_cvt_pk_bf16_f32 v101, v42, v43
v_mfma_f32_16x16x32_bf16 a[180:183], a[84:87], v[116:119], a[180:183]
v_exp_f32 v46, v46
v_mfma_f32_16x16x32_bf16 a[184:187], a[84:87], v[120:123], a[184:187]
v_exp_f32 v47, v47
v_mfma_f32_16x16x32_bf16 a[188:191], a[84:87], v[124:127], a[188:191]
s_waitcnt lgkmcnt(2)
v_exp_f32 v48, v48
v_mfma_f32_16x16x32_bf16 a[192:195], a[88:91], v[112:115], a[192:195]
ds_read_b128 a[68:71], v2 offset:17408
v_cvt_pk_bf16_f32 v102, v44, v45
v_mfma_f32_16x16x32_bf16 a[196:199], a[88:91], v[116:119], a[196:199]
v_exp_f32 v49, v49
v_mfma_f32_16x16x32_bf16 a[200:203], a[88:91], v[120:123], a[200:203]
s_cmp_lt_u32 s63, 8
s_cselect_b32 s46, s46, 536870912
v_cvt_pk_bf16_f32 v103, v46, v47
v_mfma_f32_16x16x32_bf16 a[204:207], a[88:91], v[124:127], a[204:207]
s_waitcnt lgkmcnt(2)
v_exp_f32 v50, v50
v_mfma_f32_16x16x32_bf16 a[208:211], a[92:95], v[112:115], a[208:211]
ds_read_b128 a[72:75], v2 offset:18432
v_cvt_pk_bf16_f32 v104, v48, v49
v_mfma_f32_16x16x32_bf16 a[212:215], a[92:95], v[116:119], a[212:215]
v_exp_f32 v51, v51
v_mfma_f32_16x16x32_bf16 a[216:219], a[92:95], v[120:123], a[216:219]
v_exp_f32 v52, v52
v_mfma_f32_16x16x32_bf16 a[220:223], a[92:95], v[124:127], a[220:223]
s_waitcnt lgkmcnt(2)
s_cmp_eq_u32 s48, 0
s_cbranch_scc0 L_at_rs4
L_at_rsr4:
v_mfma_f32_16x16x32_bf16 v[72:75], a[64:67], a[16:19], v[132:135]
ds_read_b128 a[76:79], v2 offset:19456
v_cvt_pk_bf16_f32 v105, v50, v51
v_mfma_f32_16x16x32_bf16 v[80:83], a[64:67], a[32:35], v[136:139]
v_exp_f32 v53, v53
v_mfma_f32_16x16x32_bf16 v[88:91], a[64:67], a[48:51], v[140:143]
s_waitcnt lgkmcnt(2)
v_exp_f32 v54, v54
v_mfma_f32_16x16x32_bf16 v[76:79], a[68:71], a[16:19], v[132:135]
ds_read_b128 a[80:83], v2 offset:20480
v_cvt_pk_bf16_f32 v106, v52, v53
v_mfma_f32_16x16x32_bf16 v[84:87], a[68:71], a[32:35], v[136:139]
v_exp_f32 v55, v55
v_mfma_f32_16x16x32_bf16 v[92:95], a[68:71], a[48:51], v[140:143]
s_waitcnt lgkmcnt(2)
v_exp_f32 v56, v56
v_mfma_f32_16x16x32_bf16 v[72:75], a[72:75], a[20:23], v[72:75]
ds_read_b128 a[84:87], v2 offset:21504
v_cvt_pk_bf16_f32 v107, v54, v55
v_mfma_f32_16x16x32_bf16 v[80:83], a[72:75], a[36:39], v[80:83]
v_exp_f32 v57, v57
v_mfma_f32_16x16x32_bf16 v[88:91], a[72:75], a[52:55], v[88:91]
s_waitcnt lgkmcnt(2)
v_exp_f32 v58, v58
v_mfma_f32_16x16x32_bf16 v[76:79], a[76:79], a[20:23], v[76:79]
ds_read_b128 a[88:91], v2 offset:22528
v_cvt_pk_bf16_f32 v108, v56, v57
v_mfma_f32_16x16x32_bf16 v[84:87], a[76:79], a[36:39], v[84:87]
v_exp_f32 v59, v59
v_mfma_f32_16x16x32_bf16 v[92:95], a[76:79], a[52:55], v[92:95]
s_waitcnt lgkmcnt(2)
v_exp_f32 v60, v60
v_mfma_f32_16x16x32_bf16 v[72:75], a[80:83], a[24:27], v[72:75]
ds_read_b128 a[92:95], v2 offset:23552
v_cvt_pk_bf16_f32 v109, v58, v59
v_mfma_f32_16x16x32_bf16 v[80:83], a[80:83], a[40:43], v[80:83]
v_exp_f32 v61, v61
v_mfma_f32_16x16x32_bf16 v[88:91], a[80:83], a[56:59], v[88:91]
s_waitcnt lgkmcnt(2)
v_exp_f32 v62, v62
v_mfma_f32_16x16x32_bf16 v[76:79], a[84:87], a[24:27], v[76:79]
ds_read_b128 a[64:67], v2 offset:8192
v_cvt_pk_bf16_f32 v110, v60, v61
v_mfma_f32_16x16x32_bf16 v[84:87], a[84:87], a[40:43], v[84:87]
v_exp_f32 v63, v63
v_mfma_f32_16x16x32_bf16 v[92:95], a[84:87], a[56:59], v[92:95]
s_waitcnt lgkmcnt(2)
v_cvt_pk_bf16_f32 v111, v62, v63
v_mfma_f32_16x16x32_bf16 v[72:75], a[88:91], a[28:31], v[72:75]
ds_read_b128 a[68:71], v2 offset:9216
v_mfma_f32_16x16x32_bf16 v[80:83], a[88:91], a[44:47], v[80:83]
v_mfma_f32_16x16x32_bf16 v[88:91], a[88:91], a[60:63], v[88:91]
s_waitcnt lgkmcnt(2)
v_mfma_f32_16x16x32_bf16 v[76:79], a[92:95], a[28:31], v[76:79]
ds_read_b128 a[72:75], v2 offset:10240
v_mfma_f32_16x16x32_bf16 v[84:87], a[92:95], a[44:47], v[84:87]
v_mfma_f32_16x16x32_bf16 v[92:95], a[92:95], a[60:63], v[92:95]
s_waitcnt lgkmcnt(2)
s_waitcnt vmcnt(8)
s_barrier
s_add_u32 s25, s61, 0
v_mov_b32 v19, 1
s_mov_b64 exec, 1
buffer_store_dword v19, v6, s[8:11], s60 offen sc1
s_mov_b64 exec, -1
v_mfma_f32_16x16x32_bf16 a[228:231], a[240:243], v[100:103], a[228:231]
s_add_u32 s24, s46, 4096
v_mfma_f32_16x16x32_bf16 a[232:235], a[240:243], v[104:107], a[232:235]
v_mfma_f32_16x16x32_bf16 a[236:239], a[240:243], v[108:111], a[236:239]
s_add_u32 m0, s47, 0
v_mfma_f32_16x16x32_bf16 a[100:103], a[64:67], v[100:103], a[100:103]
ds_read_b128 a[76:79], v2 offset:11264
v_cndmask_b32 v72, v8, v72, s[80:81]
v_mfma_f32_16x16x32_bf16 a[104:107], a[64:67], v[104:107], a[104:107]
v_cndmask_b32 v73, v8, v73, s[82:83]
v_cndmask_b32 v74, v8, v74, s[84:85]
v_mfma_f32_16x16x32_bf16 a[108:111], a[64:67], v[108:111], a[108:111]
s_waitcnt lgkmcnt(2)
buffer_load_dwordx4 v1, s[8:11], s46 offen sc1 lds
v_cndmask_b32 v75, v8, v75, s[86:87]
v_mfma_f32_16x16x32_bf16 a[116:119], a[68:71], v[100:103], a[116:119]
ds_read_b128 a[80:83], v2 offset:12288
v_cndmask_b32 v76, v8, v76, s[88:89]
v_cndmask_b32 v77, v8, v77, s[90:91]
v_mfma_f32_16x16x32_bf16 a[120:123], a[68:71], v[104:107], a[120:123]
v_cndmask_b32 v78, v8, v78, s[92:93]
v_cndmask_b32 v79, v8, v79, s[94:95]
v_mfma_f32_16x16x32_bf16 a[124:127], a[68:71], v[108:111], a[124:127]
s_waitcnt lgkmcnt(2)
buffer_load_dwordx4 v1, s[8:11], s46 offen offset:2048 sc1 lds
v_max3_f32 v16, v72, v73, v74
v_mfma_f32_16x16x32_bf16 a[132:135], a[72:75], v[100:103], a[132:135]
ds_read_b128 a[84:87], v2 offset:13312
v_max3_f32 v16, v16, v75, v80
v_max3_f32 v16, v16, v81, v82
v_mfma_f32_16x16x32_bf16 a[136:139], a[72:75], v[104:107], a[136:139]
s_add_u32 m0, s47, 896
v_max3_f32 v16, v16, v83, v88
v_max3_f32 v16, v16, v89, v90
v_mfma_f32_16x16x32_bf16 a[140:143], a[72:75], v[108:111], a[140:143]
s_waitcnt lgkmcnt(2)
v_max3_f32 v16, v16, v91, v76
v_max3_f32 v16, v16, v77, v78
v_mfma_f32_16x16x32_bf16 a[148:151], a[76:79], v[100:103], a[148:151]
ds_read_b128 a[88:91], v2 offset:14336
v_max3_f32 v16, v16, v79, v84
v_mfma_f32_16x16x32_bf16 a[152:155], a[76:79], v[104:107], a[152:155]
buffer_load_dwordx4 v1, s[8:11], s46 offen offset:128 sc1 lds
v_max3_f32 v16, v16, v85, v86
v_max3_f32 v16, v16, v87, v92
v_mfma_f32_16x16x32_bf16 a[156:159], a[76:79], v[108:111], a[156:159]
s_waitcnt lgkmcnt(2)
v_max3_f32 v16, v16, v93, v94
v_max_f32 v16, v16, v95
v_cmp_lt_f32 vcc, s54, v16
v_mfma_f32_16x16x32_bf16 a[164:167], a[80:83], v[100:103], a[164:167]
ds_read_b128 a[92:95], v2 offset:15360
s_cbranch_vccnz L_at_up5
L_at_upr5:
v_exp_f32 v72, v72
v_exp_f32 v73, v73
v_accvgpr_read_b32 v18, a224
v_mfma_f32_16x16x32_bf16 a[168:171], a[80:83], v[104:107], a[168:171]
buffer_load_dwordx4 v1, s[8:11], s46 offen offset:2176 sc1 lds
v_exp_f32 v74, v74
v_exp_f32 v75, v75
v_exp_f32 v76, v76
v_mfma_f32_16x16x32_bf16 a[172:175], a[80:83], v[108:111], a[172:175]
s_waitcnt lgkmcnt(2)
v_exp_f32 v77, v77
v_exp_f32 v78, v78
v_exp_f32 v79, v79
v_cvt_pk_bf16_f32 v116, v72, v73
v_mfma_f32_16x16x32_bf16 a[180:183], a[84:87], v[100:103], a[180:183]
ds_read_b128 a[64:67], v3
s_add_u32 m0, s47, 4096
v_exp_f32 v80, v80
v_exp_f32 v81, v81
v_cvt_pk_bf16_f32 v117, v74, v75
v_mfma_f32_16x16x32_bf16 a[184:187], a[84:87], v[104:107], a[184:187]
v_exp_f32 v82, v82
v_exp_f32 v83, v83
v_exp_f32 v84, v84
v_cvt_pk_bf16_f32 v118, v76, v77
v_mfma_f32_16x16x32_bf16 a[188:191], a[84:87], v[108:111], a[188:191]
s_waitcnt lgkmcnt(2)
v_exp_f32 v85, v85
v_exp_f32 v86, v86
v_exp_f32 v87, v87
v_cvt_pk_bf16_f32 v119, v78, v79
v_mfma_f32_16x16x32_bf16 a[196:199], a[88:91], v[100:103], a[196:199]
ds_read_b128 a[68:71], v3 offset:1024
buffer_load_dwordx4 v1, s[8:11], s24 offen sc1 lds
v_exp_f32 v88, v88
v_exp_f32 v89, v89
v_cvt_pk_bf16_f32 v120, v80, v81
v_mfma_f32_16x16x32_bf16 a[200:203], a[88:91], v[104:107], a[200:203]
v_exp_f32 v90, v90
v_exp_f32 v91, v91
v_exp_f32 v92, v92
v_cvt_pk_bf16_f32 v121, v82, v83
v_mfma_f32_16x16x32_bf16 a[204:207], a[88:91], v[108:111], a[204:207]
s_waitcnt lgkmcnt(2)
v_exp_f32 v93, v93
v_exp_f32 v94, v94
v_exp_f32 v95, v95
v_cvt_pk_bf16_f32 v122, v84, v85
v_mfma_f32_16x16x32_bf16 a[212:215], a[92:95], v[100:103], a[212:215]
ds_read_b128 a[72:75], v3 offset:2048
buffer_load_dwordx4 v1, s[8:11], s24 offen offset:2048 sc1 lds
v_cvt_pk_bf16_f32 v123, v86, v87
v_cvt_pk_bf16_f32 v124, v88, v89
v_cvt_pk_bf16_f32 v125, v90, v91
v_cvt_pk_bf16_f32 v126, v92, v93
v_cvt_pk_bf16_f32 v127, v94, v95
v_mfma_f32_16x16x32_bf16 a[216:219], a[92:95], v[104:107], a[216:219]
v_rcp_f32 v18, v18
v_accvgpr_read_b32 v224, a96
v_accvgpr_read_b32 v225, a97
v_accvgpr_read_b32 v226, a98
v_accvgpr_read_b32 v227, a99
v_accvgpr_read_b32 v228, a112
v_mfma_f32_16x16x32_bf16 a[220:223], a[92:95], v[108:111], a[220:223]
s_waitcnt lgkmcnt(2)
s_add_u32 m0, s47, 4992
s_cmp_eq_u32 s48, 0
s_cbranch_scc0 L_at_rs5
L_at_rsr5:
v_accvgpr_read_b32 v229, a113
v_accvgpr_read_b32 v230, a114
v_accvgpr_read_b32 v231, a115
v_mul_f32 v224, v224, v18
v_mul_f32 v225, v225, v18
v_mfma_f32_16x16x32_bf16 v[48:51], a[64:67], a[32:35], v[136:139]
ds_read_b128 a[76:79], v3 offset:3072
v_mul_f32 v226, v226, v18
v_mul_f32 v227, v227, v18
v_mul_f32 v228, v228, v18
v_mul_f32 v229, v229, v18
v_mul_f32 v230, v230, v18
v_mul_f32 v231, v231, v18
v_mfma_f32_16x16x32_bf16 v[56:59], a[64:67], a[48:51], v[140:143]
s_waitcnt lgkmcnt(2)
v_cvt_pk_bf16_f32 v224, v224, v225
v_cvt_pk_bf16_f32 v225, v226, v227
v_cvt_pk_bf16_f32 v226, v228, v229
v_cvt_pk_bf16_f32 v227, v230, v231
buffer_store_dwordx4 v[224:227], v6, s[8:11], s25 offen sc1
v_mfma_f32_16x16x32_bf16 v[52:55], a[68:71], a[32:35], v[136:139]
ds_read_b128 a[80:83], v3 offset:4096
buffer_load_dwordx4 v1, s[8:11], s24 offen offset:128 sc1 lds
v_accvgpr_read_b32 v232, a128
v_accvgpr_read_b32 v233, a129
v_accvgpr_read_b32 v234, a130
v_accvgpr_read_b32 v235, a131
v_mfma_f32_16x16x32_bf16 v[60:63], a[68:71], a[48:51], v[140:143]
s_waitcnt lgkmcnt(2)
v_accvgpr_read_b32 v236, a144
v_accvgpr_read_b32 v237, a145
v_accvgpr_read_b32 v238, a146
v_accvgpr_read_b32 v239, a147
v_mul_f32 v232, v232, v18
v_mul_f32 v233, v233, v18
v_mfma_f32_16x16x32_bf16 v[48:51], a[72:75], a[36:39], v[48:51]
ds_read_b128 a[84:87], v3 offset:5120
v_mul_f32 v234, v234, v18
v_mul_f32 v235, v235, v18
v_mul_f32 v236, v236, v18
v_mul_f32 v237, v237, v18
v_mul_f32 v238, v238, v18
v_mfma_f32_16x16x32_bf16 v[56:59], a[72:75], a[52:55], v[56:59]
s_waitcnt lgkmcnt(2)
buffer_load_dwordx4 v1, s[8:11], s24 offen offset:2176 sc1 lds
v_mul_f32 v239, v239, v18
v_cvt_pk_bf16_f32 v232, v232, v233
v_cvt_pk_bf16_f32 v233, v234, v235
v_cvt_pk_bf16_f32 v234, v236, v237
v_cvt_pk_bf16_f32 v235, v238, v239
v_mfma_f32_16x16x32_bf16 v[52:55], a[76:79], a[36:39], v[52:55]
ds_read_b128 a[88:91], v3 offset:6144
buffer_store_dwordx4 v[232:235], v6, s[8:11], s25 offen offset:1024 sc1
v_accvgpr_read_b32 v240, a160
v_mfma_f32_16x16x32_bf16 v[60:63], a[76:79], a[52:55], v[60:63]
s_waitcnt lgkmcnt(2)
s_add_u32 s46, s46, 1048576
v_accvgpr_read_b32 v241, a161
v_accvgpr_read_b32 v242, a162
v_accvgpr_read_b32 v243, a163
v_accvgpr_read_b32 v244, a176
v_accvgpr_read_b32 v245, a177
v_mfma_f32_16x16x32_bf16 v[48:51], a[80:83], a[40:43], v[48:51]
ds_read_b128 a[92:95], v3 offset:7168
v_accvgpr_read_b32 v246, a178
v_accvgpr_read_b32 v247, a179
v_mul_f32 v240, v240, v18
v_mul_f32 v241, v241, v18
v_mul_f32 v242, v242, v18
v_mfma_f32_16x16x32_bf16 v[56:59], a[80:83], a[56:59], v[56:59]
s_waitcnt lgkmcnt(2)
v_mul_f32 v243, v243, v18
v_mul_f32 v244, v244, v18
v_mul_f32 v245, v245, v18
v_mul_f32 v246, v246, v18
v_mul_f32 v247, v247, v18
v_cvt_pk_bf16_f32 v240, v240, v241
v_mfma_f32_16x16x32_bf16 v[52:55], a[84:87], a[40:43], v[52:55]
ds_read_b128 a[64:67], v2 offset:24576
s_add_u32 s47, s47, 32768
v_cvt_pk_bf16_f32 v241, v242, v243
v_cvt_pk_bf16_f32 v242, v244, v245
v_cvt_pk_bf16_f32 v243, v246, v247
buffer_store_dwordx4 v[240:243], v6, s[8:11], s25 offen offset:2048 sc1
v_mfma_f32_16x16x32_bf16 v[60:63], a[84:87], a[56:59], v[60:63]
s_waitcnt lgkmcnt(2)
v_accvgpr_read_b32 v248, a192
v_accvgpr_read_b32 v249, a193
v_accvgpr_read_b32 v250, a194
v_accvgpr_read_b32 v251, a195
v_accvgpr_read_b32 v252, a208
v_accvgpr_read_b32 v253, a209
v_mfma_f32_16x16x32_bf16 v[48:51], a[88:91], a[44:47], v[48:51]
ds_read_b128 a[68:71], v2 offset:25600
v_accvgpr_read_b32 v254, a210
v_accvgpr_read_b32 v255, a211
v_mul_f32 v248, v248, v18
v_mul_f32 v249, v249, v18
v_mul_f32 v250, v250, v18
v_mfma_f32_16x16x32_bf16 v[56:59], a[88:91], a[60:63], v[56:59]
s_waitcnt lgkmcnt(2)
s_and_b32 s47, s47, 131071
v_mul_f32 v251, v251, v18
v_mul_f32 v252, v252, v18
v_mul_f32 v253, v253, v18
v_mul_f32 v254, v254, v18
v_mfma_f32_16x16x32_bf16 v[52:55], a[92:95], a[44:47], v[52:55]
ds_read_b128 a[72:75], v2 offset:26624
v_mul_f32 v255, v255, v18
v_cvt_pk_bf16_f32 v248, v248, v249
v_cvt_pk_bf16_f32 v249, v250, v251
v_cvt_pk_bf16_f32 v250, v252, v253
v_mfma_f32_16x16x32_bf16 v[60:63], a[92:95], a[60:63], v[60:63]
s_waitcnt lgkmcnt(2)
v_cvt_pk_bf16_f32 v251, v254, v255
buffer_store_dwordx4 v[248:251], v6, s[8:11], s25 offen offset:3072 sc1
v_mov_b32 v4, v2
v_mov_b32 v2, v3
v_add_u32 v3, 32768, v3
v_and_b32 v3, 131071, v3
s_cmp_ge_u32 s63, 8
s_cbranch_scc1 L_at_nq
v_mov_b32 v20, 0
s_lshr_b32 s25, s42, 1
s_lshl_b32 s25, s25, 5
s_add_u32 s25, s25, s63
s_lshl_b32 s25, s25, 2
s_add_u32 s25, s25, 111173632
s_mov_b32 s28, 0
L_poll_14:
buffer_load_dword v21, v20, s[8:11], s25 offen sc1
s_add_u32 s28, s28, 1
s_cmp_gt_u32 s28, 200000
s_cbranch_scc1 L_end
s_waitcnt vmcnt(0)
v_cmp_ne_u32 vcc, 1, v21
s_cbranch_vccz L_pd_15
s_sleep 1
s_branch L_poll_14
L_pd_15:
L_at_nq:
v_mfma_f32_16x16x32_bf16 a[228:231], a[240:243], v[116:119], a[228:231]
s_lshl_b32 s26, s63, 8
v_mfma_f32_16x16x32_bf16 a[232:235], a[240:243], v[120:123], a[232:235]
s_add_u32 s26, s26, s42
v_mfma_f32_16x16x32_bf16 a[236:239], a[240:243], v[124:127], a[236:239]
s_lshl_b32 s26, s26, 13
v_mfma_f32_16x16x32_bf16 a[100:103], a[64:67], v[116:119], a[100:103]
ds_read_b128 a[76:79], v4 offset:27648
v_cndmask_b32 v48, v8, v48, s[64:65]
v_mfma_f32_16x16x32_bf16 a[104:107], a[64:67], v[120:123], a[104:107]
s_add_u32 s26, s26, 117440512
v_cndmask_b32 v49, v8, v49, s[66:67]
v_cndmask_b32 v50, v8, v50, s[68:69]
v_mfma_f32_16x16x32_bf16 a[108:111], a[64:67], v[124:127], a[108:111]
s_waitcnt lgkmcnt(2)
s_cmp_lt_u32 s63, 8
s_cselect_b32 s26, s26, 536870912
v_cndmask_b32 v51, v8, v51, s[70:71]
v_mfma_f32_16x16x32_bf16 a[116:119], a[68:71], v[116:119], a[116:119]
ds_read_b128 a[80:83], v4 offset:28672
v_cndmask_b32 v52, v8, v52, s[72:73]
v_mfma_f32_16x16x32_bf16 a[120:123], a[68:71], v[120:123], a[120:123]
s_add_u32 s27, s26, 0
v_cndmask_b32 v53, v8, v53, s[74:75]
v_cndmask_b32 v54, v8, v54, s[76:77]
v_mfma_f32_16x16x32_bf16 a[124:127], a[68:71], v[124:127], a[124:127]
s_waitcnt lgkmcnt(2)
buffer_load_dwordx4 v[160:163], v7, s[8:11], s27 offen sc1
v_cndmask_b32 v55, v8, v55, s[78:79]
v_max3_f32 v16, v48, v49, v50
v_mfma_f32_16x16x32_bf16 a[132:135], a[72:75], v[116:119], a[132:135]
ds_read_b128 a[84:87], v4 offset:29696
v_max3_f32 v16, v16, v51, v56
v_mfma_f32_16x16x32_bf16 a[136:139], a[72:75], v[120:123], a[136:139]
buffer_load_dwordx4 v[164:167], v7, s[8:11], s27 offen offset:2048 sc1
v_max3_f32 v16, v16, v57, v58
v_max3_f32 v16, v16, v59, v52
v_mfma_f32_16x16x32_bf16 a[140:143], a[72:75], v[124:127], a[140:143]
s_waitcnt lgkmcnt(2)
s_add_u32 s27, s26, 4096
v_max3_f32 v16, v16, v53, v54
v_max3_f32 v16, v16, v55, v60
v_mfma_f32_16x16x32_bf16 a[148:151], a[76:79], v[116:119], a[148:151]
ds_read_b128 a[88:91], v4 offset:30720
v_max3_f32 v16, v16, v61, v62
v_max_f32 v16, v16, v63
v_cmp_lt_f32 vcc, s54, v16
v_mfma_f32_16x16x32_bf16 a[152:155], a[76:79], v[120:123], a[152:155]
buffer_load_dwordx4 v[168:171], v7, s[8:11], s27 offen sc1
s_cbranch_vccnz L_at_up6
L_at_upr6:
v_mfma_f32_16x16x32_bf16 a[156:159], a[76:79], v[124:127], a[156:159]
s_waitcnt lgkmcnt(2)
buffer_load_dwordx4 v[172:175], v7, s[8:11], s27 offen offset:2048 sc1
v_exp_f32 v48, v48
v_mfma_f32_16x16x32_bf16 a[164:167], a[80:83], v[116:119], a[164:167]
ds_read_b128 a[92:95], v4 offset:31744
v_exp_f32 v49, v49
v_mfma_f32_16x16x32_bf16 a[168:171], a[80:83], v[120:123], a[168:171]
s_add_u32 s27, s26, 524288
v_exp_f32 v50, v50
v_cvt_pk_bf16_f32 v104, v48, v49
v_mfma_f32_16x16x32_bf16 a[172:175], a[80:83], v[124:127], a[172:175]
s_waitcnt lgkmcnt(2)
buffer_load_dwordx4 v[176:179], v7, s[8:11], s27 offen sc1
v_exp_f32 v51, v51
v_mfma_f32_16x16x32_bf16 a[180:183], a[84:87], v[116:119], a[180:183]
ds_read_b128 a[64:67], v2 offset:16384
v_exp_f32 v52, v52
v_mfma_f32_16x16x32_bf16 a[184:187], a[84:87], v[120:123], a[184:187]
buffer_load_dwordx4 v[180:183], v7, s[8:11], s27 offen offset:2048 sc1
v_exp_f32 v53, v53
v_mfma_f32_16x16x32_bf16 a[188:191], a[84:87], v[124:127], a[188:191]
s_waitcnt lgkmcnt(2)
s_add_u32 s27, s26, 528384
v_exp_f32 v54, v54
v_mfma_f32_16x16x32_bf16 a[196:199], a[88:91], v[116:119], a[196:199]
ds_read_b128 a[68:71], v2 offset:17408
v_exp_f32 v55, v55
v_mfma_f32_16x16x32_bf16 a[200:203], a[88:91], v[120:123], a[200:203]
buffer_load_dwordx4 v[184:187], v7, s[8:11], s27 offen sc1
v_exp_f32 v56, v56
v_mfma_f32_16x16x32_bf16 a[204:207], a[88:91], v[124:127], a[204:207]
s_waitcnt lgkmcnt(2)
buffer_load_dwordx4 v[188:191], v7, s[8:11], s27 offen offset:2048 sc1
v_exp_f32 v57, v57
v_mfma_f32_16x16x32_bf16 a[212:215], a[92:95], v[116:119], a[212:215]
ds_read_b128 a[72:75], v2 offset:18432
v_exp_f32 v58, v58
v_mfma_f32_16x16x32_bf16 a[216:219], a[92:95], v[120:123], a[216:219]
s_add_u32 s27, s26, 1048576
v_exp_f32 v59, v59
v_cvt_pk_bf16_f32 v105, v50, v51
v_mfma_f32_16x16x32_bf16 a[220:223], a[92:95], v[124:127], a[220:223]
s_waitcnt lgkmcnt(2)
buffer_load_dwordx4 v[192:195], v7, s[8:11], s27 offen sc1
s_cmp_eq_u32 s48, 0
s_cbranch_scc0 L_at_rs6
L_at_rsr6:
v_mfma_f32_16x16x32_bf16 v[80:83], a[64:67], a[32:35], v[136:139]
ds_read_b128 a[76:79], v2 offset:19456
v_cvt_pk_bf16_f32 v106, v52, v53
v_mfma_f32_16x16x32_bf16 v[88:91], a[64:67], a[48:51], v[140:143]
s_waitcnt lgkmcnt(2)
buffer_load_dwordx4 v[196:199], v7, s[8:11], s27 offen offset:2048 sc1
v_cvt_pk_bf16_f32 v107, v54, v55
v_mfma_f32_16x16x32_bf16 v[84:87], a[68:71], a[32:35], v[136:139]
ds_read_b128 a[80:83], v2 offset:20480
s_add_u32 s27, s26, 1052672
v_mfma_f32_16x16x32_bf16 v[92:95], a[68:71], a[48:51], v[140:143]
s_waitcnt lgkmcnt(2)
v_exp_f32 v60, v60
v_mfma_f32_16x16x32_bf16 v[80:83], a[72:75], a[36:39], v[80:83]
ds_read_b128 a[84:87], v2 offset:21504
buffer_load_dwordx4 v[200:203], v7, s[8:11], s27 offen sc1
v_mfma_f32_16x16x32_bf16 v[88:91], a[72:75], a[52:55], v[88:91]
s_waitcnt lgkmcnt(2)
buffer_load_dwordx4 v[204:207], v7, s[8:11], s27 offen offset:2048 sc1
v_cvt_pk_bf16_f32 v108, v56, v57
v_mfma_f32_16x16x32_bf16 v[84:87], a[76:79], a[36:39], v[84:87]
ds_read_b128 a[88:91], v2 offset:22528
v_cvt_pk_bf16_f32 v109, v58, v59
v_mfma_f32_16x16x32_bf16 v[92:95], a[76:79], a[52:55], v[92:95]
s_waitcnt lgkmcnt(2)
s_add_u32 s27, s26, 1572864
v_mfma_f32_16x16x32_bf16 v[80:83], a[80:83], a[40:43], v[80:83]
ds_read_b128 a[92:95], v2 offset:23552
buffer_load_dwordx4 v[208:211], v7, s[8:11], s27 offen sc1
v_mfma_f32_16x16x32_bf16 v[88:91], a[80:83], a[56:59], v[88:91]
s_waitcnt lgkmcnt(2)
v_exp_f32 v61, v61
v_mfma_f32_16x16x32_bf16 v[84:87], a[84:87], a[40:43], v[84:87]
ds_read_b128 a[64:67], v2 offset:8192
buffer_load_dwordx4 v[212:215], v7, s[8:11], s27 offen offset:2048 sc1
v_cvt_pk_bf16_f32 v110, v60, v61
v_mfma_f32_16x16x32_bf16 v[92:95], a[84:87], a[56:59], v[92:95]
s_waitcnt lgkmcnt(2)
s_add_u32 s27, s26, 1576960
v_mfma_f32_16x16x32_bf16 v[80:83], a[88:91], a[44:47], v[80:83]
ds_read_b128 a[68:71], v2 offset:9216
v_exp_f32 v62, v62
v_mfma_f32_16x16x32_bf16 v[88:91], a[88:91], a[60:63], v[88:91]
s_waitcnt lgkmcnt(2)
buffer_load_dwordx4 v[216:219], v7, s[8:11], s27 offen sc1
v_mfma_f32_16x16x32_bf16 v[84:87], a[92:95], a[44:47], v[84:87]
ds_read_b128 a[72:75], v2 offset:10240
buffer_load_dwordx4 v[220:223], v7, s[8:11], s27 offen offset:2048 sc1
v_mfma_f32_16x16x32_bf16 v[92:95], a[92:95], a[60:63], v[92:95]
s_waitcnt lgkmcnt(2)
v_exp_f32 v63, v63
s_nop 0
v_cvt_pk_bf16_f32 v111, v62, v63
s_waitcnt vmcnt(28)
s_barrier
s_add_u32 s25, s61, 524288
v_mfma_f32_16x16x32_bf16 a[232:235], a[240:243], v[104:107], a[232:235]
s_add_u32 s24, s46, 4096
v_mfma_f32_16x16x32_bf16 a[236:239], a[240:243], v[108:111], a[236:239]
s_add_u32 m0, s47, 0
v_mfma_f32_16x16x32_bf16 a[104:107], a[64:67], v[104:107], a[104:107]
ds_read_b128 a[76:79], v2 offset:11264
v_mfma_f32_16x16x32_bf16 a[108:111], a[64:67], v[108:111], a[108:111]
s_waitcnt lgkmcnt(2)
buffer_load_dwordx4 v1, s[8:11], s46 offen sc1 lds
v_cndmask_b32 v80, v8, v80, s[80:81]
v_mfma_f32_16x16x32_bf16 a[120:123], a[68:71], v[104:107], a[120:123]
ds_read_b128 a[80:83], v2 offset:12288
buffer_load_dwordx4 v1, s[8:11], s46 offen offset:2048 sc1 lds
v_cndmask_b32 v81, v8, v81, s[82:83]
v_mfma_f32_16x16x32_bf16 a[124:127], a[68:71], v[108:111], a[124:127]
s_waitcnt lgkmcnt(2)
v_cndmask_b32 v82, v8, v82, s[84:85]
v_cndmask_b32 v83, v8, v83, s[86:87]
v_mfma_f32_16x16x32_bf16 a[136:139], a[72:75], v[104:107], a[136:139]
ds_read_b128 a[84:87], v2 offset:13312
s_add_u32 m0, s47, 896
v_cndmask_b32 v84, v8, v84, s[88:89]
v_mfma_f32_16x16x32_bf16 a[140:143], a[72:75], v[108:111], a[140:143]
s_waitcnt lgkmcnt(2)
v_cndmask_b32 v85, v8, v85, s[90:91]
v_cndmask_b32 v86, v8, v86, s[92:93]
v_mfma_f32_16x16x32_bf16 a[152:155], a[76:79], v[104:107], a[152:155]
ds_read_b128 a[88:91], v2 offset:14336
buffer_load_dwordx4 v1, s[8:11], s46 offen offset:128 sc1 lds
v_cndmask_b32 v87, v8, v87, s[94:95]
v_mfma_f32_16x16x32_bf16 a[156:159], a[76:79], v[108:111], a[156:159]
s_waitcnt lgkmcnt(2)
buffer_load_dwordx4 v1, s[8:11], s46 offen offset:2176 sc1 lds
v_max3_f32 v16, v80, v81, v82
v_max3_f32 v16, v16, v83, v88
v_mfma_f32_16x16x32_bf16 a[168:171], a[80:83], v[104:107], a[168:171]
ds_read_b128 a[92:95], v2 offset:15360
v_max3_f32 v16, v16, v89, v90
v_max3_f32 v16, v16, v91, v84
v_mfma_f32_16x16x32_bf16 a[172:175], a[80:83], v[108:111], a[172:175]
s_waitcnt lgkmcnt(2)
s_add_u32 m0, s47, 4096
v_max3_f32 v16, v16, v85, v86
v_max3_f32 v16, v16, v87, v92
v_mfma_f32_16x16x32_bf16 a[184:187], a[84:87], v[104:107], a[184:187]
ds_read_b128 a[64:67], v3
v_max3_f32 v16, v16, v93, v94
v_max_f32 v16, v16, v95
v_cmp_lt_f32 vcc, s54, v16
v_mfma_f32_16x16x32_bf16 a[188:191], a[84:87], v[108:111], a[188:191]
s_waitcnt lgkmcnt(2)
buffer_load_dwordx4 v1, s[8:11], s24 offen sc1 lds
s_cbranch_vccnz L_at_up7
L_at_upr7:
v_exp_f32 v80, v80
v_exp_f32 v81, v81
v_exp_f32 v82, v82
v_exp_f32 v83, v83
v_exp_f32 v84, v84
v_accvgpr_read_b32 v18, a228
v_mfma_f32_16x16x32_bf16 a[200:203], a[88:91], v[104:107], a[200:203]
ds_read_b128 a[68:71], v3 offset:1024
buffer_load_dwordx4 v1, s[8:11], s24 offen offset:2048 sc1 lds
v_exp_f32 v85, v85
v_exp_f32 v86, v86
v_exp_f32 v87, v87
v_exp_f32 v88, v88
v_exp_f32 v89, v89
v_cvt_pk_bf16_f32 v120, v80, v81
v_mfma_f32_16x16x32_bf16 a[204:207], a[88:91], v[108:111], a[204:207]
s_waitcnt lgkmcnt(2)
v_exp_f32 v90, v90
v_exp_f32 v91, v91
v_exp_f32 v92, v92
v_exp_f32 v93, v93
v_exp_f32 v94, v94
v_exp_f32 v95, v95
v_cvt_pk_bf16_f32 v121, v82, v83
v_mfma_f32_16x16x32_bf16 a[216:219], a[92:95], v[104:107], a[216:219]
ds_read_b128 a[72:75], v3 offset:2048
s_add_u32 m0, s47, 4992
v_cvt_pk_bf16_f32 v122, v84, v85
v_cvt_pk_bf16_f32 v123, v86, v87
v_cvt_pk_bf16_f32 v124, v88, v89
v_cvt_pk_bf16_f32 v125, v90, v91
v_cvt_pk_bf16_f32 v126, v92, v93
v_cvt_pk_bf16_f32 v127, v94, v95
v_rcp_f32 v18, v18
v_accvgpr_read_b32 v224, a100
v_accvgpr_read_b32 v225, a101
v_accvgpr_read_b32 v226, a102
v_mfma_f32_16x16x32_bf16 a[220:223], a[92:95], v[108:111], a[220:223]
s_waitcnt lgkmcnt(2)
buffer_load_dwordx4 v1, s[8:11], s24 offen offset:128 sc1 lds
s_cmp_eq_u32 s48, 0
s_cbranch_scc0 L_at_rs7
L_at_rsr7:
v_accvgpr_read_b32 v227, a103
v_accvgpr_read_b32 v228, a116
v_accvgpr_read_b32 v229, a117
v_accvgpr_read_b32 v230, a118
v_accvgpr_read_b32 v231, a119
v_mul_f32 v224, v224, v18
v_mul_f32 v225, v225, v18
v_mul_f32 v226, v226, v18
v_mul_f32 v227, v227, v18
v_mul_f32 v228, v228, v18
v_mul_f32 v229, v229, v18
v_mfma_f32_16x16x32_bf16 v[56:59], a[64:67], a[48:51], v[140:143]
ds_read_b128 a[76:79], v3 offset:3072
s_waitcnt lgkmcnt(2)
v_mul_f32 v230, v230, v18
v_mul_f32 v231, v231, v18
v_cvt_pk_bf16_f32 v224, v224, v225
v_cvt_pk_bf16_f32 v225, v226, v227
v_cvt_pk_bf16_f32 v226, v228, v229
v_cvt_pk_bf16_f32 v227, v230, v231
buffer_store_dwordx4 v[224:227], v6, s[8:11], s25 offen sc1
v_accvgpr_read_b32 v232, a132
v_mfma_f32_16x16x32_bf16 v[60:63], a[68:71], a[48:51], v[140:143]
ds_read_b128 a[80:83], v3 offset:4096
s_waitcnt lgkmcnt(2)
buffer_load_dwordx4 v1, s[8:11], s24 offen offset:2176 sc1 lds
v_accvgpr_read_b32 v233, a133
v_accvgpr_read_b32 v234, a134
v_accvgpr_read_b32 v235, a135
v_accvgpr_read_b32 v236, a148
v_accvgpr_read_b32 v237, a149
v_accvgpr_read_b32 v238, a150
v_accvgpr_read_b32 v239, a151
v_mul_f32 v232, v232, v18
v_mul_f32 v233, v233, v18
v_mul_f32 v234, v234, v18
v_mul_f32 v235, v235, v18
v_mfma_f32_16x16x32_bf16 v[56:59], a[72:75], a[52:55], v[56:59]
ds_read_b128 a[84:87], v3 offset:5120
s_waitcnt lgkmcnt(2)
v_mul_f32 v236, v236, v18
v_mul_f32 v237, v237, v18
v_mul_f32 v238, v238, v18
v_mul_f32 v239, v239, v18
v_cvt_pk_bf16_f32 v232, v232, v233
v_cvt_pk_bf16_f32 v233, v234, v235
v_cvt_pk_bf16_f32 v234, v236, v237
v_cvt_pk_bf16_f32 v235, v238, v239
buffer_store_dwordx4 v[232:235], v6, s[8:11], s25 offen offset:1024 sc1
v_mfma_f32_16x16x32_bf16 v[60:63], a[76:79], a[52:55], v[60:63]
ds_read_b128 a[88:91], v3 offset:6144
s_waitcnt lgkmcnt(2)
s_add_u32 s46, s46, 1048576
v_accvgpr_read_b32 v240, a164
v_accvgpr_read_b32 v241, a165
v_accvgpr_read_b32 v242, a166
v_accvgpr_read_b32 v243, a167
v_accvgpr_read_b32 v244, a180
v_accvgpr_read_b32 v245, a181
v_accvgpr_read_b32 v246, a182
v_accvgpr_read_b32 v247, a183
v_mul_f32 v240, v240, v18
v_mul_f32 v241, v241, v18
v_mfma_f32_16x16x32_bf16 v[56:59], a[80:83], a[56:59], v[56:59]
ds_read_b128 a[92:95], v3 offset:7168
s_waitcnt lgkmcnt(2)
s_add_u32 s47, s47, 32768
v_mul_f32 v242, v242, v18
v_mul_f32 v243, v243, v18
v_mul_f32 v244, v244, v18
v_mul_f32 v245, v245, v18
v_mul_f32 v246, v246, v18
v_mul_f32 v247, v247, v18
v_cvt_pk_bf16_f32 v240, v240, v241
v_cvt_pk_bf16_f32 v241, v242, v243
v_cvt_pk_bf16_f32 v242, v244, v245
v_cvt_pk_bf16_f32 v243, v246, v247
v_mfma_f32_16x16x32_bf16 v[60:63], a[84:87], a[56:59], v[60:63]
ds_read_b128 a[64:67], v2 offset:24576
s_waitcnt lgkmcnt(2)
buffer_store_dwordx4 v[240:243], v6, s[8:11], s25 offen offset:2048 sc1
v_accvgpr_read_b32 v248, a196
v_accvgpr_read_b32 v249, a197
v_accvgpr_read_b32 v250, a198
v_accvgpr_read_b32 v251, a199
v_accvgpr_read_b32 v252, a212
v_accvgpr_read_b32 v253, a213
v_mfma_f32_16x16x32_bf16 v[56:59], a[88:91], a[60:63], v[56:59]
ds_read_b128 a[68:71], v2 offset:25600
s_waitcnt lgkmcnt(2)
s_and_b32 s47, s47, 131071
v_accvgpr_read_b32 v254, a214
v_accvgpr_read_b32 v255, a215
v_mul_f32 v248, v248, v18
v_mul_f32 v249, v249, v18
v_mul_f32 v250, v250, v18
v_mul_f32 v251, v251, v18
v_mul_f32 v252, v252, v18
v_mul_f32 v253, v253, v18
v_mul_f32 v254, v254, v18
v_mfma_f32_16x16x32_bf16 v[60:63], a[92:95], a[60:63], v[60:63]
ds_read_b128 a[72:75], v2 offset:26624
s_waitcnt lgkmcnt(2)
v_mul_f32 v255, v255, v18
v_cvt_pk_bf16_f32 v248, v248, v249
v_cvt_pk_bf16_f32 v249, v250, v251
v_cvt_pk_bf16_f32 v250, v252, v253
v_cvt_pk_bf16_f32 v251, v254, v255
buffer_store_dwordx4 v[248:251], v6, s[8:11], s25 offen offset:3072 sc1
v_mov_b32 v4, v2
v_mov_b32 v2, v3
v_add_u32 v3, 32768, v3
v_and_b32 v3, 131071, v3
v_mfma_f32_16x16x32_bf16 a[232:235], a[240:243], v[120:123], a[232:235]
v_mfma_f32_16x16x32_bf16 a[236:239], a[240:243], v[124:127], a[236:239]
v_mfma_f32_16x16x32_bf16 a[104:107], a[64:67], v[120:123], a[104:107]
ds_read_b128 a[76:79], v4 offset:27648
v_mfma_f32_16x16x32_bf16 a[108:111], a[64:67], v[124:127], a[108:111]
s_waitcnt lgkmcnt(2)
v_cndmask_b32 v56, v8, v56, s[64:65]
v_cndmask_b32 v57, v8, v57, s[66:67]
v_mfma_f32_16x16x32_bf16 a[120:123], a[68:71], v[120:123], a[120:123]
ds_read_b128 a[80:83], v4 offset:28672
v_cndmask_b32 v58, v8, v58, s[68:69]
v_mfma_f32_16x16x32_bf16 a[124:127], a[68:71], v[124:127], a[124:127]
s_waitcnt lgkmcnt(2)
v_cndmask_b32 v59, v8, v59, s[70:71]
v_cndmask_b32 v60, v8, v60, s[72:73]
v_mfma_f32_16x16x32_bf16 a[136:139], a[72:75], v[120:123], a[136:139]
ds_read_b128 a[84:87], v4 offset:29696
v_cndmask_b32 v61, v8, v61, s[74:75]
v_mfma_f32_16x16x32_bf16 a[140:143], a[72:75], v[124:127], a[140:143]
s_waitcnt lgkmcnt(2)
v_cndmask_b32 v62, v8, v62, s[76:77]
v_cndmask_b32 v63, v8, v63, s[78:79]
v_mfma_f32_16x16x32_bf16 a[152:155], a[76:79], v[120:123], a[152:155]
ds_read_b128 a[88:91], v4 offset:30720
v_max3_f32 v16, v56, v57, v58
v_mfma_f32_16x16x32_bf16 a[156:159], a[76:79], v[124:127], a[156:159]
s_waitcnt lgkmcnt(2)
v_max3_f32 v16, v16, v59, v60
v_max3_f32 v16, v16, v61, v62
v_mfma_f32_16x16x32_bf16 a[168:171], a[80:83], v[120:123], a[168:171]
ds_read_b128 a[92:95], v4 offset:31744
v_max_f32 v16, v16, v63
v_cmp_lt_f32 vcc, s54, v16
v_mfma_f32_16x16x32_bf16 a[172:175], a[80:83], v[124:127], a[172:175]
s_waitcnt lgkmcnt(2)
s_cbranch_vccnz L_at_up8
L_at_upr8:
v_mfma_f32_16x16x32_bf16 a[184:187], a[84:87], v[120:123], a[184:187]
ds_read_b128 a[64:67], v2 offset:16384
v_exp_f32 v56, v56
v_mfma_f32_16x16x32_bf16 a[188:191], a[84:87], v[124:127], a[188:191]
s_waitcnt lgkmcnt(2)
v_exp_f32 v57, v57
v_mfma_f32_16x16x32_bf16 a[200:203], a[88:91], v[120:123], a[200:203]
ds_read_b128 a[68:71], v2 offset:17408
v_exp_f32 v58, v58
v_mfma_f32_16x16x32_bf16 a[204:207], a[88:91], v[124:127], a[204:207]
s_waitcnt lgkmcnt(2)
v_exp_f32 v59, v59
v_cvt_pk_bf16_f32 v108, v56, v57
v_mfma_f32_16x16x32_bf16 a[216:219], a[92:95], v[120:123], a[216:219]
ds_read_b128 a[72:75], v2 offset:18432
v_exp_f32 v60, v60
v_mfma_f32_16x16x32_bf16 a[220:223], a[92:95], v[124:127], a[220:223]
s_waitcnt lgkmcnt(2)
s_cmp_eq_u32 s48, 0
s_cbranch_scc0 L_at_rs8
L_at_rsr8:
v_cvt_pk_bf16_f32 v109, v58, v59
v_mfma_f32_16x16x32_bf16 v[88:91], a[64:67], a[48:51], v[140:143]
ds_read_b128 a[76:79], v2 offset:19456
s_waitcnt lgkmcnt(2)
v_mfma_f32_16x16x32_bf16 v[92:95], a[68:71], a[48:51], v[140:143]
ds_read_b128 a[80:83], v2 offset:20480
s_waitcnt lgkmcnt(2)
v_exp_f32 v61, v61
v_mfma_f32_16x16x32_bf16 v[88:91], a[72:75], a[52:55], v[88:91]
ds_read_b128 a[84:87], v2 offset:21504
s_waitcnt lgkmcnt(2)
v_cvt_pk_bf16_f32 v110, v60, v61
v_mfma_f32_16x16x32_bf16 v[92:95], a[76:79], a[52:55], v[92:95]
ds_read_b128 a[88:91], v2 offset:22528
s_waitcnt lgkmcnt(2)
v_mfma_f32_16x16x32_bf16 v[88:91], a[80:83], a[56:59], v[88:91]
ds_read_b128 a[92:95], v2 offset:23552
s_waitcnt lgkmcnt(2)
v_exp_f32 v62, v62
v_mfma_f32_16x16x32_bf16 v[92:95], a[84:87], a[56:59], v[92:95]
ds_read_b128 a[64:67], v2 offset:8192
s_waitcnt lgkmcnt(2)
v_mfma_f32_16x16x32_bf16 v[88:91], a[88:91], a[60:63], v[88:91]
ds_read_b128 a[68:71], v2 offset:9216
s_waitcnt lgkmcnt(2)
v_exp_f32 v63, v63
v_mfma_f32_16x16x32_bf16 v[92:95], a[92:95], a[60:63], v[92:95]
ds_read_b128 a[72:75], v2 offset:10240
s_waitcnt lgkmcnt(2)
v_cvt_pk_bf16_f32 v111, v62, v63
s_barrier
s_add_u32 s25, s61, 1048576
v_mfma_f32_16x16x32_bf16 a[236:239], a[240:243], v[108:111], a[236:239]
s_add_u32 s24, s46, 4096
s_add_u32 m0, s47, 0
v_mfma_f32_16x16x32_bf16 a[108:111], a[64:67], v[108:111], a[108:111]
ds_read_b128 a[76:79], v2 offset:11264
s_waitcnt lgkmcnt(2)
buffer_load_dwordx4 v1, s[8:11], s46 offen sc1 lds
buffer_load_dwordx4 v1, s[8:11], s46 offen offset:2048 sc1 lds
v_mfma_f32_16x16x32_bf16 a[124:127], a[68:71], v[108:111], a[124:127]
ds_read_b128 a[80:83], v2 offset:12288
s_waitcnt lgkmcnt(2)
s_add_u32 m0, s47, 896
s_nop 0
buffer_load_dwordx4 v1, s[8:11], s46 offen offset:128 sc1 lds
v_mfma_f32_16x16x32_bf16 a[140:143], a[72:75], v[108:111], a[140:143]
ds_read_b128 a[84:87], v2 offset:13312
s_waitcnt lgkmcnt(2)
buffer_load_dwordx4 v1, s[8:11], s46 offen offset:2176 sc1 lds
s_add_u32 m0, s47, 4096
v_cndmask_b32 v88, v8, v88, s[80:81]
v_cndmask_b32 v89, v8, v89, s[82:83]
v_cndmask_b32 v90, v8, v90, s[84:85]
v_mfma_f32_16x16x32_bf16 a[156:159], a[76:79], v[108:111], a[156:159]
ds_read_b128 a[88:91], v2 offset:14336
s_waitcnt lgkmcnt(2)
buffer_load_dwordx4 v1, s[8:11], s24 offen sc1 lds
v_cndmask_b32 v91, v8, v91, s[86:87]
v_cndmask_b32 v92, v8, v92, s[88:89]
v_cndmask_b32 v93, v8, v93, s[90:91]
v_cndmask_b32 v94, v8, v94, s[92:93]
v_mfma_f32_16x16x32_bf16 a[172:175], a[80:83], v[108:111], a[172:175]
ds_read_b128 a[92:95], v2 offset:15360
s_waitcnt lgkmcnt(2)
buffer_load_dwordx4 v1, s[8:11], s24 offen offset:2048 sc1 lds
s_add_u32 m0, s47, 4992
v_cndmask_b32 v95, v8, v95, s[94:95]
v_max3_f32 v16, v88, v89, v90
v_max3_f32 v16, v16, v91, v92
v_mfma_f32_16x16x32_bf16 a[188:191], a[84:87], v[108:111], a[188:191]
ds_read_b128 a[64:67], v2 offset:24576
s_waitcnt lgkmcnt(2)
buffer_load_dwordx4 v1, s[8:11], s24 offen offset:128 sc1 lds
buffer_load_dwordx4 v1, s[8:11], s24 offen offset:2176 sc1 lds
v_max3_f32 v16, v16, v93, v94
v_max_f32 v16, v16, v95
v_cmp_lt_f32 vcc, s54, v16
v_mfma_f32_16x16x32_bf16 a[204:207], a[88:91], v[108:111], a[204:207]
ds_read_b128 a[68:71], v2 offset:25600
s_waitcnt lgkmcnt(2)
s_add_u32 s46, s46, 1048576
s_add_u32 s47, s47, 32768
s_cbranch_vccnz L_at_up9
L_at_upr9:
v_exp_f32 v88, v88
v_exp_f32 v89, v89
v_exp_f32 v90, v90
v_exp_f32 v91, v91
v_exp_f32 v92, v92
v_exp_f32 v93, v93
v_exp_f32 v94, v94
v_exp_f32 v95, v95
v_accvgpr_read_b32 v18, a232
v_rcp_f32 v18, v18
v_accvgpr_read_b32 v224, a104
v_accvgpr_read_b32 v225, a105
v_accvgpr_read_b32 v226, a106
v_accvgpr_read_b32 v227, a107
v_accvgpr_read_b32 v228, a120
v_accvgpr_read_b32 v229, a121
v_accvgpr_read_b32 v230, a122
v_accvgpr_read_b32 v231, a123
v_mul_f32 v224, v224, v18
v_mul_f32 v225, v225, v18
v_mul_f32 v226, v226, v18
v_mul_f32 v227, v227, v18
v_mul_f32 v228, v228, v18
v_mul_f32 v229, v229, v18
v_mul_f32 v230, v230, v18
v_mul_f32 v231, v231, v18
v_cvt_pk_bf16_f32 v224, v224, v225
v_cvt_pk_bf16_f32 v225, v226, v227
v_cvt_pk_bf16_f32 v226, v228, v229
v_cvt_pk_bf16_f32 v227, v230, v231
buffer_store_dwordx4 v[224:227], v6, s[8:11], s25 offen sc1
v_accvgpr_read_b32 v232, a136
v_accvgpr_read_b32 v233, a137
v_accvgpr_read_b32 v234, a138
v_accvgpr_read_b32 v235, a139
v_accvgpr_read_b32 v236, a152
v_accvgpr_read_b32 v237, a153
v_accvgpr_read_b32 v238, a154
v_accvgpr_read_b32 v239, a155
v_mul_f32 v232, v232, v18
v_mul_f32 v233, v233, v18
v_mul_f32 v234, v234, v18
v_mul_f32 v235, v235, v18
v_mul_f32 v236, v236, v18
v_mul_f32 v237, v237, v18
v_mul_f32 v238, v238, v18
v_mul_f32 v239, v239, v18
v_cvt_pk_bf16_f32 v232, v232, v233
v_mfma_f32_16x16x32_bf16 a[220:223], a[92:95], v[108:111], a[220:223]
ds_read_b128 a[72:75], v2 offset:26624
s_waitcnt lgkmcnt(2)
s_and_b32 s47, s47, 131071
s_cmp_eq_u32 s48, 0
s_cbranch_scc0 L_at_rs9
L_at_rsr9:
v_cvt_pk_bf16_f32 v124, v88, v89
v_cvt_pk_bf16_f32 v125, v90, v91
v_cvt_pk_bf16_f32 v126, v92, v93
v_cvt_pk_bf16_f32 v127, v94, v95
v_cvt_pk_bf16_f32 v233, v234, v235
v_cvt_pk_bf16_f32 v234, v236, v237
v_cvt_pk_bf16_f32 v235, v238, v239
buffer_store_dwordx4 v[232:235], v6, s[8:11], s25 offen offset:1024 sc1
v_accvgpr_read_b32 v240, a168
v_accvgpr_read_b32 v241, a169
v_accvgpr_read_b32 v242, a170
v_accvgpr_read_b32 v243, a171
v_accvgpr_read_b32 v244, a184
v_accvgpr_read_b32 v245, a185
v_accvgpr_read_b32 v246, a186
v_accvgpr_read_b32 v247, a187
v_mul_f32 v240, v240, v18
v_mul_f32 v241, v241, v18
v_mul_f32 v242, v242, v18
v_mul_f32 v243, v243, v18
v_mul_f32 v244, v244, v18
v_mul_f32 v245, v245, v18
v_mul_f32 v246, v246, v18
v_mul_f32 v247, v247, v18
v_cvt_pk_bf16_f32 v240, v240, v241
v_cvt_pk_bf16_f32 v241, v242, v243
v_cvt_pk_bf16_f32 v242, v244, v245
v_cvt_pk_bf16_f32 v243, v246, v247
buffer_store_dwordx4 v[240:243], v6, s[8:11], s25 offen offset:2048 sc1
v_accvgpr_read_b32 v248, a200
v_accvgpr_read_b32 v249, a201
v_accvgpr_read_b32 v250, a202
v_accvgpr_read_b32 v251, a203
v_accvgpr_read_b32 v252, a216
v_accvgpr_read_b32 v253, a217
v_accvgpr_read_b32 v254, a218
v_accvgpr_read_b32 v255, a219
v_mul_f32 v248, v248, v18
v_mul_f32 v249, v249, v18
v_mul_f32 v250, v250, v18
v_mul_f32 v251, v251, v18
v_mul_f32 v252, v252, v18
v_mul_f32 v253, v253, v18
v_mul_f32 v254, v254, v18
v_mul_f32 v255, v255, v18
v_cvt_pk_bf16_f32 v248, v248, v249
v_cvt_pk_bf16_f32 v249, v250, v251
v_cvt_pk_bf16_f32 v250, v252, v253
v_cvt_pk_bf16_f32 v251, v254, v255
buffer_store_dwordx4 v[248:251], v6, s[8:11], s25 offen offset:3072 sc1
v_mfma_f32_16x16x32_bf16 a[236:239], a[240:243], v[124:127], a[236:239]
v_mfma_f32_16x16x32_bf16 a[108:111], a[64:67], v[124:127], a[108:111]
ds_read_b128 a[76:79], v2 offset:27648
s_waitcnt lgkmcnt(2)
v_mfma_f32_16x16x32_bf16 a[124:127], a[68:71], v[124:127], a[124:127]
ds_read_b128 a[80:83], v2 offset:28672
s_waitcnt lgkmcnt(2)
v_mfma_f32_16x16x32_bf16 a[140:143], a[72:75], v[124:127], a[140:143]
ds_read_b128 a[84:87], v2 offset:29696
s_waitcnt lgkmcnt(2)
v_mfma_f32_16x16x32_bf16 a[156:159], a[76:79], v[124:127], a[156:159]
ds_read_b128 a[88:91], v2 offset:30720
s_waitcnt lgkmcnt(2)
v_mfma_f32_16x16x32_bf16 a[172:175], a[80:83], v[124:127], a[172:175]
ds_read_b128 a[92:95], v2 offset:31744
s_waitcnt lgkmcnt(2)
v_mfma_f32_16x16x32_bf16 a[188:191], a[84:87], v[124:127], a[188:191]
s_waitcnt lgkmcnt(1)
v_mfma_f32_16x16x32_bf16 a[204:207], a[88:91], v[124:127], a[204:207]
s_waitcnt lgkmcnt(0)
v_mfma_f32_16x16x32_bf16 a[220:223], a[92:95], v[124:127], a[220:223]
s_add_u32 s25, s61, 1572864
v_accvgpr_read_b32 v18, a236
v_rcp_f32 v18, v18
v_accvgpr_read_b32 v224, a108
v_accvgpr_read_b32 v225, a109
v_accvgpr_read_b32 v226, a110
v_accvgpr_read_b32 v227, a111
v_accvgpr_read_b32 v228, a124
v_accvgpr_read_b32 v229, a125
v_accvgpr_read_b32 v230, a126
v_accvgpr_read_b32 v231, a127
v_mul_f32 v224, v224, v18
v_mul_f32 v225, v225, v18
v_mul_f32 v226, v226, v18
v_mul_f32 v227, v227, v18
v_mul_f32 v228, v228, v18
v_mul_f32 v229, v229, v18
v_mul_f32 v230, v230, v18
v_mul_f32 v231, v231, v18
v_cvt_pk_bf16_f32 v224, v224, v225
v_cvt_pk_bf16_f32 v225, v226, v227
v_cvt_pk_bf16_f32 v226, v228, v229
v_cvt_pk_bf16_f32 v227, v230, v231
buffer_store_dwordx4 v[224:227], v6, s[8:11], s25 offen sc1
v_accvgpr_read_b32 v232, a140
v_accvgpr_read_b32 v233, a141
v_accvgpr_read_b32 v234, a142
v_accvgpr_read_b32 v235, a143
v_accvgpr_read_b32 v236, a156
v_accvgpr_read_b32 v237, a157
v_accvgpr_read_b32 v238, a158
v_accvgpr_read_b32 v239, a159
v_mul_f32 v232, v232, v18
v_mul_f32 v233, v233, v18
v_mul_f32 v234, v234, v18
v_mul_f32 v235, v235, v18
v_mul_f32 v236, v236, v18
v_mul_f32 v237, v237, v18
v_mul_f32 v238, v238, v18
v_mul_f32 v239, v239, v18
v_cvt_pk_bf16_f32 v232, v232, v233
v_cvt_pk_bf16_f32 v233, v234, v235
v_cvt_pk_bf16_f32 v234, v236, v237
v_cvt_pk_bf16_f32 v235, v238, v239
buffer_store_dwordx4 v[232:235], v6, s[8:11], s25 offen offset:1024 sc1
v_accvgpr_read_b32 v240, a172
v_accvgpr_read_b32 v241, a173
v_accvgpr_read_b32 v242, a174
v_accvgpr_read_b32 v243, a175
v_accvgpr_read_b32 v244, a188
v_accvgpr_read_b32 v245, a189
v_accvgpr_read_b32 v246, a190
v_accvgpr_read_b32 v247, a191
v_mul_f32 v240, v240, v18
v_mul_f32 v241, v241, v18
v_mul_f32 v242, v242, v18
v_mul_f32 v243, v243, v18
v_mul_f32 v244, v244, v18
v_mul_f32 v245, v245, v18
v_mul_f32 v246, v246, v18
v_mul_f32 v247, v247, v18
v_cvt_pk_bf16_f32 v240, v240, v241
v_cvt_pk_bf16_f32 v241, v242, v243
v_cvt_pk_bf16_f32 v242, v244, v245
v_cvt_pk_bf16_f32 v243, v246, v247
buffer_store_dwordx4 v[240:243], v6, s[8:11], s25 offen offset:2048 sc1
v_accvgpr_read_b32 v248, a204
v_accvgpr_read_b32 v249, a205
v_accvgpr_read_b32 v250, a206
v_accvgpr_read_b32 v251, a207
v_accvgpr_read_b32 v252, a220
v_accvgpr_read_b32 v253, a221
v_accvgpr_read_b32 v254, a222
v_accvgpr_read_b32 v255, a223
v_mul_f32 v248, v248, v18
v_mul_f32 v249, v249, v18
v_mul_f32 v250, v250, v18
v_mul_f32 v251, v251, v18
v_mul_f32 v252, v252, v18
v_mul_f32 v253, v253, v18
v_mul_f32 v254, v254, v18
v_mul_f32 v255, v255, v18
v_cvt_pk_bf16_f32 v248, v248, v249
v_cvt_pk_bf16_f32 v249, v250, v251
v_cvt_pk_bf16_f32 v250, v252, v253
v_cvt_pk_bf16_f32 v251, v254, v255
buffer_store_dwordx4 v[248:251], v6, s[8:11], s25 offen offset:3072 sc1
s_lshl_b32 s60, s41, 5
s_add_u32 s60, s60, s42
s_lshl_b32 s60, s60, 2
s_add_u32 s60, s60, 111169536
s_cmp_eq_u32 s17, 0
s_cselect_b32 s60, s60, 536870912
s_mov_b32 s41, s63
s_mov_b32 s63, 8
s_waitcnt vmcnt(28)
s_cmp_lt_u32 s41, 8
s_cbranch_scc1 L_at_item
s_waitcnt vmcnt(0)
s_barrier
v_mov_b32 v19, 1
s_mov_b64 exec, 1
buffer_store_dword v19, v6, s[8:11], s60 offen sc1
s_mov_b64 exec, -1
s_branch L_at_done
L_at_hk:
s_cmp_eq_u32 s45, 2
s_cbranch_scc0 L_at_hk2
v_mov_b32 v19, 1
s_mov_b64 exec, 1
buffer_store_dword v19, v6, s[8:11], s60 offen sc1
s_mov_b64 exec, -1
s_mov_b32 s60, 536870912
s_mov_b32 s45, 13
s_branch L_at_hkr
L_at_hk2:
v_and_b32 v20, 3, v0
v_lshlrev_b32 v20, 2, v20
s_lshl_b32 s25, s42, 7
s_add_u32 s25, s25, 111165456
s_mov_b32 s28, 0
L_poll_16:
buffer_load_dword v21, v20, s[8:11], s25 offen sc1
s_add_u32 s28, s28, 1
s_cmp_gt_u32 s28, 200000
s_cbranch_scc1 L_end
s_waitcnt vmcnt(0)
v_cmp_ne_u32 vcc, 1, v21
s_cbranch_vccz L_pd_17
s_sleep 1
s_branch L_poll_16
L_pd_17:
s_branch L_at_hkr
L_at_up0:
v_max3_f32 v16, v32, v33, v34
v_max3_f32 v16, v16, v35, v36
v_max3_f32 v16, v16, v37, v38
v_max_f32 v16, v16, v39
v_mov_b32 v17, v16
s_nop 1
v_permlane32_swap_b32 v17, v16
v_max_f32 v16, v16, v17
v_mov_b32 v17, v16
s_nop 1
v_permlane16_swap_b32 v17, v16
v_max3_f32 v16, v16, v17, s55
v_exp_f32 v12, -v16
v_sub_f32 v32, v32, v16
v_sub_f32 v33, v33, v16
v_sub_f32 v34, v34, v16
v_sub_f32 v35, v35, v16
v_sub_f32 v36, v36, v16
v_sub_f32 v37, v37, v16
v_sub_f32 v38, v38, v16
v_sub_f32 v39, v39, v16
v_sub_f32 v128, v128, v16
v_sub_f32 v129, v129, v16
v_sub_f32 v130, v130, v16
v_sub_f32 v131, v131, v16
v_max3_f32 v16, v40, v41, v42
v_max3_f32 v16, v16, v43, v44
v_max3_f32 v16, v16, v45, v46
v_max_f32 v16, v16, v47
v_mov_b32 v17, v16
s_nop 1
v_permlane32_swap_b32 v17, v16
v_max_f32 v16, v16, v17
v_mov_b32 v17, v16
s_nop 1
v_permlane16_swap_b32 v17, v16
v_max3_f32 v16, v16, v17, s55
v_exp_f32 v13, -v16
v_sub_f32 v40, v40, v16
v_sub_f32 v41, v41, v16
v_sub_f32 v42, v42, v16
v_sub_f32 v43, v43, v16
v_sub_f32 v44, v44, v16
v_sub_f32 v45, v45, v16
v_sub_f32 v46, v46, v16
v_sub_f32 v47, v47, v16
v_sub_f32 v132, v132, v16
v_sub_f32 v133, v133, v16
v_sub_f32 v134, v134, v16
v_sub_f32 v135, v135, v16
v_max3_f32 v16, v48, v49, v50
v_max3_f32 v16, v16, v51, v52
v_max3_f32 v16, v16, v53, v54
v_max_f32 v16, v16, v55
v_mov_b32 v17, v16
s_nop 1
v_permlane32_swap_b32 v17, v16
v_max_f32 v16, v16, v17
v_mov_b32 v17, v16
s_nop 1
v_permlane16_swap_b32 v17, v16
v_max3_f32 v16, v16, v17, s55
v_exp_f32 v14, -v16
v_sub_f32 v48, v48, v16
v_sub_f32 v49, v49, v16
v_sub_f32 v50, v50, v16
v_sub_f32 v51, v51, v16
v_sub_f32 v52, v52, v16
v_sub_f32 v53, v53, v16
v_sub_f32 v54, v54, v16
v_sub_f32 v55, v55, v16
v_sub_f32 v136, v136, v16
v_sub_f32 v137, v137, v16
v_sub_f32 v138, v138, v16
v_sub_f32 v139, v139, v16
v_max3_f32 v16, v56, v57, v58
v_max3_f32 v16, v16, v59, v60
v_max3_f32 v16, v16, v61, v62
v_max_f32 v16, v16, v63
v_mov_b32 v17, v16
s_nop 1
v_permlane32_swap_b32 v17, v16
v_max_f32 v16, v16, v17
v_mov_b32 v17, v16
s_nop 1
v_permlane16_swap_b32 v17, v16
v_max3_f32 v16, v16, v17, s55
v_exp_f32 v15, -v16
v_sub_f32 v56, v56, v16
v_sub_f32 v57, v57, v16
v_sub_f32 v58, v58, v16
v_sub_f32 v59, v59, v16
v_sub_f32 v60, v60, v16
v_sub_f32 v61, v61, v16
v_sub_f32 v62, v62, v16
v_sub_f32 v63, v63, v16
v_sub_f32 v140, v140, v16
v_sub_f32 v141, v141, v16
v_sub_f32 v142, v142, v16
v_sub_f32 v143, v143, v16
s_cmp_eq_u32 s55, 0
s_cselect_b32 s48, 1, 0
s_mov_b32 s55, 0
s_mov_b32 s54, s51
s_branch L_at_upr0
L_at_rs0:
s_mov_b32 s52, 0
s_branch L_at_rescale
L_at_up1:
v_max3_f32 v16, v64, v65, v66
v_max3_f32 v16, v16, v67, v68
v_max3_f32 v16, v16, v69, v70
v_max_f32 v16, v16, v71
v_mov_b32 v17, v16
s_nop 1
v_permlane32_swap_b32 v17, v16
v_max_f32 v16, v16, v17
v_mov_b32 v17, v16
s_nop 1
v_permlane16_swap_b32 v17, v16
v_max3_f32 v16, v16, v17, s55
v_exp_f32 v12, -v16
v_sub_f32 v64, v64, v16
v_sub_f32 v65, v65, v16
v_sub_f32 v66, v66, v16
v_sub_f32 v67, v67, v16
v_sub_f32 v68, v68, v16
v_sub_f32 v69, v69, v16
v_sub_f32 v70, v70, v16
v_sub_f32 v71, v71, v16
v_sub_f32 v128, v128, v16
v_sub_f32 v129, v129, v16
v_sub_f32 v130, v130, v16
v_sub_f32 v131, v131, v16
v_max3_f32 v16, v72, v73, v74
v_max3_f32 v16, v16, v75, v76
v_max3_f32 v16, v16, v77, v78
v_max_f32 v16, v16, v79
v_mov_b32 v17, v16
s_nop 1
v_permlane32_swap_b32 v17, v16
v_max_f32 v16, v16, v17
v_mov_b32 v17, v16
s_nop 1
v_permlane16_swap_b32 v17, v16
v_max3_f32 v16, v16, v17, s55
v_exp_f32 v13, -v16
v_sub_f32 v72, v72, v16
v_sub_f32 v73, v73, v16
v_sub_f32 v74, v74, v16
v_sub_f32 v75, v75, v16
v_sub_f32 v76, v76, v16
v_sub_f32 v77, v77, v16
v_sub_f32 v78, v78, v16
v_sub_f32 v79, v79, v16
v_sub_f32 v132, v132, v16
v_sub_f32 v133, v133, v16
v_sub_f32 v134, v134, v16
v_sub_f32 v135, v135, v16
v_max3_f32 v16, v80, v81, v82
v_max3_f32 v16, v16, v83, v84
v_max3_f32 v16, v16, v85, v86
v_max_f32 v16, v16, v87
v_mov_b32 v17, v16
s_nop 1
v_permlane32_swap_b32 v17, v16
v_max_f32 v16, v16, v17
v_mov_b32 v17, v16
s_nop 1
v_permlane16_swap_b32 v17, v16
v_max3_f32 v16, v16, v17, s55
v_exp_f32 v14, -v16
v_sub_f32 v80, v80, v16
v_sub_f32 v81, v81, v16
v_sub_f32 v82, v82, v16
v_sub_f32 v83, v83, v16
v_sub_f32 v84, v84, v16
v_sub_f32 v85, v85, v16
v_sub_f32 v86, v86, v16
v_sub_f32 v87, v87, v16
v_sub_f32 v136, v136, v16
v_sub_f32 v137, v137, v16
v_sub_f32 v138, v138, v16
v_sub_f32 v139, v139, v16
v_max3_f32 v16, v88, v89, v90
v_max3_f32 v16, v16, v91, v92
v_max3_f32 v16, v16, v93, v94
v_max_f32 v16, v16, v95
v_mov_b32 v17, v16
s_nop 1
v_permlane32_swap_b32 v17, v16
v_max_f32 v16, v16, v17
v_mov_b32 v17, v16
s_nop 1
v_permlane16_swap_b32 v17, v16
v_max3_f32 v16, v16, v17, s55
v_exp_f32 v15, -v16
v_sub_f32 v88, v88, v16
v_sub_f32 v89, v89, v16
v_sub_f32 v90, v90, v16
v_sub_f32 v91, v91, v16
v_sub_f32 v92, v92, v16
v_sub_f32 v93, v93, v16
v_sub_f32 v94, v94, v16
v_sub_f32 v95, v95, v16
v_sub_f32 v140, v140, v16
v_sub_f32 v141, v141, v16
v_sub_f32 v142, v142, v16
v_sub_f32 v143, v143, v16
s_cmp_eq_u32 s55, 0
s_cselect_b32 s48, 1, 0
s_mov_b32 s55, 0
s_mov_b32 s54, s51
s_branch L_at_upr1
L_at_rs1:
s_mov_b32 s52, 1
s_branch L_at_rescale
L_at_up2:
v_max3_f32 v16, v32, v33, v34
v_max3_f32 v16, v16, v35, v36
v_max3_f32 v16, v16, v37, v38
v_max_f32 v16, v16, v39
v_mov_b32 v17, v16
s_nop 1
v_permlane32_swap_b32 v17, v16
v_max_f32 v16, v16, v17
v_mov_b32 v17, v16
s_nop 1
v_permlane16_swap_b32 v17, v16
v_max3_f32 v16, v16, v17, s55
v_exp_f32 v12, -v16
v_sub_f32 v32, v32, v16
v_sub_f32 v33, v33, v16
v_sub_f32 v34, v34, v16
v_sub_f32 v35, v35, v16
v_sub_f32 v36, v36, v16
v_sub_f32 v37, v37, v16
v_sub_f32 v38, v38, v16
v_sub_f32 v39, v39, v16
v_sub_f32 v128, v128, v16
v_sub_f32 v129, v129, v16
v_sub_f32 v130, v130, v16
v_sub_f32 v131, v131, v16
v_max3_f32 v16, v40, v41, v42
v_max3_f32 v16, v16, v43, v44
v_max3_f32 v16, v16, v45, v46
v_max_f32 v16, v16, v47
v_mov_b32 v17, v16
s_nop 1
v_permlane32_swap_b32 v17, v16
v_max_f32 v16, v16, v17
v_mov_b32 v17, v16
s_nop 1
v_permlane16_swap_b32 v17, v16
v_max3_f32 v16, v16, v17, s55
v_exp_f32 v13, -v16
v_sub_f32 v40, v40, v16
v_sub_f32 v41, v41, v16
v_sub_f32 v42, v42, v16
v_sub_f32 v43, v43, v16
v_sub_f32 v44, v44, v16
v_sub_f32 v45, v45, v16
v_sub_f32 v46, v46, v16
v_sub_f32 v47, v47, v16
v_sub_f32 v132, v132, v16
v_sub_f32 v133, v133, v16
v_sub_f32 v134, v134, v16
v_sub_f32 v135, v135, v16
v_max3_f32 v16, v48, v49, v50
v_max3_f32 v16, v16, v51, v52
v_max3_f32 v16, v16, v53, v54
v_max_f32 v16, v16, v55
v_mov_b32 v17, v16
s_nop 1
v_permlane32_swap_b32 v17, v16
v_max_f32 v16, v16, v17
v_mov_b32 v17, v16
s_nop 1
v_permlane16_swap_b32 v17, v16
v_max3_f32 v16, v16, v17, s55
v_exp_f32 v14, -v16
v_sub_f32 v48, v48, v16
v_sub_f32 v49, v49, v16
v_sub_f32 v50, v50, v16
v_sub_f32 v51, v51, v16
v_sub_f32 v52, v52, v16
v_sub_f32 v53, v53, v16
v_sub_f32 v54, v54, v16
v_sub_f32 v55, v55, v16
v_sub_f32 v136, v136, v16
v_sub_f32 v137, v137, v16
v_sub_f32 v138, v138, v16
v_sub_f32 v139, v139, v16
v_max3_f32 v16, v56, v57, v58
v_max3_f32 v16, v16, v59, v60
v_max3_f32 v16, v16, v61, v62
v_max_f32 v16, v16, v63
v_mov_b32 v17, v16
s_nop 1
v_permlane32_swap_b32 v17, v16
v_max_f32 v16, v16, v17
v_mov_b32 v17, v16
s_nop 1
v_permlane16_swap_b32 v17, v16
v_max3_f32 v16, v16, v17, s55
v_exp_f32 v15, -v16
v_sub_f32 v56, v56, v16
v_sub_f32 v57, v57, v16
v_sub_f32 v58, v58, v16
v_sub_f32 v59, v59, v16
v_sub_f32 v60, v60, v16
v_sub_f32 v61, v61, v16
v_sub_f32 v62, v62, v16
v_sub_f32 v63, v63, v16
v_sub_f32 v140, v140, v16
v_sub_f32 v141, v141, v16
v_sub_f32 v142, v142, v16
v_sub_f32 v143, v143, v16
s_cmp_eq_u32 s55, 0
s_cselect_b32 s48, 1, 0
s_mov_b32 s55, 0
s_mov_b32 s54, s51
s_branch L_at_upr2
L_at_rs2:
s_mov_b32 s52, 2
s_branch L_at_rescale
L_at_up3:
v_max3_f32 v16, v64, v65, v66
v_max3_f32 v16, v16, v67, v68
v_max3_f32 v16, v16, v69, v70
v_max_f32 v16, v16, v71
v_mov_b32 v17, v16
s_nop 1
v_permlane32_swap_b32 v17, v16
v_max_f32 v16, v16, v17
v_mov_b32 v17, v16
s_nop 1
v_permlane16_swap_b32 v17, v16
v_max3_f32 v16, v16, v17, s55
v_exp_f32 v12, -v16
v_sub_f32 v64, v64, v16
v_sub_f32 v65, v65, v16
v_sub_f32 v66, v66, v16
v_sub_f32 v67, v67, v16
v_sub_f32 v68, v68, v16
v_sub_f32 v69, v69, v16
v_sub_f32 v70, v70, v16
v_sub_f32 v71, v71, v16
v_sub_f32 v128, v128, v16
v_sub_f32 v129, v129, v16
v_sub_f32 v130, v130, v16
v_sub_f32 v131, v131, v16
v_max3_f32 v16, v72, v73, v74
v_max3_f32 v16, v16, v75, v76
v_max3_f32 v16, v16, v77, v78
v_max_f32 v16, v16, v79
v_mov_b32 v17, v16
s_nop 1
v_permlane32_swap_b32 v17, v16
v_max_f32 v16, v16, v17
v_mov_b32 v17, v16
s_nop 1
v_permlane16_swap_b32 v17, v16
v_max3_f32 v16, v16, v17, s55
v_exp_f32 v13, -v16
v_sub_f32 v72, v72, v16
v_sub_f32 v73, v73, v16
v_sub_f32 v74, v74, v16
v_sub_f32 v75, v75, v16
v_sub_f32 v76, v76, v16
v_sub_f32 v77, v77, v16
v_sub_f32 v78, v78, v16
v_sub_f32 v79, v79, v16
v_sub_f32 v132, v132, v16
v_sub_f32 v133, v133, v16
v_sub_f32 v134, v134, v16
v_sub_f32 v135, v135, v16
v_max3_f32 v16, v80, v81, v82
v_max3_f32 v16, v16, v83, v84
v_max3_f32 v16, v16, v85, v86
v_max_f32 v16, v16, v87
v_mov_b32 v17, v16
s_nop 1
v_permlane32_swap_b32 v17, v16
v_max_f32 v16, v16, v17
v_mov_b32 v17, v16
s_nop 1
v_permlane16_swap_b32 v17, v16
v_max3_f32 v16, v16, v17, s55
v_exp_f32 v14, -v16
v_sub_f32 v80, v80, v16
v_sub_f32 v81, v81, v16
v_sub_f32 v82, v82, v16
v_sub_f32 v83, v83, v16
v_sub_f32 v84, v84, v16
v_sub_f32 v85, v85, v16
v_sub_f32 v86, v86, v16
v_sub_f32 v87, v87, v16
v_sub_f32 v136, v136, v16
v_sub_f32 v137, v137, v16
v_sub_f32 v138, v138, v16
v_sub_f32 v139, v139, v16
v_max3_f32 v16, v88, v89, v90
v_max3_f32 v16, v16, v91, v92
v_max3_f32 v16, v16, v93, v94
v_max_f32 v16, v16, v95
v_mov_b32 v17, v16
s_nop 1
v_permlane32_swap_b32 v17, v16
v_max_f32 v16, v16, v17
v_mov_b32 v17, v16
s_nop 1
v_permlane16_swap_b32 v17, v16
v_max3_f32 v16, v16, v17, s55
v_exp_f32 v15, -v16
v_sub_f32 v88, v88, v16
v_sub_f32 v89, v89, v16
v_sub_f32 v90, v90, v16
v_sub_f32 v91, v91, v16
v_sub_f32 v92, v92, v16
v_sub_f32 v93, v93, v16
v_sub_f32 v94, v94, v16
v_sub_f32 v95, v95, v16
v_sub_f32 v140, v140, v16
v_sub_f32 v141, v141, v16
v_sub_f32 v142, v142, v16
v_sub_f32 v143, v143, v16
s_cmp_eq_u32 s55, 0
s_cselect_b32 s48, 1, 0
s_mov_b32 s55, 0
s_mov_b32 s54, s51
s_branch L_at_upr3
L_at_rs3:
s_mov_b32 s52, 3
s_branch L_at_rescale
L_at_up4:
v_mov_b32 v12, 1.0
v_max3_f32 v16, v40, v41, v42
v_max3_f32 v16, v16, v43, v44
v_max3_f32 v16, v16, v45, v46
v_max_f32 v16, v16, v47
v_mov_b32 v17, v16
s_nop 1
v_permlane32_swap_b32 v17, v16
v_max_f32 v16, v16, v17
v_mov_b32 v17, v16
s_nop 1
v_permlane16_swap_b32 v17, v16
v_max3_f32 v16, v16, v17, s55
v_exp_f32 v13, -v16
v_sub_f32 v40, v40, v16
v_sub_f32 v41, v41, v16
v_sub_f32 v42, v42, v16
v_sub_f32 v43, v43, v16
v_sub_f32 v44, v44, v16
v_sub_f32 v45, v45, v16
v_sub_f32 v46, v46, v16
v_sub_f32 v47, v47, v16
v_sub_f32 v132, v132, v16
v_sub_f32 v133, v133, v16
v_sub_f32 v134, v134, v16
v_sub_f32 v135, v135, v16
v_max3_f32 v16, v48, v49, v50
v_max3_f32 v16, v16, v51, v52
v_max3_f32 v16, v16, v53, v54
v_max_f32 v16, v16, v55
v_mov_b32 v17, v16
s_nop 1
v_permlane32_swap_b32 v17, v16
v_max_f32 v16, v16, v17
v_mov_b32 v17, v16
s_nop 1
v_permlane16_swap_b32 v17, v16
v_max3_f32 v16, v16, v17, s55
v_exp_f32 v14, -v16
v_sub_f32 v48, v48, v16
v_sub_f32 v49, v49, v16
v_sub_f32 v50, v50, v16
v_sub_f32 v51, v51, v16
v_sub_f32 v52, v52, v16
v_sub_f32 v53, v53, v16
v_sub_f32 v54, v54, v16
v_sub_f32 v55, v55, v16
v_sub_f32 v136, v136, v16
v_sub_f32 v137, v137, v16
v_sub_f32 v138, v138, v16
v_sub_f32 v139, v139, v16
v_max3_f32 v16, v56, v57, v58
v_max3_f32 v16, v16, v59, v60
v_max3_f32 v16, v16, v61, v62
v_max_f32 v16, v16, v63
v_mov_b32 v17, v16
s_nop 1
v_permlane32_swap_b32 v17, v16
v_max_f32 v16, v16, v17
v_mov_b32 v17, v16
s_nop 1
v_permlane16_swap_b32 v17, v16
v_max3_f32 v16, v16, v17, s55
v_exp_f32 v15, -v16
v_sub_f32 v56, v56, v16
v_sub_f32 v57, v57, v16
v_sub_f32 v58, v58, v16
v_sub_f32 v59, v59, v16
v_sub_f32 v60, v60, v16
v_sub_f32 v61, v61, v16
v_sub_f32 v62, v62, v16
v_sub_f32 v63, v63, v16
v_sub_f32 v140, v140, v16
v_sub_f32 v141, v141, v16
v_sub_f32 v142, v142, v16
v_sub_f32 v143, v143, v16
s_cmp_eq_u32 s55, 0
s_cselect_b32 s48, 1, 0
s_mov_b32 s55, 0
s_mov_b32 s54, s51
s_branch L_at_upr4
L_at_rs4:
s_mov_b32 s52, 4
s_branch L_at_rescale
L_at_up5:
v_mov_b32 v12, 1.0
v_max3_f32 v16, v72, v73, v74
v_max3_f32 v16, v16, v75, v76
v_max3_f32 v16, v16, v77, v78
v_max_f32 v16, v16, v79
v_mov_b32 v17, v16
s_nop 1
v_permlane32_swap_b32 v17, v16
v_max_f32 v16, v16, v17
v_mov_b32 v17, v16
s_nop 1
v_permlane16_swap_b32 v17, v16
v_max3_f32 v16, v16, v17, s55
v_exp_f32 v13, -v16
v_sub_f32 v72, v72, v16
v_sub_f32 v73, v73, v16
v_sub_f32 v74, v74, v16
v_sub_f32 v75, v75, v16
v_sub_f32 v76, v76, v16
v_sub_f32 v77, v77, v16
v_sub_f32 v78, v78, v16
v_sub_f32 v79, v79, v16
v_sub_f32 v132, v132, v16
v_sub_f32 v133, v133, v16
v_sub_f32 v134, v134, v16
v_sub_f32 v135, v135, v16
v_max3_f32 v16, v80, v81, v82
v_max3_f32 v16, v16, v83, v84
v_max3_f32 v16, v16, v85, v86
v_max_f32 v16, v16, v87
v_mov_b32 v17, v16
s_nop 1
v_permlane32_swap_b32 v17, v16
v_max_f32 v16, v16, v17
v_mov_b32 v17, v16
s_nop 1
v_permlane16_swap_b32 v17, v16
v_max3_f32 v16, v16, v17, s55
v_exp_f32 v14, -v16
v_sub_f32 v80, v80, v16
v_sub_f32 v81, v81, v16
v_sub_f32 v82, v82, v16
v_sub_f32 v83, v83, v16
v_sub_f32 v84, v84, v16
v_sub_f32 v85, v85, v16
v_sub_f32 v86, v86, v16
v_sub_f32 v87, v87, v16
v_sub_f32 v136, v136, v16
v_sub_f32 v137, v137, v16
v_sub_f32 v138, v138, v16
v_sub_f32 v139, v139, v16
v_max3_f32 v16, v88, v89, v90
v_max3_f32 v16, v16, v91, v92
v_max3_f32 v16, v16, v93, v94
v_max_f32 v16, v16, v95
v_mov_b32 v17, v16
s_nop 1
v_permlane32_swap_b32 v17, v16
v_max_f32 v16, v16, v17
v_mov_b32 v17, v16
s_nop 1
v_permlane16_swap_b32 v17, v16
v_max3_f32 v16, v16, v17, s55
v_exp_f32 v15, -v16
v_sub_f32 v88, v88, v16
v_sub_f32 v89, v89, v16
v_sub_f32 v90, v90, v16
v_sub_f32 v91, v91, v16
v_sub_f32 v92, v92, v16
v_sub_f32 v93, v93, v16
v_sub_f32 v94, v94, v16
v_sub_f32 v95, v95, v16
v_sub_f32 v140, v140, v16
v_sub_f32 v141, v141, v16
v_sub_f32 v142, v142, v16
v_sub_f32 v143, v143, v16
s_cmp_eq_u32 s55, 0
s_cselect_b32 s48, 1, 0
s_mov_b32 s55, 0
s_mov_b32 s54, s51
s_branch L_at_upr5
L_at_rs5:
s_mov_b32 s52, 5
s_branch L_at_rescale
L_at_up6:
v_mov_b32 v12, 1.0
v_mov_b32 v13, 1.0
v_max3_f32 v16, v48, v49, v50
v_max3_f32 v16, v16, v51, v52
v_max3_f32 v16, v16, v53, v54
v_max_f32 v16, v16, v55
v_mov_b32 v17, v16
s_nop 1
v_permlane32_swap_b32 v17, v16
v_max_f32 v16, v16, v17
v_mov_b32 v17, v16
s_nop 1
v_permlane16_swap_b32 v17, v16
v_max3_f32 v16, v16, v17, s55
v_exp_f32 v14, -v16
v_sub_f32 v48, v48, v16
v_sub_f32 v49, v49, v16
v_sub_f32 v50, v50, v16
v_sub_f32 v51, v51, v16
v_sub_f32 v52, v52, v16
v_sub_f32 v53, v53, v16
v_sub_f32 v54, v54, v16
v_sub_f32 v55, v55, v16
v_sub_f32 v136, v136, v16
v_sub_f32 v137, v137, v16
v_sub_f32 v138, v138, v16
v_sub_f32 v139, v139, v16
v_max3_f32 v16, v56, v57, v58
v_max3_f32 v16, v16, v59, v60
v_max3_f32 v16, v16, v61, v62
v_max_f32 v16, v16, v63
v_mov_b32 v17, v16
s_nop 1
v_permlane32_swap_b32 v17, v16
v_max_f32 v16, v16, v17
v_mov_b32 v17, v16
s_nop 1
v_permlane16_swap_b32 v17, v16
v_max3_f32 v16, v16, v17, s55
v_exp_f32 v15, -v16
v_sub_f32 v56, v56, v16
v_sub_f32 v57, v57, v16
v_sub_f32 v58, v58, v16
v_sub_f32 v59, v59, v16
v_sub_f32 v60, v60, v16
v_sub_f32 v61, v61, v16
v_sub_f32 v62, v62, v16
v_sub_f32 v63, v63, v16
v_sub_f32 v140, v140, v16
v_sub_f32 v141, v141, v16
v_sub_f32 v142, v142, v16
v_sub_f32 v143, v143, v16
s_cmp_eq_u32 s55, 0
s_cselect_b32 s48, 1, 0
s_mov_b32 s55, 0
s_mov_b32 s54, s51
s_branch L_at_upr6
L_at_rs6:
s_mov_b32 s52, 6
s_branch L_at_rescale
L_at_up7:
v_mov_b32 v12, 1.0
v_mov_b32 v13, 1.0
v_max3_f32 v16, v80, v81, v82
v_max3_f32 v16, v16, v83, v84
v_max3_f32 v16, v16, v85, v86
v_max_f32 v16, v16, v87
v_mov_b32 v17, v16
s_nop 1
v_permlane32_swap_b32 v17, v16
v_max_f32 v16, v16, v17
v_mov_b32 v17, v16
s_nop 1
v_permlane16_swap_b32 v17, v16
v_max3_f32 v16, v16, v17, s55
v_exp_f32 v14, -v16
v_sub_f32 v80, v80, v16
v_sub_f32 v81, v81, v16
v_sub_f32 v82, v82, v16
v_sub_f32 v83, v83, v16
v_sub_f32 v84, v84, v16
v_sub_f32 v85, v85, v16
v_sub_f32 v86, v86, v16
v_sub_f32 v87, v87, v16
v_sub_f32 v136, v136, v16
v_sub_f32 v137, v137, v16
v_sub_f32 v138, v138, v16
v_sub_f32 v139, v139, v16
v_max3_f32 v16, v88, v89, v90
v_max3_f32 v16, v16, v91, v92
v_max3_f32 v16, v16, v93, v94
v_max_f32 v16, v16, v95
v_mov_b32 v17, v16
s_nop 1
v_permlane32_swap_b32 v17, v16
v_max_f32 v16, v16, v17
v_mov_b32 v17, v16
s_nop 1
v_permlane16_swap_b32 v17, v16
v_max3_f32 v16, v16, v17, s55
v_exp_f32 v15, -v16
v_sub_f32 v88, v88, v16
v_sub_f32 v89, v89, v16
v_sub_f32 v90, v90, v16
v_sub_f32 v91, v91, v16
v_sub_f32 v92, v92, v16
v_sub_f32 v93, v93, v16
v_sub_f32 v94, v94, v16
v_sub_f32 v95, v95, v16
v_sub_f32 v140, v140, v16
v_sub_f32 v141, v141, v16
v_sub_f32 v142, v142, v16
v_sub_f32 v143, v143, v16
s_cmp_eq_u32 s55, 0
s_cselect_b32 s48, 1, 0
s_mov_b32 s55, 0
s_mov_b32 s54, s51
s_branch L_at_upr7
L_at_rs7:
s_mov_b32 s52, 7
s_branch L_at_rescale
L_at_up8:
v_mov_b32 v12, 1.0
v_mov_b32 v13, 1.0
v_mov_b32 v14, 1.0
v_max3_f32 v16, v56, v57, v58
v_max3_f32 v16, v16, v59, v60
v_max3_f32 v16, v16, v61, v62
v_max_f32 v16, v16, v63
v_mov_b32 v17, v16
s_nop 1
v_permlane32_swap_b32 v17, v16
v_max_f32 v16, v16, v17
v_mov_b32 v17, v16
s_nop 1
v_permlane16_swap_b32 v17, v16
v_max3_f32 v16, v16, v17, s55
v_exp_f32 v15, -v16
v_sub_f32 v56, v56, v16
v_sub_f32 v57, v57, v16
v_sub_f32 v58, v58, v16
v_sub_f32 v59, v59, v16
v_sub_f32 v60, v60, v16
v_sub_f32 v61, v61, v16
v_sub_f32 v62, v62, v16
v_sub_f32 v63, v63, v16
v_sub_f32 v140, v140, v16
v_sub_f32 v141, v141, v16
v_sub_f32 v142, v142, v16
v_sub_f32 v143, v143, v16
s_cmp_eq_u32 s55, 0
s_cselect_b32 s48, 1, 0
s_mov_b32 s55, 0
s_mov_b32 s54, s51
s_branch L_at_upr8
L_at_rs8:
s_mov_b32 s52, 8
s_branch L_at_rescale
L_at_up9:
v_mov_b32 v12, 1.0
v_mov_b32 v13, 1.0
v_mov_b32 v14, 1.0
v_max3_f32 v16, v88, v89, v90
v_max3_f32 v16, v16, v91, v92
v_max3_f32 v16, v16, v93, v94
v_max_f32 v16, v16, v95
v_mov_b32 v17, v16
s_nop 1
v_permlane32_swap_b32 v17, v16
v_max_f32 v16, v16, v17
v_mov_b32 v17, v16
s_nop 1
v_permlane16_swap_b32 v17, v16
v_max3_f32 v16, v16, v17, s55
v_exp_f32 v15, -v16
v_sub_f32 v88, v88, v16
v_sub_f32 v89, v89, v16
v_sub_f32 v90, v90, v16
v_sub_f32 v91, v91, v16
v_sub_f32 v92, v92, v16
v_sub_f32 v93, v93, v16
v_sub_f32 v94, v94, v16
v_sub_f32 v95, v95, v16
v_sub_f32 v140, v140, v16
v_sub_f32 v141, v141, v16
v_sub_f32 v142, v142, v16
v_sub_f32 v143, v143, v16
s_cmp_eq_u32 s55, 0
s_cselect_b32 s48, 1, 0
s_mov_b32 s55, 0
s_mov_b32 s54, s51
s_branch L_at_upr9
L_at_rs9:
s_mov_b32 s52, 9
s_branch L_at_rescale
L_at_rescale:
v_accvgpr_read_b32 v24, a96
v_accvgpr_read_b32 v25, a97
v_accvgpr_read_b32 v26, a98
v_accvgpr_read_b32 v27, a99
v_accvgpr_read_b32 v28, a100
v_accvgpr_read_b32 v29, a101
v_accvgpr_read_b32 v30, a102
v_accvgpr_read_b32 v31, a103
v_mul_f32 v24, v24, v12
v_mul_f32 v25, v25, v12
v_mul_f32 v26, v26, v12
v_mul_f32 v27, v27, v12
v_mul_f32 v28, v28, v13
v_mul_f32 v29, v29, v13
v_mul_f32 v30, v30, v13
v_mul_f32 v31, v31, v13
v_accvgpr_write_b32 a96, v24
v_accvgpr_write_b32 a97, v25
v_accvgpr_write_b32 a98, v26
v_accvgpr_write_b32 a99, v27
v_accvgpr_write_b32 a100, v28
v_accvgpr_write_b32 a101, v29
v_accvgpr_write_b32 a102, v30
v_accvgpr_write_b32 a103, v31
v_accvgpr_read_b32 v24, a104
v_accvgpr_read_b32 v25, a105
v_accvgpr_read_b32 v26, a106
v_accvgpr_read_b32 v27, a107
v_accvgpr_read_b32 v28, a108
v_accvgpr_read_b32 v29, a109
v_accvgpr_read_b32 v30, a110
v_accvgpr_read_b32 v31, a111
v_mul_f32 v24, v24, v14
v_mul_f32 v25, v25, v14
v_mul_f32 v26, v26, v14
v_mul_f32 v27, v27, v14
v_mul_f32 v28, v28, v15
v_mul_f32 v29, v29, v15
v_mul_f32 v30, v30, v15
v_mul_f32 v31, v31, v15
v_accvgpr_write_b32 a104, v24
v_accvgpr_write_b32 a105, v25
v_accvgpr_write_b32 a106, v26
v_accvgpr_write_b32 a107, v27
v_accvgpr_write_b32 a108, v28
v_accvgpr_write_b32 a109, v29
v_accvgpr_write_b32 a110, v30
v_accvgpr_write_b32 a111, v31
v_accvgpr_read_b32 v24, a112
v_accvgpr_read_b32 v25, a113
v_accvgpr_read_b32 v26, a114
v_accvgpr_read_b32 v27, a115
v_accvgpr_read_b32 v28, a116
v_accvgpr_read_b32 v29, a117
v_accvgpr_read_b32 v30, a118
v_accvgpr_read_b32 v31, a119
v_mul_f32 v24, v24, v12
v_mul_f32 v25, v25, v12
v_mul_f32 v26, v26, v12
v_mul_f32 v27, v27, v12
v_mul_f32 v28, v28, v13
v_mul_f32 v29, v29, v13
v_mul_f32 v30, v30, v13
v_mul_f32 v31, v31, v13
v_accvgpr_write_b32 a112, v24
v_accvgpr_write_b32 a113, v25
v_accvgpr_write_b32 a114, v26
v_accvgpr_write_b32 a115, v27
v_accvgpr_write_b32 a116, v28
v_accvgpr_write_b32 a117, v29
v_accvgpr_write_b32 a118, v30
v_accvgpr_write_b32 a119, v31
v_accvgpr_read_b32 v24, a120
v_accvgpr_read_b32 v25, a121
v_accvgpr_read_b32 v26, a122
v_accvgpr_read_b32 v27, a123
v_accvgpr_read_b32 v28, a124
v_accvgpr_read_b32 v29, a125
v_accvgpr_read_b32 v30, a126
v_accvgpr_read_b32 v31, a127
v_mul_f32 v24, v24, v14
v_mul_f32 v25, v25, v14
v_mul_f32 v26, v26, v14
v_mul_f32 v27, v27, v14
v_mul_f32 v28, v28, v15
v_mul_f32 v29, v29, v15
v_mul_f32 v30, v30, v15
v_mul_f32 v31, v31, v15
v_accvgpr_write_b32 a120, v24
v_accvgpr_write_b32 a121, v25
v_accvgpr_write_b32 a122, v26
v_accvgpr_write_b32 a123, v27
v_accvgpr_write_b32 a124, v28
v_accvgpr_write_b32 a125, v29
v_accvgpr_write_b32 a126, v30
v_accvgpr_write_b32 a127, v31
v_accvgpr_read_b32 v24, a128
v_accvgpr_read_b32 v25, a129
v_accvgpr_read_b32 v26, a130
v_accvgpr_read_b32 v27, a131
v_accvgpr_read_b32 v28, a132
v_accvgpr_read_b32 v29, a133
v_accvgpr_read_b32 v30, a134
v_accvgpr_read_b32 v31, a135
v_mul_f32 v24, v24, v12
v_mul_f32 v25, v25, v12
v_mul_f32 v26, v26, v12
v_mul_f32 v27, v27, v12
v_mul_f32 v28, v28, v13
v_mul_f32 v29, v29, v13
v_mul_f32 v30, v30, v13
v_mul_f32 v31, v31, v13
v_accvgpr_write_b32 a128, v24
v_accvgpr_write_b32 a129, v25
v_accvgpr_write_b32 a130, v26
v_accvgpr_write_b32 a131, v27
v_accvgpr_write_b32 a132, v28
v_accvgpr_write_b32 a133, v29
v_accvgpr_write_b32 a134, v30
v_accvgpr_write_b32 a135, v31
v_accvgpr_read_b32 v24, a136
v_accvgpr_read_b32 v25, a137
v_accvgpr_read_b32 v26, a138
v_accvgpr_read_b32 v27, a139
v_accvgpr_read_b32 v28, a140
v_accvgpr_read_b32 v29, a141
v_accvgpr_read_b32 v30, a142
v_accvgpr_read_b32 v31, a143
v_mul_f32 v24, v24, v14
v_mul_f32 v25, v25, v14
v_mul_f32 v26, v26, v14
v_mul_f32 v27, v27, v14
v_mul_f32 v28, v28, v15
v_mul_f32 v29, v29, v15
v_mul_f32 v30, v30, v15
v_mul_f32 v31, v31, v15
v_accvgpr_write_b32 a136, v24
v_accvgpr_write_b32 a137, v25
v_accvgpr_write_b32 a138, v26
v_accvgpr_write_b32 a139, v27
v_accvgpr_write_b32 a140, v28
v_accvgpr_write_b32 a141, v29
v_accvgpr_write_b32 a142, v30
v_accvgpr_write_b32 a143, v31
v_accvgpr_read_b32 v24, a144
v_accvgpr_read_b32 v25, a145
v_accvgpr_read_b32 v26, a146
v_accvgpr_read_b32 v27, a147
v_accvgpr_read_b32 v28, a148
v_accvgpr_read_b32 v29, a149
v_accvgpr_read_b32 v30, a150
v_accvgpr_read_b32 v31, a151
v_mul_f32 v24, v24, v12
v_mul_f32 v25, v25, v12
v_mul_f32 v26, v26, v12
v_mul_f32 v27, v27, v12
v_mul_f32 v28, v28, v13
v_mul_f32 v29, v29, v13
v_mul_f32 v30, v30, v13
v_mul_f32 v31, v31, v13
v_accvgpr_write_b32 a144, v24
v_accvgpr_write_b32 a145, v25
v_accvgpr_write_b32 a146, v26
v_accvgpr_write_b32 a147, v27
v_accvgpr_write_b32 a148, v28
v_accvgpr_write_b32 a149, v29
v_accvgpr_write_b32 a150, v30
v_accvgpr_write_b32 a151, v31
v_accvgpr_read_b32 v24, a152
v_accvgpr_read_b32 v25, a153
v_accvgpr_read_b32 v26, a154
v_accvgpr_read_b32 v27, a155
v_accvgpr_read_b32 v28, a156
v_accvgpr_read_b32 v29, a157
v_accvgpr_read_b32 v30, a158
v_accvgpr_read_b32 v31, a159
v_mul_f32 v24, v24, v14
v_mul_f32 v25, v25, v14
v_mul_f32 v26, v26, v14
v_mul_f32 v27, v27, v14
v_mul_f32 v28, v28, v15
v_mul_f32 v29, v29, v15
v_mul_f32 v30, v30, v15
v_mul_f32 v31, v31, v15
v_accvgpr_write_b32 a152, v24
v_accvgpr_write_b32 a153, v25
v_accvgpr_write_b32 a154, v26
v_accvgpr_write_b32 a155, v27
v_accvgpr_write_b32 a156, v28
v_accvgpr_write_b32 a157, v29
v_accvgpr_write_b32 a158, v30
v_accvgpr_write_b32 a159, v31
v_accvgpr_read_b32 v24, a160
v_accvgpr_read_b32 v25, a161
v_accvgpr_read_b32 v26, a162
v_accvgpr_read_b32 v27, a163
v_accvgpr_read_b32 v28, a164
v_accvgpr_read_b32 v29, a165
v_accvgpr_read_b32 v30, a166
v_accvgpr_read_b32 v31, a167
v_mul_f32 v24, v24, v12
v_mul_f32 v25, v25, v12
v_mul_f32 v26, v26, v12
v_mul_f32 v27, v27, v12
v_mul_f32 v28, v28, v13
v_mul_f32 v29, v29, v13
v_mul_f32 v30, v30, v13
v_mul_f32 v31, v31, v13
v_accvgpr_write_b32 a160, v24
v_accvgpr_write_b32 a161, v25
v_accvgpr_write_b32 a162, v26
v_accvgpr_write_b32 a163, v27
v_accvgpr_write_b32 a164, v28
v_accvgpr_write_b32 a165, v29
v_accvgpr_write_b32 a166, v30
v_accvgpr_write_b32 a167, v31
v_accvgpr_read_b32 v24, a168
v_accvgpr_read_b32 v25, a169
v_accvgpr_read_b32 v26, a170
v_accvgpr_read_b32 v27, a171
v_accvgpr_read_b32 v28, a172
v_accvgpr_read_b32 v29, a173
v_accvgpr_read_b32 v30, a174
v_accvgpr_read_b32 v31, a175
v_mul_f32 v24, v24, v14
v_mul_f32 v25, v25, v14
v_mul_f32 v26, v26, v14
v_mul_f32 v27, v27, v14
v_mul_f32 v28, v28, v15
v_mul_f32 v29, v29, v15
v_mul_f32 v30, v30, v15
v_mul_f32 v31, v31, v15
v_accvgpr_write_b32 a168, v24
v_accvgpr_write_b32 a169, v25
v_accvgpr_write_b32 a170, v26
v_accvgpr_write_b32 a171, v27
v_accvgpr_write_b32 a172, v28
v_accvgpr_write_b32 a173, v29
v_accvgpr_write_b32 a174, v30
v_accvgpr_write_b32 a175, v31
v_accvgpr_read_b32 v24, a176
v_accvgpr_read_b32 v25, a177
v_accvgpr_read_b32 v26, a178
v_accvgpr_read_b32 v27, a179
v_accvgpr_read_b32 v28, a180
v_accvgpr_read_b32 v29, a181
v_accvgpr_read_b32 v30, a182
v_accvgpr_read_b32 v31, a183
v_mul_f32 v24, v24, v12
v_mul_f32 v25, v25, v12
v_mul_f32 v26, v26, v12
v_mul_f32 v27, v27, v12
v_mul_f32 v28, v28, v13
v_mul_f32 v29, v29, v13
v_mul_f32 v30, v30, v13
v_mul_f32 v31, v31, v13
v_accvgpr_write_b32 a176, v24
v_accvgpr_write_b32 a177, v25
v_accvgpr_write_b32 a178, v26
v_accvgpr_write_b32 a179, v27
v_accvgpr_write_b32 a180, v28
v_accvgpr_write_b32 a181, v29
v_accvgpr_write_b32 a182, v30
v_accvgpr_write_b32 a183, v31
v_accvgpr_read_b32 v24, a184
v_accvgpr_read_b32 v25, a185
v_accvgpr_read_b32 v26, a186
v_accvgpr_read_b32 v27, a187
v_accvgpr_read_b32 v28, a188
v_accvgpr_read_b32 v29, a189
v_accvgpr_read_b32 v30, a190
v_accvgpr_read_b32 v31, a191
v_mul_f32 v24, v24, v14
v_mul_f32 v25, v25, v14
v_mul_f32 v26, v26, v14
v_mul_f32 v27, v27, v14
v_mul_f32 v28, v28, v15
v_mul_f32 v29, v29, v15
v_mul_f32 v30, v30, v15
v_mul_f32 v31, v31, v15
v_accvgpr_write_b32 a184, v24
v_accvgpr_write_b32 a185, v25
v_accvgpr_write_b32 a186, v26
v_accvgpr_write_b32 a187, v27
v_accvgpr_write_b32 a188, v28
v_accvgpr_write_b32 a189, v29
v_accvgpr_write_b32 a190, v30
v_accvgpr_write_b32 a191, v31
v_accvgpr_read_b32 v24, a192
v_accvgpr_read_b32 v25, a193
v_accvgpr_read_b32 v26, a194
v_accvgpr_read_b32 v27, a195
v_accvgpr_read_b32 v28, a196
v_accvgpr_read_b32 v29, a197
v_accvgpr_read_b32 v30, a198
v_accvgpr_read_b32 v31, a199
v_mul_f32 v24, v24, v12
v_mul_f32 v25, v25, v12
v_mul_f32 v26, v26, v12
v_mul_f32 v27, v27, v12
v_mul_f32 v28, v28, v13
v_mul_f32 v29, v29, v13
v_mul_f32 v30, v30, v13
v_mul_f32 v31, v31, v13
v_accvgpr_write_b32 a192, v24
v_accvgpr_write_b32 a193, v25
v_accvgpr_write_b32 a194, v26
v_accvgpr_write_b32 a195, v27
v_accvgpr_write_b32 a196, v28
v_accvgpr_write_b32 a197, v29
v_accvgpr_write_b32 a198, v30
v_accvgpr_write_b32 a199, v31
v_accvgpr_read_b32 v24, a200
v_accvgpr_read_b32 v25, a201
v_accvgpr_read_b32 v26, a202
v_accvgpr_read_b32 v27, a203
v_accvgpr_read_b32 v28, a204
v_accvgpr_read_b32 v29, a205
v_accvgpr_read_b32 v30, a206
v_accvgpr_read_b32 v31, a207
v_mul_f32 v24, v24, v14
v_mul_f32 v25, v25, v14
v_mul_f32 v26, v26, v14
v_mul_f32 v27, v27, v14
v_mul_f32 v28, v28, v15
v_mul_f32 v29, v29, v15
v_mul_f32 v30, v30, v15
v_mul_f32 v31, v31, v15
v_accvgpr_write_b32 a200, v24
v_accvgpr_write_b32 a201, v25
v_accvgpr_write_b32 a202, v26
v_accvgpr_write_b32 a203, v27
v_accvgpr_write_b32 a204, v28
v_accvgpr_write_b32 a205, v29
v_accvgpr_write_b32 a206, v30
v_accvgpr_write_b32 a207, v31
v_accvgpr_read_b32 v24, a208
v_accvgpr_read_b32 v25, a209
v_accvgpr_read_b32 v26, a210
v_accvgpr_read_b32 v27, a211
v_accvgpr_read_b32 v28, a212
v_accvgpr_read_b32 v29, a213
v_accvgpr_read_b32 v30, a214
v_accvgpr_read_b32 v31, a215
v_mul_f32 v24, v24, v12
v_mul_f32 v25, v25, v12
v_mul_f32 v26, v26, v12
v_mul_f32 v27, v27, v12
v_mul_f32 v28, v28, v13
v_mul_f32 v29, v29, v13
v_mul_f32 v30, v30, v13
v_mul_f32 v31, v31, v13
v_accvgpr_write_b32 a208, v24
v_accvgpr_write_b32 a209, v25
v_accvgpr_write_b32 a210, v26
v_accvgpr_write_b32 a211, v27
v_accvgpr_write_b32 a212, v28
v_accvgpr_write_b32 a213, v29
v_accvgpr_write_b32 a214, v30
v_accvgpr_write_b32 a215, v31
v_accvgpr_read_b32 v24, a216
v_accvgpr_read_b32 v25, a217
v_accvgpr_read_b32 v26, a218
v_accvgpr_read_b32 v27, a219
v_accvgpr_read_b32 v28, a220
v_accvgpr_read_b32 v29, a221
v_accvgpr_read_b32 v30, a222
v_accvgpr_read_b32 v31, a223
v_mul_f32 v24, v24, v14
v_mul_f32 v25, v25, v14
v_mul_f32 v26, v26, v14
v_mul_f32 v27, v27, v14
v_mul_f32 v28, v28, v15
v_mul_f32 v29, v29, v15
v_mul_f32 v30, v30, v15
v_mul_f32 v31, v31, v15
v_accvgpr_write_b32 a216, v24
v_accvgpr_write_b32 a217, v25
v_accvgpr_write_b32 a218, v26
v_accvgpr_write_b32 a219, v27
v_accvgpr_write_b32 a220, v28
v_accvgpr_write_b32 a221, v29
v_accvgpr_write_b32 a222, v30
v_accvgpr_write_b32 a223, v31
v_accvgpr_read_b32 v24, a224
v_accvgpr_read_b32 v25, a225
v_accvgpr_read_b32 v26, a226
v_accvgpr_read_b32 v27, a227
v_accvgpr_read_b32 v28, a228
v_accvgpr_read_b32 v29, a229
v_accvgpr_read_b32 v30, a230
v_accvgpr_read_b32 v31, a231
v_mul_f32 v24, v24, v12
v_mul_f32 v25, v25, v12
v_mul_f32 v26, v26, v12
v_mul_f32 v27, v27, v12
v_mul_f32 v28, v28, v13
v_mul_f32 v29, v29, v13
v_mul_f32 v30, v30, v13
v_mul_f32 v31, v31, v13
v_accvgpr_write_b32 a224, v24
v_accvgpr_write_b32 a225, v25
v_accvgpr_write_b32 a226, v26
v_accvgpr_write_b32 a227, v27
v_accvgpr_write_b32 a228, v28
v_accvgpr_write_b32 a229, v29
v_accvgpr_write_b32 a230, v30
v_accvgpr_write_b32 a231, v31
v_accvgpr_read_b32 v24, a232
v_accvgpr_read_b32 v25, a233
v_accvgpr_read_b32 v26, a234
v_accvgpr_read_b32 v27, a235
v_accvgpr_read_b32 v28, a236
v_accvgpr_read_b32 v29, a237
v_accvgpr_read_b32 v30, a238
v_accvgpr_read_b32 v31, a239
v_mul_f32 v24, v24, v14
v_mul_f32 v25, v25, v14
v_mul_f32 v26, v26, v14
v_mul_f32 v27, v27, v14
v_mul_f32 v28, v28, v15
v_mul_f32 v29, v29, v15
v_mul_f32 v30, v30, v15
v_mul_f32 v31, v31, v15
v_accvgpr_write_b32 a232, v24
v_accvgpr_write_b32 a233, v25
v_accvgpr_write_b32 a234, v26
v_accvgpr_write_b32 a235, v27
v_accvgpr_write_b32 a236, v28
v_accvgpr_write_b32 a237, v29
v_accvgpr_write_b32 a238, v30
v_accvgpr_write_b32 a239, v31
s_mov_b32 s48, 0
s_cmp_eq_u32 s52, 0
s_cbranch_scc1 L_at_rsr0
s_cmp_eq_u32 s52, 1
s_cbranch_scc1 L_at_rsr1
s_cmp_eq_u32 s52, 2
s_cbranch_scc1 L_at_rsr2
s_cmp_eq_u32 s52, 3
s_cbranch_scc1 L_at_rsr3
s_cmp_eq_u32 s52, 4
s_cbranch_scc1 L_at_rsr4
s_cmp_eq_u32 s52, 5
s_cbranch_scc1 L_at_rsr5
s_cmp_eq_u32 s52, 6
s_cbranch_scc1 L_at_rsr6
s_cmp_eq_u32 s52, 7
s_cbranch_scc1 L_at_rsr7
s_cmp_eq_u32 s52, 8
s_cbranch_scc1 L_at_rsr8
s_branch L_at_rsr9
L_at_done:
s_load_dwordx2 s[4:5], s[0:1], 40
s_waitcnt lgkmcnt(0)
s_mov_b32 s20, s4
s_and_b32 s21, s5, 0xffff
s_mov_b32 s22, 4718592
s_mov_b32 s23, 0x20000
s_sub_u32 s25, s3, 4
s_mul_i32 s24, s25, 27
s_add_u32 s24, s24, s16
s_mul_i32 s26, s25, 5
s_add_u32 s26, s26, s16
s_add_u32 s26, s26, 81
s_cmp_ge_u32 s16, 27
s_cselect_b32 s24, s26, s24
s_cmp_ge_u32 s24, 126
s_cbranch_scc1 L_done
s_mul_i32 s25, s24, 57
s_lshr_b32 s25, s25, 9
s_mul_i32 s26, s25, 9
s_sub_u32 s40, s24, s26
s_and_b32 s27, s25, 1
s_mov_b32 s26, s40
s_mov_b32 s4, 0x0
s_mov_b32 s5, 0x0
s_cmp_ge_u32 s25, 14
s_cbranch_scc1 L_bo2
s_and_b32 s51, s25, 1
s_add_u32 s51, s51, 126
s_lshr_b32 s25, s25, 1
s_cmp_eq_u32 s25, 0
s_cselect_b32 s42, 0x20408102, s42
s_cselect_b32 s43, 0x2040810, s43
s_cmp_eq_u32 s25, 1
s_cselect_b32 s42, 0x40810204, s42
s_cselect_b32 s43, 0x4081020, s43
s_cmp_eq_u32 s25, 2
s_cselect_b32 s42, 0x81020408, s42
s_cselect_b32 s43, 0x8102040, s43
s_cmp_eq_u32 s25, 3
s_cselect_b32 s42, 0x2040811, s42
s_cselect_b32 s43, 0x10204081, s43
s_cmp_eq_u32 s25, 4
s_cselect_b32 s42, 0x4081020, s42
s_cselect_b32 s43, 0x20408102, s43
s_cmp_eq_u32 s25, 5
s_cselect_b32 s42, 0x8102040, s42
s_cselect_b32 s43, 0x40810204, s43
s_cmp_eq_u32 s25, 6
s_cselect_b32 s42, 0x10204080, s42
s_cselect_b32 s43, 0x81020408, s43
s_mov_b32 s44, 67108864
s_mov_b32 s45, 111169536
s_mov_b32 s46, 4
s_mov_b32 s47, 0
s_mov_b32 s54, 536870912
s_branch L_op
L_bdie:
s_mov_b32 s4, 0x5557fe00
s_mov_b32 s5, 0x55555555
s_cmp_eq_u32 s3, 2
s_cbranch_scc1 L_cr0
s_mov_b32 s4, 0xaaa80000
s_mov_b32 s5, 0xaaaaaaaa
s_branch L_cr0
s_and_b32 s27, s3, 1
s_lshr_b32 s26, s16, 2
s_lshl_b32 s26, s26, 1
s_and_b32 s24, s16, 1
s_add_u32 s26, s26, s24
s_mov_b32 s4, 0x5557fe00
s_mov_b32 s5, 0x55555555
s_bitcmp1_b32 s16, 1
s_cbranch_scc1 L_crew
s_mov_b32 s4, 0xaaa80000
s_mov_b32 s5, 0xaaaaaaaa
s_branch L_crew
L_part:
s_mov_b32 s4, 0x1ff
s_mov_b32 s5, 0x0
L_cr0:
s_bfe_u32 s27, s16, 0x10001
s_lshr_b32 s26, s16, 2
s_bitcmp0_b32 s16, 0
s_cselect_b32 s24, 8, 0
s_add_u32 s26, s26, s24
L_crew:
s_cmp_eq_u64 s[4:5], 0
s_cbranch_scc1 L_done
s_cmp_lt_u32 s26, 9
s_cbranch_scc1 L_bo
s_mov_b64 s[52:53], s[4:5]
s_sub_u32 s41, s26, 9
s_lshl_b32 s41, s41, 1
s_add_u32 s41, s41, s27
s_mul_i32 s24, s17, 14
s_add_u32 s41, s41, s24
s_mov_b32 s40, 0x3e0293ee
s_mov_b32 s50, 0xf149f2ca
s_mov_b32 s51, 0x41a00000
s_lshl_b32 s55, s3, 7
s_add_u32 s55, s55, 111171584
v_and_b32 v5, 31, v0
v_bfe_u32 v26, v0, 5, 1
v_lshlrev_b32 v27, 2, v26
v_sub_u32 v5, v5, v27
v_bfe_u32 v27, v0, 4, 1
v_lshlrev_b32 v6, 17, v27
v_lshl_add_u32 v6, v26, 8, v6
v_and_b32 v27, 15, v0
v_lshl_add_u32 v6, v27, 4, v6
v_and_b32 v1, 63, v0
v_min_u32 v17, 47, v1
v_lshlrev_b32 v1, 4, v1
s_lshl_b32 s24, s17, 12
s_mov_b32 m0, s24
v_bfe_u32 v26, v0, 5, 1
v_and_b32 v27, 1, v0
v_lshl_add_u32 v2, v27, 2, s24
v_lshl_add_u32 v2, v26, 5, v2
v_bfe_u32 v27, v0, 1, 2
v_lshl_add_u32 v2, v27, 8, v2
v_lshl_add_u32 v3, v26, 9, s24
v_bfe_u32 v27, v0, 4, 1
v_lshl_add_u32 v3, v27, 2, v3
v_bfe_u32 v27, v0, 3, 1
v_lshl_add_u32 v3, v27, 6, v3
v_bfe_u32 v27, v0, 2, 1
v_lshl_add_u32 v3, v27, 7, v3
v_and_b32 v27, 3, v0
v_lshl_add_u32 v3, v27, 4, v3
v_mov_b32 v4, 0
v_lshlrev_b32 v17, 7, v17
v_mul_u32_u24 v26, 24576, v26
v_add_u32 v17, v17, v26
v_add_u32 v17, 111149056, v17
v_mov_b32 v31, s50
s_mov_b32 s49, 0
s_mov_b32 s62, 0
s_mov_b32 s63, 0
s_mov_b32 s45, -1
v_cmp_le_i32 s[64:65], 0, v5
v_cmp_le_i32 s[66:67], 1, v5
v_cmp_le_i32 s[68:69], 2, v5
v_cmp_le_i32 s[70:71], 3, v5
v_cmp_le_i32 s[72:73], 8, v5
v_cmp_le_i32 s[74:75], 9, v5
v_cmp_le_i32 s[76:77], 10, v5
v_cmp_le_i32 s[78:79], 11, v5
v_cmp_le_i32 s[80:81], 16, v5
v_cmp_le_i32 s[82:83], 17, v5
v_cmp_le_i32 s[84:85], 18, v5
v_cmp_le_i32 s[86:87], 19, v5
v_cmp_le_i32 s[88:89], 24, v5
v_cmp_le_i32 s[90:91], 25, v5
v_cmp_le_i32 s[92:93], 26, v5
v_cmp_le_i32 s[94:95], 27, v5
L_nb_19:
s_ff1_i32_b64 s47, s[52:53]
s_cmp_lt_u32 s41, 32
s_cbranch_scc1 L_nb_20
s_bitset0_b64 s[52:53], s47
s_sub_u32 s41, s41, 32
s_add_u32 s62, s62, 1
s_branch L_nb_19
L_nb_20:
s_lshl_b32 s47, s47, 5
s_add_u32 s47, s47, s41
s_add_u32 s41, s41, 56
s_lshl_b32 s46, s47, 14
s_add_u32 s46, s46, 33554432
s_lshl_b32 s44, s47, 13
s_add_u32 s44, s44, 134217728
s_cmp_ge_u32 s47, 2048
s_cselect_b32 s44, 536870912, s44
s_cselect_b32 s46, 536870912, s46
s_cbranch_scc1 L_nb_18
s_lshr_b32 s25, s47, 8
s_lshl_b32 s25, s25, 2
s_cmp_eq_u32 s25, s45
s_cbranch_scc1 L_nb_18
s_mov_b32 s45, s25
s_mov_b32 s28, 0
L_poll_22:
buffer_load_dword v26, v17, s[8:11], s45 offen sc1
s_add_u32 s28, s28, 1
s_cmp_gt_u32 s28, 200000
s_cbranch_scc1 L_end
s_waitcnt vmcnt(0)
v_cmp_ne_u32 vcc, 1, v26
s_cbranch_vccz L_pd_23
s_sleep 8
s_cmp_lt_u32 s28, 32
s_cbranch_scc1 L_poll_22
s_sleep 32
s_branch L_poll_22
L_pd_23:
L_nb_18:
s_cmp_ge_u32 s47, 2048
s_cbranch_scc1 L_bt_x
s_add_u32 s25, s44, 0
buffer_load_dwordx4 a[0:3], v1, s[8:11], s25 offen sc1
buffer_load_dwordx4 a[4:7], v1, s[8:11], s25 offen offset:1024 sc1
buffer_load_dwordx4 a[8:11], v1, s[8:11], s25 offen offset:2048 sc1
buffer_load_dwordx4 a[12:15], v1, s[8:11], s25 offen offset:3072 sc1
s_add_u32 s25, s44, 4096
buffer_load_dwordx4 a[16:19], v1, s[8:11], s25 offen sc1
buffer_load_dwordx4 a[20:23], v1, s[8:11], s25 offen offset:1024 sc1
buffer_load_dwordx4 a[24:27], v1, s[8:11], s25 offen offset:2048 sc1
buffer_load_dwordx4 a[28:31], v1, s[8:11], s25 offen offset:3072 sc1
s_add_u32 s25, s46, 0
buffer_load_dwordx4 a[32:35], v1, s[8:11], s25 offen sc1
buffer_load_dwordx4 a[36:39], v1, s[8:11], s25 offen offset:1024 sc1
buffer_load_dwordx4 a[40:43], v1, s[8:11], s25 offen offset:2048 sc1
buffer_load_dwordx4 a[44:47], v1, s[8:11], s25 offen offset:3072 sc1
s_add_u32 s25, s46, 4096
buffer_load_dwordx4 a[48:51], v1, s[8:11], s25 offen sc1
buffer_load_dwordx4 a[52:55], v1, s[8:11], s25 offen offset:1024 sc1
buffer_load_dwordx4 a[56:59], v1, s[8:11], s25 offen offset:2048 sc1
buffer_load_dwordx4 a[60:63], v1, s[8:11], s25 offen offset:3072 sc1
s_add_u32 s25, s46, 8192
buffer_load_dwordx4 a[64:67], v1, s[8:11], s25 offen sc1
buffer_load_dwordx4 a[68:71], v1, s[8:11], s25 offen offset:1024 sc1
buffer_load_dwordx4 a[72:75], v1, s[8:11], s25 offen offset:2048 sc1
buffer_load_dwordx4 a[76:79], v1, s[8:11], s25 offen offset:3072 sc1
s_add_u32 s25, s46, 12288
buffer_load_dwordx4 a[80:83], v1, s[8:11], s25 offen sc1
buffer_load_dwordx4 a[84:87], v1, s[8:11], s25 offen offset:1024 sc1
buffer_load_dwordx4 a[88:91], v1, s[8:11], s25 offen offset:2048 sc1
buffer_load_dwordx4 a[92:95], v1, s[8:11], s25 offen offset:3072 sc1
s_waitcnt vmcnt(0)
s_mov_b32 s54, 536870912
s_mov_b32 s60, 536870912
s_mov_b32 s30, 0x0
s_mov_b32 s31, 0x0
L_bt:
s_waitcnt vmcnt(8)
v_mfma_f32_32x32x16_bf16 v[32:47], a[32:35], a[0:3], 0
v_mfma_f32_32x32x16_bf16 v[32:47], a[36:39], a[4:7], v[32:47]
v_mfma_f32_32x32x16_bf16 v[32:47], a[40:43], a[8:11], v[32:47]
v_mfma_f32_32x32x16_bf16 v[32:47], a[44:47], a[12:15], v[32:47]
v_mfma_f32_32x32x16_bf16 v[32:47], a[48:51], a[16:19], v[32:47]
v_mfma_f32_32x32x16_bf16 v[32:47], a[52:55], a[20:23], v[32:47]
v_mfma_f32_32x32x16_bf16 v[32:47], a[56:59], a[24:27], v[32:47]
v_mfma_f32_32x32x16_bf16 v[32:47], a[60:63], a[28:31], v[32:47]
s_and_b32 s42, s47, 31
s_lshr_b32 s43, s47, 5
s_lshl_b32 s26, s47, 12
s_add_u32 s26, s26, 100663296
s_nop 7
v_cndmask_b32 v32, v31, v32, s[64:65]
v_cndmask_b32 v33, v31, v33, s[66:67]
v_cndmask_b32 v34, v31, v34, s[68:69]
v_cndmask_b32 v35, v31, v35, s[70:71]
v_cndmask_b32 v36, v31, v36, s[72:73]
v_cndmask_b32 v37, v31, v37, s[74:75]
v_cndmask_b32 v38, v31, v38, s[76:77]
v_cndmask_b32 v39, v31, v39, s[78:79]
v_cndmask_b32 v40, v31, v40, s[80:81]
v_cndmask_b32 v41, v31, v41, s[82:83]
v_cndmask_b32 v42, v31, v42, s[84:85]
v_cndmask_b32 v43, v31, v43, s[86:87]
v_cndmask_b32 v44, v31, v44, s[88:89]
v_cndmask_b32 v45, v31, v45, s[90:91]
v_cndmask_b32 v46, v31, v46, s[92:93]
v_cndmask_b32 v47, v31, v47, s[94:95]
v_max3_f32 v20, v32, v33, v34
v_max3_f32 v20, v20, v35, v36
v_max3_f32 v20, v20, v37, v38
v_max3_f32 v20, v20, v39, v40
v_max3_f32 v20, v20, v41, v42
v_max3_f32 v20, v20, v43, v44
v_max3_f32 v20, v20, v45, v46
v_max_f32 v20, v20, v47
s_cmp_lt_u32 s43, s49
s_cbranch_scc1 L_kn_24
v_mov_b32 v26, 1
s_waitcnt vmcnt(0)
s_mov_b64 exec, 1
buffer_store_dword v26, v4, s[8:11], s54 offen
s_mov_b64 exec, -1
L_nb_27:
s_ff1_i32_b64 s48, s[52:53]
s_cmp_lt_u32 s41, 32
s_cbranch_scc1 L_nb_28
s_bitset0_b64 s[52:53], s48
s_sub_u32 s41, s41, 32
s_add_u32 s62, s62, 1
s_branch L_nb_27
L_nb_28:
s_lshl_b32 s48, s48, 5
s_add_u32 s48, s48, s41
s_add_u32 s41, s41, 56
s_lshl_b32 s46, s48, 14
s_add_u32 s46, s46, 33554432
s_lshl_b32 s44, s48, 13
s_add_u32 s44, s44, 134217728
s_cmp_ge_u32 s48, 2048
s_cselect_b32 s44, 536870912, s44
s_cselect_b32 s46, 536870912, s46
s_cbranch_scc1 L_nb_26
s_lshr_b32 s25, s48, 8
s_lshl_b32 s25, s25, 2
s_cmp_eq_u32 s25, s45
s_cbranch_scc1 L_nb_26
s_mov_b32 s45, s25
s_mov_b32 s28, 0
L_poll_30:
buffer_load_dword v26, v17, s[8:11], s45 offen sc1
s_add_u32 s28, s28, 1
s_cmp_gt_u32 s28, 200000
s_cbranch_scc1 L_end
s_waitcnt vmcnt(0)
v_cmp_ne_u32 vcc, 1, v26
s_cbranch_vccz L_pd_31
s_sleep 8
s_cmp_lt_u32 s28, 32
s_cbranch_scc1 L_poll_30
s_sleep 32
s_branch L_poll_30
L_pd_31:
L_nb_26:
s_add_u32 s25, s44, 0
buffer_load_dwordx4 a[96:99], v1, s[8:11], s25 offen sc1
buffer_load_dwordx4 a[100:103], v1, s[8:11], s25 offen offset:1024 sc1
buffer_load_dwordx4 a[104:107], v1, s[8:11], s25 offen offset:2048 sc1
buffer_load_dwordx4 a[108:111], v1, s[8:11], s25 offen offset:3072 sc1
s_add_u32 s25, s44, 4096
buffer_load_dwordx4 a[112:115], v1, s[8:11], s25 offen sc1
buffer_load_dwordx4 a[116:119], v1, s[8:11], s25 offen offset:1024 sc1
buffer_load_dwordx4 a[120:123], v1, s[8:11], s25 offen offset:2048 sc1
buffer_load_dwordx4 a[124:127], v1, s[8:11], s25 offen offset:3072 sc1
s_add_u32 s25, s46, 0
buffer_load_dwordx4 a[128:131], v1, s[8:11], s25 offen sc1
buffer_load_dwordx4 a[132:135], v1, s[8:11], s25 offen offset:1024 sc1
buffer_load_dwordx4 a[136:139], v1, s[8:11], s25 offen offset:2048 sc1
buffer_load_dwordx4 a[140:143], v1, s[8:11], s25 offen offset:3072 sc1
s_add_u32 s25, s46, 4096
buffer_load_dwordx4 a[144:147], v1, s[8:11], s25 offen sc1
buffer_load_dwordx4 a[148:151], v1, s[8:11], s25 offen offset:1024 sc1
buffer_load_dwordx4 a[152:155], v1, s[8:11], s25 offen offset:2048 sc1
buffer_load_dwordx4 a[156:159], v1, s[8:11], s25 offen offset:3072 sc1
s_add_u32 s25, s46, 8192
buffer_load_dwordx4 a[160:163], v1, s[8:11], s25 offen sc1
buffer_load_dwordx4 a[164:167], v1, s[8:11], s25 offen offset:1024 sc1
buffer_load_dwordx4 a[168:171], v1, s[8:11], s25 offen offset:2048 sc1
buffer_load_dwordx4 a[172:175], v1, s[8:11], s25 offen offset:3072 sc1
s_add_u32 s25, s46, 12288
buffer_load_dwordx4 a[176:179], v1, s[8:11], s25 offen sc1
buffer_load_dwordx4 a[180:183], v1, s[8:11], s25 offen offset:1024 sc1
buffer_load_dwordx4 a[184:187], v1, s[8:11], s25 offen offset:2048 sc1
buffer_load_dwordx4 a[188:191], v1, s[8:11], s25 offen offset:3072 sc1
s_lshl_b32 s25, s42, 7
s_add_u32 s25, s25, 111153152
s_mov_b32 s28, 0
L_poll_32:
buffer_load_dword v26, v4, s[8:11], s25 offen sc1
s_add_u32 s28, s28, 1
s_cmp_gt_u32 s28, 200000
s_cbranch_scc1 L_end
s_waitcnt vmcnt(0)
v_cmp_ge_u32 vcc, s43, v26
s_cbranch_vccz L_pd_33
s_sleep 1
s_cmp_lt_u32 s28, 32
s_cbranch_scc1 L_poll_32
s_sleep 32
s_branch L_poll_32
L_pd_33:
buffer_load_dwordx4 v1, s[8:11], s26 offen sc1 lds
buffer_load_dwordx4 v1, s[8:11], s26 offen offset:1024 sc1 lds
buffer_load_dwordx4 v1, s[8:11], s26 offen offset:2048 sc1 lds
buffer_load_dwordx4 v1, s[8:11], s26 offen offset:3072 sc1 lds
v_readfirstlane_b32 s49, v26
s_nop 0
s_min_u32 s49, s49, 63
s_sub_u32 s49, s49, 1
s_waitcnt vmcnt(3)
ds_read_b32 v96, v2 offset:8
ds_read_b32 v97, v2 offset:24
ds_read_b32 v98, v2 offset:72
ds_read_b32 v99, v2 offset:88
ds_read_b32 v100, v2 offset:136
ds_read_b32 v101, v2 offset:152
ds_read_b32 v102, v2 offset:200
ds_read_b32 v103, v2 offset:216
s_waitcnt vmcnt(2)
ds_read_b32 v104, v2 offset:1032
ds_read_b32 v105, v2 offset:1048
ds_read_b32 v106, v2 offset:1096
ds_read_b32 v107, v2 offset:1112
s_waitcnt lgkmcnt(8)
v_mfma_f32_32x32x16_bf16 v[64:79], v[96:99], a[0:3], 0
ds_read_b32 v108, v2 offset:1160
ds_read_b32 v109, v2 offset:1176
ds_read_b32 v110, v2 offset:1224
ds_read_b32 v111, v2 offset:1240
s_waitcnt lgkmcnt(8)
v_mfma_f32_32x32x16_bf16 v[64:79], v[100:103], a[4:7], v[64:79]
s_waitcnt vmcnt(1)
ds_read_b32 v112, v2 offset:2056
ds_read_b32 v113, v2 offset:2072
ds_read_b32 v114, v2 offset:2120
ds_read_b32 v115, v2 offset:2136
s_waitcnt lgkmcnt(8)
v_mfma_f32_32x32x16_bf16 v[64:79], v[104:107], a[8:11], v[64:79]
ds_read_b32 v116, v2 offset:2184
ds_read_b32 v117, v2 offset:2200
ds_read_b32 v118, v2 offset:2248
ds_read_b32 v119, v2 offset:2264
s_waitcnt lgkmcnt(8)
v_mfma_f32_32x32x16_bf16 v[64:79], v[108:111], a[12:15], v[64:79]
s_waitcnt vmcnt(0)
ds_read_b32 v120, v2 offset:3080
ds_read_b32 v121, v2 offset:3096
ds_read_b32 v122, v2 offset:3144
ds_read_b32 v123, v2 offset:3160
s_waitcnt lgkmcnt(8)
v_mfma_f32_32x32x16_bf16 v[64:79], v[112:115], a[16:19], v[64:79]
ds_read_b32 v124, v2 offset:3208
ds_read_b32 v125, v2 offset:3224
ds_read_b32 v126, v2 offset:3272
ds_read_b32 v127, v2 offset:3288
s_waitcnt lgkmcnt(8)
v_mfma_f32_32x32x16_bf16 v[64:79], v[116:119], a[20:23], v[64:79]
ds_read_b32 v8, v3
ds_read_b32 v9, v3 offset:256
ds_read_b32 v10, v3 offset:1024
ds_read_b32 v11, v3 offset:1280
s_waitcnt lgkmcnt(8)
v_mfma_f32_32x32x16_bf16 v[64:79], v[120:123], a[24:27], v[64:79]
ds_read_b32 v12, v3 offset:2048
ds_read_b32 v13, v3 offset:2304
ds_read_b32 v14, v3 offset:3072
ds_read_b32 v15, v3 offset:3328
s_waitcnt lgkmcnt(8)
v_mfma_f32_32x32x16_bf16 v[64:79], v[124:127], a[28:31], v[64:79]
s_branch L_kj_25
L_kn_24:
buffer_load_dwordx4 v1, s[8:11], s26 offen sc1 lds
buffer_load_dwordx4 v1, s[8:11], s26 offen offset:1024 sc1 lds
buffer_load_dwordx4 v1, s[8:11], s26 offen offset:2048 sc1 lds
buffer_load_dwordx4 v1, s[8:11], s26 offen offset:3072 sc1 lds
v_mov_b32 v26, 1
s_waitcnt vmcnt(4)
s_mov_b64 exec, 1
buffer_store_dword v26, v4, s[8:11], s54 offen
s_mov_b64 exec, -1
L_nb_35:
s_ff1_i32_b64 s48, s[52:53]
s_cmp_lt_u32 s41, 32
s_cbranch_scc1 L_nb_36
s_bitset0_b64 s[52:53], s48
s_sub_u32 s41, s41, 32
s_add_u32 s62, s62, 1
s_branch L_nb_35
L_nb_36:
s_lshl_b32 s48, s48, 5
s_add_u32 s48, s48, s41
s_add_u32 s41, s41, 56
s_lshl_b32 s46, s48, 14
s_add_u32 s46, s46, 33554432
s_lshl_b32 s44, s48, 13
s_add_u32 s44, s44, 134217728
s_cmp_ge_u32 s48, 2048
s_cselect_b32 s44, 536870912, s44
s_cselect_b32 s46, 536870912, s46
s_cbranch_scc1 L_nb_34
s_lshr_b32 s25, s48, 8
s_lshl_b32 s25, s25, 2
s_cmp_eq_u32 s25, s45
s_cbranch_scc1 L_nb_34
s_mov_b32 s45, s25
s_mov_b32 s28, 0
L_poll_38:
buffer_load_dword v26, v17, s[8:11], s45 offen sc1
s_add_u32 s28, s28, 1
s_cmp_gt_u32 s28, 200000
s_cbranch_scc1 L_end
s_waitcnt vmcnt(0)
v_cmp_ne_u32 vcc, 1, v26
s_cbranch_vccz L_pd_39
s_sleep 8
s_cmp_lt_u32 s28, 32
s_cbranch_scc1 L_poll_38
s_sleep 32
s_branch L_poll_38
L_pd_39:
L_nb_34:
s_add_u32 s25, s44, 0
buffer_load_dwordx4 a[96:99], v1, s[8:11], s25 offen sc1
buffer_load_dwordx4 a[100:103], v1, s[8:11], s25 offen offset:1024 sc1
buffer_load_dwordx4 a[104:107], v1, s[8:11], s25 offen offset:2048 sc1
buffer_load_dwordx4 a[108:111], v1, s[8:11], s25 offen offset:3072 sc1
s_add_u32 s25, s44, 4096
buffer_load_dwordx4 a[112:115], v1, s[8:11], s25 offen sc1
buffer_load_dwordx4 a[116:119], v1, s[8:11], s25 offen offset:1024 sc1
buffer_load_dwordx4 a[120:123], v1, s[8:11], s25 offen offset:2048 sc1
buffer_load_dwordx4 a[124:127], v1, s[8:11], s25 offen offset:3072 sc1
s_waitcnt vmcnt(12)
ds_read_b32 v96, v2 offset:8
ds_read_b32 v97, v2 offset:24
ds_read_b32 v98, v2 offset:72
ds_read_b32 v99, v2 offset:88
ds_read_b32 v100, v2 offset:136
ds_read_b32 v101, v2 offset:152
ds_read_b32 v102, v2 offset:200
ds_read_b32 v103, v2 offset:216
s_waitcnt vmcnt(11)
ds_read_b32 v104, v2 offset:1032
ds_read_b32 v105, v2 offset:1048
ds_read_b32 v106, v2 offset:1096
ds_read_b32 v107, v2 offset:1112
s_waitcnt lgkmcnt(8)
v_mfma_f32_32x32x16_bf16 v[64:79], v[96:99], a[0:3], 0
s_add_u32 s25, s46, 0
buffer_load_dwordx4 a[128:131], v1, s[8:11], s25 offen sc1
buffer_load_dwordx4 a[132:135], v1, s[8:11], s25 offen offset:1024 sc1
ds_read_b32 v108, v2 offset:1160
ds_read_b32 v109, v2 offset:1176
ds_read_b32 v110, v2 offset:1224
ds_read_b32 v111, v2 offset:1240
s_waitcnt lgkmcnt(8)
v_mfma_f32_32x32x16_bf16 v[64:79], v[100:103], a[4:7], v[64:79]
buffer_load_dwordx4 a[136:139], v1, s[8:11], s25 offen offset:2048 sc1
buffer_load_dwordx4 a[140:143], v1, s[8:11], s25 offen offset:3072 sc1
s_waitcnt vmcnt(14)
ds_read_b32 v112, v2 offset:2056
ds_read_b32 v113, v2 offset:2072
ds_read_b32 v114, v2 offset:2120
ds_read_b32 v115, v2 offset:2136
s_waitcnt lgkmcnt(8)
v_mfma_f32_32x32x16_bf16 v[64:79], v[104:107], a[8:11], v[64:79]
s_add_u32 s25, s46, 4096
buffer_load_dwordx4 a[144:147], v1, s[8:11], s25 offen sc1
buffer_load_dwordx4 a[148:151], v1, s[8:11], s25 offen offset:1024 sc1
ds_read_b32 v116, v2 offset:2184
ds_read_b32 v117, v2 offset:2200
ds_read_b32 v118, v2 offset:2248
ds_read_b32 v119, v2 offset:2264
s_waitcnt lgkmcnt(8)
v_mfma_f32_32x32x16_bf16 v[64:79], v[108:111], a[12:15], v[64:79]
buffer_load_dwordx4 a[152:155], v1, s[8:11], s25 offen offset:2048 sc1
buffer_load_dwordx4 a[156:159], v1, s[8:11], s25 offen offset:3072 sc1
s_waitcnt vmcnt(17)
ds_read_b32 v120, v2 offset:3080
ds_read_b32 v121, v2 offset:3096
ds_read_b32 v122, v2 offset:3144
ds_read_b32 v123, v2 offset:3160
s_waitcnt lgkmcnt(8)
v_mfma_f32_32x32x16_bf16 v[64:79], v[112:115], a[16:19], v[64:79]
s_add_u32 s25, s46, 8192
buffer_load_dwordx4 a[160:163], v1, s[8:11], s25 offen sc1
buffer_load_dwordx4 a[164:167], v1, s[8:11], s25 offen offset:1024 sc1
ds_read_b32 v124, v2 offset:3208
ds_read_b32 v125, v2 offset:3224
ds_read_b32 v126, v2 offset:3272
ds_read_b32 v127, v2 offset:3288
s_waitcnt lgkmcnt(8)
v_mfma_f32_32x32x16_bf16 v[64:79], v[116:119], a[20:23], v[64:79]
buffer_load_dwordx4 a[168:171], v1, s[8:11], s25 offen offset:2048 sc1
buffer_load_dwordx4 a[172:175], v1, s[8:11], s25 offen offset:3072 sc1
ds_read_b32 v8, v3
ds_read_b32 v9, v3 offset:256
ds_read_b32 v10, v3 offset:1024
ds_read_b32 v11, v3 offset:1280
s_waitcnt lgkmcnt(8)
v_mfma_f32_32x32x16_bf16 v[64:79], v[120:123], a[24:27], v[64:79]
s_add_u32 s25, s46, 12288
buffer_load_dwordx4 a[176:179], v1, s[8:11], s25 offen sc1
buffer_load_dwordx4 a[180:183], v1, s[8:11], s25 offen offset:1024 sc1
ds_read_b32 v12, v3 offset:2048
ds_read_b32 v13, v3 offset:2304
ds_read_b32 v14, v3 offset:3072
ds_read_b32 v15, v3 offset:3328
s_waitcnt lgkmcnt(8)
v_mfma_f32_32x32x16_bf16 v[64:79], v[124:127], a[28:31], v[64:79]
buffer_load_dwordx4 a[184:187], v1, s[8:11], s25 offen offset:2048 sc1
buffer_load_dwordx4 a[188:191], v1, s[8:11], s25 offen offset:3072 sc1
L_kj_25:
s_nop 10
v_max3_f32 v20, v20, v64, v65
v_max3_f32 v20, v20, v66, v67
v_mov_b32 v26, v20
s_nop 1
v_permlane32_swap_b32 v26, v20
v_max_f32 v20, v20, v26
v_mul_f32 v20, s40, v20
v_pk_fma_f32 v[64:65], v[64:65], s[40:41], v[20:21] op_sel_hi:[1,0,0] neg_lo:[0,0,1] neg_hi:[0,0,1]
v_pk_fma_f32 v[66:67], v[66:67], s[40:41], v[20:21] op_sel_hi:[1,0,0] neg_lo:[0,0,1] neg_hi:[0,0,1]
v_pk_fma_f32 v[32:33], v[32:33], s[40:41], v[20:21] op_sel_hi:[1,0,0] neg_lo:[0,0,1] neg_hi:[0,0,1]
v_pk_fma_f32 v[34:35], v[34:35], s[40:41], v[20:21] op_sel_hi:[1,0,0] neg_lo:[0,0,1] neg_hi:[0,0,1]
v_pk_fma_f32 v[36:37], v[36:37], s[40:41], v[20:21] op_sel_hi:[1,0,0] neg_lo:[0,0,1] neg_hi:[0,0,1]
v_pk_fma_f32 v[38:39], v[38:39], s[40:41], v[20:21] op_sel_hi:[1,0,0] neg_lo:[0,0,1] neg_hi:[0,0,1]
v_pk_fma_f32 v[40:41], v[40:41], s[40:41], v[20:21] op_sel_hi:[1,0,0] neg_lo:[0,0,1] neg_hi:[0,0,1]
v_pk_fma_f32 v[42:43], v[42:43], s[40:41], v[20:21] op_sel_hi:[1,0,0] neg_lo:[0,0,1] neg_hi:[0,0,1]
v_pk_fma_f32 v[44:45], v[44:45], s[40:41], v[20:21] op_sel_hi:[1,0,0] neg_lo:[0,0,1] neg_hi:[0,0,1]
v_pk_fma_f32 v[46:47], v[46:47], s[40:41], v[20:21] op_sel_hi:[1,0,0] neg_lo:[0,0,1] neg_hi:[0,0,1]
v_exp_f32 v64, v64
v_exp_f32 v65, v65
v_exp_f32 v66, v66
v_exp_f32 v67, v67
v_exp_f32 v32, v32
v_exp_f32 v33, v33
v_cvt_pk_bf16_f32 v88, v64, v65
v_cvt_pk_bf16_f32 v89, v66, v67
s_waitcnt lgkmcnt(0)
s_nop 0
v_mfma_f32_32x32x8_bf16 v[128:143], v[8:9], v[88:89], 0
v_exp_f32 v34, v34
v_exp_f32 v35, v35
v_exp_f32 v36, v36
v_mfma_f32_32x32x8_bf16 v[160:175], v[10:11], v[88:89], 0
v_exp_f32 v37, v37
v_exp_f32 v38, v38
v_mfma_f32_32x32x8_bf16 v[192:207], v[12:13], v[88:89], 0
v_exp_f32 v39, v39
v_exp_f32 v40, v40
v_exp_f32 v41, v41
v_mfma_f32_32x32x8_bf16 v[224:239], v[14:15], v[88:89], 0
v_cvt_pk_bf16_f32 v80, v32, v33
v_cvt_pk_bf16_f32 v81, v34, v35
v_cvt_pk_bf16_f32 v82, v36, v37
v_cvt_pk_bf16_f32 v83, v38, v39
s_nop 1
v_mfma_f32_32x32x16_bf16 v[128:143], a[64:67], v[80:83], v[128:143]
v_exp_f32 v42, v42
v_exp_f32 v43, v43
v_exp_f32 v44, v44
v_mfma_f32_32x32x16_bf16 v[160:175], a[72:75], v[80:83], v[160:175]
v_exp_f32 v45, v45
v_exp_f32 v46, v46
v_mfma_f32_32x32x16_bf16 v[192:207], a[80:83], v[80:83], v[192:207]
v_exp_f32 v47, v47
v_add_f32 v22, v64, v65
v_add_f32 v22, v22, v66
v_add_f32 v22, v22, v67
v_add_f32 v22, v22, v32
v_mfma_f32_32x32x16_bf16 v[224:239], a[88:91], v[80:83], v[224:239]
v_add_f32 v22, v22, v33
v_cvt_pk_bf16_f32 v84, v40, v41
v_cvt_pk_bf16_f32 v85, v42, v43
v_cvt_pk_bf16_f32 v86, v44, v45
v_cvt_pk_bf16_f32 v87, v46, v47
s_nop 1
v_mfma_f32_32x32x16_bf16 v[128:143], a[68:71], v[84:87], v[128:143]
v_add_f32 v22, v22, v34
v_add_f32 v22, v22, v35
v_add_f32 v22, v22, v36
v_add_f32 v22, v22, v37
v_add_f32 v22, v22, v38
v_mfma_f32_32x32x16_bf16 v[160:175], a[76:79], v[84:87], v[160:175]
v_add_f32 v22, v22, v39
v_add_f32 v22, v22, v40
v_add_f32 v22, v22, v41
v_add_f32 v22, v22, v42
v_mfma_f32_32x32x16_bf16 v[192:207], a[84:87], v[84:87], v[192:207]
v_add_f32 v22, v22, v43
v_add_f32 v22, v22, v44
v_add_f32 v22, v22, v45
v_add_f32 v22, v22, v46
v_add_f32 v22, v22, v47
v_mfma_f32_32x32x16_bf16 v[224:239], a[92:95], v[84:87], v[224:239]
s_lshl_b32 s26, s43, 18
s_lshl_b32 s27, s42, 12
s_add_u32 s26, s26, s27
s_add_u32 s26, s26, 83886080
v_mov_b32 v26, v22
s_nop 1
v_permlane32_swap_b32 v26, v22
v_add_f32 v26, v26, v22
v_rcp_f32 v26, v26
s_nop 0
v_pk_mul_f32 v[128:129], v[128:129], v[26:27] op_sel_hi:[1,0]
v_pk_mul_f32 v[130:131], v[130:131], v[26:27] op_sel_hi:[1,0]
v_pk_mul_f32 v[132:133], v[132:133], v[26:27] op_sel_hi:[1,0]
v_pk_mul_f32 v[134:135], v[134:135], v[26:27] op_sel_hi:[1,0]
v_pk_mul_f32 v[136:137], v[136:137], v[26:27] op_sel_hi:[1,0]
v_pk_mul_f32 v[138:139], v[138:139], v[26:27] op_sel_hi:[1,0]
v_pk_mul_f32 v[140:141], v[140:141], v[26:27] op_sel_hi:[1,0]
v_pk_mul_f32 v[142:143], v[142:143], v[26:27] op_sel_hi:[1,0]
v_cvt_pk_bf16_f32 v128, v128, v129
v_cvt_pk_bf16_f32 v129, v130, v131
v_cvt_pk_bf16_f32 v130, v132, v133
v_cvt_pk_bf16_f32 v131, v134, v135
buffer_store_dwordx4 v[128:131], v6, s[8:11], s26 offen
v_cvt_pk_bf16_f32 v136, v136, v137
v_cvt_pk_bf16_f32 v137, v138, v139
v_cvt_pk_bf16_f32 v138, v140, v141
v_cvt_pk_bf16_f32 v139, v142, v143
buffer_store_dwordx4 v[136:139], v6, s[8:11], s26 offen offset:512
v_pk_mul_f32 v[160:161], v[160:161], v[26:27] op_sel_hi:[1,0]
v_pk_mul_f32 v[162:163], v[162:163], v[26:27] op_sel_hi:[1,0]
v_pk_mul_f32 v[164:165], v[164:165], v[26:27] op_sel_hi:[1,0]
v_pk_mul_f32 v[166:167], v[166:167], v[26:27] op_sel_hi:[1,0]
v_pk_mul_f32 v[168:169], v[168:169], v[26:27] op_sel_hi:[1,0]
v_pk_mul_f32 v[170:171], v[170:171], v[26:27] op_sel_hi:[1,0]
v_pk_mul_f32 v[172:173], v[172:173], v[26:27] op_sel_hi:[1,0]
v_pk_mul_f32 v[174:175], v[174:175], v[26:27] op_sel_hi:[1,0]
v_cvt_pk_bf16_f32 v160, v160, v161
v_cvt_pk_bf16_f32 v161, v162, v163
v_cvt_pk_bf16_f32 v162, v164, v165
v_cvt_pk_bf16_f32 v163, v166, v167
buffer_store_dwordx4 v[160:163], v6, s[8:11], s26 offen offset:1024
v_cvt_pk_bf16_f32 v168, v168, v169
v_cvt_pk_bf16_f32 v169, v170, v171
v_cvt_pk_bf16_f32 v170, v172, v173
v_cvt_pk_bf16_f32 v171, v174, v175
buffer_store_dwordx4 v[168:171], v6, s[8:11], s26 offen offset:1536
v_pk_mul_f32 v[192:193], v[192:193], v[26:27] op_sel_hi:[1,0]
v_pk_mul_f32 v[194:195], v[194:195], v[26:27] op_sel_hi:[1,0]
v_pk_mul_f32 v[196:197], v[196:197], v[26:27] op_sel_hi:[1,0]
v_pk_mul_f32 v[198:199], v[198:199], v[26:27] op_sel_hi:[1,0]
v_pk_mul_f32 v[200:201], v[200:201], v[26:27] op_sel_hi:[1,0]
v_pk_mul_f32 v[202:203], v[202:203], v[26:27] op_sel_hi:[1,0]
v_pk_mul_f32 v[204:205], v[204:205], v[26:27] op_sel_hi:[1,0]
v_pk_mul_f32 v[206:207], v[206:207], v[26:27] op_sel_hi:[1,0]
v_cvt_pk_bf16_f32 v192, v192, v193
v_cvt_pk_bf16_f32 v193, v194, v195
v_cvt_pk_bf16_f32 v194, v196, v197
v_cvt_pk_bf16_f32 v195, v198, v199
buffer_store_dwordx4 v[192:195], v6, s[8:11], s26 offen offset:2048
v_cvt_pk_bf16_f32 v200, v200, v201
v_cvt_pk_bf16_f32 v201, v202, v203
v_cvt_pk_bf16_f32 v202, v204, v205
v_cvt_pk_bf16_f32 v203, v206, v207
buffer_store_dwordx4 v[200:203], v6, s[8:11], s26 offen offset:2560
v_pk_mul_f32 v[224:225], v[224:225], v[26:27] op_sel_hi:[1,0]
v_pk_mul_f32 v[226:227], v[226:227], v[26:27] op_sel_hi:[1,0]
v_pk_mul_f32 v[228:229], v[228:229], v[26:27] op_sel_hi:[1,0]
v_pk_mul_f32 v[230:231], v[230:231], v[26:27] op_sel_hi:[1,0]
v_pk_mul_f32 v[232:233], v[232:233], v[26:27] op_sel_hi:[1,0]
v_pk_mul_f32 v[234:235], v[234:235], v[26:27] op_sel_hi:[1,0]
v_pk_mul_f32 v[236:237], v[236:237], v[26:27] op_sel_hi:[1,0]
v_pk_mul_f32 v[238:239], v[238:239], v[26:27] op_sel_hi:[1,0]
v_cvt_pk_bf16_f32 v224, v224, v225
v_cvt_pk_bf16_f32 v225, v226, v227
v_cvt_pk_bf16_f32 v226, v228, v229
v_cvt_pk_bf16_f32 v227, v230, v231
buffer_store_dwordx4 v[224:227], v6, s[8:11], s26 offen offset:3072
v_cvt_pk_bf16_f32 v232, v232, v233
v_cvt_pk_bf16_f32 v233, v234, v235
v_cvt_pk_bf16_f32 v234, v236, v237
v_cvt_pk_bf16_f32 v235, v238, v239
buffer_store_dwordx4 v[232:235], v6, s[8:11], s26 offen offset:3584
s_lshl_b32 s54, s47, 2
s_add_u32 s54, s54, 111157248
s_bitcmp1_b64 s[30:31], s43
s_cselect_b32 s60, s54, 536870912
s_cselect_b32 s54, 536870912, s54
s_mov_b32 s47, s48
s_cmp_lt_u32 s47, 2048
s_cbranch_scc0 L_bt_f
s_waitcnt vmcnt(8)
v_mfma_f32_32x32x16_bf16 v[32:47], a[128:131], a[96:99], 0
v_mfma_f32_32x32x16_bf16 v[32:47], a[132:135], a[100:103], v[32:47]
v_mfma_f32_32x32x16_bf16 v[32:47], a[136:139], a[104:107], v[32:47]
v_mfma_f32_32x32x16_bf16 v[32:47], a[140:143], a[108:111], v[32:47]
v_mfma_f32_32x32x16_bf16 v[32:47], a[144:147], a[112:115], v[32:47]
v_mfma_f32_32x32x16_bf16 v[32:47], a[148:151], a[116:119], v[32:47]
v_mfma_f32_32x32x16_bf16 v[32:47], a[152:155], a[120:123], v[32:47]
v_mfma_f32_32x32x16_bf16 v[32:47], a[156:159], a[124:127], v[32:47]
s_and_b32 s42, s47, 31
s_lshr_b32 s43, s47, 5
s_lshl_b32 s26, s47, 12
s_add_u32 s26, s26, 100663296
s_nop 7
v_cndmask_b32 v32, v31, v32, s[64:65]
v_cndmask_b32 v33, v31, v33, s[66:67]
v_cndmask_b32 v34, v31, v34, s[68:69]
v_cndmask_b32 v35, v31, v35, s[70:71]
v_cndmask_b32 v36, v31, v36, s[72:73]
v_cndmask_b32 v37, v31, v37, s[74:75]
v_cndmask_b32 v38, v31, v38, s[76:77]
v_cndmask_b32 v39, v31, v39, s[78:79]
v_cndmask_b32 v40, v31, v40, s[80:81]
v_cndmask_b32 v41, v31, v41, s[82:83]
v_cndmask_b32 v42, v31, v42, s[84:85]
v_cndmask_b32 v43, v31, v43, s[86:87]
v_cndmask_b32 v44, v31, v44, s[88:89]
v_cndmask_b32 v45, v31, v45, s[90:91]
v_cndmask_b32 v46, v31, v46, s[92:93]
v_cndmask_b32 v47, v31, v47, s[94:95]
v_max3_f32 v20, v32, v33, v34
v_max3_f32 v20, v20, v35, v36
v_max3_f32 v20, v20, v37, v38
v_max3_f32 v20, v20, v39, v40
v_max3_f32 v20, v20, v41, v42
v_max3_f32 v20, v20, v43, v44
v_max3_f32 v20, v20, v45, v46
v_max_f32 v20, v20, v47
s_cmp_lt_u32 s43, s49
s_cbranch_scc1 L_kn_40
v_mov_b32 v26, 1
s_waitcnt vmcnt(0)
s_mov_b64 exec, 1
buffer_store_dword v26, v4, s[8:11], s54 offen
s_mov_b64 exec, -1
L_nb_43:
s_ff1_i32_b64 s48, s[52:53]
s_cmp_lt_u32 s41, 32
s_cbranch_scc1 L_nb_44
s_bitset0_b64 s[52:53], s48
s_sub_u32 s41, s41, 32
s_add_u32 s62, s62, 1
s_branch L_nb_43
L_nb_44:
s_lshl_b32 s48, s48, 5
s_add_u32 s48, s48, s41
s_add_u32 s41, s41, 56
s_lshl_b32 s46, s48, 14
s_add_u32 s46, s46, 33554432
s_lshl_b32 s44, s48, 13
s_add_u32 s44, s44, 134217728
s_cmp_ge_u32 s48, 2048
s_cselect_b32 s44, 536870912, s44
s_cselect_b32 s46, 536870912, s46
s_cbranch_scc1 L_nb_42
s_lshr_b32 s25, s48, 8
s_lshl_b32 s25, s25, 2
s_cmp_eq_u32 s25, s45
s_cbranch_scc1 L_nb_42
s_mov_b32 s45, s25
s_mov_b32 s28, 0
L_poll_46:
buffer_load_dword v26, v17, s[8:11], s45 offen sc1
s_add_u32 s28, s28, 1
s_cmp_gt_u32 s28, 200000
s_cbranch_scc1 L_end
s_waitcnt vmcnt(0)
v_cmp_ne_u32 vcc, 1, v26
s_cbranch_vccz L_pd_47
s_sleep 8
s_cmp_lt_u32 s28, 32
s_cbranch_scc1 L_poll_46
s_sleep 32
s_branch L_poll_46
L_pd_47:
L_nb_42:
s_add_u32 s25, s44, 0
buffer_load_dwordx4 a[0:3], v1, s[8:11], s25 offen sc1
buffer_load_dwordx4 a[4:7], v1, s[8:11], s25 offen offset:1024 sc1
buffer_load_dwordx4 a[8:11], v1, s[8:11], s25 offen offset:2048 sc1
buffer_load_dwordx4 a[12:15], v1, s[8:11], s25 offen offset:3072 sc1
s_add_u32 s25, s44, 4096
buffer_load_dwordx4 a[16:19], v1, s[8:11], s25 offen sc1
buffer_load_dwordx4 a[20:23], v1, s[8:11], s25 offen offset:1024 sc1
buffer_load_dwordx4 a[24:27], v1, s[8:11], s25 offen offset:2048 sc1
buffer_load_dwordx4 a[28:31], v1, s[8:11], s25 offen offset:3072 sc1
s_add_u32 s25, s46, 0
buffer_load_dwordx4 a[32:35], v1, s[8:11], s25 offen sc1
buffer_load_dwordx4 a[36:39], v1, s[8:11], s25 offen offset:1024 sc1
buffer_load_dwordx4 a[40:43], v1, s[8:11], s25 offen offset:2048 sc1
buffer_load_dwordx4 a[44:47], v1, s[8:11], s25 offen offset:3072 sc1
s_add_u32 s25, s46, 4096
buffer_load_dwordx4 a[48:51], v1, s[8:11], s25 offen sc1
buffer_load_dwordx4 a[52:55], v1, s[8:11], s25 offen offset:1024 sc1
buffer_load_dwordx4 a[56:59], v1, s[8:11], s25 offen offset:2048 sc1
buffer_load_dwordx4 a[60:63], v1, s[8:11], s25 offen offset:3072 sc1
s_add_u32 s25, s46, 8192
buffer_load_dwordx4 a[64:67], v1, s[8:11], s25 offen sc1
buffer_load_dwordx4 a[68:71], v1, s[8:11], s25 offen offset:1024 sc1
buffer_load_dwordx4 a[72:75], v1, s[8:11], s25 offen offset:2048 sc1
buffer_load_dwordx4 a[76:79], v1, s[8:11], s25 offen offset:3072 sc1
s_add_u32 s25, s46, 12288
buffer_load_dwordx4 a[80:83], v1, s[8:11], s25 offen sc1
buffer_load_dwordx4 a[84:87], v1, s[8:11], s25 offen offset:1024 sc1
buffer_load_dwordx4 a[88:91], v1, s[8:11], s25 offen offset:2048 sc1
buffer_load_dwordx4 a[92:95], v1, s[8:11], s25 offen offset:3072 sc1
s_lshl_b32 s25, s42, 7
s_add_u32 s25, s25, 111153152
s_mov_b32 s28, 0
L_poll_48:
buffer_load_dword v26, v4, s[8:11], s25 offen sc1
s_add_u32 s28, s28, 1
s_cmp_gt_u32 s28, 200000
s_cbranch_scc1 L_end
s_waitcnt vmcnt(0)
v_cmp_ge_u32 vcc, s43, v26
s_cbranch_vccz L_pd_49
s_sleep 1
s_cmp_lt_u32 s28, 32
s_cbranch_scc1 L_poll_48
s_sleep 32
s_branch L_poll_48
L_pd_49:
buffer_load_dwordx4 v1, s[8:11], s26 offen sc1 lds
buffer_load_dwordx4 v1, s[8:11], s26 offen offset:1024 sc1 lds
buffer_load_dwordx4 v1, s[8:11], s26 offen offset:2048 sc1 lds
buffer_load_dwordx4 v1, s[8:11], s26 offen offset:3072 sc1 lds
v_readfirstlane_b32 s49, v26
s_nop 0
s_min_u32 s49, s49, 63
s_sub_u32 s49, s49, 1
s_waitcnt vmcnt(3)
ds_read_b32 v96, v2 offset:8
ds_read_b32 v97, v2 offset:24
ds_read_b32 v98, v2 offset:72
ds_read_b32 v99, v2 offset:88
ds_read_b32 v100, v2 offset:136
ds_read_b32 v101, v2 offset:152
ds_read_b32 v102, v2 offset:200
ds_read_b32 v103, v2 offset:216
s_waitcnt vmcnt(2)
ds_read_b32 v104, v2 offset:1032
ds_read_b32 v105, v2 offset:1048
ds_read_b32 v106, v2 offset:1096
ds_read_b32 v107, v2 offset:1112
s_waitcnt lgkmcnt(8)
v_mfma_f32_32x32x16_bf16 v[64:79], v[96:99], a[96:99], 0
ds_read_b32 v108, v2 offset:1160
ds_read_b32 v109, v2 offset:1176
ds_read_b32 v110, v2 offset:1224
ds_read_b32 v111, v2 offset:1240
s_waitcnt lgkmcnt(8)
v_mfma_f32_32x32x16_bf16 v[64:79], v[100:103], a[100:103], v[64:79]
s_waitcnt vmcnt(1)
ds_read_b32 v112, v2 offset:2056
ds_read_b32 v113, v2 offset:2072
ds_read_b32 v114, v2 offset:2120
ds_read_b32 v115, v2 offset:2136
s_waitcnt lgkmcnt(8)
v_mfma_f32_32x32x16_bf16 v[64:79], v[104:107], a[104:107], v[64:79]
ds_read_b32 v116, v2 offset:2184
ds_read_b32 v117, v2 offset:2200
ds_read_b32 v118, v2 offset:2248
ds_read_b32 v119, v2 offset:2264
s_waitcnt lgkmcnt(8)
v_mfma_f32_32x32x16_bf16 v[64:79], v[108:111], a[108:111], v[64:79]
s_waitcnt vmcnt(0)
ds_read_b32 v120, v2 offset:3080
ds_read_b32 v121, v2 offset:3096
ds_read_b32 v122, v2 offset:3144
ds_read_b32 v123, v2 offset:3160
s_waitcnt lgkmcnt(8)
v_mfma_f32_32x32x16_bf16 v[64:79], v[112:115], a[112:115], v[64:79]
ds_read_b32 v124, v2 offset:3208
ds_read_b32 v125, v2 offset:3224
ds_read_b32 v126, v2 offset:3272
ds_read_b32 v127, v2 offset:3288
s_waitcnt lgkmcnt(8)
v_mfma_f32_32x32x16_bf16 v[64:79], v[116:119], a[116:119], v[64:79]
ds_read_b32 v8, v3
ds_read_b32 v9, v3 offset:256
ds_read_b32 v10, v3 offset:1024
ds_read_b32 v11, v3 offset:1280
s_waitcnt lgkmcnt(8)
v_mfma_f32_32x32x16_bf16 v[64:79], v[120:123], a[120:123], v[64:79]
ds_read_b32 v12, v3 offset:2048
ds_read_b32 v13, v3 offset:2304
ds_read_b32 v14, v3 offset:3072
ds_read_b32 v15, v3 offset:3328
s_waitcnt lgkmcnt(8)
v_mfma_f32_32x32x16_bf16 v[64:79], v[124:127], a[124:127], v[64:79]
s_branch L_kj_41
L_kn_40:
buffer_load_dwordx4 v1, s[8:11], s26 offen sc1 lds
buffer_load_dwordx4 v1, s[8:11], s26 offen offset:1024 sc1 lds
buffer_load_dwordx4 v1, s[8:11], s26 offen offset:2048 sc1 lds
buffer_load_dwordx4 v1, s[8:11], s26 offen offset:3072 sc1 lds
v_mov_b32 v26, 1
s_waitcnt vmcnt(4)
s_mov_b64 exec, 1
buffer_store_dword v26, v4, s[8:11], s54 offen
s_mov_b64 exec, -1
L_nb_51:
s_ff1_i32_b64 s48, s[52:53]
s_cmp_lt_u32 s41, 32
s_cbranch_scc1 L_nb_52
s_bitset0_b64 s[52:53], s48
s_sub_u32 s41, s41, 32
s_add_u32 s62, s62, 1
s_branch L_nb_51
L_nb_52:
s_lshl_b32 s48, s48, 5
s_add_u32 s48, s48, s41
s_add_u32 s41, s41, 56
s_lshl_b32 s46, s48, 14
s_add_u32 s46, s46, 33554432
s_lshl_b32 s44, s48, 13
s_add_u32 s44, s44, 134217728
s_cmp_ge_u32 s48, 2048
s_cselect_b32 s44, 536870912, s44
s_cselect_b32 s46, 536870912, s46
s_cbranch_scc1 L_nb_50
s_lshr_b32 s25, s48, 8
s_lshl_b32 s25, s25, 2
s_cmp_eq_u32 s25, s45
s_cbranch_scc1 L_nb_50
s_mov_b32 s45, s25
s_mov_b32 s28, 0
L_poll_54:
buffer_load_dword v26, v17, s[8:11], s45 offen sc1
s_add_u32 s28, s28, 1
s_cmp_gt_u32 s28, 200000
s_cbranch_scc1 L_end
s_waitcnt vmcnt(0)
v_cmp_ne_u32 vcc, 1, v26
s_cbranch_vccz L_pd_55
s_sleep 8
s_cmp_lt_u32 s28, 32
s_cbranch_scc1 L_poll_54
s_sleep 32
s_branch L_poll_54
L_pd_55:
L_nb_50:
s_add_u32 s25, s44, 0
buffer_load_dwordx4 a[0:3], v1, s[8:11], s25 offen sc1
buffer_load_dwordx4 a[4:7], v1, s[8:11], s25 offen offset:1024 sc1
buffer_load_dwordx4 a[8:11], v1, s[8:11], s25 offen offset:2048 sc1
buffer_load_dwordx4 a[12:15], v1, s[8:11], s25 offen offset:3072 sc1
s_add_u32 s25, s44, 4096
buffer_load_dwordx4 a[16:19], v1, s[8:11], s25 offen sc1
buffer_load_dwordx4 a[20:23], v1, s[8:11], s25 offen offset:1024 sc1
buffer_load_dwordx4 a[24:27], v1, s[8:11], s25 offen offset:2048 sc1
buffer_load_dwordx4 a[28:31], v1, s[8:11], s25 offen offset:3072 sc1
s_waitcnt vmcnt(12)
ds_read_b32 v96, v2 offset:8
ds_read_b32 v97, v2 offset:24
ds_read_b32 v98, v2 offset:72
ds_read_b32 v99, v2 offset:88
ds_read_b32 v100, v2 offset:136
ds_read_b32 v101, v2 offset:152
ds_read_b32 v102, v2 offset:200
ds_read_b32 v103, v2 offset:216
s_waitcnt vmcnt(11)
ds_read_b32 v104, v2 offset:1032
ds_read_b32 v105, v2 offset:1048
ds_read_b32 v106, v2 offset:1096
ds_read_b32 v107, v2 offset:1112
s_waitcnt lgkmcnt(8)
v_mfma_f32_32x32x16_bf16 v[64:79], v[96:99], a[96:99], 0
s_add_u32 s25, s46, 0
buffer_load_dwordx4 a[32:35], v1, s[8:11], s25 offen sc1
buffer_load_dwordx4 a[36:39], v1, s[8:11], s25 offen offset:1024 sc1
ds_read_b32 v108, v2 offset:1160
ds_read_b32 v109, v2 offset:1176
ds_read_b32 v110, v2 offset:1224
ds_read_b32 v111, v2 offset:1240
s_waitcnt lgkmcnt(8)
v_mfma_f32_32x32x16_bf16 v[64:79], v[100:103], a[100:103], v[64:79]
buffer_load_dwordx4 a[40:43], v1, s[8:11], s25 offen offset:2048 sc1
buffer_load_dwordx4 a[44:47], v1, s[8:11], s25 offen offset:3072 sc1
s_waitcnt vmcnt(14)
ds_read_b32 v112, v2 offset:2056
ds_read_b32 v113, v2 offset:2072
ds_read_b32 v114, v2 offset:2120
ds_read_b32 v115, v2 offset:2136
s_waitcnt lgkmcnt(8)
v_mfma_f32_32x32x16_bf16 v[64:79], v[104:107], a[104:107], v[64:79]
s_add_u32 s25, s46, 4096
buffer_load_dwordx4 a[48:51], v1, s[8:11], s25 offen sc1
buffer_load_dwordx4 a[52:55], v1, s[8:11], s25 offen offset:1024 sc1
ds_read_b32 v116, v2 offset:2184
ds_read_b32 v117, v2 offset:2200
ds_read_b32 v118, v2 offset:2248
ds_read_b32 v119, v2 offset:2264
s_waitcnt lgkmcnt(8)
v_mfma_f32_32x32x16_bf16 v[64:79], v[108:111], a[108:111], v[64:79]
buffer_load_dwordx4 a[56:59], v1, s[8:11], s25 offen offset:2048 sc1
buffer_load_dwordx4 a[60:63], v1, s[8:11], s25 offen offset:3072 sc1
s_waitcnt vmcnt(17)
ds_read_b32 v120, v2 offset:3080
ds_read_b32 v121, v2 offset:3096
ds_read_b32 v122, v2 offset:3144
ds_read_b32 v123, v2 offset:3160
s_waitcnt lgkmcnt(8)
v_mfma_f32_32x32x16_bf16 v[64:79], v[112:115], a[112:115], v[64:79]
s_add_u32 s25, s46, 8192
buffer_load_dwordx4 a[64:67], v1, s[8:11], s25 offen sc1
buffer_load_dwordx4 a[68:71], v1, s[8:11], s25 offen offset:1024 sc1
ds_read_b32 v124, v2 offset:3208
ds_read_b32 v125, v2 offset:3224
ds_read_b32 v126, v2 offset:3272
ds_read_b32 v127, v2 offset:3288
s_waitcnt lgkmcnt(8)
v_mfma_f32_32x32x16_bf16 v[64:79], v[116:119], a[116:119], v[64:79]
buffer_load_dwordx4 a[72:75], v1, s[8:11], s25 offen offset:2048 sc1
buffer_load_dwordx4 a[76:79], v1, s[8:11], s25 offen offset:3072 sc1
ds_read_b32 v8, v3
ds_read_b32 v9, v3 offset:256
ds_read_b32 v10, v3 offset:1024
ds_read_b32 v11, v3 offset:1280
s_waitcnt lgkmcnt(8)
v_mfma_f32_32x32x16_bf16 v[64:79], v[120:123], a[120:123], v[64:79]
s_add_u32 s25, s46, 12288
buffer_load_dwordx4 a[80:83], v1, s[8:11], s25 offen sc1
buffer_load_dwordx4 a[84:87], v1, s[8:11], s25 offen offset:1024 sc1
ds_read_b32 v12, v3 offset:2048
ds_read_b32 v13, v3 offset:2304
ds_read_b32 v14, v3 offset:3072
ds_read_b32 v15, v3 offset:3328
s_waitcnt lgkmcnt(8)
v_mfma_f32_32x32x16_bf16 v[64:79], v[124:127], a[124:127], v[64:79]
buffer_load_dwordx4 a[88:91], v1, s[8:11], s25 offen offset:2048 sc1
buffer_load_dwordx4 a[92:95], v1, s[8:11], s25 offen offset:3072 sc1
L_kj_41:
s_nop 10
v_max3_f32 v20, v20, v64, v65
v_max3_f32 v20, v20, v66, v67
v_mov_b32 v26, v20
s_nop 1
v_permlane32_swap_b32 v26, v20
v_max_f32 v20, v20, v26
v_mul_f32 v20, s40, v20
v_pk_fma_f32 v[64:65], v[64:65], s[40:41], v[20:21] op_sel_hi:[1,0,0] neg_lo:[0,0,1] neg_hi:[0,0,1]
v_pk_fma_f32 v[66:67], v[66:67], s[40:41], v[20:21] op_sel_hi:[1,0,0] neg_lo:[0,0,1] neg_hi:[0,0,1]
v_pk_fma_f32 v[32:33], v[32:33], s[40:41], v[20:21] op_sel_hi:[1,0,0] neg_lo:[0,0,1] neg_hi:[0,0,1]
v_pk_fma_f32 v[34:35], v[34:35], s[40:41], v[20:21] op_sel_hi:[1,0,0] neg_lo:[0,0,1] neg_hi:[0,0,1]
v_pk_fma_f32 v[36:37], v[36:37], s[40:41], v[20:21] op_sel_hi:[1,0,0] neg_lo:[0,0,1] neg_hi:[0,0,1]
v_pk_fma_f32 v[38:39], v[38:39], s[40:41], v[20:21] op_sel_hi:[1,0,0] neg_lo:[0,0,1] neg_hi:[0,0,1]
v_pk_fma_f32 v[40:41], v[40:41], s[40:41], v[20:21] op_sel_hi:[1,0,0] neg_lo:[0,0,1] neg_hi:[0,0,1]
v_pk_fma_f32 v[42:43], v[42:43], s[40:41], v[20:21] op_sel_hi:[1,0,0] neg_lo:[0,0,1] neg_hi:[0,0,1]
v_pk_fma_f32 v[44:45], v[44:45], s[40:41], v[20:21] op_sel_hi:[1,0,0] neg_lo:[0,0,1] neg_hi:[0,0,1]
v_pk_fma_f32 v[46:47], v[46:47], s[40:41], v[20:21] op_sel_hi:[1,0,0] neg_lo:[0,0,1] neg_hi:[0,0,1]
v_exp_f32 v64, v64
v_exp_f32 v65, v65
v_exp_f32 v66, v66
v_exp_f32 v67, v67
v_exp_f32 v32, v32
v_exp_f32 v33, v33
v_cvt_pk_bf16_f32 v88, v64, v65
v_cvt_pk_bf16_f32 v89, v66, v67
s_waitcnt lgkmcnt(0)
s_nop 0
v_mfma_f32_32x32x8_bf16 v[128:143], v[8:9], v[88:89], 0
v_exp_f32 v34, v34
v_exp_f32 v35, v35
v_exp_f32 v36, v36
v_mfma_f32_32x32x8_bf16 v[160:175], v[10:11], v[88:89], 0
v_exp_f32 v37, v37
v_exp_f32 v38, v38
v_mfma_f32_32x32x8_bf16 v[192:207], v[12:13], v[88:89], 0
v_exp_f32 v39, v39
v_exp_f32 v40, v40
v_exp_f32 v41, v41
v_mfma_f32_32x32x8_bf16 v[224:239], v[14:15], v[88:89], 0
v_cvt_pk_bf16_f32 v80, v32, v33
v_cvt_pk_bf16_f32 v81, v34, v35
v_cvt_pk_bf16_f32 v82, v36, v37
v_cvt_pk_bf16_f32 v83, v38, v39
s_nop 1
v_mfma_f32_32x32x16_bf16 v[128:143], a[160:163], v[80:83], v[128:143]
v_exp_f32 v42, v42
v_exp_f32 v43, v43
v_exp_f32 v44, v44
v_mfma_f32_32x32x16_bf16 v[160:175], a[168:171], v[80:83], v[160:175]
v_exp_f32 v45, v45
v_exp_f32 v46, v46
v_mfma_f32_32x32x16_bf16 v[192:207], a[176:179], v[80:83], v[192:207]
v_exp_f32 v47, v47
v_add_f32 v22, v64, v65
v_add_f32 v22, v22, v66
v_add_f32 v22, v22, v67
v_add_f32 v22, v22, v32
v_mfma_f32_32x32x16_bf16 v[224:239], a[184:187], v[80:83], v[224:239]
v_add_f32 v22, v22, v33
v_cvt_pk_bf16_f32 v84, v40, v41
v_cvt_pk_bf16_f32 v85, v42, v43
v_cvt_pk_bf16_f32 v86, v44, v45
v_cvt_pk_bf16_f32 v87, v46, v47
s_nop 1
v_mfma_f32_32x32x16_bf16 v[128:143], a[164:167], v[84:87], v[128:143]
v_add_f32 v22, v22, v34
v_add_f32 v22, v22, v35
v_add_f32 v22, v22, v36
v_add_f32 v22, v22, v37
v_add_f32 v22, v22, v38
v_mfma_f32_32x32x16_bf16 v[160:175], a[172:175], v[84:87], v[160:175]
v_add_f32 v22, v22, v39
v_add_f32 v22, v22, v40
v_add_f32 v22, v22, v41
v_add_f32 v22, v22, v42
v_mfma_f32_32x32x16_bf16 v[192:207], a[180:183], v[84:87], v[192:207]
v_add_f32 v22, v22, v43
v_add_f32 v22, v22, v44
v_add_f32 v22, v22, v45
v_add_f32 v22, v22, v46
v_add_f32 v22, v22, v47
v_mfma_f32_32x32x16_bf16 v[224:239], a[188:191], v[84:87], v[224:239]
s_lshl_b32 s26, s43, 18
s_lshl_b32 s27, s42, 12
s_add_u32 s26, s26, s27
s_add_u32 s26, s26, 83886080
v_mov_b32 v26, v22
s_nop 1
v_permlane32_swap_b32 v26, v22
v_add_f32 v26, v26, v22
v_rcp_f32 v26, v26
s_nop 0
v_pk_mul_f32 v[128:129], v[128:129], v[26:27] op_sel_hi:[1,0]
v_pk_mul_f32 v[130:131], v[130:131], v[26:27] op_sel_hi:[1,0]
v_pk_mul_f32 v[132:133], v[132:133], v[26:27] op_sel_hi:[1,0]
v_pk_mul_f32 v[134:135], v[134:135], v[26:27] op_sel_hi:[1,0]
v_pk_mul_f32 v[136:137], v[136:137], v[26:27] op_sel_hi:[1,0]
v_pk_mul_f32 v[138:139], v[138:139], v[26:27] op_sel_hi:[1,0]
v_pk_mul_f32 v[140:141], v[140:141], v[26:27] op_sel_hi:[1,0]
v_pk_mul_f32 v[142:143], v[142:143], v[26:27] op_sel_hi:[1,0]
v_cvt_pk_bf16_f32 v128, v128, v129
v_cvt_pk_bf16_f32 v129, v130, v131
v_cvt_pk_bf16_f32 v130, v132, v133
v_cvt_pk_bf16_f32 v131, v134, v135
buffer_store_dwordx4 v[128:131], v6, s[8:11], s26 offen
v_cvt_pk_bf16_f32 v136, v136, v137
v_cvt_pk_bf16_f32 v137, v138, v139
v_cvt_pk_bf16_f32 v138, v140, v141
v_cvt_pk_bf16_f32 v139, v142, v143
buffer_store_dwordx4 v[136:139], v6, s[8:11], s26 offen offset:512
v_pk_mul_f32 v[160:161], v[160:161], v[26:27] op_sel_hi:[1,0]
v_pk_mul_f32 v[162:163], v[162:163], v[26:27] op_sel_hi:[1,0]
v_pk_mul_f32 v[164:165], v[164:165], v[26:27] op_sel_hi:[1,0]
v_pk_mul_f32 v[166:167], v[166:167], v[26:27] op_sel_hi:[1,0]
v_pk_mul_f32 v[168:169], v[168:169], v[26:27] op_sel_hi:[1,0]
v_pk_mul_f32 v[170:171], v[170:171], v[26:27] op_sel_hi:[1,0]
v_pk_mul_f32 v[172:173], v[172:173], v[26:27] op_sel_hi:[1,0]
v_pk_mul_f32 v[174:175], v[174:175], v[26:27] op_sel_hi:[1,0]
v_cvt_pk_bf16_f32 v160, v160, v161
v_cvt_pk_bf16_f32 v161, v162, v163
v_cvt_pk_bf16_f32 v162, v164, v165
v_cvt_pk_bf16_f32 v163, v166, v167
buffer_store_dwordx4 v[160:163], v6, s[8:11], s26 offen offset:1024
v_cvt_pk_bf16_f32 v168, v168, v169
v_cvt_pk_bf16_f32 v169, v170, v171
v_cvt_pk_bf16_f32 v170, v172, v173
v_cvt_pk_bf16_f32 v171, v174, v175
buffer_store_dwordx4 v[168:171], v6, s[8:11], s26 offen offset:1536
v_pk_mul_f32 v[192:193], v[192:193], v[26:27] op_sel_hi:[1,0]
v_pk_mul_f32 v[194:195], v[194:195], v[26:27] op_sel_hi:[1,0]
v_pk_mul_f32 v[196:197], v[196:197], v[26:27] op_sel_hi:[1,0]
v_pk_mul_f32 v[198:199], v[198:199], v[26:27] op_sel_hi:[1,0]
v_pk_mul_f32 v[200:201], v[200:201], v[26:27] op_sel_hi:[1,0]
v_pk_mul_f32 v[202:203], v[202:203], v[26:27] op_sel_hi:[1,0]
v_pk_mul_f32 v[204:205], v[204:205], v[26:27] op_sel_hi:[1,0]
v_pk_mul_f32 v[206:207], v[206:207], v[26:27] op_sel_hi:[1,0]
v_cvt_pk_bf16_f32 v192, v192, v193
v_cvt_pk_bf16_f32 v193, v194, v195
v_cvt_pk_bf16_f32 v194, v196, v197
v_cvt_pk_bf16_f32 v195, v198, v199
buffer_store_dwordx4 v[192:195], v6, s[8:11], s26 offen offset:2048
v_cvt_pk_bf16_f32 v200, v200, v201
v_cvt_pk_bf16_f32 v201, v202, v203
v_cvt_pk_bf16_f32 v202, v204, v205
v_cvt_pk_bf16_f32 v203, v206, v207
buffer_store_dwordx4 v[200:203], v6, s[8:11], s26 offen offset:2560
v_pk_mul_f32 v[224:225], v[224:225], v[26:27] op_sel_hi:[1,0]
v_pk_mul_f32 v[226:227], v[226:227], v[26:27] op_sel_hi:[1,0]
v_pk_mul_f32 v[228:229], v[228:229], v[26:27] op_sel_hi:[1,0]
v_pk_mul_f32 v[230:231], v[230:231], v[26:27] op_sel_hi:[1,0]
v_pk_mul_f32 v[232:233], v[232:233], v[26:27] op_sel_hi:[1,0]
v_pk_mul_f32 v[234:235], v[234:235], v[26:27] op_sel_hi:[1,0]
v_pk_mul_f32 v[236:237], v[236:237], v[26:27] op_sel_hi:[1,0]
v_pk_mul_f32 v[238:239], v[238:239], v[26:27] op_sel_hi:[1,0]
v_cvt_pk_bf16_f32 v224, v224, v225
v_cvt_pk_bf16_f32 v225, v226, v227
v_cvt_pk_bf16_f32 v226, v228, v229
v_cvt_pk_bf16_f32 v227, v230, v231
buffer_store_dwordx4 v[224:227], v6, s[8:11], s26 offen offset:3072
v_cvt_pk_bf16_f32 v232, v232, v233
v_cvt_pk_bf16_f32 v233, v234, v235
v_cvt_pk_bf16_f32 v234, v236, v237
v_cvt_pk_bf16_f32 v235, v238, v239
buffer_store_dwordx4 v[232:235], v6, s[8:11], s26 offen offset:3584
s_lshl_b32 s54, s47, 2
s_add_u32 s54, s54, 111157248
s_bitcmp1_b64 s[30:31], s43
s_cselect_b32 s60, s54, 536870912
s_cselect_b32 s54, 536870912, s54
s_mov_b32 s47, s48
s_cmp_lt_u32 s47, 2048
s_cbranch_scc1 L_bt
L_bt_f:
v_mov_b32 v26, 1
s_waitcnt vmcnt(0)
s_mov_b64 exec, 1
buffer_store_dword v26, v4, s[8:11], s54 offen
s_mov_b64 exec, -1
L_bt_x:
s_branch L_done
L_bo:
s_andn2_b32 s4, s4, 0x0
s_andn2_b32 s5, s5, 0x0
L_bo2:
s_mov_b64 s[42:43], s[4:5]
s_mov_b32 s51, s27
s_mov_b32 s40, s26
s_mov_b32 s44, 83886080
s_mov_b32 s45, 111157248
s_mov_b32 s46, 1
s_mov_b32 s47, 1152
s_lshl_b32 s54, s3, 7
s_add_u32 s54, s54, 111171584
s_lshl2_add_u32 s24, s16, s17
s_cmp_eq_u32 s24, 4
s_cselect_b32 s54, s54, 536870912
s_load_dwordx2 s[4:5], s[0:1], 88
s_waitcnt lgkmcnt(0)
s_mov_b32 s20, s4
s_and_b32 s21, s5, 0xffff
s_mov_b32 s22, 4718592
s_mov_b32 s23, 0x20000
L_op:
s_load_dwordx2 s[4:5], s[0:1], 104
s_waitcnt lgkmcnt(0)
s_mov_b32 s12, s4
s_and_b32 s13, s5, 0xffff
s_mov_b32 s14, 4718592
s_mov_b32 s15, 0x20000
v_and_b32 v1, 63, v0
v_lshlrev_b32 v1, 4, v1
v_bfe_u32 v12, v0, 3, 3
v_bfe_u32 v13, v0, 5, 1
v_lshl_add_u32 v13, v13, 3, v12
v_mul_u32_u24 v13, s47, v13
v_mul_u32_u24 v12, 1152, v12
v_add_u32 v12, v12, v13
s_mul_i32 s50, s47, 15
s_sub_u32 s50, 18432, s50
v_bfe_u32 v13, v0, 4, 2
v_lshlrev_b32 v13, 1, v13
v_and_b32 v14, 7, v0
v_xor_b32 v13, v13, v14
v_lshl_add_u32 v12, v13, 4, v12
s_mul_i32 s24, s17, 1179648
s_lshl_b32 s25, s40, 7
s_add_u32 s24, s24, s25
v_add_u32 v2, s24, v12
s_lshl_b32 s26, s17, 15
v_bfe_u32 v12, v0, 2, 3
v_lshlrev_b32 v12, 7, v12
v_bfe_u32 v13, v0, 5, 1
v_lshl_add_u32 v12, v13, 11, v12
v_bfe_u32 v13, v0, 3, 2
v_lshl_add_u32 v12, v13, 5, v12
v_and_b32 v13, 3, v0
v_lshl_add_u32 v12, v13, 3, v12
v_add_u32 v8, s26, v12
v_xor_b32 v9, 32, v8
v_xor_b32 v10, 64, v8
v_xor_b32 v11, 96, v8
s_add_u32 s24, s40, 0
s_and_b32 s24, s24, 7
s_lshl_b32 s30, s24, 12
s_add_u32 s24, s40, 1
s_and_b32 s24, s24, 7
s_lshl_b32 s31, s24, 12
s_add_u32 s24, s40, 2
s_and_b32 s24, s24, 7
s_lshl_b32 s32, s24, 12
s_add_u32 s24, s40, 3
s_and_b32 s24, s24, 7
s_lshl_b32 s33, s24, 12
s_add_u32 s24, s40, 4
s_and_b32 s24, s24, 7
s_lshl_b32 s34, s24, 12
s_add_u32 s24, s40, 5
s_and_b32 s24, s24, 7
s_lshl_b32 s35, s24, 12
s_add_u32 s24, s40, 6
s_and_b32 s24, s24, 7
s_lshl_b32 s36, s24, 12
s_add_u32 s24, s40, 7
s_and_b32 s24, s24, 7
s_lshl_b32 s37, s24, 12
s_mul_i32 s25, s30, 36
s_add_u32 m0, s26, 0
s_add_u32 s24, s25, 0
buffer_load_dwordx4 v2, s[20:23], s24 offen lds
s_add_u32 m0, s26, 1024
s_add_u32 s24, s25, 9216
buffer_load_dwordx4 v2, s[20:23], s24 offen lds
s_add_u32 s25, s25, s50
s_add_u32 m0, s26, 2048
s_add_u32 s24, s25, 0
buffer_load_dwordx4 v2, s[20:23], s24 offen lds
s_add_u32 m0, s26, 3072
s_add_u32 s24, s25, 9216
buffer_load_dwordx4 v2, s[20:23], s24 offen lds
s_mul_i32 s25, s30, 36
s_add_u32 m0, s26, 4096
s_add_u32 s24, s25, 36864
buffer_load_dwordx4 v2, s[20:23], s24 offen lds
s_add_u32 m0, s26, 5120
s_add_u32 s24, s25, 46080
buffer_load_dwordx4 v2, s[20:23], s24 offen lds
s_add_u32 s25, s25, s50
s_add_u32 m0, s26, 6144
s_add_u32 s24, s25, 36864
buffer_load_dwordx4 v2, s[20:23], s24 offen lds
s_add_u32 m0, s26, 7168
s_add_u32 s24, s25, 46080
buffer_load_dwordx4 v2, s[20:23], s24 offen lds
s_mul_i32 s25, s30, 36
s_add_u32 m0, s26, 8192
s_add_u32 s24, s25, 73728
buffer_load_dwordx4 v2, s[20:23], s24 offen lds
s_add_u32 m0, s26, 9216
s_add_u32 s24, s25, 82944
buffer_load_dwordx4 v2, s[20:23], s24 offen lds
s_add_u32 s25, s25, s50
s_add_u32 m0, s26, 10240
s_add_u32 s24, s25, 73728
buffer_load_dwordx4 v2, s[20:23], s24 offen lds
s_add_u32 m0, s26, 11264
s_add_u32 s24, s25, 82944
buffer_load_dwordx4 v2, s[20:23], s24 offen lds
s_mul_i32 s25, s31, 36
s_add_u32 m0, s26, 12288
s_add_u32 s24, s25, 0
buffer_load_dwordx4 v2, s[20:23], s24 offen lds
s_add_u32 m0, s26, 13312
s_add_u32 s24, s25, 9216
buffer_load_dwordx4 v2, s[20:23], s24 offen lds
s_add_u32 s25, s25, s50
s_add_u32 m0, s26, 14336
s_add_u32 s24, s25, 0
buffer_load_dwordx4 v2, s[20:23], s24 offen lds
s_add_u32 m0, s26, 15360
s_add_u32 s24, s25, 9216
buffer_load_dwordx4 v2, s[20:23], s24 offen lds
s_mul_i32 s25, s31, 36
s_add_u32 m0, s26, 16384
s_add_u32 s24, s25, 36864
buffer_load_dwordx4 v2, s[20:23], s24 offen lds
s_add_u32 m0, s26, 17408
s_add_u32 s24, s25, 46080
buffer_load_dwordx4 v2, s[20:23], s24 offen lds
s_add_u32 s25, s25, s50
s_add_u32 m0, s26, 18432
s_add_u32 s24, s25, 36864
buffer_load_dwordx4 v2, s[20:23], s24 offen lds
s_add_u32 m0, s26, 19456
s_add_u32 s24, s25, 46080
buffer_load_dwordx4 v2, s[20:23], s24 offen lds
s_mul_i32 s25, s31, 36
s_add_u32 m0, s26, 20480
s_add_u32 s24, s25, 73728
buffer_load_dwordx4 v2, s[20:23], s24 offen lds
s_add_u32 m0, s26, 21504
s_add_u32 s24, s25, 82944
buffer_load_dwordx4 v2, s[20:23], s24 offen lds
s_add_u32 s25, s25, s50
s_add_u32 m0, s26, 22528
s_add_u32 s24, s25, 73728
buffer_load_dwordx4 v2, s[20:23], s24 offen lds
s_add_u32 m0, s26, 23552
s_add_u32 s24, s25, 82944
buffer_load_dwordx4 v2, s[20:23], s24 offen lds
s_mul_i32 s25, s32, 36
s_add_u32 m0, s26, 24576
s_add_u32 s24, s25, 0
buffer_load_dwordx4 v2, s[20:23], s24 offen lds
s_add_u32 m0, s26, 25600
s_add_u32 s24, s25, 9216
buffer_load_dwordx4 v2, s[20:23], s24 offen lds
s_add_u32 s25, s25, s50
s_add_u32 m0, s26, 26624
s_add_u32 s24, s25, 0
buffer_load_dwordx4 v2, s[20:23], s24 offen lds
s_add_u32 m0, s26, 27648
s_add_u32 s24, s25, 9216
buffer_load_dwordx4 v2, s[20:23], s24 offen lds
s_mul_i32 s25, s32, 36
s_add_u32 m0, s26, 28672
s_add_u32 s24, s25, 36864
buffer_load_dwordx4 v2, s[20:23], s24 offen lds
s_add_u32 m0, s26, 29696
s_add_u32 s24, s25, 46080
buffer_load_dwordx4 v2, s[20:23], s24 offen lds
s_add_u32 s25, s25, s50
s_add_u32 m0, s26, 30720
s_add_u32 s24, s25, 36864
buffer_load_dwordx4 v2, s[20:23], s24 offen lds
s_add_u32 m0, s26, 31744
s_add_u32 s24, s25, 46080
buffer_load_dwordx4 v2, s[20:23], s24 offen lds
s_waitcnt vmcnt(28)
ds_read_b64_tr_b16 v[128:129], v8
ds_read_b64_tr_b16 v[130:131], v8 offset:1024
ds_read_b64_tr_b16 v[132:133], v9
ds_read_b64_tr_b16 v[134:135], v9 offset:1024
ds_read_b64_tr_b16 v[136:137], v10
ds_read_b64_tr_b16 v[138:139], v10 offset:1024
ds_read_b64_tr_b16 v[140:141], v11
ds_read_b64_tr_b16 v[142:143], v11 offset:1024
s_waitcnt lgkmcnt(0)
s_mul_i32 s25, s32, 36
s_add_u32 m0, s26, 0
s_add_u32 s24, s25, 73728
buffer_load_dwordx4 v2, s[20:23], s24 offen lds
s_add_u32 m0, s26, 1024
s_add_u32 s24, s25, 82944
buffer_load_dwordx4 v2, s[20:23], s24 offen lds
s_add_u32 s25, s25, s50
s_add_u32 m0, s26, 2048
s_add_u32 s24, s25, 73728
buffer_load_dwordx4 v2, s[20:23], s24 offen lds
s_add_u32 m0, s26, 3072
s_add_u32 s24, s25, 82944
buffer_load_dwordx4 v2, s[20:23], s24 offen lds
s_waitcnt vmcnt(28)
ds_read_b64_tr_b16 v[144:145], v8 offset:4096
ds_read_b64_tr_b16 v[146:147], v8 offset:5120
ds_read_b64_tr_b16 v[148:149], v9 offset:4096
ds_read_b64_tr_b16 v[150:151], v9 offset:5120
ds_read_b64_tr_b16 v[152:153], v10 offset:4096
ds_read_b64_tr_b16 v[154:155], v10 offset:5120
ds_read_b64_tr_b16 v[156:157], v11 offset:4096
ds_read_b64_tr_b16 v[158:159], v11 offset:5120
s_waitcnt lgkmcnt(0)
s_mul_i32 s25, s33, 36
s_add_u32 m0, s26, 4096
s_add_u32 s24, s25, 0
buffer_load_dwordx4 v2, s[20:23], s24 offen lds
s_add_u32 m0, s26, 5120
s_add_u32 s24, s25, 9216
buffer_load_dwordx4 v2, s[20:23], s24 offen lds
s_add_u32 s25, s25, s50
s_add_u32 m0, s26, 6144
s_add_u32 s24, s25, 0
buffer_load_dwordx4 v2, s[20:23], s24 offen lds
s_add_u32 m0, s26, 7168
s_add_u32 s24, s25, 9216
buffer_load_dwordx4 v2, s[20:23], s24 offen lds
s_waitcnt vmcnt(28)
ds_read_b64_tr_b16 v[160:161], v8 offset:8192
ds_read_b64_tr_b16 v[162:163], v8 offset:9216
ds_read_b64_tr_b16 v[164:165], v9 offset:8192
ds_read_b64_tr_b16 v[166:167], v9 offset:9216
ds_read_b64_tr_b16 v[168:169], v10 offset:8192
ds_read_b64_tr_b16 v[170:171], v10 offset:9216
ds_read_b64_tr_b16 v[172:173], v11 offset:8192
ds_read_b64_tr_b16 v[174:175], v11 offset:9216
s_waitcnt lgkmcnt(0)
s_mul_i32 s25, s33, 36
s_add_u32 m0, s26, 8192
s_add_u32 s24, s25, 36864
buffer_load_dwordx4 v2, s[20:23], s24 offen lds
s_add_u32 m0, s26, 9216
s_add_u32 s24, s25, 46080
buffer_load_dwordx4 v2, s[20:23], s24 offen lds
s_add_u32 s25, s25, s50
s_add_u32 m0, s26, 10240
s_add_u32 s24, s25, 36864
buffer_load_dwordx4 v2, s[20:23], s24 offen lds
s_add_u32 m0, s26, 11264
s_add_u32 s24, s25, 46080
buffer_load_dwordx4 v2, s[20:23], s24 offen lds
s_waitcnt vmcnt(28)
ds_read_b64_tr_b16 v[176:177], v8 offset:12288
ds_read_b64_tr_b16 v[178:179], v8 offset:13312
ds_read_b64_tr_b16 v[180:181], v9 offset:12288
ds_read_b64_tr_b16 v[182:183], v9 offset:13312
ds_read_b64_tr_b16 v[184:185], v10 offset:12288
ds_read_b64_tr_b16 v[186:187], v10 offset:13312
ds_read_b64_tr_b16 v[188:189], v11 offset:12288
ds_read_b64_tr_b16 v[190:191], v11 offset:13312
s_waitcnt lgkmcnt(0)
s_mul_i32 s25, s33, 36
s_add_u32 m0, s26, 12288
s_add_u32 s24, s25, 73728
buffer_load_dwordx4 v2, s[20:23], s24 offen lds
s_add_u32 m0, s26, 13312
s_add_u32 s24, s25, 82944
buffer_load_dwordx4 v2, s[20:23], s24 offen lds
s_add_u32 s25, s25, s50
s_add_u32 m0, s26, 14336
s_add_u32 s24, s25, 73728
buffer_load_dwordx4 v2, s[20:23], s24 offen lds
s_add_u32 m0, s26, 15360
s_add_u32 s24, s25, 82944
buffer_load_dwordx4 v2, s[20:23], s24 offen lds
s_waitcnt vmcnt(28)
ds_read_b64_tr_b16 v[192:193], v8 offset:16384
ds_read_b64_tr_b16 v[194:195], v8 offset:17408
ds_read_b64_tr_b16 v[196:197], v9 offset:16384
ds_read_b64_tr_b16 v[198:199], v9 offset:17408
ds_read_b64_tr_b16 v[200:201], v10 offset:16384
ds_read_b64_tr_b16 v[202:203], v10 offset:17408
ds_read_b64_tr_b16 v[204:205], v11 offset:16384
ds_read_b64_tr_b16 v[206:207], v11 offset:17408
s_waitcnt lgkmcnt(0)
s_mul_i32 s25, s34, 36
s_add_u32 m0, s26, 16384
s_add_u32 s24, s25, 0
buffer_load_dwordx4 v2, s[20:23], s24 offen lds
s_add_u32 m0, s26, 17408
s_add_u32 s24, s25, 9216
buffer_load_dwordx4 v2, s[20:23], s24 offen lds
s_add_u32 s25, s25, s50
s_add_u32 m0, s26, 18432
s_add_u32 s24, s25, 0
buffer_load_dwordx4 v2, s[20:23], s24 offen lds
s_add_u32 m0, s26, 19456
s_add_u32 s24, s25, 9216
buffer_load_dwordx4 v2, s[20:23], s24 offen lds
s_waitcnt vmcnt(28)
ds_read_b64_tr_b16 v[208:209], v8 offset:20480
ds_read_b64_tr_b16 v[210:211], v8 offset:21504
ds_read_b64_tr_b16 v[212:213], v9 offset:20480
ds_read_b64_tr_b16 v[214:215], v9 offset:21504
ds_read_b64_tr_b16 v[216:217], v10 offset:20480
ds_read_b64_tr_b16 v[218:219], v10 offset:21504
ds_read_b64_tr_b16 v[220:221], v11 offset:20480
ds_read_b64_tr_b16 v[222:223], v11 offset:21504
s_waitcnt lgkmcnt(0)
s_mul_i32 s25, s34, 36
s_add_u32 m0, s26, 20480
s_add_u32 s24, s25, 36864
buffer_load_dwordx4 v2, s[20:23], s24 offen lds
s_add_u32 m0, s26, 21504
s_add_u32 s24, s25, 46080
buffer_load_dwordx4 v2, s[20:23], s24 offen lds
s_add_u32 s25, s25, s50
s_add_u32 m0, s26, 22528
s_add_u32 s24, s25, 36864
buffer_load_dwordx4 v2, s[20:23], s24 offen lds
s_add_u32 m0, s26, 23552
s_add_u32 s24, s25, 46080
buffer_load_dwordx4 v2, s[20:23], s24 offen lds
s_waitcnt vmcnt(28)
ds_read_b64_tr_b16 v[224:225], v8 offset:24576
ds_read_b64_tr_b16 v[226:227], v8 offset:25600
ds_read_b64_tr_b16 v[228:229], v9 offset:24576
ds_read_b64_tr_b16 v[230:231], v9 offset:25600
ds_read_b64_tr_b16 v[232:233], v10 offset:24576
ds_read_b64_tr_b16 v[234:235], v10 offset:25600
ds_read_b64_tr_b16 v[236:237], v11 offset:24576
ds_read_b64_tr_b16 v[238:239], v11 offset:25600
s_waitcnt lgkmcnt(0)
s_mul_i32 s25, s34, 36
s_add_u32 m0, s26, 24576
s_add_u32 s24, s25, 73728
buffer_load_dwordx4 v2, s[20:23], s24 offen lds
s_add_u32 m0, s26, 25600
s_add_u32 s24, s25, 82944
buffer_load_dwordx4 v2, s[20:23], s24 offen lds
s_add_u32 s25, s25, s50
s_add_u32 m0, s26, 26624
s_add_u32 s24, s25, 73728
buffer_load_dwordx4 v2, s[20:23], s24 offen lds
s_add_u32 m0, s26, 27648
s_add_u32 s24, s25, 82944
buffer_load_dwordx4 v2, s[20:23], s24 offen lds
s_waitcnt vmcnt(28)
ds_read_b64_tr_b16 v[240:241], v8 offset:28672
ds_read_b64_tr_b16 v[242:243], v8 offset:29696
ds_read_b64_tr_b16 v[244:245], v9 offset:28672
ds_read_b64_tr_b16 v[246:247], v9 offset:29696
ds_read_b64_tr_b16 v[248:249], v10 offset:28672
ds_read_b64_tr_b16 v[250:251], v10 offset:29696
ds_read_b64_tr_b16 v[252:253], v11 offset:28672
ds_read_b64_tr_b16 v[254:255], v11 offset:29696
s_waitcnt lgkmcnt(0)
s_mul_i32 s25, s35, 36
s_add_u32 m0, s26, 28672
s_add_u32 s24, s25, 0
buffer_load_dwordx4 v2, s[20:23], s24 offen lds
s_add_u32 m0, s26, 29696
s_add_u32 s24, s25, 9216
buffer_load_dwordx4 v2, s[20:23], s24 offen lds
s_add_u32 s25, s25, s50
s_add_u32 m0, s26, 30720
s_add_u32 s24, s25, 0
buffer_load_dwordx4 v2, s[20:23], s24 offen lds
s_add_u32 m0, s26, 31744
s_add_u32 s24, s25, 9216
buffer_load_dwordx4 v2, s[20:23], s24 offen lds
s_waitcnt vmcnt(28)
ds_read_b64_tr_b16 a[0:1], v8
ds_read_b64_tr_b16 a[2:3], v8 offset:1024
ds_read_b64_tr_b16 a[4:5], v9
ds_read_b64_tr_b16 a[6:7], v9 offset:1024
ds_read_b64_tr_b16 a[8:9], v10
ds_read_b64_tr_b16 a[10:11], v10 offset:1024
ds_read_b64_tr_b16 a[12:13], v11
ds_read_b64_tr_b16 a[14:15], v11 offset:1024
s_waitcnt lgkmcnt(0)
s_mul_i32 s25, s35, 36
s_add_u32 m0, s26, 0
s_add_u32 s24, s25, 36864
buffer_load_dwordx4 v2, s[20:23], s24 offen lds
s_add_u32 m0, s26, 1024
s_add_u32 s24, s25, 46080
buffer_load_dwordx4 v2, s[20:23], s24 offen lds
s_add_u32 s25, s25, s50
s_add_u32 m0, s26, 2048
s_add_u32 s24, s25, 36864
buffer_load_dwordx4 v2, s[20:23], s24 offen lds
s_add_u32 m0, s26, 3072
s_add_u32 s24, s25, 46080
buffer_load_dwordx4 v2, s[20:23], s24 offen lds
s_waitcnt vmcnt(28)
ds_read_b64_tr_b16 a[16:17], v8 offset:4096
ds_read_b64_tr_b16 a[18:19], v8 offset:5120
ds_read_b64_tr_b16 a[20:21], v9 offset:4096
ds_read_b64_tr_b16 a[22:23], v9 offset:5120
ds_read_b64_tr_b16 a[24:25], v10 offset:4096
ds_read_b64_tr_b16 a[26:27], v10 offset:5120
ds_read_b64_tr_b16 a[28:29], v11 offset:4096
ds_read_b64_tr_b16 a[30:31], v11 offset:5120
s_waitcnt lgkmcnt(0)
s_mul_i32 s25, s35, 36
s_add_u32 m0, s26, 4096
s_add_u32 s24, s25, 73728
buffer_load_dwordx4 v2, s[20:23], s24 offen lds
s_add_u32 m0, s26, 5120
s_add_u32 s24, s25, 82944
buffer_load_dwordx4 v2, s[20:23], s24 offen lds
s_add_u32 s25, s25, s50
s_add_u32 m0, s26, 6144
s_add_u32 s24, s25, 73728
buffer_load_dwordx4 v2, s[20:23], s24 offen lds
s_add_u32 m0, s26, 7168
s_add_u32 s24, s25, 82944
buffer_load_dwordx4 v2, s[20:23], s24 offen lds
s_waitcnt vmcnt(28)
ds_read_b64_tr_b16 a[32:33], v8 offset:8192
ds_read_b64_tr_b16 a[34:35], v8 offset:9216
ds_read_b64_tr_b16 a[36:37], v9 offset:8192
ds_read_b64_tr_b16 a[38:39], v9 offset:9216
ds_read_b64_tr_b16 a[40:41], v10 offset:8192
ds_read_b64_tr_b16 a[42:43], v10 offset:9216
ds_read_b64_tr_b16 a[44:45], v11 offset:8192
ds_read_b64_tr_b16 a[46:47], v11 offset:9216
s_waitcnt lgkmcnt(0)
s_mul_i32 s25, s36, 36
s_add_u32 m0, s26, 8192
s_add_u32 s24, s25, 0
buffer_load_dwordx4 v2, s[20:23], s24 offen lds
s_add_u32 m0, s26, 9216
s_add_u32 s24, s25, 9216
buffer_load_dwordx4 v2, s[20:23], s24 offen lds
s_add_u32 s25, s25, s50
s_add_u32 m0, s26, 10240
s_add_u32 s24, s25, 0
buffer_load_dwordx4 v2, s[20:23], s24 offen lds
s_add_u32 m0, s26, 11264
s_add_u32 s24, s25, 9216
buffer_load_dwordx4 v2, s[20:23], s24 offen lds
s_waitcnt vmcnt(28)
ds_read_b64_tr_b16 a[48:49], v8 offset:12288
ds_read_b64_tr_b16 a[50:51], v8 offset:13312
ds_read_b64_tr_b16 a[52:53], v9 offset:12288
ds_read_b64_tr_b16 a[54:55], v9 offset:13312
ds_read_b64_tr_b16 a[56:57], v10 offset:12288
ds_read_b64_tr_b16 a[58:59], v10 offset:13312
ds_read_b64_tr_b16 a[60:61], v11 offset:12288
ds_read_b64_tr_b16 a[62:63], v11 offset:13312
s_waitcnt lgkmcnt(0)
s_mul_i32 s25, s36, 36
s_add_u32 m0, s26, 12288
s_add_u32 s24, s25, 36864
buffer_load_dwordx4 v2, s[20:23], s24 offen lds
s_add_u32 m0, s26, 13312
s_add_u32 s24, s25, 46080
buffer_load_dwordx4 v2, s[20:23], s24 offen lds
s_add_u32 s25, s25, s50
s_add_u32 m0, s26, 14336
s_add_u32 s24, s25, 36864
buffer_load_dwordx4 v2, s[20:23], s24 offen lds
s_add_u32 m0, s26, 15360
s_add_u32 s24, s25, 46080
buffer_load_dwordx4 v2, s[20:23], s24 offen lds
s_waitcnt vmcnt(28)
ds_read_b64_tr_b16 a[64:65], v8 offset:16384
ds_read_b64_tr_b16 a[66:67], v8 offset:17408
ds_read_b64_tr_b16 a[68:69], v9 offset:16384
ds_read_b64_tr_b16 a[70:71], v9 offset:17408
ds_read_b64_tr_b16 a[72:73], v10 offset:16384
ds_read_b64_tr_b16 a[74:75], v10 offset:17408
ds_read_b64_tr_b16 a[76:77], v11 offset:16384
ds_read_b64_tr_b16 a[78:79], v11 offset:17408
s_waitcnt lgkmcnt(0)
s_mul_i32 s25, s36, 36
s_add_u32 m0, s26, 16384
s_add_u32 s24, s25, 73728
buffer_load_dwordx4 v2, s[20:23], s24 offen lds
s_add_u32 m0, s26, 17408
s_add_u32 s24, s25, 82944
buffer_load_dwordx4 v2, s[20:23], s24 offen lds
s_add_u32 s25, s25, s50
s_add_u32 m0, s26, 18432
s_add_u32 s24, s25, 73728
buffer_load_dwordx4 v2, s[20:23], s24 offen lds
s_add_u32 m0, s26, 19456
s_add_u32 s24, s25, 82944
buffer_load_dwordx4 v2, s[20:23], s24 offen lds
s_waitcnt vmcnt(28)
ds_read_b64_tr_b16 a[80:81], v8 offset:20480
ds_read_b64_tr_b16 a[82:83], v8 offset:21504
ds_read_b64_tr_b16 a[84:85], v9 offset:20480
ds_read_b64_tr_b16 a[86:87], v9 offset:21504
ds_read_b64_tr_b16 a[88:89], v10 offset:20480
ds_read_b64_tr_b16 a[90:91], v10 offset:21504
ds_read_b64_tr_b16 a[92:93], v11 offset:20480
ds_read_b64_tr_b16 a[94:95], v11 offset:21504
s_waitcnt lgkmcnt(0)
s_mul_i32 s25, s37, 36
s_add_u32 m0, s26, 20480
s_add_u32 s24, s25, 0
buffer_load_dwordx4 v2, s[20:23], s24 offen lds
s_add_u32 m0, s26, 21504
s_add_u32 s24, s25, 9216
buffer_load_dwordx4 v2, s[20:23], s24 offen lds
s_add_u32 s25, s25, s50
s_add_u32 m0, s26, 22528
s_add_u32 s24, s25, 0
buffer_load_dwordx4 v2, s[20:23], s24 offen lds
s_add_u32 m0, s26, 23552
s_add_u32 s24, s25, 9216
buffer_load_dwordx4 v2, s[20:23], s24 offen lds
s_waitcnt vmcnt(28)
ds_read_b64_tr_b16 a[96:97], v8 offset:24576
ds_read_b64_tr_b16 a[98:99], v8 offset:25600
ds_read_b64_tr_b16 a[100:101], v9 offset:24576
ds_read_b64_tr_b16 a[102:103], v9 offset:25600
ds_read_b64_tr_b16 a[104:105], v10 offset:24576
ds_read_b64_tr_b16 a[106:107], v10 offset:25600
ds_read_b64_tr_b16 a[108:109], v11 offset:24576
ds_read_b64_tr_b16 a[110:111], v11 offset:25600
s_waitcnt lgkmcnt(0)
s_mul_i32 s25, s37, 36
s_add_u32 m0, s26, 24576
s_add_u32 s24, s25, 36864
buffer_load_dwordx4 v2, s[20:23], s24 offen lds
s_add_u32 m0, s26, 25600
s_add_u32 s24, s25, 46080
buffer_load_dwordx4 v2, s[20:23], s24 offen lds
s_add_u32 s25, s25, s50
s_add_u32 m0, s26, 26624
s_add_u32 s24, s25, 36864
buffer_load_dwordx4 v2, s[20:23], s24 offen lds
s_add_u32 m0, s26, 27648
s_add_u32 s24, s25, 46080
buffer_load_dwordx4 v2, s[20:23], s24 offen lds
s_waitcnt vmcnt(28)
ds_read_b64_tr_b16 a[112:113], v8 offset:28672
ds_read_b64_tr_b16 a[114:115], v8 offset:29696
ds_read_b64_tr_b16 a[116:117], v9 offset:28672
ds_read_b64_tr_b16 a[118:119], v9 offset:29696
ds_read_b64_tr_b16 a[120:121], v10 offset:28672
ds_read_b64_tr_b16 a[122:123], v10 offset:29696
ds_read_b64_tr_b16 a[124:125], v11 offset:28672
ds_read_b64_tr_b16 a[126:127], v11 offset:29696
s_waitcnt lgkmcnt(0)
s_mul_i32 s25, s37, 36
s_add_u32 m0, s26, 28672
s_add_u32 s24, s25, 73728
buffer_load_dwordx4 v2, s[20:23], s24 offen lds
s_add_u32 m0, s26, 29696
s_add_u32 s24, s25, 82944
buffer_load_dwordx4 v2, s[20:23], s24 offen lds
s_add_u32 s25, s25, s50
s_add_u32 m0, s26, 30720
s_add_u32 s24, s25, 73728
buffer_load_dwordx4 v2, s[20:23], s24 offen lds
s_add_u32 m0, s26, 31744
s_add_u32 s24, s25, 82944
buffer_load_dwordx4 v2, s[20:23], s24 offen lds
s_waitcnt vmcnt(28)
ds_read_b64_tr_b16 a[128:129], v8
ds_read_b64_tr_b16 a[130:131], v8 offset:1024
ds_read_b64_tr_b16 a[132:133], v9
ds_read_b64_tr_b16 a[134:135], v9 offset:1024
ds_read_b64_tr_b16 a[136:137], v10
ds_read_b64_tr_b16 a[138:139], v10 offset:1024
ds_read_b64_tr_b16 a[140:141], v11
ds_read_b64_tr_b16 a[142:143], v11 offset:1024
s_waitcnt lgkmcnt(0)
s_mul_i32 s25, s30, 36
s_add_u32 m0, s26, 0
s_add_u32 s24, s25, 110592
buffer_load_dwordx4 v2, s[20:23], s24 offen lds
s_add_u32 m0, s26, 1024
s_add_u32 s24, s25, 119808
buffer_load_dwordx4 v2, s[20:23], s24 offen lds
s_add_u32 s25, s25, s50
s_add_u32 m0, s26, 2048
s_add_u32 s24, s25, 110592
buffer_load_dwordx4 v2, s[20:23], s24 offen lds
s_add_u32 m0, s26, 3072
s_add_u32 s24, s25, 119808
buffer_load_dwordx4 v2, s[20:23], s24 offen lds
s_waitcnt vmcnt(28)
ds_read_b64_tr_b16 a[144:145], v8 offset:4096
ds_read_b64_tr_b16 a[146:147], v8 offset:5120
ds_read_b64_tr_b16 a[148:149], v9 offset:4096
ds_read_b64_tr_b16 a[150:151], v9 offset:5120
ds_read_b64_tr_b16 a[152:153], v10 offset:4096
ds_read_b64_tr_b16 a[154:155], v10 offset:5120
ds_read_b64_tr_b16 a[156:157], v11 offset:4096
ds_read_b64_tr_b16 a[158:159], v11 offset:5120
s_waitcnt lgkmcnt(0)
s_mul_i32 s25, s31, 36
s_add_u32 m0, s26, 4096
s_add_u32 s24, s25, 110592
buffer_load_dwordx4 v2, s[20:23], s24 offen lds
s_add_u32 m0, s26, 5120
s_add_u32 s24, s25, 119808
buffer_load_dwordx4 v2, s[20:23], s24 offen lds
s_add_u32 s25, s25, s50
s_add_u32 m0, s26, 6144
s_add_u32 s24, s25, 110592
buffer_load_dwordx4 v2, s[20:23], s24 offen lds
s_add_u32 m0, s26, 7168
s_add_u32 s24, s25, 119808
buffer_load_dwordx4 v2, s[20:23], s24 offen lds
s_waitcnt vmcnt(28)
ds_read_b64_tr_b16 a[160:161], v8 offset:8192
ds_read_b64_tr_b16 a[162:163], v8 offset:9216
ds_read_b64_tr_b16 a[164:165], v9 offset:8192
ds_read_b64_tr_b16 a[166:167], v9 offset:9216
ds_read_b64_tr_b16 a[168:169], v10 offset:8192
ds_read_b64_tr_b16 a[170:171], v10 offset:9216
ds_read_b64_tr_b16 a[172:173], v11 offset:8192
ds_read_b64_tr_b16 a[174:175], v11 offset:9216
s_waitcnt lgkmcnt(0)
s_mul_i32 s25, s32, 36
s_add_u32 m0, s26, 8192
s_add_u32 s24, s25, 110592
buffer_load_dwordx4 v2, s[20:23], s24 offen lds
s_add_u32 m0, s26, 9216
s_add_u32 s24, s25, 119808
buffer_load_dwordx4 v2, s[20:23], s24 offen lds
s_add_u32 s25, s25, s50
s_add_u32 m0, s26, 10240
s_add_u32 s24, s25, 110592
buffer_load_dwordx4 v2, s[20:23], s24 offen lds
s_add_u32 m0, s26, 11264
s_add_u32 s24, s25, 119808
buffer_load_dwordx4 v2, s[20:23], s24 offen lds
s_waitcnt vmcnt(28)
ds_read_b64_tr_b16 a[176:177], v8 offset:12288
ds_read_b64_tr_b16 a[178:179], v8 offset:13312
ds_read_b64_tr_b16 a[180:181], v9 offset:12288
ds_read_b64_tr_b16 a[182:183], v9 offset:13312
ds_read_b64_tr_b16 a[184:185], v10 offset:12288
ds_read_b64_tr_b16 a[186:187], v10 offset:13312
ds_read_b64_tr_b16 a[188:189], v11 offset:12288
ds_read_b64_tr_b16 a[190:191], v11 offset:13312
s_waitcnt lgkmcnt(0)
s_mul_i32 s25, s33, 36
s_add_u32 m0, s26, 12288
s_add_u32 s24, s25, 110592
buffer_load_dwordx4 v2, s[20:23], s24 offen lds
s_add_u32 m0, s26, 13312
s_add_u32 s24, s25, 119808
buffer_load_dwordx4 v2, s[20:23], s24 offen lds
s_add_u32 s25, s25, s50
s_add_u32 m0, s26, 14336
s_add_u32 s24, s25, 110592
buffer_load_dwordx4 v2, s[20:23], s24 offen lds
s_add_u32 m0, s26, 15360
s_add_u32 s24, s25, 119808
buffer_load_dwordx4 v2, s[20:23], s24 offen lds
s_waitcnt vmcnt(28)
ds_read_b64_tr_b16 a[192:193], v8 offset:16384
ds_read_b64_tr_b16 a[194:195], v8 offset:17408
ds_read_b64_tr_b16 a[196:197], v9 offset:16384
ds_read_b64_tr_b16 a[198:199], v9 offset:17408
ds_read_b64_tr_b16 a[200:201], v10 offset:16384
ds_read_b64_tr_b16 a[202:203], v10 offset:17408
ds_read_b64_tr_b16 a[204:205], v11 offset:16384
ds_read_b64_tr_b16 a[206:207], v11 offset:17408
s_waitcnt lgkmcnt(0)
s_mul_i32 s25, s34, 36
s_add_u32 m0, s26, 16384
s_add_u32 s24, s25, 110592
buffer_load_dwordx4 v2, s[20:23], s24 offen lds
s_add_u32 m0, s26, 17408
s_add_u32 s24, s25, 119808
buffer_load_dwordx4 v2, s[20:23], s24 offen lds
s_add_u32 s25, s25, s50
s_add_u32 m0, s26, 18432
s_add_u32 s24, s25, 110592
buffer_load_dwordx4 v2, s[20:23], s24 offen lds
s_add_u32 m0, s26, 19456
s_add_u32 s24, s25, 119808
buffer_load_dwordx4 v2, s[20:23], s24 offen lds
s_waitcnt vmcnt(28)
ds_read_b64_tr_b16 a[208:209], v8 offset:20480
ds_read_b64_tr_b16 a[210:211], v8 offset:21504
ds_read_b64_tr_b16 a[212:213], v9 offset:20480
ds_read_b64_tr_b16 a[214:215], v9 offset:21504
ds_read_b64_tr_b16 a[216:217], v10 offset:20480
ds_read_b64_tr_b16 a[218:219], v10 offset:21504
ds_read_b64_tr_b16 a[220:221], v11 offset:20480
ds_read_b64_tr_b16 a[222:223], v11 offset:21504
s_waitcnt lgkmcnt(0)
s_mul_i32 s25, s35, 36
s_add_u32 m0, s26, 20480
s_add_u32 s24, s25, 110592
buffer_load_dwordx4 v2, s[20:23], s24 offen lds
s_add_u32 m0, s26, 21504
s_add_u32 s24, s25, 119808
buffer_load_dwordx4 v2, s[20:23], s24 offen lds
s_add_u32 s25, s25, s50
s_add_u32 m0, s26, 22528
s_add_u32 s24, s25, 110592
buffer_load_dwordx4 v2, s[20:23], s24 offen lds
s_add_u32 m0, s26, 23552
s_add_u32 s24, s25, 119808
buffer_load_dwordx4 v2, s[20:23], s24 offen lds
s_waitcnt vmcnt(28)
ds_read_b64_tr_b16 a[224:225], v8 offset:24576
ds_read_b64_tr_b16 a[226:227], v8 offset:25600
ds_read_b64_tr_b16 a[228:229], v9 offset:24576
ds_read_b64_tr_b16 a[230:231], v9 offset:25600
ds_read_b64_tr_b16 a[232:233], v10 offset:24576
ds_read_b64_tr_b16 a[234:235], v10 offset:25600
ds_read_b64_tr_b16 a[236:237], v11 offset:24576
ds_read_b64_tr_b16 a[238:239], v11 offset:25600
s_waitcnt lgkmcnt(0)
s_mul_i32 s25, s36, 36
s_add_u32 m0, s26, 24576
s_add_u32 s24, s25, 110592
buffer_load_dwordx4 v2, s[20:23], s24 offen lds
s_add_u32 m0, s26, 25600
s_add_u32 s24, s25, 119808
buffer_load_dwordx4 v2, s[20:23], s24 offen lds
s_add_u32 s25, s25, s50
s_add_u32 m0, s26, 26624
s_add_u32 s24, s25, 110592
buffer_load_dwordx4 v2, s[20:23], s24 offen lds
s_add_u32 m0, s26, 27648
s_add_u32 s24, s25, 119808
buffer_load_dwordx4 v2, s[20:23], s24 offen lds
s_waitcnt vmcnt(28)
ds_read_b64_tr_b16 a[240:241], v8 offset:28672
ds_read_b64_tr_b16 a[242:243], v8 offset:29696
ds_read_b64_tr_b16 a[244:245], v9 offset:28672
ds_read_b64_tr_b16 a[246:247], v9 offset:29696
ds_read_b64_tr_b16 a[248:249], v10 offset:28672
ds_read_b64_tr_b16 a[250:251], v10 offset:29696
ds_read_b64_tr_b16 a[252:253], v11 offset:28672
ds_read_b64_tr_b16 a[254:255], v11 offset:29696
s_waitcnt lgkmcnt(0)
s_mul_i32 s25, s37, 36
s_add_u32 m0, s26, 28672
s_add_u32 s24, s25, 110592
buffer_load_dwordx4 v2, s[20:23], s24 offen lds
s_add_u32 m0, s26, 29696
s_add_u32 s24, s25, 119808
buffer_load_dwordx4 v2, s[20:23], s24 offen lds
s_add_u32 s25, s25, s50
s_add_u32 m0, s26, 30720
s_add_u32 s24, s25, 110592
buffer_load_dwordx4 v2, s[20:23], s24 offen lds
s_add_u32 m0, s26, 31744
s_add_u32 s24, s25, 119808
buffer_load_dwordx4 v2, s[20:23], s24 offen lds
s_waitcnt vmcnt(0)
v_and_b32 v12, 15, v0
v_mul_u32_u24 v12, 2304, v12
v_lshrrev_b32 v13, 4, v0
v_lshl_add_u32 v12, v13, 3, v12
s_lshl_b32 s24, s40, 7
s_add_u32 s24, s24, s47
v_add_u32 v4, s24, v12
v_and_b32 v5, 7, v0
v_lshlrev_b32 v5, 2, v5
s_lshl_b32 s24, s17, 5
v_add_u32 v5, s24, v5
v_lshlrev_b32 v3, 4, v0
v_add_u32 v3, 131072, v3
s_lshl_b32 s24, s17, 12
s_add_u32 s24, s24, 131072
v_add_u32 v7, s24, v1
s_lshl_b32 s24, s17, 15
s_add_u32 s44, s44, s24
s_ff1_i32_b64 s41, s[42:43]
s_bitset0_b64 s[42:43], s41
s_lshl_b32 s41, s41, 1
s_xor_b32 s41, s41, s51
s_and_b32 s41, s41, 127
v_mov_b32 v14, 0
v_mov_b32 v15, 0
L_opl_w:
s_lshr_b32 s25, s41, s46
s_lshl_b32 s25, s25, 7
s_add_u32 s25, s25, s45
s_mov_b32 s28, 0
L_poll_56:
buffer_load_dword v6, v5, s[8:11], s25 offen sc1
s_add_u32 s28, s28, 1
s_cmp_gt_u32 s28, 200000
s_cbranch_scc1 L_end
s_waitcnt vmcnt(0)
v_cmp_ne_u32 vcc, 1, v6
s_cbranch_vccz L_pd_57
s_sleep 1
s_cmp_lt_u32 s28, 32
s_cbranch_scc1 L_poll_56
s_sleep 32
s_branch L_poll_56
L_pd_57:
s_lshl_b32 s48, s41, 17
s_add_u32 s48, s48, s44
s_add_u32 s24, s48, s30
buffer_load_dwordx4 v[16:19], v1, s[8:11], s24 offen sc1
buffer_load_dwordx4 v[20:23], v1, s[8:11], s24 offen offset:1024 sc1
buffer_load_dwordx4 v[24:27], v1, s[8:11], s24 offen offset:2048 sc1
buffer_load_dwordx4 v[28:31], v1, s[8:11], s24 offen offset:3072 sc1
s_add_u32 s24, s48, s31
buffer_load_dwordx4 v[32:35], v1, s[8:11], s24 offen sc1
buffer_load_dwordx4 v[36:39], v1, s[8:11], s24 offen offset:1024 sc1
buffer_load_dwordx4 v[40:43], v1, s[8:11], s24 offen offset:2048 sc1
buffer_load_dwordx4 v[44:47], v1, s[8:11], s24 offen offset:3072 sc1
s_add_u32 s24, s48, s32
buffer_load_dwordx4 v[48:51], v1, s[8:11], s24 offen sc1
buffer_load_dwordx4 v[52:55], v1, s[8:11], s24 offen offset:1024 sc1
buffer_load_dwordx4 v[56:59], v1, s[8:11], s24 offen offset:2048 sc1
buffer_load_dwordx4 v[60:63], v1, s[8:11], s24 offen offset:3072 sc1
s_add_u32 s24, s48, s33
buffer_load_dwordx4 v[64:67], v1, s[8:11], s24 offen sc1
buffer_load_dwordx4 v[68:71], v1, s[8:11], s24 offen offset:1024 sc1
buffer_load_dwordx4 v[72:75], v1, s[8:11], s24 offen offset:2048 sc1
buffer_load_dwordx4 v[76:79], v1, s[8:11], s24 offen offset:3072 sc1
s_waitcnt vmcnt(15)
v_mfma_f32_16x16x32_bf16 v[80:83], v[128:131], v[16:19], 0
s_cmp_lg_u64 s[42:43], 0
s_cselect_b32 s52, 1, 0
ds_read_b64_tr_b16 v[112:113], v8
v_mfma_f32_16x16x32_bf16 v[84:87], v[132:135], v[16:19], 0
s_ff1_i32_b64 s27, s[42:43]
ds_read_b64_tr_b16 v[114:115], v8 offset:1024
v_mfma_f32_16x16x32_bf16 v[88:91], v[136:139], v[16:19], 0
s_bitset0_b64 s[42:43], s27
s_add_u32 s24, s48, s34
ds_read_b64_tr_b16 v[116:117], v9
v_mfma_f32_16x16x32_bf16 v[92:95], v[140:143], v[16:19], 0
s_waitcnt vmcnt(14)
s_lshl_b32 s27, s27, 1
ds_read_b64_tr_b16 v[118:119], v9 offset:1024
buffer_load_dwordx4 v[16:19], v1, s[8:11], s24 offen sc1
v_mfma_f32_16x16x32_bf16 v[80:83], v[144:147], v[20:23], v[80:83]
s_xor_b32 s27, s27, s51
ds_read_b64_tr_b16 v[120:121], v10
v_mfma_f32_16x16x32_bf16 v[84:87], v[148:151], v[20:23], v[84:87]
s_and_b32 s27, s27, 127
ds_read_b64_tr_b16 v[122:123], v10 offset:1024
v_mfma_f32_16x16x32_bf16 v[88:91], v[152:155], v[20:23], v[88:91]
s_lshr_b32 s25, s27, s46
ds_read_b64_tr_b16 v[124:125], v11
v_mfma_f32_16x16x32_bf16 v[92:95], v[156:159], v[20:23], v[92:95]
s_waitcnt vmcnt(14)
s_lshl_b32 s25, s25, 7
ds_read_b64_tr_b16 v[126:127], v11 offset:1024
buffer_load_dwordx4 v[20:23], v1, s[8:11], s24 offen offset:1024 sc1
v_mfma_f32_16x16x32_bf16 v[80:83], v[160:163], v[24:27], v[80:83]
s_add_u32 s25, s25, s45
v_mfma_f32_16x16x32_bf16 v[84:87], v[164:167], v[24:27], v[84:87]
s_lshl_b32 s49, s27, 17
v_mfma_f32_16x16x32_bf16 v[88:91], v[168:171], v[24:27], v[88:91]
s_add_u32 s49, s49, s44
v_mfma_f32_16x16x32_bf16 v[92:95], v[172:175], v[24:27], v[92:95]
s_waitcnt vmcnt(14) lgkmcnt(0)
buffer_load_dwordx4 v[24:27], v1, s[8:11], s24 offen offset:2048 sc1
buffer_load_dword v6, v5, s[8:11], s25 offen sc1
v_mfma_f32_16x16x32_bf16 v[80:83], v[112:115], v[28:31], v[80:83]
v_mfma_f32_16x16x32_bf16 v[84:87], v[116:119], v[28:31], v[84:87]
v_mfma_f32_16x16x32_bf16 v[88:91], v[120:123], v[28:31], v[88:91]
v_mfma_f32_16x16x32_bf16 v[92:95], v[124:127], v[28:31], v[92:95]
s_waitcnt vmcnt(15)
buffer_load_dwordx4 v[28:31], v1, s[8:11], s24 offen offset:3072 sc1
v_mfma_f32_16x16x32_bf16 v[80:83], v[176:179], v[32:35], v[80:83]
ds_read_b64_tr_b16 v[112:113], v8 offset:4096
v_mfma_f32_16x16x32_bf16 v[84:87], v[180:183], v[32:35], v[84:87]
ds_read_b64_tr_b16 v[114:115], v8 offset:5120
v_mfma_f32_16x16x32_bf16 v[88:91], v[184:187], v[32:35], v[88:91]
s_add_u32 s24, s48, s35
ds_read_b64_tr_b16 v[116:117], v9 offset:4096
v_mfma_f32_16x16x32_bf16 v[92:95], v[188:191], v[32:35], v[92:95]
s_waitcnt vmcnt(15)
ds_read_b64_tr_b16 v[118:119], v9 offset:5120
buffer_load_dwordx4 v[32:35], v1, s[8:11], s24 offen sc1
v_mfma_f32_16x16x32_bf16 v[80:83], v[192:195], v[36:39], v[80:83]
ds_read_b64_tr_b16 v[120:121], v10 offset:4096
v_mfma_f32_16x16x32_bf16 v[84:87], v[196:199], v[36:39], v[84:87]
ds_read_b64_tr_b16 v[122:123], v10 offset:5120
v_mfma_f32_16x16x32_bf16 v[88:91], v[200:203], v[36:39], v[88:91]
ds_read_b64_tr_b16 v[124:125], v11 offset:4096
v_mfma_f32_16x16x32_bf16 v[92:95], v[204:207], v[36:39], v[92:95]
s_waitcnt vmcnt(15)
ds_read_b64_tr_b16 v[126:127], v11 offset:5120
buffer_load_dwordx4 v[36:39], v1, s[8:11], s24 offen offset:1024 sc1
v_mfma_f32_16x16x32_bf16 v[80:83], v[208:211], v[40:43], v[80:83]
v_mfma_f32_16x16x32_bf16 v[84:87], v[212:215], v[40:43], v[84:87]
v_mfma_f32_16x16x32_bf16 v[88:91], v[216:219], v[40:43], v[88:91]
v_mfma_f32_16x16x32_bf16 v[92:95], v[220:223], v[40:43], v[92:95]
s_waitcnt vmcnt(15) lgkmcnt(0)
buffer_load_dwordx4 v[40:43], v1, s[8:11], s24 offen offset:2048 sc1
v_mfma_f32_16x16x32_bf16 v[80:83], v[112:115], v[44:47], v[80:83]
v_mfma_f32_16x16x32_bf16 v[84:87], v[116:119], v[44:47], v[84:87]
v_mfma_f32_16x16x32_bf16 v[88:91], v[120:123], v[44:47], v[88:91]
v_mfma_f32_16x16x32_bf16 v[92:95], v[124:127], v[44:47], v[92:95]
s_waitcnt vmcnt(15)
buffer_load_dwordx4 v[44:47], v1, s[8:11], s24 offen offset:3072 sc1
v_mfma_f32_16x16x32_bf16 v[80:83], v[224:227], v[48:51], v[80:83]
ds_read_b64_tr_b16 v[112:113], v8 offset:8192
v_mfma_f32_16x16x32_bf16 v[84:87], v[228:231], v[48:51], v[84:87]
ds_read_b64_tr_b16 v[114:115], v8 offset:9216
v_mfma_f32_16x16x32_bf16 v[88:91], v[232:235], v[48:51], v[88:91]
s_add_u32 s24, s48, s36
ds_read_b64_tr_b16 v[116:117], v9 offset:8192
v_mfma_f32_16x16x32_bf16 v[92:95], v[236:239], v[48:51], v[92:95]
s_waitcnt vmcnt(15)
ds_read_b64_tr_b16 v[118:119], v9 offset:9216
buffer_load_dwordx4 v[48:51], v1, s[8:11], s24 offen sc1
v_mfma_f32_16x16x32_bf16 v[80:83], v[240:243], v[52:55], v[80:83]
ds_read_b64_tr_b16 v[120:121], v10 offset:8192
v_mfma_f32_16x16x32_bf16 v[84:87], v[244:247], v[52:55], v[84:87]
ds_read_b64_tr_b16 v[122:123], v10 offset:9216
v_mfma_f32_16x16x32_bf16 v[88:91], v[248:251], v[52:55], v[88:91]
ds_read_b64_tr_b16 v[124:125], v11 offset:8192
v_mfma_f32_16x16x32_bf16 v[92:95], v[252:255], v[52:55], v[92:95]
s_waitcnt vmcnt(15)
ds_read_b64_tr_b16 v[126:127], v11 offset:9216
buffer_load_dwordx4 v[52:55], v1, s[8:11], s24 offen offset:1024 sc1
v_mfma_f32_16x16x32_bf16 v[80:83], a[0:3], v[56:59], v[80:83]
v_mfma_f32_16x16x32_bf16 v[84:87], a[4:7], v[56:59], v[84:87]
v_mfma_f32_16x16x32_bf16 v[88:91], a[8:11], v[56:59], v[88:91]
v_mfma_f32_16x16x32_bf16 v[92:95], a[12:15], v[56:59], v[92:95]
s_waitcnt vmcnt(15) lgkmcnt(0)
buffer_load_dwordx4 v[56:59], v1, s[8:11], s24 offen offset:2048 sc1
v_mfma_f32_16x16x32_bf16 v[80:83], v[112:115], v[60:63], v[80:83]
v_mfma_f32_16x16x32_bf16 v[84:87], v[116:119], v[60:63], v[84:87]
v_mfma_f32_16x16x32_bf16 v[88:91], v[120:123], v[60:63], v[88:91]
v_mfma_f32_16x16x32_bf16 v[92:95], v[124:127], v[60:63], v[92:95]
s_waitcnt vmcnt(15)
buffer_load_dwordx4 v[60:63], v1, s[8:11], s24 offen offset:3072 sc1
v_mfma_f32_16x16x32_bf16 v[80:83], a[16:19], v[64:67], v[80:83]
ds_read_b64_tr_b16 v[112:113], v8 offset:12288
v_mfma_f32_16x16x32_bf16 v[84:87], a[20:23], v[64:67], v[84:87]
ds_read_b64_tr_b16 v[114:115], v8 offset:13312
v_mfma_f32_16x16x32_bf16 v[88:91], a[24:27], v[64:67], v[88:91]
s_add_u32 s24, s48, s37
ds_read_b64_tr_b16 v[116:117], v9 offset:12288
v_mfma_f32_16x16x32_bf16 v[92:95], a[28:31], v[64:67], v[92:95]
s_waitcnt vmcnt(15)
ds_read_b64_tr_b16 v[118:119], v9 offset:13312
buffer_load_dwordx4 v[64:67], v1, s[8:11], s24 offen sc1
v_mfma_f32_16x16x32_bf16 v[80:83], a[32:35], v[68:71], v[80:83]
ds_read_b64_tr_b16 v[120:121], v10 offset:12288
v_mfma_f32_16x16x32_bf16 v[84:87], a[36:39], v[68:71], v[84:87]
ds_read_b64_tr_b16 v[122:123], v10 offset:13312
v_mfma_f32_16x16x32_bf16 v[88:91], a[40:43], v[68:71], v[88:91]
ds_read_b64_tr_b16 v[124:125], v11 offset:12288
v_mfma_f32_16x16x32_bf16 v[92:95], a[44:47], v[68:71], v[92:95]
s_waitcnt vmcnt(15)
ds_read_b64_tr_b16 v[126:127], v11 offset:13312
buffer_load_dwordx4 v[68:71], v1, s[8:11], s24 offen offset:1024 sc1
buffer_load_dword v6, v5, s[8:11], s25 offen sc1
s_branch L_opl_t0
L_opl_r0:
v_mfma_f32_16x16x32_bf16 v[80:83], v[128:131], v[16:19], 0
s_cmp_lg_u64 s[42:43], 0
s_cselect_b32 s52, 1, 0
ds_read_b64_tr_b16 v[112:113], v8
v_mfma_f32_16x16x32_bf16 v[84:87], v[132:135], v[16:19], 0
s_ff1_i32_b64 s27, s[42:43]
ds_read_b64_tr_b16 v[114:115], v8 offset:1024
v_mfma_f32_16x16x32_bf16 v[88:91], v[136:139], v[16:19], 0
s_bitset0_b64 s[42:43], s27
s_add_u32 s24, s48, s34
ds_read_b64_tr_b16 v[116:117], v9
v_mfma_f32_16x16x32_bf16 v[92:95], v[140:143], v[16:19], 0
s_waitcnt vmcnt(14)
s_lshl_b32 s27, s27, 1
ds_read_b64_tr_b16 v[118:119], v9 offset:1024
buffer_load_dwordx4 v[16:19], v1, s[8:11], s24 offen sc1
v_mfma_f32_16x16x32_bf16 v[80:83], v[144:147], v[20:23], v[80:83]
s_xor_b32 s27, s27, s51
ds_read_b64_tr_b16 v[120:121], v10
v_mfma_f32_16x16x32_bf16 v[84:87], v[148:151], v[20:23], v[84:87]
s_and_b32 s27, s27, 127
ds_read_b64_tr_b16 v[122:123], v10 offset:1024
v_mfma_f32_16x16x32_bf16 v[88:91], v[152:155], v[20:23], v[88:91]
s_lshr_b32 s25, s27, s46
ds_read_b64_tr_b16 v[124:125], v11
v_mfma_f32_16x16x32_bf16 v[92:95], v[156:159], v[20:23], v[92:95]
s_waitcnt vmcnt(14)
s_lshl_b32 s25, s25, 7
ds_read_b64_tr_b16 v[126:127], v11 offset:1024
buffer_load_dwordx4 v[20:23], v1, s[8:11], s24 offen offset:1024 sc1
v_mfma_f32_16x16x32_bf16 v[80:83], v[160:163], v[24:27], v[80:83]
s_add_u32 s25, s25, s45
v_mfma_f32_16x16x32_bf16 v[84:87], v[164:167], v[24:27], v[84:87]
s_lshl_b32 s49, s27, 17
v_mfma_f32_16x16x32_bf16 v[88:91], v[168:171], v[24:27], v[88:91]
s_add_u32 s49, s49, s44
v_mfma_f32_16x16x32_bf16 v[92:95], v[172:175], v[24:27], v[92:95]
s_waitcnt vmcnt(14) lgkmcnt(0)
buffer_load_dwordx4 v[24:27], v1, s[8:11], s24 offen offset:2048 sc1
buffer_load_dword v6, v5, s[8:11], s25 offen sc1
v_mfma_f32_16x16x32_bf16 v[80:83], v[112:115], v[28:31], v[80:83]
ds_write_b128 v3, v[96:99]
v_mfma_f32_16x16x32_bf16 v[84:87], v[116:119], v[28:31], v[84:87]
ds_write_b128 v3, v[100:103] offset:4096
v_mfma_f32_16x16x32_bf16 v[88:91], v[120:123], v[28:31], v[88:91]
ds_write_b128 v3, v[104:107] offset:8192
v_mfma_f32_16x16x32_bf16 v[92:95], v[124:127], v[28:31], v[92:95]
s_waitcnt vmcnt(15)
ds_write_b128 v3, v[108:111] offset:12288
buffer_load_dwordx4 v[28:31], v1, s[8:11], s24 offen offset:3072 sc1
v_mfma_f32_16x16x32_bf16 v[80:83], v[176:179], v[32:35], v[80:83]
ds_read_b64_tr_b16 v[112:113], v8 offset:4096
v_mfma_f32_16x16x32_bf16 v[84:87], v[180:183], v[32:35], v[84:87]
ds_read_b64_tr_b16 v[114:115], v8 offset:5120
v_mfma_f32_16x16x32_bf16 v[88:91], v[184:187], v[32:35], v[88:91]
s_add_u32 s24, s48, s35
ds_read_b64_tr_b16 v[116:117], v9 offset:4096
v_mfma_f32_16x16x32_bf16 v[92:95], v[188:191], v[32:35], v[92:95]
s_waitcnt vmcnt(15)
ds_read_b64_tr_b16 v[118:119], v9 offset:5120
buffer_load_dwordx4 v[32:35], v1, s[8:11], s24 offen sc1
v_mfma_f32_16x16x32_bf16 v[80:83], v[192:195], v[36:39], v[80:83]
ds_read_b64_tr_b16 v[120:121], v10 offset:4096
v_mfma_f32_16x16x32_bf16 v[84:87], v[196:199], v[36:39], v[84:87]
ds_read_b64_tr_b16 v[122:123], v10 offset:5120
v_mfma_f32_16x16x32_bf16 v[88:91], v[200:203], v[36:39], v[88:91]
ds_read_b64_tr_b16 v[124:125], v11 offset:4096
v_mfma_f32_16x16x32_bf16 v[92:95], v[204:207], v[36:39], v[92:95]
s_waitcnt vmcnt(15)
ds_read_b64_tr_b16 v[126:127], v11 offset:5120
buffer_load_dwordx4 v[36:39], v1, s[8:11], s24 offen offset:1024 sc1
v_mfma_f32_16x16x32_bf16 v[80:83], v[208:211], v[40:43], v[80:83]
v_mfma_f32_16x16x32_bf16 v[84:87], v[212:215], v[40:43], v[84:87]
v_mfma_f32_16x16x32_bf16 v[88:91], v[216:219], v[40:43], v[88:91]
v_mfma_f32_16x16x32_bf16 v[92:95], v[220:223], v[40:43], v[92:95]
s_waitcnt vmcnt(15) lgkmcnt(0)
buffer_load_dwordx4 v[40:43], v1, s[8:11], s24 offen offset:2048 sc1
s_barrier
v_mfma_f32_16x16x32_bf16 v[80:83], v[112:115], v[44:47], v[80:83]
ds_read_b128 v[96:99], v7
v_mfma_f32_16x16x32_bf16 v[84:87], v[116:119], v[44:47], v[84:87]
ds_read_b128 v[100:103], v7 offset:1024
v_mfma_f32_16x16x32_bf16 v[88:91], v[120:123], v[44:47], v[88:91]
ds_read_b128 v[104:107], v7 offset:2048
v_mfma_f32_16x16x32_bf16 v[92:95], v[124:127], v[44:47], v[92:95]
s_waitcnt vmcnt(15)
ds_read_b128 v[108:111], v7 offset:3072
buffer_load_dwordx4 v[44:47], v1, s[8:11], s24 offen offset:3072 sc1
v_mfma_f32_16x16x32_bf16 v[80:83], v[224:227], v[48:51], v[80:83]
ds_read_b64_tr_b16 v[112:113], v8 offset:8192
v_mfma_f32_16x16x32_bf16 v[84:87], v[228:231], v[48:51], v[84:87]
ds_read_b64_tr_b16 v[114:115], v8 offset:9216
v_mfma_f32_16x16x32_bf16 v[88:91], v[232:235], v[48:51], v[88:91]
s_add_u32 s24, s48, s36
ds_read_b64_tr_b16 v[116:117], v9 offset:8192
v_mfma_f32_16x16x32_bf16 v[92:95], v[236:239], v[48:51], v[92:95]
s_waitcnt vmcnt(15)
ds_read_b64_tr_b16 v[118:119], v9 offset:9216
buffer_load_dwordx4 v[48:51], v1, s[8:11], s24 offen sc1
v_mfma_f32_16x16x32_bf16 v[80:83], v[240:243], v[52:55], v[80:83]
ds_read_b64_tr_b16 v[120:121], v10 offset:8192
v_mfma_f32_16x16x32_bf16 v[84:87], v[244:247], v[52:55], v[84:87]
ds_read_b64_tr_b16 v[122:123], v10 offset:9216
v_mfma_f32_16x16x32_bf16 v[88:91], v[248:251], v[52:55], v[88:91]
ds_read_b64_tr_b16 v[124:125], v11 offset:8192
v_mfma_f32_16x16x32_bf16 v[92:95], v[252:255], v[52:55], v[92:95]
s_waitcnt vmcnt(15)
ds_read_b64_tr_b16 v[126:127], v11 offset:9216
buffer_load_dwordx4 v[52:55], v1, s[8:11], s24 offen offset:1024 sc1
v_mfma_f32_16x16x32_bf16 v[80:83], a[0:3], v[56:59], v[80:83]
v_mfma_f32_16x16x32_bf16 v[84:87], a[4:7], v[56:59], v[84:87]
v_mfma_f32_16x16x32_bf16 v[88:91], a[8:11], v[56:59], v[88:91]
v_mfma_f32_16x16x32_bf16 v[92:95], a[12:15], v[56:59], v[92:95]
s_waitcnt vmcnt(15) lgkmcnt(0)
buffer_load_dwordx4 v[56:59], v1, s[8:11], s24 offen offset:2048 sc1
v_mfma_f32_16x16x32_bf16 v[80:83], v[112:115], v[60:63], v[80:83]
v_add_f32 v96, v96, v100
v_add_f32 v97, v97, v101
v_mfma_f32_16x16x32_bf16 v[84:87], v[116:119], v[60:63], v[84:87]
v_add_f32 v98, v98, v102
v_add_f32 v99, v99, v103
v_mfma_f32_16x16x32_bf16 v[88:91], v[120:123], v[60:63], v[88:91]
v_add_f32 v96, v96, v104
v_add_f32 v97, v97, v105
v_mfma_f32_16x16x32_bf16 v[92:95], v[124:127], v[60:63], v[92:95]
s_waitcnt vmcnt(15)
v_add_f32 v98, v98, v106
v_add_f32 v99, v99, v107
buffer_load_dwordx4 v[60:63], v1, s[8:11], s24 offen offset:3072 sc1
v_mfma_f32_16x16x32_bf16 v[80:83], a[16:19], v[64:67], v[80:83]
ds_read_b64_tr_b16 v[112:113], v8 offset:12288
v_add_f32 v96, v96, v108
v_mfma_f32_16x16x32_bf16 v[84:87], a[20:23], v[64:67], v[84:87]
ds_read_b64_tr_b16 v[114:115], v8 offset:13312
v_add_f32 v97, v97, v109
v_mfma_f32_16x16x32_bf16 v[88:91], a[24:27], v[64:67], v[88:91]
s_add_u32 s24, s48, s37
ds_read_b64_tr_b16 v[116:117], v9 offset:12288
v_add_f32 v98, v98, v110
v_mfma_f32_16x16x32_bf16 v[92:95], a[28:31], v[64:67], v[92:95]
s_waitcnt vmcnt(15)
ds_read_b64_tr_b16 v[118:119], v9 offset:13312
v_add_f32 v99, v99, v111
buffer_load_dwordx4 v[64:67], v1, s[8:11], s24 offen sc1
v_mfma_f32_16x16x32_bf16 v[80:83], a[32:35], v[68:71], v[80:83]
ds_read_b64_tr_b16 v[120:121], v10 offset:12288
v_cvt_pk_bf16_f32 v12, v96, v97
v_mfma_f32_16x16x32_bf16 v[84:87], a[36:39], v[68:71], v[84:87]
ds_read_b64_tr_b16 v[122:123], v10 offset:13312
v_cvt_pk_bf16_f32 v13, v98, v99
v_mfma_f32_16x16x32_bf16 v[88:91], a[40:43], v[68:71], v[88:91]
ds_read_b64_tr_b16 v[124:125], v11 offset:12288
v_xor_b32 v3, 16384, v3
v_mfma_f32_16x16x32_bf16 v[92:95], a[44:47], v[68:71], v[92:95]
s_waitcnt vmcnt(15)
ds_read_b64_tr_b16 v[126:127], v11 offset:13312
v_xor_b32 v7, 16384, v7
buffer_load_dwordx4 v[68:71], v1, s[8:11], s24 offen offset:1024 sc1
buffer_store_dwordx2 v[12:13], v4, s[12:15], s53 offen
L_opl_t0:
v_mfma_f32_16x16x32_bf16 v[80:83], a[48:51], v[72:75], v[80:83]
v_mfma_f32_16x16x32_bf16 v[84:87], a[52:55], v[72:75], v[84:87]
v_mfma_f32_16x16x32_bf16 v[88:91], a[56:59], v[72:75], v[88:91]
v_mfma_f32_16x16x32_bf16 v[92:95], a[60:63], v[72:75], v[92:95]
s_waitcnt vmcnt(16) lgkmcnt(0)
buffer_load_dwordx4 v[72:75], v1, s[8:11], s24 offen offset:2048 sc1
v_mfma_f32_16x16x32_bf16 v[80:83], v[112:115], v[76:79], v[80:83]
s_waitcnt vmcnt(13)
v_cmp_ne_u32 vcc, 1, v6
v_mfma_f32_16x16x32_bf16 v[84:87], v[116:119], v[76:79], v[84:87]
v_mfma_f32_16x16x32_bf16 v[88:91], v[120:123], v[76:79], v[88:91]
s_cmp_eq_u64 vcc, 0
s_cselect_b32 s50, s52, 0
v_mfma_f32_16x16x32_bf16 v[92:95], v[124:127], v[76:79], v[92:95]
s_waitcnt vmcnt(16)
buffer_load_dwordx4 v[76:79], v1, s[8:11], s24 offen offset:3072 sc1
v_mfma_f32_16x16x32_bf16 v[80:83], a[64:67], v[16:19], v[80:83]
s_cmp_eq_u32 s50, 1
s_cselect_b32 s49, s49, 536870912
ds_read_b64_tr_b16 v[112:113], v8 offset:16384
v_mfma_f32_16x16x32_bf16 v[84:87], a[68:71], v[16:19], v[84:87]
ds_read_b64_tr_b16 v[114:115], v8 offset:17408
v_mfma_f32_16x16x32_bf16 v[88:91], a[72:75], v[16:19], v[88:91]
s_add_u32 s24, s49, s30
ds_read_b64_tr_b16 v[116:117], v9 offset:16384
v_mfma_f32_16x16x32_bf16 v[92:95], a[76:79], v[16:19], v[92:95]
s_waitcnt vmcnt(16)
ds_read_b64_tr_b16 v[118:119], v9 offset:17408
buffer_load_dwordx4 v[16:19], v1, s[8:11], s24 offen sc1
v_mfma_f32_16x16x32_bf16 v[80:83], a[80:83], v[20:23], v[80:83]
ds_read_b64_tr_b16 v[120:121], v10 offset:16384
v_mfma_f32_16x16x32_bf16 v[84:87], a[84:87], v[20:23], v[84:87]
ds_read_b64_tr_b16 v[122:123], v10 offset:17408
v_mfma_f32_16x16x32_bf16 v[88:91], a[88:91], v[20:23], v[88:91]
ds_read_b64_tr_b16 v[124:125], v11 offset:16384
v_mfma_f32_16x16x32_bf16 v[92:95], a[92:95], v[20:23], v[92:95]
s_waitcnt vmcnt(16)
ds_read_b64_tr_b16 v[126:127], v11 offset:17408
buffer_load_dwordx4 v[20:23], v1, s[8:11], s24 offen offset:1024 sc1
v_mfma_f32_16x16x32_bf16 v[80:83], a[96:99], v[24:27], v[80:83]
v_mfma_f32_16x16x32_bf16 v[84:87], a[100:103], v[24:27], v[84:87]
v_mfma_f32_16x16x32_bf16 v[88:91], a[104:107], v[24:27], v[88:91]
v_mfma_f32_16x16x32_bf16 v[92:95], a[108:111], v[24:27], v[92:95]
s_waitcnt vmcnt(15) lgkmcnt(0)
buffer_load_dwordx4 v[24:27], v1, s[8:11], s24 offen offset:2048 sc1
v_mfma_f32_16x16x32_bf16 v[80:83], v[112:115], v[28:31], v[80:83]
v_mfma_f32_16x16x32_bf16 v[84:87], v[116:119], v[28:31], v[84:87]
v_mfma_f32_16x16x32_bf16 v[88:91], v[120:123], v[28:31], v[88:91]
v_mfma_f32_16x16x32_bf16 v[92:95], v[124:127], v[28:31], v[92:95]
s_waitcnt vmcnt(15)
buffer_load_dwordx4 v[28:31], v1, s[8:11], s24 offen offset:3072 sc1
v_mfma_f32_16x16x32_bf16 v[80:83], a[112:115], v[32:35], v[80:83]
ds_read_b64_tr_b16 v[112:113], v8 offset:20480
v_mfma_f32_16x16x32_bf16 v[84:87], a[116:119], v[32:35], v[84:87]
ds_read_b64_tr_b16 v[114:115], v8 offset:21504
v_mfma_f32_16x16x32_bf16 v[88:91], a[120:123], v[32:35], v[88:91]
s_add_u32 s24, s49, s31
ds_read_b64_tr_b16 v[116:117], v9 offset:20480
v_mfma_f32_16x16x32_bf16 v[92:95], a[124:127], v[32:35], v[92:95]
s_waitcnt vmcnt(15)
ds_read_b64_tr_b16 v[118:119], v9 offset:21504
buffer_load_dwordx4 v[32:35], v1, s[8:11], s24 offen sc1
v_mfma_f32_16x16x32_bf16 v[80:83], a[128:131], v[36:39], v[80:83]
ds_read_b64_tr_b16 v[120:121], v10 offset:20480
v_mfma_f32_16x16x32_bf16 v[84:87], a[132:135], v[36:39], v[84:87]
ds_read_b64_tr_b16 v[122:123], v10 offset:21504
v_mfma_f32_16x16x32_bf16 v[88:91], a[136:139], v[36:39], v[88:91]
ds_read_b64_tr_b16 v[124:125], v11 offset:20480
v_mfma_f32_16x16x32_bf16 v[92:95], a[140:143], v[36:39], v[92:95]
s_waitcnt vmcnt(15)
ds_read_b64_tr_b16 v[126:127], v11 offset:21504
buffer_load_dwordx4 v[36:39], v1, s[8:11], s24 offen offset:1024 sc1
v_mfma_f32_16x16x32_bf16 v[80:83], a[144:147], v[40:43], v[80:83]
v_mfma_f32_16x16x32_bf16 v[84:87], a[148:151], v[40:43], v[84:87]
v_mfma_f32_16x16x32_bf16 v[88:91], a[152:155], v[40:43], v[88:91]
v_mfma_f32_16x16x32_bf16 v[92:95], a[156:159], v[40:43], v[92:95]
s_waitcnt vmcnt(15) lgkmcnt(0)
buffer_load_dwordx4 v[40:43], v1, s[8:11], s24 offen offset:2048 sc1
v_mfma_f32_16x16x32_bf16 v[80:83], v[112:115], v[44:47], v[80:83]
v_mfma_f32_16x16x32_bf16 v[84:87], v[116:119], v[44:47], v[84:87]
v_mfma_f32_16x16x32_bf16 v[88:91], v[120:123], v[44:47], v[88:91]
v_mfma_f32_16x16x32_bf16 v[92:95], v[124:127], v[44:47], v[92:95]
s_waitcnt vmcnt(15)
buffer_load_dwordx4 v[44:47], v1, s[8:11], s24 offen offset:3072 sc1
v_mfma_f32_16x16x32_bf16 v[80:83], a[160:163], v[48:51], v[80:83]
ds_read_b64_tr_b16 v[112:113], v8 offset:24576
v_mfma_f32_16x16x32_bf16 v[84:87], a[164:167], v[48:51], v[84:87]
ds_read_b64_tr_b16 v[114:115], v8 offset:25600
v_mfma_f32_16x16x32_bf16 v[88:91], a[168:171], v[48:51], v[88:91]
s_add_u32 s24, s49, s32
ds_read_b64_tr_b16 v[116:117], v9 offset:24576
v_mfma_f32_16x16x32_bf16 v[92:95], a[172:175], v[48:51], v[92:95]
s_waitcnt vmcnt(15)
ds_read_b64_tr_b16 v[118:119], v9 offset:25600
buffer_load_dwordx4 v[48:51], v1, s[8:11], s24 offen sc1
v_mfma_f32_16x16x32_bf16 v[80:83], a[176:179], v[52:55], v[80:83]
ds_read_b64_tr_b16 v[120:121], v10 offset:24576
v_mfma_f32_16x16x32_bf16 v[84:87], a[180:183], v[52:55], v[84:87]
ds_read_b64_tr_b16 v[122:123], v10 offset:25600
v_mfma_f32_16x16x32_bf16 v[88:91], a[184:187], v[52:55], v[88:91]
ds_read_b64_tr_b16 v[124:125], v11 offset:24576
v_mfma_f32_16x16x32_bf16 v[92:95], a[188:191], v[52:55], v[92:95]
s_waitcnt vmcnt(15)
ds_read_b64_tr_b16 v[126:127], v11 offset:25600
buffer_load_dwordx4 v[52:55], v1, s[8:11], s24 offen offset:1024 sc1
v_mfma_f32_16x16x32_bf16 v[80:83], a[192:195], v[56:59], v[80:83]
v_mfma_f32_16x16x32_bf16 v[84:87], a[196:199], v[56:59], v[84:87]
v_mfma_f32_16x16x32_bf16 v[88:91], a[200:203], v[56:59], v[88:91]
v_mfma_f32_16x16x32_bf16 v[92:95], a[204:207], v[56:59], v[92:95]
s_waitcnt vmcnt(15) lgkmcnt(0)
buffer_load_dwordx4 v[56:59], v1, s[8:11], s24 offen offset:2048 sc1
v_mfma_f32_16x16x32_bf16 v[80:83], v[112:115], v[60:63], v[80:83]
v_mfma_f32_16x16x32_bf16 v[84:87], v[116:119], v[60:63], v[84:87]
v_mfma_f32_16x16x32_bf16 v[88:91], v[120:123], v[60:63], v[88:91]
v_mfma_f32_16x16x32_bf16 v[92:95], v[124:127], v[60:63], v[92:95]
s_waitcnt vmcnt(15)
buffer_load_dwordx4 v[60:63], v1, s[8:11], s24 offen offset:3072 sc1
v_mfma_f32_16x16x32_bf16 v[80:83], a[208:211], v[64:67], v[80:83]
ds_read_b64_tr_b16 v[112:113], v8 offset:28672
v_mfma_f32_16x16x32_bf16 v[84:87], a[212:215], v[64:67], v[84:87]
ds_read_b64_tr_b16 v[114:115], v8 offset:29696
v_mfma_f32_16x16x32_bf16 v[88:91], a[216:219], v[64:67], v[88:91]
s_add_u32 s24, s49, s33
ds_read_b64_tr_b16 v[116:117], v9 offset:28672
v_mfma_f32_16x16x32_bf16 v[92:95], a[220:223], v[64:67], v[92:95]
s_waitcnt vmcnt(15)
ds_read_b64_tr_b16 v[118:119], v9 offset:29696
buffer_load_dwordx4 v[64:67], v1, s[8:11], s24 offen sc1
v_mfma_f32_16x16x32_bf16 v[80:83], a[224:227], v[68:71], v[80:83]
ds_read_b64_tr_b16 v[120:121], v10 offset:28672
v_mfma_f32_16x16x32_bf16 v[84:87], a[228:231], v[68:71], v[84:87]
ds_read_b64_tr_b16 v[122:123], v10 offset:29696
v_mfma_f32_16x16x32_bf16 v[88:91], a[232:235], v[68:71], v[88:91]
ds_read_b64_tr_b16 v[124:125], v11 offset:28672
v_mfma_f32_16x16x32_bf16 v[92:95], a[236:239], v[68:71], v[92:95]
s_waitcnt vmcnt(14)
ds_read_b64_tr_b16 v[126:127], v11 offset:29696
buffer_load_dwordx4 v[68:71], v1, s[8:11], s24 offen offset:1024 sc1
v_mfma_f32_16x16x32_bf16 v[80:83], a[240:243], v[72:75], v[80:83]
v_mfma_f32_16x16x32_bf16 v[84:87], a[244:247], v[72:75], v[84:87]
v_mfma_f32_16x16x32_bf16 v[88:91], a[248:251], v[72:75], v[88:91]
v_mfma_f32_16x16x32_bf16 v[92:95], a[252:255], v[72:75], v[92:95]
s_waitcnt vmcnt(14) lgkmcnt(0)
buffer_load_dwordx4 v[72:75], v1, s[8:11], s24 offen offset:2048 sc1
v_mfma_f32_16x16x32_bf16 v[80:83], v[112:115], v[76:79], v[80:83]
v_mfma_f32_16x16x32_bf16 v[84:87], v[116:119], v[76:79], v[84:87]
v_mfma_f32_16x16x32_bf16 v[88:91], v[120:123], v[76:79], v[88:91]
v_mfma_f32_16x16x32_bf16 v[92:95], v[124:127], v[76:79], v[92:95]
s_waitcnt vmcnt(14)
buffer_load_dwordx4 v[76:79], v1, s[8:11], s24 offen offset:3072 sc1
s_mul_i32 s53, s41, 36864
s_mov_b32 s41, s27
s_mov_b32 s48, s49
s_cmp_eq_u32 s50, 0
s_cbranch_scc1 L_opl_c0
L_opl_r1:
v_mfma_f32_16x16x32_bf16 v[96:99], v[128:131], v[16:19], 0
s_cmp_lg_u64 s[42:43], 0
s_cselect_b32 s52, 1, 0
ds_read_b64_tr_b16 v[112:113], v8
v_mfma_f32_16x16x32_bf16 v[100:103], v[132:135], v[16:19], 0
s_ff1_i32_b64 s27, s[42:43]
ds_read_b64_tr_b16 v[114:115], v8 offset:1024
v_mfma_f32_16x16x32_bf16 v[104:107], v[136:139], v[16:19], 0
s_bitset0_b64 s[42:43], s27
s_add_u32 s24, s48, s34
ds_read_b64_tr_b16 v[116:117], v9
v_mfma_f32_16x16x32_bf16 v[108:111], v[140:143], v[16:19], 0
s_waitcnt vmcnt(14)
s_lshl_b32 s27, s27, 1
ds_read_b64_tr_b16 v[118:119], v9 offset:1024
buffer_load_dwordx4 v[16:19], v1, s[8:11], s24 offen sc1
v_mfma_f32_16x16x32_bf16 v[96:99], v[144:147], v[20:23], v[96:99]
s_xor_b32 s27, s27, s51
ds_read_b64_tr_b16 v[120:121], v10
v_mfma_f32_16x16x32_bf16 v[100:103], v[148:151], v[20:23], v[100:103]
s_and_b32 s27, s27, 127
ds_read_b64_tr_b16 v[122:123], v10 offset:1024
v_mfma_f32_16x16x32_bf16 v[104:107], v[152:155], v[20:23], v[104:107]
s_lshr_b32 s25, s27, s46
ds_read_b64_tr_b16 v[124:125], v11
v_mfma_f32_16x16x32_bf16 v[108:111], v[156:159], v[20:23], v[108:111]
s_waitcnt vmcnt(14)
s_lshl_b32 s25, s25, 7
ds_read_b64_tr_b16 v[126:127], v11 offset:1024
buffer_load_dwordx4 v[20:23], v1, s[8:11], s24 offen offset:1024 sc1
v_mfma_f32_16x16x32_bf16 v[96:99], v[160:163], v[24:27], v[96:99]
s_add_u32 s25, s25, s45
v_mfma_f32_16x16x32_bf16 v[100:103], v[164:167], v[24:27], v[100:103]
s_lshl_b32 s49, s27, 17
v_mfma_f32_16x16x32_bf16 v[104:107], v[168:171], v[24:27], v[104:107]
s_add_u32 s49, s49, s44
v_mfma_f32_16x16x32_bf16 v[108:111], v[172:175], v[24:27], v[108:111]
s_waitcnt vmcnt(14) lgkmcnt(0)
buffer_load_dwordx4 v[24:27], v1, s[8:11], s24 offen offset:2048 sc1
buffer_load_dword v6, v5, s[8:11], s25 offen sc1
v_mfma_f32_16x16x32_bf16 v[96:99], v[112:115], v[28:31], v[96:99]
ds_write_b128 v3, v[80:83]
v_mfma_f32_16x16x32_bf16 v[100:103], v[116:119], v[28:31], v[100:103]
ds_write_b128 v3, v[84:87] offset:4096
v_mfma_f32_16x16x32_bf16 v[104:107], v[120:123], v[28:31], v[104:107]
ds_write_b128 v3, v[88:91] offset:8192
v_mfma_f32_16x16x32_bf16 v[108:111], v[124:127], v[28:31], v[108:111]
s_waitcnt vmcnt(15)
ds_write_b128 v3, v[92:95] offset:12288
buffer_load_dwordx4 v[28:31], v1, s[8:11], s24 offen offset:3072 sc1
v_mfma_f32_16x16x32_bf16 v[96:99], v[176:179], v[32:35], v[96:99]
ds_read_b64_tr_b16 v[112:113], v8 offset:4096
v_mfma_f32_16x16x32_bf16 v[100:103], v[180:183], v[32:35], v[100:103]
ds_read_b64_tr_b16 v[114:115], v8 offset:5120
v_mfma_f32_16x16x32_bf16 v[104:107], v[184:187], v[32:35], v[104:107]
s_add_u32 s24, s48, s35
ds_read_b64_tr_b16 v[116:117], v9 offset:4096
v_mfma_f32_16x16x32_bf16 v[108:111], v[188:191], v[32:35], v[108:111]
s_waitcnt vmcnt(15)
ds_read_b64_tr_b16 v[118:119], v9 offset:5120
buffer_load_dwordx4 v[32:35], v1, s[8:11], s24 offen sc1
v_mfma_f32_16x16x32_bf16 v[96:99], v[192:195], v[36:39], v[96:99]
ds_read_b64_tr_b16 v[120:121], v10 offset:4096
v_mfma_f32_16x16x32_bf16 v[100:103], v[196:199], v[36:39], v[100:103]
ds_read_b64_tr_b16 v[122:123], v10 offset:5120
v_mfma_f32_16x16x32_bf16 v[104:107], v[200:203], v[36:39], v[104:107]
ds_read_b64_tr_b16 v[124:125], v11 offset:4096
v_mfma_f32_16x16x32_bf16 v[108:111], v[204:207], v[36:39], v[108:111]
s_waitcnt vmcnt(15)
ds_read_b64_tr_b16 v[126:127], v11 offset:5120
buffer_load_dwordx4 v[36:39], v1, s[8:11], s24 offen offset:1024 sc1
v_mfma_f32_16x16x32_bf16 v[96:99], v[208:211], v[40:43], v[96:99]
v_mfma_f32_16x16x32_bf16 v[100:103], v[212:215], v[40:43], v[100:103]
v_mfma_f32_16x16x32_bf16 v[104:107], v[216:219], v[40:43], v[104:107]
v_mfma_f32_16x16x32_bf16 v[108:111], v[220:223], v[40:43], v[108:111]
s_waitcnt vmcnt(15) lgkmcnt(0)
buffer_load_dwordx4 v[40:43], v1, s[8:11], s24 offen offset:2048 sc1
s_barrier
v_mfma_f32_16x16x32_bf16 v[96:99], v[112:115], v[44:47], v[96:99]
ds_read_b128 v[80:83], v7
v_mfma_f32_16x16x32_bf16 v[100:103], v[116:119], v[44:47], v[100:103]
ds_read_b128 v[84:87], v7 offset:1024
v_mfma_f32_16x16x32_bf16 v[104:107], v[120:123], v[44:47], v[104:107]
ds_read_b128 v[88:91], v7 offset:2048
v_mfma_f32_16x16x32_bf16 v[108:111], v[124:127], v[44:47], v[108:111]
s_waitcnt vmcnt(15)
ds_read_b128 v[92:95], v7 offset:3072
buffer_load_dwordx4 v[44:47], v1, s[8:11], s24 offen offset:3072 sc1
v_mfma_f32_16x16x32_bf16 v[96:99], v[224:227], v[48:51], v[96:99]
ds_read_b64_tr_b16 v[112:113], v8 offset:8192
v_mfma_f32_16x16x32_bf16 v[100:103], v[228:231], v[48:51], v[100:103]
ds_read_b64_tr_b16 v[114:115], v8 offset:9216
v_mfma_f32_16x16x32_bf16 v[104:107], v[232:235], v[48:51], v[104:107]
s_add_u32 s24, s48, s36
ds_read_b64_tr_b16 v[116:117], v9 offset:8192
v_mfma_f32_16x16x32_bf16 v[108:111], v[236:239], v[48:51], v[108:111]
s_waitcnt vmcnt(15)
ds_read_b64_tr_b16 v[118:119], v9 offset:9216
buffer_load_dwordx4 v[48:51], v1, s[8:11], s24 offen sc1
v_mfma_f32_16x16x32_bf16 v[96:99], v[240:243], v[52:55], v[96:99]
ds_read_b64_tr_b16 v[120:121], v10 offset:8192
v_mfma_f32_16x16x32_bf16 v[100:103], v[244:247], v[52:55], v[100:103]
ds_read_b64_tr_b16 v[122:123], v10 offset:9216
v_mfma_f32_16x16x32_bf16 v[104:107], v[248:251], v[52:55], v[104:107]
ds_read_b64_tr_b16 v[124:125], v11 offset:8192
v_mfma_f32_16x16x32_bf16 v[108:111], v[252:255], v[52:55], v[108:111]
s_waitcnt vmcnt(15)
ds_read_b64_tr_b16 v[126:127], v11 offset:9216
buffer_load_dwordx4 v[52:55], v1, s[8:11], s24 offen offset:1024 sc1
v_mfma_f32_16x16x32_bf16 v[96:99], a[0:3], v[56:59], v[96:99]
v_mfma_f32_16x16x32_bf16 v[100:103], a[4:7], v[56:59], v[100:103]
v_mfma_f32_16x16x32_bf16 v[104:107], a[8:11], v[56:59], v[104:107]
v_mfma_f32_16x16x32_bf16 v[108:111], a[12:15], v[56:59], v[108:111]
s_waitcnt vmcnt(15) lgkmcnt(0)
buffer_load_dwordx4 v[56:59], v1, s[8:11], s24 offen offset:2048 sc1
v_mfma_f32_16x16x32_bf16 v[96:99], v[112:115], v[60:63], v[96:99]
v_add_f32 v80, v80, v84
v_add_f32 v81, v81, v85
v_mfma_f32_16x16x32_bf16 v[100:103], v[116:119], v[60:63], v[100:103]
v_add_f32 v82, v82, v86
v_add_f32 v83, v83, v87
v_mfma_f32_16x16x32_bf16 v[104:107], v[120:123], v[60:63], v[104:107]
v_add_f32 v80, v80, v88
v_add_f32 v81, v81, v89
v_mfma_f32_16x16x32_bf16 v[108:111], v[124:127], v[60:63], v[108:111]
s_waitcnt vmcnt(15)
v_add_f32 v82, v82, v90
v_add_f32 v83, v83, v91
buffer_load_dwordx4 v[60:63], v1, s[8:11], s24 offen offset:3072 sc1
v_mfma_f32_16x16x32_bf16 v[96:99], a[16:19], v[64:67], v[96:99]
ds_read_b64_tr_b16 v[112:113], v8 offset:12288
v_add_f32 v80, v80, v92
v_mfma_f32_16x16x32_bf16 v[100:103], a[20:23], v[64:67], v[100:103]
ds_read_b64_tr_b16 v[114:115], v8 offset:13312
v_add_f32 v81, v81, v93
v_mfma_f32_16x16x32_bf16 v[104:107], a[24:27], v[64:67], v[104:107]
s_add_u32 s24, s48, s37
ds_read_b64_tr_b16 v[116:117], v9 offset:12288
v_add_f32 v82, v82, v94
v_mfma_f32_16x16x32_bf16 v[108:111], a[28:31], v[64:67], v[108:111]
s_waitcnt vmcnt(15)
ds_read_b64_tr_b16 v[118:119], v9 offset:13312
v_add_f32 v83, v83, v95
buffer_load_dwordx4 v[64:67], v1, s[8:11], s24 offen sc1
v_mfma_f32_16x16x32_bf16 v[96:99], a[32:35], v[68:71], v[96:99]
ds_read_b64_tr_b16 v[120:121], v10 offset:12288
v_cvt_pk_bf16_f32 v12, v80, v81
v_mfma_f32_16x16x32_bf16 v[100:103], a[36:39], v[68:71], v[100:103]
ds_read_b64_tr_b16 v[122:123], v10 offset:13312
v_cvt_pk_bf16_f32 v13, v82, v83
v_mfma_f32_16x16x32_bf16 v[104:107], a[40:43], v[68:71], v[104:107]
ds_read_b64_tr_b16 v[124:125], v11 offset:12288
v_xor_b32 v3, 16384, v3
v_mfma_f32_16x16x32_bf16 v[108:111], a[44:47], v[68:71], v[108:111]
s_waitcnt vmcnt(15)
ds_read_b64_tr_b16 v[126:127], v11 offset:13312
v_xor_b32 v7, 16384, v7
buffer_load_dwordx4 v[68:71], v1, s[8:11], s24 offen offset:1024 sc1
buffer_store_dwordx2 v[12:13], v4, s[12:15], s53 offen
L_opl_t1:
v_mfma_f32_16x16x32_bf16 v[96:99], a[48:51], v[72:75], v[96:99]
v_mfma_f32_16x16x32_bf16 v[100:103], a[52:55], v[72:75], v[100:103]
v_mfma_f32_16x16x32_bf16 v[104:107], a[56:59], v[72:75], v[104:107]
v_mfma_f32_16x16x32_bf16 v[108:111], a[60:63], v[72:75], v[108:111]
s_waitcnt vmcnt(16) lgkmcnt(0)
buffer_load_dwordx4 v[72:75], v1, s[8:11], s24 offen offset:2048 sc1
v_mfma_f32_16x16x32_bf16 v[96:99], v[112:115], v[76:79], v[96:99]
s_waitcnt vmcnt(13)
v_cmp_ne_u32 vcc, 1, v6
v_mfma_f32_16x16x32_bf16 v[100:103], v[116:119], v[76:79], v[100:103]
v_mfma_f32_16x16x32_bf16 v[104:107], v[120:123], v[76:79], v[104:107]
s_cmp_eq_u64 vcc, 0
s_cselect_b32 s50, s52, 0
v_mfma_f32_16x16x32_bf16 v[108:111], v[124:127], v[76:79], v[108:111]
s_waitcnt vmcnt(16)
buffer_load_dwordx4 v[76:79], v1, s[8:11], s24 offen offset:3072 sc1
v_mfma_f32_16x16x32_bf16 v[96:99], a[64:67], v[16:19], v[96:99]
s_cmp_eq_u32 s50, 1
s_cselect_b32 s49, s49, 536870912
ds_read_b64_tr_b16 v[112:113], v8 offset:16384
v_mfma_f32_16x16x32_bf16 v[100:103], a[68:71], v[16:19], v[100:103]
ds_read_b64_tr_b16 v[114:115], v8 offset:17408
v_mfma_f32_16x16x32_bf16 v[104:107], a[72:75], v[16:19], v[104:107]
s_add_u32 s24, s49, s30
ds_read_b64_tr_b16 v[116:117], v9 offset:16384
v_mfma_f32_16x16x32_bf16 v[108:111], a[76:79], v[16:19], v[108:111]
s_waitcnt vmcnt(16)
ds_read_b64_tr_b16 v[118:119], v9 offset:17408
buffer_load_dwordx4 v[16:19], v1, s[8:11], s24 offen sc1
v_mfma_f32_16x16x32_bf16 v[96:99], a[80:83], v[20:23], v[96:99]
ds_read_b64_tr_b16 v[120:121], v10 offset:16384
v_mfma_f32_16x16x32_bf16 v[100:103], a[84:87], v[20:23], v[100:103]
ds_read_b64_tr_b16 v[122:123], v10 offset:17408
v_mfma_f32_16x16x32_bf16 v[104:107], a[88:91], v[20:23], v[104:107]
ds_read_b64_tr_b16 v[124:125], v11 offset:16384
v_mfma_f32_16x16x32_bf16 v[108:111], a[92:95], v[20:23], v[108:111]
s_waitcnt vmcnt(16)
ds_read_b64_tr_b16 v[126:127], v11 offset:17408
buffer_load_dwordx4 v[20:23], v1, s[8:11], s24 offen offset:1024 sc1
v_mfma_f32_16x16x32_bf16 v[96:99], a[96:99], v[24:27], v[96:99]
v_mfma_f32_16x16x32_bf16 v[100:103], a[100:103], v[24:27], v[100:103]
v_mfma_f32_16x16x32_bf16 v[104:107], a[104:107], v[24:27], v[104:107]
v_mfma_f32_16x16x32_bf16 v[108:111], a[108:111], v[24:27], v[108:111]
s_waitcnt vmcnt(15) lgkmcnt(0)
buffer_load_dwordx4 v[24:27], v1, s[8:11], s24 offen offset:2048 sc1
v_mfma_f32_16x16x32_bf16 v[96:99], v[112:115], v[28:31], v[96:99]
v_mfma_f32_16x16x32_bf16 v[100:103], v[116:119], v[28:31], v[100:103]
v_mfma_f32_16x16x32_bf16 v[104:107], v[120:123], v[28:31], v[104:107]
v_mfma_f32_16x16x32_bf16 v[108:111], v[124:127], v[28:31], v[108:111]
s_waitcnt vmcnt(15)
buffer_load_dwordx4 v[28:31], v1, s[8:11], s24 offen offset:3072 sc1
v_mfma_f32_16x16x32_bf16 v[96:99], a[112:115], v[32:35], v[96:99]
ds_read_b64_tr_b16 v[112:113], v8 offset:20480
v_mfma_f32_16x16x32_bf16 v[100:103], a[116:119], v[32:35], v[100:103]
ds_read_b64_tr_b16 v[114:115], v8 offset:21504
v_mfma_f32_16x16x32_bf16 v[104:107], a[120:123], v[32:35], v[104:107]
s_add_u32 s24, s49, s31
ds_read_b64_tr_b16 v[116:117], v9 offset:20480
v_mfma_f32_16x16x32_bf16 v[108:111], a[124:127], v[32:35], v[108:111]
s_waitcnt vmcnt(15)
ds_read_b64_tr_b16 v[118:119], v9 offset:21504
buffer_load_dwordx4 v[32:35], v1, s[8:11], s24 offen sc1
v_mfma_f32_16x16x32_bf16 v[96:99], a[128:131], v[36:39], v[96:99]
ds_read_b64_tr_b16 v[120:121], v10 offset:20480
v_mfma_f32_16x16x32_bf16 v[100:103], a[132:135], v[36:39], v[100:103]
ds_read_b64_tr_b16 v[122:123], v10 offset:21504
v_mfma_f32_16x16x32_bf16 v[104:107], a[136:139], v[36:39], v[104:107]
ds_read_b64_tr_b16 v[124:125], v11 offset:20480
v_mfma_f32_16x16x32_bf16 v[108:111], a[140:143], v[36:39], v[108:111]
s_waitcnt vmcnt(15)
ds_read_b64_tr_b16 v[126:127], v11 offset:21504
buffer_load_dwordx4 v[36:39], v1, s[8:11], s24 offen offset:1024 sc1
v_mfma_f32_16x16x32_bf16 v[96:99], a[144:147], v[40:43], v[96:99]
v_mfma_f32_16x16x32_bf16 v[100:103], a[148:151], v[40:43], v[100:103]
v_mfma_f32_16x16x32_bf16 v[104:107], a[152:155], v[40:43], v[104:107]
v_mfma_f32_16x16x32_bf16 v[108:111], a[156:159], v[40:43], v[108:111]
s_waitcnt vmcnt(15) lgkmcnt(0)
buffer_load_dwordx4 v[40:43], v1, s[8:11], s24 offen offset:2048 sc1
v_mfma_f32_16x16x32_bf16 v[96:99], v[112:115], v[44:47], v[96:99]
v_mfma_f32_16x16x32_bf16 v[100:103], v[116:119], v[44:47], v[100:103]
v_mfma_f32_16x16x32_bf16 v[104:107], v[120:123], v[44:47], v[104:107]
v_mfma_f32_16x16x32_bf16 v[108:111], v[124:127], v[44:47], v[108:111]
s_waitcnt vmcnt(15)
buffer_load_dwordx4 v[44:47], v1, s[8:11], s24 offen offset:3072 sc1
v_mfma_f32_16x16x32_bf16 v[96:99], a[160:163], v[48:51], v[96:99]
ds_read_b64_tr_b16 v[112:113], v8 offset:24576
v_mfma_f32_16x16x32_bf16 v[100:103], a[164:167], v[48:51], v[100:103]
ds_read_b64_tr_b16 v[114:115], v8 offset:25600
v_mfma_f32_16x16x32_bf16 v[104:107], a[168:171], v[48:51], v[104:107]
s_add_u32 s24, s49, s32
ds_read_b64_tr_b16 v[116:117], v9 offset:24576
v_mfma_f32_16x16x32_bf16 v[108:111], a[172:175], v[48:51], v[108:111]
s_waitcnt vmcnt(15)
ds_read_b64_tr_b16 v[118:119], v9 offset:25600
buffer_load_dwordx4 v[48:51], v1, s[8:11], s24 offen sc1
v_mfma_f32_16x16x32_bf16 v[96:99], a[176:179], v[52:55], v[96:99]
ds_read_b64_tr_b16 v[120:121], v10 offset:24576
v_mfma_f32_16x16x32_bf16 v[100:103], a[180:183], v[52:55], v[100:103]
ds_read_b64_tr_b16 v[122:123], v10 offset:25600
v_mfma_f32_16x16x32_bf16 v[104:107], a[184:187], v[52:55], v[104:107]
ds_read_b64_tr_b16 v[124:125], v11 offset:24576
v_mfma_f32_16x16x32_bf16 v[108:111], a[188:191], v[52:55], v[108:111]
s_waitcnt vmcnt(15)
ds_read_b64_tr_b16 v[126:127], v11 offset:25600
buffer_load_dwordx4 v[52:55], v1, s[8:11], s24 offen offset:1024 sc1
v_mfma_f32_16x16x32_bf16 v[96:99], a[192:195], v[56:59], v[96:99]
v_mfma_f32_16x16x32_bf16 v[100:103], a[196:199], v[56:59], v[100:103]
v_mfma_f32_16x16x32_bf16 v[104:107], a[200:203], v[56:59], v[104:107]
v_mfma_f32_16x16x32_bf16 v[108:111], a[204:207], v[56:59], v[108:111]
s_waitcnt vmcnt(15) lgkmcnt(0)
buffer_load_dwordx4 v[56:59], v1, s[8:11], s24 offen offset:2048 sc1
v_mfma_f32_16x16x32_bf16 v[96:99], v[112:115], v[60:63], v[96:99]
v_mfma_f32_16x16x32_bf16 v[100:103], v[116:119], v[60:63], v[100:103]
v_mfma_f32_16x16x32_bf16 v[104:107], v[120:123], v[60:63], v[104:107]
v_mfma_f32_16x16x32_bf16 v[108:111], v[124:127], v[60:63], v[108:111]
s_waitcnt vmcnt(15)
buffer_load_dwordx4 v[60:63], v1, s[8:11], s24 offen offset:3072 sc1
v_mfma_f32_16x16x32_bf16 v[96:99], a[208:211], v[64:67], v[96:99]
ds_read_b64_tr_b16 v[112:113], v8 offset:28672
v_mfma_f32_16x16x32_bf16 v[100:103], a[212:215], v[64:67], v[100:103]
ds_read_b64_tr_b16 v[114:115], v8 offset:29696
v_mfma_f32_16x16x32_bf16 v[104:107], a[216:219], v[64:67], v[104:107]
s_add_u32 s24, s49, s33
ds_read_b64_tr_b16 v[116:117], v9 offset:28672
v_mfma_f32_16x16x32_bf16 v[108:111], a[220:223], v[64:67], v[108:111]
s_waitcnt vmcnt(15)
ds_read_b64_tr_b16 v[118:119], v9 offset:29696
buffer_load_dwordx4 v[64:67], v1, s[8:11], s24 offen sc1
v_mfma_f32_16x16x32_bf16 v[96:99], a[224:227], v[68:71], v[96:99]
ds_read_b64_tr_b16 v[120:121], v10 offset:28672
v_mfma_f32_16x16x32_bf16 v[100:103], a[228:231], v[68:71], v[100:103]
ds_read_b64_tr_b16 v[122:123], v10 offset:29696
v_mfma_f32_16x16x32_bf16 v[104:107], a[232:235], v[68:71], v[104:107]
ds_read_b64_tr_b16 v[124:125], v11 offset:28672
v_mfma_f32_16x16x32_bf16 v[108:111], a[236:239], v[68:71], v[108:111]
s_waitcnt vmcnt(14)
ds_read_b64_tr_b16 v[126:127], v11 offset:29696
buffer_load_dwordx4 v[68:71], v1, s[8:11], s24 offen offset:1024 sc1
v_mfma_f32_16x16x32_bf16 v[96:99], a[240:243], v[72:75], v[96:99]
v_mfma_f32_16x16x32_bf16 v[100:103], a[244:247], v[72:75], v[100:103]
v_mfma_f32_16x16x32_bf16 v[104:107], a[248:251], v[72:75], v[104:107]
v_mfma_f32_16x16x32_bf16 v[108:111], a[252:255], v[72:75], v[108:111]
s_waitcnt vmcnt(14) lgkmcnt(0)
buffer_load_dwordx4 v[72:75], v1, s[8:11], s24 offen offset:2048 sc1
v_mfma_f32_16x16x32_bf16 v[96:99], v[112:115], v[76:79], v[96:99]
v_mfma_f32_16x16x32_bf16 v[100:103], v[116:119], v[76:79], v[100:103]
v_mfma_f32_16x16x32_bf16 v[104:107], v[120:123], v[76:79], v[104:107]
v_mfma_f32_16x16x32_bf16 v[108:111], v[124:127], v[76:79], v[108:111]
s_waitcnt vmcnt(14)
buffer_load_dwordx4 v[76:79], v1, s[8:11], s24 offen offset:3072 sc1
s_mul_i32 s53, s41, 36864
s_mov_b32 s41, s27
s_mov_b32 s48, s49
s_cmp_eq_u32 s50, 0
s_cbranch_scc0 L_opl_r0
L_opl_c1:
ds_write_b128 v3, v[96:99]
ds_write_b128 v3, v[100:103] offset:4096
ds_write_b128 v3, v[104:107] offset:8192
ds_write_b128 v3, v[108:111] offset:12288
s_waitcnt lgkmcnt(0)
s_barrier
ds_read_b128 v[96:99], v7
ds_read_b128 v[100:103], v7 offset:1024
ds_read_b128 v[104:107], v7 offset:2048
ds_read_b128 v[108:111], v7 offset:3072
s_waitcnt lgkmcnt(2)
v_pk_add_f32 v[96:97], v[96:97], v[100:101]
v_pk_add_f32 v[98:99], v[98:99], v[102:103]
s_waitcnt lgkmcnt(1)
v_pk_add_f32 v[96:97], v[96:97], v[104:105]
v_pk_add_f32 v[98:99], v[98:99], v[106:107]
s_waitcnt lgkmcnt(0)
v_pk_add_f32 v[96:97], v[96:97], v[108:109]
v_pk_add_f32 v[98:99], v[98:99], v[110:111]
v_cvt_pk_bf16_f32 v12, v96, v97
v_cvt_pk_bf16_f32 v13, v98, v99
buffer_store_dwordx2 v[12:13], v4, s[12:15], s53 offen
v_xor_b32 v3, 16384, v3
v_xor_b32 v7, 16384, v7
s_cmp_lg_u32 s52, 0
s_cbranch_scc1 L_opl_w
s_branch L_opl_x
L_opl_c0:
ds_write_b128 v3, v[80:83]
ds_write_b128 v3, v[84:87] offset:4096
ds_write_b128 v3, v[88:91] offset:8192
ds_write_b128 v3, v[92:95] offset:12288
s_waitcnt lgkmcnt(0)
s_barrier
ds_read_b128 v[80:83], v7
ds_read_b128 v[84:87], v7 offset:1024
ds_read_b128 v[88:91], v7 offset:2048
ds_read_b128 v[92:95], v7 offset:3072
s_waitcnt lgkmcnt(2)
v_pk_add_f32 v[80:81], v[80:81], v[84:85]
v_pk_add_f32 v[82:83], v[82:83], v[86:87]
s_waitcnt lgkmcnt(1)
v_pk_add_f32 v[80:81], v[80:81], v[88:89]
v_pk_add_f32 v[82:83], v[82:83], v[90:91]
s_waitcnt lgkmcnt(0)
v_pk_add_f32 v[80:81], v[80:81], v[92:93]
v_pk_add_f32 v[82:83], v[82:83], v[94:95]
v_cvt_pk_bf16_f32 v12, v80, v81
v_cvt_pk_bf16_f32 v13, v82, v83
buffer_store_dwordx2 v[12:13], v4, s[12:15], s53 offen
v_xor_b32 v3, 16384, v3
v_xor_b32 v7, 16384, v7
s_cmp_lg_u32 s52, 0
s_cbranch_scc1 L_opl_w
L_opl_x:
s_branch L_done
L_team:
s_load_dwordx8 s[88:95], s[0:1], 64
s_load_dwordx2 s[96:97], s[0:1], 56
v_mov_b32 v12, v0
v_and_b32 v13, 15, v0
v_bfe_u32 v14, v0, 4, 2
v_lshlrev_b32 v3, 4, v12
v_and_b32 v2, 0x3f0, v3
s_mul_i32 s20, s17, 34816
s_add_u32 s20, s20, 24576
v_add_u32 v2, s20, v2
v_and_b32 v15, 1, v12
v_mul_u32_u24 v0, 0xaaaa, v15
v_add_u32 v0, 0xffff4444, v0
v_lshrrev_b32 v18, 2, v13
v_lshl_add_u32 v18, v18, 1, v15
v_bfe_u32 v19, v13, 1, 1
v_lshrrev_b32 v16, 5, v12
v_lshlrev_b32 v16, 8, v16
v_lshl_add_u32 v16, v18, 5, v16
v_and_b32 v17, 1, v14
v_lshl_add_u32 v16, v17, 4, v16
v_and_b32 v17, 0x7f, v16
v_xor_b32 v17, 16, v17
v_add_u32 v16, 4224, v16
v_add_u32 v17, 6272, v17
v_cmp_eq_u32 vcc, 1, v19
s_nop 1
v_cndmask_b32 v7, v17, v16, vcc
v_lshrrev_b32 v16, 1, v14
v_lshlrev_b32 v16, 8, v16
v_lshl_add_u32 v16, v15, 7, v16
v_and_b32 v17, 1, v14
v_lshl_add_u32 v16, v17, 6, v16
v_lshrrev_b32 v17, 2, v13
v_lshl_add_u32 v16, v17, 4, v16
v_mul_u32_u24 v17, 2112, v19
v_add_u32 v5, v16, v17
v_bfe_u32 v16, v13, 3, 1
v_lshlrev_b32 v16, 8, v16
v_lshl_add_u32 v16, v19, 6, v16
v_lshl_add_u32 v16, v14, 4, v16
v_bfe_u32 v17, v13, 2, 1
v_lshl_add_u32 v16, v17, 3, v16
v_lshl_add_u32 v16, v15, 2, v16
s_lshl_b32 s20, s17, 9
v_add_u32 v4, s20, v16
v_lshrrev_b32 v16, 4, v12
v_xor_b32 v17, s16, v16
v_lshlrev_b32 v16, 12, v16
v_lshl_add_u32 v16, v17, 7, v16
v_lshl_add_u32 v9, v13, 3, v16
s_lshr_b32 s20, s17, 1
s_lshl_b32 s20, s20, 2
v_add_u32 v16, s20, v14
v_xor_b32 v17, s16, v16
v_lshlrev_b32 v16, 12, v16
v_lshl_add_u32 v16, v17, 7, v16
v_lshl_add_u32 v16, v13, 2, v16
s_and_b32 s20, s17, 1
s_lshl_b32 s20, s20, 6
s_add_u32 s20, s20, 262144
v_add_u32 v10, s20, v16
v_bfe_u32 v16, v13, 2, 1
v_lshlrev_b32 v16, 5, v16
v_and_b32 v17, 1, v14
v_lshl_add_u32 v16, v17, 8, v16
v_lshrrev_b32 v17, 1, v14
v_lshl_add_u32 v16, v17, 4, v16
v_and_b32 v17, 3, v13
v_lshl_add_u32 v11, v17, 2, v16
v_lshlrev_b32 v6, 7, v12
v_lshlrev_b32 v8, 2, v12
s_mov_b32 s36, 0x11111111
s_mov_b32 s37, 0x11111111
s_mov_b32 s38, 0x22222222
s_mov_b32 s39, 0x22222222
s_mov_b32 s40, 0x44444444
s_mov_b32 s41, 0x44444444
s_mov_b32 s42, 0x88888888
s_mov_b32 s43, 0x88888888
s_mov_b32 s44, 0xf0f0f0f0
s_mov_b32 s45, 0xf0f0f0f0
s_mov_b32 s18, 0x3e0293ee
s_lshl_b32 s20, s17, 5
s_add_u32 s20, s20, s16
s_cmp_lt_u32 s20, 72
s_cselect_b32 s48, 1, 0
s_lshl_b32 s23, s20, 12
s_lshl_b32 s21, s17, 10
s_sub_u32 s23, s23, s21
s_lshr_b32 s24, s20, 2
s_lshl_b32 s24, s24, 9
s_and_b32 s21, s20, 3
s_lshl_b32 s21, s21, 6
s_add_u32 s24, s24, s21
s_add_u32 s24, s24, 109641728
s_cmp_lt_u32 s20, 72
s_cselect_b32 s24, s24, 536870912
s_lshl_b32 s25, s16, 12
s_add_u32 s26, s25, 131072
s_add_u32 s27, s25, 262144
s_cmp_lt_u32 s16, 8
s_cselect_b32 s27, s27, 536870912
s_mov_b32 s28, 109051904
s_mov_b32 s29, 109346816
s_mov_b32 s85, 109641728
s_lshl_b32 s30, s16, 14
s_add_u32 s30, s30, 33554432
s_lshl_b32 s31, s16, 12
s_add_u32 s31, s31, 100663296
s_add_u32 s35, s24, 32768
s_mov_b32 s53, 0x3f803f80
s_mov_b32 s86, 0x33333333
s_mov_b32 s87, 0x33333333
s_lshl_b32 s84, s17, 13
s_sub_u32 s84, s20, s84
s_add_u32 s84, s84, 110886912
s_cmp_lt_u32 s20, 72
s_cselect_b32 s84, s84, 536870912
s_and_b32 s21, s16, 3
s_lshl_b32 s21, s21, 7
s_add_u32 s21, s21, 110886144
s_cmp_eq_u32 s17, 3
s_cselect_b32 s84, s21, s84
s_lshl_b32 s82, s16, 7
s_add_u32 s83, s82, 111152384
s_add_u32 s82, s82, 111148288
s_mov_b32 s19, 0
v_mov_b32 v64, -1
v_mov_b32 v65, -1
v_mov_b32 v66, -1
v_mov_b32 v67, -1
s_add_u32 s20, s28, s25
buffer_store_dwordx4 v[64:67], v3, s[8:11], s20 offen
s_add_u32 s20, s28, s26
buffer_store_dwordx4 v[64:67], v3, s[8:11], s20 offen
s_add_u32 s20, s28, s27
buffer_store_dwordx4 v[64:67], v3, s[8:11], s20 offen
s_add_u32 s20, s29, s25
buffer_store_dwordx4 v[64:67], v3, s[8:11], s20 offen
s_add_u32 s20, s29, s26
buffer_store_dwordx4 v[64:67], v3, s[8:11], s20 offen
s_add_u32 s20, s29, s27
buffer_store_dwordx4 v[64:67], v3, s[8:11], s20 offen
s_add_u32 s20, s24, 16384
buffer_store_dword v64, v11, s[8:11], s20 offen
s_cmp_eq_u32 s17, 3
s_cselect_b32 s20, 536870912, s84
s_mov_b64 exec, 15
buffer_store_byte v64, v6, s[8:11], s20 offen
s_mov_b64 exec, -1
v_lshrrev_b32 v0, 4, v3
s_waitcnt lgkmcnt(0)
s_mov_b32 s46, 0x05040100
s_mov_b32 s47, 0x07060302
v_and_b32 v3, 63, v0
v_lshlrev_b32 v3, 4, v3
s_mul_i32 s20, s17, 34816
s_add_u32 s20, s20, 24576
v_add_u32 v3, s20, v3
v_bfe_u32 v64, v0, 5, 1
v_bfe_u32 v65, v0, 4, 1
v_and_b32 v66, 15, v0
v_lshlrev_b32 v1, 17, v64
v_lshl_add_u32 v1, v65, 14, v1
v_lshl_add_u32 v1, v66, 2, v1
s_lshl_b32 s20, s16, 8
s_lshl_b32 s21, s17, 6
s_add_u32 s20, s20, s21
v_add_u32 v1, s20, v1
v_lshlrev_b32 v2, 4, v64
v_lshl_add_u32 v2, v65, 2, v2
v_mul_u32_u24 v2, 1152, v2
s_mul_i32 s20, s16, 147456
v_add_u32 v2, s20, v2
v_and_b32 v4, 15, v0
s_lshl_b32 s20, s17, 4
v_add_u32 v4, s20, v4
v_lshlrev_b32 v4, 1, v4
v_add_u32 v2, v2, v4
v_add_u32 v4, v2, v4
s_mov_b32 s12, s88
s_and_b32 s13, s89, 0xffff
s_mov_b32 s14, 4718592
s_mov_b32 s15, 0x20000
s_mov_b32 s48, s90
s_and_b32 s49, s91, 0xffff
s_mov_b32 s50, 4718592
s_mov_b32 s51, 0x20000
s_mov_b32 s52, s92
s_and_b32 s53, s93, 0xffff
s_mov_b32 s54, 4718592
s_mov_b32 s55, 0x20000
s_mov_b32 s84, s94
s_and_b32 s85, s95, 0xffff
s_mov_b32 s86, 4718592
s_mov_b32 s87, 0x20000
s_mov_b32 s23, 8192
s_mov_b32 s24, 32768
s_mov_b32 s25, 40960
s_mov_b32 s26, 65536
s_mov_b32 s27, 73728
s_mov_b32 s29, 98304
s_mov_b32 s31, 106496
s_mov_b32 s32, 262144
s_mov_b32 s33, 270336
s_mov_b32 s34, 294912
s_mov_b32 s35, 303104
s_mov_b32 s36, 327680
s_mov_b32 s37, 335872
s_mov_b32 s38, 360448
s_mov_b32 s39, 368640
s_mov_b32 s44, 524288
s_barrier
buffer_load_dword v6, v1, s[48:51], 0 offen
buffer_load_dword v7, v1, s[48:51], s24 offen
buffer_load_dword v8, v1, s[48:51], s26 offen
buffer_load_dword v9, v1, s[48:51], s29 offen
buffer_load_dword v10, v1, s[48:51], s23 offen
buffer_load_dword v11, v1, s[48:51], s25 offen
buffer_load_dword v12, v1, s[48:51], s27 offen
buffer_load_dword v13, v1, s[48:51], s31 offen
s_barrier
buffer_load_dword v14, v1, s[48:51], s32 offen
buffer_load_dword v15, v1, s[48:51], s34 offen
buffer_load_dword v16, v1, s[48:51], s36 offen
buffer_load_dword v17, v1, s[48:51], s38 offen
buffer_load_dword v18, v1, s[48:51], s33 offen
buffer_load_dword v19, v1, s[48:51], s35 offen
buffer_load_dword v20, v1, s[48:51], s37 offen
buffer_load_dword v21, v1, s[48:51], s39 offen
s_barrier
buffer_load_dword v22, v1, s[52:55], 0 offen
buffer_load_dword v23, v1, s[52:55], s24 offen
buffer_load_dword v24, v1, s[52:55], s26 offen
buffer_load_dword v25, v1, s[52:55], s29 offen
buffer_load_dword v26, v1, s[52:55], s23 offen
buffer_load_dword v27, v1, s[52:55], s25 offen
buffer_load_dword v28, v1, s[52:55], s27 offen
buffer_load_dword v29, v1, s[52:55], s31 offen
s_barrier
buffer_load_dword v30, v1, s[52:55], s32 offen
buffer_load_dword v31, v1, s[52:55], s34 offen
buffer_load_dword v32, v1, s[52:55], s36 offen
buffer_load_dword v33, v1, s[52:55], s38 offen
buffer_load_dword v34, v1, s[52:55], s33 offen
buffer_load_dword v35, v1, s[52:55], s35 offen
buffer_load_dword v36, v1, s[52:55], s37 offen
buffer_load_dword v37, v1, s[52:55], s39 offen
s_barrier
v_add_u32 v1, s44, v1
buffer_load_dword v38, v1, s[48:51], 0 offen
buffer_load_dword v39, v1, s[48:51], s24 offen
buffer_load_dword v40, v1, s[48:51], s26 offen
buffer_load_dword v41, v1, s[48:51], s29 offen
buffer_load_dword v42, v1, s[48:51], s23 offen
buffer_load_dword v43, v1, s[48:51], s25 offen
buffer_load_dword v44, v1, s[48:51], s27 offen
buffer_load_dword v45, v1, s[48:51], s31 offen
s_barrier
buffer_load_dword v46, v1, s[48:51], s32 offen
buffer_load_dword v47, v1, s[48:51], s34 offen
buffer_load_dword v48, v1, s[48:51], s36 offen
buffer_load_dword v49, v1, s[48:51], s38 offen
buffer_load_dword v50, v1, s[48:51], s33 offen
buffer_load_dword v51, v1, s[48:51], s35 offen
buffer_load_dword v52, v1, s[48:51], s37 offen
buffer_load_dword v53, v1, s[48:51], s39 offen
s_barrier
buffer_load_dword v54, v1, s[52:55], 0 offen
buffer_load_dword v55, v1, s[52:55], s24 offen
buffer_load_dword v56, v1, s[52:55], s26 offen
buffer_load_dword v57, v1, s[52:55], s29 offen
buffer_load_dword v58, v1, s[52:55], s23 offen
buffer_load_dword v59, v1, s[52:55], s25 offen
buffer_load_dword v60, v1, s[52:55], s27 offen
buffer_load_dword v61, v1, s[52:55], s31 offen
s_waitcnt vmcnt(54)
v_perm_b32 v88, v7, v6, s46
v_perm_b32 v68, v7, v6, s47
s_barrier
buffer_load_dword v6, v1, s[52:55], s32 offen
buffer_load_dword v7, v1, s[52:55], s34 offen
s_waitcnt vmcnt(54)
v_perm_b32 v89, v9, v8, s46
v_perm_b32 v69, v9, v8, s47
buffer_load_dword v8, v1, s[52:55], s36 offen
buffer_load_dword v9, v1, s[52:55], s38 offen
s_waitcnt vmcnt(54)
v_perm_b32 v90, v11, v10, s46
v_perm_b32 v70, v11, v10, s47
buffer_load_dword v10, v1, s[52:55], s33 offen
buffer_load_dword v11, v1, s[52:55], s35 offen
s_waitcnt vmcnt(54)
v_perm_b32 v91, v13, v12, s46
v_perm_b32 v71, v13, v12, s47
ds_write_b128 v3, v[68:71]
s_waitcnt lgkmcnt(0)
buffer_load_dword v12, v1, s[52:55], s37 offen
buffer_load_dword v13, v1, s[52:55], s39 offen
s_waitcnt vmcnt(54)
v_perm_b32 v92, v15, v14, s46
v_perm_b32 v68, v15, v14, s47
s_barrier
s_cmp_eq_u32 s17, 0
s_cselect_b32 s98, 64, 536870912
v_mov_b32 v5, 1
s_mov_b64 exec, 1
buffer_atomic_add v5, v0, s[56:59], s98 offen
s_mov_b64 exec, -1
v_add_u32 v1, s44, v1
buffer_load_dword v14, v1, s[48:51], 0 offen
buffer_load_dword v15, v1, s[48:51], s24 offen
s_waitcnt vmcnt(55)
v_perm_b32 v93, v17, v16, s46
v_perm_b32 v69, v17, v16, s47
buffer_load_dword v16, v1, s[48:51], s26 offen
buffer_load_dword v17, v1, s[48:51], s29 offen
s_waitcnt vmcnt(55)
v_perm_b32 v94, v19, v18, s46
v_perm_b32 v70, v19, v18, s47
buffer_load_dword v18, v1, s[48:51], s23 offen
buffer_load_dword v19, v1, s[48:51], s25 offen
s_waitcnt vmcnt(55)
v_perm_b32 v95, v21, v20, s46
v_perm_b32 v71, v21, v20, s47
ds_write_b128 v3, v[68:71] offset:1024
s_waitcnt lgkmcnt(0)
buffer_load_dword v20, v1, s[48:51], s27 offen
buffer_load_dword v21, v1, s[48:51], s31 offen
s_waitcnt vmcnt(55)
v_perm_b32 v64, v23, v22, s46
v_accvgpr_write_b32 a32, v64
v_perm_b32 v68, v23, v22, s47
v_accvgpr_write_b32 a40, v68
s_barrier
buffer_load_dword v22, v1, s[48:51], s32 offen
buffer_load_dword v23, v1, s[48:51], s34 offen
s_waitcnt vmcnt(55)
v_perm_b32 v65, v25, v24, s46
v_accvgpr_write_b32 a33, v65
v_perm_b32 v69, v25, v24, s47
v_accvgpr_write_b32 a41, v69
buffer_load_dword v24, v1, s[48:51], s36 offen
buffer_load_dword v25, v1, s[48:51], s38 offen
s_waitcnt vmcnt(55)
v_perm_b32 v66, v27, v26, s46
v_accvgpr_write_b32 a34, v66
v_perm_b32 v70, v27, v26, s47
v_accvgpr_write_b32 a42, v70
buffer_load_dword v26, v1, s[48:51], s33 offen
buffer_load_dword v27, v1, s[48:51], s35 offen
s_waitcnt vmcnt(55)
v_perm_b32 v67, v29, v28, s46
v_accvgpr_write_b32 a35, v67
v_perm_b32 v71, v29, v28, s47
v_accvgpr_write_b32 a43, v71
buffer_load_dword v28, v1, s[48:51], s37 offen
buffer_load_dword v29, v1, s[48:51], s39 offen
s_waitcnt vmcnt(55)
v_perm_b32 v64, v31, v30, s46
v_accvgpr_write_b32 a36, v64
v_perm_b32 v68, v31, v30, s47
v_accvgpr_write_b32 a44, v68
s_barrier
buffer_load_dword v30, v1, s[52:55], 0 offen
buffer_load_dword v31, v1, s[52:55], s24 offen
s_waitcnt vmcnt(55)
v_perm_b32 v65, v33, v32, s46
v_accvgpr_write_b32 a37, v65
v_perm_b32 v69, v33, v32, s47
v_accvgpr_write_b32 a45, v69
buffer_load_dword v32, v1, s[52:55], s26 offen
buffer_load_dword v33, v1, s[52:55], s29 offen
s_waitcnt vmcnt(55)
v_perm_b32 v66, v35, v34, s46
v_accvgpr_write_b32 a38, v66
v_perm_b32 v70, v35, v34, s47
v_accvgpr_write_b32 a46, v70
buffer_load_dword v34, v1, s[52:55], s23 offen
buffer_load_dword v35, v1, s[52:55], s25 offen
s_waitcnt vmcnt(55)
v_perm_b32 v67, v37, v36, s46
v_accvgpr_write_b32 a39, v67
v_perm_b32 v71, v37, v36, s47
v_accvgpr_write_b32 a47, v71
buffer_load_dword v36, v1, s[52:55], s27 offen
buffer_load_dword v37, v1, s[52:55], s31 offen
s_waitcnt vmcnt(55)
v_perm_b32 v112, v39, v38, s46
v_perm_b32 v68, v39, v38, s47
s_barrier
buffer_load_dword v38, v1, s[52:55], s32 offen
buffer_load_dword v39, v1, s[52:55], s34 offen
s_waitcnt vmcnt(55)
v_perm_b32 v113, v41, v40, s46
v_perm_b32 v69, v41, v40, s47
buffer_load_dword v40, v1, s[52:55], s36 offen
buffer_load_dword v41, v1, s[52:55], s38 offen
s_waitcnt vmcnt(55)
v_perm_b32 v114, v43, v42, s46
v_perm_b32 v70, v43, v42, s47
buffer_load_dword v42, v1, s[52:55], s33 offen
buffer_load_dword v43, v1, s[52:55], s35 offen
s_waitcnt vmcnt(55)
v_perm_b32 v115, v45, v44, s46
v_perm_b32 v71, v45, v44, s47
ds_write_b128 v3, v[68:71] offset:2048
s_waitcnt lgkmcnt(0)
buffer_load_dword v44, v1, s[52:55], s37 offen
buffer_load_dword v45, v1, s[52:55], s39 offen
s_waitcnt vmcnt(55)
v_perm_b32 v116, v47, v46, s46
v_perm_b32 v68, v47, v46, s47
s_barrier
v_add_u32 v1, s44, v1
buffer_load_dword v46, v1, s[48:51], 0 offen
buffer_load_dword v47, v1, s[48:51], s24 offen
s_waitcnt vmcnt(55)
v_perm_b32 v117, v49, v48, s46
v_perm_b32 v69, v49, v48, s47
buffer_load_dword v48, v1, s[48:51], s26 offen
buffer_load_dword v49, v1, s[48:51], s29 offen
s_waitcnt vmcnt(55)
v_perm_b32 v118, v51, v50, s46
v_perm_b32 v70, v51, v50, s47
buffer_load_dword v50, v1, s[48:51], s23 offen
buffer_load_dword v51, v1, s[48:51], s25 offen
s_waitcnt vmcnt(55)
v_perm_b32 v119, v53, v52, s46
v_perm_b32 v71, v53, v52, s47
ds_write_b128 v3, v[68:71] offset:3072
s_waitcnt lgkmcnt(0)
buffer_load_dword v52, v1, s[48:51], s27 offen
buffer_load_dword v53, v1, s[48:51], s31 offen
s_waitcnt vmcnt(55)
v_perm_b32 v64, v55, v54, s46
v_accvgpr_write_b32 a48, v64
v_perm_b32 v68, v55, v54, s47
v_accvgpr_write_b32 a56, v68
s_barrier
buffer_load_dword v54, v1, s[48:51], s32 offen
buffer_load_dword v55, v1, s[48:51], s34 offen
s_waitcnt vmcnt(55)
v_perm_b32 v65, v57, v56, s46
v_accvgpr_write_b32 a49, v65
v_perm_b32 v69, v57, v56, s47
v_accvgpr_write_b32 a57, v69
buffer_load_dword v56, v1, s[48:51], s36 offen
buffer_load_dword v57, v1, s[48:51], s38 offen
s_waitcnt vmcnt(55)
v_perm_b32 v66, v59, v58, s46
v_accvgpr_write_b32 a50, v66
v_perm_b32 v70, v59, v58, s47
v_accvgpr_write_b32 a58, v70
buffer_load_dword v58, v1, s[48:51], s33 offen
buffer_load_dword v59, v1, s[48:51], s35 offen
s_waitcnt vmcnt(55)
v_perm_b32 v67, v61, v60, s46
v_accvgpr_write_b32 a51, v67
v_perm_b32 v71, v61, v60, s47
v_accvgpr_write_b32 a59, v71
buffer_load_dword v60, v1, s[48:51], s37 offen
buffer_load_dword v61, v1, s[48:51], s39 offen
s_waitcnt vmcnt(55)
v_perm_b32 v64, v7, v6, s46
v_accvgpr_write_b32 a52, v64
v_perm_b32 v68, v7, v6, s47
v_accvgpr_write_b32 a60, v68
s_barrier
buffer_load_dword v6, v1, s[52:55], 0 offen
buffer_load_dword v7, v1, s[52:55], s24 offen
s_waitcnt vmcnt(55)
v_perm_b32 v65, v9, v8, s46
v_accvgpr_write_b32 a53, v65
v_perm_b32 v69, v9, v8, s47
v_accvgpr_write_b32 a61, v69
buffer_load_dword v8, v1, s[52:55], s26 offen
buffer_load_dword v9, v1, s[52:55], s29 offen
s_waitcnt vmcnt(55)
v_perm_b32 v66, v11, v10, s46
v_accvgpr_write_b32 a54, v66
v_perm_b32 v70, v11, v10, s47
v_accvgpr_write_b32 a62, v70
buffer_load_dword v10, v1, s[52:55], s23 offen
buffer_load_dword v11, v1, s[52:55], s25 offen
s_waitcnt vmcnt(55)
v_perm_b32 v67, v13, v12, s46
v_accvgpr_write_b32 a55, v67
v_perm_b32 v71, v13, v12, s47
v_accvgpr_write_b32 a63, v71
buffer_load_dword v12, v1, s[52:55], s27 offen
buffer_load_dword v13, v1, s[52:55], s31 offen
s_waitcnt vmcnt(54)
v_perm_b32 v136, v15, v14, s46
v_perm_b32 v68, v15, v14, s47
s_barrier
buffer_load_dword v14, v1, s[52:55], s32 offen
buffer_load_dword v15, v1, s[52:55], s34 offen
s_waitcnt vmcnt(54)
v_perm_b32 v137, v17, v16, s46
v_perm_b32 v69, v17, v16, s47
buffer_load_dword v16, v1, s[52:55], s36 offen
buffer_load_dword v17, v1, s[52:55], s38 offen
s_waitcnt vmcnt(54)
v_perm_b32 v138, v19, v18, s46
v_perm_b32 v70, v19, v18, s47
buffer_load_dword v18, v1, s[52:55], s33 offen
buffer_load_dword v19, v1, s[52:55], s35 offen
s_waitcnt vmcnt(54)
v_perm_b32 v139, v21, v20, s46
v_perm_b32 v71, v21, v20, s47
ds_write_b128 v3, v[68:71] offset:4096
s_waitcnt lgkmcnt(0)
buffer_load_dword v20, v1, s[52:55], s37 offen
buffer_load_dword v21, v1, s[52:55], s39 offen
s_waitcnt vmcnt(54)
v_perm_b32 v140, v23, v22, s46
v_perm_b32 v68, v23, v22, s47
s_barrier
v_add_u32 v1, s44, v1
buffer_load_dword v22, v1, s[48:51], 0 offen
buffer_load_dword v23, v1, s[48:51], s24 offen
s_waitcnt vmcnt(54)
v_perm_b32 v141, v25, v24, s46
v_perm_b32 v69, v25, v24, s47
buffer_load_dword v24, v1, s[48:51], s26 offen
buffer_load_dword v25, v1, s[48:51], s29 offen
s_waitcnt vmcnt(54)
v_perm_b32 v142, v27, v26, s46
v_perm_b32 v70, v27, v26, s47
buffer_load_dword v26, v1, s[48:51], s23 offen
buffer_load_dword v27, v1, s[48:51], s25 offen
s_waitcnt vmcnt(54)
v_perm_b32 v143, v29, v28, s46
v_perm_b32 v71, v29, v28, s47
ds_write_b128 v3, v[68:71] offset:5120
s_waitcnt lgkmcnt(0)
buffer_load_dword v28, v1, s[48:51], s27 offen
buffer_load_dword v29, v1, s[48:51], s31 offen
s_waitcnt vmcnt(54)
v_perm_b32 v64, v31, v30, s46
v_accvgpr_write_b32 a64, v64
v_perm_b32 v68, v31, v30, s47
v_accvgpr_write_b32 a72, v68
s_barrier
buffer_load_dword v30, v1, s[48:51], s32 offen
buffer_load_dword v31, v1, s[48:51], s34 offen
s_waitcnt vmcnt(54)
v_perm_b32 v65, v33, v32, s46
v_accvgpr_write_b32 a65, v65
v_perm_b32 v69, v33, v32, s47
v_accvgpr_write_b32 a73, v69
buffer_load_dword v32, v1, s[48:51], s36 offen
buffer_load_dword v33, v1, s[48:51], s38 offen
s_waitcnt vmcnt(54)
v_perm_b32 v66, v35, v34, s46
v_accvgpr_write_b32 a66, v66
v_perm_b32 v70, v35, v34, s47
v_accvgpr_write_b32 a74, v70
buffer_load_dword v34, v1, s[48:51], s33 offen
buffer_load_dword v35, v1, s[48:51], s35 offen
s_waitcnt vmcnt(54)
v_perm_b32 v67, v37, v36, s46
v_accvgpr_write_b32 a67, v67
v_perm_b32 v71, v37, v36, s47
v_accvgpr_write_b32 a75, v71
buffer_load_dword v36, v1, s[48:51], s37 offen
buffer_load_dword v37, v1, s[48:51], s39 offen
s_waitcnt vmcnt(54)
v_perm_b32 v64, v39, v38, s46
v_accvgpr_write_b32 a68, v64
v_perm_b32 v68, v39, v38, s47
v_accvgpr_write_b32 a76, v68
s_barrier
buffer_load_dword v38, v1, s[52:55], 0 offen
buffer_load_dword v39, v1, s[52:55], s24 offen
s_waitcnt vmcnt(54)
v_perm_b32 v65, v41, v40, s46
v_accvgpr_write_b32 a69, v65
v_perm_b32 v69, v41, v40, s47
v_accvgpr_write_b32 a77, v69
buffer_load_dword v40, v1, s[52:55], s26 offen
buffer_load_dword v41, v1, s[52:55], s29 offen
s_waitcnt vmcnt(54)
v_perm_b32 v66, v43, v42, s46
v_accvgpr_write_b32 a70, v66
v_perm_b32 v70, v43, v42, s47
v_accvgpr_write_b32 a78, v70
buffer_load_dword v42, v1, s[52:55], s23 offen
buffer_load_dword v43, v1, s[52:55], s25 offen
s_waitcnt vmcnt(54)
v_perm_b32 v67, v45, v44, s46
v_accvgpr_write_b32 a71, v67
v_perm_b32 v71, v45, v44, s47
v_accvgpr_write_b32 a79, v71
buffer_load_dword v44, v1, s[52:55], s27 offen
buffer_load_dword v45, v1, s[52:55], s31 offen
s_waitcnt vmcnt(54)
v_perm_b32 v160, v47, v46, s46
v_perm_b32 v68, v47, v46, s47
s_barrier
buffer_load_dword v46, v1, s[52:55], s32 offen
buffer_load_dword v47, v1, s[52:55], s34 offen
s_waitcnt vmcnt(54)
v_perm_b32 v161, v49, v48, s46
v_perm_b32 v69, v49, v48, s47
buffer_load_dword v48, v1, s[52:55], s36 offen
buffer_load_dword v49, v1, s[52:55], s38 offen
s_waitcnt vmcnt(54)
v_perm_b32 v162, v51, v50, s46
v_perm_b32 v70, v51, v50, s47
buffer_load_dword v50, v1, s[52:55], s33 offen
buffer_load_dword v51, v1, s[52:55], s35 offen
s_waitcnt vmcnt(54)
v_perm_b32 v163, v53, v52, s46
v_perm_b32 v71, v53, v52, s47
ds_write_b128 v3, v[68:71] offset:6144
s_waitcnt lgkmcnt(0)
buffer_load_dword v52, v1, s[52:55], s37 offen
buffer_load_dword v53, v1, s[52:55], s39 offen
s_waitcnt vmcnt(54)
v_perm_b32 v164, v55, v54, s46
v_perm_b32 v68, v55, v54, s47
s_barrier
v_add_u32 v1, s44, v1
buffer_load_dword v54, v1, s[48:51], 0 offen
buffer_load_dword v55, v1, s[48:51], s24 offen
s_waitcnt vmcnt(54)
v_perm_b32 v165, v57, v56, s46
v_perm_b32 v69, v57, v56, s47
buffer_load_dword v56, v1, s[48:51], s26 offen
buffer_load_dword v57, v1, s[48:51], s29 offen
s_waitcnt vmcnt(54)
v_perm_b32 v166, v59, v58, s46
v_perm_b32 v70, v59, v58, s47
buffer_load_dword v58, v1, s[48:51], s23 offen
buffer_load_dword v59, v1, s[48:51], s25 offen
s_waitcnt vmcnt(54)
v_perm_b32 v167, v61, v60, s46
v_perm_b32 v71, v61, v60, s47
ds_write_b128 v3, v[68:71] offset:7168
s_waitcnt lgkmcnt(0)
buffer_load_dword v60, v1, s[48:51], s27 offen
buffer_load_dword v61, v1, s[48:51], s31 offen
s_waitcnt vmcnt(54)
v_perm_b32 v64, v7, v6, s46
v_accvgpr_write_b32 a80, v64
v_perm_b32 v68, v7, v6, s47
v_accvgpr_write_b32 a88, v68
s_barrier
buffer_load_dword v6, v1, s[48:51], s32 offen
buffer_load_dword v7, v1, s[48:51], s34 offen
s_waitcnt vmcnt(54)
v_perm_b32 v65, v9, v8, s46
v_accvgpr_write_b32 a81, v65
v_perm_b32 v69, v9, v8, s47
v_accvgpr_write_b32 a89, v69
buffer_load_dword v8, v1, s[48:51], s36 offen
buffer_load_dword v9, v1, s[48:51], s38 offen
s_waitcnt vmcnt(54)
v_perm_b32 v66, v11, v10, s46
v_accvgpr_write_b32 a82, v66
v_perm_b32 v70, v11, v10, s47
v_accvgpr_write_b32 a90, v70
buffer_load_dword v10, v1, s[48:51], s33 offen
buffer_load_dword v11, v1, s[48:51], s35 offen
s_waitcnt vmcnt(54)
v_perm_b32 v67, v13, v12, s46
v_accvgpr_write_b32 a83, v67
v_perm_b32 v71, v13, v12, s47
v_accvgpr_write_b32 a91, v71
buffer_load_dword v12, v1, s[48:51], s37 offen
buffer_load_dword v13, v1, s[48:51], s39 offen
s_waitcnt vmcnt(54)
v_perm_b32 v64, v15, v14, s46
v_accvgpr_write_b32 a84, v64
v_perm_b32 v68, v15, v14, s47
v_accvgpr_write_b32 a92, v68
s_barrier
buffer_load_dword v14, v1, s[52:55], 0 offen
buffer_load_dword v15, v1, s[52:55], s24 offen
s_waitcnt vmcnt(54)
v_perm_b32 v65, v17, v16, s46
v_accvgpr_write_b32 a85, v65
v_perm_b32 v69, v17, v16, s47
v_accvgpr_write_b32 a93, v69
buffer_load_dword v16, v1, s[52:55], s26 offen
buffer_load_dword v17, v1, s[52:55], s29 offen
s_waitcnt vmcnt(54)
v_perm_b32 v66, v19, v18, s46
v_accvgpr_write_b32 a86, v66
v_perm_b32 v70, v19, v18, s47
v_accvgpr_write_b32 a94, v70
buffer_load_dword v18, v1, s[52:55], s23 offen
buffer_load_dword v19, v1, s[52:55], s25 offen
s_waitcnt vmcnt(54)
v_perm_b32 v67, v21, v20, s46
v_accvgpr_write_b32 a87, v67
v_perm_b32 v71, v21, v20, s47
v_accvgpr_write_b32 a95, v71
buffer_load_dword v20, v1, s[52:55], s27 offen
buffer_load_dword v21, v1, s[52:55], s31 offen
s_waitcnt vmcnt(54)
v_perm_b32 v184, v23, v22, s46
v_perm_b32 v68, v23, v22, s47
s_barrier
buffer_load_dword v22, v1, s[52:55], s32 offen
buffer_load_dword v23, v1, s[52:55], s34 offen
s_waitcnt vmcnt(54)
v_perm_b32 v185, v25, v24, s46
v_perm_b32 v69, v25, v24, s47
buffer_load_dword v24, v1, s[52:55], s36 offen
buffer_load_dword v25, v1, s[52:55], s38 offen
s_waitcnt vmcnt(54)
v_perm_b32 v186, v27, v26, s46
v_perm_b32 v70, v27, v26, s47
buffer_load_dword v26, v1, s[52:55], s33 offen
buffer_load_dword v27, v1, s[52:55], s35 offen
s_waitcnt vmcnt(54)
v_perm_b32 v187, v29, v28, s46
v_perm_b32 v71, v29, v28, s47
ds_write_b128 v3, v[68:71] offset:8192
s_waitcnt lgkmcnt(0)
buffer_load_dword v28, v1, s[52:55], s37 offen
buffer_load_dword v29, v1, s[52:55], s39 offen
s_waitcnt vmcnt(54)
v_perm_b32 v188, v31, v30, s46
v_perm_b32 v68, v31, v30, s47
s_barrier
v_add_u32 v1, s44, v1
buffer_load_dword v30, v1, s[48:51], 0 offen
buffer_load_dword v31, v1, s[48:51], s24 offen
s_waitcnt vmcnt(54)
v_perm_b32 v189, v33, v32, s46
v_perm_b32 v69, v33, v32, s47
buffer_load_dword v32, v1, s[48:51], s26 offen
buffer_load_dword v33, v1, s[48:51], s29 offen
s_waitcnt vmcnt(54)
v_perm_b32 v190, v35, v34, s46
v_perm_b32 v70, v35, v34, s47
buffer_load_dword v34, v1, s[48:51], s23 offen
buffer_load_dword v35, v1, s[48:51], s25 offen
s_waitcnt vmcnt(54)
v_perm_b32 v191, v37, v36, s46
v_perm_b32 v71, v37, v36, s47
ds_write_b128 v3, v[68:71] offset:9216
s_waitcnt lgkmcnt(0)
buffer_load_dword v36, v1, s[48:51], s27 offen
buffer_load_dword v37, v1, s[48:51], s31 offen
s_waitcnt vmcnt(54)
v_perm_b32 v64, v39, v38, s46
v_accvgpr_write_b32 a96, v64
v_perm_b32 v68, v39, v38, s47
v_accvgpr_write_b32 a104, v68
s_barrier
buffer_load_dword v38, v1, s[48:51], s32 offen
buffer_load_dword v39, v1, s[48:51], s34 offen
s_waitcnt vmcnt(54)
v_perm_b32 v65, v41, v40, s46
v_accvgpr_write_b32 a97, v65
v_perm_b32 v69, v41, v40, s47
v_accvgpr_write_b32 a105, v69
buffer_load_dword v40, v1, s[48:51], s36 offen
buffer_load_dword v41, v1, s[48:51], s38 offen
s_waitcnt vmcnt(54)
v_perm_b32 v66, v43, v42, s46
v_accvgpr_write_b32 a98, v66
v_perm_b32 v70, v43, v42, s47
v_accvgpr_write_b32 a106, v70
buffer_load_dword v42, v1, s[48:51], s33 offen
buffer_load_dword v43, v1, s[48:51], s35 offen
s_waitcnt vmcnt(54)
v_perm_b32 v67, v45, v44, s46
v_accvgpr_write_b32 a99, v67
v_perm_b32 v71, v45, v44, s47
v_accvgpr_write_b32 a107, v71
buffer_load_dword v44, v1, s[48:51], s37 offen
buffer_load_dword v45, v1, s[48:51], s39 offen
s_waitcnt vmcnt(54)
v_perm_b32 v64, v47, v46, s46
v_accvgpr_write_b32 a100, v64
v_perm_b32 v68, v47, v46, s47
v_accvgpr_write_b32 a108, v68
s_barrier
buffer_load_dword v46, v1, s[52:55], 0 offen
buffer_load_dword v47, v1, s[52:55], s24 offen
s_waitcnt vmcnt(54)
v_perm_b32 v65, v49, v48, s46
v_accvgpr_write_b32 a101, v65
v_perm_b32 v69, v49, v48, s47
v_accvgpr_write_b32 a109, v69
buffer_load_dword v48, v1, s[52:55], s26 offen
buffer_load_dword v49, v1, s[52:55], s29 offen
s_waitcnt vmcnt(54)
v_perm_b32 v66, v51, v50, s46
v_accvgpr_write_b32 a102, v66
v_perm_b32 v70, v51, v50, s47
v_accvgpr_write_b32 a110, v70
buffer_load_dword v50, v1, s[52:55], s23 offen
buffer_load_dword v51, v1, s[52:55], s25 offen
s_waitcnt vmcnt(54)
v_perm_b32 v67, v53, v52, s46
v_accvgpr_write_b32 a103, v67
v_perm_b32 v71, v53, v52, s47
v_accvgpr_write_b32 a111, v71
buffer_load_dword v52, v1, s[52:55], s27 offen
buffer_load_dword v53, v1, s[52:55], s31 offen
s_waitcnt vmcnt(54)
v_perm_b32 v208, v55, v54, s46
v_perm_b32 v68, v55, v54, s47
s_barrier
buffer_load_dword v54, v1, s[52:55], s32 offen
buffer_load_dword v55, v1, s[52:55], s34 offen
s_waitcnt vmcnt(54)
v_perm_b32 v209, v57, v56, s46
v_perm_b32 v69, v57, v56, s47
buffer_load_dword v56, v1, s[52:55], s36 offen
buffer_load_dword v57, v1, s[52:55], s38 offen
s_waitcnt vmcnt(54)
v_perm_b32 v210, v59, v58, s46
v_perm_b32 v70, v59, v58, s47
buffer_load_dword v58, v1, s[52:55], s33 offen
buffer_load_dword v59, v1, s[52:55], s35 offen
s_waitcnt vmcnt(54)
v_perm_b32 v211, v61, v60, s46
v_perm_b32 v71, v61, v60, s47
ds_write_b128 v3, v[68:71] offset:10240
s_waitcnt lgkmcnt(0)
buffer_load_dword v60, v1, s[52:55], s37 offen
buffer_load_dword v61, v1, s[52:55], s39 offen
s_waitcnt vmcnt(54)
v_perm_b32 v212, v7, v6, s46
v_perm_b32 v68, v7, v6, s47
s_barrier
v_add_u32 v1, s44, v1
buffer_load_dword v6, v1, s[48:51], 0 offen
buffer_load_dword v7, v1, s[48:51], s24 offen
s_waitcnt vmcnt(54)
v_perm_b32 v213, v9, v8, s46
v_perm_b32 v69, v9, v8, s47
buffer_load_dword v8, v1, s[48:51], s26 offen
buffer_load_dword v9, v1, s[48:51], s29 offen
s_waitcnt vmcnt(54)
v_perm_b32 v214, v11, v10, s46
v_perm_b32 v70, v11, v10, s47
buffer_load_dword v10, v1, s[48:51], s23 offen
buffer_load_dword v11, v1, s[48:51], s25 offen
s_waitcnt vmcnt(54)
v_perm_b32 v215, v13, v12, s46
v_perm_b32 v71, v13, v12, s47
ds_write_b128 v3, v[68:71] offset:11264
s_waitcnt lgkmcnt(0)
buffer_load_dword v12, v1, s[48:51], s27 offen
buffer_load_dword v13, v1, s[48:51], s31 offen
s_waitcnt vmcnt(54)
v_perm_b32 v64, v15, v14, s46
v_accvgpr_write_b32 a112, v64
v_perm_b32 v68, v15, v14, s47
v_accvgpr_write_b32 a120, v68
s_barrier
buffer_load_dword v14, v1, s[48:51], s32 offen
buffer_load_dword v15, v1, s[48:51], s34 offen
s_waitcnt vmcnt(54)
v_perm_b32 v65, v17, v16, s46
v_accvgpr_write_b32 a113, v65
v_perm_b32 v69, v17, v16, s47
v_accvgpr_write_b32 a121, v69
buffer_load_dword v16, v1, s[48:51], s36 offen
buffer_load_dword v17, v1, s[48:51], s38 offen
s_waitcnt vmcnt(54)
v_perm_b32 v66, v19, v18, s46
v_accvgpr_write_b32 a114, v66
v_perm_b32 v70, v19, v18, s47
v_accvgpr_write_b32 a122, v70
buffer_load_dword v18, v1, s[48:51], s33 offen
buffer_load_dword v19, v1, s[48:51], s35 offen
s_waitcnt vmcnt(54)
v_perm_b32 v67, v21, v20, s46
v_accvgpr_write_b32 a115, v67
v_perm_b32 v71, v21, v20, s47
v_accvgpr_write_b32 a123, v71
buffer_load_dword v20, v1, s[48:51], s37 offen
buffer_load_dword v21, v1, s[48:51], s39 offen
s_waitcnt vmcnt(54)
v_perm_b32 v64, v23, v22, s46
v_accvgpr_write_b32 a116, v64
v_perm_b32 v68, v23, v22, s47
v_accvgpr_write_b32 a124, v68
s_barrier
buffer_load_dword v22, v1, s[52:55], 0 offen
buffer_load_dword v23, v1, s[52:55], s24 offen
s_waitcnt vmcnt(54)
v_perm_b32 v65, v25, v24, s46
v_accvgpr_write_b32 a117, v65
v_perm_b32 v69, v25, v24, s47
v_accvgpr_write_b32 a125, v69
buffer_load_dword v24, v1, s[52:55], s26 offen
buffer_load_dword v25, v1, s[52:55], s29 offen
s_waitcnt vmcnt(54)
v_perm_b32 v66, v27, v26, s46
v_accvgpr_write_b32 a118, v66
v_perm_b32 v70, v27, v26, s47
v_accvgpr_write_b32 a126, v70
buffer_load_dword v26, v1, s[52:55], s23 offen
buffer_load_dword v27, v1, s[52:55], s25 offen
s_waitcnt vmcnt(54)
v_perm_b32 v67, v29, v28, s46
v_accvgpr_write_b32 a119, v67
v_perm_b32 v71, v29, v28, s47
v_accvgpr_write_b32 a127, v71
buffer_load_dword v28, v1, s[52:55], s27 offen
buffer_load_dword v29, v1, s[52:55], s31 offen
s_waitcnt vmcnt(54)
v_perm_b32 v232, v31, v30, s46
v_perm_b32 v68, v31, v30, s47
s_barrier
buffer_load_dword v30, v1, s[52:55], s32 offen
buffer_load_dword v31, v1, s[52:55], s34 offen
s_waitcnt vmcnt(54)
v_perm_b32 v233, v33, v32, s46
v_perm_b32 v69, v33, v32, s47
buffer_load_dword v32, v1, s[52:55], s36 offen
buffer_load_dword v33, v1, s[52:55], s38 offen
s_waitcnt vmcnt(54)
v_perm_b32 v234, v35, v34, s46
v_perm_b32 v70, v35, v34, s47
buffer_load_dword v34, v1, s[52:55], s33 offen
buffer_load_dword v35, v1, s[52:55], s35 offen
s_waitcnt vmcnt(54)
v_perm_b32 v235, v37, v36, s46
v_perm_b32 v71, v37, v36, s47
ds_write_b128 v3, v[68:71] offset:12288
s_waitcnt lgkmcnt(0)
buffer_load_dword v36, v1, s[52:55], s37 offen
buffer_load_dword v37, v1, s[52:55], s39 offen
s_waitcnt vmcnt(54)
v_perm_b32 v236, v39, v38, s46
v_perm_b32 v68, v39, v38, s47
s_barrier
v_add_u32 v1, s44, v1
buffer_load_dword v38, v1, s[48:51], 0 offen
buffer_load_dword v39, v1, s[48:51], s24 offen
s_waitcnt vmcnt(54)
v_perm_b32 v237, v41, v40, s46
v_perm_b32 v69, v41, v40, s47
buffer_load_dword v40, v1, s[48:51], s26 offen
buffer_load_dword v41, v1, s[48:51], s29 offen
s_waitcnt vmcnt(54)
v_perm_b32 v238, v43, v42, s46
v_perm_b32 v70, v43, v42, s47
buffer_load_dword v42, v1, s[48:51], s23 offen
buffer_load_dword v43, v1, s[48:51], s25 offen
s_waitcnt vmcnt(54)
v_perm_b32 v239, v45, v44, s46
v_perm_b32 v71, v45, v44, s47
ds_write_b128 v3, v[68:71] offset:13312
s_waitcnt lgkmcnt(0)
buffer_load_dword v44, v1, s[48:51], s27 offen
buffer_load_dword v45, v1, s[48:51], s31 offen
s_waitcnt vmcnt(54)
v_perm_b32 v64, v47, v46, s46
v_accvgpr_write_b32 a128, v64
v_perm_b32 v68, v47, v46, s47
v_accvgpr_write_b32 a136, v68
s_barrier
buffer_load_dword v46, v1, s[48:51], s32 offen
buffer_load_dword v47, v1, s[48:51], s34 offen
s_waitcnt vmcnt(54)
v_perm_b32 v65, v49, v48, s46
v_accvgpr_write_b32 a129, v65
v_perm_b32 v69, v49, v48, s47
v_accvgpr_write_b32 a137, v69
buffer_load_dword v48, v1, s[48:51], s36 offen
buffer_load_dword v49, v1, s[48:51], s38 offen
s_waitcnt vmcnt(54)
v_perm_b32 v66, v51, v50, s46
v_accvgpr_write_b32 a130, v66
v_perm_b32 v70, v51, v50, s47
v_accvgpr_write_b32 a138, v70
buffer_load_dword v50, v1, s[48:51], s33 offen
buffer_load_dword v51, v1, s[48:51], s35 offen
s_waitcnt vmcnt(54)
v_perm_b32 v67, v53, v52, s46
v_accvgpr_write_b32 a131, v67
v_perm_b32 v71, v53, v52, s47
v_accvgpr_write_b32 a139, v71
buffer_load_dword v52, v1, s[48:51], s37 offen
buffer_load_dword v53, v1, s[48:51], s39 offen
s_waitcnt vmcnt(54)
v_perm_b32 v64, v55, v54, s46
v_accvgpr_write_b32 a132, v64
v_perm_b32 v68, v55, v54, s47
v_accvgpr_write_b32 a140, v68
s_barrier
buffer_load_dword v54, v1, s[52:55], 0 offen
buffer_load_dword v55, v1, s[52:55], s24 offen
s_waitcnt vmcnt(54)
v_perm_b32 v65, v57, v56, s46
v_accvgpr_write_b32 a133, v65
v_perm_b32 v69, v57, v56, s47
v_accvgpr_write_b32 a141, v69
buffer_load_dword v56, v1, s[52:55], s26 offen
buffer_load_dword v57, v1, s[52:55], s29 offen
s_waitcnt vmcnt(54)
v_perm_b32 v66, v59, v58, s46
v_accvgpr_write_b32 a134, v66
v_perm_b32 v70, v59, v58, s47
v_accvgpr_write_b32 a142, v70
buffer_load_dword v58, v1, s[52:55], s23 offen
buffer_load_dword v59, v1, s[52:55], s25 offen
s_waitcnt vmcnt(54)
v_perm_b32 v67, v61, v60, s46
v_accvgpr_write_b32 a135, v67
v_perm_b32 v71, v61, v60, s47
v_accvgpr_write_b32 a143, v71
buffer_load_dword v60, v1, s[52:55], s27 offen
buffer_load_dword v61, v1, s[52:55], s31 offen
s_waitcnt vmcnt(54)
v_perm_b32 v64, v7, v6, s46
v_accvgpr_write_b32 a0, v64
v_perm_b32 v68, v7, v6, s47
s_barrier
buffer_load_dword v6, v1, s[52:55], s32 offen
buffer_load_dword v7, v1, s[52:55], s34 offen
s_waitcnt vmcnt(54)
v_perm_b32 v65, v9, v8, s46
v_accvgpr_write_b32 a1, v65
v_perm_b32 v69, v9, v8, s47
buffer_load_dword v8, v1, s[52:55], s36 offen
buffer_load_dword v9, v1, s[52:55], s38 offen
s_waitcnt vmcnt(54)
v_perm_b32 v66, v11, v10, s46
v_accvgpr_write_b32 a2, v66
v_perm_b32 v70, v11, v10, s47
buffer_load_dword v10, v1, s[52:55], s33 offen
buffer_load_dword v11, v1, s[52:55], s35 offen
s_waitcnt vmcnt(54)
v_perm_b32 v67, v13, v12, s46
v_accvgpr_write_b32 a3, v67
v_perm_b32 v71, v13, v12, s47
ds_write_b128 v3, v[68:71] offset:14336
s_waitcnt lgkmcnt(0)
buffer_load_dword v12, v1, s[52:55], s37 offen
buffer_load_dword v13, v1, s[52:55], s39 offen
s_waitcnt vmcnt(54)
v_perm_b32 v64, v15, v14, s46
v_accvgpr_write_b32 a4, v64
v_perm_b32 v68, v15, v14, s47
s_barrier
s_mov_b32 s20, 0
s_mov_b32 s21, 9216
buffer_load_dword v14, v4, s[84:87], s20 offen
buffer_load_dword v15, v4, s[84:87], s20 offen offset:1152
s_waitcnt vmcnt(54)
v_perm_b32 v65, v17, v16, s46
v_accvgpr_write_b32 a5, v65
v_perm_b32 v69, v17, v16, s47
buffer_load_dword v16, v4, s[84:87], s21 offen
buffer_load_dword v17, v4, s[84:87], s21 offen offset:1152
s_waitcnt vmcnt(54)
v_perm_b32 v66, v19, v18, s46
v_accvgpr_write_b32 a6, v66
v_perm_b32 v70, v19, v18, s47
buffer_load_dword v18, v4, s[84:87], s20 offen offset:2304
buffer_load_dword v19, v4, s[84:87], s20 offen offset:3456
s_waitcnt vmcnt(54)
v_perm_b32 v67, v21, v20, s46
v_accvgpr_write_b32 a7, v67
v_perm_b32 v71, v21, v20, s47
ds_write_b128 v3, v[68:71] offset:15360
s_waitcnt lgkmcnt(0)
buffer_load_dword v20, v4, s[84:87], s21 offen offset:2304
buffer_load_dword v21, v4, s[84:87], s21 offen offset:3456
s_waitcnt vmcnt(54)
v_perm_b32 v64, v23, v22, s46
v_accvgpr_write_b32 a144, v64
v_perm_b32 v68, v23, v22, s47
v_accvgpr_write_b32 a152, v68
s_barrier
s_mov_b32 s20, 36864
s_mov_b32 s21, 46080
buffer_load_dword v22, v4, s[84:87], s20 offen
buffer_load_dword v23, v4, s[84:87], s20 offen offset:1152
s_waitcnt vmcnt(54)
v_perm_b32 v65, v25, v24, s46
v_accvgpr_write_b32 a145, v65
v_perm_b32 v69, v25, v24, s47
v_accvgpr_write_b32 a153, v69
buffer_load_dword v24, v4, s[84:87], s21 offen
buffer_load_dword v25, v4, s[84:87], s21 offen offset:1152
s_waitcnt vmcnt(54)
v_perm_b32 v66, v27, v26, s46
v_accvgpr_write_b32 a146, v66
v_perm_b32 v70, v27, v26, s47
v_accvgpr_write_b32 a154, v70
buffer_load_dword v26, v4, s[84:87], s20 offen offset:2304
buffer_load_dword v27, v4, s[84:87], s20 offen offset:3456
s_waitcnt vmcnt(54)
v_perm_b32 v67, v29, v28, s46
v_accvgpr_write_b32 a147, v67
v_perm_b32 v71, v29, v28, s47
v_accvgpr_write_b32 a155, v71
buffer_load_dword v28, v4, s[84:87], s21 offen offset:2304
buffer_load_dword v29, v4, s[84:87], s21 offen offset:3456
s_waitcnt vmcnt(54)
v_perm_b32 v64, v31, v30, s46
v_accvgpr_write_b32 a148, v64
v_perm_b32 v68, v31, v30, s47
v_accvgpr_write_b32 a156, v68
s_barrier
s_mov_b32 s20, 73728
s_mov_b32 s21, 82944
buffer_load_dword v30, v4, s[84:87], s20 offen
buffer_load_dword v31, v4, s[84:87], s20 offen offset:1152
s_waitcnt vmcnt(54)
v_perm_b32 v65, v33, v32, s46
v_accvgpr_write_b32 a149, v65
v_perm_b32 v69, v33, v32, s47
v_accvgpr_write_b32 a157, v69
buffer_load_dword v32, v4, s[84:87], s21 offen
buffer_load_dword v33, v4, s[84:87], s21 offen offset:1152
s_waitcnt vmcnt(54)
v_perm_b32 v66, v35, v34, s46
v_accvgpr_write_b32 a150, v66
v_perm_b32 v70, v35, v34, s47
v_accvgpr_write_b32 a158, v70
buffer_load_dword v34, v4, s[84:87], s20 offen offset:2304
buffer_load_dword v35, v4, s[84:87], s20 offen offset:3456
s_waitcnt vmcnt(54)
v_perm_b32 v67, v37, v36, s46
v_accvgpr_write_b32 a151, v67
v_perm_b32 v71, v37, v36, s47
v_accvgpr_write_b32 a159, v71
buffer_load_dword v36, v4, s[84:87], s21 offen offset:2304
buffer_load_dword v37, v4, s[84:87], s21 offen offset:3456
s_waitcnt vmcnt(54)
v_perm_b32 v64, v39, v38, s46
v_accvgpr_write_b32 a24, v64
v_perm_b32 v68, v39, v38, s47
s_barrier
s_mov_b32 s20, 110592
s_mov_b32 s21, 119808
buffer_load_dword v38, v4, s[84:87], s20 offen
buffer_load_dword v39, v4, s[84:87], s20 offen offset:1152
s_waitcnt vmcnt(54)
v_perm_b32 v65, v41, v40, s46
v_accvgpr_write_b32 a25, v65
v_perm_b32 v69, v41, v40, s47
buffer_load_dword v40, v4, s[84:87], s21 offen
buffer_load_dword v41, v4, s[84:87], s21 offen offset:1152
s_waitcnt vmcnt(54)
v_perm_b32 v66, v43, v42, s46
v_accvgpr_write_b32 a26, v66
v_perm_b32 v70, v43, v42, s47
buffer_load_dword v42, v4, s[84:87], s20 offen offset:2304
buffer_load_dword v43, v4, s[84:87], s20 offen offset:3456
s_waitcnt vmcnt(54)
v_perm_b32 v67, v45, v44, s46
v_accvgpr_write_b32 a27, v67
v_perm_b32 v71, v45, v44, s47
ds_write_b128 v3, v[68:71] offset:16384
s_waitcnt lgkmcnt(0)
buffer_load_dword v44, v4, s[84:87], s21 offen offset:2304
buffer_load_dword v45, v4, s[84:87], s21 offen offset:3456
s_waitcnt vmcnt(54)
v_perm_b32 v64, v47, v46, s46
v_accvgpr_write_b32 a28, v64
v_perm_b32 v68, v47, v46, s47
s_barrier
s_mov_b32 s20, 256
s_mov_b32 s21, 9472
buffer_load_dword v46, v4, s[84:87], s20 offen
buffer_load_dword v47, v4, s[84:87], s20 offen offset:1152
s_waitcnt vmcnt(54)
v_perm_b32 v65, v49, v48, s46
v_accvgpr_write_b32 a29, v65
v_perm_b32 v69, v49, v48, s47
buffer_load_dword v48, v4, s[84:87], s21 offen
buffer_load_dword v49, v4, s[84:87], s21 offen offset:1152
s_waitcnt vmcnt(54)
v_perm_b32 v66, v51, v50, s46
v_accvgpr_write_b32 a30, v66
v_perm_b32 v70, v51, v50, s47
buffer_load_dword v50, v4, s[84:87], s20 offen offset:2304
buffer_load_dword v51, v4, s[84:87], s20 offen offset:3456
s_waitcnt vmcnt(54)
v_perm_b32 v67, v53, v52, s46
v_accvgpr_write_b32 a31, v67
v_perm_b32 v71, v53, v52, s47
ds_write_b128 v3, v[68:71] offset:17408
s_waitcnt lgkmcnt(0)
buffer_load_dword v52, v4, s[84:87], s21 offen offset:2304
buffer_load_dword v53, v4, s[84:87], s21 offen offset:3456
s_waitcnt vmcnt(54)
v_perm_b32 v64, v55, v54, s46
v_accvgpr_write_b32 a160, v64
v_perm_b32 v68, v55, v54, s47
v_accvgpr_write_b32 a168, v68
s_barrier
s_mov_b32 s20, 37120
s_mov_b32 s21, 46336
buffer_load_dword v54, v4, s[84:87], s20 offen
buffer_load_dword v55, v4, s[84:87], s20 offen offset:1152
s_waitcnt vmcnt(54)
v_perm_b32 v65, v57, v56, s46
v_accvgpr_write_b32 a161, v65
v_perm_b32 v69, v57, v56, s47
v_accvgpr_write_b32 a169, v69
buffer_load_dword v56, v4, s[84:87], s21 offen
buffer_load_dword v57, v4, s[84:87], s21 offen offset:1152
s_waitcnt vmcnt(54)
v_perm_b32 v66, v59, v58, s46
v_accvgpr_write_b32 a162, v66
v_perm_b32 v70, v59, v58, s47
v_accvgpr_write_b32 a170, v70
buffer_load_dword v58, v4, s[84:87], s20 offen offset:2304
buffer_load_dword v59, v4, s[84:87], s20 offen offset:3456
s_waitcnt vmcnt(54)
v_perm_b32 v67, v61, v60, s46
v_accvgpr_write_b32 a163, v67
v_perm_b32 v71, v61, v60, s47
v_accvgpr_write_b32 a171, v71
buffer_load_dword v60, v4, s[84:87], s21 offen offset:2304
buffer_load_dword v61, v4, s[84:87], s21 offen offset:3456
s_waitcnt vmcnt(54)
v_perm_b32 v64, v7, v6, s46
v_accvgpr_write_b32 a164, v64
v_perm_b32 v68, v7, v6, s47
v_accvgpr_write_b32 a172, v68
s_barrier
s_mov_b32 s20, 73984
s_mov_b32 s21, 83200
buffer_load_dword v6, v4, s[84:87], s20 offen
buffer_load_dword v7, v4, s[84:87], s20 offen offset:1152
s_waitcnt vmcnt(54)
v_perm_b32 v65, v9, v8, s46
v_accvgpr_write_b32 a165, v65
v_perm_b32 v69, v9, v8, s47
v_accvgpr_write_b32 a173, v69
buffer_load_dword v8, v4, s[84:87], s21 offen
buffer_load_dword v9, v4, s[84:87], s21 offen offset:1152
s_waitcnt vmcnt(54)
v_perm_b32 v66, v11, v10, s46
v_accvgpr_write_b32 a166, v66
v_perm_b32 v70, v11, v10, s47
v_accvgpr_write_b32 a174, v70
buffer_load_dword v10, v4, s[84:87], s20 offen offset:2304
buffer_load_dword v11, v4, s[84:87], s20 offen offset:3456
s_waitcnt vmcnt(54)
v_perm_b32 v67, v13, v12, s46
v_accvgpr_write_b32 a167, v67
v_perm_b32 v71, v13, v12, s47
v_accvgpr_write_b32 a175, v71
buffer_load_dword v12, v4, s[84:87], s21 offen offset:2304
buffer_load_dword v13, v4, s[84:87], s21 offen offset:3456
s_waitcnt vmcnt(54)
v_perm_b32 v64, v15, v14, s46
v_accvgpr_write_b32 a176, v64
v_perm_b32 v68, v15, v14, s47
v_accvgpr_write_b32 a184, v68
s_barrier
s_mov_b32 s20, 110848
s_mov_b32 s21, 120064
buffer_load_dword v14, v4, s[84:87], s20 offen
buffer_load_dword v15, v4, s[84:87], s20 offen offset:1152
s_waitcnt vmcnt(54)
v_perm_b32 v65, v17, v16, s46
v_accvgpr_write_b32 a177, v65
v_perm_b32 v69, v17, v16, s47
v_accvgpr_write_b32 a185, v69
buffer_load_dword v16, v4, s[84:87], s21 offen
buffer_load_dword v17, v4, s[84:87], s21 offen offset:1152
s_waitcnt vmcnt(54)
v_perm_b32 v66, v19, v18, s46
v_accvgpr_write_b32 a178, v66
v_perm_b32 v70, v19, v18, s47
v_accvgpr_write_b32 a186, v70
buffer_load_dword v18, v4, s[84:87], s20 offen offset:2304
buffer_load_dword v19, v4, s[84:87], s20 offen offset:3456
s_waitcnt vmcnt(54)
v_perm_b32 v67, v21, v20, s46
v_accvgpr_write_b32 a179, v67
v_perm_b32 v71, v21, v20, s47
v_accvgpr_write_b32 a187, v71
buffer_load_dword v20, v4, s[84:87], s21 offen offset:2304
buffer_load_dword v21, v4, s[84:87], s21 offen offset:3456
s_waitcnt vmcnt(54)
v_perm_b32 v64, v23, v22, s46
v_accvgpr_write_b32 a180, v64
v_perm_b32 v68, v23, v22, s47
v_accvgpr_write_b32 a188, v68
s_barrier
s_mov_b32 s20, 512
s_mov_b32 s21, 9728
buffer_load_dword v22, v4, s[84:87], s20 offen
buffer_load_dword v23, v4, s[84:87], s20 offen offset:1152
s_waitcnt vmcnt(54)
v_perm_b32 v65, v25, v24, s46
v_accvgpr_write_b32 a181, v65
v_perm_b32 v69, v25, v24, s47
v_accvgpr_write_b32 a189, v69
buffer_load_dword v24, v4, s[84:87], s21 offen
buffer_load_dword v25, v4, s[84:87], s21 offen offset:1152
s_waitcnt vmcnt(54)
v_perm_b32 v66, v27, v26, s46
v_accvgpr_write_b32 a182, v66
v_perm_b32 v70, v27, v26, s47
v_accvgpr_write_b32 a190, v70
buffer_load_dword v26, v4, s[84:87], s20 offen offset:2304
buffer_load_dword v27, v4, s[84:87], s20 offen offset:3456
s_waitcnt vmcnt(54)
v_perm_b32 v67, v29, v28, s46
v_accvgpr_write_b32 a183, v67
v_perm_b32 v71, v29, v28, s47
v_accvgpr_write_b32 a191, v71
buffer_load_dword v28, v4, s[84:87], s21 offen offset:2304
buffer_load_dword v29, v4, s[84:87], s21 offen offset:3456
s_waitcnt vmcnt(54)
v_perm_b32 v64, v31, v30, s46
v_perm_b32 v68, v31, v30, s47
s_barrier
s_mov_b32 s20, 37376
s_mov_b32 s21, 46592
buffer_load_dword v30, v4, s[84:87], s20 offen
buffer_load_dword v31, v4, s[84:87], s20 offen offset:1152
s_waitcnt vmcnt(54)
v_perm_b32 v65, v33, v32, s46
v_perm_b32 v69, v33, v32, s47
buffer_load_dword v32, v4, s[84:87], s21 offen
buffer_load_dword v33, v4, s[84:87], s21 offen offset:1152
s_waitcnt vmcnt(54)
v_perm_b32 v66, v35, v34, s46
v_perm_b32 v70, v35, v34, s47
buffer_load_dword v34, v4, s[84:87], s20 offen offset:2304
buffer_load_dword v35, v4, s[84:87], s20 offen offset:3456
s_waitcnt vmcnt(54)
v_perm_b32 v67, v37, v36, s46
ds_write_b128 v3, v[64:67] offset:20480
s_waitcnt lgkmcnt(0)
v_perm_b32 v71, v37, v36, s47
ds_write_b128 v3, v[68:71] offset:22528
s_waitcnt lgkmcnt(0)
buffer_load_dword v36, v4, s[84:87], s21 offen offset:2304
buffer_load_dword v37, v4, s[84:87], s21 offen offset:3456
s_waitcnt vmcnt(54)
v_perm_b32 v64, v39, v38, s46
v_perm_b32 v68, v39, v38, s47
s_barrier
s_mov_b32 s20, 74240
s_mov_b32 s21, 83456
buffer_load_dword v38, v4, s[84:87], s20 offen
buffer_load_dword v39, v4, s[84:87], s20 offen offset:1152
s_waitcnt vmcnt(54)
v_perm_b32 v65, v41, v40, s46
v_perm_b32 v69, v41, v40, s47
buffer_load_dword v40, v4, s[84:87], s21 offen
buffer_load_dword v41, v4, s[84:87], s21 offen offset:1152
s_waitcnt vmcnt(54)
v_perm_b32 v66, v43, v42, s46
v_perm_b32 v70, v43, v42, s47
buffer_load_dword v42, v4, s[84:87], s20 offen offset:2304
buffer_load_dword v43, v4, s[84:87], s20 offen offset:3456
s_waitcnt vmcnt(54)
v_perm_b32 v67, v45, v44, s46
ds_write_b128 v3, v[64:67] offset:21504
s_waitcnt lgkmcnt(0)
v_perm_b32 v71, v45, v44, s47
ds_write_b128 v3, v[68:71] offset:23552
s_waitcnt lgkmcnt(0)
buffer_load_dword v44, v4, s[84:87], s21 offen offset:2304
buffer_load_dword v45, v4, s[84:87], s21 offen offset:3456
s_waitcnt vmcnt(54)
v_perm_b32 v64, v47, v46, s46
v_accvgpr_write_b32 a192, v64
v_perm_b32 v68, v47, v46, s47
v_accvgpr_write_b32 a200, v68
s_barrier
s_mov_b32 s20, 111104
s_mov_b32 s21, 120320
buffer_load_dword v46, v4, s[84:87], s20 offen
buffer_load_dword v47, v4, s[84:87], s20 offen offset:1152
s_waitcnt vmcnt(54)
v_perm_b32 v65, v49, v48, s46
v_accvgpr_write_b32 a193, v65
v_perm_b32 v69, v49, v48, s47
v_accvgpr_write_b32 a201, v69
buffer_load_dword v48, v4, s[84:87], s21 offen
buffer_load_dword v49, v4, s[84:87], s21 offen offset:1152
s_waitcnt vmcnt(54)
v_perm_b32 v66, v51, v50, s46
v_accvgpr_write_b32 a194, v66
v_perm_b32 v70, v51, v50, s47
v_accvgpr_write_b32 a202, v70
buffer_load_dword v50, v4, s[84:87], s20 offen offset:2304
buffer_load_dword v51, v4, s[84:87], s20 offen offset:3456
s_waitcnt vmcnt(54)
v_perm_b32 v67, v53, v52, s46
v_accvgpr_write_b32 a195, v67
v_perm_b32 v71, v53, v52, s47
v_accvgpr_write_b32 a203, v71
buffer_load_dword v52, v4, s[84:87], s21 offen offset:2304
buffer_load_dword v53, v4, s[84:87], s21 offen offset:3456
s_waitcnt vmcnt(54)
v_perm_b32 v64, v55, v54, s46
v_accvgpr_write_b32 a196, v64
v_perm_b32 v68, v55, v54, s47
v_accvgpr_write_b32 a204, v68
s_barrier
s_mov_b32 s20, 768
s_mov_b32 s21, 9984
buffer_load_dword v54, v4, s[84:87], s20 offen
buffer_load_dword v55, v4, s[84:87], s20 offen offset:1152
s_waitcnt vmcnt(54)
v_perm_b32 v65, v57, v56, s46
v_accvgpr_write_b32 a197, v65
v_perm_b32 v69, v57, v56, s47
v_accvgpr_write_b32 a205, v69
buffer_load_dword v56, v4, s[84:87], s21 offen
buffer_load_dword v57, v4, s[84:87], s21 offen offset:1152
s_waitcnt vmcnt(54)
v_perm_b32 v66, v59, v58, s46
v_accvgpr_write_b32 a198, v66
v_perm_b32 v70, v59, v58, s47
v_accvgpr_write_b32 a206, v70
buffer_load_dword v58, v4, s[84:87], s20 offen offset:2304
buffer_load_dword v59, v4, s[84:87], s20 offen offset:3456
s_waitcnt vmcnt(54)
v_perm_b32 v67, v61, v60, s46
v_accvgpr_write_b32 a199, v67
v_perm_b32 v71, v61, v60, s47
v_accvgpr_write_b32 a207, v71
buffer_load_dword v60, v4, s[84:87], s21 offen offset:2304
buffer_load_dword v61, v4, s[84:87], s21 offen offset:3456
s_waitcnt vmcnt(54)
v_perm_b32 v64, v7, v6, s46
v_perm_b32 v68, v7, v6, s47
s_barrier
s_mov_b32 s20, 37632
s_mov_b32 s21, 46848
buffer_load_dword v6, v4, s[84:87], s20 offen
buffer_load_dword v7, v4, s[84:87], s20 offen offset:1152
s_waitcnt vmcnt(54)
v_perm_b32 v65, v9, v8, s46
v_perm_b32 v69, v9, v8, s47
buffer_load_dword v8, v4, s[84:87], s21 offen
buffer_load_dword v9, v4, s[84:87], s21 offen offset:1152
s_waitcnt vmcnt(54)
v_perm_b32 v66, v11, v10, s46
v_perm_b32 v70, v11, v10, s47
buffer_load_dword v10, v4, s[84:87], s20 offen offset:2304
buffer_load_dword v11, v4, s[84:87], s20 offen offset:3456
s_waitcnt vmcnt(54)
v_perm_b32 v67, v13, v12, s46
ds_write_b128 v3, v[64:67] offset:24576
s_waitcnt lgkmcnt(0)
v_perm_b32 v71, v13, v12, s47
ds_write_b128 v3, v[68:71] offset:26624
s_waitcnt lgkmcnt(0)
buffer_load_dword v12, v4, s[84:87], s21 offen offset:2304
buffer_load_dword v13, v4, s[84:87], s21 offen offset:3456
s_waitcnt vmcnt(54)
v_perm_b32 v64, v15, v14, s46
v_perm_b32 v68, v15, v14, s47
s_barrier
s_mov_b32 s20, 74496
s_mov_b32 s21, 83712
buffer_load_dword v14, v4, s[84:87], s20 offen
buffer_load_dword v15, v4, s[84:87], s20 offen offset:1152
s_waitcnt vmcnt(54)
v_perm_b32 v65, v17, v16, s46
v_perm_b32 v69, v17, v16, s47
buffer_load_dword v16, v4, s[84:87], s21 offen
buffer_load_dword v17, v4, s[84:87], s21 offen offset:1152
s_waitcnt vmcnt(54)
v_perm_b32 v66, v19, v18, s46
v_perm_b32 v70, v19, v18, s47
buffer_load_dword v18, v4, s[84:87], s20 offen offset:2304
buffer_load_dword v19, v4, s[84:87], s20 offen offset:3456
s_waitcnt vmcnt(54)
v_perm_b32 v67, v21, v20, s46
ds_write_b128 v3, v[64:67] offset:25600
s_waitcnt lgkmcnt(0)
v_perm_b32 v71, v21, v20, s47
ds_write_b128 v3, v[68:71] offset:27648
s_waitcnt lgkmcnt(0)
buffer_load_dword v20, v4, s[84:87], s21 offen offset:2304
buffer_load_dword v21, v4, s[84:87], s21 offen offset:3456
s_waitcnt vmcnt(54)
v_perm_b32 v64, v23, v22, s46
v_accvgpr_write_b32 a208, v64
v_perm_b32 v68, v23, v22, s47
v_accvgpr_write_b32 a216, v68
s_barrier
s_mov_b32 s20, 111360
s_mov_b32 s21, 120576
buffer_load_dword v22, v4, s[84:87], s20 offen
buffer_load_dword v23, v4, s[84:87], s20 offen offset:1152
s_waitcnt vmcnt(54)
v_perm_b32 v65, v25, v24, s46
v_accvgpr_write_b32 a209, v65
v_perm_b32 v69, v25, v24, s47
v_accvgpr_write_b32 a217, v69
buffer_load_dword v24, v4, s[84:87], s21 offen
buffer_load_dword v25, v4, s[84:87], s21 offen offset:1152
s_waitcnt vmcnt(54)
v_perm_b32 v66, v27, v26, s46
v_accvgpr_write_b32 a210, v66
v_perm_b32 v70, v27, v26, s47
v_accvgpr_write_b32 a218, v70
buffer_load_dword v26, v4, s[84:87], s20 offen offset:2304
buffer_load_dword v27, v4, s[84:87], s20 offen offset:3456
s_waitcnt vmcnt(54)
v_perm_b32 v67, v29, v28, s46
v_accvgpr_write_b32 a211, v67
v_perm_b32 v71, v29, v28, s47
v_accvgpr_write_b32 a219, v71
buffer_load_dword v28, v4, s[84:87], s21 offen offset:2304
buffer_load_dword v29, v4, s[84:87], s21 offen offset:3456
s_waitcnt vmcnt(54)
v_perm_b32 v64, v31, v30, s46
v_accvgpr_write_b32 a212, v64
v_perm_b32 v68, v31, v30, s47
v_accvgpr_write_b32 a220, v68
s_barrier
s_mov_b32 s20, 1024
s_mov_b32 s21, 10240
buffer_load_ushort v30, v2, s[84:87], s20 offen
buffer_load_ushort v31, v2, s[84:87], s20 offen offset:1152
s_waitcnt vmcnt(54)
v_perm_b32 v65, v33, v32, s46
v_accvgpr_write_b32 a213, v65
v_perm_b32 v69, v33, v32, s47
v_accvgpr_write_b32 a221, v69
buffer_load_ushort v32, v2, s[84:87], s21 offen
buffer_load_ushort v33, v2, s[84:87], s21 offen offset:1152
s_waitcnt vmcnt(54)
v_perm_b32 v66, v35, v34, s46
v_accvgpr_write_b32 a214, v66
v_perm_b32 v70, v35, v34, s47
v_accvgpr_write_b32 a222, v70
buffer_load_ushort v34, v2, s[84:87], s20 offen offset:2304
buffer_load_ushort v35, v2, s[84:87], s20 offen offset:3456
s_waitcnt vmcnt(54)
v_perm_b32 v67, v37, v36, s46
v_accvgpr_write_b32 a215, v67
v_perm_b32 v71, v37, v36, s47
v_accvgpr_write_b32 a223, v71
buffer_load_ushort v36, v2, s[84:87], s21 offen offset:2304
buffer_load_ushort v37, v2, s[84:87], s21 offen offset:3456
s_waitcnt vmcnt(54)
v_perm_b32 v64, v39, v38, s46
v_perm_b32 v68, v39, v38, s47
s_barrier
s_mov_b32 s20, 37888
s_mov_b32 s21, 47104
buffer_load_ushort v38, v2, s[84:87], s20 offen
buffer_load_ushort v39, v2, s[84:87], s20 offen offset:1152
s_waitcnt vmcnt(54)
v_perm_b32 v65, v41, v40, s46
v_perm_b32 v69, v41, v40, s47
buffer_load_ushort v40, v2, s[84:87], s21 offen
buffer_load_ushort v41, v2, s[84:87], s21 offen offset:1152
s_waitcnt vmcnt(54)
v_perm_b32 v66, v43, v42, s46
v_perm_b32 v70, v43, v42, s47
buffer_load_ushort v42, v2, s[84:87], s20 offen offset:2304
buffer_load_ushort v43, v2, s[84:87], s20 offen offset:3456
s_waitcnt vmcnt(54)
v_perm_b32 v67, v45, v44, s46
ds_write_b128 v3, v[64:67] offset:28672
s_waitcnt lgkmcnt(0)
v_perm_b32 v71, v45, v44, s47
ds_write_b128 v3, v[68:71] offset:30720
s_waitcnt lgkmcnt(0)
buffer_load_ushort v44, v2, s[84:87], s21 offen offset:2304
buffer_load_ushort v45, v2, s[84:87], s21 offen offset:3456
s_waitcnt vmcnt(54)
v_perm_b32 v64, v47, v46, s46
v_perm_b32 v68, v47, v46, s47
s_barrier
s_mov_b32 s20, 74752
s_mov_b32 s21, 83968
buffer_load_ushort v46, v2, s[84:87], s20 offen
buffer_load_ushort v47, v2, s[84:87], s20 offen offset:1152
s_waitcnt vmcnt(54)
v_perm_b32 v65, v49, v48, s46
v_perm_b32 v69, v49, v48, s47
buffer_load_ushort v48, v2, s[84:87], s21 offen
buffer_load_ushort v49, v2, s[84:87], s21 offen offset:1152
s_waitcnt vmcnt(54)
v_perm_b32 v66, v51, v50, s46
v_perm_b32 v70, v51, v50, s47
buffer_load_ushort v50, v2, s[84:87], s20 offen offset:2304
buffer_load_ushort v51, v2, s[84:87], s20 offen offset:3456
s_waitcnt vmcnt(54)
v_perm_b32 v67, v53, v52, s46
ds_write_b128 v3, v[64:67] offset:29696
s_waitcnt lgkmcnt(0)
v_perm_b32 v71, v53, v52, s47
ds_write_b128 v3, v[68:71] offset:31744
s_waitcnt lgkmcnt(0)
buffer_load_ushort v52, v2, s[84:87], s21 offen offset:2304
buffer_load_ushort v53, v2, s[84:87], s21 offen offset:3456
s_waitcnt vmcnt(54)
v_perm_b32 v64, v55, v54, s46
v_accvgpr_write_b32 a224, v64
v_perm_b32 v68, v55, v54, s47
v_accvgpr_write_b32 a232, v68
s_barrier
s_mov_b32 s20, 111616
s_mov_b32 s21, 120832
buffer_load_ushort v54, v2, s[84:87], s20 offen
buffer_load_ushort v55, v2, s[84:87], s20 offen offset:1152
s_waitcnt vmcnt(54)
v_perm_b32 v65, v57, v56, s46
v_accvgpr_write_b32 a225, v65
v_perm_b32 v69, v57, v56, s47
v_accvgpr_write_b32 a233, v69
buffer_load_ushort v56, v2, s[84:87], s21 offen
buffer_load_ushort v57, v2, s[84:87], s21 offen offset:1152
s_waitcnt vmcnt(54)
v_perm_b32 v66, v59, v58, s46
v_accvgpr_write_b32 a226, v66
v_perm_b32 v70, v59, v58, s47
v_accvgpr_write_b32 a234, v70
buffer_load_ushort v58, v2, s[84:87], s20 offen offset:2304
buffer_load_ushort v59, v2, s[84:87], s20 offen offset:3456
s_waitcnt vmcnt(54)
v_perm_b32 v67, v61, v60, s46
v_accvgpr_write_b32 a227, v67
v_perm_b32 v71, v61, v60, s47
v_accvgpr_write_b32 a235, v71
buffer_load_ushort v60, v2, s[84:87], s21 offen offset:2304
buffer_load_ushort v61, v2, s[84:87], s21 offen offset:3456
s_waitcnt vmcnt(54)
v_perm_b32 v64, v7, v6, s46
v_accvgpr_write_b32 a228, v64
v_perm_b32 v68, v7, v6, s47
v_accvgpr_write_b32 a236, v68
s_barrier
v_subrev_u32 v1, 4194304, v1
buffer_load_dword v6, v1, s[12:15], 0 offen
buffer_load_dword v7, v1, s[12:15], s24 offen
s_waitcnt vmcnt(54)
v_perm_b32 v65, v9, v8, s46
v_accvgpr_write_b32 a229, v65
v_perm_b32 v69, v9, v8, s47
v_accvgpr_write_b32 a237, v69
buffer_load_dword v8, v1, s[12:15], s26 offen
buffer_load_dword v9, v1, s[12:15], s29 offen
s_waitcnt vmcnt(54)
v_perm_b32 v66, v11, v10, s46
v_accvgpr_write_b32 a230, v66
v_perm_b32 v70, v11, v10, s47
v_accvgpr_write_b32 a238, v70
buffer_load_dword v10, v1, s[12:15], s23 offen
buffer_load_dword v11, v1, s[12:15], s25 offen
s_waitcnt vmcnt(54)
v_perm_b32 v67, v13, v12, s46
v_accvgpr_write_b32 a231, v67
v_perm_b32 v71, v13, v12, s47
v_accvgpr_write_b32 a239, v71
buffer_load_dword v12, v1, s[12:15], s27 offen
buffer_load_dword v13, v1, s[12:15], s31 offen
s_waitcnt vmcnt(54)
v_perm_b32 v64, v15, v14, s46
v_perm_b32 v68, v15, v14, s47
v_accvgpr_write_b32 a240, v68
s_barrier
buffer_load_dword v14, v1, s[12:15], s32 offen
buffer_load_dword v15, v1, s[12:15], s34 offen
s_waitcnt vmcnt(54)
v_perm_b32 v65, v17, v16, s46
v_perm_b32 v69, v17, v16, s47
v_accvgpr_write_b32 a241, v69
buffer_load_dword v16, v1, s[12:15], s36 offen
buffer_load_dword v17, v1, s[12:15], s38 offen
s_waitcnt vmcnt(54)
v_perm_b32 v66, v19, v18, s46
v_perm_b32 v70, v19, v18, s47
v_accvgpr_write_b32 a242, v70
v_and_b32 v5, 1, v0
v_lshlrev_b32 v5, 6, v5
buffer_load_dword v5, v5, s[56:59], 0 offen offset:64 sc1
buffer_load_dword v18, v1, s[12:15], s33 offen
buffer_load_dword v19, v1, s[12:15], s35 offen
s_waitcnt vmcnt(55)
v_perm_b32 v67, v21, v20, s46
ds_write_b128 v3, v[64:67] offset:32768
s_waitcnt lgkmcnt(0)
v_perm_b32 v71, v21, v20, s47
v_accvgpr_write_b32 a243, v71
buffer_load_dword v20, v1, s[12:15], s37 offen
buffer_load_dword v21, v1, s[12:15], s39 offen
s_waitcnt vmcnt(55)
v_perm_b32 v64, v23, v22, s46
v_perm_b32 v68, v23, v22, s47
v_accvgpr_write_b32 a244, v68
s_barrier
v_add_u32 v1, s44, v1
buffer_load_dword v22, v1, s[12:15], 0 offen
buffer_load_dword v23, v1, s[12:15], s24 offen
s_waitcnt vmcnt(55)
v_perm_b32 v65, v25, v24, s46
v_perm_b32 v69, v25, v24, s47
v_accvgpr_write_b32 a245, v69
buffer_load_dword v24, v1, s[12:15], s26 offen
buffer_load_dword v25, v1, s[12:15], s29 offen
s_waitcnt vmcnt(55)
v_perm_b32 v66, v27, v26, s46
v_perm_b32 v70, v27, v26, s47
v_accvgpr_write_b32 a246, v70
buffer_load_dword v26, v1, s[12:15], s23 offen
buffer_load_dword v27, v1, s[12:15], s25 offen
s_waitcnt vmcnt(55)
v_perm_b32 v67, v29, v28, s46
ds_write_b128 v3, v[64:67] offset:33792
s_waitcnt lgkmcnt(0)
v_perm_b32 v71, v29, v28, s47
v_accvgpr_write_b32 a247, v71
buffer_load_dword v28, v1, s[12:15], s27 offen
buffer_load_dword v29, v1, s[12:15], s31 offen
s_waitcnt vmcnt(55)
v_perm_b32 v64, v31, v30, s46
v_accvgpr_write_b32 a248, v64
s_barrier
buffer_load_dword v30, v1, s[12:15], s32 offen
buffer_load_dword v31, v1, s[12:15], s34 offen
s_waitcnt vmcnt(55)
v_perm_b32 v65, v33, v32, s46
v_accvgpr_write_b32 a249, v65
buffer_load_dword v32, v1, s[12:15], s36 offen
buffer_load_dword v33, v1, s[12:15], s38 offen
s_waitcnt vmcnt(55)
v_perm_b32 v66, v35, v34, s46
v_accvgpr_write_b32 a250, v66
buffer_load_dword v34, v1, s[12:15], s33 offen
buffer_load_dword v35, v1, s[12:15], s35 offen
s_waitcnt vmcnt(55)
v_perm_b32 v67, v37, v36, s46
v_accvgpr_write_b32 a251, v67
buffer_load_dword v36, v1, s[12:15], s37 offen
buffer_load_dword v37, v1, s[12:15], s39 offen
s_waitcnt vmcnt(55)
v_perm_b32 v64, v39, v38, s46
v_accvgpr_write_b32 a252, v64
s_barrier
v_add_u32 v1, s44, v1
buffer_load_dword v38, v1, s[12:15], 0 offen
buffer_load_dword v39, v1, s[12:15], s24 offen
s_waitcnt vmcnt(55)
v_perm_b32 v65, v41, v40, s46
v_accvgpr_write_b32 a253, v65
buffer_load_dword v40, v1, s[12:15], s26 offen
buffer_load_dword v41, v1, s[12:15], s29 offen
s_waitcnt vmcnt(55)
v_perm_b32 v66, v43, v42, s46
v_accvgpr_write_b32 a254, v66
buffer_load_dword v42, v1, s[12:15], s23 offen
buffer_load_dword v43, v1, s[12:15], s25 offen
s_waitcnt vmcnt(55)
v_perm_b32 v67, v45, v44, s46
v_accvgpr_write_b32 a255, v67
buffer_load_dword v44, v1, s[12:15], s27 offen
buffer_load_dword v45, v1, s[12:15], s31 offen
s_waitcnt vmcnt(55)
v_perm_b32 v64, v47, v46, s46
s_barrier
buffer_load_dword v46, v1, s[12:15], s32 offen
buffer_load_dword v47, v1, s[12:15], s34 offen
s_waitcnt vmcnt(55)
v_perm_b32 v65, v49, v48, s46
buffer_load_dword v48, v1, s[12:15], s36 offen
buffer_load_dword v49, v1, s[12:15], s38 offen
s_waitcnt vmcnt(55)
v_perm_b32 v66, v51, v50, s46
buffer_load_dword v50, v1, s[12:15], s33 offen
buffer_load_dword v51, v1, s[12:15], s35 offen
s_waitcnt vmcnt(55)
v_perm_b32 v67, v53, v52, s46
ds_write_b128 v3, v[64:67] offset:18432
s_waitcnt lgkmcnt(0)
buffer_load_dword v52, v1, s[12:15], s37 offen
buffer_load_dword v53, v1, s[12:15], s39 offen
s_waitcnt vmcnt(55)
v_perm_b32 v64, v55, v54, s46
s_barrier
v_add_u32 v1, s44, v1
buffer_load_dword v54, v1, s[12:15], 0 offen
buffer_load_dword v55, v1, s[12:15], s24 offen
s_waitcnt vmcnt(55)
v_perm_b32 v65, v57, v56, s46
buffer_load_dword v56, v1, s[12:15], s26 offen
buffer_load_dword v57, v1, s[12:15], s29 offen
s_waitcnt vmcnt(55)
v_perm_b32 v66, v59, v58, s46
buffer_load_dword v58, v1, s[12:15], s23 offen
buffer_load_dword v59, v1, s[12:15], s25 offen
s_waitcnt vmcnt(55)
v_perm_b32 v67, v61, v60, s46
ds_write_b128 v3, v[64:67] offset:19456
s_waitcnt lgkmcnt(0)
buffer_load_dword v60, v1, s[12:15], s27 offen
buffer_load_dword v61, v1, s[12:15], s31 offen
s_waitcnt vmcnt(55)
v_perm_b32 v72, v7, v6, s46
v_perm_b32 v80, v7, v6, s47
s_barrier
buffer_load_dword v6, v1, s[12:15], s32 offen
buffer_load_dword v7, v1, s[12:15], s34 offen
s_waitcnt vmcnt(55)
v_perm_b32 v73, v9, v8, s46
v_perm_b32 v81, v9, v8, s47
buffer_load_dword v8, v1, s[12:15], s36 offen
buffer_load_dword v9, v1, s[12:15], s38 offen
s_waitcnt vmcnt(55)
v_perm_b32 v74, v11, v10, s46
v_perm_b32 v82, v11, v10, s47
buffer_load_dword v10, v1, s[12:15], s33 offen
buffer_load_dword v11, v1, s[12:15], s35 offen
s_waitcnt vmcnt(55)
v_perm_b32 v75, v13, v12, s46
v_perm_b32 v83, v13, v12, s47
buffer_load_dword v12, v1, s[12:15], s37 offen
buffer_load_dword v13, v1, s[12:15], s39 offen
s_waitcnt vmcnt(55)
v_perm_b32 v76, v15, v14, s46
v_perm_b32 v84, v15, v14, s47
s_barrier
v_add_u32 v1, s44, v1
buffer_load_dword v14, v1, s[12:15], 0 offen
buffer_load_dword v15, v1, s[12:15], s24 offen
s_waitcnt vmcnt(55)
v_perm_b32 v77, v17, v16, s46
v_perm_b32 v85, v17, v16, s47
buffer_load_dword v16, v1, s[12:15], s26 offen
buffer_load_dword v17, v1, s[12:15], s29 offen
s_waitcnt vmcnt(54)
v_perm_b32 v78, v19, v18, s46
v_perm_b32 v86, v19, v18, s47
buffer_load_dword v18, v1, s[12:15], s23 offen
buffer_load_dword v19, v1, s[12:15], s25 offen
s_waitcnt vmcnt(54)
v_perm_b32 v79, v21, v20, s46
v_perm_b32 v87, v21, v20, s47
buffer_load_dword v20, v1, s[12:15], s27 offen
buffer_load_dword v21, v1, s[12:15], s31 offen
s_waitcnt vmcnt(54)
v_perm_b32 v96, v23, v22, s46
v_perm_b32 v104, v23, v22, s47
s_barrier
buffer_load_dword v22, v1, s[12:15], s32 offen
buffer_load_dword v23, v1, s[12:15], s34 offen
s_waitcnt vmcnt(54)
v_perm_b32 v97, v25, v24, s46
v_perm_b32 v105, v25, v24, s47
buffer_load_dword v24, v1, s[12:15], s36 offen
buffer_load_dword v25, v1, s[12:15], s38 offen
s_waitcnt vmcnt(54)
v_perm_b32 v98, v27, v26, s46
v_perm_b32 v106, v27, v26, s47
v_and_b32 v62, 1, v0
v_lshlrev_b32 v63, 6, v62
v_mul_u32_u24 v62, 24, v62
v_sub_u32 v62, 32, v62
v_cmp_ne_u32 vcc, v5, v62
s_cbranch_vccz L_tok
v_add_u32 v63, 64, v63
s_mov_b32 s28, 0
L_poll_58:
buffer_load_dword v5, v63, s[56:59], 0 offen sc1
s_add_u32 s28, s28, 1
s_cmp_gt_u32 s28, 200000
s_cbranch_scc1 L_end
s_waitcnt vmcnt(0)
v_cmp_ne_u32 vcc, v5, v62
s_cbranch_vccz L_pd_59
s_sleep 1
s_branch L_poll_58
L_pd_59:
L_tok:
v_mov_b32 v5, 0
s_lshl_b32 s99, s16, 7
s_add_u32 s99, s99, 111149088
buffer_load_dword v5, v5, s[8:11], s99 offen sc1
v_lshlrev_b32 v62, 7, v0
s_getpc_b64 s[4:5]
L_pc2:
s_mov_b32 s40, s4
s_and_b32 s41, s5, 0xffff
s_mov_b32 s42, L_end-L_pc2
s_mov_b32 s43, 0x20000
buffer_load_dword v63, v62, s[40:43], 0 offen
s_mul_i32 s98, s16, 20480
s_add_u32 s98, s98, 109051904
s_cmp_eq_u32 s17, 3
s_cselect_b32 s98, 536870912, s98
buffer_load_dword v63, v62, s[8:11], s98 offen sc1
s_mov_b32 s40, s96
s_and_b32 s41, s97, 0xffff
s_mov_b32 s42, 9216
s_mov_b32 s43, 0x20000
buffer_load_dword v63, v62, s[40:43], 0 offen
buffer_load_dword v26, v1, s[12:15], s33 offen
buffer_load_dword v27, v1, s[12:15], s35 offen
s_waitcnt vmcnt(58)
v_perm_b32 v99, v29, v28, s46
v_perm_b32 v107, v29, v28, s47
buffer_load_dword v28, v1, s[12:15], s37 offen
buffer_load_dword v29, v1, s[12:15], s39 offen
s_waitcnt vmcnt(58)
v_perm_b32 v100, v31, v30, s46
v_perm_b32 v108, v31, v30, s47
s_barrier
v_add_u32 v1, s44, v1
buffer_load_dword v30, v1, s[12:15], 0 offen
buffer_load_dword v31, v1, s[12:15], s24 offen
s_waitcnt vmcnt(58)
v_perm_b32 v101, v33, v32, s46
v_perm_b32 v109, v33, v32, s47
buffer_load_dword v32, v1, s[12:15], s26 offen
buffer_load_dword v33, v1, s[12:15], s29 offen
s_waitcnt vmcnt(58)
v_perm_b32 v102, v35, v34, s46
v_perm_b32 v110, v35, v34, s47
buffer_load_dword v34, v1, s[12:15], s23 offen
buffer_load_dword v35, v1, s[12:15], s25 offen
s_waitcnt vmcnt(58)
v_perm_b32 v103, v37, v36, s46
v_perm_b32 v111, v37, v36, s47
buffer_load_dword v36, v1, s[12:15], s27 offen
buffer_load_dword v37, v1, s[12:15], s31 offen
s_waitcnt vmcnt(58)
v_perm_b32 v120, v39, v38, s46
v_perm_b32 v128, v39, v38, s47
s_barrier
buffer_load_dword v38, v1, s[12:15], s32 offen
buffer_load_dword v39, v1, s[12:15], s34 offen
s_waitcnt vmcnt(58)
v_perm_b32 v121, v41, v40, s46
v_perm_b32 v129, v41, v40, s47
buffer_load_dword v40, v1, s[12:15], s36 offen
buffer_load_dword v41, v1, s[12:15], s38 offen
s_waitcnt vmcnt(58)
v_perm_b32 v122, v43, v42, s46
v_perm_b32 v130, v43, v42, s47
buffer_load_dword v42, v1, s[12:15], s33 offen
buffer_load_dword v43, v1, s[12:15], s35 offen
s_waitcnt vmcnt(58)
v_perm_b32 v123, v45, v44, s46
v_perm_b32 v131, v45, v44, s47
buffer_load_dword v44, v1, s[12:15], s37 offen
buffer_load_dword v45, v1, s[12:15], s39 offen
s_waitcnt vmcnt(58)
v_perm_b32 v124, v47, v46, s46
v_perm_b32 v132, v47, v46, s47
s_barrier
v_add_u32 v1, s44, v1
buffer_load_dword v46, v1, s[12:15], 0 offen
buffer_load_dword v47, v1, s[12:15], s24 offen
s_waitcnt vmcnt(58)
v_perm_b32 v125, v49, v48, s46
v_perm_b32 v133, v49, v48, s47
buffer_load_dword v48, v1, s[12:15], s26 offen
buffer_load_dword v49, v1, s[12:15], s29 offen
s_waitcnt vmcnt(58)
v_perm_b32 v126, v51, v50, s46
v_perm_b32 v134, v51, v50, s47
buffer_load_dword v50, v1, s[12:15], s23 offen
buffer_load_dword v51, v1, s[12:15], s25 offen
s_waitcnt vmcnt(58)
v_perm_b32 v127, v53, v52, s46
v_perm_b32 v135, v53, v52, s47
buffer_load_dword v52, v1, s[12:15], s27 offen
buffer_load_dword v53, v1, s[12:15], s31 offen
s_waitcnt vmcnt(58)
v_perm_b32 v144, v55, v54, s46
v_perm_b32 v152, v55, v54, s47
s_barrier
buffer_load_dword v54, v1, s[12:15], s32 offen
buffer_load_dword v55, v1, s[12:15], s34 offen
s_waitcnt vmcnt(58)
v_perm_b32 v145, v57, v56, s46
v_perm_b32 v153, v57, v56, s47
buffer_load_dword v56, v1, s[12:15], s36 offen
buffer_load_dword v57, v1, s[12:15], s38 offen
s_waitcnt vmcnt(58)
v_perm_b32 v146, v59, v58, s46
v_perm_b32 v154, v59, v58, s47
buffer_load_dword v58, v1, s[12:15], s33 offen
buffer_load_dword v59, v1, s[12:15], s35 offen
s_waitcnt vmcnt(58)
v_perm_b32 v147, v61, v60, s46
v_perm_b32 v155, v61, v60, s47
buffer_load_dword v60, v1, s[12:15], s37 offen
buffer_load_dword v61, v1, s[12:15], s39 offen
s_waitcnt vmcnt(58)
v_perm_b32 v148, v7, v6, s46
v_perm_b32 v156, v7, v6, s47
s_barrier
v_add_u32 v1, s44, v1
buffer_load_dword v6, v1, s[12:15], 0 offen
buffer_load_dword v7, v1, s[12:15], s24 offen
s_waitcnt vmcnt(58)
v_perm_b32 v149, v9, v8, s46
v_perm_b32 v157, v9, v8, s47
buffer_load_dword v8, v1, s[12:15], s26 offen
buffer_load_dword v9, v1, s[12:15], s29 offen
s_waitcnt vmcnt(58)
v_perm_b32 v150, v11, v10, s46
v_perm_b32 v158, v11, v10, s47
buffer_load_dword v10, v1, s[12:15], s23 offen
buffer_load_dword v11, v1, s[12:15], s25 offen
s_waitcnt vmcnt(58)
v_perm_b32 v151, v13, v12, s46
v_perm_b32 v159, v13, v12, s47
buffer_load_dword v12, v1, s[12:15], s27 offen
buffer_load_dword v13, v1, s[12:15], s31 offen
s_waitcnt vmcnt(58)
v_perm_b32 v168, v15, v14, s46
v_perm_b32 v176, v15, v14, s47
s_barrier
buffer_load_dword v14, v1, s[12:15], s32 offen
buffer_load_dword v15, v1, s[12:15], s34 offen
s_waitcnt vmcnt(58)
v_perm_b32 v169, v17, v16, s46
v_perm_b32 v177, v17, v16, s47
buffer_load_dword v16, v1, s[12:15], s36 offen
buffer_load_dword v17, v1, s[12:15], s38 offen
s_waitcnt vmcnt(58)
v_perm_b32 v170, v19, v18, s46
v_perm_b32 v178, v19, v18, s47
buffer_load_dword v18, v1, s[12:15], s33 offen
buffer_load_dword v19, v1, s[12:15], s35 offen
s_waitcnt vmcnt(58)
v_perm_b32 v171, v21, v20, s46
v_perm_b32 v179, v21, v20, s47
buffer_load_dword v20, v1, s[12:15], s37 offen
buffer_load_dword v21, v1, s[12:15], s39 offen
s_waitcnt vmcnt(58)
v_perm_b32 v172, v23, v22, s46
v_perm_b32 v180, v23, v22, s47
s_barrier
v_add_u32 v1, s44, v1
buffer_load_dword v22, v1, s[12:15], 0 offen
buffer_load_dword v23, v1, s[12:15], s24 offen
s_waitcnt vmcnt(58)
v_perm_b32 v173, v25, v24, s46
v_perm_b32 v181, v25, v24, s47
buffer_load_dword v24, v1, s[12:15], s26 offen
buffer_load_dword v25, v1, s[12:15], s29 offen
s_waitcnt vmcnt(54)
v_perm_b32 v174, v27, v26, s46
v_perm_b32 v182, v27, v26, s47
buffer_load_dword v26, v1, s[12:15], s23 offen
buffer_load_dword v27, v1, s[12:15], s25 offen
s_waitcnt vmcnt(54)
v_perm_b32 v175, v29, v28, s46
v_perm_b32 v183, v29, v28, s47
buffer_load_dword v28, v1, s[12:15], s27 offen
buffer_load_dword v29, v1, s[12:15], s31 offen
s_waitcnt vmcnt(54)
v_perm_b32 v192, v31, v30, s46
v_perm_b32 v200, v31, v30, s47
s_barrier
buffer_load_dword v30, v1, s[12:15], s32 offen
buffer_load_dword v31, v1, s[12:15], s34 offen
s_waitcnt vmcnt(54)
v_perm_b32 v193, v33, v32, s46
v_perm_b32 v201, v33, v32, s47
buffer_load_dword v32, v1, s[12:15], s36 offen
buffer_load_dword v33, v1, s[12:15], s38 offen
s_waitcnt vmcnt(54)
v_perm_b32 v194, v35, v34, s46
v_perm_b32 v202, v35, v34, s47
v_readfirstlane_b32 s101, v5
s_cmp_lt_u32 s17, 2
s_cselect_b32 s98, s30, 536870912
s_cmp_eq_u32 s101, 1
s_cselect_b32 s98, s98, 536870912
buffer_load_dword v63, v62, s[8:11], s98 offen sc1
buffer_load_dword v34, v1, s[12:15], s33 offen
buffer_load_dword v35, v1, s[12:15], s35 offen
s_waitcnt vmcnt(55)
v_perm_b32 v195, v37, v36, s46
v_perm_b32 v203, v37, v36, s47
buffer_load_dword v36, v1, s[12:15], s37 offen
buffer_load_dword v37, v1, s[12:15], s39 offen
s_waitcnt vmcnt(55)
v_perm_b32 v196, v39, v38, s46
v_perm_b32 v204, v39, v38, s47
s_waitcnt vmcnt(53)
v_perm_b32 v197, v41, v40, s46
v_perm_b32 v205, v41, v40, s47
s_waitcnt vmcnt(51)
v_perm_b32 v198, v43, v42, s46
v_perm_b32 v206, v43, v42, s47
s_waitcnt vmcnt(49)
v_perm_b32 v199, v45, v44, s46
v_perm_b32 v207, v45, v44, s47
s_waitcnt vmcnt(47)
v_perm_b32 v216, v47, v46, s46
v_perm_b32 v224, v47, v46, s47
s_waitcnt vmcnt(45)
v_perm_b32 v217, v49, v48, s46
v_perm_b32 v225, v49, v48, s47
s_waitcnt vmcnt(43)
v_perm_b32 v218, v51, v50, s46
v_perm_b32 v226, v51, v50, s47
s_waitcnt vmcnt(41)
v_perm_b32 v219, v53, v52, s46
v_perm_b32 v227, v53, v52, s47
s_waitcnt vmcnt(39)
v_perm_b32 v220, v55, v54, s46
v_perm_b32 v228, v55, v54, s47
s_waitcnt vmcnt(37)
v_perm_b32 v221, v57, v56, s46
v_perm_b32 v229, v57, v56, s47
s_waitcnt vmcnt(35)
v_perm_b32 v222, v59, v58, s46
v_perm_b32 v230, v59, v58, s47
s_waitcnt vmcnt(33)
v_perm_b32 v223, v61, v60, s46
v_perm_b32 v231, v61, v60, s47
s_waitcnt vmcnt(31)
v_perm_b32 v240, v7, v6, s46
v_perm_b32 v248, v7, v6, s47
s_waitcnt vmcnt(29)
v_perm_b32 v241, v9, v8, s46
v_perm_b32 v249, v9, v8, s47
s_waitcnt vmcnt(27)
v_perm_b32 v242, v11, v10, s46
v_perm_b32 v250, v11, v10, s47
s_waitcnt vmcnt(25)
v_perm_b32 v243, v13, v12, s46
v_perm_b32 v251, v13, v12, s47
s_waitcnt vmcnt(23)
v_perm_b32 v244, v15, v14, s46
v_perm_b32 v252, v15, v14, s47
s_waitcnt vmcnt(21)
v_perm_b32 v245, v17, v16, s46
v_perm_b32 v253, v17, v16, s47
s_waitcnt vmcnt(19)
v_perm_b32 v246, v19, v18, s46
v_perm_b32 v254, v19, v18, s47
s_waitcnt vmcnt(17)
v_perm_b32 v247, v21, v20, s46
v_perm_b32 v255, v21, v20, s47
s_waitcnt vmcnt(15)
v_perm_b32 v64, v23, v22, s46
v_accvgpr_write_b32 a8, v64
v_perm_b32 v68, v23, v22, s47
v_accvgpr_write_b32 a16, v68
s_waitcnt vmcnt(13)
v_perm_b32 v65, v25, v24, s46
v_accvgpr_write_b32 a9, v65
v_perm_b32 v69, v25, v24, s47
v_accvgpr_write_b32 a17, v69
s_waitcnt vmcnt(11)
v_perm_b32 v66, v27, v26, s46
v_accvgpr_write_b32 a10, v66
v_perm_b32 v70, v27, v26, s47
v_accvgpr_write_b32 a18, v70
s_waitcnt vmcnt(9)
v_perm_b32 v67, v29, v28, s46
v_accvgpr_write_b32 a11, v67
v_perm_b32 v71, v29, v28, s47
v_accvgpr_write_b32 a19, v71
s_waitcnt vmcnt(7)
v_perm_b32 v64, v31, v30, s46
v_accvgpr_write_b32 a12, v64
v_perm_b32 v68, v31, v30, s47
v_accvgpr_write_b32 a20, v68
s_waitcnt vmcnt(5)
v_perm_b32 v65, v33, v32, s46
v_accvgpr_write_b32 a13, v65
v_perm_b32 v69, v33, v32, s47
v_accvgpr_write_b32 a21, v69
s_waitcnt vmcnt(2)
v_perm_b32 v66, v35, v34, s46
v_accvgpr_write_b32 a14, v66
v_perm_b32 v70, v35, v34, s47
v_accvgpr_write_b32 a22, v70
s_waitcnt vmcnt(0)
v_perm_b32 v67, v37, v36, s46
v_accvgpr_write_b32 a15, v67
v_perm_b32 v71, v37, v36, s47
v_accvgpr_write_b32 a23, v71
v_mov_b32 v12, v0
v_and_b32 v13, 15, v0
v_bfe_u32 v14, v0, 4, 2
v_lshlrev_b32 v3, 4, v12
v_and_b32 v2, 0x3f0, v3
s_mul_i32 s20, s17, 34816
s_add_u32 s20, s20, 24576
v_add_u32 v2, s20, v2
v_and_b32 v15, 1, v12
v_mul_u32_u24 v0, 0xaaaa, v15
v_add_u32 v0, 0xffff4444, v0
v_lshrrev_b32 v18, 2, v13
v_lshl_add_u32 v18, v18, 1, v15
v_bfe_u32 v19, v13, 1, 1
v_lshrrev_b32 v16, 5, v12
v_lshlrev_b32 v16, 8, v16
v_lshl_add_u32 v16, v18, 5, v16
v_and_b32 v17, 1, v14
v_lshl_add_u32 v16, v17, 4, v16
v_and_b32 v17, 0x7f, v16
v_xor_b32 v17, 16, v17
v_add_u32 v16, 4224, v16
v_add_u32 v17, 6272, v17
v_cmp_eq_u32 vcc, 1, v19
s_nop 1
v_cndmask_b32 v7, v17, v16, vcc
v_lshrrev_b32 v16, 1, v14
v_lshlrev_b32 v16, 8, v16
v_lshl_add_u32 v16, v15, 7, v16
v_and_b32 v17, 1, v14
v_lshl_add_u32 v16, v17, 6, v16
v_lshrrev_b32 v17, 2, v13
v_lshl_add_u32 v16, v17, 4, v16
v_mul_u32_u24 v17, 2112, v19
v_add_u32 v5, v16, v17
v_bfe_u32 v16, v13, 3, 1
v_lshlrev_b32 v16, 8, v16
v_lshl_add_u32 v16, v19, 6, v16
v_lshl_add_u32 v16, v14, 4, v16
v_bfe_u32 v17, v13, 2, 1
v_lshl_add_u32 v16, v17, 3, v16
v_lshl_add_u32 v16, v15, 2, v16
s_lshl_b32 s20, s17, 9
v_add_u32 v4, s20, v16
v_lshrrev_b32 v16, 4, v12
v_xor_b32 v17, s16, v16
v_lshlrev_b32 v16, 12, v16
v_lshl_add_u32 v16, v17, 7, v16
v_lshl_add_u32 v9, v13, 3, v16
s_lshr_b32 s20, s17, 1
s_lshl_b32 s20, s20, 2
v_add_u32 v16, s20, v14
v_xor_b32 v17, s16, v16
v_lshlrev_b32 v16, 12, v16
v_lshl_add_u32 v16, v17, 7, v16
v_lshl_add_u32 v16, v13, 2, v16
s_and_b32 s20, s17, 1
s_lshl_b32 s20, s20, 6
s_add_u32 s20, s20, 262144
v_add_u32 v10, s20, v16
v_bfe_u32 v16, v13, 2, 1
v_lshlrev_b32 v16, 5, v16
v_and_b32 v17, 1, v14
v_lshl_add_u32 v16, v17, 8, v16
v_lshrrev_b32 v17, 1, v14
v_lshl_add_u32 v16, v17, 4, v16
v_and_b32 v17, 3, v13
v_lshl_add_u32 v11, v17, 2, v16
v_lshlrev_b32 v6, 7, v12
v_lshlrev_b32 v8, 2, v12
s_mov_b32 s36, 0x11111111
s_mov_b32 s37, 0x11111111
s_mov_b32 s38, 0x22222222
s_mov_b32 s39, 0x22222222
s_mov_b32 s40, 0x44444444
s_mov_b32 s41, 0x44444444
s_mov_b32 s42, 0x88888888
s_mov_b32 s43, 0x88888888
s_mov_b32 s44, 0xf0f0f0f0
s_mov_b32 s45, 0xf0f0f0f0
s_mov_b32 s18, 0x3e0293ee
s_lshl_b32 s20, s17, 5
s_add_u32 s20, s20, s16
s_cmp_lt_u32 s20, 72
s_cselect_b32 s48, 1, 0
s_lshl_b32 s23, s20, 12
s_lshl_b32 s21, s17, 10
s_sub_u32 s23, s23, s21
s_lshr_b32 s24, s20, 2
s_lshl_b32 s24, s24, 9
s_and_b32 s21, s20, 3
s_lshl_b32 s21, s21, 6
s_add_u32 s24, s24, s21
s_add_u32 s24, s24, 109641728
s_cmp_lt_u32 s20, 72
s_cselect_b32 s24, s24, 536870912
s_lshl_b32 s25, s16, 12
s_add_u32 s26, s25, 131072
s_add_u32 s27, s25, 262144
s_cmp_lt_u32 s16, 8
s_cselect_b32 s27, s27, 536870912
s_mov_b32 s28, 109051904
s_mov_b32 s29, 109346816
s_mov_b32 s85, 109641728
s_lshl_b32 s30, s16, 14
s_add_u32 s30, s30, 33554432
s_lshl_b32 s31, s16, 12
s_add_u32 s31, s31, 100663296
s_add_u32 s35, s24, 32768
s_mov_b32 s53, 0x3f803f80
s_mov_b32 s86, 0x33333333
s_mov_b32 s87, 0x33333333
s_lshl_b32 s84, s17, 13
s_sub_u32 s84, s20, s84
s_add_u32 s84, s84, 110886912
s_cmp_lt_u32 s20, 72
s_cselect_b32 s84, s84, 536870912
s_and_b32 s21, s16, 3
s_lshl_b32 s21, s21, 7
s_add_u32 s21, s21, 110886144
s_cmp_eq_u32 s17, 3
s_cselect_b32 s84, s21, s84
s_lshl_b32 s82, s16, 7
s_add_u32 s83, s82, 111152384
s_add_u32 s82, s82, 111148288
s_mov_b32 s19, 0
s_mov_b32 s12, s96
s_and_b32 s13, s97, 0xffff
s_mov_b32 s14, 9216
s_mov_b32 s15, 0x20000
v_bfe_u32 v64, v3, 5, 3
v_mul_u32_u24 v64, 1152, v64
v_lshrrev_b32 v65, 8, v3
v_lshl_add_u32 v64, v65, 5, v64
v_and_b32 v65, 16, v3
v_add_u32 v64, v64, v65
buffer_load_dwordx4 v[24:27], v64, s[12:15], 0 offen
buffer_load_dwordx4 v[28:31], v64, s[12:15], 0 offen offset:512
buffer_load_dwordx4 v[32:35], v64, s[12:15], 0 offen offset:1024
s_cmp_eq_u32 s101, 1
s_cbranch_scc1 L_kv0
v_mov_b32 v66, 0
s_mov_b32 s22, 0
L_poll_60:
buffer_load_dword v67, v66, s[8:11], s99 offen sc1
s_add_u32 s22, s22, 1
s_cmp_gt_u32 s22, 200000
s_cbranch_scc1 L_end
s_waitcnt vmcnt(0)
v_cmp_ne_u32 vcc, 1, v67
s_cbranch_vccz L_pd_61
s_branch L_poll_60
L_pd_61:
s_cmp_lt_u32 s17, 2
s_cselect_b32 s98, s30, 536870912
buffer_load_dword v67, v6, s[8:11], s98 offen sc1
L_kv0:
s_waitcnt vmcnt(0)
v_perm_b32 v12, v26, v24, s46
v_perm_b32 v13, v26, v24, s47
v_perm_b32 v14, v27, v25, s46
v_perm_b32 v15, v27, v25, s47
v_min_u32 v12, 0xfffeffff, v12
v_min_u32 v13, 0xfffeffff, v13
v_min_u32 v14, 0xfffeffff, v14
v_min_u32 v15, 0xfffeffff, v15
v_perm_b32 v16, v30, v28, s46
v_perm_b32 v17, v30, v28, s47
v_perm_b32 v18, v31, v29, s46
v_perm_b32 v19, v31, v29, s47
v_min_u32 v16, 0xfffeffff, v16
v_min_u32 v17, 0xfffeffff, v17
v_min_u32 v18, 0xfffeffff, v18
v_min_u32 v19, 0xfffeffff, v19
v_perm_b32 v20, v34, v32, s46
v_perm_b32 v21, v34, v32, s47
v_perm_b32 v22, v35, v33, s46
v_perm_b32 v23, v35, v33, s47
v_min_u32 v20, 0xfffeffff, v20
v_min_u32 v21, 0xfffeffff, v21
v_min_u32 v22, 0xfffeffff, v22
v_min_u32 v23, 0xfffeffff, v23
s_cmp_lg_u32 s17, 0
s_cbranch_scc1 L_m0_62
ds_write_b128 v3, v[20:23] offset:14848
v_mov_b32 v64, 6528
v_mov_b32 v56, 0
v_mov_b32 v57, 0
v_mov_b32 v58, 0
v_mov_b32 v59, 0
ds_write_b128 v64, v[56:59]
L_m0_62:
s_waitcnt lgkmcnt(0)
s_barrier
ds_read_b32 v20, v8 offset:14848
s_waitcnt lgkmcnt(0)
s_mov_b32 s33, 109641728
s_mov_b32 s6, 109641728
s_mov_b32 s7, 109641728
s_mov_b32 s22, 0
s_cmp_eq_u32 s17, 0
s_cbranch_scc1 L_ent0
s_cmp_eq_u32 s17, 1
s_cbranch_scc1 L_ent1
s_cmp_eq_u32 s17, 2
s_cbranch_scc1 L_ent2
s_cmp_eq_u32 s17, 3
s_cbranch_scc1 L_ent3
s_branch L_end
L_ent0:
s_movk_i32 s4, -64
s_mov_b32 s14, s53
s_mov_b32 s15, s53
v_mov_b64 v[24:25], 0
v_mov_b64 v[26:27], 0
v_mov_b64 v[28:29], 0
v_mov_b64 v[30:31], 0
v_and_b32 v69, 0x380, v3
v_add_u32 v69, v69, v3
v_and_b32 v70, 0xf40, v3
v_add_u32 v70, v70, v3
v_bfe_u32 v71, v3, 7, 1
v_mad_i32_i24 v70, v71, s4, v70
v_mov_b64 v[64:65], -1
v_mov_b64 v[66:67], -1
v_add_u32 v1, 2112, v4
ds_read_b128 v[48:51], v2 offset:8192
ds_read_b128 v[52:55], v2 offset:9216
ds_read_b128 v[40:43], v2
ds_read_b128 v[44:47], v2 offset:1024
v_mov_b64 v[32:33], 0
v_mov_b64 v[34:35], 0
v_mov_b64 v[36:37], 0
v_mov_b64 v[38:39], 0
v_mov_b64 v[56:57], 0
v_mov_b64 v[58:59], 0
v_mov_b64 v[60:61], 0
v_mov_b64 v[62:63], 0
s_add_u32 s20, s30, 0
s_add_u32 s21, s30, 8192
s_add_u32 s49, s29, s25
s_add_u32 s50, s29, s26
s_add_u32 s51, s29, s27
s_add_u32 s52, s30, 524288
s_mov_b32 m0, 15872
s_nop 0
buffer_load_dwordx4 v69, s[8:11], s20 offen sc1 lds
s_mov_b32 m0, 16768
s_nop 0
buffer_load_dwordx4 v69, s[8:11], s20 offen offset:128 sc1 lds
s_waitcnt vmcnt(0) lgkmcnt(0)
s_branch L_step0
L_gr0:
buffer_load_dwordx4 v[12:15], v3, s[8:11], s33 offen sc1
buffer_load_dword v20, v8, s[8:11], s7 offen sc1
buffer_load_dwordx4 v[16:19], v3, s[8:11], s6 offen sc1
s_add_u32 s22, s22, 1
s_cmp_gt_u32 s22, 200000
s_cbranch_scc1 L_end
buffer_load_dwordx4 v[16:19], v3, s[8:11], s6 offen sc1
v_mov_b64 v[24:25], 0
v_mov_b64 v[26:27], 0
v_mov_b64 v[28:29], 0
v_mov_b64 v[30:31], 0
v_mov_b64 v[32:33], 0
v_mov_b64 v[34:35], 0
v_mov_b64 v[36:37], 0
v_mov_b64 v[38:39], 0
v_mov_b64 v[56:57], 0
v_mov_b64 v[58:59], 0
v_mov_b64 v[60:61], 0
v_mov_b64 v[62:63], 0
s_waitcnt lgkmcnt(0)
s_branch L_step0
.p2align 3
L_gat0:
buffer_load_dwordx4 v[12:15], v3, s[8:11], s33 offen sc1
buffer_load_dword v20, v8, s[8:11], s7 offen sc1
s_add_u32 s20, s30, 0
s_add_u32 s21, s30, 8192
s_add_u32 s49, s29, s25
s_add_u32 s50, s29, s26
s_add_u32 s51, s29, s27
s_add_u32 s52, s30, 524288
buffer_load_dwordx4 v[16:19], v3, s[8:11], s6 offen sc1
s_mov_b32 m0, 15872
s_waitcnt vmcnt(4)
ds_read_b128 v[40:43], v2
ds_read_b128 v[44:47], v2 offset:1024
v_mov_b64 v[32:33], 0
v_mov_b64 v[34:35], 0
v_mov_b64 v[36:37], 0
v_mov_b64 v[38:39], 0
v_mov_b64 v[56:57], 0
v_mov_b64 v[58:59], 0
v_mov_b64 v[60:61], 0
v_mov_b64 v[62:63], 0
s_nop 3
buffer_load_dwordx4 v[16:19], v3, s[8:11], s6 offen sc1
s_waitcnt lgkmcnt(0)
L_step0:
s_waitcnt vmcnt(3)
v_smfmac_f32_16x16x64_bf16 v[24:27], v[12:15], v[72:79], v0
ds_write_b128 v3, v[12:15] offset:6656
v_smfmac_f32_16x16x64_bf16 v[28:31], v[12:15], v[80:87], v0
s_waitcnt vmcnt(2)
v_max3_u32 v21, v12, v13, v14
v_max3_u32 v21, v21, v15, v20
v_cmp_le_u32 vcc, 0xffff0000, v21
v_smfmac_f32_16x16x64_bf16 v[32:35], v[12:15], v[88:95], v0
s_cbranch_vccnz L_gr0
s_waitcnt vmcnt(1)
v_max3_u32 v21, v16, v17, v18
v_max_u32 v21, v21, v19
v_cmp_le_u32 vcc, 0xffff0000, v21
ds_write_b32 v8, v20 offset:14848
v_smfmac_f32_16x16x64_bf16 v[56:59], v[12:15], a[32:39], v0
s_cbranch_vccnz L_g3r0
L_g30:
ds_write_b128 v3, v[16:19] offset:10752
v_smfmac_f32_16x16x64_bf16 v[60:63], v[12:15], a[40:47], v0
v_smfmac_f32_16x16x64_bf16 v[36:39], v[12:15], v[40:47], v0
v_smfmac_f32_16x16x64_bf16 v[24:27], v[16:19], v[168:175], v0
v_smfmac_f32_16x16x64_bf16 v[28:31], v[16:19], v[176:183], v0
s_waitcnt lgkmcnt(0)
s_barrier
ds_read_b128 v[20:23], v3 offset:7680
v_smfmac_f32_16x16x64_bf16 v[32:35], v[16:19], v[184:191], v0
ds_read_b128 v[12:15], v3 offset:8704
s_mov_b32 m0, 6272
buffer_store_dword v0, v11, s[8:11], s35 offen
v_smfmac_f32_16x16x64_bf16 v[56:59], v[16:19], a[96:103], v0
ds_read_b128 v[40:43], v2 offset:2048
buffer_store_dwordx4 v[64:67], v3, s[8:11], s49 offen
v_smfmac_f32_16x16x64_bf16 v[60:63], v[16:19], a[104:111], v0
ds_read_b128 v[44:47], v2 offset:3072
v_smfmac_f32_16x16x64_bf16 v[36:39], v[16:19], v[48:55], v0
s_waitcnt vmcnt(2)
ds_read_b128 v[16:19], v3 offset:9728
buffer_store_dwordx4 v[64:67], v3, s[8:11], s50 offen
s_waitcnt lgkmcnt(4)
v_smfmac_f32_16x16x64_bf16 v[24:27], v[20:23], v[96:103], v0
ds_read_b128 v[48:51], v2 offset:4096
v_smfmac_f32_16x16x64_bf16 v[28:31], v[20:23], v[104:111], v0
ds_read_b128 v[52:55], v2 offset:5120
buffer_store_dwordx4 v[64:67], v3, s[8:11], s51 offen
v_smfmac_f32_16x16x64_bf16 v[32:35], v[20:23], v[112:119], v0
s_waitcnt lgkmcnt(3)
v_smfmac_f32_16x16x64_bf16 v[36:39], v[20:23], v[40:47], v0
ds_read_b128 v[20:23], v3 offset:11776
buffer_load_dwordx4 v[64:67], v70, s[8:11], s21 offen sc1
v_smfmac_f32_16x16x64_bf16 v[24:27], v[12:15], v[120:127], v0
ds_read_b128 v[40:43], v2 offset:6144
v_smfmac_f32_16x16x64_bf16 v[28:31], v[12:15], v[128:135], v0
ds_read_b128 v[44:47], v2 offset:7168
buffer_load_dwordx4 v[68:71], v70, s[8:11], s21 offen offset:256 sc1
v_smfmac_f32_16x16x64_bf16 v[32:35], v[12:15], v[136:143], v0
s_waitcnt lgkmcnt(3)
v_smfmac_f32_16x16x64_bf16 v[36:39], v[12:15], v[48:55], v0
ds_read_b128 v[12:15], v3 offset:12800
v_smfmac_f32_16x16x64_bf16 v[24:27], v[16:19], v[144:151], v0
ds_read_b128 v[48:51], v2 offset:10240
v_smfmac_f32_16x16x64_bf16 v[28:31], v[16:19], v[152:159], v0
ds_read_b128 v[52:55], v2 offset:11264
v_smfmac_f32_16x16x64_bf16 v[32:35], v[16:19], v[160:167], v0
s_waitcnt lgkmcnt(3)
buffer_load_dword v6, s[8:11], s52 offen sc1 lds
v_smfmac_f32_16x16x64_bf16 v[36:39], v[16:19], v[40:47], v0
ds_read_b128 v[16:19], v3 offset:13824
v_smfmac_f32_16x16x64_bf16 v[24:27], v[20:23], v[192:199], v0
ds_read_b128 v[40:43], v2 offset:12288
v_smfmac_f32_16x16x64_bf16 v[28:31], v[20:23], v[200:207], v0
ds_read_b128 v[44:47], v2 offset:13312
v_smfmac_f32_16x16x64_bf16 v[32:35], v[20:23], v[208:215], v0
s_waitcnt lgkmcnt(3)
v_smfmac_f32_16x16x64_bf16 v[36:39], v[20:23], v[48:55], v0
ds_read_b128 v[20:23], v3 offset:14848
v_smfmac_f32_16x16x64_bf16 v[24:27], v[12:15], v[216:223], v0
ds_read_b128 v[48:51], v2 offset:14336
v_smfmac_f32_16x16x64_bf16 v[28:31], v[12:15], v[224:231], v0
ds_read_b128 v[52:55], v2 offset:15360
v_smfmac_f32_16x16x64_bf16 v[32:35], v[12:15], v[232:239], v0
s_waitcnt lgkmcnt(3)
v_smfmac_f32_16x16x64_bf16 v[36:39], v[12:15], v[40:47], v0
ds_read_b128 v[12:15], v3 offset:7680
v_smfmac_f32_16x16x64_bf16 v[24:27], v[16:19], v[240:247], v0
ds_read_b128 v[40:43], v2 offset:16384
v_smfmac_f32_16x16x64_bf16 v[28:31], v[16:19], v[248:255], v0
ds_read_b128 v[44:47], v2 offset:17408
v_smfmac_f32_16x16x64_bf16 v[32:35], v[16:19], a[0:7], v0
s_waitcnt lgkmcnt(3)
v_smfmac_f32_16x16x64_bf16 v[36:39], v[16:19], v[48:55], v0
ds_read_b128 v[16:19], v3 offset:8704
v_smfmac_f32_16x16x64_bf16 v[24:27], v[20:23], a[8:15], v0
ds_read_b128 v[48:51], v3 offset:19968
v_smfmac_f32_16x16x64_bf16 v[28:31], v[20:23], a[16:23], v0
ds_read_b128 v[52:55], v3 offset:22016
v_smfmac_f32_16x16x64_bf16 v[32:35], v[20:23], a[24:31], v0
s_waitcnt lgkmcnt(3)
v_smfmac_f32_16x16x64_bf16 v[36:39], v[20:23], v[40:47], v0
ds_read_b128 v[20:23], v3 offset:9728
s_nop 0
v_add_f32 v24, v24, v25
v_smfmac_f32_16x16x64_bf16 v[56:59], v[12:15], a[48:55], v0
ds_read_b128 v[40:43], v3 offset:15872
v_add_f32 v26, v26, v27
v_add_f32 v28, v28, v29
v_add_f32 v30, v30, v31
v_mul_f32 v24, s18, v24
v_smfmac_f32_16x16x64_bf16 v[60:63], v[12:15], a[56:63], v0
ds_read_b128 v[12:15], v3 offset:11776
v_mul_f32 v28, s18, v28
v_mul_f32 v26, s18, v26
v_mul_f32 v30, s18, v30
v_cvt_pk_bf16_f32 v24, v24, v28
s_waitcnt lgkmcnt(5)
v_smfmac_f32_16x16x64_bf16 v[56:59], v[16:19], a[64:71], v0
ds_read_b128 v[44:47], v3 offset:17920
v_cvt_pk_bf16_f32 v26, v26, v30
ds_write2_b32 v1, v24, v26 offset1:32
v_add_f32 v32, v32, v33
v_add_f32 v34, v34, v35
v_smfmac_f32_16x16x64_bf16 v[60:63], v[16:19], a[72:79], v0
ds_read_b128 v[16:19], v3 offset:12800
v_add_f32 v36, v36, v37
v_add_f32 v38, v38, v39
v_cvt_pk_bf16_f32 v1, v32, v36
v_cvt_pk_bf16_f32 v8, v34, v38
s_waitcnt lgkmcnt(5)
v_smfmac_f32_16x16x64_bf16 v[56:59], v[20:23], a[80:87], v0
ds_write2_b32 v4, v1, v8 offset1:32
v_smfmac_f32_16x16x64_bf16 v[60:63], v[20:23], a[88:95], v0
s_waitcnt lgkmcnt(4)
ds_read_b128 v[20:23], v3 offset:13824
v_smfmac_f32_16x16x64_bf16 v[56:59], v[12:15], a[112:119], v0
v_smfmac_f32_16x16x64_bf16 v[60:63], v[12:15], a[120:127], v0
s_waitcnt lgkmcnt(2)
ds_read_b128 v[12:15], v3 offset:14848
v_smfmac_f32_16x16x64_bf16 v[56:59], v[16:19], a[128:135], v0
v_smfmac_f32_16x16x64_bf16 v[60:63], v[16:19], a[136:143], v0
s_waitcnt lgkmcnt(2)
s_barrier
ds_read_b128 v[24:27], v5
s_waitcnt lgkmcnt(2)
v_smfmac_f32_16x16x64_bf16 v[56:59], v[20:23], a[144:151], v0
ds_read_b128 v[28:31], v5 offset:512
v_smfmac_f32_16x16x64_bf16 v[60:63], v[20:23], a[152:159], v0
s_waitcnt lgkmcnt(2)
ds_read_b128 v[32:35], v5 offset:1024
v_smfmac_f32_16x16x64_bf16 v[56:59], v[12:15], a[160:167], v0
ds_read_b128 v[36:39], v5 offset:1536
v_smfmac_f32_16x16x64_bf16 v[60:63], v[12:15], a[168:175], v0
s_waitcnt lgkmcnt(3)
v_mfma_f32_16x16x32_bf16 v[16:19], v[40:43], v[24:27], 0
s_waitcnt lgkmcnt(2)
ds_read_b128 v[40:43], v3 offset:16896
v_mfma_f32_16x16x32_bf16 v[16:19], v[44:47], v[28:31], v[16:19]
s_waitcnt lgkmcnt(2)
ds_read_b128 v[44:47], v3 offset:18944
v_mfma_f32_16x16x32_bf16 v[16:19], v[48:51], v[32:35], v[16:19]
s_waitcnt lgkmcnt(2)
ds_read_b128 v[48:51], v3 offset:20992
v_add_f32 v56, v56, v57
v_mfma_f32_16x16x32_bf16 v[16:19], v[52:55], v[36:39], v[16:19]
ds_read_b128 v[52:55], v3 offset:23040
v_add_f32 v58, v58, v59
v_mfma_f32_16x16x32_bf16 v[20:23], v[24:27], v[24:27], 0
s_add_u32 s49, s28, s23
v_add_f32 v60, v60, v61
v_add_f32 v62, v62, v63
v_mfma_f32_16x16x32_bf16 v[20:23], v[28:31], v[28:31], v[20:23]
s_add_u32 s50, s28, 65536
v_cvt_pk_bf16_f32 v56, v56, v58
v_cvt_pk_bf16_f32 v57, v60, v62
v_mfma_f32_16x16x32_bf16 v[20:23], v[32:35], v[32:35], v[20:23]
s_add_u32 s51, s28, 131072
v_mov_b32 v58, v1
v_mov_b32 v59, v8
v_exp_f32 v16, v16
buffer_store_dwordx4 v[56:59], v3, s[8:11], s31 offen sc1
v_mfma_f32_16x16x32_bf16 v[20:23], v[36:39], v[36:39], v[20:23]
s_waitcnt lgkmcnt(3)
v_exp_f32 v17, v17
v_mfma_f32_16x16x32_bf16 v[12:15], v[40:43], v[24:27], 0
s_waitcnt lgkmcnt(2)
v_exp_f32 v18, v18
v_mfma_f32_16x16x32_bf16 v[12:15], v[44:47], v[28:31], v[12:15]
s_waitcnt lgkmcnt(1)
v_exp_f32 v19, v19
v_mfma_f32_16x16x32_bf16 v[12:15], v[48:51], v[32:35], v[12:15]
s_waitcnt lgkmcnt(0)
v_exp_f32 v20, v20
v_mfma_f32_16x16x32_bf16 v[12:15], v[52:55], v[36:39], v[12:15]
s_add_u32 s52, s28, 196608
v_exp_f32 v21, v21
v_mov_b64 v[60:61], s[14:15]
v_cvt_pk_bf16_f32 v23, v20, v21
v_cvt_pk_bf16_f32 v20, v20, v21
v_mov_b32 v21, 0
v_mov_b32 v22, 0
v_cvt_pk_bf16_f32 v16, v16, v17
v_cvt_pk_bf16_f32 v17, v18, v19
v_mfma_f32_16x16x16_bf16 v[24:27], v[56:57], v[20:21], 0
v_exp_f32 v12, v12
v_mfma_f32_16x16x16_bf16 v[28:31], v[56:57], v[22:23], 0
v_exp_f32 v13, v13
v_mfma_f32_16x16x16_bf16 v[32:35], v[60:61], v[20:21], 0
v_exp_f32 v14, v14
v_exp_f32 v15, v15
v_mov_b64 v[62:63], s[14:15]
v_cvt_pk_bf16_f32 v18, v12, v13
v_cvt_pk_bf16_f32 v19, v14, v15
s_waitcnt vmcnt(2)
ds_read_b128 v[40:43], v2 offset:18432
v_mfma_f32_16x16x32_bf16 v[32:35], v[60:63], v[16:19], v[32:35]
ds_read_b128 v[44:47], v2 offset:19456
v_mov_b32 v20, 0
v_mfma_f32_16x16x32_bf16 v[24:27], v[64:67], v[16:19], v[24:27]
ds_read_b128 v[48:51], v2 offset:20480
v_mov_b32 v23, 0
v_mfma_f32_16x16x32_bf16 v[28:31], v[68:71], v[16:19], v[28:31]
ds_read_b128 v[52:55], v2 offset:21504
v_mov_b32 v15, 0
v_rcp_f32 v12, v32
v_subrev_u32 v14, 0x21800000, v32
v_cmp_le_u32 vcc, 0x3c000000, v14
v_pk_mul_f32 v[24:25], v[24:25], v[12:13] op_sel_hi:[1,0]
v_pk_mul_f32 v[26:27], v[26:27], v[12:13] op_sel_hi:[1,0]
ds_read_b128 v[32:35], v2 offset:22528
v_pk_mul_f32 v[28:29], v[28:29], v[12:13] op_sel_hi:[1,0]
v_pk_mul_f32 v[30:31], v[30:31], v[12:13] op_sel_hi:[1,0]
v_cvt_pk_bf16_f32 v24, v24, v28
v_cvt_pk_bf16_f32 v25, v25, v29
v_cvt_pk_bf16_f32 v26, v26, v30
v_cvt_pk_bf16_f32 v27, v27, v31
v_mfma_f32_16x16x32_bf16 v[16:19], v[20:23], v[20:23], 0
ds_write_b128 v7, v[24:27]
v_mfma_f32_16x16x32_bf16 v[12:15], v[20:23], v[20:23], 0
s_andn2_b64 vcc, vcc, s[86:87]
ds_read_b128 v[36:39], v2 offset:23552
s_cbranch_scc1 L_sm0
L_smr0:
v_mfma_f32_16x16x32_bf16 v[56:59], v[20:23], v[20:23], 0
v_mov_b32 v1, 6528
v_and_b32 v8, 0x380, v3
s_add_u32 s20, s30, 524288
v_add_u32 v8, v8, v3
s_mov_b32 m0, 15872
s_cmp_eq_u32 s19, 63
s_cbranch_scc1 L_texit
s_waitcnt lgkmcnt(0)
s_barrier
ds_read_b128 v[24:27], v3 offset:4224
v_mfma_f32_16x16x32_bf16 v[64:67], v[20:23], v[20:23], 0
ds_read_b128 v[28:31], v3 offset:5248
v_mfma_f32_16x16x32_bf16 v[60:63], v[20:23], v[20:23], 0
v_mfma_f32_16x16x32_bf16 v[68:71], v[20:23], v[20:23], 0
s_waitcnt lgkmcnt(1)
v_smfmac_f32_16x16x64_bf16 v[12:15], v[24:27], a[248:255], v0
buffer_load_dwordx4 v8, s[8:11], s20 offen sc1 lds
v_smfmac_f32_16x16x64_bf16 v[16:19], v[24:27], a[176:183], v0
s_mov_b32 m0, 16768
s_waitcnt lgkmcnt(0)
v_smfmac_f32_16x16x64_bf16 v[12:15], v[28:31], v[40:47], v0
ds_read_b128 v[40:43], v2 offset:24576
v_smfmac_f32_16x16x64_bf16 v[16:19], v[28:31], v[48:55], v0
ds_read_b128 v[44:47], v2 offset:25600
buffer_load_dwordx4 v8, s[8:11], s20 offen offset:128 sc1 lds
v_smfmac_f32_16x16x64_bf16 v[20:23], v[24:27], a[184:191], v0
ds_read_b128 v[48:51], v2 offset:26624
s_nop 1
v_add_f32 v12, v12, v13
v_add_f32 v14, v14, v15
v_cvt_pk_bf16_f32 v12, v12, v14
v_smfmac_f32_16x16x64_bf16 v[20:23], v[28:31], v[32:39], v0
ds_read_b128 v[52:55], v2 offset:27648
buffer_store_dword v12, v10, s[8:11], s28 offen
v_add_f32 v16, v16, v17
v_add_f32 v18, v18, v19
v_smfmac_f32_16x16x64_bf16 v[56:59], v[24:27], a[192:199], v0
s_waitcnt lgkmcnt(2)
ds_read_b128 v[32:35], v2 offset:28672
v_cvt_pk_bf16_f32 v16, v16, v18
v_smfmac_f32_16x16x64_bf16 v[56:59], v[28:31], v[40:47], v0
ds_read_b128 v[36:39], v2 offset:29696
v_add_f32 v20, v20, v21
v_add_f32 v22, v22, v23
v_cvt_pk_bf16_f32 v17, v20, v22
v_smfmac_f32_16x16x64_bf16 v[60:63], v[24:27], a[200:207], v0
s_waitcnt lgkmcnt(2)
ds_read_b128 v[12:15], v1
buffer_store_dwordx2 v[16:17], v9, s[8:11], s28 offen
v_smfmac_f32_16x16x64_bf16 v[60:63], v[28:31], v[48:55], v0
ds_read_b128 v[40:43], v2 offset:30720
v_add_f32 v56, v56, v57
v_add_f32 v58, v58, v59
v_cvt_pk_bf16_f32 v56, v56, v58
v_smfmac_f32_16x16x64_bf16 v[64:67], v[24:27], a[208:215], v0
s_waitcnt lgkmcnt(2)
ds_read_b128 v[44:47], v2 offset:31744
v_smfmac_f32_16x16x64_bf16 v[64:67], v[28:31], v[32:39], v0
ds_read_b128 v[20:23], v1
v_add_f32 v60, v60, v61
v_add_f32 v62, v62, v63
v_cvt_pk_bf16_f32 v57, v60, v62
v_smfmac_f32_16x16x64_bf16 v[68:71], v[24:27], a[216:223], v0
s_waitcnt lgkmcnt(1)
ds_read_b128 v[48:51], v2 offset:32768
buffer_store_dwordx2 v[56:57], v9, s[8:11], s50 offen
v_smfmac_f32_16x16x64_bf16 v[68:71], v[28:31], v[40:47], v0
ds_read_b128 v[52:55], v2 offset:33792
v_add_f32 v64, v64, v65
v_add_f32 v66, v66, v67
v_cvt_pk_bf16_f32 v64, v64, v66
v_smfmac_f32_16x16x64_bf16 v[12:15], v[24:27], a[224:231], v0
s_waitcnt lgkmcnt(0)
v_smfmac_f32_16x16x64_bf16 v[12:15], v[28:31], v[48:55], v0
s_nop 0
v_add_f32 v68, v68, v69
v_add_f32 v70, v70, v71
v_cvt_pk_bf16_f32 v65, v68, v70
v_smfmac_f32_16x16x64_bf16 v[20:23], v[24:27], a[232:239], v0
buffer_store_dwordx2 v[64:65], v9, s[8:11], s51 offen
v_smfmac_f32_16x16x64_bf16 v[20:23], v[28:31], a[240:247], v0
s_nop 0
v_add_f32 v12, v12, v13
v_add_f32 v14, v14, v15
v_cvt_pk_bf16_f32 v12, v12, v14
s_nop 3
v_add_f32 v20, v20, v21
v_add_f32 v22, v22, v23
v_cvt_pk_bf16_f32 v13, v20, v22
buffer_store_dwordx2 v[12:13], v9, s[8:11], s52 offen
L_lt0:
s_nop 15
s_nop 15
s_nop 0
buffer_load_dwordx4 v[32:35], v3, s[8:11], s49 offen sc1
buffer_load_dwordx4 v[36:39], v3, s[8:11], s49 offen offset:1024 sc1
buffer_load_dwordx4 v[40:43], v3, s[8:11], s49 offen offset:2048 sc1
buffer_load_dwordx4 v[44:47], v3, s[8:11], s49 offen offset:3072 sc1
s_add_u32 s19, s19, 1
s_mov_b32 s20, s28
s_mov_b32 s28, s29
s_mov_b32 s29, s20
s_and_b32 s20, s19, 3
s_lshl_b32 s20, s20, 14
s_add_u32 s33, s20, 109641728
s_add_u32 s34, s20, s24
s_xor_b32 s20, s20, 32768
s_add_u32 s35, s20, s24
s_add_u32 s30, s30, 524288
s_add_u32 s31, s31, 131072
s_add_u32 s6, s33, 4096
s_add_u32 s7, s33, 8192
s_mov_b32 s22, 0
buffer_load_dwordx4 v[32:35], v3, s[8:11], s49 offen sc1
buffer_load_dwordx4 v[36:39], v3, s[8:11], s49 offen offset:1024 sc1
buffer_load_dwordx4 v[40:43], v3, s[8:11], s49 offen offset:2048 sc1
buffer_load_dwordx4 v[44:47], v3, s[8:11], s49 offen offset:3072 sc1
v_mov_b64 v[24:25], 0
v_mov_b64 v[26:27], 0
v_mov_b64 v[28:29], 0
v_mov_b64 v[30:31], 0
v_and_b32 v70, 0xf40, v3
v_add_u32 v70, v70, v3
v_bfe_u32 v71, v3, 7, 1
v_mad_i32_i24 v70, v71, s4, v70
v_mov_b64 v[64:65], -1
v_mov_b64 v[66:67], -1
v_add_u32 v1, 2112, v4
ds_read_b128 v[48:51], v2 offset:8192
ds_read_b128 v[52:55], v2 offset:9216
v_lshrrev_b32 v8, 2, v3
v_mov_b32 v56, 0x3f80
v_cndmask_b32 v56, v56, 1.0, s[44:45]
v_cndmask_b32 v60, 0, v56, s[36:37]
v_cndmask_b32 v61, 0, v56, s[38:39]
v_cndmask_b32 v62, 0, v56, s[40:41]
v_cndmask_b32 v63, 0, v56, s[42:43]
s_waitcnt vmcnt(7)
v_max3_u32 v16, v32, v33, v34
v_max_u32 v16, v16, v35
v_mfma_f32_16x16x32_bf16 v[56:59], v[32:35], v[60:63], 0
s_waitcnt vmcnt(6)
v_max3_u32 v16, v16, v36, v37
v_max3_u32 v16, v16, v38, v39
v_mfma_f32_16x16x32_bf16 v[56:59], v[36:39], v[60:63], v[56:59]
s_waitcnt vmcnt(5)
v_max3_u32 v16, v16, v40, v41
v_max3_u32 v16, v16, v42, v43
v_mfma_f32_16x16x32_bf16 v[56:59], v[40:43], v[60:63], v[56:59]
s_waitcnt vmcnt(4)
v_max3_u32 v16, v16, v44, v45
v_max3_u32 v16, v16, v46, v47
v_mfma_f32_16x16x32_bf16 v[56:59], v[44:47], v[60:63], v[56:59]
v_cmp_le_u32 vcc, 0xffff0000, v16
s_cbranch_vccnz L_red0
L_redb0:
s_nop 5
v_permlane32_swap_b32 v56, v58
v_permlane32_swap_b32 v57, v59
v_pk_add_f32 v[56:57], v[56:57], v[58:59]
v_cvt_pk_bf16_f32 v56, v56, v57
buffer_store_dword v56, v11, s[8:11], s34 offen
s_add_u32 s20, s30, 0
s_add_u32 s21, s30, 8192
s_add_u32 s49, s29, s25
s_add_u32 s50, s29, s26
s_add_u32 s51, s29, s27
s_add_u32 s52, s30, 524288
s_mov_b32 m0, 15872
s_nop 9
s_barrier
s_branch L_gat0
L_red0:
s_waitcnt vmcnt(3)
v_mfma_f32_16x16x32_bf16 v[56:59], v[32:35], v[60:63], 0
v_max3_u32 v16, v32, v33, v34
v_max_u32 v16, v16, v35
s_waitcnt vmcnt(2)
v_mfma_f32_16x16x32_bf16 v[56:59], v[36:39], v[60:63], v[56:59]
v_max3_u32 v16, v16, v36, v37
v_max3_u32 v16, v16, v38, v39
s_waitcnt vmcnt(1)
v_mfma_f32_16x16x32_bf16 v[56:59], v[40:43], v[60:63], v[56:59]
v_max3_u32 v16, v16, v40, v41
v_max3_u32 v16, v16, v42, v43
s_waitcnt vmcnt(0)
v_mfma_f32_16x16x32_bf16 v[56:59], v[44:47], v[60:63], v[56:59]
v_max3_u32 v16, v16, v44, v45
v_max3_u32 v16, v16, v46, v47
v_cmp_le_u32 vcc, 0xffff0000, v16
s_cbranch_vccz L_redb0
L_red0b:
buffer_load_dwordx4 v[32:35], v3, s[8:11], s49 offen sc1
buffer_load_dwordx4 v[36:39], v3, s[8:11], s49 offen offset:1024 sc1
buffer_load_dwordx4 v[40:43], v3, s[8:11], s49 offen offset:2048 sc1
buffer_load_dwordx4 v[44:47], v3, s[8:11], s49 offen offset:3072 sc1
s_add_u32 s22, s22, 1
s_cmp_gt_u32 s22, 200000
s_cbranch_scc1 L_end
s_waitcnt vmcnt(3)
v_mfma_f32_16x16x32_bf16 v[56:59], v[32:35], v[60:63], 0
v_max3_u32 v16, v32, v33, v34
v_max_u32 v16, v16, v35
s_waitcnt vmcnt(2)
v_mfma_f32_16x16x32_bf16 v[56:59], v[36:39], v[60:63], v[56:59]
v_max3_u32 v16, v16, v36, v37
v_max3_u32 v16, v16, v38, v39
s_waitcnt vmcnt(1)
v_mfma_f32_16x16x32_bf16 v[56:59], v[40:43], v[60:63], v[56:59]
v_max3_u32 v16, v16, v40, v41
v_max3_u32 v16, v16, v42, v43
s_waitcnt vmcnt(0)
v_mfma_f32_16x16x32_bf16 v[56:59], v[44:47], v[60:63], v[56:59]
v_max3_u32 v16, v16, v44, v45
v_max3_u32 v16, v16, v46, v47
v_cmp_le_u32 vcc, 0xffff0000, v16
s_cbranch_vccz L_redb0
s_branch L_red0b
L_g3r0:
buffer_load_dwordx4 v[16:19], v3, s[8:11], s6 offen sc1
s_add_u32 s22, s22, 1
s_waitcnt vmcnt(1)
v_max3_u32 v21, v16, v17, v18
v_max_u32 v21, v21, v19
v_cmp_le_u32 vcc, 0xffff0000, v21
s_cmp_gt_u32 s22, 200000
s_cbranch_vccz L_g30
s_cbranch_scc0 L_g3r0
s_branch L_end
L_sm0:
s_waitcnt lgkmcnt(0)
ds_read_b128 v[24:27], v5
ds_read_b128 v[40:43], v3 offset:15872
ds_read_b128 v[28:31], v5 offset:512
ds_read_b128 v[44:47], v3 offset:17920
ds_read_b128 v[32:35], v5 offset:1024
ds_read_b128 v[48:51], v3 offset:19968
ds_read_b128 v[36:39], v5 offset:1536
ds_read_b128 v[52:55], v3 offset:22016
s_waitcnt lgkmcnt(0)
v_mfma_f32_16x16x32_bf16 v[16:19], v[40:43], v[24:27], 0
ds_read_b128 v[40:43], v3 offset:16896
v_mfma_f32_16x16x32_bf16 v[16:19], v[44:47], v[28:31], v[16:19]
ds_read_b128 v[44:47], v3 offset:18944
v_mfma_f32_16x16x32_bf16 v[16:19], v[48:51], v[32:35], v[16:19]
ds_read_b128 v[48:51], v3 offset:20992
v_mfma_f32_16x16x32_bf16 v[16:19], v[52:55], v[36:39], v[16:19]
ds_read_b128 v[52:55], v3 offset:23040
v_mfma_f32_16x16x32_bf16 v[20:23], v[24:27], v[24:27], 0
v_mfma_f32_16x16x32_bf16 v[20:23], v[28:31], v[28:31], v[20:23]
v_mfma_f32_16x16x32_bf16 v[20:23], v[32:35], v[32:35], v[20:23]
v_mfma_f32_16x16x32_bf16 v[20:23], v[36:39], v[36:39], v[20:23]
s_waitcnt lgkmcnt(0)
v_mfma_f32_16x16x32_bf16 v[12:15], v[40:43], v[24:27], 0
v_mfma_f32_16x16x32_bf16 v[12:15], v[44:47], v[28:31], v[12:15]
v_mfma_f32_16x16x32_bf16 v[12:15], v[48:51], v[32:35], v[12:15]
v_mfma_f32_16x16x32_bf16 v[12:15], v[52:55], v[36:39], v[12:15]
v_max3_f32 v59, v16, v17, v18
s_nop 1
v_max3_f32 v59, v59, v19, v20
s_nop 3
v_max3_f32 v59, v59, v21, v12
v_max3_f32 v59, v59, v13, v14
v_max_f32 v59, v59, v15
v_mov_b32 v22, v59
s_nop 1
v_permlane32_swap_b32 v22, v59
v_max_f32 v59, v59, v22
v_mov_b32 v22, v59
s_nop 1
v_permlane16_swap_b32 v22, v59
v_max_f32 v59, v59, v22
v_sub_f32 v20, v20, v59
v_sub_f32 v21, v21, v59
v_sub_f32 v16, v16, v59
v_sub_f32 v17, v17, v59
v_sub_f32 v18, v18, v59
v_sub_f32 v19, v19, v59
v_sub_f32 v12, v12, v59
v_sub_f32 v13, v13, v59
v_sub_f32 v14, v14, v59
v_sub_f32 v15, v15, v59
v_exp_f32 v20, v20
v_exp_f32 v21, v21
v_exp_f32 v16, v16
v_exp_f32 v17, v17
v_exp_f32 v18, v18
v_exp_f32 v19, v19
v_exp_f32 v12, v12
v_exp_f32 v13, v13
v_exp_f32 v14, v14
v_exp_f32 v15, v15
v_cvt_pk_bf16_f32 v23, v20, v21
v_cvt_pk_bf16_f32 v20, v20, v21
v_mov_b32 v21, 0
v_mov_b32 v22, 0
v_cvt_pk_bf16_f32 v16, v16, v17
v_cvt_pk_bf16_f32 v17, v18, v19
v_cvt_pk_bf16_f32 v18, v12, v13
v_cvt_pk_bf16_f32 v19, v14, v15
v_mfma_f32_16x16x16_bf16 v[24:27], v[56:57], v[20:21], 0
v_mfma_f32_16x16x16_bf16 v[28:31], v[56:57], v[22:23], 0
v_mfma_f32_16x16x16_bf16 v[32:35], v[60:61], v[20:21], 0
ds_read_b128 v[40:43], v2 offset:18432
v_mfma_f32_16x16x32_bf16 v[32:35], v[60:63], v[16:19], v[32:35]
ds_read_b128 v[44:47], v2 offset:19456
v_mov_b32 v20, 0
v_mfma_f32_16x16x32_bf16 v[24:27], v[64:67], v[16:19], v[24:27]
ds_read_b128 v[48:51], v2 offset:20480
v_mov_b32 v23, 0
v_mfma_f32_16x16x32_bf16 v[28:31], v[68:71], v[16:19], v[28:31]
ds_read_b128 v[52:55], v2 offset:21504
v_mov_b32 v15, 0
v_rcp_f32 v12, v32
v_subrev_u32 v14, 0x21800000, v32
v_cmp_le_u32 vcc, 0x3c000000, v14
v_pk_mul_f32 v[24:25], v[24:25], v[12:13] op_sel_hi:[1,0]
v_pk_mul_f32 v[26:27], v[26:27], v[12:13] op_sel_hi:[1,0]
ds_read_b128 v[32:35], v2 offset:22528
v_pk_mul_f32 v[28:29], v[28:29], v[12:13] op_sel_hi:[1,0]
v_pk_mul_f32 v[30:31], v[30:31], v[12:13] op_sel_hi:[1,0]
v_cvt_pk_bf16_f32 v24, v24, v28
v_cvt_pk_bf16_f32 v25, v25, v29
v_cvt_pk_bf16_f32 v26, v26, v30
v_cvt_pk_bf16_f32 v27, v27, v31
v_mfma_f32_16x16x32_bf16 v[16:19], v[20:23], v[20:23], 0
ds_write_b128 v7, v[24:27]
v_mfma_f32_16x16x32_bf16 v[12:15], v[20:23], v[20:23], 0
ds_read_b128 v[36:39], v2 offset:23552
s_branch L_smr0
L_ent1:
s_movk_i32 s4, -64
s_mov_b32 s14, s53
s_mov_b32 s15, s53
v_mov_b64 v[24:25], 0
v_mov_b64 v[26:27], 0
v_mov_b64 v[28:29], 0
v_mov_b64 v[30:31], 0
v_and_b32 v69, 0x380, v3
v_add_u32 v69, v69, v3
v_and_b32 v70, 0xf40, v3
v_add_u32 v70, v70, v3
v_bfe_u32 v71, v3, 7, 1
v_mad_i32_i24 v70, v71, s4, v70
v_mov_b64 v[64:65], -1
v_mov_b64 v[66:67], -1
v_add_u32 v1, 2112, v4
ds_read_b128 v[48:51], v2 offset:10240
ds_read_b128 v[52:55], v2 offset:11264
ds_read_b128 v[40:43], v2 offset:2048
ds_read_b128 v[44:47], v2 offset:3072
v_mov_b64 v[32:33], 0
v_mov_b64 v[34:35], 0
v_mov_b64 v[36:37], 0
v_mov_b64 v[38:39], 0
v_mov_b64 v[56:57], 0
v_mov_b64 v[58:59], 0
v_mov_b64 v[60:61], 0
v_mov_b64 v[62:63], 0
s_add_u32 s20, s30, 1024
s_add_u32 s21, s30, 8192
s_add_u32 s49, s29, s25
s_add_u32 s50, s29, s26
s_add_u32 s51, s29, s27
s_add_u32 s52, s30, 524288
s_mov_b32 m0, 17920
s_nop 0
buffer_load_dwordx4 v69, s[8:11], s20 offen sc1 lds
s_mov_b32 m0, 18816
s_nop 0
buffer_load_dwordx4 v69, s[8:11], s20 offen offset:128 sc1 lds
s_waitcnt vmcnt(0) lgkmcnt(0)
s_branch L_step1
L_gr1:
buffer_load_dwordx4 v[12:15], v3, s[8:11], s33 offen sc1
buffer_load_dword v20, v8, s[8:11], s7 offen sc1
buffer_load_dwordx4 v[16:19], v3, s[8:11], s6 offen sc1
s_add_u32 s22, s22, 1
s_cmp_gt_u32 s22, 200000
s_cbranch_scc1 L_end
buffer_load_dwordx4 v[16:19], v3, s[8:11], s6 offen sc1
v_mov_b64 v[24:25], 0
v_mov_b64 v[26:27], 0
v_mov_b64 v[28:29], 0
v_mov_b64 v[30:31], 0
v_mov_b64 v[32:33], 0
v_mov_b64 v[34:35], 0
v_mov_b64 v[36:37], 0
v_mov_b64 v[38:39], 0
v_mov_b64 v[56:57], 0
v_mov_b64 v[58:59], 0
v_mov_b64 v[60:61], 0
v_mov_b64 v[62:63], 0
s_waitcnt lgkmcnt(0)
s_branch L_step1
.p2align 3
L_gat1:
buffer_load_dwordx4 v[12:15], v3, s[8:11], s33 offen sc1
buffer_load_dword v20, v8, s[8:11], s7 offen sc1
s_add_u32 s20, s30, 1024
s_add_u32 s21, s30, 8192
s_add_u32 s49, s29, s25
s_add_u32 s50, s29, s26
s_add_u32 s51, s29, s27
s_add_u32 s52, s30, 524288
buffer_load_dwordx4 v[16:19], v3, s[8:11], s6 offen sc1
s_mov_b32 m0, 17920
s_waitcnt vmcnt(4)
ds_read_b128 v[40:43], v2 offset:2048
ds_read_b128 v[44:47], v2 offset:3072
v_mov_b64 v[32:33], 0
v_mov_b64 v[34:35], 0
v_mov_b64 v[36:37], 0
v_mov_b64 v[38:39], 0
v_mov_b64 v[56:57], 0
v_mov_b64 v[58:59], 0
v_mov_b64 v[60:61], 0
v_mov_b64 v[62:63], 0
s_nop 3
buffer_load_dwordx4 v[16:19], v3, s[8:11], s6 offen sc1
s_waitcnt lgkmcnt(0)
L_step1:
s_waitcnt vmcnt(3)
v_smfmac_f32_16x16x64_bf16 v[24:27], v[12:15], v[96:103], v0
ds_write_b128 v3, v[12:15] offset:6656
v_smfmac_f32_16x16x64_bf16 v[28:31], v[12:15], v[104:111], v0
s_waitcnt vmcnt(2)
v_max3_u32 v21, v12, v13, v14
v_max3_u32 v21, v21, v15, v20
v_cmp_le_u32 vcc, 0xffff0000, v21
v_smfmac_f32_16x16x64_bf16 v[32:35], v[12:15], v[112:119], v0
s_cbranch_vccnz L_gr1
s_waitcnt vmcnt(1)
v_max3_u32 v21, v16, v17, v18
v_max_u32 v21, v21, v19
v_cmp_le_u32 vcc, 0xffff0000, v21
ds_write_b32 v8, v20 offset:14848
v_smfmac_f32_16x16x64_bf16 v[56:59], v[12:15], a[48:55], v0
s_cbranch_vccnz L_g3r1
L_g31:
ds_write_b128 v3, v[16:19] offset:10752
v_smfmac_f32_16x16x64_bf16 v[60:63], v[12:15], a[56:63], v0
v_smfmac_f32_16x16x64_bf16 v[36:39], v[12:15], v[40:47], v0
v_smfmac_f32_16x16x64_bf16 v[24:27], v[16:19], v[192:199], v0
v_smfmac_f32_16x16x64_bf16 v[28:31], v[16:19], v[200:207], v0
s_waitcnt lgkmcnt(0)
s_barrier
ds_read_b128 v[20:23], v3 offset:5632
v_smfmac_f32_16x16x64_bf16 v[32:35], v[16:19], v[208:215], v0
ds_read_b128 v[12:15], v3 offset:7680
s_mov_b32 m0, 6272
buffer_store_dword v0, v11, s[8:11], s35 offen
v_smfmac_f32_16x16x64_bf16 v[56:59], v[16:19], a[112:119], v0
ds_read_b128 v[40:43], v2
v_smfmac_f32_16x16x64_bf16 v[60:63], v[16:19], a[120:127], v0
ds_read_b128 v[44:47], v2 offset:1024
buffer_store_dwordx4 v[64:67], v3, s[8:11], s49 offen
v_smfmac_f32_16x16x64_bf16 v[36:39], v[16:19], v[48:55], v0
s_waitcnt vmcnt(2)
ds_read_b128 v[16:19], v3 offset:8704
s_waitcnt lgkmcnt(4)
v_smfmac_f32_16x16x64_bf16 v[24:27], v[20:23], v[72:79], v0
ds_read_b128 v[48:51], v2 offset:4096
buffer_store_dwordx4 v[64:67], v3, s[8:11], s50 offen
v_smfmac_f32_16x16x64_bf16 v[28:31], v[20:23], v[80:87], v0
ds_read_b128 v[52:55], v2 offset:5120
v_smfmac_f32_16x16x64_bf16 v[32:35], v[20:23], v[88:95], v0
s_waitcnt lgkmcnt(3)
buffer_store_dwordx4 v[64:67], v3, s[8:11], s51 offen
v_smfmac_f32_16x16x64_bf16 v[36:39], v[20:23], v[40:47], v0
ds_read_b128 v[20:23], v3 offset:9728
buffer_load_dwordx4 v[64:67], v70, s[8:11], s21 offen sc1
v_smfmac_f32_16x16x64_bf16 v[24:27], v[12:15], v[120:127], v0
ds_read_b128 v[40:43], v2 offset:6144
v_smfmac_f32_16x16x64_bf16 v[28:31], v[12:15], v[128:135], v0
ds_read_b128 v[44:47], v2 offset:7168
buffer_load_dwordx4 v[68:71], v70, s[8:11], s21 offen offset:256 sc1
v_smfmac_f32_16x16x64_bf16 v[32:35], v[12:15], v[136:143], v0
s_waitcnt lgkmcnt(3)
v_smfmac_f32_16x16x64_bf16 v[36:39], v[12:15], v[48:55], v0
ds_read_b128 v[12:15], v3 offset:11776
v_smfmac_f32_16x16x64_bf16 v[24:27], v[16:19], v[144:151], v0
ds_read_b128 v[48:51], v2 offset:8192
v_smfmac_f32_16x16x64_bf16 v[28:31], v[16:19], v[152:159], v0
ds_read_b128 v[52:55], v2 offset:9216
v_smfmac_f32_16x16x64_bf16 v[32:35], v[16:19], v[160:167], v0
s_waitcnt lgkmcnt(3)
buffer_load_dword v6, s[8:11], s52 offen sc1 lds
v_smfmac_f32_16x16x64_bf16 v[36:39], v[16:19], v[40:47], v0
ds_read_b128 v[16:19], v3 offset:12800
v_smfmac_f32_16x16x64_bf16 v[24:27], v[20:23], v[168:175], v0
ds_read_b128 v[40:43], v2 offset:12288
v_smfmac_f32_16x16x64_bf16 v[28:31], v[20:23], v[176:183], v0
ds_read_b128 v[44:47], v2 offset:13312
v_smfmac_f32_16x16x64_bf16 v[32:35], v[20:23], v[184:191], v0
s_waitcnt lgkmcnt(3)
v_smfmac_f32_16x16x64_bf16 v[36:39], v[20:23], v[48:55], v0
ds_read_b128 v[20:23], v3 offset:13824
v_smfmac_f32_16x16x64_bf16 v[24:27], v[12:15], v[216:223], v0
ds_read_b128 v[48:51], v2 offset:14336
v_smfmac_f32_16x16x64_bf16 v[28:31], v[12:15], v[224:231], v0
ds_read_b128 v[52:55], v2 offset:15360
v_smfmac_f32_16x16x64_bf16 v[32:35], v[12:15], v[232:239], v0
s_waitcnt lgkmcnt(3)
v_smfmac_f32_16x16x64_bf16 v[36:39], v[12:15], v[40:47], v0
ds_read_b128 v[12:15], v3 offset:5632
v_smfmac_f32_16x16x64_bf16 v[24:27], v[16:19], v[240:247], v0
ds_read_b128 v[40:43], v2 offset:16384
v_smfmac_f32_16x16x64_bf16 v[28:31], v[16:19], v[248:255], v0
ds_read_b128 v[44:47], v2 offset:17408
v_smfmac_f32_16x16x64_bf16 v[32:35], v[16:19], a[0:7], v0
s_waitcnt lgkmcnt(3)
v_smfmac_f32_16x16x64_bf16 v[36:39], v[16:19], v[48:55], v0
ds_read_b128 v[16:19], v3 offset:7680
v_smfmac_f32_16x16x64_bf16 v[24:27], v[20:23], a[8:15], v0
ds_read_b128 v[48:51], v3 offset:18944
v_smfmac_f32_16x16x64_bf16 v[28:31], v[20:23], a[16:23], v0
ds_read_b128 v[52:55], v3 offset:20992
v_smfmac_f32_16x16x64_bf16 v[32:35], v[20:23], a[24:31], v0
s_waitcnt lgkmcnt(3)
v_smfmac_f32_16x16x64_bf16 v[36:39], v[20:23], v[40:47], v0
ds_read_b128 v[20:23], v3 offset:8704
s_nop 0
v_add_f32 v24, v24, v25
v_smfmac_f32_16x16x64_bf16 v[56:59], v[12:15], a[32:39], v0
ds_read_b128 v[44:47], v3 offset:16896
v_add_f32 v26, v26, v27
v_add_f32 v28, v28, v29
v_add_f32 v30, v30, v31
v_mul_f32 v24, s18, v24
v_smfmac_f32_16x16x64_bf16 v[60:63], v[12:15], a[40:47], v0
ds_read_b128 v[12:15], v3 offset:9728
v_mul_f32 v28, s18, v28
v_mul_f32 v26, s18, v26
v_mul_f32 v30, s18, v30
v_cvt_pk_bf16_f32 v24, v24, v28
s_waitcnt lgkmcnt(5)
v_smfmac_f32_16x16x64_bf16 v[56:59], v[16:19], a[64:71], v0
ds_read_b128 v[40:43], v3 offset:14848
v_cvt_pk_bf16_f32 v26, v26, v30
ds_write2_b32 v1, v24, v26 offset1:32
v_add_f32 v32, v32, v33
v_add_f32 v34, v34, v35
v_smfmac_f32_16x16x64_bf16 v[60:63], v[16:19], a[72:79], v0
ds_read_b128 v[16:19], v3 offset:11776
v_add_f32 v36, v36, v37
v_add_f32 v38, v38, v39
v_cvt_pk_bf16_f32 v1, v32, v36
v_cvt_pk_bf16_f32 v8, v34, v38
s_waitcnt lgkmcnt(5)
v_smfmac_f32_16x16x64_bf16 v[56:59], v[20:23], a[80:87], v0
ds_write2_b32 v4, v1, v8 offset1:32
v_smfmac_f32_16x16x64_bf16 v[60:63], v[20:23], a[88:95], v0
s_waitcnt lgkmcnt(4)
ds_read_b128 v[20:23], v3 offset:12800
v_smfmac_f32_16x16x64_bf16 v[56:59], v[12:15], a[96:103], v0
v_smfmac_f32_16x16x64_bf16 v[60:63], v[12:15], a[104:111], v0
s_waitcnt lgkmcnt(2)
ds_read_b128 v[12:15], v3 offset:13824
v_smfmac_f32_16x16x64_bf16 v[56:59], v[16:19], a[128:135], v0
v_smfmac_f32_16x16x64_bf16 v[60:63], v[16:19], a[136:143], v0
s_waitcnt lgkmcnt(2)
s_barrier
ds_read_b128 v[28:31], v5 offset:512
s_waitcnt lgkmcnt(2)
v_smfmac_f32_16x16x64_bf16 v[56:59], v[20:23], a[144:151], v0
ds_read_b128 v[32:35], v5 offset:1024
v_smfmac_f32_16x16x64_bf16 v[60:63], v[20:23], a[152:159], v0
s_waitcnt lgkmcnt(2)
ds_read_b128 v[36:39], v5 offset:1536
v_smfmac_f32_16x16x64_bf16 v[56:59], v[12:15], a[160:167], v0
ds_read_b128 v[24:27], v5
v_smfmac_f32_16x16x64_bf16 v[60:63], v[12:15], a[168:175], v0
s_waitcnt lgkmcnt(3)
v_mfma_f32_16x16x32_bf16 v[16:19], v[44:47], v[28:31], 0
s_waitcnt lgkmcnt(2)
ds_read_b128 v[44:47], v3 offset:17920
v_mfma_f32_16x16x32_bf16 v[16:19], v[48:51], v[32:35], v[16:19]
s_waitcnt lgkmcnt(2)
ds_read_b128 v[48:51], v3 offset:19968
v_mfma_f32_16x16x32_bf16 v[16:19], v[52:55], v[36:39], v[16:19]
s_waitcnt lgkmcnt(2)
ds_read_b128 v[52:55], v3 offset:22016
v_add_f32 v56, v56, v57
v_mfma_f32_16x16x32_bf16 v[16:19], v[40:43], v[24:27], v[16:19]
ds_read_b128 v[40:43], v3 offset:15872
v_add_f32 v58, v58, v59
v_mfma_f32_16x16x32_bf16 v[20:23], v[28:31], v[28:31], 0
s_add_u32 s49, s28, s23
v_add_f32 v60, v60, v61
v_add_f32 v62, v62, v63
v_mfma_f32_16x16x32_bf16 v[20:23], v[32:35], v[32:35], v[20:23]
s_add_u32 s50, s28, 65536
v_cvt_pk_bf16_f32 v56, v56, v58
v_cvt_pk_bf16_f32 v57, v60, v62
v_mfma_f32_16x16x32_bf16 v[20:23], v[36:39], v[36:39], v[20:23]
s_add_u32 s51, s28, 131072
v_mov_b32 v58, v1
v_mov_b32 v59, v8
v_exp_f32 v16, v16
v_mfma_f32_16x16x32_bf16 v[20:23], v[24:27], v[24:27], v[20:23]
s_waitcnt lgkmcnt(3)
v_exp_f32 v17, v17
buffer_store_dwordx4 v[56:59], v3, s[8:11], s31 offen sc1
v_mfma_f32_16x16x32_bf16 v[12:15], v[44:47], v[28:31], 0
s_waitcnt lgkmcnt(2)
v_exp_f32 v18, v18
v_mfma_f32_16x16x32_bf16 v[12:15], v[48:51], v[32:35], v[12:15]
s_waitcnt lgkmcnt(1)
v_exp_f32 v19, v19
v_mfma_f32_16x16x32_bf16 v[12:15], v[52:55], v[36:39], v[12:15]
s_waitcnt lgkmcnt(0)
v_exp_f32 v20, v20
v_mfma_f32_16x16x32_bf16 v[12:15], v[40:43], v[24:27], v[12:15]
s_add_u32 s52, s28, 196608
v_exp_f32 v21, v21
v_mov_b64 v[60:61], s[14:15]
v_cvt_pk_bf16_f32 v23, v20, v21
v_cvt_pk_bf16_f32 v20, v20, v21
v_mov_b32 v21, 0
v_mov_b32 v22, 0
v_cvt_pk_bf16_f32 v16, v16, v17
v_cvt_pk_bf16_f32 v17, v18, v19
v_mfma_f32_16x16x16_bf16 v[24:27], v[56:57], v[20:21], 0
v_exp_f32 v12, v12
v_mfma_f32_16x16x16_bf16 v[28:31], v[56:57], v[22:23], 0
v_exp_f32 v13, v13
v_mfma_f32_16x16x16_bf16 v[32:35], v[60:61], v[20:21], 0
v_exp_f32 v14, v14
v_exp_f32 v15, v15
v_mov_b64 v[62:63], s[14:15]
v_cvt_pk_bf16_f32 v18, v12, v13
v_cvt_pk_bf16_f32 v19, v14, v15
s_waitcnt vmcnt(2)
ds_read_b128 v[40:43], v2 offset:18432
v_mfma_f32_16x16x32_bf16 v[32:35], v[60:63], v[16:19], v[32:35]
ds_read_b128 v[44:47], v2 offset:19456
v_mov_b32 v20, 0
v_mfma_f32_16x16x32_bf16 v[24:27], v[64:67], v[16:19], v[24:27]
ds_read_b128 v[48:51], v2 offset:20480
v_mov_b32 v23, 0
v_mfma_f32_16x16x32_bf16 v[28:31], v[68:71], v[16:19], v[28:31]
ds_read_b128 v[52:55], v2 offset:21504
v_mov_b32 v15, 0
v_rcp_f32 v12, v32
v_subrev_u32 v14, 0x21800000, v32
v_cmp_le_u32 vcc, 0x3c000000, v14
v_pk_mul_f32 v[24:25], v[24:25], v[12:13] op_sel_hi:[1,0]
v_pk_mul_f32 v[26:27], v[26:27], v[12:13] op_sel_hi:[1,0]
ds_read_b128 v[32:35], v2 offset:22528
v_pk_mul_f32 v[28:29], v[28:29], v[12:13] op_sel_hi:[1,0]
v_pk_mul_f32 v[30:31], v[30:31], v[12:13] op_sel_hi:[1,0]
v_cvt_pk_bf16_f32 v24, v24, v28
v_cvt_pk_bf16_f32 v25, v25, v29
v_cvt_pk_bf16_f32 v26, v26, v30
v_cvt_pk_bf16_f32 v27, v27, v31
v_mfma_f32_16x16x32_bf16 v[16:19], v[20:23], v[20:23], 0
ds_write_b128 v7, v[24:27]
v_mfma_f32_16x16x32_bf16 v[12:15], v[20:23], v[20:23], 0
s_andn2_b64 vcc, vcc, s[86:87]
ds_read_b128 v[36:39], v2 offset:23552
s_cbranch_scc1 L_sm1
L_smr1:
v_mfma_f32_16x16x32_bf16 v[56:59], v[20:23], v[20:23], 0
v_mov_b32 v1, 6528
v_and_b32 v8, 0x380, v3
s_add_u32 s20, s30, 525312
v_add_u32 v8, v8, v3
s_mov_b32 m0, 17920
s_cmp_eq_u32 s19, 63
s_cbranch_scc1 L_texit
s_waitcnt lgkmcnt(0)
s_barrier
ds_read_b128 v[24:27], v3 offset:3200
v_mfma_f32_16x16x32_bf16 v[64:67], v[20:23], v[20:23], 0
ds_read_b128 v[28:31], v3 offset:4224
v_mfma_f32_16x16x32_bf16 v[60:63], v[20:23], v[20:23], 0
v_mfma_f32_16x16x32_bf16 v[68:71], v[20:23], v[20:23], 0
s_waitcnt lgkmcnt(1)
v_smfmac_f32_16x16x64_bf16 v[12:15], v[24:27], a[248:255], v0
buffer_load_dwordx4 v8, s[8:11], s20 offen sc1 lds
v_smfmac_f32_16x16x64_bf16 v[16:19], v[24:27], a[176:183], v0
s_mov_b32 m0, 18816
s_waitcnt lgkmcnt(0)
v_smfmac_f32_16x16x64_bf16 v[12:15], v[28:31], v[40:47], v0
ds_read_b128 v[40:43], v2 offset:24576
v_smfmac_f32_16x16x64_bf16 v[16:19], v[28:31], v[48:55], v0
ds_read_b128 v[44:47], v2 offset:25600
buffer_load_dwordx4 v8, s[8:11], s20 offen offset:128 sc1 lds
v_smfmac_f32_16x16x64_bf16 v[20:23], v[24:27], a[184:191], v0
ds_read_b128 v[48:51], v2 offset:26624
s_nop 1
v_add_f32 v12, v12, v13
v_add_f32 v14, v14, v15
v_cvt_pk_bf16_f32 v12, v12, v14
v_smfmac_f32_16x16x64_bf16 v[20:23], v[28:31], v[32:39], v0
ds_read_b128 v[52:55], v2 offset:27648
buffer_store_dword v12, v10, s[8:11], s28 offen
v_add_f32 v16, v16, v17
v_add_f32 v18, v18, v19
v_smfmac_f32_16x16x64_bf16 v[56:59], v[24:27], a[192:199], v0
s_waitcnt lgkmcnt(2)
ds_read_b128 v[32:35], v2 offset:28672
v_cvt_pk_bf16_f32 v16, v16, v18
v_smfmac_f32_16x16x64_bf16 v[56:59], v[28:31], v[40:47], v0
ds_read_b128 v[36:39], v2 offset:29696
v_add_f32 v20, v20, v21
v_add_f32 v22, v22, v23
v_cvt_pk_bf16_f32 v17, v20, v22
v_smfmac_f32_16x16x64_bf16 v[60:63], v[24:27], a[200:207], v0
s_waitcnt lgkmcnt(2)
ds_read_b128 v[12:15], v1
buffer_store_dwordx2 v[16:17], v9, s[8:11], s28 offen
v_smfmac_f32_16x16x64_bf16 v[60:63], v[28:31], v[48:55], v0
ds_read_b128 v[40:43], v2 offset:30720
v_add_f32 v56, v56, v57
v_add_f32 v58, v58, v59
v_cvt_pk_bf16_f32 v56, v56, v58
v_smfmac_f32_16x16x64_bf16 v[64:67], v[24:27], a[208:215], v0
s_waitcnt lgkmcnt(2)
ds_read_b128 v[44:47], v2 offset:31744
v_smfmac_f32_16x16x64_bf16 v[64:67], v[28:31], v[32:39], v0
ds_read_b128 v[20:23], v1
v_add_f32 v60, v60, v61
v_add_f32 v62, v62, v63
v_cvt_pk_bf16_f32 v57, v60, v62
v_smfmac_f32_16x16x64_bf16 v[68:71], v[24:27], a[216:223], v0
s_waitcnt lgkmcnt(1)
ds_read_b128 v[48:51], v2 offset:32768
buffer_store_dwordx2 v[56:57], v9, s[8:11], s50 offen
v_smfmac_f32_16x16x64_bf16 v[68:71], v[28:31], v[40:47], v0
ds_read_b128 v[52:55], v2 offset:33792
v_add_f32 v64, v64, v65
v_add_f32 v66, v66, v67
v_cvt_pk_bf16_f32 v64, v64, v66
v_smfmac_f32_16x16x64_bf16 v[12:15], v[24:27], a[224:231], v0
s_waitcnt lgkmcnt(0)
v_smfmac_f32_16x16x64_bf16 v[12:15], v[28:31], v[48:55], v0
s_nop 0
v_add_f32 v68, v68, v69
v_add_f32 v70, v70, v71
v_cvt_pk_bf16_f32 v65, v68, v70
v_smfmac_f32_16x16x64_bf16 v[20:23], v[24:27], a[232:239], v0
buffer_store_dwordx2 v[64:65], v9, s[8:11], s51 offen
v_smfmac_f32_16x16x64_bf16 v[20:23], v[28:31], a[240:247], v0
s_nop 0
v_add_f32 v12, v12, v13
v_add_f32 v14, v14, v15
v_cvt_pk_bf16_f32 v12, v12, v14
s_nop 3
v_add_f32 v20, v20, v21
v_add_f32 v22, v22, v23
v_cvt_pk_bf16_f32 v13, v20, v22
buffer_store_dwordx2 v[12:13], v9, s[8:11], s52 offen
L_lt1:
s_nop 15
s_nop 15
s_nop 15
s_nop 15
s_nop 4
buffer_load_dwordx4 v[32:35], v3, s[8:11], s49 offen sc1
buffer_load_dwordx4 v[36:39], v3, s[8:11], s49 offen offset:1024 sc1
buffer_load_dwordx4 v[40:43], v3, s[8:11], s49 offen offset:2048 sc1
buffer_load_dwordx4 v[44:47], v3, s[8:11], s49 offen offset:3072 sc1
s_add_u32 s19, s19, 1
s_mov_b32 s20, s28
s_mov_b32 s28, s29
s_mov_b32 s29, s20
s_and_b32 s20, s19, 3
s_lshl_b32 s20, s20, 14
s_add_u32 s33, s20, 109641728
s_add_u32 s34, s20, s24
s_xor_b32 s20, s20, 32768
s_add_u32 s35, s20, s24
s_add_u32 s30, s30, 524288
s_add_u32 s31, s31, 131072
s_add_u32 s6, s33, 4096
s_add_u32 s7, s33, 8192
s_mov_b32 s22, 0
v_mov_b64 v[24:25], 0
v_mov_b64 v[26:27], 0
v_mov_b64 v[28:29], 0
v_mov_b64 v[30:31], 0
buffer_load_dwordx4 v[32:35], v3, s[8:11], s49 offen sc1
buffer_load_dwordx4 v[36:39], v3, s[8:11], s49 offen offset:1024 sc1
buffer_load_dwordx4 v[40:43], v3, s[8:11], s49 offen offset:2048 sc1
buffer_load_dwordx4 v[44:47], v3, s[8:11], s49 offen offset:3072 sc1
v_and_b32 v70, 0xf40, v3
v_add_u32 v70, v70, v3
v_bfe_u32 v71, v3, 7, 1
v_mad_i32_i24 v70, v71, s4, v70
v_mov_b64 v[64:65], -1
v_mov_b64 v[66:67], -1
v_add_u32 v1, 2112, v4
ds_read_b128 v[48:51], v2 offset:10240
ds_read_b128 v[52:55], v2 offset:11264
v_lshrrev_b32 v8, 2, v3
v_mov_b32 v56, 0x3f80
v_cndmask_b32 v56, v56, 1.0, s[44:45]
v_cndmask_b32 v60, 0, v56, s[36:37]
v_cndmask_b32 v61, 0, v56, s[38:39]
v_cndmask_b32 v62, 0, v56, s[40:41]
v_cndmask_b32 v63, 0, v56, s[42:43]
s_waitcnt vmcnt(7)
v_max3_u32 v16, v32, v33, v34
v_max_u32 v16, v16, v35
v_mfma_f32_16x16x32_bf16 v[56:59], v[32:35], v[60:63], 0
s_waitcnt vmcnt(6)
v_max3_u32 v16, v16, v36, v37
v_max3_u32 v16, v16, v38, v39
v_mfma_f32_16x16x32_bf16 v[56:59], v[36:39], v[60:63], v[56:59]
s_waitcnt vmcnt(5)
v_max3_u32 v16, v16, v40, v41
v_max3_u32 v16, v16, v42, v43
v_mfma_f32_16x16x32_bf16 v[56:59], v[40:43], v[60:63], v[56:59]
s_waitcnt vmcnt(4)
v_max3_u32 v16, v16, v44, v45
v_max3_u32 v16, v16, v46, v47
v_mfma_f32_16x16x32_bf16 v[56:59], v[44:47], v[60:63], v[56:59]
v_cmp_le_u32 vcc, 0xffff0000, v16
s_cbranch_vccnz L_red1
L_redb1:
s_nop 5
v_permlane32_swap_b32 v56, v58
v_permlane32_swap_b32 v57, v59
v_pk_add_f32 v[56:57], v[56:57], v[58:59]
v_cvt_pk_bf16_f32 v56, v56, v57
buffer_store_dword v56, v11, s[8:11], s34 offen
s_add_u32 s20, s30, 1024
s_add_u32 s21, s30, 8192
s_add_u32 s49, s29, s25
s_add_u32 s50, s29, s26
s_add_u32 s51, s29, s27
s_add_u32 s52, s30, 524288
s_mov_b32 m0, 17920
s_nop 9
s_barrier
s_branch L_gat1
L_red1:
s_waitcnt vmcnt(3)
v_mfma_f32_16x16x32_bf16 v[56:59], v[32:35], v[60:63], 0
v_max3_u32 v16, v32, v33, v34
v_max_u32 v16, v16, v35
s_waitcnt vmcnt(2)
v_mfma_f32_16x16x32_bf16 v[56:59], v[36:39], v[60:63], v[56:59]
v_max3_u32 v16, v16, v36, v37
v_max3_u32 v16, v16, v38, v39
s_waitcnt vmcnt(1)
v_mfma_f32_16x16x32_bf16 v[56:59], v[40:43], v[60:63], v[56:59]
v_max3_u32 v16, v16, v40, v41
v_max3_u32 v16, v16, v42, v43
s_waitcnt vmcnt(0)
v_mfma_f32_16x16x32_bf16 v[56:59], v[44:47], v[60:63], v[56:59]
v_max3_u32 v16, v16, v44, v45
v_max3_u32 v16, v16, v46, v47
v_cmp_le_u32 vcc, 0xffff0000, v16
s_cbranch_vccz L_redb1
L_red1b:
buffer_load_dwordx4 v[32:35], v3, s[8:11], s49 offen sc1
buffer_load_dwordx4 v[36:39], v3, s[8:11], s49 offen offset:1024 sc1
buffer_load_dwordx4 v[40:43], v3, s[8:11], s49 offen offset:2048 sc1
buffer_load_dwordx4 v[44:47], v3, s[8:11], s49 offen offset:3072 sc1
s_add_u32 s22, s22, 1
s_cmp_gt_u32 s22, 200000
s_cbranch_scc1 L_end
s_waitcnt vmcnt(3)
v_mfma_f32_16x16x32_bf16 v[56:59], v[32:35], v[60:63], 0
v_max3_u32 v16, v32, v33, v34
v_max_u32 v16, v16, v35
s_waitcnt vmcnt(2)
v_mfma_f32_16x16x32_bf16 v[56:59], v[36:39], v[60:63], v[56:59]
v_max3_u32 v16, v16, v36, v37
v_max3_u32 v16, v16, v38, v39
s_waitcnt vmcnt(1)
v_mfma_f32_16x16x32_bf16 v[56:59], v[40:43], v[60:63], v[56:59]
v_max3_u32 v16, v16, v40, v41
v_max3_u32 v16, v16, v42, v43
s_waitcnt vmcnt(0)
v_mfma_f32_16x16x32_bf16 v[56:59], v[44:47], v[60:63], v[56:59]
v_max3_u32 v16, v16, v44, v45
v_max3_u32 v16, v16, v46, v47
v_cmp_le_u32 vcc, 0xffff0000, v16
s_cbranch_vccz L_redb1
s_branch L_red1b
L_g3r1:
buffer_load_dwordx4 v[16:19], v3, s[8:11], s6 offen sc1
s_add_u32 s22, s22, 1
s_waitcnt vmcnt(1)
v_max3_u32 v21, v16, v17, v18
v_max_u32 v21, v21, v19
v_cmp_le_u32 vcc, 0xffff0000, v21
s_cmp_gt_u32 s22, 200000
s_cbranch_vccz L_g31
s_cbranch_scc0 L_g3r1
s_branch L_end
L_sm1:
s_waitcnt lgkmcnt(0)
ds_read_b128 v[24:27], v5
ds_read_b128 v[40:43], v3 offset:14848
ds_read_b128 v[28:31], v5 offset:512
ds_read_b128 v[44:47], v3 offset:16896
ds_read_b128 v[32:35], v5 offset:1024
ds_read_b128 v[48:51], v3 offset:18944
ds_read_b128 v[36:39], v5 offset:1536
ds_read_b128 v[52:55], v3 offset:20992
s_waitcnt lgkmcnt(0)
v_mfma_f32_16x16x32_bf16 v[16:19], v[40:43], v[24:27], 0
ds_read_b128 v[40:43], v3 offset:15872
v_mfma_f32_16x16x32_bf16 v[16:19], v[44:47], v[28:31], v[16:19]
ds_read_b128 v[44:47], v3 offset:17920
v_mfma_f32_16x16x32_bf16 v[16:19], v[48:51], v[32:35], v[16:19]
ds_read_b128 v[48:51], v3 offset:19968
v_mfma_f32_16x16x32_bf16 v[16:19], v[52:55], v[36:39], v[16:19]
ds_read_b128 v[52:55], v3 offset:22016
v_mfma_f32_16x16x32_bf16 v[20:23], v[24:27], v[24:27], 0
v_mfma_f32_16x16x32_bf16 v[20:23], v[28:31], v[28:31], v[20:23]
v_mfma_f32_16x16x32_bf16 v[20:23], v[32:35], v[32:35], v[20:23]
v_mfma_f32_16x16x32_bf16 v[20:23], v[36:39], v[36:39], v[20:23]
s_waitcnt lgkmcnt(0)
v_mfma_f32_16x16x32_bf16 v[12:15], v[40:43], v[24:27], 0
v_mfma_f32_16x16x32_bf16 v[12:15], v[44:47], v[28:31], v[12:15]
v_mfma_f32_16x16x32_bf16 v[12:15], v[48:51], v[32:35], v[12:15]
v_mfma_f32_16x16x32_bf16 v[12:15], v[52:55], v[36:39], v[12:15]
v_max3_f32 v59, v16, v17, v18
s_nop 1
v_max3_f32 v59, v59, v19, v20
s_nop 3
v_max3_f32 v59, v59, v21, v12
v_max3_f32 v59, v59, v13, v14
v_max_f32 v59, v59, v15
v_mov_b32 v22, v59
s_nop 1
v_permlane32_swap_b32 v22, v59
v_max_f32 v59, v59, v22
v_mov_b32 v22, v59
s_nop 1
v_permlane16_swap_b32 v22, v59
v_max_f32 v59, v59, v22
v_sub_f32 v20, v20, v59
v_sub_f32 v21, v21, v59
v_sub_f32 v16, v16, v59
v_sub_f32 v17, v17, v59
v_sub_f32 v18, v18, v59
v_sub_f32 v19, v19, v59
v_sub_f32 v12, v12, v59
v_sub_f32 v13, v13, v59
v_sub_f32 v14, v14, v59
v_sub_f32 v15, v15, v59
v_exp_f32 v20, v20
v_exp_f32 v21, v21
v_exp_f32 v16, v16
v_exp_f32 v17, v17
v_exp_f32 v18, v18
v_exp_f32 v19, v19
v_exp_f32 v12, v12
v_exp_f32 v13, v13
v_exp_f32 v14, v14
v_exp_f32 v15, v15
v_cvt_pk_bf16_f32 v23, v20, v21
v_cvt_pk_bf16_f32 v20, v20, v21
v_mov_b32 v21, 0
v_mov_b32 v22, 0
v_cvt_pk_bf16_f32 v16, v16, v17
v_cvt_pk_bf16_f32 v17, v18, v19
v_cvt_pk_bf16_f32 v18, v12, v13
v_cvt_pk_bf16_f32 v19, v14, v15
v_mfma_f32_16x16x16_bf16 v[24:27], v[56:57], v[20:21], 0
v_mfma_f32_16x16x16_bf16 v[28:31], v[56:57], v[22:23], 0
v_mfma_f32_16x16x16_bf16 v[32:35], v[60:61], v[20:21], 0
ds_read_b128 v[40:43], v2 offset:18432
v_mfma_f32_16x16x32_bf16 v[32:35], v[60:63], v[16:19], v[32:35]
ds_read_b128 v[44:47], v2 offset:19456
v_mov_b32 v20, 0
v_mfma_f32_16x16x32_bf16 v[24:27], v[64:67], v[16:19], v[24:27]
ds_read_b128 v[48:51], v2 offset:20480
v_mov_b32 v23, 0
v_mfma_f32_16x16x32_bf16 v[28:31], v[68:71], v[16:19], v[28:31]
ds_read_b128 v[52:55], v2 offset:21504
v_mov_b32 v15, 0
v_rcp_f32 v12, v32
v_subrev_u32 v14, 0x21800000, v32
v_cmp_le_u32 vcc, 0x3c000000, v14
v_pk_mul_f32 v[24:25], v[24:25], v[12:13] op_sel_hi:[1,0]
v_pk_mul_f32 v[26:27], v[26:27], v[12:13] op_sel_hi:[1,0]
ds_read_b128 v[32:35], v2 offset:22528
v_pk_mul_f32 v[28:29], v[28:29], v[12:13] op_sel_hi:[1,0]
v_pk_mul_f32 v[30:31], v[30:31], v[12:13] op_sel_hi:[1,0]
v_cvt_pk_bf16_f32 v24, v24, v28
v_cvt_pk_bf16_f32 v25, v25, v29
v_cvt_pk_bf16_f32 v26, v26, v30
v_cvt_pk_bf16_f32 v27, v27, v31
v_mfma_f32_16x16x32_bf16 v[16:19], v[20:23], v[20:23], 0
ds_write_b128 v7, v[24:27]
v_mfma_f32_16x16x32_bf16 v[12:15], v[20:23], v[20:23], 0
ds_read_b128 v[36:39], v2 offset:23552
s_branch L_smr1
L_ent2:
s_movk_i32 s4, -64
s_mov_b32 s14, s53
s_mov_b32 s15, s53
v_mov_b64 v[24:25], 0
v_mov_b64 v[26:27], 0
v_mov_b64 v[28:29], 0
v_mov_b64 v[30:31], 0
v_and_b32 v69, 0x380, v3
v_add_u32 v69, v69, v3
v_and_b32 v70, 0xf40, v3
v_add_u32 v70, v70, v3
v_bfe_u32 v71, v3, 7, 1
v_mad_i32_i24 v70, v71, s4, v70
v_mov_b64 v[64:65], -1
v_mov_b64 v[66:67], -1
v_add_u32 v1, 2112, v4
ds_read_b128 v[48:51], v2 offset:12288
ds_read_b128 v[52:55], v2 offset:13312
ds_read_b128 v[40:43], v2 offset:4096
ds_read_b128 v[44:47], v2 offset:5120
v_mov_b64 v[32:33], 0
v_mov_b64 v[34:35], 0
v_mov_b64 v[36:37], 0
v_mov_b64 v[38:39], 0
v_mov_b64 v[56:57], 0
v_mov_b64 v[58:59], 0
v_mov_b64 v[60:61], 0
v_mov_b64 v[62:63], 0
s_add_u32 s20, s30, 2048
s_add_u32 s21, s30, 8192
s_add_u32 s49, s29, s25
s_add_u32 s50, s29, s26
s_add_u32 s51, s29, s27
s_add_u32 s52, s30, 524288
s_mov_b32 m0, 19968
s_nop 0
buffer_load_dwordx4 v69, s[8:11], s20 offen sc1 lds
s_mov_b32 m0, 20864
s_nop 0
buffer_load_dwordx4 v69, s[8:11], s20 offen offset:128 sc1 lds
s_waitcnt vmcnt(0) lgkmcnt(0)
s_branch L_step2
L_gr2:
buffer_load_dwordx4 v[12:15], v3, s[8:11], s33 offen sc1
buffer_load_dword v20, v8, s[8:11], s7 offen sc1
buffer_load_dwordx4 v[16:19], v3, s[8:11], s6 offen sc1
s_add_u32 s22, s22, 1
s_cmp_gt_u32 s22, 200000
s_cbranch_scc1 L_end
buffer_load_dwordx4 v[16:19], v3, s[8:11], s6 offen sc1
v_mov_b64 v[24:25], 0
v_mov_b64 v[26:27], 0
v_mov_b64 v[28:29], 0
v_mov_b64 v[30:31], 0
v_mov_b64 v[32:33], 0
v_mov_b64 v[34:35], 0
v_mov_b64 v[36:37], 0
v_mov_b64 v[38:39], 0
v_mov_b64 v[56:57], 0
v_mov_b64 v[58:59], 0
v_mov_b64 v[60:61], 0
v_mov_b64 v[62:63], 0
s_waitcnt lgkmcnt(0)
s_branch L_step2
.p2align 3
L_gat2:
buffer_load_dwordx4 v[12:15], v3, s[8:11], s33 offen sc1
buffer_load_dword v20, v8, s[8:11], s7 offen sc1
s_add_u32 s20, s30, 2048
s_add_u32 s21, s30, 8192
s_add_u32 s49, s29, s25
s_add_u32 s50, s29, s26
s_add_u32 s51, s29, s27
s_add_u32 s52, s30, 524288
buffer_load_dwordx4 v[16:19], v3, s[8:11], s6 offen sc1
s_mov_b32 m0, 19968
ds_read_b128 v[40:43], v2 offset:4096
ds_read_b128 v[44:47], v2 offset:5120
v_mov_b64 v[32:33], 0
v_mov_b64 v[34:35], 0
v_mov_b64 v[36:37], 0
v_mov_b64 v[38:39], 0
v_mov_b64 v[56:57], 0
v_mov_b64 v[58:59], 0
v_mov_b64 v[60:61], 0
v_mov_b64 v[62:63], 0
s_nop 3
buffer_load_dwordx4 v[16:19], v3, s[8:11], s6 offen sc1
s_waitcnt lgkmcnt(0)
L_step2:
s_waitcnt vmcnt(3)
v_smfmac_f32_16x16x64_bf16 v[24:27], v[12:15], v[120:127], v0
ds_write_b128 v3, v[12:15] offset:6656
v_smfmac_f32_16x16x64_bf16 v[28:31], v[12:15], v[128:135], v0
s_waitcnt vmcnt(2)
v_max3_u32 v21, v12, v13, v14
v_max3_u32 v21, v21, v15, v20
v_cmp_le_u32 vcc, 0xffff0000, v21
v_smfmac_f32_16x16x64_bf16 v[32:35], v[12:15], v[136:143], v0
s_cbranch_vccnz L_gr2
s_waitcnt vmcnt(1)
v_max3_u32 v21, v16, v17, v18
v_max_u32 v21, v21, v19
v_cmp_le_u32 vcc, 0xffff0000, v21
ds_write_b32 v8, v20 offset:14848
v_smfmac_f32_16x16x64_bf16 v[56:59], v[12:15], a[64:71], v0
s_cbranch_vccnz L_g3r2
L_g32:
ds_write_b128 v3, v[16:19] offset:10752
v_smfmac_f32_16x16x64_bf16 v[60:63], v[12:15], a[72:79], v0
v_smfmac_f32_16x16x64_bf16 v[36:39], v[12:15], v[40:47], v0
v_smfmac_f32_16x16x64_bf16 v[24:27], v[16:19], v[216:223], v0
v_smfmac_f32_16x16x64_bf16 v[28:31], v[16:19], v[224:231], v0
s_waitcnt lgkmcnt(0)
s_barrier
ds_read_b128 v[20:23], v3 offset:4608
v_smfmac_f32_16x16x64_bf16 v[32:35], v[16:19], v[232:239], v0
ds_read_b128 v[12:15], v3 offset:5632
s_mov_b32 m0, 6272
buffer_store_dword v0, v11, s[8:11], s35 offen
v_smfmac_f32_16x16x64_bf16 v[56:59], v[16:19], a[128:135], v0
ds_read_b128 v[40:43], v2
v_smfmac_f32_16x16x64_bf16 v[60:63], v[16:19], a[136:143], v0
ds_read_b128 v[44:47], v2 offset:1024
buffer_store_dwordx4 v[64:67], v3, s[8:11], s49 offen
v_smfmac_f32_16x16x64_bf16 v[36:39], v[16:19], v[48:55], v0
s_waitcnt vmcnt(2)
ds_read_b128 v[16:19], v3 offset:7680
s_waitcnt lgkmcnt(4)
v_smfmac_f32_16x16x64_bf16 v[24:27], v[20:23], v[72:79], v0
ds_read_b128 v[48:51], v2 offset:2048
buffer_store_dwordx4 v[64:67], v3, s[8:11], s50 offen
v_smfmac_f32_16x16x64_bf16 v[28:31], v[20:23], v[80:87], v0
ds_read_b128 v[52:55], v2 offset:3072
v_smfmac_f32_16x16x64_bf16 v[32:35], v[20:23], v[88:95], v0
s_waitcnt lgkmcnt(3)
buffer_store_dwordx4 v[64:67], v3, s[8:11], s51 offen
v_smfmac_f32_16x16x64_bf16 v[36:39], v[20:23], v[40:47], v0
ds_read_b128 v[20:23], v3 offset:8704
buffer_load_dwordx4 v[64:67], v70, s[8:11], s21 offen sc1
v_smfmac_f32_16x16x64_bf16 v[24:27], v[12:15], v[96:103], v0
ds_read_b128 v[40:43], v2 offset:6144
v_smfmac_f32_16x16x64_bf16 v[28:31], v[12:15], v[104:111], v0
ds_read_b128 v[44:47], v2 offset:7168
buffer_load_dwordx4 v[68:71], v70, s[8:11], s21 offen offset:256 sc1
v_smfmac_f32_16x16x64_bf16 v[32:35], v[12:15], v[112:119], v0
s_waitcnt lgkmcnt(3)
v_smfmac_f32_16x16x64_bf16 v[36:39], v[12:15], v[48:55], v0
ds_read_b128 v[12:15], v3 offset:9728
v_smfmac_f32_16x16x64_bf16 v[24:27], v[16:19], v[144:151], v0
ds_read_b128 v[48:51], v2 offset:8192
v_smfmac_f32_16x16x64_bf16 v[28:31], v[16:19], v[152:159], v0
ds_read_b128 v[52:55], v2 offset:9216
v_smfmac_f32_16x16x64_bf16 v[32:35], v[16:19], v[160:167], v0
s_waitcnt lgkmcnt(3)
v_smfmac_f32_16x16x64_bf16 v[36:39], v[16:19], v[40:47], v0
ds_read_b128 v[16:19], v3 offset:11776
v_smfmac_f32_16x16x64_bf16 v[24:27], v[20:23], v[168:175], v0
ds_read_b128 v[40:43], v2 offset:10240
v_smfmac_f32_16x16x64_bf16 v[28:31], v[20:23], v[176:183], v0
ds_read_b128 v[44:47], v2 offset:11264
v_smfmac_f32_16x16x64_bf16 v[32:35], v[20:23], v[184:191], v0
s_waitcnt lgkmcnt(3)
v_smfmac_f32_16x16x64_bf16 v[36:39], v[20:23], v[48:55], v0
ds_read_b128 v[20:23], v3 offset:12800
v_smfmac_f32_16x16x64_bf16 v[24:27], v[12:15], v[192:199], v0
ds_read_b128 v[48:51], v2 offset:14336
v_smfmac_f32_16x16x64_bf16 v[28:31], v[12:15], v[200:207], v0
ds_read_b128 v[52:55], v2 offset:15360
v_smfmac_f32_16x16x64_bf16 v[32:35], v[12:15], v[208:215], v0
s_waitcnt lgkmcnt(3)
v_smfmac_f32_16x16x64_bf16 v[36:39], v[12:15], v[40:47], v0
ds_read_b128 v[12:15], v3 offset:4608
v_smfmac_f32_16x16x64_bf16 v[24:27], v[16:19], v[240:247], v0
ds_read_b128 v[40:43], v2 offset:16384
v_smfmac_f32_16x16x64_bf16 v[28:31], v[16:19], v[248:255], v0
ds_read_b128 v[44:47], v2 offset:17408
v_smfmac_f32_16x16x64_bf16 v[32:35], v[16:19], a[0:7], v0
s_waitcnt lgkmcnt(3)
v_smfmac_f32_16x16x64_bf16 v[36:39], v[16:19], v[48:55], v0
ds_read_b128 v[16:19], v3 offset:5632
v_smfmac_f32_16x16x64_bf16 v[24:27], v[20:23], a[8:15], v0
ds_read_b128 v[48:51], v3 offset:17920
v_smfmac_f32_16x16x64_bf16 v[28:31], v[20:23], a[16:23], v0
ds_read_b128 v[52:55], v3 offset:19968
v_smfmac_f32_16x16x64_bf16 v[32:35], v[20:23], a[24:31], v0
s_waitcnt lgkmcnt(3)
v_smfmac_f32_16x16x64_bf16 v[36:39], v[20:23], v[40:47], v0
ds_read_b128 v[20:23], v3 offset:7680
s_nop 0
v_add_f32 v24, v24, v25
v_smfmac_f32_16x16x64_bf16 v[56:59], v[12:15], a[32:39], v0
ds_read_b128 v[40:43], v3 offset:13824
v_add_f32 v26, v26, v27
v_add_f32 v28, v28, v29
v_add_f32 v30, v30, v31
v_mul_f32 v24, s18, v24
v_smfmac_f32_16x16x64_bf16 v[60:63], v[12:15], a[40:47], v0
ds_read_b128 v[12:15], v3 offset:8704
v_mul_f32 v28, s18, v28
v_mul_f32 v26, s18, v26
v_mul_f32 v30, s18, v30
v_cvt_pk_bf16_f32 v24, v24, v28
s_waitcnt lgkmcnt(5)
v_smfmac_f32_16x16x64_bf16 v[56:59], v[16:19], a[48:55], v0
ds_read_b128 v[44:47], v3 offset:15872
v_cvt_pk_bf16_f32 v26, v26, v30
ds_write2_b32 v1, v24, v26 offset1:32
v_add_f32 v32, v32, v33
v_add_f32 v34, v34, v35
v_smfmac_f32_16x16x64_bf16 v[60:63], v[16:19], a[56:63], v0
ds_read_b128 v[16:19], v3 offset:9728
v_add_f32 v36, v36, v37
v_add_f32 v38, v38, v39
v_cvt_pk_bf16_f32 v1, v32, v36
v_cvt_pk_bf16_f32 v8, v34, v38
s_waitcnt lgkmcnt(5)
v_smfmac_f32_16x16x64_bf16 v[56:59], v[20:23], a[80:87], v0
ds_write2_b32 v4, v1, v8 offset1:32
v_smfmac_f32_16x16x64_bf16 v[60:63], v[20:23], a[88:95], v0
s_waitcnt lgkmcnt(4)
ds_read_b128 v[20:23], v3 offset:11776
v_smfmac_f32_16x16x64_bf16 v[56:59], v[12:15], a[96:103], v0
v_smfmac_f32_16x16x64_bf16 v[60:63], v[12:15], a[104:111], v0
s_waitcnt lgkmcnt(2)
ds_read_b128 v[12:15], v3 offset:12800
v_smfmac_f32_16x16x64_bf16 v[56:59], v[16:19], a[112:119], v0
v_smfmac_f32_16x16x64_bf16 v[60:63], v[16:19], a[120:127], v0
s_waitcnt lgkmcnt(2)
s_barrier
ds_read_b128 v[32:35], v5 offset:1024
s_waitcnt lgkmcnt(2)
v_smfmac_f32_16x16x64_bf16 v[56:59], v[20:23], a[144:151], v0
ds_read_b128 v[36:39], v5 offset:1536
v_smfmac_f32_16x16x64_bf16 v[60:63], v[20:23], a[152:159], v0
s_waitcnt lgkmcnt(2)
ds_read_b128 v[24:27], v5
v_smfmac_f32_16x16x64_bf16 v[56:59], v[12:15], a[160:167], v0
ds_read_b128 v[28:31], v5 offset:512
v_smfmac_f32_16x16x64_bf16 v[60:63], v[12:15], a[168:175], v0
s_waitcnt lgkmcnt(3)
v_mfma_f32_16x16x32_bf16 v[16:19], v[48:51], v[32:35], 0
s_waitcnt lgkmcnt(2)
ds_read_b128 v[48:51], v3 offset:18944
v_mfma_f32_16x16x32_bf16 v[16:19], v[52:55], v[36:39], v[16:19]
s_waitcnt lgkmcnt(2)
ds_read_b128 v[52:55], v3 offset:20992
v_mfma_f32_16x16x32_bf16 v[16:19], v[40:43], v[24:27], v[16:19]
s_waitcnt lgkmcnt(2)
ds_read_b128 v[40:43], v3 offset:14848
v_add_f32 v56, v56, v57
v_mfma_f32_16x16x32_bf16 v[16:19], v[44:47], v[28:31], v[16:19]
ds_read_b128 v[44:47], v3 offset:16896
v_add_f32 v58, v58, v59
v_mfma_f32_16x16x32_bf16 v[20:23], v[32:35], v[32:35], 0
s_add_u32 s49, s28, s23
v_add_f32 v60, v60, v61
v_add_f32 v62, v62, v63
v_mfma_f32_16x16x32_bf16 v[20:23], v[36:39], v[36:39], v[20:23]
s_add_u32 s50, s28, 65536
v_cvt_pk_bf16_f32 v56, v56, v58
v_cvt_pk_bf16_f32 v57, v60, v62
v_mfma_f32_16x16x32_bf16 v[20:23], v[24:27], v[24:27], v[20:23]
s_add_u32 s51, s28, 131072
v_mov_b32 v58, v1
v_mov_b32 v59, v8
v_exp_f32 v16, v16
v_mfma_f32_16x16x32_bf16 v[20:23], v[28:31], v[28:31], v[20:23]
s_waitcnt lgkmcnt(3)
v_exp_f32 v17, v17
v_mfma_f32_16x16x32_bf16 v[12:15], v[48:51], v[32:35], 0
s_waitcnt lgkmcnt(2)
v_exp_f32 v18, v18
buffer_store_dwordx4 v[56:59], v3, s[8:11], s31 offen sc1
v_mfma_f32_16x16x32_bf16 v[12:15], v[52:55], v[36:39], v[12:15]
s_waitcnt lgkmcnt(1)
v_exp_f32 v19, v19
v_mfma_f32_16x16x32_bf16 v[12:15], v[40:43], v[24:27], v[12:15]
s_waitcnt lgkmcnt(0)
v_exp_f32 v20, v20
v_mfma_f32_16x16x32_bf16 v[12:15], v[44:47], v[28:31], v[12:15]
s_add_u32 s52, s28, 196608
v_exp_f32 v21, v21
v_mov_b64 v[60:61], s[14:15]
v_cvt_pk_bf16_f32 v23, v20, v21
v_cvt_pk_bf16_f32 v20, v20, v21
v_mov_b32 v21, 0
v_mov_b32 v22, 0
v_cvt_pk_bf16_f32 v16, v16, v17
v_cvt_pk_bf16_f32 v17, v18, v19
v_mfma_f32_16x16x16_bf16 v[24:27], v[56:57], v[20:21], 0
v_exp_f32 v12, v12
v_mfma_f32_16x16x16_bf16 v[28:31], v[56:57], v[22:23], 0
v_exp_f32 v13, v13
v_mfma_f32_16x16x16_bf16 v[32:35], v[60:61], v[20:21], 0
v_exp_f32 v14, v14
v_exp_f32 v15, v15
v_mov_b64 v[62:63], s[14:15]
v_cvt_pk_bf16_f32 v18, v12, v13
v_cvt_pk_bf16_f32 v19, v14, v15
s_waitcnt vmcnt(1)
ds_read_b128 v[40:43], v2 offset:18432
v_mfma_f32_16x16x32_bf16 v[32:35], v[60:63], v[16:19], v[32:35]
ds_read_b128 v[44:47], v2 offset:19456
v_mov_b32 v20, 0
v_mfma_f32_16x16x32_bf16 v[24:27], v[64:67], v[16:19], v[24:27]
ds_read_b128 v[48:51], v2 offset:20480
v_mov_b32 v23, 0
v_mfma_f32_16x16x32_bf16 v[28:31], v[68:71], v[16:19], v[28:31]
ds_read_b128 v[52:55], v2 offset:21504
v_mov_b32 v15, 0
v_rcp_f32 v12, v32
v_subrev_u32 v14, 0x21800000, v32
v_cmp_le_u32 vcc, 0x3c000000, v14
v_pk_mul_f32 v[24:25], v[24:25], v[12:13] op_sel_hi:[1,0]
v_pk_mul_f32 v[26:27], v[26:27], v[12:13] op_sel_hi:[1,0]
ds_read_b128 v[32:35], v2 offset:22528
v_pk_mul_f32 v[28:29], v[28:29], v[12:13] op_sel_hi:[1,0]
v_pk_mul_f32 v[30:31], v[30:31], v[12:13] op_sel_hi:[1,0]
v_cvt_pk_bf16_f32 v24, v24, v28
v_cvt_pk_bf16_f32 v25, v25, v29
v_cvt_pk_bf16_f32 v26, v26, v30
v_cvt_pk_bf16_f32 v27, v27, v31
v_mfma_f32_16x16x32_bf16 v[16:19], v[20:23], v[20:23], 0
ds_write_b128 v7, v[24:27]
v_mfma_f32_16x16x32_bf16 v[12:15], v[20:23], v[20:23], 0
s_andn2_b64 vcc, vcc, s[86:87]
ds_read_b128 v[36:39], v2 offset:23552
s_cbranch_scc1 L_sm2
L_smr2:
v_mfma_f32_16x16x32_bf16 v[56:59], v[20:23], v[20:23], 0
v_mov_b32 v1, 6528
v_and_b32 v8, 0x380, v3
s_add_u32 s20, s30, 526336
v_add_u32 v8, v8, v3
s_mov_b32 m0, 19968
s_cmp_eq_u32 s19, 63
s_cbranch_scc1 L_texit
s_waitcnt lgkmcnt(0)
s_barrier
ds_read_b128 v[24:27], v3 offset:2176
v_mfma_f32_16x16x32_bf16 v[64:67], v[20:23], v[20:23], 0
ds_read_b128 v[28:31], v3 offset:3200
v_mfma_f32_16x16x32_bf16 v[60:63], v[20:23], v[20:23], 0
v_mfma_f32_16x16x32_bf16 v[68:71], v[20:23], v[20:23], 0
s_waitcnt lgkmcnt(1)
v_smfmac_f32_16x16x64_bf16 v[12:15], v[24:27], a[248:255], v0
buffer_load_dwordx4 v8, s[8:11], s20 offen sc1 lds
v_smfmac_f32_16x16x64_bf16 v[16:19], v[24:27], a[176:183], v0
s_mov_b32 m0, 20864
s_waitcnt lgkmcnt(0)
v_smfmac_f32_16x16x64_bf16 v[12:15], v[28:31], v[40:47], v0
ds_read_b128 v[40:43], v2 offset:24576
v_smfmac_f32_16x16x64_bf16 v[16:19], v[28:31], v[48:55], v0
ds_read_b128 v[44:47], v2 offset:25600
buffer_load_dwordx4 v8, s[8:11], s20 offen offset:128 sc1 lds
v_smfmac_f32_16x16x64_bf16 v[20:23], v[24:27], a[184:191], v0
ds_read_b128 v[48:51], v2 offset:26624
s_nop 1
v_add_f32 v12, v12, v13
v_add_f32 v14, v14, v15
v_cvt_pk_bf16_f32 v12, v12, v14
v_smfmac_f32_16x16x64_bf16 v[20:23], v[28:31], v[32:39], v0
ds_read_b128 v[52:55], v2 offset:27648
buffer_store_dword v12, v10, s[8:11], s28 offen
v_add_f32 v16, v16, v17
v_add_f32 v18, v18, v19
v_smfmac_f32_16x16x64_bf16 v[56:59], v[24:27], a[192:199], v0
s_waitcnt lgkmcnt(2)
ds_read_b128 v[32:35], v2 offset:28672
v_cvt_pk_bf16_f32 v16, v16, v18
v_smfmac_f32_16x16x64_bf16 v[56:59], v[28:31], v[40:47], v0
ds_read_b128 v[36:39], v2 offset:29696
v_add_f32 v20, v20, v21
v_add_f32 v22, v22, v23
v_cvt_pk_bf16_f32 v17, v20, v22
v_smfmac_f32_16x16x64_bf16 v[60:63], v[24:27], a[200:207], v0
s_waitcnt lgkmcnt(2)
ds_read_b128 v[12:15], v1
buffer_store_dwordx2 v[16:17], v9, s[8:11], s28 offen
v_smfmac_f32_16x16x64_bf16 v[60:63], v[28:31], v[48:55], v0
ds_read_b128 v[40:43], v2 offset:30720
v_add_f32 v56, v56, v57
v_add_f32 v58, v58, v59
v_cvt_pk_bf16_f32 v56, v56, v58
v_smfmac_f32_16x16x64_bf16 v[64:67], v[24:27], a[208:215], v0
s_waitcnt lgkmcnt(2)
ds_read_b128 v[44:47], v2 offset:31744
v_smfmac_f32_16x16x64_bf16 v[64:67], v[28:31], v[32:39], v0
ds_read_b128 v[20:23], v1
v_add_f32 v60, v60, v61
v_add_f32 v62, v62, v63
v_cvt_pk_bf16_f32 v57, v60, v62
v_smfmac_f32_16x16x64_bf16 v[68:71], v[24:27], a[216:223], v0
s_waitcnt lgkmcnt(1)
ds_read_b128 v[48:51], v2 offset:32768
buffer_store_dwordx2 v[56:57], v9, s[8:11], s50 offen
v_smfmac_f32_16x16x64_bf16 v[68:71], v[28:31], v[40:47], v0
ds_read_b128 v[52:55], v2 offset:33792
v_add_f32 v64, v64, v65
v_add_f32 v66, v66, v67
v_cvt_pk_bf16_f32 v64, v64, v66
v_smfmac_f32_16x16x64_bf16 v[12:15], v[24:27], a[224:231], v0
s_waitcnt lgkmcnt(0)
v_smfmac_f32_16x16x64_bf16 v[12:15], v[28:31], v[48:55], v0
s_nop 0
v_add_f32 v68, v68, v69
v_add_f32 v70, v70, v71
v_cvt_pk_bf16_f32 v65, v68, v70
v_smfmac_f32_16x16x64_bf16 v[20:23], v[24:27], a[232:239], v0
buffer_store_dwordx2 v[64:65], v9, s[8:11], s51 offen
v_smfmac_f32_16x16x64_bf16 v[20:23], v[28:31], a[240:247], v0
s_nop 0
v_add_f32 v12, v12, v13
v_add_f32 v14, v14, v15
v_cvt_pk_bf16_f32 v12, v12, v14
s_nop 3
v_add_f32 v20, v20, v21
v_add_f32 v22, v22, v23
v_cvt_pk_bf16_f32 v13, v20, v22
buffer_store_dwordx2 v[12:13], v9, s[8:11], s52 offen
s_cmp_eq_u32 s48, 0
s_cbranch_scc1 L_nojob2
L_lt2:
s_nop 9
buffer_load_dwordx4 v[32:35], v3, s[8:11], s49 offen sc1
buffer_load_dwordx4 v[36:39], v3, s[8:11], s49 offen offset:1024 sc1
buffer_load_dwordx4 v[40:43], v3, s[8:11], s49 offen offset:2048 sc1
buffer_load_dwordx4 v[44:47], v3, s[8:11], s49 offen offset:3072 sc1
s_add_u32 s19, s19, 1
s_mov_b32 s20, s28
s_mov_b32 s28, s29
s_mov_b32 s29, s20
s_and_b32 s20, s19, 3
s_lshl_b32 s20, s20, 14
s_add_u32 s33, s20, 109641728
s_add_u32 s34, s20, s24
s_xor_b32 s20, s20, 32768
s_add_u32 s35, s20, s24
s_add_u32 s30, s30, 524288
s_add_u32 s31, s31, 131072
s_add_u32 s6, s33, 4096
s_add_u32 s7, s33, 8192
s_mov_b32 s22, 0
v_mov_b64 v[24:25], 0
v_mov_b64 v[26:27], 0
v_mov_b64 v[28:29], 0
v_mov_b64 v[30:31], 0
v_and_b32 v70, 0xf40, v3
v_add_u32 v70, v70, v3
v_bfe_u32 v71, v3, 7, 1
v_mad_i32_i24 v70, v71, s4, v70
v_mov_b64 v[64:65], -1
v_mov_b64 v[66:67], -1
v_add_u32 v1, 2112, v4
ds_read_b128 v[48:51], v2 offset:12288
ds_read_b128 v[52:55], v2 offset:13312
v_lshrrev_b32 v8, 2, v3
v_mov_b32 v56, 0x3f80
v_cndmask_b32 v56, v56, 1.0, s[44:45]
v_cndmask_b32 v60, 0, v56, s[36:37]
v_cndmask_b32 v61, 0, v56, s[38:39]
v_cndmask_b32 v62, 0, v56, s[40:41]
v_cndmask_b32 v63, 0, v56, s[42:43]
s_waitcnt vmcnt(3)
s_nop 0
v_mfma_f32_16x16x32_bf16 v[56:59], v[32:35], v[60:63], 0
v_max3_u32 v16, v32, v33, v34
v_max_u32 v16, v16, v35
s_waitcnt vmcnt(2)
v_mfma_f32_16x16x32_bf16 v[56:59], v[36:39], v[60:63], v[56:59]
v_max3_u32 v16, v16, v36, v37
v_max3_u32 v16, v16, v38, v39
s_waitcnt vmcnt(1)
v_mfma_f32_16x16x32_bf16 v[56:59], v[40:43], v[60:63], v[56:59]
v_max3_u32 v16, v16, v40, v41
v_max3_u32 v16, v16, v42, v43
s_waitcnt vmcnt(0)
v_mfma_f32_16x16x32_bf16 v[56:59], v[44:47], v[60:63], v[56:59]
v_max3_u32 v16, v16, v44, v45
v_max3_u32 v16, v16, v46, v47
v_cmp_le_u32 vcc, 0xffff0000, v16
s_cbranch_vccnz L_red2
L_redb2:
s_nop 3
v_permlane32_swap_b32 v56, v58
v_permlane32_swap_b32 v57, v59
v_pk_add_f32 v[56:57], v[56:57], v[58:59]
v_cvt_pk_bf16_f32 v56, v56, v57
buffer_store_dword v56, v11, s[8:11], s34 offen
s_add_u32 s20, s30, 2048
s_add_u32 s21, s30, 8192
s_add_u32 s49, s29, s25
s_add_u32 s50, s29, s26
s_add_u32 s51, s29, s27
s_add_u32 s52, s30, 524288
s_mov_b32 m0, 19968
s_nop 9
s_barrier
s_branch L_gat2
L_red2:
L_red2b:
buffer_load_dwordx4 v[32:35], v3, s[8:11], s49 offen sc1
buffer_load_dwordx4 v[36:39], v3, s[8:11], s49 offen offset:1024 sc1
buffer_load_dwordx4 v[40:43], v3, s[8:11], s49 offen offset:2048 sc1
buffer_load_dwordx4 v[44:47], v3, s[8:11], s49 offen offset:3072 sc1
s_add_u32 s22, s22, 1
s_cmp_gt_u32 s22, 200000
s_cbranch_scc1 L_end
s_waitcnt vmcnt(3)
v_mfma_f32_16x16x32_bf16 v[56:59], v[32:35], v[60:63], 0
v_max3_u32 v16, v32, v33, v34
v_max_u32 v16, v16, v35
s_waitcnt vmcnt(2)
v_mfma_f32_16x16x32_bf16 v[56:59], v[36:39], v[60:63], v[56:59]
v_max3_u32 v16, v16, v36, v37
v_max3_u32 v16, v16, v38, v39
s_waitcnt vmcnt(1)
v_mfma_f32_16x16x32_bf16 v[56:59], v[40:43], v[60:63], v[56:59]
v_max3_u32 v16, v16, v40, v41
v_max3_u32 v16, v16, v42, v43
s_waitcnt vmcnt(0)
v_mfma_f32_16x16x32_bf16 v[56:59], v[44:47], v[60:63], v[56:59]
v_max3_u32 v16, v16, v44, v45
v_max3_u32 v16, v16, v46, v47
v_cmp_le_u32 vcc, 0xffff0000, v16
s_cbranch_vccz L_redb2
s_branch L_red2b
L_g3r2:
buffer_load_dwordx4 v[16:19], v3, s[8:11], s6 offen sc1
s_add_u32 s22, s22, 1
s_waitcnt vmcnt(1)
v_max3_u32 v21, v16, v17, v18
v_max_u32 v21, v21, v19
v_cmp_le_u32 vcc, 0xffff0000, v21
s_cmp_gt_u32 s22, 200000
s_cbranch_vccz L_g32
s_cbranch_scc0 L_g3r2
s_branch L_end
L_sm2:
s_waitcnt lgkmcnt(0)
ds_read_b128 v[24:27], v5
ds_read_b128 v[40:43], v3 offset:13824
ds_read_b128 v[28:31], v5 offset:512
ds_read_b128 v[44:47], v3 offset:15872
ds_read_b128 v[32:35], v5 offset:1024
ds_read_b128 v[48:51], v3 offset:17920
ds_read_b128 v[36:39], v5 offset:1536
ds_read_b128 v[52:55], v3 offset:19968
s_waitcnt lgkmcnt(0)
v_mfma_f32_16x16x32_bf16 v[16:19], v[40:43], v[24:27], 0
ds_read_b128 v[40:43], v3 offset:14848
v_mfma_f32_16x16x32_bf16 v[16:19], v[44:47], v[28:31], v[16:19]
ds_read_b128 v[44:47], v3 offset:16896
v_mfma_f32_16x16x32_bf16 v[16:19], v[48:51], v[32:35], v[16:19]
ds_read_b128 v[48:51], v3 offset:18944
v_mfma_f32_16x16x32_bf16 v[16:19], v[52:55], v[36:39], v[16:19]
ds_read_b128 v[52:55], v3 offset:20992
v_mfma_f32_16x16x32_bf16 v[20:23], v[24:27], v[24:27], 0
v_mfma_f32_16x16x32_bf16 v[20:23], v[28:31], v[28:31], v[20:23]
v_mfma_f32_16x16x32_bf16 v[20:23], v[32:35], v[32:35], v[20:23]
v_mfma_f32_16x16x32_bf16 v[20:23], v[36:39], v[36:39], v[20:23]
s_waitcnt lgkmcnt(0)
v_mfma_f32_16x16x32_bf16 v[12:15], v[40:43], v[24:27], 0
v_mfma_f32_16x16x32_bf16 v[12:15], v[44:47], v[28:31], v[12:15]
v_mfma_f32_16x16x32_bf16 v[12:15], v[48:51], v[32:35], v[12:15]
v_mfma_f32_16x16x32_bf16 v[12:15], v[52:55], v[36:39], v[12:15]
v_max3_f32 v59, v16, v17, v18
s_nop 1
v_max3_f32 v59, v59, v19, v20
s_nop 3
v_max3_f32 v59, v59, v21, v12
v_max3_f32 v59, v59, v13, v14
v_max_f32 v59, v59, v15
v_mov_b32 v22, v59
s_nop 1
v_permlane32_swap_b32 v22, v59
v_max_f32 v59, v59, v22
v_mov_b32 v22, v59
s_nop 1
v_permlane16_swap_b32 v22, v59
v_max_f32 v59, v59, v22
v_sub_f32 v20, v20, v59
v_sub_f32 v21, v21, v59
v_sub_f32 v16, v16, v59
v_sub_f32 v17, v17, v59
v_sub_f32 v18, v18, v59
v_sub_f32 v19, v19, v59
v_sub_f32 v12, v12, v59
v_sub_f32 v13, v13, v59
v_sub_f32 v14, v14, v59
v_sub_f32 v15, v15, v59
v_exp_f32 v20, v20
v_exp_f32 v21, v21
v_exp_f32 v16, v16
v_exp_f32 v17, v17
v_exp_f32 v18, v18
v_exp_f32 v19, v19
v_exp_f32 v12, v12
v_exp_f32 v13, v13
v_exp_f32 v14, v14
v_exp_f32 v15, v15
v_cvt_pk_bf16_f32 v23, v20, v21
v_cvt_pk_bf16_f32 v20, v20, v21
v_mov_b32 v21, 0
v_mov_b32 v22, 0
v_cvt_pk_bf16_f32 v16, v16, v17
v_cvt_pk_bf16_f32 v17, v18, v19
v_cvt_pk_bf16_f32 v18, v12, v13
v_cvt_pk_bf16_f32 v19, v14, v15
v_mfma_f32_16x16x16_bf16 v[24:27], v[56:57], v[20:21], 0
v_mfma_f32_16x16x16_bf16 v[28:31], v[56:57], v[22:23], 0
v_mfma_f32_16x16x16_bf16 v[32:35], v[60:61], v[20:21], 0
ds_read_b128 v[40:43], v2 offset:18432
v_mfma_f32_16x16x32_bf16 v[32:35], v[60:63], v[16:19], v[32:35]
ds_read_b128 v[44:47], v2 offset:19456
v_mov_b32 v20, 0
v_mfma_f32_16x16x32_bf16 v[24:27], v[64:67], v[16:19], v[24:27]
ds_read_b128 v[48:51], v2 offset:20480
v_mov_b32 v23, 0
v_mfma_f32_16x16x32_bf16 v[28:31], v[68:71], v[16:19], v[28:31]
ds_read_b128 v[52:55], v2 offset:21504
v_mov_b32 v15, 0
v_rcp_f32 v12, v32
v_subrev_u32 v14, 0x21800000, v32
v_cmp_le_u32 vcc, 0x3c000000, v14
v_pk_mul_f32 v[24:25], v[24:25], v[12:13] op_sel_hi:[1,0]
v_pk_mul_f32 v[26:27], v[26:27], v[12:13] op_sel_hi:[1,0]
ds_read_b128 v[32:35], v2 offset:22528
v_pk_mul_f32 v[28:29], v[28:29], v[12:13] op_sel_hi:[1,0]
v_pk_mul_f32 v[30:31], v[30:31], v[12:13] op_sel_hi:[1,0]
v_cvt_pk_bf16_f32 v24, v24, v28
v_cvt_pk_bf16_f32 v25, v25, v29
v_cvt_pk_bf16_f32 v26, v26, v30
v_cvt_pk_bf16_f32 v27, v27, v31
v_mfma_f32_16x16x32_bf16 v[16:19], v[20:23], v[20:23], 0
ds_write_b128 v7, v[24:27]
v_mfma_f32_16x16x32_bf16 v[12:15], v[20:23], v[20:23], 0
ds_read_b128 v[36:39], v2 offset:23552
s_branch L_smr2
L_nojob2:
s_add_u32 s19, s19, 1
s_mov_b32 s20, s28
s_mov_b32 s28, s29
s_mov_b32 s29, s20
s_and_b32 s20, s19, 3
s_lshl_b32 s20, s20, 14
s_add_u32 s33, s20, 109641728
s_add_u32 s34, s20, s24
s_xor_b32 s20, s20, 32768
s_add_u32 s35, s20, s24
s_add_u32 s30, s30, 524288
s_add_u32 s31, s31, 131072
s_add_u32 s6, s33, 4096
s_add_u32 s7, s33, 8192
s_mov_b32 s22, 0
v_mov_b64 v[24:25], 0
v_mov_b64 v[26:27], 0
v_mov_b64 v[28:29], 0
v_mov_b64 v[30:31], 0
v_and_b32 v70, 0xf40, v3
v_add_u32 v70, v70, v3
v_bfe_u32 v71, v3, 7, 1
v_mad_i32_i24 v70, v71, s4, v70
v_mov_b64 v[64:65], -1
v_mov_b64 v[66:67], -1
v_add_u32 v1, 2112, v4
ds_read_b128 v[48:51], v2 offset:12288
ds_read_b128 v[52:55], v2 offset:13312
v_lshrrev_b32 v8, 2, v3
s_barrier
s_branch L_gat2
L_ent3:
s_movk_i32 s4, -64
s_mov_b32 s14, s53
s_mov_b32 s15, s53
v_mov_b64 v[24:25], 0
v_mov_b64 v[26:27], 0
v_mov_b64 v[28:29], 0
v_mov_b64 v[30:31], 0
v_and_b32 v69, 0x380, v3
v_add_u32 v69, v69, v3
v_and_b32 v70, 0xf40, v3
v_add_u32 v70, v70, v3
v_bfe_u32 v71, v3, 7, 1
v_mad_i32_i24 v70, v71, s4, v70
v_mov_b64 v[64:65], -1
v_mov_b64 v[66:67], -1
v_add_u32 v1, 2112, v4
ds_read_b128 v[48:51], v2 offset:14336
ds_read_b128 v[52:55], v2 offset:15360
ds_read_b128 v[40:43], v2 offset:6144
ds_read_b128 v[44:47], v2 offset:7168
v_mov_b64 v[32:33], 0
v_mov_b64 v[34:35], 0
v_mov_b64 v[36:37], 0
v_mov_b64 v[38:39], 0
v_mov_b64 v[56:57], 0
v_mov_b64 v[58:59], 0
v_mov_b64 v[60:61], 0
v_mov_b64 v[62:63], 0
s_add_u32 s20, s30, 3072
s_add_u32 s21, s30, 8192
s_add_u32 s49, s29, s25
s_add_u32 s50, s29, s26
s_add_u32 s51, s29, s27
s_add_u32 s52, s30, 524288
s_mov_b32 m0, 22016
s_nop 0
buffer_load_dwordx4 v69, s[8:11], s20 offen sc1 lds
s_mov_b32 m0, 22912
s_nop 0
buffer_load_dwordx4 v69, s[8:11], s20 offen offset:128 sc1 lds
s_waitcnt vmcnt(0) lgkmcnt(0)
s_branch L_step3
L_gr3:
buffer_load_dwordx4 v[12:15], v3, s[8:11], s33 offen sc1
buffer_load_dword v20, v8, s[8:11], s7 offen sc1
buffer_load_dwordx4 v[16:19], v3, s[8:11], s6 offen sc1
s_add_u32 s22, s22, 1
s_cmp_gt_u32 s22, 200000
s_cbranch_scc1 L_end
buffer_load_dwordx4 v[16:19], v3, s[8:11], s6 offen sc1
v_mov_b64 v[24:25], 0
v_mov_b64 v[26:27], 0
v_mov_b64 v[28:29], 0
v_mov_b64 v[30:31], 0
v_mov_b64 v[32:33], 0
v_mov_b64 v[34:35], 0
v_mov_b64 v[36:37], 0
v_mov_b64 v[38:39], 0
v_mov_b64 v[56:57], 0
v_mov_b64 v[58:59], 0
v_mov_b64 v[60:61], 0
v_mov_b64 v[62:63], 0
s_waitcnt lgkmcnt(0)
s_branch L_step3
.p2align 3
L_gat3:
buffer_load_dwordx4 v[12:15], v3, s[8:11], s33 offen sc1
buffer_load_dword v20, v8, s[8:11], s7 offen sc1
s_add_u32 s20, s30, 3072
s_add_u32 s21, s30, 8192
s_add_u32 s49, s29, s25
s_add_u32 s50, s29, s26
s_add_u32 s51, s29, s27
s_add_u32 s52, s30, 524288
buffer_load_dwordx4 v[16:19], v3, s[8:11], s6 offen sc1
s_mov_b32 m0, 22016
ds_read_b128 v[40:43], v2 offset:6144
ds_read_b128 v[44:47], v2 offset:7168
v_mov_b64 v[32:33], 0
v_mov_b64 v[34:35], 0
v_mov_b64 v[36:37], 0
v_mov_b64 v[38:39], 0
v_mov_b64 v[56:57], 0
v_mov_b64 v[58:59], 0
v_mov_b64 v[60:61], 0
v_mov_b64 v[62:63], 0
s_nop 3
buffer_load_dwordx4 v[16:19], v3, s[8:11], s6 offen sc1
s_waitcnt lgkmcnt(0)
L_step3:
s_waitcnt vmcnt(3)
v_smfmac_f32_16x16x64_bf16 v[24:27], v[12:15], v[144:151], v0
ds_write_b128 v3, v[12:15] offset:6656
v_smfmac_f32_16x16x64_bf16 v[28:31], v[12:15], v[152:159], v0
s_waitcnt vmcnt(2)
v_max3_u32 v21, v12, v13, v14
v_max3_u32 v21, v21, v15, v20
v_cmp_le_u32 vcc, 0xffff0000, v21
v_smfmac_f32_16x16x64_bf16 v[32:35], v[12:15], v[160:167], v0
s_cbranch_vccnz L_gr3
s_waitcnt vmcnt(1)
v_max3_u32 v21, v16, v17, v18
v_max_u32 v21, v21, v19
v_cmp_le_u32 vcc, 0xffff0000, v21
ds_write_b32 v8, v20 offset:14848
v_smfmac_f32_16x16x64_bf16 v[56:59], v[12:15], a[80:87], v0
s_cbranch_vccnz L_g3r3
L_g33:
ds_write_b128 v3, v[16:19] offset:10752
v_smfmac_f32_16x16x64_bf16 v[60:63], v[12:15], a[88:95], v0
v_smfmac_f32_16x16x64_bf16 v[36:39], v[12:15], v[40:47], v0
v_smfmac_f32_16x16x64_bf16 v[24:27], v[16:19], v[240:247], v0
v_smfmac_f32_16x16x64_bf16 v[28:31], v[16:19], v[248:255], v0
s_waitcnt lgkmcnt(0)
s_barrier
ds_read_b128 v[20:23], v3 offset:3584
v_smfmac_f32_16x16x64_bf16 v[32:35], v[16:19], a[0:7], v0
ds_read_b128 v[12:15], v3 offset:4608
s_mov_b32 m0, 6272
v_smfmac_f32_16x16x64_bf16 v[56:59], v[16:19], a[144:151], v0
ds_read_b128 v[40:43], v2
v_smfmac_f32_16x16x64_bf16 v[60:63], v[16:19], a[152:159], v0
ds_read_b128 v[44:47], v2 offset:1024
buffer_store_dwordx4 v[64:67], v3, s[8:11], s49 offen
v_smfmac_f32_16x16x64_bf16 v[36:39], v[16:19], v[48:55], v0
s_waitcnt vmcnt(1)
ds_read_b128 v[16:19], v3 offset:5632
s_waitcnt lgkmcnt(4)
v_smfmac_f32_16x16x64_bf16 v[24:27], v[20:23], v[72:79], v0
ds_read_b128 v[48:51], v2 offset:2048
buffer_store_dwordx4 v[64:67], v3, s[8:11], s50 offen
v_smfmac_f32_16x16x64_bf16 v[28:31], v[20:23], v[80:87], v0
ds_read_b128 v[52:55], v2 offset:3072
v_smfmac_f32_16x16x64_bf16 v[32:35], v[20:23], v[88:95], v0
s_waitcnt lgkmcnt(3)
buffer_store_dwordx4 v[64:67], v3, s[8:11], s51 offen
v_smfmac_f32_16x16x64_bf16 v[36:39], v[20:23], v[40:47], v0
ds_read_b128 v[20:23], v3 offset:7680
buffer_load_dwordx4 v[64:67], v70, s[8:11], s21 offen sc1
v_smfmac_f32_16x16x64_bf16 v[24:27], v[12:15], v[96:103], v0
ds_read_b128 v[40:43], v2 offset:4096
v_smfmac_f32_16x16x64_bf16 v[28:31], v[12:15], v[104:111], v0
ds_read_b128 v[44:47], v2 offset:5120
buffer_load_dwordx4 v[68:71], v70, s[8:11], s21 offen offset:256 sc1
v_smfmac_f32_16x16x64_bf16 v[32:35], v[12:15], v[112:119], v0
s_waitcnt lgkmcnt(3)
v_smfmac_f32_16x16x64_bf16 v[36:39], v[12:15], v[48:55], v0
ds_read_b128 v[12:15], v3 offset:8704
v_smfmac_f32_16x16x64_bf16 v[24:27], v[16:19], v[120:127], v0
ds_read_b128 v[48:51], v2 offset:8192
v_smfmac_f32_16x16x64_bf16 v[28:31], v[16:19], v[128:135], v0
ds_read_b128 v[52:55], v2 offset:9216
v_mov_b32 v11, s19
v_smfmac_f32_16x16x64_bf16 v[32:35], v[16:19], v[136:143], v0
s_mov_b64 exec, 1
buffer_store_dword v11, v8, s[8:11], s83 offen sc1
s_mov_b64 exec, -1
s_waitcnt lgkmcnt(3)
v_smfmac_f32_16x16x64_bf16 v[36:39], v[16:19], v[40:47], v0
ds_read_b128 v[16:19], v3 offset:9728
buffer_load_dword v11, v8, s[8:11], s82 offen sc1
v_smfmac_f32_16x16x64_bf16 v[24:27], v[20:23], v[168:175], v0
ds_read_b128 v[40:43], v2 offset:10240
v_smfmac_f32_16x16x64_bf16 v[28:31], v[20:23], v[176:183], v0
ds_read_b128 v[44:47], v2 offset:11264
v_smfmac_f32_16x16x64_bf16 v[32:35], v[20:23], v[184:191], v0
s_waitcnt lgkmcnt(3)
v_smfmac_f32_16x16x64_bf16 v[36:39], v[20:23], v[48:55], v0
ds_read_b128 v[20:23], v3 offset:11776
v_smfmac_f32_16x16x64_bf16 v[24:27], v[12:15], v[192:199], v0
ds_read_b128 v[48:51], v2 offset:12288
v_smfmac_f32_16x16x64_bf16 v[28:31], v[12:15], v[200:207], v0
ds_read_b128 v[52:55], v2 offset:13312
v_smfmac_f32_16x16x64_bf16 v[32:35], v[12:15], v[208:215], v0
s_waitcnt lgkmcnt(3)
v_smfmac_f32_16x16x64_bf16 v[36:39], v[12:15], v[40:47], v0
ds_read_b128 v[12:15], v3 offset:3584
v_smfmac_f32_16x16x64_bf16 v[24:27], v[16:19], v[216:223], v0
ds_read_b128 v[40:43], v2 offset:16384
v_smfmac_f32_16x16x64_bf16 v[28:31], v[16:19], v[224:231], v0
ds_read_b128 v[44:47], v2 offset:17408
v_smfmac_f32_16x16x64_bf16 v[32:35], v[16:19], v[232:239], v0
s_waitcnt lgkmcnt(3)
v_smfmac_f32_16x16x64_bf16 v[36:39], v[16:19], v[48:55], v0
ds_read_b128 v[16:19], v3 offset:4608
v_smfmac_f32_16x16x64_bf16 v[24:27], v[20:23], a[8:15], v0
ds_read_b128 v[52:55], v3 offset:18944
v_smfmac_f32_16x16x64_bf16 v[28:31], v[20:23], a[16:23], v0
ds_read_b128 v[48:51], v3 offset:16896
v_smfmac_f32_16x16x64_bf16 v[32:35], v[20:23], a[24:31], v0
s_waitcnt lgkmcnt(3)
v_smfmac_f32_16x16x64_bf16 v[36:39], v[20:23], v[40:47], v0
ds_read_b128 v[20:23], v3 offset:5632
s_nop 0
v_add_f32 v24, v24, v25
v_smfmac_f32_16x16x64_bf16 v[56:59], v[12:15], a[32:39], v0
ds_read_b128 v[40:43], v3 offset:12800
v_add_f32 v26, v26, v27
v_add_f32 v28, v28, v29
v_add_f32 v30, v30, v31
v_mul_f32 v24, s18, v24
v_smfmac_f32_16x16x64_bf16 v[60:63], v[12:15], a[40:47], v0
ds_read_b128 v[12:15], v3 offset:7680
v_mul_f32 v28, s18, v28
v_mul_f32 v26, s18, v26
v_mul_f32 v30, s18, v30
v_cvt_pk_bf16_f32 v24, v24, v28
s_waitcnt lgkmcnt(5)
v_smfmac_f32_16x16x64_bf16 v[56:59], v[16:19], a[48:55], v0
ds_read_b128 v[44:47], v3 offset:14848
v_cvt_pk_bf16_f32 v26, v26, v30
ds_write2_b32 v1, v24, v26 offset1:32
v_add_f32 v32, v32, v33
v_add_f32 v34, v34, v35
v_smfmac_f32_16x16x64_bf16 v[60:63], v[16:19], a[56:63], v0
ds_read_b128 v[16:19], v3 offset:8704
v_add_f32 v36, v36, v37
v_add_f32 v38, v38, v39
v_cvt_pk_bf16_f32 v1, v32, v36
v_cvt_pk_bf16_f32 v8, v34, v38
s_waitcnt lgkmcnt(5)
v_smfmac_f32_16x16x64_bf16 v[56:59], v[20:23], a[64:71], v0
ds_write2_b32 v4, v1, v8 offset1:32
v_smfmac_f32_16x16x64_bf16 v[60:63], v[20:23], a[72:79], v0
s_waitcnt lgkmcnt(4)
ds_read_b128 v[20:23], v3 offset:9728
v_smfmac_f32_16x16x64_bf16 v[56:59], v[12:15], a[96:103], v0
v_smfmac_f32_16x16x64_bf16 v[60:63], v[12:15], a[104:111], v0
s_waitcnt lgkmcnt(2)
ds_read_b128 v[12:15], v3 offset:11776
v_smfmac_f32_16x16x64_bf16 v[56:59], v[16:19], a[112:119], v0
v_smfmac_f32_16x16x64_bf16 v[60:63], v[16:19], a[120:127], v0
s_waitcnt lgkmcnt(2)
s_barrier
ds_read_b128 v[36:39], v5 offset:1536
s_waitcnt lgkmcnt(2)
v_smfmac_f32_16x16x64_bf16 v[56:59], v[20:23], a[128:135], v0
ds_read_b128 v[24:27], v5
v_smfmac_f32_16x16x64_bf16 v[60:63], v[20:23], a[136:143], v0
s_waitcnt lgkmcnt(2)
ds_read_b128 v[28:31], v5 offset:512
v_smfmac_f32_16x16x64_bf16 v[56:59], v[12:15], a[160:167], v0
ds_read_b128 v[32:35], v5 offset:1024
v_smfmac_f32_16x16x64_bf16 v[60:63], v[12:15], a[168:175], v0
s_waitcnt lgkmcnt(3)
v_mfma_f32_16x16x32_bf16 v[16:19], v[52:55], v[36:39], 0
s_waitcnt lgkmcnt(2)
ds_read_b128 v[52:55], v3 offset:19968
v_mfma_f32_16x16x32_bf16 v[16:19], v[40:43], v[24:27], v[16:19]
s_waitcnt lgkmcnt(2)
ds_read_b128 v[40:43], v3 offset:13824
v_mfma_f32_16x16x32_bf16 v[16:19], v[44:47], v[28:31], v[16:19]
s_waitcnt lgkmcnt(2)
ds_read_b128 v[44:47], v3 offset:15872
v_add_f32 v56, v56, v57
v_mfma_f32_16x16x32_bf16 v[16:19], v[48:51], v[32:35], v[16:19]
ds_read_b128 v[48:51], v3 offset:17920
v_add_f32 v58, v58, v59
v_mfma_f32_16x16x32_bf16 v[20:23], v[36:39], v[36:39], 0
s_add_u32 s49, s28, s23
v_add_f32 v60, v60, v61
v_add_f32 v62, v62, v63
v_mfma_f32_16x16x32_bf16 v[20:23], v[24:27], v[24:27], v[20:23]
s_add_u32 s50, s28, 65536
v_cvt_pk_bf16_f32 v56, v56, v58
v_cvt_pk_bf16_f32 v57, v60, v62
v_mfma_f32_16x16x32_bf16 v[20:23], v[28:31], v[28:31], v[20:23]
s_add_u32 s51, s28, 131072
v_mov_b32 v58, v1
v_mov_b32 v59, v8
v_exp_f32 v16, v16
v_mfma_f32_16x16x32_bf16 v[20:23], v[32:35], v[32:35], v[20:23]
s_waitcnt lgkmcnt(3)
v_exp_f32 v17, v17
v_mfma_f32_16x16x32_bf16 v[12:15], v[52:55], v[36:39], 0
s_waitcnt lgkmcnt(2)
v_exp_f32 v18, v18
v_mfma_f32_16x16x32_bf16 v[12:15], v[40:43], v[24:27], v[12:15]
s_waitcnt lgkmcnt(1)
v_exp_f32 v19, v19
buffer_store_dwordx4 v[56:59], v3, s[8:11], s31 offen sc1
v_mfma_f32_16x16x32_bf16 v[12:15], v[44:47], v[28:31], v[12:15]
s_waitcnt lgkmcnt(0)
v_exp_f32 v20, v20
v_mfma_f32_16x16x32_bf16 v[12:15], v[48:51], v[32:35], v[12:15]
s_add_u32 s52, s28, 196608
v_exp_f32 v21, v21
v_mov_b64 v[60:61], s[14:15]
v_cvt_pk_bf16_f32 v23, v20, v21
v_cvt_pk_bf16_f32 v20, v20, v21
v_mov_b32 v21, 0
v_mov_b32 v22, 0
v_cvt_pk_bf16_f32 v16, v16, v17
v_cvt_pk_bf16_f32 v17, v18, v19
v_mfma_f32_16x16x16_bf16 v[24:27], v[56:57], v[20:21], 0
v_exp_f32 v12, v12
v_mfma_f32_16x16x16_bf16 v[28:31], v[56:57], v[22:23], 0
v_exp_f32 v13, v13
v_mfma_f32_16x16x16_bf16 v[32:35], v[60:61], v[20:21], 0
v_exp_f32 v14, v14
v_exp_f32 v15, v15
v_mov_b64 v[62:63], s[14:15]
v_cvt_pk_bf16_f32 v18, v12, v13
v_cvt_pk_bf16_f32 v19, v14, v15
s_waitcnt vmcnt(3)
ds_read_b128 v[40:43], v2 offset:18432
v_mfma_f32_16x16x32_bf16 v[32:35], v[60:63], v[16:19], v[32:35]
ds_read_b128 v[44:47], v2 offset:19456
v_mov_b32 v20, 0
v_mfma_f32_16x16x32_bf16 v[24:27], v[64:67], v[16:19], v[24:27]
ds_read_b128 v[48:51], v2 offset:20480
v_mov_b32 v23, 0
v_mfma_f32_16x16x32_bf16 v[28:31], v[68:71], v[16:19], v[28:31]
ds_read_b128 v[52:55], v2 offset:21504
v_mov_b32 v15, 0
v_rcp_f32 v12, v32
v_subrev_u32 v14, 0x21800000, v32
v_cmp_le_u32 vcc, 0x3c000000, v14
v_pk_mul_f32 v[24:25], v[24:25], v[12:13] op_sel_hi:[1,0]
v_pk_mul_f32 v[26:27], v[26:27], v[12:13] op_sel_hi:[1,0]
ds_read_b128 v[32:35], v2 offset:22528
v_pk_mul_f32 v[28:29], v[28:29], v[12:13] op_sel_hi:[1,0]
v_pk_mul_f32 v[30:31], v[30:31], v[12:13] op_sel_hi:[1,0]
v_cvt_pk_bf16_f32 v24, v24, v28
v_cvt_pk_bf16_f32 v25, v25, v29
v_cvt_pk_bf16_f32 v26, v26, v30
v_cvt_pk_bf16_f32 v27, v27, v31
v_mfma_f32_16x16x32_bf16 v[16:19], v[20:23], v[20:23], 0
ds_write_b128 v7, v[24:27]
v_mfma_f32_16x16x32_bf16 v[12:15], v[20:23], v[20:23], 0
s_andn2_b64 vcc, vcc, s[86:87]
ds_read_b128 v[36:39], v2 offset:23552
s_cbranch_scc1 L_sm3
L_smr3:
v_mfma_f32_16x16x32_bf16 v[56:59], v[20:23], v[20:23], 0
v_mov_b32 v1, 6528
v_and_b32 v8, 0x380, v3
s_add_u32 s20, s30, 527360
v_add_u32 v8, v8, v3
s_mov_b32 m0, 22016
s_cmp_eq_u32 s19, 63
s_cbranch_scc1 L_texit
s_waitcnt lgkmcnt(0)
s_barrier
ds_read_b128 v[24:27], v3 offset:1152
v_mfma_f32_16x16x32_bf16 v[64:67], v[20:23], v[20:23], 0
ds_read_b128 v[28:31], v3 offset:2176
v_mfma_f32_16x16x32_bf16 v[60:63], v[20:23], v[20:23], 0
v_mfma_f32_16x16x32_bf16 v[68:71], v[20:23], v[20:23], 0
s_waitcnt lgkmcnt(1)
v_smfmac_f32_16x16x64_bf16 v[12:15], v[24:27], a[248:255], v0
buffer_load_dwordx4 v8, s[8:11], s20 offen sc1 lds
v_smfmac_f32_16x16x64_bf16 v[16:19], v[24:27], a[176:183], v0
s_mov_b32 m0, 22912
s_waitcnt lgkmcnt(0)
v_smfmac_f32_16x16x64_bf16 v[12:15], v[28:31], v[40:47], v0
ds_read_b128 v[40:43], v2 offset:24576
v_smfmac_f32_16x16x64_bf16 v[16:19], v[28:31], v[48:55], v0
ds_read_b128 v[44:47], v2 offset:25600
buffer_load_dwordx4 v8, s[8:11], s20 offen offset:128 sc1 lds
v_smfmac_f32_16x16x64_bf16 v[20:23], v[24:27], a[184:191], v0
ds_read_b128 v[48:51], v2 offset:26624
s_nop 1
v_add_f32 v12, v12, v13
v_add_f32 v14, v14, v15
v_cvt_pk_bf16_f32 v12, v12, v14
v_smfmac_f32_16x16x64_bf16 v[20:23], v[28:31], v[32:39], v0
ds_read_b128 v[52:55], v2 offset:27648
buffer_store_dword v12, v10, s[8:11], s28 offen
v_add_f32 v16, v16, v17
v_add_f32 v18, v18, v19
v_smfmac_f32_16x16x64_bf16 v[56:59], v[24:27], a[192:199], v0
s_waitcnt lgkmcnt(2)
ds_read_b128 v[32:35], v2 offset:28672
v_cvt_pk_bf16_f32 v16, v16, v18
v_smfmac_f32_16x16x64_bf16 v[56:59], v[28:31], v[40:47], v0
ds_read_b128 v[36:39], v2 offset:29696
v_add_f32 v20, v20, v21
v_add_f32 v22, v22, v23
v_cvt_pk_bf16_f32 v17, v20, v22
v_smfmac_f32_16x16x64_bf16 v[60:63], v[24:27], a[200:207], v0
s_waitcnt lgkmcnt(2)
ds_read_b128 v[12:15], v1
buffer_store_dwordx2 v[16:17], v9, s[8:11], s28 offen
v_smfmac_f32_16x16x64_bf16 v[60:63], v[28:31], v[48:55], v0
ds_read_b128 v[40:43], v2 offset:30720
v_add_f32 v56, v56, v57
v_add_f32 v58, v58, v59
v_cvt_pk_bf16_f32 v56, v56, v58
v_smfmac_f32_16x16x64_bf16 v[64:67], v[24:27], a[208:215], v0
s_waitcnt lgkmcnt(2)
ds_read_b128 v[44:47], v2 offset:31744
v_smfmac_f32_16x16x64_bf16 v[64:67], v[28:31], v[32:39], v0
ds_read_b128 v[20:23], v1
v_add_f32 v60, v60, v61
v_add_f32 v62, v62, v63
v_cvt_pk_bf16_f32 v57, v60, v62
v_smfmac_f32_16x16x64_bf16 v[68:71], v[24:27], a[216:223], v0
s_waitcnt lgkmcnt(1)
ds_read_b128 v[48:51], v2 offset:32768
buffer_store_dwordx2 v[56:57], v9, s[8:11], s50 offen
v_smfmac_f32_16x16x64_bf16 v[68:71], v[28:31], v[40:47], v0
ds_read_b128 v[52:55], v2 offset:33792
v_add_f32 v64, v64, v65
v_add_f32 v66, v66, v67
v_cvt_pk_bf16_f32 v64, v64, v66
v_smfmac_f32_16x16x64_bf16 v[12:15], v[24:27], a[224:231], v0
s_waitcnt lgkmcnt(0)
v_smfmac_f32_16x16x64_bf16 v[12:15], v[28:31], v[48:55], v0
s_nop 0
v_add_f32 v68, v68, v69
v_add_f32 v70, v70, v71
v_cvt_pk_bf16_f32 v65, v68, v70
v_smfmac_f32_16x16x64_bf16 v[20:23], v[24:27], a[232:239], v0
buffer_store_dwordx2 v[64:65], v9, s[8:11], s51 offen
v_smfmac_f32_16x16x64_bf16 v[20:23], v[28:31], a[240:247], v0
s_nop 0
v_add_f32 v12, v12, v13
v_add_f32 v14, v14, v15
v_cvt_pk_bf16_f32 v12, v12, v14
s_nop 3
v_add_f32 v20, v20, v21
v_add_f32 v22, v22, v23
v_cvt_pk_bf16_f32 v13, v20, v22
buffer_store_dwordx2 v[12:13], v9, s[8:11], s52 offen
s_add_u32 s19, s19, 1
s_mov_b32 s20, s28
s_mov_b32 s28, s29
s_mov_b32 s29, s20
s_and_b32 s20, s19, 3
s_lshl_b32 s20, s20, 14
s_add_u32 s33, s20, 109641728
s_add_u32 s34, s20, s24
s_xor_b32 s20, s20, 32768
s_add_u32 s35, s20, s24
s_add_u32 s30, s30, 524288
s_add_u32 s31, s31, 131072
s_add_u32 s6, s33, 4096
s_add_u32 s7, s33, 8192
s_mov_b32 s22, 0
v_mov_b64 v[24:25], 0
v_mov_b64 v[26:27], 0
v_mov_b64 v[28:29], 0
v_mov_b64 v[30:31], 0
v_and_b32 v70, 0xf40, v3
v_add_u32 v70, v70, v3
v_bfe_u32 v71, v3, 7, 1
v_mad_i32_i24 v70, v71, s4, v70
v_mov_b64 v[64:65], -1
v_mov_b64 v[66:67], -1
v_add_u32 v1, 2112, v4
ds_read_b128 v[48:51], v2 offset:14336
ds_read_b128 v[52:55], v2 offset:15360
v_lshrrev_b32 v8, 2, v3
s_add_u32 s20, s19, 1
s_lshr_b32 s20, s20, 3
s_min_u32 s20, s20, 7
s_cmp_lt_u32 s19, 3
s_cselect_b32 s20, 8, s20
s_waitcnt vmcnt(8)
L_kvw:
v_readlane_b32 s21, v11, s20
s_nop 0
s_cmp_eq_u32 s21, 1
s_cbranch_scc0 L_kvp
s_barrier
s_branch L_gat3
L_g3r3:
buffer_load_dwordx4 v[16:19], v3, s[8:11], s6 offen sc1
s_add_u32 s22, s22, 1
s_waitcnt vmcnt(1)
v_max3_u32 v21, v16, v17, v18
v_max_u32 v21, v21, v19
v_cmp_le_u32 vcc, 0xffff0000, v21
s_cmp_gt_u32 s22, 200000
s_cbranch_vccz L_g33
s_cbranch_scc0 L_g3r3
s_branch L_end
L_sm3:
s_waitcnt lgkmcnt(0)
ds_read_b128 v[24:27], v5
ds_read_b128 v[40:43], v3 offset:12800
ds_read_b128 v[28:31], v5 offset:512
ds_read_b128 v[44:47], v3 offset:14848
ds_read_b128 v[32:35], v5 offset:1024
ds_read_b128 v[48:51], v3 offset:16896
ds_read_b128 v[36:39], v5 offset:1536
ds_read_b128 v[52:55], v3 offset:18944
s_waitcnt lgkmcnt(0)
v_mfma_f32_16x16x32_bf16 v[16:19], v[40:43], v[24:27], 0
ds_read_b128 v[40:43], v3 offset:13824
v_mfma_f32_16x16x32_bf16 v[16:19], v[44:47], v[28:31], v[16:19]
ds_read_b128 v[44:47], v3 offset:15872
v_mfma_f32_16x16x32_bf16 v[16:19], v[48:51], v[32:35], v[16:19]
ds_read_b128 v[48:51], v3 offset:17920
v_mfma_f32_16x16x32_bf16 v[16:19], v[52:55], v[36:39], v[16:19]
ds_read_b128 v[52:55], v3 offset:19968
v_mfma_f32_16x16x32_bf16 v[20:23], v[24:27], v[24:27], 0
v_mfma_f32_16x16x32_bf16 v[20:23], v[28:31], v[28:31], v[20:23]
v_mfma_f32_16x16x32_bf16 v[20:23], v[32:35], v[32:35], v[20:23]
v_mfma_f32_16x16x32_bf16 v[20:23], v[36:39], v[36:39], v[20:23]
s_waitcnt lgkmcnt(0)
v_mfma_f32_16x16x32_bf16 v[12:15], v[40:43], v[24:27], 0
v_mfma_f32_16x16x32_bf16 v[12:15], v[44:47], v[28:31], v[12:15]
v_mfma_f32_16x16x32_bf16 v[12:15], v[48:51], v[32:35], v[12:15]
v_mfma_f32_16x16x32_bf16 v[12:15], v[52:55], v[36:39], v[12:15]
v_max3_f32 v59, v16, v17, v18
s_nop 1
v_max3_f32 v59, v59, v19, v20
s_nop 3
v_max3_f32 v59, v59, v21, v12
v_max3_f32 v59, v59, v13, v14
v_max_f32 v59, v59, v15
v_mov_b32 v22, v59
s_nop 1
v_permlane32_swap_b32 v22, v59
v_max_f32 v59, v59, v22
v_mov_b32 v22, v59
s_nop 1
v_permlane16_swap_b32 v22, v59
v_max_f32 v59, v59, v22
v_sub_f32 v20, v20, v59
v_sub_f32 v21, v21, v59
v_sub_f32 v16, v16, v59
v_sub_f32 v17, v17, v59
v_sub_f32 v18, v18, v59
v_sub_f32 v19, v19, v59
v_sub_f32 v12, v12, v59
v_sub_f32 v13, v13, v59
v_sub_f32 v14, v14, v59
v_sub_f32 v15, v15, v59
v_exp_f32 v20, v20
v_exp_f32 v21, v21
v_exp_f32 v16, v16
v_exp_f32 v17, v17
v_exp_f32 v18, v18
v_exp_f32 v19, v19
v_exp_f32 v12, v12
v_exp_f32 v13, v13
v_exp_f32 v14, v14
v_exp_f32 v15, v15
v_cvt_pk_bf16_f32 v23, v20, v21
v_cvt_pk_bf16_f32 v20, v20, v21
v_mov_b32 v21, 0
v_mov_b32 v22, 0
v_cvt_pk_bf16_f32 v16, v16, v17
v_cvt_pk_bf16_f32 v17, v18, v19
v_cvt_pk_bf16_f32 v18, v12, v13
v_cvt_pk_bf16_f32 v19, v14, v15
v_mfma_f32_16x16x16_bf16 v[24:27], v[56:57], v[20:21], 0
v_mfma_f32_16x16x16_bf16 v[28:31], v[56:57], v[22:23], 0
v_mfma_f32_16x16x16_bf16 v[32:35], v[60:61], v[20:21], 0
ds_read_b128 v[40:43], v2 offset:18432
v_mfma_f32_16x16x32_bf16 v[32:35], v[60:63], v[16:19], v[32:35]
ds_read_b128 v[44:47], v2 offset:19456
v_mov_b32 v20, 0
v_mfma_f32_16x16x32_bf16 v[24:27], v[64:67], v[16:19], v[24:27]
ds_read_b128 v[48:51], v2 offset:20480
v_mov_b32 v23, 0
v_mfma_f32_16x16x32_bf16 v[28:31], v[68:71], v[16:19], v[28:31]
ds_read_b128 v[52:55], v2 offset:21504
v_mov_b32 v15, 0
v_rcp_f32 v12, v32
v_subrev_u32 v14, 0x21800000, v32
v_cmp_le_u32 vcc, 0x3c000000, v14
v_pk_mul_f32 v[24:25], v[24:25], v[12:13] op_sel_hi:[1,0]
v_pk_mul_f32 v[26:27], v[26:27], v[12:13] op_sel_hi:[1,0]
ds_read_b128 v[32:35], v2 offset:22528
v_pk_mul_f32 v[28:29], v[28:29], v[12:13] op_sel_hi:[1,0]
v_pk_mul_f32 v[30:31], v[30:31], v[12:13] op_sel_hi:[1,0]
v_cvt_pk_bf16_f32 v24, v24, v28
v_cvt_pk_bf16_f32 v25, v25, v29
v_cvt_pk_bf16_f32 v26, v26, v30
v_cvt_pk_bf16_f32 v27, v27, v31
v_mfma_f32_16x16x32_bf16 v[16:19], v[20:23], v[20:23], 0
ds_write_b128 v7, v[24:27]
v_mfma_f32_16x16x32_bf16 v[12:15], v[20:23], v[20:23], 0
ds_read_b128 v[36:39], v2 offset:23552
s_branch L_smr3
L_kvp:
buffer_load_dword v11, v8, s[8:11], s82 offen sc1
s_add_u32 s22, s22, 1
s_cmp_gt_u32 s22, 200000
s_cbranch_scc1 L_end
s_waitcnt vmcnt(0)
s_branch L_kvw
L_texit:
s_lshl_b32 s61, s16, 7
s_add_u32 s61, s61, 111153152
s_waitcnt vmcnt(0)
s_barrier
s_cmp_lg_u32 s17, 0
s_cbranch_scc1 L_sf_63
v_mov_b32 v20, 0
v_mov_b32 v21, 64
s_mov_b64 exec, 1
buffer_store_dword v21, v20, s[8:11], s61 offen sc1
s_mov_b64 exec, -1
L_sf_63:
L_done:
L_end:
s_endpgm
.section .rodata,"a"
.p2align 6
.amdhsa_kernel concat_heads__compressed_kv_cla__memory_aug_recurrent_mem_tr__prompt_kernel
  .amdhsa_next_free_vgpr 512
  .amdhsa_next_free_sgpr 102
  .amdhsa_accum_offset 256
  .amdhsa_group_segment_fixed_size 0
  .amdhsa_kernarg_size 128
  .amdhsa_user_sgpr_count 2
  .amdhsa_user_sgpr_kernarg_segment_ptr 1
  .amdhsa_system_sgpr_workgroup_id_x 1
.end_amdhsa_kernel
```
